```python
import torch

def _softmax(x, axis=-1):
    return torch.softmax(x, dim=axis)

def _gelu(x):
    return torch.nn.functional.gelu(x, approximate='tanh')

def _silu(x):
    return torch.nn.functional.silu(x)

def _sigmoid(x):
    return torch.sigmoid(x)

def _layernorm(x, axis=-1, eps=1e-05):
    m = x.mean(dim=axis, keepdim=True)
    v = x.var(dim=axis, keepdim=True, unbiased=False)
    return (x - m) / torch.sqrt(v + eps)

def _scatter_add(tgt, idx, src, axis=0):
    return tgt.clone().index_add_(axis, idx, src)

def _segment_sum(src, seg, n):
    out = torch.zeros((n,) + src.shape[1:], dtype=src.dtype)
    return out.index_add_(0, seg, src)

def _pad(x, pw):
    flat = tuple((v for pair in reversed(pw) for v in pair))
    return torch.nn.functional.pad(x, flat)
kernel_name = 'sequential_preLN__memory_aug_recurrent_mem_tr__moe_arch_mod__prompt'

def setup_inputs():

    _w = lambda a: (lambda t: t.to(torch.bfloat16) if t.is_floating_point() else t)(torch.as_tensor(a))

    def _A_setup():
        B, S, Dm = (1, 2048, 512)
        H, Dh = (32, 128)
        M, seg = (8, 32)
        seg = min(seg, S)
        S = S // seg * seg
        return {'x': _w((lambda *s: torch.randn(*s, dtype=torch.bfloat16) * 0.05)(B, S, Dm)), 'mem0': _w((lambda *s: torch.randn(*s, dtype=torch.bfloat16) * 0.2)(B, M, Dm)), 'Wq': _w((lambda *s: torch.randn(*s, dtype=torch.bfloat16) * 1.6)(Dm, H, Dh) * Dm ** (-0.5)), 'Wk': _w((lambda *s: torch.randn(*s, dtype=torch.bfloat16) * 1.6)(Dm, H, Dh) * Dm ** (-0.5)), 'Wv': _w((lambda *s: torch.randn(*s, dtype=torch.bfloat16) * 0.2)(Dm, H, Dh) * Dm ** (-0.5)), 'Wo': _w((lambda *s: torch.randn(*s, dtype=torch.bfloat16) * 0.2)(H, Dh, Dm) * (H * Dh) ** (-0.5)), 'seg_len': seg}
    _A_in = _A_setup()

    def _B_setup():
        B, S, D, F, C = (1, 2048, 512, 1792, 2)
        return {'x': _w((lambda *s: torch.randn(*s, dtype=torch.bfloat16) * 0.05)(B, S, D)), 'w_r': _w((lambda *s: torch.randn(*s, dtype=torch.bfloat16) * 0.05)(D)), 'w_gate': _w((lambda *s: torch.randn(*s, dtype=torch.bfloat16) * 0.05)(D, F)), 'w_up': _w((lambda *s: torch.randn(*s, dtype=torch.bfloat16) * 0.05)(D, F)), 'w_down': _w((lambda *s: torch.randn(*s, dtype=torch.bfloat16) * 0.05)(F, D))}
    _B_in = _B_setup()
    return {'A_x': _A_in['x'], 'A_mem0': _A_in['mem0'], 'A_Wq': _A_in['Wq'], 'A_Wk': _A_in['Wk'], 'A_Wv': _A_in['Wv'], 'A_Wo': _A_in['Wo'], 'A_seg_len': _A_in['seg_len'], 'B_x': _B_in['x'], 'B_w_r': _B_in['w_r'], 'B_w_gate': _B_in['w_gate'], 'B_w_up': _B_in['w_up'], 'B_w_down': _B_in['w_down']}

def reference(A_x, A_mem0, A_Wq, A_Wk, A_Wv, A_Wo, A_seg_len, B_x, B_w_r, B_w_gate, B_w_up, B_w_down):

    def _A_ref(x, mem0, Wq, Wk, Wv, Wo, seg_len):
        B, S, Dm = x.shape
        H, Dh = (Wq.shape[1], Wq.shape[2])
        M = mem0.shape[1]
        scale = Dh ** (-0.5)
        n_seg = S // seg_len
        L = M + seg_len
        idx = torch.arange(L)
        mask = (idx[:, None] < M) | (idx[:, None] >= idx[None, :])
        mem = mem0
        outs = []
        for s in range(n_seg):
            xs = x[:, s * seg_len:(s + 1) * seg_len, :].clone()
            h = torch.concatenate([mem, xs], axis=1)
            q = torch.einsum('btd,dhe->bhte', h, Wq)
            k = torch.einsum('btd,dhe->bhte', h, Wk)
            v = torch.einsum('btd,dhe->bhte', h, Wv)
            scores = torch.einsum('bhqe,bhke->bhqk', q, k) * scale
            scores = torch.where(mask[None, None], scores, -1000000000.0)
            p = _softmax(scores, axis=-1)
            o = torch.einsum('bhqk,bhke->bhqe', p, v)
            o = torch.einsum('bhte,hed->btd', o, Wo)
            mem = o[:, :M, :].clone()
            outs.append(o[:, M:, :])
        return torch.concatenate(outs, axis=1)

    def _B_ref(x, w_r, w_gate, w_up, w_down):
        B, S, D = x.shape
        C = 2
        r = x @ w_r
        idx = torch.argsort(-r, axis=-1)[:, :C]
        idx_e = (lambda x, n, axis: torch.repeat_interleave(x, n, dim=axis))(idx.reshape(B, C, 1), D, axis=2)
        x_sel = (lambda x, i, axis: torch.take_along_dim(x, i, dim=axis))(x, idx_e, axis=1)
        g = _silu(x_sel @ w_gate)
        u = x_sel @ w_up
        y = g * u @ w_down
        r_sel = _sigmoid((lambda x, i, axis: torch.take_along_dim(x, i, dim=axis))(r, idx, axis=1))
        y = y * r_sel.reshape(B, C, 1)
        b_off = (torch.arange(B) * S).reshape(B, 1)
        flat_idx = (idx + b_off).reshape(B * C)
        zero = (x * 0.0).reshape(B * S, D)
        upd = _scatter_add(zero, flat_idx, y.reshape(B * C, D), axis=0)
        return x + upd.reshape(B, S, D)
    x = A_x
    h = x + _A_ref(_layernorm(x, axis=-1), A_mem0, A_Wq, A_Wk, A_Wv, A_Wo, A_seg_len)
    h2 = h + _B_ref(_layernorm(h, axis=-1), B_w_r, B_w_gate, B_w_up, B_w_down)
    return h2
```

```asm
; @launch kernel=sequential_preLN__memory_aug_recurrent_mem_tr__moe_arch_mod__prompt_kernel grid=(256,1,1) block=(256,1,1) lds=163840
; @launch kernel=route_up_kernel grid=(112,1,1) block=(256,1,1) lds=2048
; @launch kernel=down_kernel grid=(32,1,1) block=(256,1,1) lds=1024
.amdgcn_target "amdgcn-amd-amdhsa--gfx950"
.text
.globl route_up_kernel
.p2align 8
.type route_up_kernel,@function
route_up_kernel:
    s_cmp_ge_u32 s2, 112
    s_cbranch_scc1 L_k2_end
    s_load_dwordx4 s[20:23], s[0:1], 72
    s_load_dwordx2 s[24:25], s[0:1], 112
    v_lshrrev_b32 v1, 3, v0
    v_and_b32 v2, 7, v0
    s_waitcnt lgkmcnt(0)
    s_mov_b32 s8, s24
    s_and_b32 s9, s25, 0xffff
    s_mov_b32 s10, 0x10000000
    s_mov_b32 s11, 0x20000
    s_mov_b32 s12, s20
    s_and_b32 s13, s21, 0xffff
    s_mov_b32 s14, 0x1c0000
    s_mov_b32 s15, 0x20000
    s_mov_b32 s16, s22
    s_and_b32 s17, s23, 0xffff
    s_mov_b32 s18, 0x1c0000
    s_mov_b32 s19, 0x20000
    v_lshlrev_b32 v3, 4, v0
    s_mov_b32 s26, 0x194000
    buffer_load_dwordx4 v[64:67], v3, s[8:11], s26 offen
    s_mov_b32 s26, 0x195000
    buffer_load_dwordx4 v[68:71], v3, s[8:11], s26 offen
    s_mov_b32 s26, 0x196000
    buffer_load_dwordx4 v[72:75], v3, s[8:11], s26 offen
    s_mov_b32 s26, 0x197000
    buffer_load_dwordx4 v[76:79], v3, s[8:11], s26 offen
    s_mov_b32 s26, 0x198000
    buffer_load_dwordx4 v[80:83], v3, s[8:11], s26 offen
    s_mov_b32 s26, 0x199000
    buffer_load_dwordx4 v[84:87], v3, s[8:11], s26 offen
    s_mov_b32 s26, 0x19a000
    buffer_load_dwordx4 v[88:91], v3, s[8:11], s26 offen
    s_mov_b32 s26, 0x19b000
    buffer_load_dwordx4 v[92:95], v3, s[8:11], s26 offen
    s_mov_b32 s26, 57344
    v_mul_lo_u32 v4, v1, s26
    v_lshl_add_u32 v4, v2, 2, v4
    s_lshl_b32 s27, s2, 5
    s_add_u32 s26, s27, 0
    buffer_load_dword v16, v4, s[12:15], s26 offen
    buffer_load_dword v32, v4, s[16:19], s26 offen
    s_add_u32 s26, s27, 3584
    buffer_load_dword v17, v4, s[12:15], s26 offen
    buffer_load_dword v33, v4, s[16:19], s26 offen
    s_add_u32 s26, s27, 7168
    buffer_load_dword v18, v4, s[12:15], s26 offen
    buffer_load_dword v34, v4, s[16:19], s26 offen
    s_add_u32 s26, s27, 10752
    buffer_load_dword v19, v4, s[12:15], s26 offen
    buffer_load_dword v35, v4, s[16:19], s26 offen
    s_add_u32 s26, s27, 14336
    buffer_load_dword v20, v4, s[12:15], s26 offen
    buffer_load_dword v36, v4, s[16:19], s26 offen
    s_add_u32 s26, s27, 17920
    buffer_load_dword v21, v4, s[12:15], s26 offen
    buffer_load_dword v37, v4, s[16:19], s26 offen
    s_add_u32 s26, s27, 21504
    buffer_load_dword v22, v4, s[12:15], s26 offen
    buffer_load_dword v38, v4, s[16:19], s26 offen
    s_add_u32 s26, s27, 25088
    buffer_load_dword v23, v4, s[12:15], s26 offen
    buffer_load_dword v39, v4, s[16:19], s26 offen
    s_add_u32 s26, s27, 28672
    buffer_load_dword v24, v4, s[12:15], s26 offen
    buffer_load_dword v40, v4, s[16:19], s26 offen
    s_add_u32 s26, s27, 32256
    buffer_load_dword v25, v4, s[12:15], s26 offen
    buffer_load_dword v41, v4, s[16:19], s26 offen
    s_add_u32 s26, s27, 35840
    buffer_load_dword v26, v4, s[12:15], s26 offen
    buffer_load_dword v42, v4, s[16:19], s26 offen
    s_add_u32 s26, s27, 39424
    buffer_load_dword v27, v4, s[12:15], s26 offen
    buffer_load_dword v43, v4, s[16:19], s26 offen
    s_add_u32 s26, s27, 43008
    buffer_load_dword v28, v4, s[12:15], s26 offen
    buffer_load_dword v44, v4, s[16:19], s26 offen
    s_add_u32 s26, s27, 46592
    buffer_load_dword v29, v4, s[12:15], s26 offen
    buffer_load_dword v45, v4, s[16:19], s26 offen
    s_add_u32 s26, s27, 50176
    buffer_load_dword v30, v4, s[12:15], s26 offen
    buffer_load_dword v46, v4, s[16:19], s26 offen
    s_add_u32 s26, s27, 53760
    buffer_load_dword v31, v4, s[12:15], s26 offen
    buffer_load_dword v47, v4, s[16:19], s26 offen
    s_waitcnt vmcnt(32)
    v_add_f32 v64, v64, v65
    v_add_f32 v66, v66, v67
    v_add_f32 v64, v64, v66
    v_cvt_pk_bf16_f32 v5, v64, v64
    v_lshlrev_b32 v64, 16, v5
    v_ashrrev_i32 v5, 31, v64
    v_or_b32 v5, 0x80000000, v5
    v_xor_b32 v5, v5, v64
    v_and_b32 v5, 0xffff0000, v5
    v_sub_u32 v6, 2047, v0
    v_or_b32 v48, v5, v6
    v_add_f32 v68, v68, v69
    v_add_f32 v70, v70, v71
    v_add_f32 v68, v68, v70
    v_cvt_pk_bf16_f32 v5, v68, v68
    v_lshlrev_b32 v68, 16, v5
    v_ashrrev_i32 v5, 31, v68
    v_or_b32 v5, 0x80000000, v5
    v_xor_b32 v5, v5, v68
    v_and_b32 v5, 0xffff0000, v5
    v_sub_u32 v6, 1791, v0
    v_or_b32 v49, v5, v6
    v_add_f32 v72, v72, v73
    v_add_f32 v74, v74, v75
    v_add_f32 v72, v72, v74
    v_cvt_pk_bf16_f32 v5, v72, v72
    v_lshlrev_b32 v72, 16, v5
    v_ashrrev_i32 v5, 31, v72
    v_or_b32 v5, 0x80000000, v5
    v_xor_b32 v5, v5, v72
    v_and_b32 v5, 0xffff0000, v5
    v_sub_u32 v6, 1535, v0
    v_or_b32 v50, v5, v6
    v_add_f32 v76, v76, v77
    v_add_f32 v78, v78, v79
    v_add_f32 v76, v76, v78
    v_cvt_pk_bf16_f32 v5, v76, v76
    v_lshlrev_b32 v76, 16, v5
    v_ashrrev_i32 v5, 31, v76
    v_or_b32 v5, 0x80000000, v5
    v_xor_b32 v5, v5, v76
    v_and_b32 v5, 0xffff0000, v5
    v_sub_u32 v6, 1279, v0
    v_or_b32 v51, v5, v6
    v_add_f32 v80, v80, v81
    v_add_f32 v82, v82, v83
    v_add_f32 v80, v80, v82
    v_cvt_pk_bf16_f32 v5, v80, v80
    v_lshlrev_b32 v80, 16, v5
    v_ashrrev_i32 v5, 31, v80
    v_or_b32 v5, 0x80000000, v5
    v_xor_b32 v5, v5, v80
    v_and_b32 v5, 0xffff0000, v5
    v_sub_u32 v6, 1023, v0
    v_or_b32 v52, v5, v6
    v_add_f32 v84, v84, v85
    v_add_f32 v86, v86, v87
    v_add_f32 v84, v84, v86
    v_cvt_pk_bf16_f32 v5, v84, v84
    v_lshlrev_b32 v84, 16, v5
    v_ashrrev_i32 v5, 31, v84
    v_or_b32 v5, 0x80000000, v5
    v_xor_b32 v5, v5, v84
    v_and_b32 v5, 0xffff0000, v5
    v_sub_u32 v6, 767, v0
    v_or_b32 v53, v5, v6
    v_add_f32 v88, v88, v89
    v_add_f32 v90, v90, v91
    v_add_f32 v88, v88, v90
    v_cvt_pk_bf16_f32 v5, v88, v88
    v_lshlrev_b32 v88, 16, v5
    v_ashrrev_i32 v5, 31, v88
    v_or_b32 v5, 0x80000000, v5
    v_xor_b32 v5, v5, v88
    v_and_b32 v5, 0xffff0000, v5
    v_sub_u32 v6, 511, v0
    v_or_b32 v54, v5, v6
    v_add_f32 v92, v92, v93
    v_add_f32 v94, v94, v95
    v_add_f32 v92, v92, v94
    v_cvt_pk_bf16_f32 v5, v92, v92
    v_lshlrev_b32 v92, 16, v5
    v_ashrrev_i32 v5, 31, v92
    v_or_b32 v5, 0x80000000, v5
    v_xor_b32 v5, v5, v92
    v_and_b32 v5, 0xffff0000, v5
    v_sub_u32 v6, 255, v0
    v_or_b32 v55, v5, v6
    v_lshrrev_b32 v7, 6, v0
    v_lshlrev_b32 v7, 2, v7
    v_mov_b32 v8, 0
    v_max3_u32 v5, v48, v49, v50
    v_max3_u32 v5, v5, v51, v52
    v_max3_u32 v5, v5, v53, v54
    v_max_u32 v5, v5, v55
    s_nop 1
    v_max_u32_dpp v5, v5, v5 quad_perm:[1,0,3,2] row_mask:0xf bank_mask:0xf
    s_nop 1
    v_max_u32_dpp v5, v5, v5 quad_perm:[2,3,0,1] row_mask:0xf bank_mask:0xf
    s_nop 1
    v_max_u32_dpp v5, v5, v5 row_half_mirror row_mask:0xf bank_mask:0xf
    s_nop 1
    v_max_u32_dpp v5, v5, v5 row_mirror row_mask:0xf bank_mask:0xf
    v_mov_b32 v6, v5
    s_nop 1
    v_permlane16_swap_b32 v5, v6
    v_max_u32 v5, v5, v6
    v_mov_b32 v6, v5
    s_nop 1
    v_permlane32_swap_b32 v5, v6
    v_max_u32 v5, v5, v6
    ds_write_b32 v7, v5 offset:0
    s_waitcnt lgkmcnt(0)
    s_barrier
    ds_read_b128 v[56:59], v8 offset:0
    s_waitcnt lgkmcnt(0)
    v_max3_u32 v5, v56, v57, v58
    v_max_u32 v5, v5, v59
    s_nop 0
    v_readfirstlane_b32 s28, v5
    v_cmp_ne_u32 vcc, v5, v48
    s_nop 1
    v_cndmask_b32 v48, 0, v48, vcc
    v_cmp_ne_u32 vcc, v5, v49
    s_nop 1
    v_cndmask_b32 v49, 0, v49, vcc
    v_cmp_ne_u32 vcc, v5, v50
    s_nop 1
    v_cndmask_b32 v50, 0, v50, vcc
    v_cmp_ne_u32 vcc, v5, v51
    s_nop 1
    v_cndmask_b32 v51, 0, v51, vcc
    v_cmp_ne_u32 vcc, v5, v52
    s_nop 1
    v_cndmask_b32 v52, 0, v52, vcc
    v_cmp_ne_u32 vcc, v5, v53
    s_nop 1
    v_cndmask_b32 v53, 0, v53, vcc
    v_cmp_ne_u32 vcc, v5, v54
    s_nop 1
    v_cndmask_b32 v54, 0, v54, vcc
    v_cmp_ne_u32 vcc, v5, v55
    s_nop 1
    v_cndmask_b32 v55, 0, v55, vcc
    v_max3_u32 v5, v48, v49, v50
    v_max3_u32 v5, v5, v51, v52
    v_max3_u32 v5, v5, v53, v54
    v_max_u32 v5, v5, v55
    s_nop 1
    v_max_u32_dpp v5, v5, v5 quad_perm:[1,0,3,2] row_mask:0xf bank_mask:0xf
    s_nop 1
    v_max_u32_dpp v5, v5, v5 quad_perm:[2,3,0,1] row_mask:0xf bank_mask:0xf
    s_nop 1
    v_max_u32_dpp v5, v5, v5 row_half_mirror row_mask:0xf bank_mask:0xf
    s_nop 1
    v_max_u32_dpp v5, v5, v5 row_mirror row_mask:0xf bank_mask:0xf
    v_mov_b32 v6, v5
    s_nop 1
    v_permlane16_swap_b32 v5, v6
    v_max_u32 v5, v5, v6
    v_mov_b32 v6, v5
    s_nop 1
    v_permlane32_swap_b32 v5, v6
    v_max_u32 v5, v5, v6
    ds_write_b32 v7, v5 offset:16
    s_waitcnt lgkmcnt(0)
    s_barrier
    ds_read_b128 v[56:59], v8 offset:16
    s_waitcnt lgkmcnt(0)
    v_max3_u32 v5, v56, v57, v58
    v_max_u32 v5, v5, v59
    s_nop 0
    v_readfirstlane_b32 s29, v5
    v_lshlrev_b32 v3, 5, v1
    s_and_b32 s30, s28, 0xffff
    s_sub_u32 s32, 2047, s30
    s_lshl_b32 s30, s32, 10
    s_add_u32 s30, s30, 0x600000
    buffer_load_dwordx4 v[64:67], v3, s[8:11], s30 offen
    buffer_load_dwordx4 v[68:71], v3, s[8:11], s30 offen offset:16
    s_and_b32 s30, s28, 0xffff0000
    s_xor_b32 s31, s30, 0x80000000
    s_xor_b32 s34, s30, 0xffff0000
    s_bitcmp1_b32 s30, 31
    s_cselect_b32 s36, s31, s34
    s_and_b32 s30, s29, 0xffff
    s_sub_u32 s33, 2047, s30
    s_lshl_b32 s30, s33, 10
    s_add_u32 s30, s30, 0x600000
    buffer_load_dwordx4 v[72:75], v3, s[8:11], s30 offen
    buffer_load_dwordx4 v[76:79], v3, s[8:11], s30 offen offset:16
    s_and_b32 s30, s29, 0xffff0000
    s_xor_b32 s31, s30, 0x80000000
    s_xor_b32 s34, s30, 0xffff0000
    s_bitcmp1_b32 s30, 31
    s_cselect_b32 s37, s31, s34
    v_mov_b32 v56, s32
    v_mov_b32 v57, s33
    v_mov_b32 v58, s36
    v_mov_b32 v59, s37
    v_or_b32 v5, s2, v0
    v_cmp_ne_u32 vcc, 0, v5
    v_mov_b32 v6, 0x40000000
    s_nop 0
    v_cndmask_b32 v5, v5, v6, vcc
    s_mov_b32 s30, 0x19fc00
    buffer_store_dwordx4 v[56:59], v5, s[8:11], s30 offen
    v_mov_b32 v80, 0
    v_mov_b32 v81, 0
    v_mov_b32 v82, 0
    v_mov_b32 v83, 0
    v_mov_b32 v84, 0
    v_mov_b32 v85, 0
    v_mov_b32 v86, 0
    v_mov_b32 v87, 0
    s_waitcnt vmcnt(1)
    v_lshlrev_b32 v9, 16, v64
    v_lshlrev_b32 v10, 16, v72
    v_lshlrev_b32 v11, 16, v16
    v_and_b32 v12, 0xffff0000, v16
    v_fmac_f32 v80, v9, v11
    v_fmac_f32 v81, v9, v12
    v_fmac_f32 v82, v10, v11
    v_fmac_f32 v83, v10, v12
    v_lshlrev_b32 v11, 16, v32
    v_and_b32 v12, 0xffff0000, v32
    v_fmac_f32 v84, v9, v11
    v_fmac_f32 v85, v9, v12
    v_fmac_f32 v86, v10, v11
    v_fmac_f32 v87, v10, v12
    v_and_b32 v9, 0xffff0000, v64
    v_and_b32 v10, 0xffff0000, v72
    v_lshlrev_b32 v11, 16, v17
    v_and_b32 v12, 0xffff0000, v17
    v_fmac_f32 v80, v9, v11
    v_fmac_f32 v81, v9, v12
    v_fmac_f32 v82, v10, v11
    v_fmac_f32 v83, v10, v12
    v_lshlrev_b32 v11, 16, v33
    v_and_b32 v12, 0xffff0000, v33
    v_fmac_f32 v84, v9, v11
    v_fmac_f32 v85, v9, v12
    v_fmac_f32 v86, v10, v11
    v_fmac_f32 v87, v10, v12
    v_lshlrev_b32 v9, 16, v65
    v_lshlrev_b32 v10, 16, v73
    v_lshlrev_b32 v11, 16, v18
    v_and_b32 v12, 0xffff0000, v18
    v_fmac_f32 v80, v9, v11
    v_fmac_f32 v81, v9, v12
    v_fmac_f32 v82, v10, v11
    v_fmac_f32 v83, v10, v12
    v_lshlrev_b32 v11, 16, v34
    v_and_b32 v12, 0xffff0000, v34
    v_fmac_f32 v84, v9, v11
    v_fmac_f32 v85, v9, v12
    v_fmac_f32 v86, v10, v11
    v_fmac_f32 v87, v10, v12
    v_and_b32 v9, 0xffff0000, v65
    v_and_b32 v10, 0xffff0000, v73
    v_lshlrev_b32 v11, 16, v19
    v_and_b32 v12, 0xffff0000, v19
    v_fmac_f32 v80, v9, v11
    v_fmac_f32 v81, v9, v12
    v_fmac_f32 v82, v10, v11
    v_fmac_f32 v83, v10, v12
    v_lshlrev_b32 v11, 16, v35
    v_and_b32 v12, 0xffff0000, v35
    v_fmac_f32 v84, v9, v11
    v_fmac_f32 v85, v9, v12
    v_fmac_f32 v86, v10, v11
    v_fmac_f32 v87, v10, v12
    v_lshlrev_b32 v9, 16, v66
    v_lshlrev_b32 v10, 16, v74
    v_lshlrev_b32 v11, 16, v20
    v_and_b32 v12, 0xffff0000, v20
    v_fmac_f32 v80, v9, v11
    v_fmac_f32 v81, v9, v12
    v_fmac_f32 v82, v10, v11
    v_fmac_f32 v83, v10, v12
    v_lshlrev_b32 v11, 16, v36
    v_and_b32 v12, 0xffff0000, v36
    v_fmac_f32 v84, v9, v11
    v_fmac_f32 v85, v9, v12
    v_fmac_f32 v86, v10, v11
    v_fmac_f32 v87, v10, v12
    v_and_b32 v9, 0xffff0000, v66
    v_and_b32 v10, 0xffff0000, v74
    v_lshlrev_b32 v11, 16, v21
    v_and_b32 v12, 0xffff0000, v21
    v_fmac_f32 v80, v9, v11
    v_fmac_f32 v81, v9, v12
    v_fmac_f32 v82, v10, v11
    v_fmac_f32 v83, v10, v12
    v_lshlrev_b32 v11, 16, v37
    v_and_b32 v12, 0xffff0000, v37
    v_fmac_f32 v84, v9, v11
    v_fmac_f32 v85, v9, v12
    v_fmac_f32 v86, v10, v11
    v_fmac_f32 v87, v10, v12
    v_lshlrev_b32 v9, 16, v67
    v_lshlrev_b32 v10, 16, v75
    v_lshlrev_b32 v11, 16, v22
    v_and_b32 v12, 0xffff0000, v22
    v_fmac_f32 v80, v9, v11
    v_fmac_f32 v81, v9, v12
    v_fmac_f32 v82, v10, v11
    v_fmac_f32 v83, v10, v12
    v_lshlrev_b32 v11, 16, v38
    v_and_b32 v12, 0xffff0000, v38
    v_fmac_f32 v84, v9, v11
    v_fmac_f32 v85, v9, v12
    v_fmac_f32 v86, v10, v11
    v_fmac_f32 v87, v10, v12
    v_and_b32 v9, 0xffff0000, v67
    v_and_b32 v10, 0xffff0000, v75
    v_lshlrev_b32 v11, 16, v23
    v_and_b32 v12, 0xffff0000, v23
    v_fmac_f32 v80, v9, v11
    v_fmac_f32 v81, v9, v12
    v_fmac_f32 v82, v10, v11
    v_fmac_f32 v83, v10, v12
    v_lshlrev_b32 v11, 16, v39
    v_and_b32 v12, 0xffff0000, v39
    v_fmac_f32 v84, v9, v11
    v_fmac_f32 v85, v9, v12
    v_fmac_f32 v86, v10, v11
    v_fmac_f32 v87, v10, v12
    v_lshlrev_b32 v9, 16, v68
    v_lshlrev_b32 v10, 16, v76
    v_lshlrev_b32 v11, 16, v24
    v_and_b32 v12, 0xffff0000, v24
    v_fmac_f32 v80, v9, v11
    v_fmac_f32 v81, v9, v12
    v_fmac_f32 v82, v10, v11
    v_fmac_f32 v83, v10, v12
    v_lshlrev_b32 v11, 16, v40
    v_and_b32 v12, 0xffff0000, v40
    v_fmac_f32 v84, v9, v11
    v_fmac_f32 v85, v9, v12
    v_fmac_f32 v86, v10, v11
    v_fmac_f32 v87, v10, v12
    v_and_b32 v9, 0xffff0000, v68
    v_and_b32 v10, 0xffff0000, v76
    v_lshlrev_b32 v11, 16, v25
    v_and_b32 v12, 0xffff0000, v25
    v_fmac_f32 v80, v9, v11
    v_fmac_f32 v81, v9, v12
    v_fmac_f32 v82, v10, v11
    v_fmac_f32 v83, v10, v12
    v_lshlrev_b32 v11, 16, v41
    v_and_b32 v12, 0xffff0000, v41
    v_fmac_f32 v84, v9, v11
    v_fmac_f32 v85, v9, v12
    v_fmac_f32 v86, v10, v11
    v_fmac_f32 v87, v10, v12
    v_lshlrev_b32 v9, 16, v69
    v_lshlrev_b32 v10, 16, v77
    v_lshlrev_b32 v11, 16, v26
    v_and_b32 v12, 0xffff0000, v26
    v_fmac_f32 v80, v9, v11
    v_fmac_f32 v81, v9, v12
    v_fmac_f32 v82, v10, v11
    v_fmac_f32 v83, v10, v12
    v_lshlrev_b32 v11, 16, v42
    v_and_b32 v12, 0xffff0000, v42
    v_fmac_f32 v84, v9, v11
    v_fmac_f32 v85, v9, v12
    v_fmac_f32 v86, v10, v11
    v_fmac_f32 v87, v10, v12
    v_and_b32 v9, 0xffff0000, v69
    v_and_b32 v10, 0xffff0000, v77
    v_lshlrev_b32 v11, 16, v27
    v_and_b32 v12, 0xffff0000, v27
    v_fmac_f32 v80, v9, v11
    v_fmac_f32 v81, v9, v12
    v_fmac_f32 v82, v10, v11
    v_fmac_f32 v83, v10, v12
    v_lshlrev_b32 v11, 16, v43
    v_and_b32 v12, 0xffff0000, v43
    v_fmac_f32 v84, v9, v11
    v_fmac_f32 v85, v9, v12
    v_fmac_f32 v86, v10, v11
    v_fmac_f32 v87, v10, v12
    v_lshlrev_b32 v9, 16, v70
    v_lshlrev_b32 v10, 16, v78
    v_lshlrev_b32 v11, 16, v28
    v_and_b32 v12, 0xffff0000, v28
    v_fmac_f32 v80, v9, v11
    v_fmac_f32 v81, v9, v12
    v_fmac_f32 v82, v10, v11
    v_fmac_f32 v83, v10, v12
    v_lshlrev_b32 v11, 16, v44
    v_and_b32 v12, 0xffff0000, v44
    v_fmac_f32 v84, v9, v11
    v_fmac_f32 v85, v9, v12
    v_fmac_f32 v86, v10, v11
    v_fmac_f32 v87, v10, v12
    v_and_b32 v9, 0xffff0000, v70
    v_and_b32 v10, 0xffff0000, v78
    v_lshlrev_b32 v11, 16, v29
    v_and_b32 v12, 0xffff0000, v29
    v_fmac_f32 v80, v9, v11
    v_fmac_f32 v81, v9, v12
    v_fmac_f32 v82, v10, v11
    v_fmac_f32 v83, v10, v12
    v_lshlrev_b32 v11, 16, v45
    v_and_b32 v12, 0xffff0000, v45
    v_fmac_f32 v84, v9, v11
    v_fmac_f32 v85, v9, v12
    v_fmac_f32 v86, v10, v11
    v_fmac_f32 v87, v10, v12
    v_lshlrev_b32 v9, 16, v71
    v_lshlrev_b32 v10, 16, v79
    v_lshlrev_b32 v11, 16, v30
    v_and_b32 v12, 0xffff0000, v30
    v_fmac_f32 v80, v9, v11
    v_fmac_f32 v81, v9, v12
    v_fmac_f32 v82, v10, v11
    v_fmac_f32 v83, v10, v12
    v_lshlrev_b32 v11, 16, v46
    v_and_b32 v12, 0xffff0000, v46
    v_fmac_f32 v84, v9, v11
    v_fmac_f32 v85, v9, v12
    v_fmac_f32 v86, v10, v11
    v_fmac_f32 v87, v10, v12
    v_and_b32 v9, 0xffff0000, v71
    v_and_b32 v10, 0xffff0000, v79
    v_lshlrev_b32 v11, 16, v31
    v_and_b32 v12, 0xffff0000, v31
    v_fmac_f32 v80, v9, v11
    v_fmac_f32 v81, v9, v12
    v_fmac_f32 v82, v10, v11
    v_fmac_f32 v83, v10, v12
    v_lshlrev_b32 v11, 16, v47
    v_and_b32 v12, 0xffff0000, v47
    v_fmac_f32 v84, v9, v11
    v_fmac_f32 v85, v9, v12
    v_fmac_f32 v86, v10, v11
    v_fmac_f32 v87, v10, v12
    v_add_f32_dpp v80, v80, v80 row_ror:8 row_mask:0xf bank_mask:0xf
    v_add_f32_dpp v81, v81, v81 row_ror:8 row_mask:0xf bank_mask:0xf
    v_add_f32_dpp v82, v82, v82 row_ror:8 row_mask:0xf bank_mask:0xf
    v_add_f32_dpp v83, v83, v83 row_ror:8 row_mask:0xf bank_mask:0xf
    v_add_f32_dpp v84, v84, v84 row_ror:8 row_mask:0xf bank_mask:0xf
    v_add_f32_dpp v85, v85, v85 row_ror:8 row_mask:0xf bank_mask:0xf
    v_add_f32_dpp v86, v86, v86 row_ror:8 row_mask:0xf bank_mask:0xf
    v_add_f32_dpp v87, v87, v87 row_ror:8 row_mask:0xf bank_mask:0xf
    v_mov_b32 v5, v80
    s_nop 1
    v_permlane16_swap_b32 v80, v5
    v_add_f32 v80, v80, v5
    v_mov_b32 v5, v81
    s_nop 1
    v_permlane16_swap_b32 v81, v5
    v_add_f32 v81, v81, v5
    v_mov_b32 v5, v82
    s_nop 1
    v_permlane16_swap_b32 v82, v5
    v_add_f32 v82, v82, v5
    v_mov_b32 v5, v83
    s_nop 1
    v_permlane16_swap_b32 v83, v5
    v_add_f32 v83, v83, v5
    v_mov_b32 v5, v84
    s_nop 1
    v_permlane16_swap_b32 v84, v5
    v_add_f32 v84, v84, v5
    v_mov_b32 v5, v85
    s_nop 1
    v_permlane16_swap_b32 v85, v5
    v_add_f32 v85, v85, v5
    v_mov_b32 v5, v86
    s_nop 1
    v_permlane16_swap_b32 v86, v5
    v_add_f32 v86, v86, v5
    v_mov_b32 v5, v87
    s_nop 1
    v_permlane16_swap_b32 v87, v5
    v_add_f32 v87, v87, v5
    v_mov_b32 v5, v80
    s_nop 1
    v_permlane32_swap_b32 v80, v5
    v_add_f32 v80, v80, v5
    v_mov_b32 v5, v81
    s_nop 1
    v_permlane32_swap_b32 v81, v5
    v_add_f32 v81, v81, v5
    v_mov_b32 v5, v82
    s_nop 1
    v_permlane32_swap_b32 v82, v5
    v_add_f32 v82, v82, v5
    v_mov_b32 v5, v83
    s_nop 1
    v_permlane32_swap_b32 v83, v5
    v_add_f32 v83, v83, v5
    v_mov_b32 v5, v84
    s_nop 1
    v_permlane32_swap_b32 v84, v5
    v_add_f32 v84, v84, v5
    v_mov_b32 v5, v85
    s_nop 1
    v_permlane32_swap_b32 v85, v5
    v_add_f32 v85, v85, v5
    v_mov_b32 v5, v86
    s_nop 1
    v_permlane32_swap_b32 v86, v5
    v_add_f32 v86, v86, v5
    v_mov_b32 v5, v87
    s_nop 1
    v_permlane32_swap_b32 v87, v5
    v_add_f32 v87, v87, v5
    v_lshrrev_b32 v7, 6, v0
    v_lshlrev_b32 v7, 8, v7
    v_lshl_add_u32 v7, v2, 5, v7
    ds_write_b128 v7, v[80:83] offset:64
    ds_write_b128 v7, v[84:87] offset:80
    s_waitcnt lgkmcnt(0)
    s_barrier
    v_lshrrev_b32 v7, 2, v0
    v_and_b32 v7, 7, v7
    v_lshlrev_b32 v7, 5, v7
    v_and_b32 v8, 3, v0
    v_lshl_add_u32 v7, v8, 2, v7
    ds_read2_b32 v[16:17], v7 offset0:16 offset1:20
    ds_read2_b32 v[18:19], v7 offset0:80 offset1:84
    ds_read2_b32 v[20:21], v7 offset0:144 offset1:148
    ds_read2_b32 v[22:23], v7 offset0:208 offset1:212
    s_waitcnt lgkmcnt(0)
    v_add_f32 v16, v16, v18
    v_add_f32 v20, v20, v22
    v_add_f32 v16, v16, v20
    v_cvt_pk_bf16_f32 v5, v16, v16
    v_lshlrev_b32 v16, 16, v5
    v_add_f32 v17, v17, v19
    v_add_f32 v21, v21, v23
    v_add_f32 v17, v17, v21
    v_cvt_pk_bf16_f32 v5, v17, v17
    v_lshlrev_b32 v17, 16, v5
    v_mul_f32 v18, 0xbfb8aa3b, v16
    v_exp_f32 v18, v18
    s_nop 0
    v_add_f32 v18, 1.0, v18
    v_rcp_f32 v18, v18
    s_nop 0
    v_mul_f32 v16, v16, v18
    v_cvt_pk_bf16_f32 v5, v16, v16
    v_lshlrev_b32 v16, 16, v5
    v_mul_f32 v16, v16, v17
    v_cvt_pk_bf16_f32 v5, v16, v16
    v_lshlrev_b32 v16, 16, v5
    v_lshrrev_b32 v7, 2, v0
    v_lshlrev_b32 v7, 3, v7
    v_and_b32 v8, 1, v0
    v_lshl_add_u32 v7, v8, 2, v7
    v_bfe_u32 v8, v0, 1, 1
    v_mul_u32_u24 v8, 7168, v8
    v_add_u32 v7, v7, v8
    v_cmp_lt_u32 vcc, 31, v0
    s_nop 1
    v_cndmask_b32 v7, v7, v6, vcc
    s_lshl_b32 s30, s2, 6
    s_add_u32 s30, s30, 0x19c000
    buffer_store_dword v16, v7, s[8:11], s30 offen
L_k2_end:
    s_endpgm
.globl down_kernel
.p2align 8
.type down_kernel,@function
down_kernel:
    s_cmp_ge_u32 s2, 32
    s_cbranch_scc1 L_k3_end
    s_load_dwordx4 s[20:23], s[0:1], 88
    s_load_dwordx2 s[24:25], s[0:1], 112
    v_lshrrev_b32 v1, 3, v0
    v_and_b32 v2, 7, v0
    s_waitcnt lgkmcnt(0)
    s_mov_b32 s8, s24
    s_and_b32 s9, s25, 0xffff
    s_mov_b32 s10, 0x10000000
    s_mov_b32 s11, 0x20000
    s_mov_b32 s12, s20
    s_and_b32 s13, s21, 0xffff
    s_mov_b32 s14, 0x1c0000
    s_mov_b32 s15, 0x20000
    s_mov_b32 s16, s22
    s_and_b32 s17, s23, 0xffff
    s_mov_b32 s18, 0x200000
    s_mov_b32 s19, 0x20000
    v_mul_u32_u24 v4, 57344, v1
    v_lshl_add_u32 v4, v2, 2, v4
    s_lshl_b32 s27, s2, 5
    s_add_u32 s26, s27, 0
    buffer_load_dword v16, v4, s[12:15], s26 offen offset:0
    s_add_u32 s26, s27, 0
    buffer_load_dword v17, v4, s[12:15], s26 offen offset:1024
    s_add_u32 s26, s27, 0
    buffer_load_dword v18, v4, s[12:15], s26 offen offset:2048
    s_add_u32 s26, s27, 0
    buffer_load_dword v19, v4, s[12:15], s26 offen offset:3072
    s_add_u32 s26, s27, 4096
    buffer_load_dword v20, v4, s[12:15], s26 offen offset:0
    s_add_u32 s26, s27, 4096
    buffer_load_dword v21, v4, s[12:15], s26 offen offset:1024
    s_add_u32 s26, s27, 4096
    buffer_load_dword v22, v4, s[12:15], s26 offen offset:2048
    s_add_u32 s26, s27, 4096
    buffer_load_dword v23, v4, s[12:15], s26 offen offset:3072
    s_add_u32 s26, s27, 8192
    buffer_load_dword v24, v4, s[12:15], s26 offen offset:0
    s_add_u32 s26, s27, 8192
    buffer_load_dword v25, v4, s[12:15], s26 offen offset:1024
    s_add_u32 s26, s27, 8192
    buffer_load_dword v26, v4, s[12:15], s26 offen offset:2048
    s_add_u32 s26, s27, 8192
    buffer_load_dword v27, v4, s[12:15], s26 offen offset:3072
    s_add_u32 s26, s27, 12288
    buffer_load_dword v28, v4, s[12:15], s26 offen offset:0
    s_add_u32 s26, s27, 12288
    buffer_load_dword v29, v4, s[12:15], s26 offen offset:1024
    s_add_u32 s26, s27, 12288
    buffer_load_dword v30, v4, s[12:15], s26 offen offset:2048
    s_add_u32 s26, s27, 12288
    buffer_load_dword v31, v4, s[12:15], s26 offen offset:3072
    s_add_u32 s26, s27, 16384
    buffer_load_dword v32, v4, s[12:15], s26 offen offset:0
    s_add_u32 s26, s27, 16384
    buffer_load_dword v33, v4, s[12:15], s26 offen offset:1024
    s_add_u32 s26, s27, 16384
    buffer_load_dword v34, v4, s[12:15], s26 offen offset:2048
    s_add_u32 s26, s27, 16384
    buffer_load_dword v35, v4, s[12:15], s26 offen offset:3072
    s_add_u32 s26, s27, 20480
    buffer_load_dword v36, v4, s[12:15], s26 offen offset:0
    s_add_u32 s26, s27, 20480
    buffer_load_dword v37, v4, s[12:15], s26 offen offset:1024
    s_add_u32 s26, s27, 20480
    buffer_load_dword v38, v4, s[12:15], s26 offen offset:2048
    s_add_u32 s26, s27, 20480
    buffer_load_dword v39, v4, s[12:15], s26 offen offset:3072
    s_add_u32 s26, s27, 24576
    buffer_load_dword v40, v4, s[12:15], s26 offen offset:0
    s_add_u32 s26, s27, 24576
    buffer_load_dword v41, v4, s[12:15], s26 offen offset:1024
    s_add_u32 s26, s27, 24576
    buffer_load_dword v42, v4, s[12:15], s26 offen offset:2048
    s_add_u32 s26, s27, 24576
    buffer_load_dword v43, v4, s[12:15], s26 offen offset:3072
    s_add_u32 s26, s27, 28672
    buffer_load_dword v44, v4, s[12:15], s26 offen offset:0
    s_add_u32 s26, s27, 28672
    buffer_load_dword v45, v4, s[12:15], s26 offen offset:1024
    s_add_u32 s26, s27, 28672
    buffer_load_dword v46, v4, s[12:15], s26 offen offset:2048
    s_add_u32 s26, s27, 28672
    buffer_load_dword v47, v4, s[12:15], s26 offen offset:3072
    s_add_u32 s26, s27, 32768
    buffer_load_dword v48, v4, s[12:15], s26 offen offset:0
    s_add_u32 s26, s27, 32768
    buffer_load_dword v49, v4, s[12:15], s26 offen offset:1024
    s_add_u32 s26, s27, 32768
    buffer_load_dword v50, v4, s[12:15], s26 offen offset:2048
    s_add_u32 s26, s27, 32768
    buffer_load_dword v51, v4, s[12:15], s26 offen offset:3072
    s_add_u32 s26, s27, 36864
    buffer_load_dword v52, v4, s[12:15], s26 offen offset:0
    s_add_u32 s26, s27, 36864
    buffer_load_dword v53, v4, s[12:15], s26 offen offset:1024
    s_add_u32 s26, s27, 36864
    buffer_load_dword v54, v4, s[12:15], s26 offen offset:2048
    s_add_u32 s26, s27, 36864
    buffer_load_dword v55, v4, s[12:15], s26 offen offset:3072
    s_add_u32 s26, s27, 40960
    buffer_load_dword v56, v4, s[12:15], s26 offen offset:0
    s_add_u32 s26, s27, 40960
    buffer_load_dword v57, v4, s[12:15], s26 offen offset:1024
    s_add_u32 s26, s27, 40960
    buffer_load_dword v58, v4, s[12:15], s26 offen offset:2048
    s_add_u32 s26, s27, 40960
    buffer_load_dword v59, v4, s[12:15], s26 offen offset:3072
    s_add_u32 s26, s27, 45056
    buffer_load_dword v60, v4, s[12:15], s26 offen offset:0
    s_add_u32 s26, s27, 45056
    buffer_load_dword v61, v4, s[12:15], s26 offen offset:1024
    s_add_u32 s26, s27, 45056
    buffer_load_dword v62, v4, s[12:15], s26 offen offset:2048
    s_add_u32 s26, s27, 45056
    buffer_load_dword v63, v4, s[12:15], s26 offen offset:3072
    s_add_u32 s26, s27, 49152
    buffer_load_dword v64, v4, s[12:15], s26 offen offset:0
    s_add_u32 s26, s27, 49152
    buffer_load_dword v65, v4, s[12:15], s26 offen offset:1024
    s_add_u32 s26, s27, 49152
    buffer_load_dword v66, v4, s[12:15], s26 offen offset:2048
    s_add_u32 s26, s27, 49152
    buffer_load_dword v67, v4, s[12:15], s26 offen offset:3072
    s_add_u32 s26, s27, 53248
    buffer_load_dword v68, v4, s[12:15], s26 offen offset:0
    s_add_u32 s26, s27, 53248
    buffer_load_dword v69, v4, s[12:15], s26 offen offset:1024
    s_add_u32 s26, s27, 53248
    buffer_load_dword v70, v4, s[12:15], s26 offen offset:2048
    s_add_u32 s26, s27, 53248
    buffer_load_dword v71, v4, s[12:15], s26 offen offset:3072
    v_mov_b32 v5, 0
    s_mov_b32 s30, 0x19fc00
    buffer_load_dwordx4 v[8:11], v5, s[8:11], s30 offen
    v_mul_u32_u24 v3, 224, v1
    s_waitcnt vmcnt(30)
    s_mov_b32 s30, 0x19c000
    buffer_load_dwordx4 v[72:75], v3, s[8:11], s30 offen offset:0
    buffer_load_dwordx4 v[76:79], v3, s[8:11], s30 offen offset:16
    buffer_load_dwordx4 v[80:83], v3, s[8:11], s30 offen offset:32
    buffer_load_dwordx4 v[84:87], v3, s[8:11], s30 offen offset:48
    buffer_load_dwordx4 v[88:91], v3, s[8:11], s30 offen offset:64
    buffer_load_dwordx4 v[92:95], v3, s[8:11], s30 offen offset:80
    buffer_load_dwordx4 v[96:99], v3, s[8:11], s30 offen offset:96
    buffer_load_dwordx4 v[100:103], v3, s[8:11], s30 offen offset:112
    buffer_load_dwordx4 v[104:107], v3, s[8:11], s30 offen offset:128
    buffer_load_dwordx4 v[108:111], v3, s[8:11], s30 offen offset:144
    buffer_load_dwordx4 v[112:115], v3, s[8:11], s30 offen offset:160
    buffer_load_dwordx4 v[116:119], v3, s[8:11], s30 offen offset:176
    buffer_load_dwordx4 v[120:123], v3, s[8:11], s30 offen offset:192
    buffer_load_dwordx4 v[124:127], v3, s[8:11], s30 offen offset:208
    s_mov_b32 s30, 0x19dc00
    buffer_load_dwordx4 v[128:131], v3, s[8:11], s30 offen offset:0
    buffer_load_dwordx4 v[132:135], v3, s[8:11], s30 offen offset:16
    buffer_load_dwordx4 v[136:139], v3, s[8:11], s30 offen offset:32
    buffer_load_dwordx4 v[140:143], v3, s[8:11], s30 offen offset:48
    buffer_load_dwordx4 v[144:147], v3, s[8:11], s30 offen offset:64
    buffer_load_dwordx4 v[148:151], v3, s[8:11], s30 offen offset:80
    buffer_load_dwordx4 v[152:155], v3, s[8:11], s30 offen offset:96
    buffer_load_dwordx4 v[156:159], v3, s[8:11], s30 offen offset:112
    buffer_load_dwordx4 v[160:163], v3, s[8:11], s30 offen offset:128
    buffer_load_dwordx4 v[164:167], v3, s[8:11], s30 offen offset:144
    buffer_load_dwordx4 v[168:171], v3, s[8:11], s30 offen offset:160
    buffer_load_dwordx4 v[172:175], v3, s[8:11], s30 offen offset:176
    buffer_load_dwordx4 v[176:179], v3, s[8:11], s30 offen offset:192
    buffer_load_dwordx4 v[180:183], v3, s[8:11], s30 offen offset:208
    v_mov_b32 v184, 0
    v_mov_b32 v185, 0
    v_mov_b32 v186, 0
    v_mov_b32 v187, 0
    s_waitcnt vmcnt(28)
    v_bfe_u32 v6, v0, 3, 1
    v_cmp_ne_u32 vcc, 0, v6
    s_nop 1
    v_cndmask_b32 v12, v8, v9, vcc
    v_cndmask_b32 v13, v10, v11, vcc
    v_lshlrev_b32 v12, 10, v12
    v_lshl_add_u32 v12, v2, 2, v12
    v_add_u32 v12, s27, v12
    v_mov_b32 v7, 0x40000000
    v_cmp_lt_u32 vcc, 15, v0
    s_nop 1
    v_cndmask_b32 v12, v12, v7, vcc
    s_mov_b32 s30, 0x400000
    s_mov_b32 s31, 0x600000
    buffer_load_dword v14, v12, s[8:11], s30 offen
    buffer_load_dword v15, v12, s[8:11], s31 offen
    s_waitcnt vmcnt(2)
    v_lshlrev_b32 v5, 16, v16
    v_and_b32 v7, 0xffff0000, v16
    v_fmac_f32 v184, v72, v5
    v_fmac_f32 v185, v72, v7
    v_fmac_f32 v186, v128, v5
    v_fmac_f32 v187, v128, v7
    v_lshlrev_b32 v5, 16, v17
    v_and_b32 v7, 0xffff0000, v17
    v_fmac_f32 v184, v73, v5
    v_fmac_f32 v185, v73, v7
    v_fmac_f32 v186, v129, v5
    v_fmac_f32 v187, v129, v7
    v_lshlrev_b32 v5, 16, v18
    v_and_b32 v7, 0xffff0000, v18
    v_fmac_f32 v184, v74, v5
    v_fmac_f32 v185, v74, v7
    v_fmac_f32 v186, v130, v5
    v_fmac_f32 v187, v130, v7
    v_lshlrev_b32 v5, 16, v19
    v_and_b32 v7, 0xffff0000, v19
    v_fmac_f32 v184, v75, v5
    v_fmac_f32 v185, v75, v7
    v_fmac_f32 v186, v131, v5
    v_fmac_f32 v187, v131, v7
    v_lshlrev_b32 v5, 16, v20
    v_and_b32 v7, 0xffff0000, v20
    v_fmac_f32 v184, v76, v5
    v_fmac_f32 v185, v76, v7
    v_fmac_f32 v186, v132, v5
    v_fmac_f32 v187, v132, v7
    v_lshlrev_b32 v5, 16, v21
    v_and_b32 v7, 0xffff0000, v21
    v_fmac_f32 v184, v77, v5
    v_fmac_f32 v185, v77, v7
    v_fmac_f32 v186, v133, v5
    v_fmac_f32 v187, v133, v7
    v_lshlrev_b32 v5, 16, v22
    v_and_b32 v7, 0xffff0000, v22
    v_fmac_f32 v184, v78, v5
    v_fmac_f32 v185, v78, v7
    v_fmac_f32 v186, v134, v5
    v_fmac_f32 v187, v134, v7
    v_lshlrev_b32 v5, 16, v23
    v_and_b32 v7, 0xffff0000, v23
    v_fmac_f32 v184, v79, v5
    v_fmac_f32 v185, v79, v7
    v_fmac_f32 v186, v135, v5
    v_fmac_f32 v187, v135, v7
    v_lshlrev_b32 v5, 16, v24
    v_and_b32 v7, 0xffff0000, v24
    v_fmac_f32 v184, v80, v5
    v_fmac_f32 v185, v80, v7
    v_fmac_f32 v186, v136, v5
    v_fmac_f32 v187, v136, v7
    v_lshlrev_b32 v5, 16, v25
    v_and_b32 v7, 0xffff0000, v25
    v_fmac_f32 v184, v81, v5
    v_fmac_f32 v185, v81, v7
    v_fmac_f32 v186, v137, v5
    v_fmac_f32 v187, v137, v7
    v_lshlrev_b32 v5, 16, v26
    v_and_b32 v7, 0xffff0000, v26
    v_fmac_f32 v184, v82, v5
    v_fmac_f32 v185, v82, v7
    v_fmac_f32 v186, v138, v5
    v_fmac_f32 v187, v138, v7
    v_lshlrev_b32 v5, 16, v27
    v_and_b32 v7, 0xffff0000, v27
    v_fmac_f32 v184, v83, v5
    v_fmac_f32 v185, v83, v7
    v_fmac_f32 v186, v139, v5
    v_fmac_f32 v187, v139, v7
    v_lshlrev_b32 v5, 16, v28
    v_and_b32 v7, 0xffff0000, v28
    v_fmac_f32 v184, v84, v5
    v_fmac_f32 v185, v84, v7
    v_fmac_f32 v186, v140, v5
    v_fmac_f32 v187, v140, v7
    v_lshlrev_b32 v5, 16, v29
    v_and_b32 v7, 0xffff0000, v29
    v_fmac_f32 v184, v85, v5
    v_fmac_f32 v185, v85, v7
    v_fmac_f32 v186, v141, v5
    v_fmac_f32 v187, v141, v7
    v_lshlrev_b32 v5, 16, v30
    v_and_b32 v7, 0xffff0000, v30
    v_fmac_f32 v184, v86, v5
    v_fmac_f32 v185, v86, v7
    v_fmac_f32 v186, v142, v5
    v_fmac_f32 v187, v142, v7
    v_lshlrev_b32 v5, 16, v31
    v_and_b32 v7, 0xffff0000, v31
    v_fmac_f32 v184, v87, v5
    v_fmac_f32 v185, v87, v7
    v_fmac_f32 v186, v143, v5
    v_fmac_f32 v187, v143, v7
    v_lshlrev_b32 v5, 16, v32
    v_and_b32 v7, 0xffff0000, v32
    v_fmac_f32 v184, v88, v5
    v_fmac_f32 v185, v88, v7
    v_fmac_f32 v186, v144, v5
    v_fmac_f32 v187, v144, v7
    v_lshlrev_b32 v5, 16, v33
    v_and_b32 v7, 0xffff0000, v33
    v_fmac_f32 v184, v89, v5
    v_fmac_f32 v185, v89, v7
    v_fmac_f32 v186, v145, v5
    v_fmac_f32 v187, v145, v7
    v_lshlrev_b32 v5, 16, v34
    v_and_b32 v7, 0xffff0000, v34
    v_fmac_f32 v184, v90, v5
    v_fmac_f32 v185, v90, v7
    v_fmac_f32 v186, v146, v5
    v_fmac_f32 v187, v146, v7
    v_lshlrev_b32 v5, 16, v35
    v_and_b32 v7, 0xffff0000, v35
    v_fmac_f32 v184, v91, v5
    v_fmac_f32 v185, v91, v7
    v_fmac_f32 v186, v147, v5
    v_fmac_f32 v187, v147, v7
    v_lshlrev_b32 v5, 16, v36
    v_and_b32 v7, 0xffff0000, v36
    v_fmac_f32 v184, v92, v5
    v_fmac_f32 v185, v92, v7
    v_fmac_f32 v186, v148, v5
    v_fmac_f32 v187, v148, v7
    v_lshlrev_b32 v5, 16, v37
    v_and_b32 v7, 0xffff0000, v37
    v_fmac_f32 v184, v93, v5
    v_fmac_f32 v185, v93, v7
    v_fmac_f32 v186, v149, v5
    v_fmac_f32 v187, v149, v7
    v_lshlrev_b32 v5, 16, v38
    v_and_b32 v7, 0xffff0000, v38
    v_fmac_f32 v184, v94, v5
    v_fmac_f32 v185, v94, v7
    v_fmac_f32 v186, v150, v5
    v_fmac_f32 v187, v150, v7
    v_lshlrev_b32 v5, 16, v39
    v_and_b32 v7, 0xffff0000, v39
    v_fmac_f32 v184, v95, v5
    v_fmac_f32 v185, v95, v7
    v_fmac_f32 v186, v151, v5
    v_fmac_f32 v187, v151, v7
    v_lshlrev_b32 v5, 16, v40
    v_and_b32 v7, 0xffff0000, v40
    v_fmac_f32 v184, v96, v5
    v_fmac_f32 v185, v96, v7
    v_fmac_f32 v186, v152, v5
    v_fmac_f32 v187, v152, v7
    v_lshlrev_b32 v5, 16, v41
    v_and_b32 v7, 0xffff0000, v41
    v_fmac_f32 v184, v97, v5
    v_fmac_f32 v185, v97, v7
    v_fmac_f32 v186, v153, v5
    v_fmac_f32 v187, v153, v7
    v_lshlrev_b32 v5, 16, v42
    v_and_b32 v7, 0xffff0000, v42
    v_fmac_f32 v184, v98, v5
    v_fmac_f32 v185, v98, v7
    v_fmac_f32 v186, v154, v5
    v_fmac_f32 v187, v154, v7
    v_lshlrev_b32 v5, 16, v43
    v_and_b32 v7, 0xffff0000, v43
    v_fmac_f32 v184, v99, v5
    v_fmac_f32 v185, v99, v7
    v_fmac_f32 v186, v155, v5
    v_fmac_f32 v187, v155, v7
    v_lshlrev_b32 v5, 16, v44
    v_and_b32 v7, 0xffff0000, v44
    v_fmac_f32 v184, v100, v5
    v_fmac_f32 v185, v100, v7
    v_fmac_f32 v186, v156, v5
    v_fmac_f32 v187, v156, v7
    v_lshlrev_b32 v5, 16, v45
    v_and_b32 v7, 0xffff0000, v45
    v_fmac_f32 v184, v101, v5
    v_fmac_f32 v185, v101, v7
    v_fmac_f32 v186, v157, v5
    v_fmac_f32 v187, v157, v7
    v_lshlrev_b32 v5, 16, v46
    v_and_b32 v7, 0xffff0000, v46
    v_fmac_f32 v184, v102, v5
    v_fmac_f32 v185, v102, v7
    v_fmac_f32 v186, v158, v5
    v_fmac_f32 v187, v158, v7
    v_lshlrev_b32 v5, 16, v47
    v_and_b32 v7, 0xffff0000, v47
    v_fmac_f32 v184, v103, v5
    v_fmac_f32 v185, v103, v7
    v_fmac_f32 v186, v159, v5
    v_fmac_f32 v187, v159, v7
    v_lshlrev_b32 v5, 16, v48
    v_and_b32 v7, 0xffff0000, v48
    v_fmac_f32 v184, v104, v5
    v_fmac_f32 v185, v104, v7
    v_fmac_f32 v186, v160, v5
    v_fmac_f32 v187, v160, v7
    v_lshlrev_b32 v5, 16, v49
    v_and_b32 v7, 0xffff0000, v49
    v_fmac_f32 v184, v105, v5
    v_fmac_f32 v185, v105, v7
    v_fmac_f32 v186, v161, v5
    v_fmac_f32 v187, v161, v7
    v_lshlrev_b32 v5, 16, v50
    v_and_b32 v7, 0xffff0000, v50
    v_fmac_f32 v184, v106, v5
    v_fmac_f32 v185, v106, v7
    v_fmac_f32 v186, v162, v5
    v_fmac_f32 v187, v162, v7
    v_lshlrev_b32 v5, 16, v51
    v_and_b32 v7, 0xffff0000, v51
    v_fmac_f32 v184, v107, v5
    v_fmac_f32 v185, v107, v7
    v_fmac_f32 v186, v163, v5
    v_fmac_f32 v187, v163, v7
    v_lshlrev_b32 v5, 16, v52
    v_and_b32 v7, 0xffff0000, v52
    v_fmac_f32 v184, v108, v5
    v_fmac_f32 v185, v108, v7
    v_fmac_f32 v186, v164, v5
    v_fmac_f32 v187, v164, v7
    v_lshlrev_b32 v5, 16, v53
    v_and_b32 v7, 0xffff0000, v53
    v_fmac_f32 v184, v109, v5
    v_fmac_f32 v185, v109, v7
    v_fmac_f32 v186, v165, v5
    v_fmac_f32 v187, v165, v7
    v_lshlrev_b32 v5, 16, v54
    v_and_b32 v7, 0xffff0000, v54
    v_fmac_f32 v184, v110, v5
    v_fmac_f32 v185, v110, v7
    v_fmac_f32 v186, v166, v5
    v_fmac_f32 v187, v166, v7
    v_lshlrev_b32 v5, 16, v55
    v_and_b32 v7, 0xffff0000, v55
    v_fmac_f32 v184, v111, v5
    v_fmac_f32 v185, v111, v7
    v_fmac_f32 v186, v167, v5
    v_fmac_f32 v187, v167, v7
    v_lshlrev_b32 v5, 16, v56
    v_and_b32 v7, 0xffff0000, v56
    v_fmac_f32 v184, v112, v5
    v_fmac_f32 v185, v112, v7
    v_fmac_f32 v186, v168, v5
    v_fmac_f32 v187, v168, v7
    v_lshlrev_b32 v5, 16, v57
    v_and_b32 v7, 0xffff0000, v57
    v_fmac_f32 v184, v113, v5
    v_fmac_f32 v185, v113, v7
    v_fmac_f32 v186, v169, v5
    v_fmac_f32 v187, v169, v7
    v_lshlrev_b32 v5, 16, v58
    v_and_b32 v7, 0xffff0000, v58
    v_fmac_f32 v184, v114, v5
    v_fmac_f32 v185, v114, v7
    v_fmac_f32 v186, v170, v5
    v_fmac_f32 v187, v170, v7
    v_lshlrev_b32 v5, 16, v59
    v_and_b32 v7, 0xffff0000, v59
    v_fmac_f32 v184, v115, v5
    v_fmac_f32 v185, v115, v7
    v_fmac_f32 v186, v171, v5
    v_fmac_f32 v187, v171, v7
    v_lshlrev_b32 v5, 16, v60
    v_and_b32 v7, 0xffff0000, v60
    v_fmac_f32 v184, v116, v5
    v_fmac_f32 v185, v116, v7
    v_fmac_f32 v186, v172, v5
    v_fmac_f32 v187, v172, v7
    v_lshlrev_b32 v5, 16, v61
    v_and_b32 v7, 0xffff0000, v61
    v_fmac_f32 v184, v117, v5
    v_fmac_f32 v185, v117, v7
    v_fmac_f32 v186, v173, v5
    v_fmac_f32 v187, v173, v7
    v_lshlrev_b32 v5, 16, v62
    v_and_b32 v7, 0xffff0000, v62
    v_fmac_f32 v184, v118, v5
    v_fmac_f32 v185, v118, v7
    v_fmac_f32 v186, v174, v5
    v_fmac_f32 v187, v174, v7
    v_lshlrev_b32 v5, 16, v63
    v_and_b32 v7, 0xffff0000, v63
    v_fmac_f32 v184, v119, v5
    v_fmac_f32 v185, v119, v7
    v_fmac_f32 v186, v175, v5
    v_fmac_f32 v187, v175, v7
    v_lshlrev_b32 v5, 16, v64
    v_and_b32 v7, 0xffff0000, v64
    v_fmac_f32 v184, v120, v5
    v_fmac_f32 v185, v120, v7
    v_fmac_f32 v186, v176, v5
    v_fmac_f32 v187, v176, v7
    v_lshlrev_b32 v5, 16, v65
    v_and_b32 v7, 0xffff0000, v65
    v_fmac_f32 v184, v121, v5
    v_fmac_f32 v185, v121, v7
    v_fmac_f32 v186, v177, v5
    v_fmac_f32 v187, v177, v7
    v_lshlrev_b32 v5, 16, v66
    v_and_b32 v7, 0xffff0000, v66
    v_fmac_f32 v184, v122, v5
    v_fmac_f32 v185, v122, v7
    v_fmac_f32 v186, v178, v5
    v_fmac_f32 v187, v178, v7
    v_lshlrev_b32 v5, 16, v67
    v_and_b32 v7, 0xffff0000, v67
    v_fmac_f32 v184, v123, v5
    v_fmac_f32 v185, v123, v7
    v_fmac_f32 v186, v179, v5
    v_fmac_f32 v187, v179, v7
    v_lshlrev_b32 v5, 16, v68
    v_and_b32 v7, 0xffff0000, v68
    v_fmac_f32 v184, v124, v5
    v_fmac_f32 v185, v124, v7
    v_fmac_f32 v186, v180, v5
    v_fmac_f32 v187, v180, v7
    v_lshlrev_b32 v5, 16, v69
    v_and_b32 v7, 0xffff0000, v69
    v_fmac_f32 v184, v125, v5
    v_fmac_f32 v185, v125, v7
    v_fmac_f32 v186, v181, v5
    v_fmac_f32 v187, v181, v7
    v_lshlrev_b32 v5, 16, v70
    v_and_b32 v7, 0xffff0000, v70
    v_fmac_f32 v184, v126, v5
    v_fmac_f32 v185, v126, v7
    v_fmac_f32 v186, v182, v5
    v_fmac_f32 v187, v182, v7
    v_lshlrev_b32 v5, 16, v71
    v_and_b32 v7, 0xffff0000, v71
    v_fmac_f32 v184, v127, v5
    v_fmac_f32 v185, v127, v7
    v_fmac_f32 v186, v183, v5
    v_fmac_f32 v187, v183, v7
    v_add_f32_dpp v184, v184, v184 row_ror:8 row_mask:0xf bank_mask:0xf
    v_add_f32_dpp v185, v185, v185 row_ror:8 row_mask:0xf bank_mask:0xf
    v_add_f32_dpp v186, v186, v186 row_ror:8 row_mask:0xf bank_mask:0xf
    v_add_f32_dpp v187, v187, v187 row_ror:8 row_mask:0xf bank_mask:0xf
    v_mov_b32 v5, v184
    s_nop 1
    v_permlane16_swap_b32 v184, v5
    v_add_f32 v184, v184, v5
    v_mov_b32 v5, v185
    s_nop 1
    v_permlane16_swap_b32 v185, v5
    v_add_f32 v185, v185, v5
    v_mov_b32 v5, v186
    s_nop 1
    v_permlane16_swap_b32 v186, v5
    v_add_f32 v186, v186, v5
    v_mov_b32 v5, v187
    s_nop 1
    v_permlane16_swap_b32 v187, v5
    v_add_f32 v187, v187, v5
    v_mov_b32 v5, v184
    s_nop 1
    v_permlane32_swap_b32 v184, v5
    v_add_f32 v184, v184, v5
    v_mov_b32 v5, v185
    s_nop 1
    v_permlane32_swap_b32 v185, v5
    v_add_f32 v185, v185, v5
    v_mov_b32 v5, v186
    s_nop 1
    v_permlane32_swap_b32 v186, v5
    v_add_f32 v186, v186, v5
    v_mov_b32 v5, v187
    s_nop 1
    v_permlane32_swap_b32 v187, v5
    v_add_f32 v187, v187, v5
    v_lshrrev_b32 v7, 6, v0
    v_lshlrev_b32 v7, 7, v7
    v_lshl_add_u32 v7, v2, 4, v7
    ds_write_b128 v7, v[184:187]
    s_waitcnt lgkmcnt(0)
    s_barrier
    v_lshlrev_b32 v7, 4, v2
    v_lshl_add_u32 v7, v6, 3, v7
    ds_read_b64 v[16:17], v7 offset:0
    ds_read_b64 v[18:19], v7 offset:128
    ds_read_b64 v[20:21], v7 offset:256
    ds_read_b64 v[22:23], v7 offset:384
    v_mul_f32 v24, 0xbfb8aa3b, v13
    v_exp_f32 v24, v24
    s_nop 0
    v_add_f32 v24, 1.0, v24
    v_rcp_f32 v24, v24
    s_nop 0
    v_cvt_pk_bf16_f32 v5, v24, v24
    v_lshlrev_b32 v24, 16, v5
    s_waitcnt vmcnt(0) lgkmcnt(0)
    v_lshlrev_b32 v26, 16, v15
    v_and_b32 v27, 0xffff0000, v15
    v_lshlrev_b32 v28, 16, v14
    v_and_b32 v29, 0xffff0000, v14
    v_add_f32 v16, v16, v18
    v_add_f32 v20, v20, v22
    v_add_f32 v16, v16, v20
    v_cvt_pk_bf16_f32 v5, v16, v16
    v_lshlrev_b32 v16, 16, v5
    v_mul_f32 v16, v16, v24
    v_cvt_pk_bf16_f32 v5, v16, v16
    v_lshlrev_b32 v16, 16, v5
    v_add_f32 v16, v16, v26
    v_cvt_pk_bf16_f32 v5, v16, v16
    v_lshlrev_b32 v16, 16, v5
    v_add_f32 v16, v16, v28
    v_add_f32 v17, v17, v19
    v_add_f32 v21, v21, v23
    v_add_f32 v17, v17, v21
    v_cvt_pk_bf16_f32 v5, v17, v17
    v_lshlrev_b32 v17, 16, v5
    v_mul_f32 v17, v17, v24
    v_cvt_pk_bf16_f32 v5, v17, v17
    v_lshlrev_b32 v17, 16, v5
    v_add_f32 v17, v17, v27
    v_cvt_pk_bf16_f32 v5, v17, v17
    v_lshlrev_b32 v17, 16, v5
    v_add_f32 v17, v17, v29
    v_cvt_pk_bf16_f32 v16, v16, v17
    buffer_store_dword v16, v12, s[16:19], 0 offen
L_k3_end:
    s_endpgm
.globl sequential_preLN__memory_aug_recurrent_mem_tr__moe_arch_mod__prompt_kernel
.p2align 8
.type sequential_preLN__memory_aug_recurrent_mem_tr__moe_arch_mod__prompt_kernel,@function
sequential_preLN__memory_aug_recurrent_mem_tr__moe_arch_mod__prompt_kernel:
    s_cmp_ge_u32 s2, 256
    s_cbranch_scc1 L_end
    s_load_dwordx8 s[44:51], s[0:1], 0
    s_load_dwordx4 s[52:55], s[0:1], 32
    s_load_dwordx4 s[56:59], s[0:1], 104
    s_load_dwordx2 s[80:81], s[0:1], 64
    s_load_dwordx2 s[82:83], s[0:1], 96
    v_lshrrev_b32 v1, 6, v0
    s_nop 0
    v_readfirstlane_b32 s21, v1
    s_waitcnt lgkmcnt(0)
    s_mov_b32 s8, s58
    s_and_b32 s9, s59, 0xffff
    s_mov_b32 s10, 0x10000000
    s_mov_b32 s11, 0x20000
    s_mov_b32 s16, s56
    s_and_b32 s17, s57, 0xffff
    s_mov_b32 s18, 0x100
    s_mov_b32 s19, 0x20000
    s_and_b32 s3, s2, 7
    s_cmp_lg_u32 s3, 0
    s_cbranch_scc1 L_worker
    s_lshr_b32 s20, s2, 3
    v_mov_b32 v1, 0x4444
    v_bfe_u32 v14, v0, 1, 1
    s_mov_b32 s38, 0xaaaa
    v_mad_u32_u24 v1, v14, s38, v1
    v_mov_b32 v3, 0x0
    v_bfe_u32 v14, v0, 0, 1
    s_mov_b32 s38, 0x10
    v_mad_u32_u24 v3, v14, s38, v3
    v_bfe_u32 v14, v0, 1, 1
    s_mov_b32 s38, 0x20
    v_mad_u32_u24 v3, v14, s38, v3
    v_bfe_u32 v14, v0, 2, 1
    s_mov_b32 s38, 0x40
    v_mad_u32_u24 v3, v14, s38, v3
    v_bfe_u32 v14, v0, 3, 1
    s_mov_b32 s38, 0x80
    v_mad_u32_u24 v3, v14, s38, v3
    v_bfe_u32 v14, v0, 4, 1
    s_mov_b32 s38, 0x100
    v_mad_u32_u24 v3, v14, s38, v3
    v_bfe_u32 v14, v0, 5, 1
    s_mov_b32 s38, 0x200
    v_mad_u32_u24 v3, v14, s38, v3
    v_mov_b32 v2, 0x0
    v_bfe_u32 v14, v0, 0, 1
    s_mov_b32 s38, 0x10
    v_mad_u32_u24 v2, v14, s38, v2
    v_bfe_u32 v14, v0, 1, 1
    s_mov_b32 s38, 0x20
    v_mad_u32_u24 v2, v14, s38, v2
    v_bfe_u32 v14, v0, 2, 1
    s_mov_b32 s38, 0x40
    v_mad_u32_u24 v2, v14, s38, v2
    v_bfe_u32 v14, v0, 3, 1
    s_mov_b32 s38, 0x80
    v_mad_u32_u24 v2, v14, s38, v2
    v_bfe_u32 v14, v0, 4, 1
    s_mov_b32 s38, 0x100
    v_mad_u32_u24 v2, v14, s38, v2
    v_bfe_u32 v14, v0, 5, 1
    s_mov_b32 s38, 0x200
    v_mad_u32_u24 v2, v14, s38, v2
    v_bfe_u32 v14, v0, 6, 1
    s_mov_b32 s38, 0x800
    v_mad_u32_u24 v2, v14, s38, v2
    v_bfe_u32 v14, v0, 7, 1
    s_mov_b32 s38, 0x1000
    v_mad_u32_u24 v2, v14, s38, v2
    v_mov_b32 v4, 0x8000
    v_bfe_u32 v14, v0, 0, 1
    s_mov_b32 s38, 0x10
    v_mad_u32_u24 v4, v14, s38, v4
    v_bfe_u32 v14, v0, 1, 1
    s_mov_b32 s38, 0x20
    v_mad_u32_u24 v4, v14, s38, v4
    v_bfe_u32 v14, v0, 2, 1
    s_mov_b32 s38, 0x40
    v_mad_u32_u24 v4, v14, s38, v4
    v_bfe_u32 v14, v0, 3, 1
    s_mov_b32 s38, 0x80
    v_mad_u32_u24 v4, v14, s38, v4
    v_bfe_u32 v14, v0, 4, 1
    s_mov_b32 s38, 0x100
    v_mad_u32_u24 v4, v14, s38, v4
    v_bfe_u32 v14, v0, 5, 1
    s_mov_b32 s38, 0x200
    v_mad_u32_u24 v4, v14, s38, v4
    v_bfe_u32 v14, v0, 6, 1
    s_mov_b32 s38, 0x8000
    v_mad_u32_u24 v4, v14, s38, v4
    v_bfe_u32 v14, v0, 7, 1
    s_mov_b32 s38, 0x10000
    v_mad_u32_u24 v4, v14, s38, v4
    v_mov_b32 v5, 0x4000
    v_bfe_u32 v14, v0, 0, 1
    s_mov_b32 s38, 0x4
    v_mad_u32_u24 v5, v14, s38, v5
    v_bfe_u32 v14, v0, 1, 1
    s_mov_b32 s38, 0x8
    v_mad_u32_u24 v5, v14, s38, v5
    v_bfe_u32 v14, v0, 2, 1
    s_mov_b32 s38, 0x10
    v_mad_u32_u24 v5, v14, s38, v5
    v_bfe_u32 v14, v0, 3, 1
    s_mov_b32 s38, 0x20
    v_mad_u32_u24 v5, v14, s38, v5
    v_bfe_u32 v14, v0, 4, 1
    s_mov_b32 s38, 0x240
    v_mad_u32_u24 v5, v14, s38, v5
    v_bfe_u32 v14, v0, 5, 1
    s_mov_b32 s38, 0x480
    v_mad_u32_u24 v5, v14, s38, v5
    v_bfe_u32 v14, v0, 6, 1
    s_mov_b32 s38, 0x40
    v_mad_u32_u24 v5, v14, s38, v5
    v_bfe_u32 v14, v0, 7, 1
    s_mov_b32 s38, 0x80
    v_mad_u32_u24 v5, v14, s38, v5
    v_mov_b32 v6, 0x4000
    v_bfe_u32 v14, v0, 1, 1
    s_mov_b32 s38, 0x120
    v_mad_u32_u24 v6, v14, s38, v6
    v_bfe_u32 v14, v0, 2, 1
    s_mov_b32 s38, 0x240
    v_mad_u32_u24 v6, v14, s38, v6
    v_bfe_u32 v14, v0, 3, 1
    s_mov_b32 s38, 0x480
    v_mad_u32_u24 v6, v14, s38, v6
    v_bfe_u32 v14, v0, 4, 1
    s_mov_b32 s38, 0x10
    v_mad_u32_u24 v6, v14, s38, v6
    v_bfe_u32 v14, v0, 5, 1
    s_mov_b32 s38, 0x20
    v_mad_u32_u24 v6, v14, s38, v6
    v_mov_b32 v7, 0x4900
    v_bfe_u32 v14, v0, 0, 1
    s_mov_b32 s38, 0x120
    v_mad_u32_u24 v7, v14, s38, v7
    v_bfe_u32 v14, v0, 2, 1
    s_mov_b32 s38, 0x240
    v_mad_u32_u24 v7, v14, s38, v7
    v_bfe_u32 v14, v0, 3, 1
    s_mov_b32 s38, 0x480
    v_mad_u32_u24 v7, v14, s38, v7
    v_bfe_u32 v14, v0, 4, 1
    s_mov_b32 s38, 0x10
    v_mad_u32_u24 v7, v14, s38, v7
    v_bfe_u32 v14, v0, 5, 1
    s_mov_b32 s38, 0x20
    v_mad_u32_u24 v7, v14, s38, v7
    v_mov_b32 v8, 0x5200
    v_bfe_u32 v14, v0, 1, 1
    s_mov_b32 s38, 0x10
    v_mad_u32_u24 v8, v14, s38, v8
    v_bfe_u32 v14, v0, 2, 1
    s_mov_b32 s38, 0x40
    v_mad_u32_u24 v8, v14, s38, v8
    v_bfe_u32 v14, v0, 3, 1
    s_mov_b32 s38, 0x80
    v_mad_u32_u24 v8, v14, s38, v8
    v_bfe_u32 v14, v0, 4, 1
    s_mov_b32 s38, 0x20
    v_mad_u32_u24 v8, v14, s38, v8
    v_bfe_u32 v14, v0, 5, 1
    s_mov_b32 s38, 0x100
    v_mad_u32_u24 v8, v14, s38, v8
    v_bfe_u32 v14, v0, 6, 1
    s_mov_b32 s38, 0x200
    v_mad_u32_u24 v8, v14, s38, v8
    v_bfe_u32 v14, v0, 7, 1
    s_mov_b32 s38, 0x400
    v_mad_u32_u24 v8, v14, s38, v8
    v_mov_b32 v24, 0x0
    v_bfe_u32 v14, v0, 3, 1
    s_mov_b32 s38, 0x1
    v_mad_u32_u24 v24, v14, s38, v24
    v_bfe_u32 v14, v0, 4, 1
    s_mov_b32 s38, 0x2
    v_mad_u32_u24 v24, v14, s38, v24
    v_bfe_u32 v14, v0, 5, 1
    s_mov_b32 s38, 0x4
    v_mad_u32_u24 v24, v14, s38, v24
    v_bfe_u32 v14, v0, 6, 1
    s_mov_b32 s38, 0x8
    v_mad_u32_u24 v24, v14, s38, v24
    v_bfe_u32 v14, v0, 7, 1
    s_mov_b32 s38, 0x10
    v_mad_u32_u24 v24, v14, s38, v24
    v_add_u32 v24, s20, v24
    v_and_b32 v24, 31, v24
    v_lshlrev_b32 v24, 6, v24
    v_mov_b32 v9, 0x0
    v_bfe_u32 v14, v0, 0, 1
    s_mov_b32 s38, 0x8
    v_mad_u32_u24 v9, v14, s38, v9
    v_bfe_u32 v14, v0, 1, 1
    s_mov_b32 s38, 0x10
    v_mad_u32_u24 v9, v14, s38, v9
    v_bfe_u32 v14, v0, 2, 1
    s_mov_b32 s38, 0x20
    v_mad_u32_u24 v9, v14, s38, v9
    v_bfe_u32 v14, v0, 3, 1
    s_mov_b32 s38, 0x2000
    v_mad_u32_u24 v9, v14, s38, v9
    v_bfe_u32 v14, v0, 4, 1
    s_mov_b32 s38, 0x4000
    v_mad_u32_u24 v9, v14, s38, v9
    v_bfe_u32 v14, v0, 5, 1
    s_mov_b32 s38, 0x8000
    v_mad_u32_u24 v9, v14, s38, v9
    v_bfe_u32 v14, v0, 6, 1
    s_mov_b32 s38, 0x10000
    v_mad_u32_u24 v9, v14, s38, v9
    v_bfe_u32 v14, v0, 7, 1
    s_mov_b32 s38, 0x20000
    v_mad_u32_u24 v9, v14, s38, v9
    v_add_u32 v9, v9, v24
    v_mov_b32 v10, 0x80000
    v_bfe_u32 v14, v0, 0, 1
    s_mov_b32 s38, 0x8
    v_mad_u32_u24 v10, v14, s38, v10
    v_bfe_u32 v14, v0, 1, 1
    s_mov_b32 s38, 0x20
    v_mad_u32_u24 v10, v14, s38, v10
    v_bfe_u32 v14, v0, 4, 1
    s_mov_b32 s38, 0x10
    v_mad_u32_u24 v10, v14, s38, v10
    v_bfe_u32 v14, v0, 5, 1
    s_mov_b32 s38, 0x4
    v_mad_u32_u24 v10, v14, s38, v10
    v_bfe_u32 v14, v0, 6, 1
    s_mov_b32 s38, 0x800
    v_mad_u32_u24 v10, v14, s38, v10
    v_bfe_u32 v14, v0, 7, 1
    s_mov_b32 s38, 0x1000
    v_mad_u32_u24 v10, v14, s38, v10
    v_mov_b32 v25, s20
    v_mov_b32 v24, 0x0
    v_bfe_u32 v14, v25, 0, 1
    s_mov_b32 s38, 0x100
    v_mad_u32_u24 v24, v14, s38, v24
    v_bfe_u32 v14, v25, 1, 1
    s_mov_b32 s38, 0x40
    v_mad_u32_u24 v24, v14, s38, v24
    v_bfe_u32 v14, v25, 2, 1
    s_mov_b32 s38, 0x80
    v_mad_u32_u24 v24, v14, s38, v24
    v_bfe_u32 v14, v25, 3, 1
    s_mov_b32 s38, 0x200
    v_mad_u32_u24 v24, v14, s38, v24
    v_bfe_u32 v14, v25, 4, 1
    s_mov_b32 s38, 0x400
    v_mad_u32_u24 v24, v14, s38, v24
    v_add_u32 v10, v24, v10
    v_and_b32 v24, 12, v0
    v_cmp_ne_u32 vcc, 0, v24
    v_mov_b32 v24, 0x40000000
    s_nop 0
    v_cndmask_b32 v10, v10, v24, vcc
    s_lshl_b32 s6, s20, 13
    s_add_u32 s6, s6, 0x0
    s_mov_b32 s26, 4096
    v_and_b32 v24, 15, v0
    v_mov_b32 v16, 0
    v_mov_b32 v25, 0x3f80
    v_cmp_eq_u32 vcc, 0, v24
    s_nop 1
    v_cndmask_b32 v16, v16, v25, vcc
    v_mov_b32 v25, 0x3f800000
    v_cmp_eq_u32 vcc, 1, v24
    s_nop 1
    v_cndmask_b32 v16, v16, v25, vcc
    v_mov_b32 v17, 0
    v_mov_b32 v25, 0x3f80
    v_cmp_eq_u32 vcc, 4, v24
    s_nop 1
    v_cndmask_b32 v17, v17, v25, vcc
    v_mov_b32 v25, 0x3f800000
    v_cmp_eq_u32 vcc, 5, v24
    s_nop 1
    v_cndmask_b32 v17, v17, v25, vcc
    v_mov_b32 v18, 0
    v_mov_b32 v25, 0x3f80
    v_cmp_eq_u32 vcc, 8, v24
    s_nop 1
    v_cndmask_b32 v18, v18, v25, vcc
    v_mov_b32 v25, 0x3f800000
    v_cmp_eq_u32 vcc, 9, v24
    s_nop 1
    v_cndmask_b32 v18, v18, v25, vcc
    v_mov_b32 v19, 0
    v_mov_b32 v25, 0x3f80
    v_cmp_eq_u32 vcc, 12, v24
    s_nop 1
    v_cndmask_b32 v19, v19, v25, vcc
    v_mov_b32 v25, 0x3f800000
    v_cmp_eq_u32 vcc, 13, v24
    s_nop 1
    v_cndmask_b32 v19, v19, v25, vcc
    ds_write_b128 v3, v[16:19] offset:23040
    s_mov_b32 s34, 0x05040100
    s_mov_b32 s35, 0x07060302
    s_mov_b32 s33, 0x3e0293ee
    s_mov_b32 s40, 0x4e800000
    s_mov_b32 s32, 0
    s_mov_b32 s4, 0x3f803f80
    s_mov_b32 s5, 0x3f803f80
    s_lshl_b32 s36, s20, 14
    s_lshr_b32 s37, s21, 1
    s_lshl_b32 s37, s37, 12
    s_add_u32 s25, s36, s37
    s_lshl_b32 s37, s21, 11
    s_add_u32 s39, s36, s37
    s_add_u32 s39, s39, 8192
    v_mov_b32 v20, -1
    v_mov_b32 v21, -1
    v_mov_b32 v22, -1
    v_mov_b32 v23, -1
    buffer_store_dwordx4 v[20:23], v2, s[8:11], s6 offen sc1
    buffer_store_dwordx4 v[20:23], v2, s[8:11], s6 offen offset:1024 sc1
    s_lshl_b32 s36, s20, 14
    s_add_u32 s36, s36, 0x100000
    s_add_u32 s37, s36, 0x2000
    buffer_store_dwordx4 v[20:23], v2, s[8:11], s36 offen sc1
    buffer_store_dwordx4 v[20:23], v2, s[8:11], s36 offen offset:1024 sc1
    buffer_store_dwordx4 v[20:23], v2, s[8:11], s37 offen sc1
    buffer_store_dwordx4 v[20:23], v2, s[8:11], s37 offen offset:1024 sc1
    s_mul_i32 s36, s20, 0x104000
    s_add_u32 s36, s36, 0x1102000
    s_add_u32 s37, s36, 0x82000
    buffer_store_dwordx4 v[20:23], v2, s[8:11], s36 offen sc1
    buffer_store_dwordx4 v[20:23], v2, s[8:11], s36 offen offset:1024 sc1
    buffer_store_dwordx4 v[20:23], v2, s[8:11], s37 offen sc1
    buffer_store_dwordx4 v[20:23], v2, s[8:11], s37 offen offset:1024 sc1
    v_lshlrev_b32 v24, 2, v0
    v_mov_b32 v25, 0x40000000
    v_cmp_lt_u32 vcc, 63, v0
    s_nop 1
    v_cndmask_b32 v24, v24, v25, vcc
    v_mov_b32 v25, 0
    s_lshl_b32 s36, s20, 8
    s_add_u32 s36, s36, 0x190000
    s_add_u32 s37, s36, 0x2000
    buffer_store_dword v25, v24, s[8:11], s36 offen sc1
    buffer_store_dword v25, v24, s[8:11], s37 offen sc1
    s_mov_b32 s12, s46
    s_and_b32 s13, s47, 0xffff
    s_mov_b32 s14, 0x2000
    s_mov_b32 s15, 0x20000
    v_mov_b32 v24, 0x0
    v_bfe_u32 v14, v0, 0, 1
    s_mov_b32 s38, 0x8
    v_mad_u32_u24 v24, v14, s38, v24
    v_bfe_u32 v14, v0, 1, 1
    s_mov_b32 s38, 0x10
    v_mad_u32_u24 v24, v14, s38, v24
    v_bfe_u32 v14, v0, 2, 1
    s_mov_b32 s38, 0x10000
    v_mad_u32_u24 v24, v14, s38, v24
    v_bfe_u32 v14, v0, 3, 1
    s_mov_b32 s38, 0x10000
    v_mad_u32_u24 v24, v14, s38, v24
    v_bfe_u32 v14, v0, 4, 1
    s_mov_b32 s38, 0x400
    v_mad_u32_u24 v24, v14, s38, v24
    v_bfe_u32 v14, v0, 5, 1
    s_mov_b32 s38, 0x4
    v_mad_u32_u24 v24, v14, s38, v24
    v_bfe_u32 v14, v0, 6, 1
    s_mov_b32 s38, 0x40
    v_mad_u32_u24 v24, v14, s38, v24
    v_bfe_u32 v14, v0, 7, 1
    s_mov_b32 s38, 0x80
    v_mad_u32_u24 v24, v14, s38, v24
    v_mov_b32 v16, s20
    v_mov_b32 v25, 0x0
    v_bfe_u32 v14, v16, 0, 1
    s_mov_b32 s38, 0x20
    v_mad_u32_u24 v25, v14, s38, v25
    v_bfe_u32 v14, v16, 1, 1
    s_mov_b32 s38, 0x800
    v_mad_u32_u24 v25, v14, s38, v25
    v_bfe_u32 v14, v16, 2, 1
    s_mov_b32 s38, 0x1000
    v_mad_u32_u24 v25, v14, s38, v25
    v_bfe_u32 v14, v16, 3, 1
    s_mov_b32 s38, 0x100
    v_mad_u32_u24 v25, v14, s38, v25
    v_bfe_u32 v14, v16, 4, 1
    s_mov_b32 s38, 0x200
    v_mad_u32_u24 v25, v14, s38, v25
    v_add_u32 v24, v24, v25
    buffer_load_dword v12, v24, s[12:15], 0 offen
    s_waitcnt vmcnt(0)
    s_mov_b32 s36, 0x1000000
    buffer_store_dword v12, v10, s[8:11], s36 offen sc1
    s_waitcnt vmcnt(0) lgkmcnt(0)
    s_barrier
    s_getreg_b32 s36, hwreg(HW_REG_XCC_ID)
    s_and_b32 s36, s36, 15
    s_or_b32 s36, s36, 0x100
    v_mov_b32 v24, s36
    s_lshl_b32 s37, s20, 2
    v_lshlrev_b32 v25, 20, v0
    buffer_store_dword v24, v25, s[16:19], s37 offen sc1
    v_mov_b32 v15, 0x0
    v_bfe_u32 v14, v0, 0, 1
    s_mov_b32 s38, 0x4
    v_mad_u32_u24 v15, v14, s38, v15
    v_bfe_u32 v14, v0, 1, 1
    s_mov_b32 s38, 0x8
    v_mad_u32_u24 v15, v14, s38, v15
    v_bfe_u32 v14, v0, 2, 1
    s_mov_b32 s38, 0x10
    v_mad_u32_u24 v15, v14, s38, v15
    v_bfe_u32 v14, v0, 3, 1
    s_mov_b32 s38, 0x20
    v_mad_u32_u24 v15, v14, s38, v15
    v_bfe_u32 v14, v0, 4, 1
    s_mov_b32 s38, 0x8000
    v_mad_u32_u24 v15, v14, s38, v15
    v_bfe_u32 v14, v0, 5, 1
    s_mov_b32 s38, 0x20000
    v_mad_u32_u24 v15, v14, s38, v15
    v_bfe_u32 v14, v0, 6, 1
    s_mov_b32 s38, 0x40
    v_mad_u32_u24 v15, v14, s38, v15
    v_bfe_u32 v14, v0, 7, 1
    s_mov_b32 s38, 0x80
    v_mad_u32_u24 v15, v14, s38, v15
    v_mov_b32 v11, 0x0
    v_bfe_u32 v14, v0, 0, 1
    s_mov_b32 s38, 0x4
    v_mad_u32_u24 v11, v14, s38, v11
    v_bfe_u32 v14, v0, 1, 1
    s_mov_b32 s38, 0x8
    v_mad_u32_u24 v11, v14, s38, v11
    v_bfe_u32 v14, v0, 2, 1
    s_mov_b32 s38, 0x10
    v_mad_u32_u24 v11, v14, s38, v11
    v_bfe_u32 v14, v0, 3, 1
    s_mov_b32 s38, 0x20
    v_mad_u32_u24 v11, v14, s38, v11
    v_bfe_u32 v14, v0, 4, 1
    s_mov_b32 s38, 0x1000
    v_mad_u32_u24 v11, v14, s38, v11
    v_bfe_u32 v14, v0, 5, 1
    s_mov_b32 s38, 0x4000
    v_mad_u32_u24 v11, v14, s38, v11
    v_bfe_u32 v14, v0, 6, 1
    s_mov_b32 s38, 0x100
    v_mad_u32_u24 v11, v14, s38, v11
    v_bfe_u32 v14, v0, 7, 1
    s_mov_b32 s38, 0x200
    v_mad_u32_u24 v11, v14, s38, v11
    s_mov_b32 s96, s48
    s_and_b32 s97, s49, 0xffff
    s_mov_b32 s98, 0x400000
    s_mov_b32 s99, 0x20000
    s_mov_b32 s12, s50
    s_and_b32 s13, s51, 0xffff
    s_mov_b32 s14, 0x400000
    s_mov_b32 s15, 0x20000
    s_mov_b32 s60, s52
    s_and_b32 s61, s53, 0xffff
    s_mov_b32 s62, 0x400000
    s_mov_b32 s63, 0x20000
    s_mov_b32 s92, s54
    s_and_b32 s93, s55, 0xffff
    s_mov_b32 s94, 0x400000
    s_mov_b32 s95, 0x20000
    s_xor_b32 s36, s21, 0
    s_lshl_b32 s36, s36, 18
    s_lshl_b32 s37, s20, 8
    s_add_u32 s36, s36, s37
    s_add_u32 s37, s36, 0x0
    buffer_load_dword v16, v15, s[96:99], s37 offen
    s_add_u32 s37, s36, 0x2000
    buffer_load_dword v17, v15, s[96:99], s37 offen
    s_add_u32 s37, s36, 0x10000
    buffer_load_dword v18, v15, s[96:99], s37 offen
    s_add_u32 s37, s36, 0x12000
    buffer_load_dword v19, v15, s[96:99], s37 offen
    s_add_u32 s37, s36, 0x4000
    buffer_load_dword v20, v15, s[96:99], s37 offen
    s_add_u32 s37, s36, 0x6000
    buffer_load_dword v21, v15, s[96:99], s37 offen
    s_add_u32 s37, s36, 0x14000
    buffer_load_dword v22, v15, s[96:99], s37 offen
    s_add_u32 s37, s36, 0x16000
    buffer_load_dword v23, v15, s[96:99], s37 offen
    s_add_u32 s37, s36, 0x100000
    buffer_load_dword v24, v15, s[96:99], s37 offen
    s_add_u32 s37, s36, 0x102000
    buffer_load_dword v25, v15, s[96:99], s37 offen
    s_add_u32 s37, s36, 0x110000
    buffer_load_dword v26, v15, s[96:99], s37 offen
    s_add_u32 s37, s36, 0x112000
    buffer_load_dword v27, v15, s[96:99], s37 offen
    s_add_u32 s37, s36, 0x104000
    buffer_load_dword v28, v15, s[96:99], s37 offen
    s_add_u32 s37, s36, 0x106000
    buffer_load_dword v29, v15, s[96:99], s37 offen
    s_add_u32 s37, s36, 0x114000
    buffer_load_dword v30, v15, s[96:99], s37 offen
    s_add_u32 s37, s36, 0x116000
    buffer_load_dword v31, v15, s[96:99], s37 offen
    s_xor_b32 s36, s21, 0
    s_lshl_b32 s36, s36, 18
    s_lshl_b32 s37, s20, 8
    s_add_u32 s36, s36, s37
    s_add_u32 s37, s36, 0x200000
    buffer_load_dword v32, v15, s[96:99], s37 offen
    s_add_u32 s37, s36, 0x202000
    buffer_load_dword v33, v15, s[96:99], s37 offen
    s_add_u32 s37, s36, 0x210000
    buffer_load_dword v34, v15, s[96:99], s37 offen
    s_add_u32 s37, s36, 0x212000
    buffer_load_dword v35, v15, s[96:99], s37 offen
    s_add_u32 s37, s36, 0x204000
    buffer_load_dword v36, v15, s[96:99], s37 offen
    s_add_u32 s37, s36, 0x206000
    buffer_load_dword v37, v15, s[96:99], s37 offen
    s_add_u32 s37, s36, 0x214000
    buffer_load_dword v38, v15, s[96:99], s37 offen
    s_add_u32 s37, s36, 0x216000
    buffer_load_dword v39, v15, s[96:99], s37 offen
    s_add_u32 s37, s36, 0x300000
    buffer_load_dword v40, v15, s[96:99], s37 offen
    s_add_u32 s37, s36, 0x302000
    buffer_load_dword v41, v15, s[96:99], s37 offen
    s_add_u32 s37, s36, 0x310000
    buffer_load_dword v42, v15, s[96:99], s37 offen
    s_add_u32 s37, s36, 0x312000
    buffer_load_dword v43, v15, s[96:99], s37 offen
    s_add_u32 s37, s36, 0x304000
    buffer_load_dword v44, v15, s[96:99], s37 offen
    s_add_u32 s37, s36, 0x306000
    buffer_load_dword v45, v15, s[96:99], s37 offen
    s_add_u32 s37, s36, 0x314000
    buffer_load_dword v46, v15, s[96:99], s37 offen
    s_add_u32 s37, s36, 0x316000
    buffer_load_dword v47, v15, s[96:99], s37 offen
    s_xor_b32 s36, s21, 1
    s_lshl_b32 s36, s36, 18
    s_lshl_b32 s37, s20, 8
    s_add_u32 s36, s36, s37
    s_add_u32 s37, s36, 0x0
    buffer_load_dword v48, v15, s[96:99], s37 offen
    s_add_u32 s37, s36, 0x2000
    buffer_load_dword v49, v15, s[96:99], s37 offen
    s_add_u32 s37, s36, 0x10000
    buffer_load_dword v50, v15, s[96:99], s37 offen
    s_add_u32 s37, s36, 0x12000
    buffer_load_dword v51, v15, s[96:99], s37 offen
    s_add_u32 s37, s36, 0x4000
    buffer_load_dword v52, v15, s[96:99], s37 offen
    s_add_u32 s37, s36, 0x6000
    buffer_load_dword v53, v15, s[96:99], s37 offen
    s_add_u32 s37, s36, 0x14000
    buffer_load_dword v54, v15, s[96:99], s37 offen
    s_add_u32 s37, s36, 0x16000
    buffer_load_dword v55, v15, s[96:99], s37 offen
    s_add_u32 s37, s36, 0x100000
    buffer_load_dword v56, v15, s[96:99], s37 offen
    s_add_u32 s37, s36, 0x102000
    buffer_load_dword v57, v15, s[96:99], s37 offen
    s_add_u32 s37, s36, 0x110000
    buffer_load_dword v58, v15, s[96:99], s37 offen
    s_add_u32 s37, s36, 0x112000
    buffer_load_dword v59, v15, s[96:99], s37 offen
    s_add_u32 s37, s36, 0x104000
    buffer_load_dword v60, v15, s[96:99], s37 offen
    s_add_u32 s37, s36, 0x106000
    buffer_load_dword v61, v15, s[96:99], s37 offen
    s_add_u32 s37, s36, 0x114000
    buffer_load_dword v62, v15, s[96:99], s37 offen
    s_add_u32 s37, s36, 0x116000
    buffer_load_dword v63, v15, s[96:99], s37 offen
    s_waitcnt vmcnt(32)
    s_xor_b32 s36, s21, 1
    s_lshl_b32 s36, s36, 18
    s_lshl_b32 s37, s20, 8
    s_add_u32 s36, s36, s37
    s_add_u32 s37, s36, 0x200000
    buffer_load_dword v64, v15, s[96:99], s37 offen
    s_add_u32 s37, s36, 0x202000
    buffer_load_dword v65, v15, s[96:99], s37 offen
    s_add_u32 s37, s36, 0x210000
    buffer_load_dword v66, v15, s[96:99], s37 offen
    s_add_u32 s37, s36, 0x212000
    buffer_load_dword v67, v15, s[96:99], s37 offen
    s_add_u32 s37, s36, 0x204000
    buffer_load_dword v68, v15, s[96:99], s37 offen
    s_add_u32 s37, s36, 0x206000
    buffer_load_dword v69, v15, s[96:99], s37 offen
    s_add_u32 s37, s36, 0x214000
    buffer_load_dword v70, v15, s[96:99], s37 offen
    s_add_u32 s37, s36, 0x216000
    buffer_load_dword v71, v15, s[96:99], s37 offen
    s_add_u32 s37, s36, 0x300000
    buffer_load_dword v72, v15, s[96:99], s37 offen
    s_add_u32 s37, s36, 0x302000
    buffer_load_dword v73, v15, s[96:99], s37 offen
    s_add_u32 s37, s36, 0x310000
    buffer_load_dword v74, v15, s[96:99], s37 offen
    s_add_u32 s37, s36, 0x312000
    buffer_load_dword v75, v15, s[96:99], s37 offen
    s_add_u32 s37, s36, 0x304000
    buffer_load_dword v76, v15, s[96:99], s37 offen
    s_add_u32 s37, s36, 0x306000
    buffer_load_dword v77, v15, s[96:99], s37 offen
    s_add_u32 s37, s36, 0x314000
    buffer_load_dword v78, v15, s[96:99], s37 offen
    s_add_u32 s37, s36, 0x316000
    buffer_load_dword v79, v15, s[96:99], s37 offen
    v_perm_b32 v120, v17, v16, s34
    v_perm_b32 v121, v19, v18, s34
    v_perm_b32 v122, v21, v20, s34
    v_perm_b32 v123, v23, v22, s34
    v_perm_b32 v124, v25, v24, s34
    v_perm_b32 v125, v27, v26, s34
    v_perm_b32 v126, v29, v28, s34
    v_perm_b32 v127, v31, v30, s34
    ds_write_b128 v4, v[120:123] offset:0
    ds_write_b128 v4, v[124:127] offset:1024
    s_waitcnt lgkmcnt(0)
    v_perm_b32 v120, v17, v16, s35
    v_perm_b32 v121, v19, v18, s35
    v_perm_b32 v122, v21, v20, s35
    v_perm_b32 v123, v23, v22, s35
    v_perm_b32 v124, v25, v24, s35
    v_perm_b32 v125, v27, v26, s35
    v_perm_b32 v126, v29, v28, s35
    v_perm_b32 v127, v31, v30, s35
    ds_write_b128 v4, v[120:123] offset:2048
    ds_write_b128 v4, v[124:127] offset:3072
    s_waitcnt lgkmcnt(0)
    s_waitcnt vmcnt(32)
    s_xor_b32 s36, s21, 2
    s_lshl_b32 s36, s36, 18
    s_lshl_b32 s37, s20, 8
    s_add_u32 s36, s36, s37
    s_add_u32 s37, s36, 0x0
    buffer_load_dword v16, v15, s[96:99], s37 offen
    s_add_u32 s37, s36, 0x2000
    buffer_load_dword v17, v15, s[96:99], s37 offen
    s_add_u32 s37, s36, 0x10000
    buffer_load_dword v18, v15, s[96:99], s37 offen
    s_add_u32 s37, s36, 0x12000
    buffer_load_dword v19, v15, s[96:99], s37 offen
    s_add_u32 s37, s36, 0x4000
    buffer_load_dword v20, v15, s[96:99], s37 offen
    s_add_u32 s37, s36, 0x6000
    buffer_load_dword v21, v15, s[96:99], s37 offen
    s_add_u32 s37, s36, 0x14000
    buffer_load_dword v22, v15, s[96:99], s37 offen
    s_add_u32 s37, s36, 0x16000
    buffer_load_dword v23, v15, s[96:99], s37 offen
    s_add_u32 s37, s36, 0x100000
    buffer_load_dword v24, v15, s[96:99], s37 offen
    s_add_u32 s37, s36, 0x102000
    buffer_load_dword v25, v15, s[96:99], s37 offen
    s_add_u32 s37, s36, 0x110000
    buffer_load_dword v26, v15, s[96:99], s37 offen
    s_add_u32 s37, s36, 0x112000
    buffer_load_dword v27, v15, s[96:99], s37 offen
    s_add_u32 s37, s36, 0x104000
    buffer_load_dword v28, v15, s[96:99], s37 offen
    s_add_u32 s37, s36, 0x106000
    buffer_load_dword v29, v15, s[96:99], s37 offen
    s_add_u32 s37, s36, 0x114000
    buffer_load_dword v30, v15, s[96:99], s37 offen
    s_add_u32 s37, s36, 0x116000
    buffer_load_dword v31, v15, s[96:99], s37 offen
    v_perm_b32 v120, v33, v32, s34
    v_perm_b32 v121, v35, v34, s34
    v_perm_b32 v122, v37, v36, s34
    v_perm_b32 v123, v39, v38, s34
    v_perm_b32 v124, v41, v40, s34
    v_perm_b32 v125, v43, v42, s34
    v_perm_b32 v126, v45, v44, s34
    v_perm_b32 v127, v47, v46, s34
    ds_write_b128 v4, v[120:123] offset:4096
    ds_write_b128 v4, v[124:127] offset:5120
    s_waitcnt lgkmcnt(0)
    v_perm_b32 v120, v33, v32, s35
    v_perm_b32 v121, v35, v34, s35
    v_perm_b32 v122, v37, v36, s35
    v_perm_b32 v123, v39, v38, s35
    v_perm_b32 v124, v41, v40, s35
    v_perm_b32 v125, v43, v42, s35
    v_perm_b32 v126, v45, v44, s35
    v_perm_b32 v127, v47, v46, s35
    ds_write_b128 v4, v[120:123] offset:6144
    ds_write_b128 v4, v[124:127] offset:7168
    s_waitcnt lgkmcnt(0)
    s_waitcnt vmcnt(32)
    s_xor_b32 s36, s21, 2
    s_lshl_b32 s36, s36, 18
    s_lshl_b32 s37, s20, 8
    s_add_u32 s36, s36, s37
    s_add_u32 s37, s36, 0x200000
    buffer_load_dword v32, v15, s[96:99], s37 offen
    s_add_u32 s37, s36, 0x202000
    buffer_load_dword v33, v15, s[96:99], s37 offen
    s_add_u32 s37, s36, 0x210000
    buffer_load_dword v34, v15, s[96:99], s37 offen
    s_add_u32 s37, s36, 0x212000
    buffer_load_dword v35, v15, s[96:99], s37 offen
    s_add_u32 s37, s36, 0x204000
    buffer_load_dword v36, v15, s[96:99], s37 offen
    s_add_u32 s37, s36, 0x206000
    buffer_load_dword v37, v15, s[96:99], s37 offen
    s_add_u32 s37, s36, 0x214000
    buffer_load_dword v38, v15, s[96:99], s37 offen
    s_add_u32 s37, s36, 0x216000
    buffer_load_dword v39, v15, s[96:99], s37 offen
    s_add_u32 s37, s36, 0x300000
    buffer_load_dword v40, v15, s[96:99], s37 offen
    s_add_u32 s37, s36, 0x302000
    buffer_load_dword v41, v15, s[96:99], s37 offen
    s_add_u32 s37, s36, 0x310000
    buffer_load_dword v42, v15, s[96:99], s37 offen
    s_add_u32 s37, s36, 0x312000
    buffer_load_dword v43, v15, s[96:99], s37 offen
    s_add_u32 s37, s36, 0x304000
    buffer_load_dword v44, v15, s[96:99], s37 offen
    s_add_u32 s37, s36, 0x306000
    buffer_load_dword v45, v15, s[96:99], s37 offen
    s_add_u32 s37, s36, 0x314000
    buffer_load_dword v46, v15, s[96:99], s37 offen
    s_add_u32 s37, s36, 0x316000
    buffer_load_dword v47, v15, s[96:99], s37 offen
    v_perm_b32 v120, v49, v48, s34
    v_accvgpr_write_b32 a0, v120
    v_perm_b32 v121, v51, v50, s34
    v_accvgpr_write_b32 a1, v121
    v_perm_b32 v122, v53, v52, s34
    v_accvgpr_write_b32 a2, v122
    v_perm_b32 v123, v55, v54, s34
    v_accvgpr_write_b32 a3, v123
    v_perm_b32 v124, v57, v56, s34
    v_accvgpr_write_b32 a4, v124
    v_perm_b32 v125, v59, v58, s34
    v_accvgpr_write_b32 a5, v125
    v_perm_b32 v126, v61, v60, s34
    v_accvgpr_write_b32 a6, v126
    v_perm_b32 v127, v63, v62, s34
    v_accvgpr_write_b32 a7, v127
    v_perm_b32 v120, v49, v48, s35
    v_accvgpr_write_b32 a8, v120
    v_perm_b32 v121, v51, v50, s35
    v_accvgpr_write_b32 a9, v121
    v_perm_b32 v122, v53, v52, s35
    v_accvgpr_write_b32 a10, v122
    v_perm_b32 v123, v55, v54, s35
    v_accvgpr_write_b32 a11, v123
    v_perm_b32 v124, v57, v56, s35
    v_accvgpr_write_b32 a12, v124
    v_perm_b32 v125, v59, v58, s35
    v_accvgpr_write_b32 a13, v125
    v_perm_b32 v126, v61, v60, s35
    v_accvgpr_write_b32 a14, v126
    v_perm_b32 v127, v63, v62, s35
    v_accvgpr_write_b32 a15, v127
    s_waitcnt vmcnt(32)
    s_xor_b32 s36, s21, 3
    s_lshl_b32 s36, s36, 18
    s_lshl_b32 s37, s20, 8
    s_add_u32 s36, s36, s37
    s_add_u32 s37, s36, 0x0
    buffer_load_dword v48, v15, s[96:99], s37 offen
    s_add_u32 s37, s36, 0x2000
    buffer_load_dword v49, v15, s[96:99], s37 offen
    s_add_u32 s37, s36, 0x10000
    buffer_load_dword v50, v15, s[96:99], s37 offen
    s_add_u32 s37, s36, 0x12000
    buffer_load_dword v51, v15, s[96:99], s37 offen
    s_add_u32 s37, s36, 0x4000
    buffer_load_dword v52, v15, s[96:99], s37 offen
    s_add_u32 s37, s36, 0x6000
    buffer_load_dword v53, v15, s[96:99], s37 offen
    s_add_u32 s37, s36, 0x14000
    buffer_load_dword v54, v15, s[96:99], s37 offen
    s_add_u32 s37, s36, 0x16000
    buffer_load_dword v55, v15, s[96:99], s37 offen
    s_add_u32 s37, s36, 0x100000
    buffer_load_dword v56, v15, s[96:99], s37 offen
    s_add_u32 s37, s36, 0x102000
    buffer_load_dword v57, v15, s[96:99], s37 offen
    s_add_u32 s37, s36, 0x110000
    buffer_load_dword v58, v15, s[96:99], s37 offen
    s_add_u32 s37, s36, 0x112000
    buffer_load_dword v59, v15, s[96:99], s37 offen
    s_add_u32 s37, s36, 0x104000
    buffer_load_dword v60, v15, s[96:99], s37 offen
    s_add_u32 s37, s36, 0x106000
    buffer_load_dword v61, v15, s[96:99], s37 offen
    s_add_u32 s37, s36, 0x114000
    buffer_load_dword v62, v15, s[96:99], s37 offen
    s_add_u32 s37, s36, 0x116000
    buffer_load_dword v63, v15, s[96:99], s37 offen
    v_perm_b32 v120, v65, v64, s34
    v_accvgpr_write_b32 a16, v120
    v_perm_b32 v121, v67, v66, s34
    v_accvgpr_write_b32 a17, v121
    v_perm_b32 v122, v69, v68, s34
    v_accvgpr_write_b32 a18, v122
    v_perm_b32 v123, v71, v70, s34
    v_accvgpr_write_b32 a19, v123
    v_perm_b32 v124, v73, v72, s34
    v_accvgpr_write_b32 a20, v124
    v_perm_b32 v125, v75, v74, s34
    v_accvgpr_write_b32 a21, v125
    v_perm_b32 v126, v77, v76, s34
    v_accvgpr_write_b32 a22, v126
    v_perm_b32 v127, v79, v78, s34
    v_accvgpr_write_b32 a23, v127
    v_perm_b32 v120, v65, v64, s35
    v_accvgpr_write_b32 a24, v120
    v_perm_b32 v121, v67, v66, s35
    v_accvgpr_write_b32 a25, v121
    v_perm_b32 v122, v69, v68, s35
    v_accvgpr_write_b32 a26, v122
    v_perm_b32 v123, v71, v70, s35
    v_accvgpr_write_b32 a27, v123
    v_perm_b32 v124, v73, v72, s35
    v_accvgpr_write_b32 a28, v124
    v_perm_b32 v125, v75, v74, s35
    v_accvgpr_write_b32 a29, v125
    v_perm_b32 v126, v77, v76, s35
    v_accvgpr_write_b32 a30, v126
    v_perm_b32 v127, v79, v78, s35
    v_accvgpr_write_b32 a31, v127
    s_waitcnt vmcnt(32)
    s_xor_b32 s36, s21, 3
    s_lshl_b32 s36, s36, 18
    s_lshl_b32 s37, s20, 8
    s_add_u32 s36, s36, s37
    s_add_u32 s37, s36, 0x200000
    buffer_load_dword v64, v15, s[96:99], s37 offen
    s_add_u32 s37, s36, 0x202000
    buffer_load_dword v65, v15, s[96:99], s37 offen
    s_add_u32 s37, s36, 0x210000
    buffer_load_dword v66, v15, s[96:99], s37 offen
    s_add_u32 s37, s36, 0x212000
    buffer_load_dword v67, v15, s[96:99], s37 offen
    s_add_u32 s37, s36, 0x204000
    buffer_load_dword v68, v15, s[96:99], s37 offen
    s_add_u32 s37, s36, 0x206000
    buffer_load_dword v69, v15, s[96:99], s37 offen
    s_add_u32 s37, s36, 0x214000
    buffer_load_dword v70, v15, s[96:99], s37 offen
    s_add_u32 s37, s36, 0x216000
    buffer_load_dword v71, v15, s[96:99], s37 offen
    s_add_u32 s37, s36, 0x300000
    buffer_load_dword v72, v15, s[96:99], s37 offen
    s_add_u32 s37, s36, 0x302000
    buffer_load_dword v73, v15, s[96:99], s37 offen
    s_add_u32 s37, s36, 0x310000
    buffer_load_dword v74, v15, s[96:99], s37 offen
    s_add_u32 s37, s36, 0x312000
    buffer_load_dword v75, v15, s[96:99], s37 offen
    s_add_u32 s37, s36, 0x304000
    buffer_load_dword v76, v15, s[96:99], s37 offen
    s_add_u32 s37, s36, 0x306000
    buffer_load_dword v77, v15, s[96:99], s37 offen
    s_add_u32 s37, s36, 0x314000
    buffer_load_dword v78, v15, s[96:99], s37 offen
    s_add_u32 s37, s36, 0x316000
    buffer_load_dword v79, v15, s[96:99], s37 offen
    v_perm_b32 v120, v17, v16, s34
    v_accvgpr_write_b32 a32, v120
    v_perm_b32 v121, v19, v18, s34
    v_accvgpr_write_b32 a33, v121
    v_perm_b32 v122, v21, v20, s34
    v_accvgpr_write_b32 a34, v122
    v_perm_b32 v123, v23, v22, s34
    v_accvgpr_write_b32 a35, v123
    v_perm_b32 v124, v25, v24, s34
    v_accvgpr_write_b32 a36, v124
    v_perm_b32 v125, v27, v26, s34
    v_accvgpr_write_b32 a37, v125
    v_perm_b32 v126, v29, v28, s34
    v_accvgpr_write_b32 a38, v126
    v_perm_b32 v127, v31, v30, s34
    v_accvgpr_write_b32 a39, v127
    v_perm_b32 v120, v17, v16, s35
    v_accvgpr_write_b32 a40, v120
    v_perm_b32 v121, v19, v18, s35
    v_accvgpr_write_b32 a41, v121
    v_perm_b32 v122, v21, v20, s35
    v_accvgpr_write_b32 a42, v122
    v_perm_b32 v123, v23, v22, s35
    v_accvgpr_write_b32 a43, v123
    v_perm_b32 v124, v25, v24, s35
    v_accvgpr_write_b32 a44, v124
    v_perm_b32 v125, v27, v26, s35
    v_accvgpr_write_b32 a45, v125
    v_perm_b32 v126, v29, v28, s35
    v_accvgpr_write_b32 a46, v126
    v_perm_b32 v127, v31, v30, s35
    v_accvgpr_write_b32 a47, v127
    s_waitcnt vmcnt(32)
    s_xor_b32 s36, s21, 0
    s_lshl_b32 s36, s36, 18
    s_lshl_b32 s37, s20, 8
    s_add_u32 s36, s36, s37
    s_add_u32 s37, s36, 0x0
    buffer_load_dword v16, v15, s[12:15], s37 offen
    s_add_u32 s37, s36, 0x2000
    buffer_load_dword v17, v15, s[12:15], s37 offen
    s_add_u32 s37, s36, 0x10000
    buffer_load_dword v18, v15, s[12:15], s37 offen
    s_add_u32 s37, s36, 0x12000
    buffer_load_dword v19, v15, s[12:15], s37 offen
    s_add_u32 s37, s36, 0x4000
    buffer_load_dword v20, v15, s[12:15], s37 offen
    s_add_u32 s37, s36, 0x6000
    buffer_load_dword v21, v15, s[12:15], s37 offen
    s_add_u32 s37, s36, 0x14000
    buffer_load_dword v22, v15, s[12:15], s37 offen
    s_add_u32 s37, s36, 0x16000
    buffer_load_dword v23, v15, s[12:15], s37 offen
    s_add_u32 s37, s36, 0x100000
    buffer_load_dword v24, v15, s[12:15], s37 offen
    s_add_u32 s37, s36, 0x102000
    buffer_load_dword v25, v15, s[12:15], s37 offen
    s_add_u32 s37, s36, 0x110000
    buffer_load_dword v26, v15, s[12:15], s37 offen
    s_add_u32 s37, s36, 0x112000
    buffer_load_dword v27, v15, s[12:15], s37 offen
    s_add_u32 s37, s36, 0x104000
    buffer_load_dword v28, v15, s[12:15], s37 offen
    s_add_u32 s37, s36, 0x106000
    buffer_load_dword v29, v15, s[12:15], s37 offen
    s_add_u32 s37, s36, 0x114000
    buffer_load_dword v30, v15, s[12:15], s37 offen
    s_add_u32 s37, s36, 0x116000
    buffer_load_dword v31, v15, s[12:15], s37 offen
    v_perm_b32 v120, v33, v32, s34
    v_accvgpr_write_b32 a48, v120
    v_perm_b32 v121, v35, v34, s34
    v_accvgpr_write_b32 a49, v121
    v_perm_b32 v122, v37, v36, s34
    v_accvgpr_write_b32 a50, v122
    v_perm_b32 v123, v39, v38, s34
    v_accvgpr_write_b32 a51, v123
    v_perm_b32 v124, v41, v40, s34
    v_accvgpr_write_b32 a52, v124
    v_perm_b32 v125, v43, v42, s34
    v_accvgpr_write_b32 a53, v125
    v_perm_b32 v126, v45, v44, s34
    v_accvgpr_write_b32 a54, v126
    v_perm_b32 v127, v47, v46, s34
    v_accvgpr_write_b32 a55, v127
    v_perm_b32 v120, v33, v32, s35
    v_accvgpr_write_b32 a56, v120
    v_perm_b32 v121, v35, v34, s35
    v_accvgpr_write_b32 a57, v121
    v_perm_b32 v122, v37, v36, s35
    v_accvgpr_write_b32 a58, v122
    v_perm_b32 v123, v39, v38, s35
    v_accvgpr_write_b32 a59, v123
    v_perm_b32 v124, v41, v40, s35
    v_accvgpr_write_b32 a60, v124
    v_perm_b32 v125, v43, v42, s35
    v_accvgpr_write_b32 a61, v125
    v_perm_b32 v126, v45, v44, s35
    v_accvgpr_write_b32 a62, v126
    v_perm_b32 v127, v47, v46, s35
    v_accvgpr_write_b32 a63, v127
    s_waitcnt vmcnt(32)
    s_xor_b32 s36, s21, 0
    s_lshl_b32 s36, s36, 18
    s_lshl_b32 s37, s20, 8
    s_add_u32 s36, s36, s37
    s_add_u32 s37, s36, 0x200000
    buffer_load_dword v32, v15, s[12:15], s37 offen
    s_add_u32 s37, s36, 0x202000
    buffer_load_dword v33, v15, s[12:15], s37 offen
    s_add_u32 s37, s36, 0x210000
    buffer_load_dword v34, v15, s[12:15], s37 offen
    s_add_u32 s37, s36, 0x212000
    buffer_load_dword v35, v15, s[12:15], s37 offen
    s_add_u32 s37, s36, 0x204000
    buffer_load_dword v36, v15, s[12:15], s37 offen
    s_add_u32 s37, s36, 0x206000
    buffer_load_dword v37, v15, s[12:15], s37 offen
    s_add_u32 s37, s36, 0x214000
    buffer_load_dword v38, v15, s[12:15], s37 offen
    s_add_u32 s37, s36, 0x216000
    buffer_load_dword v39, v15, s[12:15], s37 offen
    s_add_u32 s37, s36, 0x300000
    buffer_load_dword v40, v15, s[12:15], s37 offen
    s_add_u32 s37, s36, 0x302000
    buffer_load_dword v41, v15, s[12:15], s37 offen
    s_add_u32 s37, s36, 0x310000
    buffer_load_dword v42, v15, s[12:15], s37 offen
    s_add_u32 s37, s36, 0x312000
    buffer_load_dword v43, v15, s[12:15], s37 offen
    s_add_u32 s37, s36, 0x304000
    buffer_load_dword v44, v15, s[12:15], s37 offen
    s_add_u32 s37, s36, 0x306000
    buffer_load_dword v45, v15, s[12:15], s37 offen
    s_add_u32 s37, s36, 0x314000
    buffer_load_dword v46, v15, s[12:15], s37 offen
    s_add_u32 s37, s36, 0x316000
    buffer_load_dword v47, v15, s[12:15], s37 offen
    v_perm_b32 v120, v49, v48, s34
    v_accvgpr_write_b32 a64, v120
    v_perm_b32 v121, v51, v50, s34
    v_accvgpr_write_b32 a65, v121
    v_perm_b32 v122, v53, v52, s34
    v_accvgpr_write_b32 a66, v122
    v_perm_b32 v123, v55, v54, s34
    v_accvgpr_write_b32 a67, v123
    v_perm_b32 v124, v57, v56, s34
    v_accvgpr_write_b32 a68, v124
    v_perm_b32 v125, v59, v58, s34
    v_accvgpr_write_b32 a69, v125
    v_perm_b32 v126, v61, v60, s34
    v_accvgpr_write_b32 a70, v126
    v_perm_b32 v127, v63, v62, s34
    v_accvgpr_write_b32 a71, v127
    v_perm_b32 v120, v49, v48, s35
    v_accvgpr_write_b32 a72, v120
    v_perm_b32 v121, v51, v50, s35
    v_accvgpr_write_b32 a73, v121
    v_perm_b32 v122, v53, v52, s35
    v_accvgpr_write_b32 a74, v122
    v_perm_b32 v123, v55, v54, s35
    v_accvgpr_write_b32 a75, v123
    v_perm_b32 v124, v57, v56, s35
    v_accvgpr_write_b32 a76, v124
    v_perm_b32 v125, v59, v58, s35
    v_accvgpr_write_b32 a77, v125
    v_perm_b32 v126, v61, v60, s35
    v_accvgpr_write_b32 a78, v126
    v_perm_b32 v127, v63, v62, s35
    v_accvgpr_write_b32 a79, v127
    s_waitcnt vmcnt(32)
    s_xor_b32 s36, s21, 1
    s_lshl_b32 s36, s36, 18
    s_lshl_b32 s37, s20, 8
    s_add_u32 s36, s36, s37
    s_add_u32 s37, s36, 0x0
    buffer_load_dword v48, v15, s[12:15], s37 offen
    s_add_u32 s37, s36, 0x2000
    buffer_load_dword v49, v15, s[12:15], s37 offen
    s_add_u32 s37, s36, 0x10000
    buffer_load_dword v50, v15, s[12:15], s37 offen
    s_add_u32 s37, s36, 0x12000
    buffer_load_dword v51, v15, s[12:15], s37 offen
    s_add_u32 s37, s36, 0x4000
    buffer_load_dword v52, v15, s[12:15], s37 offen
    s_add_u32 s37, s36, 0x6000
    buffer_load_dword v53, v15, s[12:15], s37 offen
    s_add_u32 s37, s36, 0x14000
    buffer_load_dword v54, v15, s[12:15], s37 offen
    s_add_u32 s37, s36, 0x16000
    buffer_load_dword v55, v15, s[12:15], s37 offen
    s_add_u32 s37, s36, 0x100000
    buffer_load_dword v56, v15, s[12:15], s37 offen
    s_add_u32 s37, s36, 0x102000
    buffer_load_dword v57, v15, s[12:15], s37 offen
    s_add_u32 s37, s36, 0x110000
    buffer_load_dword v58, v15, s[12:15], s37 offen
    s_add_u32 s37, s36, 0x112000
    buffer_load_dword v59, v15, s[12:15], s37 offen
    s_add_u32 s37, s36, 0x104000
    buffer_load_dword v60, v15, s[12:15], s37 offen
    s_add_u32 s37, s36, 0x106000
    buffer_load_dword v61, v15, s[12:15], s37 offen
    s_add_u32 s37, s36, 0x114000
    buffer_load_dword v62, v15, s[12:15], s37 offen
    s_add_u32 s37, s36, 0x116000
    buffer_load_dword v63, v15, s[12:15], s37 offen
    v_perm_b32 v120, v65, v64, s34
    v_perm_b32 v121, v67, v66, s34
    v_perm_b32 v122, v69, v68, s34
    v_perm_b32 v123, v71, v70, s34
    v_perm_b32 v124, v73, v72, s34
    v_perm_b32 v125, v75, v74, s34
    v_perm_b32 v126, v77, v76, s34
    v_perm_b32 v127, v79, v78, s34
    ds_write_b128 v4, v[120:123] offset:12288
    ds_write_b128 v4, v[124:127] offset:13312
    s_waitcnt lgkmcnt(0)
    v_perm_b32 v120, v65, v64, s35
    v_perm_b32 v121, v67, v66, s35
    v_perm_b32 v122, v69, v68, s35
    v_perm_b32 v123, v71, v70, s35
    v_perm_b32 v124, v73, v72, s35
    v_perm_b32 v125, v75, v74, s35
    v_perm_b32 v126, v77, v76, s35
    v_perm_b32 v127, v79, v78, s35
    ds_write_b128 v4, v[120:123] offset:14336
    ds_write_b128 v4, v[124:127] offset:15360
    s_waitcnt lgkmcnt(0)
    s_waitcnt vmcnt(32)
    s_xor_b32 s36, s21, 1
    s_lshl_b32 s36, s36, 18
    s_lshl_b32 s37, s20, 8
    s_add_u32 s36, s36, s37
    s_add_u32 s37, s36, 0x200000
    buffer_load_dword v64, v15, s[12:15], s37 offen
    s_add_u32 s37, s36, 0x202000
    buffer_load_dword v65, v15, s[12:15], s37 offen
    s_add_u32 s37, s36, 0x210000
    buffer_load_dword v66, v15, s[12:15], s37 offen
    s_add_u32 s37, s36, 0x212000
    buffer_load_dword v67, v15, s[12:15], s37 offen
    s_add_u32 s37, s36, 0x204000
    buffer_load_dword v68, v15, s[12:15], s37 offen
    s_add_u32 s37, s36, 0x206000
    buffer_load_dword v69, v15, s[12:15], s37 offen
    s_add_u32 s37, s36, 0x214000
    buffer_load_dword v70, v15, s[12:15], s37 offen
    s_add_u32 s37, s36, 0x216000
    buffer_load_dword v71, v15, s[12:15], s37 offen
    s_add_u32 s37, s36, 0x300000
    buffer_load_dword v72, v15, s[12:15], s37 offen
    s_add_u32 s37, s36, 0x302000
    buffer_load_dword v73, v15, s[12:15], s37 offen
    s_add_u32 s37, s36, 0x310000
    buffer_load_dword v74, v15, s[12:15], s37 offen
    s_add_u32 s37, s36, 0x312000
    buffer_load_dword v75, v15, s[12:15], s37 offen
    s_add_u32 s37, s36, 0x304000
    buffer_load_dword v76, v15, s[12:15], s37 offen
    s_add_u32 s37, s36, 0x306000
    buffer_load_dword v77, v15, s[12:15], s37 offen
    s_add_u32 s37, s36, 0x314000
    buffer_load_dword v78, v15, s[12:15], s37 offen
    s_add_u32 s37, s36, 0x316000
    buffer_load_dword v79, v15, s[12:15], s37 offen
    v_perm_b32 v120, v17, v16, s34
    v_perm_b32 v121, v19, v18, s34
    v_perm_b32 v122, v21, v20, s34
    v_perm_b32 v123, v23, v22, s34
    v_perm_b32 v124, v25, v24, s34
    v_perm_b32 v125, v27, v26, s34
    v_perm_b32 v126, v29, v28, s34
    v_perm_b32 v127, v31, v30, s34
    ds_write_b128 v4, v[120:123] offset:8192
    ds_write_b128 v4, v[124:127] offset:9216
    s_waitcnt lgkmcnt(0)
    v_perm_b32 v120, v17, v16, s35
    v_perm_b32 v121, v19, v18, s35
    v_perm_b32 v122, v21, v20, s35
    v_perm_b32 v123, v23, v22, s35
    v_perm_b32 v124, v25, v24, s35
    v_perm_b32 v125, v27, v26, s35
    v_perm_b32 v126, v29, v28, s35
    v_perm_b32 v127, v31, v30, s35
    ds_write_b128 v4, v[120:123] offset:10240
    ds_write_b128 v4, v[124:127] offset:11264
    s_waitcnt lgkmcnt(0)
    s_waitcnt vmcnt(32)
    s_xor_b32 s36, s21, 2
    s_lshl_b32 s36, s36, 18
    s_lshl_b32 s37, s20, 8
    s_add_u32 s36, s36, s37
    s_add_u32 s37, s36, 0x0
    buffer_load_dword v16, v15, s[12:15], s37 offen
    s_add_u32 s37, s36, 0x2000
    buffer_load_dword v17, v15, s[12:15], s37 offen
    s_add_u32 s37, s36, 0x10000
    buffer_load_dword v18, v15, s[12:15], s37 offen
    s_add_u32 s37, s36, 0x12000
    buffer_load_dword v19, v15, s[12:15], s37 offen
    s_add_u32 s37, s36, 0x4000
    buffer_load_dword v20, v15, s[12:15], s37 offen
    s_add_u32 s37, s36, 0x6000
    buffer_load_dword v21, v15, s[12:15], s37 offen
    s_add_u32 s37, s36, 0x14000
    buffer_load_dword v22, v15, s[12:15], s37 offen
    s_add_u32 s37, s36, 0x16000
    buffer_load_dword v23, v15, s[12:15], s37 offen
    s_add_u32 s37, s36, 0x100000
    buffer_load_dword v24, v15, s[12:15], s37 offen
    s_add_u32 s37, s36, 0x102000
    buffer_load_dword v25, v15, s[12:15], s37 offen
    s_add_u32 s37, s36, 0x110000
    buffer_load_dword v26, v15, s[12:15], s37 offen
    s_add_u32 s37, s36, 0x112000
    buffer_load_dword v27, v15, s[12:15], s37 offen
    s_add_u32 s37, s36, 0x104000
    buffer_load_dword v28, v15, s[12:15], s37 offen
    s_add_u32 s37, s36, 0x106000
    buffer_load_dword v29, v15, s[12:15], s37 offen
    s_add_u32 s37, s36, 0x114000
    buffer_load_dword v30, v15, s[12:15], s37 offen
    s_add_u32 s37, s36, 0x116000
    buffer_load_dword v31, v15, s[12:15], s37 offen
    v_perm_b32 v120, v33, v32, s34
    v_accvgpr_write_b32 a80, v120
    v_perm_b32 v121, v35, v34, s34
    v_accvgpr_write_b32 a81, v121
    v_perm_b32 v122, v37, v36, s34
    v_accvgpr_write_b32 a82, v122
    v_perm_b32 v123, v39, v38, s34
    v_accvgpr_write_b32 a83, v123
    v_perm_b32 v124, v41, v40, s34
    v_accvgpr_write_b32 a84, v124
    v_perm_b32 v125, v43, v42, s34
    v_accvgpr_write_b32 a85, v125
    v_perm_b32 v126, v45, v44, s34
    v_accvgpr_write_b32 a86, v126
    v_perm_b32 v127, v47, v46, s34
    v_accvgpr_write_b32 a87, v127
    v_perm_b32 v120, v33, v32, s35
    v_accvgpr_write_b32 a88, v120
    v_perm_b32 v121, v35, v34, s35
    v_accvgpr_write_b32 a89, v121
    v_perm_b32 v122, v37, v36, s35
    v_accvgpr_write_b32 a90, v122
    v_perm_b32 v123, v39, v38, s35
    v_accvgpr_write_b32 a91, v123
    v_perm_b32 v124, v41, v40, s35
    v_accvgpr_write_b32 a92, v124
    v_perm_b32 v125, v43, v42, s35
    v_accvgpr_write_b32 a93, v125
    v_perm_b32 v126, v45, v44, s35
    v_accvgpr_write_b32 a94, v126
    v_perm_b32 v127, v47, v46, s35
    v_accvgpr_write_b32 a95, v127
    s_waitcnt vmcnt(32)
    s_xor_b32 s36, s21, 2
    s_lshl_b32 s36, s36, 18
    s_lshl_b32 s37, s20, 8
    s_add_u32 s36, s36, s37
    s_add_u32 s37, s36, 0x200000
    buffer_load_dword v32, v15, s[12:15], s37 offen
    s_add_u32 s37, s36, 0x202000
    buffer_load_dword v33, v15, s[12:15], s37 offen
    s_add_u32 s37, s36, 0x210000
    buffer_load_dword v34, v15, s[12:15], s37 offen
    s_add_u32 s37, s36, 0x212000
    buffer_load_dword v35, v15, s[12:15], s37 offen
    s_add_u32 s37, s36, 0x204000
    buffer_load_dword v36, v15, s[12:15], s37 offen
    s_add_u32 s37, s36, 0x206000
    buffer_load_dword v37, v15, s[12:15], s37 offen
    s_add_u32 s37, s36, 0x214000
    buffer_load_dword v38, v15, s[12:15], s37 offen
    s_add_u32 s37, s36, 0x216000
    buffer_load_dword v39, v15, s[12:15], s37 offen
    s_add_u32 s37, s36, 0x300000
    buffer_load_dword v40, v15, s[12:15], s37 offen
    s_add_u32 s37, s36, 0x302000
    buffer_load_dword v41, v15, s[12:15], s37 offen
    s_add_u32 s37, s36, 0x310000
    buffer_load_dword v42, v15, s[12:15], s37 offen
    s_add_u32 s37, s36, 0x312000
    buffer_load_dword v43, v15, s[12:15], s37 offen
    s_add_u32 s37, s36, 0x304000
    buffer_load_dword v44, v15, s[12:15], s37 offen
    s_add_u32 s37, s36, 0x306000
    buffer_load_dword v45, v15, s[12:15], s37 offen
    s_add_u32 s37, s36, 0x314000
    buffer_load_dword v46, v15, s[12:15], s37 offen
    s_add_u32 s37, s36, 0x316000
    buffer_load_dword v47, v15, s[12:15], s37 offen
    v_perm_b32 v120, v49, v48, s34
    v_perm_b32 v121, v51, v50, s34
    v_perm_b32 v122, v53, v52, s34
    v_perm_b32 v123, v55, v54, s34
    v_perm_b32 v124, v57, v56, s34
    v_perm_b32 v125, v59, v58, s34
    v_perm_b32 v126, v61, v60, s34
    v_perm_b32 v127, v63, v62, s34
    ds_write_b128 v4, v[120:123] offset:16384
    ds_write_b128 v4, v[124:127] offset:17408
    s_waitcnt lgkmcnt(0)
    v_perm_b32 v120, v49, v48, s35
    v_perm_b32 v121, v51, v50, s35
    v_perm_b32 v122, v53, v52, s35
    v_perm_b32 v123, v55, v54, s35
    v_perm_b32 v124, v57, v56, s35
    v_perm_b32 v125, v59, v58, s35
    v_perm_b32 v126, v61, v60, s35
    v_perm_b32 v127, v63, v62, s35
    ds_write_b128 v4, v[120:123] offset:18432
    ds_write_b128 v4, v[124:127] offset:19456
    s_waitcnt lgkmcnt(0)
    s_waitcnt vmcnt(32)
    s_xor_b32 s36, s21, 3
    s_lshl_b32 s36, s36, 18
    s_lshl_b32 s37, s20, 8
    s_add_u32 s36, s36, s37
    s_add_u32 s37, s36, 0x0
    buffer_load_dword v48, v15, s[12:15], s37 offen
    s_add_u32 s37, s36, 0x2000
    buffer_load_dword v49, v15, s[12:15], s37 offen
    s_add_u32 s37, s36, 0x10000
    buffer_load_dword v50, v15, s[12:15], s37 offen
    s_add_u32 s37, s36, 0x12000
    buffer_load_dword v51, v15, s[12:15], s37 offen
    s_add_u32 s37, s36, 0x4000
    buffer_load_dword v52, v15, s[12:15], s37 offen
    s_add_u32 s37, s36, 0x6000
    buffer_load_dword v53, v15, s[12:15], s37 offen
    s_add_u32 s37, s36, 0x14000
    buffer_load_dword v54, v15, s[12:15], s37 offen
    s_add_u32 s37, s36, 0x16000
    buffer_load_dword v55, v15, s[12:15], s37 offen
    s_add_u32 s37, s36, 0x100000
    buffer_load_dword v56, v15, s[12:15], s37 offen
    s_add_u32 s37, s36, 0x102000
    buffer_load_dword v57, v15, s[12:15], s37 offen
    s_add_u32 s37, s36, 0x110000
    buffer_load_dword v58, v15, s[12:15], s37 offen
    s_add_u32 s37, s36, 0x112000
    buffer_load_dword v59, v15, s[12:15], s37 offen
    s_add_u32 s37, s36, 0x104000
    buffer_load_dword v60, v15, s[12:15], s37 offen
    s_add_u32 s37, s36, 0x106000
    buffer_load_dword v61, v15, s[12:15], s37 offen
    s_add_u32 s37, s36, 0x114000
    buffer_load_dword v62, v15, s[12:15], s37 offen
    s_add_u32 s37, s36, 0x116000
    buffer_load_dword v63, v15, s[12:15], s37 offen
    v_perm_b32 v120, v65, v64, s34
    v_accvgpr_write_b32 a96, v120
    v_perm_b32 v121, v67, v66, s34
    v_accvgpr_write_b32 a97, v121
    v_perm_b32 v122, v69, v68, s34
    v_accvgpr_write_b32 a98, v122
    v_perm_b32 v123, v71, v70, s34
    v_accvgpr_write_b32 a99, v123
    v_perm_b32 v124, v73, v72, s34
    v_accvgpr_write_b32 a100, v124
    v_perm_b32 v125, v75, v74, s34
    v_accvgpr_write_b32 a101, v125
    v_perm_b32 v126, v77, v76, s34
    v_accvgpr_write_b32 a102, v126
    v_perm_b32 v127, v79, v78, s34
    v_accvgpr_write_b32 a103, v127
    v_perm_b32 v120, v65, v64, s35
    v_accvgpr_write_b32 a104, v120
    v_perm_b32 v121, v67, v66, s35
    v_accvgpr_write_b32 a105, v121
    v_perm_b32 v122, v69, v68, s35
    v_accvgpr_write_b32 a106, v122
    v_perm_b32 v123, v71, v70, s35
    v_accvgpr_write_b32 a107, v123
    v_perm_b32 v124, v73, v72, s35
    v_accvgpr_write_b32 a108, v124
    v_perm_b32 v125, v75, v74, s35
    v_accvgpr_write_b32 a109, v125
    v_perm_b32 v126, v77, v76, s35
    v_accvgpr_write_b32 a110, v126
    v_perm_b32 v127, v79, v78, s35
    v_accvgpr_write_b32 a111, v127
    s_waitcnt vmcnt(32)
    s_xor_b32 s36, s21, 3
    s_lshl_b32 s36, s36, 18
    s_lshl_b32 s37, s20, 8
    s_add_u32 s36, s36, s37
    s_add_u32 s37, s36, 0x200000
    buffer_load_dword v64, v15, s[12:15], s37 offen
    s_add_u32 s37, s36, 0x202000
    buffer_load_dword v65, v15, s[12:15], s37 offen
    s_add_u32 s37, s36, 0x210000
    buffer_load_dword v66, v15, s[12:15], s37 offen
    s_add_u32 s37, s36, 0x212000
    buffer_load_dword v67, v15, s[12:15], s37 offen
    s_add_u32 s37, s36, 0x204000
    buffer_load_dword v68, v15, s[12:15], s37 offen
    s_add_u32 s37, s36, 0x206000
    buffer_load_dword v69, v15, s[12:15], s37 offen
    s_add_u32 s37, s36, 0x214000
    buffer_load_dword v70, v15, s[12:15], s37 offen
    s_add_u32 s37, s36, 0x216000
    buffer_load_dword v71, v15, s[12:15], s37 offen
    s_add_u32 s37, s36, 0x300000
    buffer_load_dword v72, v15, s[12:15], s37 offen
    s_add_u32 s37, s36, 0x302000
    buffer_load_dword v73, v15, s[12:15], s37 offen
    s_add_u32 s37, s36, 0x310000
    buffer_load_dword v74, v15, s[12:15], s37 offen
    s_add_u32 s37, s36, 0x312000
    buffer_load_dword v75, v15, s[12:15], s37 offen
    s_add_u32 s37, s36, 0x304000
    buffer_load_dword v76, v15, s[12:15], s37 offen
    s_add_u32 s37, s36, 0x306000
    buffer_load_dword v77, v15, s[12:15], s37 offen
    s_add_u32 s37, s36, 0x314000
    buffer_load_dword v78, v15, s[12:15], s37 offen
    s_add_u32 s37, s36, 0x316000
    buffer_load_dword v79, v15, s[12:15], s37 offen
    v_perm_b32 v120, v17, v16, s34
    v_accvgpr_write_b32 a112, v120
    v_perm_b32 v121, v19, v18, s34
    v_accvgpr_write_b32 a113, v121
    v_perm_b32 v122, v21, v20, s34
    v_accvgpr_write_b32 a114, v122
    v_perm_b32 v123, v23, v22, s34
    v_accvgpr_write_b32 a115, v123
    v_perm_b32 v124, v25, v24, s34
    v_accvgpr_write_b32 a116, v124
    v_perm_b32 v125, v27, v26, s34
    v_accvgpr_write_b32 a117, v125
    v_perm_b32 v126, v29, v28, s34
    v_accvgpr_write_b32 a118, v126
    v_perm_b32 v127, v31, v30, s34
    v_accvgpr_write_b32 a119, v127
    v_perm_b32 v120, v17, v16, s35
    v_accvgpr_write_b32 a120, v120
    v_perm_b32 v121, v19, v18, s35
    v_accvgpr_write_b32 a121, v121
    v_perm_b32 v122, v21, v20, s35
    v_accvgpr_write_b32 a122, v122
    v_perm_b32 v123, v23, v22, s35
    v_accvgpr_write_b32 a123, v123
    v_perm_b32 v124, v25, v24, s35
    v_accvgpr_write_b32 a124, v124
    v_perm_b32 v125, v27, v26, s35
    v_accvgpr_write_b32 a125, v125
    v_perm_b32 v126, v29, v28, s35
    v_accvgpr_write_b32 a126, v126
    v_perm_b32 v127, v31, v30, s35
    v_accvgpr_write_b32 a127, v127
    s_waitcnt vmcnt(32)
    s_xor_b32 s36, s21, 0
    s_lshl_b32 s36, s36, 18
    s_lshl_b32 s37, s20, 8
    s_add_u32 s36, s36, s37
    s_add_u32 s37, s36, 0x0
    buffer_load_dword v16, v15, s[60:63], s37 offen
    s_add_u32 s37, s36, 0x2000
    buffer_load_dword v17, v15, s[60:63], s37 offen
    s_add_u32 s37, s36, 0x10000
    buffer_load_dword v18, v15, s[60:63], s37 offen
    s_add_u32 s37, s36, 0x12000
    buffer_load_dword v19, v15, s[60:63], s37 offen
    s_add_u32 s37, s36, 0x4000
    buffer_load_dword v20, v15, s[60:63], s37 offen
    s_add_u32 s37, s36, 0x6000
    buffer_load_dword v21, v15, s[60:63], s37 offen
    s_add_u32 s37, s36, 0x14000
    buffer_load_dword v22, v15, s[60:63], s37 offen
    s_add_u32 s37, s36, 0x16000
    buffer_load_dword v23, v15, s[60:63], s37 offen
    s_add_u32 s37, s36, 0x100000
    buffer_load_dword v24, v15, s[60:63], s37 offen
    s_add_u32 s37, s36, 0x102000
    buffer_load_dword v25, v15, s[60:63], s37 offen
    s_add_u32 s37, s36, 0x110000
    buffer_load_dword v26, v15, s[60:63], s37 offen
    s_add_u32 s37, s36, 0x112000
    buffer_load_dword v27, v15, s[60:63], s37 offen
    s_add_u32 s37, s36, 0x104000
    buffer_load_dword v28, v15, s[60:63], s37 offen
    s_add_u32 s37, s36, 0x106000
    buffer_load_dword v29, v15, s[60:63], s37 offen
    s_add_u32 s37, s36, 0x114000
    buffer_load_dword v30, v15, s[60:63], s37 offen
    s_add_u32 s37, s36, 0x116000
    buffer_load_dword v31, v15, s[60:63], s37 offen
    v_perm_b32 v120, v33, v32, s34
    v_accvgpr_write_b32 a128, v120
    v_perm_b32 v121, v35, v34, s34
    v_accvgpr_write_b32 a129, v121
    v_perm_b32 v122, v37, v36, s34
    v_accvgpr_write_b32 a130, v122
    v_perm_b32 v123, v39, v38, s34
    v_accvgpr_write_b32 a131, v123
    v_perm_b32 v124, v41, v40, s34
    v_accvgpr_write_b32 a132, v124
    v_perm_b32 v125, v43, v42, s34
    v_accvgpr_write_b32 a133, v125
    v_perm_b32 v126, v45, v44, s34
    v_accvgpr_write_b32 a134, v126
    v_perm_b32 v127, v47, v46, s34
    v_accvgpr_write_b32 a135, v127
    v_perm_b32 v120, v33, v32, s35
    v_accvgpr_write_b32 a136, v120
    v_perm_b32 v121, v35, v34, s35
    v_accvgpr_write_b32 a137, v121
    v_perm_b32 v122, v37, v36, s35
    v_accvgpr_write_b32 a138, v122
    v_perm_b32 v123, v39, v38, s35
    v_accvgpr_write_b32 a139, v123
    v_perm_b32 v124, v41, v40, s35
    v_accvgpr_write_b32 a140, v124
    v_perm_b32 v125, v43, v42, s35
    v_accvgpr_write_b32 a141, v125
    v_perm_b32 v126, v45, v44, s35
    v_accvgpr_write_b32 a142, v126
    v_perm_b32 v127, v47, v46, s35
    v_accvgpr_write_b32 a143, v127
    s_waitcnt vmcnt(32)
    s_xor_b32 s36, s21, 0
    s_lshl_b32 s36, s36, 18
    s_lshl_b32 s37, s20, 8
    s_add_u32 s36, s36, s37
    s_add_u32 s37, s36, 0x200000
    buffer_load_dword v32, v15, s[60:63], s37 offen
    s_add_u32 s37, s36, 0x202000
    buffer_load_dword v33, v15, s[60:63], s37 offen
    s_add_u32 s37, s36, 0x210000
    buffer_load_dword v34, v15, s[60:63], s37 offen
    s_add_u32 s37, s36, 0x212000
    buffer_load_dword v35, v15, s[60:63], s37 offen
    s_add_u32 s37, s36, 0x204000
    buffer_load_dword v36, v15, s[60:63], s37 offen
    s_add_u32 s37, s36, 0x206000
    buffer_load_dword v37, v15, s[60:63], s37 offen
    s_add_u32 s37, s36, 0x214000
    buffer_load_dword v38, v15, s[60:63], s37 offen
    s_add_u32 s37, s36, 0x216000
    buffer_load_dword v39, v15, s[60:63], s37 offen
    s_add_u32 s37, s36, 0x300000
    buffer_load_dword v40, v15, s[60:63], s37 offen
    s_add_u32 s37, s36, 0x302000
    buffer_load_dword v41, v15, s[60:63], s37 offen
    s_add_u32 s37, s36, 0x310000
    buffer_load_dword v42, v15, s[60:63], s37 offen
    s_add_u32 s37, s36, 0x312000
    buffer_load_dword v43, v15, s[60:63], s37 offen
    s_add_u32 s37, s36, 0x304000
    buffer_load_dword v44, v15, s[60:63], s37 offen
    s_add_u32 s37, s36, 0x306000
    buffer_load_dword v45, v15, s[60:63], s37 offen
    s_add_u32 s37, s36, 0x314000
    buffer_load_dword v46, v15, s[60:63], s37 offen
    s_add_u32 s37, s36, 0x316000
    buffer_load_dword v47, v15, s[60:63], s37 offen
    v_perm_b32 v120, v49, v48, s34
    v_accvgpr_write_b32 a144, v120
    v_perm_b32 v121, v51, v50, s34
    v_accvgpr_write_b32 a145, v121
    v_perm_b32 v122, v53, v52, s34
    v_accvgpr_write_b32 a146, v122
    v_perm_b32 v123, v55, v54, s34
    v_accvgpr_write_b32 a147, v123
    v_perm_b32 v124, v57, v56, s34
    v_accvgpr_write_b32 a148, v124
    v_perm_b32 v125, v59, v58, s34
    v_accvgpr_write_b32 a149, v125
    v_perm_b32 v126, v61, v60, s34
    v_accvgpr_write_b32 a150, v126
    v_perm_b32 v127, v63, v62, s34
    v_accvgpr_write_b32 a151, v127
    v_perm_b32 v120, v49, v48, s35
    v_accvgpr_write_b32 a152, v120
    v_perm_b32 v121, v51, v50, s35
    v_accvgpr_write_b32 a153, v121
    v_perm_b32 v122, v53, v52, s35
    v_accvgpr_write_b32 a154, v122
    v_perm_b32 v123, v55, v54, s35
    v_accvgpr_write_b32 a155, v123
    v_perm_b32 v124, v57, v56, s35
    v_accvgpr_write_b32 a156, v124
    v_perm_b32 v125, v59, v58, s35
    v_accvgpr_write_b32 a157, v125
    v_perm_b32 v126, v61, v60, s35
    v_accvgpr_write_b32 a158, v126
    v_perm_b32 v127, v63, v62, s35
    v_accvgpr_write_b32 a159, v127
    s_waitcnt vmcnt(32)
    s_xor_b32 s36, s21, 1
    s_lshl_b32 s36, s36, 18
    s_lshl_b32 s37, s20, 8
    s_add_u32 s36, s36, s37
    s_add_u32 s37, s36, 0x0
    buffer_load_dword v48, v15, s[60:63], s37 offen
    s_add_u32 s37, s36, 0x2000
    buffer_load_dword v49, v15, s[60:63], s37 offen
    s_add_u32 s37, s36, 0x10000
    buffer_load_dword v50, v15, s[60:63], s37 offen
    s_add_u32 s37, s36, 0x12000
    buffer_load_dword v51, v15, s[60:63], s37 offen
    s_add_u32 s37, s36, 0x4000
    buffer_load_dword v52, v15, s[60:63], s37 offen
    s_add_u32 s37, s36, 0x6000
    buffer_load_dword v53, v15, s[60:63], s37 offen
    s_add_u32 s37, s36, 0x14000
    buffer_load_dword v54, v15, s[60:63], s37 offen
    s_add_u32 s37, s36, 0x16000
    buffer_load_dword v55, v15, s[60:63], s37 offen
    s_add_u32 s37, s36, 0x100000
    buffer_load_dword v56, v15, s[60:63], s37 offen
    s_add_u32 s37, s36, 0x102000
    buffer_load_dword v57, v15, s[60:63], s37 offen
    s_add_u32 s37, s36, 0x110000
    buffer_load_dword v58, v15, s[60:63], s37 offen
    s_add_u32 s37, s36, 0x112000
    buffer_load_dword v59, v15, s[60:63], s37 offen
    s_add_u32 s37, s36, 0x104000
    buffer_load_dword v60, v15, s[60:63], s37 offen
    s_add_u32 s37, s36, 0x106000
    buffer_load_dword v61, v15, s[60:63], s37 offen
    s_add_u32 s37, s36, 0x114000
    buffer_load_dword v62, v15, s[60:63], s37 offen
    s_add_u32 s37, s36, 0x116000
    buffer_load_dword v63, v15, s[60:63], s37 offen
    v_perm_b32 v120, v65, v64, s34
    v_perm_b32 v121, v67, v66, s34
    v_perm_b32 v122, v69, v68, s34
    v_perm_b32 v123, v71, v70, s34
    v_perm_b32 v124, v73, v72, s34
    v_perm_b32 v125, v75, v74, s34
    v_perm_b32 v126, v77, v76, s34
    v_perm_b32 v127, v79, v78, s34
    ds_write_b128 v4, v[120:123] offset:20480
    ds_write_b128 v4, v[124:127] offset:21504
    s_waitcnt lgkmcnt(0)
    v_perm_b32 v120, v65, v64, s35
    v_perm_b32 v121, v67, v66, s35
    v_perm_b32 v122, v69, v68, s35
    v_perm_b32 v123, v71, v70, s35
    v_perm_b32 v124, v73, v72, s35
    v_perm_b32 v125, v75, v74, s35
    v_perm_b32 v126, v77, v76, s35
    v_perm_b32 v127, v79, v78, s35
    ds_write_b128 v4, v[120:123] offset:22528
    ds_write_b128 v4, v[124:127] offset:23552
    s_waitcnt lgkmcnt(0)
    s_waitcnt vmcnt(32)
    s_xor_b32 s36, s21, 1
    s_lshl_b32 s36, s36, 18
    s_lshl_b32 s37, s20, 8
    s_add_u32 s36, s36, s37
    s_add_u32 s37, s36, 0x200000
    buffer_load_dword v64, v15, s[60:63], s37 offen
    s_add_u32 s37, s36, 0x202000
    buffer_load_dword v65, v15, s[60:63], s37 offen
    s_add_u32 s37, s36, 0x210000
    buffer_load_dword v66, v15, s[60:63], s37 offen
    s_add_u32 s37, s36, 0x212000
    buffer_load_dword v67, v15, s[60:63], s37 offen
    s_add_u32 s37, s36, 0x204000
    buffer_load_dword v68, v15, s[60:63], s37 offen
    s_add_u32 s37, s36, 0x206000
    buffer_load_dword v69, v15, s[60:63], s37 offen
    s_add_u32 s37, s36, 0x214000
    buffer_load_dword v70, v15, s[60:63], s37 offen
    s_add_u32 s37, s36, 0x216000
    buffer_load_dword v71, v15, s[60:63], s37 offen
    s_add_u32 s37, s36, 0x300000
    buffer_load_dword v72, v15, s[60:63], s37 offen
    s_add_u32 s37, s36, 0x302000
    buffer_load_dword v73, v15, s[60:63], s37 offen
    s_add_u32 s37, s36, 0x310000
    buffer_load_dword v74, v15, s[60:63], s37 offen
    s_add_u32 s37, s36, 0x312000
    buffer_load_dword v75, v15, s[60:63], s37 offen
    s_add_u32 s37, s36, 0x304000
    buffer_load_dword v76, v15, s[60:63], s37 offen
    s_add_u32 s37, s36, 0x306000
    buffer_load_dword v77, v15, s[60:63], s37 offen
    s_add_u32 s37, s36, 0x314000
    buffer_load_dword v78, v15, s[60:63], s37 offen
    s_add_u32 s37, s36, 0x316000
    buffer_load_dword v79, v15, s[60:63], s37 offen
    v_perm_b32 v120, v17, v16, s34
    v_accvgpr_write_b32 a160, v120
    v_perm_b32 v121, v19, v18, s34
    v_accvgpr_write_b32 a161, v121
    v_perm_b32 v122, v21, v20, s34
    v_accvgpr_write_b32 a162, v122
    v_perm_b32 v123, v23, v22, s34
    v_accvgpr_write_b32 a163, v123
    v_perm_b32 v124, v25, v24, s34
    v_accvgpr_write_b32 a164, v124
    v_perm_b32 v125, v27, v26, s34
    v_accvgpr_write_b32 a165, v125
    v_perm_b32 v126, v29, v28, s34
    v_accvgpr_write_b32 a166, v126
    v_perm_b32 v127, v31, v30, s34
    v_accvgpr_write_b32 a167, v127
    v_perm_b32 v120, v17, v16, s35
    v_accvgpr_write_b32 a168, v120
    v_perm_b32 v121, v19, v18, s35
    v_accvgpr_write_b32 a169, v121
    v_perm_b32 v122, v21, v20, s35
    v_accvgpr_write_b32 a170, v122
    v_perm_b32 v123, v23, v22, s35
    v_accvgpr_write_b32 a171, v123
    v_perm_b32 v124, v25, v24, s35
    v_accvgpr_write_b32 a172, v124
    v_perm_b32 v125, v27, v26, s35
    v_accvgpr_write_b32 a173, v125
    v_perm_b32 v126, v29, v28, s35
    v_accvgpr_write_b32 a174, v126
    v_perm_b32 v127, v31, v30, s35
    v_accvgpr_write_b32 a175, v127
    s_waitcnt vmcnt(32)
    s_xor_b32 s36, s21, 2
    s_lshl_b32 s36, s36, 18
    s_lshl_b32 s37, s20, 8
    s_add_u32 s36, s36, s37
    s_add_u32 s37, s36, 0x0
    buffer_load_dword v16, v15, s[60:63], s37 offen
    s_add_u32 s37, s36, 0x2000
    buffer_load_dword v17, v15, s[60:63], s37 offen
    s_add_u32 s37, s36, 0x10000
    buffer_load_dword v18, v15, s[60:63], s37 offen
    s_add_u32 s37, s36, 0x12000
    buffer_load_dword v19, v15, s[60:63], s37 offen
    s_add_u32 s37, s36, 0x4000
    buffer_load_dword v20, v15, s[60:63], s37 offen
    s_add_u32 s37, s36, 0x6000
    buffer_load_dword v21, v15, s[60:63], s37 offen
    s_add_u32 s37, s36, 0x14000
    buffer_load_dword v22, v15, s[60:63], s37 offen
    s_add_u32 s37, s36, 0x16000
    buffer_load_dword v23, v15, s[60:63], s37 offen
    s_add_u32 s37, s36, 0x100000
    buffer_load_dword v24, v15, s[60:63], s37 offen
    s_add_u32 s37, s36, 0x102000
    buffer_load_dword v25, v15, s[60:63], s37 offen
    s_add_u32 s37, s36, 0x110000
    buffer_load_dword v26, v15, s[60:63], s37 offen
    s_add_u32 s37, s36, 0x112000
    buffer_load_dword v27, v15, s[60:63], s37 offen
    s_add_u32 s37, s36, 0x104000
    buffer_load_dword v28, v15, s[60:63], s37 offen
    s_add_u32 s37, s36, 0x106000
    buffer_load_dword v29, v15, s[60:63], s37 offen
    s_add_u32 s37, s36, 0x114000
    buffer_load_dword v30, v15, s[60:63], s37 offen
    s_add_u32 s37, s36, 0x116000
    buffer_load_dword v31, v15, s[60:63], s37 offen
    v_perm_b32 v120, v33, v32, s34
    v_accvgpr_write_b32 a176, v120
    v_perm_b32 v121, v35, v34, s34
    v_accvgpr_write_b32 a177, v121
    v_perm_b32 v122, v37, v36, s34
    v_accvgpr_write_b32 a178, v122
    v_perm_b32 v123, v39, v38, s34
    v_accvgpr_write_b32 a179, v123
    v_perm_b32 v124, v41, v40, s34
    v_accvgpr_write_b32 a180, v124
    v_perm_b32 v125, v43, v42, s34
    v_accvgpr_write_b32 a181, v125
    v_perm_b32 v126, v45, v44, s34
    v_accvgpr_write_b32 a182, v126
    v_perm_b32 v127, v47, v46, s34
    v_accvgpr_write_b32 a183, v127
    v_perm_b32 v120, v33, v32, s35
    v_accvgpr_write_b32 a184, v120
    v_perm_b32 v121, v35, v34, s35
    v_accvgpr_write_b32 a185, v121
    v_perm_b32 v122, v37, v36, s35
    v_accvgpr_write_b32 a186, v122
    v_perm_b32 v123, v39, v38, s35
    v_accvgpr_write_b32 a187, v123
    v_perm_b32 v124, v41, v40, s35
    v_accvgpr_write_b32 a188, v124
    v_perm_b32 v125, v43, v42, s35
    v_accvgpr_write_b32 a189, v125
    v_perm_b32 v126, v45, v44, s35
    v_accvgpr_write_b32 a190, v126
    v_perm_b32 v127, v47, v46, s35
    v_accvgpr_write_b32 a191, v127
    s_waitcnt vmcnt(32)
    s_xor_b32 s36, s21, 2
    s_lshl_b32 s36, s36, 18
    s_lshl_b32 s37, s20, 8
    s_add_u32 s36, s36, s37
    s_add_u32 s37, s36, 0x200000
    buffer_load_dword v32, v15, s[60:63], s37 offen
    s_add_u32 s37, s36, 0x202000
    buffer_load_dword v33, v15, s[60:63], s37 offen
    s_add_u32 s37, s36, 0x210000
    buffer_load_dword v34, v15, s[60:63], s37 offen
    s_add_u32 s37, s36, 0x212000
    buffer_load_dword v35, v15, s[60:63], s37 offen
    s_add_u32 s37, s36, 0x204000
    buffer_load_dword v36, v15, s[60:63], s37 offen
    s_add_u32 s37, s36, 0x206000
    buffer_load_dword v37, v15, s[60:63], s37 offen
    s_add_u32 s37, s36, 0x214000
    buffer_load_dword v38, v15, s[60:63], s37 offen
    s_add_u32 s37, s36, 0x216000
    buffer_load_dword v39, v15, s[60:63], s37 offen
    s_add_u32 s37, s36, 0x300000
    buffer_load_dword v40, v15, s[60:63], s37 offen
    s_add_u32 s37, s36, 0x302000
    buffer_load_dword v41, v15, s[60:63], s37 offen
    s_add_u32 s37, s36, 0x310000
    buffer_load_dword v42, v15, s[60:63], s37 offen
    s_add_u32 s37, s36, 0x312000
    buffer_load_dword v43, v15, s[60:63], s37 offen
    s_add_u32 s37, s36, 0x304000
    buffer_load_dword v44, v15, s[60:63], s37 offen
    s_add_u32 s37, s36, 0x306000
    buffer_load_dword v45, v15, s[60:63], s37 offen
    s_add_u32 s37, s36, 0x314000
    buffer_load_dword v46, v15, s[60:63], s37 offen
    s_add_u32 s37, s36, 0x316000
    buffer_load_dword v47, v15, s[60:63], s37 offen
    v_perm_b32 v120, v49, v48, s34
    v_accvgpr_write_b32 a192, v120
    v_perm_b32 v121, v51, v50, s34
    v_accvgpr_write_b32 a193, v121
    v_perm_b32 v122, v53, v52, s34
    v_accvgpr_write_b32 a194, v122
    v_perm_b32 v123, v55, v54, s34
    v_accvgpr_write_b32 a195, v123
    v_perm_b32 v124, v57, v56, s34
    v_accvgpr_write_b32 a196, v124
    v_perm_b32 v125, v59, v58, s34
    v_accvgpr_write_b32 a197, v125
    v_perm_b32 v126, v61, v60, s34
    v_accvgpr_write_b32 a198, v126
    v_perm_b32 v127, v63, v62, s34
    v_accvgpr_write_b32 a199, v127
    v_perm_b32 v120, v49, v48, s35
    v_accvgpr_write_b32 a200, v120
    v_perm_b32 v121, v51, v50, s35
    v_accvgpr_write_b32 a201, v121
    v_perm_b32 v122, v53, v52, s35
    v_accvgpr_write_b32 a202, v122
    v_perm_b32 v123, v55, v54, s35
    v_accvgpr_write_b32 a203, v123
    v_perm_b32 v124, v57, v56, s35
    v_accvgpr_write_b32 a204, v124
    v_perm_b32 v125, v59, v58, s35
    v_accvgpr_write_b32 a205, v125
    v_perm_b32 v126, v61, v60, s35
    v_accvgpr_write_b32 a206, v126
    v_perm_b32 v127, v63, v62, s35
    v_accvgpr_write_b32 a207, v127
    s_waitcnt vmcnt(32)
    s_xor_b32 s36, s21, 3
    s_lshl_b32 s36, s36, 18
    s_lshl_b32 s37, s20, 8
    s_add_u32 s36, s36, s37
    s_add_u32 s37, s36, 0x0
    buffer_load_dword v48, v15, s[60:63], s37 offen
    s_add_u32 s37, s36, 0x2000
    buffer_load_dword v49, v15, s[60:63], s37 offen
    s_add_u32 s37, s36, 0x10000
    buffer_load_dword v50, v15, s[60:63], s37 offen
    s_add_u32 s37, s36, 0x12000
    buffer_load_dword v51, v15, s[60:63], s37 offen
    s_add_u32 s37, s36, 0x4000
    buffer_load_dword v52, v15, s[60:63], s37 offen
    s_add_u32 s37, s36, 0x6000
    buffer_load_dword v53, v15, s[60:63], s37 offen
    s_add_u32 s37, s36, 0x14000
    buffer_load_dword v54, v15, s[60:63], s37 offen
    s_add_u32 s37, s36, 0x16000
    buffer_load_dword v55, v15, s[60:63], s37 offen
    s_add_u32 s37, s36, 0x100000
    buffer_load_dword v56, v15, s[60:63], s37 offen
    s_add_u32 s37, s36, 0x102000
    buffer_load_dword v57, v15, s[60:63], s37 offen
    s_add_u32 s37, s36, 0x110000
    buffer_load_dword v58, v15, s[60:63], s37 offen
    s_add_u32 s37, s36, 0x112000
    buffer_load_dword v59, v15, s[60:63], s37 offen
    s_add_u32 s37, s36, 0x104000
    buffer_load_dword v60, v15, s[60:63], s37 offen
    s_add_u32 s37, s36, 0x106000
    buffer_load_dword v61, v15, s[60:63], s37 offen
    s_add_u32 s37, s36, 0x114000
    buffer_load_dword v62, v15, s[60:63], s37 offen
    s_add_u32 s37, s36, 0x116000
    buffer_load_dword v63, v15, s[60:63], s37 offen
    v_perm_b32 v120, v65, v64, s34
    v_accvgpr_write_b32 a208, v120
    v_perm_b32 v121, v67, v66, s34
    v_accvgpr_write_b32 a209, v121
    v_perm_b32 v122, v69, v68, s34
    v_accvgpr_write_b32 a210, v122
    v_perm_b32 v123, v71, v70, s34
    v_accvgpr_write_b32 a211, v123
    v_perm_b32 v124, v73, v72, s34
    v_accvgpr_write_b32 a212, v124
    v_perm_b32 v125, v75, v74, s34
    v_accvgpr_write_b32 a213, v125
    v_perm_b32 v126, v77, v76, s34
    v_accvgpr_write_b32 a214, v126
    v_perm_b32 v127, v79, v78, s34
    v_accvgpr_write_b32 a215, v127
    v_perm_b32 v120, v65, v64, s35
    v_accvgpr_write_b32 a216, v120
    v_perm_b32 v121, v67, v66, s35
    v_accvgpr_write_b32 a217, v121
    v_perm_b32 v122, v69, v68, s35
    v_accvgpr_write_b32 a218, v122
    v_perm_b32 v123, v71, v70, s35
    v_accvgpr_write_b32 a219, v123
    v_perm_b32 v124, v73, v72, s35
    v_accvgpr_write_b32 a220, v124
    v_perm_b32 v125, v75, v74, s35
    v_accvgpr_write_b32 a221, v125
    v_perm_b32 v126, v77, v76, s35
    v_accvgpr_write_b32 a222, v126
    v_perm_b32 v127, v79, v78, s35
    v_accvgpr_write_b32 a223, v127
    s_waitcnt vmcnt(32)
    s_xor_b32 s36, s21, 3
    s_lshl_b32 s36, s36, 18
    s_lshl_b32 s37, s20, 8
    s_add_u32 s36, s36, s37
    s_add_u32 s37, s36, 0x200000
    buffer_load_dword v64, v15, s[60:63], s37 offen
    s_add_u32 s37, s36, 0x202000
    buffer_load_dword v65, v15, s[60:63], s37 offen
    s_add_u32 s37, s36, 0x210000
    buffer_load_dword v66, v15, s[60:63], s37 offen
    s_add_u32 s37, s36, 0x212000
    buffer_load_dword v67, v15, s[60:63], s37 offen
    s_add_u32 s37, s36, 0x204000
    buffer_load_dword v68, v15, s[60:63], s37 offen
    s_add_u32 s37, s36, 0x206000
    buffer_load_dword v69, v15, s[60:63], s37 offen
    s_add_u32 s37, s36, 0x214000
    buffer_load_dword v70, v15, s[60:63], s37 offen
    s_add_u32 s37, s36, 0x216000
    buffer_load_dword v71, v15, s[60:63], s37 offen
    s_add_u32 s37, s36, 0x300000
    buffer_load_dword v72, v15, s[60:63], s37 offen
    s_add_u32 s37, s36, 0x302000
    buffer_load_dword v73, v15, s[60:63], s37 offen
    s_add_u32 s37, s36, 0x310000
    buffer_load_dword v74, v15, s[60:63], s37 offen
    s_add_u32 s37, s36, 0x312000
    buffer_load_dword v75, v15, s[60:63], s37 offen
    s_add_u32 s37, s36, 0x304000
    buffer_load_dword v76, v15, s[60:63], s37 offen
    s_add_u32 s37, s36, 0x306000
    buffer_load_dword v77, v15, s[60:63], s37 offen
    s_add_u32 s37, s36, 0x314000
    buffer_load_dword v78, v15, s[60:63], s37 offen
    s_add_u32 s37, s36, 0x316000
    buffer_load_dword v79, v15, s[60:63], s37 offen
    v_perm_b32 v120, v17, v16, s34
    v_accvgpr_write_b32 a224, v120
    v_perm_b32 v121, v19, v18, s34
    v_accvgpr_write_b32 a225, v121
    v_perm_b32 v122, v21, v20, s34
    v_accvgpr_write_b32 a226, v122
    v_perm_b32 v123, v23, v22, s34
    v_accvgpr_write_b32 a227, v123
    v_perm_b32 v124, v25, v24, s34
    v_accvgpr_write_b32 a228, v124
    v_perm_b32 v125, v27, v26, s34
    v_accvgpr_write_b32 a229, v125
    v_perm_b32 v126, v29, v28, s34
    v_accvgpr_write_b32 a230, v126
    v_perm_b32 v127, v31, v30, s34
    v_accvgpr_write_b32 a231, v127
    v_perm_b32 v120, v17, v16, s35
    v_accvgpr_write_b32 a232, v120
    v_perm_b32 v121, v19, v18, s35
    v_accvgpr_write_b32 a233, v121
    v_perm_b32 v122, v21, v20, s35
    v_accvgpr_write_b32 a234, v122
    v_perm_b32 v123, v23, v22, s35
    v_accvgpr_write_b32 a235, v123
    v_perm_b32 v124, v25, v24, s35
    v_accvgpr_write_b32 a236, v124
    v_perm_b32 v125, v27, v26, s35
    v_accvgpr_write_b32 a237, v125
    v_perm_b32 v126, v29, v28, s35
    v_accvgpr_write_b32 a238, v126
    v_perm_b32 v127, v31, v30, s35
    v_accvgpr_write_b32 a239, v127
    s_waitcnt vmcnt(32)
    s_lshl_b32 s36, s20, 17
    s_add_u32 s37, s36, 0x0
    buffer_load_dword v16, v11, s[92:95], s37 offen
    s_add_u32 s37, s36, 0x400
    buffer_load_dword v17, v11, s[92:95], s37 offen
    s_add_u32 s37, s36, 0x2000
    buffer_load_dword v18, v11, s[92:95], s37 offen
    s_add_u32 s37, s36, 0x2400
    buffer_load_dword v19, v11, s[92:95], s37 offen
    s_add_u32 s37, s36, 0x800
    buffer_load_dword v20, v11, s[92:95], s37 offen
    s_add_u32 s37, s36, 0xc00
    buffer_load_dword v21, v11, s[92:95], s37 offen
    s_add_u32 s37, s36, 0x2800
    buffer_load_dword v22, v11, s[92:95], s37 offen
    s_add_u32 s37, s36, 0x2c00
    buffer_load_dword v23, v11, s[92:95], s37 offen
    s_add_u32 s37, s36, 0x8000
    buffer_load_dword v24, v11, s[92:95], s37 offen
    s_add_u32 s37, s36, 0x8400
    buffer_load_dword v25, v11, s[92:95], s37 offen
    s_add_u32 s37, s36, 0xa000
    buffer_load_dword v26, v11, s[92:95], s37 offen
    s_add_u32 s37, s36, 0xa400
    buffer_load_dword v27, v11, s[92:95], s37 offen
    s_add_u32 s37, s36, 0x8800
    buffer_load_dword v28, v11, s[92:95], s37 offen
    s_add_u32 s37, s36, 0x8c00
    buffer_load_dword v29, v11, s[92:95], s37 offen
    s_add_u32 s37, s36, 0xa800
    buffer_load_dword v30, v11, s[92:95], s37 offen
    s_add_u32 s37, s36, 0xac00
    buffer_load_dword v31, v11, s[92:95], s37 offen
    v_perm_b32 v120, v33, v32, s34
    v_accvgpr_write_b32 a240, v120
    v_perm_b32 v121, v35, v34, s34
    v_accvgpr_write_b32 a241, v121
    v_perm_b32 v122, v37, v36, s34
    v_accvgpr_write_b32 a242, v122
    v_perm_b32 v123, v39, v38, s34
    v_accvgpr_write_b32 a243, v123
    v_perm_b32 v124, v41, v40, s34
    v_accvgpr_write_b32 a244, v124
    v_perm_b32 v125, v43, v42, s34
    v_accvgpr_write_b32 a245, v125
    v_perm_b32 v126, v45, v44, s34
    v_accvgpr_write_b32 a246, v126
    v_perm_b32 v127, v47, v46, s34
    v_accvgpr_write_b32 a247, v127
    v_perm_b32 v120, v33, v32, s35
    v_accvgpr_write_b32 a248, v120
    v_perm_b32 v121, v35, v34, s35
    v_accvgpr_write_b32 a249, v121
    v_perm_b32 v122, v37, v36, s35
    v_accvgpr_write_b32 a250, v122
    v_perm_b32 v123, v39, v38, s35
    v_accvgpr_write_b32 a251, v123
    v_perm_b32 v124, v41, v40, s35
    v_accvgpr_write_b32 a252, v124
    v_perm_b32 v125, v43, v42, s35
    v_accvgpr_write_b32 a253, v125
    v_perm_b32 v126, v45, v44, s35
    v_accvgpr_write_b32 a254, v126
    v_perm_b32 v127, v47, v46, s35
    v_accvgpr_write_b32 a255, v127
    s_waitcnt vmcnt(32)
    s_lshl_b32 s36, s20, 17
    s_add_u32 s37, s36, 0x10000
    buffer_load_dword v32, v11, s[92:95], s37 offen
    s_add_u32 s37, s36, 0x10400
    buffer_load_dword v33, v11, s[92:95], s37 offen
    s_add_u32 s37, s36, 0x12000
    buffer_load_dword v34, v11, s[92:95], s37 offen
    s_add_u32 s37, s36, 0x12400
    buffer_load_dword v35, v11, s[92:95], s37 offen
    s_add_u32 s37, s36, 0x10800
    buffer_load_dword v36, v11, s[92:95], s37 offen
    s_add_u32 s37, s36, 0x10c00
    buffer_load_dword v37, v11, s[92:95], s37 offen
    s_add_u32 s37, s36, 0x12800
    buffer_load_dword v38, v11, s[92:95], s37 offen
    s_add_u32 s37, s36, 0x12c00
    buffer_load_dword v39, v11, s[92:95], s37 offen
    s_add_u32 s37, s36, 0x18000
    buffer_load_dword v40, v11, s[92:95], s37 offen
    s_add_u32 s37, s36, 0x18400
    buffer_load_dword v41, v11, s[92:95], s37 offen
    s_add_u32 s37, s36, 0x1a000
    buffer_load_dword v42, v11, s[92:95], s37 offen
    s_add_u32 s37, s36, 0x1a400
    buffer_load_dword v43, v11, s[92:95], s37 offen
    s_add_u32 s37, s36, 0x18800
    buffer_load_dword v44, v11, s[92:95], s37 offen
    s_add_u32 s37, s36, 0x18c00
    buffer_load_dword v45, v11, s[92:95], s37 offen
    s_add_u32 s37, s36, 0x1a800
    buffer_load_dword v46, v11, s[92:95], s37 offen
    s_add_u32 s37, s36, 0x1ac00
    buffer_load_dword v47, v11, s[92:95], s37 offen
    v_perm_b32 v128, v49, v48, s34
    v_perm_b32 v129, v51, v50, s34
    v_perm_b32 v130, v53, v52, s34
    v_perm_b32 v131, v55, v54, s34
    v_perm_b32 v132, v57, v56, s34
    v_perm_b32 v133, v59, v58, s34
    v_perm_b32 v134, v61, v60, s34
    v_perm_b32 v135, v63, v62, s34
    v_perm_b32 v136, v49, v48, s35
    v_perm_b32 v137, v51, v50, s35
    v_perm_b32 v138, v53, v52, s35
    v_perm_b32 v139, v55, v54, s35
    v_perm_b32 v140, v57, v56, s35
    v_perm_b32 v141, v59, v58, s35
    v_perm_b32 v142, v61, v60, s35
    v_perm_b32 v143, v63, v62, s35
    s_waitcnt vmcnt(32)
    s_lshl_b32 s36, s20, 17
    s_add_u32 s37, s36, 0x40
    buffer_load_dword v48, v11, s[92:95], s37 offen
    s_add_u32 s37, s36, 0x440
    buffer_load_dword v49, v11, s[92:95], s37 offen
    s_add_u32 s37, s36, 0x2040
    buffer_load_dword v50, v11, s[92:95], s37 offen
    s_add_u32 s37, s36, 0x2440
    buffer_load_dword v51, v11, s[92:95], s37 offen
    s_add_u32 s37, s36, 0x840
    buffer_load_dword v52, v11, s[92:95], s37 offen
    s_add_u32 s37, s36, 0xc40
    buffer_load_dword v53, v11, s[92:95], s37 offen
    s_add_u32 s37, s36, 0x2840
    buffer_load_dword v54, v11, s[92:95], s37 offen
    s_add_u32 s37, s36, 0x2c40
    buffer_load_dword v55, v11, s[92:95], s37 offen
    s_add_u32 s37, s36, 0x8040
    buffer_load_dword v56, v11, s[92:95], s37 offen
    s_add_u32 s37, s36, 0x8440
    buffer_load_dword v57, v11, s[92:95], s37 offen
    s_add_u32 s37, s36, 0xa040
    buffer_load_dword v58, v11, s[92:95], s37 offen
    s_add_u32 s37, s36, 0xa440
    buffer_load_dword v59, v11, s[92:95], s37 offen
    s_add_u32 s37, s36, 0x8840
    buffer_load_dword v60, v11, s[92:95], s37 offen
    s_add_u32 s37, s36, 0x8c40
    buffer_load_dword v61, v11, s[92:95], s37 offen
    s_add_u32 s37, s36, 0xa840
    buffer_load_dword v62, v11, s[92:95], s37 offen
    s_add_u32 s37, s36, 0xac40
    buffer_load_dword v63, v11, s[92:95], s37 offen
    v_perm_b32 v144, v65, v64, s34
    v_perm_b32 v145, v67, v66, s34
    v_perm_b32 v146, v69, v68, s34
    v_perm_b32 v147, v71, v70, s34
    v_perm_b32 v148, v73, v72, s34
    v_perm_b32 v149, v75, v74, s34
    v_perm_b32 v150, v77, v76, s34
    v_perm_b32 v151, v79, v78, s34
    v_perm_b32 v152, v65, v64, s35
    v_perm_b32 v153, v67, v66, s35
    v_perm_b32 v154, v69, v68, s35
    v_perm_b32 v155, v71, v70, s35
    v_perm_b32 v156, v73, v72, s35
    v_perm_b32 v157, v75, v74, s35
    v_perm_b32 v158, v77, v76, s35
    v_perm_b32 v159, v79, v78, s35
    s_waitcnt vmcnt(32)
    s_lshl_b32 s36, s20, 17
    s_add_u32 s37, s36, 0x10040
    buffer_load_dword v64, v11, s[92:95], s37 offen
    s_add_u32 s37, s36, 0x10440
    buffer_load_dword v65, v11, s[92:95], s37 offen
    s_add_u32 s37, s36, 0x12040
    buffer_load_dword v66, v11, s[92:95], s37 offen
    s_add_u32 s37, s36, 0x12440
    buffer_load_dword v67, v11, s[92:95], s37 offen
    s_add_u32 s37, s36, 0x10840
    buffer_load_dword v68, v11, s[92:95], s37 offen
    s_add_u32 s37, s36, 0x10c40
    buffer_load_dword v69, v11, s[92:95], s37 offen
    s_add_u32 s37, s36, 0x12840
    buffer_load_dword v70, v11, s[92:95], s37 offen
    s_add_u32 s37, s36, 0x12c40
    buffer_load_dword v71, v11, s[92:95], s37 offen
    s_add_u32 s37, s36, 0x18040
    buffer_load_dword v72, v11, s[92:95], s37 offen
    s_add_u32 s37, s36, 0x18440
    buffer_load_dword v73, v11, s[92:95], s37 offen
    s_add_u32 s37, s36, 0x1a040
    buffer_load_dword v74, v11, s[92:95], s37 offen
    s_add_u32 s37, s36, 0x1a440
    buffer_load_dword v75, v11, s[92:95], s37 offen
    s_add_u32 s37, s36, 0x18840
    buffer_load_dword v76, v11, s[92:95], s37 offen
    s_add_u32 s37, s36, 0x18c40
    buffer_load_dword v77, v11, s[92:95], s37 offen
    s_add_u32 s37, s36, 0x1a840
    buffer_load_dword v78, v11, s[92:95], s37 offen
    s_add_u32 s37, s36, 0x1ac40
    buffer_load_dword v79, v11, s[92:95], s37 offen
    v_perm_b32 v120, v17, v16, s34
    v_perm_b32 v121, v19, v18, s34
    v_perm_b32 v122, v21, v20, s34
    v_perm_b32 v123, v23, v22, s34
    v_perm_b32 v124, v25, v24, s34
    v_perm_b32 v125, v27, v26, s34
    v_perm_b32 v126, v29, v28, s34
    v_perm_b32 v127, v31, v30, s34
    ds_write_b128 v4, v[120:123] offset:24576
    ds_write_b128 v4, v[124:127] offset:25600
    s_waitcnt lgkmcnt(0)
    v_perm_b32 v120, v17, v16, s35
    v_perm_b32 v121, v19, v18, s35
    v_perm_b32 v122, v21, v20, s35
    v_perm_b32 v123, v23, v22, s35
    v_perm_b32 v124, v25, v24, s35
    v_perm_b32 v125, v27, v26, s35
    v_perm_b32 v126, v29, v28, s35
    v_perm_b32 v127, v31, v30, s35
    ds_write_b128 v4, v[120:123] offset:26624
    ds_write_b128 v4, v[124:127] offset:27648
    s_waitcnt lgkmcnt(0)
    s_waitcnt vmcnt(32)
    s_lshl_b32 s36, s20, 17
    s_add_u32 s37, s36, 0x80
    buffer_load_dword v16, v11, s[92:95], s37 offen
    s_add_u32 s37, s36, 0x480
    buffer_load_dword v17, v11, s[92:95], s37 offen
    s_add_u32 s37, s36, 0x2080
    buffer_load_dword v18, v11, s[92:95], s37 offen
    s_add_u32 s37, s36, 0x2480
    buffer_load_dword v19, v11, s[92:95], s37 offen
    s_add_u32 s37, s36, 0x880
    buffer_load_dword v20, v11, s[92:95], s37 offen
    s_add_u32 s37, s36, 0xc80
    buffer_load_dword v21, v11, s[92:95], s37 offen
    s_add_u32 s37, s36, 0x2880
    buffer_load_dword v22, v11, s[92:95], s37 offen
    s_add_u32 s37, s36, 0x2c80
    buffer_load_dword v23, v11, s[92:95], s37 offen
    s_add_u32 s37, s36, 0x8080
    buffer_load_dword v24, v11, s[92:95], s37 offen
    s_add_u32 s37, s36, 0x8480
    buffer_load_dword v25, v11, s[92:95], s37 offen
    s_add_u32 s37, s36, 0xa080
    buffer_load_dword v26, v11, s[92:95], s37 offen
    s_add_u32 s37, s36, 0xa480
    buffer_load_dword v27, v11, s[92:95], s37 offen
    s_add_u32 s37, s36, 0x8880
    buffer_load_dword v28, v11, s[92:95], s37 offen
    s_add_u32 s37, s36, 0x8c80
    buffer_load_dword v29, v11, s[92:95], s37 offen
    s_add_u32 s37, s36, 0xa880
    buffer_load_dword v30, v11, s[92:95], s37 offen
    s_add_u32 s37, s36, 0xac80
    buffer_load_dword v31, v11, s[92:95], s37 offen
    v_perm_b32 v120, v33, v32, s34
    v_perm_b32 v121, v35, v34, s34
    v_perm_b32 v122, v37, v36, s34
    v_perm_b32 v123, v39, v38, s34
    v_perm_b32 v124, v41, v40, s34
    v_perm_b32 v125, v43, v42, s34
    v_perm_b32 v126, v45, v44, s34
    v_perm_b32 v127, v47, v46, s34
    ds_write_b128 v4, v[120:123] offset:28672
    ds_write_b128 v4, v[124:127] offset:29696
    s_waitcnt lgkmcnt(0)
    v_perm_b32 v120, v33, v32, s35
    v_perm_b32 v121, v35, v34, s35
    v_perm_b32 v122, v37, v36, s35
    v_perm_b32 v123, v39, v38, s35
    v_perm_b32 v124, v41, v40, s35
    v_perm_b32 v125, v43, v42, s35
    v_perm_b32 v126, v45, v44, s35
    v_perm_b32 v127, v47, v46, s35
    ds_write_b128 v4, v[120:123] offset:30720
    ds_write_b128 v4, v[124:127] offset:31744
    s_waitcnt lgkmcnt(0)
    s_waitcnt vmcnt(32)
    s_lshl_b32 s36, s20, 17
    s_add_u32 s37, s36, 0x10080
    buffer_load_dword v32, v11, s[92:95], s37 offen
    s_add_u32 s37, s36, 0x10480
    buffer_load_dword v33, v11, s[92:95], s37 offen
    s_add_u32 s37, s36, 0x12080
    buffer_load_dword v34, v11, s[92:95], s37 offen
    s_add_u32 s37, s36, 0x12480
    buffer_load_dword v35, v11, s[92:95], s37 offen
    s_add_u32 s37, s36, 0x10880
    buffer_load_dword v36, v11, s[92:95], s37 offen
    s_add_u32 s37, s36, 0x10c80
    buffer_load_dword v37, v11, s[92:95], s37 offen
    s_add_u32 s37, s36, 0x12880
    buffer_load_dword v38, v11, s[92:95], s37 offen
    s_add_u32 s37, s36, 0x12c80
    buffer_load_dword v39, v11, s[92:95], s37 offen
    s_add_u32 s37, s36, 0x18080
    buffer_load_dword v40, v11, s[92:95], s37 offen
    s_add_u32 s37, s36, 0x18480
    buffer_load_dword v41, v11, s[92:95], s37 offen
    s_add_u32 s37, s36, 0x1a080
    buffer_load_dword v42, v11, s[92:95], s37 offen
    s_add_u32 s37, s36, 0x1a480
    buffer_load_dword v43, v11, s[92:95], s37 offen
    s_add_u32 s37, s36, 0x18880
    buffer_load_dword v44, v11, s[92:95], s37 offen
    s_add_u32 s37, s36, 0x18c80
    buffer_load_dword v45, v11, s[92:95], s37 offen
    s_add_u32 s37, s36, 0x1a880
    buffer_load_dword v46, v11, s[92:95], s37 offen
    s_add_u32 s37, s36, 0x1ac80
    buffer_load_dword v47, v11, s[92:95], s37 offen
    v_perm_b32 v160, v49, v48, s34
    v_perm_b32 v161, v51, v50, s34
    v_perm_b32 v162, v53, v52, s34
    v_perm_b32 v163, v55, v54, s34
    v_perm_b32 v164, v57, v56, s34
    v_perm_b32 v165, v59, v58, s34
    v_perm_b32 v166, v61, v60, s34
    v_perm_b32 v167, v63, v62, s34
    v_perm_b32 v168, v49, v48, s35
    v_perm_b32 v169, v51, v50, s35
    v_perm_b32 v170, v53, v52, s35
    v_perm_b32 v171, v55, v54, s35
    v_perm_b32 v172, v57, v56, s35
    v_perm_b32 v173, v59, v58, s35
    v_perm_b32 v174, v61, v60, s35
    v_perm_b32 v175, v63, v62, s35
    s_waitcnt vmcnt(32)
    s_lshl_b32 s36, s20, 17
    s_add_u32 s37, s36, 0xc0
    buffer_load_dword v48, v11, s[92:95], s37 offen
    s_add_u32 s37, s36, 0x4c0
    buffer_load_dword v49, v11, s[92:95], s37 offen
    s_add_u32 s37, s36, 0x20c0
    buffer_load_dword v50, v11, s[92:95], s37 offen
    s_add_u32 s37, s36, 0x24c0
    buffer_load_dword v51, v11, s[92:95], s37 offen
    s_add_u32 s37, s36, 0x8c0
    buffer_load_dword v52, v11, s[92:95], s37 offen
    s_add_u32 s37, s36, 0xcc0
    buffer_load_dword v53, v11, s[92:95], s37 offen
    s_add_u32 s37, s36, 0x28c0
    buffer_load_dword v54, v11, s[92:95], s37 offen
    s_add_u32 s37, s36, 0x2cc0
    buffer_load_dword v55, v11, s[92:95], s37 offen
    s_add_u32 s37, s36, 0x80c0
    buffer_load_dword v56, v11, s[92:95], s37 offen
    s_add_u32 s37, s36, 0x84c0
    buffer_load_dword v57, v11, s[92:95], s37 offen
    s_add_u32 s37, s36, 0xa0c0
    buffer_load_dword v58, v11, s[92:95], s37 offen
    s_add_u32 s37, s36, 0xa4c0
    buffer_load_dword v59, v11, s[92:95], s37 offen
    s_add_u32 s37, s36, 0x88c0
    buffer_load_dword v60, v11, s[92:95], s37 offen
    s_add_u32 s37, s36, 0x8cc0
    buffer_load_dword v61, v11, s[92:95], s37 offen
    s_add_u32 s37, s36, 0xa8c0
    buffer_load_dword v62, v11, s[92:95], s37 offen
    s_add_u32 s37, s36, 0xacc0
    buffer_load_dword v63, v11, s[92:95], s37 offen
    v_perm_b32 v208, v65, v64, s34
    v_perm_b32 v209, v67, v66, s34
    v_perm_b32 v210, v69, v68, s34
    v_perm_b32 v211, v71, v70, s34
    v_perm_b32 v212, v73, v72, s34
    v_perm_b32 v213, v75, v74, s34
    v_perm_b32 v214, v77, v76, s34
    v_perm_b32 v215, v79, v78, s34
    v_perm_b32 v216, v65, v64, s35
    v_perm_b32 v217, v67, v66, s35
    v_perm_b32 v218, v69, v68, s35
    v_perm_b32 v219, v71, v70, s35
    v_perm_b32 v220, v73, v72, s35
    v_perm_b32 v221, v75, v74, s35
    v_perm_b32 v222, v77, v76, s35
    v_perm_b32 v223, v79, v78, s35
    s_waitcnt vmcnt(32)
    s_lshl_b32 s36, s20, 17
    s_add_u32 s37, s36, 0x100c0
    buffer_load_dword v64, v11, s[92:95], s37 offen
    s_add_u32 s37, s36, 0x104c0
    buffer_load_dword v65, v11, s[92:95], s37 offen
    s_add_u32 s37, s36, 0x120c0
    buffer_load_dword v66, v11, s[92:95], s37 offen
    s_add_u32 s37, s36, 0x124c0
    buffer_load_dword v67, v11, s[92:95], s37 offen
    s_add_u32 s37, s36, 0x108c0
    buffer_load_dword v68, v11, s[92:95], s37 offen
    s_add_u32 s37, s36, 0x10cc0
    buffer_load_dword v69, v11, s[92:95], s37 offen
    s_add_u32 s37, s36, 0x128c0
    buffer_load_dword v70, v11, s[92:95], s37 offen
    s_add_u32 s37, s36, 0x12cc0
    buffer_load_dword v71, v11, s[92:95], s37 offen
    s_add_u32 s37, s36, 0x180c0
    buffer_load_dword v72, v11, s[92:95], s37 offen
    s_add_u32 s37, s36, 0x184c0
    buffer_load_dword v73, v11, s[92:95], s37 offen
    s_add_u32 s37, s36, 0x1a0c0
    buffer_load_dword v74, v11, s[92:95], s37 offen
    s_add_u32 s37, s36, 0x1a4c0
    buffer_load_dword v75, v11, s[92:95], s37 offen
    s_add_u32 s37, s36, 0x188c0
    buffer_load_dword v76, v11, s[92:95], s37 offen
    s_add_u32 s37, s36, 0x18cc0
    buffer_load_dword v77, v11, s[92:95], s37 offen
    s_add_u32 s37, s36, 0x1a8c0
    buffer_load_dword v78, v11, s[92:95], s37 offen
    s_add_u32 s37, s36, 0x1acc0
    buffer_load_dword v79, v11, s[92:95], s37 offen
    v_perm_b32 v176, v17, v16, s34
    v_perm_b32 v177, v19, v18, s34
    v_perm_b32 v178, v21, v20, s34
    v_perm_b32 v179, v23, v22, s34
    v_perm_b32 v180, v25, v24, s34
    v_perm_b32 v181, v27, v26, s34
    v_perm_b32 v182, v29, v28, s34
    v_perm_b32 v183, v31, v30, s34
    v_perm_b32 v184, v17, v16, s35
    v_perm_b32 v185, v19, v18, s35
    v_perm_b32 v186, v21, v20, s35
    v_perm_b32 v187, v23, v22, s35
    v_perm_b32 v188, v25, v24, s35
    v_perm_b32 v189, v27, v26, s35
    v_perm_b32 v190, v29, v28, s35
    v_perm_b32 v191, v31, v30, s35
    s_waitcnt vmcnt(32)
    v_perm_b32 v224, v33, v32, s34
    v_perm_b32 v225, v35, v34, s34
    v_perm_b32 v226, v37, v36, s34
    v_perm_b32 v227, v39, v38, s34
    v_perm_b32 v228, v41, v40, s34
    v_perm_b32 v229, v43, v42, s34
    v_perm_b32 v230, v45, v44, s34
    v_perm_b32 v231, v47, v46, s34
    v_perm_b32 v232, v33, v32, s35
    v_perm_b32 v233, v35, v34, s35
    v_perm_b32 v234, v37, v36, s35
    v_perm_b32 v235, v39, v38, s35
    v_perm_b32 v236, v41, v40, s35
    v_perm_b32 v237, v43, v42, s35
    v_perm_b32 v238, v45, v44, s35
    v_perm_b32 v239, v47, v46, s35
    s_waitcnt vmcnt(16)
    v_perm_b32 v192, v49, v48, s34
    v_perm_b32 v193, v51, v50, s34
    v_perm_b32 v194, v53, v52, s34
    v_perm_b32 v195, v55, v54, s34
    v_perm_b32 v196, v57, v56, s34
    v_perm_b32 v197, v59, v58, s34
    v_perm_b32 v198, v61, v60, s34
    v_perm_b32 v199, v63, v62, s34
    v_perm_b32 v200, v49, v48, s35
    v_perm_b32 v201, v51, v50, s35
    v_perm_b32 v202, v53, v52, s35
    v_perm_b32 v203, v55, v54, s35
    v_perm_b32 v204, v57, v56, s35
    v_perm_b32 v205, v59, v58, s35
    v_perm_b32 v206, v61, v60, s35
    v_perm_b32 v207, v63, v62, s35
    s_waitcnt vmcnt(0)
    v_perm_b32 v240, v65, v64, s34
    v_perm_b32 v241, v67, v66, s34
    v_perm_b32 v242, v69, v68, s34
    v_perm_b32 v243, v71, v70, s34
    v_perm_b32 v244, v73, v72, s34
    v_perm_b32 v245, v75, v74, s34
    v_perm_b32 v246, v77, v76, s34
    v_perm_b32 v247, v79, v78, s34
    v_perm_b32 v248, v65, v64, s35
    v_perm_b32 v249, v67, v66, s35
    v_perm_b32 v250, v69, v68, s35
    v_perm_b32 v251, v71, v70, s35
    v_perm_b32 v252, v73, v72, s35
    v_perm_b32 v253, v75, v74, s35
    v_perm_b32 v254, v77, v76, s35
    v_perm_b32 v255, v79, v78, s35
    v_mov_b32 v24, 0x0
    v_bfe_u32 v14, v0, 0, 1
    s_mov_b32 s38, 0x80
    v_mad_u32_u24 v24, v14, s38, v24
    v_bfe_u32 v14, v0, 1, 1
    s_mov_b32 s38, 0x100
    v_mad_u32_u24 v24, v14, s38, v24
    v_bfe_u32 v14, v0, 2, 1
    s_mov_b32 s38, 0x200
    v_mad_u32_u24 v24, v14, s38, v24
    v_bfe_u32 v14, v0, 3, 1
    s_mov_b32 s38, 0x400
    v_mad_u32_u24 v24, v14, s38, v24
    v_bfe_u32 v14, v0, 4, 1
    s_mov_b32 s38, 0x800
    v_mad_u32_u24 v24, v14, s38, v24
    v_bfe_u32 v14, v0, 6, 1
    s_mov_b32 s38, 0x1000
    v_mad_u32_u24 v24, v14, s38, v24
    v_bfe_u32 v14, v0, 7, 1
    s_mov_b32 s38, 0x2000
    v_mad_u32_u24 v24, v14, s38, v24
    s_lshl_b32 s36, s20, 14
    v_add_u32 v24, s36, v24
    s_lshl_b32 s36, s20, 8
    s_lshr_b32 s37, s21, 1
    s_lshl_b32 s37, s37, 7
    s_add_u32 s36, s36, s37
    s_add_u32 s36, s36, 0x102000
    v_and_b32 v14, 63, v0
    v_mov_b32 v25, 0x40000000
    v_cmp_lt_u32 vcc, 32, v14
    s_nop 1
    v_cndmask_b32 v24, v24, v25, vcc
    v_mov_b32 v25, s36
    v_cmp_eq_u32 vcc, 32, v14
    s_nop 1
    v_cndmask_b32 v0, v24, v25, vcc
    v_lshrrev_b32 v25, 2, v3
    v_and_b32 v25, 127, v25
L_HS:
    buffer_load_dword v24, v25, s[16:19], 0 offen sc1
    s_add_u32 s32, s32, 1
    s_cmp_gt_u32 s32, 200000
    s_cbranch_scc1 L_slow_start
    s_waitcnt vmcnt(0)
    v_cmp_eq_u32 vcc, 0, v24
    s_cbranch_vccnz L_HS
    v_readfirstlane_b32 s36, v24
    s_nop 1
    v_cmp_ne_u32 vcc, s36, v24
    s_cbranch_vccnz L_slow_start
    s_branch L_fast_start
L_fast_start:
    s_mov_b32 s22, 0
    s_mov_b32 s23, 0x1000000
    s_mov_b32 s27, 0
    s_mov_b32 s31, 0x80000
    ds_read_b128 v[104:107], v4 offset:0
    ds_read_b128 v[108:111], v4 offset:1024
    ds_read_b128 v[112:115], v4 offset:2048
    ds_read_b128 v[116:119], v4 offset:3072
    ds_read_b128 v[88:91], v4 offset:4096
    ds_read_b128 v[92:95], v4 offset:5120
    ds_read_b128 v[96:99], v4 offset:6144
    ds_read_b128 v[100:103], v4 offset:7168
    ds_read_b128 v[72:75], v4 offset:8192
    ds_read_b128 v[76:79], v4 offset:9216
    ds_read_b128 v[80:83], v4 offset:10240
    ds_read_b128 v[84:87], v4 offset:11264
    v_mov_b64 v[48:49], 0
    v_mov_b64 v[50:51], 0
    v_mov_b64 v[52:53], 0
    v_mov_b64 v[54:55], 0
    v_mov_b64 v[56:57], 0
    v_mov_b64 v[58:59], 0
    v_mov_b64 v[60:61], 0
    v_mov_b64 v[62:63], 0
    v_mov_b64 v[64:65], 0
    v_mov_b64 v[66:67], 0
    v_mov_b64 v[68:69], 0
    v_mov_b64 v[70:71], 0
    s_waitcnt lgkmcnt(0)
    s_mov_b64 s[62:63], 0
L_fast_step:
    s_bitcmp1_b64 s[62:63], s22
    s_cbranch_scc0 L_fast_refresh
    s_add_u32 s36, s22, 1
    s_bitcmp1_b64 s[62:63], s36
    s_cbranch_scc0 L_fast_refresh
    s_add_u32 s7, s23, 0x80000
    s_add_u32 s24, s23, 0x82000
    s_add_u32 s29, s23, s25
    s_add_u32 s30, s23, s39
    v_xor_b32 v28, 0x800, v2
    v_xor_b32 v36, 0x1000, v2
    v_xor_b32 v44, 0x1800, v2
L_fast_pollm:
    buffer_load_dwordx4 v[16:19], v2, s[8:11], s7 offen sc1
    buffer_load_dwordx4 v[20:23], v2, s[8:11], s7 offen offset:1024 sc1
    s_add_u32 s32, s32, 1
    s_cmp_gt_u32 s32, 200000
    s_waitcnt vmcnt(1)
    v_max3_u32 v14, v16, v17, v18
    s_waitcnt vmcnt(0)
    v_max3_u32 v24, v19, v20, v21
    v_max3_u32 v14, v14, v22, v23
    v_max_u32 v14, v14, v24
    s_cbranch_scc1 L_fast_gotm
    v_cmp_eq_u32 vcc, -1, v14
    s_cbranch_vccnz L_fast_pollm
L_fast_gotm:
    v_smfmac_f32_16x16x64_bf16 v[48:51], v[16:19], v[104:111], v1
    ds_write_b128 v2, v[16:19] offset:0
    v_smfmac_f32_16x16x64_bf16 v[52:55], v[16:19], v[112:119], v1
    ds_write_b128 v2, v[20:23] offset:1024
    v_smfmac_f32_16x16x64_bf16 v[48:51], v[20:23], v[88:95], v1
    buffer_load_dwordx4 v[104:107], v3, s[8:11], s29 offen offset:0 sc1
    v_smfmac_f32_16x16x64_bf16 v[52:55], v[20:23], v[96:103], v1
    v_smfmac_f32_16x16x64_bf16 v[56:59], v[16:19], v[72:79], v1
    buffer_load_dwordx4 v[108:111], v3, s[8:11], s29 offen offset:1024 sc1
    v_smfmac_f32_16x16x64_bf16 v[60:63], v[16:19], v[80:87], v1
    s_waitcnt lgkmcnt(0)
    s_barrier
    ds_read_b128 v[24:27], v28 offset:0
    v_smfmac_f32_16x16x64_bf16 v[56:59], v[20:23], a[80:87], v1
    ds_read_b128 v[28:31], v28 offset:1024
    v_smfmac_f32_16x16x64_bf16 v[60:63], v[20:23], a[88:95], v1
    ds_read_b128 v[32:35], v36 offset:0
    v_smfmac_f32_16x16x64_bf16 v[64:67], v[16:19], a[160:167], v1
    ds_read_b128 v[36:39], v36 offset:1024
    v_smfmac_f32_16x16x64_bf16 v[68:71], v[16:19], a[168:175], v1
    ds_read_b128 v[40:43], v44 offset:0
    s_waitcnt lgkmcnt(4)
    v_smfmac_f32_16x16x64_bf16 v[48:51], v[24:27], a[0:7], v1
    ds_read_b128 v[44:47], v44 offset:1024
    v_smfmac_f32_16x16x64_bf16 v[52:55], v[24:27], a[8:15], v1
    buffer_load_dwordx4 v[112:115], v3, s[8:11], s29 offen offset:2048 sc1
    s_waitcnt lgkmcnt(4)
    v_smfmac_f32_16x16x64_bf16 v[48:51], v[28:31], a[16:23], v1
    ds_read_b128 v[88:91], v4 offset:12288
    v_smfmac_f32_16x16x64_bf16 v[52:55], v[28:31], a[24:31], v1
    buffer_load_dwordx4 v[116:119], v3, s[8:11], s29 offen offset:3072 sc1
    s_waitcnt lgkmcnt(4)
    v_smfmac_f32_16x16x64_bf16 v[48:51], v[32:35], a[32:39], v1
    ds_read_b128 v[92:95], v4 offset:13312
    v_smfmac_f32_16x16x64_bf16 v[52:55], v[32:35], a[40:47], v1
    buffer_load_dwordx4 v[120:123], v3, s[8:11], s30 offen offset:0 sc1
    s_waitcnt lgkmcnt(4)
    v_smfmac_f32_16x16x64_bf16 v[48:51], v[36:39], a[48:55], v1
    ds_read_b128 v[96:99], v4 offset:14336
    v_smfmac_f32_16x16x64_bf16 v[52:55], v[36:39], a[56:63], v1
    ds_read_b128 v[100:103], v4 offset:15360
    s_waitcnt lgkmcnt(5)
    v_smfmac_f32_16x16x64_bf16 v[48:51], v[40:43], a[64:71], v1
    buffer_load_dwordx4 v[124:127], v3, s[8:11], s30 offen offset:1024 sc1
    v_smfmac_f32_16x16x64_bf16 v[52:55], v[40:43], a[72:79], v1
    ds_read_b128 v[72:75], v4 offset:16384
    s_waitcnt lgkmcnt(1)
    v_smfmac_f32_16x16x64_bf16 v[48:51], v[44:47], v[88:95], v1
    ds_read_b128 v[76:79], v4 offset:17408
    v_smfmac_f32_16x16x64_bf16 v[52:55], v[44:47], v[96:103], v1
    buffer_load_dword v15, v0, s[8:11], s24 offen sc1
    v_smfmac_f32_16x16x64_bf16 v[56:59], v[28:31], a[96:103], v1
    ds_read_b128 v[80:83], v4 offset:18432
    v_smfmac_f32_16x16x64_bf16 v[60:63], v[28:31], a[104:111], v1
    ds_read_b128 v[84:87], v4 offset:19456
    v_smfmac_f32_16x16x64_bf16 v[56:59], v[36:39], a[128:135], v1
    ds_read_b128 v[88:91], v4 offset:20480
    v_smfmac_f32_16x16x64_bf16 v[56:59], v[32:35], a[112:119], v1
    ds_read_b128 v[92:95], v4 offset:21504
    v_add_f32 v48, v48, v50
    v_add_f32 v49, v49, v51
    v_smfmac_f32_16x16x64_bf16 v[60:63], v[32:35], a[120:127], v1
    ds_read_b128 v[96:99], v4 offset:22528
    v_add_f32 v52, v52, v54
    v_add_f32 v53, v53, v55
    v_smfmac_f32_16x16x64_bf16 v[60:63], v[36:39], a[136:143], v1
    ds_read_b128 v[100:103], v4 offset:23552
    s_waitcnt lgkmcnt(4)
    v_cvt_pk_bf16_f32 v50, v48, v52
    v_cvt_pk_bf16_f32 v51, v49, v53
    v_smfmac_f32_16x16x64_bf16 v[56:59], v[24:27], v[72:79], v1
    ds_write2_b32 v5, v50, v51 offset0:0 offset1:72
    v_smfmac_f32_16x16x64_bf16 v[60:63], v[24:27], v[80:87], v1
    v_add_u32 v55, 2304, v5
    v_smfmac_f32_16x16x64_bf16 v[56:59], v[40:43], a[144:151], v1
    v_smfmac_f32_16x16x64_bf16 v[60:63], v[40:43], a[152:159], v1
    s_waitcnt lgkmcnt(0)
    s_barrier
    ds_read_b128 v[72:75], v6 offset:0
    v_smfmac_f32_16x16x64_bf16 v[56:59], v[44:47], v[88:95], v1
    ds_read_b128 v[76:79], v6 offset:64
    v_smfmac_f32_16x16x64_bf16 v[60:63], v[44:47], v[96:103], v1
    ds_read_b128 v[80:83], v6 offset:128
    v_smfmac_f32_16x16x64_bf16 v[64:67], v[20:23], a[176:183], v1
    ds_read_b128 v[84:87], v6 offset:192
    v_smfmac_f32_16x16x64_bf16 v[68:71], v[20:23], a[184:191], v1
    s_waitcnt vmcnt(3) lgkmcnt(3)
    v_mfma_f32_16x16x32_bf16 v[48:51], v[104:107], v[72:75], 0
    s_waitcnt lgkmcnt(2)
    v_add_f32 v56, v56, v58
    v_add_f32 v57, v57, v59
    v_mfma_f32_16x16x32_bf16 v[48:51], v[108:111], v[76:79], v[48:51]
    s_waitcnt lgkmcnt(1)
    v_add_f32 v60, v60, v62
    v_add_f32 v61, v61, v63
    v_mfma_f32_16x16x32_bf16 v[48:51], v[112:115], v[80:83], v[48:51]
    s_waitcnt lgkmcnt(0)
    v_cvt_pk_bf16_f32 v58, v56, v60
    v_cvt_pk_bf16_f32 v59, v57, v61
    v_mfma_f32_16x16x32_bf16 v[48:51], v[116:119], v[84:87], v[48:51]
    ds_write2_b32 v55, v58, v59 offset0:0 offset1:72
    v_smfmac_f32_16x16x64_bf16 v[64:67], v[24:27], a[192:199], v1
    buffer_store_dword v12, v10, s[8:11], s31 offen sc1
    v_mov_b64 v[104:105], s[4:5]
    v_smfmac_f32_16x16x64_bf16 v[68:71], v[24:27], a[200:207], v1
    v_mov_b64 v[106:107], s[4:5]
    v_smfmac_f32_16x16x64_bf16 v[64:67], v[28:31], a[208:215], v1
    s_nop 0
    v_exp_f32 v48, v48
    v_smfmac_f32_16x16x64_bf16 v[68:71], v[28:31], a[216:223], v1
    s_waitcnt lgkmcnt(0)
    s_barrier
    ds_read_b128 v[88:91], v7 offset:0
    v_exp_f32 v49, v49
    v_smfmac_f32_16x16x64_bf16 v[64:67], v[32:35], a[224:231], v1
    ds_read_b128 v[92:95], v7 offset:64
    v_exp_f32 v50, v50
    v_smfmac_f32_16x16x64_bf16 v[68:71], v[32:35], a[232:239], v1
    ds_read_b128 v[96:99], v7 offset:128
    v_exp_f32 v51, v51
    v_smfmac_f32_16x16x64_bf16 v[64:67], v[36:39], a[240:247], v1
    ds_read_b128 v[100:103], v7 offset:192
    v_cvt_pk_bf16_f32 v108, v48, v49
    v_cvt_pk_bf16_f32 v109, v50, v51
    v_smfmac_f32_16x16x64_bf16 v[68:71], v[36:39], a[248:255], v1
    ds_write_b64 v2, v[108:109] offset:8192
    s_waitcnt lgkmcnt(4)
    v_mfma_f32_16x16x32_bf16 v[52:55], v[88:91], v[72:75], 0
    s_waitcnt lgkmcnt(3)
    v_mov_b32 v113, 0
    v_mov_b32 v115, 0
    v_mfma_f32_16x16x32_bf16 v[52:55], v[92:95], v[76:79], v[52:55]
    s_waitcnt lgkmcnt(2)
    v_mov_b32 v117, 0
    v_xor_b32 v118, 0x1000, v2
    v_mfma_f32_16x16x32_bf16 v[52:55], v[96:99], v[80:83], v[52:55]
    s_waitcnt lgkmcnt(1)
    v_mov_b64 v[16:17], 0
    v_mov_b64 v[18:19], 0
    v_mfma_f32_16x16x32_bf16 v[52:55], v[100:103], v[84:87], v[52:55]
    v_mov_b64 v[20:21], 0
    v_mov_b64 v[22:23], 0
    v_smfmac_f32_16x16x64_bf16 v[64:67], v[40:43], v[128:135], v1
    s_waitcnt lgkmcnt(0)
    s_barrier
    ds_read_b64 v[110:111], v118 offset:8192
    v_mov_b64 v[24:25], 0
    v_smfmac_f32_16x16x64_bf16 v[68:71], v[40:43], v[136:143], v1
    ds_read_b128 v[88:91], v4 offset:24576
    v_mov_b64 v[26:27], 0
    v_smfmac_f32_16x16x64_bf16 v[64:67], v[44:47], v[144:151], v1
    ds_read_b128 v[92:95], v4 offset:25600
    v_mul_f32 v52, s33, v52
    v_mul_f32 v53, s33, v53
    v_smfmac_f32_16x16x64_bf16 v[68:71], v[44:47], v[152:159], v1
    ds_read_b128 v[96:99], v4 offset:26624
    s_waitcnt vmcnt(2) lgkmcnt(3)
    v_exp_f32 v52, v52
    v_mfma_f32_16x16x32_bf16 v[48:51], v[104:107], v[108:111], 0
    ds_read_b128 v[100:103], v4 offset:27648
    v_exp_f32 v53, v53
    v_mfma_f32_16x16x32_bf16 v[56:59], v[120:123], v[108:111], 0
    ds_read_b128 v[72:75], v4 offset:28672
    v_cvt_pk_bf16_f32 v112, v52, v53
    v_mov_b64 v[28:29], 0
    v_mfma_f32_16x16x32_bf16 v[60:63], v[124:127], v[108:111], 0
    ds_read_b128 v[76:79], v4 offset:29696
    v_add_f32 v64, v64, v66
    v_add_f32 v65, v65, v67
    v_mfma_f32_16x16x16_bf16 v[48:51], v[104:105], v[112:113], v[48:51]
    ds_read_b128 v[80:83], v4 offset:30720
    v_cvt_pk_bf16_f32 v114, v64, v65
    v_add_f32 v68, v68, v70
    v_add_f32 v69, v69, v71
    v_mfma_f32_16x16x16_bf16 v[56:59], v[114:115], v[112:113], v[56:59]
    ds_read_b128 v[84:87], v4 offset:31744
    v_cvt_pk_bf16_f32 v116, v68, v69
    v_mov_b64 v[30:31], 0
    v_mov_b64 v[32:33], 0
    v_mfma_f32_16x16x16_bf16 v[60:63], v[116:117], v[112:113], v[60:63]
    v_rcp_f32 v118, v48
    v_mov_b64 v[34:35], 0
    v_mov_b64 v[36:37], 0
    v_mov_b64 v[38:39], 0
    v_mov_b64 v[40:41], 0
    v_mov_b64 v[42:43], 0
    v_pk_mul_f32 v[56:57], v[56:57], v[118:119] op_sel_hi:[1,0]
    s_nop 0
    v_pk_mul_f32 v[60:61], v[60:61], v[118:119] op_sel_hi:[1,0]
    v_pk_mul_f32 v[58:59], v[58:59], v[118:119] op_sel_hi:[1,0]
    v_pk_mul_f32 v[62:63], v[62:63], v[118:119] op_sel_hi:[1,0]
    v_cvt_pk_bf16_f32 v52, v56, v60
    v_cvt_pk_bf16_f32 v53, v57, v61
    v_cvt_pk_bf16_f32 v54, v58, v62
    v_cvt_pk_bf16_f32 v55, v59, v63
    ds_write_b128 v8, v[52:55]
    v_max_f32 v118, v118, v48
    v_cmp_nge_f32 vcc, s40, v118
    s_cbranch_vccnz L_fast_safe
L_fast_rejoin:
    v_mov_b64 v[44:45], 0
    v_mov_b64 v[46:47], 0
    s_waitcnt lgkmcnt(0)
    s_barrier
    ds_read_b128 v[120:123], v3 offset:20992
    ds_read_b128 v[124:127], v3 offset:22016
    s_waitcnt lgkmcnt(1)
    v_smfmac_f32_16x16x64_bf16 v[16:19], v[120:123], v[88:95], v1
    v_smfmac_f32_16x16x64_bf16 v[20:23], v[120:123], v[96:103], v1
    s_waitcnt lgkmcnt(0)
    v_smfmac_f32_16x16x64_bf16 v[16:19], v[124:127], v[72:79], v1
    v_smfmac_f32_16x16x64_bf16 v[20:23], v[124:127], v[80:87], v1
    v_smfmac_f32_16x16x64_bf16 v[24:27], v[120:123], v[160:167], v1
    v_smfmac_f32_16x16x64_bf16 v[28:31], v[120:123], v[168:175], v1
    s_nop 4
    v_add_f32 v16, v16, v18
    v_add_f32 v17, v17, v19
    v_smfmac_f32_16x16x64_bf16 v[24:27], v[124:127], v[208:215], v1
    v_add_f32 v20, v20, v22
    v_add_f32 v21, v21, v23
    v_smfmac_f32_16x16x64_bf16 v[28:31], v[124:127], v[216:223], v1
    v_cvt_pk_bf16_f32 v48, v16, v20
    v_cvt_pk_bf16_f32 v49, v17, v21
    v_smfmac_f32_16x16x64_bf16 v[32:35], v[120:123], v[176:183], v1
    v_and_or_b32 v48, v48, -2, s27
    v_smfmac_f32_16x16x64_bf16 v[36:39], v[120:123], v[184:191], v1
    buffer_store_dwordx2 v[48:49], v9, s[8:11], 0 offen offset:0
    v_add_f32 v24, v24, v26
    v_add_f32 v25, v25, v27
    v_smfmac_f32_16x16x64_bf16 v[32:35], v[124:127], v[224:231], v1
    v_add_f32 v28, v28, v30
    v_add_f32 v29, v29, v31
    v_smfmac_f32_16x16x64_bf16 v[36:39], v[124:127], v[232:239], v1
    v_cvt_pk_bf16_f32 v50, v24, v28
    v_cvt_pk_bf16_f32 v51, v25, v29
    v_smfmac_f32_16x16x64_bf16 v[40:43], v[120:123], v[192:199], v1
    v_and_or_b32 v50, v50, -2, s27
    v_smfmac_f32_16x16x64_bf16 v[44:47], v[120:123], v[200:207], v1
    buffer_store_dwordx2 v[50:51], v9, s[8:11], 0 offen offset:2048
    v_add_f32 v32, v32, v34
    v_add_f32 v33, v33, v35
    v_smfmac_f32_16x16x64_bf16 v[40:43], v[124:127], v[240:247], v1
    v_add_f32 v36, v36, v38
    v_add_f32 v37, v37, v39
    v_smfmac_f32_16x16x64_bf16 v[44:47], v[124:127], v[248:255], v1
    v_cvt_pk_bf16_f32 v52, v32, v36
    v_cvt_pk_bf16_f32 v53, v33, v37
    v_and_or_b32 v52, v52, -2, s27
    buffer_store_dwordx2 v[52:53], v9, s[8:11], s26 offen offset:0
    s_nop 0
    v_add_f32 v40, v40, v42
    v_add_f32 v41, v41, v43
    s_nop 0
    v_add_f32 v44, v44, v46
    v_add_f32 v45, v45, v47
    v_cvt_pk_bf16_f32 v54, v40, v44
    v_cvt_pk_bf16_f32 v55, v41, v45
    v_and_or_b32 v54, v54, -2, s27
    buffer_store_dwordx2 v[54:55], v9, s[8:11], s26 offen offset:2048
L_fast_stored:
    ds_read_b128 v[24:27], v3 offset:23040
    ds_read_b128 v[104:107], v4 offset:0
    ds_read_b128 v[108:111], v4 offset:1024
    ds_read_b128 v[112:115], v4 offset:2048
    ds_read_b128 v[116:119], v4 offset:3072
    ds_read_b128 v[88:91], v4 offset:4096
    ds_read_b128 v[92:95], v4 offset:5120
    ds_read_b128 v[96:99], v4 offset:6144
    ds_read_b128 v[100:103], v4 offset:7168
    ds_read_b128 v[72:75], v4 offset:8192
    ds_read_b128 v[76:79], v4 offset:9216
    ds_read_b128 v[80:83], v4 offset:10240
    ds_read_b128 v[84:87], v4 offset:11264
    v_mov_b64 v[48:49], 0
    v_mov_b64 v[50:51], 0
    v_mov_b64 v[52:53], 0
    v_mov_b64 v[54:55], 0
    v_mov_b64 v[56:57], 0
    v_mov_b64 v[58:59], 0
    v_mov_b64 v[60:61], 0
    v_mov_b64 v[62:63], 0
    v_mov_b64 v[64:65], 0
    v_mov_b64 v[66:67], 0
    v_mov_b64 v[68:69], 0
    v_mov_b64 v[70:71], 0
    s_cmp_lt_u32 s21, 1
    s_cbranch_scc1 L_fast_poll0
    s_nop 7
    s_cmp_lt_u32 s21, 2
    s_cbranch_scc1 L_fast_poll0
    s_nop 7
    s_cmp_lt_u32 s21, 3
    s_cbranch_scc1 L_fast_poll0
    s_nop 7
L_fast_poll0:
    buffer_load_dwordx4 v[120:123], v2, s[8:11], s6 offen sc1
    buffer_load_dwordx4 v[124:127], v2, s[8:11], s6 offen offset:1024 sc1
    s_waitcnt lgkmcnt(0)
L_fast_pollp:
    s_waitcnt vmcnt(1)
    v_mfma_f32_16x16x32_bf16 v[36:39], v[24:27], v[120:123], 0
    v_bitop3_b32 v14, v120, v122, s27 bitop3:0x7e
    s_waitcnt vmcnt(0)
    v_mfma_f32_16x16x32_bf16 v[36:39], v[24:27], v[124:127], v[36:39]
    v_bitop3_b32 v11, v124, v126, s27 bitop3:0x7e
    v_bitop3_b32 v14, v14, v11, 1 bitop3:0xa8
    v_cmp_ne_u32 vcc, 0, v14
    s_add_u32 s32, s32, 1
    s_cbranch_vccz L_fast_gotp
    buffer_load_dwordx4 v[16:19], v2, s[8:11], s6 offen sc1
    buffer_load_dwordx4 v[20:23], v2, s[8:11], s6 offen offset:1024 sc1
    s_waitcnt vmcnt(1)
    v_mfma_f32_16x16x32_bf16 v[36:39], v[24:27], v[16:19], 0
    v_bitop3_b32 v14, v16, v18, s27 bitop3:0x7e
    s_waitcnt vmcnt(0)
    v_mfma_f32_16x16x32_bf16 v[36:39], v[24:27], v[20:23], v[36:39]
    v_bitop3_b32 v11, v20, v22, s27 bitop3:0x7e
    v_bitop3_b32 v14, v14, v11, 1 bitop3:0xa8
    v_cmp_ne_u32 vcc, 0, v14
    s_add_u32 s32, s32, 1
    s_cbranch_vccz L_fast_gotp
    buffer_load_dwordx4 v[120:123], v2, s[8:11], s6 offen sc1
    buffer_load_dwordx4 v[124:127], v2, s[8:11], s6 offen offset:1024 sc1
    s_cmp_le_u32 s32, 200000
    s_cbranch_scc1 L_fast_pollp
L_fast_gotp:
    s_mov_b32 s23, s24
    s_add_u32 s31, s31, 0x2000
    s_add_u32 s22, s22, 1
    s_xor_b32 s27, s27, 1
    v_add_f32_dpp v36, v36, v36 row_ror:8 row_mask:0xf bank_mask:0xf
    v_add_f32_dpp v37, v37, v37 row_ror:8 row_mask:0xf bank_mask:0xf
    s_nop 0
    v_add_f32_dpp v36, v36, v36 row_ror:4 row_mask:0xf bank_mask:0xf
    v_add_f32_dpp v37, v37, v37 row_ror:4 row_mask:0xf bank_mask:0xf
    v_cvt_pk_bf16_f32 v12, v36, v37
    buffer_store_dword v12, v10, s[8:11], s23 offen
    s_nop 15
    s_nop 15
    s_nop 15
    s_cmp_lt_u32 s22, 63
    s_cbranch_scc1 L_fast_step
    buffer_store_dword v12, v10, s[8:11], s31 offen sc1
    s_branch L_fast_done
L_fast_refresh:
    v_lshrrev_b32 v14, 2, v3
    s_lshl_b32 s36, s20, 8
    s_add_u32 s36, s36, 0x190000
    buffer_load_dword v14, v14, s[8:11], s36 offen sc1
    s_add_u32 s32, s32, 1
    s_waitcnt vmcnt(0)
    v_cmp_ne_u32 s[62:63], 0, v14
    s_nop 3
    s_bitset1_b64 s[62:63], 63
    s_cmp_le_u32 s32, 200000
    s_cbranch_scc1 L_fast_step
    s_mov_b64 s[62:63], -1
    s_branch L_fast_step
L_fast_safe:
    s_nop 11
    s_waitcnt vmcnt(0) lgkmcnt(0)
    ds_read_b128 v[72:75], v6 offset:0
    ds_read_b128 v[88:91], v7 offset:0
    ds_read_b128 v[76:79], v6 offset:64
    ds_read_b128 v[92:95], v7 offset:64
    ds_read_b128 v[80:83], v6 offset:128
    ds_read_b128 v[96:99], v7 offset:128
    ds_read_b128 v[84:87], v6 offset:192
    ds_read_b128 v[100:103], v7 offset:192
    s_xor_b32 s36, s25, 0x1000
    s_add_u32 s36, s36, s23
    buffer_load_dwordx4 v[16:19], v3, s[8:11], s29 offen offset:0 sc1
    buffer_load_dwordx4 v[32:35], v3, s[8:11], s36 offen offset:0 sc1
    buffer_load_dwordx4 v[20:23], v3, s[8:11], s29 offen offset:1024 sc1
    buffer_load_dwordx4 v[36:39], v3, s[8:11], s36 offen offset:1024 sc1
    buffer_load_dwordx4 v[24:27], v3, s[8:11], s29 offen offset:2048 sc1
    buffer_load_dwordx4 v[40:43], v3, s[8:11], s36 offen offset:2048 sc1
    buffer_load_dwordx4 v[28:31], v3, s[8:11], s29 offen offset:3072 sc1
    buffer_load_dwordx4 v[44:47], v3, s[8:11], s36 offen offset:3072 sc1
    s_waitcnt vmcnt(0) lgkmcnt(0)
    v_mfma_f32_16x16x32_bf16 v[48:51], v[16:19], v[72:75], 0
    v_mfma_f32_16x16x32_bf16 v[48:51], v[20:23], v[76:79], v[48:51]
    v_mfma_f32_16x16x32_bf16 v[48:51], v[24:27], v[80:83], v[48:51]
    v_mfma_f32_16x16x32_bf16 v[48:51], v[28:31], v[84:87], v[48:51]
    v_mfma_f32_16x16x32_bf16 v[52:55], v[32:35], v[72:75], 0
    v_mfma_f32_16x16x32_bf16 v[52:55], v[36:39], v[76:79], v[52:55]
    v_mfma_f32_16x16x32_bf16 v[52:55], v[40:43], v[80:83], v[52:55]
    v_mfma_f32_16x16x32_bf16 v[52:55], v[44:47], v[84:87], v[52:55]
    v_mfma_f32_16x16x32_bf16 v[56:59], v[88:91], v[72:75], 0
    v_mfma_f32_16x16x32_bf16 v[56:59], v[92:95], v[76:79], v[56:59]
    v_mfma_f32_16x16x32_bf16 v[56:59], v[96:99], v[80:83], v[56:59]
    v_mfma_f32_16x16x32_bf16 v[56:59], v[100:103], v[84:87], v[56:59]
    s_nop 7
    v_mul_f32 v56, s33, v56
    v_mul_f32 v57, s33, v57
    v_max3_f32 v16, v48, v49, v50
    v_max3_f32 v16, v16, v51, v52
    v_max3_f32 v16, v16, v53, v54
    v_max3_f32 v16, v16, v55, v56
    v_max_f32 v16, v16, v57
    v_mov_b32 v17, v16
    s_nop 1
    v_permlane16_swap_b32 v16, v17
    v_max_f32 v16, v16, v17
    v_mov_b32 v17, v16
    s_nop 1
    v_permlane32_swap_b32 v16, v17
    v_max_f32 v16, v16, v17
    v_sub_f32 v48, v48, v16
    v_exp_f32 v48, v48
    v_sub_f32 v49, v49, v16
    v_exp_f32 v49, v49
    v_sub_f32 v50, v50, v16
    v_exp_f32 v50, v50
    v_sub_f32 v51, v51, v16
    v_exp_f32 v51, v51
    v_sub_f32 v52, v52, v16
    v_exp_f32 v52, v52
    v_sub_f32 v53, v53, v16
    v_exp_f32 v53, v53
    v_sub_f32 v54, v54, v16
    v_exp_f32 v54, v54
    v_sub_f32 v55, v55, v16
    v_exp_f32 v55, v55
    v_sub_f32 v56, v56, v16
    v_exp_f32 v56, v56
    v_sub_f32 v57, v57, v16
    v_exp_f32 v57, v57
    v_cvt_pk_bf16_f32 v108, v48, v49
    v_cvt_pk_bf16_f32 v109, v50, v51
    v_cvt_pk_bf16_f32 v110, v52, v53
    v_cvt_pk_bf16_f32 v111, v54, v55
    v_cvt_pk_bf16_f32 v112, v56, v57
    s_nop 0
    v_mfma_f32_16x16x32_bf16 v[48:51], v[104:107], v[108:111], 0
    v_mfma_f32_16x16x32_bf16 v[56:59], v[120:123], v[108:111], 0
    v_mfma_f32_16x16x32_bf16 v[60:63], v[124:127], v[108:111], 0
    s_nop 3
    v_mfma_f32_16x16x16_bf16 v[48:51], v[104:105], v[112:113], v[48:51]
    v_mfma_f32_16x16x16_bf16 v[56:59], v[114:115], v[112:113], v[56:59]
    v_mfma_f32_16x16x16_bf16 v[60:63], v[116:117], v[112:113], v[60:63]
    s_nop 5
    v_rcp_f32 v118, v48
    s_nop 0
    v_mul_f32 v56, v56, v118
    v_mul_f32 v57, v57, v118
    v_mul_f32 v58, v58, v118
    v_mul_f32 v59, v59, v118
    v_mul_f32 v60, v60, v118
    v_mul_f32 v61, v61, v118
    v_mul_f32 v62, v62, v118
    v_mul_f32 v63, v63, v118
    v_cvt_pk_bf16_f32 v52, v56, v60
    v_cvt_pk_bf16_f32 v53, v57, v61
    v_cvt_pk_bf16_f32 v54, v58, v62
    v_cvt_pk_bf16_f32 v55, v59, v63
    ds_write_b128 v8, v[52:55]
    ds_read_b128 v[88:91], v4 offset:24576
    ds_read_b128 v[92:95], v4 offset:25600
    ds_read_b128 v[96:99], v4 offset:26624
    ds_read_b128 v[100:103], v4 offset:27648
    ds_read_b128 v[72:75], v4 offset:28672
    ds_read_b128 v[76:79], v4 offset:29696
    ds_read_b128 v[80:83], v4 offset:30720
    ds_read_b128 v[84:87], v4 offset:31744
    v_mov_b32 v16, 0
    v_mov_b32 v17, 0
    v_mov_b32 v18, 0
    v_mov_b32 v19, 0
    v_mov_b32 v20, 0
    v_mov_b32 v21, 0
    v_mov_b32 v22, 0
    v_mov_b32 v23, 0
    v_mov_b32 v24, 0
    v_mov_b32 v25, 0
    v_mov_b32 v26, 0
    v_mov_b32 v27, 0
    v_mov_b32 v28, 0
    v_mov_b32 v29, 0
    v_mov_b32 v30, 0
    v_mov_b32 v31, 0
    v_mov_b32 v32, 0
    v_mov_b32 v33, 0
    v_mov_b32 v34, 0
    v_mov_b32 v35, 0
    v_mov_b32 v36, 0
    v_mov_b32 v37, 0
    v_mov_b32 v38, 0
    v_mov_b32 v39, 0
    v_mov_b32 v40, 0
    v_mov_b32 v41, 0
    v_mov_b32 v42, 0
    v_mov_b32 v43, 0
    v_mov_b32 v44, 0
    v_mov_b32 v45, 0
    v_mov_b32 v46, 0
    v_mov_b32 v47, 0
    s_branch L_fast_rejoin
L_fast_done:
    s_branch L_end
L_slow_start:
    s_mov_b32 s22, 0
    s_mov_b32 s23, 0x1000000
    s_mov_b32 s27, 0
    s_mov_b32 s31, 0x80000
    ds_read_b128 v[104:107], v4 offset:0
    ds_read_b128 v[108:111], v4 offset:1024
    ds_read_b128 v[112:115], v4 offset:2048
    ds_read_b128 v[116:119], v4 offset:3072
    ds_read_b128 v[88:91], v4 offset:4096
    ds_read_b128 v[92:95], v4 offset:5120
    ds_read_b128 v[96:99], v4 offset:6144
    ds_read_b128 v[100:103], v4 offset:7168
    ds_read_b128 v[72:75], v4 offset:8192
    ds_read_b128 v[76:79], v4 offset:9216
    ds_read_b128 v[80:83], v4 offset:10240
    ds_read_b128 v[84:87], v4 offset:11264
    v_mov_b64 v[48:49], 0
    v_mov_b64 v[50:51], 0
    v_mov_b64 v[52:53], 0
    v_mov_b64 v[54:55], 0
    v_mov_b64 v[56:57], 0
    v_mov_b64 v[58:59], 0
    v_mov_b64 v[60:61], 0
    v_mov_b64 v[62:63], 0
    v_mov_b64 v[64:65], 0
    v_mov_b64 v[66:67], 0
    v_mov_b64 v[68:69], 0
    v_mov_b64 v[70:71], 0
    s_waitcnt lgkmcnt(0)
    s_mov_b64 s[62:63], 0
L_slow_step:
    s_bitcmp1_b64 s[62:63], s22
    s_cbranch_scc0 L_slow_refresh
    s_add_u32 s36, s22, 1
    s_bitcmp1_b64 s[62:63], s36
    s_cbranch_scc0 L_slow_refresh
    s_add_u32 s7, s23, 0x80000
    s_add_u32 s24, s23, 0x82000
    s_add_u32 s29, s23, s25
    s_add_u32 s30, s23, s39
    v_xor_b32 v28, 0x800, v2
    v_xor_b32 v36, 0x1000, v2
    v_xor_b32 v44, 0x1800, v2
L_slow_pollm:
    buffer_load_dwordx4 v[16:19], v2, s[8:11], s7 offen sc1
    buffer_load_dwordx4 v[20:23], v2, s[8:11], s7 offen offset:1024 sc1
    s_add_u32 s32, s32, 1
    s_cmp_gt_u32 s32, 200000
    s_waitcnt vmcnt(1)
    v_max3_u32 v14, v16, v17, v18
    s_waitcnt vmcnt(0)
    v_max3_u32 v24, v19, v20, v21
    v_max3_u32 v14, v14, v22, v23
    v_max_u32 v14, v14, v24
    s_cbranch_scc1 L_slow_gotm
    v_cmp_eq_u32 vcc, -1, v14
    s_cbranch_vccnz L_slow_pollm
L_slow_gotm:
    v_smfmac_f32_16x16x64_bf16 v[48:51], v[16:19], v[104:111], v1
    ds_write_b128 v2, v[16:19] offset:0
    v_smfmac_f32_16x16x64_bf16 v[52:55], v[16:19], v[112:119], v1
    ds_write_b128 v2, v[20:23] offset:1024
    v_smfmac_f32_16x16x64_bf16 v[48:51], v[20:23], v[88:95], v1
    buffer_load_dwordx4 v[104:107], v3, s[8:11], s29 offen offset:0 sc1
    v_smfmac_f32_16x16x64_bf16 v[52:55], v[20:23], v[96:103], v1
    v_smfmac_f32_16x16x64_bf16 v[56:59], v[16:19], v[72:79], v1
    buffer_load_dwordx4 v[108:111], v3, s[8:11], s29 offen offset:1024 sc1
    v_smfmac_f32_16x16x64_bf16 v[60:63], v[16:19], v[80:87], v1
    s_waitcnt lgkmcnt(0)
    s_barrier
    ds_read_b128 v[24:27], v28 offset:0
    v_smfmac_f32_16x16x64_bf16 v[56:59], v[20:23], a[80:87], v1
    ds_read_b128 v[28:31], v28 offset:1024
    v_smfmac_f32_16x16x64_bf16 v[60:63], v[20:23], a[88:95], v1
    ds_read_b128 v[32:35], v36 offset:0
    v_smfmac_f32_16x16x64_bf16 v[64:67], v[16:19], a[160:167], v1
    ds_read_b128 v[36:39], v36 offset:1024
    v_smfmac_f32_16x16x64_bf16 v[68:71], v[16:19], a[168:175], v1
    ds_read_b128 v[40:43], v44 offset:0
    s_waitcnt lgkmcnt(4)
    v_smfmac_f32_16x16x64_bf16 v[48:51], v[24:27], a[0:7], v1
    ds_read_b128 v[44:47], v44 offset:1024
    v_smfmac_f32_16x16x64_bf16 v[52:55], v[24:27], a[8:15], v1
    buffer_load_dwordx4 v[112:115], v3, s[8:11], s29 offen offset:2048 sc1
    s_waitcnt lgkmcnt(4)
    v_smfmac_f32_16x16x64_bf16 v[48:51], v[28:31], a[16:23], v1
    ds_read_b128 v[88:91], v4 offset:12288
    v_smfmac_f32_16x16x64_bf16 v[52:55], v[28:31], a[24:31], v1
    buffer_load_dwordx4 v[116:119], v3, s[8:11], s29 offen offset:3072 sc1
    s_waitcnt lgkmcnt(4)
    v_smfmac_f32_16x16x64_bf16 v[48:51], v[32:35], a[32:39], v1
    ds_read_b128 v[92:95], v4 offset:13312
    v_smfmac_f32_16x16x64_bf16 v[52:55], v[32:35], a[40:47], v1
    buffer_load_dwordx4 v[120:123], v3, s[8:11], s30 offen offset:0 sc1
    s_waitcnt lgkmcnt(4)
    v_smfmac_f32_16x16x64_bf16 v[48:51], v[36:39], a[48:55], v1
    ds_read_b128 v[96:99], v4 offset:14336
    v_smfmac_f32_16x16x64_bf16 v[52:55], v[36:39], a[56:63], v1
    ds_read_b128 v[100:103], v4 offset:15360
    s_waitcnt lgkmcnt(5)
    v_smfmac_f32_16x16x64_bf16 v[48:51], v[40:43], a[64:71], v1
    buffer_load_dwordx4 v[124:127], v3, s[8:11], s30 offen offset:1024 sc1
    v_smfmac_f32_16x16x64_bf16 v[52:55], v[40:43], a[72:79], v1
    ds_read_b128 v[72:75], v4 offset:16384
    s_waitcnt lgkmcnt(1)
    v_smfmac_f32_16x16x64_bf16 v[48:51], v[44:47], v[88:95], v1
    ds_read_b128 v[76:79], v4 offset:17408
    v_smfmac_f32_16x16x64_bf16 v[52:55], v[44:47], v[96:103], v1
    buffer_load_dword v15, v0, s[8:11], s24 offen sc1
    v_smfmac_f32_16x16x64_bf16 v[56:59], v[28:31], a[96:103], v1
    ds_read_b128 v[80:83], v4 offset:18432
    v_smfmac_f32_16x16x64_bf16 v[60:63], v[28:31], a[104:111], v1
    ds_read_b128 v[84:87], v4 offset:19456
    v_smfmac_f32_16x16x64_bf16 v[56:59], v[36:39], a[128:135], v1
    ds_read_b128 v[88:91], v4 offset:20480
    v_smfmac_f32_16x16x64_bf16 v[56:59], v[32:35], a[112:119], v1
    ds_read_b128 v[92:95], v4 offset:21504
    v_add_f32 v48, v48, v50
    v_add_f32 v49, v49, v51
    v_smfmac_f32_16x16x64_bf16 v[60:63], v[32:35], a[120:127], v1
    ds_read_b128 v[96:99], v4 offset:22528
    v_add_f32 v52, v52, v54
    v_add_f32 v53, v53, v55
    v_smfmac_f32_16x16x64_bf16 v[60:63], v[36:39], a[136:143], v1
    ds_read_b128 v[100:103], v4 offset:23552
    s_waitcnt lgkmcnt(4)
    v_cvt_pk_bf16_f32 v50, v48, v52
    v_cvt_pk_bf16_f32 v51, v49, v53
    v_smfmac_f32_16x16x64_bf16 v[56:59], v[24:27], v[72:79], v1
    ds_write2_b32 v5, v50, v51 offset0:0 offset1:72
    v_smfmac_f32_16x16x64_bf16 v[60:63], v[24:27], v[80:87], v1
    v_add_u32 v55, 2304, v5
    v_smfmac_f32_16x16x64_bf16 v[56:59], v[40:43], a[144:151], v1
    v_smfmac_f32_16x16x64_bf16 v[60:63], v[40:43], a[152:159], v1
    s_waitcnt lgkmcnt(0)
    s_barrier
    ds_read_b128 v[72:75], v6 offset:0
    v_smfmac_f32_16x16x64_bf16 v[56:59], v[44:47], v[88:95], v1
    ds_read_b128 v[76:79], v6 offset:64
    v_smfmac_f32_16x16x64_bf16 v[60:63], v[44:47], v[96:103], v1
    ds_read_b128 v[80:83], v6 offset:128
    v_smfmac_f32_16x16x64_bf16 v[64:67], v[20:23], a[176:183], v1
    ds_read_b128 v[84:87], v6 offset:192
    v_smfmac_f32_16x16x64_bf16 v[68:71], v[20:23], a[184:191], v1
    s_waitcnt vmcnt(3) lgkmcnt(3)
    v_mfma_f32_16x16x32_bf16 v[48:51], v[104:107], v[72:75], 0
    s_waitcnt lgkmcnt(2)
    v_add_f32 v56, v56, v58
    v_add_f32 v57, v57, v59
    v_mfma_f32_16x16x32_bf16 v[48:51], v[108:111], v[76:79], v[48:51]
    s_waitcnt lgkmcnt(1)
    v_add_f32 v60, v60, v62
    v_add_f32 v61, v61, v63
    v_mfma_f32_16x16x32_bf16 v[48:51], v[112:115], v[80:83], v[48:51]
    s_waitcnt lgkmcnt(0)
    v_cvt_pk_bf16_f32 v58, v56, v60
    v_cvt_pk_bf16_f32 v59, v57, v61
    v_mfma_f32_16x16x32_bf16 v[48:51], v[116:119], v[84:87], v[48:51]
    ds_write2_b32 v55, v58, v59 offset0:0 offset1:72
    v_smfmac_f32_16x16x64_bf16 v[64:67], v[24:27], a[192:199], v1
    buffer_store_dword v12, v10, s[8:11], s31 offen sc1
    v_mov_b64 v[104:105], s[4:5]
    v_smfmac_f32_16x16x64_bf16 v[68:71], v[24:27], a[200:207], v1
    v_mov_b64 v[106:107], s[4:5]
    v_smfmac_f32_16x16x64_bf16 v[64:67], v[28:31], a[208:215], v1
    s_nop 0
    v_exp_f32 v48, v48
    v_smfmac_f32_16x16x64_bf16 v[68:71], v[28:31], a[216:223], v1
    s_waitcnt lgkmcnt(0)
    s_barrier
    ds_read_b128 v[88:91], v7 offset:0
    v_exp_f32 v49, v49
    v_smfmac_f32_16x16x64_bf16 v[64:67], v[32:35], a[224:231], v1
    ds_read_b128 v[92:95], v7 offset:64
    v_exp_f32 v50, v50
    v_smfmac_f32_16x16x64_bf16 v[68:71], v[32:35], a[232:239], v1
    ds_read_b128 v[96:99], v7 offset:128
    v_exp_f32 v51, v51
    v_smfmac_f32_16x16x64_bf16 v[64:67], v[36:39], a[240:247], v1
    ds_read_b128 v[100:103], v7 offset:192
    v_cvt_pk_bf16_f32 v108, v48, v49
    v_cvt_pk_bf16_f32 v109, v50, v51
    v_smfmac_f32_16x16x64_bf16 v[68:71], v[36:39], a[248:255], v1
    ds_write_b64 v2, v[108:109] offset:8192
    s_waitcnt lgkmcnt(4)
    v_mfma_f32_16x16x32_bf16 v[52:55], v[88:91], v[72:75], 0
    s_waitcnt lgkmcnt(3)
    v_mov_b32 v113, 0
    v_mov_b32 v115, 0
    v_mfma_f32_16x16x32_bf16 v[52:55], v[92:95], v[76:79], v[52:55]
    s_waitcnt lgkmcnt(2)
    v_mov_b32 v117, 0
    v_xor_b32 v118, 0x1000, v2
    v_mfma_f32_16x16x32_bf16 v[52:55], v[96:99], v[80:83], v[52:55]
    s_waitcnt lgkmcnt(1)
    v_mov_b64 v[16:17], 0
    v_mov_b64 v[18:19], 0
    v_mfma_f32_16x16x32_bf16 v[52:55], v[100:103], v[84:87], v[52:55]
    v_mov_b64 v[20:21], 0
    v_mov_b64 v[22:23], 0
    v_smfmac_f32_16x16x64_bf16 v[64:67], v[40:43], v[128:135], v1
    s_waitcnt lgkmcnt(0)
    s_barrier
    ds_read_b64 v[110:111], v118 offset:8192
    v_mov_b64 v[24:25], 0
    v_smfmac_f32_16x16x64_bf16 v[68:71], v[40:43], v[136:143], v1
    ds_read_b128 v[88:91], v4 offset:24576
    v_mov_b64 v[26:27], 0
    v_smfmac_f32_16x16x64_bf16 v[64:67], v[44:47], v[144:151], v1
    ds_read_b128 v[92:95], v4 offset:25600
    v_mul_f32 v52, s33, v52
    v_mul_f32 v53, s33, v53
    v_smfmac_f32_16x16x64_bf16 v[68:71], v[44:47], v[152:159], v1
    ds_read_b128 v[96:99], v4 offset:26624
    s_waitcnt vmcnt(2) lgkmcnt(3)
    v_exp_f32 v52, v52
    v_mfma_f32_16x16x32_bf16 v[48:51], v[104:107], v[108:111], 0
    ds_read_b128 v[100:103], v4 offset:27648
    v_exp_f32 v53, v53
    v_mfma_f32_16x16x32_bf16 v[56:59], v[120:123], v[108:111], 0
    ds_read_b128 v[72:75], v4 offset:28672
    v_cvt_pk_bf16_f32 v112, v52, v53
    v_mov_b64 v[28:29], 0
    v_mfma_f32_16x16x32_bf16 v[60:63], v[124:127], v[108:111], 0
    ds_read_b128 v[76:79], v4 offset:29696
    v_add_f32 v64, v64, v66
    v_add_f32 v65, v65, v67
    v_mfma_f32_16x16x16_bf16 v[48:51], v[104:105], v[112:113], v[48:51]
    ds_read_b128 v[80:83], v4 offset:30720
    v_cvt_pk_bf16_f32 v114, v64, v65
    v_add_f32 v68, v68, v70
    v_add_f32 v69, v69, v71
    v_mfma_f32_16x16x16_bf16 v[56:59], v[114:115], v[112:113], v[56:59]
    ds_read_b128 v[84:87], v4 offset:31744
    v_cvt_pk_bf16_f32 v116, v68, v69
    v_mov_b64 v[30:31], 0
    v_mov_b64 v[32:33], 0
    v_mfma_f32_16x16x16_bf16 v[60:63], v[116:117], v[112:113], v[60:63]
    v_rcp_f32 v118, v48
    v_mov_b64 v[34:35], 0
    v_mov_b64 v[36:37], 0
    v_mov_b64 v[38:39], 0
    v_mov_b64 v[40:41], 0
    v_mov_b64 v[42:43], 0
    v_pk_mul_f32 v[56:57], v[56:57], v[118:119] op_sel_hi:[1,0]
    s_nop 0
    v_pk_mul_f32 v[60:61], v[60:61], v[118:119] op_sel_hi:[1,0]
    v_pk_mul_f32 v[58:59], v[58:59], v[118:119] op_sel_hi:[1,0]
    v_pk_mul_f32 v[62:63], v[62:63], v[118:119] op_sel_hi:[1,0]
    v_cvt_pk_bf16_f32 v52, v56, v60
    v_cvt_pk_bf16_f32 v53, v57, v61
    v_cvt_pk_bf16_f32 v54, v58, v62
    v_cvt_pk_bf16_f32 v55, v59, v63
    ds_write_b128 v8, v[52:55]
    v_max_f32 v118, v118, v48
    v_cmp_nge_f32 vcc, s40, v118
    s_cbranch_vccnz L_slow_safe
L_slow_rejoin:
    v_mov_b64 v[44:45], 0
    v_mov_b64 v[46:47], 0
    s_waitcnt lgkmcnt(0)
    s_barrier
    ds_read_b128 v[120:123], v3 offset:20992
    ds_read_b128 v[124:127], v3 offset:22016
    s_waitcnt lgkmcnt(1)
    v_smfmac_f32_16x16x64_bf16 v[16:19], v[120:123], v[88:95], v1
    v_smfmac_f32_16x16x64_bf16 v[20:23], v[120:123], v[96:103], v1
    s_waitcnt lgkmcnt(0)
    v_smfmac_f32_16x16x64_bf16 v[16:19], v[124:127], v[72:79], v1
    v_smfmac_f32_16x16x64_bf16 v[20:23], v[124:127], v[80:87], v1
    v_smfmac_f32_16x16x64_bf16 v[24:27], v[120:123], v[160:167], v1
    v_smfmac_f32_16x16x64_bf16 v[28:31], v[120:123], v[168:175], v1
    s_nop 4
    v_add_f32 v16, v16, v18
    v_add_f32 v17, v17, v19
    v_smfmac_f32_16x16x64_bf16 v[24:27], v[124:127], v[208:215], v1
    v_add_f32 v20, v20, v22
    v_add_f32 v21, v21, v23
    v_smfmac_f32_16x16x64_bf16 v[28:31], v[124:127], v[216:223], v1
    v_cvt_pk_bf16_f32 v48, v16, v20
    v_cvt_pk_bf16_f32 v49, v17, v21
    v_smfmac_f32_16x16x64_bf16 v[32:35], v[120:123], v[176:183], v1
    v_and_or_b32 v48, v48, -2, s27
    v_smfmac_f32_16x16x64_bf16 v[36:39], v[120:123], v[184:191], v1
    buffer_store_dwordx2 v[48:49], v9, s[8:11], 0 offen offset:0 sc1
    v_add_f32 v24, v24, v26
    v_add_f32 v25, v25, v27
    v_smfmac_f32_16x16x64_bf16 v[32:35], v[124:127], v[224:231], v1
    v_add_f32 v28, v28, v30
    v_add_f32 v29, v29, v31
    v_smfmac_f32_16x16x64_bf16 v[36:39], v[124:127], v[232:239], v1
    v_cvt_pk_bf16_f32 v50, v24, v28
    v_cvt_pk_bf16_f32 v51, v25, v29
    v_smfmac_f32_16x16x64_bf16 v[40:43], v[120:123], v[192:199], v1
    v_and_or_b32 v50, v50, -2, s27
    v_smfmac_f32_16x16x64_bf16 v[44:47], v[120:123], v[200:207], v1
    buffer_store_dwordx2 v[50:51], v9, s[8:11], 0 offen offset:2048 sc1
    v_add_f32 v32, v32, v34
    v_add_f32 v33, v33, v35
    v_smfmac_f32_16x16x64_bf16 v[40:43], v[124:127], v[240:247], v1
    v_add_f32 v36, v36, v38
    v_add_f32 v37, v37, v39
    v_smfmac_f32_16x16x64_bf16 v[44:47], v[124:127], v[248:255], v1
    v_cvt_pk_bf16_f32 v52, v32, v36
    v_cvt_pk_bf16_f32 v53, v33, v37
    v_and_or_b32 v52, v52, -2, s27
    buffer_store_dwordx2 v[52:53], v9, s[8:11], s26 offen offset:0 sc1
    s_nop 0
    v_add_f32 v40, v40, v42
    v_add_f32 v41, v41, v43
    s_nop 0
    v_add_f32 v44, v44, v46
    v_add_f32 v45, v45, v47
    v_cvt_pk_bf16_f32 v54, v40, v44
    v_cvt_pk_bf16_f32 v55, v41, v45
    v_and_or_b32 v54, v54, -2, s27
    buffer_store_dwordx2 v[54:55], v9, s[8:11], s26 offen offset:2048 sc1
L_slow_stored:
    ds_read_b128 v[24:27], v3 offset:23040
    ds_read_b128 v[104:107], v4 offset:0
    ds_read_b128 v[108:111], v4 offset:1024
    ds_read_b128 v[112:115], v4 offset:2048
    ds_read_b128 v[116:119], v4 offset:3072
    ds_read_b128 v[88:91], v4 offset:4096
    ds_read_b128 v[92:95], v4 offset:5120
    ds_read_b128 v[96:99], v4 offset:6144
    ds_read_b128 v[100:103], v4 offset:7168
    ds_read_b128 v[72:75], v4 offset:8192
    ds_read_b128 v[76:79], v4 offset:9216
    ds_read_b128 v[80:83], v4 offset:10240
    ds_read_b128 v[84:87], v4 offset:11264
    v_mov_b64 v[48:49], 0
    v_mov_b64 v[50:51], 0
    v_mov_b64 v[52:53], 0
    v_mov_b64 v[54:55], 0
    v_mov_b64 v[56:57], 0
    v_mov_b64 v[58:59], 0
    v_mov_b64 v[60:61], 0
    v_mov_b64 v[62:63], 0
    v_mov_b64 v[64:65], 0
    v_mov_b64 v[66:67], 0
    v_mov_b64 v[68:69], 0
    v_mov_b64 v[70:71], 0
    s_cmp_lt_u32 s21, 1
    s_cbranch_scc1 L_slow_poll0
    s_nop 7
    s_cmp_lt_u32 s21, 2
    s_cbranch_scc1 L_slow_poll0
    s_nop 7
    s_cmp_lt_u32 s21, 3
    s_cbranch_scc1 L_slow_poll0
    s_nop 7
L_slow_poll0:
    buffer_load_dwordx4 v[120:123], v2, s[8:11], s6 offen sc1
    buffer_load_dwordx4 v[124:127], v2, s[8:11], s6 offen offset:1024 sc1
    s_waitcnt lgkmcnt(0)
L_slow_pollp:
    s_waitcnt vmcnt(1)
    v_mfma_f32_16x16x32_bf16 v[36:39], v[24:27], v[120:123], 0
    v_bitop3_b32 v14, v120, v122, s27 bitop3:0x7e
    s_waitcnt vmcnt(0)
    v_mfma_f32_16x16x32_bf16 v[36:39], v[24:27], v[124:127], v[36:39]
    v_bitop3_b32 v11, v124, v126, s27 bitop3:0x7e
    v_bitop3_b32 v14, v14, v11, 1 bitop3:0xa8
    v_cmp_ne_u32 vcc, 0, v14
    s_add_u32 s32, s32, 1
    s_cbranch_vccz L_slow_gotp
    buffer_load_dwordx4 v[16:19], v2, s[8:11], s6 offen sc1
    buffer_load_dwordx4 v[20:23], v2, s[8:11], s6 offen offset:1024 sc1
    s_waitcnt vmcnt(1)
    v_mfma_f32_16x16x32_bf16 v[36:39], v[24:27], v[16:19], 0
    v_bitop3_b32 v14, v16, v18, s27 bitop3:0x7e
    s_waitcnt vmcnt(0)
    v_mfma_f32_16x16x32_bf16 v[36:39], v[24:27], v[20:23], v[36:39]
    v_bitop3_b32 v11, v20, v22, s27 bitop3:0x7e
    v_bitop3_b32 v14, v14, v11, 1 bitop3:0xa8
    v_cmp_ne_u32 vcc, 0, v14
    s_add_u32 s32, s32, 1
    s_cbranch_vccz L_slow_gotp
    buffer_load_dwordx4 v[120:123], v2, s[8:11], s6 offen sc1
    buffer_load_dwordx4 v[124:127], v2, s[8:11], s6 offen offset:1024 sc1
    s_cmp_le_u32 s32, 200000
    s_cbranch_scc1 L_slow_pollp
L_slow_gotp:
    s_mov_b32 s23, s24
    s_add_u32 s31, s31, 0x2000
    s_add_u32 s22, s22, 1
    s_xor_b32 s27, s27, 1
    v_add_f32_dpp v36, v36, v36 row_ror:8 row_mask:0xf bank_mask:0xf
    v_add_f32_dpp v37, v37, v37 row_ror:8 row_mask:0xf bank_mask:0xf
    s_nop 0
    v_add_f32_dpp v36, v36, v36 row_ror:4 row_mask:0xf bank_mask:0xf
    v_add_f32_dpp v37, v37, v37 row_ror:4 row_mask:0xf bank_mask:0xf
    v_cvt_pk_bf16_f32 v12, v36, v37
    buffer_store_dword v12, v10, s[8:11], s23 offen sc1
    s_nop 15
    s_nop 15
    s_nop 15
    s_cmp_lt_u32 s22, 63
    s_cbranch_scc1 L_slow_step
    buffer_store_dword v12, v10, s[8:11], s31 offen sc1
    s_branch L_slow_done
L_slow_refresh:
    v_lshrrev_b32 v14, 2, v3
    s_lshl_b32 s36, s20, 8
    s_add_u32 s36, s36, 0x190000
    buffer_load_dword v14, v14, s[8:11], s36 offen sc1
    s_add_u32 s32, s32, 1
    s_waitcnt vmcnt(0)
    v_cmp_ne_u32 s[62:63], 0, v14
    s_nop 3
    s_bitset1_b64 s[62:63], 63
    s_cmp_le_u32 s32, 200000
    s_cbranch_scc1 L_slow_step
    s_mov_b64 s[62:63], -1
    s_branch L_slow_step
L_slow_safe:
    s_nop 11
    s_waitcnt vmcnt(0) lgkmcnt(0)
    ds_read_b128 v[72:75], v6 offset:0
    ds_read_b128 v[88:91], v7 offset:0
    ds_read_b128 v[76:79], v6 offset:64
    ds_read_b128 v[92:95], v7 offset:64
    ds_read_b128 v[80:83], v6 offset:128
    ds_read_b128 v[96:99], v7 offset:128
    ds_read_b128 v[84:87], v6 offset:192
    ds_read_b128 v[100:103], v7 offset:192
    s_xor_b32 s36, s25, 0x1000
    s_add_u32 s36, s36, s23
    buffer_load_dwordx4 v[16:19], v3, s[8:11], s29 offen offset:0 sc1
    buffer_load_dwordx4 v[32:35], v3, s[8:11], s36 offen offset:0 sc1
    buffer_load_dwordx4 v[20:23], v3, s[8:11], s29 offen offset:1024 sc1
    buffer_load_dwordx4 v[36:39], v3, s[8:11], s36 offen offset:1024 sc1
    buffer_load_dwordx4 v[24:27], v3, s[8:11], s29 offen offset:2048 sc1
    buffer_load_dwordx4 v[40:43], v3, s[8:11], s36 offen offset:2048 sc1
    buffer_load_dwordx4 v[28:31], v3, s[8:11], s29 offen offset:3072 sc1
    buffer_load_dwordx4 v[44:47], v3, s[8:11], s36 offen offset:3072 sc1
    s_waitcnt vmcnt(0) lgkmcnt(0)
    v_mfma_f32_16x16x32_bf16 v[48:51], v[16:19], v[72:75], 0
    v_mfma_f32_16x16x32_bf16 v[48:51], v[20:23], v[76:79], v[48:51]
    v_mfma_f32_16x16x32_bf16 v[48:51], v[24:27], v[80:83], v[48:51]
    v_mfma_f32_16x16x32_bf16 v[48:51], v[28:31], v[84:87], v[48:51]
    v_mfma_f32_16x16x32_bf16 v[52:55], v[32:35], v[72:75], 0
    v_mfma_f32_16x16x32_bf16 v[52:55], v[36:39], v[76:79], v[52:55]
    v_mfma_f32_16x16x32_bf16 v[52:55], v[40:43], v[80:83], v[52:55]
    v_mfma_f32_16x16x32_bf16 v[52:55], v[44:47], v[84:87], v[52:55]
    v_mfma_f32_16x16x32_bf16 v[56:59], v[88:91], v[72:75], 0
    v_mfma_f32_16x16x32_bf16 v[56:59], v[92:95], v[76:79], v[56:59]
    v_mfma_f32_16x16x32_bf16 v[56:59], v[96:99], v[80:83], v[56:59]
    v_mfma_f32_16x16x32_bf16 v[56:59], v[100:103], v[84:87], v[56:59]
    s_nop 7
    v_mul_f32 v56, s33, v56
    v_mul_f32 v57, s33, v57
    v_max3_f32 v16, v48, v49, v50
    v_max3_f32 v16, v16, v51, v52
    v_max3_f32 v16, v16, v53, v54
    v_max3_f32 v16, v16, v55, v56
    v_max_f32 v16, v16, v57
    v_mov_b32 v17, v16
    s_nop 1
    v_permlane16_swap_b32 v16, v17
    v_max_f32 v16, v16, v17
    v_mov_b32 v17, v16
    s_nop 1
    v_permlane32_swap_b32 v16, v17
    v_max_f32 v16, v16, v17
    v_sub_f32 v48, v48, v16
    v_exp_f32 v48, v48
    v_sub_f32 v49, v49, v16
    v_exp_f32 v49, v49
    v_sub_f32 v50, v50, v16
    v_exp_f32 v50, v50
    v_sub_f32 v51, v51, v16
    v_exp_f32 v51, v51
    v_sub_f32 v52, v52, v16
    v_exp_f32 v52, v52
    v_sub_f32 v53, v53, v16
    v_exp_f32 v53, v53
    v_sub_f32 v54, v54, v16
    v_exp_f32 v54, v54
    v_sub_f32 v55, v55, v16
    v_exp_f32 v55, v55
    v_sub_f32 v56, v56, v16
    v_exp_f32 v56, v56
    v_sub_f32 v57, v57, v16
    v_exp_f32 v57, v57
    v_cvt_pk_bf16_f32 v108, v48, v49
    v_cvt_pk_bf16_f32 v109, v50, v51
    v_cvt_pk_bf16_f32 v110, v52, v53
    v_cvt_pk_bf16_f32 v111, v54, v55
    v_cvt_pk_bf16_f32 v112, v56, v57
    s_nop 0
    v_mfma_f32_16x16x32_bf16 v[48:51], v[104:107], v[108:111], 0
    v_mfma_f32_16x16x32_bf16 v[56:59], v[120:123], v[108:111], 0
    v_mfma_f32_16x16x32_bf16 v[60:63], v[124:127], v[108:111], 0
    s_nop 3
    v_mfma_f32_16x16x16_bf16 v[48:51], v[104:105], v[112:113], v[48:51]
    v_mfma_f32_16x16x16_bf16 v[56:59], v[114:115], v[112:113], v[56:59]
    v_mfma_f32_16x16x16_bf16 v[60:63], v[116:117], v[112:113], v[60:63]
    s_nop 5
    v_rcp_f32 v118, v48
    s_nop 0
    v_mul_f32 v56, v56, v118
    v_mul_f32 v57, v57, v118
    v_mul_f32 v58, v58, v118
    v_mul_f32 v59, v59, v118
    v_mul_f32 v60, v60, v118
    v_mul_f32 v61, v61, v118
    v_mul_f32 v62, v62, v118
    v_mul_f32 v63, v63, v118
    v_cvt_pk_bf16_f32 v52, v56, v60
    v_cvt_pk_bf16_f32 v53, v57, v61
    v_cvt_pk_bf16_f32 v54, v58, v62
    v_cvt_pk_bf16_f32 v55, v59, v63
    ds_write_b128 v8, v[52:55]
    ds_read_b128 v[88:91], v4 offset:24576
    ds_read_b128 v[92:95], v4 offset:25600
    ds_read_b128 v[96:99], v4 offset:26624
    ds_read_b128 v[100:103], v4 offset:27648
    ds_read_b128 v[72:75], v4 offset:28672
    ds_read_b128 v[76:79], v4 offset:29696
    ds_read_b128 v[80:83], v4 offset:30720
    ds_read_b128 v[84:87], v4 offset:31744
    v_mov_b32 v16, 0
    v_mov_b32 v17, 0
    v_mov_b32 v18, 0
    v_mov_b32 v19, 0
    v_mov_b32 v20, 0
    v_mov_b32 v21, 0
    v_mov_b32 v22, 0
    v_mov_b32 v23, 0
    v_mov_b32 v24, 0
    v_mov_b32 v25, 0
    v_mov_b32 v26, 0
    v_mov_b32 v27, 0
    v_mov_b32 v28, 0
    v_mov_b32 v29, 0
    v_mov_b32 v30, 0
    v_mov_b32 v31, 0
    v_mov_b32 v32, 0
    v_mov_b32 v33, 0
    v_mov_b32 v34, 0
    v_mov_b32 v35, 0
    v_mov_b32 v36, 0
    v_mov_b32 v37, 0
    v_mov_b32 v38, 0
    v_mov_b32 v39, 0
    v_mov_b32 v40, 0
    v_mov_b32 v41, 0
    v_mov_b32 v42, 0
    v_mov_b32 v43, 0
    v_mov_b32 v44, 0
    v_mov_b32 v45, 0
    v_mov_b32 v46, 0
    v_mov_b32 v47, 0
    s_branch L_slow_rejoin
L_slow_done:
    s_branch L_end
L_worker:
    s_mov_b32 s12, s44
    s_and_b32 s13, s45, 0xffff
    s_mov_b32 s14, 0x200000
    s_mov_b32 s15, 0x20000
    s_mov_b32 s60, s82
    s_and_b32 s61, s83, 0xffff
    s_mov_b32 s62, 0x200000
    s_mov_b32 s63, 0x20000
    s_mov_b32 s92, s80
    s_and_b32 s93, s81, 0xffff
    s_mov_b32 s94, 0x400
    s_mov_b32 s95, 0x20000
    s_and_b32 s36, s2, 7
    s_sub_u32 s36, s36, 1
    s_lshl_b32 s36, s36, 5
    s_lshr_b32 s37, s2, 3
    s_add_u32 s36, s36, s37
    s_mul_i32 s20, s36, 9363
    s_lshr_b32 s20, s20, 16
    s_mul_i32 s37, s20, 7
    s_sub_u32 s22, s36, s37
    v_mov_b32 v1, 0x0
    v_bfe_u32 v14, v0, 0, 1
    s_mov_b32 s38, 0x10
    v_mad_u32_u24 v1, v14, s38, v1
    v_bfe_u32 v14, v0, 1, 1
    s_mov_b32 s38, 0x20
    v_mad_u32_u24 v1, v14, s38, v1
    v_bfe_u32 v14, v0, 2, 1
    s_mov_b32 s38, 0x40
    v_mad_u32_u24 v1, v14, s38, v1
    v_bfe_u32 v14, v0, 3, 1
    s_mov_b32 s38, 0x80
    v_mad_u32_u24 v1, v14, s38, v1
    v_bfe_u32 v14, v0, 4, 1
    s_mov_b32 s38, 0x100
    v_mad_u32_u24 v1, v14, s38, v1
    v_bfe_u32 v14, v0, 5, 1
    s_mov_b32 s38, 0x200
    v_mad_u32_u24 v1, v14, s38, v1
    v_mov_b32 v2, 0x0
    v_bfe_u32 v14, v0, 0, 1
    s_mov_b32 s38, 0x10
    v_mad_u32_u24 v2, v14, s38, v2
    v_bfe_u32 v14, v0, 1, 1
    s_mov_b32 s38, 0x20
    v_mad_u32_u24 v2, v14, s38, v2
    v_bfe_u32 v14, v0, 2, 1
    s_mov_b32 s38, 0x40
    v_mad_u32_u24 v2, v14, s38, v2
    v_bfe_u32 v14, v0, 3, 1
    s_mov_b32 s38, 0x80
    v_mad_u32_u24 v2, v14, s38, v2
    v_bfe_u32 v14, v0, 4, 1
    s_mov_b32 s38, 0x100
    v_mad_u32_u24 v2, v14, s38, v2
    v_bfe_u32 v14, v0, 5, 1
    s_mov_b32 s38, 0x200
    v_mad_u32_u24 v2, v14, s38, v2
    v_bfe_u32 v14, v0, 6, 1
    s_mov_b32 s38, 0x800
    v_mad_u32_u24 v2, v14, s38, v2
    v_bfe_u32 v14, v0, 7, 1
    s_mov_b32 s38, 0x1000
    v_mad_u32_u24 v2, v14, s38, v2
    v_mov_b32 v9, 0x0
    v_bfe_u32 v14, v0, 0, 1
    s_mov_b32 s38, 0x10
    v_mad_u32_u24 v9, v14, s38, v9
    v_bfe_u32 v14, v0, 1, 1
    s_mov_b32 s38, 0x20
    v_mad_u32_u24 v9, v14, s38, v9
    v_bfe_u32 v14, v0, 2, 1
    s_mov_b32 s38, 0x40
    v_mad_u32_u24 v9, v14, s38, v9
    v_bfe_u32 v14, v0, 3, 1
    s_mov_b32 s38, 0x80
    v_mad_u32_u24 v9, v14, s38, v9
    v_bfe_u32 v14, v0, 4, 1
    s_mov_b32 s38, 0x100
    v_mad_u32_u24 v9, v14, s38, v9
    v_bfe_u32 v14, v0, 5, 1
    s_mov_b32 s38, 0x200
    v_mad_u32_u24 v9, v14, s38, v9
    v_bfe_u32 v14, v0, 6, 1
    s_mov_b32 s38, 0x400
    v_mad_u32_u24 v9, v14, s38, v9
    v_bfe_u32 v14, v0, 7, 1
    s_mov_b32 s38, 0x800
    v_mad_u32_u24 v9, v14, s38, v9
    v_mov_b32 v7, 0x8000
    v_bfe_u32 v14, v0, 0, 1
    s_mov_b32 s38, 0x10
    v_mad_u32_u24 v7, v14, s38, v7
    v_bfe_u32 v14, v0, 1, 1
    s_mov_b32 s38, 0x20
    v_mad_u32_u24 v7, v14, s38, v7
    v_bfe_u32 v14, v0, 2, 1
    s_mov_b32 s38, 0x40
    v_mad_u32_u24 v7, v14, s38, v7
    v_bfe_u32 v14, v0, 3, 1
    s_mov_b32 s38, 0x80
    v_mad_u32_u24 v7, v14, s38, v7
    v_bfe_u32 v14, v0, 4, 1
    s_mov_b32 s38, 0x100
    v_mad_u32_u24 v7, v14, s38, v7
    v_bfe_u32 v14, v0, 5, 1
    s_mov_b32 s38, 0x200
    v_mad_u32_u24 v7, v14, s38, v7
    v_bfe_u32 v14, v0, 6, 1
    s_mov_b32 s38, 0x8000
    v_mad_u32_u24 v7, v14, s38, v7
    v_bfe_u32 v14, v0, 7, 1
    s_mov_b32 s38, 0x10000
    v_mad_u32_u24 v7, v14, s38, v7
    v_mov_b32 v3, 0x0
    v_bfe_u32 v14, v0, 0, 1
    s_mov_b32 s38, 0x10
    v_mad_u32_u24 v3, v14, s38, v3
    v_bfe_u32 v14, v0, 1, 1
    s_mov_b32 s38, 0x20
    v_mad_u32_u24 v3, v14, s38, v3
    v_bfe_u32 v14, v0, 2, 1
    s_mov_b32 s38, 0x40
    v_mad_u32_u24 v3, v14, s38, v3
    v_bfe_u32 v14, v0, 3, 1
    s_mov_b32 s38, 0x400
    v_mad_u32_u24 v3, v14, s38, v3
    v_bfe_u32 v14, v0, 4, 1
    s_mov_b32 s38, 0x800
    v_mad_u32_u24 v3, v14, s38, v3
    v_bfe_u32 v14, v0, 5, 1
    s_mov_b32 s38, 0x1000
    v_mad_u32_u24 v3, v14, s38, v3
    v_bfe_u32 v14, v0, 6, 1
    s_mov_b32 s38, 0x2000
    v_mad_u32_u24 v3, v14, s38, v3
    v_bfe_u32 v14, v0, 7, 1
    s_mov_b32 s38, 0x4000
    v_mad_u32_u24 v3, v14, s38, v3
    v_mov_b32 v4, 0x0
    v_bfe_u32 v14, v0, 0, 1
    s_mov_b32 s38, 0x100
    v_mad_u32_u24 v4, v14, s38, v4
    v_bfe_u32 v14, v0, 1, 1
    s_mov_b32 s38, 0x200
    v_mad_u32_u24 v4, v14, s38, v4
    v_bfe_u32 v14, v0, 2, 1
    s_mov_b32 s38, 0x400
    v_mad_u32_u24 v4, v14, s38, v4
    v_bfe_u32 v14, v0, 6, 1
    s_mov_b32 s38, 0x80
    v_mad_u32_u24 v4, v14, s38, v4
    v_bfe_u32 v14, v0, 7, 1
    s_mov_b32 s38, 0x4000
    v_mad_u32_u24 v4, v14, s38, v4
    v_lshrrev_b32 v15, 3, v0
    v_xor_b32 v15, v15, v0
    v_and_b32 v15, 7, v15
    v_lshl_add_u32 v4, v15, 4, v4
    v_bfe_u32 v15, v0, 4, 2
    v_lshlrev_b32 v15, 4, v15
    v_xor_b32 v5, v15, v1
    v_xor_b32 v6, 64, v5
    v_mov_b32 v8, 0x5000
    v_bfe_u32 v14, v0, 0, 1
    s_mov_b32 s38, 0x10
    v_mad_u32_u24 v8, v14, s38, v8
    v_bfe_u32 v14, v0, 1, 1
    s_mov_b32 s38, 0x40
    v_mad_u32_u24 v8, v14, s38, v8
    v_bfe_u32 v14, v0, 2, 1
    s_mov_b32 s38, 0x80
    v_mad_u32_u24 v8, v14, s38, v8
    v_bfe_u32 v14, v0, 4, 1
    s_mov_b32 s38, 0x20
    v_mad_u32_u24 v8, v14, s38, v8
    v_bfe_u32 v14, v0, 5, 1
    s_mov_b32 s38, 0x100
    v_mad_u32_u24 v8, v14, s38, v8
    v_mov_b32 v10, 0x0
    v_bfe_u32 v14, v0, 0, 1
    s_mov_b32 s38, 0x10
    v_mad_u32_u24 v10, v14, s38, v10
    v_bfe_u32 v14, v0, 1, 1
    s_mov_b32 s38, 0x20
    v_mad_u32_u24 v10, v14, s38, v10
    v_bfe_u32 v14, v0, 2, 1
    s_mov_b32 s38, 0x40
    v_mad_u32_u24 v10, v14, s38, v10
    v_bfe_u32 v14, v0, 3, 1
    s_mov_b32 s38, 0x80
    v_mad_u32_u24 v10, v14, s38, v10
    v_bfe_u32 v14, v0, 4, 1
    s_mov_b32 s38, 0x20000
    v_mad_u32_u24 v10, v14, s38, v10
    v_bfe_u32 v14, v0, 5, 1
    s_mov_b32 s38, 0x40000
    v_mad_u32_u24 v10, v14, s38, v10
    v_bfe_u32 v14, v0, 6, 1
    s_mov_b32 s38, 0x100
    v_mad_u32_u24 v10, v14, s38, v10
    v_bfe_u32 v14, v0, 7, 1
    s_mov_b32 s38, 0x200
    v_mad_u32_u24 v10, v14, s38, v10
    v_mov_b32 v11, 0x0
    v_bfe_u32 v14, v0, 0, 1
    s_mov_b32 s38, 0x10
    v_mad_u32_u24 v11, v14, s38, v11
    v_bfe_u32 v14, v0, 1, 1
    s_mov_b32 s38, 0x20
    v_mad_u32_u24 v11, v14, s38, v11
    v_bfe_u32 v14, v0, 2, 1
    s_mov_b32 s38, 0x40
    v_mad_u32_u24 v11, v14, s38, v11
    v_bfe_u32 v14, v0, 3, 1
    s_mov_b32 s38, 0x80
    v_mad_u32_u24 v11, v14, s38, v11
    v_bfe_u32 v14, v0, 4, 1
    s_mov_b32 s38, 0x400
    v_mad_u32_u24 v11, v14, s38, v11
    v_bfe_u32 v14, v0, 5, 1
    s_mov_b32 s38, 0x800
    v_mad_u32_u24 v11, v14, s38, v11
    v_bfe_u32 v14, v0, 6, 1
    s_mov_b32 s38, 0x100
    v_mad_u32_u24 v11, v14, s38, v11
    v_bfe_u32 v14, v0, 7, 1
    s_mov_b32 s38, 0x200
    v_mad_u32_u24 v11, v14, s38, v11
    v_mov_b32 v12, 0x0
    v_bfe_u32 v14, v0, 0, 1
    s_mov_b32 s38, 0x10
    v_mad_u32_u24 v12, v14, s38, v12
    v_bfe_u32 v14, v0, 1, 1
    s_mov_b32 s38, 0x20
    v_mad_u32_u24 v12, v14, s38, v12
    v_bfe_u32 v14, v0, 2, 1
    s_mov_b32 s38, 0x40
    v_mad_u32_u24 v12, v14, s38, v12
    v_bfe_u32 v14, v0, 3, 1
    s_mov_b32 s38, 0x80
    v_mad_u32_u24 v12, v14, s38, v12
    v_bfe_u32 v14, v0, 4, 1
    s_mov_b32 s38, 0x4
    v_mad_u32_u24 v12, v14, s38, v12
    v_bfe_u32 v14, v0, 5, 1
    s_mov_b32 s38, 0x8
    v_mad_u32_u24 v12, v14, s38, v12
    v_bfe_u32 v14, v0, 6, 1
    s_mov_b32 s38, 0x100
    v_mad_u32_u24 v12, v14, s38, v12
    v_bfe_u32 v14, v0, 7, 1
    s_mov_b32 s38, 0x200
    v_mad_u32_u24 v12, v14, s38, v12
    v_mov_b32 v13, 0xf149f2ca
    v_and_b32 v14, 15, v0
    v_bfe_u32 v15, v0, 4, 2
    v_cmp_gt_u32 s[72:73], 2, v15
    v_lshlrev_b32 v15, 2, v15
    v_cmp_le_u32 s[64:65], v15, v14
    v_add_u32 v15, 1, v15
    v_cmp_le_u32 s[66:67], v15, v14
    v_add_u32 v15, 1, v15
    v_cmp_le_u32 s[68:69], v15, v14
    v_add_u32 v15, 1, v15
    v_cmp_le_u32 s[70:71], v15, v14
    v_add_u32 v15, 1, v15
    s_mov_b32 s34, 0x05040100
    s_mov_b32 s35, 0x07060302
    s_mov_b32 s33, 0x3e0293ee
    s_mov_b32 s32, 0
    s_mov_b32 s4, 0x3f803f80
    s_mov_b32 s5, 0x3f803f80
    v_mov_b32 v15, 0x0
    v_bfe_u32 v14, v0, 0, 1
    s_mov_b32 s38, 0x4
    v_mad_u32_u24 v15, v14, s38, v15
    v_bfe_u32 v14, v0, 1, 1
    s_mov_b32 s38, 0x8
    v_mad_u32_u24 v15, v14, s38, v15
    v_bfe_u32 v14, v0, 2, 1
    s_mov_b32 s38, 0x10
    v_mad_u32_u24 v15, v14, s38, v15
    v_bfe_u32 v14, v0, 3, 1
    s_mov_b32 s38, 0x20
    v_mad_u32_u24 v15, v14, s38, v15
    v_bfe_u32 v14, v0, 4, 1
    s_mov_b32 s38, 0x10000
    v_mad_u32_u24 v15, v14, s38, v15
    v_bfe_u32 v14, v0, 5, 1
    s_mov_b32 s38, 0x20000
    v_mad_u32_u24 v15, v14, s38, v15
    v_bfe_u32 v14, v0, 6, 1
    s_mov_b32 s38, 0x40
    v_mad_u32_u24 v15, v14, s38, v15
    v_bfe_u32 v14, v0, 7, 1
    s_mov_b32 s38, 0x80
    v_mad_u32_u24 v15, v14, s38, v15
    s_mov_b32 s96, s50
    s_and_b32 s97, s51, 0xffff
    s_mov_b32 s98, 0x400000
    s_mov_b32 s99, 0x20000
    s_mov_b32 s76, s52
    s_and_b32 s77, s53, 0xffff
    s_mov_b32 s78, 0x400000
    s_mov_b32 s79, 0x20000
    s_lshl_b32 s36, s20, 8
    s_add_u32 s37, s36, 0x0
    buffer_load_dword v16, v15, s[96:99], s37 offen
    s_add_u32 s37, s36, 0x2000
    buffer_load_dword v17, v15, s[96:99], s37 offen
    s_add_u32 s37, s36, 0x4000
    buffer_load_dword v18, v15, s[96:99], s37 offen
    s_add_u32 s37, s36, 0x6000
    buffer_load_dword v19, v15, s[96:99], s37 offen
    s_add_u32 s37, s36, 0x8000
    buffer_load_dword v20, v15, s[96:99], s37 offen
    s_add_u32 s37, s36, 0xa000
    buffer_load_dword v21, v15, s[96:99], s37 offen
    s_add_u32 s37, s36, 0xc000
    buffer_load_dword v22, v15, s[96:99], s37 offen
    s_add_u32 s37, s36, 0xe000
    buffer_load_dword v23, v15, s[96:99], s37 offen
    s_add_u32 s37, s36, 0x40000
    buffer_load_dword v24, v15, s[96:99], s37 offen
    s_add_u32 s37, s36, 0x42000
    buffer_load_dword v25, v15, s[96:99], s37 offen
    s_add_u32 s37, s36, 0x44000
    buffer_load_dword v26, v15, s[96:99], s37 offen
    s_add_u32 s37, s36, 0x46000
    buffer_load_dword v27, v15, s[96:99], s37 offen
    s_add_u32 s37, s36, 0x48000
    buffer_load_dword v28, v15, s[96:99], s37 offen
    s_add_u32 s37, s36, 0x4a000
    buffer_load_dword v29, v15, s[96:99], s37 offen
    s_add_u32 s37, s36, 0x4c000
    buffer_load_dword v30, v15, s[96:99], s37 offen
    s_add_u32 s37, s36, 0x4e000
    buffer_load_dword v31, v15, s[96:99], s37 offen
    s_add_u32 s37, s36, 0x0
    buffer_load_dword v32, v15, s[76:79], s37 offen
    s_add_u32 s37, s36, 0x2000
    buffer_load_dword v33, v15, s[76:79], s37 offen
    s_add_u32 s37, s36, 0x4000
    buffer_load_dword v34, v15, s[76:79], s37 offen
    s_add_u32 s37, s36, 0x6000
    buffer_load_dword v35, v15, s[76:79], s37 offen
    s_add_u32 s37, s36, 0x8000
    buffer_load_dword v36, v15, s[76:79], s37 offen
    s_add_u32 s37, s36, 0xa000
    buffer_load_dword v37, v15, s[76:79], s37 offen
    s_add_u32 s37, s36, 0xc000
    buffer_load_dword v38, v15, s[76:79], s37 offen
    s_add_u32 s37, s36, 0xe000
    buffer_load_dword v39, v15, s[76:79], s37 offen
    s_add_u32 s37, s36, 0x40000
    buffer_load_dword v40, v15, s[76:79], s37 offen
    s_add_u32 s37, s36, 0x42000
    buffer_load_dword v41, v15, s[76:79], s37 offen
    s_add_u32 s37, s36, 0x44000
    buffer_load_dword v42, v15, s[76:79], s37 offen
    s_add_u32 s37, s36, 0x46000
    buffer_load_dword v43, v15, s[76:79], s37 offen
    s_add_u32 s37, s36, 0x48000
    buffer_load_dword v44, v15, s[76:79], s37 offen
    s_add_u32 s37, s36, 0x4a000
    buffer_load_dword v45, v15, s[76:79], s37 offen
    s_add_u32 s37, s36, 0x4c000
    buffer_load_dword v46, v15, s[76:79], s37 offen
    s_add_u32 s37, s36, 0x4e000
    buffer_load_dword v47, v15, s[76:79], s37 offen
    s_add_u32 s37, s36, 0x80000
    buffer_load_dword v48, v15, s[96:99], s37 offen
    s_add_u32 s37, s36, 0x82000
    buffer_load_dword v49, v15, s[96:99], s37 offen
    s_add_u32 s37, s36, 0x84000
    buffer_load_dword v50, v15, s[96:99], s37 offen
    s_add_u32 s37, s36, 0x86000
    buffer_load_dword v51, v15, s[96:99], s37 offen
    s_add_u32 s37, s36, 0x88000
    buffer_load_dword v52, v15, s[96:99], s37 offen
    s_add_u32 s37, s36, 0x8a000
    buffer_load_dword v53, v15, s[96:99], s37 offen
    s_add_u32 s37, s36, 0x8c000
    buffer_load_dword v54, v15, s[96:99], s37 offen
    s_add_u32 s37, s36, 0x8e000
    buffer_load_dword v55, v15, s[96:99], s37 offen
    s_add_u32 s37, s36, 0xc0000
    buffer_load_dword v56, v15, s[96:99], s37 offen
    s_add_u32 s37, s36, 0xc2000
    buffer_load_dword v57, v15, s[96:99], s37 offen
    s_add_u32 s37, s36, 0xc4000
    buffer_load_dword v58, v15, s[96:99], s37 offen
    s_add_u32 s37, s36, 0xc6000
    buffer_load_dword v59, v15, s[96:99], s37 offen
    s_add_u32 s37, s36, 0xc8000
    buffer_load_dword v60, v15, s[96:99], s37 offen
    s_add_u32 s37, s36, 0xca000
    buffer_load_dword v61, v15, s[96:99], s37 offen
    s_add_u32 s37, s36, 0xcc000
    buffer_load_dword v62, v15, s[96:99], s37 offen
    s_add_u32 s37, s36, 0xce000
    buffer_load_dword v63, v15, s[96:99], s37 offen
    s_waitcnt vmcnt(32)
    s_add_u32 s37, s36, 0x80000
    buffer_load_dword v64, v15, s[76:79], s37 offen
    s_add_u32 s37, s36, 0x82000
    buffer_load_dword v65, v15, s[76:79], s37 offen
    s_add_u32 s37, s36, 0x84000
    buffer_load_dword v66, v15, s[76:79], s37 offen
    s_add_u32 s37, s36, 0x86000
    buffer_load_dword v67, v15, s[76:79], s37 offen
    s_add_u32 s37, s36, 0x88000
    buffer_load_dword v68, v15, s[76:79], s37 offen
    s_add_u32 s37, s36, 0x8a000
    buffer_load_dword v69, v15, s[76:79], s37 offen
    s_add_u32 s37, s36, 0x8c000
    buffer_load_dword v70, v15, s[76:79], s37 offen
    s_add_u32 s37, s36, 0x8e000
    buffer_load_dword v71, v15, s[76:79], s37 offen
    s_add_u32 s37, s36, 0xc0000
    buffer_load_dword v72, v15, s[76:79], s37 offen
    s_add_u32 s37, s36, 0xc2000
    buffer_load_dword v73, v15, s[76:79], s37 offen
    s_add_u32 s37, s36, 0xc4000
    buffer_load_dword v74, v15, s[76:79], s37 offen
    s_add_u32 s37, s36, 0xc6000
    buffer_load_dword v75, v15, s[76:79], s37 offen
    s_add_u32 s37, s36, 0xc8000
    buffer_load_dword v76, v15, s[76:79], s37 offen
    s_add_u32 s37, s36, 0xca000
    buffer_load_dword v77, v15, s[76:79], s37 offen
    s_add_u32 s37, s36, 0xcc000
    buffer_load_dword v78, v15, s[76:79], s37 offen
    s_add_u32 s37, s36, 0xce000
    buffer_load_dword v79, v15, s[76:79], s37 offen
    v_perm_b32 v120, v17, v16, s34
    v_accvgpr_write_b32 a128, v120
    v_perm_b32 v121, v19, v18, s34
    v_accvgpr_write_b32 a129, v121
    v_perm_b32 v122, v21, v20, s34
    v_accvgpr_write_b32 a130, v122
    v_perm_b32 v123, v23, v22, s34
    v_accvgpr_write_b32 a131, v123
    v_perm_b32 v120, v17, v16, s35
    v_accvgpr_write_b32 a132, v120
    v_perm_b32 v121, v19, v18, s35
    v_accvgpr_write_b32 a133, v121
    v_perm_b32 v122, v21, v20, s35
    v_accvgpr_write_b32 a134, v122
    v_perm_b32 v123, v23, v22, s35
    v_accvgpr_write_b32 a135, v123
    v_perm_b32 v120, v25, v24, s34
    v_accvgpr_write_b32 a136, v120
    v_perm_b32 v121, v27, v26, s34
    v_accvgpr_write_b32 a137, v121
    v_perm_b32 v122, v29, v28, s34
    v_accvgpr_write_b32 a138, v122
    v_perm_b32 v123, v31, v30, s34
    v_accvgpr_write_b32 a139, v123
    v_perm_b32 v120, v25, v24, s35
    v_accvgpr_write_b32 a140, v120
    v_perm_b32 v121, v27, v26, s35
    v_accvgpr_write_b32 a141, v121
    v_perm_b32 v122, v29, v28, s35
    v_accvgpr_write_b32 a142, v122
    v_perm_b32 v123, v31, v30, s35
    v_accvgpr_write_b32 a143, v123
    s_waitcnt vmcnt(32)
    s_add_u32 s37, s36, 0x100000
    buffer_load_dword v16, v15, s[96:99], s37 offen
    s_add_u32 s37, s36, 0x102000
    buffer_load_dword v17, v15, s[96:99], s37 offen
    s_add_u32 s37, s36, 0x104000
    buffer_load_dword v18, v15, s[96:99], s37 offen
    s_add_u32 s37, s36, 0x106000
    buffer_load_dword v19, v15, s[96:99], s37 offen
    s_add_u32 s37, s36, 0x108000
    buffer_load_dword v20, v15, s[96:99], s37 offen
    s_add_u32 s37, s36, 0x10a000
    buffer_load_dword v21, v15, s[96:99], s37 offen
    s_add_u32 s37, s36, 0x10c000
    buffer_load_dword v22, v15, s[96:99], s37 offen
    s_add_u32 s37, s36, 0x10e000
    buffer_load_dword v23, v15, s[96:99], s37 offen
    s_add_u32 s37, s36, 0x140000
    buffer_load_dword v24, v15, s[96:99], s37 offen
    s_add_u32 s37, s36, 0x142000
    buffer_load_dword v25, v15, s[96:99], s37 offen
    s_add_u32 s37, s36, 0x144000
    buffer_load_dword v26, v15, s[96:99], s37 offen
    s_add_u32 s37, s36, 0x146000
    buffer_load_dword v27, v15, s[96:99], s37 offen
    s_add_u32 s37, s36, 0x148000
    buffer_load_dword v28, v15, s[96:99], s37 offen
    s_add_u32 s37, s36, 0x14a000
    buffer_load_dword v29, v15, s[96:99], s37 offen
    s_add_u32 s37, s36, 0x14c000
    buffer_load_dword v30, v15, s[96:99], s37 offen
    s_add_u32 s37, s36, 0x14e000
    buffer_load_dword v31, v15, s[96:99], s37 offen
    v_perm_b32 v128, v33, v32, s34
    v_perm_b32 v129, v35, v34, s34
    v_perm_b32 v130, v37, v36, s34
    v_perm_b32 v131, v39, v38, s34
    v_perm_b32 v132, v33, v32, s35
    v_perm_b32 v133, v35, v34, s35
    v_perm_b32 v134, v37, v36, s35
    v_perm_b32 v135, v39, v38, s35
    v_perm_b32 v136, v41, v40, s34
    v_perm_b32 v137, v43, v42, s34
    v_perm_b32 v138, v45, v44, s34
    v_perm_b32 v139, v47, v46, s34
    v_perm_b32 v140, v41, v40, s35
    v_perm_b32 v141, v43, v42, s35
    v_perm_b32 v142, v45, v44, s35
    v_perm_b32 v143, v47, v46, s35
    s_waitcnt vmcnt(32)
    s_add_u32 s37, s36, 0x100000
    buffer_load_dword v32, v15, s[76:79], s37 offen
    s_add_u32 s37, s36, 0x102000
    buffer_load_dword v33, v15, s[76:79], s37 offen
    s_add_u32 s37, s36, 0x104000
    buffer_load_dword v34, v15, s[76:79], s37 offen
    s_add_u32 s37, s36, 0x106000
    buffer_load_dword v35, v15, s[76:79], s37 offen
    s_add_u32 s37, s36, 0x108000
    buffer_load_dword v36, v15, s[76:79], s37 offen
    s_add_u32 s37, s36, 0x10a000
    buffer_load_dword v37, v15, s[76:79], s37 offen
    s_add_u32 s37, s36, 0x10c000
    buffer_load_dword v38, v15, s[76:79], s37 offen
    s_add_u32 s37, s36, 0x10e000
    buffer_load_dword v39, v15, s[76:79], s37 offen
    s_add_u32 s37, s36, 0x140000
    buffer_load_dword v40, v15, s[76:79], s37 offen
    s_add_u32 s37, s36, 0x142000
    buffer_load_dword v41, v15, s[76:79], s37 offen
    s_add_u32 s37, s36, 0x144000
    buffer_load_dword v42, v15, s[76:79], s37 offen
    s_add_u32 s37, s36, 0x146000
    buffer_load_dword v43, v15, s[76:79], s37 offen
    s_add_u32 s37, s36, 0x148000
    buffer_load_dword v44, v15, s[76:79], s37 offen
    s_add_u32 s37, s36, 0x14a000
    buffer_load_dword v45, v15, s[76:79], s37 offen
    s_add_u32 s37, s36, 0x14c000
    buffer_load_dword v46, v15, s[76:79], s37 offen
    s_add_u32 s37, s36, 0x14e000
    buffer_load_dword v47, v15, s[76:79], s37 offen
    v_perm_b32 v120, v49, v48, s34
    v_accvgpr_write_b32 a144, v120
    v_perm_b32 v121, v51, v50, s34
    v_accvgpr_write_b32 a145, v121
    v_perm_b32 v122, v53, v52, s34
    v_accvgpr_write_b32 a146, v122
    v_perm_b32 v123, v55, v54, s34
    v_accvgpr_write_b32 a147, v123
    v_perm_b32 v120, v49, v48, s35
    v_accvgpr_write_b32 a148, v120
    v_perm_b32 v121, v51, v50, s35
    v_accvgpr_write_b32 a149, v121
    v_perm_b32 v122, v53, v52, s35
    v_accvgpr_write_b32 a150, v122
    v_perm_b32 v123, v55, v54, s35
    v_accvgpr_write_b32 a151, v123
    v_perm_b32 v120, v57, v56, s34
    v_accvgpr_write_b32 a152, v120
    v_perm_b32 v121, v59, v58, s34
    v_accvgpr_write_b32 a153, v121
    v_perm_b32 v122, v61, v60, s34
    v_accvgpr_write_b32 a154, v122
    v_perm_b32 v123, v63, v62, s34
    v_accvgpr_write_b32 a155, v123
    v_perm_b32 v120, v57, v56, s35
    v_accvgpr_write_b32 a156, v120
    v_perm_b32 v121, v59, v58, s35
    v_accvgpr_write_b32 a157, v121
    v_perm_b32 v122, v61, v60, s35
    v_accvgpr_write_b32 a158, v122
    v_perm_b32 v123, v63, v62, s35
    v_accvgpr_write_b32 a159, v123
    s_waitcnt vmcnt(32)
    s_add_u32 s37, s36, 0x180000
    buffer_load_dword v48, v15, s[96:99], s37 offen
    s_add_u32 s37, s36, 0x182000
    buffer_load_dword v49, v15, s[96:99], s37 offen
    s_add_u32 s37, s36, 0x184000
    buffer_load_dword v50, v15, s[96:99], s37 offen
    s_add_u32 s37, s36, 0x186000
    buffer_load_dword v51, v15, s[96:99], s37 offen
    s_add_u32 s37, s36, 0x188000
    buffer_load_dword v52, v15, s[96:99], s37 offen
    s_add_u32 s37, s36, 0x18a000
    buffer_load_dword v53, v15, s[96:99], s37 offen
    s_add_u32 s37, s36, 0x18c000
    buffer_load_dword v54, v15, s[96:99], s37 offen
    s_add_u32 s37, s36, 0x18e000
    buffer_load_dword v55, v15, s[96:99], s37 offen
    s_add_u32 s37, s36, 0x1c0000
    buffer_load_dword v56, v15, s[96:99], s37 offen
    s_add_u32 s37, s36, 0x1c2000
    buffer_load_dword v57, v15, s[96:99], s37 offen
    s_add_u32 s37, s36, 0x1c4000
    buffer_load_dword v58, v15, s[96:99], s37 offen
    s_add_u32 s37, s36, 0x1c6000
    buffer_load_dword v59, v15, s[96:99], s37 offen
    s_add_u32 s37, s36, 0x1c8000
    buffer_load_dword v60, v15, s[96:99], s37 offen
    s_add_u32 s37, s36, 0x1ca000
    buffer_load_dword v61, v15, s[96:99], s37 offen
    s_add_u32 s37, s36, 0x1cc000
    buffer_load_dword v62, v15, s[96:99], s37 offen
    s_add_u32 s37, s36, 0x1ce000
    buffer_load_dword v63, v15, s[96:99], s37 offen
    v_perm_b32 v144, v65, v64, s34
    v_perm_b32 v145, v67, v66, s34
    v_perm_b32 v146, v69, v68, s34
    v_perm_b32 v147, v71, v70, s34
    v_perm_b32 v148, v65, v64, s35
    v_perm_b32 v149, v67, v66, s35
    v_perm_b32 v150, v69, v68, s35
    v_perm_b32 v151, v71, v70, s35
    v_perm_b32 v152, v73, v72, s34
    v_perm_b32 v153, v75, v74, s34
    v_perm_b32 v154, v77, v76, s34
    v_perm_b32 v155, v79, v78, s34
    v_perm_b32 v156, v73, v72, s35
    v_perm_b32 v157, v75, v74, s35
    v_perm_b32 v158, v77, v76, s35
    v_perm_b32 v159, v79, v78, s35
    s_waitcnt vmcnt(32)
    s_add_u32 s37, s36, 0x180000
    buffer_load_dword v64, v15, s[76:79], s37 offen
    s_add_u32 s37, s36, 0x182000
    buffer_load_dword v65, v15, s[76:79], s37 offen
    s_add_u32 s37, s36, 0x184000
    buffer_load_dword v66, v15, s[76:79], s37 offen
    s_add_u32 s37, s36, 0x186000
    buffer_load_dword v67, v15, s[76:79], s37 offen
    s_add_u32 s37, s36, 0x188000
    buffer_load_dword v68, v15, s[76:79], s37 offen
    s_add_u32 s37, s36, 0x18a000
    buffer_load_dword v69, v15, s[76:79], s37 offen
    s_add_u32 s37, s36, 0x18c000
    buffer_load_dword v70, v15, s[76:79], s37 offen
    s_add_u32 s37, s36, 0x18e000
    buffer_load_dword v71, v15, s[76:79], s37 offen
    s_add_u32 s37, s36, 0x1c0000
    buffer_load_dword v72, v15, s[76:79], s37 offen
    s_add_u32 s37, s36, 0x1c2000
    buffer_load_dword v73, v15, s[76:79], s37 offen
    s_add_u32 s37, s36, 0x1c4000
    buffer_load_dword v74, v15, s[76:79], s37 offen
    s_add_u32 s37, s36, 0x1c6000
    buffer_load_dword v75, v15, s[76:79], s37 offen
    s_add_u32 s37, s36, 0x1c8000
    buffer_load_dword v76, v15, s[76:79], s37 offen
    s_add_u32 s37, s36, 0x1ca000
    buffer_load_dword v77, v15, s[76:79], s37 offen
    s_add_u32 s37, s36, 0x1cc000
    buffer_load_dword v78, v15, s[76:79], s37 offen
    s_add_u32 s37, s36, 0x1ce000
    buffer_load_dword v79, v15, s[76:79], s37 offen
    v_perm_b32 v120, v17, v16, s34
    v_accvgpr_write_b32 a160, v120
    v_perm_b32 v121, v19, v18, s34
    v_accvgpr_write_b32 a161, v121
    v_perm_b32 v122, v21, v20, s34
    v_accvgpr_write_b32 a162, v122
    v_perm_b32 v123, v23, v22, s34
    v_accvgpr_write_b32 a163, v123
    v_perm_b32 v120, v17, v16, s35
    v_accvgpr_write_b32 a164, v120
    v_perm_b32 v121, v19, v18, s35
    v_accvgpr_write_b32 a165, v121
    v_perm_b32 v122, v21, v20, s35
    v_accvgpr_write_b32 a166, v122
    v_perm_b32 v123, v23, v22, s35
    v_accvgpr_write_b32 a167, v123
    v_perm_b32 v120, v25, v24, s34
    v_accvgpr_write_b32 a168, v120
    v_perm_b32 v121, v27, v26, s34
    v_accvgpr_write_b32 a169, v121
    v_perm_b32 v122, v29, v28, s34
    v_accvgpr_write_b32 a170, v122
    v_perm_b32 v123, v31, v30, s34
    v_accvgpr_write_b32 a171, v123
    v_perm_b32 v120, v25, v24, s35
    v_accvgpr_write_b32 a172, v120
    v_perm_b32 v121, v27, v26, s35
    v_accvgpr_write_b32 a173, v121
    v_perm_b32 v122, v29, v28, s35
    v_accvgpr_write_b32 a174, v122
    v_perm_b32 v123, v31, v30, s35
    v_accvgpr_write_b32 a175, v123
    s_waitcnt vmcnt(32)
    s_add_u32 s37, s36, 0x200000
    buffer_load_dword v16, v15, s[96:99], s37 offen
    s_add_u32 s37, s36, 0x202000
    buffer_load_dword v17, v15, s[96:99], s37 offen
    s_add_u32 s37, s36, 0x204000
    buffer_load_dword v18, v15, s[96:99], s37 offen
    s_add_u32 s37, s36, 0x206000
    buffer_load_dword v19, v15, s[96:99], s37 offen
    s_add_u32 s37, s36, 0x208000
    buffer_load_dword v20, v15, s[96:99], s37 offen
    s_add_u32 s37, s36, 0x20a000
    buffer_load_dword v21, v15, s[96:99], s37 offen
    s_add_u32 s37, s36, 0x20c000
    buffer_load_dword v22, v15, s[96:99], s37 offen
    s_add_u32 s37, s36, 0x20e000
    buffer_load_dword v23, v15, s[96:99], s37 offen
    s_add_u32 s37, s36, 0x240000
    buffer_load_dword v24, v15, s[96:99], s37 offen
    s_add_u32 s37, s36, 0x242000
    buffer_load_dword v25, v15, s[96:99], s37 offen
    s_add_u32 s37, s36, 0x244000
    buffer_load_dword v26, v15, s[96:99], s37 offen
    s_add_u32 s37, s36, 0x246000
    buffer_load_dword v27, v15, s[96:99], s37 offen
    s_add_u32 s37, s36, 0x248000
    buffer_load_dword v28, v15, s[96:99], s37 offen
    s_add_u32 s37, s36, 0x24a000
    buffer_load_dword v29, v15, s[96:99], s37 offen
    s_add_u32 s37, s36, 0x24c000
    buffer_load_dword v30, v15, s[96:99], s37 offen
    s_add_u32 s37, s36, 0x24e000
    buffer_load_dword v31, v15, s[96:99], s37 offen
    v_perm_b32 v160, v33, v32, s34
    v_perm_b32 v161, v35, v34, s34
    v_perm_b32 v162, v37, v36, s34
    v_perm_b32 v163, v39, v38, s34
    v_perm_b32 v164, v33, v32, s35
    v_perm_b32 v165, v35, v34, s35
    v_perm_b32 v166, v37, v36, s35
    v_perm_b32 v167, v39, v38, s35
    v_perm_b32 v168, v41, v40, s34
    v_perm_b32 v169, v43, v42, s34
    v_perm_b32 v170, v45, v44, s34
    v_perm_b32 v171, v47, v46, s34
    v_perm_b32 v172, v41, v40, s35
    v_perm_b32 v173, v43, v42, s35
    v_perm_b32 v174, v45, v44, s35
    v_perm_b32 v175, v47, v46, s35
    s_waitcnt vmcnt(32)
    s_add_u32 s37, s36, 0x200000
    buffer_load_dword v32, v15, s[76:79], s37 offen
    s_add_u32 s37, s36, 0x202000
    buffer_load_dword v33, v15, s[76:79], s37 offen
    s_add_u32 s37, s36, 0x204000
    buffer_load_dword v34, v15, s[76:79], s37 offen
    s_add_u32 s37, s36, 0x206000
    buffer_load_dword v35, v15, s[76:79], s37 offen
    s_add_u32 s37, s36, 0x208000
    buffer_load_dword v36, v15, s[76:79], s37 offen
    s_add_u32 s37, s36, 0x20a000
    buffer_load_dword v37, v15, s[76:79], s37 offen
    s_add_u32 s37, s36, 0x20c000
    buffer_load_dword v38, v15, s[76:79], s37 offen
    s_add_u32 s37, s36, 0x20e000
    buffer_load_dword v39, v15, s[76:79], s37 offen
    s_add_u32 s37, s36, 0x240000
    buffer_load_dword v40, v15, s[76:79], s37 offen
    s_add_u32 s37, s36, 0x242000
    buffer_load_dword v41, v15, s[76:79], s37 offen
    s_add_u32 s37, s36, 0x244000
    buffer_load_dword v42, v15, s[76:79], s37 offen
    s_add_u32 s37, s36, 0x246000
    buffer_load_dword v43, v15, s[76:79], s37 offen
    s_add_u32 s37, s36, 0x248000
    buffer_load_dword v44, v15, s[76:79], s37 offen
    s_add_u32 s37, s36, 0x24a000
    buffer_load_dword v45, v15, s[76:79], s37 offen
    s_add_u32 s37, s36, 0x24c000
    buffer_load_dword v46, v15, s[76:79], s37 offen
    s_add_u32 s37, s36, 0x24e000
    buffer_load_dword v47, v15, s[76:79], s37 offen
    v_perm_b32 v120, v49, v48, s34
    v_accvgpr_write_b32 a176, v120
    v_perm_b32 v121, v51, v50, s34
    v_accvgpr_write_b32 a177, v121
    v_perm_b32 v122, v53, v52, s34
    v_accvgpr_write_b32 a178, v122
    v_perm_b32 v123, v55, v54, s34
    v_accvgpr_write_b32 a179, v123
    v_perm_b32 v120, v49, v48, s35
    v_accvgpr_write_b32 a180, v120
    v_perm_b32 v121, v51, v50, s35
    v_accvgpr_write_b32 a181, v121
    v_perm_b32 v122, v53, v52, s35
    v_accvgpr_write_b32 a182, v122
    v_perm_b32 v123, v55, v54, s35
    v_accvgpr_write_b32 a183, v123
    v_perm_b32 v120, v57, v56, s34
    v_accvgpr_write_b32 a184, v120
    v_perm_b32 v121, v59, v58, s34
    v_accvgpr_write_b32 a185, v121
    v_perm_b32 v122, v61, v60, s34
    v_accvgpr_write_b32 a186, v122
    v_perm_b32 v123, v63, v62, s34
    v_accvgpr_write_b32 a187, v123
    v_perm_b32 v120, v57, v56, s35
    v_accvgpr_write_b32 a188, v120
    v_perm_b32 v121, v59, v58, s35
    v_accvgpr_write_b32 a189, v121
    v_perm_b32 v122, v61, v60, s35
    v_accvgpr_write_b32 a190, v122
    v_perm_b32 v123, v63, v62, s35
    v_accvgpr_write_b32 a191, v123
    s_waitcnt vmcnt(32)
    s_add_u32 s37, s36, 0x280000
    buffer_load_dword v48, v15, s[96:99], s37 offen
    s_add_u32 s37, s36, 0x282000
    buffer_load_dword v49, v15, s[96:99], s37 offen
    s_add_u32 s37, s36, 0x284000
    buffer_load_dword v50, v15, s[96:99], s37 offen
    s_add_u32 s37, s36, 0x286000
    buffer_load_dword v51, v15, s[96:99], s37 offen
    s_add_u32 s37, s36, 0x288000
    buffer_load_dword v52, v15, s[96:99], s37 offen
    s_add_u32 s37, s36, 0x28a000
    buffer_load_dword v53, v15, s[96:99], s37 offen
    s_add_u32 s37, s36, 0x28c000
    buffer_load_dword v54, v15, s[96:99], s37 offen
    s_add_u32 s37, s36, 0x28e000
    buffer_load_dword v55, v15, s[96:99], s37 offen
    s_add_u32 s37, s36, 0x2c0000
    buffer_load_dword v56, v15, s[96:99], s37 offen
    s_add_u32 s37, s36, 0x2c2000
    buffer_load_dword v57, v15, s[96:99], s37 offen
    s_add_u32 s37, s36, 0x2c4000
    buffer_load_dword v58, v15, s[96:99], s37 offen
    s_add_u32 s37, s36, 0x2c6000
    buffer_load_dword v59, v15, s[96:99], s37 offen
    s_add_u32 s37, s36, 0x2c8000
    buffer_load_dword v60, v15, s[96:99], s37 offen
    s_add_u32 s37, s36, 0x2ca000
    buffer_load_dword v61, v15, s[96:99], s37 offen
    s_add_u32 s37, s36, 0x2cc000
    buffer_load_dword v62, v15, s[96:99], s37 offen
    s_add_u32 s37, s36, 0x2ce000
    buffer_load_dword v63, v15, s[96:99], s37 offen
    v_perm_b32 v176, v65, v64, s34
    v_perm_b32 v177, v67, v66, s34
    v_perm_b32 v178, v69, v68, s34
    v_perm_b32 v179, v71, v70, s34
    v_perm_b32 v180, v65, v64, s35
    v_perm_b32 v181, v67, v66, s35
    v_perm_b32 v182, v69, v68, s35
    v_perm_b32 v183, v71, v70, s35
    v_perm_b32 v184, v73, v72, s34
    v_perm_b32 v185, v75, v74, s34
    v_perm_b32 v186, v77, v76, s34
    v_perm_b32 v187, v79, v78, s34
    v_perm_b32 v188, v73, v72, s35
    v_perm_b32 v189, v75, v74, s35
    v_perm_b32 v190, v77, v76, s35
    v_perm_b32 v191, v79, v78, s35
    s_waitcnt vmcnt(32)
    s_add_u32 s37, s36, 0x280000
    buffer_load_dword v64, v15, s[76:79], s37 offen
    s_add_u32 s37, s36, 0x282000
    buffer_load_dword v65, v15, s[76:79], s37 offen
    s_add_u32 s37, s36, 0x284000
    buffer_load_dword v66, v15, s[76:79], s37 offen
    s_add_u32 s37, s36, 0x286000
    buffer_load_dword v67, v15, s[76:79], s37 offen
    s_add_u32 s37, s36, 0x288000
    buffer_load_dword v68, v15, s[76:79], s37 offen
    s_add_u32 s37, s36, 0x28a000
    buffer_load_dword v69, v15, s[76:79], s37 offen
    s_add_u32 s37, s36, 0x28c000
    buffer_load_dword v70, v15, s[76:79], s37 offen
    s_add_u32 s37, s36, 0x28e000
    buffer_load_dword v71, v15, s[76:79], s37 offen
    s_add_u32 s37, s36, 0x2c0000
    buffer_load_dword v72, v15, s[76:79], s37 offen
    s_add_u32 s37, s36, 0x2c2000
    buffer_load_dword v73, v15, s[76:79], s37 offen
    s_add_u32 s37, s36, 0x2c4000
    buffer_load_dword v74, v15, s[76:79], s37 offen
    s_add_u32 s37, s36, 0x2c6000
    buffer_load_dword v75, v15, s[76:79], s37 offen
    s_add_u32 s37, s36, 0x2c8000
    buffer_load_dword v76, v15, s[76:79], s37 offen
    s_add_u32 s37, s36, 0x2ca000
    buffer_load_dword v77, v15, s[76:79], s37 offen
    s_add_u32 s37, s36, 0x2cc000
    buffer_load_dword v78, v15, s[76:79], s37 offen
    s_add_u32 s37, s36, 0x2ce000
    buffer_load_dword v79, v15, s[76:79], s37 offen
    v_perm_b32 v120, v17, v16, s34
    v_accvgpr_write_b32 a192, v120
    v_perm_b32 v121, v19, v18, s34
    v_accvgpr_write_b32 a193, v121
    v_perm_b32 v122, v21, v20, s34
    v_accvgpr_write_b32 a194, v122
    v_perm_b32 v123, v23, v22, s34
    v_accvgpr_write_b32 a195, v123
    v_perm_b32 v120, v17, v16, s35
    v_accvgpr_write_b32 a196, v120
    v_perm_b32 v121, v19, v18, s35
    v_accvgpr_write_b32 a197, v121
    v_perm_b32 v122, v21, v20, s35
    v_accvgpr_write_b32 a198, v122
    v_perm_b32 v123, v23, v22, s35
    v_accvgpr_write_b32 a199, v123
    v_perm_b32 v120, v25, v24, s34
    v_accvgpr_write_b32 a200, v120
    v_perm_b32 v121, v27, v26, s34
    v_accvgpr_write_b32 a201, v121
    v_perm_b32 v122, v29, v28, s34
    v_accvgpr_write_b32 a202, v122
    v_perm_b32 v123, v31, v30, s34
    v_accvgpr_write_b32 a203, v123
    v_perm_b32 v120, v25, v24, s35
    v_accvgpr_write_b32 a204, v120
    v_perm_b32 v121, v27, v26, s35
    v_accvgpr_write_b32 a205, v121
    v_perm_b32 v122, v29, v28, s35
    v_accvgpr_write_b32 a206, v122
    v_perm_b32 v123, v31, v30, s35
    v_accvgpr_write_b32 a207, v123
    s_waitcnt vmcnt(32)
    s_add_u32 s37, s36, 0x300000
    buffer_load_dword v16, v15, s[96:99], s37 offen
    s_add_u32 s37, s36, 0x302000
    buffer_load_dword v17, v15, s[96:99], s37 offen
    s_add_u32 s37, s36, 0x304000
    buffer_load_dword v18, v15, s[96:99], s37 offen
    s_add_u32 s37, s36, 0x306000
    buffer_load_dword v19, v15, s[96:99], s37 offen
    s_add_u32 s37, s36, 0x308000
    buffer_load_dword v20, v15, s[96:99], s37 offen
    s_add_u32 s37, s36, 0x30a000
    buffer_load_dword v21, v15, s[96:99], s37 offen
    s_add_u32 s37, s36, 0x30c000
    buffer_load_dword v22, v15, s[96:99], s37 offen
    s_add_u32 s37, s36, 0x30e000
    buffer_load_dword v23, v15, s[96:99], s37 offen
    s_add_u32 s37, s36, 0x340000
    buffer_load_dword v24, v15, s[96:99], s37 offen
    s_add_u32 s37, s36, 0x342000
    buffer_load_dword v25, v15, s[96:99], s37 offen
    s_add_u32 s37, s36, 0x344000
    buffer_load_dword v26, v15, s[96:99], s37 offen
    s_add_u32 s37, s36, 0x346000
    buffer_load_dword v27, v15, s[96:99], s37 offen
    s_add_u32 s37, s36, 0x348000
    buffer_load_dword v28, v15, s[96:99], s37 offen
    s_add_u32 s37, s36, 0x34a000
    buffer_load_dword v29, v15, s[96:99], s37 offen
    s_add_u32 s37, s36, 0x34c000
    buffer_load_dword v30, v15, s[96:99], s37 offen
    s_add_u32 s37, s36, 0x34e000
    buffer_load_dword v31, v15, s[96:99], s37 offen
    v_perm_b32 v192, v33, v32, s34
    v_perm_b32 v193, v35, v34, s34
    v_perm_b32 v194, v37, v36, s34
    v_perm_b32 v195, v39, v38, s34
    v_perm_b32 v196, v33, v32, s35
    v_perm_b32 v197, v35, v34, s35
    v_perm_b32 v198, v37, v36, s35
    v_perm_b32 v199, v39, v38, s35
    v_perm_b32 v200, v41, v40, s34
    v_perm_b32 v201, v43, v42, s34
    v_perm_b32 v202, v45, v44, s34
    v_perm_b32 v203, v47, v46, s34
    v_perm_b32 v204, v41, v40, s35
    v_perm_b32 v205, v43, v42, s35
    v_perm_b32 v206, v45, v44, s35
    v_perm_b32 v207, v47, v46, s35
    s_waitcnt vmcnt(32)
    s_add_u32 s37, s36, 0x300000
    buffer_load_dword v32, v15, s[76:79], s37 offen
    s_add_u32 s37, s36, 0x302000
    buffer_load_dword v33, v15, s[76:79], s37 offen
    s_add_u32 s37, s36, 0x304000
    buffer_load_dword v34, v15, s[76:79], s37 offen
    s_add_u32 s37, s36, 0x306000
    buffer_load_dword v35, v15, s[76:79], s37 offen
    s_add_u32 s37, s36, 0x308000
    buffer_load_dword v36, v15, s[76:79], s37 offen
    s_add_u32 s37, s36, 0x30a000
    buffer_load_dword v37, v15, s[76:79], s37 offen
    s_add_u32 s37, s36, 0x30c000
    buffer_load_dword v38, v15, s[76:79], s37 offen
    s_add_u32 s37, s36, 0x30e000
    buffer_load_dword v39, v15, s[76:79], s37 offen
    s_add_u32 s37, s36, 0x340000
    buffer_load_dword v40, v15, s[76:79], s37 offen
    s_add_u32 s37, s36, 0x342000
    buffer_load_dword v41, v15, s[76:79], s37 offen
    s_add_u32 s37, s36, 0x344000
    buffer_load_dword v42, v15, s[76:79], s37 offen
    s_add_u32 s37, s36, 0x346000
    buffer_load_dword v43, v15, s[76:79], s37 offen
    s_add_u32 s37, s36, 0x348000
    buffer_load_dword v44, v15, s[76:79], s37 offen
    s_add_u32 s37, s36, 0x34a000
    buffer_load_dword v45, v15, s[76:79], s37 offen
    s_add_u32 s37, s36, 0x34c000
    buffer_load_dword v46, v15, s[76:79], s37 offen
    s_add_u32 s37, s36, 0x34e000
    buffer_load_dword v47, v15, s[76:79], s37 offen
    v_perm_b32 v120, v49, v48, s34
    v_accvgpr_write_b32 a208, v120
    v_perm_b32 v121, v51, v50, s34
    v_accvgpr_write_b32 a209, v121
    v_perm_b32 v122, v53, v52, s34
    v_accvgpr_write_b32 a210, v122
    v_perm_b32 v123, v55, v54, s34
    v_accvgpr_write_b32 a211, v123
    v_perm_b32 v120, v49, v48, s35
    v_accvgpr_write_b32 a212, v120
    v_perm_b32 v121, v51, v50, s35
    v_accvgpr_write_b32 a213, v121
    v_perm_b32 v122, v53, v52, s35
    v_accvgpr_write_b32 a214, v122
    v_perm_b32 v123, v55, v54, s35
    v_accvgpr_write_b32 a215, v123
    v_perm_b32 v120, v57, v56, s34
    v_accvgpr_write_b32 a216, v120
    v_perm_b32 v121, v59, v58, s34
    v_accvgpr_write_b32 a217, v121
    v_perm_b32 v122, v61, v60, s34
    v_accvgpr_write_b32 a218, v122
    v_perm_b32 v123, v63, v62, s34
    v_accvgpr_write_b32 a219, v123
    v_perm_b32 v120, v57, v56, s35
    v_accvgpr_write_b32 a220, v120
    v_perm_b32 v121, v59, v58, s35
    v_accvgpr_write_b32 a221, v121
    v_perm_b32 v122, v61, v60, s35
    v_accvgpr_write_b32 a222, v122
    v_perm_b32 v123, v63, v62, s35
    v_accvgpr_write_b32 a223, v123
    s_waitcnt vmcnt(32)
    s_add_u32 s37, s36, 0x380000
    buffer_load_dword v48, v15, s[96:99], s37 offen
    s_add_u32 s37, s36, 0x382000
    buffer_load_dword v49, v15, s[96:99], s37 offen
    s_add_u32 s37, s36, 0x384000
    buffer_load_dword v50, v15, s[96:99], s37 offen
    s_add_u32 s37, s36, 0x386000
    buffer_load_dword v51, v15, s[96:99], s37 offen
    s_add_u32 s37, s36, 0x388000
    buffer_load_dword v52, v15, s[96:99], s37 offen
    s_add_u32 s37, s36, 0x38a000
    buffer_load_dword v53, v15, s[96:99], s37 offen
    s_add_u32 s37, s36, 0x38c000
    buffer_load_dword v54, v15, s[96:99], s37 offen
    s_add_u32 s37, s36, 0x38e000
    buffer_load_dword v55, v15, s[96:99], s37 offen
    s_add_u32 s37, s36, 0x3c0000
    buffer_load_dword v56, v15, s[96:99], s37 offen
    s_add_u32 s37, s36, 0x3c2000
    buffer_load_dword v57, v15, s[96:99], s37 offen
    s_add_u32 s37, s36, 0x3c4000
    buffer_load_dword v58, v15, s[96:99], s37 offen
    s_add_u32 s37, s36, 0x3c6000
    buffer_load_dword v59, v15, s[96:99], s37 offen
    s_add_u32 s37, s36, 0x3c8000
    buffer_load_dword v60, v15, s[96:99], s37 offen
    s_add_u32 s37, s36, 0x3ca000
    buffer_load_dword v61, v15, s[96:99], s37 offen
    s_add_u32 s37, s36, 0x3cc000
    buffer_load_dword v62, v15, s[96:99], s37 offen
    s_add_u32 s37, s36, 0x3ce000
    buffer_load_dword v63, v15, s[96:99], s37 offen
    v_perm_b32 v208, v65, v64, s34
    v_perm_b32 v209, v67, v66, s34
    v_perm_b32 v210, v69, v68, s34
    v_perm_b32 v211, v71, v70, s34
    v_perm_b32 v212, v65, v64, s35
    v_perm_b32 v213, v67, v66, s35
    v_perm_b32 v214, v69, v68, s35
    v_perm_b32 v215, v71, v70, s35
    v_perm_b32 v216, v73, v72, s34
    v_perm_b32 v217, v75, v74, s34
    v_perm_b32 v218, v77, v76, s34
    v_perm_b32 v219, v79, v78, s34
    v_perm_b32 v220, v73, v72, s35
    v_perm_b32 v221, v75, v74, s35
    v_perm_b32 v222, v77, v76, s35
    v_perm_b32 v223, v79, v78, s35
    s_waitcnt vmcnt(32)
    s_add_u32 s37, s36, 0x380000
    buffer_load_dword v64, v15, s[76:79], s37 offen
    s_add_u32 s37, s36, 0x382000
    buffer_load_dword v65, v15, s[76:79], s37 offen
    s_add_u32 s37, s36, 0x384000
    buffer_load_dword v66, v15, s[76:79], s37 offen
    s_add_u32 s37, s36, 0x386000
    buffer_load_dword v67, v15, s[76:79], s37 offen
    s_add_u32 s37, s36, 0x388000
    buffer_load_dword v68, v15, s[76:79], s37 offen
    s_add_u32 s37, s36, 0x38a000
    buffer_load_dword v69, v15, s[76:79], s37 offen
    s_add_u32 s37, s36, 0x38c000
    buffer_load_dword v70, v15, s[76:79], s37 offen
    s_add_u32 s37, s36, 0x38e000
    buffer_load_dword v71, v15, s[76:79], s37 offen
    s_add_u32 s37, s36, 0x3c0000
    buffer_load_dword v72, v15, s[76:79], s37 offen
    s_add_u32 s37, s36, 0x3c2000
    buffer_load_dword v73, v15, s[76:79], s37 offen
    s_add_u32 s37, s36, 0x3c4000
    buffer_load_dword v74, v15, s[76:79], s37 offen
    s_add_u32 s37, s36, 0x3c6000
    buffer_load_dword v75, v15, s[76:79], s37 offen
    s_add_u32 s37, s36, 0x3c8000
    buffer_load_dword v76, v15, s[76:79], s37 offen
    s_add_u32 s37, s36, 0x3ca000
    buffer_load_dword v77, v15, s[76:79], s37 offen
    s_add_u32 s37, s36, 0x3cc000
    buffer_load_dword v78, v15, s[76:79], s37 offen
    s_add_u32 s37, s36, 0x3ce000
    buffer_load_dword v79, v15, s[76:79], s37 offen
    v_perm_b32 v120, v17, v16, s34
    v_accvgpr_write_b32 a224, v120
    v_perm_b32 v121, v19, v18, s34
    v_accvgpr_write_b32 a225, v121
    v_perm_b32 v122, v21, v20, s34
    v_accvgpr_write_b32 a226, v122
    v_perm_b32 v123, v23, v22, s34
    v_accvgpr_write_b32 a227, v123
    v_perm_b32 v120, v17, v16, s35
    v_accvgpr_write_b32 a228, v120
    v_perm_b32 v121, v19, v18, s35
    v_accvgpr_write_b32 a229, v121
    v_perm_b32 v122, v21, v20, s35
    v_accvgpr_write_b32 a230, v122
    v_perm_b32 v123, v23, v22, s35
    v_accvgpr_write_b32 a231, v123
    v_perm_b32 v120, v25, v24, s34
    v_accvgpr_write_b32 a232, v120
    v_perm_b32 v121, v27, v26, s34
    v_accvgpr_write_b32 a233, v121
    v_perm_b32 v122, v29, v28, s34
    v_accvgpr_write_b32 a234, v122
    v_perm_b32 v123, v31, v30, s34
    v_accvgpr_write_b32 a235, v123
    v_perm_b32 v120, v25, v24, s35
    v_accvgpr_write_b32 a236, v120
    v_perm_b32 v121, v27, v26, s35
    v_accvgpr_write_b32 a237, v121
    v_perm_b32 v122, v29, v28, s35
    v_accvgpr_write_b32 a238, v122
    v_perm_b32 v123, v31, v30, s35
    v_accvgpr_write_b32 a239, v123
    s_waitcnt vmcnt(32)
    v_perm_b32 v224, v33, v32, s34
    v_perm_b32 v225, v35, v34, s34
    v_perm_b32 v226, v37, v36, s34
    v_perm_b32 v227, v39, v38, s34
    v_perm_b32 v228, v33, v32, s35
    v_perm_b32 v229, v35, v34, s35
    v_perm_b32 v230, v37, v36, s35
    v_perm_b32 v231, v39, v38, s35
    v_perm_b32 v232, v41, v40, s34
    v_perm_b32 v233, v43, v42, s34
    v_perm_b32 v234, v45, v44, s34
    v_perm_b32 v235, v47, v46, s34
    v_perm_b32 v236, v41, v40, s35
    v_perm_b32 v237, v43, v42, s35
    v_perm_b32 v238, v45, v44, s35
    v_perm_b32 v239, v47, v46, s35
    s_waitcnt vmcnt(16)
    v_perm_b32 v120, v49, v48, s34
    v_accvgpr_write_b32 a240, v120
    v_perm_b32 v121, v51, v50, s34
    v_accvgpr_write_b32 a241, v121
    v_perm_b32 v122, v53, v52, s34
    v_accvgpr_write_b32 a242, v122
    v_perm_b32 v123, v55, v54, s34
    v_accvgpr_write_b32 a243, v123
    v_perm_b32 v120, v49, v48, s35
    v_accvgpr_write_b32 a244, v120
    v_perm_b32 v121, v51, v50, s35
    v_accvgpr_write_b32 a245, v121
    v_perm_b32 v122, v53, v52, s35
    v_accvgpr_write_b32 a246, v122
    v_perm_b32 v123, v55, v54, s35
    v_accvgpr_write_b32 a247, v123
    v_perm_b32 v120, v57, v56, s34
    v_accvgpr_write_b32 a248, v120
    v_perm_b32 v121, v59, v58, s34
    v_accvgpr_write_b32 a249, v121
    v_perm_b32 v122, v61, v60, s34
    v_accvgpr_write_b32 a250, v122
    v_perm_b32 v123, v63, v62, s34
    v_accvgpr_write_b32 a251, v123
    v_perm_b32 v120, v57, v56, s35
    v_accvgpr_write_b32 a252, v120
    v_perm_b32 v121, v59, v58, s35
    v_accvgpr_write_b32 a253, v121
    v_perm_b32 v122, v61, v60, s35
    v_accvgpr_write_b32 a254, v122
    v_perm_b32 v123, v63, v62, s35
    v_accvgpr_write_b32 a255, v123
    s_waitcnt vmcnt(0)
    v_perm_b32 v240, v65, v64, s34
    v_perm_b32 v241, v67, v66, s34
    v_perm_b32 v242, v69, v68, s34
    v_perm_b32 v243, v71, v70, s34
    v_perm_b32 v244, v65, v64, s35
    v_perm_b32 v245, v67, v66, s35
    v_perm_b32 v246, v69, v68, s35
    v_perm_b32 v247, v71, v70, s35
    v_perm_b32 v248, v73, v72, s34
    v_perm_b32 v249, v75, v74, s34
    v_perm_b32 v250, v77, v76, s34
    v_perm_b32 v251, v79, v78, s34
    v_perm_b32 v252, v73, v72, s35
    v_perm_b32 v253, v75, v74, s35
    v_perm_b32 v254, v77, v76, s35
    v_perm_b32 v255, v79, v78, s35
    v_lshrrev_b32 v15, 2, v1
    v_and_b32 v15, 127, v15
L_WHS:
    buffer_load_dword v14, v15, s[16:19], 0 offen sc1
    s_add_u32 s32, s32, 1
    s_cmp_gt_u32 s32, 200000
    s_cbranch_scc1 L_WHS_done
    s_waitcnt vmcnt(0)
    v_cmp_eq_u32 vcc, 0, v14
    s_cbranch_vccnz L_WHS
L_WHS_done:
    s_lshr_b32 s36, s21, 1
    s_lshl_b32 s36, s36, 14
    s_xor_b32 s37, s36, 16384
    v_add_u32 v80, s36, v5
    v_add_u32 v81, s37, v5
    v_add_u32 v82, s36, v6
    v_add_u32 v83, s37, v6
    s_mov_b32 s23, s22
L_P1:
    s_lshl_b32 s36, s23, 15
    buffer_load_dwordx4 v[16:19], v3, s[12:15], s36 offen offset:0
    buffer_load_dwordx4 v[20:23], v3, s[12:15], s36 offen offset:128
    buffer_load_dwordx4 v[24:27], v3, s[12:15], s36 offen offset:256
    buffer_load_dwordx4 v[28:31], v3, s[12:15], s36 offen offset:384
    buffer_load_dwordx4 v[32:35], v3, s[12:15], s36 offen offset:512
    buffer_load_dwordx4 v[36:39], v3, s[12:15], s36 offen offset:640
    buffer_load_dwordx4 v[40:43], v3, s[12:15], s36 offen offset:768
    buffer_load_dwordx4 v[44:47], v3, s[12:15], s36 offen offset:896
    v_mov_b32 v48, 0
    v_mov_b32 v49, 0
    s_waitcnt vmcnt(7)
    v_dot2_f32_bf16 v48, v16, s4, v48
    v_dot2_f32_bf16 v49, v16, v16, v49
    v_dot2_f32_bf16 v48, v17, s4, v48
    v_dot2_f32_bf16 v49, v17, v17, v49
    v_dot2_f32_bf16 v48, v18, s4, v48
    v_dot2_f32_bf16 v49, v18, v18, v49
    v_dot2_f32_bf16 v48, v19, s4, v48
    v_dot2_f32_bf16 v49, v19, v19, v49
    s_waitcnt vmcnt(6)
    v_dot2_f32_bf16 v48, v20, s4, v48
    v_dot2_f32_bf16 v49, v20, v20, v49
    v_dot2_f32_bf16 v48, v21, s4, v48
    v_dot2_f32_bf16 v49, v21, v21, v49
    v_dot2_f32_bf16 v48, v22, s4, v48
    v_dot2_f32_bf16 v49, v22, v22, v49
    v_dot2_f32_bf16 v48, v23, s4, v48
    v_dot2_f32_bf16 v49, v23, v23, v49
    s_waitcnt vmcnt(5)
    v_dot2_f32_bf16 v48, v24, s4, v48
    v_dot2_f32_bf16 v49, v24, v24, v49
    v_dot2_f32_bf16 v48, v25, s4, v48
    v_dot2_f32_bf16 v49, v25, v25, v49
    v_dot2_f32_bf16 v48, v26, s4, v48
    v_dot2_f32_bf16 v49, v26, v26, v49
    v_dot2_f32_bf16 v48, v27, s4, v48
    v_dot2_f32_bf16 v49, v27, v27, v49
    s_waitcnt vmcnt(4)
    v_dot2_f32_bf16 v48, v28, s4, v48
    v_dot2_f32_bf16 v49, v28, v28, v49
    v_dot2_f32_bf16 v48, v29, s4, v48
    v_dot2_f32_bf16 v49, v29, v29, v49
    v_dot2_f32_bf16 v48, v30, s4, v48
    v_dot2_f32_bf16 v49, v30, v30, v49
    v_dot2_f32_bf16 v48, v31, s4, v48
    v_dot2_f32_bf16 v49, v31, v31, v49
    s_waitcnt vmcnt(3)
    v_dot2_f32_bf16 v48, v32, s4, v48
    v_dot2_f32_bf16 v49, v32, v32, v49
    v_dot2_f32_bf16 v48, v33, s4, v48
    v_dot2_f32_bf16 v49, v33, v33, v49
    v_dot2_f32_bf16 v48, v34, s4, v48
    v_dot2_f32_bf16 v49, v34, v34, v49
    v_dot2_f32_bf16 v48, v35, s4, v48
    v_dot2_f32_bf16 v49, v35, v35, v49
    s_waitcnt vmcnt(2)
    v_dot2_f32_bf16 v48, v36, s4, v48
    v_dot2_f32_bf16 v49, v36, v36, v49
    v_dot2_f32_bf16 v48, v37, s4, v48
    v_dot2_f32_bf16 v49, v37, v37, v49
    v_dot2_f32_bf16 v48, v38, s4, v48
    v_dot2_f32_bf16 v49, v38, v38, v49
    v_dot2_f32_bf16 v48, v39, s4, v48
    v_dot2_f32_bf16 v49, v39, v39, v49
    s_waitcnt vmcnt(1)
    v_dot2_f32_bf16 v48, v40, s4, v48
    v_dot2_f32_bf16 v49, v40, v40, v49
    v_dot2_f32_bf16 v48, v41, s4, v48
    v_dot2_f32_bf16 v49, v41, v41, v49
    v_dot2_f32_bf16 v48, v42, s4, v48
    v_dot2_f32_bf16 v49, v42, v42, v49
    v_dot2_f32_bf16 v48, v43, s4, v48
    v_dot2_f32_bf16 v49, v43, v43, v49
    s_waitcnt vmcnt(0)
    v_dot2_f32_bf16 v48, v44, s4, v48
    v_dot2_f32_bf16 v49, v44, v44, v49
    v_dot2_f32_bf16 v48, v45, s4, v48
    v_dot2_f32_bf16 v49, v45, v45, v49
    v_dot2_f32_bf16 v48, v46, s4, v48
    v_dot2_f32_bf16 v49, v46, v46, v49
    v_dot2_f32_bf16 v48, v47, s4, v48
    v_dot2_f32_bf16 v49, v47, v47, v49
    s_nop 3
    v_add_f32_dpp v48, v48, v48 quad_perm:[1,0,3,2] row_mask:0xf bank_mask:0xf
    v_add_f32_dpp v49, v49, v49 quad_perm:[1,0,3,2] row_mask:0xf bank_mask:0xf
    s_nop 0
    v_add_f32_dpp v48, v48, v48 quad_perm:[2,3,0,1] row_mask:0xf bank_mask:0xf
    v_add_f32_dpp v49, v49, v49 quad_perm:[2,3,0,1] row_mask:0xf bank_mask:0xf
    s_nop 0
    v_add_f32_dpp v48, v48, v48 row_half_mirror row_mask:0xf bank_mask:0xf
    v_add_f32_dpp v49, v49, v49 row_half_mirror row_mask:0xf bank_mask:0xf
    v_mul_f32 v48, 0x3b000000, v48
    v_mul_f32 v49, 0x3b000000, v49
    v_fma_f32 v49, -v48, v48, v49
    v_max_f32 v49, 0, v49
    v_add_f32 v49, 0x3727c5ac, v49
    v_rsq_f32 v50, v49
    s_nop 0
    v_mul_f32 v51, v48, v50
    v_lshlrev_b32 v52, 16, v16
    v_and_b32 v53, 0xffff0000, v16
    v_fma_f32 v52, v52, v50, -v51
    v_fma_f32 v53, v53, v50, -v51
    v_cvt_pk_bf16_f32 v16, v52, v53
    v_lshlrev_b32 v52, 16, v17
    v_and_b32 v53, 0xffff0000, v17
    v_fma_f32 v52, v52, v50, -v51
    v_fma_f32 v53, v53, v50, -v51
    v_cvt_pk_bf16_f32 v17, v52, v53
    v_lshlrev_b32 v52, 16, v18
    v_and_b32 v53, 0xffff0000, v18
    v_fma_f32 v52, v52, v50, -v51
    v_fma_f32 v53, v53, v50, -v51
    v_cvt_pk_bf16_f32 v18, v52, v53
    v_lshlrev_b32 v52, 16, v19
    v_and_b32 v53, 0xffff0000, v19
    v_fma_f32 v52, v52, v50, -v51
    v_fma_f32 v53, v53, v50, -v51
    v_cvt_pk_bf16_f32 v19, v52, v53
    ds_write_b128 v4, v[16:19] offset:0
    v_lshlrev_b32 v52, 16, v20
    v_and_b32 v53, 0xffff0000, v20
    v_fma_f32 v52, v52, v50, -v51
    v_fma_f32 v53, v53, v50, -v51
    v_cvt_pk_bf16_f32 v20, v52, v53
    v_lshlrev_b32 v52, 16, v21
    v_and_b32 v53, 0xffff0000, v21
    v_fma_f32 v52, v52, v50, -v51
    v_fma_f32 v53, v53, v50, -v51
    v_cvt_pk_bf16_f32 v21, v52, v53
    v_lshlrev_b32 v52, 16, v22
    v_and_b32 v53, 0xffff0000, v22
    v_fma_f32 v52, v52, v50, -v51
    v_fma_f32 v53, v53, v50, -v51
    v_cvt_pk_bf16_f32 v22, v52, v53
    v_lshlrev_b32 v52, 16, v23
    v_and_b32 v53, 0xffff0000, v23
    v_fma_f32 v52, v52, v50, -v51
    v_fma_f32 v53, v53, v50, -v51
    v_cvt_pk_bf16_f32 v23, v52, v53
    ds_write_b128 v4, v[20:23] offset:2048
    v_lshlrev_b32 v52, 16, v24
    v_and_b32 v53, 0xffff0000, v24
    v_fma_f32 v52, v52, v50, -v51
    v_fma_f32 v53, v53, v50, -v51
    v_cvt_pk_bf16_f32 v24, v52, v53
    v_lshlrev_b32 v52, 16, v25
    v_and_b32 v53, 0xffff0000, v25
    v_fma_f32 v52, v52, v50, -v51
    v_fma_f32 v53, v53, v50, -v51
    v_cvt_pk_bf16_f32 v25, v52, v53
    v_lshlrev_b32 v52, 16, v26
    v_and_b32 v53, 0xffff0000, v26
    v_fma_f32 v52, v52, v50, -v51
    v_fma_f32 v53, v53, v50, -v51
    v_cvt_pk_bf16_f32 v26, v52, v53
    v_lshlrev_b32 v52, 16, v27
    v_and_b32 v53, 0xffff0000, v27
    v_fma_f32 v52, v52, v50, -v51
    v_fma_f32 v53, v53, v50, -v51
    v_cvt_pk_bf16_f32 v27, v52, v53
    ds_write_b128 v4, v[24:27] offset:4096
    v_lshlrev_b32 v52, 16, v28
    v_and_b32 v53, 0xffff0000, v28
    v_fma_f32 v52, v52, v50, -v51
    v_fma_f32 v53, v53, v50, -v51
    v_cvt_pk_bf16_f32 v28, v52, v53
    v_lshlrev_b32 v52, 16, v29
    v_and_b32 v53, 0xffff0000, v29
    v_fma_f32 v52, v52, v50, -v51
    v_fma_f32 v53, v53, v50, -v51
    v_cvt_pk_bf16_f32 v29, v52, v53
    v_lshlrev_b32 v52, 16, v30
    v_and_b32 v53, 0xffff0000, v30
    v_fma_f32 v52, v52, v50, -v51
    v_fma_f32 v53, v53, v50, -v51
    v_cvt_pk_bf16_f32 v30, v52, v53
    v_lshlrev_b32 v52, 16, v31
    v_and_b32 v53, 0xffff0000, v31
    v_fma_f32 v52, v52, v50, -v51
    v_fma_f32 v53, v53, v50, -v51
    v_cvt_pk_bf16_f32 v31, v52, v53
    ds_write_b128 v4, v[28:31] offset:6144
    v_lshlrev_b32 v52, 16, v32
    v_and_b32 v53, 0xffff0000, v32
    v_fma_f32 v52, v52, v50, -v51
    v_fma_f32 v53, v53, v50, -v51
    v_cvt_pk_bf16_f32 v32, v52, v53
    v_lshlrev_b32 v52, 16, v33
    v_and_b32 v53, 0xffff0000, v33
    v_fma_f32 v52, v52, v50, -v51
    v_fma_f32 v53, v53, v50, -v51
    v_cvt_pk_bf16_f32 v33, v52, v53
    v_lshlrev_b32 v52, 16, v34
    v_and_b32 v53, 0xffff0000, v34
    v_fma_f32 v52, v52, v50, -v51
    v_fma_f32 v53, v53, v50, -v51
    v_cvt_pk_bf16_f32 v34, v52, v53
    v_lshlrev_b32 v52, 16, v35
    v_and_b32 v53, 0xffff0000, v35
    v_fma_f32 v52, v52, v50, -v51
    v_fma_f32 v53, v53, v50, -v51
    v_cvt_pk_bf16_f32 v35, v52, v53
    ds_write_b128 v4, v[32:35] offset:8192
    v_lshlrev_b32 v52, 16, v36
    v_and_b32 v53, 0xffff0000, v36
    v_fma_f32 v52, v52, v50, -v51
    v_fma_f32 v53, v53, v50, -v51
    v_cvt_pk_bf16_f32 v36, v52, v53
    v_lshlrev_b32 v52, 16, v37
    v_and_b32 v53, 0xffff0000, v37
    v_fma_f32 v52, v52, v50, -v51
    v_fma_f32 v53, v53, v50, -v51
    v_cvt_pk_bf16_f32 v37, v52, v53
    v_lshlrev_b32 v52, 16, v38
    v_and_b32 v53, 0xffff0000, v38
    v_fma_f32 v52, v52, v50, -v51
    v_fma_f32 v53, v53, v50, -v51
    v_cvt_pk_bf16_f32 v38, v52, v53
    v_lshlrev_b32 v52, 16, v39
    v_and_b32 v53, 0xffff0000, v39
    v_fma_f32 v52, v52, v50, -v51
    v_fma_f32 v53, v53, v50, -v51
    v_cvt_pk_bf16_f32 v39, v52, v53
    ds_write_b128 v4, v[36:39] offset:10240
    v_lshlrev_b32 v52, 16, v40
    v_and_b32 v53, 0xffff0000, v40
    v_fma_f32 v52, v52, v50, -v51
    v_fma_f32 v53, v53, v50, -v51
    v_cvt_pk_bf16_f32 v40, v52, v53
    v_lshlrev_b32 v52, 16, v41
    v_and_b32 v53, 0xffff0000, v41
    v_fma_f32 v52, v52, v50, -v51
    v_fma_f32 v53, v53, v50, -v51
    v_cvt_pk_bf16_f32 v41, v52, v53
    v_lshlrev_b32 v52, 16, v42
    v_and_b32 v53, 0xffff0000, v42
    v_fma_f32 v52, v52, v50, -v51
    v_fma_f32 v53, v53, v50, -v51
    v_cvt_pk_bf16_f32 v42, v52, v53
    v_lshlrev_b32 v52, 16, v43
    v_and_b32 v53, 0xffff0000, v43
    v_fma_f32 v52, v52, v50, -v51
    v_fma_f32 v53, v53, v50, -v51
    v_cvt_pk_bf16_f32 v43, v52, v53
    ds_write_b128 v4, v[40:43] offset:12288
    v_lshlrev_b32 v52, 16, v44
    v_and_b32 v53, 0xffff0000, v44
    v_fma_f32 v52, v52, v50, -v51
    v_fma_f32 v53, v53, v50, -v51
    v_cvt_pk_bf16_f32 v44, v52, v53
    v_lshlrev_b32 v52, 16, v45
    v_and_b32 v53, 0xffff0000, v45
    v_fma_f32 v52, v52, v50, -v51
    v_fma_f32 v53, v53, v50, -v51
    v_cvt_pk_bf16_f32 v45, v52, v53
    v_lshlrev_b32 v52, 16, v46
    v_and_b32 v53, 0xffff0000, v46
    v_fma_f32 v52, v52, v50, -v51
    v_fma_f32 v53, v53, v50, -v51
    v_cvt_pk_bf16_f32 v46, v52, v53
    v_lshlrev_b32 v52, 16, v47
    v_and_b32 v53, 0xffff0000, v47
    v_fma_f32 v52, v52, v50, -v51
    v_fma_f32 v53, v53, v50, -v51
    v_cvt_pk_bf16_f32 v47, v52, v53
    ds_write_b128 v4, v[44:47] offset:14336
    s_waitcnt lgkmcnt(0)
    s_barrier
    ds_read_b128 v[64:67], v80 offset:0
    ds_read_b128 v[68:71], v81 offset:0
    ds_read_b128 v[72:75], v82 offset:1024
    ds_read_b128 v[76:79], v83 offset:1024
    s_waitcnt lgkmcnt(2)
    v_mfma_f32_16x16x32_bf16 v[32:35], a[128:131], v[64:67], 0
    v_mfma_f32_16x16x32_bf16 v[36:39], a[128:131], v[68:71], 0
    v_mfma_f32_16x16x32_bf16 v[40:43], a[132:135], v[64:67], 0
    v_mfma_f32_16x16x32_bf16 v[44:47], a[132:135], v[68:71], 0
    v_mfma_f32_16x16x32_bf16 v[48:51], v[64:67], v[128:131], 0
    v_mfma_f32_16x16x32_bf16 v[56:59], v[68:71], v[128:131], 0
    v_mfma_f32_16x16x32_bf16 v[52:55], v[64:67], v[132:135], 0
    v_mfma_f32_16x16x32_bf16 v[60:63], v[68:71], v[132:135], 0
    ds_read_b128 v[64:67], v80 offset:2048
    ds_read_b128 v[68:71], v81 offset:2048
    s_waitcnt lgkmcnt(2)
    v_mfma_f32_16x16x32_bf16 v[32:35], a[136:139], v[72:75], v[32:35]
    v_mfma_f32_16x16x32_bf16 v[36:39], a[136:139], v[76:79], v[36:39]
    v_mfma_f32_16x16x32_bf16 v[40:43], a[140:143], v[72:75], v[40:43]
    v_mfma_f32_16x16x32_bf16 v[44:47], a[140:143], v[76:79], v[44:47]
    v_mfma_f32_16x16x32_bf16 v[48:51], v[72:75], v[136:139], v[48:51]
    v_mfma_f32_16x16x32_bf16 v[56:59], v[76:79], v[136:139], v[56:59]
    v_mfma_f32_16x16x32_bf16 v[52:55], v[72:75], v[140:143], v[52:55]
    v_mfma_f32_16x16x32_bf16 v[60:63], v[76:79], v[140:143], v[60:63]
    ds_read_b128 v[72:75], v82 offset:3072
    ds_read_b128 v[76:79], v83 offset:3072
    s_waitcnt lgkmcnt(2)
    v_mfma_f32_16x16x32_bf16 v[32:35], a[144:147], v[64:67], v[32:35]
    v_mfma_f32_16x16x32_bf16 v[36:39], a[144:147], v[68:71], v[36:39]
    v_mfma_f32_16x16x32_bf16 v[40:43], a[148:151], v[64:67], v[40:43]
    v_mfma_f32_16x16x32_bf16 v[44:47], a[148:151], v[68:71], v[44:47]
    v_mfma_f32_16x16x32_bf16 v[48:51], v[64:67], v[144:147], v[48:51]
    v_mfma_f32_16x16x32_bf16 v[56:59], v[68:71], v[144:147], v[56:59]
    v_mfma_f32_16x16x32_bf16 v[52:55], v[64:67], v[148:151], v[52:55]
    v_mfma_f32_16x16x32_bf16 v[60:63], v[68:71], v[148:151], v[60:63]
    ds_read_b128 v[64:67], v80 offset:4096
    ds_read_b128 v[68:71], v81 offset:4096
    s_waitcnt lgkmcnt(2)
    v_mfma_f32_16x16x32_bf16 v[32:35], a[152:155], v[72:75], v[32:35]
    v_mfma_f32_16x16x32_bf16 v[36:39], a[152:155], v[76:79], v[36:39]
    v_mfma_f32_16x16x32_bf16 v[40:43], a[156:159], v[72:75], v[40:43]
    v_mfma_f32_16x16x32_bf16 v[44:47], a[156:159], v[76:79], v[44:47]
    v_mfma_f32_16x16x32_bf16 v[48:51], v[72:75], v[152:155], v[48:51]
    v_mfma_f32_16x16x32_bf16 v[56:59], v[76:79], v[152:155], v[56:59]
    v_mfma_f32_16x16x32_bf16 v[52:55], v[72:75], v[156:159], v[52:55]
    v_mfma_f32_16x16x32_bf16 v[60:63], v[76:79], v[156:159], v[60:63]
    ds_read_b128 v[72:75], v82 offset:5120
    ds_read_b128 v[76:79], v83 offset:5120
    s_waitcnt lgkmcnt(2)
    v_mfma_f32_16x16x32_bf16 v[32:35], a[160:163], v[64:67], v[32:35]
    v_mfma_f32_16x16x32_bf16 v[36:39], a[160:163], v[68:71], v[36:39]
    v_mfma_f32_16x16x32_bf16 v[40:43], a[164:167], v[64:67], v[40:43]
    v_mfma_f32_16x16x32_bf16 v[44:47], a[164:167], v[68:71], v[44:47]
    v_mfma_f32_16x16x32_bf16 v[48:51], v[64:67], v[160:163], v[48:51]
    v_mfma_f32_16x16x32_bf16 v[56:59], v[68:71], v[160:163], v[56:59]
    v_mfma_f32_16x16x32_bf16 v[52:55], v[64:67], v[164:167], v[52:55]
    v_mfma_f32_16x16x32_bf16 v[60:63], v[68:71], v[164:167], v[60:63]
    ds_read_b128 v[64:67], v80 offset:6144
    ds_read_b128 v[68:71], v81 offset:6144
    s_waitcnt lgkmcnt(2)
    v_mfma_f32_16x16x32_bf16 v[32:35], a[168:171], v[72:75], v[32:35]
    v_mfma_f32_16x16x32_bf16 v[36:39], a[168:171], v[76:79], v[36:39]
    v_mfma_f32_16x16x32_bf16 v[40:43], a[172:175], v[72:75], v[40:43]
    v_mfma_f32_16x16x32_bf16 v[44:47], a[172:175], v[76:79], v[44:47]
    v_mfma_f32_16x16x32_bf16 v[48:51], v[72:75], v[168:171], v[48:51]
    v_mfma_f32_16x16x32_bf16 v[56:59], v[76:79], v[168:171], v[56:59]
    v_mfma_f32_16x16x32_bf16 v[52:55], v[72:75], v[172:175], v[52:55]
    v_mfma_f32_16x16x32_bf16 v[60:63], v[76:79], v[172:175], v[60:63]
    ds_read_b128 v[72:75], v82 offset:7168
    ds_read_b128 v[76:79], v83 offset:7168
    s_waitcnt lgkmcnt(2)
    v_mfma_f32_16x16x32_bf16 v[32:35], a[176:179], v[64:67], v[32:35]
    v_mfma_f32_16x16x32_bf16 v[36:39], a[176:179], v[68:71], v[36:39]
    v_mfma_f32_16x16x32_bf16 v[40:43], a[180:183], v[64:67], v[40:43]
    v_mfma_f32_16x16x32_bf16 v[44:47], a[180:183], v[68:71], v[44:47]
    v_mfma_f32_16x16x32_bf16 v[48:51], v[64:67], v[176:179], v[48:51]
    v_mfma_f32_16x16x32_bf16 v[56:59], v[68:71], v[176:179], v[56:59]
    v_mfma_f32_16x16x32_bf16 v[52:55], v[64:67], v[180:183], v[52:55]
    v_mfma_f32_16x16x32_bf16 v[60:63], v[68:71], v[180:183], v[60:63]
    ds_read_b128 v[64:67], v80 offset:8192
    ds_read_b128 v[68:71], v81 offset:8192
    s_waitcnt lgkmcnt(2)
    v_mfma_f32_16x16x32_bf16 v[32:35], a[184:187], v[72:75], v[32:35]
    v_mfma_f32_16x16x32_bf16 v[36:39], a[184:187], v[76:79], v[36:39]
    v_mfma_f32_16x16x32_bf16 v[40:43], a[188:191], v[72:75], v[40:43]
    v_mfma_f32_16x16x32_bf16 v[44:47], a[188:191], v[76:79], v[44:47]
    v_mfma_f32_16x16x32_bf16 v[48:51], v[72:75], v[184:187], v[48:51]
    v_mfma_f32_16x16x32_bf16 v[56:59], v[76:79], v[184:187], v[56:59]
    v_mfma_f32_16x16x32_bf16 v[52:55], v[72:75], v[188:191], v[52:55]
    v_mfma_f32_16x16x32_bf16 v[60:63], v[76:79], v[188:191], v[60:63]
    ds_read_b128 v[72:75], v82 offset:9216
    ds_read_b128 v[76:79], v83 offset:9216
    s_waitcnt lgkmcnt(2)
    v_mfma_f32_16x16x32_bf16 v[32:35], a[192:195], v[64:67], v[32:35]
    v_mfma_f32_16x16x32_bf16 v[36:39], a[192:195], v[68:71], v[36:39]
    v_mfma_f32_16x16x32_bf16 v[40:43], a[196:199], v[64:67], v[40:43]
    v_mfma_f32_16x16x32_bf16 v[44:47], a[196:199], v[68:71], v[44:47]
    v_mfma_f32_16x16x32_bf16 v[48:51], v[64:67], v[192:195], v[48:51]
    v_mfma_f32_16x16x32_bf16 v[56:59], v[68:71], v[192:195], v[56:59]
    v_mfma_f32_16x16x32_bf16 v[52:55], v[64:67], v[196:199], v[52:55]
    v_mfma_f32_16x16x32_bf16 v[60:63], v[68:71], v[196:199], v[60:63]
    ds_read_b128 v[64:67], v80 offset:10240
    ds_read_b128 v[68:71], v81 offset:10240
    s_waitcnt lgkmcnt(2)
    v_mfma_f32_16x16x32_bf16 v[32:35], a[200:203], v[72:75], v[32:35]
    v_mfma_f32_16x16x32_bf16 v[36:39], a[200:203], v[76:79], v[36:39]
    v_mfma_f32_16x16x32_bf16 v[40:43], a[204:207], v[72:75], v[40:43]
    v_mfma_f32_16x16x32_bf16 v[44:47], a[204:207], v[76:79], v[44:47]
    v_mfma_f32_16x16x32_bf16 v[48:51], v[72:75], v[200:203], v[48:51]
    v_mfma_f32_16x16x32_bf16 v[56:59], v[76:79], v[200:203], v[56:59]
    v_mfma_f32_16x16x32_bf16 v[52:55], v[72:75], v[204:207], v[52:55]
    v_mfma_f32_16x16x32_bf16 v[60:63], v[76:79], v[204:207], v[60:63]
    ds_read_b128 v[72:75], v82 offset:11264
    ds_read_b128 v[76:79], v83 offset:11264
    s_waitcnt lgkmcnt(2)
    v_mfma_f32_16x16x32_bf16 v[32:35], a[208:211], v[64:67], v[32:35]
    v_mfma_f32_16x16x32_bf16 v[36:39], a[208:211], v[68:71], v[36:39]
    v_mfma_f32_16x16x32_bf16 v[40:43], a[212:215], v[64:67], v[40:43]
    v_mfma_f32_16x16x32_bf16 v[44:47], a[212:215], v[68:71], v[44:47]
    v_mfma_f32_16x16x32_bf16 v[48:51], v[64:67], v[208:211], v[48:51]
    v_mfma_f32_16x16x32_bf16 v[56:59], v[68:71], v[208:211], v[56:59]
    v_mfma_f32_16x16x32_bf16 v[52:55], v[64:67], v[212:215], v[52:55]
    v_mfma_f32_16x16x32_bf16 v[60:63], v[68:71], v[212:215], v[60:63]
    ds_read_b128 v[64:67], v80 offset:12288
    ds_read_b128 v[68:71], v81 offset:12288
    s_waitcnt lgkmcnt(2)
    v_mfma_f32_16x16x32_bf16 v[32:35], a[216:219], v[72:75], v[32:35]
    v_mfma_f32_16x16x32_bf16 v[36:39], a[216:219], v[76:79], v[36:39]
    v_mfma_f32_16x16x32_bf16 v[40:43], a[220:223], v[72:75], v[40:43]
    v_mfma_f32_16x16x32_bf16 v[44:47], a[220:223], v[76:79], v[44:47]
    v_mfma_f32_16x16x32_bf16 v[48:51], v[72:75], v[216:219], v[48:51]
    v_mfma_f32_16x16x32_bf16 v[56:59], v[76:79], v[216:219], v[56:59]
    v_mfma_f32_16x16x32_bf16 v[52:55], v[72:75], v[220:223], v[52:55]
    v_mfma_f32_16x16x32_bf16 v[60:63], v[76:79], v[220:223], v[60:63]
    ds_read_b128 v[72:75], v82 offset:13312
    ds_read_b128 v[76:79], v83 offset:13312
    s_waitcnt lgkmcnt(2)
    v_mfma_f32_16x16x32_bf16 v[32:35], a[224:227], v[64:67], v[32:35]
    v_mfma_f32_16x16x32_bf16 v[36:39], a[224:227], v[68:71], v[36:39]
    v_mfma_f32_16x16x32_bf16 v[40:43], a[228:231], v[64:67], v[40:43]
    v_mfma_f32_16x16x32_bf16 v[44:47], a[228:231], v[68:71], v[44:47]
    v_mfma_f32_16x16x32_bf16 v[48:51], v[64:67], v[224:227], v[48:51]
    v_mfma_f32_16x16x32_bf16 v[56:59], v[68:71], v[224:227], v[56:59]
    v_mfma_f32_16x16x32_bf16 v[52:55], v[64:67], v[228:231], v[52:55]
    v_mfma_f32_16x16x32_bf16 v[60:63], v[68:71], v[228:231], v[60:63]
    ds_read_b128 v[64:67], v80 offset:14336
    ds_read_b128 v[68:71], v81 offset:14336
    s_waitcnt lgkmcnt(2)
    v_mfma_f32_16x16x32_bf16 v[32:35], a[232:235], v[72:75], v[32:35]
    v_mfma_f32_16x16x32_bf16 v[36:39], a[232:235], v[76:79], v[36:39]
    v_mfma_f32_16x16x32_bf16 v[40:43], a[236:239], v[72:75], v[40:43]
    v_mfma_f32_16x16x32_bf16 v[44:47], a[236:239], v[76:79], v[44:47]
    v_mfma_f32_16x16x32_bf16 v[48:51], v[72:75], v[232:235], v[48:51]
    v_mfma_f32_16x16x32_bf16 v[56:59], v[76:79], v[232:235], v[56:59]
    v_mfma_f32_16x16x32_bf16 v[52:55], v[72:75], v[236:239], v[52:55]
    v_mfma_f32_16x16x32_bf16 v[60:63], v[76:79], v[236:239], v[60:63]
    ds_read_b128 v[72:75], v82 offset:15360
    ds_read_b128 v[76:79], v83 offset:15360
    s_waitcnt lgkmcnt(2)
    v_mfma_f32_16x16x32_bf16 v[32:35], a[240:243], v[64:67], v[32:35]
    v_mfma_f32_16x16x32_bf16 v[36:39], a[240:243], v[68:71], v[36:39]
    v_mfma_f32_16x16x32_bf16 v[40:43], a[244:247], v[64:67], v[40:43]
    v_mfma_f32_16x16x32_bf16 v[44:47], a[244:247], v[68:71], v[44:47]
    v_mfma_f32_16x16x32_bf16 v[48:51], v[64:67], v[240:243], v[48:51]
    v_mfma_f32_16x16x32_bf16 v[56:59], v[68:71], v[240:243], v[56:59]
    v_mfma_f32_16x16x32_bf16 v[52:55], v[64:67], v[244:247], v[52:55]
    v_mfma_f32_16x16x32_bf16 v[60:63], v[68:71], v[244:247], v[60:63]
    s_waitcnt lgkmcnt(0)
    v_mfma_f32_16x16x32_bf16 v[32:35], a[248:251], v[72:75], v[32:35]
    v_mfma_f32_16x16x32_bf16 v[36:39], a[248:251], v[76:79], v[36:39]
    v_mfma_f32_16x16x32_bf16 v[40:43], a[252:255], v[72:75], v[40:43]
    v_mfma_f32_16x16x32_bf16 v[44:47], a[252:255], v[76:79], v[44:47]
    v_mfma_f32_16x16x32_bf16 v[48:51], v[72:75], v[248:251], v[48:51]
    v_mfma_f32_16x16x32_bf16 v[56:59], v[76:79], v[248:251], v[56:59]
    v_mfma_f32_16x16x32_bf16 v[52:55], v[72:75], v[252:255], v[52:55]
    v_mfma_f32_16x16x32_bf16 v[60:63], v[76:79], v[252:255], v[60:63]
    s_nop 0
    v_mul_f32 v32, s33, v32
    v_mul_f32 v33, s33, v33
    v_mul_f32 v34, s33, v34
    v_mul_f32 v35, s33, v35
    v_mul_f32 v36, s33, v36
    v_mul_f32 v37, s33, v37
    v_mul_f32 v38, s33, v38
    v_mul_f32 v39, s33, v39
    v_mul_f32 v40, s33, v40
    v_mul_f32 v41, s33, v41
    v_mul_f32 v42, s33, v42
    v_mul_f32 v43, s33, v43
    v_mul_f32 v44, s33, v44
    v_mul_f32 v45, s33, v45
    v_mul_f32 v46, s33, v46
    v_mul_f32 v47, s33, v47
    v_cvt_pk_bf16_f32 v88, v32, v40
    v_cvt_pk_bf16_f32 v89, v33, v41
    v_cvt_pk_bf16_f32 v90, v34, v42
    v_cvt_pk_bf16_f32 v91, v35, v43
    v_cvt_pk_bf16_f32 v92, v36, v44
    v_cvt_pk_bf16_f32 v93, v37, v45
    v_cvt_pk_bf16_f32 v94, v38, v46
    v_cvt_pk_bf16_f32 v95, v39, v47
    v_cvt_pk_bf16_f32 v96, v48, v49
    v_cvt_pk_bf16_f32 v97, v50, v51
    v_cvt_pk_bf16_f32 v98, v56, v57
    v_cvt_pk_bf16_f32 v99, v58, v59
    v_cvt_pk_bf16_f32 v100, v52, v53
    v_cvt_pk_bf16_f32 v101, v54, v55
    v_cvt_pk_bf16_f32 v102, v60, v61
    v_cvt_pk_bf16_f32 v103, v62, v63
    s_mul_i32 s24, s23, 0x82000
    s_lshl_b32 s36, s20, 14
    s_add_u32 s24, s24, s36
    s_add_u32 s24, s24, 0x1000000
    s_lshr_b32 s36, s21, 1
    s_lshl_b32 s36, s36, 12
    s_xor_b32 s37, s36, 4096
    s_add_u32 s36, s36, s24
    s_add_u32 s37, s37, s24
    buffer_store_dwordx4 v[88:91], v9, s[8:11], s36 offen sc1
    buffer_store_dwordx4 v[92:95], v9, s[8:11], s37 offen sc1
    s_add_u32 s24, s24, 8192
    buffer_store_dwordx4 v[96:99], v2, s[8:11], s24 offen sc1
    buffer_store_dwordx4 v[100:103], v2, s[8:11], s24 offen offset:1024 sc1
    s_lshl_b32 s24, s20, 8
    s_lshl_b32 s36, s23, 2
    s_add_u32 s24, s24, s36
    s_add_u32 s24, s24, 0x190000
    s_waitcnt vmcnt(0)
    s_barrier
    v_cmp_ne_u32 vcc, 0, v0
    v_mov_b32 v15, 0x40000000
    v_mov_b32 v14, 1
    v_cndmask_b32 v15, v0, v15, vcc
    buffer_store_dword v14, v15, s[8:11], s24 offen sc1
    s_add_u32 s23, s23, 7
    s_cmp_lt_u32 s23, 63
    s_cbranch_scc1 L_P1
    v_mov_b32 v15, 0x0
    v_bfe_u32 v14, v0, 0, 1
    s_mov_b32 s38, 0x4
    v_mad_u32_u24 v15, v14, s38, v15
    v_bfe_u32 v14, v0, 1, 1
    s_mov_b32 s38, 0x8
    v_mad_u32_u24 v15, v14, s38, v15
    v_bfe_u32 v14, v0, 2, 1
    s_mov_b32 s38, 0x10
    v_mad_u32_u24 v15, v14, s38, v15
    v_bfe_u32 v14, v0, 3, 1
    s_mov_b32 s38, 0x20
    v_mad_u32_u24 v15, v14, s38, v15
    v_bfe_u32 v14, v0, 4, 1
    s_mov_b32 s38, 0x10000
    v_mad_u32_u24 v15, v14, s38, v15
    v_bfe_u32 v14, v0, 5, 1
    s_mov_b32 s38, 0x20000
    v_mad_u32_u24 v15, v14, s38, v15
    v_bfe_u32 v14, v0, 6, 1
    s_mov_b32 s38, 0x40
    v_mad_u32_u24 v15, v14, s38, v15
    v_bfe_u32 v14, v0, 7, 1
    s_mov_b32 s38, 0x80
    v_mad_u32_u24 v15, v14, s38, v15
    s_mov_b32 s96, s48
    s_and_b32 s97, s49, 0xffff
    s_mov_b32 s98, 0x400000
    s_mov_b32 s99, 0x20000
    s_lshl_b32 s36, s20, 8
    s_add_u32 s37, s36, 0x0
    buffer_load_dword v16, v15, s[96:99], s37 offen
    s_add_u32 s37, s36, 0x2000
    buffer_load_dword v17, v15, s[96:99], s37 offen
    s_add_u32 s37, s36, 0x4000
    buffer_load_dword v18, v15, s[96:99], s37 offen
    s_add_u32 s37, s36, 0x6000
    buffer_load_dword v19, v15, s[96:99], s37 offen
    s_add_u32 s37, s36, 0x8000
    buffer_load_dword v20, v15, s[96:99], s37 offen
    s_add_u32 s37, s36, 0xa000
    buffer_load_dword v21, v15, s[96:99], s37 offen
    s_add_u32 s37, s36, 0xc000
    buffer_load_dword v22, v15, s[96:99], s37 offen
    s_add_u32 s37, s36, 0xe000
    buffer_load_dword v23, v15, s[96:99], s37 offen
    s_add_u32 s37, s36, 0x40000
    buffer_load_dword v24, v15, s[96:99], s37 offen
    s_add_u32 s37, s36, 0x42000
    buffer_load_dword v25, v15, s[96:99], s37 offen
    s_add_u32 s37, s36, 0x44000
    buffer_load_dword v26, v15, s[96:99], s37 offen
    s_add_u32 s37, s36, 0x46000
    buffer_load_dword v27, v15, s[96:99], s37 offen
    s_add_u32 s37, s36, 0x48000
    buffer_load_dword v28, v15, s[96:99], s37 offen
    s_add_u32 s37, s36, 0x4a000
    buffer_load_dword v29, v15, s[96:99], s37 offen
    s_add_u32 s37, s36, 0x4c000
    buffer_load_dword v30, v15, s[96:99], s37 offen
    s_add_u32 s37, s36, 0x4e000
    buffer_load_dword v31, v15, s[96:99], s37 offen
    s_add_u32 s37, s36, 0x80000
    buffer_load_dword v32, v15, s[96:99], s37 offen
    s_add_u32 s37, s36, 0x82000
    buffer_load_dword v33, v15, s[96:99], s37 offen
    s_add_u32 s37, s36, 0x84000
    buffer_load_dword v34, v15, s[96:99], s37 offen
    s_add_u32 s37, s36, 0x86000
    buffer_load_dword v35, v15, s[96:99], s37 offen
    s_add_u32 s37, s36, 0x88000
    buffer_load_dword v36, v15, s[96:99], s37 offen
    s_add_u32 s37, s36, 0x8a000
    buffer_load_dword v37, v15, s[96:99], s37 offen
    s_add_u32 s37, s36, 0x8c000
    buffer_load_dword v38, v15, s[96:99], s37 offen
    s_add_u32 s37, s36, 0x8e000
    buffer_load_dword v39, v15, s[96:99], s37 offen
    s_add_u32 s37, s36, 0xc0000
    buffer_load_dword v40, v15, s[96:99], s37 offen
    s_add_u32 s37, s36, 0xc2000
    buffer_load_dword v41, v15, s[96:99], s37 offen
    s_add_u32 s37, s36, 0xc4000
    buffer_load_dword v42, v15, s[96:99], s37 offen
    s_add_u32 s37, s36, 0xc6000
    buffer_load_dword v43, v15, s[96:99], s37 offen
    s_add_u32 s37, s36, 0xc8000
    buffer_load_dword v44, v15, s[96:99], s37 offen
    s_add_u32 s37, s36, 0xca000
    buffer_load_dword v45, v15, s[96:99], s37 offen
    s_add_u32 s37, s36, 0xcc000
    buffer_load_dword v46, v15, s[96:99], s37 offen
    s_add_u32 s37, s36, 0xce000
    buffer_load_dword v47, v15, s[96:99], s37 offen
    s_add_u32 s37, s36, 0x100000
    buffer_load_dword v48, v15, s[96:99], s37 offen
    s_add_u32 s37, s36, 0x102000
    buffer_load_dword v49, v15, s[96:99], s37 offen
    s_add_u32 s37, s36, 0x104000
    buffer_load_dword v50, v15, s[96:99], s37 offen
    s_add_u32 s37, s36, 0x106000
    buffer_load_dword v51, v15, s[96:99], s37 offen
    s_add_u32 s37, s36, 0x108000
    buffer_load_dword v52, v15, s[96:99], s37 offen
    s_add_u32 s37, s36, 0x10a000
    buffer_load_dword v53, v15, s[96:99], s37 offen
    s_add_u32 s37, s36, 0x10c000
    buffer_load_dword v54, v15, s[96:99], s37 offen
    s_add_u32 s37, s36, 0x10e000
    buffer_load_dword v55, v15, s[96:99], s37 offen
    s_add_u32 s37, s36, 0x140000
    buffer_load_dword v56, v15, s[96:99], s37 offen
    s_add_u32 s37, s36, 0x142000
    buffer_load_dword v57, v15, s[96:99], s37 offen
    s_add_u32 s37, s36, 0x144000
    buffer_load_dword v58, v15, s[96:99], s37 offen
    s_add_u32 s37, s36, 0x146000
    buffer_load_dword v59, v15, s[96:99], s37 offen
    s_add_u32 s37, s36, 0x148000
    buffer_load_dword v60, v15, s[96:99], s37 offen
    s_add_u32 s37, s36, 0x14a000
    buffer_load_dword v61, v15, s[96:99], s37 offen
    s_add_u32 s37, s36, 0x14c000
    buffer_load_dword v62, v15, s[96:99], s37 offen
    s_add_u32 s37, s36, 0x14e000
    buffer_load_dword v63, v15, s[96:99], s37 offen
    s_waitcnt vmcnt(32)
    s_add_u32 s37, s36, 0x180000
    buffer_load_dword v64, v15, s[96:99], s37 offen
    s_add_u32 s37, s36, 0x182000
    buffer_load_dword v65, v15, s[96:99], s37 offen
    s_add_u32 s37, s36, 0x184000
    buffer_load_dword v66, v15, s[96:99], s37 offen
    s_add_u32 s37, s36, 0x186000
    buffer_load_dword v67, v15, s[96:99], s37 offen
    s_add_u32 s37, s36, 0x188000
    buffer_load_dword v68, v15, s[96:99], s37 offen
    s_add_u32 s37, s36, 0x18a000
    buffer_load_dword v69, v15, s[96:99], s37 offen
    s_add_u32 s37, s36, 0x18c000
    buffer_load_dword v70, v15, s[96:99], s37 offen
    s_add_u32 s37, s36, 0x18e000
    buffer_load_dword v71, v15, s[96:99], s37 offen
    s_add_u32 s37, s36, 0x1c0000
    buffer_load_dword v72, v15, s[96:99], s37 offen
    s_add_u32 s37, s36, 0x1c2000
    buffer_load_dword v73, v15, s[96:99], s37 offen
    s_add_u32 s37, s36, 0x1c4000
    buffer_load_dword v74, v15, s[96:99], s37 offen
    s_add_u32 s37, s36, 0x1c6000
    buffer_load_dword v75, v15, s[96:99], s37 offen
    s_add_u32 s37, s36, 0x1c8000
    buffer_load_dword v76, v15, s[96:99], s37 offen
    s_add_u32 s37, s36, 0x1ca000
    buffer_load_dword v77, v15, s[96:99], s37 offen
    s_add_u32 s37, s36, 0x1cc000
    buffer_load_dword v78, v15, s[96:99], s37 offen
    s_add_u32 s37, s36, 0x1ce000
    buffer_load_dword v79, v15, s[96:99], s37 offen
    v_perm_b32 v120, v17, v16, s34
    v_accvgpr_write_b32 a0, v120
    v_perm_b32 v121, v19, v18, s34
    v_accvgpr_write_b32 a1, v121
    v_perm_b32 v122, v21, v20, s34
    v_accvgpr_write_b32 a2, v122
    v_perm_b32 v123, v23, v22, s34
    v_accvgpr_write_b32 a3, v123
    v_perm_b32 v120, v17, v16, s35
    v_accvgpr_write_b32 a4, v120
    v_perm_b32 v121, v19, v18, s35
    v_accvgpr_write_b32 a5, v121
    v_perm_b32 v122, v21, v20, s35
    v_accvgpr_write_b32 a6, v122
    v_perm_b32 v123, v23, v22, s35
    v_accvgpr_write_b32 a7, v123
    v_perm_b32 v120, v25, v24, s34
    v_accvgpr_write_b32 a8, v120
    v_perm_b32 v121, v27, v26, s34
    v_accvgpr_write_b32 a9, v121
    v_perm_b32 v122, v29, v28, s34
    v_accvgpr_write_b32 a10, v122
    v_perm_b32 v123, v31, v30, s34
    v_accvgpr_write_b32 a11, v123
    v_perm_b32 v120, v25, v24, s35
    v_accvgpr_write_b32 a12, v120
    v_perm_b32 v121, v27, v26, s35
    v_accvgpr_write_b32 a13, v121
    v_perm_b32 v122, v29, v28, s35
    v_accvgpr_write_b32 a14, v122
    v_perm_b32 v123, v31, v30, s35
    v_accvgpr_write_b32 a15, v123
    s_waitcnt vmcnt(32)
    s_add_u32 s37, s36, 0x200000
    buffer_load_dword v16, v15, s[96:99], s37 offen
    s_add_u32 s37, s36, 0x202000
    buffer_load_dword v17, v15, s[96:99], s37 offen
    s_add_u32 s37, s36, 0x204000
    buffer_load_dword v18, v15, s[96:99], s37 offen
    s_add_u32 s37, s36, 0x206000
    buffer_load_dword v19, v15, s[96:99], s37 offen
    s_add_u32 s37, s36, 0x208000
    buffer_load_dword v20, v15, s[96:99], s37 offen
    s_add_u32 s37, s36, 0x20a000
    buffer_load_dword v21, v15, s[96:99], s37 offen
    s_add_u32 s37, s36, 0x20c000
    buffer_load_dword v22, v15, s[96:99], s37 offen
    s_add_u32 s37, s36, 0x20e000
    buffer_load_dword v23, v15, s[96:99], s37 offen
    s_add_u32 s37, s36, 0x240000
    buffer_load_dword v24, v15, s[96:99], s37 offen
    s_add_u32 s37, s36, 0x242000
    buffer_load_dword v25, v15, s[96:99], s37 offen
    s_add_u32 s37, s36, 0x244000
    buffer_load_dword v26, v15, s[96:99], s37 offen
    s_add_u32 s37, s36, 0x246000
    buffer_load_dword v27, v15, s[96:99], s37 offen
    s_add_u32 s37, s36, 0x248000
    buffer_load_dword v28, v15, s[96:99], s37 offen
    s_add_u32 s37, s36, 0x24a000
    buffer_load_dword v29, v15, s[96:99], s37 offen
    s_add_u32 s37, s36, 0x24c000
    buffer_load_dword v30, v15, s[96:99], s37 offen
    s_add_u32 s37, s36, 0x24e000
    buffer_load_dword v31, v15, s[96:99], s37 offen
    v_perm_b32 v120, v33, v32, s34
    v_accvgpr_write_b32 a16, v120
    v_perm_b32 v121, v35, v34, s34
    v_accvgpr_write_b32 a17, v121
    v_perm_b32 v122, v37, v36, s34
    v_accvgpr_write_b32 a18, v122
    v_perm_b32 v123, v39, v38, s34
    v_accvgpr_write_b32 a19, v123
    v_perm_b32 v120, v33, v32, s35
    v_accvgpr_write_b32 a20, v120
    v_perm_b32 v121, v35, v34, s35
    v_accvgpr_write_b32 a21, v121
    v_perm_b32 v122, v37, v36, s35
    v_accvgpr_write_b32 a22, v122
    v_perm_b32 v123, v39, v38, s35
    v_accvgpr_write_b32 a23, v123
    v_perm_b32 v120, v41, v40, s34
    v_accvgpr_write_b32 a24, v120
    v_perm_b32 v121, v43, v42, s34
    v_accvgpr_write_b32 a25, v121
    v_perm_b32 v122, v45, v44, s34
    v_accvgpr_write_b32 a26, v122
    v_perm_b32 v123, v47, v46, s34
    v_accvgpr_write_b32 a27, v123
    v_perm_b32 v120, v41, v40, s35
    v_accvgpr_write_b32 a28, v120
    v_perm_b32 v121, v43, v42, s35
    v_accvgpr_write_b32 a29, v121
    v_perm_b32 v122, v45, v44, s35
    v_accvgpr_write_b32 a30, v122
    v_perm_b32 v123, v47, v46, s35
    v_accvgpr_write_b32 a31, v123
    s_waitcnt vmcnt(32)
    s_add_u32 s37, s36, 0x280000
    buffer_load_dword v32, v15, s[96:99], s37 offen
    s_add_u32 s37, s36, 0x282000
    buffer_load_dword v33, v15, s[96:99], s37 offen
    s_add_u32 s37, s36, 0x284000
    buffer_load_dword v34, v15, s[96:99], s37 offen
    s_add_u32 s37, s36, 0x286000
    buffer_load_dword v35, v15, s[96:99], s37 offen
    s_add_u32 s37, s36, 0x288000
    buffer_load_dword v36, v15, s[96:99], s37 offen
    s_add_u32 s37, s36, 0x28a000
    buffer_load_dword v37, v15, s[96:99], s37 offen
    s_add_u32 s37, s36, 0x28c000
    buffer_load_dword v38, v15, s[96:99], s37 offen
    s_add_u32 s37, s36, 0x28e000
    buffer_load_dword v39, v15, s[96:99], s37 offen
    s_add_u32 s37, s36, 0x2c0000
    buffer_load_dword v40, v15, s[96:99], s37 offen
    s_add_u32 s37, s36, 0x2c2000
    buffer_load_dword v41, v15, s[96:99], s37 offen
    s_add_u32 s37, s36, 0x2c4000
    buffer_load_dword v42, v15, s[96:99], s37 offen
    s_add_u32 s37, s36, 0x2c6000
    buffer_load_dword v43, v15, s[96:99], s37 offen
    s_add_u32 s37, s36, 0x2c8000
    buffer_load_dword v44, v15, s[96:99], s37 offen
    s_add_u32 s37, s36, 0x2ca000
    buffer_load_dword v45, v15, s[96:99], s37 offen
    s_add_u32 s37, s36, 0x2cc000
    buffer_load_dword v46, v15, s[96:99], s37 offen
    s_add_u32 s37, s36, 0x2ce000
    buffer_load_dword v47, v15, s[96:99], s37 offen
    v_perm_b32 v120, v49, v48, s34
    v_accvgpr_write_b32 a32, v120
    v_perm_b32 v121, v51, v50, s34
    v_accvgpr_write_b32 a33, v121
    v_perm_b32 v122, v53, v52, s34
    v_accvgpr_write_b32 a34, v122
    v_perm_b32 v123, v55, v54, s34
    v_accvgpr_write_b32 a35, v123
    v_perm_b32 v120, v49, v48, s35
    v_accvgpr_write_b32 a36, v120
    v_perm_b32 v121, v51, v50, s35
    v_accvgpr_write_b32 a37, v121
    v_perm_b32 v122, v53, v52, s35
    v_accvgpr_write_b32 a38, v122
    v_perm_b32 v123, v55, v54, s35
    v_accvgpr_write_b32 a39, v123
    v_perm_b32 v120, v57, v56, s34
    v_accvgpr_write_b32 a40, v120
    v_perm_b32 v121, v59, v58, s34
    v_accvgpr_write_b32 a41, v121
    v_perm_b32 v122, v61, v60, s34
    v_accvgpr_write_b32 a42, v122
    v_perm_b32 v123, v63, v62, s34
    v_accvgpr_write_b32 a43, v123
    v_perm_b32 v120, v57, v56, s35
    v_accvgpr_write_b32 a44, v120
    v_perm_b32 v121, v59, v58, s35
    v_accvgpr_write_b32 a45, v121
    v_perm_b32 v122, v61, v60, s35
    v_accvgpr_write_b32 a46, v122
    v_perm_b32 v123, v63, v62, s35
    v_accvgpr_write_b32 a47, v123
    s_waitcnt vmcnt(32)
    s_add_u32 s37, s36, 0x300000
    buffer_load_dword v48, v15, s[96:99], s37 offen
    s_add_u32 s37, s36, 0x302000
    buffer_load_dword v49, v15, s[96:99], s37 offen
    s_add_u32 s37, s36, 0x304000
    buffer_load_dword v50, v15, s[96:99], s37 offen
    s_add_u32 s37, s36, 0x306000
    buffer_load_dword v51, v15, s[96:99], s37 offen
    s_add_u32 s37, s36, 0x308000
    buffer_load_dword v52, v15, s[96:99], s37 offen
    s_add_u32 s37, s36, 0x30a000
    buffer_load_dword v53, v15, s[96:99], s37 offen
    s_add_u32 s37, s36, 0x30c000
    buffer_load_dword v54, v15, s[96:99], s37 offen
    s_add_u32 s37, s36, 0x30e000
    buffer_load_dword v55, v15, s[96:99], s37 offen
    s_add_u32 s37, s36, 0x340000
    buffer_load_dword v56, v15, s[96:99], s37 offen
    s_add_u32 s37, s36, 0x342000
    buffer_load_dword v57, v15, s[96:99], s37 offen
    s_add_u32 s37, s36, 0x344000
    buffer_load_dword v58, v15, s[96:99], s37 offen
    s_add_u32 s37, s36, 0x346000
    buffer_load_dword v59, v15, s[96:99], s37 offen
    s_add_u32 s37, s36, 0x348000
    buffer_load_dword v60, v15, s[96:99], s37 offen
    s_add_u32 s37, s36, 0x34a000
    buffer_load_dword v61, v15, s[96:99], s37 offen
    s_add_u32 s37, s36, 0x34c000
    buffer_load_dword v62, v15, s[96:99], s37 offen
    s_add_u32 s37, s36, 0x34e000
    buffer_load_dword v63, v15, s[96:99], s37 offen
    v_perm_b32 v120, v65, v64, s34
    v_accvgpr_write_b32 a48, v120
    v_perm_b32 v121, v67, v66, s34
    v_accvgpr_write_b32 a49, v121
    v_perm_b32 v122, v69, v68, s34
    v_accvgpr_write_b32 a50, v122
    v_perm_b32 v123, v71, v70, s34
    v_accvgpr_write_b32 a51, v123
    v_perm_b32 v120, v65, v64, s35
    v_accvgpr_write_b32 a52, v120
    v_perm_b32 v121, v67, v66, s35
    v_accvgpr_write_b32 a53, v121
    v_perm_b32 v122, v69, v68, s35
    v_accvgpr_write_b32 a54, v122
    v_perm_b32 v123, v71, v70, s35
    v_accvgpr_write_b32 a55, v123
    v_perm_b32 v120, v73, v72, s34
    v_accvgpr_write_b32 a56, v120
    v_perm_b32 v121, v75, v74, s34
    v_accvgpr_write_b32 a57, v121
    v_perm_b32 v122, v77, v76, s34
    v_accvgpr_write_b32 a58, v122
    v_perm_b32 v123, v79, v78, s34
    v_accvgpr_write_b32 a59, v123
    v_perm_b32 v120, v73, v72, s35
    v_accvgpr_write_b32 a60, v120
    v_perm_b32 v121, v75, v74, s35
    v_accvgpr_write_b32 a61, v121
    v_perm_b32 v122, v77, v76, s35
    v_accvgpr_write_b32 a62, v122
    v_perm_b32 v123, v79, v78, s35
    v_accvgpr_write_b32 a63, v123
    s_waitcnt vmcnt(32)
    s_add_u32 s37, s36, 0x380000
    buffer_load_dword v64, v15, s[96:99], s37 offen
    s_add_u32 s37, s36, 0x382000
    buffer_load_dword v65, v15, s[96:99], s37 offen
    s_add_u32 s37, s36, 0x384000
    buffer_load_dword v66, v15, s[96:99], s37 offen
    s_add_u32 s37, s36, 0x386000
    buffer_load_dword v67, v15, s[96:99], s37 offen
    s_add_u32 s37, s36, 0x388000
    buffer_load_dword v68, v15, s[96:99], s37 offen
    s_add_u32 s37, s36, 0x38a000
    buffer_load_dword v69, v15, s[96:99], s37 offen
    s_add_u32 s37, s36, 0x38c000
    buffer_load_dword v70, v15, s[96:99], s37 offen
    s_add_u32 s37, s36, 0x38e000
    buffer_load_dword v71, v15, s[96:99], s37 offen
    s_add_u32 s37, s36, 0x3c0000
    buffer_load_dword v72, v15, s[96:99], s37 offen
    s_add_u32 s37, s36, 0x3c2000
    buffer_load_dword v73, v15, s[96:99], s37 offen
    s_add_u32 s37, s36, 0x3c4000
    buffer_load_dword v74, v15, s[96:99], s37 offen
    s_add_u32 s37, s36, 0x3c6000
    buffer_load_dword v75, v15, s[96:99], s37 offen
    s_add_u32 s37, s36, 0x3c8000
    buffer_load_dword v76, v15, s[96:99], s37 offen
    s_add_u32 s37, s36, 0x3ca000
    buffer_load_dword v77, v15, s[96:99], s37 offen
    s_add_u32 s37, s36, 0x3cc000
    buffer_load_dword v78, v15, s[96:99], s37 offen
    s_add_u32 s37, s36, 0x3ce000
    buffer_load_dword v79, v15, s[96:99], s37 offen
    v_perm_b32 v120, v17, v16, s34
    v_accvgpr_write_b32 a64, v120
    v_perm_b32 v121, v19, v18, s34
    v_accvgpr_write_b32 a65, v121
    v_perm_b32 v122, v21, v20, s34
    v_accvgpr_write_b32 a66, v122
    v_perm_b32 v123, v23, v22, s34
    v_accvgpr_write_b32 a67, v123
    v_perm_b32 v120, v17, v16, s35
    v_accvgpr_write_b32 a68, v120
    v_perm_b32 v121, v19, v18, s35
    v_accvgpr_write_b32 a69, v121
    v_perm_b32 v122, v21, v20, s35
    v_accvgpr_write_b32 a70, v122
    v_perm_b32 v123, v23, v22, s35
    v_accvgpr_write_b32 a71, v123
    v_perm_b32 v120, v25, v24, s34
    v_accvgpr_write_b32 a72, v120
    v_perm_b32 v121, v27, v26, s34
    v_accvgpr_write_b32 a73, v121
    v_perm_b32 v122, v29, v28, s34
    v_accvgpr_write_b32 a74, v122
    v_perm_b32 v123, v31, v30, s34
    v_accvgpr_write_b32 a75, v123
    v_perm_b32 v120, v25, v24, s35
    v_accvgpr_write_b32 a76, v120
    v_perm_b32 v121, v27, v26, s35
    v_accvgpr_write_b32 a77, v121
    v_perm_b32 v122, v29, v28, s35
    v_accvgpr_write_b32 a78, v122
    v_perm_b32 v123, v31, v30, s35
    v_accvgpr_write_b32 a79, v123
    s_waitcnt vmcnt(32)
    v_perm_b32 v120, v33, v32, s34
    v_accvgpr_write_b32 a80, v120
    v_perm_b32 v121, v35, v34, s34
    v_accvgpr_write_b32 a81, v121
    v_perm_b32 v122, v37, v36, s34
    v_accvgpr_write_b32 a82, v122
    v_perm_b32 v123, v39, v38, s34
    v_accvgpr_write_b32 a83, v123
    v_perm_b32 v120, v33, v32, s35
    v_accvgpr_write_b32 a84, v120
    v_perm_b32 v121, v35, v34, s35
    v_accvgpr_write_b32 a85, v121
    v_perm_b32 v122, v37, v36, s35
    v_accvgpr_write_b32 a86, v122
    v_perm_b32 v123, v39, v38, s35
    v_accvgpr_write_b32 a87, v123
    v_perm_b32 v120, v41, v40, s34
    v_accvgpr_write_b32 a88, v120
    v_perm_b32 v121, v43, v42, s34
    v_accvgpr_write_b32 a89, v121
    v_perm_b32 v122, v45, v44, s34
    v_accvgpr_write_b32 a90, v122
    v_perm_b32 v123, v47, v46, s34
    v_accvgpr_write_b32 a91, v123
    v_perm_b32 v120, v41, v40, s35
    v_accvgpr_write_b32 a92, v120
    v_perm_b32 v121, v43, v42, s35
    v_accvgpr_write_b32 a93, v121
    v_perm_b32 v122, v45, v44, s35
    v_accvgpr_write_b32 a94, v122
    v_perm_b32 v123, v47, v46, s35
    v_accvgpr_write_b32 a95, v123
    s_waitcnt vmcnt(16)
    v_perm_b32 v120, v49, v48, s34
    v_accvgpr_write_b32 a96, v120
    v_perm_b32 v121, v51, v50, s34
    v_accvgpr_write_b32 a97, v121
    v_perm_b32 v122, v53, v52, s34
    v_accvgpr_write_b32 a98, v122
    v_perm_b32 v123, v55, v54, s34
    v_accvgpr_write_b32 a99, v123
    v_perm_b32 v120, v49, v48, s35
    v_accvgpr_write_b32 a100, v120
    v_perm_b32 v121, v51, v50, s35
    v_accvgpr_write_b32 a101, v121
    v_perm_b32 v122, v53, v52, s35
    v_accvgpr_write_b32 a102, v122
    v_perm_b32 v123, v55, v54, s35
    v_accvgpr_write_b32 a103, v123
    v_perm_b32 v120, v57, v56, s34
    v_accvgpr_write_b32 a104, v120
    v_perm_b32 v121, v59, v58, s34
    v_accvgpr_write_b32 a105, v121
    v_perm_b32 v122, v61, v60, s34
    v_accvgpr_write_b32 a106, v122
    v_perm_b32 v123, v63, v62, s34
    v_accvgpr_write_b32 a107, v123
    v_perm_b32 v120, v57, v56, s35
    v_accvgpr_write_b32 a108, v120
    v_perm_b32 v121, v59, v58, s35
    v_accvgpr_write_b32 a109, v121
    v_perm_b32 v122, v61, v60, s35
    v_accvgpr_write_b32 a110, v122
    v_perm_b32 v123, v63, v62, s35
    v_accvgpr_write_b32 a111, v123
    s_waitcnt vmcnt(0)
    v_perm_b32 v120, v65, v64, s34
    v_accvgpr_write_b32 a112, v120
    v_perm_b32 v121, v67, v66, s34
    v_accvgpr_write_b32 a113, v121
    v_perm_b32 v122, v69, v68, s34
    v_accvgpr_write_b32 a114, v122
    v_perm_b32 v123, v71, v70, s34
    v_accvgpr_write_b32 a115, v123
    v_perm_b32 v120, v65, v64, s35
    v_accvgpr_write_b32 a116, v120
    v_perm_b32 v121, v67, v66, s35
    v_accvgpr_write_b32 a117, v121
    v_perm_b32 v122, v69, v68, s35
    v_accvgpr_write_b32 a118, v122
    v_perm_b32 v123, v71, v70, s35
    v_accvgpr_write_b32 a119, v123
    v_perm_b32 v120, v73, v72, s34
    v_accvgpr_write_b32 a120, v120
    v_perm_b32 v121, v75, v74, s34
    v_accvgpr_write_b32 a121, v121
    v_perm_b32 v122, v77, v76, s34
    v_accvgpr_write_b32 a122, v122
    v_perm_b32 v123, v79, v78, s34
    v_accvgpr_write_b32 a123, v123
    v_perm_b32 v120, v73, v72, s35
    v_accvgpr_write_b32 a124, v120
    v_perm_b32 v121, v75, v74, s35
    v_accvgpr_write_b32 a125, v121
    v_perm_b32 v122, v77, v76, s35
    v_accvgpr_write_b32 a126, v122
    v_perm_b32 v123, v79, v78, s35
    v_accvgpr_write_b32 a127, v123
    s_mov_b32 s96, s54
    s_and_b32 s97, s55, 0xffff
    s_mov_b32 s98, 0x400000
    s_mov_b32 s99, 0x20000
    v_mov_b32 v15, 0x0
    v_bfe_u32 v14, v0, 0, 1
    s_mov_b32 s38, 0x10
    v_mad_u32_u24 v15, v14, s38, v15
    v_bfe_u32 v14, v0, 1, 1
    s_mov_b32 s38, 0x20
    v_mad_u32_u24 v15, v14, s38, v15
    v_bfe_u32 v14, v0, 2, 1
    s_mov_b32 s38, 0x40
    v_mad_u32_u24 v15, v14, s38, v15
    v_bfe_u32 v14, v0, 3, 1
    s_mov_b32 s38, 0x80
    v_mad_u32_u24 v15, v14, s38, v15
    v_bfe_u32 v14, v0, 4, 1
    s_mov_b32 s38, 0x2000
    v_mad_u32_u24 v15, v14, s38, v15
    v_bfe_u32 v14, v0, 5, 1
    s_mov_b32 s38, 0x4000
    v_mad_u32_u24 v15, v14, s38, v15
    v_bfe_u32 v14, v0, 6, 1
    s_mov_b32 s38, 0x100
    v_mad_u32_u24 v15, v14, s38, v15
    v_bfe_u32 v14, v0, 7, 1
    s_mov_b32 s38, 0x200
    v_mad_u32_u24 v15, v14, s38, v15
    s_lshl_b32 s36, s20, 17
    s_add_u32 s37, s36, 0x0
    buffer_load_dwordx4 v[16:19], v15, s[96:99], s37 offen
    s_add_u32 s37, s36, 0x400
    buffer_load_dwordx4 v[20:23], v15, s[96:99], s37 offen
    s_add_u32 s37, s36, 0x800
    buffer_load_dwordx4 v[24:27], v15, s[96:99], s37 offen
    s_add_u32 s37, s36, 0xc00
    buffer_load_dwordx4 v[28:31], v15, s[96:99], s37 offen
    s_add_u32 s37, s36, 0x1000
    buffer_load_dwordx4 v[32:35], v15, s[96:99], s37 offen
    s_add_u32 s37, s36, 0x1400
    buffer_load_dwordx4 v[36:39], v15, s[96:99], s37 offen
    s_add_u32 s37, s36, 0x1800
    buffer_load_dwordx4 v[40:43], v15, s[96:99], s37 offen
    s_add_u32 s37, s36, 0x1c00
    buffer_load_dwordx4 v[44:47], v15, s[96:99], s37 offen
    s_add_u32 s37, s36, 0x8000
    buffer_load_dwordx4 v[48:51], v15, s[96:99], s37 offen
    s_add_u32 s37, s36, 0x8400
    buffer_load_dwordx4 v[52:55], v15, s[96:99], s37 offen
    s_add_u32 s37, s36, 0x8800
    buffer_load_dwordx4 v[56:59], v15, s[96:99], s37 offen
    s_add_u32 s37, s36, 0x8c00
    buffer_load_dwordx4 v[60:63], v15, s[96:99], s37 offen
    s_add_u32 s37, s36, 0x9000
    buffer_load_dwordx4 v[64:67], v15, s[96:99], s37 offen
    s_add_u32 s37, s36, 0x9400
    buffer_load_dwordx4 v[68:71], v15, s[96:99], s37 offen
    s_add_u32 s37, s36, 0x9800
    buffer_load_dwordx4 v[72:75], v15, s[96:99], s37 offen
    s_add_u32 s37, s36, 0x9c00
    buffer_load_dwordx4 v[76:79], v15, s[96:99], s37 offen
    s_add_u32 s37, s36, 0x10000
    buffer_load_dwordx4 v[80:83], v15, s[96:99], s37 offen
    s_add_u32 s37, s36, 0x10400
    buffer_load_dwordx4 v[84:87], v15, s[96:99], s37 offen
    s_add_u32 s37, s36, 0x10800
    buffer_load_dwordx4 v[88:91], v15, s[96:99], s37 offen
    s_add_u32 s37, s36, 0x10c00
    buffer_load_dwordx4 v[92:95], v15, s[96:99], s37 offen
    s_add_u32 s37, s36, 0x11000
    buffer_load_dwordx4 v[96:99], v15, s[96:99], s37 offen
    s_add_u32 s37, s36, 0x11400
    buffer_load_dwordx4 v[100:103], v15, s[96:99], s37 offen
    s_add_u32 s37, s36, 0x11800
    buffer_load_dwordx4 v[104:107], v15, s[96:99], s37 offen
    s_add_u32 s37, s36, 0x11c00
    buffer_load_dwordx4 v[108:111], v15, s[96:99], s37 offen
    s_waitcnt vmcnt(16)
    v_perm_b32 v112, v20, v16, s34
    v_perm_b32 v113, v28, v24, s34
    v_perm_b32 v114, v36, v32, s34
    v_perm_b32 v115, v44, v40, s34
    ds_write_b128 v7, v[112:115] offset:0
    v_perm_b32 v116, v20, v16, s35
    v_perm_b32 v117, v28, v24, s35
    v_perm_b32 v118, v36, v32, s35
    v_perm_b32 v119, v44, v40, s35
    ds_write_b128 v7, v[116:119] offset:1024
    v_perm_b32 v120, v21, v17, s34
    v_perm_b32 v121, v29, v25, s34
    v_perm_b32 v122, v37, v33, s34
    v_perm_b32 v123, v45, v41, s34
    ds_write_b128 v7, v[120:123] offset:2048
    v_perm_b32 v124, v21, v17, s35
    v_perm_b32 v125, v29, v25, s35
    v_perm_b32 v126, v37, v33, s35
    v_perm_b32 v127, v45, v41, s35
    ds_write_b128 v7, v[124:127] offset:3072
    s_waitcnt lgkmcnt(0)
    v_perm_b32 v112, v22, v18, s34
    v_perm_b32 v113, v30, v26, s34
    v_perm_b32 v114, v38, v34, s34
    v_perm_b32 v115, v46, v42, s34
    ds_write_b128 v7, v[112:115] offset:4096
    v_perm_b32 v116, v22, v18, s35
    v_perm_b32 v117, v30, v26, s35
    v_perm_b32 v118, v38, v34, s35
    v_perm_b32 v119, v46, v42, s35
    ds_write_b128 v7, v[116:119] offset:5120
    v_perm_b32 v120, v23, v19, s34
    v_perm_b32 v121, v31, v27, s34
    v_perm_b32 v122, v39, v35, s34
    v_perm_b32 v123, v47, v43, s34
    ds_write_b128 v7, v[120:123] offset:6144
    v_perm_b32 v124, v23, v19, s35
    v_perm_b32 v125, v31, v27, s35
    v_perm_b32 v126, v39, v35, s35
    v_perm_b32 v127, v47, v43, s35
    ds_write_b128 v7, v[124:127] offset:7168
    s_waitcnt lgkmcnt(0)
    s_add_u32 s37, s36, 0x18000
    buffer_load_dwordx4 v[16:19], v15, s[96:99], s37 offen
    s_add_u32 s37, s36, 0x18400
    buffer_load_dwordx4 v[20:23], v15, s[96:99], s37 offen
    s_add_u32 s37, s36, 0x18800
    buffer_load_dwordx4 v[24:27], v15, s[96:99], s37 offen
    s_add_u32 s37, s36, 0x18c00
    buffer_load_dwordx4 v[28:31], v15, s[96:99], s37 offen
    s_add_u32 s37, s36, 0x19000
    buffer_load_dwordx4 v[32:35], v15, s[96:99], s37 offen
    s_add_u32 s37, s36, 0x19400
    buffer_load_dwordx4 v[36:39], v15, s[96:99], s37 offen
    s_add_u32 s37, s36, 0x19800
    buffer_load_dwordx4 v[40:43], v15, s[96:99], s37 offen
    s_add_u32 s37, s36, 0x19c00
    buffer_load_dwordx4 v[44:47], v15, s[96:99], s37 offen
    s_waitcnt vmcnt(16)
    v_perm_b32 v112, v52, v48, s34
    v_perm_b32 v113, v60, v56, s34
    v_perm_b32 v114, v68, v64, s34
    v_perm_b32 v115, v76, v72, s34
    ds_write_b128 v7, v[112:115] offset:8192
    v_perm_b32 v116, v52, v48, s35
    v_perm_b32 v117, v60, v56, s35
    v_perm_b32 v118, v68, v64, s35
    v_perm_b32 v119, v76, v72, s35
    ds_write_b128 v7, v[116:119] offset:9216
    v_perm_b32 v120, v53, v49, s34
    v_perm_b32 v121, v61, v57, s34
    v_perm_b32 v122, v69, v65, s34
    v_perm_b32 v123, v77, v73, s34
    ds_write_b128 v7, v[120:123] offset:10240
    v_perm_b32 v124, v53, v49, s35
    v_perm_b32 v125, v61, v57, s35
    v_perm_b32 v126, v69, v65, s35
    v_perm_b32 v127, v77, v73, s35
    ds_write_b128 v7, v[124:127] offset:11264
    s_waitcnt lgkmcnt(0)
    v_perm_b32 v112, v54, v50, s34
    v_perm_b32 v113, v62, v58, s34
    v_perm_b32 v114, v70, v66, s34
    v_perm_b32 v115, v78, v74, s34
    ds_write_b128 v7, v[112:115] offset:12288
    v_perm_b32 v116, v54, v50, s35
    v_perm_b32 v117, v62, v58, s35
    v_perm_b32 v118, v70, v66, s35
    v_perm_b32 v119, v78, v74, s35
    ds_write_b128 v7, v[116:119] offset:13312
    v_perm_b32 v120, v55, v51, s34
    v_perm_b32 v121, v63, v59, s34
    v_perm_b32 v122, v71, v67, s34
    v_perm_b32 v123, v79, v75, s34
    ds_write_b128 v7, v[120:123] offset:14336
    v_perm_b32 v124, v55, v51, s35
    v_perm_b32 v125, v63, v59, s35
    v_perm_b32 v126, v71, v67, s35
    v_perm_b32 v127, v79, v75, s35
    ds_write_b128 v7, v[124:127] offset:15360
    s_waitcnt lgkmcnt(0)
    s_waitcnt vmcnt(8)
    v_perm_b32 v112, v84, v80, s34
    v_perm_b32 v113, v92, v88, s34
    v_perm_b32 v114, v100, v96, s34
    v_perm_b32 v115, v108, v104, s34
    ds_write_b128 v7, v[112:115] offset:16384
    v_perm_b32 v116, v84, v80, s35
    v_perm_b32 v117, v92, v88, s35
    v_perm_b32 v118, v100, v96, s35
    v_perm_b32 v119, v108, v104, s35
    ds_write_b128 v7, v[116:119] offset:17408
    v_perm_b32 v120, v85, v81, s34
    v_perm_b32 v121, v93, v89, s34
    v_perm_b32 v122, v101, v97, s34
    v_perm_b32 v123, v109, v105, s34
    ds_write_b128 v7, v[120:123] offset:18432
    v_perm_b32 v124, v85, v81, s35
    v_perm_b32 v125, v93, v89, s35
    v_perm_b32 v126, v101, v97, s35
    v_perm_b32 v127, v109, v105, s35
    ds_write_b128 v7, v[124:127] offset:19456
    s_waitcnt lgkmcnt(0)
    v_perm_b32 v112, v86, v82, s34
    v_perm_b32 v113, v94, v90, s34
    v_perm_b32 v114, v102, v98, s34
    v_perm_b32 v115, v110, v106, s34
    ds_write_b128 v7, v[112:115] offset:20480
    v_perm_b32 v116, v86, v82, s35
    v_perm_b32 v117, v94, v90, s35
    v_perm_b32 v118, v102, v98, s35
    v_perm_b32 v119, v110, v106, s35
    ds_write_b128 v7, v[116:119] offset:21504
    v_perm_b32 v120, v87, v83, s34
    v_perm_b32 v121, v95, v91, s34
    v_perm_b32 v122, v103, v99, s34
    v_perm_b32 v123, v111, v107, s34
    ds_write_b128 v7, v[120:123] offset:22528
    v_perm_b32 v124, v87, v83, s35
    v_perm_b32 v125, v95, v91, s35
    v_perm_b32 v126, v103, v99, s35
    v_perm_b32 v127, v111, v107, s35
    ds_write_b128 v7, v[124:127] offset:23552
    s_waitcnt lgkmcnt(0)
    s_waitcnt vmcnt(0)
    v_perm_b32 v112, v20, v16, s34
    v_perm_b32 v113, v28, v24, s34
    v_perm_b32 v114, v36, v32, s34
    v_perm_b32 v115, v44, v40, s34
    ds_write_b128 v7, v[112:115] offset:24576
    v_perm_b32 v116, v20, v16, s35
    v_perm_b32 v117, v28, v24, s35
    v_perm_b32 v118, v36, v32, s35
    v_perm_b32 v119, v44, v40, s35
    ds_write_b128 v7, v[116:119] offset:25600
    v_perm_b32 v120, v21, v17, s34
    v_perm_b32 v121, v29, v25, s34
    v_perm_b32 v122, v37, v33, s34
    v_perm_b32 v123, v45, v41, s34
    ds_write_b128 v7, v[120:123] offset:26624
    v_perm_b32 v124, v21, v17, s35
    v_perm_b32 v125, v29, v25, s35
    v_perm_b32 v126, v37, v33, s35
    v_perm_b32 v127, v45, v41, s35
    ds_write_b128 v7, v[124:127] offset:27648
    s_waitcnt lgkmcnt(0)
    v_perm_b32 v112, v22, v18, s34
    v_perm_b32 v113, v30, v26, s34
    v_perm_b32 v114, v38, v34, s34
    v_perm_b32 v115, v46, v42, s34
    ds_write_b128 v7, v[112:115] offset:28672
    v_perm_b32 v116, v22, v18, s35
    v_perm_b32 v117, v30, v26, s35
    v_perm_b32 v118, v38, v34, s35
    v_perm_b32 v119, v46, v42, s35
    ds_write_b128 v7, v[116:119] offset:29696
    v_perm_b32 v120, v23, v19, s34
    v_perm_b32 v121, v31, v27, s34
    v_perm_b32 v122, v39, v35, s34
    v_perm_b32 v123, v47, v43, s34
    ds_write_b128 v7, v[120:123] offset:30720
    v_perm_b32 v124, v23, v19, s35
    v_perm_b32 v125, v31, v27, s35
    v_perm_b32 v126, v39, v35, s35
    v_perm_b32 v127, v47, v43, s35
    ds_write_b128 v7, v[124:127] offset:31744
    s_waitcnt lgkmcnt(0)
    s_mov_b32 s23, s22
L_P2:
    s_lshl_b32 s36, s23, 15
    buffer_load_dwordx4 v[16:19], v3, s[12:15], s36 offen offset:0
    buffer_load_dwordx4 v[20:23], v3, s[12:15], s36 offen offset:128
    buffer_load_dwordx4 v[24:27], v3, s[12:15], s36 offen offset:256
    buffer_load_dwordx4 v[28:31], v3, s[12:15], s36 offen offset:384
    buffer_load_dwordx4 v[32:35], v3, s[12:15], s36 offen offset:512
    buffer_load_dwordx4 v[36:39], v3, s[12:15], s36 offen offset:640
    buffer_load_dwordx4 v[40:43], v3, s[12:15], s36 offen offset:768
    buffer_load_dwordx4 v[44:47], v3, s[12:15], s36 offen offset:896
    v_mov_b32 v48, 0
    v_mov_b32 v49, 0
    s_waitcnt vmcnt(7)
    v_dot2_f32_bf16 v48, v16, s4, v48
    v_dot2_f32_bf16 v49, v16, v16, v49
    v_dot2_f32_bf16 v48, v17, s4, v48
    v_dot2_f32_bf16 v49, v17, v17, v49
    v_dot2_f32_bf16 v48, v18, s4, v48
    v_dot2_f32_bf16 v49, v18, v18, v49
    v_dot2_f32_bf16 v48, v19, s4, v48
    v_dot2_f32_bf16 v49, v19, v19, v49
    s_waitcnt vmcnt(6)
    v_dot2_f32_bf16 v48, v20, s4, v48
    v_dot2_f32_bf16 v49, v20, v20, v49
    v_dot2_f32_bf16 v48, v21, s4, v48
    v_dot2_f32_bf16 v49, v21, v21, v49
    v_dot2_f32_bf16 v48, v22, s4, v48
    v_dot2_f32_bf16 v49, v22, v22, v49
    v_dot2_f32_bf16 v48, v23, s4, v48
    v_dot2_f32_bf16 v49, v23, v23, v49
    s_waitcnt vmcnt(5)
    v_dot2_f32_bf16 v48, v24, s4, v48
    v_dot2_f32_bf16 v49, v24, v24, v49
    v_dot2_f32_bf16 v48, v25, s4, v48
    v_dot2_f32_bf16 v49, v25, v25, v49
    v_dot2_f32_bf16 v48, v26, s4, v48
    v_dot2_f32_bf16 v49, v26, v26, v49
    v_dot2_f32_bf16 v48, v27, s4, v48
    v_dot2_f32_bf16 v49, v27, v27, v49
    s_waitcnt vmcnt(4)
    v_dot2_f32_bf16 v48, v28, s4, v48
    v_dot2_f32_bf16 v49, v28, v28, v49
    v_dot2_f32_bf16 v48, v29, s4, v48
    v_dot2_f32_bf16 v49, v29, v29, v49
    v_dot2_f32_bf16 v48, v30, s4, v48
    v_dot2_f32_bf16 v49, v30, v30, v49
    v_dot2_f32_bf16 v48, v31, s4, v48
    v_dot2_f32_bf16 v49, v31, v31, v49
    s_waitcnt vmcnt(3)
    v_dot2_f32_bf16 v48, v32, s4, v48
    v_dot2_f32_bf16 v49, v32, v32, v49
    v_dot2_f32_bf16 v48, v33, s4, v48
    v_dot2_f32_bf16 v49, v33, v33, v49
    v_dot2_f32_bf16 v48, v34, s4, v48
    v_dot2_f32_bf16 v49, v34, v34, v49
    v_dot2_f32_bf16 v48, v35, s4, v48
    v_dot2_f32_bf16 v49, v35, v35, v49
    s_waitcnt vmcnt(2)
    v_dot2_f32_bf16 v48, v36, s4, v48
    v_dot2_f32_bf16 v49, v36, v36, v49
    v_dot2_f32_bf16 v48, v37, s4, v48
    v_dot2_f32_bf16 v49, v37, v37, v49
    v_dot2_f32_bf16 v48, v38, s4, v48
    v_dot2_f32_bf16 v49, v38, v38, v49
    v_dot2_f32_bf16 v48, v39, s4, v48
    v_dot2_f32_bf16 v49, v39, v39, v49
    s_waitcnt vmcnt(1)
    v_dot2_f32_bf16 v48, v40, s4, v48
    v_dot2_f32_bf16 v49, v40, v40, v49
    v_dot2_f32_bf16 v48, v41, s4, v48
    v_dot2_f32_bf16 v49, v41, v41, v49
    v_dot2_f32_bf16 v48, v42, s4, v48
    v_dot2_f32_bf16 v49, v42, v42, v49
    v_dot2_f32_bf16 v48, v43, s4, v48
    v_dot2_f32_bf16 v49, v43, v43, v49
    s_waitcnt vmcnt(0)
    v_dot2_f32_bf16 v48, v44, s4, v48
    v_dot2_f32_bf16 v49, v44, v44, v49
    v_dot2_f32_bf16 v48, v45, s4, v48
    v_dot2_f32_bf16 v49, v45, v45, v49
    v_dot2_f32_bf16 v48, v46, s4, v48
    v_dot2_f32_bf16 v49, v46, v46, v49
    v_dot2_f32_bf16 v48, v47, s4, v48
    v_dot2_f32_bf16 v49, v47, v47, v49
    s_nop 3
    v_add_f32_dpp v48, v48, v48 quad_perm:[1,0,3,2] row_mask:0xf bank_mask:0xf
    v_add_f32_dpp v49, v49, v49 quad_perm:[1,0,3,2] row_mask:0xf bank_mask:0xf
    s_nop 0
    v_add_f32_dpp v48, v48, v48 quad_perm:[2,3,0,1] row_mask:0xf bank_mask:0xf
    v_add_f32_dpp v49, v49, v49 quad_perm:[2,3,0,1] row_mask:0xf bank_mask:0xf
    s_nop 0
    v_add_f32_dpp v48, v48, v48 row_half_mirror row_mask:0xf bank_mask:0xf
    v_add_f32_dpp v49, v49, v49 row_half_mirror row_mask:0xf bank_mask:0xf
    v_mul_f32 v48, 0x3b000000, v48
    v_mul_f32 v49, 0x3b000000, v49
    v_fma_f32 v49, -v48, v48, v49
    v_max_f32 v49, 0, v49
    v_add_f32 v49, 0x3727c5ac, v49
    v_rsq_f32 v50, v49
    s_nop 0
    v_mul_f32 v51, v48, v50
    v_lshlrev_b32 v52, 16, v16
    v_and_b32 v53, 0xffff0000, v16
    v_fma_f32 v52, v52, v50, -v51
    v_fma_f32 v53, v53, v50, -v51
    v_cvt_pk_bf16_f32 v16, v52, v53
    v_lshlrev_b32 v52, 16, v17
    v_and_b32 v53, 0xffff0000, v17
    v_fma_f32 v52, v52, v50, -v51
    v_fma_f32 v53, v53, v50, -v51
    v_cvt_pk_bf16_f32 v17, v52, v53
    v_lshlrev_b32 v52, 16, v18
    v_and_b32 v53, 0xffff0000, v18
    v_fma_f32 v52, v52, v50, -v51
    v_fma_f32 v53, v53, v50, -v51
    v_cvt_pk_bf16_f32 v18, v52, v53
    v_lshlrev_b32 v52, 16, v19
    v_and_b32 v53, 0xffff0000, v19
    v_fma_f32 v52, v52, v50, -v51
    v_fma_f32 v53, v53, v50, -v51
    v_cvt_pk_bf16_f32 v19, v52, v53
    ds_write_b128 v4, v[16:19] offset:0
    v_lshlrev_b32 v52, 16, v20
    v_and_b32 v53, 0xffff0000, v20
    v_fma_f32 v52, v52, v50, -v51
    v_fma_f32 v53, v53, v50, -v51
    v_cvt_pk_bf16_f32 v20, v52, v53
    v_lshlrev_b32 v52, 16, v21
    v_and_b32 v53, 0xffff0000, v21
    v_fma_f32 v52, v52, v50, -v51
    v_fma_f32 v53, v53, v50, -v51
    v_cvt_pk_bf16_f32 v21, v52, v53
    v_lshlrev_b32 v52, 16, v22
    v_and_b32 v53, 0xffff0000, v22
    v_fma_f32 v52, v52, v50, -v51
    v_fma_f32 v53, v53, v50, -v51
    v_cvt_pk_bf16_f32 v22, v52, v53
    v_lshlrev_b32 v52, 16, v23
    v_and_b32 v53, 0xffff0000, v23
    v_fma_f32 v52, v52, v50, -v51
    v_fma_f32 v53, v53, v50, -v51
    v_cvt_pk_bf16_f32 v23, v52, v53
    ds_write_b128 v4, v[20:23] offset:2048
    v_lshlrev_b32 v52, 16, v24
    v_and_b32 v53, 0xffff0000, v24
    v_fma_f32 v52, v52, v50, -v51
    v_fma_f32 v53, v53, v50, -v51
    v_cvt_pk_bf16_f32 v24, v52, v53
    v_lshlrev_b32 v52, 16, v25
    v_and_b32 v53, 0xffff0000, v25
    v_fma_f32 v52, v52, v50, -v51
    v_fma_f32 v53, v53, v50, -v51
    v_cvt_pk_bf16_f32 v25, v52, v53
    v_lshlrev_b32 v52, 16, v26
    v_and_b32 v53, 0xffff0000, v26
    v_fma_f32 v52, v52, v50, -v51
    v_fma_f32 v53, v53, v50, -v51
    v_cvt_pk_bf16_f32 v26, v52, v53
    v_lshlrev_b32 v52, 16, v27
    v_and_b32 v53, 0xffff0000, v27
    v_fma_f32 v52, v52, v50, -v51
    v_fma_f32 v53, v53, v50, -v51
    v_cvt_pk_bf16_f32 v27, v52, v53
    ds_write_b128 v4, v[24:27] offset:4096
    v_lshlrev_b32 v52, 16, v28
    v_and_b32 v53, 0xffff0000, v28
    v_fma_f32 v52, v52, v50, -v51
    v_fma_f32 v53, v53, v50, -v51
    v_cvt_pk_bf16_f32 v28, v52, v53
    v_lshlrev_b32 v52, 16, v29
    v_and_b32 v53, 0xffff0000, v29
    v_fma_f32 v52, v52, v50, -v51
    v_fma_f32 v53, v53, v50, -v51
    v_cvt_pk_bf16_f32 v29, v52, v53
    v_lshlrev_b32 v52, 16, v30
    v_and_b32 v53, 0xffff0000, v30
    v_fma_f32 v52, v52, v50, -v51
    v_fma_f32 v53, v53, v50, -v51
    v_cvt_pk_bf16_f32 v30, v52, v53
    v_lshlrev_b32 v52, 16, v31
    v_and_b32 v53, 0xffff0000, v31
    v_fma_f32 v52, v52, v50, -v51
    v_fma_f32 v53, v53, v50, -v51
    v_cvt_pk_bf16_f32 v31, v52, v53
    ds_write_b128 v4, v[28:31] offset:6144
    v_lshlrev_b32 v52, 16, v32
    v_and_b32 v53, 0xffff0000, v32
    v_fma_f32 v52, v52, v50, -v51
    v_fma_f32 v53, v53, v50, -v51
    v_cvt_pk_bf16_f32 v32, v52, v53
    v_lshlrev_b32 v52, 16, v33
    v_and_b32 v53, 0xffff0000, v33
    v_fma_f32 v52, v52, v50, -v51
    v_fma_f32 v53, v53, v50, -v51
    v_cvt_pk_bf16_f32 v33, v52, v53
    v_lshlrev_b32 v52, 16, v34
    v_and_b32 v53, 0xffff0000, v34
    v_fma_f32 v52, v52, v50, -v51
    v_fma_f32 v53, v53, v50, -v51
    v_cvt_pk_bf16_f32 v34, v52, v53
    v_lshlrev_b32 v52, 16, v35
    v_and_b32 v53, 0xffff0000, v35
    v_fma_f32 v52, v52, v50, -v51
    v_fma_f32 v53, v53, v50, -v51
    v_cvt_pk_bf16_f32 v35, v52, v53
    ds_write_b128 v4, v[32:35] offset:8192
    v_lshlrev_b32 v52, 16, v36
    v_and_b32 v53, 0xffff0000, v36
    v_fma_f32 v52, v52, v50, -v51
    v_fma_f32 v53, v53, v50, -v51
    v_cvt_pk_bf16_f32 v36, v52, v53
    v_lshlrev_b32 v52, 16, v37
    v_and_b32 v53, 0xffff0000, v37
    v_fma_f32 v52, v52, v50, -v51
    v_fma_f32 v53, v53, v50, -v51
    v_cvt_pk_bf16_f32 v37, v52, v53
    v_lshlrev_b32 v52, 16, v38
    v_and_b32 v53, 0xffff0000, v38
    v_fma_f32 v52, v52, v50, -v51
    v_fma_f32 v53, v53, v50, -v51
    v_cvt_pk_bf16_f32 v38, v52, v53
    v_lshlrev_b32 v52, 16, v39
    v_and_b32 v53, 0xffff0000, v39
    v_fma_f32 v52, v52, v50, -v51
    v_fma_f32 v53, v53, v50, -v51
    v_cvt_pk_bf16_f32 v39, v52, v53
    ds_write_b128 v4, v[36:39] offset:10240
    v_lshlrev_b32 v52, 16, v40
    v_and_b32 v53, 0xffff0000, v40
    v_fma_f32 v52, v52, v50, -v51
    v_fma_f32 v53, v53, v50, -v51
    v_cvt_pk_bf16_f32 v40, v52, v53
    v_lshlrev_b32 v52, 16, v41
    v_and_b32 v53, 0xffff0000, v41
    v_fma_f32 v52, v52, v50, -v51
    v_fma_f32 v53, v53, v50, -v51
    v_cvt_pk_bf16_f32 v41, v52, v53
    v_lshlrev_b32 v52, 16, v42
    v_and_b32 v53, 0xffff0000, v42
    v_fma_f32 v52, v52, v50, -v51
    v_fma_f32 v53, v53, v50, -v51
    v_cvt_pk_bf16_f32 v42, v52, v53
    v_lshlrev_b32 v52, 16, v43
    v_and_b32 v53, 0xffff0000, v43
    v_fma_f32 v52, v52, v50, -v51
    v_fma_f32 v53, v53, v50, -v51
    v_cvt_pk_bf16_f32 v43, v52, v53
    ds_write_b128 v4, v[40:43] offset:12288
    v_lshlrev_b32 v52, 16, v44
    v_and_b32 v53, 0xffff0000, v44
    v_fma_f32 v52, v52, v50, -v51
    v_fma_f32 v53, v53, v50, -v51
    v_cvt_pk_bf16_f32 v44, v52, v53
    v_lshlrev_b32 v52, 16, v45
    v_and_b32 v53, 0xffff0000, v45
    v_fma_f32 v52, v52, v50, -v51
    v_fma_f32 v53, v53, v50, -v51
    v_cvt_pk_bf16_f32 v45, v52, v53
    v_lshlrev_b32 v52, 16, v46
    v_and_b32 v53, 0xffff0000, v46
    v_fma_f32 v52, v52, v50, -v51
    v_fma_f32 v53, v53, v50, -v51
    v_cvt_pk_bf16_f32 v46, v52, v53
    v_lshlrev_b32 v52, 16, v47
    v_and_b32 v53, 0xffff0000, v47
    v_fma_f32 v52, v52, v50, -v51
    v_fma_f32 v53, v53, v50, -v51
    v_cvt_pk_bf16_f32 v47, v52, v53
    ds_write_b128 v4, v[44:47] offset:14336
    v_add_u32 v80, 16384, v5
    v_add_u32 v81, 16384, v6
    s_waitcnt lgkmcnt(0)
    s_barrier
    ds_read_b128 v[64:67], v5 offset:0
    ds_read_b128 v[68:71], v80 offset:0
    ds_read_b128 v[72:75], v6 offset:1024
    ds_read_b128 v[76:79], v81 offset:1024
    s_waitcnt lgkmcnt(2)
    v_mfma_f32_16x16x32_bf16 v[16:19], a[0:3], v[64:67], 0
    v_mfma_f32_16x16x32_bf16 v[20:23], a[0:3], v[68:71], 0
    v_mfma_f32_16x16x32_bf16 v[24:27], a[4:7], v[64:67], 0
    v_mfma_f32_16x16x32_bf16 v[28:31], a[4:7], v[68:71], 0
    v_mfma_f32_16x16x32_bf16 v[32:35], a[128:131], v[64:67], 0
    v_mfma_f32_16x16x32_bf16 v[36:39], a[128:131], v[68:71], 0
    v_mfma_f32_16x16x32_bf16 v[40:43], a[132:135], v[64:67], 0
    v_mfma_f32_16x16x32_bf16 v[44:47], a[132:135], v[68:71], 0
    v_mfma_f32_16x16x32_bf16 v[48:51], v[64:67], v[128:131], 0
    v_mfma_f32_16x16x32_bf16 v[56:59], v[68:71], v[128:131], 0
    v_mfma_f32_16x16x32_bf16 v[52:55], v[64:67], v[132:135], 0
    v_mfma_f32_16x16x32_bf16 v[60:63], v[68:71], v[132:135], 0
    ds_read_b128 v[64:67], v5 offset:2048
    ds_read_b128 v[68:71], v80 offset:2048
    s_waitcnt lgkmcnt(2)
    v_mfma_f32_16x16x32_bf16 v[16:19], a[8:11], v[72:75], v[16:19]
    v_mfma_f32_16x16x32_bf16 v[20:23], a[8:11], v[76:79], v[20:23]
    v_mfma_f32_16x16x32_bf16 v[24:27], a[12:15], v[72:75], v[24:27]
    v_mfma_f32_16x16x32_bf16 v[28:31], a[12:15], v[76:79], v[28:31]
    v_mfma_f32_16x16x32_bf16 v[32:35], a[136:139], v[72:75], v[32:35]
    v_mfma_f32_16x16x32_bf16 v[36:39], a[136:139], v[76:79], v[36:39]
    v_mfma_f32_16x16x32_bf16 v[40:43], a[140:143], v[72:75], v[40:43]
    v_mfma_f32_16x16x32_bf16 v[44:47], a[140:143], v[76:79], v[44:47]
    v_mfma_f32_16x16x32_bf16 v[48:51], v[72:75], v[136:139], v[48:51]
    v_mfma_f32_16x16x32_bf16 v[56:59], v[76:79], v[136:139], v[56:59]
    v_mfma_f32_16x16x32_bf16 v[52:55], v[72:75], v[140:143], v[52:55]
    v_mfma_f32_16x16x32_bf16 v[60:63], v[76:79], v[140:143], v[60:63]
    ds_read_b128 v[72:75], v6 offset:3072
    ds_read_b128 v[76:79], v81 offset:3072
    s_waitcnt lgkmcnt(2)
    v_mfma_f32_16x16x32_bf16 v[16:19], a[16:19], v[64:67], v[16:19]
    v_mfma_f32_16x16x32_bf16 v[20:23], a[16:19], v[68:71], v[20:23]
    v_mfma_f32_16x16x32_bf16 v[24:27], a[20:23], v[64:67], v[24:27]
    v_mfma_f32_16x16x32_bf16 v[28:31], a[20:23], v[68:71], v[28:31]
    v_mfma_f32_16x16x32_bf16 v[32:35], a[144:147], v[64:67], v[32:35]
    v_mfma_f32_16x16x32_bf16 v[36:39], a[144:147], v[68:71], v[36:39]
    v_mfma_f32_16x16x32_bf16 v[40:43], a[148:151], v[64:67], v[40:43]
    v_mfma_f32_16x16x32_bf16 v[44:47], a[148:151], v[68:71], v[44:47]
    v_mfma_f32_16x16x32_bf16 v[48:51], v[64:67], v[144:147], v[48:51]
    v_mfma_f32_16x16x32_bf16 v[56:59], v[68:71], v[144:147], v[56:59]
    v_mfma_f32_16x16x32_bf16 v[52:55], v[64:67], v[148:151], v[52:55]
    v_mfma_f32_16x16x32_bf16 v[60:63], v[68:71], v[148:151], v[60:63]
    ds_read_b128 v[64:67], v5 offset:4096
    ds_read_b128 v[68:71], v80 offset:4096
    s_waitcnt lgkmcnt(2)
    v_mfma_f32_16x16x32_bf16 v[16:19], a[24:27], v[72:75], v[16:19]
    v_mfma_f32_16x16x32_bf16 v[20:23], a[24:27], v[76:79], v[20:23]
    v_mfma_f32_16x16x32_bf16 v[24:27], a[28:31], v[72:75], v[24:27]
    v_mfma_f32_16x16x32_bf16 v[28:31], a[28:31], v[76:79], v[28:31]
    v_mfma_f32_16x16x32_bf16 v[32:35], a[152:155], v[72:75], v[32:35]
    v_mfma_f32_16x16x32_bf16 v[36:39], a[152:155], v[76:79], v[36:39]
    v_mfma_f32_16x16x32_bf16 v[40:43], a[156:159], v[72:75], v[40:43]
    v_mfma_f32_16x16x32_bf16 v[44:47], a[156:159], v[76:79], v[44:47]
    v_mfma_f32_16x16x32_bf16 v[48:51], v[72:75], v[152:155], v[48:51]
    v_mfma_f32_16x16x32_bf16 v[56:59], v[76:79], v[152:155], v[56:59]
    v_mfma_f32_16x16x32_bf16 v[52:55], v[72:75], v[156:159], v[52:55]
    v_mfma_f32_16x16x32_bf16 v[60:63], v[76:79], v[156:159], v[60:63]
    ds_read_b128 v[72:75], v6 offset:5120
    ds_read_b128 v[76:79], v81 offset:5120
    s_waitcnt lgkmcnt(2)
    v_mfma_f32_16x16x32_bf16 v[16:19], a[32:35], v[64:67], v[16:19]
    v_mfma_f32_16x16x32_bf16 v[20:23], a[32:35], v[68:71], v[20:23]
    v_mfma_f32_16x16x32_bf16 v[24:27], a[36:39], v[64:67], v[24:27]
    v_mfma_f32_16x16x32_bf16 v[28:31], a[36:39], v[68:71], v[28:31]
    v_mfma_f32_16x16x32_bf16 v[32:35], a[160:163], v[64:67], v[32:35]
    v_mfma_f32_16x16x32_bf16 v[36:39], a[160:163], v[68:71], v[36:39]
    v_mfma_f32_16x16x32_bf16 v[40:43], a[164:167], v[64:67], v[40:43]
    v_mfma_f32_16x16x32_bf16 v[44:47], a[164:167], v[68:71], v[44:47]
    v_mfma_f32_16x16x32_bf16 v[48:51], v[64:67], v[160:163], v[48:51]
    v_mfma_f32_16x16x32_bf16 v[56:59], v[68:71], v[160:163], v[56:59]
    v_mfma_f32_16x16x32_bf16 v[52:55], v[64:67], v[164:167], v[52:55]
    v_mfma_f32_16x16x32_bf16 v[60:63], v[68:71], v[164:167], v[60:63]
    ds_read_b128 v[64:67], v5 offset:6144
    ds_read_b128 v[68:71], v80 offset:6144
    s_waitcnt lgkmcnt(2)
    v_mfma_f32_16x16x32_bf16 v[16:19], a[40:43], v[72:75], v[16:19]
    v_mfma_f32_16x16x32_bf16 v[20:23], a[40:43], v[76:79], v[20:23]
    v_mfma_f32_16x16x32_bf16 v[24:27], a[44:47], v[72:75], v[24:27]
    v_mfma_f32_16x16x32_bf16 v[28:31], a[44:47], v[76:79], v[28:31]
    v_mfma_f32_16x16x32_bf16 v[32:35], a[168:171], v[72:75], v[32:35]
    v_mfma_f32_16x16x32_bf16 v[36:39], a[168:171], v[76:79], v[36:39]
    v_mfma_f32_16x16x32_bf16 v[40:43], a[172:175], v[72:75], v[40:43]
    v_mfma_f32_16x16x32_bf16 v[44:47], a[172:175], v[76:79], v[44:47]
    v_mfma_f32_16x16x32_bf16 v[48:51], v[72:75], v[168:171], v[48:51]
    v_mfma_f32_16x16x32_bf16 v[56:59], v[76:79], v[168:171], v[56:59]
    v_mfma_f32_16x16x32_bf16 v[52:55], v[72:75], v[172:175], v[52:55]
    v_mfma_f32_16x16x32_bf16 v[60:63], v[76:79], v[172:175], v[60:63]
    ds_read_b128 v[72:75], v6 offset:7168
    ds_read_b128 v[76:79], v81 offset:7168
    s_waitcnt lgkmcnt(2)
    v_mfma_f32_16x16x32_bf16 v[16:19], a[48:51], v[64:67], v[16:19]
    v_mfma_f32_16x16x32_bf16 v[20:23], a[48:51], v[68:71], v[20:23]
    v_mfma_f32_16x16x32_bf16 v[24:27], a[52:55], v[64:67], v[24:27]
    v_mfma_f32_16x16x32_bf16 v[28:31], a[52:55], v[68:71], v[28:31]
    v_mfma_f32_16x16x32_bf16 v[32:35], a[176:179], v[64:67], v[32:35]
    v_mfma_f32_16x16x32_bf16 v[36:39], a[176:179], v[68:71], v[36:39]
    v_mfma_f32_16x16x32_bf16 v[40:43], a[180:183], v[64:67], v[40:43]
    v_mfma_f32_16x16x32_bf16 v[44:47], a[180:183], v[68:71], v[44:47]
    v_mfma_f32_16x16x32_bf16 v[48:51], v[64:67], v[176:179], v[48:51]
    v_mfma_f32_16x16x32_bf16 v[56:59], v[68:71], v[176:179], v[56:59]
    v_mfma_f32_16x16x32_bf16 v[52:55], v[64:67], v[180:183], v[52:55]
    v_mfma_f32_16x16x32_bf16 v[60:63], v[68:71], v[180:183], v[60:63]
    ds_read_b128 v[64:67], v5 offset:8192
    ds_read_b128 v[68:71], v80 offset:8192
    s_waitcnt lgkmcnt(2)
    v_mfma_f32_16x16x32_bf16 v[16:19], a[56:59], v[72:75], v[16:19]
    v_mfma_f32_16x16x32_bf16 v[20:23], a[56:59], v[76:79], v[20:23]
    v_mfma_f32_16x16x32_bf16 v[24:27], a[60:63], v[72:75], v[24:27]
    v_mfma_f32_16x16x32_bf16 v[28:31], a[60:63], v[76:79], v[28:31]
    v_mfma_f32_16x16x32_bf16 v[32:35], a[184:187], v[72:75], v[32:35]
    v_mfma_f32_16x16x32_bf16 v[36:39], a[184:187], v[76:79], v[36:39]
    v_mfma_f32_16x16x32_bf16 v[40:43], a[188:191], v[72:75], v[40:43]
    v_mfma_f32_16x16x32_bf16 v[44:47], a[188:191], v[76:79], v[44:47]
    v_mfma_f32_16x16x32_bf16 v[48:51], v[72:75], v[184:187], v[48:51]
    v_mfma_f32_16x16x32_bf16 v[56:59], v[76:79], v[184:187], v[56:59]
    v_mfma_f32_16x16x32_bf16 v[52:55], v[72:75], v[188:191], v[52:55]
    v_mfma_f32_16x16x32_bf16 v[60:63], v[76:79], v[188:191], v[60:63]
    ds_read_b128 v[72:75], v6 offset:9216
    ds_read_b128 v[76:79], v81 offset:9216
    s_waitcnt lgkmcnt(2)
    v_mfma_f32_16x16x32_bf16 v[16:19], a[64:67], v[64:67], v[16:19]
    v_mfma_f32_16x16x32_bf16 v[20:23], a[64:67], v[68:71], v[20:23]
    v_mfma_f32_16x16x32_bf16 v[24:27], a[68:71], v[64:67], v[24:27]
    v_mfma_f32_16x16x32_bf16 v[28:31], a[68:71], v[68:71], v[28:31]
    v_mfma_f32_16x16x32_bf16 v[32:35], a[192:195], v[64:67], v[32:35]
    v_mfma_f32_16x16x32_bf16 v[36:39], a[192:195], v[68:71], v[36:39]
    v_mfma_f32_16x16x32_bf16 v[40:43], a[196:199], v[64:67], v[40:43]
    v_mfma_f32_16x16x32_bf16 v[44:47], a[196:199], v[68:71], v[44:47]
    v_mfma_f32_16x16x32_bf16 v[48:51], v[64:67], v[192:195], v[48:51]
    v_mfma_f32_16x16x32_bf16 v[56:59], v[68:71], v[192:195], v[56:59]
    v_mfma_f32_16x16x32_bf16 v[52:55], v[64:67], v[196:199], v[52:55]
    v_mfma_f32_16x16x32_bf16 v[60:63], v[68:71], v[196:199], v[60:63]
    ds_read_b128 v[64:67], v5 offset:10240
    ds_read_b128 v[68:71], v80 offset:10240
    s_waitcnt lgkmcnt(2)
    v_mfma_f32_16x16x32_bf16 v[16:19], a[72:75], v[72:75], v[16:19]
    v_mfma_f32_16x16x32_bf16 v[20:23], a[72:75], v[76:79], v[20:23]
    v_mfma_f32_16x16x32_bf16 v[24:27], a[76:79], v[72:75], v[24:27]
    v_mfma_f32_16x16x32_bf16 v[28:31], a[76:79], v[76:79], v[28:31]
    v_mfma_f32_16x16x32_bf16 v[32:35], a[200:203], v[72:75], v[32:35]
    v_mfma_f32_16x16x32_bf16 v[36:39], a[200:203], v[76:79], v[36:39]
    v_mfma_f32_16x16x32_bf16 v[40:43], a[204:207], v[72:75], v[40:43]
    v_mfma_f32_16x16x32_bf16 v[44:47], a[204:207], v[76:79], v[44:47]
    v_mfma_f32_16x16x32_bf16 v[48:51], v[72:75], v[200:203], v[48:51]
    v_mfma_f32_16x16x32_bf16 v[56:59], v[76:79], v[200:203], v[56:59]
    v_mfma_f32_16x16x32_bf16 v[52:55], v[72:75], v[204:207], v[52:55]
    v_mfma_f32_16x16x32_bf16 v[60:63], v[76:79], v[204:207], v[60:63]
    ds_read_b128 v[72:75], v6 offset:11264
    ds_read_b128 v[76:79], v81 offset:11264
    s_waitcnt lgkmcnt(2)
    v_mfma_f32_16x16x32_bf16 v[16:19], a[80:83], v[64:67], v[16:19]
    v_mfma_f32_16x16x32_bf16 v[20:23], a[80:83], v[68:71], v[20:23]
    v_mfma_f32_16x16x32_bf16 v[24:27], a[84:87], v[64:67], v[24:27]
    v_mfma_f32_16x16x32_bf16 v[28:31], a[84:87], v[68:71], v[28:31]
    v_mfma_f32_16x16x32_bf16 v[32:35], a[208:211], v[64:67], v[32:35]
    v_mfma_f32_16x16x32_bf16 v[36:39], a[208:211], v[68:71], v[36:39]
    v_mfma_f32_16x16x32_bf16 v[40:43], a[212:215], v[64:67], v[40:43]
    v_mfma_f32_16x16x32_bf16 v[44:47], a[212:215], v[68:71], v[44:47]
    v_mfma_f32_16x16x32_bf16 v[48:51], v[64:67], v[208:211], v[48:51]
    v_mfma_f32_16x16x32_bf16 v[56:59], v[68:71], v[208:211], v[56:59]
    v_mfma_f32_16x16x32_bf16 v[52:55], v[64:67], v[212:215], v[52:55]
    v_mfma_f32_16x16x32_bf16 v[60:63], v[68:71], v[212:215], v[60:63]
    ds_read_b128 v[64:67], v5 offset:12288
    ds_read_b128 v[68:71], v80 offset:12288
    s_waitcnt lgkmcnt(2)
    v_mfma_f32_16x16x32_bf16 v[16:19], a[88:91], v[72:75], v[16:19]
    v_mfma_f32_16x16x32_bf16 v[20:23], a[88:91], v[76:79], v[20:23]
    v_mfma_f32_16x16x32_bf16 v[24:27], a[92:95], v[72:75], v[24:27]
    v_mfma_f32_16x16x32_bf16 v[28:31], a[92:95], v[76:79], v[28:31]
    v_mfma_f32_16x16x32_bf16 v[32:35], a[216:219], v[72:75], v[32:35]
    v_mfma_f32_16x16x32_bf16 v[36:39], a[216:219], v[76:79], v[36:39]
    v_mfma_f32_16x16x32_bf16 v[40:43], a[220:223], v[72:75], v[40:43]
    v_mfma_f32_16x16x32_bf16 v[44:47], a[220:223], v[76:79], v[44:47]
    v_mfma_f32_16x16x32_bf16 v[48:51], v[72:75], v[216:219], v[48:51]
    v_mfma_f32_16x16x32_bf16 v[56:59], v[76:79], v[216:219], v[56:59]
    v_mfma_f32_16x16x32_bf16 v[52:55], v[72:75], v[220:223], v[52:55]
    v_mfma_f32_16x16x32_bf16 v[60:63], v[76:79], v[220:223], v[60:63]
    ds_read_b128 v[72:75], v6 offset:13312
    ds_read_b128 v[76:79], v81 offset:13312
    s_waitcnt lgkmcnt(2)
    v_mfma_f32_16x16x32_bf16 v[16:19], a[96:99], v[64:67], v[16:19]
    v_mfma_f32_16x16x32_bf16 v[20:23], a[96:99], v[68:71], v[20:23]
    v_mfma_f32_16x16x32_bf16 v[24:27], a[100:103], v[64:67], v[24:27]
    v_mfma_f32_16x16x32_bf16 v[28:31], a[100:103], v[68:71], v[28:31]
    v_mfma_f32_16x16x32_bf16 v[32:35], a[224:227], v[64:67], v[32:35]
    v_mfma_f32_16x16x32_bf16 v[36:39], a[224:227], v[68:71], v[36:39]
    v_mfma_f32_16x16x32_bf16 v[40:43], a[228:231], v[64:67], v[40:43]
    v_mfma_f32_16x16x32_bf16 v[44:47], a[228:231], v[68:71], v[44:47]
    v_mfma_f32_16x16x32_bf16 v[48:51], v[64:67], v[224:227], v[48:51]
    v_mfma_f32_16x16x32_bf16 v[56:59], v[68:71], v[224:227], v[56:59]
    v_mfma_f32_16x16x32_bf16 v[52:55], v[64:67], v[228:231], v[52:55]
    v_mfma_f32_16x16x32_bf16 v[60:63], v[68:71], v[228:231], v[60:63]
    ds_read_b128 v[64:67], v5 offset:14336
    ds_read_b128 v[68:71], v80 offset:14336
    s_waitcnt lgkmcnt(2)
    v_mfma_f32_16x16x32_bf16 v[16:19], a[104:107], v[72:75], v[16:19]
    v_mfma_f32_16x16x32_bf16 v[20:23], a[104:107], v[76:79], v[20:23]
    v_mfma_f32_16x16x32_bf16 v[24:27], a[108:111], v[72:75], v[24:27]
    v_mfma_f32_16x16x32_bf16 v[28:31], a[108:111], v[76:79], v[28:31]
    v_mfma_f32_16x16x32_bf16 v[32:35], a[232:235], v[72:75], v[32:35]
    v_mfma_f32_16x16x32_bf16 v[36:39], a[232:235], v[76:79], v[36:39]
    v_mfma_f32_16x16x32_bf16 v[40:43], a[236:239], v[72:75], v[40:43]
    v_mfma_f32_16x16x32_bf16 v[44:47], a[236:239], v[76:79], v[44:47]
    v_mfma_f32_16x16x32_bf16 v[48:51], v[72:75], v[232:235], v[48:51]
    v_mfma_f32_16x16x32_bf16 v[56:59], v[76:79], v[232:235], v[56:59]
    v_mfma_f32_16x16x32_bf16 v[52:55], v[72:75], v[236:239], v[52:55]
    v_mfma_f32_16x16x32_bf16 v[60:63], v[76:79], v[236:239], v[60:63]
    ds_read_b128 v[72:75], v6 offset:15360
    ds_read_b128 v[76:79], v81 offset:15360
    s_waitcnt lgkmcnt(2)
    v_mfma_f32_16x16x32_bf16 v[16:19], a[112:115], v[64:67], v[16:19]
    v_mfma_f32_16x16x32_bf16 v[20:23], a[112:115], v[68:71], v[20:23]
    v_mfma_f32_16x16x32_bf16 v[24:27], a[116:119], v[64:67], v[24:27]
    v_mfma_f32_16x16x32_bf16 v[28:31], a[116:119], v[68:71], v[28:31]
    v_mfma_f32_16x16x32_bf16 v[32:35], a[240:243], v[64:67], v[32:35]
    v_mfma_f32_16x16x32_bf16 v[36:39], a[240:243], v[68:71], v[36:39]
    v_mfma_f32_16x16x32_bf16 v[40:43], a[244:247], v[64:67], v[40:43]
    v_mfma_f32_16x16x32_bf16 v[44:47], a[244:247], v[68:71], v[44:47]
    v_mfma_f32_16x16x32_bf16 v[48:51], v[64:67], v[240:243], v[48:51]
    v_mfma_f32_16x16x32_bf16 v[56:59], v[68:71], v[240:243], v[56:59]
    v_mfma_f32_16x16x32_bf16 v[52:55], v[64:67], v[244:247], v[52:55]
    v_mfma_f32_16x16x32_bf16 v[60:63], v[68:71], v[244:247], v[60:63]
    s_waitcnt lgkmcnt(0)
    v_mfma_f32_16x16x32_bf16 v[16:19], a[120:123], v[72:75], v[16:19]
    v_mfma_f32_16x16x32_bf16 v[20:23], a[120:123], v[76:79], v[20:23]
    v_mfma_f32_16x16x32_bf16 v[24:27], a[124:127], v[72:75], v[24:27]
    v_mfma_f32_16x16x32_bf16 v[28:31], a[124:127], v[76:79], v[28:31]
    v_mfma_f32_16x16x32_bf16 v[32:35], a[248:251], v[72:75], v[32:35]
    v_mfma_f32_16x16x32_bf16 v[36:39], a[248:251], v[76:79], v[36:39]
    v_mfma_f32_16x16x32_bf16 v[40:43], a[252:255], v[72:75], v[40:43]
    v_mfma_f32_16x16x32_bf16 v[44:47], a[252:255], v[76:79], v[44:47]
    v_mfma_f32_16x16x32_bf16 v[48:51], v[72:75], v[248:251], v[48:51]
    v_mfma_f32_16x16x32_bf16 v[56:59], v[76:79], v[248:251], v[56:59]
    v_mfma_f32_16x16x32_bf16 v[52:55], v[72:75], v[252:255], v[52:55]
    v_mfma_f32_16x16x32_bf16 v[60:63], v[76:79], v[252:255], v[60:63]
    v_cvt_pk_bf16_f32 v80, v16, v24
    v_cvt_pk_bf16_f32 v81, v17, v25
    v_cvt_pk_bf16_f32 v82, v18, v26
    v_cvt_pk_bf16_f32 v83, v19, v27
    v_cvt_pk_bf16_f32 v84, v20, v28
    v_cvt_pk_bf16_f32 v85, v21, v29
    v_cvt_pk_bf16_f32 v86, v22, v30
    v_cvt_pk_bf16_f32 v87, v23, v31
    v_mul_f32 v32, s33, v32
    v_mul_f32 v33, s33, v33
    v_mul_f32 v34, s33, v34
    v_mul_f32 v35, s33, v35
    v_mul_f32 v36, s33, v36
    v_mul_f32 v37, s33, v37
    v_mul_f32 v38, s33, v38
    v_mul_f32 v39, s33, v39
    v_mul_f32 v40, s33, v40
    v_mul_f32 v41, s33, v41
    v_mul_f32 v42, s33, v42
    v_mul_f32 v43, s33, v43
    v_mul_f32 v44, s33, v44
    v_mul_f32 v45, s33, v45
    v_mul_f32 v46, s33, v46
    v_mul_f32 v47, s33, v47
    v_cvt_pk_bf16_f32 v88, v32, v40
    v_cvt_pk_bf16_f32 v89, v33, v41
    v_cvt_pk_bf16_f32 v90, v34, v42
    v_cvt_pk_bf16_f32 v91, v35, v43
    v_cvt_pk_bf16_f32 v92, v36, v44
    v_cvt_pk_bf16_f32 v93, v37, v45
    v_cvt_pk_bf16_f32 v94, v38, v46
    v_cvt_pk_bf16_f32 v95, v39, v47
    v_cvt_pk_bf16_f32 v120, v48, v49
    v_cvt_pk_bf16_f32 v121, v50, v51
    v_cvt_pk_bf16_f32 v122, v56, v57
    v_cvt_pk_bf16_f32 v123, v58, v59
    v_cvt_pk_bf16_f32 v124, v52, v53
    v_cvt_pk_bf16_f32 v125, v54, v55
    v_cvt_pk_bf16_f32 v126, v60, v61
    v_cvt_pk_bf16_f32 v127, v62, v63
    s_barrier
    ds_write_b128 v9, v[80:83] offset:0
    ds_write_b128 v9, v[88:91] offset:8192
    ds_write_b128 v9, v[84:87] offset:4096
    ds_write_b128 v9, v[92:95] offset:12288
    s_waitcnt lgkmcnt(0)
    s_barrier
    ds_read_b128 v[16:19], v1 offset:0
    ds_read_b128 v[20:23], v1 offset:1024
    ds_read_b128 v[24:27], v1 offset:2048
    ds_read_b128 v[28:31], v1 offset:3072
    s_waitcnt lgkmcnt(0)
    ds_read_b128 v[32:35], v1 offset:4096
    ds_read_b128 v[36:39], v1 offset:5120
    ds_read_b128 v[40:43], v1 offset:6144
    ds_read_b128 v[44:47], v1 offset:7168
    s_waitcnt lgkmcnt(0)
    ds_read_b128 v[48:51], v1 offset:8192
    ds_read_b128 v[52:55], v1 offset:9216
    ds_read_b128 v[56:59], v1 offset:10240
    ds_read_b128 v[60:63], v1 offset:11264
    ds_read_b128 v[64:67], v1 offset:12288
    ds_read_b128 v[68:71], v1 offset:13312
    ds_read_b128 v[72:75], v1 offset:14336
    ds_read_b128 v[76:79], v1 offset:15360
    s_waitcnt lgkmcnt(0)
    v_mfma_f32_16x16x32_bf16 v[80:83], v[48:51], v[16:19], 0
    v_mfma_f32_16x16x32_bf16 v[80:83], v[52:55], v[20:23], v[80:83]
    v_mfma_f32_16x16x32_bf16 v[80:83], v[56:59], v[24:27], v[80:83]
    v_mfma_f32_16x16x32_bf16 v[80:83], v[60:63], v[28:31], v[80:83]
    v_mfma_f32_16x16x32_bf16 v[84:87], v[48:51], v[32:35], 0
    v_mfma_f32_16x16x32_bf16 v[84:87], v[52:55], v[36:39], v[84:87]
    v_mfma_f32_16x16x32_bf16 v[84:87], v[56:59], v[40:43], v[84:87]
    v_mfma_f32_16x16x32_bf16 v[84:87], v[60:63], v[44:47], v[84:87]
    v_mfma_f32_16x16x32_bf16 v[88:91], v[64:67], v[32:35], 0
    v_mfma_f32_16x16x32_bf16 v[88:91], v[68:71], v[36:39], v[88:91]
    v_mfma_f32_16x16x32_bf16 v[88:91], v[72:75], v[40:43], v[88:91]
    v_mfma_f32_16x16x32_bf16 v[88:91], v[76:79], v[44:47], v[88:91]
    s_lshl_b32 s24, s23, 13
    s_add_u32 s24, s24, 0x100000
L_P2_poll:
    buffer_load_dwordx4 v[48:51], v2, s[8:11], s24 offen sc1
    buffer_load_dwordx4 v[52:55], v2, s[8:11], s24 offen offset:1024 sc1
    s_add_u32 s32, s32, 1
    s_cmp_gt_u32 s32, 200000
    s_waitcnt vmcnt(0)
    v_max3_u32 v14, v48, v49, v50
    v_max3_u32 v15, v51, v52, v53
    v_max3_u32 v14, v14, v54, v55
    v_max_u32 v14, v14, v15
    s_cbranch_scc1 L_P2_got
    v_cmp_eq_u32 vcc, -1, v14
    s_cbranch_vccz L_P2_got
    s_sleep 4
    s_branch L_P2_poll
L_P2_got:
    ds_write_b128 v2, v[48:51] offset:20480
    ds_write_b128 v2, v[52:55] offset:21504
    s_waitcnt lgkmcnt(0)
    s_barrier
    ds_read_b128 v[48:51], v8 offset:0
    ds_read_b128 v[52:55], v8 offset:2048
    ds_read_b128 v[56:59], v8 offset:4096
    ds_read_b128 v[60:63], v8 offset:6144
    ds_read_b128 v[64:67], v8 offset:512
    s_waitcnt lgkmcnt(4)
    v_mfma_f32_16x16x32_bf16 v[100:103], a[128:131], v[48:51], 0
    v_mfma_f32_16x16x32_bf16 v[104:107], a[132:135], v[48:51], 0
    v_mfma_f32_16x16x32_bf16 v[108:111], v[48:51], v[128:131], 0
    v_mfma_f32_16x16x32_bf16 v[112:115], v[48:51], v[132:135], 0
    ds_read_b128 v[68:71], v8 offset:2560
    s_waitcnt lgkmcnt(4)
    v_mfma_f32_16x16x32_bf16 v[100:103], a[136:139], v[52:55], v[100:103]
    v_mfma_f32_16x16x32_bf16 v[104:107], a[140:143], v[52:55], v[104:107]
    v_mfma_f32_16x16x32_bf16 v[108:111], v[52:55], v[136:139], v[108:111]
    v_mfma_f32_16x16x32_bf16 v[112:115], v[52:55], v[140:143], v[112:115]
    ds_read_b128 v[72:75], v8 offset:4608
    s_waitcnt lgkmcnt(4)
    v_mfma_f32_16x16x32_bf16 v[100:103], a[144:147], v[56:59], v[100:103]
    v_mfma_f32_16x16x32_bf16 v[104:107], a[148:151], v[56:59], v[104:107]
    v_mfma_f32_16x16x32_bf16 v[108:111], v[56:59], v[144:147], v[108:111]
    v_mfma_f32_16x16x32_bf16 v[112:115], v[56:59], v[148:151], v[112:115]
    ds_read_b128 v[76:79], v8 offset:6656
    s_waitcnt lgkmcnt(4)
    v_mfma_f32_16x16x32_bf16 v[100:103], a[152:155], v[60:63], v[100:103]
    v_mfma_f32_16x16x32_bf16 v[104:107], a[156:159], v[60:63], v[104:107]
    v_mfma_f32_16x16x32_bf16 v[108:111], v[60:63], v[152:155], v[108:111]
    v_mfma_f32_16x16x32_bf16 v[112:115], v[60:63], v[156:159], v[112:115]
    ds_read_b128 v[48:51], v8 offset:1024
    s_waitcnt lgkmcnt(4)
    v_mfma_f32_16x16x32_bf16 v[100:103], a[160:163], v[64:67], v[100:103]
    v_mfma_f32_16x16x32_bf16 v[104:107], a[164:167], v[64:67], v[104:107]
    v_mfma_f32_16x16x32_bf16 v[108:111], v[64:67], v[160:163], v[108:111]
    v_mfma_f32_16x16x32_bf16 v[112:115], v[64:67], v[164:167], v[112:115]
    ds_read_b128 v[52:55], v8 offset:3072
    s_waitcnt lgkmcnt(4)
    v_mfma_f32_16x16x32_bf16 v[100:103], a[168:171], v[68:71], v[100:103]
    v_mfma_f32_16x16x32_bf16 v[104:107], a[172:175], v[68:71], v[104:107]
    v_mfma_f32_16x16x32_bf16 v[108:111], v[68:71], v[168:171], v[108:111]
    v_mfma_f32_16x16x32_bf16 v[112:115], v[68:71], v[172:175], v[112:115]
    ds_read_b128 v[56:59], v8 offset:5120
    s_waitcnt lgkmcnt(4)
    v_mfma_f32_16x16x32_bf16 v[100:103], a[176:179], v[72:75], v[100:103]
    v_mfma_f32_16x16x32_bf16 v[104:107], a[180:183], v[72:75], v[104:107]
    v_mfma_f32_16x16x32_bf16 v[108:111], v[72:75], v[176:179], v[108:111]
    v_mfma_f32_16x16x32_bf16 v[112:115], v[72:75], v[180:183], v[112:115]
    ds_read_b128 v[60:63], v8 offset:7168
    s_waitcnt lgkmcnt(4)
    v_mfma_f32_16x16x32_bf16 v[100:103], a[184:187], v[76:79], v[100:103]
    v_mfma_f32_16x16x32_bf16 v[104:107], a[188:191], v[76:79], v[104:107]
    v_mfma_f32_16x16x32_bf16 v[108:111], v[76:79], v[184:187], v[108:111]
    v_mfma_f32_16x16x32_bf16 v[112:115], v[76:79], v[188:191], v[112:115]
    ds_read_b128 v[64:67], v8 offset:1536
    s_waitcnt lgkmcnt(4)
    v_mfma_f32_16x16x32_bf16 v[100:103], a[192:195], v[48:51], v[100:103]
    v_mfma_f32_16x16x32_bf16 v[104:107], a[196:199], v[48:51], v[104:107]
    v_mfma_f32_16x16x32_bf16 v[108:111], v[48:51], v[192:195], v[108:111]
    v_mfma_f32_16x16x32_bf16 v[112:115], v[48:51], v[196:199], v[112:115]
    ds_read_b128 v[68:71], v8 offset:3584
    s_waitcnt lgkmcnt(4)
    v_mfma_f32_16x16x32_bf16 v[100:103], a[200:203], v[52:55], v[100:103]
    v_mfma_f32_16x16x32_bf16 v[104:107], a[204:207], v[52:55], v[104:107]
    v_mfma_f32_16x16x32_bf16 v[108:111], v[52:55], v[200:203], v[108:111]
    v_mfma_f32_16x16x32_bf16 v[112:115], v[52:55], v[204:207], v[112:115]
    ds_read_b128 v[72:75], v8 offset:5632
    s_waitcnt lgkmcnt(4)
    v_mfma_f32_16x16x32_bf16 v[100:103], a[208:211], v[56:59], v[100:103]
    v_mfma_f32_16x16x32_bf16 v[104:107], a[212:215], v[56:59], v[104:107]
    v_mfma_f32_16x16x32_bf16 v[108:111], v[56:59], v[208:211], v[108:111]
    v_mfma_f32_16x16x32_bf16 v[112:115], v[56:59], v[212:215], v[112:115]
    ds_read_b128 v[76:79], v8 offset:7680
    s_waitcnt lgkmcnt(4)
    v_mfma_f32_16x16x32_bf16 v[100:103], a[216:219], v[60:63], v[100:103]
    v_mfma_f32_16x16x32_bf16 v[104:107], a[220:223], v[60:63], v[104:107]
    v_mfma_f32_16x16x32_bf16 v[108:111], v[60:63], v[216:219], v[108:111]
    v_mfma_f32_16x16x32_bf16 v[112:115], v[60:63], v[220:223], v[112:115]
    s_waitcnt lgkmcnt(3)
    v_mfma_f32_16x16x32_bf16 v[100:103], a[224:227], v[64:67], v[100:103]
    v_mfma_f32_16x16x32_bf16 v[104:107], a[228:231], v[64:67], v[104:107]
    v_mfma_f32_16x16x32_bf16 v[108:111], v[64:67], v[224:227], v[108:111]
    v_mfma_f32_16x16x32_bf16 v[112:115], v[64:67], v[228:231], v[112:115]
    s_waitcnt lgkmcnt(2)
    v_mfma_f32_16x16x32_bf16 v[100:103], a[232:235], v[68:71], v[100:103]
    v_mfma_f32_16x16x32_bf16 v[104:107], a[236:239], v[68:71], v[104:107]
    v_mfma_f32_16x16x32_bf16 v[108:111], v[68:71], v[232:235], v[108:111]
    v_mfma_f32_16x16x32_bf16 v[112:115], v[68:71], v[236:239], v[112:115]
    s_waitcnt lgkmcnt(1)
    v_mfma_f32_16x16x32_bf16 v[100:103], a[240:243], v[72:75], v[100:103]
    v_mfma_f32_16x16x32_bf16 v[104:107], a[244:247], v[72:75], v[104:107]
    v_mfma_f32_16x16x32_bf16 v[108:111], v[72:75], v[240:243], v[108:111]
    v_mfma_f32_16x16x32_bf16 v[112:115], v[72:75], v[244:247], v[112:115]
    s_waitcnt lgkmcnt(0)
    v_mfma_f32_16x16x32_bf16 v[100:103], a[248:251], v[76:79], v[100:103]
    v_mfma_f32_16x16x32_bf16 v[104:107], a[252:255], v[76:79], v[104:107]
    v_mfma_f32_16x16x32_bf16 v[108:111], v[76:79], v[248:251], v[108:111]
    v_mfma_f32_16x16x32_bf16 v[112:115], v[76:79], v[252:255], v[112:115]
    s_nop 4
    v_mul_f32 v100, s33, v100
    v_mul_f32 v101, s33, v101
    v_mul_f32 v102, s33, v102
    v_mul_f32 v103, s33, v103
    v_mul_f32 v104, s33, v104
    v_mul_f32 v105, s33, v105
    v_mul_f32 v106, s33, v106
    v_mul_f32 v107, s33, v107
    v_cvt_pk_bf16_f32 v48, v100, v104
    v_cvt_pk_bf16_f32 v49, v101, v105
    v_cvt_pk_bf16_f32 v50, v102, v106
    v_cvt_pk_bf16_f32 v51, v103, v107
    ds_write_b128 v9, v[48:51] offset:16384
    v_cvt_pk_bf16_f32 v116, v108, v109
    v_cvt_pk_bf16_f32 v117, v110, v111
    v_cvt_pk_bf16_f32 v118, v112, v113
    v_cvt_pk_bf16_f32 v119, v114, v115
    s_waitcnt lgkmcnt(0)
    s_barrier
    ds_read_b128 v[64:67], v1 offset:16384
    ds_read_b128 v[68:71], v1 offset:17408
    ds_read_b128 v[72:75], v1 offset:18432
    ds_read_b128 v[76:79], v1 offset:19456
    v_cndmask_b32 v80, v13, v80, s[64:65]
    v_cndmask_b32 v81, v13, v81, s[66:67]
    v_cndmask_b32 v82, v13, v82, s[68:69]
    v_cndmask_b32 v83, v13, v83, s[70:71]
    v_cndmask_b32 v88, v13, v88, s[64:65]
    v_cndmask_b32 v89, v13, v89, s[66:67]
    v_cndmask_b32 v90, v13, v90, s[68:69]
    v_cndmask_b32 v91, v13, v91, s[70:71]
    s_waitcnt lgkmcnt(0)
    v_mfma_f32_16x16x32_bf16 v[92:95], v[64:67], v[16:19], 0
    v_mfma_f32_16x16x32_bf16 v[92:95], v[68:71], v[20:23], v[92:95]
    v_mfma_f32_16x16x32_bf16 v[92:95], v[72:75], v[24:27], v[92:95]
    v_mfma_f32_16x16x32_bf16 v[92:95], v[76:79], v[28:31], v[92:95]
    v_mfma_f32_16x16x32_bf16 v[96:99], v[64:67], v[32:35], 0
    v_mfma_f32_16x16x32_bf16 v[96:99], v[68:71], v[36:39], v[96:99]
    v_mfma_f32_16x16x32_bf16 v[96:99], v[72:75], v[40:43], v[96:99]
    v_mfma_f32_16x16x32_bf16 v[96:99], v[76:79], v[44:47], v[96:99]
    s_nop 3
    v_cndmask_b32 v92, v13, v92, s[72:73]
    v_cndmask_b32 v93, v13, v93, s[72:73]
    v_cndmask_b32 v94, v13, v94, s[72:73]
    v_cndmask_b32 v95, v13, v95, s[72:73]
    v_cndmask_b32 v96, v13, v96, s[72:73]
    v_cndmask_b32 v97, v13, v97, s[72:73]
    v_cndmask_b32 v98, v13, v98, s[72:73]
    v_cndmask_b32 v99, v13, v99, s[72:73]
    v_max_f32 v48, v80, v81
    v_max3_f32 v48, v48, v82, v83
    v_max3_f32 v48, v48, v92, v93
    v_max3_f32 v48, v48, v94, v95
    v_max_f32 v49, v84, v85
    v_max3_f32 v49, v49, v86, v87
    v_max3_f32 v49, v49, v88, v89
    v_max3_f32 v49, v49, v90, v91
    v_max3_f32 v49, v49, v96, v97
    v_max3_f32 v49, v49, v98, v99
    v_mov_b32 v14, v48
    s_nop 1
    v_permlane16_swap_b32 v48, v14
    v_max_f32 v48, v48, v14
    v_mov_b32 v14, v49
    s_nop 1
    v_permlane16_swap_b32 v49, v14
    v_max_f32 v49, v49, v14
    v_mov_b32 v14, v48
    s_nop 1
    v_permlane32_swap_b32 v48, v14
    v_max_f32 v48, v48, v14
    v_mov_b32 v14, v49
    s_nop 1
    v_permlane32_swap_b32 v49, v14
    v_max_f32 v49, v49, v14
    v_sub_f32 v80, v80, v48
    v_exp_f32 v80, v80
    v_sub_f32 v81, v81, v48
    v_exp_f32 v81, v81
    v_sub_f32 v82, v82, v48
    v_exp_f32 v82, v82
    v_sub_f32 v83, v83, v48
    v_exp_f32 v83, v83
    v_sub_f32 v92, v92, v48
    v_exp_f32 v92, v92
    v_sub_f32 v93, v93, v48
    v_exp_f32 v93, v93
    v_sub_f32 v94, v94, v48
    v_exp_f32 v94, v94
    v_sub_f32 v95, v95, v48
    v_exp_f32 v95, v95
    v_sub_f32 v84, v84, v49
    v_exp_f32 v84, v84
    v_sub_f32 v85, v85, v49
    v_exp_f32 v85, v85
    v_sub_f32 v86, v86, v49
    v_exp_f32 v86, v86
    v_sub_f32 v87, v87, v49
    v_exp_f32 v87, v87
    v_sub_f32 v88, v88, v49
    v_exp_f32 v88, v88
    v_sub_f32 v89, v89, v49
    v_exp_f32 v89, v89
    v_sub_f32 v90, v90, v49
    v_exp_f32 v90, v90
    v_sub_f32 v91, v91, v49
    v_exp_f32 v91, v91
    v_sub_f32 v96, v96, v49
    v_exp_f32 v96, v96
    v_sub_f32 v97, v97, v49
    v_exp_f32 v97, v97
    v_sub_f32 v98, v98, v49
    v_exp_f32 v98, v98
    v_sub_f32 v99, v99, v49
    v_exp_f32 v99, v99
    v_cvt_pk_bf16_f32 v16, v80, v81
    v_cvt_pk_bf16_f32 v17, v82, v83
    v_mov_b64 v[18:19], 0
    v_cvt_pk_bf16_f32 v20, v84, v85
    v_cvt_pk_bf16_f32 v21, v86, v87
    v_cvt_pk_bf16_f32 v22, v88, v89
    v_cvt_pk_bf16_f32 v23, v90, v91
    v_cvt_pk_bf16_f32 v24, v92, v93
    v_cvt_pk_bf16_f32 v25, v94, v95
    v_cvt_pk_bf16_f32 v26, v96, v97
    v_cvt_pk_bf16_f32 v27, v98, v99
    v_mov_b64 v[28:29], s[4:5]
    v_mov_b64 v[30:31], s[4:5]
    s_nop 1
    v_mfma_f32_16x16x32_bf16 v[32:35], v[28:31], v[16:19], 0
    v_mfma_f32_16x16x32_bf16 v[40:43], v[120:123], v[16:19], 0
    v_mfma_f32_16x16x32_bf16 v[44:47], v[124:127], v[16:19], 0
    v_mfma_f32_16x16x32_bf16 v[36:39], v[28:31], v[20:23], 0
    v_mfma_f32_16x16x32_bf16 v[48:51], v[120:123], v[20:23], 0
    v_mfma_f32_16x16x32_bf16 v[52:55], v[124:127], v[20:23], 0
    s_nop 0
    v_mfma_f32_16x16x16_bf16 v[32:35], v[28:29], v[24:25], v[32:35]
    v_mfma_f32_16x16x16_bf16 v[40:43], v[116:117], v[24:25], v[40:43]
    v_mfma_f32_16x16x16_bf16 v[44:47], v[118:119], v[24:25], v[44:47]
    v_mfma_f32_16x16x16_bf16 v[36:39], v[28:29], v[26:27], v[36:39]
    v_mfma_f32_16x16x16_bf16 v[48:51], v[116:117], v[26:27], v[48:51]
    v_mfma_f32_16x16x16_bf16 v[52:55], v[118:119], v[26:27], v[52:55]
    s_nop 2
    v_rcp_f32 v14, v32
    s_nop 0
    v_mul_f32 v40, v40, v14
    v_mul_f32 v41, v41, v14
    v_mul_f32 v42, v42, v14
    v_mul_f32 v43, v43, v14
    v_mul_f32 v44, v44, v14
    v_mul_f32 v45, v45, v14
    v_mul_f32 v46, v46, v14
    v_mul_f32 v47, v47, v14
    v_cvt_pk_bf16_f32 v56, v40, v44
    v_cvt_pk_bf16_f32 v57, v41, v45
    v_cvt_pk_bf16_f32 v58, v42, v46
    v_cvt_pk_bf16_f32 v59, v43, v47
    ds_write_b128 v9, v[56:59] offset:0
    v_rcp_f32 v14, v36
    s_nop 0
    v_mul_f32 v48, v48, v14
    v_mul_f32 v49, v49, v14
    v_mul_f32 v50, v50, v14
    v_mul_f32 v51, v51, v14
    v_mul_f32 v52, v52, v14
    v_mul_f32 v53, v53, v14
    v_mul_f32 v54, v54, v14
    v_mul_f32 v55, v55, v14
    v_cvt_pk_bf16_f32 v60, v48, v52
    v_cvt_pk_bf16_f32 v61, v49, v53
    v_cvt_pk_bf16_f32 v62, v50, v54
    v_cvt_pk_bf16_f32 v63, v51, v55
    ds_write_b128 v9, v[60:63] offset:4096
    s_waitcnt lgkmcnt(0)
    s_barrier
    ds_read_b128 v[16:19], v1 offset:0
    ds_read_b128 v[20:23], v1 offset:1024
    ds_read_b128 v[24:27], v1 offset:2048
    ds_read_b128 v[28:31], v1 offset:3072
    ds_read_b128 v[32:35], v1 offset:4096
    ds_read_b128 v[36:39], v1 offset:5120
    ds_read_b128 v[40:43], v1 offset:6144
    ds_read_b128 v[44:47], v1 offset:7168
    ds_read_b128 v[48:51], v7 offset:0
    ds_read_b128 v[52:55], v7 offset:1024
    ds_read_b128 v[56:59], v7 offset:2048
    ds_read_b128 v[60:63], v7 offset:3072
    s_waitcnt lgkmcnt(3)
    v_mfma_f32_16x16x32_bf16 v[64:67], v[16:19], v[48:51], 0
    v_mfma_f32_16x16x32_bf16 v[96:99], v[32:35], v[48:51], 0
    ds_read_b128 v[48:51], v7 offset:4096
    s_waitcnt lgkmcnt(3)
    v_mfma_f32_16x16x32_bf16 v[68:71], v[16:19], v[52:55], 0
    v_mfma_f32_16x16x32_bf16 v[100:103], v[32:35], v[52:55], 0
    ds_read_b128 v[52:55], v7 offset:5120
    s_waitcnt lgkmcnt(3)
    v_mfma_f32_16x16x32_bf16 v[72:75], v[16:19], v[56:59], 0
    v_mfma_f32_16x16x32_bf16 v[104:107], v[32:35], v[56:59], 0
    ds_read_b128 v[56:59], v7 offset:6144
    s_waitcnt lgkmcnt(3)
    v_mfma_f32_16x16x32_bf16 v[76:79], v[16:19], v[60:63], 0
    v_mfma_f32_16x16x32_bf16 v[108:111], v[32:35], v[60:63], 0
    ds_read_b128 v[60:63], v7 offset:7168
    s_waitcnt lgkmcnt(3)
    v_mfma_f32_16x16x32_bf16 v[80:83], v[16:19], v[48:51], 0
    v_mfma_f32_16x16x32_bf16 v[112:115], v[32:35], v[48:51], 0
    ds_read_b128 v[48:51], v7 offset:8192
    s_waitcnt lgkmcnt(3)
    v_mfma_f32_16x16x32_bf16 v[84:87], v[16:19], v[52:55], 0
    v_mfma_f32_16x16x32_bf16 v[116:119], v[32:35], v[52:55], 0
    ds_read_b128 v[52:55], v7 offset:9216
    s_waitcnt lgkmcnt(3)
    v_mfma_f32_16x16x32_bf16 v[88:91], v[16:19], v[56:59], 0
    v_mfma_f32_16x16x32_bf16 v[120:123], v[32:35], v[56:59], 0
    ds_read_b128 v[56:59], v7 offset:10240
    s_waitcnt lgkmcnt(3)
    v_mfma_f32_16x16x32_bf16 v[92:95], v[16:19], v[60:63], 0
    v_mfma_f32_16x16x32_bf16 v[124:127], v[32:35], v[60:63], 0
    ds_read_b128 v[60:63], v7 offset:11264
    s_waitcnt lgkmcnt(3)
    v_mfma_f32_16x16x32_bf16 v[64:67], v[20:23], v[48:51], v[64:67]
    v_mfma_f32_16x16x32_bf16 v[96:99], v[36:39], v[48:51], v[96:99]
    ds_read_b128 v[48:51], v7 offset:12288
    s_waitcnt lgkmcnt(3)
    v_mfma_f32_16x16x32_bf16 v[68:71], v[20:23], v[52:55], v[68:71]
    v_mfma_f32_16x16x32_bf16 v[100:103], v[36:39], v[52:55], v[100:103]
    ds_read_b128 v[52:55], v7 offset:13312
    s_waitcnt lgkmcnt(3)
    v_mfma_f32_16x16x32_bf16 v[72:75], v[20:23], v[56:59], v[72:75]
    v_mfma_f32_16x16x32_bf16 v[104:107], v[36:39], v[56:59], v[104:107]
    ds_read_b128 v[56:59], v7 offset:14336
    s_waitcnt lgkmcnt(3)
    v_mfma_f32_16x16x32_bf16 v[76:79], v[20:23], v[60:63], v[76:79]
    v_mfma_f32_16x16x32_bf16 v[108:111], v[36:39], v[60:63], v[108:111]
    ds_read_b128 v[60:63], v7 offset:15360
    s_waitcnt lgkmcnt(3)
    v_mfma_f32_16x16x32_bf16 v[80:83], v[20:23], v[48:51], v[80:83]
    v_mfma_f32_16x16x32_bf16 v[112:115], v[36:39], v[48:51], v[112:115]
    ds_read_b128 v[48:51], v7 offset:16384
    s_waitcnt lgkmcnt(3)
    v_mfma_f32_16x16x32_bf16 v[84:87], v[20:23], v[52:55], v[84:87]
    v_mfma_f32_16x16x32_bf16 v[116:119], v[36:39], v[52:55], v[116:119]
    ds_read_b128 v[52:55], v7 offset:17408
    s_waitcnt lgkmcnt(3)
    v_mfma_f32_16x16x32_bf16 v[88:91], v[20:23], v[56:59], v[88:91]
    v_mfma_f32_16x16x32_bf16 v[120:123], v[36:39], v[56:59], v[120:123]
    ds_read_b128 v[56:59], v7 offset:18432
    s_waitcnt lgkmcnt(3)
    v_mfma_f32_16x16x32_bf16 v[92:95], v[20:23], v[60:63], v[92:95]
    v_mfma_f32_16x16x32_bf16 v[124:127], v[36:39], v[60:63], v[124:127]
    ds_read_b128 v[60:63], v7 offset:19456
    s_waitcnt lgkmcnt(3)
    v_mfma_f32_16x16x32_bf16 v[64:67], v[24:27], v[48:51], v[64:67]
    v_mfma_f32_16x16x32_bf16 v[96:99], v[40:43], v[48:51], v[96:99]
    ds_read_b128 v[48:51], v7 offset:20480
    s_waitcnt lgkmcnt(3)
    v_mfma_f32_16x16x32_bf16 v[68:71], v[24:27], v[52:55], v[68:71]
    v_mfma_f32_16x16x32_bf16 v[100:103], v[40:43], v[52:55], v[100:103]
    ds_read_b128 v[52:55], v7 offset:21504
    s_waitcnt lgkmcnt(3)
    v_mfma_f32_16x16x32_bf16 v[72:75], v[24:27], v[56:59], v[72:75]
    v_mfma_f32_16x16x32_bf16 v[104:107], v[40:43], v[56:59], v[104:107]
    ds_read_b128 v[56:59], v7 offset:22528
    s_waitcnt lgkmcnt(3)
    v_mfma_f32_16x16x32_bf16 v[76:79], v[24:27], v[60:63], v[76:79]
    v_mfma_f32_16x16x32_bf16 v[108:111], v[40:43], v[60:63], v[108:111]
    ds_read_b128 v[60:63], v7 offset:23552
    s_waitcnt lgkmcnt(3)
    v_mfma_f32_16x16x32_bf16 v[80:83], v[24:27], v[48:51], v[80:83]
    v_mfma_f32_16x16x32_bf16 v[112:115], v[40:43], v[48:51], v[112:115]
    ds_read_b128 v[48:51], v7 offset:24576
    s_waitcnt lgkmcnt(3)
    v_mfma_f32_16x16x32_bf16 v[84:87], v[24:27], v[52:55], v[84:87]
    v_mfma_f32_16x16x32_bf16 v[116:119], v[40:43], v[52:55], v[116:119]
    ds_read_b128 v[52:55], v7 offset:25600
    s_waitcnt lgkmcnt(3)
    v_mfma_f32_16x16x32_bf16 v[88:91], v[24:27], v[56:59], v[88:91]
    v_mfma_f32_16x16x32_bf16 v[120:123], v[40:43], v[56:59], v[120:123]
    ds_read_b128 v[56:59], v7 offset:26624
    s_waitcnt lgkmcnt(3)
    v_mfma_f32_16x16x32_bf16 v[92:95], v[24:27], v[60:63], v[92:95]
    v_mfma_f32_16x16x32_bf16 v[124:127], v[40:43], v[60:63], v[124:127]
    ds_read_b128 v[60:63], v7 offset:27648
    s_waitcnt lgkmcnt(3)
    v_mfma_f32_16x16x32_bf16 v[64:67], v[28:31], v[48:51], v[64:67]
    v_mfma_f32_16x16x32_bf16 v[96:99], v[44:47], v[48:51], v[96:99]
    ds_read_b128 v[48:51], v7 offset:28672
    s_waitcnt lgkmcnt(3)
    v_mfma_f32_16x16x32_bf16 v[68:71], v[28:31], v[52:55], v[68:71]
    v_mfma_f32_16x16x32_bf16 v[100:103], v[44:47], v[52:55], v[100:103]
    ds_read_b128 v[52:55], v7 offset:29696
    s_waitcnt lgkmcnt(3)
    v_mfma_f32_16x16x32_bf16 v[72:75], v[28:31], v[56:59], v[72:75]
    v_mfma_f32_16x16x32_bf16 v[104:107], v[44:47], v[56:59], v[104:107]
    ds_read_b128 v[56:59], v7 offset:30720
    s_waitcnt lgkmcnt(3)
    v_mfma_f32_16x16x32_bf16 v[76:79], v[28:31], v[60:63], v[76:79]
    v_mfma_f32_16x16x32_bf16 v[108:111], v[44:47], v[60:63], v[108:111]
    ds_read_b128 v[60:63], v7 offset:31744
    s_waitcnt lgkmcnt(3)
    v_mfma_f32_16x16x32_bf16 v[80:83], v[28:31], v[48:51], v[80:83]
    v_mfma_f32_16x16x32_bf16 v[112:115], v[44:47], v[48:51], v[112:115]
    s_waitcnt lgkmcnt(2)
    v_mfma_f32_16x16x32_bf16 v[84:87], v[28:31], v[52:55], v[84:87]
    v_mfma_f32_16x16x32_bf16 v[116:119], v[44:47], v[52:55], v[116:119]
    s_waitcnt lgkmcnt(1)
    v_mfma_f32_16x16x32_bf16 v[88:91], v[28:31], v[56:59], v[88:91]
    v_mfma_f32_16x16x32_bf16 v[120:123], v[44:47], v[56:59], v[120:123]
    s_waitcnt lgkmcnt(0)
    v_mfma_f32_16x16x32_bf16 v[92:95], v[28:31], v[60:63], v[92:95]
    v_mfma_f32_16x16x32_bf16 v[124:127], v[44:47], v[60:63], v[124:127]
    s_lshl_b32 s24, s23, 20
    s_lshl_b32 s36, s20, 10
    s_add_u32 s24, s24, s36
    s_add_u32 s24, s24, 0x4000000
    v_cvt_pk_bf16_f32 v16, v64, v68
    v_cvt_pk_bf16_f32 v17, v72, v76
    v_cvt_pk_bf16_f32 v18, v80, v84
    v_cvt_pk_bf16_f32 v19, v88, v92
    s_add_u32 s36, s24, 0x0
    buffer_store_dwordx4 v[16:19], v10, s[8:11], s36 offen sc1
    v_cvt_pk_bf16_f32 v20, v65, v69
    v_cvt_pk_bf16_f32 v21, v73, v77
    v_cvt_pk_bf16_f32 v22, v81, v85
    v_cvt_pk_bf16_f32 v23, v89, v93
    s_add_u32 s36, s24, 0x8000
    buffer_store_dwordx4 v[20:23], v10, s[8:11], s36 offen sc1
    v_cvt_pk_bf16_f32 v24, v66, v70
    v_cvt_pk_bf16_f32 v25, v74, v78
    v_cvt_pk_bf16_f32 v26, v82, v86
    v_cvt_pk_bf16_f32 v27, v90, v94
    s_add_u32 s36, s24, 0x10000
    buffer_store_dwordx4 v[24:27], v10, s[8:11], s36 offen sc1
    v_cvt_pk_bf16_f32 v28, v67, v71
    v_cvt_pk_bf16_f32 v29, v75, v79
    v_cvt_pk_bf16_f32 v30, v83, v87
    v_cvt_pk_bf16_f32 v31, v91, v95
    s_add_u32 s36, s24, 0x18000
    buffer_store_dwordx4 v[28:31], v10, s[8:11], s36 offen sc1
    v_cvt_pk_bf16_f32 v32, v96, v100
    v_cvt_pk_bf16_f32 v33, v104, v108
    v_cvt_pk_bf16_f32 v34, v112, v116
    v_cvt_pk_bf16_f32 v35, v120, v124
    s_add_u32 s36, s24, 0x80000
    buffer_store_dwordx4 v[32:35], v10, s[8:11], s36 offen sc1
    v_cvt_pk_bf16_f32 v36, v97, v101
    v_cvt_pk_bf16_f32 v37, v105, v109
    v_cvt_pk_bf16_f32 v38, v113, v117
    v_cvt_pk_bf16_f32 v39, v121, v125
    s_add_u32 s36, s24, 0x88000
    buffer_store_dwordx4 v[36:39], v10, s[8:11], s36 offen sc1
    v_cvt_pk_bf16_f32 v40, v98, v102
    v_cvt_pk_bf16_f32 v41, v106, v110
    v_cvt_pk_bf16_f32 v42, v114, v118
    v_cvt_pk_bf16_f32 v43, v122, v126
    s_add_u32 s36, s24, 0x90000
    buffer_store_dwordx4 v[40:43], v10, s[8:11], s36 offen sc1
    v_cvt_pk_bf16_f32 v44, v99, v103
    v_cvt_pk_bf16_f32 v45, v107, v111
    v_cvt_pk_bf16_f32 v46, v115, v119
    v_cvt_pk_bf16_f32 v47, v123, v127
    s_add_u32 s36, s24, 0x98000
    buffer_store_dwordx4 v[44:47], v10, s[8:11], s36 offen sc1
    s_lshl_b32 s25, s23, 7
    s_add_u32 s25, s25, 0x192000
    s_lshl_b32 s36, s20, 2
    s_add_u32 s24, s25, s36
    s_waitcnt vmcnt(0)
    s_barrier
    v_cmp_ne_u32 vcc, 0, v0
    v_mov_b32 v15, 0x40000000
    v_mov_b32 v14, 1
    v_cndmask_b32 v15, v0, v15, vcc
    buffer_store_dword v14, v15, s[8:11], s24 offen sc1
    v_and_b32 v15, 15, v0
    v_mov_b32 v48, 0
    v_mov_b32 v14, 0x3f80
    v_cmp_eq_u32 vcc, 0, v15
    s_nop 1
    v_cndmask_b32 v48, v48, v14, vcc
    v_mov_b32 v14, 0x3f800000
    v_cmp_eq_u32 vcc, 1, v15
    s_nop 1
    v_cndmask_b32 v48, v48, v14, vcc
    v_mov_b32 v49, 0
    v_mov_b32 v14, 0x3f80
    v_cmp_eq_u32 vcc, 4, v15
    s_nop 1
    v_cndmask_b32 v49, v49, v14, vcc
    v_mov_b32 v14, 0x3f800000
    v_cmp_eq_u32 vcc, 5, v15
    s_nop 1
    v_cndmask_b32 v49, v49, v14, vcc
    v_mov_b32 v50, 0
    v_mov_b32 v14, 0x3f80
    v_cmp_eq_u32 vcc, 8, v15
    s_nop 1
    v_cndmask_b32 v50, v50, v14, vcc
    v_mov_b32 v14, 0x3f800000
    v_cmp_eq_u32 vcc, 9, v15
    s_nop 1
    v_cndmask_b32 v50, v50, v14, vcc
    v_mov_b32 v51, 0
    v_mov_b32 v14, 0x3f80
    v_cmp_eq_u32 vcc, 12, v15
    s_nop 1
    v_cndmask_b32 v51, v51, v14, vcc
    v_mov_b32 v14, 0x3f800000
    v_cmp_eq_u32 vcc, 13, v15
    s_nop 1
    v_cndmask_b32 v51, v51, v14, vcc
    s_lshl_b32 s24, s23, 5
    s_add_u32 s24, s24, s20
    s_lshl_b32 s24, s24, 10
    buffer_load_dword v52, v12, s[12:15], s24 offen
    buffer_load_dword v53, v12, s[92:95], 0 offen
    v_lshrrev_b32 v15, 2, v1
    v_and_b32 v15, 127, v15
L_P3_poll:
    buffer_load_dword v14, v15, s[8:11], s25 offen sc1
    s_add_u32 s32, s32, 1
    s_cmp_gt_u32 s32, 200000
    s_waitcnt vmcnt(0)
    s_cbranch_scc1 L_P3_got
    v_cmp_eq_u32 vcc, 0, v14
    s_cbranch_vccnz L_P3_poll
L_P3_got:
    s_lshl_b32 s36, s24, 5
    s_add_u32 s36, s36, 0x4000000
    buffer_load_dwordx4 v[16:19], v11, s[8:11], s36 offen sc1
    s_add_u32 s36, s36, 4096
    buffer_load_dwordx4 v[20:23], v11, s[8:11], s36 offen sc1
    s_add_u32 s36, s36, 4096
    buffer_load_dwordx4 v[24:27], v11, s[8:11], s36 offen sc1
    s_add_u32 s36, s36, 4096
    buffer_load_dwordx4 v[28:31], v11, s[8:11], s36 offen sc1
    s_add_u32 s36, s36, 4096
    buffer_load_dwordx4 v[32:35], v11, s[8:11], s36 offen sc1
    s_add_u32 s36, s36, 4096
    buffer_load_dwordx4 v[36:39], v11, s[8:11], s36 offen sc1
    s_add_u32 s36, s36, 4096
    buffer_load_dwordx4 v[40:43], v11, s[8:11], s36 offen sc1
    s_add_u32 s36, s36, 4096
    buffer_load_dwordx4 v[44:47], v11, s[8:11], s36 offen sc1
    s_waitcnt vmcnt(7)
    v_mfma_f32_16x16x32_bf16 v[56:59], v[48:51], v[16:19], 0
    s_waitcnt vmcnt(6)
    v_mfma_f32_16x16x32_bf16 v[56:59], v[48:51], v[20:23], v[56:59]
    s_waitcnt vmcnt(5)
    v_mfma_f32_16x16x32_bf16 v[56:59], v[48:51], v[24:27], v[56:59]
    s_waitcnt vmcnt(4)
    v_mfma_f32_16x16x32_bf16 v[56:59], v[48:51], v[28:31], v[56:59]
    s_waitcnt vmcnt(3)
    v_mfma_f32_16x16x32_bf16 v[56:59], v[48:51], v[32:35], v[56:59]
    s_waitcnt vmcnt(2)
    v_mfma_f32_16x16x32_bf16 v[56:59], v[48:51], v[36:39], v[56:59]
    s_waitcnt vmcnt(1)
    v_mfma_f32_16x16x32_bf16 v[56:59], v[48:51], v[40:43], v[56:59]
    s_waitcnt vmcnt(0)
    v_mfma_f32_16x16x32_bf16 v[56:59], v[48:51], v[44:47], v[56:59]
    s_nop 7
    v_cvt_pk_bf16_f32 v62, v56, v57
    v_lshlrev_b32 v65, 16, v62
    v_and_b32 v66, 0xffff0000, v62
    v_lshlrev_b32 v60, 16, v52
    v_and_b32 v61, 0xffff0000, v52
    v_add_f32 v60, v60, v65
    v_add_f32 v61, v61, v66
    v_cvt_pk_bf16_f32 v62, v60, v61
    v_lshlrev_b32 v60, 16, v62
    v_and_b32 v61, 0xffff0000, v62
    v_add_f32 v63, v60, v61
    v_mul_f32 v64, v60, v60
    v_fmac_f32 v64, v61, v61
    v_add_f32_dpp v63, v63, v63 quad_perm:[1,0,3,2] row_mask:0xf bank_mask:0xf
    s_nop 0
    v_add_f32_dpp v64, v64, v64 quad_perm:[1,0,3,2] row_mask:0xf bank_mask:0xf
    v_add_f32_dpp v63, v63, v63 quad_perm:[2,3,0,1] row_mask:0xf bank_mask:0xf
    s_nop 0
    v_add_f32_dpp v64, v64, v64 quad_perm:[2,3,0,1] row_mask:0xf bank_mask:0xf
    v_add_f32_dpp v63, v63, v63 row_half_mirror row_mask:0xf bank_mask:0xf
    s_nop 0
    v_add_f32_dpp v64, v64, v64 row_half_mirror row_mask:0xf bank_mask:0xf
    v_add_f32_dpp v63, v63, v63 row_mirror row_mask:0xf bank_mask:0xf
    s_nop 0
    v_add_f32_dpp v64, v64, v64 row_mirror row_mask:0xf bank_mask:0xf
    v_mov_b32 v14, v63
    s_nop 1
    v_permlane16_swap_b32 v63, v14
    v_add_f32 v63, v63, v14
    v_mov_b32 v14, v64
    s_nop 1
    v_permlane16_swap_b32 v64, v14
    v_add_f32 v64, v64, v14
    v_mov_b32 v14, v63
    s_nop 1
    v_permlane32_swap_b32 v63, v14
    v_add_f32 v63, v63, v14
    v_mov_b32 v14, v64
    s_nop 1
    v_permlane32_swap_b32 v64, v14
    v_add_f32 v64, v64, v14
    v_mov_b32 v15, s21
    v_lshlrev_b32 v15, 3, v15
    v_add_u32 v15, 28672, v15
    ds_write2_b32 v15, v63, v64 offset0:0 offset1:1
    s_add_u32 s36, s24, 0x400000
    buffer_store_dword v62, v12, s[8:11], s36 offen
    s_waitcnt lgkmcnt(0)
    s_barrier
    v_mov_b32 v15, 28672
    ds_read_b128 v[68:71], v15
    ds_read_b128 v[72:75], v15 offset:16
    s_waitcnt lgkmcnt(0)
    v_add_f32 v63, v68, v70
    v_add_f32 v63, v63, v72
    v_add_f32 v63, v63, v74
    v_mul_f32 v63, 0x3b000000, v63
    v_add_f32 v64, v69, v71
    v_add_f32 v64, v64, v73
    v_add_f32 v64, v64, v75
    v_mul_f32 v64, 0x3b000000, v64
    v_fma_f32 v64, -v63, v63, v64
    v_max_f32 v64, 0, v64
    v_cvt_pk_bf16_f32 v14, v63, v64
    v_lshlrev_b32 v63, 16, v14
    v_and_b32 v64, 0xffff0000, v14
    v_add_f32 v64, 0x3727c5ac, v64
    v_cvt_pk_bf16_f32 v14, v64, v64
    v_lshlrev_b32 v64, 16, v14
    v_sqrt_f32 v64, v64
    s_nop 0
    v_cvt_pk_bf16_f32 v14, v64, v64
    v_lshlrev_b32 v64, 16, v14
    v_rcp_f32 v64, v64
    v_sub_f32 v65, v60, v63
    v_sub_f32 v66, v61, v63
    v_cvt_pk_bf16_f32 v14, v65, v66
    v_lshlrev_b32 v65, 16, v14
    v_and_b32 v66, 0xffff0000, v14
    v_mul_f32 v65, v65, v64
    v_mul_f32 v66, v66, v64
    v_cvt_pk_bf16_f32 v67, v65, v66
    v_lshlrev_b32 v65, 16, v67
    v_and_b32 v66, 0xffff0000, v67
    s_add_u32 s36, s24, 0x600000
    buffer_store_dword v67, v12, s[8:11], s36 offen
    v_add_f32 v60, v60, v65
    v_add_f32 v61, v61, v66
    v_cvt_pk_bf16_f32 v62, v60, v61
    buffer_store_dword v62, v12, s[60:63], s24 offen
    v_lshlrev_b32 v60, 16, v53
    v_and_b32 v61, 0xffff0000, v53
    v_mul_f32 v63, v65, v60
    v_fmac_f32 v63, v66, v61
    s_nop 1
    v_add_f32_dpp v63, v63, v63 quad_perm:[1,0,3,2] row_mask:0xf bank_mask:0xf
    s_nop 1
    v_add_f32_dpp v63, v63, v63 quad_perm:[2,3,0,1] row_mask:0xf bank_mask:0xf
    s_nop 1
    v_add_f32_dpp v63, v63, v63 row_half_mirror row_mask:0xf bank_mask:0xf
    s_nop 1
    v_add_f32_dpp v63, v63, v63 row_mirror row_mask:0xf bank_mask:0xf
    v_mov_b32 v14, v63
    s_nop 1
    v_permlane16_swap_b32 v63, v14
    v_add_f32 v63, v63, v14
    v_mov_b32 v14, v63
    s_nop 1
    v_permlane32_swap_b32 v63, v14
    v_add_f32 v63, v63, v14
    s_lshr_b32 s36, s24, 6
    s_lshl_b32 s37, s21, 2
    s_add_u32 s36, s36, s37
    s_add_u32 s36, s36, 0x194000
    v_cmp_ne_u32 vcc, 0, v1
    v_mov_b32 v15, 0x40000000
    s_nop 0
    v_cndmask_b32 v15, v1, v15, vcc
    buffer_store_dword v63, v15, s[8:11], s36 offen
    s_barrier
    s_add_u32 s23, s23, 7
    s_cmp_lt_u32 s23, 64
    s_cbranch_scc1 L_P2
L_end:
    s_endpgm
.section .rodata,"a"
.p2align 6
.amdhsa_kernel sequential_preLN__memory_aug_recurrent_mem_tr__moe_arch_mod__prompt_kernel
  .amdhsa_next_free_vgpr 512
  .amdhsa_next_free_sgpr 102
  .amdhsa_accum_offset 256
  .amdhsa_group_segment_fixed_size 0
  .amdhsa_kernarg_size 120
  .amdhsa_user_sgpr_count 2
  .amdhsa_user_sgpr_kernarg_segment_ptr 1
  .amdhsa_system_sgpr_workgroup_id_x 1
.end_amdhsa_kernel
.p2align 6
.amdhsa_kernel route_up_kernel
  .amdhsa_next_free_vgpr 96
  .amdhsa_next_free_sgpr 102
  .amdhsa_accum_offset 96
  .amdhsa_group_segment_fixed_size 0
  .amdhsa_kernarg_size 120
  .amdhsa_user_sgpr_count 2
  .amdhsa_user_sgpr_kernarg_segment_ptr 1
  .amdhsa_system_sgpr_workgroup_id_x 1
.end_amdhsa_kernel
.p2align 6
.amdhsa_kernel down_kernel
  .amdhsa_next_free_vgpr 192
  .amdhsa_next_free_sgpr 102
  .amdhsa_accum_offset 192
  .amdhsa_group_segment_fixed_size 0
  .amdhsa_kernarg_size 120
  .amdhsa_user_sgpr_count 2
  .amdhsa_user_sgpr_kernarg_segment_ptr 1
  .amdhsa_system_sgpr_workgroup_id_x 1
.end_amdhsa_kernel
```

```asm
; @launch grid=(256,1,1) block=(256,1,1) lds=163840
.amdgcn_target "amdgcn-amd-amdhsa--gfx950"
.text
.globl sequential_preLN__memory_aug_recurrent_mem_tr__moe_arch_mod__prompt_kernel
.p2align 8
.type sequential_preLN__memory_aug_recurrent_mem_tr__moe_arch_mod__prompt_kernel,@function
sequential_preLN__memory_aug_recurrent_mem_tr__moe_arch_mod__prompt_kernel:
    s_cmp_ge_u32 s2, 256
    s_cbranch_scc1 L_end
    s_load_dwordx8 s[44:51], s[0:1], 0
    s_load_dwordx4 s[52:55], s[0:1], 32
    s_load_dwordx4 s[56:59], s[0:1], 104
    s_load_dwordx2 s[80:81], s[0:1], 64
    s_load_dwordx2 s[82:83], s[0:1], 96
    s_load_dwordx4 s[84:87], s[0:1], 72
    s_load_dwordx2 s[88:89], s[0:1], 88
    v_lshrrev_b32 v1, 6, v0
    s_nop 0
    v_readfirstlane_b32 s21, v1
    s_waitcnt lgkmcnt(0)
    s_mov_b32 s8, s58
    s_and_b32 s9, s59, 0xffff
    s_mov_b32 s10, 0x10000000
    s_mov_b32 s11, 0x20000
    s_mov_b32 s16, s56
    s_and_b32 s17, s57, 0xffff
    s_mov_b32 s18, 0x100
    s_mov_b32 s19, 0x20000
    s_and_b32 s3, s2, 7
    s_cmp_lg_u32 s3, 0
    s_cbranch_scc1 L_worker
    s_lshr_b32 s20, s2, 3
    v_mov_b32 v1, 0x4444
    v_bfe_u32 v14, v0, 1, 1
    s_mov_b32 s38, 0xaaaa
    v_mad_u32_u24 v1, v14, s38, v1
    v_mov_b32 v3, 0x0
    v_bfe_u32 v14, v0, 0, 1
    s_mov_b32 s38, 0x10
    v_mad_u32_u24 v3, v14, s38, v3
    v_bfe_u32 v14, v0, 1, 1
    s_mov_b32 s38, 0x20
    v_mad_u32_u24 v3, v14, s38, v3
    v_bfe_u32 v14, v0, 2, 1
    s_mov_b32 s38, 0x40
    v_mad_u32_u24 v3, v14, s38, v3
    v_bfe_u32 v14, v0, 3, 1
    s_mov_b32 s38, 0x80
    v_mad_u32_u24 v3, v14, s38, v3
    v_bfe_u32 v14, v0, 4, 1
    s_mov_b32 s38, 0x100
    v_mad_u32_u24 v3, v14, s38, v3
    v_bfe_u32 v14, v0, 5, 1
    s_mov_b32 s38, 0x200
    v_mad_u32_u24 v3, v14, s38, v3
    v_mov_b32 v2, 0x0
    v_bfe_u32 v14, v0, 0, 1
    s_mov_b32 s38, 0x10
    v_mad_u32_u24 v2, v14, s38, v2
    v_bfe_u32 v14, v0, 1, 1
    s_mov_b32 s38, 0x20
    v_mad_u32_u24 v2, v14, s38, v2
    v_bfe_u32 v14, v0, 2, 1
    s_mov_b32 s38, 0x40
    v_mad_u32_u24 v2, v14, s38, v2
    v_bfe_u32 v14, v0, 3, 1
    s_mov_b32 s38, 0x80
    v_mad_u32_u24 v2, v14, s38, v2
    v_bfe_u32 v14, v0, 4, 1
    s_mov_b32 s38, 0x100
    v_mad_u32_u24 v2, v14, s38, v2
    v_bfe_u32 v14, v0, 5, 1
    s_mov_b32 s38, 0x200
    v_mad_u32_u24 v2, v14, s38, v2
    v_bfe_u32 v14, v0, 6, 1
    s_mov_b32 s38, 0x800
    v_mad_u32_u24 v2, v14, s38, v2
    v_bfe_u32 v14, v0, 7, 1
    s_mov_b32 s38, 0x1000
    v_mad_u32_u24 v2, v14, s38, v2
    v_mov_b32 v4, 0x8000
    v_bfe_u32 v14, v0, 0, 1
    s_mov_b32 s38, 0x10
    v_mad_u32_u24 v4, v14, s38, v4
    v_bfe_u32 v14, v0, 1, 1
    s_mov_b32 s38, 0x20
    v_mad_u32_u24 v4, v14, s38, v4
    v_bfe_u32 v14, v0, 2, 1
    s_mov_b32 s38, 0x40
    v_mad_u32_u24 v4, v14, s38, v4
    v_bfe_u32 v14, v0, 3, 1
    s_mov_b32 s38, 0x80
    v_mad_u32_u24 v4, v14, s38, v4
    v_bfe_u32 v14, v0, 4, 1
    s_mov_b32 s38, 0x100
    v_mad_u32_u24 v4, v14, s38, v4
    v_bfe_u32 v14, v0, 5, 1
    s_mov_b32 s38, 0x200
    v_mad_u32_u24 v4, v14, s38, v4
    v_bfe_u32 v14, v0, 6, 1
    s_mov_b32 s38, 0x8000
    v_mad_u32_u24 v4, v14, s38, v4
    v_bfe_u32 v14, v0, 7, 1
    s_mov_b32 s38, 0x10000
    v_mad_u32_u24 v4, v14, s38, v4
    v_mov_b32 v5, 0x4000
    v_bfe_u32 v14, v0, 0, 1
    s_mov_b32 s38, 0x4
    v_mad_u32_u24 v5, v14, s38, v5
    v_bfe_u32 v14, v0, 1, 1
    s_mov_b32 s38, 0x8
    v_mad_u32_u24 v5, v14, s38, v5
    v_bfe_u32 v14, v0, 2, 1
    s_mov_b32 s38, 0x10
    v_mad_u32_u24 v5, v14, s38, v5
    v_bfe_u32 v14, v0, 3, 1
    s_mov_b32 s38, 0x20
    v_mad_u32_u24 v5, v14, s38, v5
    v_bfe_u32 v14, v0, 4, 1
    s_mov_b32 s38, 0x240
    v_mad_u32_u24 v5, v14, s38, v5
    v_bfe_u32 v14, v0, 5, 1
    s_mov_b32 s38, 0x480
    v_mad_u32_u24 v5, v14, s38, v5
    v_bfe_u32 v14, v0, 6, 1
    s_mov_b32 s38, 0x40
    v_mad_u32_u24 v5, v14, s38, v5
    v_bfe_u32 v14, v0, 7, 1
    s_mov_b32 s38, 0x80
    v_mad_u32_u24 v5, v14, s38, v5
    v_mov_b32 v6, 0x4000
    v_bfe_u32 v14, v0, 1, 1
    s_mov_b32 s38, 0x120
    v_mad_u32_u24 v6, v14, s38, v6
    v_bfe_u32 v14, v0, 2, 1
    s_mov_b32 s38, 0x240
    v_mad_u32_u24 v6, v14, s38, v6
    v_bfe_u32 v14, v0, 3, 1
    s_mov_b32 s38, 0x480
    v_mad_u32_u24 v6, v14, s38, v6
    v_bfe_u32 v14, v0, 4, 1
    s_mov_b32 s38, 0x10
    v_mad_u32_u24 v6, v14, s38, v6
    v_bfe_u32 v14, v0, 5, 1
    s_mov_b32 s38, 0x20
    v_mad_u32_u24 v6, v14, s38, v6
    v_mov_b32 v7, 0x4900
    v_bfe_u32 v14, v0, 0, 1
    s_mov_b32 s38, 0x120
    v_mad_u32_u24 v7, v14, s38, v7
    v_bfe_u32 v14, v0, 2, 1
    s_mov_b32 s38, 0x240
    v_mad_u32_u24 v7, v14, s38, v7
    v_bfe_u32 v14, v0, 3, 1
    s_mov_b32 s38, 0x480
    v_mad_u32_u24 v7, v14, s38, v7
    v_bfe_u32 v14, v0, 4, 1
    s_mov_b32 s38, 0x10
    v_mad_u32_u24 v7, v14, s38, v7
    v_bfe_u32 v14, v0, 5, 1
    s_mov_b32 s38, 0x20
    v_mad_u32_u24 v7, v14, s38, v7
    v_mov_b32 v8, 0x5200
    v_bfe_u32 v14, v0, 1, 1
    s_mov_b32 s38, 0x10
    v_mad_u32_u24 v8, v14, s38, v8
    v_bfe_u32 v14, v0, 2, 1
    s_mov_b32 s38, 0x40
    v_mad_u32_u24 v8, v14, s38, v8
    v_bfe_u32 v14, v0, 3, 1
    s_mov_b32 s38, 0x80
    v_mad_u32_u24 v8, v14, s38, v8
    v_bfe_u32 v14, v0, 4, 1
    s_mov_b32 s38, 0x20
    v_mad_u32_u24 v8, v14, s38, v8
    v_bfe_u32 v14, v0, 5, 1
    s_mov_b32 s38, 0x100
    v_mad_u32_u24 v8, v14, s38, v8
    v_bfe_u32 v14, v0, 6, 1
    s_mov_b32 s38, 0x200
    v_mad_u32_u24 v8, v14, s38, v8
    v_bfe_u32 v14, v0, 7, 1
    s_mov_b32 s38, 0x400
    v_mad_u32_u24 v8, v14, s38, v8
    v_mov_b32 v24, 0x0
    v_bfe_u32 v14, v0, 3, 1
    s_mov_b32 s38, 0x1
    v_mad_u32_u24 v24, v14, s38, v24
    v_bfe_u32 v14, v0, 4, 1
    s_mov_b32 s38, 0x2
    v_mad_u32_u24 v24, v14, s38, v24
    v_bfe_u32 v14, v0, 5, 1
    s_mov_b32 s38, 0x4
    v_mad_u32_u24 v24, v14, s38, v24
    v_bfe_u32 v14, v0, 6, 1
    s_mov_b32 s38, 0x8
    v_mad_u32_u24 v24, v14, s38, v24
    v_bfe_u32 v14, v0, 7, 1
    s_mov_b32 s38, 0x10
    v_mad_u32_u24 v24, v14, s38, v24
    v_add_u32 v24, s20, v24
    v_and_b32 v24, 31, v24
    v_lshlrev_b32 v24, 6, v24
    v_mov_b32 v9, 0x0
    v_bfe_u32 v14, v0, 0, 1
    s_mov_b32 s38, 0x8
    v_mad_u32_u24 v9, v14, s38, v9
    v_bfe_u32 v14, v0, 1, 1
    s_mov_b32 s38, 0x10
    v_mad_u32_u24 v9, v14, s38, v9
    v_bfe_u32 v14, v0, 2, 1
    s_mov_b32 s38, 0x20
    v_mad_u32_u24 v9, v14, s38, v9
    v_bfe_u32 v14, v0, 3, 1
    s_mov_b32 s38, 0x2000
    v_mad_u32_u24 v9, v14, s38, v9
    v_bfe_u32 v14, v0, 4, 1
    s_mov_b32 s38, 0x4000
    v_mad_u32_u24 v9, v14, s38, v9
    v_bfe_u32 v14, v0, 5, 1
    s_mov_b32 s38, 0x8000
    v_mad_u32_u24 v9, v14, s38, v9
    v_bfe_u32 v14, v0, 6, 1
    s_mov_b32 s38, 0x10000
    v_mad_u32_u24 v9, v14, s38, v9
    v_bfe_u32 v14, v0, 7, 1
    s_mov_b32 s38, 0x20000
    v_mad_u32_u24 v9, v14, s38, v9
    v_add_u32 v9, v9, v24
    v_mov_b32 v10, 0x80000
    v_bfe_u32 v14, v0, 0, 1
    s_mov_b32 s38, 0x8
    v_mad_u32_u24 v10, v14, s38, v10
    v_bfe_u32 v14, v0, 1, 1
    s_mov_b32 s38, 0x20
    v_mad_u32_u24 v10, v14, s38, v10
    v_bfe_u32 v14, v0, 4, 1
    s_mov_b32 s38, 0x10
    v_mad_u32_u24 v10, v14, s38, v10
    v_bfe_u32 v14, v0, 5, 1
    s_mov_b32 s38, 0x4
    v_mad_u32_u24 v10, v14, s38, v10
    v_bfe_u32 v14, v0, 6, 1
    s_mov_b32 s38, 0x800
    v_mad_u32_u24 v10, v14, s38, v10
    v_bfe_u32 v14, v0, 7, 1
    s_mov_b32 s38, 0x1000
    v_mad_u32_u24 v10, v14, s38, v10
    v_mov_b32 v25, s20
    v_mov_b32 v24, 0x0
    v_bfe_u32 v14, v25, 0, 1
    s_mov_b32 s38, 0x100
    v_mad_u32_u24 v24, v14, s38, v24
    v_bfe_u32 v14, v25, 1, 1
    s_mov_b32 s38, 0x40
    v_mad_u32_u24 v24, v14, s38, v24
    v_bfe_u32 v14, v25, 2, 1
    s_mov_b32 s38, 0x80
    v_mad_u32_u24 v24, v14, s38, v24
    v_bfe_u32 v14, v25, 3, 1
    s_mov_b32 s38, 0x200
    v_mad_u32_u24 v24, v14, s38, v24
    v_bfe_u32 v14, v25, 4, 1
    s_mov_b32 s38, 0x400
    v_mad_u32_u24 v24, v14, s38, v24
    v_add_u32 v10, v24, v10
    v_and_b32 v24, 12, v0
    v_cmp_ne_u32 vcc, 0, v24
    v_mov_b32 v24, 0x40000000
    s_nop 0
    v_cndmask_b32 v10, v10, v24, vcc
    s_lshl_b32 s6, s20, 13
    s_add_u32 s6, s6, 0x0
    s_mov_b32 s26, 4096
    v_and_b32 v24, 15, v0
    v_mov_b32 v16, 0
    v_mov_b32 v25, 0x3f80
    v_cmp_eq_u32 vcc, 0, v24
    s_nop 1
    v_cndmask_b32 v16, v16, v25, vcc
    v_mov_b32 v25, 0x3f800000
    v_cmp_eq_u32 vcc, 1, v24
    s_nop 1
    v_cndmask_b32 v16, v16, v25, vcc
    v_mov_b32 v17, 0
    v_mov_b32 v25, 0x3f80
    v_cmp_eq_u32 vcc, 4, v24
    s_nop 1
    v_cndmask_b32 v17, v17, v25, vcc
    v_mov_b32 v25, 0x3f800000
    v_cmp_eq_u32 vcc, 5, v24
    s_nop 1
    v_cndmask_b32 v17, v17, v25, vcc
    v_mov_b32 v18, 0
    v_mov_b32 v25, 0x3f80
    v_cmp_eq_u32 vcc, 8, v24
    s_nop 1
    v_cndmask_b32 v18, v18, v25, vcc
    v_mov_b32 v25, 0x3f800000
    v_cmp_eq_u32 vcc, 9, v24
    s_nop 1
    v_cndmask_b32 v18, v18, v25, vcc
    v_mov_b32 v19, 0
    v_mov_b32 v25, 0x3f80
    v_cmp_eq_u32 vcc, 12, v24
    s_nop 1
    v_cndmask_b32 v19, v19, v25, vcc
    v_mov_b32 v25, 0x3f800000
    v_cmp_eq_u32 vcc, 13, v24
    s_nop 1
    v_cndmask_b32 v19, v19, v25, vcc
    ds_write_b128 v3, v[16:19] offset:23040
    s_mov_b32 s34, 0x05040100
    s_mov_b32 s35, 0x07060302
    s_mov_b32 s33, 0x3e0293ee
    s_mov_b32 s40, 0x4e800000
    s_mov_b32 s32, 0
    s_mov_b32 s4, 0x3f803f80
    s_mov_b32 s5, 0x3f803f80
    s_lshl_b32 s36, s20, 14
    s_lshr_b32 s37, s21, 1
    s_lshl_b32 s37, s37, 12
    s_add_u32 s25, s36, s37
    s_lshl_b32 s37, s21, 11
    s_add_u32 s39, s36, s37
    s_add_u32 s39, s39, 8192
    v_mov_b32 v20, -1
    v_mov_b32 v21, -1
    v_mov_b32 v22, -1
    v_mov_b32 v23, -1
    buffer_store_dwordx4 v[20:23], v2, s[8:11], s6 offen sc1
    buffer_store_dwordx4 v[20:23], v2, s[8:11], s6 offen offset:1024 sc1
    s_lshl_b32 s36, s20, 14
    s_add_u32 s36, s36, 0x100000
    s_add_u32 s37, s36, 0x2000
    buffer_store_dwordx4 v[20:23], v2, s[8:11], s36 offen sc1
    buffer_store_dwordx4 v[20:23], v2, s[8:11], s36 offen offset:1024 sc1
    buffer_store_dwordx4 v[20:23], v2, s[8:11], s37 offen sc1
    buffer_store_dwordx4 v[20:23], v2, s[8:11], s37 offen offset:1024 sc1
    s_mul_i32 s36, s20, 0x104000
    s_add_u32 s36, s36, 0x1102000
    s_add_u32 s37, s36, 0x82000
    buffer_store_dwordx4 v[20:23], v2, s[8:11], s36 offen sc1
    buffer_store_dwordx4 v[20:23], v2, s[8:11], s36 offen offset:1024 sc1
    buffer_store_dwordx4 v[20:23], v2, s[8:11], s37 offen sc1
    buffer_store_dwordx4 v[20:23], v2, s[8:11], s37 offen offset:1024 sc1
    v_lshlrev_b32 v24, 2, v0
    s_lshl_b32 s36, s20, 10
    s_add_u32 s37, s36, 0x194000
    buffer_store_dword v20, v24, s[8:11], s37 offen sc1
    s_add_u32 s37, s36, 0x1b0000
    buffer_store_dword v20, v24, s[8:11], s37 offen sc1
    v_lshlrev_b32 v24, 2, v0
    v_mov_b32 v25, 0x40000000
    v_cmp_lt_u32 vcc, 63, v0
    s_nop 1
    v_cndmask_b32 v24, v24, v25, vcc
    v_mov_b32 v25, 0
    s_lshl_b32 s36, s20, 8
    s_add_u32 s36, s36, 0x190000
    s_add_u32 s37, s36, 0x2000
    buffer_store_dword v25, v24, s[8:11], s36 offen sc1
    buffer_store_dword v25, v24, s[8:11], s37 offen sc1
    s_mov_b32 s12, s46
    s_and_b32 s13, s47, 0xffff
    s_mov_b32 s14, 0x2000
    s_mov_b32 s15, 0x20000
    v_mov_b32 v24, 0x0
    v_bfe_u32 v14, v0, 0, 1
    s_mov_b32 s38, 0x8
    v_mad_u32_u24 v24, v14, s38, v24
    v_bfe_u32 v14, v0, 1, 1
    s_mov_b32 s38, 0x10
    v_mad_u32_u24 v24, v14, s38, v24
    v_bfe_u32 v14, v0, 2, 1
    s_mov_b32 s38, 0x10000
    v_mad_u32_u24 v24, v14, s38, v24
    v_bfe_u32 v14, v0, 3, 1
    s_mov_b32 s38, 0x10000
    v_mad_u32_u24 v24, v14, s38, v24
    v_bfe_u32 v14, v0, 4, 1
    s_mov_b32 s38, 0x400
    v_mad_u32_u24 v24, v14, s38, v24
    v_bfe_u32 v14, v0, 5, 1
    s_mov_b32 s38, 0x4
    v_mad_u32_u24 v24, v14, s38, v24
    v_bfe_u32 v14, v0, 6, 1
    s_mov_b32 s38, 0x40
    v_mad_u32_u24 v24, v14, s38, v24
    v_bfe_u32 v14, v0, 7, 1
    s_mov_b32 s38, 0x80
    v_mad_u32_u24 v24, v14, s38, v24
    v_mov_b32 v16, s20
    v_mov_b32 v25, 0x0
    v_bfe_u32 v14, v16, 0, 1
    s_mov_b32 s38, 0x20
    v_mad_u32_u24 v25, v14, s38, v25
    v_bfe_u32 v14, v16, 1, 1
    s_mov_b32 s38, 0x800
    v_mad_u32_u24 v25, v14, s38, v25
    v_bfe_u32 v14, v16, 2, 1
    s_mov_b32 s38, 0x1000
    v_mad_u32_u24 v25, v14, s38, v25
    v_bfe_u32 v14, v16, 3, 1
    s_mov_b32 s38, 0x100
    v_mad_u32_u24 v25, v14, s38, v25
    v_bfe_u32 v14, v16, 4, 1
    s_mov_b32 s38, 0x200
    v_mad_u32_u24 v25, v14, s38, v25
    v_add_u32 v24, v24, v25
    buffer_load_dword v12, v24, s[12:15], 0 offen
    s_waitcnt vmcnt(0)
    s_mov_b32 s36, 0x1000000
    buffer_store_dword v12, v10, s[8:11], s36 offen sc1
    s_waitcnt vmcnt(0) lgkmcnt(0)
    s_barrier
    s_getreg_b32 s36, hwreg(HW_REG_XCC_ID)
    s_and_b32 s36, s36, 15
    s_or_b32 s36, s36, 0x100
    v_mov_b32 v24, s36
    s_lshl_b32 s37, s20, 2
    v_lshlrev_b32 v25, 20, v0
    buffer_store_dword v24, v25, s[16:19], s37 offen sc1
    v_mov_b32 v15, 0x0
    v_bfe_u32 v14, v0, 0, 1
    s_mov_b32 s38, 0x4
    v_mad_u32_u24 v15, v14, s38, v15
    v_bfe_u32 v14, v0, 1, 1
    s_mov_b32 s38, 0x8
    v_mad_u32_u24 v15, v14, s38, v15
    v_bfe_u32 v14, v0, 2, 1
    s_mov_b32 s38, 0x10
    v_mad_u32_u24 v15, v14, s38, v15
    v_bfe_u32 v14, v0, 3, 1
    s_mov_b32 s38, 0x20
    v_mad_u32_u24 v15, v14, s38, v15
    v_bfe_u32 v14, v0, 4, 1
    s_mov_b32 s38, 0x8000
    v_mad_u32_u24 v15, v14, s38, v15
    v_bfe_u32 v14, v0, 5, 1
    s_mov_b32 s38, 0x20000
    v_mad_u32_u24 v15, v14, s38, v15
    v_bfe_u32 v14, v0, 6, 1
    s_mov_b32 s38, 0x40
    v_mad_u32_u24 v15, v14, s38, v15
    v_bfe_u32 v14, v0, 7, 1
    s_mov_b32 s38, 0x80
    v_mad_u32_u24 v15, v14, s38, v15
    v_mov_b32 v11, 0x0
    v_bfe_u32 v14, v0, 0, 1
    s_mov_b32 s38, 0x4
    v_mad_u32_u24 v11, v14, s38, v11
    v_bfe_u32 v14, v0, 1, 1
    s_mov_b32 s38, 0x8
    v_mad_u32_u24 v11, v14, s38, v11
    v_bfe_u32 v14, v0, 2, 1
    s_mov_b32 s38, 0x10
    v_mad_u32_u24 v11, v14, s38, v11
    v_bfe_u32 v14, v0, 3, 1
    s_mov_b32 s38, 0x20
    v_mad_u32_u24 v11, v14, s38, v11
    v_bfe_u32 v14, v0, 4, 1
    s_mov_b32 s38, 0x1000
    v_mad_u32_u24 v11, v14, s38, v11
    v_bfe_u32 v14, v0, 5, 1
    s_mov_b32 s38, 0x4000
    v_mad_u32_u24 v11, v14, s38, v11
    v_bfe_u32 v14, v0, 6, 1
    s_mov_b32 s38, 0x100
    v_mad_u32_u24 v11, v14, s38, v11
    v_bfe_u32 v14, v0, 7, 1
    s_mov_b32 s38, 0x200
    v_mad_u32_u24 v11, v14, s38, v11
    s_mov_b32 s96, s48
    s_and_b32 s97, s49, 0xffff
    s_mov_b32 s98, 0x400000
    s_mov_b32 s99, 0x20000
    s_mov_b32 s12, s50
    s_and_b32 s13, s51, 0xffff
    s_mov_b32 s14, 0x400000
    s_mov_b32 s15, 0x20000
    s_mov_b32 s60, s52
    s_and_b32 s61, s53, 0xffff
    s_mov_b32 s62, 0x400000
    s_mov_b32 s63, 0x20000
    s_mov_b32 s92, s54
    s_and_b32 s93, s55, 0xffff
    s_mov_b32 s94, 0x400000
    s_mov_b32 s95, 0x20000
    s_xor_b32 s36, s21, 0
    s_lshl_b32 s36, s36, 18
    s_lshl_b32 s37, s20, 8
    s_add_u32 s36, s36, s37
    s_add_u32 s37, s36, 0x0
    buffer_load_dword v16, v15, s[96:99], s37 offen
    s_add_u32 s37, s36, 0x2000
    buffer_load_dword v17, v15, s[96:99], s37 offen
    s_add_u32 s37, s36, 0x10000
    buffer_load_dword v18, v15, s[96:99], s37 offen
    s_add_u32 s37, s36, 0x12000
    buffer_load_dword v19, v15, s[96:99], s37 offen
    s_add_u32 s37, s36, 0x4000
    buffer_load_dword v20, v15, s[96:99], s37 offen
    s_add_u32 s37, s36, 0x6000
    buffer_load_dword v21, v15, s[96:99], s37 offen
    s_add_u32 s37, s36, 0x14000
    buffer_load_dword v22, v15, s[96:99], s37 offen
    s_add_u32 s37, s36, 0x16000
    buffer_load_dword v23, v15, s[96:99], s37 offen
    s_add_u32 s37, s36, 0x100000
    buffer_load_dword v24, v15, s[96:99], s37 offen
    s_add_u32 s37, s36, 0x102000
    buffer_load_dword v25, v15, s[96:99], s37 offen
    s_add_u32 s37, s36, 0x110000
    buffer_load_dword v26, v15, s[96:99], s37 offen
    s_add_u32 s37, s36, 0x112000
    buffer_load_dword v27, v15, s[96:99], s37 offen
    s_add_u32 s37, s36, 0x104000
    buffer_load_dword v28, v15, s[96:99], s37 offen
    s_add_u32 s37, s36, 0x106000
    buffer_load_dword v29, v15, s[96:99], s37 offen
    s_add_u32 s37, s36, 0x114000
    buffer_load_dword v30, v15, s[96:99], s37 offen
    s_add_u32 s37, s36, 0x116000
    buffer_load_dword v31, v15, s[96:99], s37 offen
    s_xor_b32 s36, s21, 0
    s_lshl_b32 s36, s36, 18
    s_lshl_b32 s37, s20, 8
    s_add_u32 s36, s36, s37
    s_add_u32 s37, s36, 0x200000
    buffer_load_dword v32, v15, s[96:99], s37 offen
    s_add_u32 s37, s36, 0x202000
    buffer_load_dword v33, v15, s[96:99], s37 offen
    s_add_u32 s37, s36, 0x210000
    buffer_load_dword v34, v15, s[96:99], s37 offen
    s_add_u32 s37, s36, 0x212000
    buffer_load_dword v35, v15, s[96:99], s37 offen
    s_add_u32 s37, s36, 0x204000
    buffer_load_dword v36, v15, s[96:99], s37 offen
    s_add_u32 s37, s36, 0x206000
    buffer_load_dword v37, v15, s[96:99], s37 offen
    s_add_u32 s37, s36, 0x214000
    buffer_load_dword v38, v15, s[96:99], s37 offen
    s_add_u32 s37, s36, 0x216000
    buffer_load_dword v39, v15, s[96:99], s37 offen
    s_add_u32 s37, s36, 0x300000
    buffer_load_dword v40, v15, s[96:99], s37 offen
    s_add_u32 s37, s36, 0x302000
    buffer_load_dword v41, v15, s[96:99], s37 offen
    s_add_u32 s37, s36, 0x310000
    buffer_load_dword v42, v15, s[96:99], s37 offen
    s_add_u32 s37, s36, 0x312000
    buffer_load_dword v43, v15, s[96:99], s37 offen
    s_add_u32 s37, s36, 0x304000
    buffer_load_dword v44, v15, s[96:99], s37 offen
    s_add_u32 s37, s36, 0x306000
    buffer_load_dword v45, v15, s[96:99], s37 offen
    s_add_u32 s37, s36, 0x314000
    buffer_load_dword v46, v15, s[96:99], s37 offen
    s_add_u32 s37, s36, 0x316000
    buffer_load_dword v47, v15, s[96:99], s37 offen
    s_xor_b32 s36, s21, 1
    s_lshl_b32 s36, s36, 18
    s_lshl_b32 s37, s20, 8
    s_add_u32 s36, s36, s37
    s_add_u32 s37, s36, 0x0
    buffer_load_dword v48, v15, s[96:99], s37 offen
    s_add_u32 s37, s36, 0x2000
    buffer_load_dword v49, v15, s[96:99], s37 offen
    s_add_u32 s37, s36, 0x10000
    buffer_load_dword v50, v15, s[96:99], s37 offen
    s_add_u32 s37, s36, 0x12000
    buffer_load_dword v51, v15, s[96:99], s37 offen
    s_add_u32 s37, s36, 0x4000
    buffer_load_dword v52, v15, s[96:99], s37 offen
    s_add_u32 s37, s36, 0x6000
    buffer_load_dword v53, v15, s[96:99], s37 offen
    s_add_u32 s37, s36, 0x14000
    buffer_load_dword v54, v15, s[96:99], s37 offen
    s_add_u32 s37, s36, 0x16000
    buffer_load_dword v55, v15, s[96:99], s37 offen
    s_add_u32 s37, s36, 0x100000
    buffer_load_dword v56, v15, s[96:99], s37 offen
    s_add_u32 s37, s36, 0x102000
    buffer_load_dword v57, v15, s[96:99], s37 offen
    s_add_u32 s37, s36, 0x110000
    buffer_load_dword v58, v15, s[96:99], s37 offen
    s_add_u32 s37, s36, 0x112000
    buffer_load_dword v59, v15, s[96:99], s37 offen
    s_add_u32 s37, s36, 0x104000
    buffer_load_dword v60, v15, s[96:99], s37 offen
    s_add_u32 s37, s36, 0x106000
    buffer_load_dword v61, v15, s[96:99], s37 offen
    s_add_u32 s37, s36, 0x114000
    buffer_load_dword v62, v15, s[96:99], s37 offen
    s_add_u32 s37, s36, 0x116000
    buffer_load_dword v63, v15, s[96:99], s37 offen
    s_waitcnt vmcnt(32)
    s_xor_b32 s36, s21, 1
    s_lshl_b32 s36, s36, 18
    s_lshl_b32 s37, s20, 8
    s_add_u32 s36, s36, s37
    s_add_u32 s37, s36, 0x200000
    buffer_load_dword v64, v15, s[96:99], s37 offen
    s_add_u32 s37, s36, 0x202000
    buffer_load_dword v65, v15, s[96:99], s37 offen
    s_add_u32 s37, s36, 0x210000
    buffer_load_dword v66, v15, s[96:99], s37 offen
    s_add_u32 s37, s36, 0x212000
    buffer_load_dword v67, v15, s[96:99], s37 offen
    s_add_u32 s37, s36, 0x204000
    buffer_load_dword v68, v15, s[96:99], s37 offen
    s_add_u32 s37, s36, 0x206000
    buffer_load_dword v69, v15, s[96:99], s37 offen
    s_add_u32 s37, s36, 0x214000
    buffer_load_dword v70, v15, s[96:99], s37 offen
    s_add_u32 s37, s36, 0x216000
    buffer_load_dword v71, v15, s[96:99], s37 offen
    s_add_u32 s37, s36, 0x300000
    buffer_load_dword v72, v15, s[96:99], s37 offen
    s_add_u32 s37, s36, 0x302000
    buffer_load_dword v73, v15, s[96:99], s37 offen
    s_add_u32 s37, s36, 0x310000
    buffer_load_dword v74, v15, s[96:99], s37 offen
    s_add_u32 s37, s36, 0x312000
    buffer_load_dword v75, v15, s[96:99], s37 offen
    s_add_u32 s37, s36, 0x304000
    buffer_load_dword v76, v15, s[96:99], s37 offen
    s_add_u32 s37, s36, 0x306000
    buffer_load_dword v77, v15, s[96:99], s37 offen
    s_add_u32 s37, s36, 0x314000
    buffer_load_dword v78, v15, s[96:99], s37 offen
    s_add_u32 s37, s36, 0x316000
    buffer_load_dword v79, v15, s[96:99], s37 offen
    v_perm_b32 v120, v17, v16, s34
    v_perm_b32 v121, v19, v18, s34
    v_perm_b32 v122, v21, v20, s34
    v_perm_b32 v123, v23, v22, s34
    v_perm_b32 v124, v25, v24, s34
    v_perm_b32 v125, v27, v26, s34
    v_perm_b32 v126, v29, v28, s34
    v_perm_b32 v127, v31, v30, s34
    ds_write_b128 v4, v[120:123] offset:0
    ds_write_b128 v4, v[124:127] offset:1024
    s_waitcnt lgkmcnt(0)
    v_perm_b32 v120, v17, v16, s35
    v_perm_b32 v121, v19, v18, s35
    v_perm_b32 v122, v21, v20, s35
    v_perm_b32 v123, v23, v22, s35
    v_perm_b32 v124, v25, v24, s35
    v_perm_b32 v125, v27, v26, s35
    v_perm_b32 v126, v29, v28, s35
    v_perm_b32 v127, v31, v30, s35
    ds_write_b128 v4, v[120:123] offset:2048
    ds_write_b128 v4, v[124:127] offset:3072
    s_waitcnt lgkmcnt(0)
    s_waitcnt vmcnt(32)
    s_xor_b32 s36, s21, 2
    s_lshl_b32 s36, s36, 18
    s_lshl_b32 s37, s20, 8
    s_add_u32 s36, s36, s37
    s_add_u32 s37, s36, 0x0
    buffer_load_dword v16, v15, s[96:99], s37 offen
    s_add_u32 s37, s36, 0x2000
    buffer_load_dword v17, v15, s[96:99], s37 offen
    s_add_u32 s37, s36, 0x10000
    buffer_load_dword v18, v15, s[96:99], s37 offen
    s_add_u32 s37, s36, 0x12000
    buffer_load_dword v19, v15, s[96:99], s37 offen
    s_add_u32 s37, s36, 0x4000
    buffer_load_dword v20, v15, s[96:99], s37 offen
    s_add_u32 s37, s36, 0x6000
    buffer_load_dword v21, v15, s[96:99], s37 offen
    s_add_u32 s37, s36, 0x14000
    buffer_load_dword v22, v15, s[96:99], s37 offen
    s_add_u32 s37, s36, 0x16000
    buffer_load_dword v23, v15, s[96:99], s37 offen
    s_add_u32 s37, s36, 0x100000
    buffer_load_dword v24, v15, s[96:99], s37 offen
    s_add_u32 s37, s36, 0x102000
    buffer_load_dword v25, v15, s[96:99], s37 offen
    s_add_u32 s37, s36, 0x110000
    buffer_load_dword v26, v15, s[96:99], s37 offen
    s_add_u32 s37, s36, 0x112000
    buffer_load_dword v27, v15, s[96:99], s37 offen
    s_add_u32 s37, s36, 0x104000
    buffer_load_dword v28, v15, s[96:99], s37 offen
    s_add_u32 s37, s36, 0x106000
    buffer_load_dword v29, v15, s[96:99], s37 offen
    s_add_u32 s37, s36, 0x114000
    buffer_load_dword v30, v15, s[96:99], s37 offen
    s_add_u32 s37, s36, 0x116000
    buffer_load_dword v31, v15, s[96:99], s37 offen
    v_perm_b32 v120, v33, v32, s34
    v_perm_b32 v121, v35, v34, s34
    v_perm_b32 v122, v37, v36, s34
    v_perm_b32 v123, v39, v38, s34
    v_perm_b32 v124, v41, v40, s34
    v_perm_b32 v125, v43, v42, s34
    v_perm_b32 v126, v45, v44, s34
    v_perm_b32 v127, v47, v46, s34
    ds_write_b128 v4, v[120:123] offset:4096
    ds_write_b128 v4, v[124:127] offset:5120
    s_waitcnt lgkmcnt(0)
    v_perm_b32 v120, v33, v32, s35
    v_perm_b32 v121, v35, v34, s35
    v_perm_b32 v122, v37, v36, s35
    v_perm_b32 v123, v39, v38, s35
    v_perm_b32 v124, v41, v40, s35
    v_perm_b32 v125, v43, v42, s35
    v_perm_b32 v126, v45, v44, s35
    v_perm_b32 v127, v47, v46, s35
    ds_write_b128 v4, v[120:123] offset:6144
    ds_write_b128 v4, v[124:127] offset:7168
    s_waitcnt lgkmcnt(0)
    s_waitcnt vmcnt(32)
    s_xor_b32 s36, s21, 2
    s_lshl_b32 s36, s36, 18
    s_lshl_b32 s37, s20, 8
    s_add_u32 s36, s36, s37
    s_add_u32 s37, s36, 0x200000
    buffer_load_dword v32, v15, s[96:99], s37 offen
    s_add_u32 s37, s36, 0x202000
    buffer_load_dword v33, v15, s[96:99], s37 offen
    s_add_u32 s37, s36, 0x210000
    buffer_load_dword v34, v15, s[96:99], s37 offen
    s_add_u32 s37, s36, 0x212000
    buffer_load_dword v35, v15, s[96:99], s37 offen
    s_add_u32 s37, s36, 0x204000
    buffer_load_dword v36, v15, s[96:99], s37 offen
    s_add_u32 s37, s36, 0x206000
    buffer_load_dword v37, v15, s[96:99], s37 offen
    s_add_u32 s37, s36, 0x214000
    buffer_load_dword v38, v15, s[96:99], s37 offen
    s_add_u32 s37, s36, 0x216000
    buffer_load_dword v39, v15, s[96:99], s37 offen
    s_add_u32 s37, s36, 0x300000
    buffer_load_dword v40, v15, s[96:99], s37 offen
    s_add_u32 s37, s36, 0x302000
    buffer_load_dword v41, v15, s[96:99], s37 offen
    s_add_u32 s37, s36, 0x310000
    buffer_load_dword v42, v15, s[96:99], s37 offen
    s_add_u32 s37, s36, 0x312000
    buffer_load_dword v43, v15, s[96:99], s37 offen
    s_add_u32 s37, s36, 0x304000
    buffer_load_dword v44, v15, s[96:99], s37 offen
    s_add_u32 s37, s36, 0x306000
    buffer_load_dword v45, v15, s[96:99], s37 offen
    s_add_u32 s37, s36, 0x314000
    buffer_load_dword v46, v15, s[96:99], s37 offen
    s_add_u32 s37, s36, 0x316000
    buffer_load_dword v47, v15, s[96:99], s37 offen
    v_perm_b32 v120, v49, v48, s34
    v_accvgpr_write_b32 a0, v120
    v_perm_b32 v121, v51, v50, s34
    v_accvgpr_write_b32 a1, v121
    v_perm_b32 v122, v53, v52, s34
    v_accvgpr_write_b32 a2, v122
    v_perm_b32 v123, v55, v54, s34
    v_accvgpr_write_b32 a3, v123
    v_perm_b32 v124, v57, v56, s34
    v_accvgpr_write_b32 a4, v124
    v_perm_b32 v125, v59, v58, s34
    v_accvgpr_write_b32 a5, v125
    v_perm_b32 v126, v61, v60, s34
    v_accvgpr_write_b32 a6, v126
    v_perm_b32 v127, v63, v62, s34
    v_accvgpr_write_b32 a7, v127
    v_perm_b32 v120, v49, v48, s35
    v_accvgpr_write_b32 a8, v120
    v_perm_b32 v121, v51, v50, s35
    v_accvgpr_write_b32 a9, v121
    v_perm_b32 v122, v53, v52, s35
    v_accvgpr_write_b32 a10, v122
    v_perm_b32 v123, v55, v54, s35
    v_accvgpr_write_b32 a11, v123
    v_perm_b32 v124, v57, v56, s35
    v_accvgpr_write_b32 a12, v124
    v_perm_b32 v125, v59, v58, s35
    v_accvgpr_write_b32 a13, v125
    v_perm_b32 v126, v61, v60, s35
    v_accvgpr_write_b32 a14, v126
    v_perm_b32 v127, v63, v62, s35
    v_accvgpr_write_b32 a15, v127
    s_waitcnt vmcnt(32)
    s_xor_b32 s36, s21, 3
    s_lshl_b32 s36, s36, 18
    s_lshl_b32 s37, s20, 8
    s_add_u32 s36, s36, s37
    s_add_u32 s37, s36, 0x0
    buffer_load_dword v48, v15, s[96:99], s37 offen
    s_add_u32 s37, s36, 0x2000
    buffer_load_dword v49, v15, s[96:99], s37 offen
    s_add_u32 s37, s36, 0x10000
    buffer_load_dword v50, v15, s[96:99], s37 offen
    s_add_u32 s37, s36, 0x12000
    buffer_load_dword v51, v15, s[96:99], s37 offen
    s_add_u32 s37, s36, 0x4000
    buffer_load_dword v52, v15, s[96:99], s37 offen
    s_add_u32 s37, s36, 0x6000
    buffer_load_dword v53, v15, s[96:99], s37 offen
    s_add_u32 s37, s36, 0x14000
    buffer_load_dword v54, v15, s[96:99], s37 offen
    s_add_u32 s37, s36, 0x16000
    buffer_load_dword v55, v15, s[96:99], s37 offen
    s_add_u32 s37, s36, 0x100000
    buffer_load_dword v56, v15, s[96:99], s37 offen
    s_add_u32 s37, s36, 0x102000
    buffer_load_dword v57, v15, s[96:99], s37 offen
    s_add_u32 s37, s36, 0x110000
    buffer_load_dword v58, v15, s[96:99], s37 offen
    s_add_u32 s37, s36, 0x112000
    buffer_load_dword v59, v15, s[96:99], s37 offen
    s_add_u32 s37, s36, 0x104000
    buffer_load_dword v60, v15, s[96:99], s37 offen
    s_add_u32 s37, s36, 0x106000
    buffer_load_dword v61, v15, s[96:99], s37 offen
    s_add_u32 s37, s36, 0x114000
    buffer_load_dword v62, v15, s[96:99], s37 offen
    s_add_u32 s37, s36, 0x116000
    buffer_load_dword v63, v15, s[96:99], s37 offen
    v_perm_b32 v120, v65, v64, s34
    v_accvgpr_write_b32 a16, v120
    v_perm_b32 v121, v67, v66, s34
    v_accvgpr_write_b32 a17, v121
    v_perm_b32 v122, v69, v68, s34
    v_accvgpr_write_b32 a18, v122
    v_perm_b32 v123, v71, v70, s34
    v_accvgpr_write_b32 a19, v123
    v_perm_b32 v124, v73, v72, s34
    v_accvgpr_write_b32 a20, v124
    v_perm_b32 v125, v75, v74, s34
    v_accvgpr_write_b32 a21, v125
    v_perm_b32 v126, v77, v76, s34
    v_accvgpr_write_b32 a22, v126
    v_perm_b32 v127, v79, v78, s34
    v_accvgpr_write_b32 a23, v127
    v_perm_b32 v120, v65, v64, s35
    v_accvgpr_write_b32 a24, v120
    v_perm_b32 v121, v67, v66, s35
    v_accvgpr_write_b32 a25, v121
    v_perm_b32 v122, v69, v68, s35
    v_accvgpr_write_b32 a26, v122
    v_perm_b32 v123, v71, v70, s35
    v_accvgpr_write_b32 a27, v123
    v_perm_b32 v124, v73, v72, s35
    v_accvgpr_write_b32 a28, v124
    v_perm_b32 v125, v75, v74, s35
    v_accvgpr_write_b32 a29, v125
    v_perm_b32 v126, v77, v76, s35
    v_accvgpr_write_b32 a30, v126
    v_perm_b32 v127, v79, v78, s35
    v_accvgpr_write_b32 a31, v127
    s_waitcnt vmcnt(32)
    s_xor_b32 s36, s21, 3
    s_lshl_b32 s36, s36, 18
    s_lshl_b32 s37, s20, 8
    s_add_u32 s36, s36, s37
    s_add_u32 s37, s36, 0x200000
    buffer_load_dword v64, v15, s[96:99], s37 offen
    s_add_u32 s37, s36, 0x202000
    buffer_load_dword v65, v15, s[96:99], s37 offen
    s_add_u32 s37, s36, 0x210000
    buffer_load_dword v66, v15, s[96:99], s37 offen
    s_add_u32 s37, s36, 0x212000
    buffer_load_dword v67, v15, s[96:99], s37 offen
    s_add_u32 s37, s36, 0x204000
    buffer_load_dword v68, v15, s[96:99], s37 offen
    s_add_u32 s37, s36, 0x206000
    buffer_load_dword v69, v15, s[96:99], s37 offen
    s_add_u32 s37, s36, 0x214000
    buffer_load_dword v70, v15, s[96:99], s37 offen
    s_add_u32 s37, s36, 0x216000
    buffer_load_dword v71, v15, s[96:99], s37 offen
    s_add_u32 s37, s36, 0x300000
    buffer_load_dword v72, v15, s[96:99], s37 offen
    s_add_u32 s37, s36, 0x302000
    buffer_load_dword v73, v15, s[96:99], s37 offen
    s_add_u32 s37, s36, 0x310000
    buffer_load_dword v74, v15, s[96:99], s37 offen
    s_add_u32 s37, s36, 0x312000
    buffer_load_dword v75, v15, s[96:99], s37 offen
    s_add_u32 s37, s36, 0x304000
    buffer_load_dword v76, v15, s[96:99], s37 offen
    s_add_u32 s37, s36, 0x306000
    buffer_load_dword v77, v15, s[96:99], s37 offen
    s_add_u32 s37, s36, 0x314000
    buffer_load_dword v78, v15, s[96:99], s37 offen
    s_add_u32 s37, s36, 0x316000
    buffer_load_dword v79, v15, s[96:99], s37 offen
    v_perm_b32 v120, v17, v16, s34
    v_accvgpr_write_b32 a32, v120
    v_perm_b32 v121, v19, v18, s34
    v_accvgpr_write_b32 a33, v121
    v_perm_b32 v122, v21, v20, s34
    v_accvgpr_write_b32 a34, v122
    v_perm_b32 v123, v23, v22, s34
    v_accvgpr_write_b32 a35, v123
    v_perm_b32 v124, v25, v24, s34
    v_accvgpr_write_b32 a36, v124
    v_perm_b32 v125, v27, v26, s34
    v_accvgpr_write_b32 a37, v125
    v_perm_b32 v126, v29, v28, s34
    v_accvgpr_write_b32 a38, v126
    v_perm_b32 v127, v31, v30, s34
    v_accvgpr_write_b32 a39, v127
    v_perm_b32 v120, v17, v16, s35
    v_accvgpr_write_b32 a40, v120
    v_perm_b32 v121, v19, v18, s35
    v_accvgpr_write_b32 a41, v121
    v_perm_b32 v122, v21, v20, s35
    v_accvgpr_write_b32 a42, v122
    v_perm_b32 v123, v23, v22, s35
    v_accvgpr_write_b32 a43, v123
    v_perm_b32 v124, v25, v24, s35
    v_accvgpr_write_b32 a44, v124
    v_perm_b32 v125, v27, v26, s35
    v_accvgpr_write_b32 a45, v125
    v_perm_b32 v126, v29, v28, s35
    v_accvgpr_write_b32 a46, v126
    v_perm_b32 v127, v31, v30, s35
    v_accvgpr_write_b32 a47, v127
    s_waitcnt vmcnt(32)
    s_xor_b32 s36, s21, 0
    s_lshl_b32 s36, s36, 18
    s_lshl_b32 s37, s20, 8
    s_add_u32 s36, s36, s37
    s_add_u32 s37, s36, 0x0
    buffer_load_dword v16, v15, s[12:15], s37 offen
    s_add_u32 s37, s36, 0x2000
    buffer_load_dword v17, v15, s[12:15], s37 offen
    s_add_u32 s37, s36, 0x10000
    buffer_load_dword v18, v15, s[12:15], s37 offen
    s_add_u32 s37, s36, 0x12000
    buffer_load_dword v19, v15, s[12:15], s37 offen
    s_add_u32 s37, s36, 0x4000
    buffer_load_dword v20, v15, s[12:15], s37 offen
    s_add_u32 s37, s36, 0x6000
    buffer_load_dword v21, v15, s[12:15], s37 offen
    s_add_u32 s37, s36, 0x14000
    buffer_load_dword v22, v15, s[12:15], s37 offen
    s_add_u32 s37, s36, 0x16000
    buffer_load_dword v23, v15, s[12:15], s37 offen
    s_add_u32 s37, s36, 0x100000
    buffer_load_dword v24, v15, s[12:15], s37 offen
    s_add_u32 s37, s36, 0x102000
    buffer_load_dword v25, v15, s[12:15], s37 offen
    s_add_u32 s37, s36, 0x110000
    buffer_load_dword v26, v15, s[12:15], s37 offen
    s_add_u32 s37, s36, 0x112000
    buffer_load_dword v27, v15, s[12:15], s37 offen
    s_add_u32 s37, s36, 0x104000
    buffer_load_dword v28, v15, s[12:15], s37 offen
    s_add_u32 s37, s36, 0x106000
    buffer_load_dword v29, v15, s[12:15], s37 offen
    s_add_u32 s37, s36, 0x114000
    buffer_load_dword v30, v15, s[12:15], s37 offen
    s_add_u32 s37, s36, 0x116000
    buffer_load_dword v31, v15, s[12:15], s37 offen
    v_perm_b32 v120, v33, v32, s34
    v_accvgpr_write_b32 a48, v120
    v_perm_b32 v121, v35, v34, s34
    v_accvgpr_write_b32 a49, v121
    v_perm_b32 v122, v37, v36, s34
    v_accvgpr_write_b32 a50, v122
    v_perm_b32 v123, v39, v38, s34
    v_accvgpr_write_b32 a51, v123
    v_perm_b32 v124, v41, v40, s34
    v_accvgpr_write_b32 a52, v124
    v_perm_b32 v125, v43, v42, s34
    v_accvgpr_write_b32 a53, v125
    v_perm_b32 v126, v45, v44, s34
    v_accvgpr_write_b32 a54, v126
    v_perm_b32 v127, v47, v46, s34
    v_accvgpr_write_b32 a55, v127
    v_perm_b32 v120, v33, v32, s35
    v_accvgpr_write_b32 a56, v120
    v_perm_b32 v121, v35, v34, s35
    v_accvgpr_write_b32 a57, v121
    v_perm_b32 v122, v37, v36, s35
    v_accvgpr_write_b32 a58, v122
    v_perm_b32 v123, v39, v38, s35
    v_accvgpr_write_b32 a59, v123
    v_perm_b32 v124, v41, v40, s35
    v_accvgpr_write_b32 a60, v124
    v_perm_b32 v125, v43, v42, s35
    v_accvgpr_write_b32 a61, v125
    v_perm_b32 v126, v45, v44, s35
    v_accvgpr_write_b32 a62, v126
    v_perm_b32 v127, v47, v46, s35
    v_accvgpr_write_b32 a63, v127
    s_waitcnt vmcnt(32)
    s_xor_b32 s36, s21, 0
    s_lshl_b32 s36, s36, 18
    s_lshl_b32 s37, s20, 8
    s_add_u32 s36, s36, s37
    s_add_u32 s37, s36, 0x200000
    buffer_load_dword v32, v15, s[12:15], s37 offen
    s_add_u32 s37, s36, 0x202000
    buffer_load_dword v33, v15, s[12:15], s37 offen
    s_add_u32 s37, s36, 0x210000
    buffer_load_dword v34, v15, s[12:15], s37 offen
    s_add_u32 s37, s36, 0x212000
    buffer_load_dword v35, v15, s[12:15], s37 offen
    s_add_u32 s37, s36, 0x204000
    buffer_load_dword v36, v15, s[12:15], s37 offen
    s_add_u32 s37, s36, 0x206000
    buffer_load_dword v37, v15, s[12:15], s37 offen
    s_add_u32 s37, s36, 0x214000
    buffer_load_dword v38, v15, s[12:15], s37 offen
    s_add_u32 s37, s36, 0x216000
    buffer_load_dword v39, v15, s[12:15], s37 offen
    s_add_u32 s37, s36, 0x300000
    buffer_load_dword v40, v15, s[12:15], s37 offen
    s_add_u32 s37, s36, 0x302000
    buffer_load_dword v41, v15, s[12:15], s37 offen
    s_add_u32 s37, s36, 0x310000
    buffer_load_dword v42, v15, s[12:15], s37 offen
    s_add_u32 s37, s36, 0x312000
    buffer_load_dword v43, v15, s[12:15], s37 offen
    s_add_u32 s37, s36, 0x304000
    buffer_load_dword v44, v15, s[12:15], s37 offen
    s_add_u32 s37, s36, 0x306000
    buffer_load_dword v45, v15, s[12:15], s37 offen
    s_add_u32 s37, s36, 0x314000
    buffer_load_dword v46, v15, s[12:15], s37 offen
    s_add_u32 s37, s36, 0x316000
    buffer_load_dword v47, v15, s[12:15], s37 offen
    v_perm_b32 v120, v49, v48, s34
    v_accvgpr_write_b32 a64, v120
    v_perm_b32 v121, v51, v50, s34
    v_accvgpr_write_b32 a65, v121
    v_perm_b32 v122, v53, v52, s34
    v_accvgpr_write_b32 a66, v122
    v_perm_b32 v123, v55, v54, s34
    v_accvgpr_write_b32 a67, v123
    v_perm_b32 v124, v57, v56, s34
    v_accvgpr_write_b32 a68, v124
    v_perm_b32 v125, v59, v58, s34
    v_accvgpr_write_b32 a69, v125
    v_perm_b32 v126, v61, v60, s34
    v_accvgpr_write_b32 a70, v126
    v_perm_b32 v127, v63, v62, s34
    v_accvgpr_write_b32 a71, v127
    v_perm_b32 v120, v49, v48, s35
    v_accvgpr_write_b32 a72, v120
    v_perm_b32 v121, v51, v50, s35
    v_accvgpr_write_b32 a73, v121
    v_perm_b32 v122, v53, v52, s35
    v_accvgpr_write_b32 a74, v122
    v_perm_b32 v123, v55, v54, s35
    v_accvgpr_write_b32 a75, v123
    v_perm_b32 v124, v57, v56, s35
    v_accvgpr_write_b32 a76, v124
    v_perm_b32 v125, v59, v58, s35
    v_accvgpr_write_b32 a77, v125
    v_perm_b32 v126, v61, v60, s35
    v_accvgpr_write_b32 a78, v126
    v_perm_b32 v127, v63, v62, s35
    v_accvgpr_write_b32 a79, v127
    s_waitcnt vmcnt(32)
    s_xor_b32 s36, s21, 1
    s_lshl_b32 s36, s36, 18
    s_lshl_b32 s37, s20, 8
    s_add_u32 s36, s36, s37
    s_add_u32 s37, s36, 0x0
    buffer_load_dword v48, v15, s[12:15], s37 offen
    s_add_u32 s37, s36, 0x2000
    buffer_load_dword v49, v15, s[12:15], s37 offen
    s_add_u32 s37, s36, 0x10000
    buffer_load_dword v50, v15, s[12:15], s37 offen
    s_add_u32 s37, s36, 0x12000
    buffer_load_dword v51, v15, s[12:15], s37 offen
    s_add_u32 s37, s36, 0x4000
    buffer_load_dword v52, v15, s[12:15], s37 offen
    s_add_u32 s37, s36, 0x6000
    buffer_load_dword v53, v15, s[12:15], s37 offen
    s_add_u32 s37, s36, 0x14000
    buffer_load_dword v54, v15, s[12:15], s37 offen
    s_add_u32 s37, s36, 0x16000
    buffer_load_dword v55, v15, s[12:15], s37 offen
    s_add_u32 s37, s36, 0x100000
    buffer_load_dword v56, v15, s[12:15], s37 offen
    s_add_u32 s37, s36, 0x102000
    buffer_load_dword v57, v15, s[12:15], s37 offen
    s_add_u32 s37, s36, 0x110000
    buffer_load_dword v58, v15, s[12:15], s37 offen
    s_add_u32 s37, s36, 0x112000
    buffer_load_dword v59, v15, s[12:15], s37 offen
    s_add_u32 s37, s36, 0x104000
    buffer_load_dword v60, v15, s[12:15], s37 offen
    s_add_u32 s37, s36, 0x106000
    buffer_load_dword v61, v15, s[12:15], s37 offen
    s_add_u32 s37, s36, 0x114000
    buffer_load_dword v62, v15, s[12:15], s37 offen
    s_add_u32 s37, s36, 0x116000
    buffer_load_dword v63, v15, s[12:15], s37 offen
    v_perm_b32 v120, v65, v64, s34
    v_perm_b32 v121, v67, v66, s34
    v_perm_b32 v122, v69, v68, s34
    v_perm_b32 v123, v71, v70, s34
    v_perm_b32 v124, v73, v72, s34
    v_perm_b32 v125, v75, v74, s34
    v_perm_b32 v126, v77, v76, s34
    v_perm_b32 v127, v79, v78, s34
    ds_write_b128 v4, v[120:123] offset:12288
    ds_write_b128 v4, v[124:127] offset:13312
    s_waitcnt lgkmcnt(0)
    v_perm_b32 v120, v65, v64, s35
    v_perm_b32 v121, v67, v66, s35
    v_perm_b32 v122, v69, v68, s35
    v_perm_b32 v123, v71, v70, s35
    v_perm_b32 v124, v73, v72, s35
    v_perm_b32 v125, v75, v74, s35
    v_perm_b32 v126, v77, v76, s35
    v_perm_b32 v127, v79, v78, s35
    ds_write_b128 v4, v[120:123] offset:14336
    ds_write_b128 v4, v[124:127] offset:15360
    s_waitcnt lgkmcnt(0)
    s_waitcnt vmcnt(32)
    s_xor_b32 s36, s21, 1
    s_lshl_b32 s36, s36, 18
    s_lshl_b32 s37, s20, 8
    s_add_u32 s36, s36, s37
    s_add_u32 s37, s36, 0x200000
    buffer_load_dword v64, v15, s[12:15], s37 offen
    s_add_u32 s37, s36, 0x202000
    buffer_load_dword v65, v15, s[12:15], s37 offen
    s_add_u32 s37, s36, 0x210000
    buffer_load_dword v66, v15, s[12:15], s37 offen
    s_add_u32 s37, s36, 0x212000
    buffer_load_dword v67, v15, s[12:15], s37 offen
    s_add_u32 s37, s36, 0x204000
    buffer_load_dword v68, v15, s[12:15], s37 offen
    s_add_u32 s37, s36, 0x206000
    buffer_load_dword v69, v15, s[12:15], s37 offen
    s_add_u32 s37, s36, 0x214000
    buffer_load_dword v70, v15, s[12:15], s37 offen
    s_add_u32 s37, s36, 0x216000
    buffer_load_dword v71, v15, s[12:15], s37 offen
    s_add_u32 s37, s36, 0x300000
    buffer_load_dword v72, v15, s[12:15], s37 offen
    s_add_u32 s37, s36, 0x302000
    buffer_load_dword v73, v15, s[12:15], s37 offen
    s_add_u32 s37, s36, 0x310000
    buffer_load_dword v74, v15, s[12:15], s37 offen
    s_add_u32 s37, s36, 0x312000
    buffer_load_dword v75, v15, s[12:15], s37 offen
    s_add_u32 s37, s36, 0x304000
    buffer_load_dword v76, v15, s[12:15], s37 offen
    s_add_u32 s37, s36, 0x306000
    buffer_load_dword v77, v15, s[12:15], s37 offen
    s_add_u32 s37, s36, 0x314000
    buffer_load_dword v78, v15, s[12:15], s37 offen
    s_add_u32 s37, s36, 0x316000
    buffer_load_dword v79, v15, s[12:15], s37 offen
    v_perm_b32 v120, v17, v16, s34
    v_perm_b32 v121, v19, v18, s34
    v_perm_b32 v122, v21, v20, s34
    v_perm_b32 v123, v23, v22, s34
    v_perm_b32 v124, v25, v24, s34
    v_perm_b32 v125, v27, v26, s34
    v_perm_b32 v126, v29, v28, s34
    v_perm_b32 v127, v31, v30, s34
    ds_write_b128 v4, v[120:123] offset:8192
    ds_write_b128 v4, v[124:127] offset:9216
    s_waitcnt lgkmcnt(0)
    v_perm_b32 v120, v17, v16, s35
    v_perm_b32 v121, v19, v18, s35
    v_perm_b32 v122, v21, v20, s35
    v_perm_b32 v123, v23, v22, s35
    v_perm_b32 v124, v25, v24, s35
    v_perm_b32 v125, v27, v26, s35
    v_perm_b32 v126, v29, v28, s35
    v_perm_b32 v127, v31, v30, s35
    ds_write_b128 v4, v[120:123] offset:10240
    ds_write_b128 v4, v[124:127] offset:11264
    s_waitcnt lgkmcnt(0)
    s_waitcnt vmcnt(32)
    s_xor_b32 s36, s21, 2
    s_lshl_b32 s36, s36, 18
    s_lshl_b32 s37, s20, 8
    s_add_u32 s36, s36, s37
    s_add_u32 s37, s36, 0x0
    buffer_load_dword v16, v15, s[12:15], s37 offen
    s_add_u32 s37, s36, 0x2000
    buffer_load_dword v17, v15, s[12:15], s37 offen
    s_add_u32 s37, s36, 0x10000
    buffer_load_dword v18, v15, s[12:15], s37 offen
    s_add_u32 s37, s36, 0x12000
    buffer_load_dword v19, v15, s[12:15], s37 offen
    s_add_u32 s37, s36, 0x4000
    buffer_load_dword v20, v15, s[12:15], s37 offen
    s_add_u32 s37, s36, 0x6000
    buffer_load_dword v21, v15, s[12:15], s37 offen
    s_add_u32 s37, s36, 0x14000
    buffer_load_dword v22, v15, s[12:15], s37 offen
    s_add_u32 s37, s36, 0x16000
    buffer_load_dword v23, v15, s[12:15], s37 offen
    s_add_u32 s37, s36, 0x100000
    buffer_load_dword v24, v15, s[12:15], s37 offen
    s_add_u32 s37, s36, 0x102000
    buffer_load_dword v25, v15, s[12:15], s37 offen
    s_add_u32 s37, s36, 0x110000
    buffer_load_dword v26, v15, s[12:15], s37 offen
    s_add_u32 s37, s36, 0x112000
    buffer_load_dword v27, v15, s[12:15], s37 offen
    s_add_u32 s37, s36, 0x104000
    buffer_load_dword v28, v15, s[12:15], s37 offen
    s_add_u32 s37, s36, 0x106000
    buffer_load_dword v29, v15, s[12:15], s37 offen
    s_add_u32 s37, s36, 0x114000
    buffer_load_dword v30, v15, s[12:15], s37 offen
    s_add_u32 s37, s36, 0x116000
    buffer_load_dword v31, v15, s[12:15], s37 offen
    v_perm_b32 v120, v33, v32, s34
    v_accvgpr_write_b32 a80, v120
    v_perm_b32 v121, v35, v34, s34
    v_accvgpr_write_b32 a81, v121
    v_perm_b32 v122, v37, v36, s34
    v_accvgpr_write_b32 a82, v122
    v_perm_b32 v123, v39, v38, s34
    v_accvgpr_write_b32 a83, v123
    v_perm_b32 v124, v41, v40, s34
    v_accvgpr_write_b32 a84, v124
    v_perm_b32 v125, v43, v42, s34
    v_accvgpr_write_b32 a85, v125
    v_perm_b32 v126, v45, v44, s34
    v_accvgpr_write_b32 a86, v126
    v_perm_b32 v127, v47, v46, s34
    v_accvgpr_write_b32 a87, v127
    v_perm_b32 v120, v33, v32, s35
    v_accvgpr_write_b32 a88, v120
    v_perm_b32 v121, v35, v34, s35
    v_accvgpr_write_b32 a89, v121
    v_perm_b32 v122, v37, v36, s35
    v_accvgpr_write_b32 a90, v122
    v_perm_b32 v123, v39, v38, s35
    v_accvgpr_write_b32 a91, v123
    v_perm_b32 v124, v41, v40, s35
    v_accvgpr_write_b32 a92, v124
    v_perm_b32 v125, v43, v42, s35
    v_accvgpr_write_b32 a93, v125
    v_perm_b32 v126, v45, v44, s35
    v_accvgpr_write_b32 a94, v126
    v_perm_b32 v127, v47, v46, s35
    v_accvgpr_write_b32 a95, v127
    s_waitcnt vmcnt(32)
    s_xor_b32 s36, s21, 2
    s_lshl_b32 s36, s36, 18
    s_lshl_b32 s37, s20, 8
    s_add_u32 s36, s36, s37
    s_add_u32 s37, s36, 0x200000
    buffer_load_dword v32, v15, s[12:15], s37 offen
    s_add_u32 s37, s36, 0x202000
    buffer_load_dword v33, v15, s[12:15], s37 offen
    s_add_u32 s37, s36, 0x210000
    buffer_load_dword v34, v15, s[12:15], s37 offen
    s_add_u32 s37, s36, 0x212000
    buffer_load_dword v35, v15, s[12:15], s37 offen
    s_add_u32 s37, s36, 0x204000
    buffer_load_dword v36, v15, s[12:15], s37 offen
    s_add_u32 s37, s36, 0x206000
    buffer_load_dword v37, v15, s[12:15], s37 offen
    s_add_u32 s37, s36, 0x214000
    buffer_load_dword v38, v15, s[12:15], s37 offen
    s_add_u32 s37, s36, 0x216000
    buffer_load_dword v39, v15, s[12:15], s37 offen
    s_add_u32 s37, s36, 0x300000
    buffer_load_dword v40, v15, s[12:15], s37 offen
    s_add_u32 s37, s36, 0x302000
    buffer_load_dword v41, v15, s[12:15], s37 offen
    s_add_u32 s37, s36, 0x310000
    buffer_load_dword v42, v15, s[12:15], s37 offen
    s_add_u32 s37, s36, 0x312000
    buffer_load_dword v43, v15, s[12:15], s37 offen
    s_add_u32 s37, s36, 0x304000
    buffer_load_dword v44, v15, s[12:15], s37 offen
    s_add_u32 s37, s36, 0x306000
    buffer_load_dword v45, v15, s[12:15], s37 offen
    s_add_u32 s37, s36, 0x314000
    buffer_load_dword v46, v15, s[12:15], s37 offen
    s_add_u32 s37, s36, 0x316000
    buffer_load_dword v47, v15, s[12:15], s37 offen
    v_perm_b32 v120, v49, v48, s34
    v_perm_b32 v121, v51, v50, s34
    v_perm_b32 v122, v53, v52, s34
    v_perm_b32 v123, v55, v54, s34
    v_perm_b32 v124, v57, v56, s34
    v_perm_b32 v125, v59, v58, s34
    v_perm_b32 v126, v61, v60, s34
    v_perm_b32 v127, v63, v62, s34
    ds_write_b128 v4, v[120:123] offset:16384
    ds_write_b128 v4, v[124:127] offset:17408
    s_waitcnt lgkmcnt(0)
    v_perm_b32 v120, v49, v48, s35
    v_perm_b32 v121, v51, v50, s35
    v_perm_b32 v122, v53, v52, s35
    v_perm_b32 v123, v55, v54, s35
    v_perm_b32 v124, v57, v56, s35
    v_perm_b32 v125, v59, v58, s35
    v_perm_b32 v126, v61, v60, s35
    v_perm_b32 v127, v63, v62, s35
    ds_write_b128 v4, v[120:123] offset:18432
    ds_write_b128 v4, v[124:127] offset:19456
    s_waitcnt lgkmcnt(0)
    s_waitcnt vmcnt(32)
    s_xor_b32 s36, s21, 3
    s_lshl_b32 s36, s36, 18
    s_lshl_b32 s37, s20, 8
    s_add_u32 s36, s36, s37
    s_add_u32 s37, s36, 0x0
    buffer_load_dword v48, v15, s[12:15], s37 offen
    s_add_u32 s37, s36, 0x2000
    buffer_load_dword v49, v15, s[12:15], s37 offen
    s_add_u32 s37, s36, 0x10000
    buffer_load_dword v50, v15, s[12:15], s37 offen
    s_add_u32 s37, s36, 0x12000
    buffer_load_dword v51, v15, s[12:15], s37 offen
    s_add_u32 s37, s36, 0x4000
    buffer_load_dword v52, v15, s[12:15], s37 offen
    s_add_u32 s37, s36, 0x6000
    buffer_load_dword v53, v15, s[12:15], s37 offen
    s_add_u32 s37, s36, 0x14000
    buffer_load_dword v54, v15, s[12:15], s37 offen
    s_add_u32 s37, s36, 0x16000
    buffer_load_dword v55, v15, s[12:15], s37 offen
    s_add_u32 s37, s36, 0x100000
    buffer_load_dword v56, v15, s[12:15], s37 offen
    s_add_u32 s37, s36, 0x102000
    buffer_load_dword v57, v15, s[12:15], s37 offen
    s_add_u32 s37, s36, 0x110000
    buffer_load_dword v58, v15, s[12:15], s37 offen
    s_add_u32 s37, s36, 0x112000
    buffer_load_dword v59, v15, s[12:15], s37 offen
    s_add_u32 s37, s36, 0x104000
    buffer_load_dword v60, v15, s[12:15], s37 offen
    s_add_u32 s37, s36, 0x106000
    buffer_load_dword v61, v15, s[12:15], s37 offen
    s_add_u32 s37, s36, 0x114000
    buffer_load_dword v62, v15, s[12:15], s37 offen
    s_add_u32 s37, s36, 0x116000
    buffer_load_dword v63, v15, s[12:15], s37 offen
    v_perm_b32 v120, v65, v64, s34
    v_accvgpr_write_b32 a96, v120
    v_perm_b32 v121, v67, v66, s34
    v_accvgpr_write_b32 a97, v121
    v_perm_b32 v122, v69, v68, s34
    v_accvgpr_write_b32 a98, v122
    v_perm_b32 v123, v71, v70, s34
    v_accvgpr_write_b32 a99, v123
    v_perm_b32 v124, v73, v72, s34
    v_accvgpr_write_b32 a100, v124
    v_perm_b32 v125, v75, v74, s34
    v_accvgpr_write_b32 a101, v125
    v_perm_b32 v126, v77, v76, s34
    v_accvgpr_write_b32 a102, v126
    v_perm_b32 v127, v79, v78, s34
    v_accvgpr_write_b32 a103, v127
    v_perm_b32 v120, v65, v64, s35
    v_accvgpr_write_b32 a104, v120
    v_perm_b32 v121, v67, v66, s35
    v_accvgpr_write_b32 a105, v121
    v_perm_b32 v122, v69, v68, s35
    v_accvgpr_write_b32 a106, v122
    v_perm_b32 v123, v71, v70, s35
    v_accvgpr_write_b32 a107, v123
    v_perm_b32 v124, v73, v72, s35
    v_accvgpr_write_b32 a108, v124
    v_perm_b32 v125, v75, v74, s35
    v_accvgpr_write_b32 a109, v125
    v_perm_b32 v126, v77, v76, s35
    v_accvgpr_write_b32 a110, v126
    v_perm_b32 v127, v79, v78, s35
    v_accvgpr_write_b32 a111, v127
    s_waitcnt vmcnt(32)
    s_xor_b32 s36, s21, 3
    s_lshl_b32 s36, s36, 18
    s_lshl_b32 s37, s20, 8
    s_add_u32 s36, s36, s37
    s_add_u32 s37, s36, 0x200000
    buffer_load_dword v64, v15, s[12:15], s37 offen
    s_add_u32 s37, s36, 0x202000
    buffer_load_dword v65, v15, s[12:15], s37 offen
    s_add_u32 s37, s36, 0x210000
    buffer_load_dword v66, v15, s[12:15], s37 offen
    s_add_u32 s37, s36, 0x212000
    buffer_load_dword v67, v15, s[12:15], s37 offen
    s_add_u32 s37, s36, 0x204000
    buffer_load_dword v68, v15, s[12:15], s37 offen
    s_add_u32 s37, s36, 0x206000
    buffer_load_dword v69, v15, s[12:15], s37 offen
    s_add_u32 s37, s36, 0x214000
    buffer_load_dword v70, v15, s[12:15], s37 offen
    s_add_u32 s37, s36, 0x216000
    buffer_load_dword v71, v15, s[12:15], s37 offen
    s_add_u32 s37, s36, 0x300000
    buffer_load_dword v72, v15, s[12:15], s37 offen
    s_add_u32 s37, s36, 0x302000
    buffer_load_dword v73, v15, s[12:15], s37 offen
    s_add_u32 s37, s36, 0x310000
    buffer_load_dword v74, v15, s[12:15], s37 offen
    s_add_u32 s37, s36, 0x312000
    buffer_load_dword v75, v15, s[12:15], s37 offen
    s_add_u32 s37, s36, 0x304000
    buffer_load_dword v76, v15, s[12:15], s37 offen
    s_add_u32 s37, s36, 0x306000
    buffer_load_dword v77, v15, s[12:15], s37 offen
    s_add_u32 s37, s36, 0x314000
    buffer_load_dword v78, v15, s[12:15], s37 offen
    s_add_u32 s37, s36, 0x316000
    buffer_load_dword v79, v15, s[12:15], s37 offen
    v_perm_b32 v120, v17, v16, s34
    v_accvgpr_write_b32 a112, v120
    v_perm_b32 v121, v19, v18, s34
    v_accvgpr_write_b32 a113, v121
    v_perm_b32 v122, v21, v20, s34
    v_accvgpr_write_b32 a114, v122
    v_perm_b32 v123, v23, v22, s34
    v_accvgpr_write_b32 a115, v123
    v_perm_b32 v124, v25, v24, s34
    v_accvgpr_write_b32 a116, v124
    v_perm_b32 v125, v27, v26, s34
    v_accvgpr_write_b32 a117, v125
    v_perm_b32 v126, v29, v28, s34
    v_accvgpr_write_b32 a118, v126
    v_perm_b32 v127, v31, v30, s34
    v_accvgpr_write_b32 a119, v127
    v_perm_b32 v120, v17, v16, s35
    v_accvgpr_write_b32 a120, v120
    v_perm_b32 v121, v19, v18, s35
    v_accvgpr_write_b32 a121, v121
    v_perm_b32 v122, v21, v20, s35
    v_accvgpr_write_b32 a122, v122
    v_perm_b32 v123, v23, v22, s35
    v_accvgpr_write_b32 a123, v123
    v_perm_b32 v124, v25, v24, s35
    v_accvgpr_write_b32 a124, v124
    v_perm_b32 v125, v27, v26, s35
    v_accvgpr_write_b32 a125, v125
    v_perm_b32 v126, v29, v28, s35
    v_accvgpr_write_b32 a126, v126
    v_perm_b32 v127, v31, v30, s35
    v_accvgpr_write_b32 a127, v127
    s_waitcnt vmcnt(32)
    s_xor_b32 s36, s21, 0
    s_lshl_b32 s36, s36, 18
    s_lshl_b32 s37, s20, 8
    s_add_u32 s36, s36, s37
    s_add_u32 s37, s36, 0x0
    buffer_load_dword v16, v15, s[60:63], s37 offen
    s_add_u32 s37, s36, 0x2000
    buffer_load_dword v17, v15, s[60:63], s37 offen
    s_add_u32 s37, s36, 0x10000
    buffer_load_dword v18, v15, s[60:63], s37 offen
    s_add_u32 s37, s36, 0x12000
    buffer_load_dword v19, v15, s[60:63], s37 offen
    s_add_u32 s37, s36, 0x4000
    buffer_load_dword v20, v15, s[60:63], s37 offen
    s_add_u32 s37, s36, 0x6000
    buffer_load_dword v21, v15, s[60:63], s37 offen
    s_add_u32 s37, s36, 0x14000
    buffer_load_dword v22, v15, s[60:63], s37 offen
    s_add_u32 s37, s36, 0x16000
    buffer_load_dword v23, v15, s[60:63], s37 offen
    s_add_u32 s37, s36, 0x100000
    buffer_load_dword v24, v15, s[60:63], s37 offen
    s_add_u32 s37, s36, 0x102000
    buffer_load_dword v25, v15, s[60:63], s37 offen
    s_add_u32 s37, s36, 0x110000
    buffer_load_dword v26, v15, s[60:63], s37 offen
    s_add_u32 s37, s36, 0x112000
    buffer_load_dword v27, v15, s[60:63], s37 offen
    s_add_u32 s37, s36, 0x104000
    buffer_load_dword v28, v15, s[60:63], s37 offen
    s_add_u32 s37, s36, 0x106000
    buffer_load_dword v29, v15, s[60:63], s37 offen
    s_add_u32 s37, s36, 0x114000
    buffer_load_dword v30, v15, s[60:63], s37 offen
    s_add_u32 s37, s36, 0x116000
    buffer_load_dword v31, v15, s[60:63], s37 offen
    v_perm_b32 v120, v33, v32, s34
    v_accvgpr_write_b32 a128, v120
    v_perm_b32 v121, v35, v34, s34
    v_accvgpr_write_b32 a129, v121
    v_perm_b32 v122, v37, v36, s34
    v_accvgpr_write_b32 a130, v122
    v_perm_b32 v123, v39, v38, s34
    v_accvgpr_write_b32 a131, v123
    v_perm_b32 v124, v41, v40, s34
    v_accvgpr_write_b32 a132, v124
    v_perm_b32 v125, v43, v42, s34
    v_accvgpr_write_b32 a133, v125
    v_perm_b32 v126, v45, v44, s34
    v_accvgpr_write_b32 a134, v126
    v_perm_b32 v127, v47, v46, s34
    v_accvgpr_write_b32 a135, v127
    v_perm_b32 v120, v33, v32, s35
    v_accvgpr_write_b32 a136, v120
    v_perm_b32 v121, v35, v34, s35
    v_accvgpr_write_b32 a137, v121
    v_perm_b32 v122, v37, v36, s35
    v_accvgpr_write_b32 a138, v122
    v_perm_b32 v123, v39, v38, s35
    v_accvgpr_write_b32 a139, v123
    v_perm_b32 v124, v41, v40, s35
    v_accvgpr_write_b32 a140, v124
    v_perm_b32 v125, v43, v42, s35
    v_accvgpr_write_b32 a141, v125
    v_perm_b32 v126, v45, v44, s35
    v_accvgpr_write_b32 a142, v126
    v_perm_b32 v127, v47, v46, s35
    v_accvgpr_write_b32 a143, v127
    s_waitcnt vmcnt(32)
    s_xor_b32 s36, s21, 0
    s_lshl_b32 s36, s36, 18
    s_lshl_b32 s37, s20, 8
    s_add_u32 s36, s36, s37
    s_add_u32 s37, s36, 0x200000
    buffer_load_dword v32, v15, s[60:63], s37 offen
    s_add_u32 s37, s36, 0x202000
    buffer_load_dword v33, v15, s[60:63], s37 offen
    s_add_u32 s37, s36, 0x210000
    buffer_load_dword v34, v15, s[60:63], s37 offen
    s_add_u32 s37, s36, 0x212000
    buffer_load_dword v35, v15, s[60:63], s37 offen
    s_add_u32 s37, s36, 0x204000
    buffer_load_dword v36, v15, s[60:63], s37 offen
    s_add_u32 s37, s36, 0x206000
    buffer_load_dword v37, v15, s[60:63], s37 offen
    s_add_u32 s37, s36, 0x214000
    buffer_load_dword v38, v15, s[60:63], s37 offen
    s_add_u32 s37, s36, 0x216000
    buffer_load_dword v39, v15, s[60:63], s37 offen
    s_add_u32 s37, s36, 0x300000
    buffer_load_dword v40, v15, s[60:63], s37 offen
    s_add_u32 s37, s36, 0x302000
    buffer_load_dword v41, v15, s[60:63], s37 offen
    s_add_u32 s37, s36, 0x310000
    buffer_load_dword v42, v15, s[60:63], s37 offen
    s_add_u32 s37, s36, 0x312000
    buffer_load_dword v43, v15, s[60:63], s37 offen
    s_add_u32 s37, s36, 0x304000
    buffer_load_dword v44, v15, s[60:63], s37 offen
    s_add_u32 s37, s36, 0x306000
    buffer_load_dword v45, v15, s[60:63], s37 offen
    s_add_u32 s37, s36, 0x314000
    buffer_load_dword v46, v15, s[60:63], s37 offen
    s_add_u32 s37, s36, 0x316000
    buffer_load_dword v47, v15, s[60:63], s37 offen
    v_perm_b32 v120, v49, v48, s34
    v_accvgpr_write_b32 a144, v120
    v_perm_b32 v121, v51, v50, s34
    v_accvgpr_write_b32 a145, v121
    v_perm_b32 v122, v53, v52, s34
    v_accvgpr_write_b32 a146, v122
    v_perm_b32 v123, v55, v54, s34
    v_accvgpr_write_b32 a147, v123
    v_perm_b32 v124, v57, v56, s34
    v_accvgpr_write_b32 a148, v124
    v_perm_b32 v125, v59, v58, s34
    v_accvgpr_write_b32 a149, v125
    v_perm_b32 v126, v61, v60, s34
    v_accvgpr_write_b32 a150, v126
    v_perm_b32 v127, v63, v62, s34
    v_accvgpr_write_b32 a151, v127
    v_perm_b32 v120, v49, v48, s35
    v_accvgpr_write_b32 a152, v120
    v_perm_b32 v121, v51, v50, s35
    v_accvgpr_write_b32 a153, v121
    v_perm_b32 v122, v53, v52, s35
    v_accvgpr_write_b32 a154, v122
    v_perm_b32 v123, v55, v54, s35
    v_accvgpr_write_b32 a155, v123
    v_perm_b32 v124, v57, v56, s35
    v_accvgpr_write_b32 a156, v124
    v_perm_b32 v125, v59, v58, s35
    v_accvgpr_write_b32 a157, v125
    v_perm_b32 v126, v61, v60, s35
    v_accvgpr_write_b32 a158, v126
    v_perm_b32 v127, v63, v62, s35
    v_accvgpr_write_b32 a159, v127
    s_waitcnt vmcnt(32)
    s_xor_b32 s36, s21, 1
    s_lshl_b32 s36, s36, 18
    s_lshl_b32 s37, s20, 8
    s_add_u32 s36, s36, s37
    s_add_u32 s37, s36, 0x0
    buffer_load_dword v48, v15, s[60:63], s37 offen
    s_add_u32 s37, s36, 0x2000
    buffer_load_dword v49, v15, s[60:63], s37 offen
    s_add_u32 s37, s36, 0x10000
    buffer_load_dword v50, v15, s[60:63], s37 offen
    s_add_u32 s37, s36, 0x12000
    buffer_load_dword v51, v15, s[60:63], s37 offen
    s_add_u32 s37, s36, 0x4000
    buffer_load_dword v52, v15, s[60:63], s37 offen
    s_add_u32 s37, s36, 0x6000
    buffer_load_dword v53, v15, s[60:63], s37 offen
    s_add_u32 s37, s36, 0x14000
    buffer_load_dword v54, v15, s[60:63], s37 offen
    s_add_u32 s37, s36, 0x16000
    buffer_load_dword v55, v15, s[60:63], s37 offen
    s_add_u32 s37, s36, 0x100000
    buffer_load_dword v56, v15, s[60:63], s37 offen
    s_add_u32 s37, s36, 0x102000
    buffer_load_dword v57, v15, s[60:63], s37 offen
    s_add_u32 s37, s36, 0x110000
    buffer_load_dword v58, v15, s[60:63], s37 offen
    s_add_u32 s37, s36, 0x112000
    buffer_load_dword v59, v15, s[60:63], s37 offen
    s_add_u32 s37, s36, 0x104000
    buffer_load_dword v60, v15, s[60:63], s37 offen
    s_add_u32 s37, s36, 0x106000
    buffer_load_dword v61, v15, s[60:63], s37 offen
    s_add_u32 s37, s36, 0x114000
    buffer_load_dword v62, v15, s[60:63], s37 offen
    s_add_u32 s37, s36, 0x116000
    buffer_load_dword v63, v15, s[60:63], s37 offen
    v_perm_b32 v120, v65, v64, s34
    v_perm_b32 v121, v67, v66, s34
    v_perm_b32 v122, v69, v68, s34
    v_perm_b32 v123, v71, v70, s34
    v_perm_b32 v124, v73, v72, s34
    v_perm_b32 v125, v75, v74, s34
    v_perm_b32 v126, v77, v76, s34
    v_perm_b32 v127, v79, v78, s34
    ds_write_b128 v4, v[120:123] offset:20480
    ds_write_b128 v4, v[124:127] offset:21504
    s_waitcnt lgkmcnt(0)
    v_perm_b32 v120, v65, v64, s35
    v_perm_b32 v121, v67, v66, s35
    v_perm_b32 v122, v69, v68, s35
    v_perm_b32 v123, v71, v70, s35
    v_perm_b32 v124, v73, v72, s35
    v_perm_b32 v125, v75, v74, s35
    v_perm_b32 v126, v77, v76, s35
    v_perm_b32 v127, v79, v78, s35
    ds_write_b128 v4, v[120:123] offset:22528
    ds_write_b128 v4, v[124:127] offset:23552
    s_waitcnt lgkmcnt(0)
    s_waitcnt vmcnt(32)
    s_xor_b32 s36, s21, 1
    s_lshl_b32 s36, s36, 18
    s_lshl_b32 s37, s20, 8
    s_add_u32 s36, s36, s37
    s_add_u32 s37, s36, 0x200000
    buffer_load_dword v64, v15, s[60:63], s37 offen
    s_add_u32 s37, s36, 0x202000
    buffer_load_dword v65, v15, s[60:63], s37 offen
    s_add_u32 s37, s36, 0x210000
    buffer_load_dword v66, v15, s[60:63], s37 offen
    s_add_u32 s37, s36, 0x212000
    buffer_load_dword v67, v15, s[60:63], s37 offen
    s_add_u32 s37, s36, 0x204000
    buffer_load_dword v68, v15, s[60:63], s37 offen
    s_add_u32 s37, s36, 0x206000
    buffer_load_dword v69, v15, s[60:63], s37 offen
    s_add_u32 s37, s36, 0x214000
    buffer_load_dword v70, v15, s[60:63], s37 offen
    s_add_u32 s37, s36, 0x216000
    buffer_load_dword v71, v15, s[60:63], s37 offen
    s_add_u32 s37, s36, 0x300000
    buffer_load_dword v72, v15, s[60:63], s37 offen
    s_add_u32 s37, s36, 0x302000
    buffer_load_dword v73, v15, s[60:63], s37 offen
    s_add_u32 s37, s36, 0x310000
    buffer_load_dword v74, v15, s[60:63], s37 offen
    s_add_u32 s37, s36, 0x312000
    buffer_load_dword v75, v15, s[60:63], s37 offen
    s_add_u32 s37, s36, 0x304000
    buffer_load_dword v76, v15, s[60:63], s37 offen
    s_add_u32 s37, s36, 0x306000
    buffer_load_dword v77, v15, s[60:63], s37 offen
    s_add_u32 s37, s36, 0x314000
    buffer_load_dword v78, v15, s[60:63], s37 offen
    s_add_u32 s37, s36, 0x316000
    buffer_load_dword v79, v15, s[60:63], s37 offen
    v_perm_b32 v120, v17, v16, s34
    v_accvgpr_write_b32 a160, v120
    v_perm_b32 v121, v19, v18, s34
    v_accvgpr_write_b32 a161, v121
    v_perm_b32 v122, v21, v20, s34
    v_accvgpr_write_b32 a162, v122
    v_perm_b32 v123, v23, v22, s34
    v_accvgpr_write_b32 a163, v123
    v_perm_b32 v124, v25, v24, s34
    v_accvgpr_write_b32 a164, v124
    v_perm_b32 v125, v27, v26, s34
    v_accvgpr_write_b32 a165, v125
    v_perm_b32 v126, v29, v28, s34
    v_accvgpr_write_b32 a166, v126
    v_perm_b32 v127, v31, v30, s34
    v_accvgpr_write_b32 a167, v127
    v_perm_b32 v120, v17, v16, s35
    v_accvgpr_write_b32 a168, v120
    v_perm_b32 v121, v19, v18, s35
    v_accvgpr_write_b32 a169, v121
    v_perm_b32 v122, v21, v20, s35
    v_accvgpr_write_b32 a170, v122
    v_perm_b32 v123, v23, v22, s35
    v_accvgpr_write_b32 a171, v123
    v_perm_b32 v124, v25, v24, s35
    v_accvgpr_write_b32 a172, v124
    v_perm_b32 v125, v27, v26, s35
    v_accvgpr_write_b32 a173, v125
    v_perm_b32 v126, v29, v28, s35
    v_accvgpr_write_b32 a174, v126
    v_perm_b32 v127, v31, v30, s35
    v_accvgpr_write_b32 a175, v127
    s_waitcnt vmcnt(32)
    s_xor_b32 s36, s21, 2
    s_lshl_b32 s36, s36, 18
    s_lshl_b32 s37, s20, 8
    s_add_u32 s36, s36, s37
    s_add_u32 s37, s36, 0x0
    buffer_load_dword v16, v15, s[60:63], s37 offen
    s_add_u32 s37, s36, 0x2000
    buffer_load_dword v17, v15, s[60:63], s37 offen
    s_add_u32 s37, s36, 0x10000
    buffer_load_dword v18, v15, s[60:63], s37 offen
    s_add_u32 s37, s36, 0x12000
    buffer_load_dword v19, v15, s[60:63], s37 offen
    s_add_u32 s37, s36, 0x4000
    buffer_load_dword v20, v15, s[60:63], s37 offen
    s_add_u32 s37, s36, 0x6000
    buffer_load_dword v21, v15, s[60:63], s37 offen
    s_add_u32 s37, s36, 0x14000
    buffer_load_dword v22, v15, s[60:63], s37 offen
    s_add_u32 s37, s36, 0x16000
    buffer_load_dword v23, v15, s[60:63], s37 offen
    s_add_u32 s37, s36, 0x100000
    buffer_load_dword v24, v15, s[60:63], s37 offen
    s_add_u32 s37, s36, 0x102000
    buffer_load_dword v25, v15, s[60:63], s37 offen
    s_add_u32 s37, s36, 0x110000
    buffer_load_dword v26, v15, s[60:63], s37 offen
    s_add_u32 s37, s36, 0x112000
    buffer_load_dword v27, v15, s[60:63], s37 offen
    s_add_u32 s37, s36, 0x104000
    buffer_load_dword v28, v15, s[60:63], s37 offen
    s_add_u32 s37, s36, 0x106000
    buffer_load_dword v29, v15, s[60:63], s37 offen
    s_add_u32 s37, s36, 0x114000
    buffer_load_dword v30, v15, s[60:63], s37 offen
    s_add_u32 s37, s36, 0x116000
    buffer_load_dword v31, v15, s[60:63], s37 offen
    v_perm_b32 v120, v33, v32, s34
    v_accvgpr_write_b32 a176, v120
    v_perm_b32 v121, v35, v34, s34
    v_accvgpr_write_b32 a177, v121
    v_perm_b32 v122, v37, v36, s34
    v_accvgpr_write_b32 a178, v122
    v_perm_b32 v123, v39, v38, s34
    v_accvgpr_write_b32 a179, v123
    v_perm_b32 v124, v41, v40, s34
    v_accvgpr_write_b32 a180, v124
    v_perm_b32 v125, v43, v42, s34
    v_accvgpr_write_b32 a181, v125
    v_perm_b32 v126, v45, v44, s34
    v_accvgpr_write_b32 a182, v126
    v_perm_b32 v127, v47, v46, s34
    v_accvgpr_write_b32 a183, v127
    v_perm_b32 v120, v33, v32, s35
    v_accvgpr_write_b32 a184, v120
    v_perm_b32 v121, v35, v34, s35
    v_accvgpr_write_b32 a185, v121
    v_perm_b32 v122, v37, v36, s35
    v_accvgpr_write_b32 a186, v122
    v_perm_b32 v123, v39, v38, s35
    v_accvgpr_write_b32 a187, v123
    v_perm_b32 v124, v41, v40, s35
    v_accvgpr_write_b32 a188, v124
    v_perm_b32 v125, v43, v42, s35
    v_accvgpr_write_b32 a189, v125
    v_perm_b32 v126, v45, v44, s35
    v_accvgpr_write_b32 a190, v126
    v_perm_b32 v127, v47, v46, s35
    v_accvgpr_write_b32 a191, v127
    s_waitcnt vmcnt(32)
    s_xor_b32 s36, s21, 2
    s_lshl_b32 s36, s36, 18
    s_lshl_b32 s37, s20, 8
    s_add_u32 s36, s36, s37
    s_add_u32 s37, s36, 0x200000
    buffer_load_dword v32, v15, s[60:63], s37 offen
    s_add_u32 s37, s36, 0x202000
    buffer_load_dword v33, v15, s[60:63], s37 offen
    s_add_u32 s37, s36, 0x210000
    buffer_load_dword v34, v15, s[60:63], s37 offen
    s_add_u32 s37, s36, 0x212000
    buffer_load_dword v35, v15, s[60:63], s37 offen
    s_add_u32 s37, s36, 0x204000
    buffer_load_dword v36, v15, s[60:63], s37 offen
    s_add_u32 s37, s36, 0x206000
    buffer_load_dword v37, v15, s[60:63], s37 offen
    s_add_u32 s37, s36, 0x214000
    buffer_load_dword v38, v15, s[60:63], s37 offen
    s_add_u32 s37, s36, 0x216000
    buffer_load_dword v39, v15, s[60:63], s37 offen
    s_add_u32 s37, s36, 0x300000
    buffer_load_dword v40, v15, s[60:63], s37 offen
    s_add_u32 s37, s36, 0x302000
    buffer_load_dword v41, v15, s[60:63], s37 offen
    s_add_u32 s37, s36, 0x310000
    buffer_load_dword v42, v15, s[60:63], s37 offen
    s_add_u32 s37, s36, 0x312000
    buffer_load_dword v43, v15, s[60:63], s37 offen
    s_add_u32 s37, s36, 0x304000
    buffer_load_dword v44, v15, s[60:63], s37 offen
    s_add_u32 s37, s36, 0x306000
    buffer_load_dword v45, v15, s[60:63], s37 offen
    s_add_u32 s37, s36, 0x314000
    buffer_load_dword v46, v15, s[60:63], s37 offen
    s_add_u32 s37, s36, 0x316000
    buffer_load_dword v47, v15, s[60:63], s37 offen
    v_perm_b32 v120, v49, v48, s34
    v_accvgpr_write_b32 a192, v120
    v_perm_b32 v121, v51, v50, s34
    v_accvgpr_write_b32 a193, v121
    v_perm_b32 v122, v53, v52, s34
    v_accvgpr_write_b32 a194, v122
    v_perm_b32 v123, v55, v54, s34
    v_accvgpr_write_b32 a195, v123
    v_perm_b32 v124, v57, v56, s34
    v_accvgpr_write_b32 a196, v124
    v_perm_b32 v125, v59, v58, s34
    v_accvgpr_write_b32 a197, v125
    v_perm_b32 v126, v61, v60, s34
    v_accvgpr_write_b32 a198, v126
    v_perm_b32 v127, v63, v62, s34
    v_accvgpr_write_b32 a199, v127
    v_perm_b32 v120, v49, v48, s35
    v_accvgpr_write_b32 a200, v120
    v_perm_b32 v121, v51, v50, s35
    v_accvgpr_write_b32 a201, v121
    v_perm_b32 v122, v53, v52, s35
    v_accvgpr_write_b32 a202, v122
    v_perm_b32 v123, v55, v54, s35
    v_accvgpr_write_b32 a203, v123
    v_perm_b32 v124, v57, v56, s35
    v_accvgpr_write_b32 a204, v124
    v_perm_b32 v125, v59, v58, s35
    v_accvgpr_write_b32 a205, v125
    v_perm_b32 v126, v61, v60, s35
    v_accvgpr_write_b32 a206, v126
    v_perm_b32 v127, v63, v62, s35
    v_accvgpr_write_b32 a207, v127
    s_waitcnt vmcnt(32)
    s_xor_b32 s36, s21, 3
    s_lshl_b32 s36, s36, 18
    s_lshl_b32 s37, s20, 8
    s_add_u32 s36, s36, s37
    s_add_u32 s37, s36, 0x0
    buffer_load_dword v48, v15, s[60:63], s37 offen
    s_add_u32 s37, s36, 0x2000
    buffer_load_dword v49, v15, s[60:63], s37 offen
    s_add_u32 s37, s36, 0x10000
    buffer_load_dword v50, v15, s[60:63], s37 offen
    s_add_u32 s37, s36, 0x12000
    buffer_load_dword v51, v15, s[60:63], s37 offen
    s_add_u32 s37, s36, 0x4000
    buffer_load_dword v52, v15, s[60:63], s37 offen
    s_add_u32 s37, s36, 0x6000
    buffer_load_dword v53, v15, s[60:63], s37 offen
    s_add_u32 s37, s36, 0x14000
    buffer_load_dword v54, v15, s[60:63], s37 offen
    s_add_u32 s37, s36, 0x16000
    buffer_load_dword v55, v15, s[60:63], s37 offen
    s_add_u32 s37, s36, 0x100000
    buffer_load_dword v56, v15, s[60:63], s37 offen
    s_add_u32 s37, s36, 0x102000
    buffer_load_dword v57, v15, s[60:63], s37 offen
    s_add_u32 s37, s36, 0x110000
    buffer_load_dword v58, v15, s[60:63], s37 offen
    s_add_u32 s37, s36, 0x112000
    buffer_load_dword v59, v15, s[60:63], s37 offen
    s_add_u32 s37, s36, 0x104000
    buffer_load_dword v60, v15, s[60:63], s37 offen
    s_add_u32 s37, s36, 0x106000
    buffer_load_dword v61, v15, s[60:63], s37 offen
    s_add_u32 s37, s36, 0x114000
    buffer_load_dword v62, v15, s[60:63], s37 offen
    s_add_u32 s37, s36, 0x116000
    buffer_load_dword v63, v15, s[60:63], s37 offen
    v_perm_b32 v120, v65, v64, s34
    v_accvgpr_write_b32 a208, v120
    v_perm_b32 v121, v67, v66, s34
    v_accvgpr_write_b32 a209, v121
    v_perm_b32 v122, v69, v68, s34
    v_accvgpr_write_b32 a210, v122
    v_perm_b32 v123, v71, v70, s34
    v_accvgpr_write_b32 a211, v123
    v_perm_b32 v124, v73, v72, s34
    v_accvgpr_write_b32 a212, v124
    v_perm_b32 v125, v75, v74, s34
    v_accvgpr_write_b32 a213, v125
    v_perm_b32 v126, v77, v76, s34
    v_accvgpr_write_b32 a214, v126
    v_perm_b32 v127, v79, v78, s34
    v_accvgpr_write_b32 a215, v127
    v_perm_b32 v120, v65, v64, s35
    v_accvgpr_write_b32 a216, v120
    v_perm_b32 v121, v67, v66, s35
    v_accvgpr_write_b32 a217, v121
    v_perm_b32 v122, v69, v68, s35
    v_accvgpr_write_b32 a218, v122
    v_perm_b32 v123, v71, v70, s35
    v_accvgpr_write_b32 a219, v123
    v_perm_b32 v124, v73, v72, s35
    v_accvgpr_write_b32 a220, v124
    v_perm_b32 v125, v75, v74, s35
    v_accvgpr_write_b32 a221, v125
    v_perm_b32 v126, v77, v76, s35
    v_accvgpr_write_b32 a222, v126
    v_perm_b32 v127, v79, v78, s35
    v_accvgpr_write_b32 a223, v127
    s_waitcnt vmcnt(32)
    s_xor_b32 s36, s21, 3
    s_lshl_b32 s36, s36, 18
    s_lshl_b32 s37, s20, 8
    s_add_u32 s36, s36, s37
    s_add_u32 s37, s36, 0x200000
    buffer_load_dword v64, v15, s[60:63], s37 offen
    s_add_u32 s37, s36, 0x202000
    buffer_load_dword v65, v15, s[60:63], s37 offen
    s_add_u32 s37, s36, 0x210000
    buffer_load_dword v66, v15, s[60:63], s37 offen
    s_add_u32 s37, s36, 0x212000
    buffer_load_dword v67, v15, s[60:63], s37 offen
    s_add_u32 s37, s36, 0x204000
    buffer_load_dword v68, v15, s[60:63], s37 offen
    s_add_u32 s37, s36, 0x206000
    buffer_load_dword v69, v15, s[60:63], s37 offen
    s_add_u32 s37, s36, 0x214000
    buffer_load_dword v70, v15, s[60:63], s37 offen
    s_add_u32 s37, s36, 0x216000
    buffer_load_dword v71, v15, s[60:63], s37 offen
    s_add_u32 s37, s36, 0x300000
    buffer_load_dword v72, v15, s[60:63], s37 offen
    s_add_u32 s37, s36, 0x302000
    buffer_load_dword v73, v15, s[60:63], s37 offen
    s_add_u32 s37, s36, 0x310000
    buffer_load_dword v74, v15, s[60:63], s37 offen
    s_add_u32 s37, s36, 0x312000
    buffer_load_dword v75, v15, s[60:63], s37 offen
    s_add_u32 s37, s36, 0x304000
    buffer_load_dword v76, v15, s[60:63], s37 offen
    s_add_u32 s37, s36, 0x306000
    buffer_load_dword v77, v15, s[60:63], s37 offen
    s_add_u32 s37, s36, 0x314000
    buffer_load_dword v78, v15, s[60:63], s37 offen
    s_add_u32 s37, s36, 0x316000
    buffer_load_dword v79, v15, s[60:63], s37 offen
    v_perm_b32 v120, v17, v16, s34
    v_accvgpr_write_b32 a224, v120
    v_perm_b32 v121, v19, v18, s34
    v_accvgpr_write_b32 a225, v121
    v_perm_b32 v122, v21, v20, s34
    v_accvgpr_write_b32 a226, v122
    v_perm_b32 v123, v23, v22, s34
    v_accvgpr_write_b32 a227, v123
    v_perm_b32 v124, v25, v24, s34
    v_accvgpr_write_b32 a228, v124
    v_perm_b32 v125, v27, v26, s34
    v_accvgpr_write_b32 a229, v125
    v_perm_b32 v126, v29, v28, s34
    v_accvgpr_write_b32 a230, v126
    v_perm_b32 v127, v31, v30, s34
    v_accvgpr_write_b32 a231, v127
    v_perm_b32 v120, v17, v16, s35
    v_accvgpr_write_b32 a232, v120
    v_perm_b32 v121, v19, v18, s35
    v_accvgpr_write_b32 a233, v121
    v_perm_b32 v122, v21, v20, s35
    v_accvgpr_write_b32 a234, v122
    v_perm_b32 v123, v23, v22, s35
    v_accvgpr_write_b32 a235, v123
    v_perm_b32 v124, v25, v24, s35
    v_accvgpr_write_b32 a236, v124
    v_perm_b32 v125, v27, v26, s35
    v_accvgpr_write_b32 a237, v125
    v_perm_b32 v126, v29, v28, s35
    v_accvgpr_write_b32 a238, v126
    v_perm_b32 v127, v31, v30, s35
    v_accvgpr_write_b32 a239, v127
    s_waitcnt vmcnt(32)
    s_lshl_b32 s36, s20, 17
    s_add_u32 s37, s36, 0x0
    buffer_load_dword v16, v11, s[92:95], s37 offen
    s_add_u32 s37, s36, 0x400
    buffer_load_dword v17, v11, s[92:95], s37 offen
    s_add_u32 s37, s36, 0x2000
    buffer_load_dword v18, v11, s[92:95], s37 offen
    s_add_u32 s37, s36, 0x2400
    buffer_load_dword v19, v11, s[92:95], s37 offen
    s_add_u32 s37, s36, 0x800
    buffer_load_dword v20, v11, s[92:95], s37 offen
    s_add_u32 s37, s36, 0xc00
    buffer_load_dword v21, v11, s[92:95], s37 offen
    s_add_u32 s37, s36, 0x2800
    buffer_load_dword v22, v11, s[92:95], s37 offen
    s_add_u32 s37, s36, 0x2c00
    buffer_load_dword v23, v11, s[92:95], s37 offen
    s_add_u32 s37, s36, 0x8000
    buffer_load_dword v24, v11, s[92:95], s37 offen
    s_add_u32 s37, s36, 0x8400
    buffer_load_dword v25, v11, s[92:95], s37 offen
    s_add_u32 s37, s36, 0xa000
    buffer_load_dword v26, v11, s[92:95], s37 offen
    s_add_u32 s37, s36, 0xa400
    buffer_load_dword v27, v11, s[92:95], s37 offen
    s_add_u32 s37, s36, 0x8800
    buffer_load_dword v28, v11, s[92:95], s37 offen
    s_add_u32 s37, s36, 0x8c00
    buffer_load_dword v29, v11, s[92:95], s37 offen
    s_add_u32 s37, s36, 0xa800
    buffer_load_dword v30, v11, s[92:95], s37 offen
    s_add_u32 s37, s36, 0xac00
    buffer_load_dword v31, v11, s[92:95], s37 offen
    v_perm_b32 v120, v33, v32, s34
    v_accvgpr_write_b32 a240, v120
    v_perm_b32 v121, v35, v34, s34
    v_accvgpr_write_b32 a241, v121
    v_perm_b32 v122, v37, v36, s34
    v_accvgpr_write_b32 a242, v122
    v_perm_b32 v123, v39, v38, s34
    v_accvgpr_write_b32 a243, v123
    v_perm_b32 v124, v41, v40, s34
    v_accvgpr_write_b32 a244, v124
    v_perm_b32 v125, v43, v42, s34
    v_accvgpr_write_b32 a245, v125
    v_perm_b32 v126, v45, v44, s34
    v_accvgpr_write_b32 a246, v126
    v_perm_b32 v127, v47, v46, s34
    v_accvgpr_write_b32 a247, v127
    v_perm_b32 v120, v33, v32, s35
    v_accvgpr_write_b32 a248, v120
    v_perm_b32 v121, v35, v34, s35
    v_accvgpr_write_b32 a249, v121
    v_perm_b32 v122, v37, v36, s35
    v_accvgpr_write_b32 a250, v122
    v_perm_b32 v123, v39, v38, s35
    v_accvgpr_write_b32 a251, v123
    v_perm_b32 v124, v41, v40, s35
    v_accvgpr_write_b32 a252, v124
    v_perm_b32 v125, v43, v42, s35
    v_accvgpr_write_b32 a253, v125
    v_perm_b32 v126, v45, v44, s35
    v_accvgpr_write_b32 a254, v126
    v_perm_b32 v127, v47, v46, s35
    v_accvgpr_write_b32 a255, v127
    s_waitcnt vmcnt(32)
    s_lshl_b32 s36, s20, 17
    s_add_u32 s37, s36, 0x10000
    buffer_load_dword v32, v11, s[92:95], s37 offen
    s_add_u32 s37, s36, 0x10400
    buffer_load_dword v33, v11, s[92:95], s37 offen
    s_add_u32 s37, s36, 0x12000
    buffer_load_dword v34, v11, s[92:95], s37 offen
    s_add_u32 s37, s36, 0x12400
    buffer_load_dword v35, v11, s[92:95], s37 offen
    s_add_u32 s37, s36, 0x10800
    buffer_load_dword v36, v11, s[92:95], s37 offen
    s_add_u32 s37, s36, 0x10c00
    buffer_load_dword v37, v11, s[92:95], s37 offen
    s_add_u32 s37, s36, 0x12800
    buffer_load_dword v38, v11, s[92:95], s37 offen
    s_add_u32 s37, s36, 0x12c00
    buffer_load_dword v39, v11, s[92:95], s37 offen
    s_add_u32 s37, s36, 0x18000
    buffer_load_dword v40, v11, s[92:95], s37 offen
    s_add_u32 s37, s36, 0x18400
    buffer_load_dword v41, v11, s[92:95], s37 offen
    s_add_u32 s37, s36, 0x1a000
    buffer_load_dword v42, v11, s[92:95], s37 offen
    s_add_u32 s37, s36, 0x1a400
    buffer_load_dword v43, v11, s[92:95], s37 offen
    s_add_u32 s37, s36, 0x18800
    buffer_load_dword v44, v11, s[92:95], s37 offen
    s_add_u32 s37, s36, 0x18c00
    buffer_load_dword v45, v11, s[92:95], s37 offen
    s_add_u32 s37, s36, 0x1a800
    buffer_load_dword v46, v11, s[92:95], s37 offen
    s_add_u32 s37, s36, 0x1ac00
    buffer_load_dword v47, v11, s[92:95], s37 offen
    v_perm_b32 v128, v49, v48, s34
    v_perm_b32 v129, v51, v50, s34
    v_perm_b32 v130, v53, v52, s34
    v_perm_b32 v131, v55, v54, s34
    v_perm_b32 v132, v57, v56, s34
    v_perm_b32 v133, v59, v58, s34
    v_perm_b32 v134, v61, v60, s34
    v_perm_b32 v135, v63, v62, s34
    v_perm_b32 v136, v49, v48, s35
    v_perm_b32 v137, v51, v50, s35
    v_perm_b32 v138, v53, v52, s35
    v_perm_b32 v139, v55, v54, s35
    v_perm_b32 v140, v57, v56, s35
    v_perm_b32 v141, v59, v58, s35
    v_perm_b32 v142, v61, v60, s35
    v_perm_b32 v143, v63, v62, s35
    s_waitcnt vmcnt(32)
    s_lshl_b32 s36, s20, 17
    s_add_u32 s37, s36, 0x40
    buffer_load_dword v48, v11, s[92:95], s37 offen
    s_add_u32 s37, s36, 0x440
    buffer_load_dword v49, v11, s[92:95], s37 offen
    s_add_u32 s37, s36, 0x2040
    buffer_load_dword v50, v11, s[92:95], s37 offen
    s_add_u32 s37, s36, 0x2440
    buffer_load_dword v51, v11, s[92:95], s37 offen
    s_add_u32 s37, s36, 0x840
    buffer_load_dword v52, v11, s[92:95], s37 offen
    s_add_u32 s37, s36, 0xc40
    buffer_load_dword v53, v11, s[92:95], s37 offen
    s_add_u32 s37, s36, 0x2840
    buffer_load_dword v54, v11, s[92:95], s37 offen
    s_add_u32 s37, s36, 0x2c40
    buffer_load_dword v55, v11, s[92:95], s37 offen
    s_add_u32 s37, s36, 0x8040
    buffer_load_dword v56, v11, s[92:95], s37 offen
    s_add_u32 s37, s36, 0x8440
    buffer_load_dword v57, v11, s[92:95], s37 offen
    s_add_u32 s37, s36, 0xa040
    buffer_load_dword v58, v11, s[92:95], s37 offen
    s_add_u32 s37, s36, 0xa440
    buffer_load_dword v59, v11, s[92:95], s37 offen
    s_add_u32 s37, s36, 0x8840
    buffer_load_dword v60, v11, s[92:95], s37 offen
    s_add_u32 s37, s36, 0x8c40
    buffer_load_dword v61, v11, s[92:95], s37 offen
    s_add_u32 s37, s36, 0xa840
    buffer_load_dword v62, v11, s[92:95], s37 offen
    s_add_u32 s37, s36, 0xac40
    buffer_load_dword v63, v11, s[92:95], s37 offen
    v_perm_b32 v144, v65, v64, s34
    v_perm_b32 v145, v67, v66, s34
    v_perm_b32 v146, v69, v68, s34
    v_perm_b32 v147, v71, v70, s34
    v_perm_b32 v148, v73, v72, s34
    v_perm_b32 v149, v75, v74, s34
    v_perm_b32 v150, v77, v76, s34
    v_perm_b32 v151, v79, v78, s34
    v_perm_b32 v152, v65, v64, s35
    v_perm_b32 v153, v67, v66, s35
    v_perm_b32 v154, v69, v68, s35
    v_perm_b32 v155, v71, v70, s35
    v_perm_b32 v156, v73, v72, s35
    v_perm_b32 v157, v75, v74, s35
    v_perm_b32 v158, v77, v76, s35
    v_perm_b32 v159, v79, v78, s35
    s_waitcnt vmcnt(32)
    s_lshl_b32 s36, s20, 17
    s_add_u32 s37, s36, 0x10040
    buffer_load_dword v64, v11, s[92:95], s37 offen
    s_add_u32 s37, s36, 0x10440
    buffer_load_dword v65, v11, s[92:95], s37 offen
    s_add_u32 s37, s36, 0x12040
    buffer_load_dword v66, v11, s[92:95], s37 offen
    s_add_u32 s37, s36, 0x12440
    buffer_load_dword v67, v11, s[92:95], s37 offen
    s_add_u32 s37, s36, 0x10840
    buffer_load_dword v68, v11, s[92:95], s37 offen
    s_add_u32 s37, s36, 0x10c40
    buffer_load_dword v69, v11, s[92:95], s37 offen
    s_add_u32 s37, s36, 0x12840
    buffer_load_dword v70, v11, s[92:95], s37 offen
    s_add_u32 s37, s36, 0x12c40
    buffer_load_dword v71, v11, s[92:95], s37 offen
    s_add_u32 s37, s36, 0x18040
    buffer_load_dword v72, v11, s[92:95], s37 offen
    s_add_u32 s37, s36, 0x18440
    buffer_load_dword v73, v11, s[92:95], s37 offen
    s_add_u32 s37, s36, 0x1a040
    buffer_load_dword v74, v11, s[92:95], s37 offen
    s_add_u32 s37, s36, 0x1a440
    buffer_load_dword v75, v11, s[92:95], s37 offen
    s_add_u32 s37, s36, 0x18840
    buffer_load_dword v76, v11, s[92:95], s37 offen
    s_add_u32 s37, s36, 0x18c40
    buffer_load_dword v77, v11, s[92:95], s37 offen
    s_add_u32 s37, s36, 0x1a840
    buffer_load_dword v78, v11, s[92:95], s37 offen
    s_add_u32 s37, s36, 0x1ac40
    buffer_load_dword v79, v11, s[92:95], s37 offen
    v_perm_b32 v120, v17, v16, s34
    v_perm_b32 v121, v19, v18, s34
    v_perm_b32 v122, v21, v20, s34
    v_perm_b32 v123, v23, v22, s34
    v_perm_b32 v124, v25, v24, s34
    v_perm_b32 v125, v27, v26, s34
    v_perm_b32 v126, v29, v28, s34
    v_perm_b32 v127, v31, v30, s34
    ds_write_b128 v4, v[120:123] offset:24576
    ds_write_b128 v4, v[124:127] offset:25600
    s_waitcnt lgkmcnt(0)
    v_perm_b32 v120, v17, v16, s35
    v_perm_b32 v121, v19, v18, s35
    v_perm_b32 v122, v21, v20, s35
    v_perm_b32 v123, v23, v22, s35
    v_perm_b32 v124, v25, v24, s35
    v_perm_b32 v125, v27, v26, s35
    v_perm_b32 v126, v29, v28, s35
    v_perm_b32 v127, v31, v30, s35
    ds_write_b128 v4, v[120:123] offset:26624
    ds_write_b128 v4, v[124:127] offset:27648
    s_waitcnt lgkmcnt(0)
    s_waitcnt vmcnt(32)
    s_lshl_b32 s36, s20, 17
    s_add_u32 s37, s36, 0x80
    buffer_load_dword v16, v11, s[92:95], s37 offen
    s_add_u32 s37, s36, 0x480
    buffer_load_dword v17, v11, s[92:95], s37 offen
    s_add_u32 s37, s36, 0x2080
    buffer_load_dword v18, v11, s[92:95], s37 offen
    s_add_u32 s37, s36, 0x2480
    buffer_load_dword v19, v11, s[92:95], s37 offen
    s_add_u32 s37, s36, 0x880
    buffer_load_dword v20, v11, s[92:95], s37 offen
    s_add_u32 s37, s36, 0xc80
    buffer_load_dword v21, v11, s[92:95], s37 offen
    s_add_u32 s37, s36, 0x2880
    buffer_load_dword v22, v11, s[92:95], s37 offen
    s_add_u32 s37, s36, 0x2c80
    buffer_load_dword v23, v11, s[92:95], s37 offen
    s_add_u32 s37, s36, 0x8080
    buffer_load_dword v24, v11, s[92:95], s37 offen
    s_add_u32 s37, s36, 0x8480
    buffer_load_dword v25, v11, s[92:95], s37 offen
    s_add_u32 s37, s36, 0xa080
    buffer_load_dword v26, v11, s[92:95], s37 offen
    s_add_u32 s37, s36, 0xa480
    buffer_load_dword v27, v11, s[92:95], s37 offen
    s_add_u32 s37, s36, 0x8880
    buffer_load_dword v28, v11, s[92:95], s37 offen
    s_add_u32 s37, s36, 0x8c80
    buffer_load_dword v29, v11, s[92:95], s37 offen
    s_add_u32 s37, s36, 0xa880
    buffer_load_dword v30, v11, s[92:95], s37 offen
    s_add_u32 s37, s36, 0xac80
    buffer_load_dword v31, v11, s[92:95], s37 offen
    v_perm_b32 v120, v33, v32, s34
    v_perm_b32 v121, v35, v34, s34
    v_perm_b32 v122, v37, v36, s34
    v_perm_b32 v123, v39, v38, s34
    v_perm_b32 v124, v41, v40, s34
    v_perm_b32 v125, v43, v42, s34
    v_perm_b32 v126, v45, v44, s34
    v_perm_b32 v127, v47, v46, s34
    ds_write_b128 v4, v[120:123] offset:28672
    ds_write_b128 v4, v[124:127] offset:29696
    s_waitcnt lgkmcnt(0)
    v_perm_b32 v120, v33, v32, s35
    v_perm_b32 v121, v35, v34, s35
    v_perm_b32 v122, v37, v36, s35
    v_perm_b32 v123, v39, v38, s35
    v_perm_b32 v124, v41, v40, s35
    v_perm_b32 v125, v43, v42, s35
    v_perm_b32 v126, v45, v44, s35
    v_perm_b32 v127, v47, v46, s35
    ds_write_b128 v4, v[120:123] offset:30720
    ds_write_b128 v4, v[124:127] offset:31744
    s_waitcnt lgkmcnt(0)
    s_waitcnt vmcnt(32)
    s_lshl_b32 s36, s20, 17
    s_add_u32 s37, s36, 0x10080
    buffer_load_dword v32, v11, s[92:95], s37 offen
    s_add_u32 s37, s36, 0x10480
    buffer_load_dword v33, v11, s[92:95], s37 offen
    s_add_u32 s37, s36, 0x12080
    buffer_load_dword v34, v11, s[92:95], s37 offen
    s_add_u32 s37, s36, 0x12480
    buffer_load_dword v35, v11, s[92:95], s37 offen
    s_add_u32 s37, s36, 0x10880
    buffer_load_dword v36, v11, s[92:95], s37 offen
    s_add_u32 s37, s36, 0x10c80
    buffer_load_dword v37, v11, s[92:95], s37 offen
    s_add_u32 s37, s36, 0x12880
    buffer_load_dword v38, v11, s[92:95], s37 offen
    s_add_u32 s37, s36, 0x12c80
    buffer_load_dword v39, v11, s[92:95], s37 offen
    s_add_u32 s37, s36, 0x18080
    buffer_load_dword v40, v11, s[92:95], s37 offen
    s_add_u32 s37, s36, 0x18480
    buffer_load_dword v41, v11, s[92:95], s37 offen
    s_add_u32 s37, s36, 0x1a080
    buffer_load_dword v42, v11, s[92:95], s37 offen
    s_add_u32 s37, s36, 0x1a480
    buffer_load_dword v43, v11, s[92:95], s37 offen
    s_add_u32 s37, s36, 0x18880
    buffer_load_dword v44, v11, s[92:95], s37 offen
    s_add_u32 s37, s36, 0x18c80
    buffer_load_dword v45, v11, s[92:95], s37 offen
    s_add_u32 s37, s36, 0x1a880
    buffer_load_dword v46, v11, s[92:95], s37 offen
    s_add_u32 s37, s36, 0x1ac80
    buffer_load_dword v47, v11, s[92:95], s37 offen
    v_perm_b32 v160, v49, v48, s34
    v_perm_b32 v161, v51, v50, s34
    v_perm_b32 v162, v53, v52, s34
    v_perm_b32 v163, v55, v54, s34
    v_perm_b32 v164, v57, v56, s34
    v_perm_b32 v165, v59, v58, s34
    v_perm_b32 v166, v61, v60, s34
    v_perm_b32 v167, v63, v62, s34
    v_perm_b32 v168, v49, v48, s35
    v_perm_b32 v169, v51, v50, s35
    v_perm_b32 v170, v53, v52, s35
    v_perm_b32 v171, v55, v54, s35
    v_perm_b32 v172, v57, v56, s35
    v_perm_b32 v173, v59, v58, s35
    v_perm_b32 v174, v61, v60, s35
    v_perm_b32 v175, v63, v62, s35
    s_waitcnt vmcnt(32)
    s_lshl_b32 s36, s20, 17
    s_add_u32 s37, s36, 0xc0
    buffer_load_dword v48, v11, s[92:95], s37 offen
    s_add_u32 s37, s36, 0x4c0
    buffer_load_dword v49, v11, s[92:95], s37 offen
    s_add_u32 s37, s36, 0x20c0
    buffer_load_dword v50, v11, s[92:95], s37 offen
    s_add_u32 s37, s36, 0x24c0
    buffer_load_dword v51, v11, s[92:95], s37 offen
    s_add_u32 s37, s36, 0x8c0
    buffer_load_dword v52, v11, s[92:95], s37 offen
    s_add_u32 s37, s36, 0xcc0
    buffer_load_dword v53, v11, s[92:95], s37 offen
    s_add_u32 s37, s36, 0x28c0
    buffer_load_dword v54, v11, s[92:95], s37 offen
    s_add_u32 s37, s36, 0x2cc0
    buffer_load_dword v55, v11, s[92:95], s37 offen
    s_add_u32 s37, s36, 0x80c0
    buffer_load_dword v56, v11, s[92:95], s37 offen
    s_add_u32 s37, s36, 0x84c0
    buffer_load_dword v57, v11, s[92:95], s37 offen
    s_add_u32 s37, s36, 0xa0c0
    buffer_load_dword v58, v11, s[92:95], s37 offen
    s_add_u32 s37, s36, 0xa4c0
    buffer_load_dword v59, v11, s[92:95], s37 offen
    s_add_u32 s37, s36, 0x88c0
    buffer_load_dword v60, v11, s[92:95], s37 offen
    s_add_u32 s37, s36, 0x8cc0
    buffer_load_dword v61, v11, s[92:95], s37 offen
    s_add_u32 s37, s36, 0xa8c0
    buffer_load_dword v62, v11, s[92:95], s37 offen
    s_add_u32 s37, s36, 0xacc0
    buffer_load_dword v63, v11, s[92:95], s37 offen
    v_perm_b32 v208, v65, v64, s34
    v_perm_b32 v209, v67, v66, s34
    v_perm_b32 v210, v69, v68, s34
    v_perm_b32 v211, v71, v70, s34
    v_perm_b32 v212, v73, v72, s34
    v_perm_b32 v213, v75, v74, s34
    v_perm_b32 v214, v77, v76, s34
    v_perm_b32 v215, v79, v78, s34
    v_perm_b32 v216, v65, v64, s35
    v_perm_b32 v217, v67, v66, s35
    v_perm_b32 v218, v69, v68, s35
    v_perm_b32 v219, v71, v70, s35
    v_perm_b32 v220, v73, v72, s35
    v_perm_b32 v221, v75, v74, s35
    v_perm_b32 v222, v77, v76, s35
    v_perm_b32 v223, v79, v78, s35
    s_waitcnt vmcnt(32)
    s_lshl_b32 s36, s20, 17
    s_add_u32 s37, s36, 0x100c0
    buffer_load_dword v64, v11, s[92:95], s37 offen
    s_add_u32 s37, s36, 0x104c0
    buffer_load_dword v65, v11, s[92:95], s37 offen
    s_add_u32 s37, s36, 0x120c0
    buffer_load_dword v66, v11, s[92:95], s37 offen
    s_add_u32 s37, s36, 0x124c0
    buffer_load_dword v67, v11, s[92:95], s37 offen
    s_add_u32 s37, s36, 0x108c0
    buffer_load_dword v68, v11, s[92:95], s37 offen
    s_add_u32 s37, s36, 0x10cc0
    buffer_load_dword v69, v11, s[92:95], s37 offen
    s_add_u32 s37, s36, 0x128c0
    buffer_load_dword v70, v11, s[92:95], s37 offen
    s_add_u32 s37, s36, 0x12cc0
    buffer_load_dword v71, v11, s[92:95], s37 offen
    s_add_u32 s37, s36, 0x180c0
    buffer_load_dword v72, v11, s[92:95], s37 offen
    s_add_u32 s37, s36, 0x184c0
    buffer_load_dword v73, v11, s[92:95], s37 offen
    s_add_u32 s37, s36, 0x1a0c0
    buffer_load_dword v74, v11, s[92:95], s37 offen
    s_add_u32 s37, s36, 0x1a4c0
    buffer_load_dword v75, v11, s[92:95], s37 offen
    s_add_u32 s37, s36, 0x188c0
    buffer_load_dword v76, v11, s[92:95], s37 offen
    s_add_u32 s37, s36, 0x18cc0
    buffer_load_dword v77, v11, s[92:95], s37 offen
    s_add_u32 s37, s36, 0x1a8c0
    buffer_load_dword v78, v11, s[92:95], s37 offen
    s_add_u32 s37, s36, 0x1acc0
    buffer_load_dword v79, v11, s[92:95], s37 offen
    v_perm_b32 v176, v17, v16, s34
    v_perm_b32 v177, v19, v18, s34
    v_perm_b32 v178, v21, v20, s34
    v_perm_b32 v179, v23, v22, s34
    v_perm_b32 v180, v25, v24, s34
    v_perm_b32 v181, v27, v26, s34
    v_perm_b32 v182, v29, v28, s34
    v_perm_b32 v183, v31, v30, s34
    v_perm_b32 v184, v17, v16, s35
    v_perm_b32 v185, v19, v18, s35
    v_perm_b32 v186, v21, v20, s35
    v_perm_b32 v187, v23, v22, s35
    v_perm_b32 v188, v25, v24, s35
    v_perm_b32 v189, v27, v26, s35
    v_perm_b32 v190, v29, v28, s35
    v_perm_b32 v191, v31, v30, s35
    s_waitcnt vmcnt(32)
    v_perm_b32 v224, v33, v32, s34
    v_perm_b32 v225, v35, v34, s34
    v_perm_b32 v226, v37, v36, s34
    v_perm_b32 v227, v39, v38, s34
    v_perm_b32 v228, v41, v40, s34
    v_perm_b32 v229, v43, v42, s34
    v_perm_b32 v230, v45, v44, s34
    v_perm_b32 v231, v47, v46, s34
    v_perm_b32 v232, v33, v32, s35
    v_perm_b32 v233, v35, v34, s35
    v_perm_b32 v234, v37, v36, s35
    v_perm_b32 v235, v39, v38, s35
    v_perm_b32 v236, v41, v40, s35
    v_perm_b32 v237, v43, v42, s35
    v_perm_b32 v238, v45, v44, s35
    v_perm_b32 v239, v47, v46, s35
    s_waitcnt vmcnt(16)
    v_perm_b32 v192, v49, v48, s34
    v_perm_b32 v193, v51, v50, s34
    v_perm_b32 v194, v53, v52, s34
    v_perm_b32 v195, v55, v54, s34
    v_perm_b32 v196, v57, v56, s34
    v_perm_b32 v197, v59, v58, s34
    v_perm_b32 v198, v61, v60, s34
    v_perm_b32 v199, v63, v62, s34
    v_perm_b32 v200, v49, v48, s35
    v_perm_b32 v201, v51, v50, s35
    v_perm_b32 v202, v53, v52, s35
    v_perm_b32 v203, v55, v54, s35
    v_perm_b32 v204, v57, v56, s35
    v_perm_b32 v205, v59, v58, s35
    v_perm_b32 v206, v61, v60, s35
    v_perm_b32 v207, v63, v62, s35
    s_waitcnt vmcnt(0)
    v_perm_b32 v240, v65, v64, s34
    v_perm_b32 v241, v67, v66, s34
    v_perm_b32 v242, v69, v68, s34
    v_perm_b32 v243, v71, v70, s34
    v_perm_b32 v244, v73, v72, s34
    v_perm_b32 v245, v75, v74, s34
    v_perm_b32 v246, v77, v76, s34
    v_perm_b32 v247, v79, v78, s34
    v_perm_b32 v248, v65, v64, s35
    v_perm_b32 v249, v67, v66, s35
    v_perm_b32 v250, v69, v68, s35
    v_perm_b32 v251, v71, v70, s35
    v_perm_b32 v252, v73, v72, s35
    v_perm_b32 v253, v75, v74, s35
    v_perm_b32 v254, v77, v76, s35
    v_perm_b32 v255, v79, v78, s35
    v_mov_b32 v24, 0x0
    v_bfe_u32 v14, v0, 0, 1
    s_mov_b32 s38, 0x80
    v_mad_u32_u24 v24, v14, s38, v24
    v_bfe_u32 v14, v0, 1, 1
    s_mov_b32 s38, 0x100
    v_mad_u32_u24 v24, v14, s38, v24
    v_bfe_u32 v14, v0, 2, 1
    s_mov_b32 s38, 0x200
    v_mad_u32_u24 v24, v14, s38, v24
    v_bfe_u32 v14, v0, 3, 1
    s_mov_b32 s38, 0x400
    v_mad_u32_u24 v24, v14, s38, v24
    v_bfe_u32 v14, v0, 4, 1
    s_mov_b32 s38, 0x800
    v_mad_u32_u24 v24, v14, s38, v24
    v_bfe_u32 v14, v0, 6, 1
    s_mov_b32 s38, 0x1000
    v_mad_u32_u24 v24, v14, s38, v24
    v_bfe_u32 v14, v0, 7, 1
    s_mov_b32 s38, 0x2000
    v_mad_u32_u24 v24, v14, s38, v24
    s_lshl_b32 s36, s20, 14
    v_add_u32 v24, s36, v24
    s_lshl_b32 s36, s20, 8
    s_lshr_b32 s37, s21, 1
    s_lshl_b32 s37, s37, 7
    s_add_u32 s36, s36, s37
    s_add_u32 s36, s36, 0x102000
    v_and_b32 v14, 63, v0
    v_mov_b32 v25, 0x40000000
    v_cmp_lt_u32 vcc, 32, v14
    s_nop 1
    v_cndmask_b32 v24, v24, v25, vcc
    v_mov_b32 v25, s36
    v_cmp_eq_u32 vcc, 32, v14
    s_nop 1
    v_cndmask_b32 v0, v24, v25, vcc
    v_lshrrev_b32 v25, 2, v3
    v_and_b32 v25, 127, v25
L_HS:
    buffer_load_dword v24, v25, s[16:19], 0 offen sc1
    s_add_u32 s32, s32, 1
    s_cmp_gt_u32 s32, 200000
    s_cbranch_scc1 L_slow_start
    s_waitcnt vmcnt(0)
    v_cmp_eq_u32 vcc, 0, v24
    s_cbranch_vccnz L_HS
    v_readfirstlane_b32 s36, v24
    s_nop 1
    v_cmp_ne_u32 vcc, s36, v24
    s_cbranch_vccnz L_slow_start
    s_branch L_fast_start
L_fast_start:
    s_mov_b32 s22, 0
    s_mov_b32 s23, 0x1000000
    s_mov_b32 s27, 0
    s_mov_b32 s31, 0x80000
    ds_read_b128 v[104:107], v4 offset:0
    ds_read_b128 v[108:111], v4 offset:1024
    ds_read_b128 v[112:115], v4 offset:2048
    ds_read_b128 v[116:119], v4 offset:3072
    ds_read_b128 v[88:91], v4 offset:4096
    ds_read_b128 v[92:95], v4 offset:5120
    ds_read_b128 v[96:99], v4 offset:6144
    ds_read_b128 v[100:103], v4 offset:7168
    ds_read_b128 v[72:75], v4 offset:8192
    ds_read_b128 v[76:79], v4 offset:9216
    ds_read_b128 v[80:83], v4 offset:10240
    ds_read_b128 v[84:87], v4 offset:11264
    v_mov_b64 v[48:49], 0
    v_mov_b64 v[50:51], 0
    v_mov_b64 v[52:53], 0
    v_mov_b64 v[54:55], 0
    v_mov_b64 v[56:57], 0
    v_mov_b64 v[58:59], 0
    v_mov_b64 v[60:61], 0
    v_mov_b64 v[62:63], 0
    v_mov_b64 v[64:65], 0
    v_mov_b64 v[66:67], 0
    v_mov_b64 v[68:69], 0
    v_mov_b64 v[70:71], 0
    s_waitcnt lgkmcnt(0)
    s_mov_b64 s[62:63], 0
L_fast_step:
    s_bitcmp1_b64 s[62:63], s22
    s_cbranch_scc0 L_fast_refresh
    s_add_u32 s36, s22, 1
    s_bitcmp1_b64 s[62:63], s36
    s_cbranch_scc0 L_fast_refresh
    s_add_u32 s7, s23, 0x80000
    s_add_u32 s24, s23, 0x82000
    s_add_u32 s29, s23, s25
    s_add_u32 s30, s23, s39
    v_xor_b32 v28, 0x800, v2
    v_xor_b32 v36, 0x1000, v2
    v_xor_b32 v44, 0x1800, v2
L_fast_pollm:
    buffer_load_dwordx4 v[16:19], v2, s[8:11], s7 offen sc1
    buffer_load_dwordx4 v[20:23], v2, s[8:11], s7 offen offset:1024 sc1
    s_add_u32 s32, s32, 1
    s_cmp_gt_u32 s32, 200000
    s_waitcnt vmcnt(1)
    v_max3_u32 v14, v16, v17, v18
    s_waitcnt vmcnt(0)
    v_max3_u32 v24, v19, v20, v21
    v_max3_u32 v14, v14, v22, v23
    v_max_u32 v14, v14, v24
    s_cbranch_scc1 L_fast_gotm
    v_cmp_eq_u32 vcc, -1, v14
    s_cbranch_vccnz L_fast_pollm
L_fast_gotm:
    v_smfmac_f32_16x16x64_bf16 v[48:51], v[16:19], v[104:111], v1
    ds_write_b128 v2, v[16:19] offset:0
    v_smfmac_f32_16x16x64_bf16 v[52:55], v[16:19], v[112:119], v1
    ds_write_b128 v2, v[20:23] offset:1024
    v_smfmac_f32_16x16x64_bf16 v[48:51], v[20:23], v[88:95], v1
    buffer_load_dwordx4 v[104:107], v3, s[8:11], s29 offen offset:0 sc1
    v_smfmac_f32_16x16x64_bf16 v[52:55], v[20:23], v[96:103], v1
    v_smfmac_f32_16x16x64_bf16 v[56:59], v[16:19], v[72:79], v1
    buffer_load_dwordx4 v[108:111], v3, s[8:11], s29 offen offset:1024 sc1
    v_smfmac_f32_16x16x64_bf16 v[60:63], v[16:19], v[80:87], v1
    s_waitcnt lgkmcnt(0)
    s_barrier
    ds_read_b128 v[24:27], v28 offset:0
    v_smfmac_f32_16x16x64_bf16 v[56:59], v[20:23], a[80:87], v1
    ds_read_b128 v[28:31], v28 offset:1024
    v_smfmac_f32_16x16x64_bf16 v[60:63], v[20:23], a[88:95], v1
    ds_read_b128 v[32:35], v36 offset:0
    v_smfmac_f32_16x16x64_bf16 v[64:67], v[16:19], a[160:167], v1
    ds_read_b128 v[36:39], v36 offset:1024
    v_smfmac_f32_16x16x64_bf16 v[68:71], v[16:19], a[168:175], v1
    ds_read_b128 v[40:43], v44 offset:0
    s_waitcnt lgkmcnt(4)
    v_smfmac_f32_16x16x64_bf16 v[48:51], v[24:27], a[0:7], v1
    ds_read_b128 v[44:47], v44 offset:1024
    v_smfmac_f32_16x16x64_bf16 v[52:55], v[24:27], a[8:15], v1
    buffer_load_dwordx4 v[112:115], v3, s[8:11], s29 offen offset:2048 sc1
    s_waitcnt lgkmcnt(4)
    v_smfmac_f32_16x16x64_bf16 v[48:51], v[28:31], a[16:23], v1
    ds_read_b128 v[88:91], v4 offset:12288
    v_smfmac_f32_16x16x64_bf16 v[52:55], v[28:31], a[24:31], v1
    buffer_load_dwordx4 v[116:119], v3, s[8:11], s29 offen offset:3072 sc1
    s_waitcnt lgkmcnt(4)
    v_smfmac_f32_16x16x64_bf16 v[48:51], v[32:35], a[32:39], v1
    ds_read_b128 v[92:95], v4 offset:13312
    v_smfmac_f32_16x16x64_bf16 v[52:55], v[32:35], a[40:47], v1
    buffer_load_dwordx4 v[120:123], v3, s[8:11], s30 offen offset:0 sc1
    s_waitcnt lgkmcnt(4)
    v_smfmac_f32_16x16x64_bf16 v[48:51], v[36:39], a[48:55], v1
    ds_read_b128 v[96:99], v4 offset:14336
    v_smfmac_f32_16x16x64_bf16 v[52:55], v[36:39], a[56:63], v1
    ds_read_b128 v[100:103], v4 offset:15360
    s_waitcnt lgkmcnt(5)
    v_smfmac_f32_16x16x64_bf16 v[48:51], v[40:43], a[64:71], v1
    buffer_load_dwordx4 v[124:127], v3, s[8:11], s30 offen offset:1024 sc1
    v_smfmac_f32_16x16x64_bf16 v[52:55], v[40:43], a[72:79], v1
    ds_read_b128 v[72:75], v4 offset:16384
    s_waitcnt lgkmcnt(1)
    v_smfmac_f32_16x16x64_bf16 v[48:51], v[44:47], v[88:95], v1
    ds_read_b128 v[76:79], v4 offset:17408
    v_smfmac_f32_16x16x64_bf16 v[52:55], v[44:47], v[96:103], v1
    buffer_load_dword v15, v0, s[8:11], s24 offen sc1
    v_smfmac_f32_16x16x64_bf16 v[56:59], v[28:31], a[96:103], v1
    ds_read_b128 v[80:83], v4 offset:18432
    v_smfmac_f32_16x16x64_bf16 v[60:63], v[28:31], a[104:111], v1
    ds_read_b128 v[84:87], v4 offset:19456
    v_smfmac_f32_16x16x64_bf16 v[56:59], v[36:39], a[128:135], v1
    ds_read_b128 v[88:91], v4 offset:20480
    v_smfmac_f32_16x16x64_bf16 v[56:59], v[32:35], a[112:119], v1
    ds_read_b128 v[92:95], v4 offset:21504
    v_add_f32 v48, v48, v50
    v_add_f32 v49, v49, v51
    v_smfmac_f32_16x16x64_bf16 v[60:63], v[32:35], a[120:127], v1
    ds_read_b128 v[96:99], v4 offset:22528
    v_add_f32 v52, v52, v54
    v_add_f32 v53, v53, v55
    v_smfmac_f32_16x16x64_bf16 v[60:63], v[36:39], a[136:143], v1
    ds_read_b128 v[100:103], v4 offset:23552
    s_waitcnt lgkmcnt(4)
    v_cvt_pk_bf16_f32 v50, v48, v52
    v_cvt_pk_bf16_f32 v51, v49, v53
    v_smfmac_f32_16x16x64_bf16 v[56:59], v[24:27], v[72:79], v1
    ds_write2_b32 v5, v50, v51 offset0:0 offset1:72
    v_smfmac_f32_16x16x64_bf16 v[60:63], v[24:27], v[80:87], v1
    v_add_u32 v55, 2304, v5
    v_smfmac_f32_16x16x64_bf16 v[56:59], v[40:43], a[144:151], v1
    v_smfmac_f32_16x16x64_bf16 v[60:63], v[40:43], a[152:159], v1
    s_waitcnt lgkmcnt(0)
    s_barrier
    ds_read_b128 v[72:75], v6 offset:0
    v_smfmac_f32_16x16x64_bf16 v[56:59], v[44:47], v[88:95], v1
    ds_read_b128 v[76:79], v6 offset:64
    v_smfmac_f32_16x16x64_bf16 v[60:63], v[44:47], v[96:103], v1
    ds_read_b128 v[80:83], v6 offset:128
    v_smfmac_f32_16x16x64_bf16 v[64:67], v[20:23], a[176:183], v1
    ds_read_b128 v[84:87], v6 offset:192
    v_smfmac_f32_16x16x64_bf16 v[68:71], v[20:23], a[184:191], v1
    s_waitcnt vmcnt(3) lgkmcnt(3)
    v_mfma_f32_16x16x32_bf16 v[48:51], v[104:107], v[72:75], 0
    s_waitcnt lgkmcnt(2)
    v_add_f32 v56, v56, v58
    v_add_f32 v57, v57, v59
    v_mfma_f32_16x16x32_bf16 v[48:51], v[108:111], v[76:79], v[48:51]
    s_waitcnt lgkmcnt(1)
    v_add_f32 v60, v60, v62
    v_add_f32 v61, v61, v63
    v_mfma_f32_16x16x32_bf16 v[48:51], v[112:115], v[80:83], v[48:51]
    s_waitcnt lgkmcnt(0)
    v_cvt_pk_bf16_f32 v58, v56, v60
    v_cvt_pk_bf16_f32 v59, v57, v61
    v_mfma_f32_16x16x32_bf16 v[48:51], v[116:119], v[84:87], v[48:51]
    ds_write2_b32 v55, v58, v59 offset0:0 offset1:72
    v_smfmac_f32_16x16x64_bf16 v[64:67], v[24:27], a[192:199], v1
    buffer_store_dword v12, v10, s[8:11], s31 offen sc1
    v_mov_b64 v[104:105], s[4:5]
    v_smfmac_f32_16x16x64_bf16 v[68:71], v[24:27], a[200:207], v1
    v_mov_b64 v[106:107], s[4:5]
    v_smfmac_f32_16x16x64_bf16 v[64:67], v[28:31], a[208:215], v1
    s_nop 0
    v_exp_f32 v48, v48
    v_smfmac_f32_16x16x64_bf16 v[68:71], v[28:31], a[216:223], v1
    s_waitcnt lgkmcnt(0)
    s_barrier
    ds_read_b128 v[88:91], v7 offset:0
    v_exp_f32 v49, v49
    v_smfmac_f32_16x16x64_bf16 v[64:67], v[32:35], a[224:231], v1
    ds_read_b128 v[92:95], v7 offset:64
    v_exp_f32 v50, v50
    v_smfmac_f32_16x16x64_bf16 v[68:71], v[32:35], a[232:239], v1
    ds_read_b128 v[96:99], v7 offset:128
    v_exp_f32 v51, v51
    v_smfmac_f32_16x16x64_bf16 v[64:67], v[36:39], a[240:247], v1
    ds_read_b128 v[100:103], v7 offset:192
    v_cvt_pk_bf16_f32 v108, v48, v49
    v_cvt_pk_bf16_f32 v109, v50, v51
    v_smfmac_f32_16x16x64_bf16 v[68:71], v[36:39], a[248:255], v1
    ds_write_b64 v2, v[108:109] offset:8192
    s_waitcnt lgkmcnt(4)
    v_mfma_f32_16x16x32_bf16 v[52:55], v[88:91], v[72:75], 0
    s_waitcnt lgkmcnt(3)
    v_mov_b32 v113, 0
    v_mov_b32 v115, 0
    v_mfma_f32_16x16x32_bf16 v[52:55], v[92:95], v[76:79], v[52:55]
    s_waitcnt lgkmcnt(2)
    v_mov_b32 v117, 0
    v_xor_b32 v118, 0x1000, v2
    v_mfma_f32_16x16x32_bf16 v[52:55], v[96:99], v[80:83], v[52:55]
    s_waitcnt lgkmcnt(1)
    v_mov_b64 v[16:17], 0
    v_mov_b64 v[18:19], 0
    v_mfma_f32_16x16x32_bf16 v[52:55], v[100:103], v[84:87], v[52:55]
    v_mov_b64 v[20:21], 0
    v_mov_b64 v[22:23], 0
    v_smfmac_f32_16x16x64_bf16 v[64:67], v[40:43], v[128:135], v1
    s_waitcnt lgkmcnt(0)
    s_barrier
    ds_read_b64 v[110:111], v118 offset:8192
    v_mov_b64 v[24:25], 0
    v_smfmac_f32_16x16x64_bf16 v[68:71], v[40:43], v[136:143], v1
    ds_read_b128 v[88:91], v4 offset:24576
    v_mov_b64 v[26:27], 0
    v_smfmac_f32_16x16x64_bf16 v[64:67], v[44:47], v[144:151], v1
    ds_read_b128 v[92:95], v4 offset:25600
    v_mul_f32 v52, s33, v52
    v_mul_f32 v53, s33, v53
    v_smfmac_f32_16x16x64_bf16 v[68:71], v[44:47], v[152:159], v1
    ds_read_b128 v[96:99], v4 offset:26624
    s_waitcnt vmcnt(2) lgkmcnt(3)
    v_exp_f32 v52, v52
    v_mfma_f32_16x16x32_bf16 v[48:51], v[104:107], v[108:111], 0
    ds_read_b128 v[100:103], v4 offset:27648
    v_exp_f32 v53, v53
    v_mfma_f32_16x16x32_bf16 v[56:59], v[120:123], v[108:111], 0
    ds_read_b128 v[72:75], v4 offset:28672
    v_cvt_pk_bf16_f32 v112, v52, v53
    v_mov_b64 v[28:29], 0
    v_mfma_f32_16x16x32_bf16 v[60:63], v[124:127], v[108:111], 0
    ds_read_b128 v[76:79], v4 offset:29696
    v_add_f32 v64, v64, v66
    v_add_f32 v65, v65, v67
    v_mfma_f32_16x16x16_bf16 v[48:51], v[104:105], v[112:113], v[48:51]
    ds_read_b128 v[80:83], v4 offset:30720
    v_cvt_pk_bf16_f32 v114, v64, v65
    v_add_f32 v68, v68, v70
    v_add_f32 v69, v69, v71
    v_mfma_f32_16x16x16_bf16 v[56:59], v[114:115], v[112:113], v[56:59]
    ds_read_b128 v[84:87], v4 offset:31744
    v_cvt_pk_bf16_f32 v116, v68, v69
    v_mov_b64 v[30:31], 0
    v_mov_b64 v[32:33], 0
    v_mfma_f32_16x16x16_bf16 v[60:63], v[116:117], v[112:113], v[60:63]
    v_rcp_f32 v118, v48
    v_mov_b64 v[34:35], 0
    v_mov_b64 v[36:37], 0
    v_mov_b64 v[38:39], 0
    v_mov_b64 v[40:41], 0
    v_mov_b64 v[42:43], 0
    v_pk_mul_f32 v[56:57], v[56:57], v[118:119] op_sel_hi:[1,0]
    s_nop 0
    v_pk_mul_f32 v[60:61], v[60:61], v[118:119] op_sel_hi:[1,0]
    v_pk_mul_f32 v[58:59], v[58:59], v[118:119] op_sel_hi:[1,0]
    v_pk_mul_f32 v[62:63], v[62:63], v[118:119] op_sel_hi:[1,0]
    v_cvt_pk_bf16_f32 v52, v56, v60
    v_cvt_pk_bf16_f32 v53, v57, v61
    v_cvt_pk_bf16_f32 v54, v58, v62
    v_cvt_pk_bf16_f32 v55, v59, v63
    ds_write_b128 v8, v[52:55]
    v_max_f32 v118, v118, v48
    v_cmp_nge_f32 vcc, s40, v118
    s_cbranch_vccnz L_fast_safe
L_fast_rejoin:
    v_mov_b64 v[44:45], 0
    v_mov_b64 v[46:47], 0
    s_waitcnt lgkmcnt(0)
    s_barrier
    ds_read_b128 v[120:123], v3 offset:20992
    ds_read_b128 v[124:127], v3 offset:22016
    s_waitcnt lgkmcnt(1)
    v_smfmac_f32_16x16x64_bf16 v[16:19], v[120:123], v[88:95], v1
    v_smfmac_f32_16x16x64_bf16 v[20:23], v[120:123], v[96:103], v1
    s_waitcnt lgkmcnt(0)
    v_smfmac_f32_16x16x64_bf16 v[16:19], v[124:127], v[72:79], v1
    v_smfmac_f32_16x16x64_bf16 v[20:23], v[124:127], v[80:87], v1
    v_smfmac_f32_16x16x64_bf16 v[24:27], v[120:123], v[160:167], v1
    v_smfmac_f32_16x16x64_bf16 v[28:31], v[120:123], v[168:175], v1
    s_nop 4
    v_add_f32 v16, v16, v18
    v_add_f32 v17, v17, v19
    v_smfmac_f32_16x16x64_bf16 v[24:27], v[124:127], v[208:215], v1
    v_add_f32 v20, v20, v22
    v_add_f32 v21, v21, v23
    v_smfmac_f32_16x16x64_bf16 v[28:31], v[124:127], v[216:223], v1
    v_cvt_pk_bf16_f32 v48, v16, v20
    v_cvt_pk_bf16_f32 v49, v17, v21
    v_smfmac_f32_16x16x64_bf16 v[32:35], v[120:123], v[176:183], v1
    v_and_or_b32 v48, v48, -2, s27
    v_smfmac_f32_16x16x64_bf16 v[36:39], v[120:123], v[184:191], v1
    buffer_store_dwordx2 v[48:49], v9, s[8:11], 0 offen offset:0
    v_add_f32 v24, v24, v26
    v_add_f32 v25, v25, v27
    v_smfmac_f32_16x16x64_bf16 v[32:35], v[124:127], v[224:231], v1
    v_add_f32 v28, v28, v30
    v_add_f32 v29, v29, v31
    v_smfmac_f32_16x16x64_bf16 v[36:39], v[124:127], v[232:239], v1
    v_cvt_pk_bf16_f32 v50, v24, v28
    v_cvt_pk_bf16_f32 v51, v25, v29
    v_smfmac_f32_16x16x64_bf16 v[40:43], v[120:123], v[192:199], v1
    v_and_or_b32 v50, v50, -2, s27
    v_smfmac_f32_16x16x64_bf16 v[44:47], v[120:123], v[200:207], v1
    buffer_store_dwordx2 v[50:51], v9, s[8:11], 0 offen offset:2048
    v_add_f32 v32, v32, v34
    v_add_f32 v33, v33, v35
    v_smfmac_f32_16x16x64_bf16 v[40:43], v[124:127], v[240:247], v1
    v_add_f32 v36, v36, v38
    v_add_f32 v37, v37, v39
    v_smfmac_f32_16x16x64_bf16 v[44:47], v[124:127], v[248:255], v1
    v_cvt_pk_bf16_f32 v52, v32, v36
    v_cvt_pk_bf16_f32 v53, v33, v37
    v_and_or_b32 v52, v52, -2, s27
    buffer_store_dwordx2 v[52:53], v9, s[8:11], s26 offen offset:0
    s_nop 0
    v_add_f32 v40, v40, v42
    v_add_f32 v41, v41, v43
    s_nop 0
    v_add_f32 v44, v44, v46
    v_add_f32 v45, v45, v47
    v_cvt_pk_bf16_f32 v54, v40, v44
    v_cvt_pk_bf16_f32 v55, v41, v45
    v_and_or_b32 v54, v54, -2, s27
    buffer_store_dwordx2 v[54:55], v9, s[8:11], s26 offen offset:2048
L_fast_stored:
    ds_read_b128 v[24:27], v3 offset:23040
    ds_read_b128 v[104:107], v4 offset:0
    ds_read_b128 v[108:111], v4 offset:1024
    ds_read_b128 v[112:115], v4 offset:2048
    ds_read_b128 v[116:119], v4 offset:3072
    ds_read_b128 v[88:91], v4 offset:4096
    ds_read_b128 v[92:95], v4 offset:5120
    ds_read_b128 v[96:99], v4 offset:6144
    ds_read_b128 v[100:103], v4 offset:7168
    ds_read_b128 v[72:75], v4 offset:8192
    ds_read_b128 v[76:79], v4 offset:9216
    ds_read_b128 v[80:83], v4 offset:10240
    ds_read_b128 v[84:87], v4 offset:11264
    v_mov_b64 v[48:49], 0
    v_mov_b64 v[50:51], 0
    v_mov_b64 v[52:53], 0
    v_mov_b64 v[54:55], 0
    v_mov_b64 v[56:57], 0
    v_mov_b64 v[58:59], 0
    v_mov_b64 v[60:61], 0
    v_mov_b64 v[62:63], 0
    v_mov_b64 v[64:65], 0
    v_mov_b64 v[66:67], 0
    v_mov_b64 v[68:69], 0
    v_mov_b64 v[70:71], 0
    s_cmp_lt_u32 s21, 1
    s_cbranch_scc1 L_fast_poll0
    s_nop 7
    s_cmp_lt_u32 s21, 2
    s_cbranch_scc1 L_fast_poll0
    s_nop 7
    s_cmp_lt_u32 s21, 3
    s_cbranch_scc1 L_fast_poll0
    s_nop 7
L_fast_poll0:
    buffer_load_dwordx4 v[120:123], v2, s[8:11], s6 offen sc1
    buffer_load_dwordx4 v[124:127], v2, s[8:11], s6 offen offset:1024 sc1
    s_waitcnt lgkmcnt(0)
L_fast_pollp:
    s_waitcnt vmcnt(1)
    v_mfma_f32_16x16x32_bf16 v[36:39], v[24:27], v[120:123], 0
    v_bitop3_b32 v14, v120, v122, s27 bitop3:0x7e
    s_waitcnt vmcnt(0)
    v_mfma_f32_16x16x32_bf16 v[36:39], v[24:27], v[124:127], v[36:39]
    v_bitop3_b32 v11, v124, v126, s27 bitop3:0x7e
    v_bitop3_b32 v14, v14, v11, 1 bitop3:0xa8
    v_cmp_ne_u32 vcc, 0, v14
    s_add_u32 s32, s32, 1
    s_cbranch_vccz L_fast_gotp
    buffer_load_dwordx4 v[16:19], v2, s[8:11], s6 offen sc1
    buffer_load_dwordx4 v[20:23], v2, s[8:11], s6 offen offset:1024 sc1
    s_waitcnt vmcnt(1)
    v_mfma_f32_16x16x32_bf16 v[36:39], v[24:27], v[16:19], 0
    v_bitop3_b32 v14, v16, v18, s27 bitop3:0x7e
    s_waitcnt vmcnt(0)
    v_mfma_f32_16x16x32_bf16 v[36:39], v[24:27], v[20:23], v[36:39]
    v_bitop3_b32 v11, v20, v22, s27 bitop3:0x7e
    v_bitop3_b32 v14, v14, v11, 1 bitop3:0xa8
    v_cmp_ne_u32 vcc, 0, v14
    s_add_u32 s32, s32, 1
    s_cbranch_vccz L_fast_gotp
    buffer_load_dwordx4 v[120:123], v2, s[8:11], s6 offen sc1
    buffer_load_dwordx4 v[124:127], v2, s[8:11], s6 offen offset:1024 sc1
    s_cmp_le_u32 s32, 200000
    s_cbranch_scc1 L_fast_pollp
L_fast_gotp:
    s_mov_b32 s23, s24
    s_add_u32 s31, s31, 0x2000
    s_add_u32 s22, s22, 1
    s_xor_b32 s27, s27, 1
    v_add_f32_dpp v36, v36, v36 row_ror:8 row_mask:0xf bank_mask:0xf
    v_add_f32_dpp v37, v37, v37 row_ror:8 row_mask:0xf bank_mask:0xf
    s_nop 0
    v_add_f32_dpp v36, v36, v36 row_ror:4 row_mask:0xf bank_mask:0xf
    v_add_f32_dpp v37, v37, v37 row_ror:4 row_mask:0xf bank_mask:0xf
    v_cvt_pk_bf16_f32 v12, v36, v37
    buffer_store_dword v12, v10, s[8:11], s23 offen
    s_nop 15
    s_nop 15
    s_nop 15
    s_cmp_lt_u32 s22, 63
    s_cbranch_scc1 L_fast_step
    buffer_store_dword v12, v10, s[8:11], s31 offen sc1
    s_branch L_fast_done
L_fast_refresh:
    v_lshrrev_b32 v14, 2, v3
    s_lshl_b32 s36, s20, 8
    s_add_u32 s36, s36, 0x190000
    buffer_load_dword v14, v14, s[8:11], s36 offen sc1
    s_add_u32 s32, s32, 1
    s_waitcnt vmcnt(0)
    v_cmp_ne_u32 s[62:63], 0, v14
    s_nop 3
    s_bitset1_b64 s[62:63], 63
    s_cmp_le_u32 s32, 200000
    s_cbranch_scc1 L_fast_step
    s_mov_b64 s[62:63], -1
    s_branch L_fast_step
L_fast_safe:
    s_nop 11
    s_waitcnt vmcnt(0) lgkmcnt(0)
    ds_read_b128 v[72:75], v6 offset:0
    ds_read_b128 v[88:91], v7 offset:0
    ds_read_b128 v[76:79], v6 offset:64
    ds_read_b128 v[92:95], v7 offset:64
    ds_read_b128 v[80:83], v6 offset:128
    ds_read_b128 v[96:99], v7 offset:128
    ds_read_b128 v[84:87], v6 offset:192
    ds_read_b128 v[100:103], v7 offset:192
    s_xor_b32 s36, s25, 0x1000
    s_add_u32 s36, s36, s23
    buffer_load_dwordx4 v[16:19], v3, s[8:11], s29 offen offset:0 sc1
    buffer_load_dwordx4 v[32:35], v3, s[8:11], s36 offen offset:0 sc1
    buffer_load_dwordx4 v[20:23], v3, s[8:11], s29 offen offset:1024 sc1
    buffer_load_dwordx4 v[36:39], v3, s[8:11], s36 offen offset:1024 sc1
    buffer_load_dwordx4 v[24:27], v3, s[8:11], s29 offen offset:2048 sc1
    buffer_load_dwordx4 v[40:43], v3, s[8:11], s36 offen offset:2048 sc1
    buffer_load_dwordx4 v[28:31], v3, s[8:11], s29 offen offset:3072 sc1
    buffer_load_dwordx4 v[44:47], v3, s[8:11], s36 offen offset:3072 sc1
    s_waitcnt vmcnt(0) lgkmcnt(0)
    v_mfma_f32_16x16x32_bf16 v[48:51], v[16:19], v[72:75], 0
    v_mfma_f32_16x16x32_bf16 v[48:51], v[20:23], v[76:79], v[48:51]
    v_mfma_f32_16x16x32_bf16 v[48:51], v[24:27], v[80:83], v[48:51]
    v_mfma_f32_16x16x32_bf16 v[48:51], v[28:31], v[84:87], v[48:51]
    v_mfma_f32_16x16x32_bf16 v[52:55], v[32:35], v[72:75], 0
    v_mfma_f32_16x16x32_bf16 v[52:55], v[36:39], v[76:79], v[52:55]
    v_mfma_f32_16x16x32_bf16 v[52:55], v[40:43], v[80:83], v[52:55]
    v_mfma_f32_16x16x32_bf16 v[52:55], v[44:47], v[84:87], v[52:55]
    v_mfma_f32_16x16x32_bf16 v[56:59], v[88:91], v[72:75], 0
    v_mfma_f32_16x16x32_bf16 v[56:59], v[92:95], v[76:79], v[56:59]
    v_mfma_f32_16x16x32_bf16 v[56:59], v[96:99], v[80:83], v[56:59]
    v_mfma_f32_16x16x32_bf16 v[56:59], v[100:103], v[84:87], v[56:59]
    s_nop 7
    v_mul_f32 v56, s33, v56
    v_mul_f32 v57, s33, v57
    v_max3_f32 v16, v48, v49, v50
    v_max3_f32 v16, v16, v51, v52
    v_max3_f32 v16, v16, v53, v54
    v_max3_f32 v16, v16, v55, v56
    v_max_f32 v16, v16, v57
    v_mov_b32 v17, v16
    s_nop 1
    v_permlane16_swap_b32 v16, v17
    v_max_f32 v16, v16, v17
    v_mov_b32 v17, v16
    s_nop 1
    v_permlane32_swap_b32 v16, v17
    v_max_f32 v16, v16, v17
    v_sub_f32 v48, v48, v16
    v_exp_f32 v48, v48
    v_sub_f32 v49, v49, v16
    v_exp_f32 v49, v49
    v_sub_f32 v50, v50, v16
    v_exp_f32 v50, v50
    v_sub_f32 v51, v51, v16
    v_exp_f32 v51, v51
    v_sub_f32 v52, v52, v16
    v_exp_f32 v52, v52
    v_sub_f32 v53, v53, v16
    v_exp_f32 v53, v53
    v_sub_f32 v54, v54, v16
    v_exp_f32 v54, v54
    v_sub_f32 v55, v55, v16
    v_exp_f32 v55, v55
    v_sub_f32 v56, v56, v16
    v_exp_f32 v56, v56
    v_sub_f32 v57, v57, v16
    v_exp_f32 v57, v57
    v_cvt_pk_bf16_f32 v108, v48, v49
    v_cvt_pk_bf16_f32 v109, v50, v51
    v_cvt_pk_bf16_f32 v110, v52, v53
    v_cvt_pk_bf16_f32 v111, v54, v55
    v_cvt_pk_bf16_f32 v112, v56, v57
    s_nop 0
    v_mfma_f32_16x16x32_bf16 v[48:51], v[104:107], v[108:111], 0
    v_mfma_f32_16x16x32_bf16 v[56:59], v[120:123], v[108:111], 0
    v_mfma_f32_16x16x32_bf16 v[60:63], v[124:127], v[108:111], 0
    s_nop 3
    v_mfma_f32_16x16x16_bf16 v[48:51], v[104:105], v[112:113], v[48:51]
    v_mfma_f32_16x16x16_bf16 v[56:59], v[114:115], v[112:113], v[56:59]
    v_mfma_f32_16x16x16_bf16 v[60:63], v[116:117], v[112:113], v[60:63]
    s_nop 5
    v_rcp_f32 v118, v48
    s_nop 0
    v_mul_f32 v56, v56, v118
    v_mul_f32 v57, v57, v118
    v_mul_f32 v58, v58, v118
    v_mul_f32 v59, v59, v118
    v_mul_f32 v60, v60, v118
    v_mul_f32 v61, v61, v118
    v_mul_f32 v62, v62, v118
    v_mul_f32 v63, v63, v118
    v_cvt_pk_bf16_f32 v52, v56, v60
    v_cvt_pk_bf16_f32 v53, v57, v61
    v_cvt_pk_bf16_f32 v54, v58, v62
    v_cvt_pk_bf16_f32 v55, v59, v63
    ds_write_b128 v8, v[52:55]
    ds_read_b128 v[88:91], v4 offset:24576
    ds_read_b128 v[92:95], v4 offset:25600
    ds_read_b128 v[96:99], v4 offset:26624
    ds_read_b128 v[100:103], v4 offset:27648
    ds_read_b128 v[72:75], v4 offset:28672
    ds_read_b128 v[76:79], v4 offset:29696
    ds_read_b128 v[80:83], v4 offset:30720
    ds_read_b128 v[84:87], v4 offset:31744
    v_mov_b32 v16, 0
    v_mov_b32 v17, 0
    v_mov_b32 v18, 0
    v_mov_b32 v19, 0
    v_mov_b32 v20, 0
    v_mov_b32 v21, 0
    v_mov_b32 v22, 0
    v_mov_b32 v23, 0
    v_mov_b32 v24, 0
    v_mov_b32 v25, 0
    v_mov_b32 v26, 0
    v_mov_b32 v27, 0
    v_mov_b32 v28, 0
    v_mov_b32 v29, 0
    v_mov_b32 v30, 0
    v_mov_b32 v31, 0
    v_mov_b32 v32, 0
    v_mov_b32 v33, 0
    v_mov_b32 v34, 0
    v_mov_b32 v35, 0
    v_mov_b32 v36, 0
    v_mov_b32 v37, 0
    v_mov_b32 v38, 0
    v_mov_b32 v39, 0
    v_mov_b32 v40, 0
    v_mov_b32 v41, 0
    v_mov_b32 v42, 0
    v_mov_b32 v43, 0
    v_mov_b32 v44, 0
    v_mov_b32 v45, 0
    v_mov_b32 v46, 0
    v_mov_b32 v47, 0
    s_branch L_fast_rejoin
L_fast_done:
    s_branch L_end
L_slow_start:
    s_mov_b32 s22, 0
    s_mov_b32 s23, 0x1000000
    s_mov_b32 s27, 0
    s_mov_b32 s31, 0x80000
    ds_read_b128 v[104:107], v4 offset:0
    ds_read_b128 v[108:111], v4 offset:1024
    ds_read_b128 v[112:115], v4 offset:2048
    ds_read_b128 v[116:119], v4 offset:3072
    ds_read_b128 v[88:91], v4 offset:4096
    ds_read_b128 v[92:95], v4 offset:5120
    ds_read_b128 v[96:99], v4 offset:6144
    ds_read_b128 v[100:103], v4 offset:7168
    ds_read_b128 v[72:75], v4 offset:8192
    ds_read_b128 v[76:79], v4 offset:9216
    ds_read_b128 v[80:83], v4 offset:10240
    ds_read_b128 v[84:87], v4 offset:11264
    v_mov_b64 v[48:49], 0
    v_mov_b64 v[50:51], 0
    v_mov_b64 v[52:53], 0
    v_mov_b64 v[54:55], 0
    v_mov_b64 v[56:57], 0
    v_mov_b64 v[58:59], 0
    v_mov_b64 v[60:61], 0
    v_mov_b64 v[62:63], 0
    v_mov_b64 v[64:65], 0
    v_mov_b64 v[66:67], 0
    v_mov_b64 v[68:69], 0
    v_mov_b64 v[70:71], 0
    s_waitcnt lgkmcnt(0)
    s_mov_b64 s[62:63], 0
L_slow_step:
    s_bitcmp1_b64 s[62:63], s22
    s_cbranch_scc0 L_slow_refresh
    s_add_u32 s36, s22, 1
    s_bitcmp1_b64 s[62:63], s36
    s_cbranch_scc0 L_slow_refresh
    s_add_u32 s7, s23, 0x80000
    s_add_u32 s24, s23, 0x82000
    s_add_u32 s29, s23, s25
    s_add_u32 s30, s23, s39
    v_xor_b32 v28, 0x800, v2
    v_xor_b32 v36, 0x1000, v2
    v_xor_b32 v44, 0x1800, v2
L_slow_pollm:
    buffer_load_dwordx4 v[16:19], v2, s[8:11], s7 offen sc1
    buffer_load_dwordx4 v[20:23], v2, s[8:11], s7 offen offset:1024 sc1
    s_add_u32 s32, s32, 1
    s_cmp_gt_u32 s32, 200000
    s_waitcnt vmcnt(1)
    v_max3_u32 v14, v16, v17, v18
    s_waitcnt vmcnt(0)
    v_max3_u32 v24, v19, v20, v21
    v_max3_u32 v14, v14, v22, v23
    v_max_u32 v14, v14, v24
    s_cbranch_scc1 L_slow_gotm
    v_cmp_eq_u32 vcc, -1, v14
    s_cbranch_vccnz L_slow_pollm
L_slow_gotm:
    v_smfmac_f32_16x16x64_bf16 v[48:51], v[16:19], v[104:111], v1
    ds_write_b128 v2, v[16:19] offset:0
    v_smfmac_f32_16x16x64_bf16 v[52:55], v[16:19], v[112:119], v1
    ds_write_b128 v2, v[20:23] offset:1024
    v_smfmac_f32_16x16x64_bf16 v[48:51], v[20:23], v[88:95], v1
    buffer_load_dwordx4 v[104:107], v3, s[8:11], s29 offen offset:0 sc1
    v_smfmac_f32_16x16x64_bf16 v[52:55], v[20:23], v[96:103], v1
    v_smfmac_f32_16x16x64_bf16 v[56:59], v[16:19], v[72:79], v1
    buffer_load_dwordx4 v[108:111], v3, s[8:11], s29 offen offset:1024 sc1
    v_smfmac_f32_16x16x64_bf16 v[60:63], v[16:19], v[80:87], v1
    s_waitcnt lgkmcnt(0)
    s_barrier
    ds_read_b128 v[24:27], v28 offset:0
    v_smfmac_f32_16x16x64_bf16 v[56:59], v[20:23], a[80:87], v1
    ds_read_b128 v[28:31], v28 offset:1024
    v_smfmac_f32_16x16x64_bf16 v[60:63], v[20:23], a[88:95], v1
    ds_read_b128 v[32:35], v36 offset:0
    v_smfmac_f32_16x16x64_bf16 v[64:67], v[16:19], a[160:167], v1
    ds_read_b128 v[36:39], v36 offset:1024
    v_smfmac_f32_16x16x64_bf16 v[68:71], v[16:19], a[168:175], v1
    ds_read_b128 v[40:43], v44 offset:0
    s_waitcnt lgkmcnt(4)
    v_smfmac_f32_16x16x64_bf16 v[48:51], v[24:27], a[0:7], v1
    ds_read_b128 v[44:47], v44 offset:1024
    v_smfmac_f32_16x16x64_bf16 v[52:55], v[24:27], a[8:15], v1
    buffer_load_dwordx4 v[112:115], v3, s[8:11], s29 offen offset:2048 sc1
    s_waitcnt lgkmcnt(4)
    v_smfmac_f32_16x16x64_bf16 v[48:51], v[28:31], a[16:23], v1
    ds_read_b128 v[88:91], v4 offset:12288
    v_smfmac_f32_16x16x64_bf16 v[52:55], v[28:31], a[24:31], v1
    buffer_load_dwordx4 v[116:119], v3, s[8:11], s29 offen offset:3072 sc1
    s_waitcnt lgkmcnt(4)
    v_smfmac_f32_16x16x64_bf16 v[48:51], v[32:35], a[32:39], v1
    ds_read_b128 v[92:95], v4 offset:13312
    v_smfmac_f32_16x16x64_bf16 v[52:55], v[32:35], a[40:47], v1
    buffer_load_dwordx4 v[120:123], v3, s[8:11], s30 offen offset:0 sc1
    s_waitcnt lgkmcnt(4)
    v_smfmac_f32_16x16x64_bf16 v[48:51], v[36:39], a[48:55], v1
    ds_read_b128 v[96:99], v4 offset:14336
    v_smfmac_f32_16x16x64_bf16 v[52:55], v[36:39], a[56:63], v1
    ds_read_b128 v[100:103], v4 offset:15360
    s_waitcnt lgkmcnt(5)
    v_smfmac_f32_16x16x64_bf16 v[48:51], v[40:43], a[64:71], v1
    buffer_load_dwordx4 v[124:127], v3, s[8:11], s30 offen offset:1024 sc1
    v_smfmac_f32_16x16x64_bf16 v[52:55], v[40:43], a[72:79], v1
    ds_read_b128 v[72:75], v4 offset:16384
    s_waitcnt lgkmcnt(1)
    v_smfmac_f32_16x16x64_bf16 v[48:51], v[44:47], v[88:95], v1
    ds_read_b128 v[76:79], v4 offset:17408
    v_smfmac_f32_16x16x64_bf16 v[52:55], v[44:47], v[96:103], v1
    buffer_load_dword v15, v0, s[8:11], s24 offen sc1
    v_smfmac_f32_16x16x64_bf16 v[56:59], v[28:31], a[96:103], v1
    ds_read_b128 v[80:83], v4 offset:18432
    v_smfmac_f32_16x16x64_bf16 v[60:63], v[28:31], a[104:111], v1
    ds_read_b128 v[84:87], v4 offset:19456
    v_smfmac_f32_16x16x64_bf16 v[56:59], v[36:39], a[128:135], v1
    ds_read_b128 v[88:91], v4 offset:20480
    v_smfmac_f32_16x16x64_bf16 v[56:59], v[32:35], a[112:119], v1
    ds_read_b128 v[92:95], v4 offset:21504
    v_add_f32 v48, v48, v50
    v_add_f32 v49, v49, v51
    v_smfmac_f32_16x16x64_bf16 v[60:63], v[32:35], a[120:127], v1
    ds_read_b128 v[96:99], v4 offset:22528
    v_add_f32 v52, v52, v54
    v_add_f32 v53, v53, v55
    v_smfmac_f32_16x16x64_bf16 v[60:63], v[36:39], a[136:143], v1
    ds_read_b128 v[100:103], v4 offset:23552
    s_waitcnt lgkmcnt(4)
    v_cvt_pk_bf16_f32 v50, v48, v52
    v_cvt_pk_bf16_f32 v51, v49, v53
    v_smfmac_f32_16x16x64_bf16 v[56:59], v[24:27], v[72:79], v1
    ds_write2_b32 v5, v50, v51 offset0:0 offset1:72
    v_smfmac_f32_16x16x64_bf16 v[60:63], v[24:27], v[80:87], v1
    v_add_u32 v55, 2304, v5
    v_smfmac_f32_16x16x64_bf16 v[56:59], v[40:43], a[144:151], v1
    v_smfmac_f32_16x16x64_bf16 v[60:63], v[40:43], a[152:159], v1
    s_waitcnt lgkmcnt(0)
    s_barrier
    ds_read_b128 v[72:75], v6 offset:0
    v_smfmac_f32_16x16x64_bf16 v[56:59], v[44:47], v[88:95], v1
    ds_read_b128 v[76:79], v6 offset:64
    v_smfmac_f32_16x16x64_bf16 v[60:63], v[44:47], v[96:103], v1
    ds_read_b128 v[80:83], v6 offset:128
    v_smfmac_f32_16x16x64_bf16 v[64:67], v[20:23], a[176:183], v1
    ds_read_b128 v[84:87], v6 offset:192
    v_smfmac_f32_16x16x64_bf16 v[68:71], v[20:23], a[184:191], v1
    s_waitcnt vmcnt(3) lgkmcnt(3)
    v_mfma_f32_16x16x32_bf16 v[48:51], v[104:107], v[72:75], 0
    s_waitcnt lgkmcnt(2)
    v_add_f32 v56, v56, v58
    v_add_f32 v57, v57, v59
    v_mfma_f32_16x16x32_bf16 v[48:51], v[108:111], v[76:79], v[48:51]
    s_waitcnt lgkmcnt(1)
    v_add_f32 v60, v60, v62
    v_add_f32 v61, v61, v63
    v_mfma_f32_16x16x32_bf16 v[48:51], v[112:115], v[80:83], v[48:51]
    s_waitcnt lgkmcnt(0)
    v_cvt_pk_bf16_f32 v58, v56, v60
    v_cvt_pk_bf16_f32 v59, v57, v61
    v_mfma_f32_16x16x32_bf16 v[48:51], v[116:119], v[84:87], v[48:51]
    ds_write2_b32 v55, v58, v59 offset0:0 offset1:72
    v_smfmac_f32_16x16x64_bf16 v[64:67], v[24:27], a[192:199], v1
    buffer_store_dword v12, v10, s[8:11], s31 offen sc1
    v_mov_b64 v[104:105], s[4:5]
    v_smfmac_f32_16x16x64_bf16 v[68:71], v[24:27], a[200:207], v1
    v_mov_b64 v[106:107], s[4:5]
    v_smfmac_f32_16x16x64_bf16 v[64:67], v[28:31], a[208:215], v1
    s_nop 0
    v_exp_f32 v48, v48
    v_smfmac_f32_16x16x64_bf16 v[68:71], v[28:31], a[216:223], v1
    s_waitcnt lgkmcnt(0)
    s_barrier
    ds_read_b128 v[88:91], v7 offset:0
    v_exp_f32 v49, v49
    v_smfmac_f32_16x16x64_bf16 v[64:67], v[32:35], a[224:231], v1
    ds_read_b128 v[92:95], v7 offset:64
    v_exp_f32 v50, v50
    v_smfmac_f32_16x16x64_bf16 v[68:71], v[32:35], a[232:239], v1
    ds_read_b128 v[96:99], v7 offset:128
    v_exp_f32 v51, v51
    v_smfmac_f32_16x16x64_bf16 v[64:67], v[36:39], a[240:247], v1
    ds_read_b128 v[100:103], v7 offset:192
    v_cvt_pk_bf16_f32 v108, v48, v49
    v_cvt_pk_bf16_f32 v109, v50, v51
    v_smfmac_f32_16x16x64_bf16 v[68:71], v[36:39], a[248:255], v1
    ds_write_b64 v2, v[108:109] offset:8192
    s_waitcnt lgkmcnt(4)
    v_mfma_f32_16x16x32_bf16 v[52:55], v[88:91], v[72:75], 0
    s_waitcnt lgkmcnt(3)
    v_mov_b32 v113, 0
    v_mov_b32 v115, 0
    v_mfma_f32_16x16x32_bf16 v[52:55], v[92:95], v[76:79], v[52:55]
    s_waitcnt lgkmcnt(2)
    v_mov_b32 v117, 0
    v_xor_b32 v118, 0x1000, v2
    v_mfma_f32_16x16x32_bf16 v[52:55], v[96:99], v[80:83], v[52:55]
    s_waitcnt lgkmcnt(1)
    v_mov_b64 v[16:17], 0
    v_mov_b64 v[18:19], 0
    v_mfma_f32_16x16x32_bf16 v[52:55], v[100:103], v[84:87], v[52:55]
    v_mov_b64 v[20:21], 0
    v_mov_b64 v[22:23], 0
    v_smfmac_f32_16x16x64_bf16 v[64:67], v[40:43], v[128:135], v1
    s_waitcnt lgkmcnt(0)
    s_barrier
    ds_read_b64 v[110:111], v118 offset:8192
    v_mov_b64 v[24:25], 0
    v_smfmac_f32_16x16x64_bf16 v[68:71], v[40:43], v[136:143], v1
    ds_read_b128 v[88:91], v4 offset:24576
    v_mov_b64 v[26:27], 0
    v_smfmac_f32_16x16x64_bf16 v[64:67], v[44:47], v[144:151], v1
    ds_read_b128 v[92:95], v4 offset:25600
    v_mul_f32 v52, s33, v52
    v_mul_f32 v53, s33, v53
    v_smfmac_f32_16x16x64_bf16 v[68:71], v[44:47], v[152:159], v1
    ds_read_b128 v[96:99], v4 offset:26624
    s_waitcnt vmcnt(2) lgkmcnt(3)
    v_exp_f32 v52, v52
    v_mfma_f32_16x16x32_bf16 v[48:51], v[104:107], v[108:111], 0
    ds_read_b128 v[100:103], v4 offset:27648
    v_exp_f32 v53, v53
    v_mfma_f32_16x16x32_bf16 v[56:59], v[120:123], v[108:111], 0
    ds_read_b128 v[72:75], v4 offset:28672
    v_cvt_pk_bf16_f32 v112, v52, v53
    v_mov_b64 v[28:29], 0
    v_mfma_f32_16x16x32_bf16 v[60:63], v[124:127], v[108:111], 0
    ds_read_b128 v[76:79], v4 offset:29696
    v_add_f32 v64, v64, v66
    v_add_f32 v65, v65, v67
    v_mfma_f32_16x16x16_bf16 v[48:51], v[104:105], v[112:113], v[48:51]
    ds_read_b128 v[80:83], v4 offset:30720
    v_cvt_pk_bf16_f32 v114, v64, v65
    v_add_f32 v68, v68, v70
    v_add_f32 v69, v69, v71
    v_mfma_f32_16x16x16_bf16 v[56:59], v[114:115], v[112:113], v[56:59]
    ds_read_b128 v[84:87], v4 offset:31744
    v_cvt_pk_bf16_f32 v116, v68, v69
    v_mov_b64 v[30:31], 0
    v_mov_b64 v[32:33], 0
    v_mfma_f32_16x16x16_bf16 v[60:63], v[116:117], v[112:113], v[60:63]
    v_rcp_f32 v118, v48
    v_mov_b64 v[34:35], 0
    v_mov_b64 v[36:37], 0
    v_mov_b64 v[38:39], 0
    v_mov_b64 v[40:41], 0
    v_mov_b64 v[42:43], 0
    v_pk_mul_f32 v[56:57], v[56:57], v[118:119] op_sel_hi:[1,0]
    s_nop 0
    v_pk_mul_f32 v[60:61], v[60:61], v[118:119] op_sel_hi:[1,0]
    v_pk_mul_f32 v[58:59], v[58:59], v[118:119] op_sel_hi:[1,0]
    v_pk_mul_f32 v[62:63], v[62:63], v[118:119] op_sel_hi:[1,0]
    v_cvt_pk_bf16_f32 v52, v56, v60
    v_cvt_pk_bf16_f32 v53, v57, v61
    v_cvt_pk_bf16_f32 v54, v58, v62
    v_cvt_pk_bf16_f32 v55, v59, v63
    ds_write_b128 v8, v[52:55]
    v_max_f32 v118, v118, v48
    v_cmp_nge_f32 vcc, s40, v118
    s_cbranch_vccnz L_slow_safe
L_slow_rejoin:
    v_mov_b64 v[44:45], 0
    v_mov_b64 v[46:47], 0
    s_waitcnt lgkmcnt(0)
    s_barrier
    ds_read_b128 v[120:123], v3 offset:20992
    ds_read_b128 v[124:127], v3 offset:22016
    s_waitcnt lgkmcnt(1)
    v_smfmac_f32_16x16x64_bf16 v[16:19], v[120:123], v[88:95], v1
    v_smfmac_f32_16x16x64_bf16 v[20:23], v[120:123], v[96:103], v1
    s_waitcnt lgkmcnt(0)
    v_smfmac_f32_16x16x64_bf16 v[16:19], v[124:127], v[72:79], v1
    v_smfmac_f32_16x16x64_bf16 v[20:23], v[124:127], v[80:87], v1
    v_smfmac_f32_16x16x64_bf16 v[24:27], v[120:123], v[160:167], v1
    v_smfmac_f32_16x16x64_bf16 v[28:31], v[120:123], v[168:175], v1
    s_nop 4
    v_add_f32 v16, v16, v18
    v_add_f32 v17, v17, v19
    v_smfmac_f32_16x16x64_bf16 v[24:27], v[124:127], v[208:215], v1
    v_add_f32 v20, v20, v22
    v_add_f32 v21, v21, v23
    v_smfmac_f32_16x16x64_bf16 v[28:31], v[124:127], v[216:223], v1
    v_cvt_pk_bf16_f32 v48, v16, v20
    v_cvt_pk_bf16_f32 v49, v17, v21
    v_smfmac_f32_16x16x64_bf16 v[32:35], v[120:123], v[176:183], v1
    v_and_or_b32 v48, v48, -2, s27
    v_smfmac_f32_16x16x64_bf16 v[36:39], v[120:123], v[184:191], v1
    buffer_store_dwordx2 v[48:49], v9, s[8:11], 0 offen offset:0 sc1
    v_add_f32 v24, v24, v26
    v_add_f32 v25, v25, v27
    v_smfmac_f32_16x16x64_bf16 v[32:35], v[124:127], v[224:231], v1
    v_add_f32 v28, v28, v30
    v_add_f32 v29, v29, v31
    v_smfmac_f32_16x16x64_bf16 v[36:39], v[124:127], v[232:239], v1
    v_cvt_pk_bf16_f32 v50, v24, v28
    v_cvt_pk_bf16_f32 v51, v25, v29
    v_smfmac_f32_16x16x64_bf16 v[40:43], v[120:123], v[192:199], v1
    v_and_or_b32 v50, v50, -2, s27
    v_smfmac_f32_16x16x64_bf16 v[44:47], v[120:123], v[200:207], v1
    buffer_store_dwordx2 v[50:51], v9, s[8:11], 0 offen offset:2048 sc1
    v_add_f32 v32, v32, v34
    v_add_f32 v33, v33, v35
    v_smfmac_f32_16x16x64_bf16 v[40:43], v[124:127], v[240:247], v1
    v_add_f32 v36, v36, v38
    v_add_f32 v37, v37, v39
    v_smfmac_f32_16x16x64_bf16 v[44:47], v[124:127], v[248:255], v1
    v_cvt_pk_bf16_f32 v52, v32, v36
    v_cvt_pk_bf16_f32 v53, v33, v37
    v_and_or_b32 v52, v52, -2, s27
    buffer_store_dwordx2 v[52:53], v9, s[8:11], s26 offen offset:0 sc1
    s_nop 0
    v_add_f32 v40, v40, v42
    v_add_f32 v41, v41, v43
    s_nop 0
    v_add_f32 v44, v44, v46
    v_add_f32 v45, v45, v47
    v_cvt_pk_bf16_f32 v54, v40, v44
    v_cvt_pk_bf16_f32 v55, v41, v45
    v_and_or_b32 v54, v54, -2, s27
    buffer_store_dwordx2 v[54:55], v9, s[8:11], s26 offen offset:2048 sc1
L_slow_stored:
    ds_read_b128 v[24:27], v3 offset:23040
    ds_read_b128 v[104:107], v4 offset:0
    ds_read_b128 v[108:111], v4 offset:1024
    ds_read_b128 v[112:115], v4 offset:2048
    ds_read_b128 v[116:119], v4 offset:3072
    ds_read_b128 v[88:91], v4 offset:4096
    ds_read_b128 v[92:95], v4 offset:5120
    ds_read_b128 v[96:99], v4 offset:6144
    ds_read_b128 v[100:103], v4 offset:7168
    ds_read_b128 v[72:75], v4 offset:8192
    ds_read_b128 v[76:79], v4 offset:9216
    ds_read_b128 v[80:83], v4 offset:10240
    ds_read_b128 v[84:87], v4 offset:11264
    v_mov_b64 v[48:49], 0
    v_mov_b64 v[50:51], 0
    v_mov_b64 v[52:53], 0
    v_mov_b64 v[54:55], 0
    v_mov_b64 v[56:57], 0
    v_mov_b64 v[58:59], 0
    v_mov_b64 v[60:61], 0
    v_mov_b64 v[62:63], 0
    v_mov_b64 v[64:65], 0
    v_mov_b64 v[66:67], 0
    v_mov_b64 v[68:69], 0
    v_mov_b64 v[70:71], 0
    s_cmp_lt_u32 s21, 1
    s_cbranch_scc1 L_slow_poll0
    s_nop 7
    s_cmp_lt_u32 s21, 2
    s_cbranch_scc1 L_slow_poll0
    s_nop 7
    s_cmp_lt_u32 s21, 3
    s_cbranch_scc1 L_slow_poll0
    s_nop 7
L_slow_poll0:
    buffer_load_dwordx4 v[120:123], v2, s[8:11], s6 offen sc1
    buffer_load_dwordx4 v[124:127], v2, s[8:11], s6 offen offset:1024 sc1
    s_waitcnt lgkmcnt(0)
L_slow_pollp:
    s_waitcnt vmcnt(1)
    v_mfma_f32_16x16x32_bf16 v[36:39], v[24:27], v[120:123], 0
    v_bitop3_b32 v14, v120, v122, s27 bitop3:0x7e
    s_waitcnt vmcnt(0)
    v_mfma_f32_16x16x32_bf16 v[36:39], v[24:27], v[124:127], v[36:39]
    v_bitop3_b32 v11, v124, v126, s27 bitop3:0x7e
    v_bitop3_b32 v14, v14, v11, 1 bitop3:0xa8
    v_cmp_ne_u32 vcc, 0, v14
    s_add_u32 s32, s32, 1
    s_cbranch_vccz L_slow_gotp
    buffer_load_dwordx4 v[16:19], v2, s[8:11], s6 offen sc1
    buffer_load_dwordx4 v[20:23], v2, s[8:11], s6 offen offset:1024 sc1
    s_waitcnt vmcnt(1)
    v_mfma_f32_16x16x32_bf16 v[36:39], v[24:27], v[16:19], 0
    v_bitop3_b32 v14, v16, v18, s27 bitop3:0x7e
    s_waitcnt vmcnt(0)
    v_mfma_f32_16x16x32_bf16 v[36:39], v[24:27], v[20:23], v[36:39]
    v_bitop3_b32 v11, v20, v22, s27 bitop3:0x7e
    v_bitop3_b32 v14, v14, v11, 1 bitop3:0xa8
    v_cmp_ne_u32 vcc, 0, v14
    s_add_u32 s32, s32, 1
    s_cbranch_vccz L_slow_gotp
    buffer_load_dwordx4 v[120:123], v2, s[8:11], s6 offen sc1
    buffer_load_dwordx4 v[124:127], v2, s[8:11], s6 offen offset:1024 sc1
    s_cmp_le_u32 s32, 200000
    s_cbranch_scc1 L_slow_pollp
L_slow_gotp:
    s_mov_b32 s23, s24
    s_add_u32 s31, s31, 0x2000
    s_add_u32 s22, s22, 1
    s_xor_b32 s27, s27, 1
    v_add_f32_dpp v36, v36, v36 row_ror:8 row_mask:0xf bank_mask:0xf
    v_add_f32_dpp v37, v37, v37 row_ror:8 row_mask:0xf bank_mask:0xf
    s_nop 0
    v_add_f32_dpp v36, v36, v36 row_ror:4 row_mask:0xf bank_mask:0xf
    v_add_f32_dpp v37, v37, v37 row_ror:4 row_mask:0xf bank_mask:0xf
    v_cvt_pk_bf16_f32 v12, v36, v37
    buffer_store_dword v12, v10, s[8:11], s23 offen sc1
    s_nop 15
    s_nop 15
    s_nop 15
    s_cmp_lt_u32 s22, 63
    s_cbranch_scc1 L_slow_step
    buffer_store_dword v12, v10, s[8:11], s31 offen sc1
    s_branch L_slow_done
L_slow_refresh:
    v_lshrrev_b32 v14, 2, v3
    s_lshl_b32 s36, s20, 8
    s_add_u32 s36, s36, 0x190000
    buffer_load_dword v14, v14, s[8:11], s36 offen sc1
    s_add_u32 s32, s32, 1
    s_waitcnt vmcnt(0)
    v_cmp_ne_u32 s[62:63], 0, v14
    s_nop 3
    s_bitset1_b64 s[62:63], 63
    s_cmp_le_u32 s32, 200000
    s_cbranch_scc1 L_slow_step
    s_mov_b64 s[62:63], -1
    s_branch L_slow_step
L_slow_safe:
    s_nop 11
    s_waitcnt vmcnt(0) lgkmcnt(0)
    ds_read_b128 v[72:75], v6 offset:0
    ds_read_b128 v[88:91], v7 offset:0
    ds_read_b128 v[76:79], v6 offset:64
    ds_read_b128 v[92:95], v7 offset:64
    ds_read_b128 v[80:83], v6 offset:128
    ds_read_b128 v[96:99], v7 offset:128
    ds_read_b128 v[84:87], v6 offset:192
    ds_read_b128 v[100:103], v7 offset:192
    s_xor_b32 s36, s25, 0x1000
    s_add_u32 s36, s36, s23
    buffer_load_dwordx4 v[16:19], v3, s[8:11], s29 offen offset:0 sc1
    buffer_load_dwordx4 v[32:35], v3, s[8:11], s36 offen offset:0 sc1
    buffer_load_dwordx4 v[20:23], v3, s[8:11], s29 offen offset:1024 sc1
    buffer_load_dwordx4 v[36:39], v3, s[8:11], s36 offen offset:1024 sc1
    buffer_load_dwordx4 v[24:27], v3, s[8:11], s29 offen offset:2048 sc1
    buffer_load_dwordx4 v[40:43], v3, s[8:11], s36 offen offset:2048 sc1
    buffer_load_dwordx4 v[28:31], v3, s[8:11], s29 offen offset:3072 sc1
    buffer_load_dwordx4 v[44:47], v3, s[8:11], s36 offen offset:3072 sc1
    s_waitcnt vmcnt(0) lgkmcnt(0)
    v_mfma_f32_16x16x32_bf16 v[48:51], v[16:19], v[72:75], 0
    v_mfma_f32_16x16x32_bf16 v[48:51], v[20:23], v[76:79], v[48:51]
    v_mfma_f32_16x16x32_bf16 v[48:51], v[24:27], v[80:83], v[48:51]
    v_mfma_f32_16x16x32_bf16 v[48:51], v[28:31], v[84:87], v[48:51]
    v_mfma_f32_16x16x32_bf16 v[52:55], v[32:35], v[72:75], 0
    v_mfma_f32_16x16x32_bf16 v[52:55], v[36:39], v[76:79], v[52:55]
    v_mfma_f32_16x16x32_bf16 v[52:55], v[40:43], v[80:83], v[52:55]
    v_mfma_f32_16x16x32_bf16 v[52:55], v[44:47], v[84:87], v[52:55]
    v_mfma_f32_16x16x32_bf16 v[56:59], v[88:91], v[72:75], 0
    v_mfma_f32_16x16x32_bf16 v[56:59], v[92:95], v[76:79], v[56:59]
    v_mfma_f32_16x16x32_bf16 v[56:59], v[96:99], v[80:83], v[56:59]
    v_mfma_f32_16x16x32_bf16 v[56:59], v[100:103], v[84:87], v[56:59]
    s_nop 7
    v_mul_f32 v56, s33, v56
    v_mul_f32 v57, s33, v57
    v_max3_f32 v16, v48, v49, v50
    v_max3_f32 v16, v16, v51, v52
    v_max3_f32 v16, v16, v53, v54
    v_max3_f32 v16, v16, v55, v56
    v_max_f32 v16, v16, v57
    v_mov_b32 v17, v16
    s_nop 1
    v_permlane16_swap_b32 v16, v17
    v_max_f32 v16, v16, v17
    v_mov_b32 v17, v16
    s_nop 1
    v_permlane32_swap_b32 v16, v17
    v_max_f32 v16, v16, v17
    v_sub_f32 v48, v48, v16
    v_exp_f32 v48, v48
    v_sub_f32 v49, v49, v16
    v_exp_f32 v49, v49
    v_sub_f32 v50, v50, v16
    v_exp_f32 v50, v50
    v_sub_f32 v51, v51, v16
    v_exp_f32 v51, v51
    v_sub_f32 v52, v52, v16
    v_exp_f32 v52, v52
    v_sub_f32 v53, v53, v16
    v_exp_f32 v53, v53
    v_sub_f32 v54, v54, v16
    v_exp_f32 v54, v54
    v_sub_f32 v55, v55, v16
    v_exp_f32 v55, v55
    v_sub_f32 v56, v56, v16
    v_exp_f32 v56, v56
    v_sub_f32 v57, v57, v16
    v_exp_f32 v57, v57
    v_cvt_pk_bf16_f32 v108, v48, v49
    v_cvt_pk_bf16_f32 v109, v50, v51
    v_cvt_pk_bf16_f32 v110, v52, v53
    v_cvt_pk_bf16_f32 v111, v54, v55
    v_cvt_pk_bf16_f32 v112, v56, v57
    s_nop 0
    v_mfma_f32_16x16x32_bf16 v[48:51], v[104:107], v[108:111], 0
    v_mfma_f32_16x16x32_bf16 v[56:59], v[120:123], v[108:111], 0
    v_mfma_f32_16x16x32_bf16 v[60:63], v[124:127], v[108:111], 0
    s_nop 3
    v_mfma_f32_16x16x16_bf16 v[48:51], v[104:105], v[112:113], v[48:51]
    v_mfma_f32_16x16x16_bf16 v[56:59], v[114:115], v[112:113], v[56:59]
    v_mfma_f32_16x16x16_bf16 v[60:63], v[116:117], v[112:113], v[60:63]
    s_nop 5
    v_rcp_f32 v118, v48
    s_nop 0
    v_mul_f32 v56, v56, v118
    v_mul_f32 v57, v57, v118
    v_mul_f32 v58, v58, v118
    v_mul_f32 v59, v59, v118
    v_mul_f32 v60, v60, v118
    v_mul_f32 v61, v61, v118
    v_mul_f32 v62, v62, v118
    v_mul_f32 v63, v63, v118
    v_cvt_pk_bf16_f32 v52, v56, v60
    v_cvt_pk_bf16_f32 v53, v57, v61
    v_cvt_pk_bf16_f32 v54, v58, v62
    v_cvt_pk_bf16_f32 v55, v59, v63
    ds_write_b128 v8, v[52:55]
    ds_read_b128 v[88:91], v4 offset:24576
    ds_read_b128 v[92:95], v4 offset:25600
    ds_read_b128 v[96:99], v4 offset:26624
    ds_read_b128 v[100:103], v4 offset:27648
    ds_read_b128 v[72:75], v4 offset:28672
    ds_read_b128 v[76:79], v4 offset:29696
    ds_read_b128 v[80:83], v4 offset:30720
    ds_read_b128 v[84:87], v4 offset:31744
    v_mov_b32 v16, 0
    v_mov_b32 v17, 0
    v_mov_b32 v18, 0
    v_mov_b32 v19, 0
    v_mov_b32 v20, 0
    v_mov_b32 v21, 0
    v_mov_b32 v22, 0
    v_mov_b32 v23, 0
    v_mov_b32 v24, 0
    v_mov_b32 v25, 0
    v_mov_b32 v26, 0
    v_mov_b32 v27, 0
    v_mov_b32 v28, 0
    v_mov_b32 v29, 0
    v_mov_b32 v30, 0
    v_mov_b32 v31, 0
    v_mov_b32 v32, 0
    v_mov_b32 v33, 0
    v_mov_b32 v34, 0
    v_mov_b32 v35, 0
    v_mov_b32 v36, 0
    v_mov_b32 v37, 0
    v_mov_b32 v38, 0
    v_mov_b32 v39, 0
    v_mov_b32 v40, 0
    v_mov_b32 v41, 0
    v_mov_b32 v42, 0
    v_mov_b32 v43, 0
    v_mov_b32 v44, 0
    v_mov_b32 v45, 0
    v_mov_b32 v46, 0
    v_mov_b32 v47, 0
    s_branch L_slow_rejoin
L_slow_done:
    s_branch L_end
L_worker:
    s_mov_b32 s12, s44
    s_and_b32 s13, s45, 0xffff
    s_mov_b32 s14, 0x200000
    s_mov_b32 s15, 0x20000
    s_mov_b32 s60, s82
    s_and_b32 s61, s83, 0xffff
    s_mov_b32 s62, 0x200000
    s_mov_b32 s63, 0x20000
    s_mov_b32 s92, s80
    s_and_b32 s93, s81, 0xffff
    s_mov_b32 s94, 0x400
    s_mov_b32 s95, 0x20000
    s_and_b32 s36, s2, 7
    s_sub_u32 s36, s36, 1
    s_lshl_b32 s36, s36, 5
    s_lshr_b32 s37, s2, 3
    s_add_u32 s36, s36, s37
    s_mul_i32 s20, s36, 9363
    s_lshr_b32 s20, s20, 16
    s_mul_i32 s37, s20, 7
    s_sub_u32 s22, s36, s37
    v_mov_b32 v1, 0x0
    v_bfe_u32 v14, v0, 0, 1
    s_mov_b32 s38, 0x10
    v_mad_u32_u24 v1, v14, s38, v1
    v_bfe_u32 v14, v0, 1, 1
    s_mov_b32 s38, 0x20
    v_mad_u32_u24 v1, v14, s38, v1
    v_bfe_u32 v14, v0, 2, 1
    s_mov_b32 s38, 0x40
    v_mad_u32_u24 v1, v14, s38, v1
    v_bfe_u32 v14, v0, 3, 1
    s_mov_b32 s38, 0x80
    v_mad_u32_u24 v1, v14, s38, v1
    v_bfe_u32 v14, v0, 4, 1
    s_mov_b32 s38, 0x100
    v_mad_u32_u24 v1, v14, s38, v1
    v_bfe_u32 v14, v0, 5, 1
    s_mov_b32 s38, 0x200
    v_mad_u32_u24 v1, v14, s38, v1
    v_mov_b32 v2, 0x0
    v_bfe_u32 v14, v0, 0, 1
    s_mov_b32 s38, 0x10
    v_mad_u32_u24 v2, v14, s38, v2
    v_bfe_u32 v14, v0, 1, 1
    s_mov_b32 s38, 0x20
    v_mad_u32_u24 v2, v14, s38, v2
    v_bfe_u32 v14, v0, 2, 1
    s_mov_b32 s38, 0x40
    v_mad_u32_u24 v2, v14, s38, v2
    v_bfe_u32 v14, v0, 3, 1
    s_mov_b32 s38, 0x80
    v_mad_u32_u24 v2, v14, s38, v2
    v_bfe_u32 v14, v0, 4, 1
    s_mov_b32 s38, 0x100
    v_mad_u32_u24 v2, v14, s38, v2
    v_bfe_u32 v14, v0, 5, 1
    s_mov_b32 s38, 0x200
    v_mad_u32_u24 v2, v14, s38, v2
    v_bfe_u32 v14, v0, 6, 1
    s_mov_b32 s38, 0x800
    v_mad_u32_u24 v2, v14, s38, v2
    v_bfe_u32 v14, v0, 7, 1
    s_mov_b32 s38, 0x1000
    v_mad_u32_u24 v2, v14, s38, v2
    v_mov_b32 v9, 0x0
    v_bfe_u32 v14, v0, 0, 1
    s_mov_b32 s38, 0x10
    v_mad_u32_u24 v9, v14, s38, v9
    v_bfe_u32 v14, v0, 1, 1
    s_mov_b32 s38, 0x20
    v_mad_u32_u24 v9, v14, s38, v9
    v_bfe_u32 v14, v0, 2, 1
    s_mov_b32 s38, 0x40
    v_mad_u32_u24 v9, v14, s38, v9
    v_bfe_u32 v14, v0, 3, 1
    s_mov_b32 s38, 0x80
    v_mad_u32_u24 v9, v14, s38, v9
    v_bfe_u32 v14, v0, 4, 1
    s_mov_b32 s38, 0x100
    v_mad_u32_u24 v9, v14, s38, v9
    v_bfe_u32 v14, v0, 5, 1
    s_mov_b32 s38, 0x200
    v_mad_u32_u24 v9, v14, s38, v9
    v_bfe_u32 v14, v0, 6, 1
    s_mov_b32 s38, 0x400
    v_mad_u32_u24 v9, v14, s38, v9
    v_bfe_u32 v14, v0, 7, 1
    s_mov_b32 s38, 0x800
    v_mad_u32_u24 v9, v14, s38, v9
    v_mov_b32 v7, 0x8000
    v_bfe_u32 v14, v0, 0, 1
    s_mov_b32 s38, 0x10
    v_mad_u32_u24 v7, v14, s38, v7
    v_bfe_u32 v14, v0, 1, 1
    s_mov_b32 s38, 0x20
    v_mad_u32_u24 v7, v14, s38, v7
    v_bfe_u32 v14, v0, 2, 1
    s_mov_b32 s38, 0x40
    v_mad_u32_u24 v7, v14, s38, v7
    v_bfe_u32 v14, v0, 3, 1
    s_mov_b32 s38, 0x80
    v_mad_u32_u24 v7, v14, s38, v7
    v_bfe_u32 v14, v0, 4, 1
    s_mov_b32 s38, 0x100
    v_mad_u32_u24 v7, v14, s38, v7
    v_bfe_u32 v14, v0, 5, 1
    s_mov_b32 s38, 0x200
    v_mad_u32_u24 v7, v14, s38, v7
    v_bfe_u32 v14, v0, 6, 1
    s_mov_b32 s38, 0x8000
    v_mad_u32_u24 v7, v14, s38, v7
    v_bfe_u32 v14, v0, 7, 1
    s_mov_b32 s38, 0x10000
    v_mad_u32_u24 v7, v14, s38, v7
    v_mov_b32 v3, 0x0
    v_bfe_u32 v14, v0, 0, 1
    s_mov_b32 s38, 0x10
    v_mad_u32_u24 v3, v14, s38, v3
    v_bfe_u32 v14, v0, 1, 1
    s_mov_b32 s38, 0x20
    v_mad_u32_u24 v3, v14, s38, v3
    v_bfe_u32 v14, v0, 2, 1
    s_mov_b32 s38, 0x40
    v_mad_u32_u24 v3, v14, s38, v3
    v_bfe_u32 v14, v0, 3, 1
    s_mov_b32 s38, 0x400
    v_mad_u32_u24 v3, v14, s38, v3
    v_bfe_u32 v14, v0, 4, 1
    s_mov_b32 s38, 0x800
    v_mad_u32_u24 v3, v14, s38, v3
    v_bfe_u32 v14, v0, 5, 1
    s_mov_b32 s38, 0x1000
    v_mad_u32_u24 v3, v14, s38, v3
    v_bfe_u32 v14, v0, 6, 1
    s_mov_b32 s38, 0x2000
    v_mad_u32_u24 v3, v14, s38, v3
    v_bfe_u32 v14, v0, 7, 1
    s_mov_b32 s38, 0x4000
    v_mad_u32_u24 v3, v14, s38, v3
    v_mov_b32 v4, 0x0
    v_bfe_u32 v14, v0, 0, 1
    s_mov_b32 s38, 0x100
    v_mad_u32_u24 v4, v14, s38, v4
    v_bfe_u32 v14, v0, 1, 1
    s_mov_b32 s38, 0x200
    v_mad_u32_u24 v4, v14, s38, v4
    v_bfe_u32 v14, v0, 2, 1
    s_mov_b32 s38, 0x400
    v_mad_u32_u24 v4, v14, s38, v4
    v_bfe_u32 v14, v0, 6, 1
    s_mov_b32 s38, 0x80
    v_mad_u32_u24 v4, v14, s38, v4
    v_bfe_u32 v14, v0, 7, 1
    s_mov_b32 s38, 0x4000
    v_mad_u32_u24 v4, v14, s38, v4
    v_lshrrev_b32 v15, 3, v0
    v_xor_b32 v15, v15, v0
    v_and_b32 v15, 7, v15
    v_lshl_add_u32 v4, v15, 4, v4
    v_bfe_u32 v15, v0, 4, 2
    v_lshlrev_b32 v15, 4, v15
    v_xor_b32 v5, v15, v1
    v_xor_b32 v6, 64, v5
    v_mov_b32 v8, 0x5000
    v_bfe_u32 v14, v0, 0, 1
    s_mov_b32 s38, 0x10
    v_mad_u32_u24 v8, v14, s38, v8
    v_bfe_u32 v14, v0, 1, 1
    s_mov_b32 s38, 0x40
    v_mad_u32_u24 v8, v14, s38, v8
    v_bfe_u32 v14, v0, 2, 1
    s_mov_b32 s38, 0x80
    v_mad_u32_u24 v8, v14, s38, v8
    v_bfe_u32 v14, v0, 4, 1
    s_mov_b32 s38, 0x20
    v_mad_u32_u24 v8, v14, s38, v8
    v_bfe_u32 v14, v0, 5, 1
    s_mov_b32 s38, 0x100
    v_mad_u32_u24 v8, v14, s38, v8
    v_mov_b32 v10, 0x0
    v_bfe_u32 v14, v0, 0, 1
    s_mov_b32 s38, 0x10
    v_mad_u32_u24 v10, v14, s38, v10
    v_bfe_u32 v14, v0, 1, 1
    s_mov_b32 s38, 0x20
    v_mad_u32_u24 v10, v14, s38, v10
    v_bfe_u32 v14, v0, 2, 1
    s_mov_b32 s38, 0x40
    v_mad_u32_u24 v10, v14, s38, v10
    v_bfe_u32 v14, v0, 3, 1
    s_mov_b32 s38, 0x80
    v_mad_u32_u24 v10, v14, s38, v10
    v_bfe_u32 v14, v0, 4, 1
    s_mov_b32 s38, 0x20000
    v_mad_u32_u24 v10, v14, s38, v10
    v_bfe_u32 v14, v0, 5, 1
    s_mov_b32 s38, 0x40000
    v_mad_u32_u24 v10, v14, s38, v10
    v_bfe_u32 v14, v0, 6, 1
    s_mov_b32 s38, 0x100
    v_mad_u32_u24 v10, v14, s38, v10
    v_bfe_u32 v14, v0, 7, 1
    s_mov_b32 s38, 0x200
    v_mad_u32_u24 v10, v14, s38, v10
    v_mov_b32 v11, 0x0
    v_bfe_u32 v14, v0, 0, 1
    s_mov_b32 s38, 0x10
    v_mad_u32_u24 v11, v14, s38, v11
    v_bfe_u32 v14, v0, 1, 1
    s_mov_b32 s38, 0x20
    v_mad_u32_u24 v11, v14, s38, v11
    v_bfe_u32 v14, v0, 2, 1
    s_mov_b32 s38, 0x40
    v_mad_u32_u24 v11, v14, s38, v11
    v_bfe_u32 v14, v0, 3, 1
    s_mov_b32 s38, 0x80
    v_mad_u32_u24 v11, v14, s38, v11
    v_bfe_u32 v14, v0, 4, 1
    s_mov_b32 s38, 0x400
    v_mad_u32_u24 v11, v14, s38, v11
    v_bfe_u32 v14, v0, 5, 1
    s_mov_b32 s38, 0x800
    v_mad_u32_u24 v11, v14, s38, v11
    v_bfe_u32 v14, v0, 6, 1
    s_mov_b32 s38, 0x100
    v_mad_u32_u24 v11, v14, s38, v11
    v_bfe_u32 v14, v0, 7, 1
    s_mov_b32 s38, 0x200
    v_mad_u32_u24 v11, v14, s38, v11
    v_mov_b32 v12, 0x0
    v_bfe_u32 v14, v0, 0, 1
    s_mov_b32 s38, 0x10
    v_mad_u32_u24 v12, v14, s38, v12
    v_bfe_u32 v14, v0, 1, 1
    s_mov_b32 s38, 0x20
    v_mad_u32_u24 v12, v14, s38, v12
    v_bfe_u32 v14, v0, 2, 1
    s_mov_b32 s38, 0x40
    v_mad_u32_u24 v12, v14, s38, v12
    v_bfe_u32 v14, v0, 3, 1
    s_mov_b32 s38, 0x80
    v_mad_u32_u24 v12, v14, s38, v12
    v_bfe_u32 v14, v0, 4, 1
    s_mov_b32 s38, 0x4
    v_mad_u32_u24 v12, v14, s38, v12
    v_bfe_u32 v14, v0, 5, 1
    s_mov_b32 s38, 0x8
    v_mad_u32_u24 v12, v14, s38, v12
    v_bfe_u32 v14, v0, 6, 1
    s_mov_b32 s38, 0x100
    v_mad_u32_u24 v12, v14, s38, v12
    v_bfe_u32 v14, v0, 7, 1
    s_mov_b32 s38, 0x200
    v_mad_u32_u24 v12, v14, s38, v12
    v_mov_b32 v13, 0xf149f2ca
    v_and_b32 v14, 15, v0
    v_bfe_u32 v15, v0, 4, 2
    v_cmp_gt_u32 s[72:73], 2, v15
    v_lshlrev_b32 v15, 2, v15
    v_cmp_le_u32 s[64:65], v15, v14
    v_add_u32 v15, 1, v15
    v_cmp_le_u32 s[66:67], v15, v14
    v_add_u32 v15, 1, v15
    v_cmp_le_u32 s[68:69], v15, v14
    v_add_u32 v15, 1, v15
    v_cmp_le_u32 s[70:71], v15, v14
    v_add_u32 v15, 1, v15
    s_mov_b32 s34, 0x05040100
    s_mov_b32 s35, 0x07060302
    s_mov_b32 s33, 0x3e0293ee
    s_mov_b32 s32, 0
    s_mov_b32 s4, 0x3f803f80
    s_mov_b32 s5, 0x3f803f80
    s_mov_b32 s23, s22
    s_lshl_b32 s36, s23, 15
    buffer_load_dwordx4 v[96:99], v3, s[12:15], s36 offen offset:0
    buffer_load_dwordx4 v[100:103], v3, s[12:15], s36 offen offset:128
    buffer_load_dwordx4 v[104:107], v3, s[12:15], s36 offen offset:256
    buffer_load_dwordx4 v[108:111], v3, s[12:15], s36 offen offset:384
    buffer_load_dwordx4 v[112:115], v3, s[12:15], s36 offen offset:512
    buffer_load_dwordx4 v[116:119], v3, s[12:15], s36 offen offset:640
    buffer_load_dwordx4 v[120:123], v3, s[12:15], s36 offen offset:768
    buffer_load_dwordx4 v[124:127], v3, s[12:15], s36 offen offset:896
    v_mov_b32 v15, 0x0
    v_bfe_u32 v14, v0, 0, 1
    s_mov_b32 s38, 0x4
    v_mad_u32_u24 v15, v14, s38, v15
    v_bfe_u32 v14, v0, 1, 1
    s_mov_b32 s38, 0x8
    v_mad_u32_u24 v15, v14, s38, v15
    v_bfe_u32 v14, v0, 2, 1
    s_mov_b32 s38, 0x10
    v_mad_u32_u24 v15, v14, s38, v15
    v_bfe_u32 v14, v0, 3, 1
    s_mov_b32 s38, 0x20
    v_mad_u32_u24 v15, v14, s38, v15
    v_bfe_u32 v14, v0, 4, 1
    s_mov_b32 s38, 0x10000
    v_mad_u32_u24 v15, v14, s38, v15
    v_bfe_u32 v14, v0, 5, 1
    s_mov_b32 s38, 0x20000
    v_mad_u32_u24 v15, v14, s38, v15
    v_bfe_u32 v14, v0, 6, 1
    s_mov_b32 s38, 0x40
    v_mad_u32_u24 v15, v14, s38, v15
    v_bfe_u32 v14, v0, 7, 1
    s_mov_b32 s38, 0x80
    v_mad_u32_u24 v15, v14, s38, v15
    s_mov_b32 s40, s50
    s_and_b32 s41, s51, 0xffff
    s_mov_b32 s42, 0x400000
    s_mov_b32 s43, 0x20000
    s_mov_b32 s76, s52
    s_and_b32 s77, s53, 0xffff
    s_mov_b32 s78, 0x400000
    s_mov_b32 s79, 0x20000
    s_mov_b32 s96, s48
    s_and_b32 s97, s49, 0xffff
    s_mov_b32 s98, 0x400000
    s_mov_b32 s99, 0x20000
    s_lshl_b32 s36, s20, 8
    s_add_u32 s37, s36, 0x0
    buffer_load_dword v16, v15, s[40:43], s37 offen
    s_add_u32 s37, s36, 0x2000
    buffer_load_dword v17, v15, s[40:43], s37 offen
    s_add_u32 s37, s36, 0x4000
    buffer_load_dword v18, v15, s[40:43], s37 offen
    s_add_u32 s37, s36, 0x6000
    buffer_load_dword v19, v15, s[40:43], s37 offen
    s_add_u32 s37, s36, 0x8000
    buffer_load_dword v20, v15, s[40:43], s37 offen
    s_add_u32 s37, s36, 0xa000
    buffer_load_dword v21, v15, s[40:43], s37 offen
    s_add_u32 s37, s36, 0xc000
    buffer_load_dword v22, v15, s[40:43], s37 offen
    s_add_u32 s37, s36, 0xe000
    buffer_load_dword v23, v15, s[40:43], s37 offen
    s_add_u32 s37, s36, 0x40000
    buffer_load_dword v24, v15, s[40:43], s37 offen
    s_add_u32 s37, s36, 0x42000
    buffer_load_dword v25, v15, s[40:43], s37 offen
    s_add_u32 s37, s36, 0x44000
    buffer_load_dword v26, v15, s[40:43], s37 offen
    s_add_u32 s37, s36, 0x46000
    buffer_load_dword v27, v15, s[40:43], s37 offen
    s_add_u32 s37, s36, 0x48000
    buffer_load_dword v28, v15, s[40:43], s37 offen
    s_add_u32 s37, s36, 0x4a000
    buffer_load_dword v29, v15, s[40:43], s37 offen
    s_add_u32 s37, s36, 0x4c000
    buffer_load_dword v30, v15, s[40:43], s37 offen
    s_add_u32 s37, s36, 0x4e000
    buffer_load_dword v31, v15, s[40:43], s37 offen
    s_add_u32 s37, s36, 0x0
    buffer_load_dword v32, v15, s[76:79], s37 offen
    s_add_u32 s37, s36, 0x2000
    buffer_load_dword v33, v15, s[76:79], s37 offen
    s_add_u32 s37, s36, 0x4000
    buffer_load_dword v34, v15, s[76:79], s37 offen
    s_add_u32 s37, s36, 0x6000
    buffer_load_dword v35, v15, s[76:79], s37 offen
    s_add_u32 s37, s36, 0x8000
    buffer_load_dword v36, v15, s[76:79], s37 offen
    s_add_u32 s37, s36, 0xa000
    buffer_load_dword v37, v15, s[76:79], s37 offen
    s_add_u32 s37, s36, 0xc000
    buffer_load_dword v38, v15, s[76:79], s37 offen
    s_add_u32 s37, s36, 0xe000
    buffer_load_dword v39, v15, s[76:79], s37 offen
    s_add_u32 s37, s36, 0x40000
    buffer_load_dword v40, v15, s[76:79], s37 offen
    s_add_u32 s37, s36, 0x42000
    buffer_load_dword v41, v15, s[76:79], s37 offen
    s_add_u32 s37, s36, 0x44000
    buffer_load_dword v42, v15, s[76:79], s37 offen
    s_add_u32 s37, s36, 0x46000
    buffer_load_dword v43, v15, s[76:79], s37 offen
    s_add_u32 s37, s36, 0x48000
    buffer_load_dword v44, v15, s[76:79], s37 offen
    s_add_u32 s37, s36, 0x4a000
    buffer_load_dword v45, v15, s[76:79], s37 offen
    s_add_u32 s37, s36, 0x4c000
    buffer_load_dword v46, v15, s[76:79], s37 offen
    s_add_u32 s37, s36, 0x4e000
    buffer_load_dword v47, v15, s[76:79], s37 offen
    s_add_u32 s37, s36, 0x0
    buffer_load_dword v48, v15, s[96:99], s37 offen
    s_add_u32 s37, s36, 0x2000
    buffer_load_dword v49, v15, s[96:99], s37 offen
    s_add_u32 s37, s36, 0x4000
    buffer_load_dword v50, v15, s[96:99], s37 offen
    s_add_u32 s37, s36, 0x6000
    buffer_load_dword v51, v15, s[96:99], s37 offen
    s_add_u32 s37, s36, 0x8000
    buffer_load_dword v52, v15, s[96:99], s37 offen
    s_add_u32 s37, s36, 0xa000
    buffer_load_dword v53, v15, s[96:99], s37 offen
    s_add_u32 s37, s36, 0xc000
    buffer_load_dword v54, v15, s[96:99], s37 offen
    s_add_u32 s37, s36, 0xe000
    buffer_load_dword v55, v15, s[96:99], s37 offen
    s_add_u32 s37, s36, 0x40000
    buffer_load_dword v56, v15, s[96:99], s37 offen
    s_add_u32 s37, s36, 0x42000
    buffer_load_dword v57, v15, s[96:99], s37 offen
    s_add_u32 s37, s36, 0x44000
    buffer_load_dword v58, v15, s[96:99], s37 offen
    s_add_u32 s37, s36, 0x46000
    buffer_load_dword v59, v15, s[96:99], s37 offen
    s_add_u32 s37, s36, 0x48000
    buffer_load_dword v60, v15, s[96:99], s37 offen
    s_add_u32 s37, s36, 0x4a000
    buffer_load_dword v61, v15, s[96:99], s37 offen
    s_add_u32 s37, s36, 0x4c000
    buffer_load_dword v62, v15, s[96:99], s37 offen
    s_add_u32 s37, s36, 0x4e000
    buffer_load_dword v63, v15, s[96:99], s37 offen
    s_waitcnt vmcnt(32)
    s_add_u32 s37, s36, 0x80000
    buffer_load_dword v64, v15, s[40:43], s37 offen
    s_add_u32 s37, s36, 0x82000
    buffer_load_dword v65, v15, s[40:43], s37 offen
    s_add_u32 s37, s36, 0x84000
    buffer_load_dword v66, v15, s[40:43], s37 offen
    s_add_u32 s37, s36, 0x86000
    buffer_load_dword v67, v15, s[40:43], s37 offen
    s_add_u32 s37, s36, 0x88000
    buffer_load_dword v68, v15, s[40:43], s37 offen
    s_add_u32 s37, s36, 0x8a000
    buffer_load_dword v69, v15, s[40:43], s37 offen
    s_add_u32 s37, s36, 0x8c000
    buffer_load_dword v70, v15, s[40:43], s37 offen
    s_add_u32 s37, s36, 0x8e000
    buffer_load_dword v71, v15, s[40:43], s37 offen
    s_add_u32 s37, s36, 0xc0000
    buffer_load_dword v72, v15, s[40:43], s37 offen
    s_add_u32 s37, s36, 0xc2000
    buffer_load_dword v73, v15, s[40:43], s37 offen
    s_add_u32 s37, s36, 0xc4000
    buffer_load_dword v74, v15, s[40:43], s37 offen
    s_add_u32 s37, s36, 0xc6000
    buffer_load_dword v75, v15, s[40:43], s37 offen
    s_add_u32 s37, s36, 0xc8000
    buffer_load_dword v76, v15, s[40:43], s37 offen
    s_add_u32 s37, s36, 0xca000
    buffer_load_dword v77, v15, s[40:43], s37 offen
    s_add_u32 s37, s36, 0xcc000
    buffer_load_dword v78, v15, s[40:43], s37 offen
    s_add_u32 s37, s36, 0xce000
    buffer_load_dword v79, v15, s[40:43], s37 offen
    v_perm_b32 v80, v17, v16, s34
    v_accvgpr_write_b32 a128, v80
    v_perm_b32 v81, v19, v18, s34
    v_accvgpr_write_b32 a129, v81
    v_perm_b32 v82, v21, v20, s34
    v_accvgpr_write_b32 a130, v82
    v_perm_b32 v83, v23, v22, s34
    v_accvgpr_write_b32 a131, v83
    v_perm_b32 v80, v17, v16, s35
    v_accvgpr_write_b32 a132, v80
    v_perm_b32 v81, v19, v18, s35
    v_accvgpr_write_b32 a133, v81
    v_perm_b32 v82, v21, v20, s35
    v_accvgpr_write_b32 a134, v82
    v_perm_b32 v83, v23, v22, s35
    v_accvgpr_write_b32 a135, v83
    v_perm_b32 v80, v25, v24, s34
    v_accvgpr_write_b32 a136, v80
    v_perm_b32 v81, v27, v26, s34
    v_accvgpr_write_b32 a137, v81
    v_perm_b32 v82, v29, v28, s34
    v_accvgpr_write_b32 a138, v82
    v_perm_b32 v83, v31, v30, s34
    v_accvgpr_write_b32 a139, v83
    v_perm_b32 v80, v25, v24, s35
    v_accvgpr_write_b32 a140, v80
    v_perm_b32 v81, v27, v26, s35
    v_accvgpr_write_b32 a141, v81
    v_perm_b32 v82, v29, v28, s35
    v_accvgpr_write_b32 a142, v82
    v_perm_b32 v83, v31, v30, s35
    v_accvgpr_write_b32 a143, v83
    s_waitcnt vmcnt(32)
    s_add_u32 s37, s36, 0x80000
    buffer_load_dword v16, v15, s[76:79], s37 offen
    s_add_u32 s37, s36, 0x82000
    buffer_load_dword v17, v15, s[76:79], s37 offen
    s_add_u32 s37, s36, 0x84000
    buffer_load_dword v18, v15, s[76:79], s37 offen
    s_add_u32 s37, s36, 0x86000
    buffer_load_dword v19, v15, s[76:79], s37 offen
    s_add_u32 s37, s36, 0x88000
    buffer_load_dword v20, v15, s[76:79], s37 offen
    s_add_u32 s37, s36, 0x8a000
    buffer_load_dword v21, v15, s[76:79], s37 offen
    s_add_u32 s37, s36, 0x8c000
    buffer_load_dword v22, v15, s[76:79], s37 offen
    s_add_u32 s37, s36, 0x8e000
    buffer_load_dword v23, v15, s[76:79], s37 offen
    s_add_u32 s37, s36, 0xc0000
    buffer_load_dword v24, v15, s[76:79], s37 offen
    s_add_u32 s37, s36, 0xc2000
    buffer_load_dword v25, v15, s[76:79], s37 offen
    s_add_u32 s37, s36, 0xc4000
    buffer_load_dword v26, v15, s[76:79], s37 offen
    s_add_u32 s37, s36, 0xc6000
    buffer_load_dword v27, v15, s[76:79], s37 offen
    s_add_u32 s37, s36, 0xc8000
    buffer_load_dword v28, v15, s[76:79], s37 offen
    s_add_u32 s37, s36, 0xca000
    buffer_load_dword v29, v15, s[76:79], s37 offen
    s_add_u32 s37, s36, 0xcc000
    buffer_load_dword v30, v15, s[76:79], s37 offen
    s_add_u32 s37, s36, 0xce000
    buffer_load_dword v31, v15, s[76:79], s37 offen
    v_perm_b32 v128, v33, v32, s34
    v_perm_b32 v129, v35, v34, s34
    v_perm_b32 v130, v37, v36, s34
    v_perm_b32 v131, v39, v38, s34
    v_perm_b32 v132, v33, v32, s35
    v_perm_b32 v133, v35, v34, s35
    v_perm_b32 v134, v37, v36, s35
    v_perm_b32 v135, v39, v38, s35
    v_perm_b32 v136, v41, v40, s34
    v_perm_b32 v137, v43, v42, s34
    v_perm_b32 v138, v45, v44, s34
    v_perm_b32 v139, v47, v46, s34
    v_perm_b32 v140, v41, v40, s35
    v_perm_b32 v141, v43, v42, s35
    v_perm_b32 v142, v45, v44, s35
    v_perm_b32 v143, v47, v46, s35
    s_waitcnt vmcnt(32)
    s_add_u32 s37, s36, 0x80000
    buffer_load_dword v32, v15, s[96:99], s37 offen
    s_add_u32 s37, s36, 0x82000
    buffer_load_dword v33, v15, s[96:99], s37 offen
    s_add_u32 s37, s36, 0x84000
    buffer_load_dword v34, v15, s[96:99], s37 offen
    s_add_u32 s37, s36, 0x86000
    buffer_load_dword v35, v15, s[96:99], s37 offen
    s_add_u32 s37, s36, 0x88000
    buffer_load_dword v36, v15, s[96:99], s37 offen
    s_add_u32 s37, s36, 0x8a000
    buffer_load_dword v37, v15, s[96:99], s37 offen
    s_add_u32 s37, s36, 0x8c000
    buffer_load_dword v38, v15, s[96:99], s37 offen
    s_add_u32 s37, s36, 0x8e000
    buffer_load_dword v39, v15, s[96:99], s37 offen
    s_add_u32 s37, s36, 0xc0000
    buffer_load_dword v40, v15, s[96:99], s37 offen
    s_add_u32 s37, s36, 0xc2000
    buffer_load_dword v41, v15, s[96:99], s37 offen
    s_add_u32 s37, s36, 0xc4000
    buffer_load_dword v42, v15, s[96:99], s37 offen
    s_add_u32 s37, s36, 0xc6000
    buffer_load_dword v43, v15, s[96:99], s37 offen
    s_add_u32 s37, s36, 0xc8000
    buffer_load_dword v44, v15, s[96:99], s37 offen
    s_add_u32 s37, s36, 0xca000
    buffer_load_dword v45, v15, s[96:99], s37 offen
    s_add_u32 s37, s36, 0xcc000
    buffer_load_dword v46, v15, s[96:99], s37 offen
    s_add_u32 s37, s36, 0xce000
    buffer_load_dword v47, v15, s[96:99], s37 offen
    v_perm_b32 v80, v49, v48, s34
    v_accvgpr_write_b32 a0, v80
    v_perm_b32 v81, v51, v50, s34
    v_accvgpr_write_b32 a1, v81
    v_perm_b32 v82, v53, v52, s34
    v_accvgpr_write_b32 a2, v82
    v_perm_b32 v83, v55, v54, s34
    v_accvgpr_write_b32 a3, v83
    v_perm_b32 v80, v49, v48, s35
    v_accvgpr_write_b32 a4, v80
    v_perm_b32 v81, v51, v50, s35
    v_accvgpr_write_b32 a5, v81
    v_perm_b32 v82, v53, v52, s35
    v_accvgpr_write_b32 a6, v82
    v_perm_b32 v83, v55, v54, s35
    v_accvgpr_write_b32 a7, v83
    v_perm_b32 v80, v57, v56, s34
    v_accvgpr_write_b32 a8, v80
    v_perm_b32 v81, v59, v58, s34
    v_accvgpr_write_b32 a9, v81
    v_perm_b32 v82, v61, v60, s34
    v_accvgpr_write_b32 a10, v82
    v_perm_b32 v83, v63, v62, s34
    v_accvgpr_write_b32 a11, v83
    v_perm_b32 v80, v57, v56, s35
    v_accvgpr_write_b32 a12, v80
    v_perm_b32 v81, v59, v58, s35
    v_accvgpr_write_b32 a13, v81
    v_perm_b32 v82, v61, v60, s35
    v_accvgpr_write_b32 a14, v82
    v_perm_b32 v83, v63, v62, s35
    v_accvgpr_write_b32 a15, v83
    s_waitcnt vmcnt(32)
    s_add_u32 s37, s36, 0x100000
    buffer_load_dword v48, v15, s[40:43], s37 offen
    s_add_u32 s37, s36, 0x102000
    buffer_load_dword v49, v15, s[40:43], s37 offen
    s_add_u32 s37, s36, 0x104000
    buffer_load_dword v50, v15, s[40:43], s37 offen
    s_add_u32 s37, s36, 0x106000
    buffer_load_dword v51, v15, s[40:43], s37 offen
    s_add_u32 s37, s36, 0x108000
    buffer_load_dword v52, v15, s[40:43], s37 offen
    s_add_u32 s37, s36, 0x10a000
    buffer_load_dword v53, v15, s[40:43], s37 offen
    s_add_u32 s37, s36, 0x10c000
    buffer_load_dword v54, v15, s[40:43], s37 offen
    s_add_u32 s37, s36, 0x10e000
    buffer_load_dword v55, v15, s[40:43], s37 offen
    s_add_u32 s37, s36, 0x140000
    buffer_load_dword v56, v15, s[40:43], s37 offen
    s_add_u32 s37, s36, 0x142000
    buffer_load_dword v57, v15, s[40:43], s37 offen
    s_add_u32 s37, s36, 0x144000
    buffer_load_dword v58, v15, s[40:43], s37 offen
    s_add_u32 s37, s36, 0x146000
    buffer_load_dword v59, v15, s[40:43], s37 offen
    s_add_u32 s37, s36, 0x148000
    buffer_load_dword v60, v15, s[40:43], s37 offen
    s_add_u32 s37, s36, 0x14a000
    buffer_load_dword v61, v15, s[40:43], s37 offen
    s_add_u32 s37, s36, 0x14c000
    buffer_load_dword v62, v15, s[40:43], s37 offen
    s_add_u32 s37, s36, 0x14e000
    buffer_load_dword v63, v15, s[40:43], s37 offen
    v_perm_b32 v80, v65, v64, s34
    v_accvgpr_write_b32 a144, v80
    v_perm_b32 v81, v67, v66, s34
    v_accvgpr_write_b32 a145, v81
    v_perm_b32 v82, v69, v68, s34
    v_accvgpr_write_b32 a146, v82
    v_perm_b32 v83, v71, v70, s34
    v_accvgpr_write_b32 a147, v83
    v_perm_b32 v80, v65, v64, s35
    v_accvgpr_write_b32 a148, v80
    v_perm_b32 v81, v67, v66, s35
    v_accvgpr_write_b32 a149, v81
    v_perm_b32 v82, v69, v68, s35
    v_accvgpr_write_b32 a150, v82
    v_perm_b32 v83, v71, v70, s35
    v_accvgpr_write_b32 a151, v83
    v_perm_b32 v80, v73, v72, s34
    v_accvgpr_write_b32 a152, v80
    v_perm_b32 v81, v75, v74, s34
    v_accvgpr_write_b32 a153, v81
    v_perm_b32 v82, v77, v76, s34
    v_accvgpr_write_b32 a154, v82
    v_perm_b32 v83, v79, v78, s34
    v_accvgpr_write_b32 a155, v83
    v_perm_b32 v80, v73, v72, s35
    v_accvgpr_write_b32 a156, v80
    v_perm_b32 v81, v75, v74, s35
    v_accvgpr_write_b32 a157, v81
    v_perm_b32 v82, v77, v76, s35
    v_accvgpr_write_b32 a158, v82
    v_perm_b32 v83, v79, v78, s35
    v_accvgpr_write_b32 a159, v83
    s_waitcnt vmcnt(32)
    s_add_u32 s37, s36, 0x100000
    buffer_load_dword v64, v15, s[76:79], s37 offen
    s_add_u32 s37, s36, 0x102000
    buffer_load_dword v65, v15, s[76:79], s37 offen
    s_add_u32 s37, s36, 0x104000
    buffer_load_dword v66, v15, s[76:79], s37 offen
    s_add_u32 s37, s36, 0x106000
    buffer_load_dword v67, v15, s[76:79], s37 offen
    s_add_u32 s37, s36, 0x108000
    buffer_load_dword v68, v15, s[76:79], s37 offen
    s_add_u32 s37, s36, 0x10a000
    buffer_load_dword v69, v15, s[76:79], s37 offen
    s_add_u32 s37, s36, 0x10c000
    buffer_load_dword v70, v15, s[76:79], s37 offen
    s_add_u32 s37, s36, 0x10e000
    buffer_load_dword v71, v15, s[76:79], s37 offen
    s_add_u32 s37, s36, 0x140000
    buffer_load_dword v72, v15, s[76:79], s37 offen
    s_add_u32 s37, s36, 0x142000
    buffer_load_dword v73, v15, s[76:79], s37 offen
    s_add_u32 s37, s36, 0x144000
    buffer_load_dword v74, v15, s[76:79], s37 offen
    s_add_u32 s37, s36, 0x146000
    buffer_load_dword v75, v15, s[76:79], s37 offen
    s_add_u32 s37, s36, 0x148000
    buffer_load_dword v76, v15, s[76:79], s37 offen
    s_add_u32 s37, s36, 0x14a000
    buffer_load_dword v77, v15, s[76:79], s37 offen
    s_add_u32 s37, s36, 0x14c000
    buffer_load_dword v78, v15, s[76:79], s37 offen
    s_add_u32 s37, s36, 0x14e000
    buffer_load_dword v79, v15, s[76:79], s37 offen
    v_perm_b32 v144, v17, v16, s34
    v_perm_b32 v145, v19, v18, s34
    v_perm_b32 v146, v21, v20, s34
    v_perm_b32 v147, v23, v22, s34
    v_perm_b32 v148, v17, v16, s35
    v_perm_b32 v149, v19, v18, s35
    v_perm_b32 v150, v21, v20, s35
    v_perm_b32 v151, v23, v22, s35
    v_perm_b32 v152, v25, v24, s34
    v_perm_b32 v153, v27, v26, s34
    v_perm_b32 v154, v29, v28, s34
    v_perm_b32 v155, v31, v30, s34
    v_perm_b32 v156, v25, v24, s35
    v_perm_b32 v157, v27, v26, s35
    v_perm_b32 v158, v29, v28, s35
    v_perm_b32 v159, v31, v30, s35
    s_waitcnt vmcnt(32)
    s_add_u32 s37, s36, 0x100000
    buffer_load_dword v16, v15, s[96:99], s37 offen
    s_add_u32 s37, s36, 0x102000
    buffer_load_dword v17, v15, s[96:99], s37 offen
    s_add_u32 s37, s36, 0x104000
    buffer_load_dword v18, v15, s[96:99], s37 offen
    s_add_u32 s37, s36, 0x106000
    buffer_load_dword v19, v15, s[96:99], s37 offen
    s_add_u32 s37, s36, 0x108000
    buffer_load_dword v20, v15, s[96:99], s37 offen
    s_add_u32 s37, s36, 0x10a000
    buffer_load_dword v21, v15, s[96:99], s37 offen
    s_add_u32 s37, s36, 0x10c000
    buffer_load_dword v22, v15, s[96:99], s37 offen
    s_add_u32 s37, s36, 0x10e000
    buffer_load_dword v23, v15, s[96:99], s37 offen
    s_add_u32 s37, s36, 0x140000
    buffer_load_dword v24, v15, s[96:99], s37 offen
    s_add_u32 s37, s36, 0x142000
    buffer_load_dword v25, v15, s[96:99], s37 offen
    s_add_u32 s37, s36, 0x144000
    buffer_load_dword v26, v15, s[96:99], s37 offen
    s_add_u32 s37, s36, 0x146000
    buffer_load_dword v27, v15, s[96:99], s37 offen
    s_add_u32 s37, s36, 0x148000
    buffer_load_dword v28, v15, s[96:99], s37 offen
    s_add_u32 s37, s36, 0x14a000
    buffer_load_dword v29, v15, s[96:99], s37 offen
    s_add_u32 s37, s36, 0x14c000
    buffer_load_dword v30, v15, s[96:99], s37 offen
    s_add_u32 s37, s36, 0x14e000
    buffer_load_dword v31, v15, s[96:99], s37 offen
    v_perm_b32 v80, v33, v32, s34
    v_accvgpr_write_b32 a16, v80
    v_perm_b32 v81, v35, v34, s34
    v_accvgpr_write_b32 a17, v81
    v_perm_b32 v82, v37, v36, s34
    v_accvgpr_write_b32 a18, v82
    v_perm_b32 v83, v39, v38, s34
    v_accvgpr_write_b32 a19, v83
    v_perm_b32 v80, v33, v32, s35
    v_accvgpr_write_b32 a20, v80
    v_perm_b32 v81, v35, v34, s35
    v_accvgpr_write_b32 a21, v81
    v_perm_b32 v82, v37, v36, s35
    v_accvgpr_write_b32 a22, v82
    v_perm_b32 v83, v39, v38, s35
    v_accvgpr_write_b32 a23, v83
    v_perm_b32 v80, v41, v40, s34
    v_accvgpr_write_b32 a24, v80
    v_perm_b32 v81, v43, v42, s34
    v_accvgpr_write_b32 a25, v81
    v_perm_b32 v82, v45, v44, s34
    v_accvgpr_write_b32 a26, v82
    v_perm_b32 v83, v47, v46, s34
    v_accvgpr_write_b32 a27, v83
    v_perm_b32 v80, v41, v40, s35
    v_accvgpr_write_b32 a28, v80
    v_perm_b32 v81, v43, v42, s35
    v_accvgpr_write_b32 a29, v81
    v_perm_b32 v82, v45, v44, s35
    v_accvgpr_write_b32 a30, v82
    v_perm_b32 v83, v47, v46, s35
    v_accvgpr_write_b32 a31, v83
    s_waitcnt vmcnt(32)
    s_add_u32 s37, s36, 0x180000
    buffer_load_dword v32, v15, s[40:43], s37 offen
    s_add_u32 s37, s36, 0x182000
    buffer_load_dword v33, v15, s[40:43], s37 offen
    s_add_u32 s37, s36, 0x184000
    buffer_load_dword v34, v15, s[40:43], s37 offen
    s_add_u32 s37, s36, 0x186000
    buffer_load_dword v35, v15, s[40:43], s37 offen
    s_add_u32 s37, s36, 0x188000
    buffer_load_dword v36, v15, s[40:43], s37 offen
    s_add_u32 s37, s36, 0x18a000
    buffer_load_dword v37, v15, s[40:43], s37 offen
    s_add_u32 s37, s36, 0x18c000
    buffer_load_dword v38, v15, s[40:43], s37 offen
    s_add_u32 s37, s36, 0x18e000
    buffer_load_dword v39, v15, s[40:43], s37 offen
    s_add_u32 s37, s36, 0x1c0000
    buffer_load_dword v40, v15, s[40:43], s37 offen
    s_add_u32 s37, s36, 0x1c2000
    buffer_load_dword v41, v15, s[40:43], s37 offen
    s_add_u32 s37, s36, 0x1c4000
    buffer_load_dword v42, v15, s[40:43], s37 offen
    s_add_u32 s37, s36, 0x1c6000
    buffer_load_dword v43, v15, s[40:43], s37 offen
    s_add_u32 s37, s36, 0x1c8000
    buffer_load_dword v44, v15, s[40:43], s37 offen
    s_add_u32 s37, s36, 0x1ca000
    buffer_load_dword v45, v15, s[40:43], s37 offen
    s_add_u32 s37, s36, 0x1cc000
    buffer_load_dword v46, v15, s[40:43], s37 offen
    s_add_u32 s37, s36, 0x1ce000
    buffer_load_dword v47, v15, s[40:43], s37 offen
    v_perm_b32 v80, v49, v48, s34
    v_accvgpr_write_b32 a160, v80
    v_perm_b32 v81, v51, v50, s34
    v_accvgpr_write_b32 a161, v81
    v_perm_b32 v82, v53, v52, s34
    v_accvgpr_write_b32 a162, v82
    v_perm_b32 v83, v55, v54, s34
    v_accvgpr_write_b32 a163, v83
    v_perm_b32 v80, v49, v48, s35
    v_accvgpr_write_b32 a164, v80
    v_perm_b32 v81, v51, v50, s35
    v_accvgpr_write_b32 a165, v81
    v_perm_b32 v82, v53, v52, s35
    v_accvgpr_write_b32 a166, v82
    v_perm_b32 v83, v55, v54, s35
    v_accvgpr_write_b32 a167, v83
    v_perm_b32 v80, v57, v56, s34
    v_accvgpr_write_b32 a168, v80
    v_perm_b32 v81, v59, v58, s34
    v_accvgpr_write_b32 a169, v81
    v_perm_b32 v82, v61, v60, s34
    v_accvgpr_write_b32 a170, v82
    v_perm_b32 v83, v63, v62, s34
    v_accvgpr_write_b32 a171, v83
    v_perm_b32 v80, v57, v56, s35
    v_accvgpr_write_b32 a172, v80
    v_perm_b32 v81, v59, v58, s35
    v_accvgpr_write_b32 a173, v81
    v_perm_b32 v82, v61, v60, s35
    v_accvgpr_write_b32 a174, v82
    v_perm_b32 v83, v63, v62, s35
    v_accvgpr_write_b32 a175, v83
    s_waitcnt vmcnt(32)
    s_add_u32 s37, s36, 0x180000
    buffer_load_dword v48, v15, s[76:79], s37 offen
    s_add_u32 s37, s36, 0x182000
    buffer_load_dword v49, v15, s[76:79], s37 offen
    s_add_u32 s37, s36, 0x184000
    buffer_load_dword v50, v15, s[76:79], s37 offen
    s_add_u32 s37, s36, 0x186000
    buffer_load_dword v51, v15, s[76:79], s37 offen
    s_add_u32 s37, s36, 0x188000
    buffer_load_dword v52, v15, s[76:79], s37 offen
    s_add_u32 s37, s36, 0x18a000
    buffer_load_dword v53, v15, s[76:79], s37 offen
    s_add_u32 s37, s36, 0x18c000
    buffer_load_dword v54, v15, s[76:79], s37 offen
    s_add_u32 s37, s36, 0x18e000
    buffer_load_dword v55, v15, s[76:79], s37 offen
    s_add_u32 s37, s36, 0x1c0000
    buffer_load_dword v56, v15, s[76:79], s37 offen
    s_add_u32 s37, s36, 0x1c2000
    buffer_load_dword v57, v15, s[76:79], s37 offen
    s_add_u32 s37, s36, 0x1c4000
    buffer_load_dword v58, v15, s[76:79], s37 offen
    s_add_u32 s37, s36, 0x1c6000
    buffer_load_dword v59, v15, s[76:79], s37 offen
    s_add_u32 s37, s36, 0x1c8000
    buffer_load_dword v60, v15, s[76:79], s37 offen
    s_add_u32 s37, s36, 0x1ca000
    buffer_load_dword v61, v15, s[76:79], s37 offen
    s_add_u32 s37, s36, 0x1cc000
    buffer_load_dword v62, v15, s[76:79], s37 offen
    s_add_u32 s37, s36, 0x1ce000
    buffer_load_dword v63, v15, s[76:79], s37 offen
    v_perm_b32 v160, v65, v64, s34
    v_perm_b32 v161, v67, v66, s34
    v_perm_b32 v162, v69, v68, s34
    v_perm_b32 v163, v71, v70, s34
    v_perm_b32 v164, v65, v64, s35
    v_perm_b32 v165, v67, v66, s35
    v_perm_b32 v166, v69, v68, s35
    v_perm_b32 v167, v71, v70, s35
    v_perm_b32 v168, v73, v72, s34
    v_perm_b32 v169, v75, v74, s34
    v_perm_b32 v170, v77, v76, s34
    v_perm_b32 v171, v79, v78, s34
    v_perm_b32 v172, v73, v72, s35
    v_perm_b32 v173, v75, v74, s35
    v_perm_b32 v174, v77, v76, s35
    v_perm_b32 v175, v79, v78, s35
    s_waitcnt vmcnt(32)
    s_add_u32 s37, s36, 0x180000
    buffer_load_dword v64, v15, s[96:99], s37 offen
    s_add_u32 s37, s36, 0x182000
    buffer_load_dword v65, v15, s[96:99], s37 offen
    s_add_u32 s37, s36, 0x184000
    buffer_load_dword v66, v15, s[96:99], s37 offen
    s_add_u32 s37, s36, 0x186000
    buffer_load_dword v67, v15, s[96:99], s37 offen
    s_add_u32 s37, s36, 0x188000
    buffer_load_dword v68, v15, s[96:99], s37 offen
    s_add_u32 s37, s36, 0x18a000
    buffer_load_dword v69, v15, s[96:99], s37 offen
    s_add_u32 s37, s36, 0x18c000
    buffer_load_dword v70, v15, s[96:99], s37 offen
    s_add_u32 s37, s36, 0x18e000
    buffer_load_dword v71, v15, s[96:99], s37 offen
    s_add_u32 s37, s36, 0x1c0000
    buffer_load_dword v72, v15, s[96:99], s37 offen
    s_add_u32 s37, s36, 0x1c2000
    buffer_load_dword v73, v15, s[96:99], s37 offen
    s_add_u32 s37, s36, 0x1c4000
    buffer_load_dword v74, v15, s[96:99], s37 offen
    s_add_u32 s37, s36, 0x1c6000
    buffer_load_dword v75, v15, s[96:99], s37 offen
    s_add_u32 s37, s36, 0x1c8000
    buffer_load_dword v76, v15, s[96:99], s37 offen
    s_add_u32 s37, s36, 0x1ca000
    buffer_load_dword v77, v15, s[96:99], s37 offen
    s_add_u32 s37, s36, 0x1cc000
    buffer_load_dword v78, v15, s[96:99], s37 offen
    s_add_u32 s37, s36, 0x1ce000
    buffer_load_dword v79, v15, s[96:99], s37 offen
    v_perm_b32 v80, v17, v16, s34
    v_accvgpr_write_b32 a32, v80
    v_perm_b32 v81, v19, v18, s34
    v_accvgpr_write_b32 a33, v81
    v_perm_b32 v82, v21, v20, s34
    v_accvgpr_write_b32 a34, v82
    v_perm_b32 v83, v23, v22, s34
    v_accvgpr_write_b32 a35, v83
    v_perm_b32 v80, v17, v16, s35
    v_accvgpr_write_b32 a36, v80
    v_perm_b32 v81, v19, v18, s35
    v_accvgpr_write_b32 a37, v81
    v_perm_b32 v82, v21, v20, s35
    v_accvgpr_write_b32 a38, v82
    v_perm_b32 v83, v23, v22, s35
    v_accvgpr_write_b32 a39, v83
    v_perm_b32 v80, v25, v24, s34
    v_accvgpr_write_b32 a40, v80
    v_perm_b32 v81, v27, v26, s34
    v_accvgpr_write_b32 a41, v81
    v_perm_b32 v82, v29, v28, s34
    v_accvgpr_write_b32 a42, v82
    v_perm_b32 v83, v31, v30, s34
    v_accvgpr_write_b32 a43, v83
    v_perm_b32 v80, v25, v24, s35
    v_accvgpr_write_b32 a44, v80
    v_perm_b32 v81, v27, v26, s35
    v_accvgpr_write_b32 a45, v81
    v_perm_b32 v82, v29, v28, s35
    v_accvgpr_write_b32 a46, v82
    v_perm_b32 v83, v31, v30, s35
    v_accvgpr_write_b32 a47, v83
    s_waitcnt vmcnt(32)
    s_add_u32 s37, s36, 0x200000
    buffer_load_dword v16, v15, s[40:43], s37 offen
    s_add_u32 s37, s36, 0x202000
    buffer_load_dword v17, v15, s[40:43], s37 offen
    s_add_u32 s37, s36, 0x204000
    buffer_load_dword v18, v15, s[40:43], s37 offen
    s_add_u32 s37, s36, 0x206000
    buffer_load_dword v19, v15, s[40:43], s37 offen
    s_add_u32 s37, s36, 0x208000
    buffer_load_dword v20, v15, s[40:43], s37 offen
    s_add_u32 s37, s36, 0x20a000
    buffer_load_dword v21, v15, s[40:43], s37 offen
    s_add_u32 s37, s36, 0x20c000
    buffer_load_dword v22, v15, s[40:43], s37 offen
    s_add_u32 s37, s36, 0x20e000
    buffer_load_dword v23, v15, s[40:43], s37 offen
    s_add_u32 s37, s36, 0x240000
    buffer_load_dword v24, v15, s[40:43], s37 offen
    s_add_u32 s37, s36, 0x242000
    buffer_load_dword v25, v15, s[40:43], s37 offen
    s_add_u32 s37, s36, 0x244000
    buffer_load_dword v26, v15, s[40:43], s37 offen
    s_add_u32 s37, s36, 0x246000
    buffer_load_dword v27, v15, s[40:43], s37 offen
    s_add_u32 s37, s36, 0x248000
    buffer_load_dword v28, v15, s[40:43], s37 offen
    s_add_u32 s37, s36, 0x24a000
    buffer_load_dword v29, v15, s[40:43], s37 offen
    s_add_u32 s37, s36, 0x24c000
    buffer_load_dword v30, v15, s[40:43], s37 offen
    s_add_u32 s37, s36, 0x24e000
    buffer_load_dword v31, v15, s[40:43], s37 offen
    v_perm_b32 v80, v33, v32, s34
    v_accvgpr_write_b32 a176, v80
    v_perm_b32 v81, v35, v34, s34
    v_accvgpr_write_b32 a177, v81
    v_perm_b32 v82, v37, v36, s34
    v_accvgpr_write_b32 a178, v82
    v_perm_b32 v83, v39, v38, s34
    v_accvgpr_write_b32 a179, v83
    v_perm_b32 v80, v33, v32, s35
    v_accvgpr_write_b32 a180, v80
    v_perm_b32 v81, v35, v34, s35
    v_accvgpr_write_b32 a181, v81
    v_perm_b32 v82, v37, v36, s35
    v_accvgpr_write_b32 a182, v82
    v_perm_b32 v83, v39, v38, s35
    v_accvgpr_write_b32 a183, v83
    v_perm_b32 v80, v41, v40, s34
    v_accvgpr_write_b32 a184, v80
    v_perm_b32 v81, v43, v42, s34
    v_accvgpr_write_b32 a185, v81
    v_perm_b32 v82, v45, v44, s34
    v_accvgpr_write_b32 a186, v82
    v_perm_b32 v83, v47, v46, s34
    v_accvgpr_write_b32 a187, v83
    v_perm_b32 v80, v41, v40, s35
    v_accvgpr_write_b32 a188, v80
    v_perm_b32 v81, v43, v42, s35
    v_accvgpr_write_b32 a189, v81
    v_perm_b32 v82, v45, v44, s35
    v_accvgpr_write_b32 a190, v82
    v_perm_b32 v83, v47, v46, s35
    v_accvgpr_write_b32 a191, v83
    s_waitcnt vmcnt(32)
    s_add_u32 s37, s36, 0x200000
    buffer_load_dword v32, v15, s[76:79], s37 offen
    s_add_u32 s37, s36, 0x202000
    buffer_load_dword v33, v15, s[76:79], s37 offen
    s_add_u32 s37, s36, 0x204000
    buffer_load_dword v34, v15, s[76:79], s37 offen
    s_add_u32 s37, s36, 0x206000
    buffer_load_dword v35, v15, s[76:79], s37 offen
    s_add_u32 s37, s36, 0x208000
    buffer_load_dword v36, v15, s[76:79], s37 offen
    s_add_u32 s37, s36, 0x20a000
    buffer_load_dword v37, v15, s[76:79], s37 offen
    s_add_u32 s37, s36, 0x20c000
    buffer_load_dword v38, v15, s[76:79], s37 offen
    s_add_u32 s37, s36, 0x20e000
    buffer_load_dword v39, v15, s[76:79], s37 offen
    s_add_u32 s37, s36, 0x240000
    buffer_load_dword v40, v15, s[76:79], s37 offen
    s_add_u32 s37, s36, 0x242000
    buffer_load_dword v41, v15, s[76:79], s37 offen
    s_add_u32 s37, s36, 0x244000
    buffer_load_dword v42, v15, s[76:79], s37 offen
    s_add_u32 s37, s36, 0x246000
    buffer_load_dword v43, v15, s[76:79], s37 offen
    s_add_u32 s37, s36, 0x248000
    buffer_load_dword v44, v15, s[76:79], s37 offen
    s_add_u32 s37, s36, 0x24a000
    buffer_load_dword v45, v15, s[76:79], s37 offen
    s_add_u32 s37, s36, 0x24c000
    buffer_load_dword v46, v15, s[76:79], s37 offen
    s_add_u32 s37, s36, 0x24e000
    buffer_load_dword v47, v15, s[76:79], s37 offen
    v_perm_b32 v176, v49, v48, s34
    v_perm_b32 v177, v51, v50, s34
    v_perm_b32 v178, v53, v52, s34
    v_perm_b32 v179, v55, v54, s34
    v_perm_b32 v180, v49, v48, s35
    v_perm_b32 v181, v51, v50, s35
    v_perm_b32 v182, v53, v52, s35
    v_perm_b32 v183, v55, v54, s35
    v_perm_b32 v184, v57, v56, s34
    v_perm_b32 v185, v59, v58, s34
    v_perm_b32 v186, v61, v60, s34
    v_perm_b32 v187, v63, v62, s34
    v_perm_b32 v188, v57, v56, s35
    v_perm_b32 v189, v59, v58, s35
    v_perm_b32 v190, v61, v60, s35
    v_perm_b32 v191, v63, v62, s35
    s_waitcnt vmcnt(32)
    s_add_u32 s37, s36, 0x200000
    buffer_load_dword v48, v15, s[96:99], s37 offen
    s_add_u32 s37, s36, 0x202000
    buffer_load_dword v49, v15, s[96:99], s37 offen
    s_add_u32 s37, s36, 0x204000
    buffer_load_dword v50, v15, s[96:99], s37 offen
    s_add_u32 s37, s36, 0x206000
    buffer_load_dword v51, v15, s[96:99], s37 offen
    s_add_u32 s37, s36, 0x208000
    buffer_load_dword v52, v15, s[96:99], s37 offen
    s_add_u32 s37, s36, 0x20a000
    buffer_load_dword v53, v15, s[96:99], s37 offen
    s_add_u32 s37, s36, 0x20c000
    buffer_load_dword v54, v15, s[96:99], s37 offen
    s_add_u32 s37, s36, 0x20e000
    buffer_load_dword v55, v15, s[96:99], s37 offen
    s_add_u32 s37, s36, 0x240000
    buffer_load_dword v56, v15, s[96:99], s37 offen
    s_add_u32 s37, s36, 0x242000
    buffer_load_dword v57, v15, s[96:99], s37 offen
    s_add_u32 s37, s36, 0x244000
    buffer_load_dword v58, v15, s[96:99], s37 offen
    s_add_u32 s37, s36, 0x246000
    buffer_load_dword v59, v15, s[96:99], s37 offen
    s_add_u32 s37, s36, 0x248000
    buffer_load_dword v60, v15, s[96:99], s37 offen
    s_add_u32 s37, s36, 0x24a000
    buffer_load_dword v61, v15, s[96:99], s37 offen
    s_add_u32 s37, s36, 0x24c000
    buffer_load_dword v62, v15, s[96:99], s37 offen
    s_add_u32 s37, s36, 0x24e000
    buffer_load_dword v63, v15, s[96:99], s37 offen
    v_perm_b32 v80, v65, v64, s34
    v_accvgpr_write_b32 a48, v80
    v_perm_b32 v81, v67, v66, s34
    v_accvgpr_write_b32 a49, v81
    v_perm_b32 v82, v69, v68, s34
    v_accvgpr_write_b32 a50, v82
    v_perm_b32 v83, v71, v70, s34
    v_accvgpr_write_b32 a51, v83
    v_perm_b32 v80, v65, v64, s35
    v_accvgpr_write_b32 a52, v80
    v_perm_b32 v81, v67, v66, s35
    v_accvgpr_write_b32 a53, v81
    v_perm_b32 v82, v69, v68, s35
    v_accvgpr_write_b32 a54, v82
    v_perm_b32 v83, v71, v70, s35
    v_accvgpr_write_b32 a55, v83
    v_perm_b32 v80, v73, v72, s34
    v_accvgpr_write_b32 a56, v80
    v_perm_b32 v81, v75, v74, s34
    v_accvgpr_write_b32 a57, v81
    v_perm_b32 v82, v77, v76, s34
    v_accvgpr_write_b32 a58, v82
    v_perm_b32 v83, v79, v78, s34
    v_accvgpr_write_b32 a59, v83
    v_perm_b32 v80, v73, v72, s35
    v_accvgpr_write_b32 a60, v80
    v_perm_b32 v81, v75, v74, s35
    v_accvgpr_write_b32 a61, v81
    v_perm_b32 v82, v77, v76, s35
    v_accvgpr_write_b32 a62, v82
    v_perm_b32 v83, v79, v78, s35
    v_accvgpr_write_b32 a63, v83
    s_waitcnt vmcnt(32)
    s_add_u32 s37, s36, 0x280000
    buffer_load_dword v64, v15, s[40:43], s37 offen
    s_add_u32 s37, s36, 0x282000
    buffer_load_dword v65, v15, s[40:43], s37 offen
    s_add_u32 s37, s36, 0x284000
    buffer_load_dword v66, v15, s[40:43], s37 offen
    s_add_u32 s37, s36, 0x286000
    buffer_load_dword v67, v15, s[40:43], s37 offen
    s_add_u32 s37, s36, 0x288000
    buffer_load_dword v68, v15, s[40:43], s37 offen
    s_add_u32 s37, s36, 0x28a000
    buffer_load_dword v69, v15, s[40:43], s37 offen
    s_add_u32 s37, s36, 0x28c000
    buffer_load_dword v70, v15, s[40:43], s37 offen
    s_add_u32 s37, s36, 0x28e000
    buffer_load_dword v71, v15, s[40:43], s37 offen
    s_add_u32 s37, s36, 0x2c0000
    buffer_load_dword v72, v15, s[40:43], s37 offen
    s_add_u32 s37, s36, 0x2c2000
    buffer_load_dword v73, v15, s[40:43], s37 offen
    s_add_u32 s37, s36, 0x2c4000
    buffer_load_dword v74, v15, s[40:43], s37 offen
    s_add_u32 s37, s36, 0x2c6000
    buffer_load_dword v75, v15, s[40:43], s37 offen
    s_add_u32 s37, s36, 0x2c8000
    buffer_load_dword v76, v15, s[40:43], s37 offen
    s_add_u32 s37, s36, 0x2ca000
    buffer_load_dword v77, v15, s[40:43], s37 offen
    s_add_u32 s37, s36, 0x2cc000
    buffer_load_dword v78, v15, s[40:43], s37 offen
    s_add_u32 s37, s36, 0x2ce000
    buffer_load_dword v79, v15, s[40:43], s37 offen
    v_perm_b32 v80, v17, v16, s34
    v_accvgpr_write_b32 a192, v80
    v_perm_b32 v81, v19, v18, s34
    v_accvgpr_write_b32 a193, v81
    v_perm_b32 v82, v21, v20, s34
    v_accvgpr_write_b32 a194, v82
    v_perm_b32 v83, v23, v22, s34
    v_accvgpr_write_b32 a195, v83
    v_perm_b32 v80, v17, v16, s35
    v_accvgpr_write_b32 a196, v80
    v_perm_b32 v81, v19, v18, s35
    v_accvgpr_write_b32 a197, v81
    v_perm_b32 v82, v21, v20, s35
    v_accvgpr_write_b32 a198, v82
    v_perm_b32 v83, v23, v22, s35
    v_accvgpr_write_b32 a199, v83
    v_perm_b32 v80, v25, v24, s34
    v_accvgpr_write_b32 a200, v80
    v_perm_b32 v81, v27, v26, s34
    v_accvgpr_write_b32 a201, v81
    v_perm_b32 v82, v29, v28, s34
    v_accvgpr_write_b32 a202, v82
    v_perm_b32 v83, v31, v30, s34
    v_accvgpr_write_b32 a203, v83
    v_perm_b32 v80, v25, v24, s35
    v_accvgpr_write_b32 a204, v80
    v_perm_b32 v81, v27, v26, s35
    v_accvgpr_write_b32 a205, v81
    v_perm_b32 v82, v29, v28, s35
    v_accvgpr_write_b32 a206, v82
    v_perm_b32 v83, v31, v30, s35
    v_accvgpr_write_b32 a207, v83
    s_waitcnt vmcnt(32)
    s_add_u32 s37, s36, 0x280000
    buffer_load_dword v16, v15, s[76:79], s37 offen
    s_add_u32 s37, s36, 0x282000
    buffer_load_dword v17, v15, s[76:79], s37 offen
    s_add_u32 s37, s36, 0x284000
    buffer_load_dword v18, v15, s[76:79], s37 offen
    s_add_u32 s37, s36, 0x286000
    buffer_load_dword v19, v15, s[76:79], s37 offen
    s_add_u32 s37, s36, 0x288000
    buffer_load_dword v20, v15, s[76:79], s37 offen
    s_add_u32 s37, s36, 0x28a000
    buffer_load_dword v21, v15, s[76:79], s37 offen
    s_add_u32 s37, s36, 0x28c000
    buffer_load_dword v22, v15, s[76:79], s37 offen
    s_add_u32 s37, s36, 0x28e000
    buffer_load_dword v23, v15, s[76:79], s37 offen
    s_add_u32 s37, s36, 0x2c0000
    buffer_load_dword v24, v15, s[76:79], s37 offen
    s_add_u32 s37, s36, 0x2c2000
    buffer_load_dword v25, v15, s[76:79], s37 offen
    s_add_u32 s37, s36, 0x2c4000
    buffer_load_dword v26, v15, s[76:79], s37 offen
    s_add_u32 s37, s36, 0x2c6000
    buffer_load_dword v27, v15, s[76:79], s37 offen
    s_add_u32 s37, s36, 0x2c8000
    buffer_load_dword v28, v15, s[76:79], s37 offen
    s_add_u32 s37, s36, 0x2ca000
    buffer_load_dword v29, v15, s[76:79], s37 offen
    s_add_u32 s37, s36, 0x2cc000
    buffer_load_dword v30, v15, s[76:79], s37 offen
    s_add_u32 s37, s36, 0x2ce000
    buffer_load_dword v31, v15, s[76:79], s37 offen
    v_perm_b32 v192, v33, v32, s34
    v_perm_b32 v193, v35, v34, s34
    v_perm_b32 v194, v37, v36, s34
    v_perm_b32 v195, v39, v38, s34
    v_perm_b32 v196, v33, v32, s35
    v_perm_b32 v197, v35, v34, s35
    v_perm_b32 v198, v37, v36, s35
    v_perm_b32 v199, v39, v38, s35
    v_perm_b32 v200, v41, v40, s34
    v_perm_b32 v201, v43, v42, s34
    v_perm_b32 v202, v45, v44, s34
    v_perm_b32 v203, v47, v46, s34
    v_perm_b32 v204, v41, v40, s35
    v_perm_b32 v205, v43, v42, s35
    v_perm_b32 v206, v45, v44, s35
    v_perm_b32 v207, v47, v46, s35
    s_waitcnt vmcnt(32)
    s_add_u32 s37, s36, 0x280000
    buffer_load_dword v32, v15, s[96:99], s37 offen
    s_add_u32 s37, s36, 0x282000
    buffer_load_dword v33, v15, s[96:99], s37 offen
    s_add_u32 s37, s36, 0x284000
    buffer_load_dword v34, v15, s[96:99], s37 offen
    s_add_u32 s37, s36, 0x286000
    buffer_load_dword v35, v15, s[96:99], s37 offen
    s_add_u32 s37, s36, 0x288000
    buffer_load_dword v36, v15, s[96:99], s37 offen
    s_add_u32 s37, s36, 0x28a000
    buffer_load_dword v37, v15, s[96:99], s37 offen
    s_add_u32 s37, s36, 0x28c000
    buffer_load_dword v38, v15, s[96:99], s37 offen
    s_add_u32 s37, s36, 0x28e000
    buffer_load_dword v39, v15, s[96:99], s37 offen
    s_add_u32 s37, s36, 0x2c0000
    buffer_load_dword v40, v15, s[96:99], s37 offen
    s_add_u32 s37, s36, 0x2c2000
    buffer_load_dword v41, v15, s[96:99], s37 offen
    s_add_u32 s37, s36, 0x2c4000
    buffer_load_dword v42, v15, s[96:99], s37 offen
    s_add_u32 s37, s36, 0x2c6000
    buffer_load_dword v43, v15, s[96:99], s37 offen
    s_add_u32 s37, s36, 0x2c8000
    buffer_load_dword v44, v15, s[96:99], s37 offen
    s_add_u32 s37, s36, 0x2ca000
    buffer_load_dword v45, v15, s[96:99], s37 offen
    s_add_u32 s37, s36, 0x2cc000
    buffer_load_dword v46, v15, s[96:99], s37 offen
    s_add_u32 s37, s36, 0x2ce000
    buffer_load_dword v47, v15, s[96:99], s37 offen
    v_perm_b32 v80, v49, v48, s34
    v_accvgpr_write_b32 a64, v80
    v_perm_b32 v81, v51, v50, s34
    v_accvgpr_write_b32 a65, v81
    v_perm_b32 v82, v53, v52, s34
    v_accvgpr_write_b32 a66, v82
    v_perm_b32 v83, v55, v54, s34
    v_accvgpr_write_b32 a67, v83
    v_perm_b32 v80, v49, v48, s35
    v_accvgpr_write_b32 a68, v80
    v_perm_b32 v81, v51, v50, s35
    v_accvgpr_write_b32 a69, v81
    v_perm_b32 v82, v53, v52, s35
    v_accvgpr_write_b32 a70, v82
    v_perm_b32 v83, v55, v54, s35
    v_accvgpr_write_b32 a71, v83
    v_perm_b32 v80, v57, v56, s34
    v_accvgpr_write_b32 a72, v80
    v_perm_b32 v81, v59, v58, s34
    v_accvgpr_write_b32 a73, v81
    v_perm_b32 v82, v61, v60, s34
    v_accvgpr_write_b32 a74, v82
    v_perm_b32 v83, v63, v62, s34
    v_accvgpr_write_b32 a75, v83
    v_perm_b32 v80, v57, v56, s35
    v_accvgpr_write_b32 a76, v80
    v_perm_b32 v81, v59, v58, s35
    v_accvgpr_write_b32 a77, v81
    v_perm_b32 v82, v61, v60, s35
    v_accvgpr_write_b32 a78, v82
    v_perm_b32 v83, v63, v62, s35
    v_accvgpr_write_b32 a79, v83
    s_waitcnt vmcnt(32)
    s_add_u32 s37, s36, 0x300000
    buffer_load_dword v48, v15, s[40:43], s37 offen
    s_add_u32 s37, s36, 0x302000
    buffer_load_dword v49, v15, s[40:43], s37 offen
    s_add_u32 s37, s36, 0x304000
    buffer_load_dword v50, v15, s[40:43], s37 offen
    s_add_u32 s37, s36, 0x306000
    buffer_load_dword v51, v15, s[40:43], s37 offen
    s_add_u32 s37, s36, 0x308000
    buffer_load_dword v52, v15, s[40:43], s37 offen
    s_add_u32 s37, s36, 0x30a000
    buffer_load_dword v53, v15, s[40:43], s37 offen
    s_add_u32 s37, s36, 0x30c000
    buffer_load_dword v54, v15, s[40:43], s37 offen
    s_add_u32 s37, s36, 0x30e000
    buffer_load_dword v55, v15, s[40:43], s37 offen
    s_add_u32 s37, s36, 0x340000
    buffer_load_dword v56, v15, s[40:43], s37 offen
    s_add_u32 s37, s36, 0x342000
    buffer_load_dword v57, v15, s[40:43], s37 offen
    s_add_u32 s37, s36, 0x344000
    buffer_load_dword v58, v15, s[40:43], s37 offen
    s_add_u32 s37, s36, 0x346000
    buffer_load_dword v59, v15, s[40:43], s37 offen
    s_add_u32 s37, s36, 0x348000
    buffer_load_dword v60, v15, s[40:43], s37 offen
    s_add_u32 s37, s36, 0x34a000
    buffer_load_dword v61, v15, s[40:43], s37 offen
    s_add_u32 s37, s36, 0x34c000
    buffer_load_dword v62, v15, s[40:43], s37 offen
    s_add_u32 s37, s36, 0x34e000
    buffer_load_dword v63, v15, s[40:43], s37 offen
    v_perm_b32 v80, v65, v64, s34
    v_accvgpr_write_b32 a208, v80
    v_perm_b32 v81, v67, v66, s34
    v_accvgpr_write_b32 a209, v81
    v_perm_b32 v82, v69, v68, s34
    v_accvgpr_write_b32 a210, v82
    v_perm_b32 v83, v71, v70, s34
    v_accvgpr_write_b32 a211, v83
    v_perm_b32 v80, v65, v64, s35
    v_accvgpr_write_b32 a212, v80
    v_perm_b32 v81, v67, v66, s35
    v_accvgpr_write_b32 a213, v81
    v_perm_b32 v82, v69, v68, s35
    v_accvgpr_write_b32 a214, v82
    v_perm_b32 v83, v71, v70, s35
    v_accvgpr_write_b32 a215, v83
    v_perm_b32 v80, v73, v72, s34
    v_accvgpr_write_b32 a216, v80
    v_perm_b32 v81, v75, v74, s34
    v_accvgpr_write_b32 a217, v81
    v_perm_b32 v82, v77, v76, s34
    v_accvgpr_write_b32 a218, v82
    v_perm_b32 v83, v79, v78, s34
    v_accvgpr_write_b32 a219, v83
    v_perm_b32 v80, v73, v72, s35
    v_accvgpr_write_b32 a220, v80
    v_perm_b32 v81, v75, v74, s35
    v_accvgpr_write_b32 a221, v81
    v_perm_b32 v82, v77, v76, s35
    v_accvgpr_write_b32 a222, v82
    v_perm_b32 v83, v79, v78, s35
    v_accvgpr_write_b32 a223, v83
    s_waitcnt vmcnt(32)
    s_add_u32 s37, s36, 0x300000
    buffer_load_dword v64, v15, s[76:79], s37 offen
    s_add_u32 s37, s36, 0x302000
    buffer_load_dword v65, v15, s[76:79], s37 offen
    s_add_u32 s37, s36, 0x304000
    buffer_load_dword v66, v15, s[76:79], s37 offen
    s_add_u32 s37, s36, 0x306000
    buffer_load_dword v67, v15, s[76:79], s37 offen
    s_add_u32 s37, s36, 0x308000
    buffer_load_dword v68, v15, s[76:79], s37 offen
    s_add_u32 s37, s36, 0x30a000
    buffer_load_dword v69, v15, s[76:79], s37 offen
    s_add_u32 s37, s36, 0x30c000
    buffer_load_dword v70, v15, s[76:79], s37 offen
    s_add_u32 s37, s36, 0x30e000
    buffer_load_dword v71, v15, s[76:79], s37 offen
    s_add_u32 s37, s36, 0x340000
    buffer_load_dword v72, v15, s[76:79], s37 offen
    s_add_u32 s37, s36, 0x342000
    buffer_load_dword v73, v15, s[76:79], s37 offen
    s_add_u32 s37, s36, 0x344000
    buffer_load_dword v74, v15, s[76:79], s37 offen
    s_add_u32 s37, s36, 0x346000
    buffer_load_dword v75, v15, s[76:79], s37 offen
    s_add_u32 s37, s36, 0x348000
    buffer_load_dword v76, v15, s[76:79], s37 offen
    s_add_u32 s37, s36, 0x34a000
    buffer_load_dword v77, v15, s[76:79], s37 offen
    s_add_u32 s37, s36, 0x34c000
    buffer_load_dword v78, v15, s[76:79], s37 offen
    s_add_u32 s37, s36, 0x34e000
    buffer_load_dword v79, v15, s[76:79], s37 offen
    v_perm_b32 v208, v17, v16, s34
    v_perm_b32 v209, v19, v18, s34
    v_perm_b32 v210, v21, v20, s34
    v_perm_b32 v211, v23, v22, s34
    v_perm_b32 v212, v17, v16, s35
    v_perm_b32 v213, v19, v18, s35
    v_perm_b32 v214, v21, v20, s35
    v_perm_b32 v215, v23, v22, s35
    v_perm_b32 v216, v25, v24, s34
    v_perm_b32 v217, v27, v26, s34
    v_perm_b32 v218, v29, v28, s34
    v_perm_b32 v219, v31, v30, s34
    v_perm_b32 v220, v25, v24, s35
    v_perm_b32 v221, v27, v26, s35
    v_perm_b32 v222, v29, v28, s35
    v_perm_b32 v223, v31, v30, s35
    s_waitcnt vmcnt(32)
    s_add_u32 s37, s36, 0x300000
    buffer_load_dword v16, v15, s[96:99], s37 offen
    s_add_u32 s37, s36, 0x302000
    buffer_load_dword v17, v15, s[96:99], s37 offen
    s_add_u32 s37, s36, 0x304000
    buffer_load_dword v18, v15, s[96:99], s37 offen
    s_add_u32 s37, s36, 0x306000
    buffer_load_dword v19, v15, s[96:99], s37 offen
    s_add_u32 s37, s36, 0x308000
    buffer_load_dword v20, v15, s[96:99], s37 offen
    s_add_u32 s37, s36, 0x30a000
    buffer_load_dword v21, v15, s[96:99], s37 offen
    s_add_u32 s37, s36, 0x30c000
    buffer_load_dword v22, v15, s[96:99], s37 offen
    s_add_u32 s37, s36, 0x30e000
    buffer_load_dword v23, v15, s[96:99], s37 offen
    s_add_u32 s37, s36, 0x340000
    buffer_load_dword v24, v15, s[96:99], s37 offen
    s_add_u32 s37, s36, 0x342000
    buffer_load_dword v25, v15, s[96:99], s37 offen
    s_add_u32 s37, s36, 0x344000
    buffer_load_dword v26, v15, s[96:99], s37 offen
    s_add_u32 s37, s36, 0x346000
    buffer_load_dword v27, v15, s[96:99], s37 offen
    s_add_u32 s37, s36, 0x348000
    buffer_load_dword v28, v15, s[96:99], s37 offen
    s_add_u32 s37, s36, 0x34a000
    buffer_load_dword v29, v15, s[96:99], s37 offen
    s_add_u32 s37, s36, 0x34c000
    buffer_load_dword v30, v15, s[96:99], s37 offen
    s_add_u32 s37, s36, 0x34e000
    buffer_load_dword v31, v15, s[96:99], s37 offen
    v_perm_b32 v80, v33, v32, s34
    v_accvgpr_write_b32 a80, v80
    v_perm_b32 v81, v35, v34, s34
    v_accvgpr_write_b32 a81, v81
    v_perm_b32 v82, v37, v36, s34
    v_accvgpr_write_b32 a82, v82
    v_perm_b32 v83, v39, v38, s34
    v_accvgpr_write_b32 a83, v83
    v_perm_b32 v80, v33, v32, s35
    v_accvgpr_write_b32 a84, v80
    v_perm_b32 v81, v35, v34, s35
    v_accvgpr_write_b32 a85, v81
    v_perm_b32 v82, v37, v36, s35
    v_accvgpr_write_b32 a86, v82
    v_perm_b32 v83, v39, v38, s35
    v_accvgpr_write_b32 a87, v83
    v_perm_b32 v80, v41, v40, s34
    v_accvgpr_write_b32 a88, v80
    v_perm_b32 v81, v43, v42, s34
    v_accvgpr_write_b32 a89, v81
    v_perm_b32 v82, v45, v44, s34
    v_accvgpr_write_b32 a90, v82
    v_perm_b32 v83, v47, v46, s34
    v_accvgpr_write_b32 a91, v83
    v_perm_b32 v80, v41, v40, s35
    v_accvgpr_write_b32 a92, v80
    v_perm_b32 v81, v43, v42, s35
    v_accvgpr_write_b32 a93, v81
    v_perm_b32 v82, v45, v44, s35
    v_accvgpr_write_b32 a94, v82
    v_perm_b32 v83, v47, v46, s35
    v_accvgpr_write_b32 a95, v83
    s_waitcnt vmcnt(32)
    s_add_u32 s37, s36, 0x380000
    buffer_load_dword v32, v15, s[40:43], s37 offen
    s_add_u32 s37, s36, 0x382000
    buffer_load_dword v33, v15, s[40:43], s37 offen
    s_add_u32 s37, s36, 0x384000
    buffer_load_dword v34, v15, s[40:43], s37 offen
    s_add_u32 s37, s36, 0x386000
    buffer_load_dword v35, v15, s[40:43], s37 offen
    s_add_u32 s37, s36, 0x388000
    buffer_load_dword v36, v15, s[40:43], s37 offen
    s_add_u32 s37, s36, 0x38a000
    buffer_load_dword v37, v15, s[40:43], s37 offen
    s_add_u32 s37, s36, 0x38c000
    buffer_load_dword v38, v15, s[40:43], s37 offen
    s_add_u32 s37, s36, 0x38e000
    buffer_load_dword v39, v15, s[40:43], s37 offen
    s_add_u32 s37, s36, 0x3c0000
    buffer_load_dword v40, v15, s[40:43], s37 offen
    s_add_u32 s37, s36, 0x3c2000
    buffer_load_dword v41, v15, s[40:43], s37 offen
    s_add_u32 s37, s36, 0x3c4000
    buffer_load_dword v42, v15, s[40:43], s37 offen
    s_add_u32 s37, s36, 0x3c6000
    buffer_load_dword v43, v15, s[40:43], s37 offen
    s_add_u32 s37, s36, 0x3c8000
    buffer_load_dword v44, v15, s[40:43], s37 offen
    s_add_u32 s37, s36, 0x3ca000
    buffer_load_dword v45, v15, s[40:43], s37 offen
    s_add_u32 s37, s36, 0x3cc000
    buffer_load_dword v46, v15, s[40:43], s37 offen
    s_add_u32 s37, s36, 0x3ce000
    buffer_load_dword v47, v15, s[40:43], s37 offen
    v_perm_b32 v80, v49, v48, s34
    v_accvgpr_write_b32 a224, v80
    v_perm_b32 v81, v51, v50, s34
    v_accvgpr_write_b32 a225, v81
    v_perm_b32 v82, v53, v52, s34
    v_accvgpr_write_b32 a226, v82
    v_perm_b32 v83, v55, v54, s34
    v_accvgpr_write_b32 a227, v83
    v_perm_b32 v80, v49, v48, s35
    v_accvgpr_write_b32 a228, v80
    v_perm_b32 v81, v51, v50, s35
    v_accvgpr_write_b32 a229, v81
    v_perm_b32 v82, v53, v52, s35
    v_accvgpr_write_b32 a230, v82
    v_perm_b32 v83, v55, v54, s35
    v_accvgpr_write_b32 a231, v83
    v_perm_b32 v80, v57, v56, s34
    v_accvgpr_write_b32 a232, v80
    v_perm_b32 v81, v59, v58, s34
    v_accvgpr_write_b32 a233, v81
    v_perm_b32 v82, v61, v60, s34
    v_accvgpr_write_b32 a234, v82
    v_perm_b32 v83, v63, v62, s34
    v_accvgpr_write_b32 a235, v83
    v_perm_b32 v80, v57, v56, s35
    v_accvgpr_write_b32 a236, v80
    v_perm_b32 v81, v59, v58, s35
    v_accvgpr_write_b32 a237, v81
    v_perm_b32 v82, v61, v60, s35
    v_accvgpr_write_b32 a238, v82
    v_perm_b32 v83, v63, v62, s35
    v_accvgpr_write_b32 a239, v83
    s_waitcnt vmcnt(32)
    s_add_u32 s37, s36, 0x380000
    buffer_load_dword v48, v15, s[76:79], s37 offen
    s_add_u32 s37, s36, 0x382000
    buffer_load_dword v49, v15, s[76:79], s37 offen
    s_add_u32 s37, s36, 0x384000
    buffer_load_dword v50, v15, s[76:79], s37 offen
    s_add_u32 s37, s36, 0x386000
    buffer_load_dword v51, v15, s[76:79], s37 offen
    s_add_u32 s37, s36, 0x388000
    buffer_load_dword v52, v15, s[76:79], s37 offen
    s_add_u32 s37, s36, 0x38a000
    buffer_load_dword v53, v15, s[76:79], s37 offen
    s_add_u32 s37, s36, 0x38c000
    buffer_load_dword v54, v15, s[76:79], s37 offen
    s_add_u32 s37, s36, 0x38e000
    buffer_load_dword v55, v15, s[76:79], s37 offen
    s_add_u32 s37, s36, 0x3c0000
    buffer_load_dword v56, v15, s[76:79], s37 offen
    s_add_u32 s37, s36, 0x3c2000
    buffer_load_dword v57, v15, s[76:79], s37 offen
    s_add_u32 s37, s36, 0x3c4000
    buffer_load_dword v58, v15, s[76:79], s37 offen
    s_add_u32 s37, s36, 0x3c6000
    buffer_load_dword v59, v15, s[76:79], s37 offen
    s_add_u32 s37, s36, 0x3c8000
    buffer_load_dword v60, v15, s[76:79], s37 offen
    s_add_u32 s37, s36, 0x3ca000
    buffer_load_dword v61, v15, s[76:79], s37 offen
    s_add_u32 s37, s36, 0x3cc000
    buffer_load_dword v62, v15, s[76:79], s37 offen
    s_add_u32 s37, s36, 0x3ce000
    buffer_load_dword v63, v15, s[76:79], s37 offen
    v_perm_b32 v224, v65, v64, s34
    v_perm_b32 v225, v67, v66, s34
    v_perm_b32 v226, v69, v68, s34
    v_perm_b32 v227, v71, v70, s34
    v_perm_b32 v228, v65, v64, s35
    v_perm_b32 v229, v67, v66, s35
    v_perm_b32 v230, v69, v68, s35
    v_perm_b32 v231, v71, v70, s35
    v_perm_b32 v232, v73, v72, s34
    v_perm_b32 v233, v75, v74, s34
    v_perm_b32 v234, v77, v76, s34
    v_perm_b32 v235, v79, v78, s34
    v_perm_b32 v236, v73, v72, s35
    v_perm_b32 v237, v75, v74, s35
    v_perm_b32 v238, v77, v76, s35
    v_perm_b32 v239, v79, v78, s35
    s_waitcnt vmcnt(32)
    s_add_u32 s37, s36, 0x380000
    buffer_load_dword v64, v15, s[96:99], s37 offen
    s_add_u32 s37, s36, 0x382000
    buffer_load_dword v65, v15, s[96:99], s37 offen
    s_add_u32 s37, s36, 0x384000
    buffer_load_dword v66, v15, s[96:99], s37 offen
    s_add_u32 s37, s36, 0x386000
    buffer_load_dword v67, v15, s[96:99], s37 offen
    s_add_u32 s37, s36, 0x388000
    buffer_load_dword v68, v15, s[96:99], s37 offen
    s_add_u32 s37, s36, 0x38a000
    buffer_load_dword v69, v15, s[96:99], s37 offen
    s_add_u32 s37, s36, 0x38c000
    buffer_load_dword v70, v15, s[96:99], s37 offen
    s_add_u32 s37, s36, 0x38e000
    buffer_load_dword v71, v15, s[96:99], s37 offen
    s_add_u32 s37, s36, 0x3c0000
    buffer_load_dword v72, v15, s[96:99], s37 offen
    s_add_u32 s37, s36, 0x3c2000
    buffer_load_dword v73, v15, s[96:99], s37 offen
    s_add_u32 s37, s36, 0x3c4000
    buffer_load_dword v74, v15, s[96:99], s37 offen
    s_add_u32 s37, s36, 0x3c6000
    buffer_load_dword v75, v15, s[96:99], s37 offen
    s_add_u32 s37, s36, 0x3c8000
    buffer_load_dword v76, v15, s[96:99], s37 offen
    s_add_u32 s37, s36, 0x3ca000
    buffer_load_dword v77, v15, s[96:99], s37 offen
    s_add_u32 s37, s36, 0x3cc000
    buffer_load_dword v78, v15, s[96:99], s37 offen
    s_add_u32 s37, s36, 0x3ce000
    buffer_load_dword v79, v15, s[96:99], s37 offen
    v_perm_b32 v80, v17, v16, s34
    v_accvgpr_write_b32 a96, v80
    v_perm_b32 v81, v19, v18, s34
    v_accvgpr_write_b32 a97, v81
    v_perm_b32 v82, v21, v20, s34
    v_accvgpr_write_b32 a98, v82
    v_perm_b32 v83, v23, v22, s34
    v_accvgpr_write_b32 a99, v83
    v_perm_b32 v80, v17, v16, s35
    v_accvgpr_write_b32 a100, v80
    v_perm_b32 v81, v19, v18, s35
    v_accvgpr_write_b32 a101, v81
    v_perm_b32 v82, v21, v20, s35
    v_accvgpr_write_b32 a102, v82
    v_perm_b32 v83, v23, v22, s35
    v_accvgpr_write_b32 a103, v83
    v_perm_b32 v80, v25, v24, s34
    v_accvgpr_write_b32 a104, v80
    v_perm_b32 v81, v27, v26, s34
    v_accvgpr_write_b32 a105, v81
    v_perm_b32 v82, v29, v28, s34
    v_accvgpr_write_b32 a106, v82
    v_perm_b32 v83, v31, v30, s34
    v_accvgpr_write_b32 a107, v83
    v_perm_b32 v80, v25, v24, s35
    v_accvgpr_write_b32 a108, v80
    v_perm_b32 v81, v27, v26, s35
    v_accvgpr_write_b32 a109, v81
    v_perm_b32 v82, v29, v28, s35
    v_accvgpr_write_b32 a110, v82
    v_perm_b32 v83, v31, v30, s35
    v_accvgpr_write_b32 a111, v83
    s_waitcnt vmcnt(32)
    v_perm_b32 v80, v33, v32, s34
    v_accvgpr_write_b32 a240, v80
    v_perm_b32 v81, v35, v34, s34
    v_accvgpr_write_b32 a241, v81
    v_perm_b32 v82, v37, v36, s34
    v_accvgpr_write_b32 a242, v82
    v_perm_b32 v83, v39, v38, s34
    v_accvgpr_write_b32 a243, v83
    v_perm_b32 v80, v33, v32, s35
    v_accvgpr_write_b32 a244, v80
    v_perm_b32 v81, v35, v34, s35
    v_accvgpr_write_b32 a245, v81
    v_perm_b32 v82, v37, v36, s35
    v_accvgpr_write_b32 a246, v82
    v_perm_b32 v83, v39, v38, s35
    v_accvgpr_write_b32 a247, v83
    v_perm_b32 v80, v41, v40, s34
    v_accvgpr_write_b32 a248, v80
    v_perm_b32 v81, v43, v42, s34
    v_accvgpr_write_b32 a249, v81
    v_perm_b32 v82, v45, v44, s34
    v_accvgpr_write_b32 a250, v82
    v_perm_b32 v83, v47, v46, s34
    v_accvgpr_write_b32 a251, v83
    v_perm_b32 v80, v41, v40, s35
    v_accvgpr_write_b32 a252, v80
    v_perm_b32 v81, v43, v42, s35
    v_accvgpr_write_b32 a253, v81
    v_perm_b32 v82, v45, v44, s35
    v_accvgpr_write_b32 a254, v82
    v_perm_b32 v83, v47, v46, s35
    v_accvgpr_write_b32 a255, v83
    s_waitcnt vmcnt(16)
    v_perm_b32 v240, v49, v48, s34
    v_perm_b32 v241, v51, v50, s34
    v_perm_b32 v242, v53, v52, s34
    v_perm_b32 v243, v55, v54, s34
    v_perm_b32 v244, v49, v48, s35
    v_perm_b32 v245, v51, v50, s35
    v_perm_b32 v246, v53, v52, s35
    v_perm_b32 v247, v55, v54, s35
    v_perm_b32 v248, v57, v56, s34
    v_perm_b32 v249, v59, v58, s34
    v_perm_b32 v250, v61, v60, s34
    v_perm_b32 v251, v63, v62, s34
    v_perm_b32 v252, v57, v56, s35
    v_perm_b32 v253, v59, v58, s35
    v_perm_b32 v254, v61, v60, s35
    v_perm_b32 v255, v63, v62, s35
    s_waitcnt vmcnt(0)
    v_perm_b32 v80, v65, v64, s34
    v_accvgpr_write_b32 a112, v80
    v_perm_b32 v81, v67, v66, s34
    v_accvgpr_write_b32 a113, v81
    v_perm_b32 v82, v69, v68, s34
    v_accvgpr_write_b32 a114, v82
    v_perm_b32 v83, v71, v70, s34
    v_accvgpr_write_b32 a115, v83
    v_perm_b32 v80, v65, v64, s35
    v_accvgpr_write_b32 a116, v80
    v_perm_b32 v81, v67, v66, s35
    v_accvgpr_write_b32 a117, v81
    v_perm_b32 v82, v69, v68, s35
    v_accvgpr_write_b32 a118, v82
    v_perm_b32 v83, v71, v70, s35
    v_accvgpr_write_b32 a119, v83
    v_perm_b32 v80, v73, v72, s34
    v_accvgpr_write_b32 a120, v80
    v_perm_b32 v81, v75, v74, s34
    v_accvgpr_write_b32 a121, v81
    v_perm_b32 v82, v77, v76, s34
    v_accvgpr_write_b32 a122, v82
    v_perm_b32 v83, v79, v78, s34
    v_accvgpr_write_b32 a123, v83
    v_perm_b32 v80, v73, v72, s35
    v_accvgpr_write_b32 a124, v80
    v_perm_b32 v81, v75, v74, s35
    v_accvgpr_write_b32 a125, v81
    v_perm_b32 v82, v77, v76, s35
    v_accvgpr_write_b32 a126, v82
    v_perm_b32 v83, v79, v78, s35
    v_accvgpr_write_b32 a127, v83
    v_lshrrev_b32 v15, 2, v1
    v_and_b32 v15, 127, v15
L_WHS:
    buffer_load_dword v14, v15, s[16:19], 0 offen sc1
    s_add_u32 s32, s32, 1
    s_cmp_gt_u32 s32, 200000
    s_cbranch_scc1 L_WHS_done
    s_waitcnt vmcnt(0)
    v_cmp_eq_u32 vcc, 0, v14
    s_cbranch_vccnz L_WHS
L_WHS_done:
    s_lshr_b32 s36, s21, 1
    s_lshl_b32 s36, s36, 14
    s_xor_b32 s37, s36, 16384
    v_add_u32 v80, s36, v5
    v_add_u32 v81, s37, v5
    v_add_u32 v82, s36, v6
    v_add_u32 v83, s37, v6
    s_mov_b32 s25, 0x40000000
L_P1:
    s_waitcnt vmcnt(6)
    v_mov_b32 v16, 0
    v_mov_b32 v17, 0
    v_dot2_f32_bf16 v16, v96, s4, v16
    v_dot2_f32_bf16 v17, v96, v96, v17
    v_dot2_f32_bf16 v16, v97, s4, v16
    v_dot2_f32_bf16 v17, v97, v97, v17
    v_dot2_f32_bf16 v16, v98, s4, v16
    v_dot2_f32_bf16 v17, v98, v98, v17
    v_dot2_f32_bf16 v16, v99, s4, v16
    v_dot2_f32_bf16 v17, v99, v99, v17
    v_dot2_f32_bf16 v16, v100, s4, v16
    v_dot2_f32_bf16 v17, v100, v100, v17
    v_dot2_f32_bf16 v16, v101, s4, v16
    v_dot2_f32_bf16 v17, v101, v101, v17
    v_dot2_f32_bf16 v16, v102, s4, v16
    v_dot2_f32_bf16 v17, v102, v102, v17
    v_dot2_f32_bf16 v16, v103, s4, v16
    v_dot2_f32_bf16 v17, v103, v103, v17
    v_dot2_f32_bf16 v16, v104, s4, v16
    v_dot2_f32_bf16 v17, v104, v104, v17
    v_dot2_f32_bf16 v16, v105, s4, v16
    v_dot2_f32_bf16 v17, v105, v105, v17
    v_dot2_f32_bf16 v16, v106, s4, v16
    v_dot2_f32_bf16 v17, v106, v106, v17
    v_dot2_f32_bf16 v16, v107, s4, v16
    v_dot2_f32_bf16 v17, v107, v107, v17
    v_dot2_f32_bf16 v16, v108, s4, v16
    v_dot2_f32_bf16 v17, v108, v108, v17
    v_dot2_f32_bf16 v16, v109, s4, v16
    v_dot2_f32_bf16 v17, v109, v109, v17
    v_dot2_f32_bf16 v16, v110, s4, v16
    v_dot2_f32_bf16 v17, v110, v110, v17
    v_dot2_f32_bf16 v16, v111, s4, v16
    v_dot2_f32_bf16 v17, v111, v111, v17
    v_dot2_f32_bf16 v16, v112, s4, v16
    v_dot2_f32_bf16 v17, v112, v112, v17
    v_dot2_f32_bf16 v16, v113, s4, v16
    v_dot2_f32_bf16 v17, v113, v113, v17
    v_dot2_f32_bf16 v16, v114, s4, v16
    v_dot2_f32_bf16 v17, v114, v114, v17
    v_dot2_f32_bf16 v16, v115, s4, v16
    v_dot2_f32_bf16 v17, v115, v115, v17
    v_dot2_f32_bf16 v16, v116, s4, v16
    v_dot2_f32_bf16 v17, v116, v116, v17
    v_dot2_f32_bf16 v16, v117, s4, v16
    v_dot2_f32_bf16 v17, v117, v117, v17
    v_dot2_f32_bf16 v16, v118, s4, v16
    v_dot2_f32_bf16 v17, v118, v118, v17
    v_dot2_f32_bf16 v16, v119, s4, v16
    v_dot2_f32_bf16 v17, v119, v119, v17
    v_dot2_f32_bf16 v16, v120, s4, v16
    v_dot2_f32_bf16 v17, v120, v120, v17
    v_dot2_f32_bf16 v16, v121, s4, v16
    v_dot2_f32_bf16 v17, v121, v121, v17
    v_dot2_f32_bf16 v16, v122, s4, v16
    v_dot2_f32_bf16 v17, v122, v122, v17
    v_dot2_f32_bf16 v16, v123, s4, v16
    v_dot2_f32_bf16 v17, v123, v123, v17
    v_dot2_f32_bf16 v16, v124, s4, v16
    v_dot2_f32_bf16 v17, v124, v124, v17
    v_dot2_f32_bf16 v16, v125, s4, v16
    v_dot2_f32_bf16 v17, v125, v125, v17
    v_dot2_f32_bf16 v16, v126, s4, v16
    v_dot2_f32_bf16 v17, v126, v126, v17
    v_dot2_f32_bf16 v16, v127, s4, v16
    v_dot2_f32_bf16 v17, v127, v127, v17
    s_nop 3
    v_add_f32_dpp v16, v16, v16 quad_perm:[1,0,3,2] row_mask:0xf bank_mask:0xf
    v_add_f32_dpp v17, v17, v17 quad_perm:[1,0,3,2] row_mask:0xf bank_mask:0xf
    s_nop 0
    v_add_f32_dpp v16, v16, v16 quad_perm:[2,3,0,1] row_mask:0xf bank_mask:0xf
    v_add_f32_dpp v17, v17, v17 quad_perm:[2,3,0,1] row_mask:0xf bank_mask:0xf
    s_nop 0
    v_add_f32_dpp v16, v16, v16 row_half_mirror row_mask:0xf bank_mask:0xf
    v_add_f32_dpp v17, v17, v17 row_half_mirror row_mask:0xf bank_mask:0xf
    v_mul_f32 v16, 0x3b000000, v16
    v_mul_f32 v17, 0x3b000000, v17
    v_fma_f32 v17, -v16, v16, v17
    v_max_f32 v17, 0, v17
    v_cvt_pk_bf16_f32 v14, v16, v17
    v_lshlrev_b32 v16, 16, v14
    v_and_b32 v17, 0xffff0000, v14
    v_add_f32 v17, 0x3727c5ac, v17
    v_cvt_pk_bf16_f32 v14, v17, v17
    v_lshlrev_b32 v17, 16, v14
    v_sqrt_f32 v17, v17
    s_nop 0
    v_cvt_pk_bf16_f32 v14, v17, v17
    v_lshlrev_b32 v17, 16, v14
    v_rcp_f32 v17, v17
    v_lshlrev_b32 v18, 16, v96
    v_and_b32 v19, 0xffff0000, v96
    v_sub_f32 v18, v18, v16
    v_sub_f32 v19, v19, v16
    v_cvt_pk_bf16_f32 v96, v18, v19
    v_lshlrev_b32 v18, 16, v96
    v_and_b32 v19, 0xffff0000, v96
    v_mul_f32 v18, v18, v17
    v_mul_f32 v19, v19, v17
    v_cvt_pk_bf16_f32 v96, v18, v19
    v_lshlrev_b32 v18, 16, v97
    v_and_b32 v19, 0xffff0000, v97
    v_sub_f32 v18, v18, v16
    v_sub_f32 v19, v19, v16
    v_cvt_pk_bf16_f32 v97, v18, v19
    v_lshlrev_b32 v18, 16, v97
    v_and_b32 v19, 0xffff0000, v97
    v_mul_f32 v18, v18, v17
    v_mul_f32 v19, v19, v17
    v_cvt_pk_bf16_f32 v97, v18, v19
    v_lshlrev_b32 v18, 16, v98
    v_and_b32 v19, 0xffff0000, v98
    v_sub_f32 v18, v18, v16
    v_sub_f32 v19, v19, v16
    v_cvt_pk_bf16_f32 v98, v18, v19
    v_lshlrev_b32 v18, 16, v98
    v_and_b32 v19, 0xffff0000, v98
    v_mul_f32 v18, v18, v17
    v_mul_f32 v19, v19, v17
    v_cvt_pk_bf16_f32 v98, v18, v19
    v_lshlrev_b32 v18, 16, v99
    v_and_b32 v19, 0xffff0000, v99
    v_sub_f32 v18, v18, v16
    v_sub_f32 v19, v19, v16
    v_cvt_pk_bf16_f32 v99, v18, v19
    v_lshlrev_b32 v18, 16, v99
    v_and_b32 v19, 0xffff0000, v99
    v_mul_f32 v18, v18, v17
    v_mul_f32 v19, v19, v17
    v_cvt_pk_bf16_f32 v99, v18, v19
    ds_write_b128 v4, v[96:99] offset:0
    v_lshlrev_b32 v18, 16, v100
    v_and_b32 v19, 0xffff0000, v100
    v_sub_f32 v18, v18, v16
    v_sub_f32 v19, v19, v16
    v_cvt_pk_bf16_f32 v100, v18, v19
    v_lshlrev_b32 v18, 16, v100
    v_and_b32 v19, 0xffff0000, v100
    v_mul_f32 v18, v18, v17
    v_mul_f32 v19, v19, v17
    v_cvt_pk_bf16_f32 v100, v18, v19
    v_lshlrev_b32 v18, 16, v101
    v_and_b32 v19, 0xffff0000, v101
    v_sub_f32 v18, v18, v16
    v_sub_f32 v19, v19, v16
    v_cvt_pk_bf16_f32 v101, v18, v19
    v_lshlrev_b32 v18, 16, v101
    v_and_b32 v19, 0xffff0000, v101
    v_mul_f32 v18, v18, v17
    v_mul_f32 v19, v19, v17
    v_cvt_pk_bf16_f32 v101, v18, v19
    v_lshlrev_b32 v18, 16, v102
    v_and_b32 v19, 0xffff0000, v102
    v_sub_f32 v18, v18, v16
    v_sub_f32 v19, v19, v16
    v_cvt_pk_bf16_f32 v102, v18, v19
    v_lshlrev_b32 v18, 16, v102
    v_and_b32 v19, 0xffff0000, v102
    v_mul_f32 v18, v18, v17
    v_mul_f32 v19, v19, v17
    v_cvt_pk_bf16_f32 v102, v18, v19
    v_lshlrev_b32 v18, 16, v103
    v_and_b32 v19, 0xffff0000, v103
    v_sub_f32 v18, v18, v16
    v_sub_f32 v19, v19, v16
    v_cvt_pk_bf16_f32 v103, v18, v19
    v_lshlrev_b32 v18, 16, v103
    v_and_b32 v19, 0xffff0000, v103
    v_mul_f32 v18, v18, v17
    v_mul_f32 v19, v19, v17
    v_cvt_pk_bf16_f32 v103, v18, v19
    ds_write_b128 v4, v[100:103] offset:2048
    v_lshlrev_b32 v18, 16, v104
    v_and_b32 v19, 0xffff0000, v104
    v_sub_f32 v18, v18, v16
    v_sub_f32 v19, v19, v16
    v_cvt_pk_bf16_f32 v104, v18, v19
    v_lshlrev_b32 v18, 16, v104
    v_and_b32 v19, 0xffff0000, v104
    v_mul_f32 v18, v18, v17
    v_mul_f32 v19, v19, v17
    v_cvt_pk_bf16_f32 v104, v18, v19
    v_lshlrev_b32 v18, 16, v105
    v_and_b32 v19, 0xffff0000, v105
    v_sub_f32 v18, v18, v16
    v_sub_f32 v19, v19, v16
    v_cvt_pk_bf16_f32 v105, v18, v19
    v_lshlrev_b32 v18, 16, v105
    v_and_b32 v19, 0xffff0000, v105
    v_mul_f32 v18, v18, v17
    v_mul_f32 v19, v19, v17
    v_cvt_pk_bf16_f32 v105, v18, v19
    v_lshlrev_b32 v18, 16, v106
    v_and_b32 v19, 0xffff0000, v106
    v_sub_f32 v18, v18, v16
    v_sub_f32 v19, v19, v16
    v_cvt_pk_bf16_f32 v106, v18, v19
    v_lshlrev_b32 v18, 16, v106
    v_and_b32 v19, 0xffff0000, v106
    v_mul_f32 v18, v18, v17
    v_mul_f32 v19, v19, v17
    v_cvt_pk_bf16_f32 v106, v18, v19
    v_lshlrev_b32 v18, 16, v107
    v_and_b32 v19, 0xffff0000, v107
    v_sub_f32 v18, v18, v16
    v_sub_f32 v19, v19, v16
    v_cvt_pk_bf16_f32 v107, v18, v19
    v_lshlrev_b32 v18, 16, v107
    v_and_b32 v19, 0xffff0000, v107
    v_mul_f32 v18, v18, v17
    v_mul_f32 v19, v19, v17
    v_cvt_pk_bf16_f32 v107, v18, v19
    ds_write_b128 v4, v[104:107] offset:4096
    v_lshlrev_b32 v18, 16, v108
    v_and_b32 v19, 0xffff0000, v108
    v_sub_f32 v18, v18, v16
    v_sub_f32 v19, v19, v16
    v_cvt_pk_bf16_f32 v108, v18, v19
    v_lshlrev_b32 v18, 16, v108
    v_and_b32 v19, 0xffff0000, v108
    v_mul_f32 v18, v18, v17
    v_mul_f32 v19, v19, v17
    v_cvt_pk_bf16_f32 v108, v18, v19
    v_lshlrev_b32 v18, 16, v109
    v_and_b32 v19, 0xffff0000, v109
    v_sub_f32 v18, v18, v16
    v_sub_f32 v19, v19, v16
    v_cvt_pk_bf16_f32 v109, v18, v19
    v_lshlrev_b32 v18, 16, v109
    v_and_b32 v19, 0xffff0000, v109
    v_mul_f32 v18, v18, v17
    v_mul_f32 v19, v19, v17
    v_cvt_pk_bf16_f32 v109, v18, v19
    v_lshlrev_b32 v18, 16, v110
    v_and_b32 v19, 0xffff0000, v110
    v_sub_f32 v18, v18, v16
    v_sub_f32 v19, v19, v16
    v_cvt_pk_bf16_f32 v110, v18, v19
    v_lshlrev_b32 v18, 16, v110
    v_and_b32 v19, 0xffff0000, v110
    v_mul_f32 v18, v18, v17
    v_mul_f32 v19, v19, v17
    v_cvt_pk_bf16_f32 v110, v18, v19
    v_lshlrev_b32 v18, 16, v111
    v_and_b32 v19, 0xffff0000, v111
    v_sub_f32 v18, v18, v16
    v_sub_f32 v19, v19, v16
    v_cvt_pk_bf16_f32 v111, v18, v19
    v_lshlrev_b32 v18, 16, v111
    v_and_b32 v19, 0xffff0000, v111
    v_mul_f32 v18, v18, v17
    v_mul_f32 v19, v19, v17
    v_cvt_pk_bf16_f32 v111, v18, v19
    ds_write_b128 v4, v[108:111] offset:6144
    v_lshlrev_b32 v18, 16, v112
    v_and_b32 v19, 0xffff0000, v112
    v_sub_f32 v18, v18, v16
    v_sub_f32 v19, v19, v16
    v_cvt_pk_bf16_f32 v112, v18, v19
    v_lshlrev_b32 v18, 16, v112
    v_and_b32 v19, 0xffff0000, v112
    v_mul_f32 v18, v18, v17
    v_mul_f32 v19, v19, v17
    v_cvt_pk_bf16_f32 v112, v18, v19
    v_lshlrev_b32 v18, 16, v113
    v_and_b32 v19, 0xffff0000, v113
    v_sub_f32 v18, v18, v16
    v_sub_f32 v19, v19, v16
    v_cvt_pk_bf16_f32 v113, v18, v19
    v_lshlrev_b32 v18, 16, v113
    v_and_b32 v19, 0xffff0000, v113
    v_mul_f32 v18, v18, v17
    v_mul_f32 v19, v19, v17
    v_cvt_pk_bf16_f32 v113, v18, v19
    v_lshlrev_b32 v18, 16, v114
    v_and_b32 v19, 0xffff0000, v114
    v_sub_f32 v18, v18, v16
    v_sub_f32 v19, v19, v16
    v_cvt_pk_bf16_f32 v114, v18, v19
    v_lshlrev_b32 v18, 16, v114
    v_and_b32 v19, 0xffff0000, v114
    v_mul_f32 v18, v18, v17
    v_mul_f32 v19, v19, v17
    v_cvt_pk_bf16_f32 v114, v18, v19
    v_lshlrev_b32 v18, 16, v115
    v_and_b32 v19, 0xffff0000, v115
    v_sub_f32 v18, v18, v16
    v_sub_f32 v19, v19, v16
    v_cvt_pk_bf16_f32 v115, v18, v19
    v_lshlrev_b32 v18, 16, v115
    v_and_b32 v19, 0xffff0000, v115
    v_mul_f32 v18, v18, v17
    v_mul_f32 v19, v19, v17
    v_cvt_pk_bf16_f32 v115, v18, v19
    ds_write_b128 v4, v[112:115] offset:8192
    v_lshlrev_b32 v18, 16, v116
    v_and_b32 v19, 0xffff0000, v116
    v_sub_f32 v18, v18, v16
    v_sub_f32 v19, v19, v16
    v_cvt_pk_bf16_f32 v116, v18, v19
    v_lshlrev_b32 v18, 16, v116
    v_and_b32 v19, 0xffff0000, v116
    v_mul_f32 v18, v18, v17
    v_mul_f32 v19, v19, v17
    v_cvt_pk_bf16_f32 v116, v18, v19
    v_lshlrev_b32 v18, 16, v117
    v_and_b32 v19, 0xffff0000, v117
    v_sub_f32 v18, v18, v16
    v_sub_f32 v19, v19, v16
    v_cvt_pk_bf16_f32 v117, v18, v19
    v_lshlrev_b32 v18, 16, v117
    v_and_b32 v19, 0xffff0000, v117
    v_mul_f32 v18, v18, v17
    v_mul_f32 v19, v19, v17
    v_cvt_pk_bf16_f32 v117, v18, v19
    v_lshlrev_b32 v18, 16, v118
    v_and_b32 v19, 0xffff0000, v118
    v_sub_f32 v18, v18, v16
    v_sub_f32 v19, v19, v16
    v_cvt_pk_bf16_f32 v118, v18, v19
    v_lshlrev_b32 v18, 16, v118
    v_and_b32 v19, 0xffff0000, v118
    v_mul_f32 v18, v18, v17
    v_mul_f32 v19, v19, v17
    v_cvt_pk_bf16_f32 v118, v18, v19
    v_lshlrev_b32 v18, 16, v119
    v_and_b32 v19, 0xffff0000, v119
    v_sub_f32 v18, v18, v16
    v_sub_f32 v19, v19, v16
    v_cvt_pk_bf16_f32 v119, v18, v19
    v_lshlrev_b32 v18, 16, v119
    v_and_b32 v19, 0xffff0000, v119
    v_mul_f32 v18, v18, v17
    v_mul_f32 v19, v19, v17
    v_cvt_pk_bf16_f32 v119, v18, v19
    ds_write_b128 v4, v[116:119] offset:10240
    v_lshlrev_b32 v18, 16, v120
    v_and_b32 v19, 0xffff0000, v120
    v_sub_f32 v18, v18, v16
    v_sub_f32 v19, v19, v16
    v_cvt_pk_bf16_f32 v120, v18, v19
    v_lshlrev_b32 v18, 16, v120
    v_and_b32 v19, 0xffff0000, v120
    v_mul_f32 v18, v18, v17
    v_mul_f32 v19, v19, v17
    v_cvt_pk_bf16_f32 v120, v18, v19
    v_lshlrev_b32 v18, 16, v121
    v_and_b32 v19, 0xffff0000, v121
    v_sub_f32 v18, v18, v16
    v_sub_f32 v19, v19, v16
    v_cvt_pk_bf16_f32 v121, v18, v19
    v_lshlrev_b32 v18, 16, v121
    v_and_b32 v19, 0xffff0000, v121
    v_mul_f32 v18, v18, v17
    v_mul_f32 v19, v19, v17
    v_cvt_pk_bf16_f32 v121, v18, v19
    v_lshlrev_b32 v18, 16, v122
    v_and_b32 v19, 0xffff0000, v122
    v_sub_f32 v18, v18, v16
    v_sub_f32 v19, v19, v16
    v_cvt_pk_bf16_f32 v122, v18, v19
    v_lshlrev_b32 v18, 16, v122
    v_and_b32 v19, 0xffff0000, v122
    v_mul_f32 v18, v18, v17
    v_mul_f32 v19, v19, v17
    v_cvt_pk_bf16_f32 v122, v18, v19
    v_lshlrev_b32 v18, 16, v123
    v_and_b32 v19, 0xffff0000, v123
    v_sub_f32 v18, v18, v16
    v_sub_f32 v19, v19, v16
    v_cvt_pk_bf16_f32 v123, v18, v19
    v_lshlrev_b32 v18, 16, v123
    v_and_b32 v19, 0xffff0000, v123
    v_mul_f32 v18, v18, v17
    v_mul_f32 v19, v19, v17
    v_cvt_pk_bf16_f32 v123, v18, v19
    ds_write_b128 v4, v[120:123] offset:12288
    v_lshlrev_b32 v18, 16, v124
    v_and_b32 v19, 0xffff0000, v124
    v_sub_f32 v18, v18, v16
    v_sub_f32 v19, v19, v16
    v_cvt_pk_bf16_f32 v124, v18, v19
    v_lshlrev_b32 v18, 16, v124
    v_and_b32 v19, 0xffff0000, v124
    v_mul_f32 v18, v18, v17
    v_mul_f32 v19, v19, v17
    v_cvt_pk_bf16_f32 v124, v18, v19
    v_lshlrev_b32 v18, 16, v125
    v_and_b32 v19, 0xffff0000, v125
    v_sub_f32 v18, v18, v16
    v_sub_f32 v19, v19, v16
    v_cvt_pk_bf16_f32 v125, v18, v19
    v_lshlrev_b32 v18, 16, v125
    v_and_b32 v19, 0xffff0000, v125
    v_mul_f32 v18, v18, v17
    v_mul_f32 v19, v19, v17
    v_cvt_pk_bf16_f32 v125, v18, v19
    v_lshlrev_b32 v18, 16, v126
    v_and_b32 v19, 0xffff0000, v126
    v_sub_f32 v18, v18, v16
    v_sub_f32 v19, v19, v16
    v_cvt_pk_bf16_f32 v126, v18, v19
    v_lshlrev_b32 v18, 16, v126
    v_and_b32 v19, 0xffff0000, v126
    v_mul_f32 v18, v18, v17
    v_mul_f32 v19, v19, v17
    v_cvt_pk_bf16_f32 v126, v18, v19
    v_lshlrev_b32 v18, 16, v127
    v_and_b32 v19, 0xffff0000, v127
    v_sub_f32 v18, v18, v16
    v_sub_f32 v19, v19, v16
    v_cvt_pk_bf16_f32 v127, v18, v19
    v_lshlrev_b32 v18, 16, v127
    v_and_b32 v19, 0xffff0000, v127
    v_mul_f32 v18, v18, v17
    v_mul_f32 v19, v19, v17
    v_cvt_pk_bf16_f32 v127, v18, v19
    ds_write_b128 v4, v[124:127] offset:14336
    s_waitcnt vmcnt(0) lgkmcnt(0)
    s_barrier
    v_cmp_ne_u32 vcc, 0, v0
    v_mov_b32 v15, 0x40000000
    v_mov_b32 v14, 1
    v_cndmask_b32 v15, v0, v15, vcc
    buffer_store_dword v14, v15, s[8:11], s25 offen sc1
    s_add_u32 s24, s23, 7
    s_min_u32 s24, s24, 63
    s_lshl_b32 s36, s24, 15
    buffer_load_dwordx4 v[96:99], v3, s[12:15], s36 offen offset:0
    buffer_load_dwordx4 v[100:103], v3, s[12:15], s36 offen offset:128
    buffer_load_dwordx4 v[104:107], v3, s[12:15], s36 offen offset:256
    buffer_load_dwordx4 v[108:111], v3, s[12:15], s36 offen offset:384
    buffer_load_dwordx4 v[112:115], v3, s[12:15], s36 offen offset:512
    buffer_load_dwordx4 v[116:119], v3, s[12:15], s36 offen offset:640
    buffer_load_dwordx4 v[120:123], v3, s[12:15], s36 offen offset:768
    buffer_load_dwordx4 v[124:127], v3, s[12:15], s36 offen offset:896
    ds_read_b128 v[64:67], v80 offset:0
    ds_read_b128 v[68:71], v81 offset:0
    ds_read_b128 v[72:75], v82 offset:1024
    ds_read_b128 v[76:79], v83 offset:1024
    s_waitcnt lgkmcnt(2)
    v_mfma_f32_16x16x32_bf16 v[32:35], a[128:131], v[64:67], 0
    v_mfma_f32_16x16x32_bf16 v[36:39], a[128:131], v[68:71], 0
    v_mfma_f32_16x16x32_bf16 v[40:43], a[132:135], v[64:67], 0
    v_mfma_f32_16x16x32_bf16 v[44:47], a[132:135], v[68:71], 0
    v_mfma_f32_16x16x32_bf16 v[48:51], v[64:67], v[128:131], 0
    v_mfma_f32_16x16x32_bf16 v[56:59], v[68:71], v[128:131], 0
    v_mfma_f32_16x16x32_bf16 v[52:55], v[64:67], v[132:135], 0
    v_mfma_f32_16x16x32_bf16 v[60:63], v[68:71], v[132:135], 0
    v_mfma_f32_16x16x32_bf16 v[16:19], a[0:3], v[64:67], 0
    v_mfma_f32_16x16x32_bf16 v[20:23], a[0:3], v[68:71], 0
    v_mfma_f32_16x16x32_bf16 v[24:27], a[4:7], v[64:67], 0
    v_mfma_f32_16x16x32_bf16 v[28:31], a[4:7], v[68:71], 0
    ds_read_b128 v[64:67], v80 offset:2048
    ds_read_b128 v[68:71], v81 offset:2048
    s_waitcnt lgkmcnt(2)
    v_mfma_f32_16x16x32_bf16 v[32:35], a[136:139], v[72:75], v[32:35]
    v_mfma_f32_16x16x32_bf16 v[36:39], a[136:139], v[76:79], v[36:39]
    v_mfma_f32_16x16x32_bf16 v[40:43], a[140:143], v[72:75], v[40:43]
    v_mfma_f32_16x16x32_bf16 v[44:47], a[140:143], v[76:79], v[44:47]
    v_mfma_f32_16x16x32_bf16 v[48:51], v[72:75], v[136:139], v[48:51]
    v_mfma_f32_16x16x32_bf16 v[56:59], v[76:79], v[136:139], v[56:59]
    v_mfma_f32_16x16x32_bf16 v[52:55], v[72:75], v[140:143], v[52:55]
    v_mfma_f32_16x16x32_bf16 v[60:63], v[76:79], v[140:143], v[60:63]
    v_mfma_f32_16x16x32_bf16 v[16:19], a[8:11], v[72:75], v[16:19]
    v_mfma_f32_16x16x32_bf16 v[20:23], a[8:11], v[76:79], v[20:23]
    v_mfma_f32_16x16x32_bf16 v[24:27], a[12:15], v[72:75], v[24:27]
    v_mfma_f32_16x16x32_bf16 v[28:31], a[12:15], v[76:79], v[28:31]
    ds_read_b128 v[72:75], v82 offset:3072
    ds_read_b128 v[76:79], v83 offset:3072
    s_waitcnt lgkmcnt(2)
    v_mfma_f32_16x16x32_bf16 v[32:35], a[144:147], v[64:67], v[32:35]
    v_mfma_f32_16x16x32_bf16 v[36:39], a[144:147], v[68:71], v[36:39]
    v_mfma_f32_16x16x32_bf16 v[40:43], a[148:151], v[64:67], v[40:43]
    v_mfma_f32_16x16x32_bf16 v[44:47], a[148:151], v[68:71], v[44:47]
    v_mfma_f32_16x16x32_bf16 v[48:51], v[64:67], v[144:147], v[48:51]
    v_mfma_f32_16x16x32_bf16 v[56:59], v[68:71], v[144:147], v[56:59]
    v_mfma_f32_16x16x32_bf16 v[52:55], v[64:67], v[148:151], v[52:55]
    v_mfma_f32_16x16x32_bf16 v[60:63], v[68:71], v[148:151], v[60:63]
    v_mfma_f32_16x16x32_bf16 v[16:19], a[16:19], v[64:67], v[16:19]
    v_mfma_f32_16x16x32_bf16 v[20:23], a[16:19], v[68:71], v[20:23]
    v_mfma_f32_16x16x32_bf16 v[24:27], a[20:23], v[64:67], v[24:27]
    v_mfma_f32_16x16x32_bf16 v[28:31], a[20:23], v[68:71], v[28:31]
    ds_read_b128 v[64:67], v80 offset:4096
    ds_read_b128 v[68:71], v81 offset:4096
    s_waitcnt lgkmcnt(2)
    v_mfma_f32_16x16x32_bf16 v[32:35], a[152:155], v[72:75], v[32:35]
    v_mfma_f32_16x16x32_bf16 v[36:39], a[152:155], v[76:79], v[36:39]
    v_mfma_f32_16x16x32_bf16 v[40:43], a[156:159], v[72:75], v[40:43]
    v_mfma_f32_16x16x32_bf16 v[44:47], a[156:159], v[76:79], v[44:47]
    v_mfma_f32_16x16x32_bf16 v[48:51], v[72:75], v[152:155], v[48:51]
    v_mfma_f32_16x16x32_bf16 v[56:59], v[76:79], v[152:155], v[56:59]
    v_mfma_f32_16x16x32_bf16 v[52:55], v[72:75], v[156:159], v[52:55]
    v_mfma_f32_16x16x32_bf16 v[60:63], v[76:79], v[156:159], v[60:63]
    v_mfma_f32_16x16x32_bf16 v[16:19], a[24:27], v[72:75], v[16:19]
    v_mfma_f32_16x16x32_bf16 v[20:23], a[24:27], v[76:79], v[20:23]
    v_mfma_f32_16x16x32_bf16 v[24:27], a[28:31], v[72:75], v[24:27]
    v_mfma_f32_16x16x32_bf16 v[28:31], a[28:31], v[76:79], v[28:31]
    ds_read_b128 v[72:75], v82 offset:5120
    ds_read_b128 v[76:79], v83 offset:5120
    s_waitcnt lgkmcnt(2)
    v_mfma_f32_16x16x32_bf16 v[32:35], a[160:163], v[64:67], v[32:35]
    v_mfma_f32_16x16x32_bf16 v[36:39], a[160:163], v[68:71], v[36:39]
    v_mfma_f32_16x16x32_bf16 v[40:43], a[164:167], v[64:67], v[40:43]
    v_mfma_f32_16x16x32_bf16 v[44:47], a[164:167], v[68:71], v[44:47]
    v_mfma_f32_16x16x32_bf16 v[48:51], v[64:67], v[160:163], v[48:51]
    v_mfma_f32_16x16x32_bf16 v[56:59], v[68:71], v[160:163], v[56:59]
    v_mfma_f32_16x16x32_bf16 v[52:55], v[64:67], v[164:167], v[52:55]
    v_mfma_f32_16x16x32_bf16 v[60:63], v[68:71], v[164:167], v[60:63]
    v_mfma_f32_16x16x32_bf16 v[16:19], a[32:35], v[64:67], v[16:19]
    v_mfma_f32_16x16x32_bf16 v[20:23], a[32:35], v[68:71], v[20:23]
    v_mfma_f32_16x16x32_bf16 v[24:27], a[36:39], v[64:67], v[24:27]
    v_mfma_f32_16x16x32_bf16 v[28:31], a[36:39], v[68:71], v[28:31]
    ds_read_b128 v[64:67], v80 offset:6144
    ds_read_b128 v[68:71], v81 offset:6144
    s_waitcnt lgkmcnt(2)
    v_mfma_f32_16x16x32_bf16 v[32:35], a[168:171], v[72:75], v[32:35]
    v_mfma_f32_16x16x32_bf16 v[36:39], a[168:171], v[76:79], v[36:39]
    v_mfma_f32_16x16x32_bf16 v[40:43], a[172:175], v[72:75], v[40:43]
    v_mfma_f32_16x16x32_bf16 v[44:47], a[172:175], v[76:79], v[44:47]
    v_mfma_f32_16x16x32_bf16 v[48:51], v[72:75], v[168:171], v[48:51]
    v_mfma_f32_16x16x32_bf16 v[56:59], v[76:79], v[168:171], v[56:59]
    v_mfma_f32_16x16x32_bf16 v[52:55], v[72:75], v[172:175], v[52:55]
    v_mfma_f32_16x16x32_bf16 v[60:63], v[76:79], v[172:175], v[60:63]
    v_mfma_f32_16x16x32_bf16 v[16:19], a[40:43], v[72:75], v[16:19]
    v_mfma_f32_16x16x32_bf16 v[20:23], a[40:43], v[76:79], v[20:23]
    v_mfma_f32_16x16x32_bf16 v[24:27], a[44:47], v[72:75], v[24:27]
    v_mfma_f32_16x16x32_bf16 v[28:31], a[44:47], v[76:79], v[28:31]
    ds_read_b128 v[72:75], v82 offset:7168
    ds_read_b128 v[76:79], v83 offset:7168
    s_waitcnt lgkmcnt(2)
    v_mfma_f32_16x16x32_bf16 v[32:35], a[176:179], v[64:67], v[32:35]
    v_mfma_f32_16x16x32_bf16 v[36:39], a[176:179], v[68:71], v[36:39]
    v_mfma_f32_16x16x32_bf16 v[40:43], a[180:183], v[64:67], v[40:43]
    v_mfma_f32_16x16x32_bf16 v[44:47], a[180:183], v[68:71], v[44:47]
    v_mfma_f32_16x16x32_bf16 v[48:51], v[64:67], v[176:179], v[48:51]
    v_mfma_f32_16x16x32_bf16 v[56:59], v[68:71], v[176:179], v[56:59]
    v_mfma_f32_16x16x32_bf16 v[52:55], v[64:67], v[180:183], v[52:55]
    v_mfma_f32_16x16x32_bf16 v[60:63], v[68:71], v[180:183], v[60:63]
    v_mfma_f32_16x16x32_bf16 v[16:19], a[48:51], v[64:67], v[16:19]
    v_mfma_f32_16x16x32_bf16 v[20:23], a[48:51], v[68:71], v[20:23]
    v_mfma_f32_16x16x32_bf16 v[24:27], a[52:55], v[64:67], v[24:27]
    v_mfma_f32_16x16x32_bf16 v[28:31], a[52:55], v[68:71], v[28:31]
    ds_read_b128 v[64:67], v80 offset:8192
    ds_read_b128 v[68:71], v81 offset:8192
    s_waitcnt lgkmcnt(2)
    v_mfma_f32_16x16x32_bf16 v[32:35], a[184:187], v[72:75], v[32:35]
    v_mfma_f32_16x16x32_bf16 v[36:39], a[184:187], v[76:79], v[36:39]
    v_mfma_f32_16x16x32_bf16 v[40:43], a[188:191], v[72:75], v[40:43]
    v_mfma_f32_16x16x32_bf16 v[44:47], a[188:191], v[76:79], v[44:47]
    v_mfma_f32_16x16x32_bf16 v[48:51], v[72:75], v[184:187], v[48:51]
    v_mfma_f32_16x16x32_bf16 v[56:59], v[76:79], v[184:187], v[56:59]
    v_mfma_f32_16x16x32_bf16 v[52:55], v[72:75], v[188:191], v[52:55]
    v_mfma_f32_16x16x32_bf16 v[60:63], v[76:79], v[188:191], v[60:63]
    v_mfma_f32_16x16x32_bf16 v[16:19], a[56:59], v[72:75], v[16:19]
    v_mfma_f32_16x16x32_bf16 v[20:23], a[56:59], v[76:79], v[20:23]
    v_mfma_f32_16x16x32_bf16 v[24:27], a[60:63], v[72:75], v[24:27]
    v_mfma_f32_16x16x32_bf16 v[28:31], a[60:63], v[76:79], v[28:31]
    ds_read_b128 v[72:75], v82 offset:9216
    ds_read_b128 v[76:79], v83 offset:9216
    s_waitcnt lgkmcnt(2)
    v_mfma_f32_16x16x32_bf16 v[32:35], a[192:195], v[64:67], v[32:35]
    v_mfma_f32_16x16x32_bf16 v[36:39], a[192:195], v[68:71], v[36:39]
    v_mfma_f32_16x16x32_bf16 v[40:43], a[196:199], v[64:67], v[40:43]
    v_mfma_f32_16x16x32_bf16 v[44:47], a[196:199], v[68:71], v[44:47]
    v_mfma_f32_16x16x32_bf16 v[48:51], v[64:67], v[192:195], v[48:51]
    v_mfma_f32_16x16x32_bf16 v[56:59], v[68:71], v[192:195], v[56:59]
    v_mfma_f32_16x16x32_bf16 v[52:55], v[64:67], v[196:199], v[52:55]
    v_mfma_f32_16x16x32_bf16 v[60:63], v[68:71], v[196:199], v[60:63]
    v_mfma_f32_16x16x32_bf16 v[16:19], a[64:67], v[64:67], v[16:19]
    v_mfma_f32_16x16x32_bf16 v[20:23], a[64:67], v[68:71], v[20:23]
    v_mfma_f32_16x16x32_bf16 v[24:27], a[68:71], v[64:67], v[24:27]
    v_mfma_f32_16x16x32_bf16 v[28:31], a[68:71], v[68:71], v[28:31]
    ds_read_b128 v[64:67], v80 offset:10240
    ds_read_b128 v[68:71], v81 offset:10240
    s_waitcnt lgkmcnt(2)
    v_mfma_f32_16x16x32_bf16 v[32:35], a[200:203], v[72:75], v[32:35]
    v_mfma_f32_16x16x32_bf16 v[36:39], a[200:203], v[76:79], v[36:39]
    v_mfma_f32_16x16x32_bf16 v[40:43], a[204:207], v[72:75], v[40:43]
    v_mfma_f32_16x16x32_bf16 v[44:47], a[204:207], v[76:79], v[44:47]
    v_mfma_f32_16x16x32_bf16 v[48:51], v[72:75], v[200:203], v[48:51]
    v_mfma_f32_16x16x32_bf16 v[56:59], v[76:79], v[200:203], v[56:59]
    v_mfma_f32_16x16x32_bf16 v[52:55], v[72:75], v[204:207], v[52:55]
    v_mfma_f32_16x16x32_bf16 v[60:63], v[76:79], v[204:207], v[60:63]
    v_mfma_f32_16x16x32_bf16 v[16:19], a[72:75], v[72:75], v[16:19]
    v_mfma_f32_16x16x32_bf16 v[20:23], a[72:75], v[76:79], v[20:23]
    v_mfma_f32_16x16x32_bf16 v[24:27], a[76:79], v[72:75], v[24:27]
    v_mfma_f32_16x16x32_bf16 v[28:31], a[76:79], v[76:79], v[28:31]
    ds_read_b128 v[72:75], v82 offset:11264
    ds_read_b128 v[76:79], v83 offset:11264
    s_waitcnt lgkmcnt(2)
    v_mfma_f32_16x16x32_bf16 v[32:35], a[208:211], v[64:67], v[32:35]
    v_mfma_f32_16x16x32_bf16 v[36:39], a[208:211], v[68:71], v[36:39]
    v_mfma_f32_16x16x32_bf16 v[40:43], a[212:215], v[64:67], v[40:43]
    v_mfma_f32_16x16x32_bf16 v[44:47], a[212:215], v[68:71], v[44:47]
    v_mfma_f32_16x16x32_bf16 v[48:51], v[64:67], v[208:211], v[48:51]
    v_mfma_f32_16x16x32_bf16 v[56:59], v[68:71], v[208:211], v[56:59]
    v_mfma_f32_16x16x32_bf16 v[52:55], v[64:67], v[212:215], v[52:55]
    v_mfma_f32_16x16x32_bf16 v[60:63], v[68:71], v[212:215], v[60:63]
    v_mfma_f32_16x16x32_bf16 v[16:19], a[80:83], v[64:67], v[16:19]
    v_mfma_f32_16x16x32_bf16 v[20:23], a[80:83], v[68:71], v[20:23]
    v_mfma_f32_16x16x32_bf16 v[24:27], a[84:87], v[64:67], v[24:27]
    v_mfma_f32_16x16x32_bf16 v[28:31], a[84:87], v[68:71], v[28:31]
    ds_read_b128 v[64:67], v80 offset:12288
    ds_read_b128 v[68:71], v81 offset:12288
    s_waitcnt lgkmcnt(2)
    v_mfma_f32_16x16x32_bf16 v[32:35], a[216:219], v[72:75], v[32:35]
    v_mfma_f32_16x16x32_bf16 v[36:39], a[216:219], v[76:79], v[36:39]
    v_mfma_f32_16x16x32_bf16 v[40:43], a[220:223], v[72:75], v[40:43]
    v_mfma_f32_16x16x32_bf16 v[44:47], a[220:223], v[76:79], v[44:47]
    v_mfma_f32_16x16x32_bf16 v[48:51], v[72:75], v[216:219], v[48:51]
    v_mfma_f32_16x16x32_bf16 v[56:59], v[76:79], v[216:219], v[56:59]
    v_mfma_f32_16x16x32_bf16 v[52:55], v[72:75], v[220:223], v[52:55]
    v_mfma_f32_16x16x32_bf16 v[60:63], v[76:79], v[220:223], v[60:63]
    v_mfma_f32_16x16x32_bf16 v[16:19], a[88:91], v[72:75], v[16:19]
    v_mfma_f32_16x16x32_bf16 v[20:23], a[88:91], v[76:79], v[20:23]
    v_mfma_f32_16x16x32_bf16 v[24:27], a[92:95], v[72:75], v[24:27]
    v_mfma_f32_16x16x32_bf16 v[28:31], a[92:95], v[76:79], v[28:31]
    ds_read_b128 v[72:75], v82 offset:13312
    ds_read_b128 v[76:79], v83 offset:13312
    s_waitcnt lgkmcnt(2)
    v_mfma_f32_16x16x32_bf16 v[32:35], a[224:227], v[64:67], v[32:35]
    v_mfma_f32_16x16x32_bf16 v[36:39], a[224:227], v[68:71], v[36:39]
    v_mfma_f32_16x16x32_bf16 v[40:43], a[228:231], v[64:67], v[40:43]
    v_mfma_f32_16x16x32_bf16 v[44:47], a[228:231], v[68:71], v[44:47]
    v_mfma_f32_16x16x32_bf16 v[48:51], v[64:67], v[224:227], v[48:51]
    v_mfma_f32_16x16x32_bf16 v[56:59], v[68:71], v[224:227], v[56:59]
    v_mfma_f32_16x16x32_bf16 v[52:55], v[64:67], v[228:231], v[52:55]
    v_mfma_f32_16x16x32_bf16 v[60:63], v[68:71], v[228:231], v[60:63]
    v_mfma_f32_16x16x32_bf16 v[16:19], a[96:99], v[64:67], v[16:19]
    v_mfma_f32_16x16x32_bf16 v[20:23], a[96:99], v[68:71], v[20:23]
    v_mfma_f32_16x16x32_bf16 v[24:27], a[100:103], v[64:67], v[24:27]
    v_mfma_f32_16x16x32_bf16 v[28:31], a[100:103], v[68:71], v[28:31]
    ds_read_b128 v[64:67], v80 offset:14336
    ds_read_b128 v[68:71], v81 offset:14336
    s_waitcnt lgkmcnt(2)
    v_mfma_f32_16x16x32_bf16 v[32:35], a[232:235], v[72:75], v[32:35]
    v_mfma_f32_16x16x32_bf16 v[36:39], a[232:235], v[76:79], v[36:39]
    v_mfma_f32_16x16x32_bf16 v[40:43], a[236:239], v[72:75], v[40:43]
    v_mfma_f32_16x16x32_bf16 v[44:47], a[236:239], v[76:79], v[44:47]
    v_mfma_f32_16x16x32_bf16 v[48:51], v[72:75], v[232:235], v[48:51]
    v_mfma_f32_16x16x32_bf16 v[56:59], v[76:79], v[232:235], v[56:59]
    v_mfma_f32_16x16x32_bf16 v[52:55], v[72:75], v[236:239], v[52:55]
    v_mfma_f32_16x16x32_bf16 v[60:63], v[76:79], v[236:239], v[60:63]
    v_mfma_f32_16x16x32_bf16 v[16:19], a[104:107], v[72:75], v[16:19]
    v_mfma_f32_16x16x32_bf16 v[20:23], a[104:107], v[76:79], v[20:23]
    v_mfma_f32_16x16x32_bf16 v[24:27], a[108:111], v[72:75], v[24:27]
    v_mfma_f32_16x16x32_bf16 v[28:31], a[108:111], v[76:79], v[28:31]
    ds_read_b128 v[72:75], v82 offset:15360
    ds_read_b128 v[76:79], v83 offset:15360
    s_waitcnt lgkmcnt(2)
    v_mfma_f32_16x16x32_bf16 v[32:35], a[240:243], v[64:67], v[32:35]
    v_mfma_f32_16x16x32_bf16 v[36:39], a[240:243], v[68:71], v[36:39]
    v_mfma_f32_16x16x32_bf16 v[40:43], a[244:247], v[64:67], v[40:43]
    v_mfma_f32_16x16x32_bf16 v[44:47], a[244:247], v[68:71], v[44:47]
    v_mfma_f32_16x16x32_bf16 v[48:51], v[64:67], v[240:243], v[48:51]
    v_mfma_f32_16x16x32_bf16 v[56:59], v[68:71], v[240:243], v[56:59]
    v_mfma_f32_16x16x32_bf16 v[52:55], v[64:67], v[244:247], v[52:55]
    v_mfma_f32_16x16x32_bf16 v[60:63], v[68:71], v[244:247], v[60:63]
    v_mfma_f32_16x16x32_bf16 v[16:19], a[112:115], v[64:67], v[16:19]
    v_mfma_f32_16x16x32_bf16 v[20:23], a[112:115], v[68:71], v[20:23]
    v_mfma_f32_16x16x32_bf16 v[24:27], a[116:119], v[64:67], v[24:27]
    v_mfma_f32_16x16x32_bf16 v[28:31], a[116:119], v[68:71], v[28:31]
    s_waitcnt lgkmcnt(0)
    v_mfma_f32_16x16x32_bf16 v[32:35], a[248:251], v[72:75], v[32:35]
    v_mfma_f32_16x16x32_bf16 v[36:39], a[248:251], v[76:79], v[36:39]
    v_mfma_f32_16x16x32_bf16 v[40:43], a[252:255], v[72:75], v[40:43]
    v_mfma_f32_16x16x32_bf16 v[44:47], a[252:255], v[76:79], v[44:47]
    v_mfma_f32_16x16x32_bf16 v[48:51], v[72:75], v[248:251], v[48:51]
    v_mfma_f32_16x16x32_bf16 v[56:59], v[76:79], v[248:251], v[56:59]
    v_mfma_f32_16x16x32_bf16 v[52:55], v[72:75], v[252:255], v[52:55]
    v_mfma_f32_16x16x32_bf16 v[60:63], v[76:79], v[252:255], v[60:63]
    v_mfma_f32_16x16x32_bf16 v[16:19], a[120:123], v[72:75], v[16:19]
    v_mfma_f32_16x16x32_bf16 v[20:23], a[120:123], v[76:79], v[20:23]
    v_mfma_f32_16x16x32_bf16 v[24:27], a[124:127], v[72:75], v[24:27]
    v_mfma_f32_16x16x32_bf16 v[28:31], a[124:127], v[76:79], v[28:31]
    s_barrier
    v_mul_f32 v32, s33, v32
    v_mul_f32 v33, s33, v33
    v_mul_f32 v34, s33, v34
    v_mul_f32 v35, s33, v35
    v_mul_f32 v36, s33, v36
    v_mul_f32 v37, s33, v37
    v_mul_f32 v38, s33, v38
    v_mul_f32 v39, s33, v39
    v_mul_f32 v40, s33, v40
    v_mul_f32 v41, s33, v41
    v_mul_f32 v42, s33, v42
    v_mul_f32 v43, s33, v43
    v_mul_f32 v44, s33, v44
    v_mul_f32 v45, s33, v45
    v_mul_f32 v46, s33, v46
    v_mul_f32 v47, s33, v47
    v_cvt_pk_bf16_f32 v64, v32, v40
    v_cvt_pk_bf16_f32 v65, v33, v41
    v_cvt_pk_bf16_f32 v66, v34, v42
    v_cvt_pk_bf16_f32 v67, v35, v43
    v_cvt_pk_bf16_f32 v68, v36, v44
    v_cvt_pk_bf16_f32 v69, v37, v45
    v_cvt_pk_bf16_f32 v70, v38, v46
    v_cvt_pk_bf16_f32 v71, v39, v47
    v_cvt_pk_bf16_f32 v72, v48, v49
    v_cvt_pk_bf16_f32 v73, v50, v51
    v_cvt_pk_bf16_f32 v74, v56, v57
    v_cvt_pk_bf16_f32 v75, v58, v59
    v_cvt_pk_bf16_f32 v76, v52, v53
    v_cvt_pk_bf16_f32 v77, v54, v55
    v_cvt_pk_bf16_f32 v78, v60, v61
    v_cvt_pk_bf16_f32 v79, v62, v63
    v_cvt_pk_bf16_f32 v84, v16, v24
    v_cvt_pk_bf16_f32 v85, v17, v25
    v_cvt_pk_bf16_f32 v86, v18, v26
    v_cvt_pk_bf16_f32 v87, v19, v27
    v_cvt_pk_bf16_f32 v88, v20, v28
    v_cvt_pk_bf16_f32 v89, v21, v29
    v_cvt_pk_bf16_f32 v90, v22, v30
    v_cvt_pk_bf16_f32 v91, v23, v31
    s_mul_i32 s24, s23, 0x82000
    s_lshl_b32 s36, s20, 14
    s_add_u32 s24, s24, s36
    s_add_u32 s24, s24, 0x1000000
    s_lshr_b32 s36, s21, 1
    s_lshl_b32 s36, s36, 12
    s_xor_b32 s37, s36, 4096
    s_add_u32 s36, s36, s24
    s_add_u32 s37, s37, s24
    buffer_store_dwordx4 v[64:67], v9, s[8:11], s36 offen sc1
    buffer_store_dwordx4 v[68:71], v9, s[8:11], s37 offen sc1
    s_add_u32 s24, s24, 8192
    buffer_store_dwordx4 v[72:75], v2, s[8:11], s24 offen sc1
    buffer_store_dwordx4 v[76:79], v2, s[8:11], s24 offen offset:1024 sc1
    s_add_u32 s36, s36, 0x7000000
    s_add_u32 s37, s37, 0x7000000
    buffer_store_dwordx4 v[84:87], v9, s[8:11], s36 offen sc1
    buffer_store_dwordx4 v[88:91], v9, s[8:11], s37 offen sc1
    s_lshl_b32 s25, s20, 8
    s_lshl_b32 s36, s23, 2
    s_add_u32 s25, s25, s36
    s_add_u32 s25, s25, 0x190000
    s_add_u32 s23, s23, 7
    s_cmp_lt_u32 s23, 64
    s_cbranch_scc1 L_P1
    s_waitcnt vmcnt(0)
    s_barrier
    v_cmp_ne_u32 vcc, 0, v0
    v_mov_b32 v15, 0x40000000
    v_mov_b32 v14, 1
    v_cndmask_b32 v15, v0, v15, vcc
    buffer_store_dword v14, v15, s[8:11], s25 offen sc1
    s_mov_b32 s96, s54
    s_and_b32 s97, s55, 0xffff
    s_mov_b32 s98, 0x400000
    s_mov_b32 s99, 0x20000
    v_mov_b32 v15, 0x0
    v_bfe_u32 v14, v0, 0, 1
    s_mov_b32 s38, 0x10
    v_mad_u32_u24 v15, v14, s38, v15
    v_bfe_u32 v14, v0, 1, 1
    s_mov_b32 s38, 0x20
    v_mad_u32_u24 v15, v14, s38, v15
    v_bfe_u32 v14, v0, 2, 1
    s_mov_b32 s38, 0x40
    v_mad_u32_u24 v15, v14, s38, v15
    v_bfe_u32 v14, v0, 3, 1
    s_mov_b32 s38, 0x80
    v_mad_u32_u24 v15, v14, s38, v15
    v_bfe_u32 v14, v0, 4, 1
    s_mov_b32 s38, 0x2000
    v_mad_u32_u24 v15, v14, s38, v15
    v_bfe_u32 v14, v0, 5, 1
    s_mov_b32 s38, 0x4000
    v_mad_u32_u24 v15, v14, s38, v15
    v_bfe_u32 v14, v0, 6, 1
    s_mov_b32 s38, 0x100
    v_mad_u32_u24 v15, v14, s38, v15
    v_bfe_u32 v14, v0, 7, 1
    s_mov_b32 s38, 0x200
    v_mad_u32_u24 v15, v14, s38, v15
    s_lshl_b32 s36, s20, 17
    s_add_u32 s37, s36, 0x0
    buffer_load_dwordx4 v[16:19], v15, s[96:99], s37 offen
    s_add_u32 s37, s36, 0x400
    buffer_load_dwordx4 v[20:23], v15, s[96:99], s37 offen
    s_add_u32 s37, s36, 0x800
    buffer_load_dwordx4 v[24:27], v15, s[96:99], s37 offen
    s_add_u32 s37, s36, 0xc00
    buffer_load_dwordx4 v[28:31], v15, s[96:99], s37 offen
    s_add_u32 s37, s36, 0x1000
    buffer_load_dwordx4 v[32:35], v15, s[96:99], s37 offen
    s_add_u32 s37, s36, 0x1400
    buffer_load_dwordx4 v[36:39], v15, s[96:99], s37 offen
    s_add_u32 s37, s36, 0x1800
    buffer_load_dwordx4 v[40:43], v15, s[96:99], s37 offen
    s_add_u32 s37, s36, 0x1c00
    buffer_load_dwordx4 v[44:47], v15, s[96:99], s37 offen
    s_add_u32 s37, s36, 0x8000
    buffer_load_dwordx4 v[48:51], v15, s[96:99], s37 offen
    s_add_u32 s37, s36, 0x8400
    buffer_load_dwordx4 v[52:55], v15, s[96:99], s37 offen
    s_add_u32 s37, s36, 0x8800
    buffer_load_dwordx4 v[56:59], v15, s[96:99], s37 offen
    s_add_u32 s37, s36, 0x8c00
    buffer_load_dwordx4 v[60:63], v15, s[96:99], s37 offen
    s_add_u32 s37, s36, 0x9000
    buffer_load_dwordx4 v[64:67], v15, s[96:99], s37 offen
    s_add_u32 s37, s36, 0x9400
    buffer_load_dwordx4 v[68:71], v15, s[96:99], s37 offen
    s_add_u32 s37, s36, 0x9800
    buffer_load_dwordx4 v[72:75], v15, s[96:99], s37 offen
    s_add_u32 s37, s36, 0x9c00
    buffer_load_dwordx4 v[76:79], v15, s[96:99], s37 offen
    s_add_u32 s37, s36, 0x10000
    buffer_load_dwordx4 v[80:83], v15, s[96:99], s37 offen
    s_add_u32 s37, s36, 0x10400
    buffer_load_dwordx4 v[84:87], v15, s[96:99], s37 offen
    s_add_u32 s37, s36, 0x10800
    buffer_load_dwordx4 v[88:91], v15, s[96:99], s37 offen
    s_add_u32 s37, s36, 0x10c00
    buffer_load_dwordx4 v[92:95], v15, s[96:99], s37 offen
    s_add_u32 s37, s36, 0x11000
    buffer_load_dwordx4 v[96:99], v15, s[96:99], s37 offen
    s_add_u32 s37, s36, 0x11400
    buffer_load_dwordx4 v[100:103], v15, s[96:99], s37 offen
    s_add_u32 s37, s36, 0x11800
    buffer_load_dwordx4 v[104:107], v15, s[96:99], s37 offen
    s_add_u32 s37, s36, 0x11c00
    buffer_load_dwordx4 v[108:111], v15, s[96:99], s37 offen
    s_waitcnt vmcnt(16)
    v_perm_b32 v112, v20, v16, s34
    v_perm_b32 v113, v28, v24, s34
    v_perm_b32 v114, v36, v32, s34
    v_perm_b32 v115, v44, v40, s34
    ds_write_b128 v7, v[112:115] offset:0
    v_perm_b32 v116, v20, v16, s35
    v_perm_b32 v117, v28, v24, s35
    v_perm_b32 v118, v36, v32, s35
    v_perm_b32 v119, v44, v40, s35
    ds_write_b128 v7, v[116:119] offset:1024
    v_perm_b32 v120, v21, v17, s34
    v_perm_b32 v121, v29, v25, s34
    v_perm_b32 v122, v37, v33, s34
    v_perm_b32 v123, v45, v41, s34
    ds_write_b128 v7, v[120:123] offset:2048
    v_perm_b32 v124, v21, v17, s35
    v_perm_b32 v125, v29, v25, s35
    v_perm_b32 v126, v37, v33, s35
    v_perm_b32 v127, v45, v41, s35
    ds_write_b128 v7, v[124:127] offset:3072
    s_waitcnt lgkmcnt(0)
    v_perm_b32 v112, v22, v18, s34
    v_perm_b32 v113, v30, v26, s34
    v_perm_b32 v114, v38, v34, s34
    v_perm_b32 v115, v46, v42, s34
    ds_write_b128 v7, v[112:115] offset:4096
    v_perm_b32 v116, v22, v18, s35
    v_perm_b32 v117, v30, v26, s35
    v_perm_b32 v118, v38, v34, s35
    v_perm_b32 v119, v46, v42, s35
    ds_write_b128 v7, v[116:119] offset:5120
    v_perm_b32 v120, v23, v19, s34
    v_perm_b32 v121, v31, v27, s34
    v_perm_b32 v122, v39, v35, s34
    v_perm_b32 v123, v47, v43, s34
    ds_write_b128 v7, v[120:123] offset:6144
    v_perm_b32 v124, v23, v19, s35
    v_perm_b32 v125, v31, v27, s35
    v_perm_b32 v126, v39, v35, s35
    v_perm_b32 v127, v47, v43, s35
    ds_write_b128 v7, v[124:127] offset:7168
    s_waitcnt lgkmcnt(0)
    s_add_u32 s37, s36, 0x18000
    buffer_load_dwordx4 v[16:19], v15, s[96:99], s37 offen
    s_add_u32 s37, s36, 0x18400
    buffer_load_dwordx4 v[20:23], v15, s[96:99], s37 offen
    s_add_u32 s37, s36, 0x18800
    buffer_load_dwordx4 v[24:27], v15, s[96:99], s37 offen
    s_add_u32 s37, s36, 0x18c00
    buffer_load_dwordx4 v[28:31], v15, s[96:99], s37 offen
    s_add_u32 s37, s36, 0x19000
    buffer_load_dwordx4 v[32:35], v15, s[96:99], s37 offen
    s_add_u32 s37, s36, 0x19400
    buffer_load_dwordx4 v[36:39], v15, s[96:99], s37 offen
    s_add_u32 s37, s36, 0x19800
    buffer_load_dwordx4 v[40:43], v15, s[96:99], s37 offen
    s_add_u32 s37, s36, 0x19c00
    buffer_load_dwordx4 v[44:47], v15, s[96:99], s37 offen
    s_waitcnt vmcnt(16)
    v_perm_b32 v112, v52, v48, s34
    v_perm_b32 v113, v60, v56, s34
    v_perm_b32 v114, v68, v64, s34
    v_perm_b32 v115, v76, v72, s34
    ds_write_b128 v7, v[112:115] offset:8192
    v_perm_b32 v116, v52, v48, s35
    v_perm_b32 v117, v60, v56, s35
    v_perm_b32 v118, v68, v64, s35
    v_perm_b32 v119, v76, v72, s35
    ds_write_b128 v7, v[116:119] offset:9216
    v_perm_b32 v120, v53, v49, s34
    v_perm_b32 v121, v61, v57, s34
    v_perm_b32 v122, v69, v65, s34
    v_perm_b32 v123, v77, v73, s34
    ds_write_b128 v7, v[120:123] offset:10240
    v_perm_b32 v124, v53, v49, s35
    v_perm_b32 v125, v61, v57, s35
    v_perm_b32 v126, v69, v65, s35
    v_perm_b32 v127, v77, v73, s35
    ds_write_b128 v7, v[124:127] offset:11264
    s_waitcnt lgkmcnt(0)
    v_perm_b32 v112, v54, v50, s34
    v_perm_b32 v113, v62, v58, s34
    v_perm_b32 v114, v70, v66, s34
    v_perm_b32 v115, v78, v74, s34
    ds_write_b128 v7, v[112:115] offset:12288
    v_perm_b32 v116, v54, v50, s35
    v_perm_b32 v117, v62, v58, s35
    v_perm_b32 v118, v70, v66, s35
    v_perm_b32 v119, v78, v74, s35
    ds_write_b128 v7, v[116:119] offset:13312
    v_perm_b32 v120, v55, v51, s34
    v_perm_b32 v121, v63, v59, s34
    v_perm_b32 v122, v71, v67, s34
    v_perm_b32 v123, v79, v75, s34
    ds_write_b128 v7, v[120:123] offset:14336
    v_perm_b32 v124, v55, v51, s35
    v_perm_b32 v125, v63, v59, s35
    v_perm_b32 v126, v71, v67, s35
    v_perm_b32 v127, v79, v75, s35
    ds_write_b128 v7, v[124:127] offset:15360
    s_waitcnt lgkmcnt(0)
    s_waitcnt vmcnt(8)
    v_perm_b32 v112, v84, v80, s34
    v_perm_b32 v113, v92, v88, s34
    v_perm_b32 v114, v100, v96, s34
    v_perm_b32 v115, v108, v104, s34
    ds_write_b128 v7, v[112:115] offset:16384
    v_perm_b32 v116, v84, v80, s35
    v_perm_b32 v117, v92, v88, s35
    v_perm_b32 v118, v100, v96, s35
    v_perm_b32 v119, v108, v104, s35
    ds_write_b128 v7, v[116:119] offset:17408
    v_perm_b32 v120, v85, v81, s34
    v_perm_b32 v121, v93, v89, s34
    v_perm_b32 v122, v101, v97, s34
    v_perm_b32 v123, v109, v105, s34
    ds_write_b128 v7, v[120:123] offset:18432
    v_perm_b32 v124, v85, v81, s35
    v_perm_b32 v125, v93, v89, s35
    v_perm_b32 v126, v101, v97, s35
    v_perm_b32 v127, v109, v105, s35
    ds_write_b128 v7, v[124:127] offset:19456
    s_waitcnt lgkmcnt(0)
    v_perm_b32 v112, v86, v82, s34
    v_perm_b32 v113, v94, v90, s34
    v_perm_b32 v114, v102, v98, s34
    v_perm_b32 v115, v110, v106, s34
    ds_write_b128 v7, v[112:115] offset:20480
    v_perm_b32 v116, v86, v82, s35
    v_perm_b32 v117, v94, v90, s35
    v_perm_b32 v118, v102, v98, s35
    v_perm_b32 v119, v110, v106, s35
    ds_write_b128 v7, v[116:119] offset:21504
    v_perm_b32 v120, v87, v83, s34
    v_perm_b32 v121, v95, v91, s34
    v_perm_b32 v122, v103, v99, s34
    v_perm_b32 v123, v111, v107, s34
    ds_write_b128 v7, v[120:123] offset:22528
    v_perm_b32 v124, v87, v83, s35
    v_perm_b32 v125, v95, v91, s35
    v_perm_b32 v126, v103, v99, s35
    v_perm_b32 v127, v111, v107, s35
    ds_write_b128 v7, v[124:127] offset:23552
    s_waitcnt lgkmcnt(0)
    s_waitcnt vmcnt(0)
    v_perm_b32 v112, v20, v16, s34
    v_perm_b32 v113, v28, v24, s34
    v_perm_b32 v114, v36, v32, s34
    v_perm_b32 v115, v44, v40, s34
    ds_write_b128 v7, v[112:115] offset:24576
    v_perm_b32 v116, v20, v16, s35
    v_perm_b32 v117, v28, v24, s35
    v_perm_b32 v118, v36, v32, s35
    v_perm_b32 v119, v44, v40, s35
    ds_write_b128 v7, v[116:119] offset:25600
    v_perm_b32 v120, v21, v17, s34
    v_perm_b32 v121, v29, v25, s34
    v_perm_b32 v122, v37, v33, s34
    v_perm_b32 v123, v45, v41, s34
    ds_write_b128 v7, v[120:123] offset:26624
    v_perm_b32 v124, v21, v17, s35
    v_perm_b32 v125, v29, v25, s35
    v_perm_b32 v126, v37, v33, s35
    v_perm_b32 v127, v45, v41, s35
    ds_write_b128 v7, v[124:127] offset:27648
    s_waitcnt lgkmcnt(0)
    v_perm_b32 v112, v22, v18, s34
    v_perm_b32 v113, v30, v26, s34
    v_perm_b32 v114, v38, v34, s34
    v_perm_b32 v115, v46, v42, s34
    ds_write_b128 v7, v[112:115] offset:28672
    v_perm_b32 v116, v22, v18, s35
    v_perm_b32 v117, v30, v26, s35
    v_perm_b32 v118, v38, v34, s35
    v_perm_b32 v119, v46, v42, s35
    ds_write_b128 v7, v[116:119] offset:29696
    v_perm_b32 v120, v23, v19, s34
    v_perm_b32 v121, v31, v27, s34
    v_perm_b32 v122, v39, v35, s34
    v_perm_b32 v123, v47, v43, s34
    ds_write_b128 v7, v[120:123] offset:30720
    v_perm_b32 v124, v23, v19, s35
    v_perm_b32 v125, v31, v27, s35
    v_perm_b32 v126, v39, v35, s35
    v_perm_b32 v127, v47, v43, s35
    ds_write_b128 v7, v[124:127] offset:31744
    s_waitcnt lgkmcnt(0)
    s_mov_b32 s23, s22
L_P2:
    s_mul_i32 s24, s23, 0x82000
    s_lshl_b32 s36, s20, 14
    s_add_u32 s24, s24, s36
    s_add_u32 s24, s24, 0x1000000
    s_add_u32 s36, s24, 0
    s_add_u32 s37, s36, 0x7000000
    buffer_load_dwordx4 v[48:51], v1, s[8:11], s36 offen offset:0 sc1
    buffer_load_dwordx4 v[16:19], v1, s[8:11], s37 offen offset:0 sc1
    buffer_load_dwordx4 v[52:55], v1, s[8:11], s36 offen offset:1024 sc1
    buffer_load_dwordx4 v[20:23], v1, s[8:11], s37 offen offset:1024 sc1
    buffer_load_dwordx4 v[56:59], v1, s[8:11], s36 offen offset:2048 sc1
    buffer_load_dwordx4 v[24:27], v1, s[8:11], s37 offen offset:2048 sc1
    buffer_load_dwordx4 v[60:63], v1, s[8:11], s36 offen offset:3072 sc1
    buffer_load_dwordx4 v[28:31], v1, s[8:11], s37 offen offset:3072 sc1
    s_add_u32 s36, s24, 4096
    s_add_u32 s37, s36, 0x7000000
    buffer_load_dwordx4 v[64:67], v1, s[8:11], s36 offen offset:0 sc1
    buffer_load_dwordx4 v[32:35], v1, s[8:11], s37 offen offset:0 sc1
    buffer_load_dwordx4 v[68:71], v1, s[8:11], s36 offen offset:1024 sc1
    buffer_load_dwordx4 v[36:39], v1, s[8:11], s37 offen offset:1024 sc1
    buffer_load_dwordx4 v[72:75], v1, s[8:11], s36 offen offset:2048 sc1
    buffer_load_dwordx4 v[40:43], v1, s[8:11], s37 offen offset:2048 sc1
    buffer_load_dwordx4 v[76:79], v1, s[8:11], s36 offen offset:3072 sc1
    buffer_load_dwordx4 v[44:47], v1, s[8:11], s37 offen offset:3072 sc1
    s_add_u32 s24, s24, 8192
    buffer_load_dwordx4 v[120:123], v2, s[8:11], s24 offen sc1
    buffer_load_dwordx4 v[124:127], v2, s[8:11], s24 offen offset:1024 sc1
    s_waitcnt vmcnt(0)
    s_cmp_lt_u32 s21, 2
    s_cbranch_scc1 L_P2_noswap
    v_swap_b32 v120, v122
    v_swap_b32 v121, v123
    v_swap_b32 v124, v126
    v_swap_b32 v125, v127
L_P2_noswap:
    s_nop 1
    v_mfma_f32_16x16x32_bf16 v[80:83], v[48:51], v[16:19], 0
    v_mfma_f32_16x16x32_bf16 v[80:83], v[52:55], v[20:23], v[80:83]
    v_mfma_f32_16x16x32_bf16 v[80:83], v[56:59], v[24:27], v[80:83]
    v_mfma_f32_16x16x32_bf16 v[80:83], v[60:63], v[28:31], v[80:83]
    v_mfma_f32_16x16x32_bf16 v[84:87], v[48:51], v[32:35], 0
    v_mfma_f32_16x16x32_bf16 v[84:87], v[52:55], v[36:39], v[84:87]
    v_mfma_f32_16x16x32_bf16 v[84:87], v[56:59], v[40:43], v[84:87]
    v_mfma_f32_16x16x32_bf16 v[84:87], v[60:63], v[44:47], v[84:87]
    v_mfma_f32_16x16x32_bf16 v[88:91], v[64:67], v[32:35], 0
    v_mfma_f32_16x16x32_bf16 v[88:91], v[68:71], v[36:39], v[88:91]
    v_mfma_f32_16x16x32_bf16 v[88:91], v[72:75], v[40:43], v[88:91]
    v_mfma_f32_16x16x32_bf16 v[88:91], v[76:79], v[44:47], v[88:91]
    s_lshl_b32 s24, s23, 13
    s_add_u32 s24, s24, 0x100000
L_P2_poll:
    buffer_load_dwordx4 v[48:51], v2, s[8:11], s24 offen sc1
    buffer_load_dwordx4 v[52:55], v2, s[8:11], s24 offen offset:1024 sc1
    s_add_u32 s32, s32, 1
    s_cmp_gt_u32 s32, 200000
    s_waitcnt vmcnt(0)
    v_max3_u32 v14, v48, v49, v50
    v_max3_u32 v15, v51, v52, v53
    v_max3_u32 v14, v14, v54, v55
    v_max_u32 v14, v14, v15
    s_cbranch_scc1 L_P2_got
    v_cmp_eq_u32 vcc, -1, v14
    s_cbranch_vccz L_P2_got
    s_sleep 4
    s_branch L_P2_poll
L_P2_got:
    ds_write_b128 v2, v[48:51] offset:20480
    ds_write_b128 v2, v[52:55] offset:21504
    s_waitcnt lgkmcnt(0)
    s_barrier
    ds_read_b128 v[48:51], v8 offset:0
    ds_read_b128 v[52:55], v8 offset:2048
    ds_read_b128 v[56:59], v8 offset:4096
    ds_read_b128 v[60:63], v8 offset:6144
    ds_read_b128 v[64:67], v8 offset:512
    s_waitcnt lgkmcnt(4)
    v_mfma_f32_16x16x32_bf16 v[100:103], a[128:131], v[48:51], 0
    v_mfma_f32_16x16x32_bf16 v[104:107], a[132:135], v[48:51], 0
    v_mfma_f32_16x16x32_bf16 v[108:111], v[48:51], v[128:131], 0
    v_mfma_f32_16x16x32_bf16 v[112:115], v[48:51], v[132:135], 0
    ds_read_b128 v[68:71], v8 offset:2560
    s_waitcnt lgkmcnt(4)
    v_mfma_f32_16x16x32_bf16 v[100:103], a[136:139], v[52:55], v[100:103]
    v_mfma_f32_16x16x32_bf16 v[104:107], a[140:143], v[52:55], v[104:107]
    v_mfma_f32_16x16x32_bf16 v[108:111], v[52:55], v[136:139], v[108:111]
    v_mfma_f32_16x16x32_bf16 v[112:115], v[52:55], v[140:143], v[112:115]
    ds_read_b128 v[72:75], v8 offset:4608
    s_waitcnt lgkmcnt(4)
    v_mfma_f32_16x16x32_bf16 v[100:103], a[144:147], v[56:59], v[100:103]
    v_mfma_f32_16x16x32_bf16 v[104:107], a[148:151], v[56:59], v[104:107]
    v_mfma_f32_16x16x32_bf16 v[108:111], v[56:59], v[144:147], v[108:111]
    v_mfma_f32_16x16x32_bf16 v[112:115], v[56:59], v[148:151], v[112:115]
    ds_read_b128 v[76:79], v8 offset:6656
    s_waitcnt lgkmcnt(4)
    v_mfma_f32_16x16x32_bf16 v[100:103], a[152:155], v[60:63], v[100:103]
    v_mfma_f32_16x16x32_bf16 v[104:107], a[156:159], v[60:63], v[104:107]
    v_mfma_f32_16x16x32_bf16 v[108:111], v[60:63], v[152:155], v[108:111]
    v_mfma_f32_16x16x32_bf16 v[112:115], v[60:63], v[156:159], v[112:115]
    ds_read_b128 v[48:51], v8 offset:1024
    s_waitcnt lgkmcnt(4)
    v_mfma_f32_16x16x32_bf16 v[100:103], a[160:163], v[64:67], v[100:103]
    v_mfma_f32_16x16x32_bf16 v[104:107], a[164:167], v[64:67], v[104:107]
    v_mfma_f32_16x16x32_bf16 v[108:111], v[64:67], v[160:163], v[108:111]
    v_mfma_f32_16x16x32_bf16 v[112:115], v[64:67], v[164:167], v[112:115]
    ds_read_b128 v[52:55], v8 offset:3072
    s_waitcnt lgkmcnt(4)
    v_mfma_f32_16x16x32_bf16 v[100:103], a[168:171], v[68:71], v[100:103]
    v_mfma_f32_16x16x32_bf16 v[104:107], a[172:175], v[68:71], v[104:107]
    v_mfma_f32_16x16x32_bf16 v[108:111], v[68:71], v[168:171], v[108:111]
    v_mfma_f32_16x16x32_bf16 v[112:115], v[68:71], v[172:175], v[112:115]
    ds_read_b128 v[56:59], v8 offset:5120
    s_waitcnt lgkmcnt(4)
    v_mfma_f32_16x16x32_bf16 v[100:103], a[176:179], v[72:75], v[100:103]
    v_mfma_f32_16x16x32_bf16 v[104:107], a[180:183], v[72:75], v[104:107]
    v_mfma_f32_16x16x32_bf16 v[108:111], v[72:75], v[176:179], v[108:111]
    v_mfma_f32_16x16x32_bf16 v[112:115], v[72:75], v[180:183], v[112:115]
    ds_read_b128 v[60:63], v8 offset:7168
    s_waitcnt lgkmcnt(4)
    v_mfma_f32_16x16x32_bf16 v[100:103], a[184:187], v[76:79], v[100:103]
    v_mfma_f32_16x16x32_bf16 v[104:107], a[188:191], v[76:79], v[104:107]
    v_mfma_f32_16x16x32_bf16 v[108:111], v[76:79], v[184:187], v[108:111]
    v_mfma_f32_16x16x32_bf16 v[112:115], v[76:79], v[188:191], v[112:115]
    ds_read_b128 v[64:67], v8 offset:1536
    s_waitcnt lgkmcnt(4)
    v_mfma_f32_16x16x32_bf16 v[100:103], a[192:195], v[48:51], v[100:103]
    v_mfma_f32_16x16x32_bf16 v[104:107], a[196:199], v[48:51], v[104:107]
    v_mfma_f32_16x16x32_bf16 v[108:111], v[48:51], v[192:195], v[108:111]
    v_mfma_f32_16x16x32_bf16 v[112:115], v[48:51], v[196:199], v[112:115]
    ds_read_b128 v[68:71], v8 offset:3584
    s_waitcnt lgkmcnt(4)
    v_mfma_f32_16x16x32_bf16 v[100:103], a[200:203], v[52:55], v[100:103]
    v_mfma_f32_16x16x32_bf16 v[104:107], a[204:207], v[52:55], v[104:107]
    v_mfma_f32_16x16x32_bf16 v[108:111], v[52:55], v[200:203], v[108:111]
    v_mfma_f32_16x16x32_bf16 v[112:115], v[52:55], v[204:207], v[112:115]
    ds_read_b128 v[72:75], v8 offset:5632
    s_waitcnt lgkmcnt(4)
    v_mfma_f32_16x16x32_bf16 v[100:103], a[208:211], v[56:59], v[100:103]
    v_mfma_f32_16x16x32_bf16 v[104:107], a[212:215], v[56:59], v[104:107]
    v_mfma_f32_16x16x32_bf16 v[108:111], v[56:59], v[208:211], v[108:111]
    v_mfma_f32_16x16x32_bf16 v[112:115], v[56:59], v[212:215], v[112:115]
    ds_read_b128 v[76:79], v8 offset:7680
    s_waitcnt lgkmcnt(4)
    v_mfma_f32_16x16x32_bf16 v[100:103], a[216:219], v[60:63], v[100:103]
    v_mfma_f32_16x16x32_bf16 v[104:107], a[220:223], v[60:63], v[104:107]
    v_mfma_f32_16x16x32_bf16 v[108:111], v[60:63], v[216:219], v[108:111]
    v_mfma_f32_16x16x32_bf16 v[112:115], v[60:63], v[220:223], v[112:115]
    s_waitcnt lgkmcnt(3)
    v_mfma_f32_16x16x32_bf16 v[100:103], a[224:227], v[64:67], v[100:103]
    v_mfma_f32_16x16x32_bf16 v[104:107], a[228:231], v[64:67], v[104:107]
    v_mfma_f32_16x16x32_bf16 v[108:111], v[64:67], v[224:227], v[108:111]
    v_mfma_f32_16x16x32_bf16 v[112:115], v[64:67], v[228:231], v[112:115]
    s_waitcnt lgkmcnt(2)
    v_mfma_f32_16x16x32_bf16 v[100:103], a[232:235], v[68:71], v[100:103]
    v_mfma_f32_16x16x32_bf16 v[104:107], a[236:239], v[68:71], v[104:107]
    v_mfma_f32_16x16x32_bf16 v[108:111], v[68:71], v[232:235], v[108:111]
    v_mfma_f32_16x16x32_bf16 v[112:115], v[68:71], v[236:239], v[112:115]
    s_waitcnt lgkmcnt(1)
    v_mfma_f32_16x16x32_bf16 v[100:103], a[240:243], v[72:75], v[100:103]
    v_mfma_f32_16x16x32_bf16 v[104:107], a[244:247], v[72:75], v[104:107]
    v_mfma_f32_16x16x32_bf16 v[108:111], v[72:75], v[240:243], v[108:111]
    v_mfma_f32_16x16x32_bf16 v[112:115], v[72:75], v[244:247], v[112:115]
    s_waitcnt lgkmcnt(0)
    v_mfma_f32_16x16x32_bf16 v[100:103], a[248:251], v[76:79], v[100:103]
    v_mfma_f32_16x16x32_bf16 v[104:107], a[252:255], v[76:79], v[104:107]
    v_mfma_f32_16x16x32_bf16 v[108:111], v[76:79], v[248:251], v[108:111]
    v_mfma_f32_16x16x32_bf16 v[112:115], v[76:79], v[252:255], v[112:115]
    s_nop 4
    v_mul_f32 v100, s33, v100
    v_mul_f32 v101, s33, v101
    v_mul_f32 v102, s33, v102
    v_mul_f32 v103, s33, v103
    v_mul_f32 v104, s33, v104
    v_mul_f32 v105, s33, v105
    v_mul_f32 v106, s33, v106
    v_mul_f32 v107, s33, v107
    v_cvt_pk_bf16_f32 v48, v100, v104
    v_cvt_pk_bf16_f32 v49, v101, v105
    v_cvt_pk_bf16_f32 v50, v102, v106
    v_cvt_pk_bf16_f32 v51, v103, v107
    ds_write_b128 v9, v[48:51] offset:16384
    v_cvt_pk_bf16_f32 v116, v108, v109
    v_cvt_pk_bf16_f32 v117, v110, v111
    v_cvt_pk_bf16_f32 v118, v112, v113
    v_cvt_pk_bf16_f32 v119, v114, v115
    s_waitcnt lgkmcnt(0)
    s_barrier
    ds_read_b128 v[64:67], v1 offset:16384
    ds_read_b128 v[68:71], v1 offset:17408
    ds_read_b128 v[72:75], v1 offset:18432
    ds_read_b128 v[76:79], v1 offset:19456
    v_cndmask_b32 v80, v13, v80, s[64:65]
    v_cndmask_b32 v81, v13, v81, s[66:67]
    v_cndmask_b32 v82, v13, v82, s[68:69]
    v_cndmask_b32 v83, v13, v83, s[70:71]
    v_cndmask_b32 v88, v13, v88, s[64:65]
    v_cndmask_b32 v89, v13, v89, s[66:67]
    v_cndmask_b32 v90, v13, v90, s[68:69]
    v_cndmask_b32 v91, v13, v91, s[70:71]
    s_waitcnt lgkmcnt(0)
    v_mfma_f32_16x16x32_bf16 v[92:95], v[64:67], v[16:19], 0
    v_mfma_f32_16x16x32_bf16 v[92:95], v[68:71], v[20:23], v[92:95]
    v_mfma_f32_16x16x32_bf16 v[92:95], v[72:75], v[24:27], v[92:95]
    v_mfma_f32_16x16x32_bf16 v[92:95], v[76:79], v[28:31], v[92:95]
    v_mfma_f32_16x16x32_bf16 v[96:99], v[64:67], v[32:35], 0
    v_mfma_f32_16x16x32_bf16 v[96:99], v[68:71], v[36:39], v[96:99]
    v_mfma_f32_16x16x32_bf16 v[96:99], v[72:75], v[40:43], v[96:99]
    v_mfma_f32_16x16x32_bf16 v[96:99], v[76:79], v[44:47], v[96:99]
    s_nop 3
    v_cndmask_b32 v92, v13, v92, s[72:73]
    v_cndmask_b32 v93, v13, v93, s[72:73]
    v_cndmask_b32 v94, v13, v94, s[72:73]
    v_cndmask_b32 v95, v13, v95, s[72:73]
    v_cndmask_b32 v96, v13, v96, s[72:73]
    v_cndmask_b32 v97, v13, v97, s[72:73]
    v_cndmask_b32 v98, v13, v98, s[72:73]
    v_cndmask_b32 v99, v13, v99, s[72:73]
    v_max_f32 v48, v80, v81
    v_max3_f32 v48, v48, v82, v83
    v_max3_f32 v48, v48, v92, v93
    v_max3_f32 v48, v48, v94, v95
    v_max_f32 v49, v84, v85
    v_max3_f32 v49, v49, v86, v87
    v_max3_f32 v49, v49, v88, v89
    v_max3_f32 v49, v49, v90, v91
    v_max3_f32 v49, v49, v96, v97
    v_max3_f32 v49, v49, v98, v99
    v_mov_b32 v14, v48
    s_nop 1
    v_permlane16_swap_b32 v48, v14
    v_max_f32 v48, v48, v14
    v_mov_b32 v14, v49
    s_nop 1
    v_permlane16_swap_b32 v49, v14
    v_max_f32 v49, v49, v14
    v_mov_b32 v14, v48
    s_nop 1
    v_permlane32_swap_b32 v48, v14
    v_max_f32 v48, v48, v14
    v_mov_b32 v14, v49
    s_nop 1
    v_permlane32_swap_b32 v49, v14
    v_max_f32 v49, v49, v14
    v_sub_f32 v80, v80, v48
    v_exp_f32 v80, v80
    v_sub_f32 v81, v81, v48
    v_exp_f32 v81, v81
    v_sub_f32 v82, v82, v48
    v_exp_f32 v82, v82
    v_sub_f32 v83, v83, v48
    v_exp_f32 v83, v83
    v_sub_f32 v92, v92, v48
    v_exp_f32 v92, v92
    v_sub_f32 v93, v93, v48
    v_exp_f32 v93, v93
    v_sub_f32 v94, v94, v48
    v_exp_f32 v94, v94
    v_sub_f32 v95, v95, v48
    v_exp_f32 v95, v95
    v_sub_f32 v84, v84, v49
    v_exp_f32 v84, v84
    v_sub_f32 v85, v85, v49
    v_exp_f32 v85, v85
    v_sub_f32 v86, v86, v49
    v_exp_f32 v86, v86
    v_sub_f32 v87, v87, v49
    v_exp_f32 v87, v87
    v_sub_f32 v88, v88, v49
    v_exp_f32 v88, v88
    v_sub_f32 v89, v89, v49
    v_exp_f32 v89, v89
    v_sub_f32 v90, v90, v49
    v_exp_f32 v90, v90
    v_sub_f32 v91, v91, v49
    v_exp_f32 v91, v91
    v_sub_f32 v96, v96, v49
    v_exp_f32 v96, v96
    v_sub_f32 v97, v97, v49
    v_exp_f32 v97, v97
    v_sub_f32 v98, v98, v49
    v_exp_f32 v98, v98
    v_sub_f32 v99, v99, v49
    v_exp_f32 v99, v99
    v_cvt_pk_bf16_f32 v16, v80, v81
    v_cvt_pk_bf16_f32 v17, v82, v83
    v_mov_b64 v[18:19], 0
    v_cvt_pk_bf16_f32 v20, v84, v85
    v_cvt_pk_bf16_f32 v21, v86, v87
    v_cvt_pk_bf16_f32 v22, v88, v89
    v_cvt_pk_bf16_f32 v23, v90, v91
    v_cvt_pk_bf16_f32 v24, v92, v93
    v_cvt_pk_bf16_f32 v25, v94, v95
    v_cvt_pk_bf16_f32 v26, v96, v97
    v_cvt_pk_bf16_f32 v27, v98, v99
    v_mov_b64 v[28:29], s[4:5]
    v_mov_b64 v[30:31], s[4:5]
    s_nop 1
    v_mfma_f32_16x16x32_bf16 v[32:35], v[28:31], v[16:19], 0
    v_mfma_f32_16x16x32_bf16 v[40:43], v[120:123], v[16:19], 0
    v_mfma_f32_16x16x32_bf16 v[44:47], v[124:127], v[16:19], 0
    v_mfma_f32_16x16x32_bf16 v[36:39], v[28:31], v[20:23], 0
    v_mfma_f32_16x16x32_bf16 v[48:51], v[120:123], v[20:23], 0
    v_mfma_f32_16x16x32_bf16 v[52:55], v[124:127], v[20:23], 0
    s_nop 0
    v_mfma_f32_16x16x16_bf16 v[32:35], v[28:29], v[24:25], v[32:35]
    v_mfma_f32_16x16x16_bf16 v[40:43], v[116:117], v[24:25], v[40:43]
    v_mfma_f32_16x16x16_bf16 v[44:47], v[118:119], v[24:25], v[44:47]
    v_mfma_f32_16x16x16_bf16 v[36:39], v[28:29], v[26:27], v[36:39]
    v_mfma_f32_16x16x16_bf16 v[48:51], v[116:117], v[26:27], v[48:51]
    v_mfma_f32_16x16x16_bf16 v[52:55], v[118:119], v[26:27], v[52:55]
    s_nop 2
    v_rcp_f32 v14, v32
    s_nop 0
    v_mul_f32 v40, v40, v14
    v_mul_f32 v41, v41, v14
    v_mul_f32 v42, v42, v14
    v_mul_f32 v43, v43, v14
    v_mul_f32 v44, v44, v14
    v_mul_f32 v45, v45, v14
    v_mul_f32 v46, v46, v14
    v_mul_f32 v47, v47, v14
    v_cvt_pk_bf16_f32 v56, v40, v44
    v_cvt_pk_bf16_f32 v57, v41, v45
    v_cvt_pk_bf16_f32 v58, v42, v46
    v_cvt_pk_bf16_f32 v59, v43, v47
    ds_write_b128 v9, v[56:59] offset:0
    v_rcp_f32 v14, v36
    s_nop 0
    v_mul_f32 v48, v48, v14
    v_mul_f32 v49, v49, v14
    v_mul_f32 v50, v50, v14
    v_mul_f32 v51, v51, v14
    v_mul_f32 v52, v52, v14
    v_mul_f32 v53, v53, v14
    v_mul_f32 v54, v54, v14
    v_mul_f32 v55, v55, v14
    v_cvt_pk_bf16_f32 v60, v48, v52
    v_cvt_pk_bf16_f32 v61, v49, v53
    v_cvt_pk_bf16_f32 v62, v50, v54
    v_cvt_pk_bf16_f32 v63, v51, v55
    ds_write_b128 v9, v[60:63] offset:4096
    s_waitcnt lgkmcnt(0)
    s_barrier
    ds_read_b128 v[16:19], v1 offset:0
    ds_read_b128 v[20:23], v1 offset:1024
    ds_read_b128 v[24:27], v1 offset:2048
    ds_read_b128 v[28:31], v1 offset:3072
    ds_read_b128 v[32:35], v1 offset:4096
    ds_read_b128 v[36:39], v1 offset:5120
    ds_read_b128 v[40:43], v1 offset:6144
    ds_read_b128 v[44:47], v1 offset:7168
    ds_read_b128 v[48:51], v7 offset:0
    ds_read_b128 v[52:55], v7 offset:1024
    ds_read_b128 v[56:59], v7 offset:2048
    ds_read_b128 v[60:63], v7 offset:3072
    s_waitcnt lgkmcnt(3)
    v_mfma_f32_16x16x32_bf16 v[64:67], v[16:19], v[48:51], 0
    v_mfma_f32_16x16x32_bf16 v[96:99], v[32:35], v[48:51], 0
    ds_read_b128 v[48:51], v7 offset:4096
    s_waitcnt lgkmcnt(3)
    v_mfma_f32_16x16x32_bf16 v[68:71], v[16:19], v[52:55], 0
    v_mfma_f32_16x16x32_bf16 v[100:103], v[32:35], v[52:55], 0
    ds_read_b128 v[52:55], v7 offset:5120
    s_waitcnt lgkmcnt(3)
    v_mfma_f32_16x16x32_bf16 v[72:75], v[16:19], v[56:59], 0
    v_mfma_f32_16x16x32_bf16 v[104:107], v[32:35], v[56:59], 0
    ds_read_b128 v[56:59], v7 offset:6144
    s_waitcnt lgkmcnt(3)
    v_mfma_f32_16x16x32_bf16 v[76:79], v[16:19], v[60:63], 0
    v_mfma_f32_16x16x32_bf16 v[108:111], v[32:35], v[60:63], 0
    ds_read_b128 v[60:63], v7 offset:7168
    s_waitcnt lgkmcnt(3)
    v_mfma_f32_16x16x32_bf16 v[80:83], v[16:19], v[48:51], 0
    v_mfma_f32_16x16x32_bf16 v[112:115], v[32:35], v[48:51], 0
    ds_read_b128 v[48:51], v7 offset:8192
    s_waitcnt lgkmcnt(3)
    v_mfma_f32_16x16x32_bf16 v[84:87], v[16:19], v[52:55], 0
    v_mfma_f32_16x16x32_bf16 v[116:119], v[32:35], v[52:55], 0
    ds_read_b128 v[52:55], v7 offset:9216
    s_waitcnt lgkmcnt(3)
    v_mfma_f32_16x16x32_bf16 v[88:91], v[16:19], v[56:59], 0
    v_mfma_f32_16x16x32_bf16 v[120:123], v[32:35], v[56:59], 0
    ds_read_b128 v[56:59], v7 offset:10240
    s_waitcnt lgkmcnt(3)
    v_mfma_f32_16x16x32_bf16 v[92:95], v[16:19], v[60:63], 0
    v_mfma_f32_16x16x32_bf16 v[124:127], v[32:35], v[60:63], 0
    ds_read_b128 v[60:63], v7 offset:11264
    s_waitcnt lgkmcnt(3)
    v_mfma_f32_16x16x32_bf16 v[64:67], v[20:23], v[48:51], v[64:67]
    v_mfma_f32_16x16x32_bf16 v[96:99], v[36:39], v[48:51], v[96:99]
    ds_read_b128 v[48:51], v7 offset:12288
    s_waitcnt lgkmcnt(3)
    v_mfma_f32_16x16x32_bf16 v[68:71], v[20:23], v[52:55], v[68:71]
    v_mfma_f32_16x16x32_bf16 v[100:103], v[36:39], v[52:55], v[100:103]
    ds_read_b128 v[52:55], v7 offset:13312
    s_waitcnt lgkmcnt(3)
    v_mfma_f32_16x16x32_bf16 v[72:75], v[20:23], v[56:59], v[72:75]
    v_mfma_f32_16x16x32_bf16 v[104:107], v[36:39], v[56:59], v[104:107]
    ds_read_b128 v[56:59], v7 offset:14336
    s_waitcnt lgkmcnt(3)
    v_mfma_f32_16x16x32_bf16 v[76:79], v[20:23], v[60:63], v[76:79]
    v_mfma_f32_16x16x32_bf16 v[108:111], v[36:39], v[60:63], v[108:111]
    ds_read_b128 v[60:63], v7 offset:15360
    s_waitcnt lgkmcnt(3)
    v_mfma_f32_16x16x32_bf16 v[80:83], v[20:23], v[48:51], v[80:83]
    v_mfma_f32_16x16x32_bf16 v[112:115], v[36:39], v[48:51], v[112:115]
    ds_read_b128 v[48:51], v7 offset:16384
    s_waitcnt lgkmcnt(3)
    v_mfma_f32_16x16x32_bf16 v[84:87], v[20:23], v[52:55], v[84:87]
    v_mfma_f32_16x16x32_bf16 v[116:119], v[36:39], v[52:55], v[116:119]
    ds_read_b128 v[52:55], v7 offset:17408
    s_waitcnt lgkmcnt(3)
    v_mfma_f32_16x16x32_bf16 v[88:91], v[20:23], v[56:59], v[88:91]
    v_mfma_f32_16x16x32_bf16 v[120:123], v[36:39], v[56:59], v[120:123]
    ds_read_b128 v[56:59], v7 offset:18432
    s_waitcnt lgkmcnt(3)
    v_mfma_f32_16x16x32_bf16 v[92:95], v[20:23], v[60:63], v[92:95]
    v_mfma_f32_16x16x32_bf16 v[124:127], v[36:39], v[60:63], v[124:127]
    ds_read_b128 v[60:63], v7 offset:19456
    s_waitcnt lgkmcnt(3)
    v_mfma_f32_16x16x32_bf16 v[64:67], v[24:27], v[48:51], v[64:67]
    v_mfma_f32_16x16x32_bf16 v[96:99], v[40:43], v[48:51], v[96:99]
    ds_read_b128 v[48:51], v7 offset:20480
    s_waitcnt lgkmcnt(3)
    v_mfma_f32_16x16x32_bf16 v[68:71], v[24:27], v[52:55], v[68:71]
    v_mfma_f32_16x16x32_bf16 v[100:103], v[40:43], v[52:55], v[100:103]
    ds_read_b128 v[52:55], v7 offset:21504
    s_waitcnt lgkmcnt(3)
    v_mfma_f32_16x16x32_bf16 v[72:75], v[24:27], v[56:59], v[72:75]
    v_mfma_f32_16x16x32_bf16 v[104:107], v[40:43], v[56:59], v[104:107]
    ds_read_b128 v[56:59], v7 offset:22528
    s_waitcnt lgkmcnt(3)
    v_mfma_f32_16x16x32_bf16 v[76:79], v[24:27], v[60:63], v[76:79]
    v_mfma_f32_16x16x32_bf16 v[108:111], v[40:43], v[60:63], v[108:111]
    ds_read_b128 v[60:63], v7 offset:23552
    s_waitcnt lgkmcnt(3)
    v_mfma_f32_16x16x32_bf16 v[80:83], v[24:27], v[48:51], v[80:83]
    v_mfma_f32_16x16x32_bf16 v[112:115], v[40:43], v[48:51], v[112:115]
    ds_read_b128 v[48:51], v7 offset:24576
    s_waitcnt lgkmcnt(3)
    v_mfma_f32_16x16x32_bf16 v[84:87], v[24:27], v[52:55], v[84:87]
    v_mfma_f32_16x16x32_bf16 v[116:119], v[40:43], v[52:55], v[116:119]
    ds_read_b128 v[52:55], v7 offset:25600
    s_waitcnt lgkmcnt(3)
    v_mfma_f32_16x16x32_bf16 v[88:91], v[24:27], v[56:59], v[88:91]
    v_mfma_f32_16x16x32_bf16 v[120:123], v[40:43], v[56:59], v[120:123]
    ds_read_b128 v[56:59], v7 offset:26624
    s_waitcnt lgkmcnt(3)
    v_mfma_f32_16x16x32_bf16 v[92:95], v[24:27], v[60:63], v[92:95]
    v_mfma_f32_16x16x32_bf16 v[124:127], v[40:43], v[60:63], v[124:127]
    ds_read_b128 v[60:63], v7 offset:27648
    s_waitcnt lgkmcnt(3)
    v_mfma_f32_16x16x32_bf16 v[64:67], v[28:31], v[48:51], v[64:67]
    v_mfma_f32_16x16x32_bf16 v[96:99], v[44:47], v[48:51], v[96:99]
    ds_read_b128 v[48:51], v7 offset:28672
    s_waitcnt lgkmcnt(3)
    v_mfma_f32_16x16x32_bf16 v[68:71], v[28:31], v[52:55], v[68:71]
    v_mfma_f32_16x16x32_bf16 v[100:103], v[44:47], v[52:55], v[100:103]
    ds_read_b128 v[52:55], v7 offset:29696
    s_waitcnt lgkmcnt(3)
    v_mfma_f32_16x16x32_bf16 v[72:75], v[28:31], v[56:59], v[72:75]
    v_mfma_f32_16x16x32_bf16 v[104:107], v[44:47], v[56:59], v[104:107]
    ds_read_b128 v[56:59], v7 offset:30720
    s_waitcnt lgkmcnt(3)
    v_mfma_f32_16x16x32_bf16 v[76:79], v[28:31], v[60:63], v[76:79]
    v_mfma_f32_16x16x32_bf16 v[108:111], v[44:47], v[60:63], v[108:111]
    ds_read_b128 v[60:63], v7 offset:31744
    s_waitcnt lgkmcnt(3)
    v_mfma_f32_16x16x32_bf16 v[80:83], v[28:31], v[48:51], v[80:83]
    v_mfma_f32_16x16x32_bf16 v[112:115], v[44:47], v[48:51], v[112:115]
    s_waitcnt lgkmcnt(2)
    v_mfma_f32_16x16x32_bf16 v[84:87], v[28:31], v[52:55], v[84:87]
    v_mfma_f32_16x16x32_bf16 v[116:119], v[44:47], v[52:55], v[116:119]
    s_waitcnt lgkmcnt(1)
    v_mfma_f32_16x16x32_bf16 v[88:91], v[28:31], v[56:59], v[88:91]
    v_mfma_f32_16x16x32_bf16 v[120:123], v[44:47], v[56:59], v[120:123]
    s_waitcnt lgkmcnt(0)
    v_mfma_f32_16x16x32_bf16 v[92:95], v[28:31], v[60:63], v[92:95]
    v_mfma_f32_16x16x32_bf16 v[124:127], v[44:47], v[60:63], v[124:127]
    s_lshl_b32 s24, s23, 20
    s_lshl_b32 s36, s20, 10
    s_add_u32 s24, s24, s36
    s_add_u32 s24, s24, 0x4000000
    v_cvt_pk_bf16_f32 v16, v64, v68
    v_cvt_pk_bf16_f32 v17, v72, v76
    v_cvt_pk_bf16_f32 v18, v80, v84
    v_cvt_pk_bf16_f32 v19, v88, v92
    s_add_u32 s36, s24, 0x0
    buffer_store_dwordx4 v[16:19], v10, s[8:11], s36 offen sc1
    v_cvt_pk_bf16_f32 v20, v65, v69
    v_cvt_pk_bf16_f32 v21, v73, v77
    v_cvt_pk_bf16_f32 v22, v81, v85
    v_cvt_pk_bf16_f32 v23, v89, v93
    s_add_u32 s36, s24, 0x8000
    buffer_store_dwordx4 v[20:23], v10, s[8:11], s36 offen sc1
    v_cvt_pk_bf16_f32 v24, v66, v70
    v_cvt_pk_bf16_f32 v25, v74, v78
    v_cvt_pk_bf16_f32 v26, v82, v86
    v_cvt_pk_bf16_f32 v27, v90, v94
    s_add_u32 s36, s24, 0x10000
    buffer_store_dwordx4 v[24:27], v10, s[8:11], s36 offen sc1
    v_cvt_pk_bf16_f32 v28, v67, v71
    v_cvt_pk_bf16_f32 v29, v75, v79
    v_cvt_pk_bf16_f32 v30, v83, v87
    v_cvt_pk_bf16_f32 v31, v91, v95
    s_add_u32 s36, s24, 0x18000
    buffer_store_dwordx4 v[28:31], v10, s[8:11], s36 offen sc1
    v_cvt_pk_bf16_f32 v32, v96, v100
    v_cvt_pk_bf16_f32 v33, v104, v108
    v_cvt_pk_bf16_f32 v34, v112, v116
    v_cvt_pk_bf16_f32 v35, v120, v124
    s_add_u32 s36, s24, 0x80000
    buffer_store_dwordx4 v[32:35], v10, s[8:11], s36 offen sc1
    v_cvt_pk_bf16_f32 v36, v97, v101
    v_cvt_pk_bf16_f32 v37, v105, v109
    v_cvt_pk_bf16_f32 v38, v113, v117
    v_cvt_pk_bf16_f32 v39, v121, v125
    s_add_u32 s36, s24, 0x88000
    buffer_store_dwordx4 v[36:39], v10, s[8:11], s36 offen sc1
    v_cvt_pk_bf16_f32 v40, v98, v102
    v_cvt_pk_bf16_f32 v41, v106, v110
    v_cvt_pk_bf16_f32 v42, v114, v118
    v_cvt_pk_bf16_f32 v43, v122, v126
    s_add_u32 s36, s24, 0x90000
    buffer_store_dwordx4 v[40:43], v10, s[8:11], s36 offen sc1
    v_cvt_pk_bf16_f32 v44, v99, v103
    v_cvt_pk_bf16_f32 v45, v107, v111
    v_cvt_pk_bf16_f32 v46, v115, v119
    v_cvt_pk_bf16_f32 v47, v123, v127
    s_add_u32 s36, s24, 0x98000
    buffer_store_dwordx4 v[44:47], v10, s[8:11], s36 offen sc1
    s_lshl_b32 s25, s23, 7
    s_add_u32 s25, s25, 0x192000
    s_lshl_b32 s36, s20, 2
    s_add_u32 s24, s25, s36
    s_waitcnt vmcnt(0)
    s_barrier
    v_cmp_ne_u32 vcc, 0, v0
    v_mov_b32 v15, 0x40000000
    v_mov_b32 v14, 1
    v_cndmask_b32 v15, v0, v15, vcc
    buffer_store_dword v14, v15, s[8:11], s24 offen sc1
    v_and_b32 v15, 15, v0
    v_mov_b32 v48, 0
    v_mov_b32 v14, 0x3f80
    v_cmp_eq_u32 vcc, 0, v15
    s_nop 1
    v_cndmask_b32 v48, v48, v14, vcc
    v_mov_b32 v14, 0x3f800000
    v_cmp_eq_u32 vcc, 1, v15
    s_nop 1
    v_cndmask_b32 v48, v48, v14, vcc
    v_mov_b32 v49, 0
    v_mov_b32 v14, 0x3f80
    v_cmp_eq_u32 vcc, 4, v15
    s_nop 1
    v_cndmask_b32 v49, v49, v14, vcc
    v_mov_b32 v14, 0x3f800000
    v_cmp_eq_u32 vcc, 5, v15
    s_nop 1
    v_cndmask_b32 v49, v49, v14, vcc
    v_mov_b32 v50, 0
    v_mov_b32 v14, 0x3f80
    v_cmp_eq_u32 vcc, 8, v15
    s_nop 1
    v_cndmask_b32 v50, v50, v14, vcc
    v_mov_b32 v14, 0x3f800000
    v_cmp_eq_u32 vcc, 9, v15
    s_nop 1
    v_cndmask_b32 v50, v50, v14, vcc
    v_mov_b32 v51, 0
    v_mov_b32 v14, 0x3f80
    v_cmp_eq_u32 vcc, 12, v15
    s_nop 1
    v_cndmask_b32 v51, v51, v14, vcc
    v_mov_b32 v14, 0x3f800000
    v_cmp_eq_u32 vcc, 13, v15
    s_nop 1
    v_cndmask_b32 v51, v51, v14, vcc
    s_lshl_b32 s24, s23, 5
    s_add_u32 s24, s24, s20
    s_lshl_b32 s24, s24, 10
    buffer_load_dword v52, v12, s[12:15], s24 offen
    buffer_load_dword v53, v12, s[92:95], 0 offen
    v_lshrrev_b32 v15, 2, v1
    v_and_b32 v15, 127, v15
L_P3_poll:
    buffer_load_dword v14, v15, s[8:11], s25 offen sc1
    s_add_u32 s32, s32, 1
    s_cmp_gt_u32 s32, 200000
    s_waitcnt vmcnt(0)
    s_cbranch_scc1 L_P3_got
    v_cmp_eq_u32 vcc, 0, v14
    s_cbranch_vccnz L_P3_poll
L_P3_got:
    s_lshl_b32 s36, s24, 5
    s_add_u32 s36, s36, 0x4000000
    buffer_load_dwordx4 v[16:19], v11, s[8:11], s36 offen sc1
    s_add_u32 s36, s36, 4096
    buffer_load_dwordx4 v[20:23], v11, s[8:11], s36 offen sc1
    s_add_u32 s36, s36, 4096
    buffer_load_dwordx4 v[24:27], v11, s[8:11], s36 offen sc1
    s_add_u32 s36, s36, 4096
    buffer_load_dwordx4 v[28:31], v11, s[8:11], s36 offen sc1
    s_add_u32 s36, s36, 4096
    buffer_load_dwordx4 v[32:35], v11, s[8:11], s36 offen sc1
    s_add_u32 s36, s36, 4096
    buffer_load_dwordx4 v[36:39], v11, s[8:11], s36 offen sc1
    s_add_u32 s36, s36, 4096
    buffer_load_dwordx4 v[40:43], v11, s[8:11], s36 offen sc1
    s_add_u32 s36, s36, 4096
    buffer_load_dwordx4 v[44:47], v11, s[8:11], s36 offen sc1
    s_waitcnt vmcnt(7)
    v_mfma_f32_16x16x32_bf16 v[56:59], v[48:51], v[16:19], 0
    s_waitcnt vmcnt(6)
    v_mfma_f32_16x16x32_bf16 v[56:59], v[48:51], v[20:23], v[56:59]
    s_waitcnt vmcnt(5)
    v_mfma_f32_16x16x32_bf16 v[56:59], v[48:51], v[24:27], v[56:59]
    s_waitcnt vmcnt(4)
    v_mfma_f32_16x16x32_bf16 v[56:59], v[48:51], v[28:31], v[56:59]
    s_waitcnt vmcnt(3)
    v_mfma_f32_16x16x32_bf16 v[56:59], v[48:51], v[32:35], v[56:59]
    s_waitcnt vmcnt(2)
    v_mfma_f32_16x16x32_bf16 v[56:59], v[48:51], v[36:39], v[56:59]
    s_waitcnt vmcnt(1)
    v_mfma_f32_16x16x32_bf16 v[56:59], v[48:51], v[40:43], v[56:59]
    s_waitcnt vmcnt(0)
    v_mfma_f32_16x16x32_bf16 v[56:59], v[48:51], v[44:47], v[56:59]
    s_nop 7
    v_cvt_pk_bf16_f32 v62, v56, v57
    v_lshlrev_b32 v65, 16, v62
    v_and_b32 v66, 0xffff0000, v62
    v_lshlrev_b32 v60, 16, v52
    v_and_b32 v61, 0xffff0000, v52
    v_add_f32 v60, v60, v65
    v_add_f32 v61, v61, v66
    v_cvt_pk_bf16_f32 v62, v60, v61
    v_lshlrev_b32 v60, 16, v62
    v_and_b32 v61, 0xffff0000, v62
    v_add_f32 v63, v60, v61
    v_mul_f32 v64, v60, v60
    v_fmac_f32 v64, v61, v61
    v_add_f32_dpp v63, v63, v63 quad_perm:[1,0,3,2] row_mask:0xf bank_mask:0xf
    s_nop 0
    v_add_f32_dpp v64, v64, v64 quad_perm:[1,0,3,2] row_mask:0xf bank_mask:0xf
    v_add_f32_dpp v63, v63, v63 quad_perm:[2,3,0,1] row_mask:0xf bank_mask:0xf
    s_nop 0
    v_add_f32_dpp v64, v64, v64 quad_perm:[2,3,0,1] row_mask:0xf bank_mask:0xf
    v_add_f32_dpp v63, v63, v63 row_half_mirror row_mask:0xf bank_mask:0xf
    s_nop 0
    v_add_f32_dpp v64, v64, v64 row_half_mirror row_mask:0xf bank_mask:0xf
    v_add_f32_dpp v63, v63, v63 row_mirror row_mask:0xf bank_mask:0xf
    s_nop 0
    v_add_f32_dpp v64, v64, v64 row_mirror row_mask:0xf bank_mask:0xf
    v_mov_b32 v14, v63
    s_nop 1
    v_permlane16_swap_b32 v63, v14
    v_add_f32 v63, v63, v14
    v_mov_b32 v14, v64
    s_nop 1
    v_permlane16_swap_b32 v64, v14
    v_add_f32 v64, v64, v14
    v_mov_b32 v14, v63
    s_nop 1
    v_permlane32_swap_b32 v63, v14
    v_add_f32 v63, v63, v14
    v_mov_b32 v14, v64
    s_nop 1
    v_permlane32_swap_b32 v64, v14
    v_add_f32 v64, v64, v14
    v_mov_b32 v15, s21
    v_lshlrev_b32 v15, 3, v15
    v_add_u32 v15, 28672, v15
    ds_write2_b32 v15, v63, v64 offset0:0 offset1:1
    s_add_u32 s36, s24, 0x400000
    buffer_store_dword v62, v12, s[8:11], s36 offen sc1
    s_waitcnt lgkmcnt(0)
    s_barrier
    v_mov_b32 v15, 28672
    ds_read_b128 v[68:71], v15
    ds_read_b128 v[72:75], v15 offset:16
    s_waitcnt lgkmcnt(0)
    v_add_f32 v63, v68, v70
    v_add_f32 v63, v63, v72
    v_add_f32 v63, v63, v74
    v_mul_f32 v63, 0x3b000000, v63
    v_add_f32 v64, v69, v71
    v_add_f32 v64, v64, v73
    v_add_f32 v64, v64, v75
    v_mul_f32 v64, 0x3b000000, v64
    v_fma_f32 v64, -v63, v63, v64
    v_max_f32 v64, 0, v64
    v_cvt_pk_bf16_f32 v14, v63, v64
    v_lshlrev_b32 v63, 16, v14
    v_and_b32 v64, 0xffff0000, v14
    v_add_f32 v64, 0x3727c5ac, v64
    v_cvt_pk_bf16_f32 v14, v64, v64
    v_lshlrev_b32 v64, 16, v14
    v_sqrt_f32 v64, v64
    s_nop 0
    v_cvt_pk_bf16_f32 v14, v64, v64
    v_lshlrev_b32 v64, 16, v14
    v_rcp_f32 v64, v64
    v_sub_f32 v65, v60, v63
    v_sub_f32 v66, v61, v63
    v_cvt_pk_bf16_f32 v14, v65, v66
    v_lshlrev_b32 v65, 16, v14
    v_and_b32 v66, 0xffff0000, v14
    v_mul_f32 v65, v65, v64
    v_mul_f32 v66, v66, v64
    v_cvt_pk_bf16_f32 v67, v65, v66
    v_lshlrev_b32 v65, 16, v67
    v_and_b32 v66, 0xffff0000, v67
    s_add_u32 s36, s24, 0x600000
    buffer_store_dword v67, v12, s[8:11], s36 offen sc1
    v_add_f32 v60, v60, v65
    v_add_f32 v61, v61, v66
    v_cvt_pk_bf16_f32 v62, v60, v61
    buffer_store_dword v62, v12, s[60:63], s24 offen sc1
    v_lshlrev_b32 v60, 16, v53
    v_and_b32 v61, 0xffff0000, v53
    v_mul_f32 v63, v65, v60
    v_fmac_f32 v63, v66, v61
    s_nop 1
    v_add_f32_dpp v63, v63, v63 quad_perm:[1,0,3,2] row_mask:0xf bank_mask:0xf
    s_nop 1
    v_add_f32_dpp v63, v63, v63 quad_perm:[2,3,0,1] row_mask:0xf bank_mask:0xf
    s_nop 1
    v_add_f32_dpp v63, v63, v63 row_half_mirror row_mask:0xf bank_mask:0xf
    s_nop 1
    v_add_f32_dpp v63, v63, v63 row_mirror row_mask:0xf bank_mask:0xf
    v_mov_b32 v14, v63
    s_nop 1
    v_permlane16_swap_b32 v63, v14
    v_add_f32 v63, v63, v14
    v_mov_b32 v14, v63
    s_nop 1
    v_permlane32_swap_b32 v63, v14
    v_add_f32 v63, v63, v14
    s_lshr_b32 s36, s24, 6
    s_lshl_b32 s37, s21, 2
    s_add_u32 s36, s36, s37
    s_add_u32 s36, s36, 0x194000
    v_cmp_ne_u32 vcc, 0, v1
    v_mov_b32 v15, 0x40000000
    s_nop 0
    v_cndmask_b32 v15, v1, v15, vcc
    s_waitcnt vmcnt(0)
    buffer_store_dword v63, v15, s[8:11], s36 offen sc1
    s_barrier
    s_add_u32 s23, s23, 7
    s_cmp_lt_u32 s23, 64
    s_cbranch_scc1 L_P2
    s_cmp_eq_u32 s22, 3
    s_cbranch_scc1 L_stageB
    s_sub_u32 s25, s22, 1
    s_cmp_ge_u32 s25, 2
    s_cbranch_scc1 L_end
    s_cmp_ge_u32 s20, 28
    s_cbranch_scc1 L_end
    s_lshl_b32 s3, s20, 1
    s_add_u32 s25, s25, s3
    s_mov_b32 s64, s84
    s_and_b32 s65, s85, 0xffff
    s_mov_b32 s66, 0x1c0000
    s_mov_b32 s67, 0x20000
    s_mov_b32 s68, s86
    s_and_b32 s69, s87, 0xffff
    s_mov_b32 s70, 0x1c0000
    s_mov_b32 s71, 0x20000
    v_lshrrev_b32 v1, 4, v0
    v_and_b32 v2, 15, v0
    s_mov_b32 s36, 114688
    v_mul_lo_u32 v4, v1, s36
    v_lshl_add_u32 v4, v2, 2, v4
    s_lshl_b32 s37, s25, 6
    s_add_u32 s36, s37, 0
    buffer_load_dword v16, v4, s[64:67], s36 offen
    buffer_load_dword v48, v4, s[68:71], s36 offen
    s_add_u32 s36, s37, 3584
    buffer_load_dword v17, v4, s[64:67], s36 offen
    buffer_load_dword v49, v4, s[68:71], s36 offen
    s_add_u32 s36, s37, 7168
    buffer_load_dword v18, v4, s[64:67], s36 offen
    buffer_load_dword v50, v4, s[68:71], s36 offen
    s_add_u32 s36, s37, 10752
    buffer_load_dword v19, v4, s[64:67], s36 offen
    buffer_load_dword v51, v4, s[68:71], s36 offen
    s_add_u32 s36, s37, 14336
    buffer_load_dword v20, v4, s[64:67], s36 offen
    buffer_load_dword v52, v4, s[68:71], s36 offen
    s_add_u32 s36, s37, 17920
    buffer_load_dword v21, v4, s[64:67], s36 offen
    buffer_load_dword v53, v4, s[68:71], s36 offen
    s_add_u32 s36, s37, 21504
    buffer_load_dword v22, v4, s[64:67], s36 offen
    buffer_load_dword v54, v4, s[68:71], s36 offen
    s_add_u32 s36, s37, 25088
    buffer_load_dword v23, v4, s[64:67], s36 offen
    buffer_load_dword v55, v4, s[68:71], s36 offen
    s_add_u32 s36, s37, 28672
    buffer_load_dword v24, v4, s[64:67], s36 offen
    buffer_load_dword v56, v4, s[68:71], s36 offen
    s_add_u32 s36, s37, 32256
    buffer_load_dword v25, v4, s[64:67], s36 offen
    buffer_load_dword v57, v4, s[68:71], s36 offen
    s_add_u32 s36, s37, 35840
    buffer_load_dword v26, v4, s[64:67], s36 offen
    buffer_load_dword v58, v4, s[68:71], s36 offen
    s_add_u32 s36, s37, 39424
    buffer_load_dword v27, v4, s[64:67], s36 offen
    buffer_load_dword v59, v4, s[68:71], s36 offen
    s_add_u32 s36, s37, 43008
    buffer_load_dword v28, v4, s[64:67], s36 offen
    buffer_load_dword v60, v4, s[68:71], s36 offen
    s_add_u32 s36, s37, 46592
    buffer_load_dword v29, v4, s[64:67], s36 offen
    buffer_load_dword v61, v4, s[68:71], s36 offen
    s_add_u32 s36, s37, 50176
    buffer_load_dword v30, v4, s[64:67], s36 offen
    buffer_load_dword v62, v4, s[68:71], s36 offen
    s_add_u32 s36, s37, 53760
    buffer_load_dword v31, v4, s[64:67], s36 offen
    buffer_load_dword v63, v4, s[68:71], s36 offen
    s_waitcnt vmcnt(16)
    s_add_u32 s36, s37, 57344
    buffer_load_dword v32, v4, s[64:67], s36 offen
    buffer_load_dword v64, v4, s[68:71], s36 offen
    s_add_u32 s36, s37, 60928
    buffer_load_dword v33, v4, s[64:67], s36 offen
    buffer_load_dword v65, v4, s[68:71], s36 offen
    s_add_u32 s36, s37, 64512
    buffer_load_dword v34, v4, s[64:67], s36 offen
    buffer_load_dword v66, v4, s[68:71], s36 offen
    s_add_u32 s36, s37, 68096
    buffer_load_dword v35, v4, s[64:67], s36 offen
    buffer_load_dword v67, v4, s[68:71], s36 offen
    s_add_u32 s36, s37, 71680
    buffer_load_dword v36, v4, s[64:67], s36 offen
    buffer_load_dword v68, v4, s[68:71], s36 offen
    s_add_u32 s36, s37, 75264
    buffer_load_dword v37, v4, s[64:67], s36 offen
    buffer_load_dword v69, v4, s[68:71], s36 offen
    s_add_u32 s36, s37, 78848
    buffer_load_dword v38, v4, s[64:67], s36 offen
    buffer_load_dword v70, v4, s[68:71], s36 offen
    s_add_u32 s36, s37, 82432
    buffer_load_dword v39, v4, s[64:67], s36 offen
    buffer_load_dword v71, v4, s[68:71], s36 offen
    s_add_u32 s36, s37, 86016
    buffer_load_dword v40, v4, s[64:67], s36 offen
    buffer_load_dword v72, v4, s[68:71], s36 offen
    s_add_u32 s36, s37, 89600
    buffer_load_dword v41, v4, s[64:67], s36 offen
    buffer_load_dword v73, v4, s[68:71], s36 offen
    s_add_u32 s36, s37, 93184
    buffer_load_dword v42, v4, s[64:67], s36 offen
    buffer_load_dword v74, v4, s[68:71], s36 offen
    s_add_u32 s36, s37, 96768
    buffer_load_dword v43, v4, s[64:67], s36 offen
    buffer_load_dword v75, v4, s[68:71], s36 offen
    s_add_u32 s36, s37, 100352
    buffer_load_dword v44, v4, s[64:67], s36 offen
    buffer_load_dword v76, v4, s[68:71], s36 offen
    s_add_u32 s36, s37, 103936
    buffer_load_dword v45, v4, s[64:67], s36 offen
    buffer_load_dword v77, v4, s[68:71], s36 offen
    s_add_u32 s36, s37, 107520
    buffer_load_dword v46, v4, s[64:67], s36 offen
    buffer_load_dword v78, v4, s[68:71], s36 offen
    s_add_u32 s36, s37, 111104
    buffer_load_dword v47, v4, s[64:67], s36 offen
    buffer_load_dword v79, v4, s[68:71], s36 offen
    s_waitcnt vmcnt(0)
    v_perm_b32 v80, v17, v16, s34
    v_perm_b32 v81, v19, v18, s34
    v_perm_b32 v82, v21, v20, s34
    v_perm_b32 v83, v23, v22, s34
    v_perm_b32 v84, v25, v24, s34
    v_perm_b32 v85, v27, v26, s34
    v_perm_b32 v86, v29, v28, s34
    v_perm_b32 v87, v31, v30, s34
    v_perm_b32 v88, v33, v32, s34
    v_perm_b32 v89, v35, v34, s34
    v_perm_b32 v90, v37, v36, s34
    v_perm_b32 v91, v39, v38, s34
    v_perm_b32 v92, v41, v40, s34
    v_perm_b32 v93, v43, v42, s34
    v_perm_b32 v94, v45, v44, s34
    v_perm_b32 v95, v47, v46, s34
    v_perm_b32 v96, v17, v16, s35
    v_perm_b32 v97, v19, v18, s35
    v_perm_b32 v98, v21, v20, s35
    v_perm_b32 v99, v23, v22, s35
    v_perm_b32 v100, v25, v24, s35
    v_perm_b32 v101, v27, v26, s35
    v_perm_b32 v102, v29, v28, s35
    v_perm_b32 v103, v31, v30, s35
    v_perm_b32 v104, v33, v32, s35
    v_perm_b32 v105, v35, v34, s35
    v_perm_b32 v106, v37, v36, s35
    v_perm_b32 v107, v39, v38, s35
    v_perm_b32 v108, v41, v40, s35
    v_perm_b32 v109, v43, v42, s35
    v_perm_b32 v110, v45, v44, s35
    v_perm_b32 v111, v47, v46, s35
    v_perm_b32 v112, v49, v48, s34
    v_perm_b32 v113, v51, v50, s34
    v_perm_b32 v114, v53, v52, s34
    v_perm_b32 v115, v55, v54, s34
    v_perm_b32 v116, v57, v56, s34
    v_perm_b32 v117, v59, v58, s34
    v_perm_b32 v118, v61, v60, s34
    v_perm_b32 v119, v63, v62, s34
    v_perm_b32 v120, v65, v64, s34
    v_perm_b32 v121, v67, v66, s34
    v_perm_b32 v122, v69, v68, s34
    v_perm_b32 v123, v71, v70, s34
    v_perm_b32 v124, v73, v72, s34
    v_perm_b32 v125, v75, v74, s34
    v_perm_b32 v126, v77, v76, s34
    v_perm_b32 v127, v79, v78, s34
    v_perm_b32 v128, v49, v48, s35
    v_perm_b32 v129, v51, v50, s35
    v_perm_b32 v130, v53, v52, s35
    v_perm_b32 v131, v55, v54, s35
    v_perm_b32 v132, v57, v56, s35
    v_perm_b32 v133, v59, v58, s35
    v_perm_b32 v134, v61, v60, s35
    v_perm_b32 v135, v63, v62, s35
    v_perm_b32 v136, v65, v64, s35
    v_perm_b32 v137, v67, v66, s35
    v_perm_b32 v138, v69, v68, s35
    v_perm_b32 v139, v71, v70, s35
    v_perm_b32 v140, v73, v72, s35
    v_perm_b32 v141, v75, v74, s35
    v_perm_b32 v142, v77, v76, s35
    v_perm_b32 v143, v79, v78, s35
    s_mov_b32 s24, 0
    s_mov_b64 s[28:29], 0
    v_lshlrev_b32 v3, 4, v0
L_A0_rp:
    s_mov_b32 s36, 0x194000
    buffer_load_dwordx4 v[200:203], v3, s[8:11], s36 offen sc1
    s_mov_b32 s36, 0x195000
    buffer_load_dwordx4 v[204:207], v3, s[8:11], s36 offen sc1
    s_mov_b32 s36, 0x196000
    buffer_load_dwordx4 v[208:211], v3, s[8:11], s36 offen sc1
    s_mov_b32 s36, 0x197000
    buffer_load_dwordx4 v[212:215], v3, s[8:11], s36 offen sc1
    s_mov_b32 s36, 0x198000
    buffer_load_dwordx4 v[216:219], v3, s[8:11], s36 offen sc1
    s_mov_b32 s36, 0x199000
    buffer_load_dwordx4 v[220:223], v3, s[8:11], s36 offen sc1
    s_mov_b32 s36, 0x19a000
    buffer_load_dwordx4 v[224:227], v3, s[8:11], s36 offen sc1
    s_add_u32 s32, s32, 1
    v_mov_b32 v5, 0
    s_waitcnt vmcnt(0)
    v_max3_u32 v5, v5, v200, v201
    v_max3_u32 v5, v5, v202, v203
    v_max3_u32 v5, v5, v204, v205
    v_max3_u32 v5, v5, v206, v207
    v_max3_u32 v5, v5, v208, v209
    v_max3_u32 v5, v5, v210, v211
    v_max3_u32 v5, v5, v212, v213
    v_max3_u32 v5, v5, v214, v215
    v_max3_u32 v5, v5, v216, v217
    v_max3_u32 v5, v5, v218, v219
    v_max3_u32 v5, v5, v220, v221
    v_max3_u32 v5, v5, v222, v223
    v_max3_u32 v5, v5, v224, v225
    v_max3_u32 v5, v5, v226, v227
    s_cmp_gt_u32 s32, 200000
    s_cbranch_scc1 L_A0_rp_ok
    v_cmp_eq_u32 vcc, -1, v5
    s_cbranch_vccz L_A0_rp_ok
    s_sleep 2
    s_branch L_A0_rp
L_A0_rp_ok:
    v_add_f32 v200, v200, v201
    v_add_f32 v202, v202, v203
    v_add_f32 v200, v200, v202
    v_cvt_pk_bf16_f32 v5, v200, v200
    v_lshlrev_b32 v200, 16, v5
    v_ashrrev_i32 v5, 31, v200
    v_or_b32 v5, 0x80000000, v5
    v_xor_b32 v5, v5, v200
    v_and_b32 v5, 0xffff0000, v5
    v_sub_u32 v6, 2047, v0
    v_or_b32 v232, v5, v6
    v_add_f32 v204, v204, v205
    v_add_f32 v206, v206, v207
    v_add_f32 v204, v204, v206
    v_cvt_pk_bf16_f32 v5, v204, v204
    v_lshlrev_b32 v204, 16, v5
    v_ashrrev_i32 v5, 31, v204
    v_or_b32 v5, 0x80000000, v5
    v_xor_b32 v5, v5, v204
    v_and_b32 v5, 0xffff0000, v5
    v_sub_u32 v6, 1791, v0
    v_or_b32 v233, v5, v6
    v_add_f32 v208, v208, v209
    v_add_f32 v210, v210, v211
    v_add_f32 v208, v208, v210
    v_cvt_pk_bf16_f32 v5, v208, v208
    v_lshlrev_b32 v208, 16, v5
    v_ashrrev_i32 v5, 31, v208
    v_or_b32 v5, 0x80000000, v5
    v_xor_b32 v5, v5, v208
    v_and_b32 v5, 0xffff0000, v5
    v_sub_u32 v6, 1535, v0
    v_or_b32 v234, v5, v6
    v_add_f32 v212, v212, v213
    v_add_f32 v214, v214, v215
    v_add_f32 v212, v212, v214
    v_cvt_pk_bf16_f32 v5, v212, v212
    v_lshlrev_b32 v212, 16, v5
    v_ashrrev_i32 v5, 31, v212
    v_or_b32 v5, 0x80000000, v5
    v_xor_b32 v5, v5, v212
    v_and_b32 v5, 0xffff0000, v5
    v_sub_u32 v6, 1279, v0
    v_or_b32 v235, v5, v6
    v_add_f32 v216, v216, v217
    v_add_f32 v218, v218, v219
    v_add_f32 v216, v216, v218
    v_cvt_pk_bf16_f32 v5, v216, v216
    v_lshlrev_b32 v216, 16, v5
    v_ashrrev_i32 v5, 31, v216
    v_or_b32 v5, 0x80000000, v5
    v_xor_b32 v5, v5, v216
    v_and_b32 v5, 0xffff0000, v5
    v_sub_u32 v6, 1023, v0
    v_or_b32 v236, v5, v6
    v_add_f32 v220, v220, v221
    v_add_f32 v222, v222, v223
    v_add_f32 v220, v220, v222
    v_cvt_pk_bf16_f32 v5, v220, v220
    v_lshlrev_b32 v220, 16, v5
    v_ashrrev_i32 v5, 31, v220
    v_or_b32 v5, 0x80000000, v5
    v_xor_b32 v5, v5, v220
    v_and_b32 v5, 0xffff0000, v5
    v_sub_u32 v6, 767, v0
    v_or_b32 v237, v5, v6
    v_add_f32 v224, v224, v225
    v_add_f32 v226, v226, v227
    v_add_f32 v224, v224, v226
    v_cvt_pk_bf16_f32 v5, v224, v224
    v_lshlrev_b32 v224, 16, v5
    v_ashrrev_i32 v5, 31, v224
    v_or_b32 v5, 0x80000000, v5
    v_xor_b32 v5, v5, v224
    v_and_b32 v5, 0xffff0000, v5
    v_sub_u32 v6, 511, v0
    v_or_b32 v238, v5, v6
L_A_round:
    v_lshlrev_b32 v3, 4, v0
L_A1_rp:
    s_mov_b32 s36, 0x19b000
    buffer_load_dwordx4 v[228:231], v3, s[8:11], s36 offen sc1
    s_add_u32 s32, s32, 1
    v_mov_b32 v5, 0
    s_waitcnt vmcnt(0)
    v_max3_u32 v5, v5, v228, v229
    v_max3_u32 v5, v5, v230, v231
    s_mul_i32 s37, s24, 96
    s_add_u32 s37, s37, 160
    v_cmp_gt_u32 s[74:75], s37, v0
    s_nop 1
    v_cndmask_b32 v5, 0, v5, s[74:75]
    s_cmp_gt_u32 s32, 200000
    s_cbranch_scc1 L_A1_rp_ok
    v_cmp_eq_u32 vcc, -1, v5
    s_cbranch_vccz L_A1_rp_ok
    s_sleep 2
    s_branch L_A1_rp
L_A1_rp_ok:
    v_add_f32 v228, v228, v229
    v_add_f32 v230, v230, v231
    v_add_f32 v228, v228, v230
    v_cvt_pk_bf16_f32 v5, v228, v228
    v_lshlrev_b32 v228, 16, v5
    v_ashrrev_i32 v5, 31, v228
    v_or_b32 v5, 0x80000000, v5
    v_xor_b32 v5, v5, v228
    v_and_b32 v5, 0xffff0000, v5
    v_sub_u32 v6, 255, v0
    v_or_b32 v239, v5, v6
    v_cndmask_b32 v239, 0, v239, s[74:75]
    v_mov_b32 v240, v232
    v_mov_b32 v241, v233
    v_mov_b32 v242, v234
    v_mov_b32 v243, v235
    v_mov_b32 v244, v236
    v_mov_b32 v245, v237
    v_mov_b32 v246, v238
    v_mov_b32 v247, v239
    v_lshrrev_b32 v7, 6, v0
    v_lshlrev_b32 v7, 2, v7
    v_mov_b32 v8, 0
    s_barrier
    v_max3_u32 v5, v240, v241, v242
    v_max3_u32 v5, v5, v243, v244
    v_max3_u32 v5, v5, v245, v246
    v_max_u32 v5, v5, v247
    s_nop 1
    v_max_u32_dpp v5, v5, v5 quad_perm:[1,0,3,2] row_mask:0xf bank_mask:0xf
    s_nop 1
    v_max_u32_dpp v5, v5, v5 quad_perm:[2,3,0,1] row_mask:0xf bank_mask:0xf
    s_nop 1
    v_max_u32_dpp v5, v5, v5 row_half_mirror row_mask:0xf bank_mask:0xf
    s_nop 1
    v_max_u32_dpp v5, v5, v5 row_mirror row_mask:0xf bank_mask:0xf
    v_mov_b32 v6, v5
    s_nop 1
    v_permlane16_swap_b32 v5, v6
    v_max_u32 v5, v5, v6
    v_mov_b32 v6, v5
    s_nop 1
    v_permlane32_swap_b32 v5, v6
    v_max_u32 v5, v5, v6
    ds_write_b32 v7, v5 offset:0
    s_waitcnt lgkmcnt(0)
    s_barrier
    ds_read_b128 v[248:251], v8 offset:0
    s_waitcnt lgkmcnt(0)
    v_max3_u32 v5, v248, v249, v250
    v_max_u32 v5, v5, v251
    s_nop 0
    v_readfirstlane_b32 s26, v5
    v_cmp_ne_u32 vcc, v5, v240
    s_nop 1
    v_cndmask_b32 v240, 0, v240, vcc
    v_cmp_ne_u32 vcc, v5, v241
    s_nop 1
    v_cndmask_b32 v241, 0, v241, vcc
    v_cmp_ne_u32 vcc, v5, v242
    s_nop 1
    v_cndmask_b32 v242, 0, v242, vcc
    v_cmp_ne_u32 vcc, v5, v243
    s_nop 1
    v_cndmask_b32 v243, 0, v243, vcc
    v_cmp_ne_u32 vcc, v5, v244
    s_nop 1
    v_cndmask_b32 v244, 0, v244, vcc
    v_cmp_ne_u32 vcc, v5, v245
    s_nop 1
    v_cndmask_b32 v245, 0, v245, vcc
    v_cmp_ne_u32 vcc, v5, v246
    s_nop 1
    v_cndmask_b32 v246, 0, v246, vcc
    v_cmp_ne_u32 vcc, v5, v247
    s_nop 1
    v_cndmask_b32 v247, 0, v247, vcc
    v_max3_u32 v5, v240, v241, v242
    v_max3_u32 v5, v5, v243, v244
    v_max3_u32 v5, v5, v245, v246
    v_max_u32 v5, v5, v247
    s_nop 1
    v_max_u32_dpp v5, v5, v5 quad_perm:[1,0,3,2] row_mask:0xf bank_mask:0xf
    s_nop 1
    v_max_u32_dpp v5, v5, v5 quad_perm:[2,3,0,1] row_mask:0xf bank_mask:0xf
    s_nop 1
    v_max_u32_dpp v5, v5, v5 row_half_mirror row_mask:0xf bank_mask:0xf
    s_nop 1
    v_max_u32_dpp v5, v5, v5 row_mirror row_mask:0xf bank_mask:0xf
    v_mov_b32 v6, v5
    s_nop 1
    v_permlane16_swap_b32 v5, v6
    v_max_u32 v5, v5, v6
    v_mov_b32 v6, v5
    s_nop 1
    v_permlane32_swap_b32 v5, v6
    v_max_u32 v5, v5, v6
    ds_write_b32 v7, v5 offset:16
    s_waitcnt lgkmcnt(0)
    s_barrier
    ds_read_b128 v[248:251], v8 offset:16
    s_waitcnt lgkmcnt(0)
    v_max3_u32 v5, v248, v249, v250
    v_max_u32 v5, v5, v251
    s_nop 0
    v_readfirstlane_b32 s27, v5
    s_nop 3
    s_and_b32 s36, s26, 0x7ff
    s_sub_u32 s30, 2047, s36
    s_and_b32 s36, s26, 0xffff0000
    s_xor_b32 s37, s36, 0x80000000
    s_xor_b32 s40, s36, 0xffff0000
    s_bitcmp1_b32 s36, 31
    s_cselect_b32 s40, s37, s40
    s_and_b32 s36, s27, 0x7ff
    s_sub_u32 s31, 2047, s36
    s_and_b32 s36, s27, 0xffff0000
    s_xor_b32 s37, s36, 0x80000000
    s_xor_b32 s41, s36, 0xffff0000
    s_bitcmp1_b32 s36, 31
    s_cselect_b32 s41, s37, s41
    s_cmp_eq_u64 s[26:27], s[28:29]
    s_cbranch_scc1 L_end
    s_mov_b64 s[28:29], s[26:27]
    v_lshlrev_b32 v3, 6, v1
    s_lshl_b32 s36, s30, 10
    s_add_u32 s36, s36, 0x600000
    buffer_load_dwordx4 v[16:19], v3, s[8:11], s36 offen offset:0 sc1
    buffer_load_dwordx4 v[20:23], v3, s[8:11], s36 offen offset:16 sc1
    buffer_load_dwordx4 v[24:27], v3, s[8:11], s36 offen offset:32 sc1
    buffer_load_dwordx4 v[28:31], v3, s[8:11], s36 offen offset:48 sc1
    s_lshl_b32 s36, s31, 10
    s_add_u32 s36, s36, 0x600000
    buffer_load_dwordx4 v[32:35], v3, s[8:11], s36 offen offset:0 sc1
    buffer_load_dwordx4 v[36:39], v3, s[8:11], s36 offen offset:16 sc1
    buffer_load_dwordx4 v[40:43], v3, s[8:11], s36 offen offset:32 sc1
    buffer_load_dwordx4 v[44:47], v3, s[8:11], s36 offen offset:48 sc1
    v_mov_b32 v48, 0
    v_mov_b32 v49, 0
    v_mov_b32 v50, 0
    v_mov_b32 v51, 0
    v_mov_b32 v52, 0
    v_mov_b32 v53, 0
    v_mov_b32 v54, 0
    v_mov_b32 v55, 0
    s_waitcnt vmcnt(0)
    v_dot2_f32_bf16 v48, v16, v80, v48
    v_dot2_f32_bf16 v49, v16, v96, v49
    v_dot2_f32_bf16 v50, v32, v80, v50
    v_dot2_f32_bf16 v51, v32, v96, v51
    v_dot2_f32_bf16 v52, v16, v112, v52
    v_dot2_f32_bf16 v53, v16, v128, v53
    v_dot2_f32_bf16 v54, v32, v112, v54
    v_dot2_f32_bf16 v55, v32, v128, v55
    v_dot2_f32_bf16 v48, v17, v81, v48
    v_dot2_f32_bf16 v49, v17, v97, v49
    v_dot2_f32_bf16 v50, v33, v81, v50
    v_dot2_f32_bf16 v51, v33, v97, v51
    v_dot2_f32_bf16 v52, v17, v113, v52
    v_dot2_f32_bf16 v53, v17, v129, v53
    v_dot2_f32_bf16 v54, v33, v113, v54
    v_dot2_f32_bf16 v55, v33, v129, v55
    v_dot2_f32_bf16 v48, v18, v82, v48
    v_dot2_f32_bf16 v49, v18, v98, v49
    v_dot2_f32_bf16 v50, v34, v82, v50
    v_dot2_f32_bf16 v51, v34, v98, v51
    v_dot2_f32_bf16 v52, v18, v114, v52
    v_dot2_f32_bf16 v53, v18, v130, v53
    v_dot2_f32_bf16 v54, v34, v114, v54
    v_dot2_f32_bf16 v55, v34, v130, v55
    v_dot2_f32_bf16 v48, v19, v83, v48
    v_dot2_f32_bf16 v49, v19, v99, v49
    v_dot2_f32_bf16 v50, v35, v83, v50
    v_dot2_f32_bf16 v51, v35, v99, v51
    v_dot2_f32_bf16 v52, v19, v115, v52
    v_dot2_f32_bf16 v53, v19, v131, v53
    v_dot2_f32_bf16 v54, v35, v115, v54
    v_dot2_f32_bf16 v55, v35, v131, v55
    v_dot2_f32_bf16 v48, v20, v84, v48
    v_dot2_f32_bf16 v49, v20, v100, v49
    v_dot2_f32_bf16 v50, v36, v84, v50
    v_dot2_f32_bf16 v51, v36, v100, v51
    v_dot2_f32_bf16 v52, v20, v116, v52
    v_dot2_f32_bf16 v53, v20, v132, v53
    v_dot2_f32_bf16 v54, v36, v116, v54
    v_dot2_f32_bf16 v55, v36, v132, v55
    v_dot2_f32_bf16 v48, v21, v85, v48
    v_dot2_f32_bf16 v49, v21, v101, v49
    v_dot2_f32_bf16 v50, v37, v85, v50
    v_dot2_f32_bf16 v51, v37, v101, v51
    v_dot2_f32_bf16 v52, v21, v117, v52
    v_dot2_f32_bf16 v53, v21, v133, v53
    v_dot2_f32_bf16 v54, v37, v117, v54
    v_dot2_f32_bf16 v55, v37, v133, v55
    v_dot2_f32_bf16 v48, v22, v86, v48
    v_dot2_f32_bf16 v49, v22, v102, v49
    v_dot2_f32_bf16 v50, v38, v86, v50
    v_dot2_f32_bf16 v51, v38, v102, v51
    v_dot2_f32_bf16 v52, v22, v118, v52
    v_dot2_f32_bf16 v53, v22, v134, v53
    v_dot2_f32_bf16 v54, v38, v118, v54
    v_dot2_f32_bf16 v55, v38, v134, v55
    v_dot2_f32_bf16 v48, v23, v87, v48
    v_dot2_f32_bf16 v49, v23, v103, v49
    v_dot2_f32_bf16 v50, v39, v87, v50
    v_dot2_f32_bf16 v51, v39, v103, v51
    v_dot2_f32_bf16 v52, v23, v119, v52
    v_dot2_f32_bf16 v53, v23, v135, v53
    v_dot2_f32_bf16 v54, v39, v119, v54
    v_dot2_f32_bf16 v55, v39, v135, v55
    v_dot2_f32_bf16 v48, v24, v88, v48
    v_dot2_f32_bf16 v49, v24, v104, v49
    v_dot2_f32_bf16 v50, v40, v88, v50
    v_dot2_f32_bf16 v51, v40, v104, v51
    v_dot2_f32_bf16 v52, v24, v120, v52
    v_dot2_f32_bf16 v53, v24, v136, v53
    v_dot2_f32_bf16 v54, v40, v120, v54
    v_dot2_f32_bf16 v55, v40, v136, v55
    v_dot2_f32_bf16 v48, v25, v89, v48
    v_dot2_f32_bf16 v49, v25, v105, v49
    v_dot2_f32_bf16 v50, v41, v89, v50
    v_dot2_f32_bf16 v51, v41, v105, v51
    v_dot2_f32_bf16 v52, v25, v121, v52
    v_dot2_f32_bf16 v53, v25, v137, v53
    v_dot2_f32_bf16 v54, v41, v121, v54
    v_dot2_f32_bf16 v55, v41, v137, v55
    v_dot2_f32_bf16 v48, v26, v90, v48
    v_dot2_f32_bf16 v49, v26, v106, v49
    v_dot2_f32_bf16 v50, v42, v90, v50
    v_dot2_f32_bf16 v51, v42, v106, v51
    v_dot2_f32_bf16 v52, v26, v122, v52
    v_dot2_f32_bf16 v53, v26, v138, v53
    v_dot2_f32_bf16 v54, v42, v122, v54
    v_dot2_f32_bf16 v55, v42, v138, v55
    v_dot2_f32_bf16 v48, v27, v91, v48
    v_dot2_f32_bf16 v49, v27, v107, v49
    v_dot2_f32_bf16 v50, v43, v91, v50
    v_dot2_f32_bf16 v51, v43, v107, v51
    v_dot2_f32_bf16 v52, v27, v123, v52
    v_dot2_f32_bf16 v53, v27, v139, v53
    v_dot2_f32_bf16 v54, v43, v123, v54
    v_dot2_f32_bf16 v55, v43, v139, v55
    v_dot2_f32_bf16 v48, v28, v92, v48
    v_dot2_f32_bf16 v49, v28, v108, v49
    v_dot2_f32_bf16 v50, v44, v92, v50
    v_dot2_f32_bf16 v51, v44, v108, v51
    v_dot2_f32_bf16 v52, v28, v124, v52
    v_dot2_f32_bf16 v53, v28, v140, v53
    v_dot2_f32_bf16 v54, v44, v124, v54
    v_dot2_f32_bf16 v55, v44, v140, v55
    v_dot2_f32_bf16 v48, v29, v93, v48
    v_dot2_f32_bf16 v49, v29, v109, v49
    v_dot2_f32_bf16 v50, v45, v93, v50
    v_dot2_f32_bf16 v51, v45, v109, v51
    v_dot2_f32_bf16 v52, v29, v125, v52
    v_dot2_f32_bf16 v53, v29, v141, v53
    v_dot2_f32_bf16 v54, v45, v125, v54
    v_dot2_f32_bf16 v55, v45, v141, v55
    v_dot2_f32_bf16 v48, v30, v94, v48
    v_dot2_f32_bf16 v49, v30, v110, v49
    v_dot2_f32_bf16 v50, v46, v94, v50
    v_dot2_f32_bf16 v51, v46, v110, v51
    v_dot2_f32_bf16 v52, v30, v126, v52
    v_dot2_f32_bf16 v53, v30, v142, v53
    v_dot2_f32_bf16 v54, v46, v126, v54
    v_dot2_f32_bf16 v55, v46, v142, v55
    v_dot2_f32_bf16 v48, v31, v95, v48
    v_dot2_f32_bf16 v49, v31, v111, v49
    v_dot2_f32_bf16 v50, v47, v95, v50
    v_dot2_f32_bf16 v51, v47, v111, v51
    v_dot2_f32_bf16 v52, v31, v127, v52
    v_dot2_f32_bf16 v53, v31, v143, v53
    v_dot2_f32_bf16 v54, v47, v127, v54
    v_dot2_f32_bf16 v55, v47, v143, v55
    s_nop 3
    v_mov_b32 v5, v48
    s_nop 1
    v_permlane16_swap_b32 v48, v5
    v_add_f32 v48, v48, v5
    v_mov_b32 v5, v49
    s_nop 1
    v_permlane16_swap_b32 v49, v5
    v_add_f32 v49, v49, v5
    v_mov_b32 v5, v50
    s_nop 1
    v_permlane16_swap_b32 v50, v5
    v_add_f32 v50, v50, v5
    v_mov_b32 v5, v51
    s_nop 1
    v_permlane16_swap_b32 v51, v5
    v_add_f32 v51, v51, v5
    v_mov_b32 v5, v52
    s_nop 1
    v_permlane16_swap_b32 v52, v5
    v_add_f32 v52, v52, v5
    v_mov_b32 v5, v53
    s_nop 1
    v_permlane16_swap_b32 v53, v5
    v_add_f32 v53, v53, v5
    v_mov_b32 v5, v54
    s_nop 1
    v_permlane16_swap_b32 v54, v5
    v_add_f32 v54, v54, v5
    v_mov_b32 v5, v55
    s_nop 1
    v_permlane16_swap_b32 v55, v5
    v_add_f32 v55, v55, v5
    v_mov_b32 v5, v48
    s_nop 1
    v_permlane32_swap_b32 v48, v5
    v_add_f32 v48, v48, v5
    v_mov_b32 v5, v49
    s_nop 1
    v_permlane32_swap_b32 v49, v5
    v_add_f32 v49, v49, v5
    v_mov_b32 v5, v50
    s_nop 1
    v_permlane32_swap_b32 v50, v5
    v_add_f32 v50, v50, v5
    v_mov_b32 v5, v51
    s_nop 1
    v_permlane32_swap_b32 v51, v5
    v_add_f32 v51, v51, v5
    v_mov_b32 v5, v52
    s_nop 1
    v_permlane32_swap_b32 v52, v5
    v_add_f32 v52, v52, v5
    v_mov_b32 v5, v53
    s_nop 1
    v_permlane32_swap_b32 v53, v5
    v_add_f32 v53, v53, v5
    v_mov_b32 v5, v54
    s_nop 1
    v_permlane32_swap_b32 v54, v5
    v_add_f32 v54, v54, v5
    v_mov_b32 v5, v55
    s_nop 1
    v_permlane32_swap_b32 v55, v5
    v_add_f32 v55, v55, v5
    v_lshrrev_b32 v7, 6, v0
    v_lshlrev_b32 v7, 9, v7
    v_lshl_add_u32 v7, v2, 5, v7
    ds_write_b128 v7, v[48:51] offset:64
    ds_write_b128 v7, v[52:55] offset:80
    s_waitcnt lgkmcnt(0)
    s_barrier
    v_bfe_u32 v7, v0, 2, 4
    v_lshlrev_b32 v7, 5, v7
    v_and_b32 v8, 3, v0
    v_lshl_add_u32 v7, v8, 2, v7
    ds_read_b32 v56, v7 offset:64
    ds_read_b32 v57, v7 offset:80
    ds_read_b32 v58, v7 offset:576
    ds_read_b32 v59, v7 offset:592
    ds_read_b32 v60, v7 offset:1088
    ds_read_b32 v61, v7 offset:1104
    ds_read_b32 v62, v7 offset:1600
    ds_read_b32 v63, v7 offset:1616
    s_waitcnt lgkmcnt(0)
    v_add_f32 v56, v56, v58
    v_add_f32 v60, v60, v62
    v_add_f32 v56, v56, v60
    v_cvt_pk_bf16_f32 v5, v56, v56
    v_lshlrev_b32 v56, 16, v5
    v_add_f32 v57, v57, v59
    v_add_f32 v61, v61, v63
    v_add_f32 v57, v57, v61
    v_cvt_pk_bf16_f32 v5, v57, v57
    v_lshlrev_b32 v57, 16, v5
    v_mul_f32 v58, 0xbfb8aa3b, v56
    v_exp_f32 v58, v58
    s_nop 0
    v_add_f32 v58, 1.0, v58
    v_rcp_f32 v58, v58
    s_nop 0
    v_mul_f32 v56, v56, v58
    v_cvt_pk_bf16_f32 v5, v56, v56
    v_lshlrev_b32 v56, 16, v5
    v_mul_f32 v56, v56, v57
    v_cvt_pk_bf16_f32 v5, v56, v56
    v_lshlrev_b32 v56, 16, v5
    v_lshrrev_b32 v7, 2, v0
    v_lshlrev_b32 v7, 3, v7
    v_and_b32 v8, 1, v0
    v_lshl_add_u32 v7, v8, 2, v7
    v_bfe_u32 v8, v0, 1, 1
    v_mul_u32_u24 v8, 7168, v8
    v_add_u32 v7, v7, v8
    v_mov_b32 v6, 0x40000000
    v_cmp_lt_u32 vcc, 63, v0
    s_nop 1
    v_cndmask_b32 v7, v7, v6, vcc
    s_mul_i32 s36, s24, 14336
    s_lshl_b32 s37, s25, 7
    s_add_u32 s36, s36, s37
    s_add_u32 s36, s36, 0x1b0000
    buffer_store_dword v56, v7, s[8:11], s36 offen sc1
    s_add_u32 s24, s24, 1
    s_cmp_lt_u32 s24, 2
    s_cbranch_scc1 L_A_round
    s_branch L_end
L_stageB:
    s_mov_b32 s64, s88
    s_and_b32 s65, s89, 0xffff
    s_mov_b32 s66, 0x1c0000
    s_mov_b32 s67, 0x20000
    v_lshrrev_b32 v1, 3, v0
    v_and_b32 v2, 7, v0
    v_mul_u32_u24 v4, 57344, v1
    v_lshl_add_u32 v4, v2, 2, v4
    s_lshl_b32 s68, s20, 5
    s_add_u32 s36, s68, 0
    buffer_load_dword v16, v4, s[64:67], s36 offen offset:0
    s_add_u32 s36, s68, 0
    buffer_load_dword v17, v4, s[64:67], s36 offen offset:1024
    s_add_u32 s36, s68, 0
    buffer_load_dword v18, v4, s[64:67], s36 offen offset:2048
    s_add_u32 s36, s68, 0
    buffer_load_dword v19, v4, s[64:67], s36 offen offset:3072
    s_add_u32 s36, s68, 4096
    buffer_load_dword v20, v4, s[64:67], s36 offen offset:0
    s_add_u32 s36, s68, 4096
    buffer_load_dword v21, v4, s[64:67], s36 offen offset:1024
    s_add_u32 s36, s68, 4096
    buffer_load_dword v22, v4, s[64:67], s36 offen offset:2048
    s_add_u32 s36, s68, 4096
    buffer_load_dword v23, v4, s[64:67], s36 offen offset:3072
    s_add_u32 s36, s68, 8192
    buffer_load_dword v24, v4, s[64:67], s36 offen offset:0
    s_add_u32 s36, s68, 8192
    buffer_load_dword v25, v4, s[64:67], s36 offen offset:1024
    s_add_u32 s36, s68, 8192
    buffer_load_dword v26, v4, s[64:67], s36 offen offset:2048
    s_add_u32 s36, s68, 8192
    buffer_load_dword v27, v4, s[64:67], s36 offen offset:3072
    s_add_u32 s36, s68, 12288
    buffer_load_dword v28, v4, s[64:67], s36 offen offset:0
    s_add_u32 s36, s68, 12288
    buffer_load_dword v29, v4, s[64:67], s36 offen offset:1024
    s_add_u32 s36, s68, 12288
    buffer_load_dword v30, v4, s[64:67], s36 offen offset:2048
    s_add_u32 s36, s68, 12288
    buffer_load_dword v31, v4, s[64:67], s36 offen offset:3072
    s_add_u32 s36, s68, 16384
    buffer_load_dword v32, v4, s[64:67], s36 offen offset:0
    s_add_u32 s36, s68, 16384
    buffer_load_dword v33, v4, s[64:67], s36 offen offset:1024
    s_add_u32 s36, s68, 16384
    buffer_load_dword v34, v4, s[64:67], s36 offen offset:2048
    s_add_u32 s36, s68, 16384
    buffer_load_dword v35, v4, s[64:67], s36 offen offset:3072
    s_add_u32 s36, s68, 20480
    buffer_load_dword v36, v4, s[64:67], s36 offen offset:0
    s_add_u32 s36, s68, 20480
    buffer_load_dword v37, v4, s[64:67], s36 offen offset:1024
    s_add_u32 s36, s68, 20480
    buffer_load_dword v38, v4, s[64:67], s36 offen offset:2048
    s_add_u32 s36, s68, 20480
    buffer_load_dword v39, v4, s[64:67], s36 offen offset:3072
    s_add_u32 s36, s68, 24576
    buffer_load_dword v40, v4, s[64:67], s36 offen offset:0
    s_add_u32 s36, s68, 24576
    buffer_load_dword v41, v4, s[64:67], s36 offen offset:1024
    s_add_u32 s36, s68, 24576
    buffer_load_dword v42, v4, s[64:67], s36 offen offset:2048
    s_add_u32 s36, s68, 24576
    buffer_load_dword v43, v4, s[64:67], s36 offen offset:3072
    s_add_u32 s36, s68, 28672
    buffer_load_dword v44, v4, s[64:67], s36 offen offset:0
    s_add_u32 s36, s68, 28672
    buffer_load_dword v45, v4, s[64:67], s36 offen offset:1024
    s_add_u32 s36, s68, 28672
    buffer_load_dword v46, v4, s[64:67], s36 offen offset:2048
    s_add_u32 s36, s68, 28672
    buffer_load_dword v47, v4, s[64:67], s36 offen offset:3072
    s_add_u32 s36, s68, 32768
    buffer_load_dword v48, v4, s[64:67], s36 offen offset:0
    s_add_u32 s36, s68, 32768
    buffer_load_dword v49, v4, s[64:67], s36 offen offset:1024
    s_add_u32 s36, s68, 32768
    buffer_load_dword v50, v4, s[64:67], s36 offen offset:2048
    s_add_u32 s36, s68, 32768
    buffer_load_dword v51, v4, s[64:67], s36 offen offset:3072
    s_add_u32 s36, s68, 36864
    buffer_load_dword v52, v4, s[64:67], s36 offen offset:0
    s_add_u32 s36, s68, 36864
    buffer_load_dword v53, v4, s[64:67], s36 offen offset:1024
    s_add_u32 s36, s68, 36864
    buffer_load_dword v54, v4, s[64:67], s36 offen offset:2048
    s_add_u32 s36, s68, 36864
    buffer_load_dword v55, v4, s[64:67], s36 offen offset:3072
    s_add_u32 s36, s68, 40960
    buffer_load_dword v56, v4, s[64:67], s36 offen offset:0
    s_add_u32 s36, s68, 40960
    buffer_load_dword v57, v4, s[64:67], s36 offen offset:1024
    s_add_u32 s36, s68, 40960
    buffer_load_dword v58, v4, s[64:67], s36 offen offset:2048
    s_add_u32 s36, s68, 40960
    buffer_load_dword v59, v4, s[64:67], s36 offen offset:3072
    s_add_u32 s36, s68, 45056
    buffer_load_dword v60, v4, s[64:67], s36 offen offset:0
    s_add_u32 s36, s68, 45056
    buffer_load_dword v61, v4, s[64:67], s36 offen offset:1024
    s_add_u32 s36, s68, 45056
    buffer_load_dword v62, v4, s[64:67], s36 offen offset:2048
    s_add_u32 s36, s68, 45056
    buffer_load_dword v63, v4, s[64:67], s36 offen offset:3072
    s_add_u32 s36, s68, 49152
    buffer_load_dword v64, v4, s[64:67], s36 offen offset:0
    s_add_u32 s36, s68, 49152
    buffer_load_dword v65, v4, s[64:67], s36 offen offset:1024
    s_add_u32 s36, s68, 49152
    buffer_load_dword v66, v4, s[64:67], s36 offen offset:2048
    s_add_u32 s36, s68, 49152
    buffer_load_dword v67, v4, s[64:67], s36 offen offset:3072
    s_add_u32 s36, s68, 53248
    buffer_load_dword v68, v4, s[64:67], s36 offen offset:0
    s_add_u32 s36, s68, 53248
    buffer_load_dword v69, v4, s[64:67], s36 offen offset:1024
    s_add_u32 s36, s68, 53248
    buffer_load_dword v70, v4, s[64:67], s36 offen offset:2048
    s_add_u32 s36, s68, 53248
    buffer_load_dword v71, v4, s[64:67], s36 offen offset:3072
    s_waitcnt vmcnt(0)
    s_mov_b32 s24, 0
    s_mov_b64 s[28:29], 0
    v_mov_b32 v12, 0x40000000
    v_mov_b32 v11, 0
    v_lshlrev_b32 v3, 4, v0
L_B0_rp:
    s_mov_b32 s36, 0x194000
    buffer_load_dwordx4 v[200:203], v3, s[8:11], s36 offen sc1
    s_mov_b32 s36, 0x195000
    buffer_load_dwordx4 v[204:207], v3, s[8:11], s36 offen sc1
    s_mov_b32 s36, 0x196000
    buffer_load_dwordx4 v[208:211], v3, s[8:11], s36 offen sc1
    s_mov_b32 s36, 0x197000
    buffer_load_dwordx4 v[212:215], v3, s[8:11], s36 offen sc1
    s_mov_b32 s36, 0x198000
    buffer_load_dwordx4 v[216:219], v3, s[8:11], s36 offen sc1
    s_mov_b32 s36, 0x199000
    buffer_load_dwordx4 v[220:223], v3, s[8:11], s36 offen sc1
    s_mov_b32 s36, 0x19a000
    buffer_load_dwordx4 v[224:227], v3, s[8:11], s36 offen sc1
    s_add_u32 s32, s32, 1
    v_mov_b32 v5, 0
    s_waitcnt vmcnt(0)
    v_max3_u32 v5, v5, v200, v201
    v_max3_u32 v5, v5, v202, v203
    v_max3_u32 v5, v5, v204, v205
    v_max3_u32 v5, v5, v206, v207
    v_max3_u32 v5, v5, v208, v209
    v_max3_u32 v5, v5, v210, v211
    v_max3_u32 v5, v5, v212, v213
    v_max3_u32 v5, v5, v214, v215
    v_max3_u32 v5, v5, v216, v217
    v_max3_u32 v5, v5, v218, v219
    v_max3_u32 v5, v5, v220, v221
    v_max3_u32 v5, v5, v222, v223
    v_max3_u32 v5, v5, v224, v225
    v_max3_u32 v5, v5, v226, v227
    s_cmp_gt_u32 s32, 200000
    s_cbranch_scc1 L_B0_rp_ok
    v_cmp_eq_u32 vcc, -1, v5
    s_cbranch_vccz L_B0_rp_ok
    s_sleep 2
    s_branch L_B0_rp
L_B0_rp_ok:
    v_add_f32 v200, v200, v201
    v_add_f32 v202, v202, v203
    v_add_f32 v200, v200, v202
    v_cvt_pk_bf16_f32 v5, v200, v200
    v_lshlrev_b32 v200, 16, v5
    v_ashrrev_i32 v5, 31, v200
    v_or_b32 v5, 0x80000000, v5
    v_xor_b32 v5, v5, v200
    v_and_b32 v5, 0xffff0000, v5
    v_sub_u32 v6, 2047, v0
    v_or_b32 v232, v5, v6
    v_add_f32 v204, v204, v205
    v_add_f32 v206, v206, v207
    v_add_f32 v204, v204, v206
    v_cvt_pk_bf16_f32 v5, v204, v204
    v_lshlrev_b32 v204, 16, v5
    v_ashrrev_i32 v5, 31, v204
    v_or_b32 v5, 0x80000000, v5
    v_xor_b32 v5, v5, v204
    v_and_b32 v5, 0xffff0000, v5
    v_sub_u32 v6, 1791, v0
    v_or_b32 v233, v5, v6
    v_add_f32 v208, v208, v209
    v_add_f32 v210, v210, v211
    v_add_f32 v208, v208, v210
    v_cvt_pk_bf16_f32 v5, v208, v208
    v_lshlrev_b32 v208, 16, v5
    v_ashrrev_i32 v5, 31, v208
    v_or_b32 v5, 0x80000000, v5
    v_xor_b32 v5, v5, v208
    v_and_b32 v5, 0xffff0000, v5
    v_sub_u32 v6, 1535, v0
    v_or_b32 v234, v5, v6
    v_add_f32 v212, v212, v213
    v_add_f32 v214, v214, v215
    v_add_f32 v212, v212, v214
    v_cvt_pk_bf16_f32 v5, v212, v212
    v_lshlrev_b32 v212, 16, v5
    v_ashrrev_i32 v5, 31, v212
    v_or_b32 v5, 0x80000000, v5
    v_xor_b32 v5, v5, v212
    v_and_b32 v5, 0xffff0000, v5
    v_sub_u32 v6, 1279, v0
    v_or_b32 v235, v5, v6
    v_add_f32 v216, v216, v217
    v_add_f32 v218, v218, v219
    v_add_f32 v216, v216, v218
    v_cvt_pk_bf16_f32 v5, v216, v216
    v_lshlrev_b32 v216, 16, v5
    v_ashrrev_i32 v5, 31, v216
    v_or_b32 v5, 0x80000000, v5
    v_xor_b32 v5, v5, v216
    v_and_b32 v5, 0xffff0000, v5
    v_sub_u32 v6, 1023, v0
    v_or_b32 v236, v5, v6
    v_add_f32 v220, v220, v221
    v_add_f32 v222, v222, v223
    v_add_f32 v220, v220, v222
    v_cvt_pk_bf16_f32 v5, v220, v220
    v_lshlrev_b32 v220, 16, v5
    v_ashrrev_i32 v5, 31, v220
    v_or_b32 v5, 0x80000000, v5
    v_xor_b32 v5, v5, v220
    v_and_b32 v5, 0xffff0000, v5
    v_sub_u32 v6, 767, v0
    v_or_b32 v237, v5, v6
    v_add_f32 v224, v224, v225
    v_add_f32 v226, v226, v227
    v_add_f32 v224, v224, v226
    v_cvt_pk_bf16_f32 v5, v224, v224
    v_lshlrev_b32 v224, 16, v5
    v_ashrrev_i32 v5, 31, v224
    v_or_b32 v5, 0x80000000, v5
    v_xor_b32 v5, v5, v224
    v_and_b32 v5, 0xffff0000, v5
    v_sub_u32 v6, 511, v0
    v_or_b32 v238, v5, v6
L_B_round:
    v_lshlrev_b32 v3, 4, v0
L_B1_rp:
    s_mov_b32 s36, 0x19b000
    buffer_load_dwordx4 v[228:231], v3, s[8:11], s36 offen sc1
    s_add_u32 s32, s32, 1
    v_mov_b32 v5, 0
    s_waitcnt vmcnt(0)
    v_max3_u32 v5, v5, v228, v229
    v_max3_u32 v5, v5, v230, v231
    s_mul_i32 s37, s24, 96
    s_add_u32 s37, s37, 160
    v_cmp_gt_u32 s[74:75], s37, v0
    s_nop 1
    v_cndmask_b32 v5, 0, v5, s[74:75]
    s_cmp_gt_u32 s32, 200000
    s_cbranch_scc1 L_B1_rp_ok
    v_cmp_eq_u32 vcc, -1, v5
    s_cbranch_vccz L_B1_rp_ok
    s_sleep 2
    s_branch L_B1_rp
L_B1_rp_ok:
    v_add_f32 v228, v228, v229
    v_add_f32 v230, v230, v231
    v_add_f32 v228, v228, v230
    v_cvt_pk_bf16_f32 v5, v228, v228
    v_lshlrev_b32 v228, 16, v5
    v_ashrrev_i32 v5, 31, v228
    v_or_b32 v5, 0x80000000, v5
    v_xor_b32 v5, v5, v228
    v_and_b32 v5, 0xffff0000, v5
    v_sub_u32 v6, 255, v0
    v_or_b32 v239, v5, v6
    v_cndmask_b32 v239, 0, v239, s[74:75]
    v_mov_b32 v240, v232
    v_mov_b32 v241, v233
    v_mov_b32 v242, v234
    v_mov_b32 v243, v235
    v_mov_b32 v244, v236
    v_mov_b32 v245, v237
    v_mov_b32 v246, v238
    v_mov_b32 v247, v239
    v_lshrrev_b32 v7, 6, v0
    v_lshlrev_b32 v7, 2, v7
    v_mov_b32 v8, 0
    s_barrier
    v_max3_u32 v5, v240, v241, v242
    v_max3_u32 v5, v5, v243, v244
    v_max3_u32 v5, v5, v245, v246
    v_max_u32 v5, v5, v247
    s_nop 1
    v_max_u32_dpp v5, v5, v5 quad_perm:[1,0,3,2] row_mask:0xf bank_mask:0xf
    s_nop 1
    v_max_u32_dpp v5, v5, v5 quad_perm:[2,3,0,1] row_mask:0xf bank_mask:0xf
    s_nop 1
    v_max_u32_dpp v5, v5, v5 row_half_mirror row_mask:0xf bank_mask:0xf
    s_nop 1
    v_max_u32_dpp v5, v5, v5 row_mirror row_mask:0xf bank_mask:0xf
    v_mov_b32 v6, v5
    s_nop 1
    v_permlane16_swap_b32 v5, v6
    v_max_u32 v5, v5, v6
    v_mov_b32 v6, v5
    s_nop 1
    v_permlane32_swap_b32 v5, v6
    v_max_u32 v5, v5, v6
    ds_write_b32 v7, v5 offset:0
    s_waitcnt lgkmcnt(0)
    s_barrier
    ds_read_b128 v[248:251], v8 offset:0
    s_waitcnt lgkmcnt(0)
    v_max3_u32 v5, v248, v249, v250
    v_max_u32 v5, v5, v251
    s_nop 0
    v_readfirstlane_b32 s26, v5
    v_cmp_ne_u32 vcc, v5, v240
    s_nop 1
    v_cndmask_b32 v240, 0, v240, vcc
    v_cmp_ne_u32 vcc, v5, v241
    s_nop 1
    v_cndmask_b32 v241, 0, v241, vcc
    v_cmp_ne_u32 vcc, v5, v242
    s_nop 1
    v_cndmask_b32 v242, 0, v242, vcc
    v_cmp_ne_u32 vcc, v5, v243
    s_nop 1
    v_cndmask_b32 v243, 0, v243, vcc
    v_cmp_ne_u32 vcc, v5, v244
    s_nop 1
    v_cndmask_b32 v244, 0, v244, vcc
    v_cmp_ne_u32 vcc, v5, v245
    s_nop 1
    v_cndmask_b32 v245, 0, v245, vcc
    v_cmp_ne_u32 vcc, v5, v246
    s_nop 1
    v_cndmask_b32 v246, 0, v246, vcc
    v_cmp_ne_u32 vcc, v5, v247
    s_nop 1
    v_cndmask_b32 v247, 0, v247, vcc
    v_max3_u32 v5, v240, v241, v242
    v_max3_u32 v5, v5, v243, v244
    v_max3_u32 v5, v5, v245, v246
    v_max_u32 v5, v5, v247
    s_nop 1
    v_max_u32_dpp v5, v5, v5 quad_perm:[1,0,3,2] row_mask:0xf bank_mask:0xf
    s_nop 1
    v_max_u32_dpp v5, v5, v5 quad_perm:[2,3,0,1] row_mask:0xf bank_mask:0xf
    s_nop 1
    v_max_u32_dpp v5, v5, v5 row_half_mirror row_mask:0xf bank_mask:0xf
    s_nop 1
    v_max_u32_dpp v5, v5, v5 row_mirror row_mask:0xf bank_mask:0xf
    v_mov_b32 v6, v5
    s_nop 1
    v_permlane16_swap_b32 v5, v6
    v_max_u32 v5, v5, v6
    v_mov_b32 v6, v5
    s_nop 1
    v_permlane32_swap_b32 v5, v6
    v_max_u32 v5, v5, v6
    ds_write_b32 v7, v5 offset:16
    s_waitcnt lgkmcnt(0)
    s_barrier
    ds_read_b128 v[248:251], v8 offset:16
    s_waitcnt lgkmcnt(0)
    v_max3_u32 v5, v248, v249, v250
    v_max_u32 v5, v5, v251
    s_nop 0
    v_readfirstlane_b32 s27, v5
    s_nop 3
    s_and_b32 s36, s26, 0x7ff
    s_sub_u32 s30, 2047, s36
    s_and_b32 s36, s26, 0xffff0000
    s_xor_b32 s37, s36, 0x80000000
    s_xor_b32 s40, s36, 0xffff0000
    s_bitcmp1_b32 s36, 31
    s_cselect_b32 s40, s37, s40
    s_and_b32 s36, s27, 0x7ff
    s_sub_u32 s31, 2047, s36
    s_and_b32 s36, s27, 0xffff0000
    s_xor_b32 s37, s36, 0x80000000
    s_xor_b32 s41, s36, 0xffff0000
    s_bitcmp1_b32 s36, 31
    s_cselect_b32 s41, s37, s41
    s_cmp_eq_u64 s[26:27], s[28:29]
    s_cbranch_scc1 L_B_store
    s_mov_b64 s[28:29], s[26:27]
    v_bfe_u32 v9, v0, 3, 1
    v_cmp_ne_u32 vcc, 0, v9
    v_mov_b32 v5, s30
    v_mov_b32 v6, s31
    v_cndmask_b32 v12, v5, v6, vcc
    v_mov_b32 v5, s40
    v_mov_b32 v6, s41
    v_cndmask_b32 v13, v5, v6, vcc
    v_lshlrev_b32 v12, 10, v12
    v_lshl_add_u32 v12, v2, 2, v12
    v_add_u32 v12, s68, v12
    v_mov_b32 v7, 0x40000000
    v_cmp_lt_u32 vcc, 15, v0
    s_nop 1
    v_cndmask_b32 v12, v12, v7, vcc
    s_mov_b32 s36, 0x400000
    s_mov_b32 s37, 0x600000
    buffer_load_dword v14, v12, s[8:11], s36 offen sc1
    buffer_load_dword v15, v12, s[8:11], s37 offen sc1
    v_mul_u32_u24 v3, 224, v1
    s_mul_i32 s36, s24, 14336
    s_add_u32 s36, s36, 0x1b0000
    s_add_u32 s37, s36, 7168
L_B_poll:
    buffer_load_dwordx4 v[72:75], v3, s[8:11], s36 offen offset:0 sc1
    buffer_load_dwordx4 v[76:79], v3, s[8:11], s36 offen offset:16 sc1
    buffer_load_dwordx4 v[80:83], v3, s[8:11], s36 offen offset:32 sc1
    buffer_load_dwordx4 v[84:87], v3, s[8:11], s36 offen offset:48 sc1
    buffer_load_dwordx4 v[88:91], v3, s[8:11], s36 offen offset:64 sc1
    buffer_load_dwordx4 v[92:95], v3, s[8:11], s36 offen offset:80 sc1
    buffer_load_dwordx4 v[96:99], v3, s[8:11], s36 offen offset:96 sc1
    buffer_load_dwordx4 v[100:103], v3, s[8:11], s36 offen offset:112 sc1
    buffer_load_dwordx4 v[104:107], v3, s[8:11], s36 offen offset:128 sc1
    buffer_load_dwordx4 v[108:111], v3, s[8:11], s36 offen offset:144 sc1
    buffer_load_dwordx4 v[112:115], v3, s[8:11], s36 offen offset:160 sc1
    buffer_load_dwordx4 v[116:119], v3, s[8:11], s36 offen offset:176 sc1
    buffer_load_dwordx4 v[120:123], v3, s[8:11], s36 offen offset:192 sc1
    buffer_load_dwordx4 v[124:127], v3, s[8:11], s36 offen offset:208 sc1
    buffer_load_dwordx4 v[128:131], v3, s[8:11], s37 offen offset:0 sc1
    buffer_load_dwordx4 v[132:135], v3, s[8:11], s37 offen offset:16 sc1
    buffer_load_dwordx4 v[136:139], v3, s[8:11], s37 offen offset:32 sc1
    buffer_load_dwordx4 v[140:143], v3, s[8:11], s37 offen offset:48 sc1
    buffer_load_dwordx4 v[144:147], v3, s[8:11], s37 offen offset:64 sc1
    buffer_load_dwordx4 v[148:151], v3, s[8:11], s37 offen offset:80 sc1
    buffer_load_dwordx4 v[152:155], v3, s[8:11], s37 offen offset:96 sc1
    buffer_load_dwordx4 v[156:159], v3, s[8:11], s37 offen offset:112 sc1
    buffer_load_dwordx4 v[160:163], v3, s[8:11], s37 offen offset:128 sc1
    buffer_load_dwordx4 v[164:167], v3, s[8:11], s37 offen offset:144 sc1
    buffer_load_dwordx4 v[168:171], v3, s[8:11], s37 offen offset:160 sc1
    buffer_load_dwordx4 v[172:175], v3, s[8:11], s37 offen offset:176 sc1
    buffer_load_dwordx4 v[176:179], v3, s[8:11], s37 offen offset:192 sc1
    buffer_load_dwordx4 v[180:183], v3, s[8:11], s37 offen offset:208 sc1
    s_add_u32 s32, s32, 1
    s_cmp_gt_u32 s32, 200000
    v_mov_b32 v5, 0
    s_waitcnt vmcnt(0)
    v_max3_u32 v5, v5, v72, v73
    v_max3_u32 v5, v5, v74, v75
    v_max3_u32 v5, v5, v76, v77
    v_max3_u32 v5, v5, v78, v79
    v_max3_u32 v5, v5, v80, v81
    v_max3_u32 v5, v5, v82, v83
    v_max3_u32 v5, v5, v84, v85
    v_max3_u32 v5, v5, v86, v87
    v_max3_u32 v5, v5, v88, v89
    v_max3_u32 v5, v5, v90, v91
    v_max3_u32 v5, v5, v92, v93
    v_max3_u32 v5, v5, v94, v95
    v_max3_u32 v5, v5, v96, v97
    v_max3_u32 v5, v5, v98, v99
    v_max3_u32 v5, v5, v100, v101
    v_max3_u32 v5, v5, v102, v103
    v_max3_u32 v5, v5, v104, v105
    v_max3_u32 v5, v5, v106, v107
    v_max3_u32 v5, v5, v108, v109
    v_max3_u32 v5, v5, v110, v111
    v_max3_u32 v5, v5, v112, v113
    v_max3_u32 v5, v5, v114, v115
    v_max3_u32 v5, v5, v116, v117
    v_max3_u32 v5, v5, v118, v119
    v_max3_u32 v5, v5, v120, v121
    v_max3_u32 v5, v5, v122, v123
    v_max3_u32 v5, v5, v124, v125
    v_max3_u32 v5, v5, v126, v127
    v_max3_u32 v5, v5, v128, v129
    v_max3_u32 v5, v5, v130, v131
    v_max3_u32 v5, v5, v132, v133
    v_max3_u32 v5, v5, v134, v135
    v_max3_u32 v5, v5, v136, v137
    v_max3_u32 v5, v5, v138, v139
    v_max3_u32 v5, v5, v140, v141
    v_max3_u32 v5, v5, v142, v143
    v_max3_u32 v5, v5, v144, v145
    v_max3_u32 v5, v5, v146, v147
    v_max3_u32 v5, v5, v148, v149
    v_max3_u32 v5, v5, v150, v151
    v_max3_u32 v5, v5, v152, v153
    v_max3_u32 v5, v5, v154, v155
    v_max3_u32 v5, v5, v156, v157
    v_max3_u32 v5, v5, v158, v159
    v_max3_u32 v5, v5, v160, v161
    v_max3_u32 v5, v5, v162, v163
    v_max3_u32 v5, v5, v164, v165
    v_max3_u32 v5, v5, v166, v167
    v_max3_u32 v5, v5, v168, v169
    v_max3_u32 v5, v5, v170, v171
    v_max3_u32 v5, v5, v172, v173
    v_max3_u32 v5, v5, v174, v175
    v_max3_u32 v5, v5, v176, v177
    v_max3_u32 v5, v5, v178, v179
    v_max3_u32 v5, v5, v180, v181
    v_max3_u32 v5, v5, v182, v183
    s_cbranch_scc1 L_B_got
    v_cmp_eq_u32 vcc, -1, v5
    s_cbranch_vccnz L_B_poll
L_B_got:
    v_mov_b32 v184, 0
    v_mov_b32 v185, 0
    v_mov_b32 v186, 0
    v_mov_b32 v187, 0
    v_lshlrev_b32 v5, 16, v16
    v_and_b32 v7, 0xffff0000, v16
    v_fmac_f32 v184, v72, v5
    v_fmac_f32 v185, v72, v7
    v_fmac_f32 v186, v128, v5
    v_fmac_f32 v187, v128, v7
    v_lshlrev_b32 v5, 16, v17
    v_and_b32 v7, 0xffff0000, v17
    v_fmac_f32 v184, v73, v5
    v_fmac_f32 v185, v73, v7
    v_fmac_f32 v186, v129, v5
    v_fmac_f32 v187, v129, v7
    v_lshlrev_b32 v5, 16, v18
    v_and_b32 v7, 0xffff0000, v18
    v_fmac_f32 v184, v74, v5
    v_fmac_f32 v185, v74, v7
    v_fmac_f32 v186, v130, v5
    v_fmac_f32 v187, v130, v7
    v_lshlrev_b32 v5, 16, v19
    v_and_b32 v7, 0xffff0000, v19
    v_fmac_f32 v184, v75, v5
    v_fmac_f32 v185, v75, v7
    v_fmac_f32 v186, v131, v5
    v_fmac_f32 v187, v131, v7
    v_lshlrev_b32 v5, 16, v20
    v_and_b32 v7, 0xffff0000, v20
    v_fmac_f32 v184, v76, v5
    v_fmac_f32 v185, v76, v7
    v_fmac_f32 v186, v132, v5
    v_fmac_f32 v187, v132, v7
    v_lshlrev_b32 v5, 16, v21
    v_and_b32 v7, 0xffff0000, v21
    v_fmac_f32 v184, v77, v5
    v_fmac_f32 v185, v77, v7
    v_fmac_f32 v186, v133, v5
    v_fmac_f32 v187, v133, v7
    v_lshlrev_b32 v5, 16, v22
    v_and_b32 v7, 0xffff0000, v22
    v_fmac_f32 v184, v78, v5
    v_fmac_f32 v185, v78, v7
    v_fmac_f32 v186, v134, v5
    v_fmac_f32 v187, v134, v7
    v_lshlrev_b32 v5, 16, v23
    v_and_b32 v7, 0xffff0000, v23
    v_fmac_f32 v184, v79, v5
    v_fmac_f32 v185, v79, v7
    v_fmac_f32 v186, v135, v5
    v_fmac_f32 v187, v135, v7
    v_lshlrev_b32 v5, 16, v24
    v_and_b32 v7, 0xffff0000, v24
    v_fmac_f32 v184, v80, v5
    v_fmac_f32 v185, v80, v7
    v_fmac_f32 v186, v136, v5
    v_fmac_f32 v187, v136, v7
    v_lshlrev_b32 v5, 16, v25
    v_and_b32 v7, 0xffff0000, v25
    v_fmac_f32 v184, v81, v5
    v_fmac_f32 v185, v81, v7
    v_fmac_f32 v186, v137, v5
    v_fmac_f32 v187, v137, v7
    v_lshlrev_b32 v5, 16, v26
    v_and_b32 v7, 0xffff0000, v26
    v_fmac_f32 v184, v82, v5
    v_fmac_f32 v185, v82, v7
    v_fmac_f32 v186, v138, v5
    v_fmac_f32 v187, v138, v7
    v_lshlrev_b32 v5, 16, v27
    v_and_b32 v7, 0xffff0000, v27
    v_fmac_f32 v184, v83, v5
    v_fmac_f32 v185, v83, v7
    v_fmac_f32 v186, v139, v5
    v_fmac_f32 v187, v139, v7
    v_lshlrev_b32 v5, 16, v28
    v_and_b32 v7, 0xffff0000, v28
    v_fmac_f32 v184, v84, v5
    v_fmac_f32 v185, v84, v7
    v_fmac_f32 v186, v140, v5
    v_fmac_f32 v187, v140, v7
    v_lshlrev_b32 v5, 16, v29
    v_and_b32 v7, 0xffff0000, v29
    v_fmac_f32 v184, v85, v5
    v_fmac_f32 v185, v85, v7
    v_fmac_f32 v186, v141, v5
    v_fmac_f32 v187, v141, v7
    v_lshlrev_b32 v5, 16, v30
    v_and_b32 v7, 0xffff0000, v30
    v_fmac_f32 v184, v86, v5
    v_fmac_f32 v185, v86, v7
    v_fmac_f32 v186, v142, v5
    v_fmac_f32 v187, v142, v7
    v_lshlrev_b32 v5, 16, v31
    v_and_b32 v7, 0xffff0000, v31
    v_fmac_f32 v184, v87, v5
    v_fmac_f32 v185, v87, v7
    v_fmac_f32 v186, v143, v5
    v_fmac_f32 v187, v143, v7
    v_lshlrev_b32 v5, 16, v32
    v_and_b32 v7, 0xffff0000, v32
    v_fmac_f32 v184, v88, v5
    v_fmac_f32 v185, v88, v7
    v_fmac_f32 v186, v144, v5
    v_fmac_f32 v187, v144, v7
    v_lshlrev_b32 v5, 16, v33
    v_and_b32 v7, 0xffff0000, v33
    v_fmac_f32 v184, v89, v5
    v_fmac_f32 v185, v89, v7
    v_fmac_f32 v186, v145, v5
    v_fmac_f32 v187, v145, v7
    v_lshlrev_b32 v5, 16, v34
    v_and_b32 v7, 0xffff0000, v34
    v_fmac_f32 v184, v90, v5
    v_fmac_f32 v185, v90, v7
    v_fmac_f32 v186, v146, v5
    v_fmac_f32 v187, v146, v7
    v_lshlrev_b32 v5, 16, v35
    v_and_b32 v7, 0xffff0000, v35
    v_fmac_f32 v184, v91, v5
    v_fmac_f32 v185, v91, v7
    v_fmac_f32 v186, v147, v5
    v_fmac_f32 v187, v147, v7
    v_lshlrev_b32 v5, 16, v36
    v_and_b32 v7, 0xffff0000, v36
    v_fmac_f32 v184, v92, v5
    v_fmac_f32 v185, v92, v7
    v_fmac_f32 v186, v148, v5
    v_fmac_f32 v187, v148, v7
    v_lshlrev_b32 v5, 16, v37
    v_and_b32 v7, 0xffff0000, v37
    v_fmac_f32 v184, v93, v5
    v_fmac_f32 v185, v93, v7
    v_fmac_f32 v186, v149, v5
    v_fmac_f32 v187, v149, v7
    v_lshlrev_b32 v5, 16, v38
    v_and_b32 v7, 0xffff0000, v38
    v_fmac_f32 v184, v94, v5
    v_fmac_f32 v185, v94, v7
    v_fmac_f32 v186, v150, v5
    v_fmac_f32 v187, v150, v7
    v_lshlrev_b32 v5, 16, v39
    v_and_b32 v7, 0xffff0000, v39
    v_fmac_f32 v184, v95, v5
    v_fmac_f32 v185, v95, v7
    v_fmac_f32 v186, v151, v5
    v_fmac_f32 v187, v151, v7
    v_lshlrev_b32 v5, 16, v40
    v_and_b32 v7, 0xffff0000, v40
    v_fmac_f32 v184, v96, v5
    v_fmac_f32 v185, v96, v7
    v_fmac_f32 v186, v152, v5
    v_fmac_f32 v187, v152, v7
    v_lshlrev_b32 v5, 16, v41
    v_and_b32 v7, 0xffff0000, v41
    v_fmac_f32 v184, v97, v5
    v_fmac_f32 v185, v97, v7
    v_fmac_f32 v186, v153, v5
    v_fmac_f32 v187, v153, v7
    v_lshlrev_b32 v5, 16, v42
    v_and_b32 v7, 0xffff0000, v42
    v_fmac_f32 v184, v98, v5
    v_fmac_f32 v185, v98, v7
    v_fmac_f32 v186, v154, v5
    v_fmac_f32 v187, v154, v7
    v_lshlrev_b32 v5, 16, v43
    v_and_b32 v7, 0xffff0000, v43
    v_fmac_f32 v184, v99, v5
    v_fmac_f32 v185, v99, v7
    v_fmac_f32 v186, v155, v5
    v_fmac_f32 v187, v155, v7
    v_lshlrev_b32 v5, 16, v44
    v_and_b32 v7, 0xffff0000, v44
    v_fmac_f32 v184, v100, v5
    v_fmac_f32 v185, v100, v7
    v_fmac_f32 v186, v156, v5
    v_fmac_f32 v187, v156, v7
    v_lshlrev_b32 v5, 16, v45
    v_and_b32 v7, 0xffff0000, v45
    v_fmac_f32 v184, v101, v5
    v_fmac_f32 v185, v101, v7
    v_fmac_f32 v186, v157, v5
    v_fmac_f32 v187, v157, v7
    v_lshlrev_b32 v5, 16, v46
    v_and_b32 v7, 0xffff0000, v46
    v_fmac_f32 v184, v102, v5
    v_fmac_f32 v185, v102, v7
    v_fmac_f32 v186, v158, v5
    v_fmac_f32 v187, v158, v7
    v_lshlrev_b32 v5, 16, v47
    v_and_b32 v7, 0xffff0000, v47
    v_fmac_f32 v184, v103, v5
    v_fmac_f32 v185, v103, v7
    v_fmac_f32 v186, v159, v5
    v_fmac_f32 v187, v159, v7
    v_lshlrev_b32 v5, 16, v48
    v_and_b32 v7, 0xffff0000, v48
    v_fmac_f32 v184, v104, v5
    v_fmac_f32 v185, v104, v7
    v_fmac_f32 v186, v160, v5
    v_fmac_f32 v187, v160, v7
    v_lshlrev_b32 v5, 16, v49
    v_and_b32 v7, 0xffff0000, v49
    v_fmac_f32 v184, v105, v5
    v_fmac_f32 v185, v105, v7
    v_fmac_f32 v186, v161, v5
    v_fmac_f32 v187, v161, v7
    v_lshlrev_b32 v5, 16, v50
    v_and_b32 v7, 0xffff0000, v50
    v_fmac_f32 v184, v106, v5
    v_fmac_f32 v185, v106, v7
    v_fmac_f32 v186, v162, v5
    v_fmac_f32 v187, v162, v7
    v_lshlrev_b32 v5, 16, v51
    v_and_b32 v7, 0xffff0000, v51
    v_fmac_f32 v184, v107, v5
    v_fmac_f32 v185, v107, v7
    v_fmac_f32 v186, v163, v5
    v_fmac_f32 v187, v163, v7
    v_lshlrev_b32 v5, 16, v52
    v_and_b32 v7, 0xffff0000, v52
    v_fmac_f32 v184, v108, v5
    v_fmac_f32 v185, v108, v7
    v_fmac_f32 v186, v164, v5
    v_fmac_f32 v187, v164, v7
    v_lshlrev_b32 v5, 16, v53
    v_and_b32 v7, 0xffff0000, v53
    v_fmac_f32 v184, v109, v5
    v_fmac_f32 v185, v109, v7
    v_fmac_f32 v186, v165, v5
    v_fmac_f32 v187, v165, v7
    v_lshlrev_b32 v5, 16, v54
    v_and_b32 v7, 0xffff0000, v54
    v_fmac_f32 v184, v110, v5
    v_fmac_f32 v185, v110, v7
    v_fmac_f32 v186, v166, v5
    v_fmac_f32 v187, v166, v7
    v_lshlrev_b32 v5, 16, v55
    v_and_b32 v7, 0xffff0000, v55
    v_fmac_f32 v184, v111, v5
    v_fmac_f32 v185, v111, v7
    v_fmac_f32 v186, v167, v5
    v_fmac_f32 v187, v167, v7
    v_lshlrev_b32 v5, 16, v56
    v_and_b32 v7, 0xffff0000, v56
    v_fmac_f32 v184, v112, v5
    v_fmac_f32 v185, v112, v7
    v_fmac_f32 v186, v168, v5
    v_fmac_f32 v187, v168, v7
    v_lshlrev_b32 v5, 16, v57
    v_and_b32 v7, 0xffff0000, v57
    v_fmac_f32 v184, v113, v5
    v_fmac_f32 v185, v113, v7
    v_fmac_f32 v186, v169, v5
    v_fmac_f32 v187, v169, v7
    v_lshlrev_b32 v5, 16, v58
    v_and_b32 v7, 0xffff0000, v58
    v_fmac_f32 v184, v114, v5
    v_fmac_f32 v185, v114, v7
    v_fmac_f32 v186, v170, v5
    v_fmac_f32 v187, v170, v7
    v_lshlrev_b32 v5, 16, v59
    v_and_b32 v7, 0xffff0000, v59
    v_fmac_f32 v184, v115, v5
    v_fmac_f32 v185, v115, v7
    v_fmac_f32 v186, v171, v5
    v_fmac_f32 v187, v171, v7
    v_lshlrev_b32 v5, 16, v60
    v_and_b32 v7, 0xffff0000, v60
    v_fmac_f32 v184, v116, v5
    v_fmac_f32 v185, v116, v7
    v_fmac_f32 v186, v172, v5
    v_fmac_f32 v187, v172, v7
    v_lshlrev_b32 v5, 16, v61
    v_and_b32 v7, 0xffff0000, v61
    v_fmac_f32 v184, v117, v5
    v_fmac_f32 v185, v117, v7
    v_fmac_f32 v186, v173, v5
    v_fmac_f32 v187, v173, v7
    v_lshlrev_b32 v5, 16, v62
    v_and_b32 v7, 0xffff0000, v62
    v_fmac_f32 v184, v118, v5
    v_fmac_f32 v185, v118, v7
    v_fmac_f32 v186, v174, v5
    v_fmac_f32 v187, v174, v7
    v_lshlrev_b32 v5, 16, v63
    v_and_b32 v7, 0xffff0000, v63
    v_fmac_f32 v184, v119, v5
    v_fmac_f32 v185, v119, v7
    v_fmac_f32 v186, v175, v5
    v_fmac_f32 v187, v175, v7
    v_lshlrev_b32 v5, 16, v64
    v_and_b32 v7, 0xffff0000, v64
    v_fmac_f32 v184, v120, v5
    v_fmac_f32 v185, v120, v7
    v_fmac_f32 v186, v176, v5
    v_fmac_f32 v187, v176, v7
    v_lshlrev_b32 v5, 16, v65
    v_and_b32 v7, 0xffff0000, v65
    v_fmac_f32 v184, v121, v5
    v_fmac_f32 v185, v121, v7
    v_fmac_f32 v186, v177, v5
    v_fmac_f32 v187, v177, v7
    v_lshlrev_b32 v5, 16, v66
    v_and_b32 v7, 0xffff0000, v66
    v_fmac_f32 v184, v122, v5
    v_fmac_f32 v185, v122, v7
    v_fmac_f32 v186, v178, v5
    v_fmac_f32 v187, v178, v7
    v_lshlrev_b32 v5, 16, v67
    v_and_b32 v7, 0xffff0000, v67
    v_fmac_f32 v184, v123, v5
    v_fmac_f32 v185, v123, v7
    v_fmac_f32 v186, v179, v5
    v_fmac_f32 v187, v179, v7
    v_lshlrev_b32 v5, 16, v68
    v_and_b32 v7, 0xffff0000, v68
    v_fmac_f32 v184, v124, v5
    v_fmac_f32 v185, v124, v7
    v_fmac_f32 v186, v180, v5
    v_fmac_f32 v187, v180, v7
    v_lshlrev_b32 v5, 16, v69
    v_and_b32 v7, 0xffff0000, v69
    v_fmac_f32 v184, v125, v5
    v_fmac_f32 v185, v125, v7
    v_fmac_f32 v186, v181, v5
    v_fmac_f32 v187, v181, v7
    v_lshlrev_b32 v5, 16, v70
    v_and_b32 v7, 0xffff0000, v70
    v_fmac_f32 v184, v126, v5
    v_fmac_f32 v185, v126, v7
    v_fmac_f32 v186, v182, v5
    v_fmac_f32 v187, v182, v7
    v_lshlrev_b32 v5, 16, v71
    v_and_b32 v7, 0xffff0000, v71
    v_fmac_f32 v184, v127, v5
    v_fmac_f32 v185, v127, v7
    v_fmac_f32 v186, v183, v5
    v_fmac_f32 v187, v183, v7
    v_add_f32_dpp v184, v184, v184 row_ror:8 row_mask:0xf bank_mask:0xf
    v_add_f32_dpp v185, v185, v185 row_ror:8 row_mask:0xf bank_mask:0xf
    v_add_f32_dpp v186, v186, v186 row_ror:8 row_mask:0xf bank_mask:0xf
    v_add_f32_dpp v187, v187, v187 row_ror:8 row_mask:0xf bank_mask:0xf
    v_mov_b32 v5, v184
    s_nop 1
    v_permlane16_swap_b32 v184, v5
    v_add_f32 v184, v184, v5
    v_mov_b32 v5, v185
    s_nop 1
    v_permlane16_swap_b32 v185, v5
    v_add_f32 v185, v185, v5
    v_mov_b32 v5, v186
    s_nop 1
    v_permlane16_swap_b32 v186, v5
    v_add_f32 v186, v186, v5
    v_mov_b32 v5, v187
    s_nop 1
    v_permlane16_swap_b32 v187, v5
    v_add_f32 v187, v187, v5
    v_mov_b32 v5, v184
    s_nop 1
    v_permlane32_swap_b32 v184, v5
    v_add_f32 v184, v184, v5
    v_mov_b32 v5, v185
    s_nop 1
    v_permlane32_swap_b32 v185, v5
    v_add_f32 v185, v185, v5
    v_mov_b32 v5, v186
    s_nop 1
    v_permlane32_swap_b32 v186, v5
    v_add_f32 v186, v186, v5
    v_mov_b32 v5, v187
    s_nop 1
    v_permlane32_swap_b32 v187, v5
    v_add_f32 v187, v187, v5
    v_lshrrev_b32 v7, 6, v0
    v_lshlrev_b32 v7, 7, v7
    v_lshl_add_u32 v7, v2, 4, v7
    ds_write_b128 v7, v[184:187] offset:64
    s_waitcnt lgkmcnt(0)
    s_barrier
    v_lshlrev_b32 v7, 4, v2
    v_lshl_add_u32 v7, v9, 3, v7
    ds_read_b64 v[188:189], v7 offset:64
    ds_read_b64 v[190:191], v7 offset:192
    ds_read_b64 v[192:193], v7 offset:320
    ds_read_b64 v[194:195], v7 offset:448
    v_mul_f32 v10, 0xbfb8aa3b, v13
    v_exp_f32 v10, v10
    s_nop 0
    v_add_f32 v10, 1.0, v10
    v_rcp_f32 v10, v10
    s_nop 0
    v_cvt_pk_bf16_f32 v5, v10, v10
    v_lshlrev_b32 v10, 16, v5
    s_waitcnt lgkmcnt(0)
    v_lshlrev_b32 v196, 16, v15
    v_and_b32 v197, 0xffff0000, v15
    v_lshlrev_b32 v198, 16, v14
    v_and_b32 v199, 0xffff0000, v14
    v_add_f32 v188, v188, v190
    v_add_f32 v192, v192, v194
    v_add_f32 v188, v188, v192
    v_cvt_pk_bf16_f32 v5, v188, v188
    v_lshlrev_b32 v188, 16, v5
    v_mul_f32 v188, v188, v10
    v_cvt_pk_bf16_f32 v5, v188, v188
    v_lshlrev_b32 v188, 16, v5
    v_add_f32 v188, v188, v196
    v_cvt_pk_bf16_f32 v5, v188, v188
    v_lshlrev_b32 v188, 16, v5
    v_add_f32 v188, v188, v198
    v_add_f32 v189, v189, v191
    v_add_f32 v193, v193, v195
    v_add_f32 v189, v189, v193
    v_cvt_pk_bf16_f32 v5, v189, v189
    v_lshlrev_b32 v189, 16, v5
    v_mul_f32 v189, v189, v10
    v_cvt_pk_bf16_f32 v5, v189, v189
    v_lshlrev_b32 v189, 16, v5
    v_add_f32 v189, v189, v197
    v_cvt_pk_bf16_f32 v5, v189, v189
    v_lshlrev_b32 v189, 16, v5
    v_add_f32 v189, v189, v199
    v_cvt_pk_bf16_f32 v11, v188, v189
    s_add_u32 s24, s24, 1
    s_cmp_lt_u32 s24, 2
    s_cbranch_scc1 L_B_round
L_B_store:
    buffer_store_dword v11, v12, s[60:63], 0 offen sc1
    s_branch L_end
L_end:
    s_endpgm
.section .rodata,"a"
.p2align 6
.amdhsa_kernel sequential_preLN__memory_aug_recurrent_mem_tr__moe_arch_mod__prompt_kernel
  .amdhsa_next_free_vgpr 512
  .amdhsa_next_free_sgpr 102
  .amdhsa_accum_offset 256
  .amdhsa_group_segment_fixed_size 0
  .amdhsa_kernarg_size 120
  .amdhsa_user_sgpr_count 2
  .amdhsa_user_sgpr_kernarg_segment_ptr 1
  .amdhsa_system_sgpr_workgroup_id_x 1
.end_amdhsa_kernel
```

```asm
; @launch grid=(256,1,1) block=(256,1,1) lds=163840
.amdgcn_target "amdgcn-amd-amdhsa--gfx950"
.text
.globl sequential_preLN__memory_aug_recurrent_mem_tr__moe_arch_mod__prompt_kernel
.p2align 8
.type sequential_preLN__memory_aug_recurrent_mem_tr__moe_arch_mod__prompt_kernel,@function
sequential_preLN__memory_aug_recurrent_mem_tr__moe_arch_mod__prompt_kernel:
    s_cmp_ge_u32 s2, 256
    s_cbranch_scc1 L_end
    s_load_dwordx8 s[44:51], s[0:1], 0
    s_load_dwordx4 s[52:55], s[0:1], 32
    s_load_dwordx4 s[56:59], s[0:1], 104
    s_load_dwordx2 s[80:81], s[0:1], 64
    s_load_dwordx2 s[82:83], s[0:1], 96
    s_load_dwordx4 s[84:87], s[0:1], 72
    s_load_dwordx2 s[88:89], s[0:1], 88
    v_lshrrev_b32 v1, 6, v0
    s_nop 0
    v_readfirstlane_b32 s21, v1
    s_waitcnt lgkmcnt(0)
    s_mov_b32 s8, s58
    s_and_b32 s9, s59, 0xffff
    s_mov_b32 s10, 0x10000000
    s_mov_b32 s11, 0x20000
    s_mov_b32 s16, s56
    s_and_b32 s17, s57, 0xffff
    s_mov_b32 s18, 0x100
    s_mov_b32 s19, 0x20000
    s_and_b32 s3, s2, 7
    s_cmp_lg_u32 s3, 0
    s_cbranch_scc1 L_worker
    s_lshr_b32 s20, s2, 3
    v_mov_b32 v1, 0x4444
    v_bfe_u32 v14, v0, 1, 1
    s_mov_b32 s38, 0xaaaa
    v_mad_u32_u24 v1, v14, s38, v1
    v_mov_b32 v3, 0x0
    v_bfe_u32 v14, v0, 0, 1
    s_mov_b32 s38, 0x10
    v_mad_u32_u24 v3, v14, s38, v3
    v_bfe_u32 v14, v0, 1, 1
    s_mov_b32 s38, 0x20
    v_mad_u32_u24 v3, v14, s38, v3
    v_bfe_u32 v14, v0, 2, 1
    s_mov_b32 s38, 0x40
    v_mad_u32_u24 v3, v14, s38, v3
    v_bfe_u32 v14, v0, 3, 1
    s_mov_b32 s38, 0x80
    v_mad_u32_u24 v3, v14, s38, v3
    v_bfe_u32 v14, v0, 4, 1
    s_mov_b32 s38, 0x100
    v_mad_u32_u24 v3, v14, s38, v3
    v_bfe_u32 v14, v0, 5, 1
    s_mov_b32 s38, 0x200
    v_mad_u32_u24 v3, v14, s38, v3
    v_mov_b32 v2, 0x0
    v_bfe_u32 v14, v0, 0, 1
    s_mov_b32 s38, 0x10
    v_mad_u32_u24 v2, v14, s38, v2
    v_bfe_u32 v14, v0, 1, 1
    s_mov_b32 s38, 0x20
    v_mad_u32_u24 v2, v14, s38, v2
    v_bfe_u32 v14, v0, 2, 1
    s_mov_b32 s38, 0x40
    v_mad_u32_u24 v2, v14, s38, v2
    v_bfe_u32 v14, v0, 3, 1
    s_mov_b32 s38, 0x80
    v_mad_u32_u24 v2, v14, s38, v2
    v_bfe_u32 v14, v0, 4, 1
    s_mov_b32 s38, 0x100
    v_mad_u32_u24 v2, v14, s38, v2
    v_bfe_u32 v14, v0, 5, 1
    s_mov_b32 s38, 0x200
    v_mad_u32_u24 v2, v14, s38, v2
    v_bfe_u32 v14, v0, 6, 1
    s_mov_b32 s38, 0x800
    v_mad_u32_u24 v2, v14, s38, v2
    v_bfe_u32 v14, v0, 7, 1
    s_mov_b32 s38, 0x1000
    v_mad_u32_u24 v2, v14, s38, v2
    v_mov_b32 v4, 0x8000
    v_bfe_u32 v14, v0, 0, 1
    s_mov_b32 s38, 0x10
    v_mad_u32_u24 v4, v14, s38, v4
    v_bfe_u32 v14, v0, 1, 1
    s_mov_b32 s38, 0x20
    v_mad_u32_u24 v4, v14, s38, v4
    v_bfe_u32 v14, v0, 2, 1
    s_mov_b32 s38, 0x40
    v_mad_u32_u24 v4, v14, s38, v4
    v_bfe_u32 v14, v0, 3, 1
    s_mov_b32 s38, 0x80
    v_mad_u32_u24 v4, v14, s38, v4
    v_bfe_u32 v14, v0, 4, 1
    s_mov_b32 s38, 0x100
    v_mad_u32_u24 v4, v14, s38, v4
    v_bfe_u32 v14, v0, 5, 1
    s_mov_b32 s38, 0x200
    v_mad_u32_u24 v4, v14, s38, v4
    v_bfe_u32 v14, v0, 6, 1
    s_mov_b32 s38, 0x8000
    v_mad_u32_u24 v4, v14, s38, v4
    v_bfe_u32 v14, v0, 7, 1
    s_mov_b32 s38, 0x10000
    v_mad_u32_u24 v4, v14, s38, v4
    v_mov_b32 v5, 0x4000
    v_bfe_u32 v14, v0, 0, 1
    s_mov_b32 s38, 0x4
    v_mad_u32_u24 v5, v14, s38, v5
    v_bfe_u32 v14, v0, 1, 1
    s_mov_b32 s38, 0x8
    v_mad_u32_u24 v5, v14, s38, v5
    v_bfe_u32 v14, v0, 2, 1
    s_mov_b32 s38, 0x10
    v_mad_u32_u24 v5, v14, s38, v5
    v_bfe_u32 v14, v0, 3, 1
    s_mov_b32 s38, 0x20
    v_mad_u32_u24 v5, v14, s38, v5
    v_bfe_u32 v14, v0, 4, 1
    s_mov_b32 s38, 0x240
    v_mad_u32_u24 v5, v14, s38, v5
    v_bfe_u32 v14, v0, 5, 1
    s_mov_b32 s38, 0x480
    v_mad_u32_u24 v5, v14, s38, v5
    v_bfe_u32 v14, v0, 6, 1
    s_mov_b32 s38, 0x40
    v_mad_u32_u24 v5, v14, s38, v5
    v_bfe_u32 v14, v0, 7, 1
    s_mov_b32 s38, 0x80
    v_mad_u32_u24 v5, v14, s38, v5
    v_mov_b32 v6, 0x4000
    v_bfe_u32 v14, v0, 1, 1
    s_mov_b32 s38, 0x120
    v_mad_u32_u24 v6, v14, s38, v6
    v_bfe_u32 v14, v0, 2, 1
    s_mov_b32 s38, 0x240
    v_mad_u32_u24 v6, v14, s38, v6
    v_bfe_u32 v14, v0, 3, 1
    s_mov_b32 s38, 0x480
    v_mad_u32_u24 v6, v14, s38, v6
    v_bfe_u32 v14, v0, 4, 1
    s_mov_b32 s38, 0x10
    v_mad_u32_u24 v6, v14, s38, v6
    v_bfe_u32 v14, v0, 5, 1
    s_mov_b32 s38, 0x20
    v_mad_u32_u24 v6, v14, s38, v6
    v_mov_b32 v7, 0x4900
    v_bfe_u32 v14, v0, 0, 1
    s_mov_b32 s38, 0x120
    v_mad_u32_u24 v7, v14, s38, v7
    v_bfe_u32 v14, v0, 2, 1
    s_mov_b32 s38, 0x240
    v_mad_u32_u24 v7, v14, s38, v7
    v_bfe_u32 v14, v0, 3, 1
    s_mov_b32 s38, 0x480
    v_mad_u32_u24 v7, v14, s38, v7
    v_bfe_u32 v14, v0, 4, 1
    s_mov_b32 s38, 0x10
    v_mad_u32_u24 v7, v14, s38, v7
    v_bfe_u32 v14, v0, 5, 1
    s_mov_b32 s38, 0x20
    v_mad_u32_u24 v7, v14, s38, v7
    v_mov_b32 v8, 0x5200
    v_bfe_u32 v14, v0, 1, 1
    s_mov_b32 s38, 0x10
    v_mad_u32_u24 v8, v14, s38, v8
    v_bfe_u32 v14, v0, 2, 1
    s_mov_b32 s38, 0x40
    v_mad_u32_u24 v8, v14, s38, v8
    v_bfe_u32 v14, v0, 3, 1
    s_mov_b32 s38, 0x80
    v_mad_u32_u24 v8, v14, s38, v8
    v_bfe_u32 v14, v0, 4, 1
    s_mov_b32 s38, 0x20
    v_mad_u32_u24 v8, v14, s38, v8
    v_bfe_u32 v14, v0, 5, 1
    s_mov_b32 s38, 0x100
    v_mad_u32_u24 v8, v14, s38, v8
    v_bfe_u32 v14, v0, 6, 1
    s_mov_b32 s38, 0x200
    v_mad_u32_u24 v8, v14, s38, v8
    v_bfe_u32 v14, v0, 7, 1
    s_mov_b32 s38, 0x400
    v_mad_u32_u24 v8, v14, s38, v8
    v_mov_b32 v24, 0x0
    v_bfe_u32 v14, v0, 3, 1
    s_mov_b32 s38, 0x1
    v_mad_u32_u24 v24, v14, s38, v24
    v_bfe_u32 v14, v0, 4, 1
    s_mov_b32 s38, 0x2
    v_mad_u32_u24 v24, v14, s38, v24
    v_bfe_u32 v14, v0, 5, 1
    s_mov_b32 s38, 0x4
    v_mad_u32_u24 v24, v14, s38, v24
    v_bfe_u32 v14, v0, 6, 1
    s_mov_b32 s38, 0x8
    v_mad_u32_u24 v24, v14, s38, v24
    v_bfe_u32 v14, v0, 7, 1
    s_mov_b32 s38, 0x10
    v_mad_u32_u24 v24, v14, s38, v24
    v_add_u32 v24, s20, v24
    v_and_b32 v24, 31, v24
    v_lshlrev_b32 v24, 6, v24
    v_mov_b32 v9, 0x0
    v_bfe_u32 v14, v0, 0, 1
    s_mov_b32 s38, 0x8
    v_mad_u32_u24 v9, v14, s38, v9
    v_bfe_u32 v14, v0, 1, 1
    s_mov_b32 s38, 0x10
    v_mad_u32_u24 v9, v14, s38, v9
    v_bfe_u32 v14, v0, 2, 1
    s_mov_b32 s38, 0x20
    v_mad_u32_u24 v9, v14, s38, v9
    v_bfe_u32 v14, v0, 3, 1
    s_mov_b32 s38, 0x2000
    v_mad_u32_u24 v9, v14, s38, v9
    v_bfe_u32 v14, v0, 4, 1
    s_mov_b32 s38, 0x4000
    v_mad_u32_u24 v9, v14, s38, v9
    v_bfe_u32 v14, v0, 5, 1
    s_mov_b32 s38, 0x8000
    v_mad_u32_u24 v9, v14, s38, v9
    v_bfe_u32 v14, v0, 6, 1
    s_mov_b32 s38, 0x10000
    v_mad_u32_u24 v9, v14, s38, v9
    v_bfe_u32 v14, v0, 7, 1
    s_mov_b32 s38, 0x20000
    v_mad_u32_u24 v9, v14, s38, v9
    v_add_u32 v9, v9, v24
    v_mov_b32 v10, 0x80000
    v_bfe_u32 v14, v0, 0, 1
    s_mov_b32 s38, 0x8
    v_mad_u32_u24 v10, v14, s38, v10
    v_bfe_u32 v14, v0, 1, 1
    s_mov_b32 s38, 0x20
    v_mad_u32_u24 v10, v14, s38, v10
    v_bfe_u32 v14, v0, 4, 1
    s_mov_b32 s38, 0x10
    v_mad_u32_u24 v10, v14, s38, v10
    v_bfe_u32 v14, v0, 5, 1
    s_mov_b32 s38, 0x4
    v_mad_u32_u24 v10, v14, s38, v10
    v_bfe_u32 v14, v0, 6, 1
    s_mov_b32 s38, 0x800
    v_mad_u32_u24 v10, v14, s38, v10
    v_bfe_u32 v14, v0, 7, 1
    s_mov_b32 s38, 0x1000
    v_mad_u32_u24 v10, v14, s38, v10
    v_mov_b32 v25, s20
    v_mov_b32 v24, 0x0
    v_bfe_u32 v14, v25, 0, 1
    s_mov_b32 s38, 0x100
    v_mad_u32_u24 v24, v14, s38, v24
    v_bfe_u32 v14, v25, 1, 1
    s_mov_b32 s38, 0x40
    v_mad_u32_u24 v24, v14, s38, v24
    v_bfe_u32 v14, v25, 2, 1
    s_mov_b32 s38, 0x80
    v_mad_u32_u24 v24, v14, s38, v24
    v_bfe_u32 v14, v25, 3, 1
    s_mov_b32 s38, 0x200
    v_mad_u32_u24 v24, v14, s38, v24
    v_bfe_u32 v14, v25, 4, 1
    s_mov_b32 s38, 0x400
    v_mad_u32_u24 v24, v14, s38, v24
    v_add_u32 v10, v24, v10
    v_and_b32 v24, 12, v0
    v_cmp_ne_u32 vcc, 0, v24
    v_mov_b32 v24, 0x40000000
    s_nop 0
    v_cndmask_b32 v10, v10, v24, vcc
    s_lshl_b32 s6, s20, 13
    s_add_u32 s6, s6, 0x0
    s_mov_b32 s26, 4096
    v_and_b32 v24, 15, v0
    v_mov_b32 v16, 0
    v_mov_b32 v25, 0x3f80
    v_cmp_eq_u32 vcc, 0, v24
    s_nop 1
    v_cndmask_b32 v16, v16, v25, vcc
    v_mov_b32 v25, 0x3f800000
    v_cmp_eq_u32 vcc, 1, v24
    s_nop 1
    v_cndmask_b32 v16, v16, v25, vcc
    v_mov_b32 v17, 0
    v_mov_b32 v25, 0x3f80
    v_cmp_eq_u32 vcc, 4, v24
    s_nop 1
    v_cndmask_b32 v17, v17, v25, vcc
    v_mov_b32 v25, 0x3f800000
    v_cmp_eq_u32 vcc, 5, v24
    s_nop 1
    v_cndmask_b32 v17, v17, v25, vcc
    v_mov_b32 v18, 0
    v_mov_b32 v25, 0x3f80
    v_cmp_eq_u32 vcc, 8, v24
    s_nop 1
    v_cndmask_b32 v18, v18, v25, vcc
    v_mov_b32 v25, 0x3f800000
    v_cmp_eq_u32 vcc, 9, v24
    s_nop 1
    v_cndmask_b32 v18, v18, v25, vcc
    v_mov_b32 v19, 0
    v_mov_b32 v25, 0x3f80
    v_cmp_eq_u32 vcc, 12, v24
    s_nop 1
    v_cndmask_b32 v19, v19, v25, vcc
    v_mov_b32 v25, 0x3f800000
    v_cmp_eq_u32 vcc, 13, v24
    s_nop 1
    v_cndmask_b32 v19, v19, v25, vcc
    ds_write_b128 v3, v[16:19] offset:23040
    s_mov_b32 s34, 0x05040100
    s_mov_b32 s35, 0x07060302
    s_mov_b32 s33, 0x3e0293ee
    s_mov_b32 s40, 0x4e800000
    s_mov_b32 s32, 0
    s_mov_b32 s4, 0x3f803f80
    s_mov_b32 s5, 0x3f803f80
    s_lshl_b32 s36, s20, 14
    s_lshr_b32 s37, s21, 1
    s_lshl_b32 s37, s37, 12
    s_add_u32 s25, s36, s37
    s_lshl_b32 s37, s21, 11
    s_add_u32 s39, s36, s37
    s_add_u32 s39, s39, 8192
    v_mov_b32 v11, 0x0
    v_bfe_u32 v14, v0, 0, 1
    s_mov_b32 s38, 0x4
    v_mad_u32_u24 v11, v14, s38, v11
    v_bfe_u32 v14, v0, 1, 1
    s_mov_b32 s38, 0x8
    v_mad_u32_u24 v11, v14, s38, v11
    v_bfe_u32 v14, v0, 2, 1
    s_mov_b32 s38, 0x10
    v_mad_u32_u24 v11, v14, s38, v11
    v_bfe_u32 v14, v0, 3, 1
    s_mov_b32 s38, 0x20
    v_mad_u32_u24 v11, v14, s38, v11
    v_bfe_u32 v14, v0, 4, 1
    s_mov_b32 s38, 0x800
    v_mad_u32_u24 v11, v14, s38, v11
    v_bfe_u32 v14, v0, 5, 1
    s_mov_b32 s38, 0x2000
    v_mad_u32_u24 v11, v14, s38, v11
    v_bfe_u32 v14, v0, 6, 1
    s_mov_b32 s38, 0x100
    v_mad_u32_u24 v11, v14, s38, v11
    v_bfe_u32 v14, v0, 7, 1
    s_mov_b32 s38, 0x200
    v_mad_u32_u24 v11, v14, s38, v11
    s_mov_b32 s96, s48
    s_and_b32 s97, s49, 0xffff
    s_mov_b32 s98, 0x400000
    s_mov_b32 s99, 0x20000
    s_mov_b32 s88, s50
    s_and_b32 s89, s51, 0xffff
    s_mov_b32 s90, 0x400000
    s_mov_b32 s91, 0x20000
    s_mov_b32 s60, s52
    s_and_b32 s61, s53, 0xffff
    s_mov_b32 s62, 0x400000
    s_mov_b32 s63, 0x20000
    s_mov_b32 s92, s54
    s_and_b32 s93, s55, 0xffff
    s_mov_b32 s94, 0x400000
    s_mov_b32 s95, 0x20000
    s_lshl_b32 s29, s20, 17
    v_mov_b32 v16, 0x0
    v_bfe_u32 v14, v0, 0, 1
    s_mov_b32 s38, 0x10
    v_mad_u32_u24 v16, v14, s38, v16
    v_bfe_u32 v14, v0, 1, 1
    s_mov_b32 s38, 0x20
    v_mad_u32_u24 v16, v14, s38, v16
    v_bfe_u32 v14, v0, 2, 1
    s_mov_b32 s38, 0x40
    v_mad_u32_u24 v16, v14, s38, v16
    v_bfe_u32 v14, v0, 3, 1
    s_mov_b32 s38, 0x80
    v_mad_u32_u24 v16, v14, s38, v16
    v_bfe_u32 v14, v0, 4, 1
    s_mov_b32 s38, 0x2000
    v_mad_u32_u24 v16, v14, s38, v16
    v_bfe_u32 v14, v0, 5, 1
    s_mov_b32 s38, 0x4000
    v_mad_u32_u24 v16, v14, s38, v16
    v_bfe_u32 v14, v0, 6, 1
    s_mov_b32 s38, 0x40000
    v_mad_u32_u24 v16, v14, s38, v16
    v_bfe_u32 v14, v0, 7, 1
    s_mov_b32 s38, 0x80000
    v_mad_u32_u24 v16, v14, s38, v16
    v_mov_b32 v28, 0x0
    v_bfe_u32 v14, v0, 4, 1
    s_mov_b32 s38, 0x20
    v_mad_u32_u24 v28, v14, s38, v28
    v_xor_b32 v16, v16, v28
    v_xor_b32 v17, 64, v16
    v_xor_b32 v18, 128, v16
    v_xor_b32 v19, 192, v16
    v_mov_b32 v20, 0x0
    v_bfe_u32 v14, v0, 0, 1
    s_mov_b32 s38, 0x8
    v_mad_u32_u24 v20, v14, s38, v20
    v_bfe_u32 v14, v0, 1, 1
    s_mov_b32 s38, 0x10
    v_mad_u32_u24 v20, v14, s38, v20
    v_bfe_u32 v14, v0, 2, 1
    s_mov_b32 s38, 0x100
    v_mad_u32_u24 v20, v14, s38, v20
    v_bfe_u32 v14, v0, 3, 1
    s_mov_b32 s38, 0x800
    v_mad_u32_u24 v20, v14, s38, v20
    v_bfe_u32 v14, v0, 4, 1
    s_mov_b32 s38, 0x400
    v_mad_u32_u24 v20, v14, s38, v20
    v_bfe_u32 v14, v0, 5, 1
    s_mov_b32 s38, 0x1000
    v_mad_u32_u24 v20, v14, s38, v20
    v_mov_b32 v28, 0x0
    v_bfe_u32 v14, v0, 2, 1
    s_mov_b32 s38, 0x20
    v_mad_u32_u24 v28, v14, s38, v28
    v_bfe_u32 v14, v0, 3, 1
    s_mov_b32 s38, 0x80
    v_mad_u32_u24 v28, v14, s38, v28
    v_bfe_u32 v14, v0, 4, 1
    s_mov_b32 s38, 0x40
    v_mad_u32_u24 v28, v14, s38, v28
    v_mov_b32 v29, 0x0
    v_bfe_u32 v14, v0, 6, 1
    s_mov_b32 s38, 0x40
    v_mad_u32_u24 v29, v14, s38, v29
    v_bfe_u32 v14, v0, 7, 1
    s_mov_b32 s38, 0x80
    v_mad_u32_u24 v29, v14, s38, v29
    v_xor_b32 v28, v28, v29
    v_add_u32 v28, v28, v20
    s_xor_b32 s36, s21, 0
    s_add_u32 s36, s36, 1
    s_lshl_b32 s36, s36, 15
    v_add_u32 v20, s36, v28
    v_xor_b32 v21, 32, v20
    s_xor_b32 s36, s21, 1
    s_add_u32 s36, s36, 1
    s_lshl_b32 s36, s36, 15
    v_add_u32 v22, s36, v28
    v_xor_b32 v23, 32, v22
    s_xor_b32 s36, s21, 2
    s_add_u32 s36, s36, 1
    s_lshl_b32 s36, s36, 15
    v_add_u32 v24, s36, v28
    v_xor_b32 v25, 32, v24
    s_xor_b32 s36, s21, 3
    s_add_u32 s36, s36, 1
    s_lshl_b32 s36, s36, 15
    v_add_u32 v26, s36, v28
    v_xor_b32 v27, 32, v26
    s_add_u32 s28, s21, 1
    s_lshl_b32 s28, s28, 15
    s_lshl_b32 s3, s20, 8
    s_add_u32 m0, s28, 0
    s_add_u32 s37, s3, 0x0
    buffer_load_dwordx4 v16, s[60:63], s37 offen lds
    s_add_u32 m0, s28, 1024
    s_add_u32 s37, s3, 0x8000
    buffer_load_dwordx4 v17, s[60:63], s37 offen lds
    s_add_u32 m0, s28, 2048
    s_add_u32 s37, s3, 0x10000
    buffer_load_dwordx4 v18, s[60:63], s37 offen lds
    s_add_u32 m0, s28, 3072
    s_add_u32 s37, s3, 0x18000
    buffer_load_dwordx4 v19, s[60:63], s37 offen lds
    s_add_u32 m0, s28, 4096
    s_add_u32 s37, s3, 0x20000
    buffer_load_dwordx4 v16, s[60:63], s37 offen lds
    s_add_u32 m0, s28, 5120
    s_add_u32 s37, s3, 0x28000
    buffer_load_dwordx4 v17, s[60:63], s37 offen lds
    s_add_u32 m0, s28, 6144
    s_add_u32 s37, s3, 0x30000
    buffer_load_dwordx4 v18, s[60:63], s37 offen lds
    s_add_u32 m0, s28, 7168
    s_add_u32 s37, s3, 0x38000
    buffer_load_dwordx4 v19, s[60:63], s37 offen lds
    s_mov_b32 s12, s46
    s_and_b32 s13, s47, 0xffff
    s_mov_b32 s14, 0x2000
    s_mov_b32 s15, 0x20000
    v_mov_b32 v104, 0x0
    v_bfe_u32 v14, v0, 0, 1
    s_mov_b32 s38, 0x8
    v_mad_u32_u24 v104, v14, s38, v104
    v_bfe_u32 v14, v0, 1, 1
    s_mov_b32 s38, 0x10
    v_mad_u32_u24 v104, v14, s38, v104
    v_bfe_u32 v14, v0, 2, 1
    s_mov_b32 s38, 0x10000
    v_mad_u32_u24 v104, v14, s38, v104
    v_bfe_u32 v14, v0, 3, 1
    s_mov_b32 s38, 0x10000
    v_mad_u32_u24 v104, v14, s38, v104
    v_bfe_u32 v14, v0, 4, 1
    s_mov_b32 s38, 0x400
    v_mad_u32_u24 v104, v14, s38, v104
    v_bfe_u32 v14, v0, 5, 1
    s_mov_b32 s38, 0x4
    v_mad_u32_u24 v104, v14, s38, v104
    v_bfe_u32 v14, v0, 6, 1
    s_mov_b32 s38, 0x40
    v_mad_u32_u24 v104, v14, s38, v104
    v_bfe_u32 v14, v0, 7, 1
    s_mov_b32 s38, 0x80
    v_mad_u32_u24 v104, v14, s38, v104
    v_mov_b32 v106, s20
    v_mov_b32 v105, 0x0
    v_bfe_u32 v14, v106, 0, 1
    s_mov_b32 s38, 0x20
    v_mad_u32_u24 v105, v14, s38, v105
    v_bfe_u32 v14, v106, 1, 1
    s_mov_b32 s38, 0x800
    v_mad_u32_u24 v105, v14, s38, v105
    v_bfe_u32 v14, v106, 2, 1
    s_mov_b32 s38, 0x1000
    v_mad_u32_u24 v105, v14, s38, v105
    v_bfe_u32 v14, v106, 3, 1
    s_mov_b32 s38, 0x100
    v_mad_u32_u24 v105, v14, s38, v105
    v_bfe_u32 v14, v106, 4, 1
    s_mov_b32 s38, 0x200
    v_mad_u32_u24 v105, v14, s38, v105
    v_add_u32 v104, v104, v105
    buffer_load_dword v12, v104, s[12:15], 0 offen
    v_mov_b32 v100, -1
    v_mov_b32 v101, -1
    v_mov_b32 v102, -1
    v_mov_b32 v103, -1
    buffer_store_dwordx4 v[100:103], v2, s[8:11], s6 offen sc1
    buffer_store_dwordx4 v[100:103], v2, s[8:11], s6 offen offset:1024 sc1
    s_lshl_b32 s36, s20, 14
    s_add_u32 s36, s36, 0x100000
    s_add_u32 s37, s36, 0x2000
    buffer_store_dwordx4 v[100:103], v2, s[8:11], s36 offen sc1
    buffer_store_dwordx4 v[100:103], v2, s[8:11], s36 offen offset:1024 sc1
    buffer_store_dwordx4 v[100:103], v2, s[8:11], s37 offen sc1
    buffer_store_dwordx4 v[100:103], v2, s[8:11], s37 offen offset:1024 sc1
    s_mul_i32 s36, s20, 0x104000
    s_add_u32 s36, s36, 0x1102000
    s_add_u32 s37, s36, 0x82000
    buffer_store_dwordx4 v[100:103], v2, s[8:11], s36 offen sc1
    buffer_store_dwordx4 v[100:103], v2, s[8:11], s36 offen offset:1024 sc1
    buffer_store_dwordx4 v[100:103], v2, s[8:11], s37 offen sc1
    buffer_store_dwordx4 v[100:103], v2, s[8:11], s37 offen offset:1024 sc1
    v_lshlrev_b32 v104, 2, v0
    s_lshl_b32 s36, s20, 10
    s_add_u32 s37, s36, 0x194000
    buffer_store_dword v100, v104, s[8:11], s37 offen sc1
    s_add_u32 s37, s36, 0x1b0000
    buffer_store_dword v100, v104, s[8:11], s37 offen sc1
    v_mov_b32 v105, 0x40000000
    v_cmp_lt_u32 vcc, 63, v0
    s_nop 1
    v_cndmask_b32 v104, v104, v105, vcc
    v_mov_b32 v105, 0
    s_lshl_b32 s36, s20, 8
    s_add_u32 s36, s36, 0x190000
    s_add_u32 s37, s36, 0x2000
    buffer_store_dword v105, v104, s[8:11], s36 offen sc1
    buffer_store_dword v105, v104, s[8:11], s37 offen sc1
    s_add_u32 m0, s28, 8192
    s_add_u32 s37, s3, 0x100000
    buffer_load_dwordx4 v16, s[60:63], s37 offen lds
    s_add_u32 m0, s28, 9216
    s_add_u32 s37, s3, 0x108000
    buffer_load_dwordx4 v17, s[60:63], s37 offen lds
    s_add_u32 m0, s28, 10240
    s_add_u32 s37, s3, 0x110000
    buffer_load_dwordx4 v18, s[60:63], s37 offen lds
    s_add_u32 m0, s28, 11264
    s_add_u32 s37, s3, 0x118000
    buffer_load_dwordx4 v19, s[60:63], s37 offen lds
    s_add_u32 m0, s28, 12288
    s_add_u32 s37, s3, 0x120000
    buffer_load_dwordx4 v16, s[60:63], s37 offen lds
    s_add_u32 m0, s28, 13312
    s_add_u32 s37, s3, 0x128000
    buffer_load_dwordx4 v17, s[60:63], s37 offen lds
    s_add_u32 m0, s28, 14336
    s_add_u32 s37, s3, 0x130000
    buffer_load_dwordx4 v18, s[60:63], s37 offen lds
    s_add_u32 m0, s28, 15360
    s_add_u32 s37, s3, 0x138000
    buffer_load_dwordx4 v19, s[60:63], s37 offen lds
    s_add_u32 m0, s28, 16384
    s_add_u32 s37, s3, 0x200000
    buffer_load_dwordx4 v16, s[60:63], s37 offen lds
    s_add_u32 m0, s28, 17408
    s_add_u32 s37, s3, 0x208000
    buffer_load_dwordx4 v17, s[60:63], s37 offen lds
    s_add_u32 m0, s28, 18432
    s_add_u32 s37, s3, 0x210000
    buffer_load_dwordx4 v18, s[60:63], s37 offen lds
    s_add_u32 m0, s28, 19456
    s_add_u32 s37, s3, 0x218000
    buffer_load_dwordx4 v19, s[60:63], s37 offen lds
    s_add_u32 m0, s28, 20480
    s_add_u32 s37, s3, 0x220000
    buffer_load_dwordx4 v16, s[60:63], s37 offen lds
    s_add_u32 m0, s28, 21504
    s_add_u32 s37, s3, 0x228000
    buffer_load_dwordx4 v17, s[60:63], s37 offen lds
    s_add_u32 m0, s28, 22528
    s_add_u32 s37, s3, 0x230000
    buffer_load_dwordx4 v18, s[60:63], s37 offen lds
    s_add_u32 m0, s28, 23552
    s_add_u32 s37, s3, 0x238000
    buffer_load_dwordx4 v19, s[60:63], s37 offen lds
    s_add_u32 s37, s29, 0x0
    buffer_load_dword v32, v11, s[92:95], s37 offen
    s_add_u32 s37, s29, 0x4000
    buffer_load_dword v33, v11, s[92:95], s37 offen
    s_add_u32 s37, s29, 0x1000
    buffer_load_dword v34, v11, s[92:95], s37 offen
    s_add_u32 s37, s29, 0x5000
    buffer_load_dword v35, v11, s[92:95], s37 offen
    s_add_u32 s37, s29, 0x400
    buffer_load_dword v36, v11, s[92:95], s37 offen
    s_add_u32 s37, s29, 0x4400
    buffer_load_dword v37, v11, s[92:95], s37 offen
    s_add_u32 s37, s29, 0x1400
    buffer_load_dword v38, v11, s[92:95], s37 offen
    s_add_u32 s37, s29, 0x5400
    buffer_load_dword v39, v11, s[92:95], s37 offen
    s_add_u32 s37, s29, 0x8000
    buffer_load_dword v40, v11, s[92:95], s37 offen
    s_add_u32 s37, s29, 0xc000
    buffer_load_dword v41, v11, s[92:95], s37 offen
    s_add_u32 s37, s29, 0x9000
    buffer_load_dword v42, v11, s[92:95], s37 offen
    s_add_u32 s37, s29, 0xd000
    buffer_load_dword v43, v11, s[92:95], s37 offen
    s_add_u32 s37, s29, 0x8400
    buffer_load_dword v44, v11, s[92:95], s37 offen
    s_add_u32 s37, s29, 0xc400
    buffer_load_dword v45, v11, s[92:95], s37 offen
    s_add_u32 s37, s29, 0x9400
    buffer_load_dword v46, v11, s[92:95], s37 offen
    s_add_u32 s37, s29, 0xd400
    buffer_load_dword v47, v11, s[92:95], s37 offen
    s_waitcnt vmcnt(47)
    s_barrier
    ds_read_b64_tr_b16 a[160:161], v20 offset:0
    ds_read_b64_tr_b16 a[162:163], v20 offset:512
    ds_read_b64_tr_b16 a[168:169], v21 offset:0
    ds_read_b64_tr_b16 a[170:171], v21 offset:512
    ds_read_b64_tr_b16 a[192:193], v22 offset:0
    ds_read_b64_tr_b16 a[194:195], v22 offset:512
    ds_read_b64_tr_b16 a[200:201], v23 offset:0
    ds_read_b64_tr_b16 a[202:203], v23 offset:512
    ds_read_b64_tr_b16 a[224:225], v24 offset:0
    ds_read_b64_tr_b16 a[226:227], v24 offset:512
    ds_read_b64_tr_b16 a[232:233], v25 offset:0
    ds_read_b64_tr_b16 a[234:235], v25 offset:512
    s_waitcnt lgkmcnt(4)
    ds_read_b64_tr_b16 v[128:129], v26 offset:0
    ds_read_b64_tr_b16 v[130:131], v26 offset:512
    ds_read_b64_tr_b16 v[136:137], v27 offset:0
    ds_read_b64_tr_b16 v[138:139], v27 offset:512
    s_waitcnt lgkmcnt(0)
    s_barrier
    s_add_u32 m0, s28, 0
    s_add_u32 s37, s3, 0x300000
    buffer_load_dwordx4 v16, s[60:63], s37 offen lds
    s_add_u32 m0, s28, 1024
    s_add_u32 s37, s3, 0x308000
    buffer_load_dwordx4 v17, s[60:63], s37 offen lds
    s_add_u32 m0, s28, 2048
    s_add_u32 s37, s3, 0x310000
    buffer_load_dwordx4 v18, s[60:63], s37 offen lds
    s_add_u32 m0, s28, 3072
    s_add_u32 s37, s3, 0x318000
    buffer_load_dwordx4 v19, s[60:63], s37 offen lds
    s_add_u32 m0, s28, 4096
    s_add_u32 s37, s3, 0x320000
    buffer_load_dwordx4 v16, s[60:63], s37 offen lds
    s_add_u32 m0, s28, 5120
    s_add_u32 s37, s3, 0x328000
    buffer_load_dwordx4 v17, s[60:63], s37 offen lds
    s_add_u32 m0, s28, 6144
    s_add_u32 s37, s3, 0x330000
    buffer_load_dwordx4 v18, s[60:63], s37 offen lds
    s_add_u32 m0, s28, 7168
    s_add_u32 s37, s3, 0x338000
    buffer_load_dwordx4 v19, s[60:63], s37 offen lds
    s_waitcnt vmcnt(40)
    s_mov_b32 s36, 0x1000000
    buffer_store_dword v12, v10, s[8:11], s36 offen sc1
    s_add_u32 s37, s29, 0x10000
    buffer_load_dword v48, v11, s[92:95], s37 offen
    s_add_u32 s37, s29, 0x14000
    buffer_load_dword v49, v11, s[92:95], s37 offen
    s_add_u32 s37, s29, 0x11000
    buffer_load_dword v50, v11, s[92:95], s37 offen
    s_add_u32 s37, s29, 0x15000
    buffer_load_dword v51, v11, s[92:95], s37 offen
    s_add_u32 s37, s29, 0x10400
    buffer_load_dword v52, v11, s[92:95], s37 offen
    s_add_u32 s37, s29, 0x14400
    buffer_load_dword v53, v11, s[92:95], s37 offen
    s_add_u32 s37, s29, 0x11400
    buffer_load_dword v54, v11, s[92:95], s37 offen
    s_add_u32 s37, s29, 0x15400
    buffer_load_dword v55, v11, s[92:95], s37 offen
    s_add_u32 s37, s29, 0x18000
    buffer_load_dword v56, v11, s[92:95], s37 offen
    s_add_u32 s37, s29, 0x1c000
    buffer_load_dword v57, v11, s[92:95], s37 offen
    s_add_u32 s37, s29, 0x19000
    buffer_load_dword v58, v11, s[92:95], s37 offen
    s_add_u32 s37, s29, 0x1d000
    buffer_load_dword v59, v11, s[92:95], s37 offen
    s_add_u32 s37, s29, 0x18400
    buffer_load_dword v60, v11, s[92:95], s37 offen
    s_add_u32 s37, s29, 0x1c400
    buffer_load_dword v61, v11, s[92:95], s37 offen
    s_add_u32 s37, s29, 0x19400
    buffer_load_dword v62, v11, s[92:95], s37 offen
    s_add_u32 s37, s29, 0x1d400
    buffer_load_dword v63, v11, s[92:95], s37 offen
    s_waitcnt vmcnt(49)
    s_barrier
    ds_read_b64_tr_b16 a[164:165], v20 offset:8192
    ds_read_b64_tr_b16 a[166:167], v20 offset:8704
    ds_read_b64_tr_b16 a[172:173], v21 offset:8192
    ds_read_b64_tr_b16 a[174:175], v21 offset:8704
    ds_read_b64_tr_b16 a[196:197], v22 offset:8192
    ds_read_b64_tr_b16 a[198:199], v22 offset:8704
    ds_read_b64_tr_b16 a[204:205], v23 offset:8192
    ds_read_b64_tr_b16 a[206:207], v23 offset:8704
    ds_read_b64_tr_b16 a[228:229], v24 offset:8192
    ds_read_b64_tr_b16 a[230:231], v24 offset:8704
    ds_read_b64_tr_b16 a[236:237], v25 offset:8192
    ds_read_b64_tr_b16 a[238:239], v25 offset:8704
    s_waitcnt lgkmcnt(4)
    ds_read_b64_tr_b16 v[132:133], v26 offset:8192
    ds_read_b64_tr_b16 v[134:135], v26 offset:8704
    ds_read_b64_tr_b16 v[140:141], v27 offset:8192
    ds_read_b64_tr_b16 v[142:143], v27 offset:8704
    s_waitcnt lgkmcnt(0)
    s_barrier
    s_add_u32 m0, s28, 8192
    s_add_u32 s37, s3, 0x0
    buffer_load_dwordx4 v16, s[88:91], s37 offen lds
    s_add_u32 m0, s28, 9216
    s_add_u32 s37, s3, 0x8000
    buffer_load_dwordx4 v17, s[88:91], s37 offen lds
    s_add_u32 m0, s28, 10240
    s_add_u32 s37, s3, 0x10000
    buffer_load_dwordx4 v18, s[88:91], s37 offen lds
    s_add_u32 m0, s28, 11264
    s_add_u32 s37, s3, 0x18000
    buffer_load_dwordx4 v19, s[88:91], s37 offen lds
    s_add_u32 m0, s28, 12288
    s_add_u32 s37, s3, 0x20000
    buffer_load_dwordx4 v16, s[88:91], s37 offen lds
    s_add_u32 m0, s28, 13312
    s_add_u32 s37, s3, 0x28000
    buffer_load_dwordx4 v17, s[88:91], s37 offen lds
    s_add_u32 m0, s28, 14336
    s_add_u32 s37, s3, 0x30000
    buffer_load_dwordx4 v18, s[88:91], s37 offen lds
    s_add_u32 m0, s28, 15360
    s_add_u32 s37, s3, 0x38000
    buffer_load_dwordx4 v19, s[88:91], s37 offen lds
    s_waitcnt vmcnt(33)
    v_perm_b32 v120, v33, v32, s34
    v_perm_b32 v121, v35, v34, s34
    v_perm_b32 v122, v37, v36, s34
    v_perm_b32 v123, v39, v38, s34
    v_perm_b32 v124, v41, v40, s34
    v_perm_b32 v125, v43, v42, s34
    v_perm_b32 v126, v45, v44, s34
    v_perm_b32 v127, v47, v46, s34
    ds_write_b128 v4, v[120:123] offset:24576
    ds_write_b128 v4, v[124:127] offset:25600
    s_waitcnt lgkmcnt(0)
    v_perm_b32 v120, v33, v32, s35
    v_perm_b32 v121, v35, v34, s35
    v_perm_b32 v122, v37, v36, s35
    v_perm_b32 v123, v39, v38, s35
    v_perm_b32 v124, v41, v40, s35
    v_perm_b32 v125, v43, v42, s35
    v_perm_b32 v126, v45, v44, s35
    v_perm_b32 v127, v47, v46, s35
    ds_write_b128 v4, v[120:123] offset:26624
    ds_write_b128 v4, v[124:127] offset:27648
    s_waitcnt lgkmcnt(0)
    s_add_u32 s37, s29, 0x40
    buffer_load_dword v80, v11, s[92:95], s37 offen
    s_add_u32 s37, s29, 0x4040
    buffer_load_dword v81, v11, s[92:95], s37 offen
    s_add_u32 s37, s29, 0x1040
    buffer_load_dword v82, v11, s[92:95], s37 offen
    s_add_u32 s37, s29, 0x5040
    buffer_load_dword v83, v11, s[92:95], s37 offen
    s_add_u32 s37, s29, 0x440
    buffer_load_dword v84, v11, s[92:95], s37 offen
    s_add_u32 s37, s29, 0x4440
    buffer_load_dword v85, v11, s[92:95], s37 offen
    s_add_u32 s37, s29, 0x1440
    buffer_load_dword v86, v11, s[92:95], s37 offen
    s_add_u32 s37, s29, 0x5440
    buffer_load_dword v87, v11, s[92:95], s37 offen
    s_add_u32 s37, s29, 0x8040
    buffer_load_dword v88, v11, s[92:95], s37 offen
    s_add_u32 s37, s29, 0xc040
    buffer_load_dword v89, v11, s[92:95], s37 offen
    s_add_u32 s37, s29, 0x9040
    buffer_load_dword v90, v11, s[92:95], s37 offen
    s_add_u32 s37, s29, 0xd040
    buffer_load_dword v91, v11, s[92:95], s37 offen
    s_add_u32 s37, s29, 0x8440
    buffer_load_dword v92, v11, s[92:95], s37 offen
    s_add_u32 s37, s29, 0xc440
    buffer_load_dword v93, v11, s[92:95], s37 offen
    s_add_u32 s37, s29, 0x9440
    buffer_load_dword v94, v11, s[92:95], s37 offen
    s_add_u32 s37, s29, 0xd440
    buffer_load_dword v95, v11, s[92:95], s37 offen
    s_barrier
    ds_read_b64_tr_b16 a[176:177], v20 offset:16384
    ds_read_b64_tr_b16 a[178:179], v20 offset:16896
    ds_read_b64_tr_b16 a[184:185], v21 offset:16384
    ds_read_b64_tr_b16 a[186:187], v21 offset:16896
    ds_read_b64_tr_b16 a[208:209], v22 offset:16384
    ds_read_b64_tr_b16 a[210:211], v22 offset:16896
    ds_read_b64_tr_b16 a[216:217], v23 offset:16384
    ds_read_b64_tr_b16 a[218:219], v23 offset:16896
    ds_read_b64_tr_b16 a[240:241], v24 offset:16384
    ds_read_b64_tr_b16 a[242:243], v24 offset:16896
    ds_read_b64_tr_b16 a[248:249], v25 offset:16384
    ds_read_b64_tr_b16 a[250:251], v25 offset:16896
    s_waitcnt lgkmcnt(4)
    ds_read_b64_tr_b16 v[144:145], v26 offset:16384
    ds_read_b64_tr_b16 v[146:147], v26 offset:16896
    ds_read_b64_tr_b16 v[152:153], v27 offset:16384
    ds_read_b64_tr_b16 v[154:155], v27 offset:16896
    s_waitcnt lgkmcnt(0)
    s_barrier
    s_add_u32 m0, s28, 16384
    s_add_u32 s37, s3, 0x100000
    buffer_load_dwordx4 v16, s[88:91], s37 offen lds
    s_add_u32 m0, s28, 17408
    s_add_u32 s37, s3, 0x108000
    buffer_load_dwordx4 v17, s[88:91], s37 offen lds
    s_add_u32 m0, s28, 18432
    s_add_u32 s37, s3, 0x110000
    buffer_load_dwordx4 v18, s[88:91], s37 offen lds
    s_add_u32 m0, s28, 19456
    s_add_u32 s37, s3, 0x118000
    buffer_load_dwordx4 v19, s[88:91], s37 offen lds
    s_add_u32 m0, s28, 20480
    s_add_u32 s37, s3, 0x120000
    buffer_load_dwordx4 v16, s[88:91], s37 offen lds
    s_add_u32 m0, s28, 21504
    s_add_u32 s37, s3, 0x128000
    buffer_load_dwordx4 v17, s[88:91], s37 offen lds
    s_add_u32 m0, s28, 22528
    s_add_u32 s37, s3, 0x130000
    buffer_load_dwordx4 v18, s[88:91], s37 offen lds
    s_add_u32 m0, s28, 23552
    s_add_u32 s37, s3, 0x138000
    buffer_load_dwordx4 v19, s[88:91], s37 offen lds
    s_waitcnt vmcnt(48)
    s_barrier
    s_getreg_b32 s36, hwreg(HW_REG_XCC_ID)
    s_and_b32 s36, s36, 15
    s_or_b32 s36, s36, 0x100
    v_mov_b32 v30, s36
    s_lshl_b32 s37, s20, 2
    v_lshlrev_b32 v31, 20, v0
    buffer_store_dword v30, v31, s[16:19], s37 offen sc1
    s_waitcnt vmcnt(33)
    v_perm_b32 v120, v49, v48, s34
    v_perm_b32 v121, v51, v50, s34
    v_perm_b32 v122, v53, v52, s34
    v_perm_b32 v123, v55, v54, s34
    v_perm_b32 v124, v57, v56, s34
    v_perm_b32 v125, v59, v58, s34
    v_perm_b32 v126, v61, v60, s34
    v_perm_b32 v127, v63, v62, s34
    ds_write_b128 v4, v[120:123] offset:28672
    ds_write_b128 v4, v[124:127] offset:29696
    s_waitcnt lgkmcnt(0)
    v_perm_b32 v120, v49, v48, s35
    v_perm_b32 v121, v51, v50, s35
    v_perm_b32 v122, v53, v52, s35
    v_perm_b32 v123, v55, v54, s35
    v_perm_b32 v124, v57, v56, s35
    v_perm_b32 v125, v59, v58, s35
    v_perm_b32 v126, v61, v60, s35
    v_perm_b32 v127, v63, v62, s35
    ds_write_b128 v4, v[120:123] offset:30720
    ds_write_b128 v4, v[124:127] offset:31744
    s_waitcnt lgkmcnt(0)
    s_add_u32 s37, s29, 0x10040
    buffer_load_dword v32, v11, s[92:95], s37 offen
    s_add_u32 s37, s29, 0x14040
    buffer_load_dword v33, v11, s[92:95], s37 offen
    s_add_u32 s37, s29, 0x11040
    buffer_load_dword v34, v11, s[92:95], s37 offen
    s_add_u32 s37, s29, 0x15040
    buffer_load_dword v35, v11, s[92:95], s37 offen
    s_add_u32 s37, s29, 0x10440
    buffer_load_dword v36, v11, s[92:95], s37 offen
    s_add_u32 s37, s29, 0x14440
    buffer_load_dword v37, v11, s[92:95], s37 offen
    s_add_u32 s37, s29, 0x11440
    buffer_load_dword v38, v11, s[92:95], s37 offen
    s_add_u32 s37, s29, 0x15440
    buffer_load_dword v39, v11, s[92:95], s37 offen
    s_add_u32 s37, s29, 0x18040
    buffer_load_dword v40, v11, s[92:95], s37 offen
    s_add_u32 s37, s29, 0x1c040
    buffer_load_dword v41, v11, s[92:95], s37 offen
    s_add_u32 s37, s29, 0x19040
    buffer_load_dword v42, v11, s[92:95], s37 offen
    s_add_u32 s37, s29, 0x1d040
    buffer_load_dword v43, v11, s[92:95], s37 offen
    s_add_u32 s37, s29, 0x18440
    buffer_load_dword v44, v11, s[92:95], s37 offen
    s_add_u32 s37, s29, 0x1c440
    buffer_load_dword v45, v11, s[92:95], s37 offen
    s_add_u32 s37, s29, 0x19440
    buffer_load_dword v46, v11, s[92:95], s37 offen
    s_add_u32 s37, s29, 0x1d440
    buffer_load_dword v47, v11, s[92:95], s37 offen
    s_barrier
    ds_read_b64_tr_b16 a[180:181], v20 offset:0
    ds_read_b64_tr_b16 a[182:183], v20 offset:512
    ds_read_b64_tr_b16 a[188:189], v21 offset:0
    ds_read_b64_tr_b16 a[190:191], v21 offset:512
    ds_read_b64_tr_b16 a[212:213], v22 offset:0
    ds_read_b64_tr_b16 a[214:215], v22 offset:512
    ds_read_b64_tr_b16 a[220:221], v23 offset:0
    ds_read_b64_tr_b16 a[222:223], v23 offset:512
    ds_read_b64_tr_b16 a[244:245], v24 offset:0
    ds_read_b64_tr_b16 a[246:247], v24 offset:512
    ds_read_b64_tr_b16 a[252:253], v25 offset:0
    ds_read_b64_tr_b16 a[254:255], v25 offset:512
    s_waitcnt lgkmcnt(4)
    ds_read_b64_tr_b16 v[148:149], v26 offset:0
    ds_read_b64_tr_b16 v[150:151], v26 offset:512
    ds_read_b64_tr_b16 v[156:157], v27 offset:0
    ds_read_b64_tr_b16 v[158:159], v27 offset:512
    s_waitcnt lgkmcnt(0)
    s_barrier
    s_add_u32 m0, s28, 0
    s_add_u32 s37, s3, 0x200000
    buffer_load_dwordx4 v16, s[88:91], s37 offen lds
    s_add_u32 m0, s28, 1024
    s_add_u32 s37, s3, 0x208000
    buffer_load_dwordx4 v17, s[88:91], s37 offen lds
    s_add_u32 m0, s28, 2048
    s_add_u32 s37, s3, 0x210000
    buffer_load_dwordx4 v18, s[88:91], s37 offen lds
    s_add_u32 m0, s28, 3072
    s_add_u32 s37, s3, 0x218000
    buffer_load_dwordx4 v19, s[88:91], s37 offen lds
    s_add_u32 m0, s28, 4096
    s_add_u32 s37, s3, 0x220000
    buffer_load_dwordx4 v16, s[88:91], s37 offen lds
    s_add_u32 m0, s28, 5120
    s_add_u32 s37, s3, 0x228000
    buffer_load_dwordx4 v17, s[88:91], s37 offen lds
    s_add_u32 m0, s28, 6144
    s_add_u32 s37, s3, 0x230000
    buffer_load_dwordx4 v18, s[88:91], s37 offen lds
    s_add_u32 m0, s28, 7168
    s_add_u32 s37, s3, 0x238000
    buffer_load_dwordx4 v19, s[88:91], s37 offen lds
    s_waitcnt vmcnt(33)
    v_perm_b32 v160, v81, v80, s34
    v_perm_b32 v161, v83, v82, s34
    v_perm_b32 v162, v85, v84, s34
    v_perm_b32 v163, v87, v86, s34
    v_perm_b32 v164, v89, v88, s34
    v_perm_b32 v165, v91, v90, s34
    v_perm_b32 v166, v93, v92, s34
    v_perm_b32 v167, v95, v94, s34
    v_perm_b32 v168, v81, v80, s35
    v_perm_b32 v169, v83, v82, s35
    v_perm_b32 v170, v85, v84, s35
    v_perm_b32 v171, v87, v86, s35
    v_perm_b32 v172, v89, v88, s35
    v_perm_b32 v173, v91, v90, s35
    v_perm_b32 v174, v93, v92, s35
    v_perm_b32 v175, v95, v94, s35
    s_add_u32 s37, s29, 0x80
    buffer_load_dword v48, v11, s[92:95], s37 offen
    s_add_u32 s37, s29, 0x4080
    buffer_load_dword v49, v11, s[92:95], s37 offen
    s_add_u32 s37, s29, 0x1080
    buffer_load_dword v50, v11, s[92:95], s37 offen
    s_add_u32 s37, s29, 0x5080
    buffer_load_dword v51, v11, s[92:95], s37 offen
    s_add_u32 s37, s29, 0x480
    buffer_load_dword v52, v11, s[92:95], s37 offen
    s_add_u32 s37, s29, 0x4480
    buffer_load_dword v53, v11, s[92:95], s37 offen
    s_add_u32 s37, s29, 0x1480
    buffer_load_dword v54, v11, s[92:95], s37 offen
    s_add_u32 s37, s29, 0x5480
    buffer_load_dword v55, v11, s[92:95], s37 offen
    s_add_u32 s37, s29, 0x8080
    buffer_load_dword v56, v11, s[92:95], s37 offen
    s_add_u32 s37, s29, 0xc080
    buffer_load_dword v57, v11, s[92:95], s37 offen
    s_add_u32 s37, s29, 0x9080
    buffer_load_dword v58, v11, s[92:95], s37 offen
    s_add_u32 s37, s29, 0xd080
    buffer_load_dword v59, v11, s[92:95], s37 offen
    s_add_u32 s37, s29, 0x8480
    buffer_load_dword v60, v11, s[92:95], s37 offen
    s_add_u32 s37, s29, 0xc480
    buffer_load_dword v61, v11, s[92:95], s37 offen
    s_add_u32 s37, s29, 0x9480
    buffer_load_dword v62, v11, s[92:95], s37 offen
    s_add_u32 s37, s29, 0xd480
    buffer_load_dword v63, v11, s[92:95], s37 offen
    s_barrier
    ds_read_b64_tr_b16 v[64:65], v20 offset:8192
    ds_read_b64_tr_b16 v[66:67], v20 offset:8704
    ds_read_b64_tr_b16 v[72:73], v21 offset:8192
    ds_read_b64_tr_b16 v[74:75], v21 offset:8704
    ds_read_b64_tr_b16 v[96:97], v22 offset:8192
    ds_read_b64_tr_b16 v[98:99], v22 offset:8704
    ds_read_b64_tr_b16 v[104:105], v23 offset:8192
    ds_read_b64_tr_b16 v[106:107], v23 offset:8704
    ds_read_b64_tr_b16 a[112:113], v24 offset:8192
    ds_read_b64_tr_b16 a[114:115], v24 offset:8704
    ds_read_b64_tr_b16 a[120:121], v25 offset:8192
    ds_read_b64_tr_b16 a[122:123], v25 offset:8704
    s_waitcnt lgkmcnt(4)
    ds_read_b64_tr_b16 a[144:145], v26 offset:8192
    ds_read_b64_tr_b16 a[146:147], v26 offset:8704
    ds_read_b64_tr_b16 a[152:153], v27 offset:8192
    ds_read_b64_tr_b16 a[154:155], v27 offset:8704
    s_waitcnt lgkmcnt(0)
    s_barrier
    s_add_u32 m0, s28, 8192
    s_add_u32 s37, s3, 0x300000
    buffer_load_dwordx4 v16, s[88:91], s37 offen lds
    s_add_u32 m0, s28, 9216
    s_add_u32 s37, s3, 0x308000
    buffer_load_dwordx4 v17, s[88:91], s37 offen lds
    s_add_u32 m0, s28, 10240
    s_add_u32 s37, s3, 0x310000
    buffer_load_dwordx4 v18, s[88:91], s37 offen lds
    s_add_u32 m0, s28, 11264
    s_add_u32 s37, s3, 0x318000
    buffer_load_dwordx4 v19, s[88:91], s37 offen lds
    s_add_u32 m0, s28, 12288
    s_add_u32 s37, s3, 0x320000
    buffer_load_dwordx4 v16, s[88:91], s37 offen lds
    s_add_u32 m0, s28, 13312
    s_add_u32 s37, s3, 0x328000
    buffer_load_dwordx4 v17, s[88:91], s37 offen lds
    s_add_u32 m0, s28, 14336
    s_add_u32 s37, s3, 0x330000
    buffer_load_dwordx4 v18, s[88:91], s37 offen lds
    s_add_u32 m0, s28, 15360
    s_add_u32 s37, s3, 0x338000
    buffer_load_dwordx4 v19, s[88:91], s37 offen lds
    s_waitcnt vmcnt(32)
    v_perm_b32 v208, v33, v32, s34
    v_perm_b32 v209, v35, v34, s34
    v_perm_b32 v210, v37, v36, s34
    v_perm_b32 v211, v39, v38, s34
    v_perm_b32 v212, v41, v40, s34
    v_perm_b32 v213, v43, v42, s34
    v_perm_b32 v214, v45, v44, s34
    v_perm_b32 v215, v47, v46, s34
    v_perm_b32 v216, v33, v32, s35
    v_perm_b32 v217, v35, v34, s35
    v_perm_b32 v218, v37, v36, s35
    v_perm_b32 v219, v39, v38, s35
    v_perm_b32 v220, v41, v40, s35
    v_perm_b32 v221, v43, v42, s35
    v_perm_b32 v222, v45, v44, s35
    v_perm_b32 v223, v47, v46, s35
    s_add_u32 s37, s29, 0x10080
    buffer_load_dword v80, v11, s[92:95], s37 offen
    s_add_u32 s37, s29, 0x14080
    buffer_load_dword v81, v11, s[92:95], s37 offen
    s_add_u32 s37, s29, 0x11080
    buffer_load_dword v82, v11, s[92:95], s37 offen
    s_add_u32 s37, s29, 0x15080
    buffer_load_dword v83, v11, s[92:95], s37 offen
    s_add_u32 s37, s29, 0x10480
    buffer_load_dword v84, v11, s[92:95], s37 offen
    s_add_u32 s37, s29, 0x14480
    buffer_load_dword v85, v11, s[92:95], s37 offen
    s_add_u32 s37, s29, 0x11480
    buffer_load_dword v86, v11, s[92:95], s37 offen
    s_add_u32 s37, s29, 0x15480
    buffer_load_dword v87, v11, s[92:95], s37 offen
    s_add_u32 s37, s29, 0x18080
    buffer_load_dword v88, v11, s[92:95], s37 offen
    s_add_u32 s37, s29, 0x1c080
    buffer_load_dword v89, v11, s[92:95], s37 offen
    s_add_u32 s37, s29, 0x19080
    buffer_load_dword v90, v11, s[92:95], s37 offen
    s_add_u32 s37, s29, 0x1d080
    buffer_load_dword v91, v11, s[92:95], s37 offen
    s_add_u32 s37, s29, 0x18480
    buffer_load_dword v92, v11, s[92:95], s37 offen
    s_add_u32 s37, s29, 0x1c480
    buffer_load_dword v93, v11, s[92:95], s37 offen
    s_add_u32 s37, s29, 0x19480
    buffer_load_dword v94, v11, s[92:95], s37 offen
    s_add_u32 s37, s29, 0x1d480
    buffer_load_dword v95, v11, s[92:95], s37 offen
    s_barrier
    ds_read_b64_tr_b16 v[68:69], v20 offset:16384
    ds_read_b64_tr_b16 v[70:71], v20 offset:16896
    ds_read_b64_tr_b16 v[76:77], v21 offset:16384
    ds_read_b64_tr_b16 v[78:79], v21 offset:16896
    ds_read_b64_tr_b16 v[100:101], v22 offset:16384
    ds_read_b64_tr_b16 v[102:103], v22 offset:16896
    ds_read_b64_tr_b16 v[108:109], v23 offset:16384
    ds_read_b64_tr_b16 v[110:111], v23 offset:16896
    ds_read_b64_tr_b16 a[116:117], v24 offset:16384
    ds_read_b64_tr_b16 a[118:119], v24 offset:16896
    ds_read_b64_tr_b16 a[124:125], v25 offset:16384
    ds_read_b64_tr_b16 a[126:127], v25 offset:16896
    s_waitcnt lgkmcnt(4)
    ds_read_b64_tr_b16 a[148:149], v26 offset:16384
    ds_read_b64_tr_b16 a[150:151], v26 offset:16896
    ds_read_b64_tr_b16 a[156:157], v27 offset:16384
    ds_read_b64_tr_b16 a[158:159], v27 offset:16896
    s_waitcnt lgkmcnt(0)
    s_barrier
    s_add_u32 m0, s28, 16384
    s_add_u32 s37, s3, 0x0
    buffer_load_dwordx4 v16, s[96:99], s37 offen lds
    s_add_u32 m0, s28, 17408
    s_add_u32 s37, s3, 0x8000
    buffer_load_dwordx4 v17, s[96:99], s37 offen lds
    s_add_u32 m0, s28, 18432
    s_add_u32 s37, s3, 0x10000
    buffer_load_dwordx4 v18, s[96:99], s37 offen lds
    s_add_u32 m0, s28, 19456
    s_add_u32 s37, s3, 0x18000
    buffer_load_dwordx4 v19, s[96:99], s37 offen lds
    s_add_u32 m0, s28, 20480
    s_add_u32 s37, s3, 0x20000
    buffer_load_dwordx4 v16, s[96:99], s37 offen lds
    s_add_u32 m0, s28, 21504
    s_add_u32 s37, s3, 0x28000
    buffer_load_dwordx4 v17, s[96:99], s37 offen lds
    s_add_u32 m0, s28, 22528
    s_add_u32 s37, s3, 0x30000
    buffer_load_dwordx4 v18, s[96:99], s37 offen lds
    s_add_u32 m0, s28, 23552
    s_add_u32 s37, s3, 0x38000
    buffer_load_dwordx4 v19, s[96:99], s37 offen lds
    s_waitcnt vmcnt(32)
    v_perm_b32 v176, v49, v48, s34
    v_perm_b32 v177, v51, v50, s34
    v_perm_b32 v178, v53, v52, s34
    v_perm_b32 v179, v55, v54, s34
    v_perm_b32 v180, v57, v56, s34
    v_perm_b32 v181, v59, v58, s34
    v_perm_b32 v182, v61, v60, s34
    v_perm_b32 v183, v63, v62, s34
    v_perm_b32 v184, v49, v48, s35
    v_perm_b32 v185, v51, v50, s35
    v_perm_b32 v186, v53, v52, s35
    v_perm_b32 v187, v55, v54, s35
    v_perm_b32 v188, v57, v56, s35
    v_perm_b32 v189, v59, v58, s35
    v_perm_b32 v190, v61, v60, s35
    v_perm_b32 v191, v63, v62, s35
    s_add_u32 s37, s29, 0xc0
    buffer_load_dword v32, v11, s[92:95], s37 offen
    s_add_u32 s37, s29, 0x40c0
    buffer_load_dword v33, v11, s[92:95], s37 offen
    s_add_u32 s37, s29, 0x10c0
    buffer_load_dword v34, v11, s[92:95], s37 offen
    s_add_u32 s37, s29, 0x50c0
    buffer_load_dword v35, v11, s[92:95], s37 offen
    s_add_u32 s37, s29, 0x4c0
    buffer_load_dword v36, v11, s[92:95], s37 offen
    s_add_u32 s37, s29, 0x44c0
    buffer_load_dword v37, v11, s[92:95], s37 offen
    s_add_u32 s37, s29, 0x14c0
    buffer_load_dword v38, v11, s[92:95], s37 offen
    s_add_u32 s37, s29, 0x54c0
    buffer_load_dword v39, v11, s[92:95], s37 offen
    s_add_u32 s37, s29, 0x80c0
    buffer_load_dword v40, v11, s[92:95], s37 offen
    s_add_u32 s37, s29, 0xc0c0
    buffer_load_dword v41, v11, s[92:95], s37 offen
    s_add_u32 s37, s29, 0x90c0
    buffer_load_dword v42, v11, s[92:95], s37 offen
    s_add_u32 s37, s29, 0xd0c0
    buffer_load_dword v43, v11, s[92:95], s37 offen
    s_add_u32 s37, s29, 0x84c0
    buffer_load_dword v44, v11, s[92:95], s37 offen
    s_add_u32 s37, s29, 0xc4c0
    buffer_load_dword v45, v11, s[92:95], s37 offen
    s_add_u32 s37, s29, 0x94c0
    buffer_load_dword v46, v11, s[92:95], s37 offen
    s_add_u32 s37, s29, 0xd4c0
    buffer_load_dword v47, v11, s[92:95], s37 offen
    s_barrier
    ds_read_b64_tr_b16 a[80:81], v20 offset:0
    ds_read_b64_tr_b16 a[82:83], v20 offset:512
    ds_read_b64_tr_b16 a[88:89], v21 offset:0
    ds_read_b64_tr_b16 a[90:91], v21 offset:512
    ds_read_b64_tr_b16 a[96:97], v22 offset:0
    ds_read_b64_tr_b16 a[98:99], v22 offset:512
    ds_read_b64_tr_b16 a[104:105], v23 offset:0
    ds_read_b64_tr_b16 a[106:107], v23 offset:512
    ds_read_b64_tr_b16 a[128:129], v24 offset:0
    ds_read_b64_tr_b16 a[130:131], v24 offset:512
    ds_read_b64_tr_b16 a[136:137], v25 offset:0
    ds_read_b64_tr_b16 a[138:139], v25 offset:512
    s_waitcnt lgkmcnt(4)
    ds_read_b64_tr_b16 v[112:113], v26 offset:0
    ds_read_b64_tr_b16 v[114:115], v26 offset:512
    ds_read_b64_tr_b16 v[120:121], v27 offset:0
    ds_read_b64_tr_b16 v[122:123], v27 offset:512
    s_waitcnt lgkmcnt(0)
    s_barrier
    s_add_u32 m0, s28, 0
    s_add_u32 s37, s3, 0x100000
    buffer_load_dwordx4 v16, s[96:99], s37 offen lds
    s_add_u32 m0, s28, 1024
    s_add_u32 s37, s3, 0x108000
    buffer_load_dwordx4 v17, s[96:99], s37 offen lds
    s_add_u32 m0, s28, 2048
    s_add_u32 s37, s3, 0x110000
    buffer_load_dwordx4 v18, s[96:99], s37 offen lds
    s_add_u32 m0, s28, 3072
    s_add_u32 s37, s3, 0x118000
    buffer_load_dwordx4 v19, s[96:99], s37 offen lds
    s_add_u32 m0, s28, 4096
    s_add_u32 s37, s3, 0x120000
    buffer_load_dwordx4 v16, s[96:99], s37 offen lds
    s_add_u32 m0, s28, 5120
    s_add_u32 s37, s3, 0x128000
    buffer_load_dwordx4 v17, s[96:99], s37 offen lds
    s_add_u32 m0, s28, 6144
    s_add_u32 s37, s3, 0x130000
    buffer_load_dwordx4 v18, s[96:99], s37 offen lds
    s_add_u32 m0, s28, 7168
    s_add_u32 s37, s3, 0x138000
    buffer_load_dwordx4 v19, s[96:99], s37 offen lds
    s_waitcnt vmcnt(32)
    v_perm_b32 v224, v81, v80, s34
    v_perm_b32 v225, v83, v82, s34
    v_perm_b32 v226, v85, v84, s34
    v_perm_b32 v227, v87, v86, s34
    v_perm_b32 v228, v89, v88, s34
    v_perm_b32 v229, v91, v90, s34
    v_perm_b32 v230, v93, v92, s34
    v_perm_b32 v231, v95, v94, s34
    v_perm_b32 v232, v81, v80, s35
    v_perm_b32 v233, v83, v82, s35
    v_perm_b32 v234, v85, v84, s35
    v_perm_b32 v235, v87, v86, s35
    v_perm_b32 v236, v89, v88, s35
    v_perm_b32 v237, v91, v90, s35
    v_perm_b32 v238, v93, v92, s35
    v_perm_b32 v239, v95, v94, s35
    s_add_u32 s37, s29, 0x100c0
    buffer_load_dword v48, v11, s[92:95], s37 offen
    s_add_u32 s37, s29, 0x140c0
    buffer_load_dword v49, v11, s[92:95], s37 offen
    s_add_u32 s37, s29, 0x110c0
    buffer_load_dword v50, v11, s[92:95], s37 offen
    s_add_u32 s37, s29, 0x150c0
    buffer_load_dword v51, v11, s[92:95], s37 offen
    s_add_u32 s37, s29, 0x104c0
    buffer_load_dword v52, v11, s[92:95], s37 offen
    s_add_u32 s37, s29, 0x144c0
    buffer_load_dword v53, v11, s[92:95], s37 offen
    s_add_u32 s37, s29, 0x114c0
    buffer_load_dword v54, v11, s[92:95], s37 offen
    s_add_u32 s37, s29, 0x154c0
    buffer_load_dword v55, v11, s[92:95], s37 offen
    s_add_u32 s37, s29, 0x180c0
    buffer_load_dword v56, v11, s[92:95], s37 offen
    s_add_u32 s37, s29, 0x1c0c0
    buffer_load_dword v57, v11, s[92:95], s37 offen
    s_add_u32 s37, s29, 0x190c0
    buffer_load_dword v58, v11, s[92:95], s37 offen
    s_add_u32 s37, s29, 0x1d0c0
    buffer_load_dword v59, v11, s[92:95], s37 offen
    s_add_u32 s37, s29, 0x184c0
    buffer_load_dword v60, v11, s[92:95], s37 offen
    s_add_u32 s37, s29, 0x1c4c0
    buffer_load_dword v61, v11, s[92:95], s37 offen
    s_add_u32 s37, s29, 0x194c0
    buffer_load_dword v62, v11, s[92:95], s37 offen
    s_add_u32 s37, s29, 0x1d4c0
    buffer_load_dword v63, v11, s[92:95], s37 offen
    s_barrier
    ds_read_b64_tr_b16 a[84:85], v20 offset:8192
    ds_read_b64_tr_b16 a[86:87], v20 offset:8704
    ds_read_b64_tr_b16 a[92:93], v21 offset:8192
    ds_read_b64_tr_b16 a[94:95], v21 offset:8704
    ds_read_b64_tr_b16 a[100:101], v22 offset:8192
    ds_read_b64_tr_b16 a[102:103], v22 offset:8704
    ds_read_b64_tr_b16 a[108:109], v23 offset:8192
    ds_read_b64_tr_b16 a[110:111], v23 offset:8704
    ds_read_b64_tr_b16 a[132:133], v24 offset:8192
    ds_read_b64_tr_b16 a[134:135], v24 offset:8704
    ds_read_b64_tr_b16 a[140:141], v25 offset:8192
    ds_read_b64_tr_b16 a[142:143], v25 offset:8704
    s_waitcnt lgkmcnt(4)
    ds_read_b64_tr_b16 v[116:117], v26 offset:8192
    ds_read_b64_tr_b16 v[118:119], v26 offset:8704
    ds_read_b64_tr_b16 v[124:125], v27 offset:8192
    ds_read_b64_tr_b16 v[126:127], v27 offset:8704
    s_waitcnt lgkmcnt(0)
    s_barrier
    s_add_u32 m0, s28, 8192
    s_add_u32 s37, s3, 0x200000
    buffer_load_dwordx4 v16, s[96:99], s37 offen lds
    s_add_u32 m0, s28, 9216
    s_add_u32 s37, s3, 0x208000
    buffer_load_dwordx4 v17, s[96:99], s37 offen lds
    s_add_u32 m0, s28, 10240
    s_add_u32 s37, s3, 0x210000
    buffer_load_dwordx4 v18, s[96:99], s37 offen lds
    s_add_u32 m0, s28, 11264
    s_add_u32 s37, s3, 0x218000
    buffer_load_dwordx4 v19, s[96:99], s37 offen lds
    s_add_u32 m0, s28, 12288
    s_add_u32 s37, s3, 0x220000
    buffer_load_dwordx4 v16, s[96:99], s37 offen lds
    s_add_u32 m0, s28, 13312
    s_add_u32 s37, s3, 0x228000
    buffer_load_dwordx4 v17, s[96:99], s37 offen lds
    s_add_u32 m0, s28, 14336
    s_add_u32 s37, s3, 0x230000
    buffer_load_dwordx4 v18, s[96:99], s37 offen lds
    s_add_u32 m0, s28, 15360
    s_add_u32 s37, s3, 0x238000
    buffer_load_dwordx4 v19, s[96:99], s37 offen lds
    s_waitcnt vmcnt(32)
    v_perm_b32 v192, v33, v32, s34
    v_perm_b32 v193, v35, v34, s34
    v_perm_b32 v194, v37, v36, s34
    v_perm_b32 v195, v39, v38, s34
    v_perm_b32 v196, v41, v40, s34
    v_perm_b32 v197, v43, v42, s34
    v_perm_b32 v198, v45, v44, s34
    v_perm_b32 v199, v47, v46, s34
    v_perm_b32 v200, v33, v32, s35
    v_perm_b32 v201, v35, v34, s35
    v_perm_b32 v202, v37, v36, s35
    v_perm_b32 v203, v39, v38, s35
    v_perm_b32 v204, v41, v40, s35
    v_perm_b32 v205, v43, v42, s35
    v_perm_b32 v206, v45, v44, s35
    v_perm_b32 v207, v47, v46, s35
    s_barrier
    ds_read_b64_tr_b16 v[32:33], v20 offset:16384
    ds_read_b64_tr_b16 v[34:35], v20 offset:16896
    ds_read_b64_tr_b16 v[40:41], v21 offset:16384
    ds_read_b64_tr_b16 v[42:43], v21 offset:16896
    ds_read_b64_tr_b16 a[0:1], v22 offset:16384
    ds_read_b64_tr_b16 a[2:3], v22 offset:16896
    ds_read_b64_tr_b16 a[8:9], v23 offset:16384
    ds_read_b64_tr_b16 a[10:11], v23 offset:16896
    ds_read_b64_tr_b16 a[32:33], v24 offset:16384
    ds_read_b64_tr_b16 a[34:35], v24 offset:16896
    ds_read_b64_tr_b16 a[40:41], v25 offset:16384
    ds_read_b64_tr_b16 a[42:43], v25 offset:16896
    s_waitcnt lgkmcnt(4)
    ds_read_b64_tr_b16 a[64:65], v26 offset:16384
    ds_read_b64_tr_b16 a[66:67], v26 offset:16896
    ds_read_b64_tr_b16 a[72:73], v27 offset:16384
    ds_read_b64_tr_b16 a[74:75], v27 offset:16896
    s_waitcnt lgkmcnt(0)
    s_barrier
    s_add_u32 m0, s28, 16384
    s_add_u32 s37, s3, 0x300000
    buffer_load_dwordx4 v16, s[96:99], s37 offen lds
    s_add_u32 m0, s28, 17408
    s_add_u32 s37, s3, 0x308000
    buffer_load_dwordx4 v17, s[96:99], s37 offen lds
    s_add_u32 m0, s28, 18432
    s_add_u32 s37, s3, 0x310000
    buffer_load_dwordx4 v18, s[96:99], s37 offen lds
    s_add_u32 m0, s28, 19456
    s_add_u32 s37, s3, 0x318000
    buffer_load_dwordx4 v19, s[96:99], s37 offen lds
    s_add_u32 m0, s28, 20480
    s_add_u32 s37, s3, 0x320000
    buffer_load_dwordx4 v16, s[96:99], s37 offen lds
    s_add_u32 m0, s28, 21504
    s_add_u32 s37, s3, 0x328000
    buffer_load_dwordx4 v17, s[96:99], s37 offen lds
    s_add_u32 m0, s28, 22528
    s_add_u32 s37, s3, 0x330000
    buffer_load_dwordx4 v18, s[96:99], s37 offen lds
    s_add_u32 m0, s28, 23552
    s_add_u32 s37, s3, 0x338000
    buffer_load_dwordx4 v19, s[96:99], s37 offen lds
    s_waitcnt vmcnt(16)
    v_perm_b32 v240, v49, v48, s34
    v_perm_b32 v241, v51, v50, s34
    v_perm_b32 v242, v53, v52, s34
    v_perm_b32 v243, v55, v54, s34
    v_perm_b32 v244, v57, v56, s34
    v_perm_b32 v245, v59, v58, s34
    v_perm_b32 v246, v61, v60, s34
    v_perm_b32 v247, v63, v62, s34
    v_perm_b32 v248, v49, v48, s35
    v_perm_b32 v249, v51, v50, s35
    v_perm_b32 v250, v53, v52, s35
    v_perm_b32 v251, v55, v54, s35
    v_perm_b32 v252, v57, v56, s35
    v_perm_b32 v253, v59, v58, s35
    v_perm_b32 v254, v61, v60, s35
    v_perm_b32 v255, v63, v62, s35
    s_barrier
    ds_read_b64_tr_b16 v[36:37], v20 offset:0
    ds_read_b64_tr_b16 v[38:39], v20 offset:512
    ds_read_b64_tr_b16 v[44:45], v21 offset:0
    ds_read_b64_tr_b16 v[46:47], v21 offset:512
    ds_read_b64_tr_b16 a[4:5], v22 offset:0
    ds_read_b64_tr_b16 a[6:7], v22 offset:512
    ds_read_b64_tr_b16 a[12:13], v23 offset:0
    ds_read_b64_tr_b16 a[14:15], v23 offset:512
    ds_read_b64_tr_b16 a[36:37], v24 offset:0
    ds_read_b64_tr_b16 a[38:39], v24 offset:512
    ds_read_b64_tr_b16 a[44:45], v25 offset:0
    ds_read_b64_tr_b16 a[46:47], v25 offset:512
    s_waitcnt lgkmcnt(4)
    ds_read_b64_tr_b16 a[68:69], v26 offset:0
    ds_read_b64_tr_b16 a[70:71], v26 offset:512
    ds_read_b64_tr_b16 a[76:77], v27 offset:0
    ds_read_b64_tr_b16 a[78:79], v27 offset:512
    s_waitcnt lgkmcnt(0)
    s_barrier
    s_waitcnt vmcnt(8)
    s_barrier
    ds_read_b64_tr_b16 v[48:49], v20 offset:8192
    ds_read_b64_tr_b16 v[50:51], v20 offset:8704
    ds_read_b64_tr_b16 v[56:57], v21 offset:8192
    ds_read_b64_tr_b16 v[58:59], v21 offset:8704
    ds_read_b64_tr_b16 a[16:17], v22 offset:8192
    ds_read_b64_tr_b16 a[18:19], v22 offset:8704
    ds_read_b64_tr_b16 a[24:25], v23 offset:8192
    ds_read_b64_tr_b16 a[26:27], v23 offset:8704
    ds_read_b64_tr_b16 a[48:49], v24 offset:8192
    ds_read_b64_tr_b16 a[50:51], v24 offset:8704
    ds_read_b64_tr_b16 a[56:57], v25 offset:8192
    ds_read_b64_tr_b16 a[58:59], v25 offset:8704
    s_waitcnt lgkmcnt(4)
    ds_read_b64_tr_b16 v[80:81], v26 offset:8192
    ds_read_b64_tr_b16 v[82:83], v26 offset:8704
    ds_read_b64_tr_b16 v[88:89], v27 offset:8192
    ds_read_b64_tr_b16 v[90:91], v27 offset:8704
    s_waitcnt lgkmcnt(0)
    s_barrier
    s_waitcnt vmcnt(0)
    s_barrier
    ds_read_b64_tr_b16 v[52:53], v20 offset:16384
    ds_read_b64_tr_b16 v[54:55], v20 offset:16896
    ds_read_b64_tr_b16 v[60:61], v21 offset:16384
    ds_read_b64_tr_b16 v[62:63], v21 offset:16896
    ds_read_b64_tr_b16 a[20:21], v22 offset:16384
    ds_read_b64_tr_b16 a[22:23], v22 offset:16896
    ds_read_b64_tr_b16 a[28:29], v23 offset:16384
    ds_read_b64_tr_b16 a[30:31], v23 offset:16896
    ds_read_b64_tr_b16 a[52:53], v24 offset:16384
    ds_read_b64_tr_b16 a[54:55], v24 offset:16896
    ds_read_b64_tr_b16 a[60:61], v25 offset:16384
    ds_read_b64_tr_b16 a[62:63], v25 offset:16896
    s_waitcnt lgkmcnt(4)
    ds_read_b64_tr_b16 v[84:85], v26 offset:16384
    ds_read_b64_tr_b16 v[86:87], v26 offset:16896
    ds_read_b64_tr_b16 v[92:93], v27 offset:16384
    ds_read_b64_tr_b16 v[94:95], v27 offset:16896
    s_waitcnt lgkmcnt(0)
    s_barrier
    ds_write_b128 v4, v[32:35] offset:0
    ds_write_b128 v4, v[36:39] offset:1024
    ds_write_b128 v4, v[40:43] offset:2048
    ds_write_b128 v4, v[44:47] offset:3072
    ds_write_b128 v4, v[48:51] offset:4096
    ds_write_b128 v4, v[52:55] offset:5120
    ds_write_b128 v4, v[56:59] offset:6144
    ds_write_b128 v4, v[60:63] offset:7168
    s_waitcnt lgkmcnt(0)
    ds_write_b128 v4, v[64:67] offset:8192
    ds_write_b128 v4, v[68:71] offset:9216
    ds_write_b128 v4, v[72:75] offset:10240
    ds_write_b128 v4, v[76:79] offset:11264
    ds_write_b128 v4, v[80:83] offset:12288
    ds_write_b128 v4, v[84:87] offset:13312
    ds_write_b128 v4, v[88:91] offset:14336
    ds_write_b128 v4, v[92:95] offset:15360
    s_waitcnt lgkmcnt(0)
    ds_write_b128 v4, v[96:99] offset:16384
    ds_write_b128 v4, v[100:103] offset:17408
    ds_write_b128 v4, v[104:107] offset:18432
    ds_write_b128 v4, v[108:111] offset:19456
    ds_write_b128 v4, v[112:115] offset:20480
    ds_write_b128 v4, v[116:119] offset:21504
    ds_write_b128 v4, v[120:123] offset:22528
    ds_write_b128 v4, v[124:127] offset:23552
    s_waitcnt lgkmcnt(0)
    s_waitcnt lgkmcnt(0)
    v_mov_b32 v24, 0x0
    v_bfe_u32 v14, v0, 0, 1
    s_mov_b32 s38, 0x80
    v_mad_u32_u24 v24, v14, s38, v24
    v_bfe_u32 v14, v0, 1, 1
    s_mov_b32 s38, 0x100
    v_mad_u32_u24 v24, v14, s38, v24
    v_bfe_u32 v14, v0, 2, 1
    s_mov_b32 s38, 0x200
    v_mad_u32_u24 v24, v14, s38, v24
    v_bfe_u32 v14, v0, 3, 1
    s_mov_b32 s38, 0x400
    v_mad_u32_u24 v24, v14, s38, v24
    v_bfe_u32 v14, v0, 4, 1
    s_mov_b32 s38, 0x800
    v_mad_u32_u24 v24, v14, s38, v24
    v_bfe_u32 v14, v0, 6, 1
    s_mov_b32 s38, 0x1000
    v_mad_u32_u24 v24, v14, s38, v24
    v_bfe_u32 v14, v0, 7, 1
    s_mov_b32 s38, 0x2000
    v_mad_u32_u24 v24, v14, s38, v24
    s_lshl_b32 s36, s20, 14
    v_add_u32 v24, s36, v24
    s_lshl_b32 s36, s20, 8
    s_lshr_b32 s37, s21, 1
    s_lshl_b32 s37, s37, 7
    s_add_u32 s36, s36, s37
    s_add_u32 s36, s36, 0x102000
    v_and_b32 v14, 63, v0
    v_mov_b32 v25, 0x40000000
    v_cmp_lt_u32 vcc, 32, v14
    s_nop 1
    v_cndmask_b32 v24, v24, v25, vcc
    v_mov_b32 v25, s36
    v_cmp_eq_u32 vcc, 32, v14
    s_nop 1
    v_cndmask_b32 v0, v24, v25, vcc
    v_lshrrev_b32 v25, 2, v3
    v_and_b32 v25, 127, v25
L_HS:
    buffer_load_dword v24, v25, s[16:19], 0 offen sc1
    s_add_u32 s32, s32, 1
    s_cmp_gt_u32 s32, 200000
    s_cbranch_scc1 L_slow_start
    s_waitcnt vmcnt(0)
    v_cmp_eq_u32 vcc, 0, v24
    s_cbranch_vccnz L_HS
    v_readfirstlane_b32 s36, v24
    s_nop 1
    v_cmp_ne_u32 vcc, s36, v24
    s_cbranch_vccnz L_slow_start
    s_branch L_fast_start
L_fast_start:
    s_mov_b32 s22, 0
    s_mov_b32 s23, 0x1000000
    s_mov_b32 s27, 0
    s_mov_b32 s31, 0x80000
    ds_read_b128 v[104:107], v4 offset:0
    ds_read_b128 v[108:111], v4 offset:1024
    ds_read_b128 v[112:115], v4 offset:2048
    ds_read_b128 v[116:119], v4 offset:3072
    ds_read_b128 v[88:91], v4 offset:4096
    ds_read_b128 v[92:95], v4 offset:5120
    ds_read_b128 v[96:99], v4 offset:6144
    ds_read_b128 v[100:103], v4 offset:7168
    ds_read_b128 v[72:75], v4 offset:8192
    ds_read_b128 v[76:79], v4 offset:9216
    ds_read_b128 v[80:83], v4 offset:10240
    ds_read_b128 v[84:87], v4 offset:11264
    v_mov_b64 v[48:49], 0
    v_mov_b64 v[50:51], 0
    v_mov_b64 v[52:53], 0
    v_mov_b64 v[54:55], 0
    v_mov_b64 v[56:57], 0
    v_mov_b64 v[58:59], 0
    v_mov_b64 v[60:61], 0
    v_mov_b64 v[62:63], 0
    v_mov_b64 v[64:65], 0
    v_mov_b64 v[66:67], 0
    v_mov_b64 v[68:69], 0
    v_mov_b64 v[70:71], 0
    s_waitcnt lgkmcnt(0)
    s_mov_b64 s[62:63], 0
L_fast_step:
    s_bitcmp1_b64 s[62:63], s22
    s_cbranch_scc0 L_fast_refresh
    s_add_u32 s36, s22, 1
    s_bitcmp1_b64 s[62:63], s36
    s_cbranch_scc0 L_fast_refresh
    s_add_u32 s7, s23, 0x80000
    s_add_u32 s24, s23, 0x82000
    s_add_u32 s29, s23, s25
    s_add_u32 s30, s23, s39
    v_xor_b32 v28, 0x800, v2
    v_xor_b32 v36, 0x1000, v2
    v_xor_b32 v44, 0x1800, v2
L_fast_pollm:
    buffer_load_dwordx4 v[16:19], v2, s[8:11], s7 offen sc1
    buffer_load_dwordx4 v[20:23], v2, s[8:11], s7 offen offset:1024 sc1
    s_add_u32 s32, s32, 1
    s_cmp_gt_u32 s32, 200000
    s_waitcnt vmcnt(1)
    v_max3_u32 v14, v16, v17, v18
    s_waitcnt vmcnt(0)
    v_max3_u32 v24, v19, v20, v21
    v_max3_u32 v14, v14, v22, v23
    v_max_u32 v14, v14, v24
    s_cbranch_scc1 L_fast_gotm
    v_cmp_eq_u32 vcc, -1, v14
    s_cbranch_vccnz L_fast_pollm
L_fast_gotm:
    v_smfmac_f32_16x16x64_bf16 v[48:51], v[16:19], v[104:111], v1
    ds_write_b128 v2, v[16:19] offset:0
    v_smfmac_f32_16x16x64_bf16 v[52:55], v[16:19], v[112:119], v1
    ds_write_b128 v2, v[20:23] offset:1024
    v_smfmac_f32_16x16x64_bf16 v[48:51], v[20:23], v[88:95], v1
    buffer_load_dwordx4 v[104:107], v3, s[8:11], s29 offen offset:0 sc1
    v_smfmac_f32_16x16x64_bf16 v[52:55], v[20:23], v[96:103], v1
    v_smfmac_f32_16x16x64_bf16 v[56:59], v[16:19], v[72:79], v1
    buffer_load_dwordx4 v[108:111], v3, s[8:11], s29 offen offset:1024 sc1
    v_smfmac_f32_16x16x64_bf16 v[60:63], v[16:19], v[80:87], v1
    s_waitcnt lgkmcnt(0)
    s_barrier
    ds_read_b128 v[24:27], v28 offset:0
    v_smfmac_f32_16x16x64_bf16 v[56:59], v[20:23], a[80:87], v1
    ds_read_b128 v[28:31], v28 offset:1024
    v_smfmac_f32_16x16x64_bf16 v[60:63], v[20:23], a[88:95], v1
    ds_read_b128 v[32:35], v36 offset:0
    v_smfmac_f32_16x16x64_bf16 v[64:67], v[16:19], a[160:167], v1
    ds_read_b128 v[36:39], v36 offset:1024
    v_smfmac_f32_16x16x64_bf16 v[68:71], v[16:19], a[168:175], v1
    ds_read_b128 v[40:43], v44 offset:0
    s_waitcnt lgkmcnt(4)
    v_smfmac_f32_16x16x64_bf16 v[48:51], v[24:27], a[0:7], v1
    ds_read_b128 v[44:47], v44 offset:1024
    v_smfmac_f32_16x16x64_bf16 v[52:55], v[24:27], a[8:15], v1
    buffer_load_dwordx4 v[112:115], v3, s[8:11], s29 offen offset:2048 sc1
    s_waitcnt lgkmcnt(4)
    v_smfmac_f32_16x16x64_bf16 v[48:51], v[28:31], a[16:23], v1
    ds_read_b128 v[88:91], v4 offset:12288
    v_smfmac_f32_16x16x64_bf16 v[52:55], v[28:31], a[24:31], v1
    buffer_load_dwordx4 v[116:119], v3, s[8:11], s29 offen offset:3072 sc1
    s_waitcnt lgkmcnt(4)
    v_smfmac_f32_16x16x64_bf16 v[48:51], v[32:35], a[32:39], v1
    ds_read_b128 v[92:95], v4 offset:13312
    v_smfmac_f32_16x16x64_bf16 v[52:55], v[32:35], a[40:47], v1
    buffer_load_dwordx4 v[120:123], v3, s[8:11], s30 offen offset:0 sc1
    s_waitcnt lgkmcnt(4)
    v_smfmac_f32_16x16x64_bf16 v[48:51], v[36:39], a[48:55], v1
    ds_read_b128 v[96:99], v4 offset:14336
    v_smfmac_f32_16x16x64_bf16 v[52:55], v[36:39], a[56:63], v1
    ds_read_b128 v[100:103], v4 offset:15360
    s_waitcnt lgkmcnt(5)
    v_smfmac_f32_16x16x64_bf16 v[48:51], v[40:43], a[64:71], v1
    buffer_load_dwordx4 v[124:127], v3, s[8:11], s30 offen offset:1024 sc1
    v_smfmac_f32_16x16x64_bf16 v[52:55], v[40:43], a[72:79], v1
    ds_read_b128 v[72:75], v4 offset:16384
    s_waitcnt lgkmcnt(1)
    v_smfmac_f32_16x16x64_bf16 v[48:51], v[44:47], v[88:95], v1
    ds_read_b128 v[76:79], v4 offset:17408
    v_smfmac_f32_16x16x64_bf16 v[52:55], v[44:47], v[96:103], v1
    buffer_load_dword v15, v0, s[8:11], s24 offen sc1
    v_smfmac_f32_16x16x64_bf16 v[56:59], v[28:31], a[96:103], v1
    ds_read_b128 v[80:83], v4 offset:18432
    v_smfmac_f32_16x16x64_bf16 v[60:63], v[28:31], a[104:111], v1
    ds_read_b128 v[84:87], v4 offset:19456
    v_smfmac_f32_16x16x64_bf16 v[56:59], v[36:39], a[128:135], v1
    ds_read_b128 v[88:91], v4 offset:20480
    v_smfmac_f32_16x16x64_bf16 v[56:59], v[32:35], a[112:119], v1
    ds_read_b128 v[92:95], v4 offset:21504
    v_add_f32 v48, v48, v50
    v_add_f32 v49, v49, v51
    v_smfmac_f32_16x16x64_bf16 v[60:63], v[32:35], a[120:127], v1
    ds_read_b128 v[96:99], v4 offset:22528
    v_add_f32 v52, v52, v54
    v_add_f32 v53, v53, v55
    v_smfmac_f32_16x16x64_bf16 v[60:63], v[36:39], a[136:143], v1
    ds_read_b128 v[100:103], v4 offset:23552
    s_waitcnt lgkmcnt(4)
    v_cvt_pk_bf16_f32 v50, v48, v52
    v_cvt_pk_bf16_f32 v51, v49, v53
    v_smfmac_f32_16x16x64_bf16 v[56:59], v[24:27], v[72:79], v1
    ds_write2_b32 v5, v50, v51 offset0:0 offset1:72
    v_smfmac_f32_16x16x64_bf16 v[60:63], v[24:27], v[80:87], v1
    v_add_u32 v55, 2304, v5
    v_smfmac_f32_16x16x64_bf16 v[56:59], v[40:43], a[144:151], v1
    v_smfmac_f32_16x16x64_bf16 v[60:63], v[40:43], a[152:159], v1
    s_waitcnt lgkmcnt(0)
    s_barrier
    ds_read_b128 v[72:75], v6 offset:0
    v_smfmac_f32_16x16x64_bf16 v[56:59], v[44:47], v[88:95], v1
    ds_read_b128 v[76:79], v6 offset:64
    v_smfmac_f32_16x16x64_bf16 v[60:63], v[44:47], v[96:103], v1
    ds_read_b128 v[80:83], v6 offset:128
    v_smfmac_f32_16x16x64_bf16 v[64:67], v[20:23], a[176:183], v1
    ds_read_b128 v[84:87], v6 offset:192
    v_smfmac_f32_16x16x64_bf16 v[68:71], v[20:23], a[184:191], v1
    s_waitcnt vmcnt(3) lgkmcnt(3)
    v_mfma_f32_16x16x32_bf16 v[48:51], v[104:107], v[72:75], 0
    s_waitcnt lgkmcnt(2)
    v_add_f32 v56, v56, v58
    v_add_f32 v57, v57, v59
    v_mfma_f32_16x16x32_bf16 v[48:51], v[108:111], v[76:79], v[48:51]
    s_waitcnt lgkmcnt(1)
    v_add_f32 v60, v60, v62
    v_add_f32 v61, v61, v63
    v_mfma_f32_16x16x32_bf16 v[48:51], v[112:115], v[80:83], v[48:51]
    s_waitcnt lgkmcnt(0)
    v_cvt_pk_bf16_f32 v58, v56, v60
    v_cvt_pk_bf16_f32 v59, v57, v61
    v_mfma_f32_16x16x32_bf16 v[48:51], v[116:119], v[84:87], v[48:51]
    ds_write2_b32 v55, v58, v59 offset0:0 offset1:72
    v_smfmac_f32_16x16x64_bf16 v[64:67], v[24:27], a[192:199], v1
    buffer_store_dword v12, v10, s[8:11], s31 offen sc1
    v_mov_b64 v[104:105], s[4:5]
    v_smfmac_f32_16x16x64_bf16 v[68:71], v[24:27], a[200:207], v1
    v_mov_b64 v[106:107], s[4:5]
    v_smfmac_f32_16x16x64_bf16 v[64:67], v[28:31], a[208:215], v1
    s_nop 0
    v_exp_f32 v48, v48
    v_smfmac_f32_16x16x64_bf16 v[68:71], v[28:31], a[216:223], v1
    s_waitcnt lgkmcnt(0)
    s_barrier
    ds_read_b128 v[88:91], v7 offset:0
    v_exp_f32 v49, v49
    v_smfmac_f32_16x16x64_bf16 v[64:67], v[32:35], a[224:231], v1
    ds_read_b128 v[92:95], v7 offset:64
    v_exp_f32 v50, v50
    v_smfmac_f32_16x16x64_bf16 v[68:71], v[32:35], a[232:239], v1
    ds_read_b128 v[96:99], v7 offset:128
    v_exp_f32 v51, v51
    v_smfmac_f32_16x16x64_bf16 v[64:67], v[36:39], a[240:247], v1
    ds_read_b128 v[100:103], v7 offset:192
    v_cvt_pk_bf16_f32 v108, v48, v49
    v_cvt_pk_bf16_f32 v109, v50, v51
    v_smfmac_f32_16x16x64_bf16 v[68:71], v[36:39], a[248:255], v1
    ds_write_b64 v2, v[108:109] offset:8192
    s_waitcnt lgkmcnt(4)
    v_mfma_f32_16x16x32_bf16 v[52:55], v[88:91], v[72:75], 0
    s_waitcnt lgkmcnt(3)
    v_mov_b32 v113, 0
    v_mov_b32 v115, 0
    v_mfma_f32_16x16x32_bf16 v[52:55], v[92:95], v[76:79], v[52:55]
    s_waitcnt lgkmcnt(2)
    v_mov_b32 v117, 0
    v_xor_b32 v118, 0x1000, v2
    v_mfma_f32_16x16x32_bf16 v[52:55], v[96:99], v[80:83], v[52:55]
    s_waitcnt lgkmcnt(1)
    v_mov_b64 v[16:17], 0
    v_mov_b64 v[18:19], 0
    v_mfma_f32_16x16x32_bf16 v[52:55], v[100:103], v[84:87], v[52:55]
    v_mov_b64 v[20:21], 0
    v_mov_b64 v[22:23], 0
    v_smfmac_f32_16x16x64_bf16 v[64:67], v[40:43], v[128:135], v1
    s_waitcnt lgkmcnt(0)
    s_barrier
    ds_read_b64 v[110:111], v118 offset:8192
    v_mov_b64 v[24:25], 0
    v_smfmac_f32_16x16x64_bf16 v[68:71], v[40:43], v[136:143], v1
    ds_read_b128 v[88:91], v4 offset:24576
    v_mov_b64 v[26:27], 0
    v_smfmac_f32_16x16x64_bf16 v[64:67], v[44:47], v[144:151], v1
    ds_read_b128 v[92:95], v4 offset:25600
    v_mul_f32 v52, s33, v52
    v_mul_f32 v53, s33, v53
    v_smfmac_f32_16x16x64_bf16 v[68:71], v[44:47], v[152:159], v1
    ds_read_b128 v[96:99], v4 offset:26624
    s_waitcnt vmcnt(2) lgkmcnt(3)
    v_exp_f32 v52, v52
    v_mfma_f32_16x16x32_bf16 v[48:51], v[104:107], v[108:111], 0
    ds_read_b128 v[100:103], v4 offset:27648
    v_exp_f32 v53, v53
    v_mfma_f32_16x16x32_bf16 v[56:59], v[120:123], v[108:111], 0
    ds_read_b128 v[72:75], v4 offset:28672
    v_cvt_pk_bf16_f32 v112, v52, v53
    v_mov_b64 v[28:29], 0
    v_mfma_f32_16x16x32_bf16 v[60:63], v[124:127], v[108:111], 0
    ds_read_b128 v[76:79], v4 offset:29696
    v_add_f32 v64, v64, v66
    v_add_f32 v65, v65, v67
    v_mfma_f32_16x16x16_bf16 v[48:51], v[104:105], v[112:113], v[48:51]
    ds_read_b128 v[80:83], v4 offset:30720
    v_cvt_pk_bf16_f32 v114, v64, v65
    v_add_f32 v68, v68, v70
    v_add_f32 v69, v69, v71
    v_mfma_f32_16x16x16_bf16 v[56:59], v[114:115], v[112:113], v[56:59]
    ds_read_b128 v[84:87], v4 offset:31744
    v_cvt_pk_bf16_f32 v116, v68, v69
    v_mov_b64 v[30:31], 0
    v_mov_b64 v[32:33], 0
    v_mfma_f32_16x16x16_bf16 v[60:63], v[116:117], v[112:113], v[60:63]
    v_rcp_f32 v118, v48
    v_mov_b64 v[34:35], 0
    v_mov_b64 v[36:37], 0
    v_mov_b64 v[38:39], 0
    v_mov_b64 v[40:41], 0
    v_mov_b64 v[42:43], 0
    v_pk_mul_f32 v[56:57], v[56:57], v[118:119] op_sel_hi:[1,0]
    s_nop 0
    v_pk_mul_f32 v[60:61], v[60:61], v[118:119] op_sel_hi:[1,0]
    v_pk_mul_f32 v[58:59], v[58:59], v[118:119] op_sel_hi:[1,0]
    v_pk_mul_f32 v[62:63], v[62:63], v[118:119] op_sel_hi:[1,0]
    v_cvt_pk_bf16_f32 v52, v56, v60
    v_cvt_pk_bf16_f32 v53, v57, v61
    v_cvt_pk_bf16_f32 v54, v58, v62
    v_cvt_pk_bf16_f32 v55, v59, v63
    ds_write_b128 v8, v[52:55]
    v_max_f32 v118, v118, v48
    v_cmp_nge_f32 vcc, s40, v118
    s_cbranch_vccnz L_fast_safe
L_fast_rejoin:
    v_mov_b64 v[44:45], 0
    v_mov_b64 v[46:47], 0
    s_waitcnt lgkmcnt(0)
    s_barrier
    ds_read_b128 v[120:123], v3 offset:20992
    ds_read_b128 v[124:127], v3 offset:22016
    s_waitcnt lgkmcnt(1)
    v_smfmac_f32_16x16x64_bf16 v[16:19], v[120:123], v[88:95], v1
    v_smfmac_f32_16x16x64_bf16 v[20:23], v[120:123], v[96:103], v1
    s_waitcnt lgkmcnt(0)
    v_smfmac_f32_16x16x64_bf16 v[16:19], v[124:127], v[72:79], v1
    v_smfmac_f32_16x16x64_bf16 v[20:23], v[124:127], v[80:87], v1
    v_smfmac_f32_16x16x64_bf16 v[24:27], v[120:123], v[160:167], v1
    v_smfmac_f32_16x16x64_bf16 v[28:31], v[120:123], v[168:175], v1
    s_nop 4
    v_add_f32 v16, v16, v18
    v_add_f32 v17, v17, v19
    v_smfmac_f32_16x16x64_bf16 v[24:27], v[124:127], v[208:215], v1
    v_add_f32 v20, v20, v22
    v_add_f32 v21, v21, v23
    v_smfmac_f32_16x16x64_bf16 v[28:31], v[124:127], v[216:223], v1
    v_cvt_pk_bf16_f32 v48, v16, v20
    v_cvt_pk_bf16_f32 v49, v17, v21
    v_smfmac_f32_16x16x64_bf16 v[32:35], v[120:123], v[176:183], v1
    v_and_or_b32 v48, v48, -2, s27
    v_smfmac_f32_16x16x64_bf16 v[36:39], v[120:123], v[184:191], v1
    buffer_store_dwordx2 v[48:49], v9, s[8:11], 0 offen offset:0
    v_add_f32 v24, v24, v26
    v_add_f32 v25, v25, v27
    v_smfmac_f32_16x16x64_bf16 v[32:35], v[124:127], v[224:231], v1
    v_add_f32 v28, v28, v30
    v_add_f32 v29, v29, v31
    v_smfmac_f32_16x16x64_bf16 v[36:39], v[124:127], v[232:239], v1
    v_cvt_pk_bf16_f32 v50, v24, v28
    v_cvt_pk_bf16_f32 v51, v25, v29
    v_smfmac_f32_16x16x64_bf16 v[40:43], v[120:123], v[192:199], v1
    v_and_or_b32 v50, v50, -2, s27
    v_smfmac_f32_16x16x64_bf16 v[44:47], v[120:123], v[200:207], v1
    buffer_store_dwordx2 v[50:51], v9, s[8:11], 0 offen offset:2048
    v_add_f32 v32, v32, v34
    v_add_f32 v33, v33, v35
    v_smfmac_f32_16x16x64_bf16 v[40:43], v[124:127], v[240:247], v1
    v_add_f32 v36, v36, v38
    v_add_f32 v37, v37, v39
    v_smfmac_f32_16x16x64_bf16 v[44:47], v[124:127], v[248:255], v1
    v_cvt_pk_bf16_f32 v52, v32, v36
    v_cvt_pk_bf16_f32 v53, v33, v37
    v_and_or_b32 v52, v52, -2, s27
    buffer_store_dwordx2 v[52:53], v9, s[8:11], s26 offen offset:0
    s_nop 0
    v_add_f32 v40, v40, v42
    v_add_f32 v41, v41, v43
    s_nop 0
    v_add_f32 v44, v44, v46
    v_add_f32 v45, v45, v47
    v_cvt_pk_bf16_f32 v54, v40, v44
    v_cvt_pk_bf16_f32 v55, v41, v45
    v_and_or_b32 v54, v54, -2, s27
    buffer_store_dwordx2 v[54:55], v9, s[8:11], s26 offen offset:2048
L_fast_stored:
    ds_read_b128 v[24:27], v3 offset:23040
    ds_read_b128 v[104:107], v4 offset:0
    ds_read_b128 v[108:111], v4 offset:1024
    ds_read_b128 v[112:115], v4 offset:2048
    ds_read_b128 v[116:119], v4 offset:3072
    ds_read_b128 v[88:91], v4 offset:4096
    ds_read_b128 v[92:95], v4 offset:5120
    ds_read_b128 v[96:99], v4 offset:6144
    ds_read_b128 v[100:103], v4 offset:7168
    ds_read_b128 v[72:75], v4 offset:8192
    ds_read_b128 v[76:79], v4 offset:9216
    ds_read_b128 v[80:83], v4 offset:10240
    ds_read_b128 v[84:87], v4 offset:11264
    v_mov_b64 v[48:49], 0
    v_mov_b64 v[50:51], 0
    v_mov_b64 v[52:53], 0
    v_mov_b64 v[54:55], 0
    v_mov_b64 v[56:57], 0
    v_mov_b64 v[58:59], 0
    v_mov_b64 v[60:61], 0
    v_mov_b64 v[62:63], 0
    v_mov_b64 v[64:65], 0
    v_mov_b64 v[66:67], 0
    v_mov_b64 v[68:69], 0
    v_mov_b64 v[70:71], 0
    s_cmp_lt_u32 s21, 1
    s_cbranch_scc1 L_fast_poll0
    s_nop 7
    s_cmp_lt_u32 s21, 2
    s_cbranch_scc1 L_fast_poll0
    s_nop 7
    s_cmp_lt_u32 s21, 3
    s_cbranch_scc1 L_fast_poll0
    s_nop 7
L_fast_poll0:
    buffer_load_dwordx4 v[120:123], v2, s[8:11], s6 offen sc1
    buffer_load_dwordx4 v[124:127], v2, s[8:11], s6 offen offset:1024 sc1
    s_waitcnt lgkmcnt(0)
L_fast_pollp:
    s_waitcnt vmcnt(1)
    v_mfma_f32_16x16x32_bf16 v[36:39], v[24:27], v[120:123], 0
    v_bitop3_b32 v14, v120, v122, s27 bitop3:0x7e
    s_waitcnt vmcnt(0)
    v_mfma_f32_16x16x32_bf16 v[36:39], v[24:27], v[124:127], v[36:39]
    v_bitop3_b32 v11, v124, v126, s27 bitop3:0x7e
    v_bitop3_b32 v14, v14, v11, 1 bitop3:0xa8
    v_cmp_ne_u32 vcc, 0, v14
    s_add_u32 s32, s32, 1
    s_cbranch_vccz L_fast_gotp
    buffer_load_dwordx4 v[16:19], v2, s[8:11], s6 offen sc1
    buffer_load_dwordx4 v[20:23], v2, s[8:11], s6 offen offset:1024 sc1
    s_waitcnt vmcnt(1)
    v_mfma_f32_16x16x32_bf16 v[36:39], v[24:27], v[16:19], 0
    v_bitop3_b32 v14, v16, v18, s27 bitop3:0x7e
    s_waitcnt vmcnt(0)
    v_mfma_f32_16x16x32_bf16 v[36:39], v[24:27], v[20:23], v[36:39]
    v_bitop3_b32 v11, v20, v22, s27 bitop3:0x7e
    v_bitop3_b32 v14, v14, v11, 1 bitop3:0xa8
    v_cmp_ne_u32 vcc, 0, v14
    s_add_u32 s32, s32, 1
    s_cbranch_vccz L_fast_gotp
    buffer_load_dwordx4 v[120:123], v2, s[8:11], s6 offen sc1
    buffer_load_dwordx4 v[124:127], v2, s[8:11], s6 offen offset:1024 sc1
    s_cmp_le_u32 s32, 200000
    s_cbranch_scc1 L_fast_pollp
L_fast_gotp:
    s_mov_b32 s23, s24
    s_add_u32 s31, s31, 0x2000
    s_add_u32 s22, s22, 1
    s_xor_b32 s27, s27, 1
    v_add_f32_dpp v36, v36, v36 row_ror:8 row_mask:0xf bank_mask:0xf
    v_add_f32_dpp v37, v37, v37 row_ror:8 row_mask:0xf bank_mask:0xf
    s_nop 0
    v_add_f32_dpp v36, v36, v36 row_ror:4 row_mask:0xf bank_mask:0xf
    v_add_f32_dpp v37, v37, v37 row_ror:4 row_mask:0xf bank_mask:0xf
    v_cvt_pk_bf16_f32 v12, v36, v37
    buffer_store_dword v12, v10, s[8:11], s23 offen
    s_nop 15
    s_nop 15
    s_nop 15
    s_cmp_lt_u32 s22, 63
    s_cbranch_scc1 L_fast_step
    buffer_store_dword v12, v10, s[8:11], s31 offen sc1
    s_branch L_fast_done
L_fast_refresh:
    v_lshrrev_b32 v14, 2, v3
    s_lshl_b32 s36, s20, 8
    s_add_u32 s36, s36, 0x190000
    buffer_load_dword v14, v14, s[8:11], s36 offen sc1
    s_add_u32 s32, s32, 1
    s_waitcnt vmcnt(0)
    v_cmp_ne_u32 s[62:63], 0, v14
    s_nop 3
    s_bitset1_b64 s[62:63], 63
    s_cmp_le_u32 s32, 200000
    s_cbranch_scc1 L_fast_step
    s_mov_b64 s[62:63], -1
    s_branch L_fast_step
L_fast_safe:
    s_nop 11
    s_waitcnt vmcnt(0) lgkmcnt(0)
    ds_read_b128 v[72:75], v6 offset:0
    ds_read_b128 v[88:91], v7 offset:0
    ds_read_b128 v[76:79], v6 offset:64
    ds_read_b128 v[92:95], v7 offset:64
    ds_read_b128 v[80:83], v6 offset:128
    ds_read_b128 v[96:99], v7 offset:128
    ds_read_b128 v[84:87], v6 offset:192
    ds_read_b128 v[100:103], v7 offset:192
    s_xor_b32 s36, s25, 0x1000
    s_add_u32 s36, s36, s23
    buffer_load_dwordx4 v[16:19], v3, s[8:11], s29 offen offset:0 sc1
    buffer_load_dwordx4 v[32:35], v3, s[8:11], s36 offen offset:0 sc1
    buffer_load_dwordx4 v[20:23], v3, s[8:11], s29 offen offset:1024 sc1
    buffer_load_dwordx4 v[36:39], v3, s[8:11], s36 offen offset:1024 sc1
    buffer_load_dwordx4 v[24:27], v3, s[8:11], s29 offen offset:2048 sc1
    buffer_load_dwordx4 v[40:43], v3, s[8:11], s36 offen offset:2048 sc1
    buffer_load_dwordx4 v[28:31], v3, s[8:11], s29 offen offset:3072 sc1
    buffer_load_dwordx4 v[44:47], v3, s[8:11], s36 offen offset:3072 sc1
    s_waitcnt vmcnt(0) lgkmcnt(0)
    v_mfma_f32_16x16x32_bf16 v[48:51], v[16:19], v[72:75], 0
    v_mfma_f32_16x16x32_bf16 v[48:51], v[20:23], v[76:79], v[48:51]
    v_mfma_f32_16x16x32_bf16 v[48:51], v[24:27], v[80:83], v[48:51]
    v_mfma_f32_16x16x32_bf16 v[48:51], v[28:31], v[84:87], v[48:51]
    v_mfma_f32_16x16x32_bf16 v[52:55], v[32:35], v[72:75], 0
    v_mfma_f32_16x16x32_bf16 v[52:55], v[36:39], v[76:79], v[52:55]
    v_mfma_f32_16x16x32_bf16 v[52:55], v[40:43], v[80:83], v[52:55]
    v_mfma_f32_16x16x32_bf16 v[52:55], v[44:47], v[84:87], v[52:55]
    v_mfma_f32_16x16x32_bf16 v[56:59], v[88:91], v[72:75], 0
    v_mfma_f32_16x16x32_bf16 v[56:59], v[92:95], v[76:79], v[56:59]
    v_mfma_f32_16x16x32_bf16 v[56:59], v[96:99], v[80:83], v[56:59]
    v_mfma_f32_16x16x32_bf16 v[56:59], v[100:103], v[84:87], v[56:59]
    s_nop 7
    v_mul_f32 v56, s33, v56
    v_mul_f32 v57, s33, v57
    v_max3_f32 v16, v48, v49, v50
    v_max3_f32 v16, v16, v51, v52
    v_max3_f32 v16, v16, v53, v54
    v_max3_f32 v16, v16, v55, v56
    v_max_f32 v16, v16, v57
    v_mov_b32 v17, v16
    s_nop 1
    v_permlane16_swap_b32 v16, v17
    v_max_f32 v16, v16, v17
    v_mov_b32 v17, v16
    s_nop 1
    v_permlane32_swap_b32 v16, v17
    v_max_f32 v16, v16, v17
    v_sub_f32 v48, v48, v16
    v_exp_f32 v48, v48
    v_sub_f32 v49, v49, v16
    v_exp_f32 v49, v49
    v_sub_f32 v50, v50, v16
    v_exp_f32 v50, v50
    v_sub_f32 v51, v51, v16
    v_exp_f32 v51, v51
    v_sub_f32 v52, v52, v16
    v_exp_f32 v52, v52
    v_sub_f32 v53, v53, v16
    v_exp_f32 v53, v53
    v_sub_f32 v54, v54, v16
    v_exp_f32 v54, v54
    v_sub_f32 v55, v55, v16
    v_exp_f32 v55, v55
    v_sub_f32 v56, v56, v16
    v_exp_f32 v56, v56
    v_sub_f32 v57, v57, v16
    v_exp_f32 v57, v57
    v_cvt_pk_bf16_f32 v108, v48, v49
    v_cvt_pk_bf16_f32 v109, v50, v51
    v_cvt_pk_bf16_f32 v110, v52, v53
    v_cvt_pk_bf16_f32 v111, v54, v55
    v_cvt_pk_bf16_f32 v112, v56, v57
    s_nop 0
    v_mfma_f32_16x16x32_bf16 v[48:51], v[104:107], v[108:111], 0
    v_mfma_f32_16x16x32_bf16 v[56:59], v[120:123], v[108:111], 0
    v_mfma_f32_16x16x32_bf16 v[60:63], v[124:127], v[108:111], 0
    s_nop 3
    v_mfma_f32_16x16x16_bf16 v[48:51], v[104:105], v[112:113], v[48:51]
    v_mfma_f32_16x16x16_bf16 v[56:59], v[114:115], v[112:113], v[56:59]
    v_mfma_f32_16x16x16_bf16 v[60:63], v[116:117], v[112:113], v[60:63]
    s_nop 5
    v_rcp_f32 v118, v48
    s_nop 0
    v_mul_f32 v56, v56, v118
    v_mul_f32 v57, v57, v118
    v_mul_f32 v58, v58, v118
    v_mul_f32 v59, v59, v118
    v_mul_f32 v60, v60, v118
    v_mul_f32 v61, v61, v118
    v_mul_f32 v62, v62, v118
    v_mul_f32 v63, v63, v118
    v_cvt_pk_bf16_f32 v52, v56, v60
    v_cvt_pk_bf16_f32 v53, v57, v61
    v_cvt_pk_bf16_f32 v54, v58, v62
    v_cvt_pk_bf16_f32 v55, v59, v63
    ds_write_b128 v8, v[52:55]
    ds_read_b128 v[88:91], v4 offset:24576
    ds_read_b128 v[92:95], v4 offset:25600
    ds_read_b128 v[96:99], v4 offset:26624
    ds_read_b128 v[100:103], v4 offset:27648
    ds_read_b128 v[72:75], v4 offset:28672
    ds_read_b128 v[76:79], v4 offset:29696
    ds_read_b128 v[80:83], v4 offset:30720
    ds_read_b128 v[84:87], v4 offset:31744
    v_mov_b32 v16, 0
    v_mov_b32 v17, 0
    v_mov_b32 v18, 0
    v_mov_b32 v19, 0
    v_mov_b32 v20, 0
    v_mov_b32 v21, 0
    v_mov_b32 v22, 0
    v_mov_b32 v23, 0
    v_mov_b32 v24, 0
    v_mov_b32 v25, 0
    v_mov_b32 v26, 0
    v_mov_b32 v27, 0
    v_mov_b32 v28, 0
    v_mov_b32 v29, 0
    v_mov_b32 v30, 0
    v_mov_b32 v31, 0
    v_mov_b32 v32, 0
    v_mov_b32 v33, 0
    v_mov_b32 v34, 0
    v_mov_b32 v35, 0
    v_mov_b32 v36, 0
    v_mov_b32 v37, 0
    v_mov_b32 v38, 0
    v_mov_b32 v39, 0
    v_mov_b32 v40, 0
    v_mov_b32 v41, 0
    v_mov_b32 v42, 0
    v_mov_b32 v43, 0
    v_mov_b32 v44, 0
    v_mov_b32 v45, 0
    v_mov_b32 v46, 0
    v_mov_b32 v47, 0
    s_branch L_fast_rejoin
L_fast_done:
    s_branch L_end
L_slow_start:
    s_mov_b32 s22, 0
    s_mov_b32 s23, 0x1000000
    s_mov_b32 s27, 0
    s_mov_b32 s31, 0x80000
    ds_read_b128 v[104:107], v4 offset:0
    ds_read_b128 v[108:111], v4 offset:1024
    ds_read_b128 v[112:115], v4 offset:2048
    ds_read_b128 v[116:119], v4 offset:3072
    ds_read_b128 v[88:91], v4 offset:4096
    ds_read_b128 v[92:95], v4 offset:5120
    ds_read_b128 v[96:99], v4 offset:6144
    ds_read_b128 v[100:103], v4 offset:7168
    ds_read_b128 v[72:75], v4 offset:8192
    ds_read_b128 v[76:79], v4 offset:9216
    ds_read_b128 v[80:83], v4 offset:10240
    ds_read_b128 v[84:87], v4 offset:11264
    v_mov_b64 v[48:49], 0
    v_mov_b64 v[50:51], 0
    v_mov_b64 v[52:53], 0
    v_mov_b64 v[54:55], 0
    v_mov_b64 v[56:57], 0
    v_mov_b64 v[58:59], 0
    v_mov_b64 v[60:61], 0
    v_mov_b64 v[62:63], 0
    v_mov_b64 v[64:65], 0
    v_mov_b64 v[66:67], 0
    v_mov_b64 v[68:69], 0
    v_mov_b64 v[70:71], 0
    s_waitcnt lgkmcnt(0)
    s_mov_b64 s[62:63], 0
L_slow_step:
    s_bitcmp1_b64 s[62:63], s22
    s_cbranch_scc0 L_slow_refresh
    s_add_u32 s36, s22, 1
    s_bitcmp1_b64 s[62:63], s36
    s_cbranch_scc0 L_slow_refresh
    s_add_u32 s7, s23, 0x80000
    s_add_u32 s24, s23, 0x82000
    s_add_u32 s29, s23, s25
    s_add_u32 s30, s23, s39
    v_xor_b32 v28, 0x800, v2
    v_xor_b32 v36, 0x1000, v2
    v_xor_b32 v44, 0x1800, v2
L_slow_pollm:
    buffer_load_dwordx4 v[16:19], v2, s[8:11], s7 offen sc1
    buffer_load_dwordx4 v[20:23], v2, s[8:11], s7 offen offset:1024 sc1
    s_add_u32 s32, s32, 1
    s_cmp_gt_u32 s32, 200000
    s_waitcnt vmcnt(1)
    v_max3_u32 v14, v16, v17, v18
    s_waitcnt vmcnt(0)
    v_max3_u32 v24, v19, v20, v21
    v_max3_u32 v14, v14, v22, v23
    v_max_u32 v14, v14, v24
    s_cbranch_scc1 L_slow_gotm
    v_cmp_eq_u32 vcc, -1, v14
    s_cbranch_vccnz L_slow_pollm
L_slow_gotm:
    v_smfmac_f32_16x16x64_bf16 v[48:51], v[16:19], v[104:111], v1
    ds_write_b128 v2, v[16:19] offset:0
    v_smfmac_f32_16x16x64_bf16 v[52:55], v[16:19], v[112:119], v1
    ds_write_b128 v2, v[20:23] offset:1024
    v_smfmac_f32_16x16x64_bf16 v[48:51], v[20:23], v[88:95], v1
    buffer_load_dwordx4 v[104:107], v3, s[8:11], s29 offen offset:0 sc1
    v_smfmac_f32_16x16x64_bf16 v[52:55], v[20:23], v[96:103], v1
    v_smfmac_f32_16x16x64_bf16 v[56:59], v[16:19], v[72:79], v1
    buffer_load_dwordx4 v[108:111], v3, s[8:11], s29 offen offset:1024 sc1
    v_smfmac_f32_16x16x64_bf16 v[60:63], v[16:19], v[80:87], v1
    s_waitcnt lgkmcnt(0)
    s_barrier
    ds_read_b128 v[24:27], v28 offset:0
    v_smfmac_f32_16x16x64_bf16 v[56:59], v[20:23], a[80:87], v1
    ds_read_b128 v[28:31], v28 offset:1024
    v_smfmac_f32_16x16x64_bf16 v[60:63], v[20:23], a[88:95], v1
    ds_read_b128 v[32:35], v36 offset:0
    v_smfmac_f32_16x16x64_bf16 v[64:67], v[16:19], a[160:167], v1
    ds_read_b128 v[36:39], v36 offset:1024
    v_smfmac_f32_16x16x64_bf16 v[68:71], v[16:19], a[168:175], v1
    ds_read_b128 v[40:43], v44 offset:0
    s_waitcnt lgkmcnt(4)
    v_smfmac_f32_16x16x64_bf16 v[48:51], v[24:27], a[0:7], v1
    ds_read_b128 v[44:47], v44 offset:1024
    v_smfmac_f32_16x16x64_bf16 v[52:55], v[24:27], a[8:15], v1
    buffer_load_dwordx4 v[112:115], v3, s[8:11], s29 offen offset:2048 sc1
    s_waitcnt lgkmcnt(4)
    v_smfmac_f32_16x16x64_bf16 v[48:51], v[28:31], a[16:23], v1
    ds_read_b128 v[88:91], v4 offset:12288
    v_smfmac_f32_16x16x64_bf16 v[52:55], v[28:31], a[24:31], v1
    buffer_load_dwordx4 v[116:119], v3, s[8:11], s29 offen offset:3072 sc1
    s_waitcnt lgkmcnt(4)
    v_smfmac_f32_16x16x64_bf16 v[48:51], v[32:35], a[32:39], v1
    ds_read_b128 v[92:95], v4 offset:13312
    v_smfmac_f32_16x16x64_bf16 v[52:55], v[32:35], a[40:47], v1
    buffer_load_dwordx4 v[120:123], v3, s[8:11], s30 offen offset:0 sc1
    s_waitcnt lgkmcnt(4)
    v_smfmac_f32_16x16x64_bf16 v[48:51], v[36:39], a[48:55], v1
    ds_read_b128 v[96:99], v4 offset:14336
    v_smfmac_f32_16x16x64_bf16 v[52:55], v[36:39], a[56:63], v1
    ds_read_b128 v[100:103], v4 offset:15360
    s_waitcnt lgkmcnt(5)
    v_smfmac_f32_16x16x64_bf16 v[48:51], v[40:43], a[64:71], v1
    buffer_load_dwordx4 v[124:127], v3, s[8:11], s30 offen offset:1024 sc1
    v_smfmac_f32_16x16x64_bf16 v[52:55], v[40:43], a[72:79], v1
    ds_read_b128 v[72:75], v4 offset:16384
    s_waitcnt lgkmcnt(1)
    v_smfmac_f32_16x16x64_bf16 v[48:51], v[44:47], v[88:95], v1
    ds_read_b128 v[76:79], v4 offset:17408
    v_smfmac_f32_16x16x64_bf16 v[52:55], v[44:47], v[96:103], v1
    buffer_load_dword v15, v0, s[8:11], s24 offen sc1
    v_smfmac_f32_16x16x64_bf16 v[56:59], v[28:31], a[96:103], v1
    ds_read_b128 v[80:83], v4 offset:18432
    v_smfmac_f32_16x16x64_bf16 v[60:63], v[28:31], a[104:111], v1
    ds_read_b128 v[84:87], v4 offset:19456
    v_smfmac_f32_16x16x64_bf16 v[56:59], v[36:39], a[128:135], v1
    ds_read_b128 v[88:91], v4 offset:20480
    v_smfmac_f32_16x16x64_bf16 v[56:59], v[32:35], a[112:119], v1
    ds_read_b128 v[92:95], v4 offset:21504
    v_add_f32 v48, v48, v50
    v_add_f32 v49, v49, v51
    v_smfmac_f32_16x16x64_bf16 v[60:63], v[32:35], a[120:127], v1
    ds_read_b128 v[96:99], v4 offset:22528
    v_add_f32 v52, v52, v54
    v_add_f32 v53, v53, v55
    v_smfmac_f32_16x16x64_bf16 v[60:63], v[36:39], a[136:143], v1
    ds_read_b128 v[100:103], v4 offset:23552
    s_waitcnt lgkmcnt(4)
    v_cvt_pk_bf16_f32 v50, v48, v52
    v_cvt_pk_bf16_f32 v51, v49, v53
    v_smfmac_f32_16x16x64_bf16 v[56:59], v[24:27], v[72:79], v1
    ds_write2_b32 v5, v50, v51 offset0:0 offset1:72
    v_smfmac_f32_16x16x64_bf16 v[60:63], v[24:27], v[80:87], v1
    v_add_u32 v55, 2304, v5
    v_smfmac_f32_16x16x64_bf16 v[56:59], v[40:43], a[144:151], v1
    v_smfmac_f32_16x16x64_bf16 v[60:63], v[40:43], a[152:159], v1
    s_waitcnt lgkmcnt(0)
    s_barrier
    ds_read_b128 v[72:75], v6 offset:0
    v_smfmac_f32_16x16x64_bf16 v[56:59], v[44:47], v[88:95], v1
    ds_read_b128 v[76:79], v6 offset:64
    v_smfmac_f32_16x16x64_bf16 v[60:63], v[44:47], v[96:103], v1
    ds_read_b128 v[80:83], v6 offset:128
    v_smfmac_f32_16x16x64_bf16 v[64:67], v[20:23], a[176:183], v1
    ds_read_b128 v[84:87], v6 offset:192
    v_smfmac_f32_16x16x64_bf16 v[68:71], v[20:23], a[184:191], v1
    s_waitcnt vmcnt(3) lgkmcnt(3)
    v_mfma_f32_16x16x32_bf16 v[48:51], v[104:107], v[72:75], 0
    s_waitcnt lgkmcnt(2)
    v_add_f32 v56, v56, v58
    v_add_f32 v57, v57, v59
    v_mfma_f32_16x16x32_bf16 v[48:51], v[108:111], v[76:79], v[48:51]
    s_waitcnt lgkmcnt(1)
    v_add_f32 v60, v60, v62
    v_add_f32 v61, v61, v63
    v_mfma_f32_16x16x32_bf16 v[48:51], v[112:115], v[80:83], v[48:51]
    s_waitcnt lgkmcnt(0)
    v_cvt_pk_bf16_f32 v58, v56, v60
    v_cvt_pk_bf16_f32 v59, v57, v61
    v_mfma_f32_16x16x32_bf16 v[48:51], v[116:119], v[84:87], v[48:51]
    ds_write2_b32 v55, v58, v59 offset0:0 offset1:72
    v_smfmac_f32_16x16x64_bf16 v[64:67], v[24:27], a[192:199], v1
    buffer_store_dword v12, v10, s[8:11], s31 offen sc1
    v_mov_b64 v[104:105], s[4:5]
    v_smfmac_f32_16x16x64_bf16 v[68:71], v[24:27], a[200:207], v1
    v_mov_b64 v[106:107], s[4:5]
    v_smfmac_f32_16x16x64_bf16 v[64:67], v[28:31], a[208:215], v1
    s_nop 0
    v_exp_f32 v48, v48
    v_smfmac_f32_16x16x64_bf16 v[68:71], v[28:31], a[216:223], v1
    s_waitcnt lgkmcnt(0)
    s_barrier
    ds_read_b128 v[88:91], v7 offset:0
    v_exp_f32 v49, v49
    v_smfmac_f32_16x16x64_bf16 v[64:67], v[32:35], a[224:231], v1
    ds_read_b128 v[92:95], v7 offset:64
    v_exp_f32 v50, v50
    v_smfmac_f32_16x16x64_bf16 v[68:71], v[32:35], a[232:239], v1
    ds_read_b128 v[96:99], v7 offset:128
    v_exp_f32 v51, v51
    v_smfmac_f32_16x16x64_bf16 v[64:67], v[36:39], a[240:247], v1
    ds_read_b128 v[100:103], v7 offset:192
    v_cvt_pk_bf16_f32 v108, v48, v49
    v_cvt_pk_bf16_f32 v109, v50, v51
    v_smfmac_f32_16x16x64_bf16 v[68:71], v[36:39], a[248:255], v1
    ds_write_b64 v2, v[108:109] offset:8192
    s_waitcnt lgkmcnt(4)
    v_mfma_f32_16x16x32_bf16 v[52:55], v[88:91], v[72:75], 0
    s_waitcnt lgkmcnt(3)
    v_mov_b32 v113, 0
    v_mov_b32 v115, 0
    v_mfma_f32_16x16x32_bf16 v[52:55], v[92:95], v[76:79], v[52:55]
    s_waitcnt lgkmcnt(2)
    v_mov_b32 v117, 0
    v_xor_b32 v118, 0x1000, v2
    v_mfma_f32_16x16x32_bf16 v[52:55], v[96:99], v[80:83], v[52:55]
    s_waitcnt lgkmcnt(1)
    v_mov_b64 v[16:17], 0
    v_mov_b64 v[18:19], 0
    v_mfma_f32_16x16x32_bf16 v[52:55], v[100:103], v[84:87], v[52:55]
    v_mov_b64 v[20:21], 0
    v_mov_b64 v[22:23], 0
    v_smfmac_f32_16x16x64_bf16 v[64:67], v[40:43], v[128:135], v1
    s_waitcnt lgkmcnt(0)
    s_barrier
    ds_read_b64 v[110:111], v118 offset:8192
    v_mov_b64 v[24:25], 0
    v_smfmac_f32_16x16x64_bf16 v[68:71], v[40:43], v[136:143], v1
    ds_read_b128 v[88:91], v4 offset:24576
    v_mov_b64 v[26:27], 0
    v_smfmac_f32_16x16x64_bf16 v[64:67], v[44:47], v[144:151], v1
    ds_read_b128 v[92:95], v4 offset:25600
    v_mul_f32 v52, s33, v52
    v_mul_f32 v53, s33, v53
    v_smfmac_f32_16x16x64_bf16 v[68:71], v[44:47], v[152:159], v1
    ds_read_b128 v[96:99], v4 offset:26624
    s_waitcnt vmcnt(2) lgkmcnt(3)
    v_exp_f32 v52, v52
    v_mfma_f32_16x16x32_bf16 v[48:51], v[104:107], v[108:111], 0
    ds_read_b128 v[100:103], v4 offset:27648
    v_exp_f32 v53, v53
    v_mfma_f32_16x16x32_bf16 v[56:59], v[120:123], v[108:111], 0
    ds_read_b128 v[72:75], v4 offset:28672
    v_cvt_pk_bf16_f32 v112, v52, v53
    v_mov_b64 v[28:29], 0
    v_mfma_f32_16x16x32_bf16 v[60:63], v[124:127], v[108:111], 0
    ds_read_b128 v[76:79], v4 offset:29696
    v_add_f32 v64, v64, v66
    v_add_f32 v65, v65, v67
    v_mfma_f32_16x16x16_bf16 v[48:51], v[104:105], v[112:113], v[48:51]
    ds_read_b128 v[80:83], v4 offset:30720
    v_cvt_pk_bf16_f32 v114, v64, v65
    v_add_f32 v68, v68, v70
    v_add_f32 v69, v69, v71
    v_mfma_f32_16x16x16_bf16 v[56:59], v[114:115], v[112:113], v[56:59]
    ds_read_b128 v[84:87], v4 offset:31744
    v_cvt_pk_bf16_f32 v116, v68, v69
    v_mov_b64 v[30:31], 0
    v_mov_b64 v[32:33], 0
    v_mfma_f32_16x16x16_bf16 v[60:63], v[116:117], v[112:113], v[60:63]
    v_rcp_f32 v118, v48
    v_mov_b64 v[34:35], 0
    v_mov_b64 v[36:37], 0
    v_mov_b64 v[38:39], 0
    v_mov_b64 v[40:41], 0
    v_mov_b64 v[42:43], 0
    v_pk_mul_f32 v[56:57], v[56:57], v[118:119] op_sel_hi:[1,0]
    s_nop 0
    v_pk_mul_f32 v[60:61], v[60:61], v[118:119] op_sel_hi:[1,0]
    v_pk_mul_f32 v[58:59], v[58:59], v[118:119] op_sel_hi:[1,0]
    v_pk_mul_f32 v[62:63], v[62:63], v[118:119] op_sel_hi:[1,0]
    v_cvt_pk_bf16_f32 v52, v56, v60
    v_cvt_pk_bf16_f32 v53, v57, v61
    v_cvt_pk_bf16_f32 v54, v58, v62
    v_cvt_pk_bf16_f32 v55, v59, v63
    ds_write_b128 v8, v[52:55]
    v_max_f32 v118, v118, v48
    v_cmp_nge_f32 vcc, s40, v118
    s_cbranch_vccnz L_slow_safe
L_slow_rejoin:
    v_mov_b64 v[44:45], 0
    v_mov_b64 v[46:47], 0
    s_waitcnt lgkmcnt(0)
    s_barrier
    ds_read_b128 v[120:123], v3 offset:20992
    ds_read_b128 v[124:127], v3 offset:22016
    s_waitcnt lgkmcnt(1)
    v_smfmac_f32_16x16x64_bf16 v[16:19], v[120:123], v[88:95], v1
    v_smfmac_f32_16x16x64_bf16 v[20:23], v[120:123], v[96:103], v1
    s_waitcnt lgkmcnt(0)
    v_smfmac_f32_16x16x64_bf16 v[16:19], v[124:127], v[72:79], v1
    v_smfmac_f32_16x16x64_bf16 v[20:23], v[124:127], v[80:87], v1
    v_smfmac_f32_16x16x64_bf16 v[24:27], v[120:123], v[160:167], v1
    v_smfmac_f32_16x16x64_bf16 v[28:31], v[120:123], v[168:175], v1
    s_nop 4
    v_add_f32 v16, v16, v18
    v_add_f32 v17, v17, v19
    v_smfmac_f32_16x16x64_bf16 v[24:27], v[124:127], v[208:215], v1
    v_add_f32 v20, v20, v22
    v_add_f32 v21, v21, v23
    v_smfmac_f32_16x16x64_bf16 v[28:31], v[124:127], v[216:223], v1
    v_cvt_pk_bf16_f32 v48, v16, v20
    v_cvt_pk_bf16_f32 v49, v17, v21
    v_smfmac_f32_16x16x64_bf16 v[32:35], v[120:123], v[176:183], v1
    v_and_or_b32 v48, v48, -2, s27
    v_smfmac_f32_16x16x64_bf16 v[36:39], v[120:123], v[184:191], v1
    buffer_store_dwordx2 v[48:49], v9, s[8:11], 0 offen offset:0 sc1
    v_add_f32 v24, v24, v26
    v_add_f32 v25, v25, v27
    v_smfmac_f32_16x16x64_bf16 v[32:35], v[124:127], v[224:231], v1
    v_add_f32 v28, v28, v30
    v_add_f32 v29, v29, v31
    v_smfmac_f32_16x16x64_bf16 v[36:39], v[124:127], v[232:239], v1
    v_cvt_pk_bf16_f32 v50, v24, v28
    v_cvt_pk_bf16_f32 v51, v25, v29
    v_smfmac_f32_16x16x64_bf16 v[40:43], v[120:123], v[192:199], v1
    v_and_or_b32 v50, v50, -2, s27
    v_smfmac_f32_16x16x64_bf16 v[44:47], v[120:123], v[200:207], v1
    buffer_store_dwordx2 v[50:51], v9, s[8:11], 0 offen offset:2048 sc1
    v_add_f32 v32, v32, v34
    v_add_f32 v33, v33, v35
    v_smfmac_f32_16x16x64_bf16 v[40:43], v[124:127], v[240:247], v1
    v_add_f32 v36, v36, v38
    v_add_f32 v37, v37, v39
    v_smfmac_f32_16x16x64_bf16 v[44:47], v[124:127], v[248:255], v1
    v_cvt_pk_bf16_f32 v52, v32, v36
    v_cvt_pk_bf16_f32 v53, v33, v37
    v_and_or_b32 v52, v52, -2, s27
    buffer_store_dwordx2 v[52:53], v9, s[8:11], s26 offen offset:0 sc1
    s_nop 0
    v_add_f32 v40, v40, v42
    v_add_f32 v41, v41, v43
    s_nop 0
    v_add_f32 v44, v44, v46
    v_add_f32 v45, v45, v47
    v_cvt_pk_bf16_f32 v54, v40, v44
    v_cvt_pk_bf16_f32 v55, v41, v45
    v_and_or_b32 v54, v54, -2, s27
    buffer_store_dwordx2 v[54:55], v9, s[8:11], s26 offen offset:2048 sc1
L_slow_stored:
    ds_read_b128 v[24:27], v3 offset:23040
    ds_read_b128 v[104:107], v4 offset:0
    ds_read_b128 v[108:111], v4 offset:1024
    ds_read_b128 v[112:115], v4 offset:2048
    ds_read_b128 v[116:119], v4 offset:3072
    ds_read_b128 v[88:91], v4 offset:4096
    ds_read_b128 v[92:95], v4 offset:5120
    ds_read_b128 v[96:99], v4 offset:6144
    ds_read_b128 v[100:103], v4 offset:7168
    ds_read_b128 v[72:75], v4 offset:8192
    ds_read_b128 v[76:79], v4 offset:9216
    ds_read_b128 v[80:83], v4 offset:10240
    ds_read_b128 v[84:87], v4 offset:11264
    v_mov_b64 v[48:49], 0
    v_mov_b64 v[50:51], 0
    v_mov_b64 v[52:53], 0
    v_mov_b64 v[54:55], 0
    v_mov_b64 v[56:57], 0
    v_mov_b64 v[58:59], 0
    v_mov_b64 v[60:61], 0
    v_mov_b64 v[62:63], 0
    v_mov_b64 v[64:65], 0
    v_mov_b64 v[66:67], 0
    v_mov_b64 v[68:69], 0
    v_mov_b64 v[70:71], 0
    s_cmp_lt_u32 s21, 1
    s_cbranch_scc1 L_slow_poll0
    s_nop 7
    s_cmp_lt_u32 s21, 2
    s_cbranch_scc1 L_slow_poll0
    s_nop 7
    s_cmp_lt_u32 s21, 3
    s_cbranch_scc1 L_slow_poll0
    s_nop 7
L_slow_poll0:
    buffer_load_dwordx4 v[120:123], v2, s[8:11], s6 offen sc1
    buffer_load_dwordx4 v[124:127], v2, s[8:11], s6 offen offset:1024 sc1
    s_waitcnt lgkmcnt(0)
L_slow_pollp:
    s_waitcnt vmcnt(1)
    v_mfma_f32_16x16x32_bf16 v[36:39], v[24:27], v[120:123], 0
    v_bitop3_b32 v14, v120, v122, s27 bitop3:0x7e
    s_waitcnt vmcnt(0)
    v_mfma_f32_16x16x32_bf16 v[36:39], v[24:27], v[124:127], v[36:39]
    v_bitop3_b32 v11, v124, v126, s27 bitop3:0x7e
    v_bitop3_b32 v14, v14, v11, 1 bitop3:0xa8
    v_cmp_ne_u32 vcc, 0, v14
    s_add_u32 s32, s32, 1
    s_cbranch_vccz L_slow_gotp
    buffer_load_dwordx4 v[16:19], v2, s[8:11], s6 offen sc1
    buffer_load_dwordx4 v[20:23], v2, s[8:11], s6 offen offset:1024 sc1
    s_waitcnt vmcnt(1)
    v_mfma_f32_16x16x32_bf16 v[36:39], v[24:27], v[16:19], 0
    v_bitop3_b32 v14, v16, v18, s27 bitop3:0x7e
    s_waitcnt vmcnt(0)
    v_mfma_f32_16x16x32_bf16 v[36:39], v[24:27], v[20:23], v[36:39]
    v_bitop3_b32 v11, v20, v22, s27 bitop3:0x7e
    v_bitop3_b32 v14, v14, v11, 1 bitop3:0xa8
    v_cmp_ne_u32 vcc, 0, v14
    s_add_u32 s32, s32, 1
    s_cbranch_vccz L_slow_gotp
    buffer_load_dwordx4 v[120:123], v2, s[8:11], s6 offen sc1
    buffer_load_dwordx4 v[124:127], v2, s[8:11], s6 offen offset:1024 sc1
    s_cmp_le_u32 s32, 200000
    s_cbranch_scc1 L_slow_pollp
L_slow_gotp:
    s_mov_b32 s23, s24
    s_add_u32 s31, s31, 0x2000
    s_add_u32 s22, s22, 1
    s_xor_b32 s27, s27, 1
    v_add_f32_dpp v36, v36, v36 row_ror:8 row_mask:0xf bank_mask:0xf
    v_add_f32_dpp v37, v37, v37 row_ror:8 row_mask:0xf bank_mask:0xf
    s_nop 0
    v_add_f32_dpp v36, v36, v36 row_ror:4 row_mask:0xf bank_mask:0xf
    v_add_f32_dpp v37, v37, v37 row_ror:4 row_mask:0xf bank_mask:0xf
    v_cvt_pk_bf16_f32 v12, v36, v37
    buffer_store_dword v12, v10, s[8:11], s23 offen sc1
    s_nop 15
    s_nop 15
    s_nop 15
    s_cmp_lt_u32 s22, 63
    s_cbranch_scc1 L_slow_step
    buffer_store_dword v12, v10, s[8:11], s31 offen sc1
    s_branch L_slow_done
L_slow_refresh:
    v_lshrrev_b32 v14, 2, v3
    s_lshl_b32 s36, s20, 8
    s_add_u32 s36, s36, 0x190000
    buffer_load_dword v14, v14, s[8:11], s36 offen sc1
    s_add_u32 s32, s32, 1
    s_waitcnt vmcnt(0)
    v_cmp_ne_u32 s[62:63], 0, v14
    s_nop 3
    s_bitset1_b64 s[62:63], 63
    s_cmp_le_u32 s32, 200000
    s_cbranch_scc1 L_slow_step
    s_mov_b64 s[62:63], -1
    s_branch L_slow_step
L_slow_safe:
    s_nop 11
    s_waitcnt vmcnt(0) lgkmcnt(0)
    ds_read_b128 v[72:75], v6 offset:0
    ds_read_b128 v[88:91], v7 offset:0
    ds_read_b128 v[76:79], v6 offset:64
    ds_read_b128 v[92:95], v7 offset:64
    ds_read_b128 v[80:83], v6 offset:128
    ds_read_b128 v[96:99], v7 offset:128
    ds_read_b128 v[84:87], v6 offset:192
    ds_read_b128 v[100:103], v7 offset:192
    s_xor_b32 s36, s25, 0x1000
    s_add_u32 s36, s36, s23
    buffer_load_dwordx4 v[16:19], v3, s[8:11], s29 offen offset:0 sc1
    buffer_load_dwordx4 v[32:35], v3, s[8:11], s36 offen offset:0 sc1
    buffer_load_dwordx4 v[20:23], v3, s[8:11], s29 offen offset:1024 sc1
    buffer_load_dwordx4 v[36:39], v3, s[8:11], s36 offen offset:1024 sc1
    buffer_load_dwordx4 v[24:27], v3, s[8:11], s29 offen offset:2048 sc1
    buffer_load_dwordx4 v[40:43], v3, s[8:11], s36 offen offset:2048 sc1
    buffer_load_dwordx4 v[28:31], v3, s[8:11], s29 offen offset:3072 sc1
    buffer_load_dwordx4 v[44:47], v3, s[8:11], s36 offen offset:3072 sc1
    s_waitcnt vmcnt(0) lgkmcnt(0)
    v_mfma_f32_16x16x32_bf16 v[48:51], v[16:19], v[72:75], 0
    v_mfma_f32_16x16x32_bf16 v[48:51], v[20:23], v[76:79], v[48:51]
    v_mfma_f32_16x16x32_bf16 v[48:51], v[24:27], v[80:83], v[48:51]
    v_mfma_f32_16x16x32_bf16 v[48:51], v[28:31], v[84:87], v[48:51]
    v_mfma_f32_16x16x32_bf16 v[52:55], v[32:35], v[72:75], 0
    v_mfma_f32_16x16x32_bf16 v[52:55], v[36:39], v[76:79], v[52:55]
    v_mfma_f32_16x16x32_bf16 v[52:55], v[40:43], v[80:83], v[52:55]
    v_mfma_f32_16x16x32_bf16 v[52:55], v[44:47], v[84:87], v[52:55]
    v_mfma_f32_16x16x32_bf16 v[56:59], v[88:91], v[72:75], 0
    v_mfma_f32_16x16x32_bf16 v[56:59], v[92:95], v[76:79], v[56:59]
    v_mfma_f32_16x16x32_bf16 v[56:59], v[96:99], v[80:83], v[56:59]
    v_mfma_f32_16x16x32_bf16 v[56:59], v[100:103], v[84:87], v[56:59]
    s_nop 7
    v_mul_f32 v56, s33, v56
    v_mul_f32 v57, s33, v57
    v_max3_f32 v16, v48, v49, v50
    v_max3_f32 v16, v16, v51, v52
    v_max3_f32 v16, v16, v53, v54
    v_max3_f32 v16, v16, v55, v56
    v_max_f32 v16, v16, v57
    v_mov_b32 v17, v16
    s_nop 1
    v_permlane16_swap_b32 v16, v17
    v_max_f32 v16, v16, v17
    v_mov_b32 v17, v16
    s_nop 1
    v_permlane32_swap_b32 v16, v17
    v_max_f32 v16, v16, v17
    v_sub_f32 v48, v48, v16
    v_exp_f32 v48, v48
    v_sub_f32 v49, v49, v16
    v_exp_f32 v49, v49
    v_sub_f32 v50, v50, v16
    v_exp_f32 v50, v50
    v_sub_f32 v51, v51, v16
    v_exp_f32 v51, v51
    v_sub_f32 v52, v52, v16
    v_exp_f32 v52, v52
    v_sub_f32 v53, v53, v16
    v_exp_f32 v53, v53
    v_sub_f32 v54, v54, v16
    v_exp_f32 v54, v54
    v_sub_f32 v55, v55, v16
    v_exp_f32 v55, v55
    v_sub_f32 v56, v56, v16
    v_exp_f32 v56, v56
    v_sub_f32 v57, v57, v16
    v_exp_f32 v57, v57
    v_cvt_pk_bf16_f32 v108, v48, v49
    v_cvt_pk_bf16_f32 v109, v50, v51
    v_cvt_pk_bf16_f32 v110, v52, v53
    v_cvt_pk_bf16_f32 v111, v54, v55
    v_cvt_pk_bf16_f32 v112, v56, v57
    s_nop 0
    v_mfma_f32_16x16x32_bf16 v[48:51], v[104:107], v[108:111], 0
    v_mfma_f32_16x16x32_bf16 v[56:59], v[120:123], v[108:111], 0
    v_mfma_f32_16x16x32_bf16 v[60:63], v[124:127], v[108:111], 0
    s_nop 3
    v_mfma_f32_16x16x16_bf16 v[48:51], v[104:105], v[112:113], v[48:51]
    v_mfma_f32_16x16x16_bf16 v[56:59], v[114:115], v[112:113], v[56:59]
    v_mfma_f32_16x16x16_bf16 v[60:63], v[116:117], v[112:113], v[60:63]
    s_nop 5
    v_rcp_f32 v118, v48
    s_nop 0
    v_mul_f32 v56, v56, v118
    v_mul_f32 v57, v57, v118
    v_mul_f32 v58, v58, v118
    v_mul_f32 v59, v59, v118
    v_mul_f32 v60, v60, v118
    v_mul_f32 v61, v61, v118
    v_mul_f32 v62, v62, v118
    v_mul_f32 v63, v63, v118
    v_cvt_pk_bf16_f32 v52, v56, v60
    v_cvt_pk_bf16_f32 v53, v57, v61
    v_cvt_pk_bf16_f32 v54, v58, v62
    v_cvt_pk_bf16_f32 v55, v59, v63
    ds_write_b128 v8, v[52:55]
    ds_read_b128 v[88:91], v4 offset:24576
    ds_read_b128 v[92:95], v4 offset:25600
    ds_read_b128 v[96:99], v4 offset:26624
    ds_read_b128 v[100:103], v4 offset:27648
    ds_read_b128 v[72:75], v4 offset:28672
    ds_read_b128 v[76:79], v4 offset:29696
    ds_read_b128 v[80:83], v4 offset:30720
    ds_read_b128 v[84:87], v4 offset:31744
    v_mov_b32 v16, 0
    v_mov_b32 v17, 0
    v_mov_b32 v18, 0
    v_mov_b32 v19, 0
    v_mov_b32 v20, 0
    v_mov_b32 v21, 0
    v_mov_b32 v22, 0
    v_mov_b32 v23, 0
    v_mov_b32 v24, 0
    v_mov_b32 v25, 0
    v_mov_b32 v26, 0
    v_mov_b32 v27, 0
    v_mov_b32 v28, 0
    v_mov_b32 v29, 0
    v_mov_b32 v30, 0
    v_mov_b32 v31, 0
    v_mov_b32 v32, 0
    v_mov_b32 v33, 0
    v_mov_b32 v34, 0
    v_mov_b32 v35, 0
    v_mov_b32 v36, 0
    v_mov_b32 v37, 0
    v_mov_b32 v38, 0
    v_mov_b32 v39, 0
    v_mov_b32 v40, 0
    v_mov_b32 v41, 0
    v_mov_b32 v42, 0
    v_mov_b32 v43, 0
    v_mov_b32 v44, 0
    v_mov_b32 v45, 0
    v_mov_b32 v46, 0
    v_mov_b32 v47, 0
    s_branch L_slow_rejoin
L_slow_done:
    s_branch L_end
L_worker:
    s_mov_b32 s12, s44
    s_and_b32 s13, s45, 0xffff
    s_mov_b32 s14, 0x200000
    s_mov_b32 s15, 0x20000
    s_mov_b32 s60, s82
    s_and_b32 s61, s83, 0xffff
    s_mov_b32 s62, 0x200000
    s_mov_b32 s63, 0x20000
    s_mov_b32 s92, s80
    s_and_b32 s93, s81, 0xffff
    s_mov_b32 s94, 0x400
    s_mov_b32 s95, 0x20000
    s_and_b32 s36, s2, 7
    s_sub_u32 s36, s36, 1
    s_lshl_b32 s36, s36, 5
    s_lshr_b32 s37, s2, 3
    s_add_u32 s36, s36, s37
    s_mul_i32 s20, s36, 9363
    s_lshr_b32 s20, s20, 16
    s_mul_i32 s37, s20, 7
    s_sub_u32 s22, s36, s37
    v_mov_b32 v1, 0x0
    v_bfe_u32 v14, v0, 0, 1
    s_mov_b32 s38, 0x10
    v_mad_u32_u24 v1, v14, s38, v1
    v_bfe_u32 v14, v0, 1, 1
    s_mov_b32 s38, 0x20
    v_mad_u32_u24 v1, v14, s38, v1
    v_bfe_u32 v14, v0, 2, 1
    s_mov_b32 s38, 0x40
    v_mad_u32_u24 v1, v14, s38, v1
    v_bfe_u32 v14, v0, 3, 1
    s_mov_b32 s38, 0x80
    v_mad_u32_u24 v1, v14, s38, v1
    v_bfe_u32 v14, v0, 4, 1
    s_mov_b32 s38, 0x100
    v_mad_u32_u24 v1, v14, s38, v1
    v_bfe_u32 v14, v0, 5, 1
    s_mov_b32 s38, 0x200
    v_mad_u32_u24 v1, v14, s38, v1
    v_mov_b32 v2, 0x0
    v_bfe_u32 v14, v0, 0, 1
    s_mov_b32 s38, 0x10
    v_mad_u32_u24 v2, v14, s38, v2
    v_bfe_u32 v14, v0, 1, 1
    s_mov_b32 s38, 0x20
    v_mad_u32_u24 v2, v14, s38, v2
    v_bfe_u32 v14, v0, 2, 1
    s_mov_b32 s38, 0x40
    v_mad_u32_u24 v2, v14, s38, v2
    v_bfe_u32 v14, v0, 3, 1
    s_mov_b32 s38, 0x80
    v_mad_u32_u24 v2, v14, s38, v2
    v_bfe_u32 v14, v0, 4, 1
    s_mov_b32 s38, 0x100
    v_mad_u32_u24 v2, v14, s38, v2
    v_bfe_u32 v14, v0, 5, 1
    s_mov_b32 s38, 0x200
    v_mad_u32_u24 v2, v14, s38, v2
    v_bfe_u32 v14, v0, 6, 1
    s_mov_b32 s38, 0x800
    v_mad_u32_u24 v2, v14, s38, v2
    v_bfe_u32 v14, v0, 7, 1
    s_mov_b32 s38, 0x1000
    v_mad_u32_u24 v2, v14, s38, v2
    v_mov_b32 v9, 0x0
    v_bfe_u32 v14, v0, 0, 1
    s_mov_b32 s38, 0x10
    v_mad_u32_u24 v9, v14, s38, v9
    v_bfe_u32 v14, v0, 1, 1
    s_mov_b32 s38, 0x20
    v_mad_u32_u24 v9, v14, s38, v9
    v_bfe_u32 v14, v0, 2, 1
    s_mov_b32 s38, 0x40
    v_mad_u32_u24 v9, v14, s38, v9
    v_bfe_u32 v14, v0, 3, 1
    s_mov_b32 s38, 0x80
    v_mad_u32_u24 v9, v14, s38, v9
    v_bfe_u32 v14, v0, 4, 1
    s_mov_b32 s38, 0x100
    v_mad_u32_u24 v9, v14, s38, v9
    v_bfe_u32 v14, v0, 5, 1
    s_mov_b32 s38, 0x200
    v_mad_u32_u24 v9, v14, s38, v9
    v_bfe_u32 v14, v0, 6, 1
    s_mov_b32 s38, 0x400
    v_mad_u32_u24 v9, v14, s38, v9
    v_bfe_u32 v14, v0, 7, 1
    s_mov_b32 s38, 0x800
    v_mad_u32_u24 v9, v14, s38, v9
    v_mov_b32 v7, 0x8000
    v_bfe_u32 v14, v0, 0, 1
    s_mov_b32 s38, 0x10
    v_mad_u32_u24 v7, v14, s38, v7
    v_bfe_u32 v14, v0, 1, 1
    s_mov_b32 s38, 0x20
    v_mad_u32_u24 v7, v14, s38, v7
    v_bfe_u32 v14, v0, 2, 1
    s_mov_b32 s38, 0x40
    v_mad_u32_u24 v7, v14, s38, v7
    v_bfe_u32 v14, v0, 3, 1
    s_mov_b32 s38, 0x80
    v_mad_u32_u24 v7, v14, s38, v7
    v_bfe_u32 v14, v0, 4, 1
    s_mov_b32 s38, 0x100
    v_mad_u32_u24 v7, v14, s38, v7
    v_bfe_u32 v14, v0, 5, 1
    s_mov_b32 s38, 0x200
    v_mad_u32_u24 v7, v14, s38, v7
    v_bfe_u32 v14, v0, 6, 1
    s_mov_b32 s38, 0x8000
    v_mad_u32_u24 v7, v14, s38, v7
    v_bfe_u32 v14, v0, 7, 1
    s_mov_b32 s38, 0x10000
    v_mad_u32_u24 v7, v14, s38, v7
    v_mov_b32 v3, 0x0
    v_bfe_u32 v14, v0, 0, 1
    s_mov_b32 s38, 0x10
    v_mad_u32_u24 v3, v14, s38, v3
    v_bfe_u32 v14, v0, 1, 1
    s_mov_b32 s38, 0x20
    v_mad_u32_u24 v3, v14, s38, v3
    v_bfe_u32 v14, v0, 2, 1
    s_mov_b32 s38, 0x40
    v_mad_u32_u24 v3, v14, s38, v3
    v_bfe_u32 v14, v0, 3, 1
    s_mov_b32 s38, 0x400
    v_mad_u32_u24 v3, v14, s38, v3
    v_bfe_u32 v14, v0, 4, 1
    s_mov_b32 s38, 0x800
    v_mad_u32_u24 v3, v14, s38, v3
    v_bfe_u32 v14, v0, 5, 1
    s_mov_b32 s38, 0x1000
    v_mad_u32_u24 v3, v14, s38, v3
    v_bfe_u32 v14, v0, 6, 1
    s_mov_b32 s38, 0x2000
    v_mad_u32_u24 v3, v14, s38, v3
    v_bfe_u32 v14, v0, 7, 1
    s_mov_b32 s38, 0x4000
    v_mad_u32_u24 v3, v14, s38, v3
    v_mov_b32 v4, 0x0
    v_bfe_u32 v14, v0, 0, 1
    s_mov_b32 s38, 0x100
    v_mad_u32_u24 v4, v14, s38, v4
    v_bfe_u32 v14, v0, 1, 1
    s_mov_b32 s38, 0x200
    v_mad_u32_u24 v4, v14, s38, v4
    v_bfe_u32 v14, v0, 2, 1
    s_mov_b32 s38, 0x400
    v_mad_u32_u24 v4, v14, s38, v4
    v_bfe_u32 v14, v0, 6, 1
    s_mov_b32 s38, 0x80
    v_mad_u32_u24 v4, v14, s38, v4
    v_bfe_u32 v14, v0, 7, 1
    s_mov_b32 s38, 0x4000
    v_mad_u32_u24 v4, v14, s38, v4
    v_lshrrev_b32 v15, 3, v0
    v_xor_b32 v15, v15, v0
    v_and_b32 v15, 7, v15
    v_lshl_add_u32 v4, v15, 4, v4
    v_bfe_u32 v15, v0, 4, 2
    v_lshlrev_b32 v15, 4, v15
    v_xor_b32 v5, v15, v1
    v_xor_b32 v6, 64, v5
    v_mov_b32 v8, 0x5000
    v_bfe_u32 v14, v0, 0, 1
    s_mov_b32 s38, 0x10
    v_mad_u32_u24 v8, v14, s38, v8
    v_bfe_u32 v14, v0, 1, 1
    s_mov_b32 s38, 0x40
    v_mad_u32_u24 v8, v14, s38, v8
    v_bfe_u32 v14, v0, 2, 1
    s_mov_b32 s38, 0x80
    v_mad_u32_u24 v8, v14, s38, v8
    v_bfe_u32 v14, v0, 4, 1
    s_mov_b32 s38, 0x20
    v_mad_u32_u24 v8, v14, s38, v8
    v_bfe_u32 v14, v0, 5, 1
    s_mov_b32 s38, 0x100
    v_mad_u32_u24 v8, v14, s38, v8
    v_mov_b32 v10, 0x0
    v_bfe_u32 v14, v0, 0, 1
    s_mov_b32 s38, 0x10
    v_mad_u32_u24 v10, v14, s38, v10
    v_bfe_u32 v14, v0, 1, 1
    s_mov_b32 s38, 0x20
    v_mad_u32_u24 v10, v14, s38, v10
    v_bfe_u32 v14, v0, 2, 1
    s_mov_b32 s38, 0x40
    v_mad_u32_u24 v10, v14, s38, v10
    v_bfe_u32 v14, v0, 3, 1
    s_mov_b32 s38, 0x80
    v_mad_u32_u24 v10, v14, s38, v10
    v_bfe_u32 v14, v0, 4, 1
    s_mov_b32 s38, 0x20000
    v_mad_u32_u24 v10, v14, s38, v10
    v_bfe_u32 v14, v0, 5, 1
    s_mov_b32 s38, 0x40000
    v_mad_u32_u24 v10, v14, s38, v10
    v_bfe_u32 v14, v0, 6, 1
    s_mov_b32 s38, 0x100
    v_mad_u32_u24 v10, v14, s38, v10
    v_bfe_u32 v14, v0, 7, 1
    s_mov_b32 s38, 0x200
    v_mad_u32_u24 v10, v14, s38, v10
    v_mov_b32 v11, 0x0
    v_bfe_u32 v14, v0, 0, 1
    s_mov_b32 s38, 0x10
    v_mad_u32_u24 v11, v14, s38, v11
    v_bfe_u32 v14, v0, 1, 1
    s_mov_b32 s38, 0x20
    v_mad_u32_u24 v11, v14, s38, v11
    v_bfe_u32 v14, v0, 2, 1
    s_mov_b32 s38, 0x40
    v_mad_u32_u24 v11, v14, s38, v11
    v_bfe_u32 v14, v0, 3, 1
    s_mov_b32 s38, 0x80
    v_mad_u32_u24 v11, v14, s38, v11
    v_bfe_u32 v14, v0, 4, 1
    s_mov_b32 s38, 0x400
    v_mad_u32_u24 v11, v14, s38, v11
    v_bfe_u32 v14, v0, 5, 1
    s_mov_b32 s38, 0x800
    v_mad_u32_u24 v11, v14, s38, v11
    v_bfe_u32 v14, v0, 6, 1
    s_mov_b32 s38, 0x100
    v_mad_u32_u24 v11, v14, s38, v11
    v_bfe_u32 v14, v0, 7, 1
    s_mov_b32 s38, 0x200
    v_mad_u32_u24 v11, v14, s38, v11
    v_mov_b32 v12, 0x0
    v_bfe_u32 v14, v0, 0, 1
    s_mov_b32 s38, 0x10
    v_mad_u32_u24 v12, v14, s38, v12
    v_bfe_u32 v14, v0, 1, 1
    s_mov_b32 s38, 0x20
    v_mad_u32_u24 v12, v14, s38, v12
    v_bfe_u32 v14, v0, 2, 1
    s_mov_b32 s38, 0x40
    v_mad_u32_u24 v12, v14, s38, v12
    v_bfe_u32 v14, v0, 3, 1
    s_mov_b32 s38, 0x80
    v_mad_u32_u24 v12, v14, s38, v12
    v_bfe_u32 v14, v0, 4, 1
    s_mov_b32 s38, 0x4
    v_mad_u32_u24 v12, v14, s38, v12
    v_bfe_u32 v14, v0, 5, 1
    s_mov_b32 s38, 0x8
    v_mad_u32_u24 v12, v14, s38, v12
    v_bfe_u32 v14, v0, 6, 1
    s_mov_b32 s38, 0x100
    v_mad_u32_u24 v12, v14, s38, v12
    v_bfe_u32 v14, v0, 7, 1
    s_mov_b32 s38, 0x200
    v_mad_u32_u24 v12, v14, s38, v12
    v_mov_b32 v13, 0xf149f2ca
    v_and_b32 v14, 15, v0
    v_bfe_u32 v15, v0, 4, 2
    v_cmp_gt_u32 s[72:73], 2, v15
    v_lshlrev_b32 v15, 2, v15
    v_cmp_le_u32 s[64:65], v15, v14
    v_add_u32 v15, 1, v15
    v_cmp_le_u32 s[66:67], v15, v14
    v_add_u32 v15, 1, v15
    v_cmp_le_u32 s[68:69], v15, v14
    v_add_u32 v15, 1, v15
    v_cmp_le_u32 s[70:71], v15, v14
    v_add_u32 v15, 1, v15
    s_mov_b32 s34, 0x05040100
    s_mov_b32 s35, 0x07060302
    s_mov_b32 s33, 0x3e0293ee
    s_mov_b32 s32, 0
    s_mov_b32 s4, 0x3f803f80
    s_mov_b32 s5, 0x3f803f80
    s_mov_b32 s23, s22
    s_mov_b32 s96, s54
    s_and_b32 s97, s55, 0xffff
    s_mov_b32 s98, 0x400000
    s_mov_b32 s99, 0x20000
    s_lshl_b32 s3, s20, 17
    s_and_b32 s28, s22, 3
    s_lshl_b32 s28, s28, 15
    s_add_u32 s3, s3, s28
    v_lshlrev_b32 v30, 7, v0
    buffer_load_dword v31, v30, s[96:99], s3 offen
    s_lshl_b32 s36, s23, 15
    buffer_load_dwordx4 v[96:99], v3, s[12:15], s36 offen offset:0
    buffer_load_dwordx4 v[100:103], v3, s[12:15], s36 offen offset:128
    buffer_load_dwordx4 v[104:107], v3, s[12:15], s36 offen offset:256
    buffer_load_dwordx4 v[108:111], v3, s[12:15], s36 offen offset:384
    buffer_load_dwordx4 v[112:115], v3, s[12:15], s36 offen offset:512
    buffer_load_dwordx4 v[116:119], v3, s[12:15], s36 offen offset:640
    buffer_load_dwordx4 v[120:123], v3, s[12:15], s36 offen offset:768
    buffer_load_dwordx4 v[124:127], v3, s[12:15], s36 offen offset:896
    s_mov_b32 s76, s52
    s_and_b32 s77, s53, 0xffff
    s_mov_b32 s78, 0x400000
    s_mov_b32 s79, 0x20000
    s_mov_b32 s40, s50
    s_and_b32 s41, s51, 0xffff
    s_mov_b32 s42, 0x400000
    s_mov_b32 s43, 0x20000
    s_mov_b32 s96, s48
    s_and_b32 s97, s49, 0xffff
    s_mov_b32 s98, 0x400000
    s_mov_b32 s99, 0x20000
    v_mov_b32 v16, 0x0
    v_bfe_u32 v14, v0, 0, 1
    s_mov_b32 s38, 0x10
    v_mad_u32_u24 v16, v14, s38, v16
    v_bfe_u32 v14, v0, 1, 1
    s_mov_b32 s38, 0x20
    v_mad_u32_u24 v16, v14, s38, v16
    v_bfe_u32 v14, v0, 2, 1
    s_mov_b32 s38, 0x40
    v_mad_u32_u24 v16, v14, s38, v16
    v_bfe_u32 v14, v0, 3, 1
    s_mov_b32 s38, 0x80
    v_mad_u32_u24 v16, v14, s38, v16
    v_bfe_u32 v14, v0, 4, 1
    s_mov_b32 s38, 0x2000
    v_mad_u32_u24 v16, v14, s38, v16
    v_bfe_u32 v14, v0, 5, 1
    s_mov_b32 s38, 0x4000
    v_mad_u32_u24 v16, v14, s38, v16
    v_bfe_u32 v14, v0, 6, 1
    s_mov_b32 s38, 0x40000
    v_mad_u32_u24 v16, v14, s38, v16
    v_bfe_u32 v14, v0, 7, 1
    s_mov_b32 s38, 0x80000
    v_mad_u32_u24 v16, v14, s38, v16
    v_mov_b32 v28, 0x0
    v_bfe_u32 v14, v0, 4, 1
    s_mov_b32 s38, 0x20
    v_mad_u32_u24 v28, v14, s38, v28
    v_bfe_u32 v14, v0, 5, 1
    s_mov_b32 s38, 0x40
    v_mad_u32_u24 v28, v14, s38, v28
    v_xor_b32 v16, v16, v28
    v_xor_b32 v17, 0, v16
    v_xor_b32 v18, 128, v16
    v_xor_b32 v19, 128, v16
    v_mov_b32 v20, 0x0
    v_bfe_u32 v14, v0, 0, 1
    s_mov_b32 s38, 0x8
    v_mad_u32_u24 v20, v14, s38, v20
    v_bfe_u32 v14, v0, 1, 1
    s_mov_b32 s38, 0x10
    v_mad_u32_u24 v20, v14, s38, v20
    v_bfe_u32 v14, v0, 2, 1
    s_mov_b32 s38, 0x100
    v_mad_u32_u24 v20, v14, s38, v20
    v_bfe_u32 v14, v0, 3, 1
    s_mov_b32 s38, 0x200
    v_mad_u32_u24 v20, v14, s38, v20
    v_bfe_u32 v14, v0, 4, 1
    s_mov_b32 s38, 0x800
    v_mad_u32_u24 v20, v14, s38, v20
    v_bfe_u32 v14, v0, 5, 1
    s_mov_b32 s38, 0x1000
    v_mad_u32_u24 v20, v14, s38, v20
    v_mov_b32 v28, 0x0
    v_bfe_u32 v14, v0, 2, 1
    s_mov_b32 s38, 0x20
    v_mad_u32_u24 v28, v14, s38, v28
    v_bfe_u32 v14, v0, 3, 1
    s_mov_b32 s38, 0x40
    v_mad_u32_u24 v28, v14, s38, v28
    v_bfe_u32 v14, v0, 4, 1
    s_mov_b32 s38, 0x80
    v_mad_u32_u24 v28, v14, s38, v28
    v_mov_b32 v29, 0x0
    v_bfe_u32 v14, v0, 6, 1
    s_mov_b32 s38, 0x40
    v_mad_u32_u24 v29, v14, s38, v29
    v_bfe_u32 v14, v0, 7, 1
    s_mov_b32 s38, 0x80
    v_mad_u32_u24 v29, v14, s38, v29
    v_xor_b32 v28, v28, v29
    v_add_u32 v28, v28, v20
    v_add_u32 v20, 0x8000, v28
    v_xor_b32 v21, 32, v20
    v_add_u32 v22, 0x10000, v28
    v_xor_b32 v23, 32, v22
    v_add_u32 v24, 0x18000, v28
    v_xor_b32 v25, 32, v24
    v_add_u32 v26, 0x20000, v28
    v_xor_b32 v27, 32, v26
    s_add_u32 s28, s21, 1
    s_lshl_b32 s28, s28, 15
    s_lshl_b32 s3, s20, 8
    s_add_u32 m0, s28, 0
    s_add_u32 s37, s3, 0x0
    buffer_load_dwordx4 v16, s[76:79], s37 offen lds
    s_add_u32 m0, s28, 1024
    s_add_u32 s37, s3, 0x8000
    buffer_load_dwordx4 v17, s[76:79], s37 offen lds
    s_add_u32 m0, s28, 2048
    s_add_u32 s37, s3, 0x10000
    buffer_load_dwordx4 v18, s[76:79], s37 offen lds
    s_add_u32 m0, s28, 3072
    s_add_u32 s37, s3, 0x18000
    buffer_load_dwordx4 v19, s[76:79], s37 offen lds
    s_add_u32 m0, s28, 4096
    s_add_u32 s37, s3, 0x20000
    buffer_load_dwordx4 v16, s[76:79], s37 offen lds
    s_add_u32 m0, s28, 5120
    s_add_u32 s37, s3, 0x28000
    buffer_load_dwordx4 v17, s[76:79], s37 offen lds
    s_add_u32 m0, s28, 6144
    s_add_u32 s37, s3, 0x30000
    buffer_load_dwordx4 v18, s[76:79], s37 offen lds
    s_add_u32 m0, s28, 7168
    s_add_u32 s37, s3, 0x38000
    buffer_load_dwordx4 v19, s[76:79], s37 offen lds
    s_add_u32 m0, s28, 8192
    s_add_u32 s37, s3, 0x100000
    buffer_load_dwordx4 v16, s[76:79], s37 offen lds
    s_add_u32 m0, s28, 9216
    s_add_u32 s37, s3, 0x108000
    buffer_load_dwordx4 v17, s[76:79], s37 offen lds
    s_add_u32 m0, s28, 10240
    s_add_u32 s37, s3, 0x110000
    buffer_load_dwordx4 v18, s[76:79], s37 offen lds
    s_add_u32 m0, s28, 11264
    s_add_u32 s37, s3, 0x118000
    buffer_load_dwordx4 v19, s[76:79], s37 offen lds
    s_add_u32 m0, s28, 12288
    s_add_u32 s37, s3, 0x120000
    buffer_load_dwordx4 v16, s[76:79], s37 offen lds
    s_add_u32 m0, s28, 13312
    s_add_u32 s37, s3, 0x128000
    buffer_load_dwordx4 v17, s[76:79], s37 offen lds
    s_add_u32 m0, s28, 14336
    s_add_u32 s37, s3, 0x130000
    buffer_load_dwordx4 v18, s[76:79], s37 offen lds
    s_add_u32 m0, s28, 15360
    s_add_u32 s37, s3, 0x138000
    buffer_load_dwordx4 v19, s[76:79], s37 offen lds
    s_add_u32 m0, s28, 16384
    s_add_u32 s37, s3, 0x200000
    buffer_load_dwordx4 v16, s[76:79], s37 offen lds
    s_add_u32 m0, s28, 17408
    s_add_u32 s37, s3, 0x208000
    buffer_load_dwordx4 v17, s[76:79], s37 offen lds
    s_add_u32 m0, s28, 18432
    s_add_u32 s37, s3, 0x210000
    buffer_load_dwordx4 v18, s[76:79], s37 offen lds
    s_add_u32 m0, s28, 19456
    s_add_u32 s37, s3, 0x218000
    buffer_load_dwordx4 v19, s[76:79], s37 offen lds
    s_add_u32 m0, s28, 20480
    s_add_u32 s37, s3, 0x220000
    buffer_load_dwordx4 v16, s[76:79], s37 offen lds
    s_add_u32 m0, s28, 21504
    s_add_u32 s37, s3, 0x228000
    buffer_load_dwordx4 v17, s[76:79], s37 offen lds
    s_add_u32 m0, s28, 22528
    s_add_u32 s37, s3, 0x230000
    buffer_load_dwordx4 v18, s[76:79], s37 offen lds
    s_add_u32 m0, s28, 23552
    s_add_u32 s37, s3, 0x238000
    buffer_load_dwordx4 v19, s[76:79], s37 offen lds
    s_waitcnt vmcnt(16)
    s_barrier
    ds_read_b64_tr_b16 v[128:129], v20 offset:0
    ds_read_b64_tr_b16 v[130:131], v20 offset:1024
    ds_read_b64_tr_b16 v[132:133], v21 offset:0
    ds_read_b64_tr_b16 v[134:135], v21 offset:1024
    ds_read_b64_tr_b16 v[136:137], v22 offset:0
    ds_read_b64_tr_b16 v[138:139], v22 offset:1024
    ds_read_b64_tr_b16 v[140:141], v23 offset:0
    ds_read_b64_tr_b16 v[142:143], v23 offset:1024
    ds_read_b64_tr_b16 v[144:145], v24 offset:0
    ds_read_b64_tr_b16 v[146:147], v24 offset:1024
    ds_read_b64_tr_b16 v[148:149], v25 offset:0
    ds_read_b64_tr_b16 v[150:151], v25 offset:1024
    s_waitcnt lgkmcnt(4)
    ds_read_b64_tr_b16 v[152:153], v26 offset:0
    ds_read_b64_tr_b16 v[154:155], v26 offset:1024
    ds_read_b64_tr_b16 v[156:157], v27 offset:0
    ds_read_b64_tr_b16 v[158:159], v27 offset:1024
    s_waitcnt lgkmcnt(0)
    s_barrier
    s_add_u32 m0, s28, 0
    s_add_u32 s37, s3, 0x300000
    buffer_load_dwordx4 v16, s[76:79], s37 offen lds
    s_add_u32 m0, s28, 1024
    s_add_u32 s37, s3, 0x308000
    buffer_load_dwordx4 v17, s[76:79], s37 offen lds
    s_add_u32 m0, s28, 2048
    s_add_u32 s37, s3, 0x310000
    buffer_load_dwordx4 v18, s[76:79], s37 offen lds
    s_add_u32 m0, s28, 3072
    s_add_u32 s37, s3, 0x318000
    buffer_load_dwordx4 v19, s[76:79], s37 offen lds
    s_add_u32 m0, s28, 4096
    s_add_u32 s37, s3, 0x320000
    buffer_load_dwordx4 v16, s[76:79], s37 offen lds
    s_add_u32 m0, s28, 5120
    s_add_u32 s37, s3, 0x328000
    buffer_load_dwordx4 v17, s[76:79], s37 offen lds
    s_add_u32 m0, s28, 6144
    s_add_u32 s37, s3, 0x330000
    buffer_load_dwordx4 v18, s[76:79], s37 offen lds
    s_add_u32 m0, s28, 7168
    s_add_u32 s37, s3, 0x338000
    buffer_load_dwordx4 v19, s[76:79], s37 offen lds
    s_waitcnt vmcnt(16)
    s_barrier
    ds_read_b64_tr_b16 v[160:161], v20 offset:8192
    ds_read_b64_tr_b16 v[162:163], v20 offset:9216
    ds_read_b64_tr_b16 v[164:165], v21 offset:8192
    ds_read_b64_tr_b16 v[166:167], v21 offset:9216
    ds_read_b64_tr_b16 v[168:169], v22 offset:8192
    ds_read_b64_tr_b16 v[170:171], v22 offset:9216
    ds_read_b64_tr_b16 v[172:173], v23 offset:8192
    ds_read_b64_tr_b16 v[174:175], v23 offset:9216
    ds_read_b64_tr_b16 v[176:177], v24 offset:8192
    ds_read_b64_tr_b16 v[178:179], v24 offset:9216
    ds_read_b64_tr_b16 v[180:181], v25 offset:8192
    ds_read_b64_tr_b16 v[182:183], v25 offset:9216
    s_waitcnt lgkmcnt(4)
    ds_read_b64_tr_b16 v[184:185], v26 offset:8192
    ds_read_b64_tr_b16 v[186:187], v26 offset:9216
    ds_read_b64_tr_b16 v[188:189], v27 offset:8192
    ds_read_b64_tr_b16 v[190:191], v27 offset:9216
    s_waitcnt lgkmcnt(0)
    s_barrier
    s_add_u32 m0, s28, 8192
    s_add_u32 s37, s3, 0x0
    buffer_load_dwordx4 v16, s[40:43], s37 offen lds
    s_add_u32 m0, s28, 9216
    s_add_u32 s37, s3, 0x8000
    buffer_load_dwordx4 v17, s[40:43], s37 offen lds
    s_add_u32 m0, s28, 10240
    s_add_u32 s37, s3, 0x10000
    buffer_load_dwordx4 v18, s[40:43], s37 offen lds
    s_add_u32 m0, s28, 11264
    s_add_u32 s37, s3, 0x18000
    buffer_load_dwordx4 v19, s[40:43], s37 offen lds
    s_add_u32 m0, s28, 12288
    s_add_u32 s37, s3, 0x20000
    buffer_load_dwordx4 v16, s[40:43], s37 offen lds
    s_add_u32 m0, s28, 13312
    s_add_u32 s37, s3, 0x28000
    buffer_load_dwordx4 v17, s[40:43], s37 offen lds
    s_add_u32 m0, s28, 14336
    s_add_u32 s37, s3, 0x30000
    buffer_load_dwordx4 v18, s[40:43], s37 offen lds
    s_add_u32 m0, s28, 15360
    s_add_u32 s37, s3, 0x38000
    buffer_load_dwordx4 v19, s[40:43], s37 offen lds
    s_waitcnt vmcnt(16)
    s_barrier
    ds_read_b64_tr_b16 v[192:193], v20 offset:16384
    ds_read_b64_tr_b16 v[194:195], v20 offset:17408
    ds_read_b64_tr_b16 v[196:197], v21 offset:16384
    ds_read_b64_tr_b16 v[198:199], v21 offset:17408
    ds_read_b64_tr_b16 v[200:201], v22 offset:16384
    ds_read_b64_tr_b16 v[202:203], v22 offset:17408
    ds_read_b64_tr_b16 v[204:205], v23 offset:16384
    ds_read_b64_tr_b16 v[206:207], v23 offset:17408
    ds_read_b64_tr_b16 v[208:209], v24 offset:16384
    ds_read_b64_tr_b16 v[210:211], v24 offset:17408
    ds_read_b64_tr_b16 v[212:213], v25 offset:16384
    ds_read_b64_tr_b16 v[214:215], v25 offset:17408
    s_waitcnt lgkmcnt(4)
    ds_read_b64_tr_b16 v[216:217], v26 offset:16384
    ds_read_b64_tr_b16 v[218:219], v26 offset:17408
    ds_read_b64_tr_b16 v[220:221], v27 offset:16384
    ds_read_b64_tr_b16 v[222:223], v27 offset:17408
    s_waitcnt lgkmcnt(0)
    s_barrier
    s_add_u32 m0, s28, 16384
    s_add_u32 s37, s3, 0x100000
    buffer_load_dwordx4 v16, s[40:43], s37 offen lds
    s_add_u32 m0, s28, 17408
    s_add_u32 s37, s3, 0x108000
    buffer_load_dwordx4 v17, s[40:43], s37 offen lds
    s_add_u32 m0, s28, 18432
    s_add_u32 s37, s3, 0x110000
    buffer_load_dwordx4 v18, s[40:43], s37 offen lds
    s_add_u32 m0, s28, 19456
    s_add_u32 s37, s3, 0x118000
    buffer_load_dwordx4 v19, s[40:43], s37 offen lds
    s_add_u32 m0, s28, 20480
    s_add_u32 s37, s3, 0x120000
    buffer_load_dwordx4 v16, s[40:43], s37 offen lds
    s_add_u32 m0, s28, 21504
    s_add_u32 s37, s3, 0x128000
    buffer_load_dwordx4 v17, s[40:43], s37 offen lds
    s_add_u32 m0, s28, 22528
    s_add_u32 s37, s3, 0x130000
    buffer_load_dwordx4 v18, s[40:43], s37 offen lds
    s_add_u32 m0, s28, 23552
    s_add_u32 s37, s3, 0x138000
    buffer_load_dwordx4 v19, s[40:43], s37 offen lds
    s_waitcnt vmcnt(16)
    s_barrier
    ds_read_b64_tr_b16 v[224:225], v20 offset:0
    ds_read_b64_tr_b16 v[226:227], v20 offset:1024
    ds_read_b64_tr_b16 v[228:229], v21 offset:0
    ds_read_b64_tr_b16 v[230:231], v21 offset:1024
    ds_read_b64_tr_b16 v[232:233], v22 offset:0
    ds_read_b64_tr_b16 v[234:235], v22 offset:1024
    ds_read_b64_tr_b16 v[236:237], v23 offset:0
    ds_read_b64_tr_b16 v[238:239], v23 offset:1024
    ds_read_b64_tr_b16 v[240:241], v24 offset:0
    ds_read_b64_tr_b16 v[242:243], v24 offset:1024
    ds_read_b64_tr_b16 v[244:245], v25 offset:0
    ds_read_b64_tr_b16 v[246:247], v25 offset:1024
    s_waitcnt lgkmcnt(4)
    ds_read_b64_tr_b16 v[248:249], v26 offset:0
    ds_read_b64_tr_b16 v[250:251], v26 offset:1024
    ds_read_b64_tr_b16 v[252:253], v27 offset:0
    ds_read_b64_tr_b16 v[254:255], v27 offset:1024
    s_waitcnt lgkmcnt(0)
    s_barrier
    s_add_u32 m0, s28, 0
    s_add_u32 s37, s3, 0x200000
    buffer_load_dwordx4 v16, s[40:43], s37 offen lds
    s_add_u32 m0, s28, 1024
    s_add_u32 s37, s3, 0x208000
    buffer_load_dwordx4 v17, s[40:43], s37 offen lds
    s_add_u32 m0, s28, 2048
    s_add_u32 s37, s3, 0x210000
    buffer_load_dwordx4 v18, s[40:43], s37 offen lds
    s_add_u32 m0, s28, 3072
    s_add_u32 s37, s3, 0x218000
    buffer_load_dwordx4 v19, s[40:43], s37 offen lds
    s_add_u32 m0, s28, 4096
    s_add_u32 s37, s3, 0x220000
    buffer_load_dwordx4 v16, s[40:43], s37 offen lds
    s_add_u32 m0, s28, 5120
    s_add_u32 s37, s3, 0x228000
    buffer_load_dwordx4 v17, s[40:43], s37 offen lds
    s_add_u32 m0, s28, 6144
    s_add_u32 s37, s3, 0x230000
    buffer_load_dwordx4 v18, s[40:43], s37 offen lds
    s_add_u32 m0, s28, 7168
    s_add_u32 s37, s3, 0x238000
    buffer_load_dwordx4 v19, s[40:43], s37 offen lds
    s_waitcnt vmcnt(16)
    s_barrier
    ds_read_b64_tr_b16 a[128:129], v20 offset:8192
    ds_read_b64_tr_b16 a[130:131], v20 offset:9216
    ds_read_b64_tr_b16 a[132:133], v21 offset:8192
    ds_read_b64_tr_b16 a[134:135], v21 offset:9216
    ds_read_b64_tr_b16 a[136:137], v22 offset:8192
    ds_read_b64_tr_b16 a[138:139], v22 offset:9216
    ds_read_b64_tr_b16 a[140:141], v23 offset:8192
    ds_read_b64_tr_b16 a[142:143], v23 offset:9216
    ds_read_b64_tr_b16 a[144:145], v24 offset:8192
    ds_read_b64_tr_b16 a[146:147], v24 offset:9216
    ds_read_b64_tr_b16 a[148:149], v25 offset:8192
    ds_read_b64_tr_b16 a[150:151], v25 offset:9216
    s_waitcnt lgkmcnt(4)
    ds_read_b64_tr_b16 a[152:153], v26 offset:8192
    ds_read_b64_tr_b16 a[154:155], v26 offset:9216
    ds_read_b64_tr_b16 a[156:157], v27 offset:8192
    ds_read_b64_tr_b16 a[158:159], v27 offset:9216
    s_waitcnt lgkmcnt(0)
    s_barrier
    s_add_u32 m0, s28, 8192
    s_add_u32 s37, s3, 0x300000
    buffer_load_dwordx4 v16, s[40:43], s37 offen lds
    s_add_u32 m0, s28, 9216
    s_add_u32 s37, s3, 0x308000
    buffer_load_dwordx4 v17, s[40:43], s37 offen lds
    s_add_u32 m0, s28, 10240
    s_add_u32 s37, s3, 0x310000
    buffer_load_dwordx4 v18, s[40:43], s37 offen lds
    s_add_u32 m0, s28, 11264
    s_add_u32 s37, s3, 0x318000
    buffer_load_dwordx4 v19, s[40:43], s37 offen lds
    s_add_u32 m0, s28, 12288
    s_add_u32 s37, s3, 0x320000
    buffer_load_dwordx4 v16, s[40:43], s37 offen lds
    s_add_u32 m0, s28, 13312
    s_add_u32 s37, s3, 0x328000
    buffer_load_dwordx4 v17, s[40:43], s37 offen lds
    s_add_u32 m0, s28, 14336
    s_add_u32 s37, s3, 0x330000
    buffer_load_dwordx4 v18, s[40:43], s37 offen lds
    s_add_u32 m0, s28, 15360
    s_add_u32 s37, s3, 0x338000
    buffer_load_dwordx4 v19, s[40:43], s37 offen lds
    s_waitcnt vmcnt(16)
    s_barrier
    ds_read_b64_tr_b16 a[160:161], v20 offset:16384
    ds_read_b64_tr_b16 a[162:163], v20 offset:17408
    ds_read_b64_tr_b16 a[164:165], v21 offset:16384
    ds_read_b64_tr_b16 a[166:167], v21 offset:17408
    ds_read_b64_tr_b16 a[168:169], v22 offset:16384
    ds_read_b64_tr_b16 a[170:171], v22 offset:17408
    ds_read_b64_tr_b16 a[172:173], v23 offset:16384
    ds_read_b64_tr_b16 a[174:175], v23 offset:17408
    ds_read_b64_tr_b16 a[176:177], v24 offset:16384
    ds_read_b64_tr_b16 a[178:179], v24 offset:17408
    ds_read_b64_tr_b16 a[180:181], v25 offset:16384
    ds_read_b64_tr_b16 a[182:183], v25 offset:17408
    s_waitcnt lgkmcnt(4)
    ds_read_b64_tr_b16 a[184:185], v26 offset:16384
    ds_read_b64_tr_b16 a[186:187], v26 offset:17408
    ds_read_b64_tr_b16 a[188:189], v27 offset:16384
    ds_read_b64_tr_b16 a[190:191], v27 offset:17408
    s_waitcnt lgkmcnt(0)
    s_barrier
    s_add_u32 m0, s28, 16384
    s_add_u32 s37, s3, 0x0
    buffer_load_dwordx4 v16, s[96:99], s37 offen lds
    s_add_u32 m0, s28, 17408
    s_add_u32 s37, s3, 0x8000
    buffer_load_dwordx4 v17, s[96:99], s37 offen lds
    s_add_u32 m0, s28, 18432
    s_add_u32 s37, s3, 0x10000
    buffer_load_dwordx4 v18, s[96:99], s37 offen lds
    s_add_u32 m0, s28, 19456
    s_add_u32 s37, s3, 0x18000
    buffer_load_dwordx4 v19, s[96:99], s37 offen lds
    s_add_u32 m0, s28, 20480
    s_add_u32 s37, s3, 0x20000
    buffer_load_dwordx4 v16, s[96:99], s37 offen lds
    s_add_u32 m0, s28, 21504
    s_add_u32 s37, s3, 0x28000
    buffer_load_dwordx4 v17, s[96:99], s37 offen lds
    s_add_u32 m0, s28, 22528
    s_add_u32 s37, s3, 0x30000
    buffer_load_dwordx4 v18, s[96:99], s37 offen lds
    s_add_u32 m0, s28, 23552
    s_add_u32 s37, s3, 0x38000
    buffer_load_dwordx4 v19, s[96:99], s37 offen lds
    s_waitcnt vmcnt(16)
    s_barrier
    ds_read_b64_tr_b16 a[192:193], v20 offset:0
    ds_read_b64_tr_b16 a[194:195], v20 offset:1024
    ds_read_b64_tr_b16 a[196:197], v21 offset:0
    ds_read_b64_tr_b16 a[198:199], v21 offset:1024
    ds_read_b64_tr_b16 a[200:201], v22 offset:0
    ds_read_b64_tr_b16 a[202:203], v22 offset:1024
    ds_read_b64_tr_b16 a[204:205], v23 offset:0
    ds_read_b64_tr_b16 a[206:207], v23 offset:1024
    ds_read_b64_tr_b16 a[208:209], v24 offset:0
    ds_read_b64_tr_b16 a[210:211], v24 offset:1024
    ds_read_b64_tr_b16 a[212:213], v25 offset:0
    ds_read_b64_tr_b16 a[214:215], v25 offset:1024
    s_waitcnt lgkmcnt(4)
    ds_read_b64_tr_b16 a[216:217], v26 offset:0
    ds_read_b64_tr_b16 a[218:219], v26 offset:1024
    ds_read_b64_tr_b16 a[220:221], v27 offset:0
    ds_read_b64_tr_b16 a[222:223], v27 offset:1024
    s_waitcnt lgkmcnt(0)
    s_barrier
    s_add_u32 m0, s28, 0
    s_add_u32 s37, s3, 0x100000
    buffer_load_dwordx4 v16, s[96:99], s37 offen lds
    s_add_u32 m0, s28, 1024
    s_add_u32 s37, s3, 0x108000
    buffer_load_dwordx4 v17, s[96:99], s37 offen lds
    s_add_u32 m0, s28, 2048
    s_add_u32 s37, s3, 0x110000
    buffer_load_dwordx4 v18, s[96:99], s37 offen lds
    s_add_u32 m0, s28, 3072
    s_add_u32 s37, s3, 0x118000
    buffer_load_dwordx4 v19, s[96:99], s37 offen lds
    s_add_u32 m0, s28, 4096
    s_add_u32 s37, s3, 0x120000
    buffer_load_dwordx4 v16, s[96:99], s37 offen lds
    s_add_u32 m0, s28, 5120
    s_add_u32 s37, s3, 0x128000
    buffer_load_dwordx4 v17, s[96:99], s37 offen lds
    s_add_u32 m0, s28, 6144
    s_add_u32 s37, s3, 0x130000
    buffer_load_dwordx4 v18, s[96:99], s37 offen lds
    s_add_u32 m0, s28, 7168
    s_add_u32 s37, s3, 0x138000
    buffer_load_dwordx4 v19, s[96:99], s37 offen lds
    s_waitcnt vmcnt(16)
    s_barrier
    ds_read_b64_tr_b16 a[224:225], v20 offset:8192
    ds_read_b64_tr_b16 a[226:227], v20 offset:9216
    ds_read_b64_tr_b16 a[228:229], v21 offset:8192
    ds_read_b64_tr_b16 a[230:231], v21 offset:9216
    ds_read_b64_tr_b16 a[232:233], v22 offset:8192
    ds_read_b64_tr_b16 a[234:235], v22 offset:9216
    ds_read_b64_tr_b16 a[236:237], v23 offset:8192
    ds_read_b64_tr_b16 a[238:239], v23 offset:9216
    ds_read_b64_tr_b16 a[240:241], v24 offset:8192
    ds_read_b64_tr_b16 a[242:243], v24 offset:9216
    ds_read_b64_tr_b16 a[244:245], v25 offset:8192
    ds_read_b64_tr_b16 a[246:247], v25 offset:9216
    s_waitcnt lgkmcnt(4)
    ds_read_b64_tr_b16 a[248:249], v26 offset:8192
    ds_read_b64_tr_b16 a[250:251], v26 offset:9216
    ds_read_b64_tr_b16 a[252:253], v27 offset:8192
    ds_read_b64_tr_b16 a[254:255], v27 offset:9216
    s_waitcnt lgkmcnt(0)
    s_barrier
    s_add_u32 m0, s28, 8192
    s_add_u32 s37, s3, 0x200000
    buffer_load_dwordx4 v16, s[96:99], s37 offen lds
    s_add_u32 m0, s28, 9216
    s_add_u32 s37, s3, 0x208000
    buffer_load_dwordx4 v17, s[96:99], s37 offen lds
    s_add_u32 m0, s28, 10240
    s_add_u32 s37, s3, 0x210000
    buffer_load_dwordx4 v18, s[96:99], s37 offen lds
    s_add_u32 m0, s28, 11264
    s_add_u32 s37, s3, 0x218000
    buffer_load_dwordx4 v19, s[96:99], s37 offen lds
    s_add_u32 m0, s28, 12288
    s_add_u32 s37, s3, 0x220000
    buffer_load_dwordx4 v16, s[96:99], s37 offen lds
    s_add_u32 m0, s28, 13312
    s_add_u32 s37, s3, 0x228000
    buffer_load_dwordx4 v17, s[96:99], s37 offen lds
    s_add_u32 m0, s28, 14336
    s_add_u32 s37, s3, 0x230000
    buffer_load_dwordx4 v18, s[96:99], s37 offen lds
    s_add_u32 m0, s28, 15360
    s_add_u32 s37, s3, 0x238000
    buffer_load_dwordx4 v19, s[96:99], s37 offen lds
    s_waitcnt vmcnt(16)
    s_barrier
    ds_read_b64_tr_b16 a[0:1], v20 offset:16384
    ds_read_b64_tr_b16 a[2:3], v20 offset:17408
    ds_read_b64_tr_b16 a[4:5], v21 offset:16384
    ds_read_b64_tr_b16 a[6:7], v21 offset:17408
    ds_read_b64_tr_b16 a[8:9], v22 offset:16384
    ds_read_b64_tr_b16 a[10:11], v22 offset:17408
    ds_read_b64_tr_b16 a[12:13], v23 offset:16384
    ds_read_b64_tr_b16 a[14:15], v23 offset:17408
    ds_read_b64_tr_b16 a[16:17], v24 offset:16384
    ds_read_b64_tr_b16 a[18:19], v24 offset:17408
    ds_read_b64_tr_b16 a[20:21], v25 offset:16384
    ds_read_b64_tr_b16 a[22:23], v25 offset:17408
    s_waitcnt lgkmcnt(4)
    ds_read_b64_tr_b16 a[24:25], v26 offset:16384
    ds_read_b64_tr_b16 a[26:27], v26 offset:17408
    ds_read_b64_tr_b16 a[28:29], v27 offset:16384
    ds_read_b64_tr_b16 a[30:31], v27 offset:17408
    s_waitcnt lgkmcnt(0)
    s_barrier
    s_add_u32 m0, s28, 16384
    s_add_u32 s37, s3, 0x300000
    buffer_load_dwordx4 v16, s[96:99], s37 offen lds
    s_add_u32 m0, s28, 17408
    s_add_u32 s37, s3, 0x308000
    buffer_load_dwordx4 v17, s[96:99], s37 offen lds
    s_add_u32 m0, s28, 18432
    s_add_u32 s37, s3, 0x310000
    buffer_load_dwordx4 v18, s[96:99], s37 offen lds
    s_add_u32 m0, s28, 19456
    s_add_u32 s37, s3, 0x318000
    buffer_load_dwordx4 v19, s[96:99], s37 offen lds
    s_add_u32 m0, s28, 20480
    s_add_u32 s37, s3, 0x320000
    buffer_load_dwordx4 v16, s[96:99], s37 offen lds
    s_add_u32 m0, s28, 21504
    s_add_u32 s37, s3, 0x328000
    buffer_load_dwordx4 v17, s[96:99], s37 offen lds
    s_add_u32 m0, s28, 22528
    s_add_u32 s37, s3, 0x330000
    buffer_load_dwordx4 v18, s[96:99], s37 offen lds
    s_add_u32 m0, s28, 23552
    s_add_u32 s37, s3, 0x338000
    buffer_load_dwordx4 v19, s[96:99], s37 offen lds
    s_waitcnt vmcnt(16)
    s_barrier
    ds_read_b64_tr_b16 a[32:33], v20 offset:0
    ds_read_b64_tr_b16 a[34:35], v20 offset:1024
    ds_read_b64_tr_b16 a[36:37], v21 offset:0
    ds_read_b64_tr_b16 a[38:39], v21 offset:1024
    ds_read_b64_tr_b16 a[40:41], v22 offset:0
    ds_read_b64_tr_b16 a[42:43], v22 offset:1024
    ds_read_b64_tr_b16 a[44:45], v23 offset:0
    ds_read_b64_tr_b16 a[46:47], v23 offset:1024
    ds_read_b64_tr_b16 a[48:49], v24 offset:0
    ds_read_b64_tr_b16 a[50:51], v24 offset:1024
    ds_read_b64_tr_b16 a[52:53], v25 offset:0
    ds_read_b64_tr_b16 a[54:55], v25 offset:1024
    s_waitcnt lgkmcnt(4)
    ds_read_b64_tr_b16 a[56:57], v26 offset:0
    ds_read_b64_tr_b16 a[58:59], v26 offset:1024
    ds_read_b64_tr_b16 a[60:61], v27 offset:0
    ds_read_b64_tr_b16 a[62:63], v27 offset:1024
    s_waitcnt lgkmcnt(0)
    s_barrier
    s_waitcnt vmcnt(8)
    s_barrier
    ds_read_b64_tr_b16 a[64:65], v20 offset:8192
    ds_read_b64_tr_b16 a[66:67], v20 offset:9216
    ds_read_b64_tr_b16 a[68:69], v21 offset:8192
    ds_read_b64_tr_b16 a[70:71], v21 offset:9216
    ds_read_b64_tr_b16 a[72:73], v22 offset:8192
    ds_read_b64_tr_b16 a[74:75], v22 offset:9216
    ds_read_b64_tr_b16 a[76:77], v23 offset:8192
    ds_read_b64_tr_b16 a[78:79], v23 offset:9216
    ds_read_b64_tr_b16 a[80:81], v24 offset:8192
    ds_read_b64_tr_b16 a[82:83], v24 offset:9216
    ds_read_b64_tr_b16 a[84:85], v25 offset:8192
    ds_read_b64_tr_b16 a[86:87], v25 offset:9216
    s_waitcnt lgkmcnt(4)
    ds_read_b64_tr_b16 a[88:89], v26 offset:8192
    ds_read_b64_tr_b16 a[90:91], v26 offset:9216
    ds_read_b64_tr_b16 a[92:93], v27 offset:8192
    ds_read_b64_tr_b16 a[94:95], v27 offset:9216
    s_waitcnt lgkmcnt(0)
    s_barrier
    s_waitcnt vmcnt(0)
    s_barrier
    ds_read_b64_tr_b16 a[96:97], v20 offset:16384
    ds_read_b64_tr_b16 a[98:99], v20 offset:17408
    ds_read_b64_tr_b16 a[100:101], v21 offset:16384
    ds_read_b64_tr_b16 a[102:103], v21 offset:17408
    ds_read_b64_tr_b16 a[104:105], v22 offset:16384
    ds_read_b64_tr_b16 a[106:107], v22 offset:17408
    ds_read_b64_tr_b16 a[108:109], v23 offset:16384
    ds_read_b64_tr_b16 a[110:111], v23 offset:17408
    ds_read_b64_tr_b16 a[112:113], v24 offset:16384
    ds_read_b64_tr_b16 a[114:115], v24 offset:17408
    ds_read_b64_tr_b16 a[116:117], v25 offset:16384
    ds_read_b64_tr_b16 a[118:119], v25 offset:17408
    s_waitcnt lgkmcnt(4)
    ds_read_b64_tr_b16 a[120:121], v26 offset:16384
    ds_read_b64_tr_b16 a[122:123], v26 offset:17408
    ds_read_b64_tr_b16 a[124:125], v27 offset:16384
    ds_read_b64_tr_b16 a[126:127], v27 offset:17408
    s_waitcnt lgkmcnt(0)
    s_barrier
    v_lshrrev_b32 v15, 2, v1
    v_and_b32 v15, 127, v15
L_WHS:
    buffer_load_dword v14, v15, s[16:19], 0 offen sc1
    s_add_u32 s32, s32, 1
    s_cmp_gt_u32 s32, 200000
    s_cbranch_scc1 L_WHS_done
    s_waitcnt vmcnt(0)
    v_cmp_eq_u32 vcc, 0, v14
    s_cbranch_vccnz L_WHS
L_WHS_done:
    s_lshr_b32 s36, s21, 1
    s_lshl_b32 s36, s36, 14
    s_xor_b32 s37, s36, 16384
    v_add_u32 v80, s36, v5
    v_add_u32 v81, s37, v5
    v_add_u32 v82, s36, v6
    v_add_u32 v83, s37, v6
    s_mov_b32 s25, 0x40000000
L_P1:
    s_waitcnt vmcnt(6)
    v_mov_b32 v16, 0
    v_mov_b32 v17, 0
    v_dot2_f32_bf16 v16, v96, s4, v16
    v_dot2_f32_bf16 v17, v96, v96, v17
    v_dot2_f32_bf16 v16, v97, s4, v16
    v_dot2_f32_bf16 v17, v97, v97, v17
    v_dot2_f32_bf16 v16, v98, s4, v16
    v_dot2_f32_bf16 v17, v98, v98, v17
    v_dot2_f32_bf16 v16, v99, s4, v16
    v_dot2_f32_bf16 v17, v99, v99, v17
    v_dot2_f32_bf16 v16, v100, s4, v16
    v_dot2_f32_bf16 v17, v100, v100, v17
    v_dot2_f32_bf16 v16, v101, s4, v16
    v_dot2_f32_bf16 v17, v101, v101, v17
    v_dot2_f32_bf16 v16, v102, s4, v16
    v_dot2_f32_bf16 v17, v102, v102, v17
    v_dot2_f32_bf16 v16, v103, s4, v16
    v_dot2_f32_bf16 v17, v103, v103, v17
    v_dot2_f32_bf16 v16, v104, s4, v16
    v_dot2_f32_bf16 v17, v104, v104, v17
    v_dot2_f32_bf16 v16, v105, s4, v16
    v_dot2_f32_bf16 v17, v105, v105, v17
    v_dot2_f32_bf16 v16, v106, s4, v16
    v_dot2_f32_bf16 v17, v106, v106, v17
    v_dot2_f32_bf16 v16, v107, s4, v16
    v_dot2_f32_bf16 v17, v107, v107, v17
    v_dot2_f32_bf16 v16, v108, s4, v16
    v_dot2_f32_bf16 v17, v108, v108, v17
    v_dot2_f32_bf16 v16, v109, s4, v16
    v_dot2_f32_bf16 v17, v109, v109, v17
    v_dot2_f32_bf16 v16, v110, s4, v16
    v_dot2_f32_bf16 v17, v110, v110, v17
    v_dot2_f32_bf16 v16, v111, s4, v16
    v_dot2_f32_bf16 v17, v111, v111, v17
    v_dot2_f32_bf16 v16, v112, s4, v16
    v_dot2_f32_bf16 v17, v112, v112, v17
    v_dot2_f32_bf16 v16, v113, s4, v16
    v_dot2_f32_bf16 v17, v113, v113, v17
    v_dot2_f32_bf16 v16, v114, s4, v16
    v_dot2_f32_bf16 v17, v114, v114, v17
    v_dot2_f32_bf16 v16, v115, s4, v16
    v_dot2_f32_bf16 v17, v115, v115, v17
    v_dot2_f32_bf16 v16, v116, s4, v16
    v_dot2_f32_bf16 v17, v116, v116, v17
    v_dot2_f32_bf16 v16, v117, s4, v16
    v_dot2_f32_bf16 v17, v117, v117, v17
    v_dot2_f32_bf16 v16, v118, s4, v16
    v_dot2_f32_bf16 v17, v118, v118, v17
    v_dot2_f32_bf16 v16, v119, s4, v16
    v_dot2_f32_bf16 v17, v119, v119, v17
    v_dot2_f32_bf16 v16, v120, s4, v16
    v_dot2_f32_bf16 v17, v120, v120, v17
    v_dot2_f32_bf16 v16, v121, s4, v16
    v_dot2_f32_bf16 v17, v121, v121, v17
    v_dot2_f32_bf16 v16, v122, s4, v16
    v_dot2_f32_bf16 v17, v122, v122, v17
    v_dot2_f32_bf16 v16, v123, s4, v16
    v_dot2_f32_bf16 v17, v123, v123, v17
    v_dot2_f32_bf16 v16, v124, s4, v16
    v_dot2_f32_bf16 v17, v124, v124, v17
    v_dot2_f32_bf16 v16, v125, s4, v16
    v_dot2_f32_bf16 v17, v125, v125, v17
    v_dot2_f32_bf16 v16, v126, s4, v16
    v_dot2_f32_bf16 v17, v126, v126, v17
    v_dot2_f32_bf16 v16, v127, s4, v16
    v_dot2_f32_bf16 v17, v127, v127, v17
    s_nop 3
    v_add_f32_dpp v16, v16, v16 quad_perm:[1,0,3,2] row_mask:0xf bank_mask:0xf
    v_add_f32_dpp v17, v17, v17 quad_perm:[1,0,3,2] row_mask:0xf bank_mask:0xf
    s_nop 0
    v_add_f32_dpp v16, v16, v16 quad_perm:[2,3,0,1] row_mask:0xf bank_mask:0xf
    v_add_f32_dpp v17, v17, v17 quad_perm:[2,3,0,1] row_mask:0xf bank_mask:0xf
    s_nop 0
    v_add_f32_dpp v16, v16, v16 row_half_mirror row_mask:0xf bank_mask:0xf
    v_add_f32_dpp v17, v17, v17 row_half_mirror row_mask:0xf bank_mask:0xf
    v_mul_f32 v16, 0x3b000000, v16
    v_mul_f32 v17, 0x3b000000, v17
    v_fma_f32 v17, -v16, v16, v17
    v_max_f32 v17, 0, v17
    v_cvt_pk_bf16_f32 v14, v16, v17
    v_lshlrev_b32 v16, 16, v14
    v_and_b32 v17, 0xffff0000, v14
    v_add_f32 v17, 0x3727c5ac, v17
    v_cvt_pk_bf16_f32 v14, v17, v17
    v_lshlrev_b32 v17, 16, v14
    v_sqrt_f32 v17, v17
    s_nop 0
    v_cvt_pk_bf16_f32 v14, v17, v17
    v_lshlrev_b32 v17, 16, v14
    v_rcp_f32 v17, v17
    v_lshlrev_b32 v18, 16, v96
    v_and_b32 v19, 0xffff0000, v96
    v_sub_f32 v18, v18, v16
    v_sub_f32 v19, v19, v16
    v_cvt_pk_bf16_f32 v96, v18, v19
    v_lshlrev_b32 v18, 16, v96
    v_and_b32 v19, 0xffff0000, v96
    v_mul_f32 v18, v18, v17
    v_mul_f32 v19, v19, v17
    v_cvt_pk_bf16_f32 v96, v18, v19
    v_lshlrev_b32 v18, 16, v97
    v_and_b32 v19, 0xffff0000, v97
    v_sub_f32 v18, v18, v16
    v_sub_f32 v19, v19, v16
    v_cvt_pk_bf16_f32 v97, v18, v19
    v_lshlrev_b32 v18, 16, v97
    v_and_b32 v19, 0xffff0000, v97
    v_mul_f32 v18, v18, v17
    v_mul_f32 v19, v19, v17
    v_cvt_pk_bf16_f32 v97, v18, v19
    v_lshlrev_b32 v18, 16, v98
    v_and_b32 v19, 0xffff0000, v98
    v_sub_f32 v18, v18, v16
    v_sub_f32 v19, v19, v16
    v_cvt_pk_bf16_f32 v98, v18, v19
    v_lshlrev_b32 v18, 16, v98
    v_and_b32 v19, 0xffff0000, v98
    v_mul_f32 v18, v18, v17
    v_mul_f32 v19, v19, v17
    v_cvt_pk_bf16_f32 v98, v18, v19
    v_lshlrev_b32 v18, 16, v99
    v_and_b32 v19, 0xffff0000, v99
    v_sub_f32 v18, v18, v16
    v_sub_f32 v19, v19, v16
    v_cvt_pk_bf16_f32 v99, v18, v19
    v_lshlrev_b32 v18, 16, v99
    v_and_b32 v19, 0xffff0000, v99
    v_mul_f32 v18, v18, v17
    v_mul_f32 v19, v19, v17
    v_cvt_pk_bf16_f32 v99, v18, v19
    ds_write_b128 v4, v[96:99] offset:0
    v_lshlrev_b32 v18, 16, v100
    v_and_b32 v19, 0xffff0000, v100
    v_sub_f32 v18, v18, v16
    v_sub_f32 v19, v19, v16
    v_cvt_pk_bf16_f32 v100, v18, v19
    v_lshlrev_b32 v18, 16, v100
    v_and_b32 v19, 0xffff0000, v100
    v_mul_f32 v18, v18, v17
    v_mul_f32 v19, v19, v17
    v_cvt_pk_bf16_f32 v100, v18, v19
    v_lshlrev_b32 v18, 16, v101
    v_and_b32 v19, 0xffff0000, v101
    v_sub_f32 v18, v18, v16
    v_sub_f32 v19, v19, v16
    v_cvt_pk_bf16_f32 v101, v18, v19
    v_lshlrev_b32 v18, 16, v101
    v_and_b32 v19, 0xffff0000, v101
    v_mul_f32 v18, v18, v17
    v_mul_f32 v19, v19, v17
    v_cvt_pk_bf16_f32 v101, v18, v19
    v_lshlrev_b32 v18, 16, v102
    v_and_b32 v19, 0xffff0000, v102
    v_sub_f32 v18, v18, v16
    v_sub_f32 v19, v19, v16
    v_cvt_pk_bf16_f32 v102, v18, v19
    v_lshlrev_b32 v18, 16, v102
    v_and_b32 v19, 0xffff0000, v102
    v_mul_f32 v18, v18, v17
    v_mul_f32 v19, v19, v17
    v_cvt_pk_bf16_f32 v102, v18, v19
    v_lshlrev_b32 v18, 16, v103
    v_and_b32 v19, 0xffff0000, v103
    v_sub_f32 v18, v18, v16
    v_sub_f32 v19, v19, v16
    v_cvt_pk_bf16_f32 v103, v18, v19
    v_lshlrev_b32 v18, 16, v103
    v_and_b32 v19, 0xffff0000, v103
    v_mul_f32 v18, v18, v17
    v_mul_f32 v19, v19, v17
    v_cvt_pk_bf16_f32 v103, v18, v19
    ds_write_b128 v4, v[100:103] offset:2048
    v_lshlrev_b32 v18, 16, v104
    v_and_b32 v19, 0xffff0000, v104
    v_sub_f32 v18, v18, v16
    v_sub_f32 v19, v19, v16
    v_cvt_pk_bf16_f32 v104, v18, v19
    v_lshlrev_b32 v18, 16, v104
    v_and_b32 v19, 0xffff0000, v104
    v_mul_f32 v18, v18, v17
    v_mul_f32 v19, v19, v17
    v_cvt_pk_bf16_f32 v104, v18, v19
    v_lshlrev_b32 v18, 16, v105
    v_and_b32 v19, 0xffff0000, v105
    v_sub_f32 v18, v18, v16
    v_sub_f32 v19, v19, v16
    v_cvt_pk_bf16_f32 v105, v18, v19
    v_lshlrev_b32 v18, 16, v105
    v_and_b32 v19, 0xffff0000, v105
    v_mul_f32 v18, v18, v17
    v_mul_f32 v19, v19, v17
    v_cvt_pk_bf16_f32 v105, v18, v19
    v_lshlrev_b32 v18, 16, v106
    v_and_b32 v19, 0xffff0000, v106
    v_sub_f32 v18, v18, v16
    v_sub_f32 v19, v19, v16
    v_cvt_pk_bf16_f32 v106, v18, v19
    v_lshlrev_b32 v18, 16, v106
    v_and_b32 v19, 0xffff0000, v106
    v_mul_f32 v18, v18, v17
    v_mul_f32 v19, v19, v17
    v_cvt_pk_bf16_f32 v106, v18, v19
    v_lshlrev_b32 v18, 16, v107
    v_and_b32 v19, 0xffff0000, v107
    v_sub_f32 v18, v18, v16
    v_sub_f32 v19, v19, v16
    v_cvt_pk_bf16_f32 v107, v18, v19
    v_lshlrev_b32 v18, 16, v107
    v_and_b32 v19, 0xffff0000, v107
    v_mul_f32 v18, v18, v17
    v_mul_f32 v19, v19, v17
    v_cvt_pk_bf16_f32 v107, v18, v19
    ds_write_b128 v4, v[104:107] offset:4096
    v_lshlrev_b32 v18, 16, v108
    v_and_b32 v19, 0xffff0000, v108
    v_sub_f32 v18, v18, v16
    v_sub_f32 v19, v19, v16
    v_cvt_pk_bf16_f32 v108, v18, v19
    v_lshlrev_b32 v18, 16, v108
    v_and_b32 v19, 0xffff0000, v108
    v_mul_f32 v18, v18, v17
    v_mul_f32 v19, v19, v17
    v_cvt_pk_bf16_f32 v108, v18, v19
    v_lshlrev_b32 v18, 16, v109
    v_and_b32 v19, 0xffff0000, v109
    v_sub_f32 v18, v18, v16
    v_sub_f32 v19, v19, v16
    v_cvt_pk_bf16_f32 v109, v18, v19
    v_lshlrev_b32 v18, 16, v109
    v_and_b32 v19, 0xffff0000, v109
    v_mul_f32 v18, v18, v17
    v_mul_f32 v19, v19, v17
    v_cvt_pk_bf16_f32 v109, v18, v19
    v_lshlrev_b32 v18, 16, v110
    v_and_b32 v19, 0xffff0000, v110
    v_sub_f32 v18, v18, v16
    v_sub_f32 v19, v19, v16
    v_cvt_pk_bf16_f32 v110, v18, v19
    v_lshlrev_b32 v18, 16, v110
    v_and_b32 v19, 0xffff0000, v110
    v_mul_f32 v18, v18, v17
    v_mul_f32 v19, v19, v17
    v_cvt_pk_bf16_f32 v110, v18, v19
    v_lshlrev_b32 v18, 16, v111
    v_and_b32 v19, 0xffff0000, v111
    v_sub_f32 v18, v18, v16
    v_sub_f32 v19, v19, v16
    v_cvt_pk_bf16_f32 v111, v18, v19
    v_lshlrev_b32 v18, 16, v111
    v_and_b32 v19, 0xffff0000, v111
    v_mul_f32 v18, v18, v17
    v_mul_f32 v19, v19, v17
    v_cvt_pk_bf16_f32 v111, v18, v19
    ds_write_b128 v4, v[108:111] offset:6144
    v_lshlrev_b32 v18, 16, v112
    v_and_b32 v19, 0xffff0000, v112
    v_sub_f32 v18, v18, v16
    v_sub_f32 v19, v19, v16
    v_cvt_pk_bf16_f32 v112, v18, v19
    v_lshlrev_b32 v18, 16, v112
    v_and_b32 v19, 0xffff0000, v112
    v_mul_f32 v18, v18, v17
    v_mul_f32 v19, v19, v17
    v_cvt_pk_bf16_f32 v112, v18, v19
    v_lshlrev_b32 v18, 16, v113
    v_and_b32 v19, 0xffff0000, v113
    v_sub_f32 v18, v18, v16
    v_sub_f32 v19, v19, v16
    v_cvt_pk_bf16_f32 v113, v18, v19
    v_lshlrev_b32 v18, 16, v113
    v_and_b32 v19, 0xffff0000, v113
    v_mul_f32 v18, v18, v17
    v_mul_f32 v19, v19, v17
    v_cvt_pk_bf16_f32 v113, v18, v19
    v_lshlrev_b32 v18, 16, v114
    v_and_b32 v19, 0xffff0000, v114
    v_sub_f32 v18, v18, v16
    v_sub_f32 v19, v19, v16
    v_cvt_pk_bf16_f32 v114, v18, v19
    v_lshlrev_b32 v18, 16, v114
    v_and_b32 v19, 0xffff0000, v114
    v_mul_f32 v18, v18, v17
    v_mul_f32 v19, v19, v17
    v_cvt_pk_bf16_f32 v114, v18, v19
    v_lshlrev_b32 v18, 16, v115
    v_and_b32 v19, 0xffff0000, v115
    v_sub_f32 v18, v18, v16
    v_sub_f32 v19, v19, v16
    v_cvt_pk_bf16_f32 v115, v18, v19
    v_lshlrev_b32 v18, 16, v115
    v_and_b32 v19, 0xffff0000, v115
    v_mul_f32 v18, v18, v17
    v_mul_f32 v19, v19, v17
    v_cvt_pk_bf16_f32 v115, v18, v19
    ds_write_b128 v4, v[112:115] offset:8192
    v_lshlrev_b32 v18, 16, v116
    v_and_b32 v19, 0xffff0000, v116
    v_sub_f32 v18, v18, v16
    v_sub_f32 v19, v19, v16
    v_cvt_pk_bf16_f32 v116, v18, v19
    v_lshlrev_b32 v18, 16, v116
    v_and_b32 v19, 0xffff0000, v116
    v_mul_f32 v18, v18, v17
    v_mul_f32 v19, v19, v17
    v_cvt_pk_bf16_f32 v116, v18, v19
    v_lshlrev_b32 v18, 16, v117
    v_and_b32 v19, 0xffff0000, v117
    v_sub_f32 v18, v18, v16
    v_sub_f32 v19, v19, v16
    v_cvt_pk_bf16_f32 v117, v18, v19
    v_lshlrev_b32 v18, 16, v117
    v_and_b32 v19, 0xffff0000, v117
    v_mul_f32 v18, v18, v17
    v_mul_f32 v19, v19, v17
    v_cvt_pk_bf16_f32 v117, v18, v19
    v_lshlrev_b32 v18, 16, v118
    v_and_b32 v19, 0xffff0000, v118
    v_sub_f32 v18, v18, v16
    v_sub_f32 v19, v19, v16
    v_cvt_pk_bf16_f32 v118, v18, v19
    v_lshlrev_b32 v18, 16, v118
    v_and_b32 v19, 0xffff0000, v118
    v_mul_f32 v18, v18, v17
    v_mul_f32 v19, v19, v17
    v_cvt_pk_bf16_f32 v118, v18, v19
    v_lshlrev_b32 v18, 16, v119
    v_and_b32 v19, 0xffff0000, v119
    v_sub_f32 v18, v18, v16
    v_sub_f32 v19, v19, v16
    v_cvt_pk_bf16_f32 v119, v18, v19
    v_lshlrev_b32 v18, 16, v119
    v_and_b32 v19, 0xffff0000, v119
    v_mul_f32 v18, v18, v17
    v_mul_f32 v19, v19, v17
    v_cvt_pk_bf16_f32 v119, v18, v19
    ds_write_b128 v4, v[116:119] offset:10240
    v_lshlrev_b32 v18, 16, v120
    v_and_b32 v19, 0xffff0000, v120
    v_sub_f32 v18, v18, v16
    v_sub_f32 v19, v19, v16
    v_cvt_pk_bf16_f32 v120, v18, v19
    v_lshlrev_b32 v18, 16, v120
    v_and_b32 v19, 0xffff0000, v120
    v_mul_f32 v18, v18, v17
    v_mul_f32 v19, v19, v17
    v_cvt_pk_bf16_f32 v120, v18, v19
    v_lshlrev_b32 v18, 16, v121
    v_and_b32 v19, 0xffff0000, v121
    v_sub_f32 v18, v18, v16
    v_sub_f32 v19, v19, v16
    v_cvt_pk_bf16_f32 v121, v18, v19
    v_lshlrev_b32 v18, 16, v121
    v_and_b32 v19, 0xffff0000, v121
    v_mul_f32 v18, v18, v17
    v_mul_f32 v19, v19, v17
    v_cvt_pk_bf16_f32 v121, v18, v19
    v_lshlrev_b32 v18, 16, v122
    v_and_b32 v19, 0xffff0000, v122
    v_sub_f32 v18, v18, v16
    v_sub_f32 v19, v19, v16
    v_cvt_pk_bf16_f32 v122, v18, v19
    v_lshlrev_b32 v18, 16, v122
    v_and_b32 v19, 0xffff0000, v122
    v_mul_f32 v18, v18, v17
    v_mul_f32 v19, v19, v17
    v_cvt_pk_bf16_f32 v122, v18, v19
    v_lshlrev_b32 v18, 16, v123
    v_and_b32 v19, 0xffff0000, v123
    v_sub_f32 v18, v18, v16
    v_sub_f32 v19, v19, v16
    v_cvt_pk_bf16_f32 v123, v18, v19
    v_lshlrev_b32 v18, 16, v123
    v_and_b32 v19, 0xffff0000, v123
    v_mul_f32 v18, v18, v17
    v_mul_f32 v19, v19, v17
    v_cvt_pk_bf16_f32 v123, v18, v19
    ds_write_b128 v4, v[120:123] offset:12288
    v_lshlrev_b32 v18, 16, v124
    v_and_b32 v19, 0xffff0000, v124
    v_sub_f32 v18, v18, v16
    v_sub_f32 v19, v19, v16
    v_cvt_pk_bf16_f32 v124, v18, v19
    v_lshlrev_b32 v18, 16, v124
    v_and_b32 v19, 0xffff0000, v124
    v_mul_f32 v18, v18, v17
    v_mul_f32 v19, v19, v17
    v_cvt_pk_bf16_f32 v124, v18, v19
    v_lshlrev_b32 v18, 16, v125
    v_and_b32 v19, 0xffff0000, v125
    v_sub_f32 v18, v18, v16
    v_sub_f32 v19, v19, v16
    v_cvt_pk_bf16_f32 v125, v18, v19
    v_lshlrev_b32 v18, 16, v125
    v_and_b32 v19, 0xffff0000, v125
    v_mul_f32 v18, v18, v17
    v_mul_f32 v19, v19, v17
    v_cvt_pk_bf16_f32 v125, v18, v19
    v_lshlrev_b32 v18, 16, v126
    v_and_b32 v19, 0xffff0000, v126
    v_sub_f32 v18, v18, v16
    v_sub_f32 v19, v19, v16
    v_cvt_pk_bf16_f32 v126, v18, v19
    v_lshlrev_b32 v18, 16, v126
    v_and_b32 v19, 0xffff0000, v126
    v_mul_f32 v18, v18, v17
    v_mul_f32 v19, v19, v17
    v_cvt_pk_bf16_f32 v126, v18, v19
    v_lshlrev_b32 v18, 16, v127
    v_and_b32 v19, 0xffff0000, v127
    v_sub_f32 v18, v18, v16
    v_sub_f32 v19, v19, v16
    v_cvt_pk_bf16_f32 v127, v18, v19
    v_lshlrev_b32 v18, 16, v127
    v_and_b32 v19, 0xffff0000, v127
    v_mul_f32 v18, v18, v17
    v_mul_f32 v19, v19, v17
    v_cvt_pk_bf16_f32 v127, v18, v19
    ds_write_b128 v4, v[124:127] offset:14336
    s_waitcnt vmcnt(0) lgkmcnt(0)
    s_barrier
    v_cmp_ne_u32 vcc, 0, v0
    v_mov_b32 v15, 0x40000000
    v_mov_b32 v14, 1
    v_cndmask_b32 v15, v0, v15, vcc
    buffer_store_dword v14, v15, s[8:11], s25 offen sc1
    s_add_u32 s24, s23, 7
    s_min_u32 s24, s24, 63
    s_lshl_b32 s36, s24, 15
    buffer_load_dwordx4 v[96:99], v3, s[12:15], s36 offen offset:0
    buffer_load_dwordx4 v[100:103], v3, s[12:15], s36 offen offset:128
    buffer_load_dwordx4 v[104:107], v3, s[12:15], s36 offen offset:256
    buffer_load_dwordx4 v[108:111], v3, s[12:15], s36 offen offset:384
    buffer_load_dwordx4 v[112:115], v3, s[12:15], s36 offen offset:512
    buffer_load_dwordx4 v[116:119], v3, s[12:15], s36 offen offset:640
    buffer_load_dwordx4 v[120:123], v3, s[12:15], s36 offen offset:768
    buffer_load_dwordx4 v[124:127], v3, s[12:15], s36 offen offset:896
    ds_read_b128 v[64:67], v80 offset:0
    ds_read_b128 v[68:71], v81 offset:0
    ds_read_b128 v[72:75], v82 offset:1024
    ds_read_b128 v[76:79], v83 offset:1024
    s_waitcnt lgkmcnt(2)
    v_mfma_f32_16x16x32_bf16 v[32:35], a[128:131], v[64:67], 0
    v_mfma_f32_16x16x32_bf16 v[36:39], a[128:131], v[68:71], 0
    v_mfma_f32_16x16x32_bf16 v[40:43], a[132:135], v[64:67], 0
    v_mfma_f32_16x16x32_bf16 v[44:47], a[132:135], v[68:71], 0
    v_mfma_f32_16x16x32_bf16 v[48:51], v[64:67], v[128:131], 0
    v_mfma_f32_16x16x32_bf16 v[56:59], v[68:71], v[128:131], 0
    v_mfma_f32_16x16x32_bf16 v[52:55], v[64:67], v[132:135], 0
    v_mfma_f32_16x16x32_bf16 v[60:63], v[68:71], v[132:135], 0
    v_mfma_f32_16x16x32_bf16 v[16:19], a[0:3], v[64:67], 0
    v_mfma_f32_16x16x32_bf16 v[20:23], a[0:3], v[68:71], 0
    v_mfma_f32_16x16x32_bf16 v[24:27], a[4:7], v[64:67], 0
    v_mfma_f32_16x16x32_bf16 v[28:31], a[4:7], v[68:71], 0
    ds_read_b128 v[64:67], v80 offset:2048
    ds_read_b128 v[68:71], v81 offset:2048
    s_waitcnt lgkmcnt(2)
    v_mfma_f32_16x16x32_bf16 v[32:35], a[136:139], v[72:75], v[32:35]
    v_mfma_f32_16x16x32_bf16 v[36:39], a[136:139], v[76:79], v[36:39]
    v_mfma_f32_16x16x32_bf16 v[40:43], a[140:143], v[72:75], v[40:43]
    v_mfma_f32_16x16x32_bf16 v[44:47], a[140:143], v[76:79], v[44:47]
    v_mfma_f32_16x16x32_bf16 v[48:51], v[72:75], v[136:139], v[48:51]
    v_mfma_f32_16x16x32_bf16 v[56:59], v[76:79], v[136:139], v[56:59]
    v_mfma_f32_16x16x32_bf16 v[52:55], v[72:75], v[140:143], v[52:55]
    v_mfma_f32_16x16x32_bf16 v[60:63], v[76:79], v[140:143], v[60:63]
    v_mfma_f32_16x16x32_bf16 v[16:19], a[8:11], v[72:75], v[16:19]
    v_mfma_f32_16x16x32_bf16 v[20:23], a[8:11], v[76:79], v[20:23]
    v_mfma_f32_16x16x32_bf16 v[24:27], a[12:15], v[72:75], v[24:27]
    v_mfma_f32_16x16x32_bf16 v[28:31], a[12:15], v[76:79], v[28:31]
    ds_read_b128 v[72:75], v82 offset:3072
    ds_read_b128 v[76:79], v83 offset:3072
    s_waitcnt lgkmcnt(2)
    v_mfma_f32_16x16x32_bf16 v[32:35], a[144:147], v[64:67], v[32:35]
    v_mfma_f32_16x16x32_bf16 v[36:39], a[144:147], v[68:71], v[36:39]
    v_mfma_f32_16x16x32_bf16 v[40:43], a[148:151], v[64:67], v[40:43]
    v_mfma_f32_16x16x32_bf16 v[44:47], a[148:151], v[68:71], v[44:47]
    v_mfma_f32_16x16x32_bf16 v[48:51], v[64:67], v[144:147], v[48:51]
    v_mfma_f32_16x16x32_bf16 v[56:59], v[68:71], v[144:147], v[56:59]
    v_mfma_f32_16x16x32_bf16 v[52:55], v[64:67], v[148:151], v[52:55]
    v_mfma_f32_16x16x32_bf16 v[60:63], v[68:71], v[148:151], v[60:63]
    v_mfma_f32_16x16x32_bf16 v[16:19], a[16:19], v[64:67], v[16:19]
    v_mfma_f32_16x16x32_bf16 v[20:23], a[16:19], v[68:71], v[20:23]
    v_mfma_f32_16x16x32_bf16 v[24:27], a[20:23], v[64:67], v[24:27]
    v_mfma_f32_16x16x32_bf16 v[28:31], a[20:23], v[68:71], v[28:31]
    ds_read_b128 v[64:67], v80 offset:4096
    ds_read_b128 v[68:71], v81 offset:4096
    s_waitcnt lgkmcnt(2)
    v_mfma_f32_16x16x32_bf16 v[32:35], a[152:155], v[72:75], v[32:35]
    v_mfma_f32_16x16x32_bf16 v[36:39], a[152:155], v[76:79], v[36:39]
    v_mfma_f32_16x16x32_bf16 v[40:43], a[156:159], v[72:75], v[40:43]
    v_mfma_f32_16x16x32_bf16 v[44:47], a[156:159], v[76:79], v[44:47]
    v_mfma_f32_16x16x32_bf16 v[48:51], v[72:75], v[152:155], v[48:51]
    v_mfma_f32_16x16x32_bf16 v[56:59], v[76:79], v[152:155], v[56:59]
    v_mfma_f32_16x16x32_bf16 v[52:55], v[72:75], v[156:159], v[52:55]
    v_mfma_f32_16x16x32_bf16 v[60:63], v[76:79], v[156:159], v[60:63]
    v_mfma_f32_16x16x32_bf16 v[16:19], a[24:27], v[72:75], v[16:19]
    v_mfma_f32_16x16x32_bf16 v[20:23], a[24:27], v[76:79], v[20:23]
    v_mfma_f32_16x16x32_bf16 v[24:27], a[28:31], v[72:75], v[24:27]
    v_mfma_f32_16x16x32_bf16 v[28:31], a[28:31], v[76:79], v[28:31]
    ds_read_b128 v[72:75], v82 offset:5120
    ds_read_b128 v[76:79], v83 offset:5120
    s_waitcnt lgkmcnt(2)
    v_mfma_f32_16x16x32_bf16 v[32:35], a[160:163], v[64:67], v[32:35]
    v_mfma_f32_16x16x32_bf16 v[36:39], a[160:163], v[68:71], v[36:39]
    v_mfma_f32_16x16x32_bf16 v[40:43], a[164:167], v[64:67], v[40:43]
    v_mfma_f32_16x16x32_bf16 v[44:47], a[164:167], v[68:71], v[44:47]
    v_mfma_f32_16x16x32_bf16 v[48:51], v[64:67], v[160:163], v[48:51]
    v_mfma_f32_16x16x32_bf16 v[56:59], v[68:71], v[160:163], v[56:59]
    v_mfma_f32_16x16x32_bf16 v[52:55], v[64:67], v[164:167], v[52:55]
    v_mfma_f32_16x16x32_bf16 v[60:63], v[68:71], v[164:167], v[60:63]
    v_mfma_f32_16x16x32_bf16 v[16:19], a[32:35], v[64:67], v[16:19]
    v_mfma_f32_16x16x32_bf16 v[20:23], a[32:35], v[68:71], v[20:23]
    v_mfma_f32_16x16x32_bf16 v[24:27], a[36:39], v[64:67], v[24:27]
    v_mfma_f32_16x16x32_bf16 v[28:31], a[36:39], v[68:71], v[28:31]
    ds_read_b128 v[64:67], v80 offset:6144
    ds_read_b128 v[68:71], v81 offset:6144
    s_waitcnt lgkmcnt(2)
    v_mfma_f32_16x16x32_bf16 v[32:35], a[168:171], v[72:75], v[32:35]
    v_mfma_f32_16x16x32_bf16 v[36:39], a[168:171], v[76:79], v[36:39]
    v_mfma_f32_16x16x32_bf16 v[40:43], a[172:175], v[72:75], v[40:43]
    v_mfma_f32_16x16x32_bf16 v[44:47], a[172:175], v[76:79], v[44:47]
    v_mfma_f32_16x16x32_bf16 v[48:51], v[72:75], v[168:171], v[48:51]
    v_mfma_f32_16x16x32_bf16 v[56:59], v[76:79], v[168:171], v[56:59]
    v_mfma_f32_16x16x32_bf16 v[52:55], v[72:75], v[172:175], v[52:55]
    v_mfma_f32_16x16x32_bf16 v[60:63], v[76:79], v[172:175], v[60:63]
    v_mfma_f32_16x16x32_bf16 v[16:19], a[40:43], v[72:75], v[16:19]
    v_mfma_f32_16x16x32_bf16 v[20:23], a[40:43], v[76:79], v[20:23]
    v_mfma_f32_16x16x32_bf16 v[24:27], a[44:47], v[72:75], v[24:27]
    v_mfma_f32_16x16x32_bf16 v[28:31], a[44:47], v[76:79], v[28:31]
    ds_read_b128 v[72:75], v82 offset:7168
    ds_read_b128 v[76:79], v83 offset:7168
    s_waitcnt lgkmcnt(2)
    v_mfma_f32_16x16x32_bf16 v[32:35], a[176:179], v[64:67], v[32:35]
    v_mfma_f32_16x16x32_bf16 v[36:39], a[176:179], v[68:71], v[36:39]
    v_mfma_f32_16x16x32_bf16 v[40:43], a[180:183], v[64:67], v[40:43]
    v_mfma_f32_16x16x32_bf16 v[44:47], a[180:183], v[68:71], v[44:47]
    v_mfma_f32_16x16x32_bf16 v[48:51], v[64:67], v[176:179], v[48:51]
    v_mfma_f32_16x16x32_bf16 v[56:59], v[68:71], v[176:179], v[56:59]
    v_mfma_f32_16x16x32_bf16 v[52:55], v[64:67], v[180:183], v[52:55]
    v_mfma_f32_16x16x32_bf16 v[60:63], v[68:71], v[180:183], v[60:63]
    v_mfma_f32_16x16x32_bf16 v[16:19], a[48:51], v[64:67], v[16:19]
    v_mfma_f32_16x16x32_bf16 v[20:23], a[48:51], v[68:71], v[20:23]
    v_mfma_f32_16x16x32_bf16 v[24:27], a[52:55], v[64:67], v[24:27]
    v_mfma_f32_16x16x32_bf16 v[28:31], a[52:55], v[68:71], v[28:31]
    ds_read_b128 v[64:67], v80 offset:8192
    ds_read_b128 v[68:71], v81 offset:8192
    s_waitcnt lgkmcnt(2)
    v_mfma_f32_16x16x32_bf16 v[32:35], a[184:187], v[72:75], v[32:35]
    v_mfma_f32_16x16x32_bf16 v[36:39], a[184:187], v[76:79], v[36:39]
    v_mfma_f32_16x16x32_bf16 v[40:43], a[188:191], v[72:75], v[40:43]
    v_mfma_f32_16x16x32_bf16 v[44:47], a[188:191], v[76:79], v[44:47]
    v_mfma_f32_16x16x32_bf16 v[48:51], v[72:75], v[184:187], v[48:51]
    v_mfma_f32_16x16x32_bf16 v[56:59], v[76:79], v[184:187], v[56:59]
    v_mfma_f32_16x16x32_bf16 v[52:55], v[72:75], v[188:191], v[52:55]
    v_mfma_f32_16x16x32_bf16 v[60:63], v[76:79], v[188:191], v[60:63]
    v_mfma_f32_16x16x32_bf16 v[16:19], a[56:59], v[72:75], v[16:19]
    v_mfma_f32_16x16x32_bf16 v[20:23], a[56:59], v[76:79], v[20:23]
    v_mfma_f32_16x16x32_bf16 v[24:27], a[60:63], v[72:75], v[24:27]
    v_mfma_f32_16x16x32_bf16 v[28:31], a[60:63], v[76:79], v[28:31]
    ds_read_b128 v[72:75], v82 offset:9216
    ds_read_b128 v[76:79], v83 offset:9216
    s_waitcnt lgkmcnt(2)
    v_mfma_f32_16x16x32_bf16 v[32:35], a[192:195], v[64:67], v[32:35]
    v_mfma_f32_16x16x32_bf16 v[36:39], a[192:195], v[68:71], v[36:39]
    v_mfma_f32_16x16x32_bf16 v[40:43], a[196:199], v[64:67], v[40:43]
    v_mfma_f32_16x16x32_bf16 v[44:47], a[196:199], v[68:71], v[44:47]
    v_mfma_f32_16x16x32_bf16 v[48:51], v[64:67], v[192:195], v[48:51]
    v_mfma_f32_16x16x32_bf16 v[56:59], v[68:71], v[192:195], v[56:59]
    v_mfma_f32_16x16x32_bf16 v[52:55], v[64:67], v[196:199], v[52:55]
    v_mfma_f32_16x16x32_bf16 v[60:63], v[68:71], v[196:199], v[60:63]
    v_mfma_f32_16x16x32_bf16 v[16:19], a[64:67], v[64:67], v[16:19]
    v_mfma_f32_16x16x32_bf16 v[20:23], a[64:67], v[68:71], v[20:23]
    v_mfma_f32_16x16x32_bf16 v[24:27], a[68:71], v[64:67], v[24:27]
    v_mfma_f32_16x16x32_bf16 v[28:31], a[68:71], v[68:71], v[28:31]
    ds_read_b128 v[64:67], v80 offset:10240
    ds_read_b128 v[68:71], v81 offset:10240
    s_waitcnt lgkmcnt(2)
    v_mfma_f32_16x16x32_bf16 v[32:35], a[200:203], v[72:75], v[32:35]
    v_mfma_f32_16x16x32_bf16 v[36:39], a[200:203], v[76:79], v[36:39]
    v_mfma_f32_16x16x32_bf16 v[40:43], a[204:207], v[72:75], v[40:43]
    v_mfma_f32_16x16x32_bf16 v[44:47], a[204:207], v[76:79], v[44:47]
    v_mfma_f32_16x16x32_bf16 v[48:51], v[72:75], v[200:203], v[48:51]
    v_mfma_f32_16x16x32_bf16 v[56:59], v[76:79], v[200:203], v[56:59]
    v_mfma_f32_16x16x32_bf16 v[52:55], v[72:75], v[204:207], v[52:55]
    v_mfma_f32_16x16x32_bf16 v[60:63], v[76:79], v[204:207], v[60:63]
    v_mfma_f32_16x16x32_bf16 v[16:19], a[72:75], v[72:75], v[16:19]
    v_mfma_f32_16x16x32_bf16 v[20:23], a[72:75], v[76:79], v[20:23]
    v_mfma_f32_16x16x32_bf16 v[24:27], a[76:79], v[72:75], v[24:27]
    v_mfma_f32_16x16x32_bf16 v[28:31], a[76:79], v[76:79], v[28:31]
    ds_read_b128 v[72:75], v82 offset:11264
    ds_read_b128 v[76:79], v83 offset:11264
    s_waitcnt lgkmcnt(2)
    v_mfma_f32_16x16x32_bf16 v[32:35], a[208:211], v[64:67], v[32:35]
    v_mfma_f32_16x16x32_bf16 v[36:39], a[208:211], v[68:71], v[36:39]
    v_mfma_f32_16x16x32_bf16 v[40:43], a[212:215], v[64:67], v[40:43]
    v_mfma_f32_16x16x32_bf16 v[44:47], a[212:215], v[68:71], v[44:47]
    v_mfma_f32_16x16x32_bf16 v[48:51], v[64:67], v[208:211], v[48:51]
    v_mfma_f32_16x16x32_bf16 v[56:59], v[68:71], v[208:211], v[56:59]
    v_mfma_f32_16x16x32_bf16 v[52:55], v[64:67], v[212:215], v[52:55]
    v_mfma_f32_16x16x32_bf16 v[60:63], v[68:71], v[212:215], v[60:63]
    v_mfma_f32_16x16x32_bf16 v[16:19], a[80:83], v[64:67], v[16:19]
    v_mfma_f32_16x16x32_bf16 v[20:23], a[80:83], v[68:71], v[20:23]
    v_mfma_f32_16x16x32_bf16 v[24:27], a[84:87], v[64:67], v[24:27]
    v_mfma_f32_16x16x32_bf16 v[28:31], a[84:87], v[68:71], v[28:31]
    ds_read_b128 v[64:67], v80 offset:12288
    ds_read_b128 v[68:71], v81 offset:12288
    s_waitcnt lgkmcnt(2)
    v_mfma_f32_16x16x32_bf16 v[32:35], a[216:219], v[72:75], v[32:35]
    v_mfma_f32_16x16x32_bf16 v[36:39], a[216:219], v[76:79], v[36:39]
    v_mfma_f32_16x16x32_bf16 v[40:43], a[220:223], v[72:75], v[40:43]
    v_mfma_f32_16x16x32_bf16 v[44:47], a[220:223], v[76:79], v[44:47]
    v_mfma_f32_16x16x32_bf16 v[48:51], v[72:75], v[216:219], v[48:51]
    v_mfma_f32_16x16x32_bf16 v[56:59], v[76:79], v[216:219], v[56:59]
    v_mfma_f32_16x16x32_bf16 v[52:55], v[72:75], v[220:223], v[52:55]
    v_mfma_f32_16x16x32_bf16 v[60:63], v[76:79], v[220:223], v[60:63]
    v_mfma_f32_16x16x32_bf16 v[16:19], a[88:91], v[72:75], v[16:19]
    v_mfma_f32_16x16x32_bf16 v[20:23], a[88:91], v[76:79], v[20:23]
    v_mfma_f32_16x16x32_bf16 v[24:27], a[92:95], v[72:75], v[24:27]
    v_mfma_f32_16x16x32_bf16 v[28:31], a[92:95], v[76:79], v[28:31]
    ds_read_b128 v[72:75], v82 offset:13312
    ds_read_b128 v[76:79], v83 offset:13312
    s_waitcnt lgkmcnt(2)
    v_mfma_f32_16x16x32_bf16 v[32:35], a[224:227], v[64:67], v[32:35]
    v_mfma_f32_16x16x32_bf16 v[36:39], a[224:227], v[68:71], v[36:39]
    v_mfma_f32_16x16x32_bf16 v[40:43], a[228:231], v[64:67], v[40:43]
    v_mfma_f32_16x16x32_bf16 v[44:47], a[228:231], v[68:71], v[44:47]
    v_mfma_f32_16x16x32_bf16 v[48:51], v[64:67], v[224:227], v[48:51]
    v_mfma_f32_16x16x32_bf16 v[56:59], v[68:71], v[224:227], v[56:59]
    v_mfma_f32_16x16x32_bf16 v[52:55], v[64:67], v[228:231], v[52:55]
    v_mfma_f32_16x16x32_bf16 v[60:63], v[68:71], v[228:231], v[60:63]
    v_mfma_f32_16x16x32_bf16 v[16:19], a[96:99], v[64:67], v[16:19]
    v_mfma_f32_16x16x32_bf16 v[20:23], a[96:99], v[68:71], v[20:23]
    v_mfma_f32_16x16x32_bf16 v[24:27], a[100:103], v[64:67], v[24:27]
    v_mfma_f32_16x16x32_bf16 v[28:31], a[100:103], v[68:71], v[28:31]
    ds_read_b128 v[64:67], v80 offset:14336
    ds_read_b128 v[68:71], v81 offset:14336
    s_waitcnt lgkmcnt(2)
    v_mfma_f32_16x16x32_bf16 v[32:35], a[232:235], v[72:75], v[32:35]
    v_mfma_f32_16x16x32_bf16 v[36:39], a[232:235], v[76:79], v[36:39]
    v_mfma_f32_16x16x32_bf16 v[40:43], a[236:239], v[72:75], v[40:43]
    v_mfma_f32_16x16x32_bf16 v[44:47], a[236:239], v[76:79], v[44:47]
    v_mfma_f32_16x16x32_bf16 v[48:51], v[72:75], v[232:235], v[48:51]
    v_mfma_f32_16x16x32_bf16 v[56:59], v[76:79], v[232:235], v[56:59]
    v_mfma_f32_16x16x32_bf16 v[52:55], v[72:75], v[236:239], v[52:55]
    v_mfma_f32_16x16x32_bf16 v[60:63], v[76:79], v[236:239], v[60:63]
    v_mfma_f32_16x16x32_bf16 v[16:19], a[104:107], v[72:75], v[16:19]
    v_mfma_f32_16x16x32_bf16 v[20:23], a[104:107], v[76:79], v[20:23]
    v_mfma_f32_16x16x32_bf16 v[24:27], a[108:111], v[72:75], v[24:27]
    v_mfma_f32_16x16x32_bf16 v[28:31], a[108:111], v[76:79], v[28:31]
    ds_read_b128 v[72:75], v82 offset:15360
    ds_read_b128 v[76:79], v83 offset:15360
    s_waitcnt lgkmcnt(2)
    v_mfma_f32_16x16x32_bf16 v[32:35], a[240:243], v[64:67], v[32:35]
    v_mfma_f32_16x16x32_bf16 v[36:39], a[240:243], v[68:71], v[36:39]
    v_mfma_f32_16x16x32_bf16 v[40:43], a[244:247], v[64:67], v[40:43]
    v_mfma_f32_16x16x32_bf16 v[44:47], a[244:247], v[68:71], v[44:47]
    v_mfma_f32_16x16x32_bf16 v[48:51], v[64:67], v[240:243], v[48:51]
    v_mfma_f32_16x16x32_bf16 v[56:59], v[68:71], v[240:243], v[56:59]
    v_mfma_f32_16x16x32_bf16 v[52:55], v[64:67], v[244:247], v[52:55]
    v_mfma_f32_16x16x32_bf16 v[60:63], v[68:71], v[244:247], v[60:63]
    v_mfma_f32_16x16x32_bf16 v[16:19], a[112:115], v[64:67], v[16:19]
    v_mfma_f32_16x16x32_bf16 v[20:23], a[112:115], v[68:71], v[20:23]
    v_mfma_f32_16x16x32_bf16 v[24:27], a[116:119], v[64:67], v[24:27]
    v_mfma_f32_16x16x32_bf16 v[28:31], a[116:119], v[68:71], v[28:31]
    s_waitcnt lgkmcnt(0)
    v_mfma_f32_16x16x32_bf16 v[32:35], a[248:251], v[72:75], v[32:35]
    v_mfma_f32_16x16x32_bf16 v[36:39], a[248:251], v[76:79], v[36:39]
    v_mfma_f32_16x16x32_bf16 v[40:43], a[252:255], v[72:75], v[40:43]
    v_mfma_f32_16x16x32_bf16 v[44:47], a[252:255], v[76:79], v[44:47]
    v_mfma_f32_16x16x32_bf16 v[48:51], v[72:75], v[248:251], v[48:51]
    v_mfma_f32_16x16x32_bf16 v[56:59], v[76:79], v[248:251], v[56:59]
    v_mfma_f32_16x16x32_bf16 v[52:55], v[72:75], v[252:255], v[52:55]
    v_mfma_f32_16x16x32_bf16 v[60:63], v[76:79], v[252:255], v[60:63]
    v_mfma_f32_16x16x32_bf16 v[16:19], a[120:123], v[72:75], v[16:19]
    v_mfma_f32_16x16x32_bf16 v[20:23], a[120:123], v[76:79], v[20:23]
    v_mfma_f32_16x16x32_bf16 v[24:27], a[124:127], v[72:75], v[24:27]
    v_mfma_f32_16x16x32_bf16 v[28:31], a[124:127], v[76:79], v[28:31]
    s_barrier
    v_mul_f32 v32, s33, v32
    v_mul_f32 v33, s33, v33
    v_mul_f32 v34, s33, v34
    v_mul_f32 v35, s33, v35
    v_mul_f32 v36, s33, v36
    v_mul_f32 v37, s33, v37
    v_mul_f32 v38, s33, v38
    v_mul_f32 v39, s33, v39
    v_mul_f32 v40, s33, v40
    v_mul_f32 v41, s33, v41
    v_mul_f32 v42, s33, v42
    v_mul_f32 v43, s33, v43
    v_mul_f32 v44, s33, v44
    v_mul_f32 v45, s33, v45
    v_mul_f32 v46, s33, v46
    v_mul_f32 v47, s33, v47
    v_cvt_pk_bf16_f32 v64, v32, v40
    v_cvt_pk_bf16_f32 v65, v33, v41
    v_cvt_pk_bf16_f32 v66, v34, v42
    v_cvt_pk_bf16_f32 v67, v35, v43
    v_cvt_pk_bf16_f32 v68, v36, v44
    v_cvt_pk_bf16_f32 v69, v37, v45
    v_cvt_pk_bf16_f32 v70, v38, v46
    v_cvt_pk_bf16_f32 v71, v39, v47
    v_cvt_pk_bf16_f32 v72, v48, v49
    v_cvt_pk_bf16_f32 v73, v50, v51
    v_cvt_pk_bf16_f32 v74, v56, v57
    v_cvt_pk_bf16_f32 v75, v58, v59
    v_cvt_pk_bf16_f32 v76, v52, v53
    v_cvt_pk_bf16_f32 v77, v54, v55
    v_cvt_pk_bf16_f32 v78, v60, v61
    v_cvt_pk_bf16_f32 v79, v62, v63
    v_cvt_pk_bf16_f32 v84, v16, v24
    v_cvt_pk_bf16_f32 v85, v17, v25
    v_cvt_pk_bf16_f32 v86, v18, v26
    v_cvt_pk_bf16_f32 v87, v19, v27
    v_cvt_pk_bf16_f32 v88, v20, v28
    v_cvt_pk_bf16_f32 v89, v21, v29
    v_cvt_pk_bf16_f32 v90, v22, v30
    v_cvt_pk_bf16_f32 v91, v23, v31
    s_mul_i32 s24, s23, 0x82000
    s_lshl_b32 s36, s20, 14
    s_add_u32 s24, s24, s36
    s_add_u32 s24, s24, 0x1000000
    s_lshr_b32 s36, s21, 1
    s_lshl_b32 s36, s36, 12
    s_xor_b32 s37, s36, 4096
    s_add_u32 s36, s36, s24
    s_add_u32 s37, s37, s24
    buffer_store_dwordx4 v[64:67], v9, s[8:11], s36 offen sc1
    buffer_store_dwordx4 v[68:71], v9, s[8:11], s37 offen sc1
    s_add_u32 s24, s24, 8192
    buffer_store_dwordx4 v[72:75], v2, s[8:11], s24 offen sc1
    buffer_store_dwordx4 v[76:79], v2, s[8:11], s24 offen offset:1024 sc1
    s_add_u32 s36, s36, 0x7000000
    s_add_u32 s37, s37, 0x7000000
    buffer_store_dwordx4 v[84:87], v9, s[8:11], s36 offen sc1
    buffer_store_dwordx4 v[88:91], v9, s[8:11], s37 offen sc1
    s_lshl_b32 s25, s20, 8
    s_lshl_b32 s36, s23, 2
    s_add_u32 s25, s25, s36
    s_add_u32 s25, s25, 0x190000
    s_add_u32 s23, s23, 7
    s_cmp_lt_u32 s23, 64
    s_cbranch_scc1 L_P1
    s_waitcnt vmcnt(0)
    s_barrier
    v_cmp_ne_u32 vcc, 0, v0
    v_mov_b32 v15, 0x40000000
    v_mov_b32 v14, 1
    v_cndmask_b32 v15, v0, v15, vcc
    buffer_store_dword v14, v15, s[8:11], s25 offen sc1
    s_mov_b32 s96, s54
    s_and_b32 s97, s55, 0xffff
    s_mov_b32 s98, 0x400000
    s_mov_b32 s99, 0x20000
    v_mov_b32 v15, 0x0
    v_bfe_u32 v14, v0, 0, 1
    s_mov_b32 s38, 0x10
    v_mad_u32_u24 v15, v14, s38, v15
    v_bfe_u32 v14, v0, 1, 1
    s_mov_b32 s38, 0x20
    v_mad_u32_u24 v15, v14, s38, v15
    v_bfe_u32 v14, v0, 2, 1
    s_mov_b32 s38, 0x40
    v_mad_u32_u24 v15, v14, s38, v15
    v_bfe_u32 v14, v0, 3, 1
    s_mov_b32 s38, 0x80
    v_mad_u32_u24 v15, v14, s38, v15
    v_bfe_u32 v14, v0, 4, 1
    s_mov_b32 s38, 0x1000
    v_mad_u32_u24 v15, v14, s38, v15
    v_bfe_u32 v14, v0, 5, 1
    s_mov_b32 s38, 0x2000
    v_mad_u32_u24 v15, v14, s38, v15
    v_bfe_u32 v14, v0, 6, 1
    s_mov_b32 s38, 0x100
    v_mad_u32_u24 v15, v14, s38, v15
    v_bfe_u32 v14, v0, 7, 1
    s_mov_b32 s38, 0x200
    v_mad_u32_u24 v15, v14, s38, v15
    s_lshl_b32 s36, s20, 17
    s_add_u32 s37, s36, 0x0
    buffer_load_dwordx4 v[16:19], v15, s[96:99], s37 offen
    s_add_u32 s37, s36, 0x4000
    buffer_load_dwordx4 v[20:23], v15, s[96:99], s37 offen
    s_add_u32 s37, s36, 0x400
    buffer_load_dwordx4 v[24:27], v15, s[96:99], s37 offen
    s_add_u32 s37, s36, 0x4400
    buffer_load_dwordx4 v[28:31], v15, s[96:99], s37 offen
    s_add_u32 s37, s36, 0x800
    buffer_load_dwordx4 v[32:35], v15, s[96:99], s37 offen
    s_add_u32 s37, s36, 0x4800
    buffer_load_dwordx4 v[36:39], v15, s[96:99], s37 offen
    s_add_u32 s37, s36, 0xc00
    buffer_load_dwordx4 v[40:43], v15, s[96:99], s37 offen
    s_add_u32 s37, s36, 0x4c00
    buffer_load_dwordx4 v[44:47], v15, s[96:99], s37 offen
    s_add_u32 s37, s36, 0x8000
    buffer_load_dwordx4 v[48:51], v15, s[96:99], s37 offen
    s_add_u32 s37, s36, 0xc000
    buffer_load_dwordx4 v[52:55], v15, s[96:99], s37 offen
    s_add_u32 s37, s36, 0x8400
    buffer_load_dwordx4 v[56:59], v15, s[96:99], s37 offen
    s_add_u32 s37, s36, 0xc400
    buffer_load_dwordx4 v[60:63], v15, s[96:99], s37 offen
    s_add_u32 s37, s36, 0x8800
    buffer_load_dwordx4 v[64:67], v15, s[96:99], s37 offen
    s_add_u32 s37, s36, 0xc800
    buffer_load_dwordx4 v[68:71], v15, s[96:99], s37 offen
    s_add_u32 s37, s36, 0x8c00
    buffer_load_dwordx4 v[72:75], v15, s[96:99], s37 offen
    s_add_u32 s37, s36, 0xcc00
    buffer_load_dwordx4 v[76:79], v15, s[96:99], s37 offen
    s_add_u32 s37, s36, 0x10000
    buffer_load_dwordx4 v[80:83], v15, s[96:99], s37 offen
    s_add_u32 s37, s36, 0x14000
    buffer_load_dwordx4 v[84:87], v15, s[96:99], s37 offen
    s_add_u32 s37, s36, 0x10400
    buffer_load_dwordx4 v[88:91], v15, s[96:99], s37 offen
    s_add_u32 s37, s36, 0x14400
    buffer_load_dwordx4 v[92:95], v15, s[96:99], s37 offen
    s_add_u32 s37, s36, 0x10800
    buffer_load_dwordx4 v[96:99], v15, s[96:99], s37 offen
    s_add_u32 s37, s36, 0x14800
    buffer_load_dwordx4 v[100:103], v15, s[96:99], s37 offen
    s_add_u32 s37, s36, 0x10c00
    buffer_load_dwordx4 v[104:107], v15, s[96:99], s37 offen
    s_add_u32 s37, s36, 0x14c00
    buffer_load_dwordx4 v[108:111], v15, s[96:99], s37 offen
    s_waitcnt vmcnt(16)
    v_perm_b32 v112, v20, v16, s34
    v_perm_b32 v113, v28, v24, s34
    v_perm_b32 v114, v36, v32, s34
    v_perm_b32 v115, v44, v40, s34
    ds_write_b128 v7, v[112:115] offset:0
    v_perm_b32 v116, v20, v16, s35
    v_perm_b32 v117, v28, v24, s35
    v_perm_b32 v118, v36, v32, s35
    v_perm_b32 v119, v44, v40, s35
    ds_write_b128 v7, v[116:119] offset:1024
    v_perm_b32 v120, v21, v17, s34
    v_perm_b32 v121, v29, v25, s34
    v_perm_b32 v122, v37, v33, s34
    v_perm_b32 v123, v45, v41, s34
    ds_write_b128 v7, v[120:123] offset:2048
    v_perm_b32 v124, v21, v17, s35
    v_perm_b32 v125, v29, v25, s35
    v_perm_b32 v126, v37, v33, s35
    v_perm_b32 v127, v45, v41, s35
    ds_write_b128 v7, v[124:127] offset:3072
    s_waitcnt lgkmcnt(0)
    v_perm_b32 v112, v22, v18, s34
    v_perm_b32 v113, v30, v26, s34
    v_perm_b32 v114, v38, v34, s34
    v_perm_b32 v115, v46, v42, s34
    ds_write_b128 v7, v[112:115] offset:4096
    v_perm_b32 v116, v22, v18, s35
    v_perm_b32 v117, v30, v26, s35
    v_perm_b32 v118, v38, v34, s35
    v_perm_b32 v119, v46, v42, s35
    ds_write_b128 v7, v[116:119] offset:5120
    v_perm_b32 v120, v23, v19, s34
    v_perm_b32 v121, v31, v27, s34
    v_perm_b32 v122, v39, v35, s34
    v_perm_b32 v123, v47, v43, s34
    ds_write_b128 v7, v[120:123] offset:6144
    v_perm_b32 v124, v23, v19, s35
    v_perm_b32 v125, v31, v27, s35
    v_perm_b32 v126, v39, v35, s35
    v_perm_b32 v127, v47, v43, s35
    ds_write_b128 v7, v[124:127] offset:7168
    s_waitcnt lgkmcnt(0)
    s_add_u32 s37, s36, 0x18000
    buffer_load_dwordx4 v[16:19], v15, s[96:99], s37 offen
    s_add_u32 s37, s36, 0x1c000
    buffer_load_dwordx4 v[20:23], v15, s[96:99], s37 offen
    s_add_u32 s37, s36, 0x18400
    buffer_load_dwordx4 v[24:27], v15, s[96:99], s37 offen
    s_add_u32 s37, s36, 0x1c400
    buffer_load_dwordx4 v[28:31], v15, s[96:99], s37 offen
    s_add_u32 s37, s36, 0x18800
    buffer_load_dwordx4 v[32:35], v15, s[96:99], s37 offen
    s_add_u32 s37, s36, 0x1c800
    buffer_load_dwordx4 v[36:39], v15, s[96:99], s37 offen
    s_add_u32 s37, s36, 0x18c00
    buffer_load_dwordx4 v[40:43], v15, s[96:99], s37 offen
    s_add_u32 s37, s36, 0x1cc00
    buffer_load_dwordx4 v[44:47], v15, s[96:99], s37 offen
    s_waitcnt vmcnt(16)
    v_perm_b32 v112, v52, v48, s34
    v_perm_b32 v113, v60, v56, s34
    v_perm_b32 v114, v68, v64, s34
    v_perm_b32 v115, v76, v72, s34
    ds_write_b128 v7, v[112:115] offset:8192
    v_perm_b32 v116, v52, v48, s35
    v_perm_b32 v117, v60, v56, s35
    v_perm_b32 v118, v68, v64, s35
    v_perm_b32 v119, v76, v72, s35
    ds_write_b128 v7, v[116:119] offset:9216
    v_perm_b32 v120, v53, v49, s34
    v_perm_b32 v121, v61, v57, s34
    v_perm_b32 v122, v69, v65, s34
    v_perm_b32 v123, v77, v73, s34
    ds_write_b128 v7, v[120:123] offset:10240
    v_perm_b32 v124, v53, v49, s35
    v_perm_b32 v125, v61, v57, s35
    v_perm_b32 v126, v69, v65, s35
    v_perm_b32 v127, v77, v73, s35
    ds_write_b128 v7, v[124:127] offset:11264
    s_waitcnt lgkmcnt(0)
    v_perm_b32 v112, v54, v50, s34
    v_perm_b32 v113, v62, v58, s34
    v_perm_b32 v114, v70, v66, s34
    v_perm_b32 v115, v78, v74, s34
    ds_write_b128 v7, v[112:115] offset:12288
    v_perm_b32 v116, v54, v50, s35
    v_perm_b32 v117, v62, v58, s35
    v_perm_b32 v118, v70, v66, s35
    v_perm_b32 v119, v78, v74, s35
    ds_write_b128 v7, v[116:119] offset:13312
    v_perm_b32 v120, v55, v51, s34
    v_perm_b32 v121, v63, v59, s34
    v_perm_b32 v122, v71, v67, s34
    v_perm_b32 v123, v79, v75, s34
    ds_write_b128 v7, v[120:123] offset:14336
    v_perm_b32 v124, v55, v51, s35
    v_perm_b32 v125, v63, v59, s35
    v_perm_b32 v126, v71, v67, s35
    v_perm_b32 v127, v79, v75, s35
    ds_write_b128 v7, v[124:127] offset:15360
    s_waitcnt lgkmcnt(0)
    s_waitcnt vmcnt(8)
    v_perm_b32 v112, v84, v80, s34
    v_perm_b32 v113, v92, v88, s34
    v_perm_b32 v114, v100, v96, s34
    v_perm_b32 v115, v108, v104, s34
    ds_write_b128 v7, v[112:115] offset:16384
    v_perm_b32 v116, v84, v80, s35
    v_perm_b32 v117, v92, v88, s35
    v_perm_b32 v118, v100, v96, s35
    v_perm_b32 v119, v108, v104, s35
    ds_write_b128 v7, v[116:119] offset:17408
    v_perm_b32 v120, v85, v81, s34
    v_perm_b32 v121, v93, v89, s34
    v_perm_b32 v122, v101, v97, s34
    v_perm_b32 v123, v109, v105, s34
    ds_write_b128 v7, v[120:123] offset:18432
    v_perm_b32 v124, v85, v81, s35
    v_perm_b32 v125, v93, v89, s35
    v_perm_b32 v126, v101, v97, s35
    v_perm_b32 v127, v109, v105, s35
    ds_write_b128 v7, v[124:127] offset:19456
    s_waitcnt lgkmcnt(0)
    v_perm_b32 v112, v86, v82, s34
    v_perm_b32 v113, v94, v90, s34
    v_perm_b32 v114, v102, v98, s34
    v_perm_b32 v115, v110, v106, s34
    ds_write_b128 v7, v[112:115] offset:20480
    v_perm_b32 v116, v86, v82, s35
    v_perm_b32 v117, v94, v90, s35
    v_perm_b32 v118, v102, v98, s35
    v_perm_b32 v119, v110, v106, s35
    ds_write_b128 v7, v[116:119] offset:21504
    v_perm_b32 v120, v87, v83, s34
    v_perm_b32 v121, v95, v91, s34
    v_perm_b32 v122, v103, v99, s34
    v_perm_b32 v123, v111, v107, s34
    ds_write_b128 v7, v[120:123] offset:22528
    v_perm_b32 v124, v87, v83, s35
    v_perm_b32 v125, v95, v91, s35
    v_perm_b32 v126, v103, v99, s35
    v_perm_b32 v127, v111, v107, s35
    ds_write_b128 v7, v[124:127] offset:23552
    s_waitcnt lgkmcnt(0)
    s_waitcnt vmcnt(0)
    v_perm_b32 v112, v20, v16, s34
    v_perm_b32 v113, v28, v24, s34
    v_perm_b32 v114, v36, v32, s34
    v_perm_b32 v115, v44, v40, s34
    ds_write_b128 v7, v[112:115] offset:24576
    v_perm_b32 v116, v20, v16, s35
    v_perm_b32 v117, v28, v24, s35
    v_perm_b32 v118, v36, v32, s35
    v_perm_b32 v119, v44, v40, s35
    ds_write_b128 v7, v[116:119] offset:25600
    v_perm_b32 v120, v21, v17, s34
    v_perm_b32 v121, v29, v25, s34
    v_perm_b32 v122, v37, v33, s34
    v_perm_b32 v123, v45, v41, s34
    ds_write_b128 v7, v[120:123] offset:26624
    v_perm_b32 v124, v21, v17, s35
    v_perm_b32 v125, v29, v25, s35
    v_perm_b32 v126, v37, v33, s35
    v_perm_b32 v127, v45, v41, s35
    ds_write_b128 v7, v[124:127] offset:27648
    s_waitcnt lgkmcnt(0)
    v_perm_b32 v112, v22, v18, s34
    v_perm_b32 v113, v30, v26, s34
    v_perm_b32 v114, v38, v34, s34
    v_perm_b32 v115, v46, v42, s34
    ds_write_b128 v7, v[112:115] offset:28672
    v_perm_b32 v116, v22, v18, s35
    v_perm_b32 v117, v30, v26, s35
    v_perm_b32 v118, v38, v34, s35
    v_perm_b32 v119, v46, v42, s35
    ds_write_b128 v7, v[116:119] offset:29696
    v_perm_b32 v120, v23, v19, s34
    v_perm_b32 v121, v31, v27, s34
    v_perm_b32 v122, v39, v35, s34
    v_perm_b32 v123, v47, v43, s34
    ds_write_b128 v7, v[120:123] offset:30720
    v_perm_b32 v124, v23, v19, s35
    v_perm_b32 v125, v31, v27, s35
    v_perm_b32 v126, v39, v35, s35
    v_perm_b32 v127, v47, v43, s35
    ds_write_b128 v7, v[124:127] offset:31744
    s_waitcnt lgkmcnt(0)
    s_mov_b32 s23, s22
L_P2:
    s_mul_i32 s24, s23, 0x82000
    s_lshl_b32 s36, s20, 14
    s_add_u32 s24, s24, s36
    s_add_u32 s24, s24, 0x1000000
    s_add_u32 s36, s24, 0
    s_add_u32 s37, s36, 0x7000000
    buffer_load_dwordx4 v[48:51], v1, s[8:11], s36 offen offset:0 sc1
    buffer_load_dwordx4 v[16:19], v1, s[8:11], s37 offen offset:0 sc1
    buffer_load_dwordx4 v[52:55], v1, s[8:11], s36 offen offset:1024 sc1
    buffer_load_dwordx4 v[20:23], v1, s[8:11], s37 offen offset:1024 sc1
    buffer_load_dwordx4 v[56:59], v1, s[8:11], s36 offen offset:2048 sc1
    buffer_load_dwordx4 v[24:27], v1, s[8:11], s37 offen offset:2048 sc1
    buffer_load_dwordx4 v[60:63], v1, s[8:11], s36 offen offset:3072 sc1
    buffer_load_dwordx4 v[28:31], v1, s[8:11], s37 offen offset:3072 sc1
    s_add_u32 s36, s24, 4096
    s_add_u32 s37, s36, 0x7000000
    buffer_load_dwordx4 v[64:67], v1, s[8:11], s36 offen offset:0 sc1
    buffer_load_dwordx4 v[32:35], v1, s[8:11], s37 offen offset:0 sc1
    buffer_load_dwordx4 v[68:71], v1, s[8:11], s36 offen offset:1024 sc1
    buffer_load_dwordx4 v[36:39], v1, s[8:11], s37 offen offset:1024 sc1
    buffer_load_dwordx4 v[72:75], v1, s[8:11], s36 offen offset:2048 sc1
    buffer_load_dwordx4 v[40:43], v1, s[8:11], s37 offen offset:2048 sc1
    buffer_load_dwordx4 v[76:79], v1, s[8:11], s36 offen offset:3072 sc1
    buffer_load_dwordx4 v[44:47], v1, s[8:11], s37 offen offset:3072 sc1
    s_add_u32 s24, s24, 8192
    buffer_load_dwordx4 v[120:123], v2, s[8:11], s24 offen sc1
    buffer_load_dwordx4 v[124:127], v2, s[8:11], s24 offen offset:1024 sc1
    s_waitcnt vmcnt(0)
    s_cmp_lt_u32 s21, 2
    s_cbranch_scc1 L_P2_noswap
    v_swap_b32 v120, v122
    v_swap_b32 v121, v123
    v_swap_b32 v124, v126
    v_swap_b32 v125, v127
L_P2_noswap:
    s_nop 1
    v_mfma_f32_16x16x32_bf16 v[80:83], v[48:51], v[16:19], 0
    v_mfma_f32_16x16x32_bf16 v[80:83], v[52:55], v[20:23], v[80:83]
    v_mfma_f32_16x16x32_bf16 v[80:83], v[56:59], v[24:27], v[80:83]
    v_mfma_f32_16x16x32_bf16 v[80:83], v[60:63], v[28:31], v[80:83]
    v_mfma_f32_16x16x32_bf16 v[84:87], v[48:51], v[32:35], 0
    v_mfma_f32_16x16x32_bf16 v[84:87], v[52:55], v[36:39], v[84:87]
    v_mfma_f32_16x16x32_bf16 v[84:87], v[56:59], v[40:43], v[84:87]
    v_mfma_f32_16x16x32_bf16 v[84:87], v[60:63], v[44:47], v[84:87]
    v_mfma_f32_16x16x32_bf16 v[88:91], v[64:67], v[32:35], 0
    v_mfma_f32_16x16x32_bf16 v[88:91], v[68:71], v[36:39], v[88:91]
    v_mfma_f32_16x16x32_bf16 v[88:91], v[72:75], v[40:43], v[88:91]
    v_mfma_f32_16x16x32_bf16 v[88:91], v[76:79], v[44:47], v[88:91]
    s_lshl_b32 s24, s23, 13
    s_add_u32 s24, s24, 0x100000
L_P2_poll:
    buffer_load_dwordx4 v[48:51], v2, s[8:11], s24 offen sc1
    buffer_load_dwordx4 v[52:55], v2, s[8:11], s24 offen offset:1024 sc1
    s_add_u32 s32, s32, 1
    s_cmp_gt_u32 s32, 200000
    s_waitcnt vmcnt(0)
    v_max3_u32 v14, v48, v49, v50
    v_max3_u32 v15, v51, v52, v53
    v_max3_u32 v14, v14, v54, v55
    v_max_u32 v14, v14, v15
    s_cbranch_scc1 L_P2_got
    v_cmp_eq_u32 vcc, -1, v14
    s_cbranch_vccz L_P2_got
    s_sleep 4
    s_branch L_P2_poll
L_P2_got:
    ds_write_b128 v2, v[48:51] offset:20480
    ds_write_b128 v2, v[52:55] offset:21504
    s_waitcnt lgkmcnt(0)
    s_barrier
    ds_read_b128 v[48:51], v8 offset:0
    ds_read_b128 v[52:55], v8 offset:2048
    ds_read_b128 v[56:59], v8 offset:4096
    ds_read_b128 v[60:63], v8 offset:6144
    ds_read_b128 v[64:67], v8 offset:512
    s_waitcnt lgkmcnt(4)
    v_mfma_f32_16x16x32_bf16 v[100:103], a[128:131], v[48:51], 0
    v_mfma_f32_16x16x32_bf16 v[104:107], a[132:135], v[48:51], 0
    v_mfma_f32_16x16x32_bf16 v[108:111], v[48:51], v[128:131], 0
    v_mfma_f32_16x16x32_bf16 v[112:115], v[48:51], v[132:135], 0
    ds_read_b128 v[68:71], v8 offset:2560
    s_waitcnt lgkmcnt(4)
    v_mfma_f32_16x16x32_bf16 v[100:103], a[136:139], v[52:55], v[100:103]
    v_mfma_f32_16x16x32_bf16 v[104:107], a[140:143], v[52:55], v[104:107]
    v_mfma_f32_16x16x32_bf16 v[108:111], v[52:55], v[136:139], v[108:111]
    v_mfma_f32_16x16x32_bf16 v[112:115], v[52:55], v[140:143], v[112:115]
    ds_read_b128 v[72:75], v8 offset:4608
    s_waitcnt lgkmcnt(4)
    v_mfma_f32_16x16x32_bf16 v[100:103], a[144:147], v[56:59], v[100:103]
    v_mfma_f32_16x16x32_bf16 v[104:107], a[148:151], v[56:59], v[104:107]
    v_mfma_f32_16x16x32_bf16 v[108:111], v[56:59], v[144:147], v[108:111]
    v_mfma_f32_16x16x32_bf16 v[112:115], v[56:59], v[148:151], v[112:115]
    ds_read_b128 v[76:79], v8 offset:6656
    s_waitcnt lgkmcnt(4)
    v_mfma_f32_16x16x32_bf16 v[100:103], a[152:155], v[60:63], v[100:103]
    v_mfma_f32_16x16x32_bf16 v[104:107], a[156:159], v[60:63], v[104:107]
    v_mfma_f32_16x16x32_bf16 v[108:111], v[60:63], v[152:155], v[108:111]
    v_mfma_f32_16x16x32_bf16 v[112:115], v[60:63], v[156:159], v[112:115]
    ds_read_b128 v[48:51], v8 offset:1024
    s_waitcnt lgkmcnt(4)
    v_mfma_f32_16x16x32_bf16 v[100:103], a[160:163], v[64:67], v[100:103]
    v_mfma_f32_16x16x32_bf16 v[104:107], a[164:167], v[64:67], v[104:107]
    v_mfma_f32_16x16x32_bf16 v[108:111], v[64:67], v[160:163], v[108:111]
    v_mfma_f32_16x16x32_bf16 v[112:115], v[64:67], v[164:167], v[112:115]
    ds_read_b128 v[52:55], v8 offset:3072
    s_waitcnt lgkmcnt(4)
    v_mfma_f32_16x16x32_bf16 v[100:103], a[168:171], v[68:71], v[100:103]
    v_mfma_f32_16x16x32_bf16 v[104:107], a[172:175], v[68:71], v[104:107]
    v_mfma_f32_16x16x32_bf16 v[108:111], v[68:71], v[168:171], v[108:111]
    v_mfma_f32_16x16x32_bf16 v[112:115], v[68:71], v[172:175], v[112:115]
    ds_read_b128 v[56:59], v8 offset:5120
    s_waitcnt lgkmcnt(4)
    v_mfma_f32_16x16x32_bf16 v[100:103], a[176:179], v[72:75], v[100:103]
    v_mfma_f32_16x16x32_bf16 v[104:107], a[180:183], v[72:75], v[104:107]
    v_mfma_f32_16x16x32_bf16 v[108:111], v[72:75], v[176:179], v[108:111]
    v_mfma_f32_16x16x32_bf16 v[112:115], v[72:75], v[180:183], v[112:115]
    ds_read_b128 v[60:63], v8 offset:7168
    s_waitcnt lgkmcnt(4)
    v_mfma_f32_16x16x32_bf16 v[100:103], a[184:187], v[76:79], v[100:103]
    v_mfma_f32_16x16x32_bf16 v[104:107], a[188:191], v[76:79], v[104:107]
    v_mfma_f32_16x16x32_bf16 v[108:111], v[76:79], v[184:187], v[108:111]
    v_mfma_f32_16x16x32_bf16 v[112:115], v[76:79], v[188:191], v[112:115]
    ds_read_b128 v[64:67], v8 offset:1536
    s_waitcnt lgkmcnt(4)
    v_mfma_f32_16x16x32_bf16 v[100:103], a[192:195], v[48:51], v[100:103]
    v_mfma_f32_16x16x32_bf16 v[104:107], a[196:199], v[48:51], v[104:107]
    v_mfma_f32_16x16x32_bf16 v[108:111], v[48:51], v[192:195], v[108:111]
    v_mfma_f32_16x16x32_bf16 v[112:115], v[48:51], v[196:199], v[112:115]
    ds_read_b128 v[68:71], v8 offset:3584
    s_waitcnt lgkmcnt(4)
    v_mfma_f32_16x16x32_bf16 v[100:103], a[200:203], v[52:55], v[100:103]
    v_mfma_f32_16x16x32_bf16 v[104:107], a[204:207], v[52:55], v[104:107]
    v_mfma_f32_16x16x32_bf16 v[108:111], v[52:55], v[200:203], v[108:111]
    v_mfma_f32_16x16x32_bf16 v[112:115], v[52:55], v[204:207], v[112:115]
    ds_read_b128 v[72:75], v8 offset:5632
    s_waitcnt lgkmcnt(4)
    v_mfma_f32_16x16x32_bf16 v[100:103], a[208:211], v[56:59], v[100:103]
    v_mfma_f32_16x16x32_bf16 v[104:107], a[212:215], v[56:59], v[104:107]
    v_mfma_f32_16x16x32_bf16 v[108:111], v[56:59], v[208:211], v[108:111]
    v_mfma_f32_16x16x32_bf16 v[112:115], v[56:59], v[212:215], v[112:115]
    ds_read_b128 v[76:79], v8 offset:7680
    s_waitcnt lgkmcnt(4)
    v_mfma_f32_16x16x32_bf16 v[100:103], a[216:219], v[60:63], v[100:103]
    v_mfma_f32_16x16x32_bf16 v[104:107], a[220:223], v[60:63], v[104:107]
    v_mfma_f32_16x16x32_bf16 v[108:111], v[60:63], v[216:219], v[108:111]
    v_mfma_f32_16x16x32_bf16 v[112:115], v[60:63], v[220:223], v[112:115]
    s_waitcnt lgkmcnt(3)
    v_mfma_f32_16x16x32_bf16 v[100:103], a[224:227], v[64:67], v[100:103]
    v_mfma_f32_16x16x32_bf16 v[104:107], a[228:231], v[64:67], v[104:107]
    v_mfma_f32_16x16x32_bf16 v[108:111], v[64:67], v[224:227], v[108:111]
    v_mfma_f32_16x16x32_bf16 v[112:115], v[64:67], v[228:231], v[112:115]
    s_waitcnt lgkmcnt(2)
    v_mfma_f32_16x16x32_bf16 v[100:103], a[232:235], v[68:71], v[100:103]
    v_mfma_f32_16x16x32_bf16 v[104:107], a[236:239], v[68:71], v[104:107]
    v_mfma_f32_16x16x32_bf16 v[108:111], v[68:71], v[232:235], v[108:111]
    v_mfma_f32_16x16x32_bf16 v[112:115], v[68:71], v[236:239], v[112:115]
    s_waitcnt lgkmcnt(1)
    v_mfma_f32_16x16x32_bf16 v[100:103], a[240:243], v[72:75], v[100:103]
    v_mfma_f32_16x16x32_bf16 v[104:107], a[244:247], v[72:75], v[104:107]
    v_mfma_f32_16x16x32_bf16 v[108:111], v[72:75], v[240:243], v[108:111]
    v_mfma_f32_16x16x32_bf16 v[112:115], v[72:75], v[244:247], v[112:115]
    s_waitcnt lgkmcnt(0)
    v_mfma_f32_16x16x32_bf16 v[100:103], a[248:251], v[76:79], v[100:103]
    v_mfma_f32_16x16x32_bf16 v[104:107], a[252:255], v[76:79], v[104:107]
    v_mfma_f32_16x16x32_bf16 v[108:111], v[76:79], v[248:251], v[108:111]
    v_mfma_f32_16x16x32_bf16 v[112:115], v[76:79], v[252:255], v[112:115]
    s_nop 4
    v_mul_f32 v100, s33, v100
    v_mul_f32 v101, s33, v101
    v_mul_f32 v102, s33, v102
    v_mul_f32 v103, s33, v103
    v_mul_f32 v104, s33, v104
    v_mul_f32 v105, s33, v105
    v_mul_f32 v106, s33, v106
    v_mul_f32 v107, s33, v107
    v_cvt_pk_bf16_f32 v48, v100, v104
    v_cvt_pk_bf16_f32 v49, v101, v105
    v_cvt_pk_bf16_f32 v50, v102, v106
    v_cvt_pk_bf16_f32 v51, v103, v107
    ds_write_b128 v9, v[48:51] offset:16384
    v_cvt_pk_bf16_f32 v116, v108, v109
    v_cvt_pk_bf16_f32 v117, v110, v111
    v_cvt_pk_bf16_f32 v118, v112, v113
    v_cvt_pk_bf16_f32 v119, v114, v115
    s_waitcnt lgkmcnt(0)
    s_barrier
    ds_read_b128 v[64:67], v1 offset:16384
    ds_read_b128 v[68:71], v1 offset:17408
    ds_read_b128 v[72:75], v1 offset:18432
    ds_read_b128 v[76:79], v1 offset:19456
    v_cndmask_b32 v80, v13, v80, s[64:65]
    v_cndmask_b32 v81, v13, v81, s[66:67]
    v_cndmask_b32 v82, v13, v82, s[68:69]
    v_cndmask_b32 v83, v13, v83, s[70:71]
    v_cndmask_b32 v88, v13, v88, s[64:65]
    v_cndmask_b32 v89, v13, v89, s[66:67]
    v_cndmask_b32 v90, v13, v90, s[68:69]
    v_cndmask_b32 v91, v13, v91, s[70:71]
    s_waitcnt lgkmcnt(0)
    v_mfma_f32_16x16x32_bf16 v[92:95], v[64:67], v[16:19], 0
    v_mfma_f32_16x16x32_bf16 v[92:95], v[68:71], v[20:23], v[92:95]
    v_mfma_f32_16x16x32_bf16 v[92:95], v[72:75], v[24:27], v[92:95]
    v_mfma_f32_16x16x32_bf16 v[92:95], v[76:79], v[28:31], v[92:95]
    v_mfma_f32_16x16x32_bf16 v[96:99], v[64:67], v[32:35], 0
    v_mfma_f32_16x16x32_bf16 v[96:99], v[68:71], v[36:39], v[96:99]
    v_mfma_f32_16x16x32_bf16 v[96:99], v[72:75], v[40:43], v[96:99]
    v_mfma_f32_16x16x32_bf16 v[96:99], v[76:79], v[44:47], v[96:99]
    s_nop 3
    v_cndmask_b32 v92, v13, v92, s[72:73]
    v_cndmask_b32 v93, v13, v93, s[72:73]
    v_cndmask_b32 v94, v13, v94, s[72:73]
    v_cndmask_b32 v95, v13, v95, s[72:73]
    v_cndmask_b32 v96, v13, v96, s[72:73]
    v_cndmask_b32 v97, v13, v97, s[72:73]
    v_cndmask_b32 v98, v13, v98, s[72:73]
    v_cndmask_b32 v99, v13, v99, s[72:73]
    v_max_f32 v48, v80, v81
    v_max3_f32 v48, v48, v82, v83
    v_max3_f32 v48, v48, v92, v93
    v_max3_f32 v48, v48, v94, v95
    v_max_f32 v49, v84, v85
    v_max3_f32 v49, v49, v86, v87
    v_max3_f32 v49, v49, v88, v89
    v_max3_f32 v49, v49, v90, v91
    v_max3_f32 v49, v49, v96, v97
    v_max3_f32 v49, v49, v98, v99
    v_mov_b32 v14, v48
    s_nop 1
    v_permlane16_swap_b32 v48, v14
    v_max_f32 v48, v48, v14
    v_mov_b32 v14, v49
    s_nop 1
    v_permlane16_swap_b32 v49, v14
    v_max_f32 v49, v49, v14
    v_mov_b32 v14, v48
    s_nop 1
    v_permlane32_swap_b32 v48, v14
    v_max_f32 v48, v48, v14
    v_mov_b32 v14, v49
    s_nop 1
    v_permlane32_swap_b32 v49, v14
    v_max_f32 v49, v49, v14
    v_sub_f32 v80, v80, v48
    v_exp_f32 v80, v80
    v_sub_f32 v81, v81, v48
    v_exp_f32 v81, v81
    v_sub_f32 v82, v82, v48
    v_exp_f32 v82, v82
    v_sub_f32 v83, v83, v48
    v_exp_f32 v83, v83
    v_sub_f32 v92, v92, v48
    v_exp_f32 v92, v92
    v_sub_f32 v93, v93, v48
    v_exp_f32 v93, v93
    v_sub_f32 v94, v94, v48
    v_exp_f32 v94, v94
    v_sub_f32 v95, v95, v48
    v_exp_f32 v95, v95
    v_sub_f32 v84, v84, v49
    v_exp_f32 v84, v84
    v_sub_f32 v85, v85, v49
    v_exp_f32 v85, v85
    v_sub_f32 v86, v86, v49
    v_exp_f32 v86, v86
    v_sub_f32 v87, v87, v49
    v_exp_f32 v87, v87
    v_sub_f32 v88, v88, v49
    v_exp_f32 v88, v88
    v_sub_f32 v89, v89, v49
    v_exp_f32 v89, v89
    v_sub_f32 v90, v90, v49
    v_exp_f32 v90, v90
    v_sub_f32 v91, v91, v49
    v_exp_f32 v91, v91
    v_sub_f32 v96, v96, v49
    v_exp_f32 v96, v96
    v_sub_f32 v97, v97, v49
    v_exp_f32 v97, v97
    v_sub_f32 v98, v98, v49
    v_exp_f32 v98, v98
    v_sub_f32 v99, v99, v49
    v_exp_f32 v99, v99
    v_cvt_pk_bf16_f32 v16, v80, v81
    v_cvt_pk_bf16_f32 v17, v82, v83
    v_mov_b64 v[18:19], 0
    v_cvt_pk_bf16_f32 v20, v84, v85
    v_cvt_pk_bf16_f32 v21, v86, v87
    v_cvt_pk_bf16_f32 v22, v88, v89
    v_cvt_pk_bf16_f32 v23, v90, v91
    v_cvt_pk_bf16_f32 v24, v92, v93
    v_cvt_pk_bf16_f32 v25, v94, v95
    v_cvt_pk_bf16_f32 v26, v96, v97
    v_cvt_pk_bf16_f32 v27, v98, v99
    v_mov_b64 v[28:29], s[4:5]
    v_mov_b64 v[30:31], s[4:5]
    s_nop 1
    v_mfma_f32_16x16x32_bf16 v[32:35], v[28:31], v[16:19], 0
    v_mfma_f32_16x16x32_bf16 v[40:43], v[120:123], v[16:19], 0
    v_mfma_f32_16x16x32_bf16 v[44:47], v[124:127], v[16:19], 0
    v_mfma_f32_16x16x32_bf16 v[36:39], v[28:31], v[20:23], 0
    v_mfma_f32_16x16x32_bf16 v[48:51], v[120:123], v[20:23], 0
    v_mfma_f32_16x16x32_bf16 v[52:55], v[124:127], v[20:23], 0
    s_nop 0
    v_mfma_f32_16x16x16_bf16 v[32:35], v[28:29], v[24:25], v[32:35]
    v_mfma_f32_16x16x16_bf16 v[40:43], v[116:117], v[24:25], v[40:43]
    v_mfma_f32_16x16x16_bf16 v[44:47], v[118:119], v[24:25], v[44:47]
    v_mfma_f32_16x16x16_bf16 v[36:39], v[28:29], v[26:27], v[36:39]
    v_mfma_f32_16x16x16_bf16 v[48:51], v[116:117], v[26:27], v[48:51]
    v_mfma_f32_16x16x16_bf16 v[52:55], v[118:119], v[26:27], v[52:55]
    s_nop 2
    v_rcp_f32 v14, v32
    s_nop 0
    v_mul_f32 v40, v40, v14
    v_mul_f32 v41, v41, v14
    v_mul_f32 v42, v42, v14
    v_mul_f32 v43, v43, v14
    v_mul_f32 v44, v44, v14
    v_mul_f32 v45, v45, v14
    v_mul_f32 v46, v46, v14
    v_mul_f32 v47, v47, v14
    v_cvt_pk_bf16_f32 v56, v40, v44
    v_cvt_pk_bf16_f32 v57, v41, v45
    v_cvt_pk_bf16_f32 v58, v42, v46
    v_cvt_pk_bf16_f32 v59, v43, v47
    ds_write_b128 v9, v[56:59] offset:0
    v_rcp_f32 v14, v36
    s_nop 0
    v_mul_f32 v48, v48, v14
    v_mul_f32 v49, v49, v14
    v_mul_f32 v50, v50, v14
    v_mul_f32 v51, v51, v14
    v_mul_f32 v52, v52, v14
    v_mul_f32 v53, v53, v14
    v_mul_f32 v54, v54, v14
    v_mul_f32 v55, v55, v14
    v_cvt_pk_bf16_f32 v60, v48, v52
    v_cvt_pk_bf16_f32 v61, v49, v53
    v_cvt_pk_bf16_f32 v62, v50, v54
    v_cvt_pk_bf16_f32 v63, v51, v55
    ds_write_b128 v9, v[60:63] offset:4096
    s_waitcnt lgkmcnt(0)
    s_barrier
    ds_read_b128 v[16:19], v1 offset:0
    ds_read_b128 v[20:23], v1 offset:1024
    ds_read_b128 v[24:27], v1 offset:2048
    ds_read_b128 v[28:31], v1 offset:3072
    ds_read_b128 v[32:35], v1 offset:4096
    ds_read_b128 v[36:39], v1 offset:5120
    ds_read_b128 v[40:43], v1 offset:6144
    ds_read_b128 v[44:47], v1 offset:7168
    ds_read_b128 v[48:51], v7 offset:0
    ds_read_b128 v[52:55], v7 offset:1024
    ds_read_b128 v[56:59], v7 offset:2048
    ds_read_b128 v[60:63], v7 offset:3072
    s_waitcnt lgkmcnt(3)
    v_mfma_f32_16x16x32_bf16 v[64:67], v[16:19], v[48:51], 0
    v_mfma_f32_16x16x32_bf16 v[96:99], v[32:35], v[48:51], 0
    ds_read_b128 v[48:51], v7 offset:4096
    s_waitcnt lgkmcnt(3)
    v_mfma_f32_16x16x32_bf16 v[68:71], v[16:19], v[52:55], 0
    v_mfma_f32_16x16x32_bf16 v[100:103], v[32:35], v[52:55], 0
    ds_read_b128 v[52:55], v7 offset:5120
    s_waitcnt lgkmcnt(3)
    v_mfma_f32_16x16x32_bf16 v[72:75], v[16:19], v[56:59], 0
    v_mfma_f32_16x16x32_bf16 v[104:107], v[32:35], v[56:59], 0
    ds_read_b128 v[56:59], v7 offset:6144
    s_waitcnt lgkmcnt(3)
    v_mfma_f32_16x16x32_bf16 v[76:79], v[16:19], v[60:63], 0
    v_mfma_f32_16x16x32_bf16 v[108:111], v[32:35], v[60:63], 0
    ds_read_b128 v[60:63], v7 offset:7168
    s_waitcnt lgkmcnt(3)
    v_mfma_f32_16x16x32_bf16 v[80:83], v[16:19], v[48:51], 0
    v_mfma_f32_16x16x32_bf16 v[112:115], v[32:35], v[48:51], 0
    ds_read_b128 v[48:51], v7 offset:8192
    s_waitcnt lgkmcnt(3)
    v_mfma_f32_16x16x32_bf16 v[84:87], v[16:19], v[52:55], 0
    v_mfma_f32_16x16x32_bf16 v[116:119], v[32:35], v[52:55], 0
    ds_read_b128 v[52:55], v7 offset:9216
    s_waitcnt lgkmcnt(3)
    v_mfma_f32_16x16x32_bf16 v[88:91], v[16:19], v[56:59], 0
    v_mfma_f32_16x16x32_bf16 v[120:123], v[32:35], v[56:59], 0
    ds_read_b128 v[56:59], v7 offset:10240
    s_waitcnt lgkmcnt(3)
    v_mfma_f32_16x16x32_bf16 v[92:95], v[16:19], v[60:63], 0
    v_mfma_f32_16x16x32_bf16 v[124:127], v[32:35], v[60:63], 0
    ds_read_b128 v[60:63], v7 offset:11264
    s_waitcnt lgkmcnt(3)
    v_mfma_f32_16x16x32_bf16 v[64:67], v[20:23], v[48:51], v[64:67]
    v_mfma_f32_16x16x32_bf16 v[96:99], v[36:39], v[48:51], v[96:99]
    ds_read_b128 v[48:51], v7 offset:12288
    s_waitcnt lgkmcnt(3)
    v_mfma_f32_16x16x32_bf16 v[68:71], v[20:23], v[52:55], v[68:71]
    v_mfma_f32_16x16x32_bf16 v[100:103], v[36:39], v[52:55], v[100:103]
    ds_read_b128 v[52:55], v7 offset:13312
    s_waitcnt lgkmcnt(3)
    v_mfma_f32_16x16x32_bf16 v[72:75], v[20:23], v[56:59], v[72:75]
    v_mfma_f32_16x16x32_bf16 v[104:107], v[36:39], v[56:59], v[104:107]
    ds_read_b128 v[56:59], v7 offset:14336
    s_waitcnt lgkmcnt(3)
    v_mfma_f32_16x16x32_bf16 v[76:79], v[20:23], v[60:63], v[76:79]
    v_mfma_f32_16x16x32_bf16 v[108:111], v[36:39], v[60:63], v[108:111]
    ds_read_b128 v[60:63], v7 offset:15360
    s_waitcnt lgkmcnt(3)
    v_mfma_f32_16x16x32_bf16 v[80:83], v[20:23], v[48:51], v[80:83]
    v_mfma_f32_16x16x32_bf16 v[112:115], v[36:39], v[48:51], v[112:115]
    ds_read_b128 v[48:51], v7 offset:16384
    s_waitcnt lgkmcnt(3)
    v_mfma_f32_16x16x32_bf16 v[84:87], v[20:23], v[52:55], v[84:87]
    v_mfma_f32_16x16x32_bf16 v[116:119], v[36:39], v[52:55], v[116:119]
    ds_read_b128 v[52:55], v7 offset:17408
    s_waitcnt lgkmcnt(3)
    v_mfma_f32_16x16x32_bf16 v[88:91], v[20:23], v[56:59], v[88:91]
    v_mfma_f32_16x16x32_bf16 v[120:123], v[36:39], v[56:59], v[120:123]
    ds_read_b128 v[56:59], v7 offset:18432
    s_waitcnt lgkmcnt(3)
    v_mfma_f32_16x16x32_bf16 v[92:95], v[20:23], v[60:63], v[92:95]
    v_mfma_f32_16x16x32_bf16 v[124:127], v[36:39], v[60:63], v[124:127]
    ds_read_b128 v[60:63], v7 offset:19456
    s_waitcnt lgkmcnt(3)
    v_mfma_f32_16x16x32_bf16 v[64:67], v[24:27], v[48:51], v[64:67]
    v_mfma_f32_16x16x32_bf16 v[96:99], v[40:43], v[48:51], v[96:99]
    ds_read_b128 v[48:51], v7 offset:20480
    s_waitcnt lgkmcnt(3)
    v_mfma_f32_16x16x32_bf16 v[68:71], v[24:27], v[52:55], v[68:71]
    v_mfma_f32_16x16x32_bf16 v[100:103], v[40:43], v[52:55], v[100:103]
    ds_read_b128 v[52:55], v7 offset:21504
    s_waitcnt lgkmcnt(3)
    v_mfma_f32_16x16x32_bf16 v[72:75], v[24:27], v[56:59], v[72:75]
    v_mfma_f32_16x16x32_bf16 v[104:107], v[40:43], v[56:59], v[104:107]
    ds_read_b128 v[56:59], v7 offset:22528
    s_waitcnt lgkmcnt(3)
    v_mfma_f32_16x16x32_bf16 v[76:79], v[24:27], v[60:63], v[76:79]
    v_mfma_f32_16x16x32_bf16 v[108:111], v[40:43], v[60:63], v[108:111]
    ds_read_b128 v[60:63], v7 offset:23552
    s_waitcnt lgkmcnt(3)
    v_mfma_f32_16x16x32_bf16 v[80:83], v[24:27], v[48:51], v[80:83]
    v_mfma_f32_16x16x32_bf16 v[112:115], v[40:43], v[48:51], v[112:115]
    ds_read_b128 v[48:51], v7 offset:24576
    s_waitcnt lgkmcnt(3)
    v_mfma_f32_16x16x32_bf16 v[84:87], v[24:27], v[52:55], v[84:87]
    v_mfma_f32_16x16x32_bf16 v[116:119], v[40:43], v[52:55], v[116:119]
    ds_read_b128 v[52:55], v7 offset:25600
    s_waitcnt lgkmcnt(3)
    v_mfma_f32_16x16x32_bf16 v[88:91], v[24:27], v[56:59], v[88:91]
    v_mfma_f32_16x16x32_bf16 v[120:123], v[40:43], v[56:59], v[120:123]
    ds_read_b128 v[56:59], v7 offset:26624
    s_waitcnt lgkmcnt(3)
    v_mfma_f32_16x16x32_bf16 v[92:95], v[24:27], v[60:63], v[92:95]
    v_mfma_f32_16x16x32_bf16 v[124:127], v[40:43], v[60:63], v[124:127]
    ds_read_b128 v[60:63], v7 offset:27648
    s_waitcnt lgkmcnt(3)
    v_mfma_f32_16x16x32_bf16 v[64:67], v[28:31], v[48:51], v[64:67]
    v_mfma_f32_16x16x32_bf16 v[96:99], v[44:47], v[48:51], v[96:99]
    ds_read_b128 v[48:51], v7 offset:28672
    s_waitcnt lgkmcnt(3)
    v_mfma_f32_16x16x32_bf16 v[68:71], v[28:31], v[52:55], v[68:71]
    v_mfma_f32_16x16x32_bf16 v[100:103], v[44:47], v[52:55], v[100:103]
    ds_read_b128 v[52:55], v7 offset:29696
    s_waitcnt lgkmcnt(3)
    v_mfma_f32_16x16x32_bf16 v[72:75], v[28:31], v[56:59], v[72:75]
    v_mfma_f32_16x16x32_bf16 v[104:107], v[44:47], v[56:59], v[104:107]
    ds_read_b128 v[56:59], v7 offset:30720
    s_waitcnt lgkmcnt(3)
    v_mfma_f32_16x16x32_bf16 v[76:79], v[28:31], v[60:63], v[76:79]
    v_mfma_f32_16x16x32_bf16 v[108:111], v[44:47], v[60:63], v[108:111]
    ds_read_b128 v[60:63], v7 offset:31744
    s_waitcnt lgkmcnt(3)
    v_mfma_f32_16x16x32_bf16 v[80:83], v[28:31], v[48:51], v[80:83]
    v_mfma_f32_16x16x32_bf16 v[112:115], v[44:47], v[48:51], v[112:115]
    s_waitcnt lgkmcnt(2)
    v_mfma_f32_16x16x32_bf16 v[84:87], v[28:31], v[52:55], v[84:87]
    v_mfma_f32_16x16x32_bf16 v[116:119], v[44:47], v[52:55], v[116:119]
    s_waitcnt lgkmcnt(1)
    v_mfma_f32_16x16x32_bf16 v[88:91], v[28:31], v[56:59], v[88:91]
    v_mfma_f32_16x16x32_bf16 v[120:123], v[44:47], v[56:59], v[120:123]
    s_waitcnt lgkmcnt(0)
    v_mfma_f32_16x16x32_bf16 v[92:95], v[28:31], v[60:63], v[92:95]
    v_mfma_f32_16x16x32_bf16 v[124:127], v[44:47], v[60:63], v[124:127]
    s_lshl_b32 s24, s23, 20
    s_lshl_b32 s36, s20, 10
    s_add_u32 s24, s24, s36
    s_add_u32 s24, s24, 0x4000000
    v_cvt_pk_bf16_f32 v16, v64, v68
    v_cvt_pk_bf16_f32 v17, v72, v76
    v_cvt_pk_bf16_f32 v18, v80, v84
    v_cvt_pk_bf16_f32 v19, v88, v92
    s_add_u32 s36, s24, 0x0
    buffer_store_dwordx4 v[16:19], v10, s[8:11], s36 offen sc1
    v_cvt_pk_bf16_f32 v20, v65, v69
    v_cvt_pk_bf16_f32 v21, v73, v77
    v_cvt_pk_bf16_f32 v22, v81, v85
    v_cvt_pk_bf16_f32 v23, v89, v93
    s_add_u32 s36, s24, 0x8000
    buffer_store_dwordx4 v[20:23], v10, s[8:11], s36 offen sc1
    v_cvt_pk_bf16_f32 v24, v66, v70
    v_cvt_pk_bf16_f32 v25, v74, v78
    v_cvt_pk_bf16_f32 v26, v82, v86
    v_cvt_pk_bf16_f32 v27, v90, v94
    s_add_u32 s36, s24, 0x10000
    buffer_store_dwordx4 v[24:27], v10, s[8:11], s36 offen sc1
    v_cvt_pk_bf16_f32 v28, v67, v71
    v_cvt_pk_bf16_f32 v29, v75, v79
    v_cvt_pk_bf16_f32 v30, v83, v87
    v_cvt_pk_bf16_f32 v31, v91, v95
    s_add_u32 s36, s24, 0x18000
    buffer_store_dwordx4 v[28:31], v10, s[8:11], s36 offen sc1
    v_cvt_pk_bf16_f32 v32, v96, v100
    v_cvt_pk_bf16_f32 v33, v104, v108
    v_cvt_pk_bf16_f32 v34, v112, v116
    v_cvt_pk_bf16_f32 v35, v120, v124
    s_add_u32 s36, s24, 0x80000
    buffer_store_dwordx4 v[32:35], v10, s[8:11], s36 offen sc1
    v_cvt_pk_bf16_f32 v36, v97, v101
    v_cvt_pk_bf16_f32 v37, v105, v109
    v_cvt_pk_bf16_f32 v38, v113, v117
    v_cvt_pk_bf16_f32 v39, v121, v125
    s_add_u32 s36, s24, 0x88000
    buffer_store_dwordx4 v[36:39], v10, s[8:11], s36 offen sc1
    v_cvt_pk_bf16_f32 v40, v98, v102
    v_cvt_pk_bf16_f32 v41, v106, v110
    v_cvt_pk_bf16_f32 v42, v114, v118
    v_cvt_pk_bf16_f32 v43, v122, v126
    s_add_u32 s36, s24, 0x90000
    buffer_store_dwordx4 v[40:43], v10, s[8:11], s36 offen sc1
    v_cvt_pk_bf16_f32 v44, v99, v103
    v_cvt_pk_bf16_f32 v45, v107, v111
    v_cvt_pk_bf16_f32 v46, v115, v119
    v_cvt_pk_bf16_f32 v47, v123, v127
    s_add_u32 s36, s24, 0x98000
    buffer_store_dwordx4 v[44:47], v10, s[8:11], s36 offen sc1
    s_lshl_b32 s25, s23, 7
    s_add_u32 s25, s25, 0x192000
    s_lshl_b32 s36, s20, 2
    s_add_u32 s24, s25, s36
    s_waitcnt vmcnt(0)
    s_barrier
    v_cmp_ne_u32 vcc, 0, v0
    v_mov_b32 v15, 0x40000000
    v_mov_b32 v14, 1
    v_cndmask_b32 v15, v0, v15, vcc
    buffer_store_dword v14, v15, s[8:11], s24 offen sc1
    v_and_b32 v15, 15, v0
    v_mov_b32 v48, 0
    v_mov_b32 v14, 0x3f80
    v_cmp_eq_u32 vcc, 0, v15
    s_nop 1
    v_cndmask_b32 v48, v48, v14, vcc
    v_mov_b32 v14, 0x3f800000
    v_cmp_eq_u32 vcc, 1, v15
    s_nop 1
    v_cndmask_b32 v48, v48, v14, vcc
    v_mov_b32 v49, 0
    v_mov_b32 v14, 0x3f80
    v_cmp_eq_u32 vcc, 4, v15
    s_nop 1
    v_cndmask_b32 v49, v49, v14, vcc
    v_mov_b32 v14, 0x3f800000
    v_cmp_eq_u32 vcc, 5, v15
    s_nop 1
    v_cndmask_b32 v49, v49, v14, vcc
    v_mov_b32 v50, 0
    v_mov_b32 v14, 0x3f80
    v_cmp_eq_u32 vcc, 8, v15
    s_nop 1
    v_cndmask_b32 v50, v50, v14, vcc
    v_mov_b32 v14, 0x3f800000
    v_cmp_eq_u32 vcc, 9, v15
    s_nop 1
    v_cndmask_b32 v50, v50, v14, vcc
    v_mov_b32 v51, 0
    v_mov_b32 v14, 0x3f80
    v_cmp_eq_u32 vcc, 12, v15
    s_nop 1
    v_cndmask_b32 v51, v51, v14, vcc
    v_mov_b32 v14, 0x3f800000
    v_cmp_eq_u32 vcc, 13, v15
    s_nop 1
    v_cndmask_b32 v51, v51, v14, vcc
    s_lshl_b32 s24, s23, 5
    s_add_u32 s24, s24, s20
    s_lshl_b32 s24, s24, 10
    buffer_load_dword v52, v12, s[12:15], s24 offen
    buffer_load_dword v53, v12, s[92:95], 0 offen
    v_lshrrev_b32 v15, 2, v1
    v_and_b32 v15, 127, v15
L_P3_poll:
    buffer_load_dword v14, v15, s[8:11], s25 offen sc1
    s_add_u32 s32, s32, 1
    s_cmp_gt_u32 s32, 200000
    s_waitcnt vmcnt(0)
    s_cbranch_scc1 L_P3_got
    v_cmp_eq_u32 vcc, 0, v14
    s_cbranch_vccnz L_P3_poll
L_P3_got:
    s_lshl_b32 s36, s24, 5
    s_add_u32 s36, s36, 0x4000000
    buffer_load_dwordx4 v[16:19], v11, s[8:11], s36 offen sc1
    s_add_u32 s36, s36, 4096
    buffer_load_dwordx4 v[20:23], v11, s[8:11], s36 offen sc1
    s_add_u32 s36, s36, 4096
    buffer_load_dwordx4 v[24:27], v11, s[8:11], s36 offen sc1
    s_add_u32 s36, s36, 4096
    buffer_load_dwordx4 v[28:31], v11, s[8:11], s36 offen sc1
    s_add_u32 s36, s36, 4096
    buffer_load_dwordx4 v[32:35], v11, s[8:11], s36 offen sc1
    s_add_u32 s36, s36, 4096
    buffer_load_dwordx4 v[36:39], v11, s[8:11], s36 offen sc1
    s_add_u32 s36, s36, 4096
    buffer_load_dwordx4 v[40:43], v11, s[8:11], s36 offen sc1
    s_add_u32 s36, s36, 4096
    buffer_load_dwordx4 v[44:47], v11, s[8:11], s36 offen sc1
    s_waitcnt vmcnt(7)
    v_mfma_f32_16x16x32_bf16 v[56:59], v[48:51], v[16:19], 0
    s_waitcnt vmcnt(6)
    v_mfma_f32_16x16x32_bf16 v[56:59], v[48:51], v[20:23], v[56:59]
    s_waitcnt vmcnt(5)
    v_mfma_f32_16x16x32_bf16 v[56:59], v[48:51], v[24:27], v[56:59]
    s_waitcnt vmcnt(4)
    v_mfma_f32_16x16x32_bf16 v[56:59], v[48:51], v[28:31], v[56:59]
    s_waitcnt vmcnt(3)
    v_mfma_f32_16x16x32_bf16 v[56:59], v[48:51], v[32:35], v[56:59]
    s_waitcnt vmcnt(2)
    v_mfma_f32_16x16x32_bf16 v[56:59], v[48:51], v[36:39], v[56:59]
    s_waitcnt vmcnt(1)
    v_mfma_f32_16x16x32_bf16 v[56:59], v[48:51], v[40:43], v[56:59]
    s_waitcnt vmcnt(0)
    v_mfma_f32_16x16x32_bf16 v[56:59], v[48:51], v[44:47], v[56:59]
    s_nop 7
    v_cvt_pk_bf16_f32 v62, v56, v57
    v_lshlrev_b32 v65, 16, v62
    v_and_b32 v66, 0xffff0000, v62
    v_lshlrev_b32 v60, 16, v52
    v_and_b32 v61, 0xffff0000, v52
    v_add_f32 v60, v60, v65
    v_add_f32 v61, v61, v66
    v_cvt_pk_bf16_f32 v62, v60, v61
    v_lshlrev_b32 v60, 16, v62
    v_and_b32 v61, 0xffff0000, v62
    v_add_f32 v63, v60, v61
    v_mul_f32 v64, v60, v60
    v_fmac_f32 v64, v61, v61
    v_add_f32_dpp v63, v63, v63 quad_perm:[1,0,3,2] row_mask:0xf bank_mask:0xf
    s_nop 0
    v_add_f32_dpp v64, v64, v64 quad_perm:[1,0,3,2] row_mask:0xf bank_mask:0xf
    v_add_f32_dpp v63, v63, v63 quad_perm:[2,3,0,1] row_mask:0xf bank_mask:0xf
    s_nop 0
    v_add_f32_dpp v64, v64, v64 quad_perm:[2,3,0,1] row_mask:0xf bank_mask:0xf
    v_add_f32_dpp v63, v63, v63 row_half_mirror row_mask:0xf bank_mask:0xf
    s_nop 0
    v_add_f32_dpp v64, v64, v64 row_half_mirror row_mask:0xf bank_mask:0xf
    v_add_f32_dpp v63, v63, v63 row_mirror row_mask:0xf bank_mask:0xf
    s_nop 0
    v_add_f32_dpp v64, v64, v64 row_mirror row_mask:0xf bank_mask:0xf
    v_mov_b32 v14, v63
    s_nop 1
    v_permlane16_swap_b32 v63, v14
    v_add_f32 v63, v63, v14
    v_mov_b32 v14, v64
    s_nop 1
    v_permlane16_swap_b32 v64, v14
    v_add_f32 v64, v64, v14
    v_mov_b32 v14, v63
    s_nop 1
    v_permlane32_swap_b32 v63, v14
    v_add_f32 v63, v63, v14
    v_mov_b32 v14, v64
    s_nop 1
    v_permlane32_swap_b32 v64, v14
    v_add_f32 v64, v64, v14
    v_mov_b32 v15, s21
    v_lshlrev_b32 v15, 3, v15
    v_add_u32 v15, 28672, v15
    ds_write2_b32 v15, v63, v64 offset0:0 offset1:1
    s_add_u32 s36, s24, 0x400000
    buffer_store_dword v62, v12, s[8:11], s36 offen sc1
    s_waitcnt lgkmcnt(0)
    s_barrier
    v_mov_b32 v15, 28672
    ds_read_b128 v[68:71], v15
    ds_read_b128 v[72:75], v15 offset:16
    s_waitcnt lgkmcnt(0)
    v_add_f32 v63, v68, v70
    v_add_f32 v63, v63, v72
    v_add_f32 v63, v63, v74
    v_mul_f32 v63, 0x3b000000, v63
    v_add_f32 v64, v69, v71
    v_add_f32 v64, v64, v73
    v_add_f32 v64, v64, v75
    v_mul_f32 v64, 0x3b000000, v64
    v_fma_f32 v64, -v63, v63, v64
    v_max_f32 v64, 0, v64
    v_cvt_pk_bf16_f32 v14, v63, v64
    v_lshlrev_b32 v63, 16, v14
    v_and_b32 v64, 0xffff0000, v14
    v_add_f32 v64, 0x3727c5ac, v64
    v_cvt_pk_bf16_f32 v14, v64, v64
    v_lshlrev_b32 v64, 16, v14
    v_sqrt_f32 v64, v64
    s_nop 0
    v_cvt_pk_bf16_f32 v14, v64, v64
    v_lshlrev_b32 v64, 16, v14
    v_rcp_f32 v64, v64
    v_sub_f32 v65, v60, v63
    v_sub_f32 v66, v61, v63
    v_cvt_pk_bf16_f32 v14, v65, v66
    v_lshlrev_b32 v65, 16, v14
    v_and_b32 v66, 0xffff0000, v14
    v_mul_f32 v65, v65, v64
    v_mul_f32 v66, v66, v64
    v_cvt_pk_bf16_f32 v67, v65, v66
    v_lshlrev_b32 v65, 16, v67
    v_and_b32 v66, 0xffff0000, v67
    s_add_u32 s36, s24, 0x600000
    buffer_store_dword v67, v12, s[8:11], s36 offen sc1
    v_add_f32 v60, v60, v65
    v_add_f32 v61, v61, v66
    v_cvt_pk_bf16_f32 v62, v60, v61
    buffer_store_dword v62, v12, s[60:63], s24 offen sc1
    v_lshlrev_b32 v60, 16, v53
    v_and_b32 v61, 0xffff0000, v53
    v_mul_f32 v63, v65, v60
    v_fmac_f32 v63, v66, v61
    s_nop 1
    v_add_f32_dpp v63, v63, v63 quad_perm:[1,0,3,2] row_mask:0xf bank_mask:0xf
    s_nop 1
    v_add_f32_dpp v63, v63, v63 quad_perm:[2,3,0,1] row_mask:0xf bank_mask:0xf
    s_nop 1
    v_add_f32_dpp v63, v63, v63 row_half_mirror row_mask:0xf bank_mask:0xf
    s_nop 1
    v_add_f32_dpp v63, v63, v63 row_mirror row_mask:0xf bank_mask:0xf
    v_mov_b32 v14, v63
    s_nop 1
    v_permlane16_swap_b32 v63, v14
    v_add_f32 v63, v63, v14
    v_mov_b32 v14, v63
    s_nop 1
    v_permlane32_swap_b32 v63, v14
    v_add_f32 v63, v63, v14
    s_lshr_b32 s36, s24, 6
    s_lshl_b32 s37, s21, 2
    s_add_u32 s36, s36, s37
    s_add_u32 s36, s36, 0x194000
    v_cmp_ne_u32 vcc, 0, v1
    v_mov_b32 v15, 0x40000000
    s_nop 0
    v_cndmask_b32 v15, v1, v15, vcc
    s_waitcnt vmcnt(0)
    buffer_store_dword v63, v15, s[8:11], s36 offen sc1
    s_barrier
    s_add_u32 s23, s23, 7
    s_cmp_lt_u32 s23, 64
    s_cbranch_scc1 L_P2
    s_cmp_eq_u32 s22, 3
    s_cbranch_scc1 L_stageB
    s_sub_u32 s25, s22, 1
    s_cmp_ge_u32 s25, 2
    s_cbranch_scc1 L_end
    s_cmp_ge_u32 s20, 28
    s_cbranch_scc1 L_end
    s_lshl_b32 s3, s20, 1
    s_add_u32 s25, s25, s3
    s_mov_b32 s64, s84
    s_and_b32 s65, s85, 0xffff
    s_mov_b32 s66, 0x1c0000
    s_mov_b32 s67, 0x20000
    s_mov_b32 s68, s86
    s_and_b32 s69, s87, 0xffff
    s_mov_b32 s70, 0x1c0000
    s_mov_b32 s71, 0x20000
    v_lshrrev_b32 v1, 4, v0
    v_and_b32 v2, 15, v0
    s_mov_b32 s36, 114688
    v_mul_lo_u32 v4, v1, s36
    v_lshl_add_u32 v4, v2, 2, v4
    s_lshl_b32 s37, s25, 6
    s_add_u32 s36, s37, 0
    buffer_load_dword v16, v4, s[64:67], s36 offen
    buffer_load_dword v48, v4, s[68:71], s36 offen
    s_add_u32 s36, s37, 3584
    buffer_load_dword v17, v4, s[64:67], s36 offen
    buffer_load_dword v49, v4, s[68:71], s36 offen
    s_add_u32 s36, s37, 7168
    buffer_load_dword v18, v4, s[64:67], s36 offen
    buffer_load_dword v50, v4, s[68:71], s36 offen
    s_add_u32 s36, s37, 10752
    buffer_load_dword v19, v4, s[64:67], s36 offen
    buffer_load_dword v51, v4, s[68:71], s36 offen
    s_add_u32 s36, s37, 14336
    buffer_load_dword v20, v4, s[64:67], s36 offen
    buffer_load_dword v52, v4, s[68:71], s36 offen
    s_add_u32 s36, s37, 17920
    buffer_load_dword v21, v4, s[64:67], s36 offen
    buffer_load_dword v53, v4, s[68:71], s36 offen
    s_add_u32 s36, s37, 21504
    buffer_load_dword v22, v4, s[64:67], s36 offen
    buffer_load_dword v54, v4, s[68:71], s36 offen
    s_add_u32 s36, s37, 25088
    buffer_load_dword v23, v4, s[64:67], s36 offen
    buffer_load_dword v55, v4, s[68:71], s36 offen
    s_add_u32 s36, s37, 28672
    buffer_load_dword v24, v4, s[64:67], s36 offen
    buffer_load_dword v56, v4, s[68:71], s36 offen
    s_add_u32 s36, s37, 32256
    buffer_load_dword v25, v4, s[64:67], s36 offen
    buffer_load_dword v57, v4, s[68:71], s36 offen
    s_add_u32 s36, s37, 35840
    buffer_load_dword v26, v4, s[64:67], s36 offen
    buffer_load_dword v58, v4, s[68:71], s36 offen
    s_add_u32 s36, s37, 39424
    buffer_load_dword v27, v4, s[64:67], s36 offen
    buffer_load_dword v59, v4, s[68:71], s36 offen
    s_add_u32 s36, s37, 43008
    buffer_load_dword v28, v4, s[64:67], s36 offen
    buffer_load_dword v60, v4, s[68:71], s36 offen
    s_add_u32 s36, s37, 46592
    buffer_load_dword v29, v4, s[64:67], s36 offen
    buffer_load_dword v61, v4, s[68:71], s36 offen
    s_add_u32 s36, s37, 50176
    buffer_load_dword v30, v4, s[64:67], s36 offen
    buffer_load_dword v62, v4, s[68:71], s36 offen
    s_add_u32 s36, s37, 53760
    buffer_load_dword v31, v4, s[64:67], s36 offen
    buffer_load_dword v63, v4, s[68:71], s36 offen
    s_waitcnt vmcnt(16)
    s_add_u32 s36, s37, 57344
    buffer_load_dword v32, v4, s[64:67], s36 offen
    buffer_load_dword v64, v4, s[68:71], s36 offen
    s_add_u32 s36, s37, 60928
    buffer_load_dword v33, v4, s[64:67], s36 offen
    buffer_load_dword v65, v4, s[68:71], s36 offen
    s_add_u32 s36, s37, 64512
    buffer_load_dword v34, v4, s[64:67], s36 offen
    buffer_load_dword v66, v4, s[68:71], s36 offen
    s_add_u32 s36, s37, 68096
    buffer_load_dword v35, v4, s[64:67], s36 offen
    buffer_load_dword v67, v4, s[68:71], s36 offen
    s_add_u32 s36, s37, 71680
    buffer_load_dword v36, v4, s[64:67], s36 offen
    buffer_load_dword v68, v4, s[68:71], s36 offen
    s_add_u32 s36, s37, 75264
    buffer_load_dword v37, v4, s[64:67], s36 offen
    buffer_load_dword v69, v4, s[68:71], s36 offen
    s_add_u32 s36, s37, 78848
    buffer_load_dword v38, v4, s[64:67], s36 offen
    buffer_load_dword v70, v4, s[68:71], s36 offen
    s_add_u32 s36, s37, 82432
    buffer_load_dword v39, v4, s[64:67], s36 offen
    buffer_load_dword v71, v4, s[68:71], s36 offen
    s_add_u32 s36, s37, 86016
    buffer_load_dword v40, v4, s[64:67], s36 offen
    buffer_load_dword v72, v4, s[68:71], s36 offen
    s_add_u32 s36, s37, 89600
    buffer_load_dword v41, v4, s[64:67], s36 offen
    buffer_load_dword v73, v4, s[68:71], s36 offen
    s_add_u32 s36, s37, 93184
    buffer_load_dword v42, v4, s[64:67], s36 offen
    buffer_load_dword v74, v4, s[68:71], s36 offen
    s_add_u32 s36, s37, 96768
    buffer_load_dword v43, v4, s[64:67], s36 offen
    buffer_load_dword v75, v4, s[68:71], s36 offen
    s_add_u32 s36, s37, 100352
    buffer_load_dword v44, v4, s[64:67], s36 offen
    buffer_load_dword v76, v4, s[68:71], s36 offen
    s_add_u32 s36, s37, 103936
    buffer_load_dword v45, v4, s[64:67], s36 offen
    buffer_load_dword v77, v4, s[68:71], s36 offen
    s_add_u32 s36, s37, 107520
    buffer_load_dword v46, v4, s[64:67], s36 offen
    buffer_load_dword v78, v4, s[68:71], s36 offen
    s_add_u32 s36, s37, 111104
    buffer_load_dword v47, v4, s[64:67], s36 offen
    buffer_load_dword v79, v4, s[68:71], s36 offen
    s_waitcnt vmcnt(0)
    v_perm_b32 v80, v17, v16, s34
    v_perm_b32 v81, v19, v18, s34
    v_perm_b32 v82, v21, v20, s34
    v_perm_b32 v83, v23, v22, s34
    v_perm_b32 v84, v25, v24, s34
    v_perm_b32 v85, v27, v26, s34
    v_perm_b32 v86, v29, v28, s34
    v_perm_b32 v87, v31, v30, s34
    v_perm_b32 v88, v33, v32, s34
    v_perm_b32 v89, v35, v34, s34
    v_perm_b32 v90, v37, v36, s34
    v_perm_b32 v91, v39, v38, s34
    v_perm_b32 v92, v41, v40, s34
    v_perm_b32 v93, v43, v42, s34
    v_perm_b32 v94, v45, v44, s34
    v_perm_b32 v95, v47, v46, s34
    v_perm_b32 v96, v17, v16, s35
    v_perm_b32 v97, v19, v18, s35
    v_perm_b32 v98, v21, v20, s35
    v_perm_b32 v99, v23, v22, s35
    v_perm_b32 v100, v25, v24, s35
    v_perm_b32 v101, v27, v26, s35
    v_perm_b32 v102, v29, v28, s35
    v_perm_b32 v103, v31, v30, s35
    v_perm_b32 v104, v33, v32, s35
    v_perm_b32 v105, v35, v34, s35
    v_perm_b32 v106, v37, v36, s35
    v_perm_b32 v107, v39, v38, s35
    v_perm_b32 v108, v41, v40, s35
    v_perm_b32 v109, v43, v42, s35
    v_perm_b32 v110, v45, v44, s35
    v_perm_b32 v111, v47, v46, s35
    v_perm_b32 v112, v49, v48, s34
    v_perm_b32 v113, v51, v50, s34
    v_perm_b32 v114, v53, v52, s34
    v_perm_b32 v115, v55, v54, s34
    v_perm_b32 v116, v57, v56, s34
    v_perm_b32 v117, v59, v58, s34
    v_perm_b32 v118, v61, v60, s34
    v_perm_b32 v119, v63, v62, s34
    v_perm_b32 v120, v65, v64, s34
    v_perm_b32 v121, v67, v66, s34
    v_perm_b32 v122, v69, v68, s34
    v_perm_b32 v123, v71, v70, s34
    v_perm_b32 v124, v73, v72, s34
    v_perm_b32 v125, v75, v74, s34
    v_perm_b32 v126, v77, v76, s34
    v_perm_b32 v127, v79, v78, s34
    v_perm_b32 v128, v49, v48, s35
    v_perm_b32 v129, v51, v50, s35
    v_perm_b32 v130, v53, v52, s35
    v_perm_b32 v131, v55, v54, s35
    v_perm_b32 v132, v57, v56, s35
    v_perm_b32 v133, v59, v58, s35
    v_perm_b32 v134, v61, v60, s35
    v_perm_b32 v135, v63, v62, s35
    v_perm_b32 v136, v65, v64, s35
    v_perm_b32 v137, v67, v66, s35
    v_perm_b32 v138, v69, v68, s35
    v_perm_b32 v139, v71, v70, s35
    v_perm_b32 v140, v73, v72, s35
    v_perm_b32 v141, v75, v74, s35
    v_perm_b32 v142, v77, v76, s35
    v_perm_b32 v143, v79, v78, s35
    s_mov_b32 s24, 0
    s_mov_b64 s[28:29], 0
    v_lshlrev_b32 v3, 4, v0
L_A0_rp:
    s_mov_b32 s36, 0x194000
    buffer_load_dwordx4 v[200:203], v3, s[8:11], s36 offen sc1
    s_mov_b32 s36, 0x195000
    buffer_load_dwordx4 v[204:207], v3, s[8:11], s36 offen sc1
    s_mov_b32 s36, 0x196000
    buffer_load_dwordx4 v[208:211], v3, s[8:11], s36 offen sc1
    s_mov_b32 s36, 0x197000
    buffer_load_dwordx4 v[212:215], v3, s[8:11], s36 offen sc1
    s_mov_b32 s36, 0x198000
    buffer_load_dwordx4 v[216:219], v3, s[8:11], s36 offen sc1
    s_mov_b32 s36, 0x199000
    buffer_load_dwordx4 v[220:223], v3, s[8:11], s36 offen sc1
    s_mov_b32 s36, 0x19a000
    buffer_load_dwordx4 v[224:227], v3, s[8:11], s36 offen sc1
    s_add_u32 s32, s32, 1
    v_mov_b32 v5, 0
    s_waitcnt vmcnt(0)
    v_max3_u32 v5, v5, v200, v201
    v_max3_u32 v5, v5, v202, v203
    v_max3_u32 v5, v5, v204, v205
    v_max3_u32 v5, v5, v206, v207
    v_max3_u32 v5, v5, v208, v209
    v_max3_u32 v5, v5, v210, v211
    v_max3_u32 v5, v5, v212, v213
    v_max3_u32 v5, v5, v214, v215
    v_max3_u32 v5, v5, v216, v217
    v_max3_u32 v5, v5, v218, v219
    v_max3_u32 v5, v5, v220, v221
    v_max3_u32 v5, v5, v222, v223
    v_max3_u32 v5, v5, v224, v225
    v_max3_u32 v5, v5, v226, v227
    s_cmp_gt_u32 s32, 200000
    s_cbranch_scc1 L_A0_rp_ok
    v_cmp_eq_u32 vcc, -1, v5
    s_cbranch_vccz L_A0_rp_ok
    s_sleep 2
    s_branch L_A0_rp
L_A0_rp_ok:
    v_add_f32 v200, v200, v201
    v_add_f32 v202, v202, v203
    v_add_f32 v200, v200, v202
    v_cvt_pk_bf16_f32 v5, v200, v200
    v_lshlrev_b32 v200, 16, v5
    v_ashrrev_i32 v5, 31, v200
    v_or_b32 v5, 0x80000000, v5
    v_xor_b32 v5, v5, v200
    v_and_b32 v5, 0xffff0000, v5
    v_sub_u32 v6, 2047, v0
    v_or_b32 v232, v5, v6
    v_add_f32 v204, v204, v205
    v_add_f32 v206, v206, v207
    v_add_f32 v204, v204, v206
    v_cvt_pk_bf16_f32 v5, v204, v204
    v_lshlrev_b32 v204, 16, v5
    v_ashrrev_i32 v5, 31, v204
    v_or_b32 v5, 0x80000000, v5
    v_xor_b32 v5, v5, v204
    v_and_b32 v5, 0xffff0000, v5
    v_sub_u32 v6, 1791, v0
    v_or_b32 v233, v5, v6
    v_add_f32 v208, v208, v209
    v_add_f32 v210, v210, v211
    v_add_f32 v208, v208, v210
    v_cvt_pk_bf16_f32 v5, v208, v208
    v_lshlrev_b32 v208, 16, v5
    v_ashrrev_i32 v5, 31, v208
    v_or_b32 v5, 0x80000000, v5
    v_xor_b32 v5, v5, v208
    v_and_b32 v5, 0xffff0000, v5
    v_sub_u32 v6, 1535, v0
    v_or_b32 v234, v5, v6
    v_add_f32 v212, v212, v213
    v_add_f32 v214, v214, v215
    v_add_f32 v212, v212, v214
    v_cvt_pk_bf16_f32 v5, v212, v212
    v_lshlrev_b32 v212, 16, v5
    v_ashrrev_i32 v5, 31, v212
    v_or_b32 v5, 0x80000000, v5
    v_xor_b32 v5, v5, v212
    v_and_b32 v5, 0xffff0000, v5
    v_sub_u32 v6, 1279, v0
    v_or_b32 v235, v5, v6
    v_add_f32 v216, v216, v217
    v_add_f32 v218, v218, v219
    v_add_f32 v216, v216, v218
    v_cvt_pk_bf16_f32 v5, v216, v216
    v_lshlrev_b32 v216, 16, v5
    v_ashrrev_i32 v5, 31, v216
    v_or_b32 v5, 0x80000000, v5
    v_xor_b32 v5, v5, v216
    v_and_b32 v5, 0xffff0000, v5
    v_sub_u32 v6, 1023, v0
    v_or_b32 v236, v5, v6
    v_add_f32 v220, v220, v221
    v_add_f32 v222, v222, v223
    v_add_f32 v220, v220, v222
    v_cvt_pk_bf16_f32 v5, v220, v220
    v_lshlrev_b32 v220, 16, v5
    v_ashrrev_i32 v5, 31, v220
    v_or_b32 v5, 0x80000000, v5
    v_xor_b32 v5, v5, v220
    v_and_b32 v5, 0xffff0000, v5
    v_sub_u32 v6, 767, v0
    v_or_b32 v237, v5, v6
    v_add_f32 v224, v224, v225
    v_add_f32 v226, v226, v227
    v_add_f32 v224, v224, v226
    v_cvt_pk_bf16_f32 v5, v224, v224
    v_lshlrev_b32 v224, 16, v5
    v_ashrrev_i32 v5, 31, v224
    v_or_b32 v5, 0x80000000, v5
    v_xor_b32 v5, v5, v224
    v_and_b32 v5, 0xffff0000, v5
    v_sub_u32 v6, 511, v0
    v_or_b32 v238, v5, v6
L_A_round:
    v_lshlrev_b32 v3, 4, v0
L_A1_rp:
    s_mov_b32 s36, 0x19b000
    buffer_load_dwordx4 v[228:231], v3, s[8:11], s36 offen sc1
    s_add_u32 s32, s32, 1
    v_mov_b32 v5, 0
    s_waitcnt vmcnt(0)
    v_max3_u32 v5, v5, v228, v229
    v_max3_u32 v5, v5, v230, v231
    s_mul_i32 s37, s24, 96
    s_add_u32 s37, s37, 160
    v_cmp_gt_u32 s[74:75], s37, v0
    s_nop 1
    v_cndmask_b32 v5, 0, v5, s[74:75]
    s_cmp_gt_u32 s32, 200000
    s_cbranch_scc1 L_A1_rp_ok
    v_cmp_eq_u32 vcc, -1, v5
    s_cbranch_vccz L_A1_rp_ok
    s_sleep 2
    s_branch L_A1_rp
L_A1_rp_ok:
    v_add_f32 v228, v228, v229
    v_add_f32 v230, v230, v231
    v_add_f32 v228, v228, v230
    v_cvt_pk_bf16_f32 v5, v228, v228
    v_lshlrev_b32 v228, 16, v5
    v_ashrrev_i32 v5, 31, v228
    v_or_b32 v5, 0x80000000, v5
    v_xor_b32 v5, v5, v228
    v_and_b32 v5, 0xffff0000, v5
    v_sub_u32 v6, 255, v0
    v_or_b32 v239, v5, v6
    v_cndmask_b32 v239, 0, v239, s[74:75]
    v_mov_b32 v240, v232
    v_mov_b32 v241, v233
    v_mov_b32 v242, v234
    v_mov_b32 v243, v235
    v_mov_b32 v244, v236
    v_mov_b32 v245, v237
    v_mov_b32 v246, v238
    v_mov_b32 v247, v239
    v_lshrrev_b32 v7, 6, v0
    v_lshlrev_b32 v7, 2, v7
    v_mov_b32 v8, 0
    s_barrier
    v_max3_u32 v5, v240, v241, v242
    v_max3_u32 v5, v5, v243, v244
    v_max3_u32 v5, v5, v245, v246
    v_max_u32 v5, v5, v247
    s_nop 1
    v_max_u32_dpp v5, v5, v5 quad_perm:[1,0,3,2] row_mask:0xf bank_mask:0xf
    s_nop 1
    v_max_u32_dpp v5, v5, v5 quad_perm:[2,3,0,1] row_mask:0xf bank_mask:0xf
    s_nop 1
    v_max_u32_dpp v5, v5, v5 row_half_mirror row_mask:0xf bank_mask:0xf
    s_nop 1
    v_max_u32_dpp v5, v5, v5 row_mirror row_mask:0xf bank_mask:0xf
    v_mov_b32 v6, v5
    s_nop 1
    v_permlane16_swap_b32 v5, v6
    v_max_u32 v5, v5, v6
    v_mov_b32 v6, v5
    s_nop 1
    v_permlane32_swap_b32 v5, v6
    v_max_u32 v5, v5, v6
    ds_write_b32 v7, v5 offset:0
    s_waitcnt lgkmcnt(0)
    s_barrier
    ds_read_b128 v[248:251], v8 offset:0
    s_waitcnt lgkmcnt(0)
    v_max3_u32 v5, v248, v249, v250
    v_max_u32 v5, v5, v251
    s_nop 0
    v_readfirstlane_b32 s26, v5
    v_cmp_ne_u32 vcc, v5, v240
    s_nop 1
    v_cndmask_b32 v240, 0, v240, vcc
    v_cmp_ne_u32 vcc, v5, v241
    s_nop 1
    v_cndmask_b32 v241, 0, v241, vcc
    v_cmp_ne_u32 vcc, v5, v242
    s_nop 1
    v_cndmask_b32 v242, 0, v242, vcc
    v_cmp_ne_u32 vcc, v5, v243
    s_nop 1
    v_cndmask_b32 v243, 0, v243, vcc
    v_cmp_ne_u32 vcc, v5, v244
    s_nop 1
    v_cndmask_b32 v244, 0, v244, vcc
    v_cmp_ne_u32 vcc, v5, v245
    s_nop 1
    v_cndmask_b32 v245, 0, v245, vcc
    v_cmp_ne_u32 vcc, v5, v246
    s_nop 1
    v_cndmask_b32 v246, 0, v246, vcc
    v_cmp_ne_u32 vcc, v5, v247
    s_nop 1
    v_cndmask_b32 v247, 0, v247, vcc
    v_max3_u32 v5, v240, v241, v242
    v_max3_u32 v5, v5, v243, v244
    v_max3_u32 v5, v5, v245, v246
    v_max_u32 v5, v5, v247
    s_nop 1
    v_max_u32_dpp v5, v5, v5 quad_perm:[1,0,3,2] row_mask:0xf bank_mask:0xf
    s_nop 1
    v_max_u32_dpp v5, v5, v5 quad_perm:[2,3,0,1] row_mask:0xf bank_mask:0xf
    s_nop 1
    v_max_u32_dpp v5, v5, v5 row_half_mirror row_mask:0xf bank_mask:0xf
    s_nop 1
    v_max_u32_dpp v5, v5, v5 row_mirror row_mask:0xf bank_mask:0xf
    v_mov_b32 v6, v5
    s_nop 1
    v_permlane16_swap_b32 v5, v6
    v_max_u32 v5, v5, v6
    v_mov_b32 v6, v5
    s_nop 1
    v_permlane32_swap_b32 v5, v6
    v_max_u32 v5, v5, v6
    ds_write_b32 v7, v5 offset:16
    s_waitcnt lgkmcnt(0)
    s_barrier
    ds_read_b128 v[248:251], v8 offset:16
    s_waitcnt lgkmcnt(0)
    v_max3_u32 v5, v248, v249, v250
    v_max_u32 v5, v5, v251
    s_nop 0
    v_readfirstlane_b32 s27, v5
    s_nop 3
    s_and_b32 s36, s26, 0x7ff
    s_sub_u32 s30, 2047, s36
    s_and_b32 s36, s26, 0xffff0000
    s_xor_b32 s37, s36, 0x80000000
    s_xor_b32 s40, s36, 0xffff0000
    s_bitcmp1_b32 s36, 31
    s_cselect_b32 s40, s37, s40
    s_and_b32 s36, s27, 0x7ff
    s_sub_u32 s31, 2047, s36
    s_and_b32 s36, s27, 0xffff0000
    s_xor_b32 s37, s36, 0x80000000
    s_xor_b32 s41, s36, 0xffff0000
    s_bitcmp1_b32 s36, 31
    s_cselect_b32 s41, s37, s41
    s_cmp_eq_u64 s[26:27], s[28:29]
    s_cbranch_scc1 L_end
    s_mov_b64 s[28:29], s[26:27]
    v_lshlrev_b32 v3, 6, v1
    s_lshl_b32 s36, s30, 10
    s_add_u32 s36, s36, 0x600000
    buffer_load_dwordx4 v[16:19], v3, s[8:11], s36 offen offset:0 sc1
    buffer_load_dwordx4 v[20:23], v3, s[8:11], s36 offen offset:16 sc1
    buffer_load_dwordx4 v[24:27], v3, s[8:11], s36 offen offset:32 sc1
    buffer_load_dwordx4 v[28:31], v3, s[8:11], s36 offen offset:48 sc1
    s_lshl_b32 s36, s31, 10
    s_add_u32 s36, s36, 0x600000
    buffer_load_dwordx4 v[32:35], v3, s[8:11], s36 offen offset:0 sc1
    buffer_load_dwordx4 v[36:39], v3, s[8:11], s36 offen offset:16 sc1
    buffer_load_dwordx4 v[40:43], v3, s[8:11], s36 offen offset:32 sc1
    buffer_load_dwordx4 v[44:47], v3, s[8:11], s36 offen offset:48 sc1
    v_mov_b32 v48, 0
    v_mov_b32 v49, 0
    v_mov_b32 v50, 0
    v_mov_b32 v51, 0
    v_mov_b32 v52, 0
    v_mov_b32 v53, 0
    v_mov_b32 v54, 0
    v_mov_b32 v55, 0
    s_waitcnt vmcnt(0)
    v_dot2_f32_bf16 v48, v16, v80, v48
    v_dot2_f32_bf16 v49, v16, v96, v49
    v_dot2_f32_bf16 v50, v32, v80, v50
    v_dot2_f32_bf16 v51, v32, v96, v51
    v_dot2_f32_bf16 v52, v16, v112, v52
    v_dot2_f32_bf16 v53, v16, v128, v53
    v_dot2_f32_bf16 v54, v32, v112, v54
    v_dot2_f32_bf16 v55, v32, v128, v55
    v_dot2_f32_bf16 v48, v17, v81, v48
    v_dot2_f32_bf16 v49, v17, v97, v49
    v_dot2_f32_bf16 v50, v33, v81, v50
    v_dot2_f32_bf16 v51, v33, v97, v51
    v_dot2_f32_bf16 v52, v17, v113, v52
    v_dot2_f32_bf16 v53, v17, v129, v53
    v_dot2_f32_bf16 v54, v33, v113, v54
    v_dot2_f32_bf16 v55, v33, v129, v55
    v_dot2_f32_bf16 v48, v18, v82, v48
    v_dot2_f32_bf16 v49, v18, v98, v49
    v_dot2_f32_bf16 v50, v34, v82, v50
    v_dot2_f32_bf16 v51, v34, v98, v51
    v_dot2_f32_bf16 v52, v18, v114, v52
    v_dot2_f32_bf16 v53, v18, v130, v53
    v_dot2_f32_bf16 v54, v34, v114, v54
    v_dot2_f32_bf16 v55, v34, v130, v55
    v_dot2_f32_bf16 v48, v19, v83, v48
    v_dot2_f32_bf16 v49, v19, v99, v49
    v_dot2_f32_bf16 v50, v35, v83, v50
    v_dot2_f32_bf16 v51, v35, v99, v51
    v_dot2_f32_bf16 v52, v19, v115, v52
    v_dot2_f32_bf16 v53, v19, v131, v53
    v_dot2_f32_bf16 v54, v35, v115, v54
    v_dot2_f32_bf16 v55, v35, v131, v55
    v_dot2_f32_bf16 v48, v20, v84, v48
    v_dot2_f32_bf16 v49, v20, v100, v49
    v_dot2_f32_bf16 v50, v36, v84, v50
    v_dot2_f32_bf16 v51, v36, v100, v51
    v_dot2_f32_bf16 v52, v20, v116, v52
    v_dot2_f32_bf16 v53, v20, v132, v53
    v_dot2_f32_bf16 v54, v36, v116, v54
    v_dot2_f32_bf16 v55, v36, v132, v55
    v_dot2_f32_bf16 v48, v21, v85, v48
    v_dot2_f32_bf16 v49, v21, v101, v49
    v_dot2_f32_bf16 v50, v37, v85, v50
    v_dot2_f32_bf16 v51, v37, v101, v51
    v_dot2_f32_bf16 v52, v21, v117, v52
    v_dot2_f32_bf16 v53, v21, v133, v53
    v_dot2_f32_bf16 v54, v37, v117, v54
    v_dot2_f32_bf16 v55, v37, v133, v55
    v_dot2_f32_bf16 v48, v22, v86, v48
    v_dot2_f32_bf16 v49, v22, v102, v49
    v_dot2_f32_bf16 v50, v38, v86, v50
    v_dot2_f32_bf16 v51, v38, v102, v51
    v_dot2_f32_bf16 v52, v22, v118, v52
    v_dot2_f32_bf16 v53, v22, v134, v53
    v_dot2_f32_bf16 v54, v38, v118, v54
    v_dot2_f32_bf16 v55, v38, v134, v55
    v_dot2_f32_bf16 v48, v23, v87, v48
    v_dot2_f32_bf16 v49, v23, v103, v49
    v_dot2_f32_bf16 v50, v39, v87, v50
    v_dot2_f32_bf16 v51, v39, v103, v51
    v_dot2_f32_bf16 v52, v23, v119, v52
    v_dot2_f32_bf16 v53, v23, v135, v53
    v_dot2_f32_bf16 v54, v39, v119, v54
    v_dot2_f32_bf16 v55, v39, v135, v55
    v_dot2_f32_bf16 v48, v24, v88, v48
    v_dot2_f32_bf16 v49, v24, v104, v49
    v_dot2_f32_bf16 v50, v40, v88, v50
    v_dot2_f32_bf16 v51, v40, v104, v51
    v_dot2_f32_bf16 v52, v24, v120, v52
    v_dot2_f32_bf16 v53, v24, v136, v53
    v_dot2_f32_bf16 v54, v40, v120, v54
    v_dot2_f32_bf16 v55, v40, v136, v55
    v_dot2_f32_bf16 v48, v25, v89, v48
    v_dot2_f32_bf16 v49, v25, v105, v49
    v_dot2_f32_bf16 v50, v41, v89, v50
    v_dot2_f32_bf16 v51, v41, v105, v51
    v_dot2_f32_bf16 v52, v25, v121, v52
    v_dot2_f32_bf16 v53, v25, v137, v53
    v_dot2_f32_bf16 v54, v41, v121, v54
    v_dot2_f32_bf16 v55, v41, v137, v55
    v_dot2_f32_bf16 v48, v26, v90, v48
    v_dot2_f32_bf16 v49, v26, v106, v49
    v_dot2_f32_bf16 v50, v42, v90, v50
    v_dot2_f32_bf16 v51, v42, v106, v51
    v_dot2_f32_bf16 v52, v26, v122, v52
    v_dot2_f32_bf16 v53, v26, v138, v53
    v_dot2_f32_bf16 v54, v42, v122, v54
    v_dot2_f32_bf16 v55, v42, v138, v55
    v_dot2_f32_bf16 v48, v27, v91, v48
    v_dot2_f32_bf16 v49, v27, v107, v49
    v_dot2_f32_bf16 v50, v43, v91, v50
    v_dot2_f32_bf16 v51, v43, v107, v51
    v_dot2_f32_bf16 v52, v27, v123, v52
    v_dot2_f32_bf16 v53, v27, v139, v53
    v_dot2_f32_bf16 v54, v43, v123, v54
    v_dot2_f32_bf16 v55, v43, v139, v55
    v_dot2_f32_bf16 v48, v28, v92, v48
    v_dot2_f32_bf16 v49, v28, v108, v49
    v_dot2_f32_bf16 v50, v44, v92, v50
    v_dot2_f32_bf16 v51, v44, v108, v51
    v_dot2_f32_bf16 v52, v28, v124, v52
    v_dot2_f32_bf16 v53, v28, v140, v53
    v_dot2_f32_bf16 v54, v44, v124, v54
    v_dot2_f32_bf16 v55, v44, v140, v55
    v_dot2_f32_bf16 v48, v29, v93, v48
    v_dot2_f32_bf16 v49, v29, v109, v49
    v_dot2_f32_bf16 v50, v45, v93, v50
    v_dot2_f32_bf16 v51, v45, v109, v51
    v_dot2_f32_bf16 v52, v29, v125, v52
    v_dot2_f32_bf16 v53, v29, v141, v53
    v_dot2_f32_bf16 v54, v45, v125, v54
    v_dot2_f32_bf16 v55, v45, v141, v55
    v_dot2_f32_bf16 v48, v30, v94, v48
    v_dot2_f32_bf16 v49, v30, v110, v49
    v_dot2_f32_bf16 v50, v46, v94, v50
    v_dot2_f32_bf16 v51, v46, v110, v51
    v_dot2_f32_bf16 v52, v30, v126, v52
    v_dot2_f32_bf16 v53, v30, v142, v53
    v_dot2_f32_bf16 v54, v46, v126, v54
    v_dot2_f32_bf16 v55, v46, v142, v55
    v_dot2_f32_bf16 v48, v31, v95, v48
    v_dot2_f32_bf16 v49, v31, v111, v49
    v_dot2_f32_bf16 v50, v47, v95, v50
    v_dot2_f32_bf16 v51, v47, v111, v51
    v_dot2_f32_bf16 v52, v31, v127, v52
    v_dot2_f32_bf16 v53, v31, v143, v53
    v_dot2_f32_bf16 v54, v47, v127, v54
    v_dot2_f32_bf16 v55, v47, v143, v55
    s_nop 3
    v_mov_b32 v5, v48
    s_nop 1
    v_permlane16_swap_b32 v48, v5
    v_add_f32 v48, v48, v5
    v_mov_b32 v5, v49
    s_nop 1
    v_permlane16_swap_b32 v49, v5
    v_add_f32 v49, v49, v5
    v_mov_b32 v5, v50
    s_nop 1
    v_permlane16_swap_b32 v50, v5
    v_add_f32 v50, v50, v5
    v_mov_b32 v5, v51
    s_nop 1
    v_permlane16_swap_b32 v51, v5
    v_add_f32 v51, v51, v5
    v_mov_b32 v5, v52
    s_nop 1
    v_permlane16_swap_b32 v52, v5
    v_add_f32 v52, v52, v5
    v_mov_b32 v5, v53
    s_nop 1
    v_permlane16_swap_b32 v53, v5
    v_add_f32 v53, v53, v5
    v_mov_b32 v5, v54
    s_nop 1
    v_permlane16_swap_b32 v54, v5
    v_add_f32 v54, v54, v5
    v_mov_b32 v5, v55
    s_nop 1
    v_permlane16_swap_b32 v55, v5
    v_add_f32 v55, v55, v5
    v_mov_b32 v5, v48
    s_nop 1
    v_permlane32_swap_b32 v48, v5
    v_add_f32 v48, v48, v5
    v_mov_b32 v5, v49
    s_nop 1
    v_permlane32_swap_b32 v49, v5
    v_add_f32 v49, v49, v5
    v_mov_b32 v5, v50
    s_nop 1
    v_permlane32_swap_b32 v50, v5
    v_add_f32 v50, v50, v5
    v_mov_b32 v5, v51
    s_nop 1
    v_permlane32_swap_b32 v51, v5
    v_add_f32 v51, v51, v5
    v_mov_b32 v5, v52
    s_nop 1
    v_permlane32_swap_b32 v52, v5
    v_add_f32 v52, v52, v5
    v_mov_b32 v5, v53
    s_nop 1
    v_permlane32_swap_b32 v53, v5
    v_add_f32 v53, v53, v5
    v_mov_b32 v5, v54
    s_nop 1
    v_permlane32_swap_b32 v54, v5
    v_add_f32 v54, v54, v5
    v_mov_b32 v5, v55
    s_nop 1
    v_permlane32_swap_b32 v55, v5
    v_add_f32 v55, v55, v5
    v_lshrrev_b32 v7, 6, v0
    v_lshlrev_b32 v7, 9, v7
    v_lshl_add_u32 v7, v2, 5, v7
    ds_write_b128 v7, v[48:51] offset:64
    ds_write_b128 v7, v[52:55] offset:80
    s_waitcnt lgkmcnt(0)
    s_barrier
    v_bfe_u32 v7, v0, 2, 4
    v_lshlrev_b32 v7, 5, v7
    v_and_b32 v8, 3, v0
    v_lshl_add_u32 v7, v8, 2, v7
    ds_read_b32 v56, v7 offset:64
    ds_read_b32 v57, v7 offset:80
    ds_read_b32 v58, v7 offset:576
    ds_read_b32 v59, v7 offset:592
    ds_read_b32 v60, v7 offset:1088
    ds_read_b32 v61, v7 offset:1104
    ds_read_b32 v62, v7 offset:1600
    ds_read_b32 v63, v7 offset:1616
    s_waitcnt lgkmcnt(0)
    v_add_f32 v56, v56, v58
    v_add_f32 v60, v60, v62
    v_add_f32 v56, v56, v60
    v_cvt_pk_bf16_f32 v5, v56, v56
    v_lshlrev_b32 v56, 16, v5
    v_add_f32 v57, v57, v59
    v_add_f32 v61, v61, v63
    v_add_f32 v57, v57, v61
    v_cvt_pk_bf16_f32 v5, v57, v57
    v_lshlrev_b32 v57, 16, v5
    v_mul_f32 v58, 0xbfb8aa3b, v56
    v_exp_f32 v58, v58
    s_nop 0
    v_add_f32 v58, 1.0, v58
    v_rcp_f32 v58, v58
    s_nop 0
    v_mul_f32 v56, v56, v58
    v_cvt_pk_bf16_f32 v5, v56, v56
    v_lshlrev_b32 v56, 16, v5
    v_mul_f32 v56, v56, v57
    v_cvt_pk_bf16_f32 v5, v56, v56
    v_lshlrev_b32 v56, 16, v5
    v_lshrrev_b32 v7, 2, v0
    v_lshlrev_b32 v7, 3, v7
    v_and_b32 v8, 1, v0
    v_lshl_add_u32 v7, v8, 2, v7
    v_bfe_u32 v8, v0, 1, 1
    v_mul_u32_u24 v8, 7168, v8
    v_add_u32 v7, v7, v8
    v_mov_b32 v6, 0x40000000
    v_cmp_lt_u32 vcc, 63, v0
    s_nop 1
    v_cndmask_b32 v7, v7, v6, vcc
    s_mul_i32 s36, s24, 14336
    s_lshl_b32 s37, s25, 7
    s_add_u32 s36, s36, s37
    s_add_u32 s36, s36, 0x1b0000
    buffer_store_dword v56, v7, s[8:11], s36 offen sc1
    s_add_u32 s24, s24, 1
    s_cmp_lt_u32 s24, 2
    s_cbranch_scc1 L_A_round
    s_branch L_end
L_stageB:
    s_mov_b32 s64, s88
    s_and_b32 s65, s89, 0xffff
    s_mov_b32 s66, 0x1c0000
    s_mov_b32 s67, 0x20000
    v_lshrrev_b32 v1, 3, v0
    v_and_b32 v2, 7, v0
    v_mul_u32_u24 v4, 57344, v1
    v_lshl_add_u32 v4, v2, 2, v4
    s_lshl_b32 s68, s20, 5
    s_add_u32 s36, s68, 0
    buffer_load_dword v16, v4, s[64:67], s36 offen offset:0
    s_add_u32 s36, s68, 0
    buffer_load_dword v17, v4, s[64:67], s36 offen offset:1024
    s_add_u32 s36, s68, 0
    buffer_load_dword v18, v4, s[64:67], s36 offen offset:2048
    s_add_u32 s36, s68, 0
    buffer_load_dword v19, v4, s[64:67], s36 offen offset:3072
    s_add_u32 s36, s68, 4096
    buffer_load_dword v20, v4, s[64:67], s36 offen offset:0
    s_add_u32 s36, s68, 4096
    buffer_load_dword v21, v4, s[64:67], s36 offen offset:1024
    s_add_u32 s36, s68, 4096
    buffer_load_dword v22, v4, s[64:67], s36 offen offset:2048
    s_add_u32 s36, s68, 4096
    buffer_load_dword v23, v4, s[64:67], s36 offen offset:3072
    s_add_u32 s36, s68, 8192
    buffer_load_dword v24, v4, s[64:67], s36 offen offset:0
    s_add_u32 s36, s68, 8192
    buffer_load_dword v25, v4, s[64:67], s36 offen offset:1024
    s_add_u32 s36, s68, 8192
    buffer_load_dword v26, v4, s[64:67], s36 offen offset:2048
    s_add_u32 s36, s68, 8192
    buffer_load_dword v27, v4, s[64:67], s36 offen offset:3072
    s_add_u32 s36, s68, 12288
    buffer_load_dword v28, v4, s[64:67], s36 offen offset:0
    s_add_u32 s36, s68, 12288
    buffer_load_dword v29, v4, s[64:67], s36 offen offset:1024
    s_add_u32 s36, s68, 12288
    buffer_load_dword v30, v4, s[64:67], s36 offen offset:2048
    s_add_u32 s36, s68, 12288
    buffer_load_dword v31, v4, s[64:67], s36 offen offset:3072
    s_add_u32 s36, s68, 16384
    buffer_load_dword v32, v4, s[64:67], s36 offen offset:0
    s_add_u32 s36, s68, 16384
    buffer_load_dword v33, v4, s[64:67], s36 offen offset:1024
    s_add_u32 s36, s68, 16384
    buffer_load_dword v34, v4, s[64:67], s36 offen offset:2048
    s_add_u32 s36, s68, 16384
    buffer_load_dword v35, v4, s[64:67], s36 offen offset:3072
    s_add_u32 s36, s68, 20480
    buffer_load_dword v36, v4, s[64:67], s36 offen offset:0
    s_add_u32 s36, s68, 20480
    buffer_load_dword v37, v4, s[64:67], s36 offen offset:1024
    s_add_u32 s36, s68, 20480
    buffer_load_dword v38, v4, s[64:67], s36 offen offset:2048
    s_add_u32 s36, s68, 20480
    buffer_load_dword v39, v4, s[64:67], s36 offen offset:3072
    s_add_u32 s36, s68, 24576
    buffer_load_dword v40, v4, s[64:67], s36 offen offset:0
    s_add_u32 s36, s68, 24576
    buffer_load_dword v41, v4, s[64:67], s36 offen offset:1024
    s_add_u32 s36, s68, 24576
    buffer_load_dword v42, v4, s[64:67], s36 offen offset:2048
    s_add_u32 s36, s68, 24576
    buffer_load_dword v43, v4, s[64:67], s36 offen offset:3072
    s_add_u32 s36, s68, 28672
    buffer_load_dword v44, v4, s[64:67], s36 offen offset:0
    s_add_u32 s36, s68, 28672
    buffer_load_dword v45, v4, s[64:67], s36 offen offset:1024
    s_add_u32 s36, s68, 28672
    buffer_load_dword v46, v4, s[64:67], s36 offen offset:2048
    s_add_u32 s36, s68, 28672
    buffer_load_dword v47, v4, s[64:67], s36 offen offset:3072
    s_add_u32 s36, s68, 32768
    buffer_load_dword v48, v4, s[64:67], s36 offen offset:0
    s_add_u32 s36, s68, 32768
    buffer_load_dword v49, v4, s[64:67], s36 offen offset:1024
    s_add_u32 s36, s68, 32768
    buffer_load_dword v50, v4, s[64:67], s36 offen offset:2048
    s_add_u32 s36, s68, 32768
    buffer_load_dword v51, v4, s[64:67], s36 offen offset:3072
    s_add_u32 s36, s68, 36864
    buffer_load_dword v52, v4, s[64:67], s36 offen offset:0
    s_add_u32 s36, s68, 36864
    buffer_load_dword v53, v4, s[64:67], s36 offen offset:1024
    s_add_u32 s36, s68, 36864
    buffer_load_dword v54, v4, s[64:67], s36 offen offset:2048
    s_add_u32 s36, s68, 36864
    buffer_load_dword v55, v4, s[64:67], s36 offen offset:3072
    s_add_u32 s36, s68, 40960
    buffer_load_dword v56, v4, s[64:67], s36 offen offset:0
    s_add_u32 s36, s68, 40960
    buffer_load_dword v57, v4, s[64:67], s36 offen offset:1024
    s_add_u32 s36, s68, 40960
    buffer_load_dword v58, v4, s[64:67], s36 offen offset:2048
    s_add_u32 s36, s68, 40960
    buffer_load_dword v59, v4, s[64:67], s36 offen offset:3072
    s_add_u32 s36, s68, 45056
    buffer_load_dword v60, v4, s[64:67], s36 offen offset:0
    s_add_u32 s36, s68, 45056
    buffer_load_dword v61, v4, s[64:67], s36 offen offset:1024
    s_add_u32 s36, s68, 45056
    buffer_load_dword v62, v4, s[64:67], s36 offen offset:2048
    s_add_u32 s36, s68, 45056
    buffer_load_dword v63, v4, s[64:67], s36 offen offset:3072
    s_add_u32 s36, s68, 49152
    buffer_load_dword v64, v4, s[64:67], s36 offen offset:0
    s_add_u32 s36, s68, 49152
    buffer_load_dword v65, v4, s[64:67], s36 offen offset:1024
    s_add_u32 s36, s68, 49152
    buffer_load_dword v66, v4, s[64:67], s36 offen offset:2048
    s_add_u32 s36, s68, 49152
    buffer_load_dword v67, v4, s[64:67], s36 offen offset:3072
    s_add_u32 s36, s68, 53248
    buffer_load_dword v68, v4, s[64:67], s36 offen offset:0
    s_add_u32 s36, s68, 53248
    buffer_load_dword v69, v4, s[64:67], s36 offen offset:1024
    s_add_u32 s36, s68, 53248
    buffer_load_dword v70, v4, s[64:67], s36 offen offset:2048
    s_add_u32 s36, s68, 53248
    buffer_load_dword v71, v4, s[64:67], s36 offen offset:3072
    s_waitcnt vmcnt(0)
    s_mov_b32 s24, 0
    s_mov_b64 s[28:29], 0
    v_mov_b32 v12, 0x40000000
    v_mov_b32 v11, 0
    v_lshlrev_b32 v3, 4, v0
L_B0_rp:
    s_mov_b32 s36, 0x194000
    buffer_load_dwordx4 v[200:203], v3, s[8:11], s36 offen sc1
    s_mov_b32 s36, 0x195000
    buffer_load_dwordx4 v[204:207], v3, s[8:11], s36 offen sc1
    s_mov_b32 s36, 0x196000
    buffer_load_dwordx4 v[208:211], v3, s[8:11], s36 offen sc1
    s_mov_b32 s36, 0x197000
    buffer_load_dwordx4 v[212:215], v3, s[8:11], s36 offen sc1
    s_mov_b32 s36, 0x198000
    buffer_load_dwordx4 v[216:219], v3, s[8:11], s36 offen sc1
    s_mov_b32 s36, 0x199000
    buffer_load_dwordx4 v[220:223], v3, s[8:11], s36 offen sc1
    s_mov_b32 s36, 0x19a000
    buffer_load_dwordx4 v[224:227], v3, s[8:11], s36 offen sc1
    s_add_u32 s32, s32, 1
    v_mov_b32 v5, 0
    s_waitcnt vmcnt(0)
    v_max3_u32 v5, v5, v200, v201
    v_max3_u32 v5, v5, v202, v203
    v_max3_u32 v5, v5, v204, v205
    v_max3_u32 v5, v5, v206, v207
    v_max3_u32 v5, v5, v208, v209
    v_max3_u32 v5, v5, v210, v211
    v_max3_u32 v5, v5, v212, v213
    v_max3_u32 v5, v5, v214, v215
    v_max3_u32 v5, v5, v216, v217
    v_max3_u32 v5, v5, v218, v219
    v_max3_u32 v5, v5, v220, v221
    v_max3_u32 v5, v5, v222, v223
    v_max3_u32 v5, v5, v224, v225
    v_max3_u32 v5, v5, v226, v227
    s_cmp_gt_u32 s32, 200000
    s_cbranch_scc1 L_B0_rp_ok
    v_cmp_eq_u32 vcc, -1, v5
    s_cbranch_vccz L_B0_rp_ok
    s_sleep 2
    s_branch L_B0_rp
L_B0_rp_ok:
    v_add_f32 v200, v200, v201
    v_add_f32 v202, v202, v203
    v_add_f32 v200, v200, v202
    v_cvt_pk_bf16_f32 v5, v200, v200
    v_lshlrev_b32 v200, 16, v5
    v_ashrrev_i32 v5, 31, v200
    v_or_b32 v5, 0x80000000, v5
    v_xor_b32 v5, v5, v200
    v_and_b32 v5, 0xffff0000, v5
    v_sub_u32 v6, 2047, v0
    v_or_b32 v232, v5, v6
    v_add_f32 v204, v204, v205
    v_add_f32 v206, v206, v207
    v_add_f32 v204, v204, v206
    v_cvt_pk_bf16_f32 v5, v204, v204
    v_lshlrev_b32 v204, 16, v5
    v_ashrrev_i32 v5, 31, v204
    v_or_b32 v5, 0x80000000, v5
    v_xor_b32 v5, v5, v204
    v_and_b32 v5, 0xffff0000, v5
    v_sub_u32 v6, 1791, v0
    v_or_b32 v233, v5, v6
    v_add_f32 v208, v208, v209
    v_add_f32 v210, v210, v211
    v_add_f32 v208, v208, v210
    v_cvt_pk_bf16_f32 v5, v208, v208
    v_lshlrev_b32 v208, 16, v5
    v_ashrrev_i32 v5, 31, v208
    v_or_b32 v5, 0x80000000, v5
    v_xor_b32 v5, v5, v208
    v_and_b32 v5, 0xffff0000, v5
    v_sub_u32 v6, 1535, v0
    v_or_b32 v234, v5, v6
    v_add_f32 v212, v212, v213
    v_add_f32 v214, v214, v215
    v_add_f32 v212, v212, v214
    v_cvt_pk_bf16_f32 v5, v212, v212
    v_lshlrev_b32 v212, 16, v5
    v_ashrrev_i32 v5, 31, v212
    v_or_b32 v5, 0x80000000, v5
    v_xor_b32 v5, v5, v212
    v_and_b32 v5, 0xffff0000, v5
    v_sub_u32 v6, 1279, v0
    v_or_b32 v235, v5, v6
    v_add_f32 v216, v216, v217
    v_add_f32 v218, v218, v219
    v_add_f32 v216, v216, v218
    v_cvt_pk_bf16_f32 v5, v216, v216
    v_lshlrev_b32 v216, 16, v5
    v_ashrrev_i32 v5, 31, v216
    v_or_b32 v5, 0x80000000, v5
    v_xor_b32 v5, v5, v216
    v_and_b32 v5, 0xffff0000, v5
    v_sub_u32 v6, 1023, v0
    v_or_b32 v236, v5, v6
    v_add_f32 v220, v220, v221
    v_add_f32 v222, v222, v223
    v_add_f32 v220, v220, v222
    v_cvt_pk_bf16_f32 v5, v220, v220
    v_lshlrev_b32 v220, 16, v5
    v_ashrrev_i32 v5, 31, v220
    v_or_b32 v5, 0x80000000, v5
    v_xor_b32 v5, v5, v220
    v_and_b32 v5, 0xffff0000, v5
    v_sub_u32 v6, 767, v0
    v_or_b32 v237, v5, v6
    v_add_f32 v224, v224, v225
    v_add_f32 v226, v226, v227
    v_add_f32 v224, v224, v226
    v_cvt_pk_bf16_f32 v5, v224, v224
    v_lshlrev_b32 v224, 16, v5
    v_ashrrev_i32 v5, 31, v224
    v_or_b32 v5, 0x80000000, v5
    v_xor_b32 v5, v5, v224
    v_and_b32 v5, 0xffff0000, v5
    v_sub_u32 v6, 511, v0
    v_or_b32 v238, v5, v6
L_B_round:
    v_lshlrev_b32 v3, 4, v0
L_B1_rp:
    s_mov_b32 s36, 0x19b000
    buffer_load_dwordx4 v[228:231], v3, s[8:11], s36 offen sc1
    s_add_u32 s32, s32, 1
    v_mov_b32 v5, 0
    s_waitcnt vmcnt(0)
    v_max3_u32 v5, v5, v228, v229
    v_max3_u32 v5, v5, v230, v231
    s_mul_i32 s37, s24, 96
    s_add_u32 s37, s37, 160
    v_cmp_gt_u32 s[74:75], s37, v0
    s_nop 1
    v_cndmask_b32 v5, 0, v5, s[74:75]
    s_cmp_gt_u32 s32, 200000
    s_cbranch_scc1 L_B1_rp_ok
    v_cmp_eq_u32 vcc, -1, v5
    s_cbranch_vccz L_B1_rp_ok
    s_sleep 2
    s_branch L_B1_rp
L_B1_rp_ok:
    v_add_f32 v228, v228, v229
    v_add_f32 v230, v230, v231
    v_add_f32 v228, v228, v230
    v_cvt_pk_bf16_f32 v5, v228, v228
    v_lshlrev_b32 v228, 16, v5
    v_ashrrev_i32 v5, 31, v228
    v_or_b32 v5, 0x80000000, v5
    v_xor_b32 v5, v5, v228
    v_and_b32 v5, 0xffff0000, v5
    v_sub_u32 v6, 255, v0
    v_or_b32 v239, v5, v6
    v_cndmask_b32 v239, 0, v239, s[74:75]
    v_mov_b32 v240, v232
    v_mov_b32 v241, v233
    v_mov_b32 v242, v234
    v_mov_b32 v243, v235
    v_mov_b32 v244, v236
    v_mov_b32 v245, v237
    v_mov_b32 v246, v238
    v_mov_b32 v247, v239
    v_lshrrev_b32 v7, 6, v0
    v_lshlrev_b32 v7, 2, v7
    v_mov_b32 v8, 0
    s_barrier
    v_max3_u32 v5, v240, v241, v242
    v_max3_u32 v5, v5, v243, v244
    v_max3_u32 v5, v5, v245, v246
    v_max_u32 v5, v5, v247
    s_nop 1
    v_max_u32_dpp v5, v5, v5 quad_perm:[1,0,3,2] row_mask:0xf bank_mask:0xf
    s_nop 1
    v_max_u32_dpp v5, v5, v5 quad_perm:[2,3,0,1] row_mask:0xf bank_mask:0xf
    s_nop 1
    v_max_u32_dpp v5, v5, v5 row_half_mirror row_mask:0xf bank_mask:0xf
    s_nop 1
    v_max_u32_dpp v5, v5, v5 row_mirror row_mask:0xf bank_mask:0xf
    v_mov_b32 v6, v5
    s_nop 1
    v_permlane16_swap_b32 v5, v6
    v_max_u32 v5, v5, v6
    v_mov_b32 v6, v5
    s_nop 1
    v_permlane32_swap_b32 v5, v6
    v_max_u32 v5, v5, v6
    ds_write_b32 v7, v5 offset:0
    s_waitcnt lgkmcnt(0)
    s_barrier
    ds_read_b128 v[248:251], v8 offset:0
    s_waitcnt lgkmcnt(0)
    v_max3_u32 v5, v248, v249, v250
    v_max_u32 v5, v5, v251
    s_nop 0
    v_readfirstlane_b32 s26, v5
    v_cmp_ne_u32 vcc, v5, v240
    s_nop 1
    v_cndmask_b32 v240, 0, v240, vcc
    v_cmp_ne_u32 vcc, v5, v241
    s_nop 1
    v_cndmask_b32 v241, 0, v241, vcc
    v_cmp_ne_u32 vcc, v5, v242
    s_nop 1
    v_cndmask_b32 v242, 0, v242, vcc
    v_cmp_ne_u32 vcc, v5, v243
    s_nop 1
    v_cndmask_b32 v243, 0, v243, vcc
    v_cmp_ne_u32 vcc, v5, v244
    s_nop 1
    v_cndmask_b32 v244, 0, v244, vcc
    v_cmp_ne_u32 vcc, v5, v245
    s_nop 1
    v_cndmask_b32 v245, 0, v245, vcc
    v_cmp_ne_u32 vcc, v5, v246
    s_nop 1
    v_cndmask_b32 v246, 0, v246, vcc
    v_cmp_ne_u32 vcc, v5, v247
    s_nop 1
    v_cndmask_b32 v247, 0, v247, vcc
    v_max3_u32 v5, v240, v241, v242
    v_max3_u32 v5, v5, v243, v244
    v_max3_u32 v5, v5, v245, v246
    v_max_u32 v5, v5, v247
    s_nop 1
    v_max_u32_dpp v5, v5, v5 quad_perm:[1,0,3,2] row_mask:0xf bank_mask:0xf
    s_nop 1
    v_max_u32_dpp v5, v5, v5 quad_perm:[2,3,0,1] row_mask:0xf bank_mask:0xf
    s_nop 1
    v_max_u32_dpp v5, v5, v5 row_half_mirror row_mask:0xf bank_mask:0xf
    s_nop 1
    v_max_u32_dpp v5, v5, v5 row_mirror row_mask:0xf bank_mask:0xf
    v_mov_b32 v6, v5
    s_nop 1
    v_permlane16_swap_b32 v5, v6
    v_max_u32 v5, v5, v6
    v_mov_b32 v6, v5
    s_nop 1
    v_permlane32_swap_b32 v5, v6
    v_max_u32 v5, v5, v6
    ds_write_b32 v7, v5 offset:16
    s_waitcnt lgkmcnt(0)
    s_barrier
    ds_read_b128 v[248:251], v8 offset:16
    s_waitcnt lgkmcnt(0)
    v_max3_u32 v5, v248, v249, v250
    v_max_u32 v5, v5, v251
    s_nop 0
    v_readfirstlane_b32 s27, v5
    s_nop 3
    s_and_b32 s36, s26, 0x7ff
    s_sub_u32 s30, 2047, s36
    s_and_b32 s36, s26, 0xffff0000
    s_xor_b32 s37, s36, 0x80000000
    s_xor_b32 s40, s36, 0xffff0000
    s_bitcmp1_b32 s36, 31
    s_cselect_b32 s40, s37, s40
    s_and_b32 s36, s27, 0x7ff
    s_sub_u32 s31, 2047, s36
    s_and_b32 s36, s27, 0xffff0000
    s_xor_b32 s37, s36, 0x80000000
    s_xor_b32 s41, s36, 0xffff0000
    s_bitcmp1_b32 s36, 31
    s_cselect_b32 s41, s37, s41
    s_cmp_eq_u64 s[26:27], s[28:29]
    s_cbranch_scc1 L_B_store
    s_mov_b64 s[28:29], s[26:27]
    v_bfe_u32 v9, v0, 3, 1
    v_cmp_ne_u32 vcc, 0, v9
    v_mov_b32 v5, s30
    v_mov_b32 v6, s31
    v_cndmask_b32 v12, v5, v6, vcc
    v_mov_b32 v5, s40
    v_mov_b32 v6, s41
    v_cndmask_b32 v13, v5, v6, vcc
    v_lshlrev_b32 v12, 10, v12
    v_lshl_add_u32 v12, v2, 2, v12
    v_add_u32 v12, s68, v12
    v_mov_b32 v7, 0x40000000
    v_cmp_lt_u32 vcc, 15, v0
    s_nop 1
    v_cndmask_b32 v12, v12, v7, vcc
    s_mov_b32 s36, 0x400000
    s_mov_b32 s37, 0x600000
    buffer_load_dword v14, v12, s[8:11], s36 offen sc1
    buffer_load_dword v15, v12, s[8:11], s37 offen sc1
    v_mul_u32_u24 v3, 224, v1
    s_mul_i32 s36, s24, 14336
    s_add_u32 s36, s36, 0x1b0000
    s_add_u32 s37, s36, 7168
L_B_poll:
    buffer_load_dwordx4 v[72:75], v3, s[8:11], s36 offen offset:0 sc1
    buffer_load_dwordx4 v[76:79], v3, s[8:11], s36 offen offset:16 sc1
    buffer_load_dwordx4 v[80:83], v3, s[8:11], s36 offen offset:32 sc1
    buffer_load_dwordx4 v[84:87], v3, s[8:11], s36 offen offset:48 sc1
    buffer_load_dwordx4 v[88:91], v3, s[8:11], s36 offen offset:64 sc1
    buffer_load_dwordx4 v[92:95], v3, s[8:11], s36 offen offset:80 sc1
    buffer_load_dwordx4 v[96:99], v3, s[8:11], s36 offen offset:96 sc1
    buffer_load_dwordx4 v[100:103], v3, s[8:11], s36 offen offset:112 sc1
    buffer_load_dwordx4 v[104:107], v3, s[8:11], s36 offen offset:128 sc1
    buffer_load_dwordx4 v[108:111], v3, s[8:11], s36 offen offset:144 sc1
    buffer_load_dwordx4 v[112:115], v3, s[8:11], s36 offen offset:160 sc1
    buffer_load_dwordx4 v[116:119], v3, s[8:11], s36 offen offset:176 sc1
    buffer_load_dwordx4 v[120:123], v3, s[8:11], s36 offen offset:192 sc1
    buffer_load_dwordx4 v[124:127], v3, s[8:11], s36 offen offset:208 sc1
    buffer_load_dwordx4 v[128:131], v3, s[8:11], s37 offen offset:0 sc1
    buffer_load_dwordx4 v[132:135], v3, s[8:11], s37 offen offset:16 sc1
    buffer_load_dwordx4 v[136:139], v3, s[8:11], s37 offen offset:32 sc1
    buffer_load_dwordx4 v[140:143], v3, s[8:11], s37 offen offset:48 sc1
    buffer_load_dwordx4 v[144:147], v3, s[8:11], s37 offen offset:64 sc1
    buffer_load_dwordx4 v[148:151], v3, s[8:11], s37 offen offset:80 sc1
    buffer_load_dwordx4 v[152:155], v3, s[8:11], s37 offen offset:96 sc1
    buffer_load_dwordx4 v[156:159], v3, s[8:11], s37 offen offset:112 sc1
    buffer_load_dwordx4 v[160:163], v3, s[8:11], s37 offen offset:128 sc1
    buffer_load_dwordx4 v[164:167], v3, s[8:11], s37 offen offset:144 sc1
    buffer_load_dwordx4 v[168:171], v3, s[8:11], s37 offen offset:160 sc1
    buffer_load_dwordx4 v[172:175], v3, s[8:11], s37 offen offset:176 sc1
    buffer_load_dwordx4 v[176:179], v3, s[8:11], s37 offen offset:192 sc1
    buffer_load_dwordx4 v[180:183], v3, s[8:11], s37 offen offset:208 sc1
    s_add_u32 s32, s32, 1
    s_cmp_gt_u32 s32, 200000
    v_mov_b32 v5, 0
    s_waitcnt vmcnt(0)
    v_max3_u32 v5, v5, v72, v73
    v_max3_u32 v5, v5, v74, v75
    v_max3_u32 v5, v5, v76, v77
    v_max3_u32 v5, v5, v78, v79
    v_max3_u32 v5, v5, v80, v81
    v_max3_u32 v5, v5, v82, v83
    v_max3_u32 v5, v5, v84, v85
    v_max3_u32 v5, v5, v86, v87
    v_max3_u32 v5, v5, v88, v89
    v_max3_u32 v5, v5, v90, v91
    v_max3_u32 v5, v5, v92, v93
    v_max3_u32 v5, v5, v94, v95
    v_max3_u32 v5, v5, v96, v97
    v_max3_u32 v5, v5, v98, v99
    v_max3_u32 v5, v5, v100, v101
    v_max3_u32 v5, v5, v102, v103
    v_max3_u32 v5, v5, v104, v105
    v_max3_u32 v5, v5, v106, v107
    v_max3_u32 v5, v5, v108, v109
    v_max3_u32 v5, v5, v110, v111
    v_max3_u32 v5, v5, v112, v113
    v_max3_u32 v5, v5, v114, v115
    v_max3_u32 v5, v5, v116, v117
    v_max3_u32 v5, v5, v118, v119
    v_max3_u32 v5, v5, v120, v121
    v_max3_u32 v5, v5, v122, v123
    v_max3_u32 v5, v5, v124, v125
    v_max3_u32 v5, v5, v126, v127
    v_max3_u32 v5, v5, v128, v129
    v_max3_u32 v5, v5, v130, v131
    v_max3_u32 v5, v5, v132, v133
    v_max3_u32 v5, v5, v134, v135
    v_max3_u32 v5, v5, v136, v137
    v_max3_u32 v5, v5, v138, v139
    v_max3_u32 v5, v5, v140, v141
    v_max3_u32 v5, v5, v142, v143
    v_max3_u32 v5, v5, v144, v145
    v_max3_u32 v5, v5, v146, v147
    v_max3_u32 v5, v5, v148, v149
    v_max3_u32 v5, v5, v150, v151
    v_max3_u32 v5, v5, v152, v153
    v_max3_u32 v5, v5, v154, v155
    v_max3_u32 v5, v5, v156, v157
    v_max3_u32 v5, v5, v158, v159
    v_max3_u32 v5, v5, v160, v161
    v_max3_u32 v5, v5, v162, v163
    v_max3_u32 v5, v5, v164, v165
    v_max3_u32 v5, v5, v166, v167
    v_max3_u32 v5, v5, v168, v169
    v_max3_u32 v5, v5, v170, v171
    v_max3_u32 v5, v5, v172, v173
    v_max3_u32 v5, v5, v174, v175
    v_max3_u32 v5, v5, v176, v177
    v_max3_u32 v5, v5, v178, v179
    v_max3_u32 v5, v5, v180, v181
    v_max3_u32 v5, v5, v182, v183
    s_cbranch_scc1 L_B_got
    v_cmp_eq_u32 vcc, -1, v5
    s_cbranch_vccnz L_B_poll
L_B_got:
    v_mov_b32 v184, 0
    v_mov_b32 v185, 0
    v_mov_b32 v186, 0
    v_mov_b32 v187, 0
    v_lshlrev_b32 v5, 16, v16
    v_and_b32 v7, 0xffff0000, v16
    v_fmac_f32 v184, v72, v5
    v_fmac_f32 v185, v72, v7
    v_fmac_f32 v186, v128, v5
    v_fmac_f32 v187, v128, v7
    v_lshlrev_b32 v5, 16, v17
    v_and_b32 v7, 0xffff0000, v17
    v_fmac_f32 v184, v73, v5
    v_fmac_f32 v185, v73, v7
    v_fmac_f32 v186, v129, v5
    v_fmac_f32 v187, v129, v7
    v_lshlrev_b32 v5, 16, v18
    v_and_b32 v7, 0xffff0000, v18
    v_fmac_f32 v184, v74, v5
    v_fmac_f32 v185, v74, v7
    v_fmac_f32 v186, v130, v5
    v_fmac_f32 v187, v130, v7
    v_lshlrev_b32 v5, 16, v19
    v_and_b32 v7, 0xffff0000, v19
    v_fmac_f32 v184, v75, v5
    v_fmac_f32 v185, v75, v7
    v_fmac_f32 v186, v131, v5
    v_fmac_f32 v187, v131, v7
    v_lshlrev_b32 v5, 16, v20
    v_and_b32 v7, 0xffff0000, v20
    v_fmac_f32 v184, v76, v5
    v_fmac_f32 v185, v76, v7
    v_fmac_f32 v186, v132, v5
    v_fmac_f32 v187, v132, v7
    v_lshlrev_b32 v5, 16, v21
    v_and_b32 v7, 0xffff0000, v21
    v_fmac_f32 v184, v77, v5
    v_fmac_f32 v185, v77, v7
    v_fmac_f32 v186, v133, v5
    v_fmac_f32 v187, v133, v7
    v_lshlrev_b32 v5, 16, v22
    v_and_b32 v7, 0xffff0000, v22
    v_fmac_f32 v184, v78, v5
    v_fmac_f32 v185, v78, v7
    v_fmac_f32 v186, v134, v5
    v_fmac_f32 v187, v134, v7
    v_lshlrev_b32 v5, 16, v23
    v_and_b32 v7, 0xffff0000, v23
    v_fmac_f32 v184, v79, v5
    v_fmac_f32 v185, v79, v7
    v_fmac_f32 v186, v135, v5
    v_fmac_f32 v187, v135, v7
    v_lshlrev_b32 v5, 16, v24
    v_and_b32 v7, 0xffff0000, v24
    v_fmac_f32 v184, v80, v5
    v_fmac_f32 v185, v80, v7
    v_fmac_f32 v186, v136, v5
    v_fmac_f32 v187, v136, v7
    v_lshlrev_b32 v5, 16, v25
    v_and_b32 v7, 0xffff0000, v25
    v_fmac_f32 v184, v81, v5
    v_fmac_f32 v185, v81, v7
    v_fmac_f32 v186, v137, v5
    v_fmac_f32 v187, v137, v7
    v_lshlrev_b32 v5, 16, v26
    v_and_b32 v7, 0xffff0000, v26
    v_fmac_f32 v184, v82, v5
    v_fmac_f32 v185, v82, v7
    v_fmac_f32 v186, v138, v5
    v_fmac_f32 v187, v138, v7
    v_lshlrev_b32 v5, 16, v27
    v_and_b32 v7, 0xffff0000, v27
    v_fmac_f32 v184, v83, v5
    v_fmac_f32 v185, v83, v7
    v_fmac_f32 v186, v139, v5
    v_fmac_f32 v187, v139, v7
    v_lshlrev_b32 v5, 16, v28
    v_and_b32 v7, 0xffff0000, v28
    v_fmac_f32 v184, v84, v5
    v_fmac_f32 v185, v84, v7
    v_fmac_f32 v186, v140, v5
    v_fmac_f32 v187, v140, v7
    v_lshlrev_b32 v5, 16, v29
    v_and_b32 v7, 0xffff0000, v29
    v_fmac_f32 v184, v85, v5
    v_fmac_f32 v185, v85, v7
    v_fmac_f32 v186, v141, v5
    v_fmac_f32 v187, v141, v7
    v_lshlrev_b32 v5, 16, v30
    v_and_b32 v7, 0xffff0000, v30
    v_fmac_f32 v184, v86, v5
    v_fmac_f32 v185, v86, v7
    v_fmac_f32 v186, v142, v5
    v_fmac_f32 v187, v142, v7
    v_lshlrev_b32 v5, 16, v31
    v_and_b32 v7, 0xffff0000, v31
    v_fmac_f32 v184, v87, v5
    v_fmac_f32 v185, v87, v7
    v_fmac_f32 v186, v143, v5
    v_fmac_f32 v187, v143, v7
    v_lshlrev_b32 v5, 16, v32
    v_and_b32 v7, 0xffff0000, v32
    v_fmac_f32 v184, v88, v5
    v_fmac_f32 v185, v88, v7
    v_fmac_f32 v186, v144, v5
    v_fmac_f32 v187, v144, v7
    v_lshlrev_b32 v5, 16, v33
    v_and_b32 v7, 0xffff0000, v33
    v_fmac_f32 v184, v89, v5
    v_fmac_f32 v185, v89, v7
    v_fmac_f32 v186, v145, v5
    v_fmac_f32 v187, v145, v7
    v_lshlrev_b32 v5, 16, v34
    v_and_b32 v7, 0xffff0000, v34
    v_fmac_f32 v184, v90, v5
    v_fmac_f32 v185, v90, v7
    v_fmac_f32 v186, v146, v5
    v_fmac_f32 v187, v146, v7
    v_lshlrev_b32 v5, 16, v35
    v_and_b32 v7, 0xffff0000, v35
    v_fmac_f32 v184, v91, v5
    v_fmac_f32 v185, v91, v7
    v_fmac_f32 v186, v147, v5
    v_fmac_f32 v187, v147, v7
    v_lshlrev_b32 v5, 16, v36
    v_and_b32 v7, 0xffff0000, v36
    v_fmac_f32 v184, v92, v5
    v_fmac_f32 v185, v92, v7
    v_fmac_f32 v186, v148, v5
    v_fmac_f32 v187, v148, v7
    v_lshlrev_b32 v5, 16, v37
    v_and_b32 v7, 0xffff0000, v37
    v_fmac_f32 v184, v93, v5
    v_fmac_f32 v185, v93, v7
    v_fmac_f32 v186, v149, v5
    v_fmac_f32 v187, v149, v7
    v_lshlrev_b32 v5, 16, v38
    v_and_b32 v7, 0xffff0000, v38
    v_fmac_f32 v184, v94, v5
    v_fmac_f32 v185, v94, v7
    v_fmac_f32 v186, v150, v5
    v_fmac_f32 v187, v150, v7
    v_lshlrev_b32 v5, 16, v39
    v_and_b32 v7, 0xffff0000, v39
    v_fmac_f32 v184, v95, v5
    v_fmac_f32 v185, v95, v7
    v_fmac_f32 v186, v151, v5
    v_fmac_f32 v187, v151, v7
    v_lshlrev_b32 v5, 16, v40
    v_and_b32 v7, 0xffff0000, v40
    v_fmac_f32 v184, v96, v5
    v_fmac_f32 v185, v96, v7
    v_fmac_f32 v186, v152, v5
    v_fmac_f32 v187, v152, v7
    v_lshlrev_b32 v5, 16, v41
    v_and_b32 v7, 0xffff0000, v41
    v_fmac_f32 v184, v97, v5
    v_fmac_f32 v185, v97, v7
    v_fmac_f32 v186, v153, v5
    v_fmac_f32 v187, v153, v7
    v_lshlrev_b32 v5, 16, v42
    v_and_b32 v7, 0xffff0000, v42
    v_fmac_f32 v184, v98, v5
    v_fmac_f32 v185, v98, v7
    v_fmac_f32 v186, v154, v5
    v_fmac_f32 v187, v154, v7
    v_lshlrev_b32 v5, 16, v43
    v_and_b32 v7, 0xffff0000, v43
    v_fmac_f32 v184, v99, v5
    v_fmac_f32 v185, v99, v7
    v_fmac_f32 v186, v155, v5
    v_fmac_f32 v187, v155, v7
    v_lshlrev_b32 v5, 16, v44
    v_and_b32 v7, 0xffff0000, v44
    v_fmac_f32 v184, v100, v5
    v_fmac_f32 v185, v100, v7
    v_fmac_f32 v186, v156, v5
    v_fmac_f32 v187, v156, v7
    v_lshlrev_b32 v5, 16, v45
    v_and_b32 v7, 0xffff0000, v45
    v_fmac_f32 v184, v101, v5
    v_fmac_f32 v185, v101, v7
    v_fmac_f32 v186, v157, v5
    v_fmac_f32 v187, v157, v7
    v_lshlrev_b32 v5, 16, v46
    v_and_b32 v7, 0xffff0000, v46
    v_fmac_f32 v184, v102, v5
    v_fmac_f32 v185, v102, v7
    v_fmac_f32 v186, v158, v5
    v_fmac_f32 v187, v158, v7
    v_lshlrev_b32 v5, 16, v47
    v_and_b32 v7, 0xffff0000, v47
    v_fmac_f32 v184, v103, v5
    v_fmac_f32 v185, v103, v7
    v_fmac_f32 v186, v159, v5
    v_fmac_f32 v187, v159, v7
    v_lshlrev_b32 v5, 16, v48
    v_and_b32 v7, 0xffff0000, v48
    v_fmac_f32 v184, v104, v5
    v_fmac_f32 v185, v104, v7
    v_fmac_f32 v186, v160, v5
    v_fmac_f32 v187, v160, v7
    v_lshlrev_b32 v5, 16, v49
    v_and_b32 v7, 0xffff0000, v49
    v_fmac_f32 v184, v105, v5
    v_fmac_f32 v185, v105, v7
    v_fmac_f32 v186, v161, v5
    v_fmac_f32 v187, v161, v7
    v_lshlrev_b32 v5, 16, v50
    v_and_b32 v7, 0xffff0000, v50
    v_fmac_f32 v184, v106, v5
    v_fmac_f32 v185, v106, v7
    v_fmac_f32 v186, v162, v5
    v_fmac_f32 v187, v162, v7
    v_lshlrev_b32 v5, 16, v51
    v_and_b32 v7, 0xffff0000, v51
    v_fmac_f32 v184, v107, v5
    v_fmac_f32 v185, v107, v7
    v_fmac_f32 v186, v163, v5
    v_fmac_f32 v187, v163, v7
    v_lshlrev_b32 v5, 16, v52
    v_and_b32 v7, 0xffff0000, v52
    v_fmac_f32 v184, v108, v5
    v_fmac_f32 v185, v108, v7
    v_fmac_f32 v186, v164, v5
    v_fmac_f32 v187, v164, v7
    v_lshlrev_b32 v5, 16, v53
    v_and_b32 v7, 0xffff0000, v53
    v_fmac_f32 v184, v109, v5
    v_fmac_f32 v185, v109, v7
    v_fmac_f32 v186, v165, v5
    v_fmac_f32 v187, v165, v7
    v_lshlrev_b32 v5, 16, v54
    v_and_b32 v7, 0xffff0000, v54
    v_fmac_f32 v184, v110, v5
    v_fmac_f32 v185, v110, v7
    v_fmac_f32 v186, v166, v5
    v_fmac_f32 v187, v166, v7
    v_lshlrev_b32 v5, 16, v55
    v_and_b32 v7, 0xffff0000, v55
    v_fmac_f32 v184, v111, v5
    v_fmac_f32 v185, v111, v7
    v_fmac_f32 v186, v167, v5
    v_fmac_f32 v187, v167, v7
    v_lshlrev_b32 v5, 16, v56
    v_and_b32 v7, 0xffff0000, v56
    v_fmac_f32 v184, v112, v5
    v_fmac_f32 v185, v112, v7
    v_fmac_f32 v186, v168, v5
    v_fmac_f32 v187, v168, v7
    v_lshlrev_b32 v5, 16, v57
    v_and_b32 v7, 0xffff0000, v57
    v_fmac_f32 v184, v113, v5
    v_fmac_f32 v185, v113, v7
    v_fmac_f32 v186, v169, v5
    v_fmac_f32 v187, v169, v7
    v_lshlrev_b32 v5, 16, v58
    v_and_b32 v7, 0xffff0000, v58
    v_fmac_f32 v184, v114, v5
    v_fmac_f32 v185, v114, v7
    v_fmac_f32 v186, v170, v5
    v_fmac_f32 v187, v170, v7
    v_lshlrev_b32 v5, 16, v59
    v_and_b32 v7, 0xffff0000, v59
    v_fmac_f32 v184, v115, v5
    v_fmac_f32 v185, v115, v7
    v_fmac_f32 v186, v171, v5
    v_fmac_f32 v187, v171, v7
    v_lshlrev_b32 v5, 16, v60
    v_and_b32 v7, 0xffff0000, v60
    v_fmac_f32 v184, v116, v5
    v_fmac_f32 v185, v116, v7
    v_fmac_f32 v186, v172, v5
    v_fmac_f32 v187, v172, v7
    v_lshlrev_b32 v5, 16, v61
    v_and_b32 v7, 0xffff0000, v61
    v_fmac_f32 v184, v117, v5
    v_fmac_f32 v185, v117, v7
    v_fmac_f32 v186, v173, v5
    v_fmac_f32 v187, v173, v7
    v_lshlrev_b32 v5, 16, v62
    v_and_b32 v7, 0xffff0000, v62
    v_fmac_f32 v184, v118, v5
    v_fmac_f32 v185, v118, v7
    v_fmac_f32 v186, v174, v5
    v_fmac_f32 v187, v174, v7
    v_lshlrev_b32 v5, 16, v63
    v_and_b32 v7, 0xffff0000, v63
    v_fmac_f32 v184, v119, v5
    v_fmac_f32 v185, v119, v7
    v_fmac_f32 v186, v175, v5
    v_fmac_f32 v187, v175, v7
    v_lshlrev_b32 v5, 16, v64
    v_and_b32 v7, 0xffff0000, v64
    v_fmac_f32 v184, v120, v5
    v_fmac_f32 v185, v120, v7
    v_fmac_f32 v186, v176, v5
    v_fmac_f32 v187, v176, v7
    v_lshlrev_b32 v5, 16, v65
    v_and_b32 v7, 0xffff0000, v65
    v_fmac_f32 v184, v121, v5
    v_fmac_f32 v185, v121, v7
    v_fmac_f32 v186, v177, v5
    v_fmac_f32 v187, v177, v7
    v_lshlrev_b32 v5, 16, v66
    v_and_b32 v7, 0xffff0000, v66
    v_fmac_f32 v184, v122, v5
    v_fmac_f32 v185, v122, v7
    v_fmac_f32 v186, v178, v5
    v_fmac_f32 v187, v178, v7
    v_lshlrev_b32 v5, 16, v67
    v_and_b32 v7, 0xffff0000, v67
    v_fmac_f32 v184, v123, v5
    v_fmac_f32 v185, v123, v7
    v_fmac_f32 v186, v179, v5
    v_fmac_f32 v187, v179, v7
    v_lshlrev_b32 v5, 16, v68
    v_and_b32 v7, 0xffff0000, v68
    v_fmac_f32 v184, v124, v5
    v_fmac_f32 v185, v124, v7
    v_fmac_f32 v186, v180, v5
    v_fmac_f32 v187, v180, v7
    v_lshlrev_b32 v5, 16, v69
    v_and_b32 v7, 0xffff0000, v69
    v_fmac_f32 v184, v125, v5
    v_fmac_f32 v185, v125, v7
    v_fmac_f32 v186, v181, v5
    v_fmac_f32 v187, v181, v7
    v_lshlrev_b32 v5, 16, v70
    v_and_b32 v7, 0xffff0000, v70
    v_fmac_f32 v184, v126, v5
    v_fmac_f32 v185, v126, v7
    v_fmac_f32 v186, v182, v5
    v_fmac_f32 v187, v182, v7
    v_lshlrev_b32 v5, 16, v71
    v_and_b32 v7, 0xffff0000, v71
    v_fmac_f32 v184, v127, v5
    v_fmac_f32 v185, v127, v7
    v_fmac_f32 v186, v183, v5
    v_fmac_f32 v187, v183, v7
    v_add_f32_dpp v184, v184, v184 row_ror:8 row_mask:0xf bank_mask:0xf
    v_add_f32_dpp v185, v185, v185 row_ror:8 row_mask:0xf bank_mask:0xf
    v_add_f32_dpp v186, v186, v186 row_ror:8 row_mask:0xf bank_mask:0xf
    v_add_f32_dpp v187, v187, v187 row_ror:8 row_mask:0xf bank_mask:0xf
    v_mov_b32 v5, v184
    s_nop 1
    v_permlane16_swap_b32 v184, v5
    v_add_f32 v184, v184, v5
    v_mov_b32 v5, v185
    s_nop 1
    v_permlane16_swap_b32 v185, v5
    v_add_f32 v185, v185, v5
    v_mov_b32 v5, v186
    s_nop 1
    v_permlane16_swap_b32 v186, v5
    v_add_f32 v186, v186, v5
    v_mov_b32 v5, v187
    s_nop 1
    v_permlane16_swap_b32 v187, v5
    v_add_f32 v187, v187, v5
    v_mov_b32 v5, v184
    s_nop 1
    v_permlane32_swap_b32 v184, v5
    v_add_f32 v184, v184, v5
    v_mov_b32 v5, v185
    s_nop 1
    v_permlane32_swap_b32 v185, v5
    v_add_f32 v185, v185, v5
    v_mov_b32 v5, v186
    s_nop 1
    v_permlane32_swap_b32 v186, v5
    v_add_f32 v186, v186, v5
    v_mov_b32 v5, v187
    s_nop 1
    v_permlane32_swap_b32 v187, v5
    v_add_f32 v187, v187, v5
    v_lshrrev_b32 v7, 6, v0
    v_lshlrev_b32 v7, 7, v7
    v_lshl_add_u32 v7, v2, 4, v7
    ds_write_b128 v7, v[184:187] offset:64
    s_waitcnt lgkmcnt(0)
    s_barrier
    v_lshlrev_b32 v7, 4, v2
    v_lshl_add_u32 v7, v9, 3, v7
    ds_read_b64 v[188:189], v7 offset:64
    ds_read_b64 v[190:191], v7 offset:192
    ds_read_b64 v[192:193], v7 offset:320
    ds_read_b64 v[194:195], v7 offset:448
    v_mul_f32 v10, 0xbfb8aa3b, v13
    v_exp_f32 v10, v10
    s_nop 0
    v_add_f32 v10, 1.0, v10
    v_rcp_f32 v10, v10
    s_nop 0
    v_cvt_pk_bf16_f32 v5, v10, v10
    v_lshlrev_b32 v10, 16, v5
    s_waitcnt lgkmcnt(0)
    v_lshlrev_b32 v196, 16, v15
    v_and_b32 v197, 0xffff0000, v15
    v_lshlrev_b32 v198, 16, v14
    v_and_b32 v199, 0xffff0000, v14
    v_add_f32 v188, v188, v190
    v_add_f32 v192, v192, v194
    v_add_f32 v188, v188, v192
    v_cvt_pk_bf16_f32 v5, v188, v188
    v_lshlrev_b32 v188, 16, v5
    v_mul_f32 v188, v188, v10
    v_cvt_pk_bf16_f32 v5, v188, v188
    v_lshlrev_b32 v188, 16, v5
    v_add_f32 v188, v188, v196
    v_cvt_pk_bf16_f32 v5, v188, v188
    v_lshlrev_b32 v188, 16, v5
    v_add_f32 v188, v188, v198
    v_add_f32 v189, v189, v191
    v_add_f32 v193, v193, v195
    v_add_f32 v189, v189, v193
    v_cvt_pk_bf16_f32 v5, v189, v189
    v_lshlrev_b32 v189, 16, v5
    v_mul_f32 v189, v189, v10
    v_cvt_pk_bf16_f32 v5, v189, v189
    v_lshlrev_b32 v189, 16, v5
    v_add_f32 v189, v189, v197
    v_cvt_pk_bf16_f32 v5, v189, v189
    v_lshlrev_b32 v189, 16, v5
    v_add_f32 v189, v189, v199
    v_cvt_pk_bf16_f32 v11, v188, v189
    s_add_u32 s24, s24, 1
    s_cmp_lt_u32 s24, 2
    s_cbranch_scc1 L_B_round
L_B_store:
    buffer_store_dword v11, v12, s[60:63], 0 offen sc1
    s_branch L_end
L_end:
    s_endpgm
.section .rodata,"a"
.p2align 6
.amdhsa_kernel sequential_preLN__memory_aug_recurrent_mem_tr__moe_arch_mod__prompt_kernel
  .amdhsa_next_free_vgpr 512
  .amdhsa_next_free_sgpr 102
  .amdhsa_accum_offset 256
  .amdhsa_group_segment_fixed_size 0
  .amdhsa_kernarg_size 120
  .amdhsa_user_sgpr_count 2
  .amdhsa_user_sgpr_kernarg_segment_ptr 1
  .amdhsa_system_sgpr_workgroup_id_x 1
.end_amdhsa_kernel
```

```asm
; @launch grid=(256,1,1) block=(256,1,1) lds=163840
.amdgcn_target "amdgcn-amd-amdhsa--gfx950"
.text
.globl sequential_preLN__memory_aug_recurrent_mem_tr__moe_arch_mod__prompt_kernel
.p2align 8
.type sequential_preLN__memory_aug_recurrent_mem_tr__moe_arch_mod__prompt_kernel,@function
sequential_preLN__memory_aug_recurrent_mem_tr__moe_arch_mod__prompt_kernel:
    s_cmp_ge_u32 s2, 256
    s_cbranch_scc1 L_end
    s_load_dwordx8 s[44:51], s[0:1], 0
    s_load_dwordx4 s[52:55], s[0:1], 32
    s_load_dwordx4 s[56:59], s[0:1], 104
    s_load_dwordx2 s[80:81], s[0:1], 64
    s_load_dwordx2 s[82:83], s[0:1], 96
    s_load_dwordx4 s[84:87], s[0:1], 72
    s_load_dwordx2 s[88:89], s[0:1], 88
    v_lshrrev_b32 v1, 6, v0
    s_nop 0
    v_readfirstlane_b32 s21, v1
    s_waitcnt lgkmcnt(0)
    s_mov_b32 s8, s58
    s_and_b32 s9, s59, 0xffff
    s_mov_b32 s10, 0x10000000
    s_mov_b32 s11, 0x20000
    s_mov_b32 s16, s56
    s_and_b32 s17, s57, 0xffff
    s_mov_b32 s18, 0x100
    s_mov_b32 s19, 0x20000
    s_and_b32 s3, s2, 7
    s_cmp_lg_u32 s3, 0
    s_cbranch_scc1 L_worker
    s_lshr_b32 s20, s2, 3
    v_mov_b32 v1, 0x4444
    v_bfe_u32 v14, v0, 1, 1
    s_mov_b32 s38, 0xaaaa
    v_mad_u32_u24 v1, v14, s38, v1
    v_mov_b32 v3, 0x0
    v_bfe_u32 v14, v0, 0, 1
    s_mov_b32 s38, 0x10
    v_mad_u32_u24 v3, v14, s38, v3
    v_bfe_u32 v14, v0, 1, 1
    s_mov_b32 s38, 0x20
    v_mad_u32_u24 v3, v14, s38, v3
    v_bfe_u32 v14, v0, 2, 1
    s_mov_b32 s38, 0x40
    v_mad_u32_u24 v3, v14, s38, v3
    v_bfe_u32 v14, v0, 3, 1
    s_mov_b32 s38, 0x80
    v_mad_u32_u24 v3, v14, s38, v3
    v_bfe_u32 v14, v0, 4, 1
    s_mov_b32 s38, 0x100
    v_mad_u32_u24 v3, v14, s38, v3
    v_bfe_u32 v14, v0, 5, 1
    s_mov_b32 s38, 0x200
    v_mad_u32_u24 v3, v14, s38, v3
    v_mov_b32 v2, 0x0
    v_bfe_u32 v14, v0, 0, 1
    s_mov_b32 s38, 0x10
    v_mad_u32_u24 v2, v14, s38, v2
    v_bfe_u32 v14, v0, 1, 1
    s_mov_b32 s38, 0x20
    v_mad_u32_u24 v2, v14, s38, v2
    v_bfe_u32 v14, v0, 2, 1
    s_mov_b32 s38, 0x40
    v_mad_u32_u24 v2, v14, s38, v2
    v_bfe_u32 v14, v0, 3, 1
    s_mov_b32 s38, 0x80
    v_mad_u32_u24 v2, v14, s38, v2
    v_bfe_u32 v14, v0, 4, 1
    s_mov_b32 s38, 0x100
    v_mad_u32_u24 v2, v14, s38, v2
    v_bfe_u32 v14, v0, 5, 1
    s_mov_b32 s38, 0x200
    v_mad_u32_u24 v2, v14, s38, v2
    v_bfe_u32 v14, v0, 6, 1
    s_mov_b32 s38, 0x800
    v_mad_u32_u24 v2, v14, s38, v2
    v_bfe_u32 v14, v0, 7, 1
    s_mov_b32 s38, 0x1000
    v_mad_u32_u24 v2, v14, s38, v2
    v_mov_b32 v4, 0x8000
    v_bfe_u32 v14, v0, 0, 1
    s_mov_b32 s38, 0x10
    v_mad_u32_u24 v4, v14, s38, v4
    v_bfe_u32 v14, v0, 1, 1
    s_mov_b32 s38, 0x20
    v_mad_u32_u24 v4, v14, s38, v4
    v_bfe_u32 v14, v0, 2, 1
    s_mov_b32 s38, 0x40
    v_mad_u32_u24 v4, v14, s38, v4
    v_bfe_u32 v14, v0, 3, 1
    s_mov_b32 s38, 0x80
    v_mad_u32_u24 v4, v14, s38, v4
    v_bfe_u32 v14, v0, 4, 1
    s_mov_b32 s38, 0x100
    v_mad_u32_u24 v4, v14, s38, v4
    v_bfe_u32 v14, v0, 5, 1
    s_mov_b32 s38, 0x200
    v_mad_u32_u24 v4, v14, s38, v4
    v_bfe_u32 v14, v0, 6, 1
    s_mov_b32 s38, 0x8000
    v_mad_u32_u24 v4, v14, s38, v4
    v_bfe_u32 v14, v0, 7, 1
    s_mov_b32 s38, 0x10000
    v_mad_u32_u24 v4, v14, s38, v4
    v_mov_b32 v5, 0x4000
    v_bfe_u32 v14, v0, 0, 1
    s_mov_b32 s38, 0x4
    v_mad_u32_u24 v5, v14, s38, v5
    v_bfe_u32 v14, v0, 1, 1
    s_mov_b32 s38, 0x8
    v_mad_u32_u24 v5, v14, s38, v5
    v_bfe_u32 v14, v0, 2, 1
    s_mov_b32 s38, 0x10
    v_mad_u32_u24 v5, v14, s38, v5
    v_bfe_u32 v14, v0, 3, 1
    s_mov_b32 s38, 0x20
    v_mad_u32_u24 v5, v14, s38, v5
    v_bfe_u32 v14, v0, 4, 1
    s_mov_b32 s38, 0x240
    v_mad_u32_u24 v5, v14, s38, v5
    v_bfe_u32 v14, v0, 5, 1
    s_mov_b32 s38, 0x480
    v_mad_u32_u24 v5, v14, s38, v5
    v_bfe_u32 v14, v0, 6, 1
    s_mov_b32 s38, 0x40
    v_mad_u32_u24 v5, v14, s38, v5
    v_bfe_u32 v14, v0, 7, 1
    s_mov_b32 s38, 0x80
    v_mad_u32_u24 v5, v14, s38, v5
    v_mov_b32 v6, 0x4000
    v_bfe_u32 v14, v0, 1, 1
    s_mov_b32 s38, 0x120
    v_mad_u32_u24 v6, v14, s38, v6
    v_bfe_u32 v14, v0, 2, 1
    s_mov_b32 s38, 0x240
    v_mad_u32_u24 v6, v14, s38, v6
    v_bfe_u32 v14, v0, 3, 1
    s_mov_b32 s38, 0x480
    v_mad_u32_u24 v6, v14, s38, v6
    v_bfe_u32 v14, v0, 4, 1
    s_mov_b32 s38, 0x10
    v_mad_u32_u24 v6, v14, s38, v6
    v_bfe_u32 v14, v0, 5, 1
    s_mov_b32 s38, 0x20
    v_mad_u32_u24 v6, v14, s38, v6
    v_mov_b32 v7, 0x4900
    v_bfe_u32 v14, v0, 0, 1
    s_mov_b32 s38, 0x120
    v_mad_u32_u24 v7, v14, s38, v7
    v_bfe_u32 v14, v0, 2, 1
    s_mov_b32 s38, 0x240
    v_mad_u32_u24 v7, v14, s38, v7
    v_bfe_u32 v14, v0, 3, 1
    s_mov_b32 s38, 0x480
    v_mad_u32_u24 v7, v14, s38, v7
    v_bfe_u32 v14, v0, 4, 1
    s_mov_b32 s38, 0x10
    v_mad_u32_u24 v7, v14, s38, v7
    v_bfe_u32 v14, v0, 5, 1
    s_mov_b32 s38, 0x20
    v_mad_u32_u24 v7, v14, s38, v7
    v_mov_b32 v8, 0x5200
    v_bfe_u32 v14, v0, 1, 1
    s_mov_b32 s38, 0x10
    v_mad_u32_u24 v8, v14, s38, v8
    v_bfe_u32 v14, v0, 2, 1
    s_mov_b32 s38, 0x40
    v_mad_u32_u24 v8, v14, s38, v8
    v_bfe_u32 v14, v0, 3, 1
    s_mov_b32 s38, 0x80
    v_mad_u32_u24 v8, v14, s38, v8
    v_bfe_u32 v14, v0, 4, 1
    s_mov_b32 s38, 0x20
    v_mad_u32_u24 v8, v14, s38, v8
    v_bfe_u32 v14, v0, 5, 1
    s_mov_b32 s38, 0x100
    v_mad_u32_u24 v8, v14, s38, v8
    v_bfe_u32 v14, v0, 6, 1
    s_mov_b32 s38, 0x200
    v_mad_u32_u24 v8, v14, s38, v8
    v_bfe_u32 v14, v0, 7, 1
    s_mov_b32 s38, 0x400
    v_mad_u32_u24 v8, v14, s38, v8
    v_mov_b32 v24, 0x0
    v_bfe_u32 v14, v0, 3, 1
    s_mov_b32 s38, 0x1
    v_mad_u32_u24 v24, v14, s38, v24
    v_bfe_u32 v14, v0, 4, 1
    s_mov_b32 s38, 0x2
    v_mad_u32_u24 v24, v14, s38, v24
    v_bfe_u32 v14, v0, 5, 1
    s_mov_b32 s38, 0x4
    v_mad_u32_u24 v24, v14, s38, v24
    v_bfe_u32 v14, v0, 6, 1
    s_mov_b32 s38, 0x8
    v_mad_u32_u24 v24, v14, s38, v24
    v_bfe_u32 v14, v0, 7, 1
    s_mov_b32 s38, 0x10
    v_mad_u32_u24 v24, v14, s38, v24
    v_add_u32 v24, s20, v24
    v_and_b32 v24, 31, v24
    v_lshlrev_b32 v24, 6, v24
    v_mov_b32 v9, 0x0
    v_bfe_u32 v14, v0, 0, 1
    s_mov_b32 s38, 0x8
    v_mad_u32_u24 v9, v14, s38, v9
    v_bfe_u32 v14, v0, 1, 1
    s_mov_b32 s38, 0x10
    v_mad_u32_u24 v9, v14, s38, v9
    v_bfe_u32 v14, v0, 2, 1
    s_mov_b32 s38, 0x20
    v_mad_u32_u24 v9, v14, s38, v9
    v_bfe_u32 v14, v0, 3, 1
    s_mov_b32 s38, 0x2000
    v_mad_u32_u24 v9, v14, s38, v9
    v_bfe_u32 v14, v0, 4, 1
    s_mov_b32 s38, 0x4000
    v_mad_u32_u24 v9, v14, s38, v9
    v_bfe_u32 v14, v0, 5, 1
    s_mov_b32 s38, 0x8000
    v_mad_u32_u24 v9, v14, s38, v9
    v_bfe_u32 v14, v0, 6, 1
    s_mov_b32 s38, 0x10000
    v_mad_u32_u24 v9, v14, s38, v9
    v_bfe_u32 v14, v0, 7, 1
    s_mov_b32 s38, 0x20000
    v_mad_u32_u24 v9, v14, s38, v9
    v_add_u32 v9, v9, v24
    v_mov_b32 v10, 0x80000
    v_bfe_u32 v14, v0, 0, 1
    s_mov_b32 s38, 0x8
    v_mad_u32_u24 v10, v14, s38, v10
    v_bfe_u32 v14, v0, 1, 1
    s_mov_b32 s38, 0x20
    v_mad_u32_u24 v10, v14, s38, v10
    v_bfe_u32 v14, v0, 4, 1
    s_mov_b32 s38, 0x10
    v_mad_u32_u24 v10, v14, s38, v10
    v_bfe_u32 v14, v0, 5, 1
    s_mov_b32 s38, 0x4
    v_mad_u32_u24 v10, v14, s38, v10
    v_bfe_u32 v14, v0, 6, 1
    s_mov_b32 s38, 0x800
    v_mad_u32_u24 v10, v14, s38, v10
    v_bfe_u32 v14, v0, 7, 1
    s_mov_b32 s38, 0x1000
    v_mad_u32_u24 v10, v14, s38, v10
    v_mov_b32 v25, s20
    v_mov_b32 v24, 0x0
    v_bfe_u32 v14, v25, 0, 1
    s_mov_b32 s38, 0x100
    v_mad_u32_u24 v24, v14, s38, v24
    v_bfe_u32 v14, v25, 1, 1
    s_mov_b32 s38, 0x40
    v_mad_u32_u24 v24, v14, s38, v24
    v_bfe_u32 v14, v25, 2, 1
    s_mov_b32 s38, 0x80
    v_mad_u32_u24 v24, v14, s38, v24
    v_bfe_u32 v14, v25, 3, 1
    s_mov_b32 s38, 0x200
    v_mad_u32_u24 v24, v14, s38, v24
    v_bfe_u32 v14, v25, 4, 1
    s_mov_b32 s38, 0x400
    v_mad_u32_u24 v24, v14, s38, v24
    v_add_u32 v10, v24, v10
    v_and_b32 v24, 12, v0
    v_cmp_ne_u32 vcc, 0, v24
    v_mov_b32 v24, 0x40000000
    s_nop 0
    v_cndmask_b32 v10, v10, v24, vcc
    s_lshl_b32 s6, s20, 13
    s_add_u32 s6, s6, 0x0
    s_mov_b32 s26, 4096
    v_and_b32 v24, 15, v0
    v_mov_b32 v16, 0
    v_mov_b32 v25, 0x3f80
    v_cmp_eq_u32 vcc, 0, v24
    s_nop 1
    v_cndmask_b32 v16, v16, v25, vcc
    v_mov_b32 v25, 0x3f800000
    v_cmp_eq_u32 vcc, 1, v24
    s_nop 1
    v_cndmask_b32 v16, v16, v25, vcc
    v_mov_b32 v17, 0
    v_mov_b32 v25, 0x3f80
    v_cmp_eq_u32 vcc, 4, v24
    s_nop 1
    v_cndmask_b32 v17, v17, v25, vcc
    v_mov_b32 v25, 0x3f800000
    v_cmp_eq_u32 vcc, 5, v24
    s_nop 1
    v_cndmask_b32 v17, v17, v25, vcc
    v_mov_b32 v18, 0
    v_mov_b32 v25, 0x3f80
    v_cmp_eq_u32 vcc, 8, v24
    s_nop 1
    v_cndmask_b32 v18, v18, v25, vcc
    v_mov_b32 v25, 0x3f800000
    v_cmp_eq_u32 vcc, 9, v24
    s_nop 1
    v_cndmask_b32 v18, v18, v25, vcc
    v_mov_b32 v19, 0
    v_mov_b32 v25, 0x3f80
    v_cmp_eq_u32 vcc, 12, v24
    s_nop 1
    v_cndmask_b32 v19, v19, v25, vcc
    v_mov_b32 v25, 0x3f800000
    v_cmp_eq_u32 vcc, 13, v24
    s_nop 1
    v_cndmask_b32 v19, v19, v25, vcc
    ds_write_b128 v3, v[16:19] offset:23040
    s_mov_b32 s34, 0x05040100
    s_mov_b32 s35, 0x07060302
    s_mov_b32 s33, 0x3e0293ee
    s_mov_b32 s40, 0x4e800000
    s_mov_b32 s32, 0
    s_mov_b32 s4, 0x3f803f80
    s_mov_b32 s5, 0x3f803f80
    s_lshl_b32 s36, s20, 14
    s_lshr_b32 s37, s21, 1
    s_lshl_b32 s37, s37, 12
    s_add_u32 s25, s36, s37
    s_lshl_b32 s37, s21, 11
    s_add_u32 s39, s36, s37
    s_add_u32 s39, s39, 8192
    v_mov_b32 v11, 0x0
    v_bfe_u32 v14, v0, 0, 1
    s_mov_b32 s38, 0x4
    v_mad_u32_u24 v11, v14, s38, v11
    v_bfe_u32 v14, v0, 1, 1
    s_mov_b32 s38, 0x8
    v_mad_u32_u24 v11, v14, s38, v11
    v_bfe_u32 v14, v0, 2, 1
    s_mov_b32 s38, 0x10
    v_mad_u32_u24 v11, v14, s38, v11
    v_bfe_u32 v14, v0, 3, 1
    s_mov_b32 s38, 0x20
    v_mad_u32_u24 v11, v14, s38, v11
    v_bfe_u32 v14, v0, 4, 1
    s_mov_b32 s38, 0x800
    v_mad_u32_u24 v11, v14, s38, v11
    v_bfe_u32 v14, v0, 5, 1
    s_mov_b32 s38, 0x2000
    v_mad_u32_u24 v11, v14, s38, v11
    v_bfe_u32 v14, v0, 6, 1
    s_mov_b32 s38, 0x100
    v_mad_u32_u24 v11, v14, s38, v11
    v_bfe_u32 v14, v0, 7, 1
    s_mov_b32 s38, 0x200
    v_mad_u32_u24 v11, v14, s38, v11
    s_mov_b32 s96, s48
    s_and_b32 s97, s49, 0xffff
    s_mov_b32 s98, 0x400000
    s_mov_b32 s99, 0x20000
    s_mov_b32 s88, s50
    s_and_b32 s89, s51, 0xffff
    s_mov_b32 s90, 0x400000
    s_mov_b32 s91, 0x20000
    s_mov_b32 s60, s52
    s_and_b32 s61, s53, 0xffff
    s_mov_b32 s62, 0x400000
    s_mov_b32 s63, 0x20000
    s_mov_b32 s92, s54
    s_and_b32 s93, s55, 0xffff
    s_mov_b32 s94, 0x400000
    s_mov_b32 s95, 0x20000
    s_lshl_b32 s29, s20, 17
    v_mov_b32 v16, 0x0
    v_bfe_u32 v14, v0, 0, 1
    s_mov_b32 s38, 0x10
    v_mad_u32_u24 v16, v14, s38, v16
    v_bfe_u32 v14, v0, 1, 1
    s_mov_b32 s38, 0x20
    v_mad_u32_u24 v16, v14, s38, v16
    v_bfe_u32 v14, v0, 2, 1
    s_mov_b32 s38, 0x40
    v_mad_u32_u24 v16, v14, s38, v16
    v_bfe_u32 v14, v0, 3, 1
    s_mov_b32 s38, 0x80
    v_mad_u32_u24 v16, v14, s38, v16
    v_bfe_u32 v14, v0, 4, 1
    s_mov_b32 s38, 0x2000
    v_mad_u32_u24 v16, v14, s38, v16
    v_bfe_u32 v14, v0, 5, 1
    s_mov_b32 s38, 0x4000
    v_mad_u32_u24 v16, v14, s38, v16
    v_bfe_u32 v14, v0, 6, 1
    s_mov_b32 s38, 0x40000
    v_mad_u32_u24 v16, v14, s38, v16
    v_bfe_u32 v14, v0, 7, 1
    s_mov_b32 s38, 0x80000
    v_mad_u32_u24 v16, v14, s38, v16
    v_mov_b32 v28, 0x0
    v_bfe_u32 v14, v0, 4, 1
    s_mov_b32 s38, 0x20
    v_mad_u32_u24 v28, v14, s38, v28
    v_xor_b32 v16, v16, v28
    v_xor_b32 v17, 64, v16
    v_xor_b32 v18, 128, v16
    v_xor_b32 v19, 192, v16
    v_mov_b32 v20, 0x0
    v_bfe_u32 v14, v0, 0, 1
    s_mov_b32 s38, 0x8
    v_mad_u32_u24 v20, v14, s38, v20
    v_bfe_u32 v14, v0, 1, 1
    s_mov_b32 s38, 0x10
    v_mad_u32_u24 v20, v14, s38, v20
    v_bfe_u32 v14, v0, 2, 1
    s_mov_b32 s38, 0x100
    v_mad_u32_u24 v20, v14, s38, v20
    v_bfe_u32 v14, v0, 3, 1
    s_mov_b32 s38, 0x800
    v_mad_u32_u24 v20, v14, s38, v20
    v_bfe_u32 v14, v0, 4, 1
    s_mov_b32 s38, 0x400
    v_mad_u32_u24 v20, v14, s38, v20
    v_bfe_u32 v14, v0, 5, 1
    s_mov_b32 s38, 0x1000
    v_mad_u32_u24 v20, v14, s38, v20
    v_mov_b32 v28, 0x0
    v_bfe_u32 v14, v0, 2, 1
    s_mov_b32 s38, 0x20
    v_mad_u32_u24 v28, v14, s38, v28
    v_bfe_u32 v14, v0, 3, 1
    s_mov_b32 s38, 0x80
    v_mad_u32_u24 v28, v14, s38, v28
    v_bfe_u32 v14, v0, 4, 1
    s_mov_b32 s38, 0x40
    v_mad_u32_u24 v28, v14, s38, v28
    v_mov_b32 v29, 0x0
    v_bfe_u32 v14, v0, 6, 1
    s_mov_b32 s38, 0x40
    v_mad_u32_u24 v29, v14, s38, v29
    v_bfe_u32 v14, v0, 7, 1
    s_mov_b32 s38, 0x80
    v_mad_u32_u24 v29, v14, s38, v29
    v_xor_b32 v28, v28, v29
    v_add_u32 v28, v28, v20
    s_xor_b32 s36, s21, 0
    s_add_u32 s36, s36, 1
    s_lshl_b32 s36, s36, 15
    v_add_u32 v20, s36, v28
    v_xor_b32 v21, 32, v20
    s_xor_b32 s36, s21, 1
    s_add_u32 s36, s36, 1
    s_lshl_b32 s36, s36, 15
    v_add_u32 v22, s36, v28
    v_xor_b32 v23, 32, v22
    s_xor_b32 s36, s21, 2
    s_add_u32 s36, s36, 1
    s_lshl_b32 s36, s36, 15
    v_add_u32 v24, s36, v28
    v_xor_b32 v25, 32, v24
    s_xor_b32 s36, s21, 3
    s_add_u32 s36, s36, 1
    s_lshl_b32 s36, s36, 15
    v_add_u32 v26, s36, v28
    v_xor_b32 v27, 32, v26
    s_add_u32 s28, s21, 1
    s_lshl_b32 s28, s28, 15
    s_lshl_b32 s3, s20, 8
    s_add_u32 m0, s28, 0
    s_add_u32 s37, s3, 0x0
    buffer_load_dwordx4 v16, s[60:63], s37 offen nt lds
    s_add_u32 m0, s28, 1024
    s_add_u32 s37, s3, 0x8000
    buffer_load_dwordx4 v17, s[60:63], s37 offen nt lds
    s_add_u32 m0, s28, 2048
    s_add_u32 s37, s3, 0x10000
    buffer_load_dwordx4 v18, s[60:63], s37 offen nt lds
    s_add_u32 m0, s28, 3072
    s_add_u32 s37, s3, 0x18000
    buffer_load_dwordx4 v19, s[60:63], s37 offen nt lds
    s_add_u32 m0, s28, 4096
    s_add_u32 s37, s3, 0x20000
    buffer_load_dwordx4 v16, s[60:63], s37 offen nt lds
    s_add_u32 m0, s28, 5120
    s_add_u32 s37, s3, 0x28000
    buffer_load_dwordx4 v17, s[60:63], s37 offen nt lds
    s_add_u32 m0, s28, 6144
    s_add_u32 s37, s3, 0x30000
    buffer_load_dwordx4 v18, s[60:63], s37 offen nt lds
    s_add_u32 m0, s28, 7168
    s_add_u32 s37, s3, 0x38000
    buffer_load_dwordx4 v19, s[60:63], s37 offen nt lds
    s_mov_b32 s12, s46
    s_and_b32 s13, s47, 0xffff
    s_mov_b32 s14, 0x2000
    s_mov_b32 s15, 0x20000
    v_mov_b32 v104, 0x0
    v_bfe_u32 v14, v0, 0, 1
    s_mov_b32 s38, 0x8
    v_mad_u32_u24 v104, v14, s38, v104
    v_bfe_u32 v14, v0, 1, 1
    s_mov_b32 s38, 0x10
    v_mad_u32_u24 v104, v14, s38, v104
    v_bfe_u32 v14, v0, 2, 1
    s_mov_b32 s38, 0x10000
    v_mad_u32_u24 v104, v14, s38, v104
    v_bfe_u32 v14, v0, 3, 1
    s_mov_b32 s38, 0x10000
    v_mad_u32_u24 v104, v14, s38, v104
    v_bfe_u32 v14, v0, 4, 1
    s_mov_b32 s38, 0x400
    v_mad_u32_u24 v104, v14, s38, v104
    v_bfe_u32 v14, v0, 5, 1
    s_mov_b32 s38, 0x4
    v_mad_u32_u24 v104, v14, s38, v104
    v_bfe_u32 v14, v0, 6, 1
    s_mov_b32 s38, 0x40
    v_mad_u32_u24 v104, v14, s38, v104
    v_bfe_u32 v14, v0, 7, 1
    s_mov_b32 s38, 0x80
    v_mad_u32_u24 v104, v14, s38, v104
    v_mov_b32 v106, s20
    v_mov_b32 v105, 0x0
    v_bfe_u32 v14, v106, 0, 1
    s_mov_b32 s38, 0x20
    v_mad_u32_u24 v105, v14, s38, v105
    v_bfe_u32 v14, v106, 1, 1
    s_mov_b32 s38, 0x800
    v_mad_u32_u24 v105, v14, s38, v105
    v_bfe_u32 v14, v106, 2, 1
    s_mov_b32 s38, 0x1000
    v_mad_u32_u24 v105, v14, s38, v105
    v_bfe_u32 v14, v106, 3, 1
    s_mov_b32 s38, 0x100
    v_mad_u32_u24 v105, v14, s38, v105
    v_bfe_u32 v14, v106, 4, 1
    s_mov_b32 s38, 0x200
    v_mad_u32_u24 v105, v14, s38, v105
    v_add_u32 v104, v104, v105
    buffer_load_dword v12, v104, s[12:15], 0 offen
    v_mov_b32 v100, -1
    v_mov_b32 v101, -1
    v_mov_b32 v102, -1
    v_mov_b32 v103, -1
    buffer_store_dwordx4 v[100:103], v2, s[8:11], s6 offen sc1
    buffer_store_dwordx4 v[100:103], v2, s[8:11], s6 offen offset:1024 sc1
    s_lshl_b32 s36, s20, 14
    s_add_u32 s36, s36, 0x100000
    s_add_u32 s37, s36, 0x2000
    buffer_store_dwordx4 v[100:103], v2, s[8:11], s36 offen sc1
    buffer_store_dwordx4 v[100:103], v2, s[8:11], s36 offen offset:1024 sc1
    buffer_store_dwordx4 v[100:103], v2, s[8:11], s37 offen sc1
    buffer_store_dwordx4 v[100:103], v2, s[8:11], s37 offen offset:1024 sc1
    s_mul_i32 s36, s20, 0x104000
    s_add_u32 s36, s36, 0x1102000
    s_add_u32 s37, s36, 0x82000
    buffer_store_dwordx4 v[100:103], v2, s[8:11], s36 offen sc1
    buffer_store_dwordx4 v[100:103], v2, s[8:11], s36 offen offset:1024 sc1
    buffer_store_dwordx4 v[100:103], v2, s[8:11], s37 offen sc1
    buffer_store_dwordx4 v[100:103], v2, s[8:11], s37 offen offset:1024 sc1
    v_lshlrev_b32 v104, 2, v0
    s_lshl_b32 s36, s20, 10
    s_add_u32 s37, s36, 0x194000
    buffer_store_dword v100, v104, s[8:11], s37 offen sc1
    s_add_u32 s37, s36, 0x1b0000
    buffer_store_dword v100, v104, s[8:11], s37 offen sc1
    s_add_u32 s37, s36, 0x1b8000
    buffer_store_dword v100, v104, s[8:11], s37 offen sc1
    v_mov_b32 v105, 0x40000000
    v_cmp_lt_u32 vcc, 63, v0
    s_nop 1
    v_cndmask_b32 v104, v104, v105, vcc
    v_mov_b32 v105, 0
    s_lshl_b32 s36, s20, 8
    s_add_u32 s36, s36, 0x190000
    s_add_u32 s37, s36, 0x2000
    buffer_store_dword v105, v104, s[8:11], s36 offen sc1
    buffer_store_dword v105, v104, s[8:11], s37 offen sc1
    s_add_u32 m0, s28, 8192
    s_add_u32 s37, s3, 0x100000
    buffer_load_dwordx4 v16, s[60:63], s37 offen nt lds
    s_add_u32 m0, s28, 9216
    s_add_u32 s37, s3, 0x108000
    buffer_load_dwordx4 v17, s[60:63], s37 offen nt lds
    s_add_u32 m0, s28, 10240
    s_add_u32 s37, s3, 0x110000
    buffer_load_dwordx4 v18, s[60:63], s37 offen nt lds
    s_add_u32 m0, s28, 11264
    s_add_u32 s37, s3, 0x118000
    buffer_load_dwordx4 v19, s[60:63], s37 offen nt lds
    s_add_u32 m0, s28, 12288
    s_add_u32 s37, s3, 0x120000
    buffer_load_dwordx4 v16, s[60:63], s37 offen nt lds
    s_add_u32 m0, s28, 13312
    s_add_u32 s37, s3, 0x128000
    buffer_load_dwordx4 v17, s[60:63], s37 offen nt lds
    s_add_u32 m0, s28, 14336
    s_add_u32 s37, s3, 0x130000
    buffer_load_dwordx4 v18, s[60:63], s37 offen nt lds
    s_add_u32 m0, s28, 15360
    s_add_u32 s37, s3, 0x138000
    buffer_load_dwordx4 v19, s[60:63], s37 offen nt lds
    s_add_u32 m0, s28, 16384
    s_add_u32 s37, s3, 0x200000
    buffer_load_dwordx4 v16, s[60:63], s37 offen nt lds
    s_add_u32 m0, s28, 17408
    s_add_u32 s37, s3, 0x208000
    buffer_load_dwordx4 v17, s[60:63], s37 offen nt lds
    s_add_u32 m0, s28, 18432
    s_add_u32 s37, s3, 0x210000
    buffer_load_dwordx4 v18, s[60:63], s37 offen nt lds
    s_add_u32 m0, s28, 19456
    s_add_u32 s37, s3, 0x218000
    buffer_load_dwordx4 v19, s[60:63], s37 offen nt lds
    s_add_u32 m0, s28, 20480
    s_add_u32 s37, s3, 0x220000
    buffer_load_dwordx4 v16, s[60:63], s37 offen nt lds
    s_add_u32 m0, s28, 21504
    s_add_u32 s37, s3, 0x228000
    buffer_load_dwordx4 v17, s[60:63], s37 offen nt lds
    s_add_u32 m0, s28, 22528
    s_add_u32 s37, s3, 0x230000
    buffer_load_dwordx4 v18, s[60:63], s37 offen nt lds
    s_add_u32 m0, s28, 23552
    s_add_u32 s37, s3, 0x238000
    buffer_load_dwordx4 v19, s[60:63], s37 offen nt lds
    s_add_u32 s37, s29, 0x0
    buffer_load_dword v32, v11, s[92:95], s37 offen
    s_add_u32 s37, s29, 0x4000
    buffer_load_dword v33, v11, s[92:95], s37 offen
    s_add_u32 s37, s29, 0x1000
    buffer_load_dword v34, v11, s[92:95], s37 offen
    s_add_u32 s37, s29, 0x5000
    buffer_load_dword v35, v11, s[92:95], s37 offen
    s_add_u32 s37, s29, 0x400
    buffer_load_dword v36, v11, s[92:95], s37 offen
    s_add_u32 s37, s29, 0x4400
    buffer_load_dword v37, v11, s[92:95], s37 offen
    s_add_u32 s37, s29, 0x1400
    buffer_load_dword v38, v11, s[92:95], s37 offen
    s_add_u32 s37, s29, 0x5400
    buffer_load_dword v39, v11, s[92:95], s37 offen
    s_add_u32 s37, s29, 0x8000
    buffer_load_dword v40, v11, s[92:95], s37 offen
    s_add_u32 s37, s29, 0xc000
    buffer_load_dword v41, v11, s[92:95], s37 offen
    s_add_u32 s37, s29, 0x9000
    buffer_load_dword v42, v11, s[92:95], s37 offen
    s_add_u32 s37, s29, 0xd000
    buffer_load_dword v43, v11, s[92:95], s37 offen
    s_add_u32 s37, s29, 0x8400
    buffer_load_dword v44, v11, s[92:95], s37 offen
    s_add_u32 s37, s29, 0xc400
    buffer_load_dword v45, v11, s[92:95], s37 offen
    s_add_u32 s37, s29, 0x9400
    buffer_load_dword v46, v11, s[92:95], s37 offen
    s_add_u32 s37, s29, 0xd400
    buffer_load_dword v47, v11, s[92:95], s37 offen
    s_waitcnt vmcnt(48)
    s_barrier
    ds_read_b64_tr_b16 a[160:161], v20 offset:0
    ds_read_b64_tr_b16 a[162:163], v20 offset:512
    ds_read_b64_tr_b16 a[168:169], v21 offset:0
    ds_read_b64_tr_b16 a[170:171], v21 offset:512
    ds_read_b64_tr_b16 a[192:193], v22 offset:0
    ds_read_b64_tr_b16 a[194:195], v22 offset:512
    ds_read_b64_tr_b16 a[200:201], v23 offset:0
    ds_read_b64_tr_b16 a[202:203], v23 offset:512
    ds_read_b64_tr_b16 a[224:225], v24 offset:0
    ds_read_b64_tr_b16 a[226:227], v24 offset:512
    ds_read_b64_tr_b16 a[232:233], v25 offset:0
    ds_read_b64_tr_b16 a[234:235], v25 offset:512
    s_waitcnt lgkmcnt(4)
    ds_read_b64_tr_b16 v[128:129], v26 offset:0
    ds_read_b64_tr_b16 v[130:131], v26 offset:512
    ds_read_b64_tr_b16 v[136:137], v27 offset:0
    ds_read_b64_tr_b16 v[138:139], v27 offset:512
    s_waitcnt lgkmcnt(0)
    s_barrier
    s_add_u32 m0, s28, 0
    s_add_u32 s37, s3, 0x300000
    buffer_load_dwordx4 v16, s[60:63], s37 offen nt lds
    s_add_u32 m0, s28, 1024
    s_add_u32 s37, s3, 0x308000
    buffer_load_dwordx4 v17, s[60:63], s37 offen nt lds
    s_add_u32 m0, s28, 2048
    s_add_u32 s37, s3, 0x310000
    buffer_load_dwordx4 v18, s[60:63], s37 offen nt lds
    s_add_u32 m0, s28, 3072
    s_add_u32 s37, s3, 0x318000
    buffer_load_dwordx4 v19, s[60:63], s37 offen nt lds
    s_add_u32 m0, s28, 4096
    s_add_u32 s37, s3, 0x320000
    buffer_load_dwordx4 v16, s[60:63], s37 offen nt lds
    s_add_u32 m0, s28, 5120
    s_add_u32 s37, s3, 0x328000
    buffer_load_dwordx4 v17, s[60:63], s37 offen nt lds
    s_add_u32 m0, s28, 6144
    s_add_u32 s37, s3, 0x330000
    buffer_load_dwordx4 v18, s[60:63], s37 offen nt lds
    s_add_u32 m0, s28, 7168
    s_add_u32 s37, s3, 0x338000
    buffer_load_dwordx4 v19, s[60:63], s37 offen nt lds
    s_waitcnt vmcnt(40)
    s_mov_b32 s36, 0x1000000
    buffer_store_dword v12, v10, s[8:11], s36 offen sc1
    s_add_u32 s37, s29, 0x10000
    buffer_load_dword v48, v11, s[92:95], s37 offen
    s_add_u32 s37, s29, 0x14000
    buffer_load_dword v49, v11, s[92:95], s37 offen
    s_add_u32 s37, s29, 0x11000
    buffer_load_dword v50, v11, s[92:95], s37 offen
    s_add_u32 s37, s29, 0x15000
    buffer_load_dword v51, v11, s[92:95], s37 offen
    s_add_u32 s37, s29, 0x10400
    buffer_load_dword v52, v11, s[92:95], s37 offen
    s_add_u32 s37, s29, 0x14400
    buffer_load_dword v53, v11, s[92:95], s37 offen
    s_add_u32 s37, s29, 0x11400
    buffer_load_dword v54, v11, s[92:95], s37 offen
    s_add_u32 s37, s29, 0x15400
    buffer_load_dword v55, v11, s[92:95], s37 offen
    s_add_u32 s37, s29, 0x18000
    buffer_load_dword v56, v11, s[92:95], s37 offen
    s_add_u32 s37, s29, 0x1c000
    buffer_load_dword v57, v11, s[92:95], s37 offen
    s_add_u32 s37, s29, 0x19000
    buffer_load_dword v58, v11, s[92:95], s37 offen
    s_add_u32 s37, s29, 0x1d000
    buffer_load_dword v59, v11, s[92:95], s37 offen
    s_add_u32 s37, s29, 0x18400
    buffer_load_dword v60, v11, s[92:95], s37 offen
    s_add_u32 s37, s29, 0x1c400
    buffer_load_dword v61, v11, s[92:95], s37 offen
    s_add_u32 s37, s29, 0x19400
    buffer_load_dword v62, v11, s[92:95], s37 offen
    s_add_u32 s37, s29, 0x1d400
    buffer_load_dword v63, v11, s[92:95], s37 offen
    s_waitcnt vmcnt(49)
    s_barrier
    ds_read_b64_tr_b16 a[164:165], v20 offset:8192
    ds_read_b64_tr_b16 a[166:167], v20 offset:8704
    ds_read_b64_tr_b16 a[172:173], v21 offset:8192
    ds_read_b64_tr_b16 a[174:175], v21 offset:8704
    ds_read_b64_tr_b16 a[196:197], v22 offset:8192
    ds_read_b64_tr_b16 a[198:199], v22 offset:8704
    ds_read_b64_tr_b16 a[204:205], v23 offset:8192
    ds_read_b64_tr_b16 a[206:207], v23 offset:8704
    ds_read_b64_tr_b16 a[228:229], v24 offset:8192
    ds_read_b64_tr_b16 a[230:231], v24 offset:8704
    ds_read_b64_tr_b16 a[236:237], v25 offset:8192
    ds_read_b64_tr_b16 a[238:239], v25 offset:8704
    s_waitcnt lgkmcnt(4)
    ds_read_b64_tr_b16 v[132:133], v26 offset:8192
    ds_read_b64_tr_b16 v[134:135], v26 offset:8704
    ds_read_b64_tr_b16 v[140:141], v27 offset:8192
    ds_read_b64_tr_b16 v[142:143], v27 offset:8704
    s_waitcnt lgkmcnt(0)
    s_barrier
    s_add_u32 m0, s28, 8192
    s_add_u32 s37, s3, 0x0
    buffer_load_dwordx4 v16, s[88:91], s37 offen nt lds
    s_add_u32 m0, s28, 9216
    s_add_u32 s37, s3, 0x8000
    buffer_load_dwordx4 v17, s[88:91], s37 offen nt lds
    s_add_u32 m0, s28, 10240
    s_add_u32 s37, s3, 0x10000
    buffer_load_dwordx4 v18, s[88:91], s37 offen nt lds
    s_add_u32 m0, s28, 11264
    s_add_u32 s37, s3, 0x18000
    buffer_load_dwordx4 v19, s[88:91], s37 offen nt lds
    s_add_u32 m0, s28, 12288
    s_add_u32 s37, s3, 0x20000
    buffer_load_dwordx4 v16, s[88:91], s37 offen nt lds
    s_add_u32 m0, s28, 13312
    s_add_u32 s37, s3, 0x28000
    buffer_load_dwordx4 v17, s[88:91], s37 offen nt lds
    s_add_u32 m0, s28, 14336
    s_add_u32 s37, s3, 0x30000
    buffer_load_dwordx4 v18, s[88:91], s37 offen nt lds
    s_add_u32 m0, s28, 15360
    s_add_u32 s37, s3, 0x38000
    buffer_load_dwordx4 v19, s[88:91], s37 offen nt lds
    s_waitcnt vmcnt(33)
    v_perm_b32 v120, v33, v32, s34
    v_perm_b32 v121, v35, v34, s34
    v_perm_b32 v122, v37, v36, s34
    v_perm_b32 v123, v39, v38, s34
    v_perm_b32 v124, v41, v40, s34
    v_perm_b32 v125, v43, v42, s34
    v_perm_b32 v126, v45, v44, s34
    v_perm_b32 v127, v47, v46, s34
    ds_write_b128 v4, v[120:123] offset:24576
    ds_write_b128 v4, v[124:127] offset:25600
    s_waitcnt lgkmcnt(0)
    v_perm_b32 v120, v33, v32, s35
    v_perm_b32 v121, v35, v34, s35
    v_perm_b32 v122, v37, v36, s35
    v_perm_b32 v123, v39, v38, s35
    v_perm_b32 v124, v41, v40, s35
    v_perm_b32 v125, v43, v42, s35
    v_perm_b32 v126, v45, v44, s35
    v_perm_b32 v127, v47, v46, s35
    ds_write_b128 v4, v[120:123] offset:26624
    ds_write_b128 v4, v[124:127] offset:27648
    s_waitcnt lgkmcnt(0)
    s_add_u32 s37, s29, 0x40
    buffer_load_dword v80, v11, s[92:95], s37 offen
    s_add_u32 s37, s29, 0x4040
    buffer_load_dword v81, v11, s[92:95], s37 offen
    s_add_u32 s37, s29, 0x1040
    buffer_load_dword v82, v11, s[92:95], s37 offen
    s_add_u32 s37, s29, 0x5040
    buffer_load_dword v83, v11, s[92:95], s37 offen
    s_add_u32 s37, s29, 0x440
    buffer_load_dword v84, v11, s[92:95], s37 offen
    s_add_u32 s37, s29, 0x4440
    buffer_load_dword v85, v11, s[92:95], s37 offen
    s_add_u32 s37, s29, 0x1440
    buffer_load_dword v86, v11, s[92:95], s37 offen
    s_add_u32 s37, s29, 0x5440
    buffer_load_dword v87, v11, s[92:95], s37 offen
    s_add_u32 s37, s29, 0x8040
    buffer_load_dword v88, v11, s[92:95], s37 offen
    s_add_u32 s37, s29, 0xc040
    buffer_load_dword v89, v11, s[92:95], s37 offen
    s_add_u32 s37, s29, 0x9040
    buffer_load_dword v90, v11, s[92:95], s37 offen
    s_add_u32 s37, s29, 0xd040
    buffer_load_dword v91, v11, s[92:95], s37 offen
    s_add_u32 s37, s29, 0x8440
    buffer_load_dword v92, v11, s[92:95], s37 offen
    s_add_u32 s37, s29, 0xc440
    buffer_load_dword v93, v11, s[92:95], s37 offen
    s_add_u32 s37, s29, 0x9440
    buffer_load_dword v94, v11, s[92:95], s37 offen
    s_add_u32 s37, s29, 0xd440
    buffer_load_dword v95, v11, s[92:95], s37 offen
    s_barrier
    ds_read_b64_tr_b16 a[176:177], v20 offset:16384
    ds_read_b64_tr_b16 a[178:179], v20 offset:16896
    ds_read_b64_tr_b16 a[184:185], v21 offset:16384
    ds_read_b64_tr_b16 a[186:187], v21 offset:16896
    ds_read_b64_tr_b16 a[208:209], v22 offset:16384
    ds_read_b64_tr_b16 a[210:211], v22 offset:16896
    ds_read_b64_tr_b16 a[216:217], v23 offset:16384
    ds_read_b64_tr_b16 a[218:219], v23 offset:16896
    ds_read_b64_tr_b16 a[240:241], v24 offset:16384
    ds_read_b64_tr_b16 a[242:243], v24 offset:16896
    ds_read_b64_tr_b16 a[248:249], v25 offset:16384
    ds_read_b64_tr_b16 a[250:251], v25 offset:16896
    s_waitcnt lgkmcnt(4)
    ds_read_b64_tr_b16 v[144:145], v26 offset:16384
    ds_read_b64_tr_b16 v[146:147], v26 offset:16896
    ds_read_b64_tr_b16 v[152:153], v27 offset:16384
    ds_read_b64_tr_b16 v[154:155], v27 offset:16896
    s_waitcnt lgkmcnt(0)
    s_barrier
    s_add_u32 m0, s28, 16384
    s_add_u32 s37, s3, 0x100000
    buffer_load_dwordx4 v16, s[88:91], s37 offen nt lds
    s_add_u32 m0, s28, 17408
    s_add_u32 s37, s3, 0x108000
    buffer_load_dwordx4 v17, s[88:91], s37 offen nt lds
    s_add_u32 m0, s28, 18432
    s_add_u32 s37, s3, 0x110000
    buffer_load_dwordx4 v18, s[88:91], s37 offen nt lds
    s_add_u32 m0, s28, 19456
    s_add_u32 s37, s3, 0x118000
    buffer_load_dwordx4 v19, s[88:91], s37 offen nt lds
    s_add_u32 m0, s28, 20480
    s_add_u32 s37, s3, 0x120000
    buffer_load_dwordx4 v16, s[88:91], s37 offen nt lds
    s_add_u32 m0, s28, 21504
    s_add_u32 s37, s3, 0x128000
    buffer_load_dwordx4 v17, s[88:91], s37 offen nt lds
    s_add_u32 m0, s28, 22528
    s_add_u32 s37, s3, 0x130000
    buffer_load_dwordx4 v18, s[88:91], s37 offen nt lds
    s_add_u32 m0, s28, 23552
    s_add_u32 s37, s3, 0x138000
    buffer_load_dwordx4 v19, s[88:91], s37 offen nt lds
    s_waitcnt vmcnt(48)
    s_barrier
    s_getreg_b32 s36, hwreg(HW_REG_XCC_ID)
    s_and_b32 s36, s36, 15
    s_or_b32 s36, s36, 0x100
    v_mov_b32 v30, s36
    s_lshl_b32 s37, s20, 2
    v_lshlrev_b32 v31, 20, v0
    buffer_store_dword v30, v31, s[16:19], s37 offen offset:128 sc1
    s_waitcnt vmcnt(33)
    v_perm_b32 v120, v49, v48, s34
    v_perm_b32 v121, v51, v50, s34
    v_perm_b32 v122, v53, v52, s34
    v_perm_b32 v123, v55, v54, s34
    v_perm_b32 v124, v57, v56, s34
    v_perm_b32 v125, v59, v58, s34
    v_perm_b32 v126, v61, v60, s34
    v_perm_b32 v127, v63, v62, s34
    ds_write_b128 v4, v[120:123] offset:28672
    ds_write_b128 v4, v[124:127] offset:29696
    s_waitcnt lgkmcnt(0)
    v_perm_b32 v120, v49, v48, s35
    v_perm_b32 v121, v51, v50, s35
    v_perm_b32 v122, v53, v52, s35
    v_perm_b32 v123, v55, v54, s35
    v_perm_b32 v124, v57, v56, s35
    v_perm_b32 v125, v59, v58, s35
    v_perm_b32 v126, v61, v60, s35
    v_perm_b32 v127, v63, v62, s35
    ds_write_b128 v4, v[120:123] offset:30720
    ds_write_b128 v4, v[124:127] offset:31744
    s_waitcnt lgkmcnt(0)
    s_add_u32 s37, s29, 0x10040
    buffer_load_dword v32, v11, s[92:95], s37 offen
    s_add_u32 s37, s29, 0x14040
    buffer_load_dword v33, v11, s[92:95], s37 offen
    s_add_u32 s37, s29, 0x11040
    buffer_load_dword v34, v11, s[92:95], s37 offen
    s_add_u32 s37, s29, 0x15040
    buffer_load_dword v35, v11, s[92:95], s37 offen
    s_add_u32 s37, s29, 0x10440
    buffer_load_dword v36, v11, s[92:95], s37 offen
    s_add_u32 s37, s29, 0x14440
    buffer_load_dword v37, v11, s[92:95], s37 offen
    s_add_u32 s37, s29, 0x11440
    buffer_load_dword v38, v11, s[92:95], s37 offen
    s_add_u32 s37, s29, 0x15440
    buffer_load_dword v39, v11, s[92:95], s37 offen
    s_add_u32 s37, s29, 0x18040
    buffer_load_dword v40, v11, s[92:95], s37 offen
    s_add_u32 s37, s29, 0x1c040
    buffer_load_dword v41, v11, s[92:95], s37 offen
    s_add_u32 s37, s29, 0x19040
    buffer_load_dword v42, v11, s[92:95], s37 offen
    s_add_u32 s37, s29, 0x1d040
    buffer_load_dword v43, v11, s[92:95], s37 offen
    s_add_u32 s37, s29, 0x18440
    buffer_load_dword v44, v11, s[92:95], s37 offen
    s_add_u32 s37, s29, 0x1c440
    buffer_load_dword v45, v11, s[92:95], s37 offen
    s_add_u32 s37, s29, 0x19440
    buffer_load_dword v46, v11, s[92:95], s37 offen
    s_add_u32 s37, s29, 0x1d440
    buffer_load_dword v47, v11, s[92:95], s37 offen
    s_barrier
    ds_read_b64_tr_b16 a[180:181], v20 offset:0
    ds_read_b64_tr_b16 a[182:183], v20 offset:512
    ds_read_b64_tr_b16 a[188:189], v21 offset:0
    ds_read_b64_tr_b16 a[190:191], v21 offset:512
    ds_read_b64_tr_b16 a[212:213], v22 offset:0
    ds_read_b64_tr_b16 a[214:215], v22 offset:512
    ds_read_b64_tr_b16 a[220:221], v23 offset:0
    ds_read_b64_tr_b16 a[222:223], v23 offset:512
    ds_read_b64_tr_b16 a[244:245], v24 offset:0
    ds_read_b64_tr_b16 a[246:247], v24 offset:512
    ds_read_b64_tr_b16 a[252:253], v25 offset:0
    ds_read_b64_tr_b16 a[254:255], v25 offset:512
    s_waitcnt lgkmcnt(4)
    ds_read_b64_tr_b16 v[148:149], v26 offset:0
    ds_read_b64_tr_b16 v[150:151], v26 offset:512
    ds_read_b64_tr_b16 v[156:157], v27 offset:0
    ds_read_b64_tr_b16 v[158:159], v27 offset:512
    s_waitcnt lgkmcnt(0)
    s_barrier
    s_add_u32 m0, s28, 0
    s_add_u32 s37, s3, 0x200000
    buffer_load_dwordx4 v16, s[88:91], s37 offen nt lds
    s_add_u32 m0, s28, 1024
    s_add_u32 s37, s3, 0x208000
    buffer_load_dwordx4 v17, s[88:91], s37 offen nt lds
    s_add_u32 m0, s28, 2048
    s_add_u32 s37, s3, 0x210000
    buffer_load_dwordx4 v18, s[88:91], s37 offen nt lds
    s_add_u32 m0, s28, 3072
    s_add_u32 s37, s3, 0x218000
    buffer_load_dwordx4 v19, s[88:91], s37 offen nt lds
    s_add_u32 m0, s28, 4096
    s_add_u32 s37, s3, 0x220000
    buffer_load_dwordx4 v16, s[88:91], s37 offen nt lds
    s_add_u32 m0, s28, 5120
    s_add_u32 s37, s3, 0x228000
    buffer_load_dwordx4 v17, s[88:91], s37 offen nt lds
    s_add_u32 m0, s28, 6144
    s_add_u32 s37, s3, 0x230000
    buffer_load_dwordx4 v18, s[88:91], s37 offen nt lds
    s_add_u32 m0, s28, 7168
    s_add_u32 s37, s3, 0x238000
    buffer_load_dwordx4 v19, s[88:91], s37 offen nt lds
    s_waitcnt vmcnt(33)
    v_perm_b32 v160, v81, v80, s34
    v_perm_b32 v161, v83, v82, s34
    v_perm_b32 v162, v85, v84, s34
    v_perm_b32 v163, v87, v86, s34
    v_perm_b32 v164, v89, v88, s34
    v_perm_b32 v165, v91, v90, s34
    v_perm_b32 v166, v93, v92, s34
    v_perm_b32 v167, v95, v94, s34
    v_perm_b32 v168, v81, v80, s35
    v_perm_b32 v169, v83, v82, s35
    v_perm_b32 v170, v85, v84, s35
    v_perm_b32 v171, v87, v86, s35
    v_perm_b32 v172, v89, v88, s35
    v_perm_b32 v173, v91, v90, s35
    v_perm_b32 v174, v93, v92, s35
    v_perm_b32 v175, v95, v94, s35
    s_add_u32 s37, s29, 0x80
    buffer_load_dword v48, v11, s[92:95], s37 offen
    s_add_u32 s37, s29, 0x4080
    buffer_load_dword v49, v11, s[92:95], s37 offen
    s_add_u32 s37, s29, 0x1080
    buffer_load_dword v50, v11, s[92:95], s37 offen
    s_add_u32 s37, s29, 0x5080
    buffer_load_dword v51, v11, s[92:95], s37 offen
    s_add_u32 s37, s29, 0x480
    buffer_load_dword v52, v11, s[92:95], s37 offen
    s_add_u32 s37, s29, 0x4480
    buffer_load_dword v53, v11, s[92:95], s37 offen
    s_add_u32 s37, s29, 0x1480
    buffer_load_dword v54, v11, s[92:95], s37 offen
    s_add_u32 s37, s29, 0x5480
    buffer_load_dword v55, v11, s[92:95], s37 offen
    s_add_u32 s37, s29, 0x8080
    buffer_load_dword v56, v11, s[92:95], s37 offen
    s_add_u32 s37, s29, 0xc080
    buffer_load_dword v57, v11, s[92:95], s37 offen
    s_add_u32 s37, s29, 0x9080
    buffer_load_dword v58, v11, s[92:95], s37 offen
    s_add_u32 s37, s29, 0xd080
    buffer_load_dword v59, v11, s[92:95], s37 offen
    s_add_u32 s37, s29, 0x8480
    buffer_load_dword v60, v11, s[92:95], s37 offen
    s_add_u32 s37, s29, 0xc480
    buffer_load_dword v61, v11, s[92:95], s37 offen
    s_add_u32 s37, s29, 0x9480
    buffer_load_dword v62, v11, s[92:95], s37 offen
    s_add_u32 s37, s29, 0xd480
    buffer_load_dword v63, v11, s[92:95], s37 offen
    s_barrier
    ds_read_b64_tr_b16 v[64:65], v20 offset:8192
    ds_read_b64_tr_b16 v[66:67], v20 offset:8704
    ds_read_b64_tr_b16 v[72:73], v21 offset:8192
    ds_read_b64_tr_b16 v[74:75], v21 offset:8704
    ds_read_b64_tr_b16 v[96:97], v22 offset:8192
    ds_read_b64_tr_b16 v[98:99], v22 offset:8704
    ds_read_b64_tr_b16 v[104:105], v23 offset:8192
    ds_read_b64_tr_b16 v[106:107], v23 offset:8704
    ds_read_b64_tr_b16 a[112:113], v24 offset:8192
    ds_read_b64_tr_b16 a[114:115], v24 offset:8704
    ds_read_b64_tr_b16 a[120:121], v25 offset:8192
    ds_read_b64_tr_b16 a[122:123], v25 offset:8704
    s_waitcnt lgkmcnt(4)
    ds_read_b64_tr_b16 a[144:145], v26 offset:8192
    ds_read_b64_tr_b16 a[146:147], v26 offset:8704
    ds_read_b64_tr_b16 a[152:153], v27 offset:8192
    ds_read_b64_tr_b16 a[154:155], v27 offset:8704
    s_waitcnt lgkmcnt(0)
    s_barrier
    s_add_u32 m0, s28, 8192
    s_add_u32 s37, s3, 0x300000
    buffer_load_dwordx4 v16, s[88:91], s37 offen nt lds
    s_add_u32 m0, s28, 9216
    s_add_u32 s37, s3, 0x308000
    buffer_load_dwordx4 v17, s[88:91], s37 offen nt lds
    s_add_u32 m0, s28, 10240
    s_add_u32 s37, s3, 0x310000
    buffer_load_dwordx4 v18, s[88:91], s37 offen nt lds
    s_add_u32 m0, s28, 11264
    s_add_u32 s37, s3, 0x318000
    buffer_load_dwordx4 v19, s[88:91], s37 offen nt lds
    s_add_u32 m0, s28, 12288
    s_add_u32 s37, s3, 0x320000
    buffer_load_dwordx4 v16, s[88:91], s37 offen nt lds
    s_add_u32 m0, s28, 13312
    s_add_u32 s37, s3, 0x328000
    buffer_load_dwordx4 v17, s[88:91], s37 offen nt lds
    s_add_u32 m0, s28, 14336
    s_add_u32 s37, s3, 0x330000
    buffer_load_dwordx4 v18, s[88:91], s37 offen nt lds
    s_add_u32 m0, s28, 15360
    s_add_u32 s37, s3, 0x338000
    buffer_load_dwordx4 v19, s[88:91], s37 offen nt lds
    s_waitcnt vmcnt(32)
    v_perm_b32 v208, v33, v32, s34
    v_perm_b32 v209, v35, v34, s34
    v_perm_b32 v210, v37, v36, s34
    v_perm_b32 v211, v39, v38, s34
    v_perm_b32 v212, v41, v40, s34
    v_perm_b32 v213, v43, v42, s34
    v_perm_b32 v214, v45, v44, s34
    v_perm_b32 v215, v47, v46, s34
    v_perm_b32 v216, v33, v32, s35
    v_perm_b32 v217, v35, v34, s35
    v_perm_b32 v218, v37, v36, s35
    v_perm_b32 v219, v39, v38, s35
    v_perm_b32 v220, v41, v40, s35
    v_perm_b32 v221, v43, v42, s35
    v_perm_b32 v222, v45, v44, s35
    v_perm_b32 v223, v47, v46, s35
    s_add_u32 s37, s29, 0x10080
    buffer_load_dword v80, v11, s[92:95], s37 offen
    s_add_u32 s37, s29, 0x14080
    buffer_load_dword v81, v11, s[92:95], s37 offen
    s_add_u32 s37, s29, 0x11080
    buffer_load_dword v82, v11, s[92:95], s37 offen
    s_add_u32 s37, s29, 0x15080
    buffer_load_dword v83, v11, s[92:95], s37 offen
    s_add_u32 s37, s29, 0x10480
    buffer_load_dword v84, v11, s[92:95], s37 offen
    s_add_u32 s37, s29, 0x14480
    buffer_load_dword v85, v11, s[92:95], s37 offen
    s_add_u32 s37, s29, 0x11480
    buffer_load_dword v86, v11, s[92:95], s37 offen
    s_add_u32 s37, s29, 0x15480
    buffer_load_dword v87, v11, s[92:95], s37 offen
    s_add_u32 s37, s29, 0x18080
    buffer_load_dword v88, v11, s[92:95], s37 offen
    s_add_u32 s37, s29, 0x1c080
    buffer_load_dword v89, v11, s[92:95], s37 offen
    s_add_u32 s37, s29, 0x19080
    buffer_load_dword v90, v11, s[92:95], s37 offen
    s_add_u32 s37, s29, 0x1d080
    buffer_load_dword v91, v11, s[92:95], s37 offen
    s_add_u32 s37, s29, 0x18480
    buffer_load_dword v92, v11, s[92:95], s37 offen
    s_add_u32 s37, s29, 0x1c480
    buffer_load_dword v93, v11, s[92:95], s37 offen
    s_add_u32 s37, s29, 0x19480
    buffer_load_dword v94, v11, s[92:95], s37 offen
    s_add_u32 s37, s29, 0x1d480
    buffer_load_dword v95, v11, s[92:95], s37 offen
    s_barrier
    ds_read_b64_tr_b16 v[68:69], v20 offset:16384
    ds_read_b64_tr_b16 v[70:71], v20 offset:16896
    ds_read_b64_tr_b16 v[76:77], v21 offset:16384
    ds_read_b64_tr_b16 v[78:79], v21 offset:16896
    ds_read_b64_tr_b16 v[100:101], v22 offset:16384
    ds_read_b64_tr_b16 v[102:103], v22 offset:16896
    ds_read_b64_tr_b16 v[108:109], v23 offset:16384
    ds_read_b64_tr_b16 v[110:111], v23 offset:16896
    ds_read_b64_tr_b16 a[116:117], v24 offset:16384
    ds_read_b64_tr_b16 a[118:119], v24 offset:16896
    ds_read_b64_tr_b16 a[124:125], v25 offset:16384
    ds_read_b64_tr_b16 a[126:127], v25 offset:16896
    s_waitcnt lgkmcnt(4)
    ds_read_b64_tr_b16 a[148:149], v26 offset:16384
    ds_read_b64_tr_b16 a[150:151], v26 offset:16896
    ds_read_b64_tr_b16 a[156:157], v27 offset:16384
    ds_read_b64_tr_b16 a[158:159], v27 offset:16896
    s_waitcnt lgkmcnt(0)
    s_barrier
    s_add_u32 m0, s28, 16384
    s_add_u32 s37, s3, 0x0
    buffer_load_dwordx4 v16, s[96:99], s37 offen nt lds
    s_add_u32 m0, s28, 17408
    s_add_u32 s37, s3, 0x8000
    buffer_load_dwordx4 v17, s[96:99], s37 offen nt lds
    s_add_u32 m0, s28, 18432
    s_add_u32 s37, s3, 0x10000
    buffer_load_dwordx4 v18, s[96:99], s37 offen nt lds
    s_add_u32 m0, s28, 19456
    s_add_u32 s37, s3, 0x18000
    buffer_load_dwordx4 v19, s[96:99], s37 offen nt lds
    s_add_u32 m0, s28, 20480
    s_add_u32 s37, s3, 0x20000
    buffer_load_dwordx4 v16, s[96:99], s37 offen nt lds
    s_add_u32 m0, s28, 21504
    s_add_u32 s37, s3, 0x28000
    buffer_load_dwordx4 v17, s[96:99], s37 offen nt lds
    s_add_u32 m0, s28, 22528
    s_add_u32 s37, s3, 0x30000
    buffer_load_dwordx4 v18, s[96:99], s37 offen nt lds
    s_add_u32 m0, s28, 23552
    s_add_u32 s37, s3, 0x38000
    buffer_load_dwordx4 v19, s[96:99], s37 offen nt lds
    s_waitcnt vmcnt(32)
    v_perm_b32 v176, v49, v48, s34
    v_perm_b32 v177, v51, v50, s34
    v_perm_b32 v178, v53, v52, s34
    v_perm_b32 v179, v55, v54, s34
    v_perm_b32 v180, v57, v56, s34
    v_perm_b32 v181, v59, v58, s34
    v_perm_b32 v182, v61, v60, s34
    v_perm_b32 v183, v63, v62, s34
    v_perm_b32 v184, v49, v48, s35
    v_perm_b32 v185, v51, v50, s35
    v_perm_b32 v186, v53, v52, s35
    v_perm_b32 v187, v55, v54, s35
    v_perm_b32 v188, v57, v56, s35
    v_perm_b32 v189, v59, v58, s35
    v_perm_b32 v190, v61, v60, s35
    v_perm_b32 v191, v63, v62, s35
    s_add_u32 s37, s29, 0xc0
    buffer_load_dword v32, v11, s[92:95], s37 offen
    s_add_u32 s37, s29, 0x40c0
    buffer_load_dword v33, v11, s[92:95], s37 offen
    s_add_u32 s37, s29, 0x10c0
    buffer_load_dword v34, v11, s[92:95], s37 offen
    s_add_u32 s37, s29, 0x50c0
    buffer_load_dword v35, v11, s[92:95], s37 offen
    s_add_u32 s37, s29, 0x4c0
    buffer_load_dword v36, v11, s[92:95], s37 offen
    s_add_u32 s37, s29, 0x44c0
    buffer_load_dword v37, v11, s[92:95], s37 offen
    s_add_u32 s37, s29, 0x14c0
    buffer_load_dword v38, v11, s[92:95], s37 offen
    s_add_u32 s37, s29, 0x54c0
    buffer_load_dword v39, v11, s[92:95], s37 offen
    s_add_u32 s37, s29, 0x80c0
    buffer_load_dword v40, v11, s[92:95], s37 offen
    s_add_u32 s37, s29, 0xc0c0
    buffer_load_dword v41, v11, s[92:95], s37 offen
    s_add_u32 s37, s29, 0x90c0
    buffer_load_dword v42, v11, s[92:95], s37 offen
    s_add_u32 s37, s29, 0xd0c0
    buffer_load_dword v43, v11, s[92:95], s37 offen
    s_add_u32 s37, s29, 0x84c0
    buffer_load_dword v44, v11, s[92:95], s37 offen
    s_add_u32 s37, s29, 0xc4c0
    buffer_load_dword v45, v11, s[92:95], s37 offen
    s_add_u32 s37, s29, 0x94c0
    buffer_load_dword v46, v11, s[92:95], s37 offen
    s_add_u32 s37, s29, 0xd4c0
    buffer_load_dword v47, v11, s[92:95], s37 offen
    s_barrier
    ds_read_b64_tr_b16 a[80:81], v20 offset:0
    ds_read_b64_tr_b16 a[82:83], v20 offset:512
    ds_read_b64_tr_b16 a[88:89], v21 offset:0
    ds_read_b64_tr_b16 a[90:91], v21 offset:512
    ds_read_b64_tr_b16 a[96:97], v22 offset:0
    ds_read_b64_tr_b16 a[98:99], v22 offset:512
    ds_read_b64_tr_b16 a[104:105], v23 offset:0
    ds_read_b64_tr_b16 a[106:107], v23 offset:512
    ds_read_b64_tr_b16 a[128:129], v24 offset:0
    ds_read_b64_tr_b16 a[130:131], v24 offset:512
    ds_read_b64_tr_b16 a[136:137], v25 offset:0
    ds_read_b64_tr_b16 a[138:139], v25 offset:512
    s_waitcnt lgkmcnt(4)
    ds_read_b64_tr_b16 v[112:113], v26 offset:0
    ds_read_b64_tr_b16 v[114:115], v26 offset:512
    ds_read_b64_tr_b16 v[120:121], v27 offset:0
    ds_read_b64_tr_b16 v[122:123], v27 offset:512
    s_waitcnt lgkmcnt(0)
    s_barrier
    s_add_u32 m0, s28, 0
    s_add_u32 s37, s3, 0x100000
    buffer_load_dwordx4 v16, s[96:99], s37 offen nt lds
    s_add_u32 m0, s28, 1024
    s_add_u32 s37, s3, 0x108000
    buffer_load_dwordx4 v17, s[96:99], s37 offen nt lds
    s_add_u32 m0, s28, 2048
    s_add_u32 s37, s3, 0x110000
    buffer_load_dwordx4 v18, s[96:99], s37 offen nt lds
    s_add_u32 m0, s28, 3072
    s_add_u32 s37, s3, 0x118000
    buffer_load_dwordx4 v19, s[96:99], s37 offen nt lds
    s_add_u32 m0, s28, 4096
    s_add_u32 s37, s3, 0x120000
    buffer_load_dwordx4 v16, s[96:99], s37 offen nt lds
    s_add_u32 m0, s28, 5120
    s_add_u32 s37, s3, 0x128000
    buffer_load_dwordx4 v17, s[96:99], s37 offen nt lds
    s_add_u32 m0, s28, 6144
    s_add_u32 s37, s3, 0x130000
    buffer_load_dwordx4 v18, s[96:99], s37 offen nt lds
    s_add_u32 m0, s28, 7168
    s_add_u32 s37, s3, 0x138000
    buffer_load_dwordx4 v19, s[96:99], s37 offen nt lds
    s_waitcnt vmcnt(32)
    v_perm_b32 v224, v81, v80, s34
    v_perm_b32 v225, v83, v82, s34
    v_perm_b32 v226, v85, v84, s34
    v_perm_b32 v227, v87, v86, s34
    v_perm_b32 v228, v89, v88, s34
    v_perm_b32 v229, v91, v90, s34
    v_perm_b32 v230, v93, v92, s34
    v_perm_b32 v231, v95, v94, s34
    v_perm_b32 v232, v81, v80, s35
    v_perm_b32 v233, v83, v82, s35
    v_perm_b32 v234, v85, v84, s35
    v_perm_b32 v235, v87, v86, s35
    v_perm_b32 v236, v89, v88, s35
    v_perm_b32 v237, v91, v90, s35
    v_perm_b32 v238, v93, v92, s35
    v_perm_b32 v239, v95, v94, s35
    s_add_u32 s37, s29, 0x100c0
    buffer_load_dword v48, v11, s[92:95], s37 offen
    s_add_u32 s37, s29, 0x140c0
    buffer_load_dword v49, v11, s[92:95], s37 offen
    s_add_u32 s37, s29, 0x110c0
    buffer_load_dword v50, v11, s[92:95], s37 offen
    s_add_u32 s37, s29, 0x150c0
    buffer_load_dword v51, v11, s[92:95], s37 offen
    s_add_u32 s37, s29, 0x104c0
    buffer_load_dword v52, v11, s[92:95], s37 offen
    s_add_u32 s37, s29, 0x144c0
    buffer_load_dword v53, v11, s[92:95], s37 offen
    s_add_u32 s37, s29, 0x114c0
    buffer_load_dword v54, v11, s[92:95], s37 offen
    s_add_u32 s37, s29, 0x154c0
    buffer_load_dword v55, v11, s[92:95], s37 offen
    s_add_u32 s37, s29, 0x180c0
    buffer_load_dword v56, v11, s[92:95], s37 offen
    s_add_u32 s37, s29, 0x1c0c0
    buffer_load_dword v57, v11, s[92:95], s37 offen
    s_add_u32 s37, s29, 0x190c0
    buffer_load_dword v58, v11, s[92:95], s37 offen
    s_add_u32 s37, s29, 0x1d0c0
    buffer_load_dword v59, v11, s[92:95], s37 offen
    s_add_u32 s37, s29, 0x184c0
    buffer_load_dword v60, v11, s[92:95], s37 offen
    s_add_u32 s37, s29, 0x1c4c0
    buffer_load_dword v61, v11, s[92:95], s37 offen
    s_add_u32 s37, s29, 0x194c0
    buffer_load_dword v62, v11, s[92:95], s37 offen
    s_add_u32 s37, s29, 0x1d4c0
    buffer_load_dword v63, v11, s[92:95], s37 offen
    s_barrier
    ds_read_b64_tr_b16 a[84:85], v20 offset:8192
    ds_read_b64_tr_b16 a[86:87], v20 offset:8704
    ds_read_b64_tr_b16 a[92:93], v21 offset:8192
    ds_read_b64_tr_b16 a[94:95], v21 offset:8704
    ds_read_b64_tr_b16 a[100:101], v22 offset:8192
    ds_read_b64_tr_b16 a[102:103], v22 offset:8704
    ds_read_b64_tr_b16 a[108:109], v23 offset:8192
    ds_read_b64_tr_b16 a[110:111], v23 offset:8704
    ds_read_b64_tr_b16 a[132:133], v24 offset:8192
    ds_read_b64_tr_b16 a[134:135], v24 offset:8704
    ds_read_b64_tr_b16 a[140:141], v25 offset:8192
    ds_read_b64_tr_b16 a[142:143], v25 offset:8704
    s_waitcnt lgkmcnt(4)
    ds_read_b64_tr_b16 v[116:117], v26 offset:8192
    ds_read_b64_tr_b16 v[118:119], v26 offset:8704
    ds_read_b64_tr_b16 v[124:125], v27 offset:8192
    ds_read_b64_tr_b16 v[126:127], v27 offset:8704
    s_waitcnt lgkmcnt(0)
    s_barrier
    s_add_u32 m0, s28, 8192
    s_add_u32 s37, s3, 0x200000
    buffer_load_dwordx4 v16, s[96:99], s37 offen nt lds
    s_add_u32 m0, s28, 9216
    s_add_u32 s37, s3, 0x208000
    buffer_load_dwordx4 v17, s[96:99], s37 offen nt lds
    s_add_u32 m0, s28, 10240
    s_add_u32 s37, s3, 0x210000
    buffer_load_dwordx4 v18, s[96:99], s37 offen nt lds
    s_add_u32 m0, s28, 11264
    s_add_u32 s37, s3, 0x218000
    buffer_load_dwordx4 v19, s[96:99], s37 offen nt lds
    s_add_u32 m0, s28, 12288
    s_add_u32 s37, s3, 0x220000
    buffer_load_dwordx4 v16, s[96:99], s37 offen nt lds
    s_add_u32 m0, s28, 13312
    s_add_u32 s37, s3, 0x228000
    buffer_load_dwordx4 v17, s[96:99], s37 offen nt lds
    s_add_u32 m0, s28, 14336
    s_add_u32 s37, s3, 0x230000
    buffer_load_dwordx4 v18, s[96:99], s37 offen nt lds
    s_add_u32 m0, s28, 15360
    s_add_u32 s37, s3, 0x238000
    buffer_load_dwordx4 v19, s[96:99], s37 offen nt lds
    s_waitcnt vmcnt(32)
    v_perm_b32 v192, v33, v32, s34
    v_perm_b32 v193, v35, v34, s34
    v_perm_b32 v194, v37, v36, s34
    v_perm_b32 v195, v39, v38, s34
    v_perm_b32 v196, v41, v40, s34
    v_perm_b32 v197, v43, v42, s34
    v_perm_b32 v198, v45, v44, s34
    v_perm_b32 v199, v47, v46, s34
    v_perm_b32 v200, v33, v32, s35
    v_perm_b32 v201, v35, v34, s35
    v_perm_b32 v202, v37, v36, s35
    v_perm_b32 v203, v39, v38, s35
    v_perm_b32 v204, v41, v40, s35
    v_perm_b32 v205, v43, v42, s35
    v_perm_b32 v206, v45, v44, s35
    v_perm_b32 v207, v47, v46, s35
    s_barrier
    ds_read_b64_tr_b16 v[32:33], v20 offset:16384
    ds_read_b64_tr_b16 v[34:35], v20 offset:16896
    ds_read_b64_tr_b16 v[40:41], v21 offset:16384
    ds_read_b64_tr_b16 v[42:43], v21 offset:16896
    ds_read_b64_tr_b16 a[0:1], v22 offset:16384
    ds_read_b64_tr_b16 a[2:3], v22 offset:16896
    ds_read_b64_tr_b16 a[8:9], v23 offset:16384
    ds_read_b64_tr_b16 a[10:11], v23 offset:16896
    ds_read_b64_tr_b16 a[32:33], v24 offset:16384
    ds_read_b64_tr_b16 a[34:35], v24 offset:16896
    ds_read_b64_tr_b16 a[40:41], v25 offset:16384
    ds_read_b64_tr_b16 a[42:43], v25 offset:16896
    s_waitcnt lgkmcnt(4)
    ds_read_b64_tr_b16 a[64:65], v26 offset:16384
    ds_read_b64_tr_b16 a[66:67], v26 offset:16896
    ds_read_b64_tr_b16 a[72:73], v27 offset:16384
    ds_read_b64_tr_b16 a[74:75], v27 offset:16896
    s_waitcnt lgkmcnt(0)
    s_barrier
    s_add_u32 m0, s28, 16384
    s_add_u32 s37, s3, 0x300000
    buffer_load_dwordx4 v16, s[96:99], s37 offen nt lds
    s_add_u32 m0, s28, 17408
    s_add_u32 s37, s3, 0x308000
    buffer_load_dwordx4 v17, s[96:99], s37 offen nt lds
    s_add_u32 m0, s28, 18432
    s_add_u32 s37, s3, 0x310000
    buffer_load_dwordx4 v18, s[96:99], s37 offen nt lds
    s_add_u32 m0, s28, 19456
    s_add_u32 s37, s3, 0x318000
    buffer_load_dwordx4 v19, s[96:99], s37 offen nt lds
    s_add_u32 m0, s28, 20480
    s_add_u32 s37, s3, 0x320000
    buffer_load_dwordx4 v16, s[96:99], s37 offen nt lds
    s_add_u32 m0, s28, 21504
    s_add_u32 s37, s3, 0x328000
    buffer_load_dwordx4 v17, s[96:99], s37 offen nt lds
    s_add_u32 m0, s28, 22528
    s_add_u32 s37, s3, 0x330000
    buffer_load_dwordx4 v18, s[96:99], s37 offen nt lds
    s_add_u32 m0, s28, 23552
    s_add_u32 s37, s3, 0x338000
    buffer_load_dwordx4 v19, s[96:99], s37 offen nt lds
    s_waitcnt vmcnt(16)
    v_perm_b32 v240, v49, v48, s34
    v_perm_b32 v241, v51, v50, s34
    v_perm_b32 v242, v53, v52, s34
    v_perm_b32 v243, v55, v54, s34
    v_perm_b32 v244, v57, v56, s34
    v_perm_b32 v245, v59, v58, s34
    v_perm_b32 v246, v61, v60, s34
    v_perm_b32 v247, v63, v62, s34
    v_perm_b32 v248, v49, v48, s35
    v_perm_b32 v249, v51, v50, s35
    v_perm_b32 v250, v53, v52, s35
    v_perm_b32 v251, v55, v54, s35
    v_perm_b32 v252, v57, v56, s35
    v_perm_b32 v253, v59, v58, s35
    v_perm_b32 v254, v61, v60, s35
    v_perm_b32 v255, v63, v62, s35
    s_barrier
    ds_read_b64_tr_b16 v[36:37], v20 offset:0
    ds_read_b64_tr_b16 v[38:39], v20 offset:512
    ds_read_b64_tr_b16 v[44:45], v21 offset:0
    ds_read_b64_tr_b16 v[46:47], v21 offset:512
    ds_read_b64_tr_b16 a[4:5], v22 offset:0
    ds_read_b64_tr_b16 a[6:7], v22 offset:512
    ds_read_b64_tr_b16 a[12:13], v23 offset:0
    ds_read_b64_tr_b16 a[14:15], v23 offset:512
    ds_read_b64_tr_b16 a[36:37], v24 offset:0
    ds_read_b64_tr_b16 a[38:39], v24 offset:512
    ds_read_b64_tr_b16 a[44:45], v25 offset:0
    ds_read_b64_tr_b16 a[46:47], v25 offset:512
    s_waitcnt lgkmcnt(4)
    ds_read_b64_tr_b16 a[68:69], v26 offset:0
    ds_read_b64_tr_b16 a[70:71], v26 offset:512
    ds_read_b64_tr_b16 a[76:77], v27 offset:0
    ds_read_b64_tr_b16 a[78:79], v27 offset:512
    s_waitcnt lgkmcnt(0)
    s_barrier
    s_waitcnt vmcnt(8)
    s_barrier
    ds_read_b64_tr_b16 v[48:49], v20 offset:8192
    ds_read_b64_tr_b16 v[50:51], v20 offset:8704
    ds_read_b64_tr_b16 v[56:57], v21 offset:8192
    ds_read_b64_tr_b16 v[58:59], v21 offset:8704
    ds_read_b64_tr_b16 a[16:17], v22 offset:8192
    ds_read_b64_tr_b16 a[18:19], v22 offset:8704
    ds_read_b64_tr_b16 a[24:25], v23 offset:8192
    ds_read_b64_tr_b16 a[26:27], v23 offset:8704
    ds_read_b64_tr_b16 a[48:49], v24 offset:8192
    ds_read_b64_tr_b16 a[50:51], v24 offset:8704
    ds_read_b64_tr_b16 a[56:57], v25 offset:8192
    ds_read_b64_tr_b16 a[58:59], v25 offset:8704
    s_waitcnt lgkmcnt(4)
    ds_read_b64_tr_b16 v[80:81], v26 offset:8192
    ds_read_b64_tr_b16 v[82:83], v26 offset:8704
    ds_read_b64_tr_b16 v[88:89], v27 offset:8192
    ds_read_b64_tr_b16 v[90:91], v27 offset:8704
    s_waitcnt lgkmcnt(0)
    s_barrier
    s_waitcnt vmcnt(0)
    s_barrier
    ds_read_b64_tr_b16 v[52:53], v20 offset:16384
    ds_read_b64_tr_b16 v[54:55], v20 offset:16896
    ds_read_b64_tr_b16 v[60:61], v21 offset:16384
    ds_read_b64_tr_b16 v[62:63], v21 offset:16896
    ds_read_b64_tr_b16 a[20:21], v22 offset:16384
    ds_read_b64_tr_b16 a[22:23], v22 offset:16896
    ds_read_b64_tr_b16 a[28:29], v23 offset:16384
    ds_read_b64_tr_b16 a[30:31], v23 offset:16896
    ds_read_b64_tr_b16 a[52:53], v24 offset:16384
    ds_read_b64_tr_b16 a[54:55], v24 offset:16896
    ds_read_b64_tr_b16 a[60:61], v25 offset:16384
    ds_read_b64_tr_b16 a[62:63], v25 offset:16896
    s_waitcnt lgkmcnt(4)
    ds_read_b64_tr_b16 v[84:85], v26 offset:16384
    ds_read_b64_tr_b16 v[86:87], v26 offset:16896
    ds_read_b64_tr_b16 v[92:93], v27 offset:16384
    ds_read_b64_tr_b16 v[94:95], v27 offset:16896
    s_waitcnt lgkmcnt(0)
    s_barrier
    ds_write_b128 v4, v[32:35] offset:0
    ds_write_b128 v4, v[36:39] offset:1024
    ds_write_b128 v4, v[40:43] offset:2048
    ds_write_b128 v4, v[44:47] offset:3072
    ds_write_b128 v4, v[48:51] offset:4096
    ds_write_b128 v4, v[52:55] offset:5120
    ds_write_b128 v4, v[56:59] offset:6144
    ds_write_b128 v4, v[60:63] offset:7168
    s_waitcnt lgkmcnt(0)
    ds_write_b128 v4, v[64:67] offset:8192
    ds_write_b128 v4, v[68:71] offset:9216
    ds_write_b128 v4, v[72:75] offset:10240
    ds_write_b128 v4, v[76:79] offset:11264
    ds_write_b128 v4, v[80:83] offset:12288
    ds_write_b128 v4, v[84:87] offset:13312
    ds_write_b128 v4, v[88:91] offset:14336
    ds_write_b128 v4, v[92:95] offset:15360
    s_waitcnt lgkmcnt(0)
    ds_write_b128 v4, v[96:99] offset:16384
    ds_write_b128 v4, v[100:103] offset:17408
    ds_write_b128 v4, v[104:107] offset:18432
    ds_write_b128 v4, v[108:111] offset:19456
    ds_write_b128 v4, v[112:115] offset:20480
    ds_write_b128 v4, v[116:119] offset:21504
    ds_write_b128 v4, v[120:123] offset:22528
    ds_write_b128 v4, v[124:127] offset:23552
    s_waitcnt lgkmcnt(0)
    s_waitcnt lgkmcnt(0)
    v_mov_b32 v24, 0x0
    v_bfe_u32 v14, v0, 0, 1
    s_mov_b32 s38, 0x80
    v_mad_u32_u24 v24, v14, s38, v24
    v_bfe_u32 v14, v0, 1, 1
    s_mov_b32 s38, 0x100
    v_mad_u32_u24 v24, v14, s38, v24
    v_bfe_u32 v14, v0, 2, 1
    s_mov_b32 s38, 0x200
    v_mad_u32_u24 v24, v14, s38, v24
    v_bfe_u32 v14, v0, 3, 1
    s_mov_b32 s38, 0x400
    v_mad_u32_u24 v24, v14, s38, v24
    v_bfe_u32 v14, v0, 4, 1
    s_mov_b32 s38, 0x800
    v_mad_u32_u24 v24, v14, s38, v24
    v_bfe_u32 v14, v0, 6, 1
    s_mov_b32 s38, 0x1000
    v_mad_u32_u24 v24, v14, s38, v24
    v_bfe_u32 v14, v0, 7, 1
    s_mov_b32 s38, 0x2000
    v_mad_u32_u24 v24, v14, s38, v24
    s_lshl_b32 s36, s20, 14
    v_add_u32 v24, s36, v24
    s_lshl_b32 s36, s20, 8
    s_lshr_b32 s37, s21, 1
    s_lshl_b32 s37, s37, 7
    s_add_u32 s36, s36, s37
    s_add_u32 s36, s36, 0x102000
    v_and_b32 v14, 63, v0
    v_mov_b32 v25, 0x40000000
    v_cmp_lt_u32 vcc, 32, v14
    s_nop 1
    v_cndmask_b32 v24, v24, v25, vcc
    v_mov_b32 v25, s36
    v_cmp_eq_u32 vcc, 32, v14
    s_nop 1
    v_cndmask_b32 v0, v24, v25, vcc
    v_lshrrev_b32 v25, 2, v3
    v_and_b32 v25, 127, v25
L_HS:
    buffer_load_dword v24, v25, s[16:19], 0 offen offset:128 sc1
    s_add_u32 s32, s32, 1
    s_cmp_gt_u32 s32, 200000
    s_cbranch_scc1 L_slow_start
    s_waitcnt vmcnt(0)
    v_cmp_eq_u32 vcc, 0, v24
    s_cbranch_vccnz L_HS
    v_readfirstlane_b32 s36, v24
    s_nop 1
    v_cmp_ne_u32 vcc, s36, v24
    s_cbranch_vccnz L_slow_start
    s_branch L_fast_start
L_fast_start:
    s_mov_b32 s22, 0
    s_mov_b32 s23, 0x1000000
    s_mov_b32 s27, 0
    s_mov_b32 s31, 0x80000
    ds_read_b128 v[104:107], v4 offset:0
    ds_read_b128 v[108:111], v4 offset:1024
    ds_read_b128 v[112:115], v4 offset:2048
    ds_read_b128 v[116:119], v4 offset:3072
    ds_read_b128 v[88:91], v4 offset:4096
    ds_read_b128 v[92:95], v4 offset:5120
    ds_read_b128 v[96:99], v4 offset:6144
    ds_read_b128 v[100:103], v4 offset:7168
    ds_read_b128 v[72:75], v4 offset:8192
    ds_read_b128 v[76:79], v4 offset:9216
    ds_read_b128 v[80:83], v4 offset:10240
    ds_read_b128 v[84:87], v4 offset:11264
    v_mov_b64 v[48:49], 0
    v_mov_b64 v[50:51], 0
    v_mov_b64 v[52:53], 0
    v_mov_b64 v[54:55], 0
    v_mov_b64 v[56:57], 0
    v_mov_b64 v[58:59], 0
    v_mov_b64 v[60:61], 0
    v_mov_b64 v[62:63], 0
    v_mov_b64 v[64:65], 0
    v_mov_b64 v[66:67], 0
    v_mov_b64 v[68:69], 0
    v_mov_b64 v[70:71], 0
    s_waitcnt lgkmcnt(0)
    s_mov_b64 s[62:63], 0
L_fast_step:
    s_bitcmp1_b64 s[62:63], s22
    s_cbranch_scc0 L_fast_refresh
    s_add_u32 s36, s22, 1
    s_bitcmp1_b64 s[62:63], s36
    s_cbranch_scc0 L_fast_refresh
    s_add_u32 s7, s23, 0x80000
    s_add_u32 s24, s23, 0x82000
    s_add_u32 s29, s23, s25
    s_add_u32 s30, s23, s39
    v_xor_b32 v28, 0x800, v2
    v_xor_b32 v36, 0x1000, v2
    v_xor_b32 v44, 0x1800, v2
L_fast_pollm:
    buffer_load_dwordx4 v[16:19], v2, s[8:11], s7 offen sc1
    buffer_load_dwordx4 v[20:23], v2, s[8:11], s7 offen offset:1024 sc1
    s_add_u32 s32, s32, 1
    s_cmp_gt_u32 s32, 200000
    s_waitcnt vmcnt(1)
    v_max3_u32 v14, v16, v17, v18
    s_waitcnt vmcnt(0)
    v_max3_u32 v24, v19, v20, v21
    v_max3_u32 v14, v14, v22, v23
    v_max_u32 v14, v14, v24
    s_cbranch_scc1 L_fast_gotm
    v_cmp_eq_u32 vcc, -1, v14
    s_cbranch_vccnz L_fast_pollm
L_fast_gotm:
    v_smfmac_f32_16x16x64_bf16 v[48:51], v[16:19], v[104:111], v1
    ds_write_b128 v2, v[16:19] offset:0
    v_smfmac_f32_16x16x64_bf16 v[52:55], v[16:19], v[112:119], v1
    ds_write_b128 v2, v[20:23] offset:1024
    v_smfmac_f32_16x16x64_bf16 v[48:51], v[20:23], v[88:95], v1
    buffer_load_dwordx4 v[104:107], v3, s[8:11], s29 offen offset:0 sc1
    v_smfmac_f32_16x16x64_bf16 v[52:55], v[20:23], v[96:103], v1
    v_smfmac_f32_16x16x64_bf16 v[56:59], v[16:19], v[72:79], v1
    buffer_load_dwordx4 v[108:111], v3, s[8:11], s29 offen offset:1024 sc1
    v_smfmac_f32_16x16x64_bf16 v[60:63], v[16:19], v[80:87], v1
    s_waitcnt lgkmcnt(0)
    s_barrier
    ds_read_b128 v[24:27], v28 offset:0
    v_smfmac_f32_16x16x64_bf16 v[56:59], v[20:23], a[80:87], v1
    ds_read_b128 v[28:31], v28 offset:1024
    v_smfmac_f32_16x16x64_bf16 v[60:63], v[20:23], a[88:95], v1
    ds_read_b128 v[32:35], v36 offset:0
    v_smfmac_f32_16x16x64_bf16 v[64:67], v[16:19], a[160:167], v1
    ds_read_b128 v[36:39], v36 offset:1024
    v_smfmac_f32_16x16x64_bf16 v[68:71], v[16:19], a[168:175], v1
    ds_read_b128 v[40:43], v44 offset:0
    s_waitcnt lgkmcnt(4)
    v_smfmac_f32_16x16x64_bf16 v[48:51], v[24:27], a[0:7], v1
    ds_read_b128 v[44:47], v44 offset:1024
    v_smfmac_f32_16x16x64_bf16 v[52:55], v[24:27], a[8:15], v1
    buffer_load_dwordx4 v[112:115], v3, s[8:11], s29 offen offset:2048 sc1
    s_waitcnt lgkmcnt(4)
    v_smfmac_f32_16x16x64_bf16 v[48:51], v[28:31], a[16:23], v1
    ds_read_b128 v[88:91], v4 offset:12288
    v_smfmac_f32_16x16x64_bf16 v[52:55], v[28:31], a[24:31], v1
    buffer_load_dwordx4 v[116:119], v3, s[8:11], s29 offen offset:3072 sc1
    s_waitcnt lgkmcnt(4)
    v_smfmac_f32_16x16x64_bf16 v[48:51], v[32:35], a[32:39], v1
    ds_read_b128 v[92:95], v4 offset:13312
    v_smfmac_f32_16x16x64_bf16 v[52:55], v[32:35], a[40:47], v1
    buffer_load_dwordx4 v[120:123], v3, s[8:11], s30 offen offset:0 sc1
    s_waitcnt lgkmcnt(4)
    v_smfmac_f32_16x16x64_bf16 v[48:51], v[36:39], a[48:55], v1
    ds_read_b128 v[96:99], v4 offset:14336
    v_smfmac_f32_16x16x64_bf16 v[52:55], v[36:39], a[56:63], v1
    ds_read_b128 v[100:103], v4 offset:15360
    s_waitcnt lgkmcnt(5)
    v_smfmac_f32_16x16x64_bf16 v[48:51], v[40:43], a[64:71], v1
    buffer_load_dwordx4 v[124:127], v3, s[8:11], s30 offen offset:1024 sc1
    v_smfmac_f32_16x16x64_bf16 v[52:55], v[40:43], a[72:79], v1
    ds_read_b128 v[72:75], v4 offset:16384
    s_waitcnt lgkmcnt(1)
    v_smfmac_f32_16x16x64_bf16 v[48:51], v[44:47], v[88:95], v1
    ds_read_b128 v[76:79], v4 offset:17408
    v_smfmac_f32_16x16x64_bf16 v[52:55], v[44:47], v[96:103], v1
    buffer_load_dword v15, v0, s[8:11], s24 offen sc1
    v_smfmac_f32_16x16x64_bf16 v[56:59], v[28:31], a[96:103], v1
    ds_read_b128 v[80:83], v4 offset:18432
    v_smfmac_f32_16x16x64_bf16 v[60:63], v[28:31], a[104:111], v1
    ds_read_b128 v[84:87], v4 offset:19456
    v_smfmac_f32_16x16x64_bf16 v[56:59], v[36:39], a[128:135], v1
    ds_read_b128 v[88:91], v4 offset:20480
    v_smfmac_f32_16x16x64_bf16 v[56:59], v[32:35], a[112:119], v1
    ds_read_b128 v[92:95], v4 offset:21504
    v_add_f32 v48, v48, v50
    v_add_f32 v49, v49, v51
    v_smfmac_f32_16x16x64_bf16 v[60:63], v[32:35], a[120:127], v1
    ds_read_b128 v[96:99], v4 offset:22528
    v_add_f32 v52, v52, v54
    v_add_f32 v53, v53, v55
    v_smfmac_f32_16x16x64_bf16 v[60:63], v[36:39], a[136:143], v1
    ds_read_b128 v[100:103], v4 offset:23552
    s_waitcnt lgkmcnt(4)
    v_cvt_pk_bf16_f32 v50, v48, v52
    v_cvt_pk_bf16_f32 v51, v49, v53
    v_smfmac_f32_16x16x64_bf16 v[56:59], v[24:27], v[72:79], v1
    ds_write2_b32 v5, v50, v51 offset0:0 offset1:72
    v_smfmac_f32_16x16x64_bf16 v[60:63], v[24:27], v[80:87], v1
    v_add_u32 v55, 2304, v5
    v_smfmac_f32_16x16x64_bf16 v[56:59], v[40:43], a[144:151], v1
    v_smfmac_f32_16x16x64_bf16 v[60:63], v[40:43], a[152:159], v1
    s_waitcnt lgkmcnt(0)
    s_barrier
    ds_read_b128 v[72:75], v6 offset:0
    v_smfmac_f32_16x16x64_bf16 v[56:59], v[44:47], v[88:95], v1
    ds_read_b128 v[76:79], v6 offset:64
    v_smfmac_f32_16x16x64_bf16 v[60:63], v[44:47], v[96:103], v1
    ds_read_b128 v[80:83], v6 offset:128
    v_smfmac_f32_16x16x64_bf16 v[64:67], v[20:23], a[176:183], v1
    ds_read_b128 v[84:87], v6 offset:192
    v_smfmac_f32_16x16x64_bf16 v[68:71], v[20:23], a[184:191], v1
    s_waitcnt vmcnt(3) lgkmcnt(3)
    v_mfma_f32_16x16x32_bf16 v[48:51], v[104:107], v[72:75], 0
    s_waitcnt lgkmcnt(2)
    v_add_f32 v56, v56, v58
    v_add_f32 v57, v57, v59
    v_mfma_f32_16x16x32_bf16 v[48:51], v[108:111], v[76:79], v[48:51]
    s_waitcnt lgkmcnt(1)
    v_add_f32 v60, v60, v62
    v_add_f32 v61, v61, v63
    v_mfma_f32_16x16x32_bf16 v[48:51], v[112:115], v[80:83], v[48:51]
    s_waitcnt lgkmcnt(0)
    v_cvt_pk_bf16_f32 v58, v56, v60
    v_cvt_pk_bf16_f32 v59, v57, v61
    v_mfma_f32_16x16x32_bf16 v[48:51], v[116:119], v[84:87], v[48:51]
    ds_write2_b32 v55, v58, v59 offset0:0 offset1:72
    v_smfmac_f32_16x16x64_bf16 v[64:67], v[24:27], a[192:199], v1
    buffer_store_dword v12, v10, s[8:11], s31 offen sc1
    v_mov_b64 v[104:105], s[4:5]
    v_smfmac_f32_16x16x64_bf16 v[68:71], v[24:27], a[200:207], v1
    v_mov_b64 v[106:107], s[4:5]
    v_smfmac_f32_16x16x64_bf16 v[64:67], v[28:31], a[208:215], v1
    s_nop 0
    v_exp_f32 v48, v48
    v_smfmac_f32_16x16x64_bf16 v[68:71], v[28:31], a[216:223], v1
    s_waitcnt lgkmcnt(0)
    s_barrier
    ds_read_b128 v[88:91], v7 offset:0
    v_exp_f32 v49, v49
    v_smfmac_f32_16x16x64_bf16 v[64:67], v[32:35], a[224:231], v1
    ds_read_b128 v[92:95], v7 offset:64
    v_exp_f32 v50, v50
    v_smfmac_f32_16x16x64_bf16 v[68:71], v[32:35], a[232:239], v1
    ds_read_b128 v[96:99], v7 offset:128
    v_exp_f32 v51, v51
    v_smfmac_f32_16x16x64_bf16 v[64:67], v[36:39], a[240:247], v1
    ds_read_b128 v[100:103], v7 offset:192
    v_cvt_pk_bf16_f32 v108, v48, v49
    v_cvt_pk_bf16_f32 v109, v50, v51
    v_smfmac_f32_16x16x64_bf16 v[68:71], v[36:39], a[248:255], v1
    ds_write_b64 v2, v[108:109] offset:8192
    s_waitcnt lgkmcnt(4)
    v_mfma_f32_16x16x32_bf16 v[52:55], v[88:91], v[72:75], 0
    s_waitcnt lgkmcnt(3)
    v_mov_b32 v113, 0
    v_mov_b32 v115, 0
    v_mfma_f32_16x16x32_bf16 v[52:55], v[92:95], v[76:79], v[52:55]
    s_waitcnt lgkmcnt(2)
    v_mov_b32 v117, 0
    v_xor_b32 v118, 0x1000, v2
    v_mfma_f32_16x16x32_bf16 v[52:55], v[96:99], v[80:83], v[52:55]
    s_waitcnt lgkmcnt(1)
    v_mov_b64 v[16:17], 0
    v_mov_b64 v[18:19], 0
    v_mfma_f32_16x16x32_bf16 v[52:55], v[100:103], v[84:87], v[52:55]
    v_mov_b64 v[20:21], 0
    v_mov_b64 v[22:23], 0
    v_smfmac_f32_16x16x64_bf16 v[64:67], v[40:43], v[128:135], v1
    s_waitcnt lgkmcnt(0)
    s_barrier
    ds_read_b64 v[110:111], v118 offset:8192
    v_mov_b64 v[24:25], 0
    v_smfmac_f32_16x16x64_bf16 v[68:71], v[40:43], v[136:143], v1
    ds_read_b128 v[88:91], v4 offset:24576
    v_mov_b64 v[26:27], 0
    v_smfmac_f32_16x16x64_bf16 v[64:67], v[44:47], v[144:151], v1
    ds_read_b128 v[92:95], v4 offset:25600
    v_mul_f32 v52, s33, v52
    v_mul_f32 v53, s33, v53
    v_smfmac_f32_16x16x64_bf16 v[68:71], v[44:47], v[152:159], v1
    ds_read_b128 v[96:99], v4 offset:26624
    s_waitcnt vmcnt(2) lgkmcnt(3)
    v_exp_f32 v52, v52
    v_mfma_f32_16x16x32_bf16 v[48:51], v[104:107], v[108:111], 0
    ds_read_b128 v[100:103], v4 offset:27648
    v_exp_f32 v53, v53
    v_mfma_f32_16x16x32_bf16 v[56:59], v[120:123], v[108:111], 0
    ds_read_b128 v[72:75], v4 offset:28672
    v_cvt_pk_bf16_f32 v112, v52, v53
    v_mov_b64 v[28:29], 0
    v_mfma_f32_16x16x32_bf16 v[60:63], v[124:127], v[108:111], 0
    ds_read_b128 v[76:79], v4 offset:29696
    v_add_f32 v64, v64, v66
    v_add_f32 v65, v65, v67
    v_mfma_f32_16x16x16_bf16 v[48:51], v[104:105], v[112:113], v[48:51]
    ds_read_b128 v[80:83], v4 offset:30720
    v_cvt_pk_bf16_f32 v114, v64, v65
    v_add_f32 v68, v68, v70
    v_add_f32 v69, v69, v71
    v_mfma_f32_16x16x16_bf16 v[56:59], v[114:115], v[112:113], v[56:59]
    ds_read_b128 v[84:87], v4 offset:31744
    v_cvt_pk_bf16_f32 v116, v68, v69
    v_mov_b64 v[30:31], 0
    v_mov_b64 v[32:33], 0
    v_mfma_f32_16x16x16_bf16 v[60:63], v[116:117], v[112:113], v[60:63]
    v_rcp_f32 v118, v48
    v_mov_b64 v[34:35], 0
    v_mov_b64 v[36:37], 0
    v_mov_b64 v[38:39], 0
    v_mov_b64 v[40:41], 0
    v_mov_b64 v[42:43], 0
    v_pk_mul_f32 v[56:57], v[56:57], v[118:119] op_sel_hi:[1,0]
    s_nop 0
    v_pk_mul_f32 v[60:61], v[60:61], v[118:119] op_sel_hi:[1,0]
    v_pk_mul_f32 v[58:59], v[58:59], v[118:119] op_sel_hi:[1,0]
    v_pk_mul_f32 v[62:63], v[62:63], v[118:119] op_sel_hi:[1,0]
    v_cvt_pk_bf16_f32 v52, v56, v60
    v_cvt_pk_bf16_f32 v53, v57, v61
    v_cvt_pk_bf16_f32 v54, v58, v62
    v_cvt_pk_bf16_f32 v55, v59, v63
    ds_write_b128 v8, v[52:55]
    v_max_f32 v118, v118, v48
    v_cmp_nge_f32 vcc, s40, v118
    s_cbranch_vccnz L_fast_safe
L_fast_rejoin:
    v_mov_b64 v[44:45], 0
    v_mov_b64 v[46:47], 0
    s_waitcnt lgkmcnt(0)
    s_barrier
    ds_read_b128 v[120:123], v3 offset:20992
    ds_read_b128 v[124:127], v3 offset:22016
    s_waitcnt lgkmcnt(1)
    v_smfmac_f32_16x16x64_bf16 v[16:19], v[120:123], v[88:95], v1
    v_smfmac_f32_16x16x64_bf16 v[20:23], v[120:123], v[96:103], v1
    s_waitcnt lgkmcnt(0)
    v_smfmac_f32_16x16x64_bf16 v[16:19], v[124:127], v[72:79], v1
    v_smfmac_f32_16x16x64_bf16 v[20:23], v[124:127], v[80:87], v1
    v_smfmac_f32_16x16x64_bf16 v[24:27], v[120:123], v[160:167], v1
    v_smfmac_f32_16x16x64_bf16 v[28:31], v[120:123], v[168:175], v1
    s_nop 4
    v_add_f32 v16, v16, v18
    v_add_f32 v17, v17, v19
    v_smfmac_f32_16x16x64_bf16 v[24:27], v[124:127], v[208:215], v1
    v_add_f32 v20, v20, v22
    v_add_f32 v21, v21, v23
    v_smfmac_f32_16x16x64_bf16 v[28:31], v[124:127], v[216:223], v1
    v_cvt_pk_bf16_f32 v48, v16, v20
    v_cvt_pk_bf16_f32 v49, v17, v21
    v_smfmac_f32_16x16x64_bf16 v[32:35], v[120:123], v[176:183], v1
    v_and_or_b32 v48, v48, -2, s27
    v_smfmac_f32_16x16x64_bf16 v[36:39], v[120:123], v[184:191], v1
    buffer_store_dwordx2 v[48:49], v9, s[8:11], 0 offen offset:0
    v_add_f32 v24, v24, v26
    v_add_f32 v25, v25, v27
    v_smfmac_f32_16x16x64_bf16 v[32:35], v[124:127], v[224:231], v1
    v_add_f32 v28, v28, v30
    v_add_f32 v29, v29, v31
    v_smfmac_f32_16x16x64_bf16 v[36:39], v[124:127], v[232:239], v1
    v_cvt_pk_bf16_f32 v50, v24, v28
    v_cvt_pk_bf16_f32 v51, v25, v29
    v_smfmac_f32_16x16x64_bf16 v[40:43], v[120:123], v[192:199], v1
    v_and_or_b32 v50, v50, -2, s27
    v_smfmac_f32_16x16x64_bf16 v[44:47], v[120:123], v[200:207], v1
    buffer_store_dwordx2 v[50:51], v9, s[8:11], 0 offen offset:2048
    v_add_f32 v32, v32, v34
    v_add_f32 v33, v33, v35
    v_smfmac_f32_16x16x64_bf16 v[40:43], v[124:127], v[240:247], v1
    v_add_f32 v36, v36, v38
    v_add_f32 v37, v37, v39
    v_smfmac_f32_16x16x64_bf16 v[44:47], v[124:127], v[248:255], v1
    v_cvt_pk_bf16_f32 v52, v32, v36
    v_cvt_pk_bf16_f32 v53, v33, v37
    v_and_or_b32 v52, v52, -2, s27
    buffer_store_dwordx2 v[52:53], v9, s[8:11], s26 offen offset:0
    s_nop 0
    v_add_f32 v40, v40, v42
    v_add_f32 v41, v41, v43
    s_nop 0
    v_add_f32 v44, v44, v46
    v_add_f32 v45, v45, v47
    v_cvt_pk_bf16_f32 v54, v40, v44
    v_cvt_pk_bf16_f32 v55, v41, v45
    v_and_or_b32 v54, v54, -2, s27
    buffer_store_dwordx2 v[54:55], v9, s[8:11], s26 offen offset:2048
L_fast_stored:
    ds_read_b128 v[24:27], v3 offset:23040
    ds_read_b128 v[104:107], v4 offset:0
    ds_read_b128 v[108:111], v4 offset:1024
    ds_read_b128 v[112:115], v4 offset:2048
    ds_read_b128 v[116:119], v4 offset:3072
    ds_read_b128 v[88:91], v4 offset:4096
    ds_read_b128 v[92:95], v4 offset:5120
    ds_read_b128 v[96:99], v4 offset:6144
    ds_read_b128 v[100:103], v4 offset:7168
    ds_read_b128 v[72:75], v4 offset:8192
    ds_read_b128 v[76:79], v4 offset:9216
    ds_read_b128 v[80:83], v4 offset:10240
    ds_read_b128 v[84:87], v4 offset:11264
    v_mov_b64 v[48:49], 0
    v_mov_b64 v[50:51], 0
    v_mov_b64 v[52:53], 0
    v_mov_b64 v[54:55], 0
    v_mov_b64 v[56:57], 0
    v_mov_b64 v[58:59], 0
    v_mov_b64 v[60:61], 0
    v_mov_b64 v[62:63], 0
    v_mov_b64 v[64:65], 0
    v_mov_b64 v[66:67], 0
    v_mov_b64 v[68:69], 0
    v_mov_b64 v[70:71], 0
    s_cmp_lt_u32 s21, 1
    s_cbranch_scc1 L_fast_poll0
    s_nop 7
    s_cmp_lt_u32 s21, 2
    s_cbranch_scc1 L_fast_poll0
    s_nop 7
    s_cmp_lt_u32 s21, 3
    s_cbranch_scc1 L_fast_poll0
    s_nop 7
L_fast_poll0:
    buffer_load_dwordx4 v[120:123], v2, s[8:11], s6 offen sc1
    buffer_load_dwordx4 v[124:127], v2, s[8:11], s6 offen offset:1024 sc1
    s_waitcnt lgkmcnt(0)
L_fast_pollp:
    s_waitcnt vmcnt(1)
    v_mfma_f32_16x16x32_bf16 v[36:39], v[24:27], v[120:123], 0
    v_bitop3_b32 v14, v120, v122, s27 bitop3:0x7e
    s_waitcnt vmcnt(0)
    v_mfma_f32_16x16x32_bf16 v[36:39], v[24:27], v[124:127], v[36:39]
    v_bitop3_b32 v11, v124, v126, s27 bitop3:0x7e
    v_bitop3_b32 v14, v14, v11, 1 bitop3:0xa8
    v_cmp_ne_u32 vcc, 0, v14
    s_add_u32 s32, s32, 1
    s_cbranch_vccz L_fast_gotp
    buffer_load_dwordx4 v[16:19], v2, s[8:11], s6 offen sc1
    buffer_load_dwordx4 v[20:23], v2, s[8:11], s6 offen offset:1024 sc1
    s_waitcnt vmcnt(1)
    v_mfma_f32_16x16x32_bf16 v[36:39], v[24:27], v[16:19], 0
    v_bitop3_b32 v14, v16, v18, s27 bitop3:0x7e
    s_waitcnt vmcnt(0)
    v_mfma_f32_16x16x32_bf16 v[36:39], v[24:27], v[20:23], v[36:39]
    v_bitop3_b32 v11, v20, v22, s27 bitop3:0x7e
    v_bitop3_b32 v14, v14, v11, 1 bitop3:0xa8
    v_cmp_ne_u32 vcc, 0, v14
    s_add_u32 s32, s32, 1
    s_cbranch_vccz L_fast_gotp
    buffer_load_dwordx4 v[120:123], v2, s[8:11], s6 offen sc1
    buffer_load_dwordx4 v[124:127], v2, s[8:11], s6 offen offset:1024 sc1
    s_cmp_le_u32 s32, 200000
    s_cbranch_scc1 L_fast_pollp
L_fast_gotp:
    s_mov_b32 s23, s24
    s_add_u32 s31, s31, 0x2000
    s_add_u32 s22, s22, 1
    s_xor_b32 s27, s27, 1
    v_add_f32_dpp v36, v36, v36 row_ror:8 row_mask:0xf bank_mask:0xf
    v_add_f32_dpp v37, v37, v37 row_ror:8 row_mask:0xf bank_mask:0xf
    s_nop 0
    v_add_f32_dpp v36, v36, v36 row_ror:4 row_mask:0xf bank_mask:0xf
    v_add_f32_dpp v37, v37, v37 row_ror:4 row_mask:0xf bank_mask:0xf
    v_cvt_pk_bf16_f32 v12, v36, v37
    buffer_store_dword v12, v10, s[8:11], s23 offen
    s_nop 15
    s_nop 15
    s_nop 15
    s_cmp_lt_u32 s22, 63
    s_cbranch_scc1 L_fast_step
    buffer_store_dword v12, v10, s[8:11], s31 offen sc1
    s_branch L_fast_done
L_fast_refresh:
    v_lshrrev_b32 v14, 2, v3
    s_lshl_b32 s36, s20, 8
    s_add_u32 s36, s36, 0x190000
    buffer_load_dword v14, v14, s[8:11], s36 offen sc1
    s_add_u32 s32, s32, 1
    s_waitcnt vmcnt(0)
    v_cmp_ne_u32 s[62:63], 0, v14
    s_nop 3
    s_bitset1_b64 s[62:63], 63
    s_cmp_le_u32 s32, 200000
    s_cbranch_scc1 L_fast_step
    s_mov_b64 s[62:63], -1
    s_branch L_fast_step
L_fast_safe:
    s_nop 11
    s_waitcnt vmcnt(0) lgkmcnt(0)
    ds_read_b128 v[72:75], v6 offset:0
    ds_read_b128 v[88:91], v7 offset:0
    ds_read_b128 v[76:79], v6 offset:64
    ds_read_b128 v[92:95], v7 offset:64
    ds_read_b128 v[80:83], v6 offset:128
    ds_read_b128 v[96:99], v7 offset:128
    ds_read_b128 v[84:87], v6 offset:192
    ds_read_b128 v[100:103], v7 offset:192
    s_xor_b32 s36, s25, 0x1000
    s_add_u32 s36, s36, s23
    buffer_load_dwordx4 v[16:19], v3, s[8:11], s29 offen offset:0 sc1
    buffer_load_dwordx4 v[32:35], v3, s[8:11], s36 offen offset:0 sc1
    buffer_load_dwordx4 v[20:23], v3, s[8:11], s29 offen offset:1024 sc1
    buffer_load_dwordx4 v[36:39], v3, s[8:11], s36 offen offset:1024 sc1
    buffer_load_dwordx4 v[24:27], v3, s[8:11], s29 offen offset:2048 sc1
    buffer_load_dwordx4 v[40:43], v3, s[8:11], s36 offen offset:2048 sc1
    buffer_load_dwordx4 v[28:31], v3, s[8:11], s29 offen offset:3072 sc1
    buffer_load_dwordx4 v[44:47], v3, s[8:11], s36 offen offset:3072 sc1
    s_waitcnt vmcnt(0) lgkmcnt(0)
    v_mfma_f32_16x16x32_bf16 v[48:51], v[16:19], v[72:75], 0
    v_mfma_f32_16x16x32_bf16 v[48:51], v[20:23], v[76:79], v[48:51]
    v_mfma_f32_16x16x32_bf16 v[48:51], v[24:27], v[80:83], v[48:51]
    v_mfma_f32_16x16x32_bf16 v[48:51], v[28:31], v[84:87], v[48:51]
    v_mfma_f32_16x16x32_bf16 v[52:55], v[32:35], v[72:75], 0
    v_mfma_f32_16x16x32_bf16 v[52:55], v[36:39], v[76:79], v[52:55]
    v_mfma_f32_16x16x32_bf16 v[52:55], v[40:43], v[80:83], v[52:55]
    v_mfma_f32_16x16x32_bf16 v[52:55], v[44:47], v[84:87], v[52:55]
    v_mfma_f32_16x16x32_bf16 v[56:59], v[88:91], v[72:75], 0
    v_mfma_f32_16x16x32_bf16 v[56:59], v[92:95], v[76:79], v[56:59]
    v_mfma_f32_16x16x32_bf16 v[56:59], v[96:99], v[80:83], v[56:59]
    v_mfma_f32_16x16x32_bf16 v[56:59], v[100:103], v[84:87], v[56:59]
    s_nop 7
    v_mul_f32 v56, s33, v56
    v_mul_f32 v57, s33, v57
    v_max3_f32 v16, v48, v49, v50
    v_max3_f32 v16, v16, v51, v52
    v_max3_f32 v16, v16, v53, v54
    v_max3_f32 v16, v16, v55, v56
    v_max_f32 v16, v16, v57
    v_mov_b32 v17, v16
    s_nop 1
    v_permlane16_swap_b32 v16, v17
    v_max_f32 v16, v16, v17
    v_mov_b32 v17, v16
    s_nop 1
    v_permlane32_swap_b32 v16, v17
    v_max_f32 v16, v16, v17
    v_sub_f32 v48, v48, v16
    v_exp_f32 v48, v48
    v_sub_f32 v49, v49, v16
    v_exp_f32 v49, v49
    v_sub_f32 v50, v50, v16
    v_exp_f32 v50, v50
    v_sub_f32 v51, v51, v16
    v_exp_f32 v51, v51
    v_sub_f32 v52, v52, v16
    v_exp_f32 v52, v52
    v_sub_f32 v53, v53, v16
    v_exp_f32 v53, v53
    v_sub_f32 v54, v54, v16
    v_exp_f32 v54, v54
    v_sub_f32 v55, v55, v16
    v_exp_f32 v55, v55
    v_sub_f32 v56, v56, v16
    v_exp_f32 v56, v56
    v_sub_f32 v57, v57, v16
    v_exp_f32 v57, v57
    v_cvt_pk_bf16_f32 v108, v48, v49
    v_cvt_pk_bf16_f32 v109, v50, v51
    v_cvt_pk_bf16_f32 v110, v52, v53
    v_cvt_pk_bf16_f32 v111, v54, v55
    v_cvt_pk_bf16_f32 v112, v56, v57
    s_nop 0
    v_mfma_f32_16x16x32_bf16 v[48:51], v[104:107], v[108:111], 0
    v_mfma_f32_16x16x32_bf16 v[56:59], v[120:123], v[108:111], 0
    v_mfma_f32_16x16x32_bf16 v[60:63], v[124:127], v[108:111], 0
    s_nop 3
    v_mfma_f32_16x16x16_bf16 v[48:51], v[104:105], v[112:113], v[48:51]
    v_mfma_f32_16x16x16_bf16 v[56:59], v[114:115], v[112:113], v[56:59]
    v_mfma_f32_16x16x16_bf16 v[60:63], v[116:117], v[112:113], v[60:63]
    s_nop 5
    v_rcp_f32 v118, v48
    s_nop 0
    v_mul_f32 v56, v56, v118
    v_mul_f32 v57, v57, v118
    v_mul_f32 v58, v58, v118
    v_mul_f32 v59, v59, v118
    v_mul_f32 v60, v60, v118
    v_mul_f32 v61, v61, v118
    v_mul_f32 v62, v62, v118
    v_mul_f32 v63, v63, v118
    v_cvt_pk_bf16_f32 v52, v56, v60
    v_cvt_pk_bf16_f32 v53, v57, v61
    v_cvt_pk_bf16_f32 v54, v58, v62
    v_cvt_pk_bf16_f32 v55, v59, v63
    ds_write_b128 v8, v[52:55]
    ds_read_b128 v[88:91], v4 offset:24576
    ds_read_b128 v[92:95], v4 offset:25600
    ds_read_b128 v[96:99], v4 offset:26624
    ds_read_b128 v[100:103], v4 offset:27648
    ds_read_b128 v[72:75], v4 offset:28672
    ds_read_b128 v[76:79], v4 offset:29696
    ds_read_b128 v[80:83], v4 offset:30720
    ds_read_b128 v[84:87], v4 offset:31744
    v_mov_b32 v16, 0
    v_mov_b32 v17, 0
    v_mov_b32 v18, 0
    v_mov_b32 v19, 0
    v_mov_b32 v20, 0
    v_mov_b32 v21, 0
    v_mov_b32 v22, 0
    v_mov_b32 v23, 0
    v_mov_b32 v24, 0
    v_mov_b32 v25, 0
    v_mov_b32 v26, 0
    v_mov_b32 v27, 0
    v_mov_b32 v28, 0
    v_mov_b32 v29, 0
    v_mov_b32 v30, 0
    v_mov_b32 v31, 0
    v_mov_b32 v32, 0
    v_mov_b32 v33, 0
    v_mov_b32 v34, 0
    v_mov_b32 v35, 0
    v_mov_b32 v36, 0
    v_mov_b32 v37, 0
    v_mov_b32 v38, 0
    v_mov_b32 v39, 0
    v_mov_b32 v40, 0
    v_mov_b32 v41, 0
    v_mov_b32 v42, 0
    v_mov_b32 v43, 0
    v_mov_b32 v44, 0
    v_mov_b32 v45, 0
    v_mov_b32 v46, 0
    v_mov_b32 v47, 0
    s_branch L_fast_rejoin
L_fast_done:
    s_branch L_end
L_slow_start:
    s_mov_b32 s22, 0
    s_mov_b32 s23, 0x1000000
    s_mov_b32 s27, 0
    s_mov_b32 s31, 0x80000
    ds_read_b128 v[104:107], v4 offset:0
    ds_read_b128 v[108:111], v4 offset:1024
    ds_read_b128 v[112:115], v4 offset:2048
    ds_read_b128 v[116:119], v4 offset:3072
    ds_read_b128 v[88:91], v4 offset:4096
    ds_read_b128 v[92:95], v4 offset:5120
    ds_read_b128 v[96:99], v4 offset:6144
    ds_read_b128 v[100:103], v4 offset:7168
    ds_read_b128 v[72:75], v4 offset:8192
    ds_read_b128 v[76:79], v4 offset:9216
    ds_read_b128 v[80:83], v4 offset:10240
    ds_read_b128 v[84:87], v4 offset:11264
    v_mov_b64 v[48:49], 0
    v_mov_b64 v[50:51], 0
    v_mov_b64 v[52:53], 0
    v_mov_b64 v[54:55], 0
    v_mov_b64 v[56:57], 0
    v_mov_b64 v[58:59], 0
    v_mov_b64 v[60:61], 0
    v_mov_b64 v[62:63], 0
    v_mov_b64 v[64:65], 0
    v_mov_b64 v[66:67], 0
    v_mov_b64 v[68:69], 0
    v_mov_b64 v[70:71], 0
    s_waitcnt lgkmcnt(0)
    s_mov_b64 s[62:63], 0
L_slow_step:
    s_bitcmp1_b64 s[62:63], s22
    s_cbranch_scc0 L_slow_refresh
    s_add_u32 s36, s22, 1
    s_bitcmp1_b64 s[62:63], s36
    s_cbranch_scc0 L_slow_refresh
    s_add_u32 s7, s23, 0x80000
    s_add_u32 s24, s23, 0x82000
    s_add_u32 s29, s23, s25
    s_add_u32 s30, s23, s39
    v_xor_b32 v28, 0x800, v2
    v_xor_b32 v36, 0x1000, v2
    v_xor_b32 v44, 0x1800, v2
L_slow_pollm:
    buffer_load_dwordx4 v[16:19], v2, s[8:11], s7 offen sc1
    buffer_load_dwordx4 v[20:23], v2, s[8:11], s7 offen offset:1024 sc1
    s_add_u32 s32, s32, 1
    s_cmp_gt_u32 s32, 200000
    s_waitcnt vmcnt(1)
    v_max3_u32 v14, v16, v17, v18
    s_waitcnt vmcnt(0)
    v_max3_u32 v24, v19, v20, v21
    v_max3_u32 v14, v14, v22, v23
    v_max_u32 v14, v14, v24
    s_cbranch_scc1 L_slow_gotm
    v_cmp_eq_u32 vcc, -1, v14
    s_cbranch_vccnz L_slow_pollm
L_slow_gotm:
    v_smfmac_f32_16x16x64_bf16 v[48:51], v[16:19], v[104:111], v1
    ds_write_b128 v2, v[16:19] offset:0
    v_smfmac_f32_16x16x64_bf16 v[52:55], v[16:19], v[112:119], v1
    ds_write_b128 v2, v[20:23] offset:1024
    v_smfmac_f32_16x16x64_bf16 v[48:51], v[20:23], v[88:95], v1
    buffer_load_dwordx4 v[104:107], v3, s[8:11], s29 offen offset:0 sc1
    v_smfmac_f32_16x16x64_bf16 v[52:55], v[20:23], v[96:103], v1
    v_smfmac_f32_16x16x64_bf16 v[56:59], v[16:19], v[72:79], v1
    buffer_load_dwordx4 v[108:111], v3, s[8:11], s29 offen offset:1024 sc1
    v_smfmac_f32_16x16x64_bf16 v[60:63], v[16:19], v[80:87], v1
    s_waitcnt lgkmcnt(0)
    s_barrier
    ds_read_b128 v[24:27], v28 offset:0
    v_smfmac_f32_16x16x64_bf16 v[56:59], v[20:23], a[80:87], v1
    ds_read_b128 v[28:31], v28 offset:1024
    v_smfmac_f32_16x16x64_bf16 v[60:63], v[20:23], a[88:95], v1
    ds_read_b128 v[32:35], v36 offset:0
    v_smfmac_f32_16x16x64_bf16 v[64:67], v[16:19], a[160:167], v1
    ds_read_b128 v[36:39], v36 offset:1024
    v_smfmac_f32_16x16x64_bf16 v[68:71], v[16:19], a[168:175], v1
    ds_read_b128 v[40:43], v44 offset:0
    s_waitcnt lgkmcnt(4)
    v_smfmac_f32_16x16x64_bf16 v[48:51], v[24:27], a[0:7], v1
    ds_read_b128 v[44:47], v44 offset:1024
    v_smfmac_f32_16x16x64_bf16 v[52:55], v[24:27], a[8:15], v1
    buffer_load_dwordx4 v[112:115], v3, s[8:11], s29 offen offset:2048 sc1
    s_waitcnt lgkmcnt(4)
    v_smfmac_f32_16x16x64_bf16 v[48:51], v[28:31], a[16:23], v1
    ds_read_b128 v[88:91], v4 offset:12288
    v_smfmac_f32_16x16x64_bf16 v[52:55], v[28:31], a[24:31], v1
    buffer_load_dwordx4 v[116:119], v3, s[8:11], s29 offen offset:3072 sc1
    s_waitcnt lgkmcnt(4)
    v_smfmac_f32_16x16x64_bf16 v[48:51], v[32:35], a[32:39], v1
    ds_read_b128 v[92:95], v4 offset:13312
    v_smfmac_f32_16x16x64_bf16 v[52:55], v[32:35], a[40:47], v1
    buffer_load_dwordx4 v[120:123], v3, s[8:11], s30 offen offset:0 sc1
    s_waitcnt lgkmcnt(4)
    v_smfmac_f32_16x16x64_bf16 v[48:51], v[36:39], a[48:55], v1
    ds_read_b128 v[96:99], v4 offset:14336
    v_smfmac_f32_16x16x64_bf16 v[52:55], v[36:39], a[56:63], v1
    ds_read_b128 v[100:103], v4 offset:15360
    s_waitcnt lgkmcnt(5)
    v_smfmac_f32_16x16x64_bf16 v[48:51], v[40:43], a[64:71], v1
    buffer_load_dwordx4 v[124:127], v3, s[8:11], s30 offen offset:1024 sc1
    v_smfmac_f32_16x16x64_bf16 v[52:55], v[40:43], a[72:79], v1
    ds_read_b128 v[72:75], v4 offset:16384
    s_waitcnt lgkmcnt(1)
    v_smfmac_f32_16x16x64_bf16 v[48:51], v[44:47], v[88:95], v1
    ds_read_b128 v[76:79], v4 offset:17408
    v_smfmac_f32_16x16x64_bf16 v[52:55], v[44:47], v[96:103], v1
    buffer_load_dword v15, v0, s[8:11], s24 offen sc1
    v_smfmac_f32_16x16x64_bf16 v[56:59], v[28:31], a[96:103], v1
    ds_read_b128 v[80:83], v4 offset:18432
    v_smfmac_f32_16x16x64_bf16 v[60:63], v[28:31], a[104:111], v1
    ds_read_b128 v[84:87], v4 offset:19456
    v_smfmac_f32_16x16x64_bf16 v[56:59], v[36:39], a[128:135], v1
    ds_read_b128 v[88:91], v4 offset:20480
    v_smfmac_f32_16x16x64_bf16 v[56:59], v[32:35], a[112:119], v1
    ds_read_b128 v[92:95], v4 offset:21504
    v_add_f32 v48, v48, v50
    v_add_f32 v49, v49, v51
    v_smfmac_f32_16x16x64_bf16 v[60:63], v[32:35], a[120:127], v1
    ds_read_b128 v[96:99], v4 offset:22528
    v_add_f32 v52, v52, v54
    v_add_f32 v53, v53, v55
    v_smfmac_f32_16x16x64_bf16 v[60:63], v[36:39], a[136:143], v1
    ds_read_b128 v[100:103], v4 offset:23552
    s_waitcnt lgkmcnt(4)
    v_cvt_pk_bf16_f32 v50, v48, v52
    v_cvt_pk_bf16_f32 v51, v49, v53
    v_smfmac_f32_16x16x64_bf16 v[56:59], v[24:27], v[72:79], v1
    ds_write2_b32 v5, v50, v51 offset0:0 offset1:72
    v_smfmac_f32_16x16x64_bf16 v[60:63], v[24:27], v[80:87], v1
    v_add_u32 v55, 2304, v5
    v_smfmac_f32_16x16x64_bf16 v[56:59], v[40:43], a[144:151], v1
    v_smfmac_f32_16x16x64_bf16 v[60:63], v[40:43], a[152:159], v1
    s_waitcnt lgkmcnt(0)
    s_barrier
    ds_read_b128 v[72:75], v6 offset:0
    v_smfmac_f32_16x16x64_bf16 v[56:59], v[44:47], v[88:95], v1
    ds_read_b128 v[76:79], v6 offset:64
    v_smfmac_f32_16x16x64_bf16 v[60:63], v[44:47], v[96:103], v1
    ds_read_b128 v[80:83], v6 offset:128
    v_smfmac_f32_16x16x64_bf16 v[64:67], v[20:23], a[176:183], v1
    ds_read_b128 v[84:87], v6 offset:192
    v_smfmac_f32_16x16x64_bf16 v[68:71], v[20:23], a[184:191], v1
    s_waitcnt vmcnt(3) lgkmcnt(3)
    v_mfma_f32_16x16x32_bf16 v[48:51], v[104:107], v[72:75], 0
    s_waitcnt lgkmcnt(2)
    v_add_f32 v56, v56, v58
    v_add_f32 v57, v57, v59
    v_mfma_f32_16x16x32_bf16 v[48:51], v[108:111], v[76:79], v[48:51]
    s_waitcnt lgkmcnt(1)
    v_add_f32 v60, v60, v62
    v_add_f32 v61, v61, v63
    v_mfma_f32_16x16x32_bf16 v[48:51], v[112:115], v[80:83], v[48:51]
    s_waitcnt lgkmcnt(0)
    v_cvt_pk_bf16_f32 v58, v56, v60
    v_cvt_pk_bf16_f32 v59, v57, v61
    v_mfma_f32_16x16x32_bf16 v[48:51], v[116:119], v[84:87], v[48:51]
    ds_write2_b32 v55, v58, v59 offset0:0 offset1:72
    v_smfmac_f32_16x16x64_bf16 v[64:67], v[24:27], a[192:199], v1
    buffer_store_dword v12, v10, s[8:11], s31 offen sc1
    v_mov_b64 v[104:105], s[4:5]
    v_smfmac_f32_16x16x64_bf16 v[68:71], v[24:27], a[200:207], v1
    v_mov_b64 v[106:107], s[4:5]
    v_smfmac_f32_16x16x64_bf16 v[64:67], v[28:31], a[208:215], v1
    s_nop 0
    v_exp_f32 v48, v48
    v_smfmac_f32_16x16x64_bf16 v[68:71], v[28:31], a[216:223], v1
    s_waitcnt lgkmcnt(0)
    s_barrier
    ds_read_b128 v[88:91], v7 offset:0
    v_exp_f32 v49, v49
    v_smfmac_f32_16x16x64_bf16 v[64:67], v[32:35], a[224:231], v1
    ds_read_b128 v[92:95], v7 offset:64
    v_exp_f32 v50, v50
    v_smfmac_f32_16x16x64_bf16 v[68:71], v[32:35], a[232:239], v1
    ds_read_b128 v[96:99], v7 offset:128
    v_exp_f32 v51, v51
    v_smfmac_f32_16x16x64_bf16 v[64:67], v[36:39], a[240:247], v1
    ds_read_b128 v[100:103], v7 offset:192
    v_cvt_pk_bf16_f32 v108, v48, v49
    v_cvt_pk_bf16_f32 v109, v50, v51
    v_smfmac_f32_16x16x64_bf16 v[68:71], v[36:39], a[248:255], v1
    ds_write_b64 v2, v[108:109] offset:8192
    s_waitcnt lgkmcnt(4)
    v_mfma_f32_16x16x32_bf16 v[52:55], v[88:91], v[72:75], 0
    s_waitcnt lgkmcnt(3)
    v_mov_b32 v113, 0
    v_mov_b32 v115, 0
    v_mfma_f32_16x16x32_bf16 v[52:55], v[92:95], v[76:79], v[52:55]
    s_waitcnt lgkmcnt(2)
    v_mov_b32 v117, 0
    v_xor_b32 v118, 0x1000, v2
    v_mfma_f32_16x16x32_bf16 v[52:55], v[96:99], v[80:83], v[52:55]
    s_waitcnt lgkmcnt(1)
    v_mov_b64 v[16:17], 0
    v_mov_b64 v[18:19], 0
    v_mfma_f32_16x16x32_bf16 v[52:55], v[100:103], v[84:87], v[52:55]
    v_mov_b64 v[20:21], 0
    v_mov_b64 v[22:23], 0
    v_smfmac_f32_16x16x64_bf16 v[64:67], v[40:43], v[128:135], v1
    s_waitcnt lgkmcnt(0)
    s_barrier
    ds_read_b64 v[110:111], v118 offset:8192
    v_mov_b64 v[24:25], 0
    v_smfmac_f32_16x16x64_bf16 v[68:71], v[40:43], v[136:143], v1
    ds_read_b128 v[88:91], v4 offset:24576
    v_mov_b64 v[26:27], 0
    v_smfmac_f32_16x16x64_bf16 v[64:67], v[44:47], v[144:151], v1
    ds_read_b128 v[92:95], v4 offset:25600
    v_mul_f32 v52, s33, v52
    v_mul_f32 v53, s33, v53
    v_smfmac_f32_16x16x64_bf16 v[68:71], v[44:47], v[152:159], v1
    ds_read_b128 v[96:99], v4 offset:26624
    s_waitcnt vmcnt(2) lgkmcnt(3)
    v_exp_f32 v52, v52
    v_mfma_f32_16x16x32_bf16 v[48:51], v[104:107], v[108:111], 0
    ds_read_b128 v[100:103], v4 offset:27648
    v_exp_f32 v53, v53
    v_mfma_f32_16x16x32_bf16 v[56:59], v[120:123], v[108:111], 0
    ds_read_b128 v[72:75], v4 offset:28672
    v_cvt_pk_bf16_f32 v112, v52, v53
    v_mov_b64 v[28:29], 0
    v_mfma_f32_16x16x32_bf16 v[60:63], v[124:127], v[108:111], 0
    ds_read_b128 v[76:79], v4 offset:29696
    v_add_f32 v64, v64, v66
    v_add_f32 v65, v65, v67
    v_mfma_f32_16x16x16_bf16 v[48:51], v[104:105], v[112:113], v[48:51]
    ds_read_b128 v[80:83], v4 offset:30720
    v_cvt_pk_bf16_f32 v114, v64, v65
    v_add_f32 v68, v68, v70
    v_add_f32 v69, v69, v71
    v_mfma_f32_16x16x16_bf16 v[56:59], v[114:115], v[112:113], v[56:59]
    ds_read_b128 v[84:87], v4 offset:31744
    v_cvt_pk_bf16_f32 v116, v68, v69
    v_mov_b64 v[30:31], 0
    v_mov_b64 v[32:33], 0
    v_mfma_f32_16x16x16_bf16 v[60:63], v[116:117], v[112:113], v[60:63]
    v_rcp_f32 v118, v48
    v_mov_b64 v[34:35], 0
    v_mov_b64 v[36:37], 0
    v_mov_b64 v[38:39], 0
    v_mov_b64 v[40:41], 0
    v_mov_b64 v[42:43], 0
    v_pk_mul_f32 v[56:57], v[56:57], v[118:119] op_sel_hi:[1,0]
    s_nop 0
    v_pk_mul_f32 v[60:61], v[60:61], v[118:119] op_sel_hi:[1,0]
    v_pk_mul_f32 v[58:59], v[58:59], v[118:119] op_sel_hi:[1,0]
    v_pk_mul_f32 v[62:63], v[62:63], v[118:119] op_sel_hi:[1,0]
    v_cvt_pk_bf16_f32 v52, v56, v60
    v_cvt_pk_bf16_f32 v53, v57, v61
    v_cvt_pk_bf16_f32 v54, v58, v62
    v_cvt_pk_bf16_f32 v55, v59, v63
    ds_write_b128 v8, v[52:55]
    v_max_f32 v118, v118, v48
    v_cmp_nge_f32 vcc, s40, v118
    s_cbranch_vccnz L_slow_safe
L_slow_rejoin:
    v_mov_b64 v[44:45], 0
    v_mov_b64 v[46:47], 0
    s_waitcnt lgkmcnt(0)
    s_barrier
    ds_read_b128 v[120:123], v3 offset:20992
    ds_read_b128 v[124:127], v3 offset:22016
    s_waitcnt lgkmcnt(1)
    v_smfmac_f32_16x16x64_bf16 v[16:19], v[120:123], v[88:95], v1
    v_smfmac_f32_16x16x64_bf16 v[20:23], v[120:123], v[96:103], v1
    s_waitcnt lgkmcnt(0)
    v_smfmac_f32_16x16x64_bf16 v[16:19], v[124:127], v[72:79], v1
    v_smfmac_f32_16x16x64_bf16 v[20:23], v[124:127], v[80:87], v1
    v_smfmac_f32_16x16x64_bf16 v[24:27], v[120:123], v[160:167], v1
    v_smfmac_f32_16x16x64_bf16 v[28:31], v[120:123], v[168:175], v1
    s_nop 4
    v_add_f32 v16, v16, v18
    v_add_f32 v17, v17, v19
    v_smfmac_f32_16x16x64_bf16 v[24:27], v[124:127], v[208:215], v1
    v_add_f32 v20, v20, v22
    v_add_f32 v21, v21, v23
    v_smfmac_f32_16x16x64_bf16 v[28:31], v[124:127], v[216:223], v1
    v_cvt_pk_bf16_f32 v48, v16, v20
    v_cvt_pk_bf16_f32 v49, v17, v21
    v_smfmac_f32_16x16x64_bf16 v[32:35], v[120:123], v[176:183], v1
    v_and_or_b32 v48, v48, -2, s27
    v_smfmac_f32_16x16x64_bf16 v[36:39], v[120:123], v[184:191], v1
    buffer_store_dwordx2 v[48:49], v9, s[8:11], 0 offen offset:0 sc1
    v_add_f32 v24, v24, v26
    v_add_f32 v25, v25, v27
    v_smfmac_f32_16x16x64_bf16 v[32:35], v[124:127], v[224:231], v1
    v_add_f32 v28, v28, v30
    v_add_f32 v29, v29, v31
    v_smfmac_f32_16x16x64_bf16 v[36:39], v[124:127], v[232:239], v1
    v_cvt_pk_bf16_f32 v50, v24, v28
    v_cvt_pk_bf16_f32 v51, v25, v29
    v_smfmac_f32_16x16x64_bf16 v[40:43], v[120:123], v[192:199], v1
    v_and_or_b32 v50, v50, -2, s27
    v_smfmac_f32_16x16x64_bf16 v[44:47], v[120:123], v[200:207], v1
    buffer_store_dwordx2 v[50:51], v9, s[8:11], 0 offen offset:2048 sc1
    v_add_f32 v32, v32, v34
    v_add_f32 v33, v33, v35
    v_smfmac_f32_16x16x64_bf16 v[40:43], v[124:127], v[240:247], v1
    v_add_f32 v36, v36, v38
    v_add_f32 v37, v37, v39
    v_smfmac_f32_16x16x64_bf16 v[44:47], v[124:127], v[248:255], v1
    v_cvt_pk_bf16_f32 v52, v32, v36
    v_cvt_pk_bf16_f32 v53, v33, v37
    v_and_or_b32 v52, v52, -2, s27
    buffer_store_dwordx2 v[52:53], v9, s[8:11], s26 offen offset:0 sc1
    s_nop 0
    v_add_f32 v40, v40, v42
    v_add_f32 v41, v41, v43
    s_nop 0
    v_add_f32 v44, v44, v46
    v_add_f32 v45, v45, v47
    v_cvt_pk_bf16_f32 v54, v40, v44
    v_cvt_pk_bf16_f32 v55, v41, v45
    v_and_or_b32 v54, v54, -2, s27
    buffer_store_dwordx2 v[54:55], v9, s[8:11], s26 offen offset:2048 sc1
L_slow_stored:
    ds_read_b128 v[24:27], v3 offset:23040
    ds_read_b128 v[104:107], v4 offset:0
    ds_read_b128 v[108:111], v4 offset:1024
    ds_read_b128 v[112:115], v4 offset:2048
    ds_read_b128 v[116:119], v4 offset:3072
    ds_read_b128 v[88:91], v4 offset:4096
    ds_read_b128 v[92:95], v4 offset:5120
    ds_read_b128 v[96:99], v4 offset:6144
    ds_read_b128 v[100:103], v4 offset:7168
    ds_read_b128 v[72:75], v4 offset:8192
    ds_read_b128 v[76:79], v4 offset:9216
    ds_read_b128 v[80:83], v4 offset:10240
    ds_read_b128 v[84:87], v4 offset:11264
    v_mov_b64 v[48:49], 0
    v_mov_b64 v[50:51], 0
    v_mov_b64 v[52:53], 0
    v_mov_b64 v[54:55], 0
    v_mov_b64 v[56:57], 0
    v_mov_b64 v[58:59], 0
    v_mov_b64 v[60:61], 0
    v_mov_b64 v[62:63], 0
    v_mov_b64 v[64:65], 0
    v_mov_b64 v[66:67], 0
    v_mov_b64 v[68:69], 0
    v_mov_b64 v[70:71], 0
    s_cmp_lt_u32 s21, 1
    s_cbranch_scc1 L_slow_poll0
    s_nop 7
    s_cmp_lt_u32 s21, 2
    s_cbranch_scc1 L_slow_poll0
    s_nop 7
    s_cmp_lt_u32 s21, 3
    s_cbranch_scc1 L_slow_poll0
    s_nop 7
L_slow_poll0:
    buffer_load_dwordx4 v[120:123], v2, s[8:11], s6 offen sc1
    buffer_load_dwordx4 v[124:127], v2, s[8:11], s6 offen offset:1024 sc1
    s_waitcnt lgkmcnt(0)
L_slow_pollp:
    s_waitcnt vmcnt(1)
    v_mfma_f32_16x16x32_bf16 v[36:39], v[24:27], v[120:123], 0
    v_bitop3_b32 v14, v120, v122, s27 bitop3:0x7e
    s_waitcnt vmcnt(0)
    v_mfma_f32_16x16x32_bf16 v[36:39], v[24:27], v[124:127], v[36:39]
    v_bitop3_b32 v11, v124, v126, s27 bitop3:0x7e
    v_bitop3_b32 v14, v14, v11, 1 bitop3:0xa8
    v_cmp_ne_u32 vcc, 0, v14
    s_add_u32 s32, s32, 1
    s_cbranch_vccz L_slow_gotp
    buffer_load_dwordx4 v[16:19], v2, s[8:11], s6 offen sc1
    buffer_load_dwordx4 v[20:23], v2, s[8:11], s6 offen offset:1024 sc1
    s_waitcnt vmcnt(1)
    v_mfma_f32_16x16x32_bf16 v[36:39], v[24:27], v[16:19], 0
    v_bitop3_b32 v14, v16, v18, s27 bitop3:0x7e
    s_waitcnt vmcnt(0)
    v_mfma_f32_16x16x32_bf16 v[36:39], v[24:27], v[20:23], v[36:39]
    v_bitop3_b32 v11, v20, v22, s27 bitop3:0x7e
    v_bitop3_b32 v14, v14, v11, 1 bitop3:0xa8
    v_cmp_ne_u32 vcc, 0, v14
    s_add_u32 s32, s32, 1
    s_cbranch_vccz L_slow_gotp
    buffer_load_dwordx4 v[120:123], v2, s[8:11], s6 offen sc1
    buffer_load_dwordx4 v[124:127], v2, s[8:11], s6 offen offset:1024 sc1
    s_cmp_le_u32 s32, 200000
    s_cbranch_scc1 L_slow_pollp
L_slow_gotp:
    s_mov_b32 s23, s24
    s_add_u32 s31, s31, 0x2000
    s_add_u32 s22, s22, 1
    s_xor_b32 s27, s27, 1
    v_add_f32_dpp v36, v36, v36 row_ror:8 row_mask:0xf bank_mask:0xf
    v_add_f32_dpp v37, v37, v37 row_ror:8 row_mask:0xf bank_mask:0xf
    s_nop 0
    v_add_f32_dpp v36, v36, v36 row_ror:4 row_mask:0xf bank_mask:0xf
    v_add_f32_dpp v37, v37, v37 row_ror:4 row_mask:0xf bank_mask:0xf
    v_cvt_pk_bf16_f32 v12, v36, v37
    buffer_store_dword v12, v10, s[8:11], s23 offen sc1
    s_nop 15
    s_nop 15
    s_nop 15
    s_cmp_lt_u32 s22, 63
    s_cbranch_scc1 L_slow_step
    buffer_store_dword v12, v10, s[8:11], s31 offen sc1
    s_branch L_slow_done
L_slow_refresh:
    v_lshrrev_b32 v14, 2, v3
    s_lshl_b32 s36, s20, 8
    s_add_u32 s36, s36, 0x190000
    buffer_load_dword v14, v14, s[8:11], s36 offen sc1
    s_add_u32 s32, s32, 1
    s_waitcnt vmcnt(0)
    v_cmp_ne_u32 s[62:63], 0, v14
    s_nop 3
    s_bitset1_b64 s[62:63], 63
    s_cmp_le_u32 s32, 200000
    s_cbranch_scc1 L_slow_step
    s_mov_b64 s[62:63], -1
    s_branch L_slow_step
L_slow_safe:
    s_nop 11
    s_waitcnt vmcnt(0) lgkmcnt(0)
    ds_read_b128 v[72:75], v6 offset:0
    ds_read_b128 v[88:91], v7 offset:0
    ds_read_b128 v[76:79], v6 offset:64
    ds_read_b128 v[92:95], v7 offset:64
    ds_read_b128 v[80:83], v6 offset:128
    ds_read_b128 v[96:99], v7 offset:128
    ds_read_b128 v[84:87], v6 offset:192
    ds_read_b128 v[100:103], v7 offset:192
    s_xor_b32 s36, s25, 0x1000
    s_add_u32 s36, s36, s23
    buffer_load_dwordx4 v[16:19], v3, s[8:11], s29 offen offset:0 sc1
    buffer_load_dwordx4 v[32:35], v3, s[8:11], s36 offen offset:0 sc1
    buffer_load_dwordx4 v[20:23], v3, s[8:11], s29 offen offset:1024 sc1
    buffer_load_dwordx4 v[36:39], v3, s[8:11], s36 offen offset:1024 sc1
    buffer_load_dwordx4 v[24:27], v3, s[8:11], s29 offen offset:2048 sc1
    buffer_load_dwordx4 v[40:43], v3, s[8:11], s36 offen offset:2048 sc1
    buffer_load_dwordx4 v[28:31], v3, s[8:11], s29 offen offset:3072 sc1
    buffer_load_dwordx4 v[44:47], v3, s[8:11], s36 offen offset:3072 sc1
    s_waitcnt vmcnt(0) lgkmcnt(0)
    v_mfma_f32_16x16x32_bf16 v[48:51], v[16:19], v[72:75], 0
    v_mfma_f32_16x16x32_bf16 v[48:51], v[20:23], v[76:79], v[48:51]
    v_mfma_f32_16x16x32_bf16 v[48:51], v[24:27], v[80:83], v[48:51]
    v_mfma_f32_16x16x32_bf16 v[48:51], v[28:31], v[84:87], v[48:51]
    v_mfma_f32_16x16x32_bf16 v[52:55], v[32:35], v[72:75], 0
    v_mfma_f32_16x16x32_bf16 v[52:55], v[36:39], v[76:79], v[52:55]
    v_mfma_f32_16x16x32_bf16 v[52:55], v[40:43], v[80:83], v[52:55]
    v_mfma_f32_16x16x32_bf16 v[52:55], v[44:47], v[84:87], v[52:55]
    v_mfma_f32_16x16x32_bf16 v[56:59], v[88:91], v[72:75], 0
    v_mfma_f32_16x16x32_bf16 v[56:59], v[92:95], v[76:79], v[56:59]
    v_mfma_f32_16x16x32_bf16 v[56:59], v[96:99], v[80:83], v[56:59]
    v_mfma_f32_16x16x32_bf16 v[56:59], v[100:103], v[84:87], v[56:59]
    s_nop 7
    v_mul_f32 v56, s33, v56
    v_mul_f32 v57, s33, v57
    v_max3_f32 v16, v48, v49, v50
    v_max3_f32 v16, v16, v51, v52
    v_max3_f32 v16, v16, v53, v54
    v_max3_f32 v16, v16, v55, v56
    v_max_f32 v16, v16, v57
    v_mov_b32 v17, v16
    s_nop 1
    v_permlane16_swap_b32 v16, v17
    v_max_f32 v16, v16, v17
    v_mov_b32 v17, v16
    s_nop 1
    v_permlane32_swap_b32 v16, v17
    v_max_f32 v16, v16, v17
    v_sub_f32 v48, v48, v16
    v_exp_f32 v48, v48
    v_sub_f32 v49, v49, v16
    v_exp_f32 v49, v49
    v_sub_f32 v50, v50, v16
    v_exp_f32 v50, v50
    v_sub_f32 v51, v51, v16
    v_exp_f32 v51, v51
    v_sub_f32 v52, v52, v16
    v_exp_f32 v52, v52
    v_sub_f32 v53, v53, v16
    v_exp_f32 v53, v53
    v_sub_f32 v54, v54, v16
    v_exp_f32 v54, v54
    v_sub_f32 v55, v55, v16
    v_exp_f32 v55, v55
    v_sub_f32 v56, v56, v16
    v_exp_f32 v56, v56
    v_sub_f32 v57, v57, v16
    v_exp_f32 v57, v57
    v_cvt_pk_bf16_f32 v108, v48, v49
    v_cvt_pk_bf16_f32 v109, v50, v51
    v_cvt_pk_bf16_f32 v110, v52, v53
    v_cvt_pk_bf16_f32 v111, v54, v55
    v_cvt_pk_bf16_f32 v112, v56, v57
    s_nop 0
    v_mfma_f32_16x16x32_bf16 v[48:51], v[104:107], v[108:111], 0
    v_mfma_f32_16x16x32_bf16 v[56:59], v[120:123], v[108:111], 0
    v_mfma_f32_16x16x32_bf16 v[60:63], v[124:127], v[108:111], 0
    s_nop 3
    v_mfma_f32_16x16x16_bf16 v[48:51], v[104:105], v[112:113], v[48:51]
    v_mfma_f32_16x16x16_bf16 v[56:59], v[114:115], v[112:113], v[56:59]
    v_mfma_f32_16x16x16_bf16 v[60:63], v[116:117], v[112:113], v[60:63]
    s_nop 5
    v_rcp_f32 v118, v48
    s_nop 0
    v_mul_f32 v56, v56, v118
    v_mul_f32 v57, v57, v118
    v_mul_f32 v58, v58, v118
    v_mul_f32 v59, v59, v118
    v_mul_f32 v60, v60, v118
    v_mul_f32 v61, v61, v118
    v_mul_f32 v62, v62, v118
    v_mul_f32 v63, v63, v118
    v_cvt_pk_bf16_f32 v52, v56, v60
    v_cvt_pk_bf16_f32 v53, v57, v61
    v_cvt_pk_bf16_f32 v54, v58, v62
    v_cvt_pk_bf16_f32 v55, v59, v63
    ds_write_b128 v8, v[52:55]
    ds_read_b128 v[88:91], v4 offset:24576
    ds_read_b128 v[92:95], v4 offset:25600
    ds_read_b128 v[96:99], v4 offset:26624
    ds_read_b128 v[100:103], v4 offset:27648
    ds_read_b128 v[72:75], v4 offset:28672
    ds_read_b128 v[76:79], v4 offset:29696
    ds_read_b128 v[80:83], v4 offset:30720
    ds_read_b128 v[84:87], v4 offset:31744
    v_mov_b32 v16, 0
    v_mov_b32 v17, 0
    v_mov_b32 v18, 0
    v_mov_b32 v19, 0
    v_mov_b32 v20, 0
    v_mov_b32 v21, 0
    v_mov_b32 v22, 0
    v_mov_b32 v23, 0
    v_mov_b32 v24, 0
    v_mov_b32 v25, 0
    v_mov_b32 v26, 0
    v_mov_b32 v27, 0
    v_mov_b32 v28, 0
    v_mov_b32 v29, 0
    v_mov_b32 v30, 0
    v_mov_b32 v31, 0
    v_mov_b32 v32, 0
    v_mov_b32 v33, 0
    v_mov_b32 v34, 0
    v_mov_b32 v35, 0
    v_mov_b32 v36, 0
    v_mov_b32 v37, 0
    v_mov_b32 v38, 0
    v_mov_b32 v39, 0
    v_mov_b32 v40, 0
    v_mov_b32 v41, 0
    v_mov_b32 v42, 0
    v_mov_b32 v43, 0
    v_mov_b32 v44, 0
    v_mov_b32 v45, 0
    v_mov_b32 v46, 0
    v_mov_b32 v47, 0
    s_branch L_slow_rejoin
L_slow_done:
    s_branch L_end
L_worker:
    s_mov_b32 s12, s44
    s_and_b32 s13, s45, 0xffff
    s_mov_b32 s14, 0x200000
    s_mov_b32 s15, 0x20000
    s_mov_b32 s60, s82
    s_and_b32 s61, s83, 0xffff
    s_mov_b32 s62, 0x200000
    s_mov_b32 s63, 0x20000
    s_cmp_eq_u32 s3, 7
    s_cbranch_scc1 L_mlp
    s_mov_b32 s92, s80
    s_and_b32 s93, s81, 0xffff
    s_mov_b32 s94, 0x400
    s_mov_b32 s95, 0x20000
    s_and_b32 s36, s2, 7
    s_sub_u32 s36, s36, 1
    s_lshl_b32 s36, s36, 5
    s_lshr_b32 s37, s2, 3
    s_add_u32 s36, s36, s37
    s_mul_i32 s20, s36, 10923
    s_lshr_b32 s20, s20, 16
    s_mul_i32 s37, s20, 6
    s_sub_u32 s22, s36, s37
    v_mov_b32 v1, 0x0
    v_bfe_u32 v14, v0, 0, 1
    s_mov_b32 s38, 0x10
    v_mad_u32_u24 v1, v14, s38, v1
    v_bfe_u32 v14, v0, 1, 1
    s_mov_b32 s38, 0x20
    v_mad_u32_u24 v1, v14, s38, v1
    v_bfe_u32 v14, v0, 2, 1
    s_mov_b32 s38, 0x40
    v_mad_u32_u24 v1, v14, s38, v1
    v_bfe_u32 v14, v0, 3, 1
    s_mov_b32 s38, 0x80
    v_mad_u32_u24 v1, v14, s38, v1
    v_bfe_u32 v14, v0, 4, 1
    s_mov_b32 s38, 0x100
    v_mad_u32_u24 v1, v14, s38, v1
    v_bfe_u32 v14, v0, 5, 1
    s_mov_b32 s38, 0x200
    v_mad_u32_u24 v1, v14, s38, v1
    v_mov_b32 v2, 0x0
    v_bfe_u32 v14, v0, 0, 1
    s_mov_b32 s38, 0x10
    v_mad_u32_u24 v2, v14, s38, v2
    v_bfe_u32 v14, v0, 1, 1
    s_mov_b32 s38, 0x20
    v_mad_u32_u24 v2, v14, s38, v2
    v_bfe_u32 v14, v0, 2, 1
    s_mov_b32 s38, 0x40
    v_mad_u32_u24 v2, v14, s38, v2
    v_bfe_u32 v14, v0, 3, 1
    s_mov_b32 s38, 0x80
    v_mad_u32_u24 v2, v14, s38, v2
    v_bfe_u32 v14, v0, 4, 1
    s_mov_b32 s38, 0x100
    v_mad_u32_u24 v2, v14, s38, v2
    v_bfe_u32 v14, v0, 5, 1
    s_mov_b32 s38, 0x200
    v_mad_u32_u24 v2, v14, s38, v2
    v_bfe_u32 v14, v0, 6, 1
    s_mov_b32 s38, 0x800
    v_mad_u32_u24 v2, v14, s38, v2
    v_bfe_u32 v14, v0, 7, 1
    s_mov_b32 s38, 0x1000
    v_mad_u32_u24 v2, v14, s38, v2
    v_mov_b32 v9, 0x0
    v_bfe_u32 v14, v0, 0, 1
    s_mov_b32 s38, 0x10
    v_mad_u32_u24 v9, v14, s38, v9
    v_bfe_u32 v14, v0, 1, 1
    s_mov_b32 s38, 0x20
    v_mad_u32_u24 v9, v14, s38, v9
    v_bfe_u32 v14, v0, 2, 1
    s_mov_b32 s38, 0x40
    v_mad_u32_u24 v9, v14, s38, v9
    v_bfe_u32 v14, v0, 3, 1
    s_mov_b32 s38, 0x80
    v_mad_u32_u24 v9, v14, s38, v9
    v_bfe_u32 v14, v0, 4, 1
    s_mov_b32 s38, 0x100
    v_mad_u32_u24 v9, v14, s38, v9
    v_bfe_u32 v14, v0, 5, 1
    s_mov_b32 s38, 0x200
    v_mad_u32_u24 v9, v14, s38, v9
    v_bfe_u32 v14, v0, 6, 1
    s_mov_b32 s38, 0x400
    v_mad_u32_u24 v9, v14, s38, v9
    v_bfe_u32 v14, v0, 7, 1
    s_mov_b32 s38, 0x800
    v_mad_u32_u24 v9, v14, s38, v9
    v_mov_b32 v7, 0x8000
    v_bfe_u32 v14, v0, 0, 1
    s_mov_b32 s38, 0x10
    v_mad_u32_u24 v7, v14, s38, v7
    v_bfe_u32 v14, v0, 1, 1
    s_mov_b32 s38, 0x20
    v_mad_u32_u24 v7, v14, s38, v7
    v_bfe_u32 v14, v0, 2, 1
    s_mov_b32 s38, 0x40
    v_mad_u32_u24 v7, v14, s38, v7
    v_bfe_u32 v14, v0, 3, 1
    s_mov_b32 s38, 0x80
    v_mad_u32_u24 v7, v14, s38, v7
    v_bfe_u32 v14, v0, 4, 1
    s_mov_b32 s38, 0x100
    v_mad_u32_u24 v7, v14, s38, v7
    v_bfe_u32 v14, v0, 5, 1
    s_mov_b32 s38, 0x200
    v_mad_u32_u24 v7, v14, s38, v7
    v_bfe_u32 v14, v0, 6, 1
    s_mov_b32 s38, 0x8000
    v_mad_u32_u24 v7, v14, s38, v7
    v_bfe_u32 v14, v0, 7, 1
    s_mov_b32 s38, 0x10000
    v_mad_u32_u24 v7, v14, s38, v7
    v_mov_b32 v3, 0x0
    v_bfe_u32 v14, v0, 0, 1
    s_mov_b32 s38, 0x10
    v_mad_u32_u24 v3, v14, s38, v3
    v_bfe_u32 v14, v0, 1, 1
    s_mov_b32 s38, 0x20
    v_mad_u32_u24 v3, v14, s38, v3
    v_bfe_u32 v14, v0, 2, 1
    s_mov_b32 s38, 0x40
    v_mad_u32_u24 v3, v14, s38, v3
    v_bfe_u32 v14, v0, 3, 1
    s_mov_b32 s38, 0x400
    v_mad_u32_u24 v3, v14, s38, v3
    v_bfe_u32 v14, v0, 4, 1
    s_mov_b32 s38, 0x800
    v_mad_u32_u24 v3, v14, s38, v3
    v_bfe_u32 v14, v0, 5, 1
    s_mov_b32 s38, 0x1000
    v_mad_u32_u24 v3, v14, s38, v3
    v_bfe_u32 v14, v0, 6, 1
    s_mov_b32 s38, 0x2000
    v_mad_u32_u24 v3, v14, s38, v3
    v_bfe_u32 v14, v0, 7, 1
    s_mov_b32 s38, 0x4000
    v_mad_u32_u24 v3, v14, s38, v3
    v_mov_b32 v4, 0x0
    v_bfe_u32 v14, v0, 0, 1
    s_mov_b32 s38, 0x100
    v_mad_u32_u24 v4, v14, s38, v4
    v_bfe_u32 v14, v0, 1, 1
    s_mov_b32 s38, 0x200
    v_mad_u32_u24 v4, v14, s38, v4
    v_bfe_u32 v14, v0, 2, 1
    s_mov_b32 s38, 0x400
    v_mad_u32_u24 v4, v14, s38, v4
    v_bfe_u32 v14, v0, 6, 1
    s_mov_b32 s38, 0x80
    v_mad_u32_u24 v4, v14, s38, v4
    v_bfe_u32 v14, v0, 7, 1
    s_mov_b32 s38, 0x4000
    v_mad_u32_u24 v4, v14, s38, v4
    v_lshrrev_b32 v15, 3, v0
    v_xor_b32 v15, v15, v0
    v_and_b32 v15, 7, v15
    v_lshl_add_u32 v4, v15, 4, v4
    v_bfe_u32 v15, v0, 4, 2
    v_lshlrev_b32 v15, 4, v15
    v_xor_b32 v5, v15, v1
    v_xor_b32 v6, 64, v5
    v_mov_b32 v8, 0x5000
    v_bfe_u32 v14, v0, 0, 1
    s_mov_b32 s38, 0x10
    v_mad_u32_u24 v8, v14, s38, v8
    v_bfe_u32 v14, v0, 1, 1
    s_mov_b32 s38, 0x40
    v_mad_u32_u24 v8, v14, s38, v8
    v_bfe_u32 v14, v0, 2, 1
    s_mov_b32 s38, 0x80
    v_mad_u32_u24 v8, v14, s38, v8
    v_bfe_u32 v14, v0, 4, 1
    s_mov_b32 s38, 0x20
    v_mad_u32_u24 v8, v14, s38, v8
    v_bfe_u32 v14, v0, 5, 1
    s_mov_b32 s38, 0x100
    v_mad_u32_u24 v8, v14, s38, v8
    v_mov_b32 v10, 0x0
    v_bfe_u32 v14, v0, 0, 1
    s_mov_b32 s38, 0x10
    v_mad_u32_u24 v10, v14, s38, v10
    v_bfe_u32 v14, v0, 1, 1
    s_mov_b32 s38, 0x20
    v_mad_u32_u24 v10, v14, s38, v10
    v_bfe_u32 v14, v0, 2, 1
    s_mov_b32 s38, 0x40
    v_mad_u32_u24 v10, v14, s38, v10
    v_bfe_u32 v14, v0, 3, 1
    s_mov_b32 s38, 0x80
    v_mad_u32_u24 v10, v14, s38, v10
    v_bfe_u32 v14, v0, 4, 1
    s_mov_b32 s38, 0x20000
    v_mad_u32_u24 v10, v14, s38, v10
    v_bfe_u32 v14, v0, 5, 1
    s_mov_b32 s38, 0x40000
    v_mad_u32_u24 v10, v14, s38, v10
    v_bfe_u32 v14, v0, 6, 1
    s_mov_b32 s38, 0x100
    v_mad_u32_u24 v10, v14, s38, v10
    v_bfe_u32 v14, v0, 7, 1
    s_mov_b32 s38, 0x200
    v_mad_u32_u24 v10, v14, s38, v10
    v_mov_b32 v11, 0x0
    v_bfe_u32 v14, v0, 0, 1
    s_mov_b32 s38, 0x10
    v_mad_u32_u24 v11, v14, s38, v11
    v_bfe_u32 v14, v0, 1, 1
    s_mov_b32 s38, 0x20
    v_mad_u32_u24 v11, v14, s38, v11
    v_bfe_u32 v14, v0, 2, 1
    s_mov_b32 s38, 0x40
    v_mad_u32_u24 v11, v14, s38, v11
    v_bfe_u32 v14, v0, 3, 1
    s_mov_b32 s38, 0x80
    v_mad_u32_u24 v11, v14, s38, v11
    v_bfe_u32 v14, v0, 4, 1
    s_mov_b32 s38, 0x400
    v_mad_u32_u24 v11, v14, s38, v11
    v_bfe_u32 v14, v0, 5, 1
    s_mov_b32 s38, 0x800
    v_mad_u32_u24 v11, v14, s38, v11
    v_bfe_u32 v14, v0, 6, 1
    s_mov_b32 s38, 0x100
    v_mad_u32_u24 v11, v14, s38, v11
    v_bfe_u32 v14, v0, 7, 1
    s_mov_b32 s38, 0x200
    v_mad_u32_u24 v11, v14, s38, v11
    v_mov_b32 v12, 0x0
    v_bfe_u32 v14, v0, 0, 1
    s_mov_b32 s38, 0x10
    v_mad_u32_u24 v12, v14, s38, v12
    v_bfe_u32 v14, v0, 1, 1
    s_mov_b32 s38, 0x20
    v_mad_u32_u24 v12, v14, s38, v12
    v_bfe_u32 v14, v0, 2, 1
    s_mov_b32 s38, 0x40
    v_mad_u32_u24 v12, v14, s38, v12
    v_bfe_u32 v14, v0, 3, 1
    s_mov_b32 s38, 0x80
    v_mad_u32_u24 v12, v14, s38, v12
    v_bfe_u32 v14, v0, 4, 1
    s_mov_b32 s38, 0x4
    v_mad_u32_u24 v12, v14, s38, v12
    v_bfe_u32 v14, v0, 5, 1
    s_mov_b32 s38, 0x8
    v_mad_u32_u24 v12, v14, s38, v12
    v_bfe_u32 v14, v0, 6, 1
    s_mov_b32 s38, 0x100
    v_mad_u32_u24 v12, v14, s38, v12
    v_bfe_u32 v14, v0, 7, 1
    s_mov_b32 s38, 0x200
    v_mad_u32_u24 v12, v14, s38, v12
    v_mov_b32 v13, 0xf149f2ca
    v_and_b32 v14, 15, v0
    v_bfe_u32 v15, v0, 4, 2
    v_cmp_gt_u32 s[72:73], 2, v15
    v_lshlrev_b32 v15, 2, v15
    v_cmp_le_u32 s[64:65], v15, v14
    v_add_u32 v15, 1, v15
    v_cmp_le_u32 s[66:67], v15, v14
    v_add_u32 v15, 1, v15
    v_cmp_le_u32 s[68:69], v15, v14
    v_add_u32 v15, 1, v15
    v_cmp_le_u32 s[70:71], v15, v14
    v_add_u32 v15, 1, v15
    s_mov_b32 s34, 0x05040100
    s_mov_b32 s35, 0x07060302
    s_mov_b32 s33, 0x3e0293ee
    s_mov_b32 s32, 0
    s_mov_b32 s4, 0x3f803f80
    s_mov_b32 s5, 0x3f803f80
    s_mov_b32 s23, s22
    s_mov_b32 s96, s54
    s_and_b32 s97, s55, 0xffff
    s_mov_b32 s98, 0x400000
    s_mov_b32 s99, 0x20000
    s_lshl_b32 s3, s20, 17
    s_and_b32 s28, s22, 3
    s_lshl_b32 s28, s28, 15
    s_add_u32 s3, s3, s28
    v_lshlrev_b32 v30, 7, v0
    buffer_load_dword v31, v30, s[96:99], s3 offen
    s_lshl_b32 s36, s23, 15
    buffer_load_dwordx4 v[96:99], v3, s[12:15], s36 offen offset:0
    buffer_load_dwordx4 v[100:103], v3, s[12:15], s36 offen offset:128
    buffer_load_dwordx4 v[104:107], v3, s[12:15], s36 offen offset:256
    buffer_load_dwordx4 v[108:111], v3, s[12:15], s36 offen offset:384
    buffer_load_dwordx4 v[112:115], v3, s[12:15], s36 offen offset:512
    buffer_load_dwordx4 v[116:119], v3, s[12:15], s36 offen offset:640
    buffer_load_dwordx4 v[120:123], v3, s[12:15], s36 offen offset:768
    buffer_load_dwordx4 v[124:127], v3, s[12:15], s36 offen offset:896
    s_mov_b32 s76, s52
    s_and_b32 s77, s53, 0xffff
    s_mov_b32 s78, 0x400000
    s_mov_b32 s79, 0x20000
    s_mov_b32 s40, s50
    s_and_b32 s41, s51, 0xffff
    s_mov_b32 s42, 0x400000
    s_mov_b32 s43, 0x20000
    s_mov_b32 s96, s48
    s_and_b32 s97, s49, 0xffff
    s_mov_b32 s98, 0x400000
    s_mov_b32 s99, 0x20000
    v_mov_b32 v16, 0x0
    v_bfe_u32 v14, v0, 0, 1
    s_mov_b32 s38, 0x10
    v_mad_u32_u24 v16, v14, s38, v16
    v_bfe_u32 v14, v0, 1, 1
    s_mov_b32 s38, 0x20
    v_mad_u32_u24 v16, v14, s38, v16
    v_bfe_u32 v14, v0, 2, 1
    s_mov_b32 s38, 0x40
    v_mad_u32_u24 v16, v14, s38, v16
    v_bfe_u32 v14, v0, 3, 1
    s_mov_b32 s38, 0x80
    v_mad_u32_u24 v16, v14, s38, v16
    v_bfe_u32 v14, v0, 4, 1
    s_mov_b32 s38, 0x2000
    v_mad_u32_u24 v16, v14, s38, v16
    v_bfe_u32 v14, v0, 5, 1
    s_mov_b32 s38, 0x4000
    v_mad_u32_u24 v16, v14, s38, v16
    v_bfe_u32 v14, v0, 6, 1
    s_mov_b32 s38, 0x40000
    v_mad_u32_u24 v16, v14, s38, v16
    v_bfe_u32 v14, v0, 7, 1
    s_mov_b32 s38, 0x80000
    v_mad_u32_u24 v16, v14, s38, v16
    v_mov_b32 v28, 0x0
    v_bfe_u32 v14, v0, 4, 1
    s_mov_b32 s38, 0x20
    v_mad_u32_u24 v28, v14, s38, v28
    v_bfe_u32 v14, v0, 5, 1
    s_mov_b32 s38, 0x40
    v_mad_u32_u24 v28, v14, s38, v28
    v_xor_b32 v16, v16, v28
    v_xor_b32 v17, 0, v16
    v_xor_b32 v18, 128, v16
    v_xor_b32 v19, 128, v16
    v_mov_b32 v20, 0x0
    v_bfe_u32 v14, v0, 0, 1
    s_mov_b32 s38, 0x8
    v_mad_u32_u24 v20, v14, s38, v20
    v_bfe_u32 v14, v0, 1, 1
    s_mov_b32 s38, 0x10
    v_mad_u32_u24 v20, v14, s38, v20
    v_bfe_u32 v14, v0, 2, 1
    s_mov_b32 s38, 0x100
    v_mad_u32_u24 v20, v14, s38, v20
    v_bfe_u32 v14, v0, 3, 1
    s_mov_b32 s38, 0x200
    v_mad_u32_u24 v20, v14, s38, v20
    v_bfe_u32 v14, v0, 4, 1
    s_mov_b32 s38, 0x800
    v_mad_u32_u24 v20, v14, s38, v20
    v_bfe_u32 v14, v0, 5, 1
    s_mov_b32 s38, 0x1000
    v_mad_u32_u24 v20, v14, s38, v20
    v_mov_b32 v28, 0x0
    v_bfe_u32 v14, v0, 2, 1
    s_mov_b32 s38, 0x20
    v_mad_u32_u24 v28, v14, s38, v28
    v_bfe_u32 v14, v0, 3, 1
    s_mov_b32 s38, 0x40
    v_mad_u32_u24 v28, v14, s38, v28
    v_bfe_u32 v14, v0, 4, 1
    s_mov_b32 s38, 0x80
    v_mad_u32_u24 v28, v14, s38, v28
    v_mov_b32 v29, 0x0
    v_bfe_u32 v14, v0, 6, 1
    s_mov_b32 s38, 0x40
    v_mad_u32_u24 v29, v14, s38, v29
    v_bfe_u32 v14, v0, 7, 1
    s_mov_b32 s38, 0x80
    v_mad_u32_u24 v29, v14, s38, v29
    v_xor_b32 v28, v28, v29
    v_add_u32 v28, v28, v20
    v_add_u32 v20, 0x8000, v28
    v_xor_b32 v21, 32, v20
    v_add_u32 v22, 0x10000, v28
    v_xor_b32 v23, 32, v22
    v_add_u32 v24, 0x18000, v28
    v_xor_b32 v25, 32, v24
    v_add_u32 v26, 0x20000, v28
    v_xor_b32 v27, 32, v26
    s_add_u32 s28, s21, 1
    s_lshl_b32 s28, s28, 15
    s_lshl_b32 s3, s20, 8
    s_add_u32 m0, s28, 0
    s_add_u32 s37, s3, 0x0
    buffer_load_dwordx4 v16, s[76:79], s37 offen lds
    s_add_u32 m0, s28, 1024
    s_add_u32 s37, s3, 0x8000
    buffer_load_dwordx4 v17, s[76:79], s37 offen lds
    s_add_u32 m0, s28, 2048
    s_add_u32 s37, s3, 0x10000
    buffer_load_dwordx4 v18, s[76:79], s37 offen lds
    s_add_u32 m0, s28, 3072
    s_add_u32 s37, s3, 0x18000
    buffer_load_dwordx4 v19, s[76:79], s37 offen lds
    s_add_u32 m0, s28, 4096
    s_add_u32 s37, s3, 0x20000
    buffer_load_dwordx4 v16, s[76:79], s37 offen lds
    s_add_u32 m0, s28, 5120
    s_add_u32 s37, s3, 0x28000
    buffer_load_dwordx4 v17, s[76:79], s37 offen lds
    s_add_u32 m0, s28, 6144
    s_add_u32 s37, s3, 0x30000
    buffer_load_dwordx4 v18, s[76:79], s37 offen lds
    s_add_u32 m0, s28, 7168
    s_add_u32 s37, s3, 0x38000
    buffer_load_dwordx4 v19, s[76:79], s37 offen lds
    s_add_u32 m0, s28, 8192
    s_add_u32 s37, s3, 0x100000
    buffer_load_dwordx4 v16, s[76:79], s37 offen lds
    s_add_u32 m0, s28, 9216
    s_add_u32 s37, s3, 0x108000
    buffer_load_dwordx4 v17, s[76:79], s37 offen lds
    s_add_u32 m0, s28, 10240
    s_add_u32 s37, s3, 0x110000
    buffer_load_dwordx4 v18, s[76:79], s37 offen lds
    s_add_u32 m0, s28, 11264
    s_add_u32 s37, s3, 0x118000
    buffer_load_dwordx4 v19, s[76:79], s37 offen lds
    s_add_u32 m0, s28, 12288
    s_add_u32 s37, s3, 0x120000
    buffer_load_dwordx4 v16, s[76:79], s37 offen lds
    s_add_u32 m0, s28, 13312
    s_add_u32 s37, s3, 0x128000
    buffer_load_dwordx4 v17, s[76:79], s37 offen lds
    s_add_u32 m0, s28, 14336
    s_add_u32 s37, s3, 0x130000
    buffer_load_dwordx4 v18, s[76:79], s37 offen lds
    s_add_u32 m0, s28, 15360
    s_add_u32 s37, s3, 0x138000
    buffer_load_dwordx4 v19, s[76:79], s37 offen lds
    s_add_u32 m0, s28, 16384
    s_add_u32 s37, s3, 0x200000
    buffer_load_dwordx4 v16, s[76:79], s37 offen lds
    s_add_u32 m0, s28, 17408
    s_add_u32 s37, s3, 0x208000
    buffer_load_dwordx4 v17, s[76:79], s37 offen lds
    s_add_u32 m0, s28, 18432
    s_add_u32 s37, s3, 0x210000
    buffer_load_dwordx4 v18, s[76:79], s37 offen lds
    s_add_u32 m0, s28, 19456
    s_add_u32 s37, s3, 0x218000
    buffer_load_dwordx4 v19, s[76:79], s37 offen lds
    s_add_u32 m0, s28, 20480
    s_add_u32 s37, s3, 0x220000
    buffer_load_dwordx4 v16, s[76:79], s37 offen lds
    s_add_u32 m0, s28, 21504
    s_add_u32 s37, s3, 0x228000
    buffer_load_dwordx4 v17, s[76:79], s37 offen lds
    s_add_u32 m0, s28, 22528
    s_add_u32 s37, s3, 0x230000
    buffer_load_dwordx4 v18, s[76:79], s37 offen lds
    s_add_u32 m0, s28, 23552
    s_add_u32 s37, s3, 0x238000
    buffer_load_dwordx4 v19, s[76:79], s37 offen lds
    s_waitcnt vmcnt(16)
    s_barrier
    ds_read_b64_tr_b16 v[128:129], v20 offset:0
    ds_read_b64_tr_b16 v[130:131], v20 offset:1024
    ds_read_b64_tr_b16 v[132:133], v21 offset:0
    ds_read_b64_tr_b16 v[134:135], v21 offset:1024
    ds_read_b64_tr_b16 v[136:137], v22 offset:0
    ds_read_b64_tr_b16 v[138:139], v22 offset:1024
    ds_read_b64_tr_b16 v[140:141], v23 offset:0
    ds_read_b64_tr_b16 v[142:143], v23 offset:1024
    ds_read_b64_tr_b16 v[144:145], v24 offset:0
    ds_read_b64_tr_b16 v[146:147], v24 offset:1024
    ds_read_b64_tr_b16 v[148:149], v25 offset:0
    ds_read_b64_tr_b16 v[150:151], v25 offset:1024
    s_waitcnt lgkmcnt(4)
    ds_read_b64_tr_b16 v[152:153], v26 offset:0
    ds_read_b64_tr_b16 v[154:155], v26 offset:1024
    ds_read_b64_tr_b16 v[156:157], v27 offset:0
    ds_read_b64_tr_b16 v[158:159], v27 offset:1024
    s_waitcnt lgkmcnt(0)
    s_barrier
    s_add_u32 m0, s28, 0
    s_add_u32 s37, s3, 0x300000
    buffer_load_dwordx4 v16, s[76:79], s37 offen lds
    s_add_u32 m0, s28, 1024
    s_add_u32 s37, s3, 0x308000
    buffer_load_dwordx4 v17, s[76:79], s37 offen lds
    s_add_u32 m0, s28, 2048
    s_add_u32 s37, s3, 0x310000
    buffer_load_dwordx4 v18, s[76:79], s37 offen lds
    s_add_u32 m0, s28, 3072
    s_add_u32 s37, s3, 0x318000
    buffer_load_dwordx4 v19, s[76:79], s37 offen lds
    s_add_u32 m0, s28, 4096
    s_add_u32 s37, s3, 0x320000
    buffer_load_dwordx4 v16, s[76:79], s37 offen lds
    s_add_u32 m0, s28, 5120
    s_add_u32 s37, s3, 0x328000
    buffer_load_dwordx4 v17, s[76:79], s37 offen lds
    s_add_u32 m0, s28, 6144
    s_add_u32 s37, s3, 0x330000
    buffer_load_dwordx4 v18, s[76:79], s37 offen lds
    s_add_u32 m0, s28, 7168
    s_add_u32 s37, s3, 0x338000
    buffer_load_dwordx4 v19, s[76:79], s37 offen lds
    s_waitcnt vmcnt(16)
    s_barrier
    ds_read_b64_tr_b16 v[160:161], v20 offset:8192
    ds_read_b64_tr_b16 v[162:163], v20 offset:9216
    ds_read_b64_tr_b16 v[164:165], v21 offset:8192
    ds_read_b64_tr_b16 v[166:167], v21 offset:9216
    ds_read_b64_tr_b16 v[168:169], v22 offset:8192
    ds_read_b64_tr_b16 v[170:171], v22 offset:9216
    ds_read_b64_tr_b16 v[172:173], v23 offset:8192
    ds_read_b64_tr_b16 v[174:175], v23 offset:9216
    ds_read_b64_tr_b16 v[176:177], v24 offset:8192
    ds_read_b64_tr_b16 v[178:179], v24 offset:9216
    ds_read_b64_tr_b16 v[180:181], v25 offset:8192
    ds_read_b64_tr_b16 v[182:183], v25 offset:9216
    s_waitcnt lgkmcnt(4)
    ds_read_b64_tr_b16 v[184:185], v26 offset:8192
    ds_read_b64_tr_b16 v[186:187], v26 offset:9216
    ds_read_b64_tr_b16 v[188:189], v27 offset:8192
    ds_read_b64_tr_b16 v[190:191], v27 offset:9216
    s_waitcnt lgkmcnt(0)
    s_barrier
    s_add_u32 m0, s28, 8192
    s_add_u32 s37, s3, 0x0
    buffer_load_dwordx4 v16, s[40:43], s37 offen lds
    s_add_u32 m0, s28, 9216
    s_add_u32 s37, s3, 0x8000
    buffer_load_dwordx4 v17, s[40:43], s37 offen lds
    s_add_u32 m0, s28, 10240
    s_add_u32 s37, s3, 0x10000
    buffer_load_dwordx4 v18, s[40:43], s37 offen lds
    s_add_u32 m0, s28, 11264
    s_add_u32 s37, s3, 0x18000
    buffer_load_dwordx4 v19, s[40:43], s37 offen lds
    s_add_u32 m0, s28, 12288
    s_add_u32 s37, s3, 0x20000
    buffer_load_dwordx4 v16, s[40:43], s37 offen lds
    s_add_u32 m0, s28, 13312
    s_add_u32 s37, s3, 0x28000
    buffer_load_dwordx4 v17, s[40:43], s37 offen lds
    s_add_u32 m0, s28, 14336
    s_add_u32 s37, s3, 0x30000
    buffer_load_dwordx4 v18, s[40:43], s37 offen lds
    s_add_u32 m0, s28, 15360
    s_add_u32 s37, s3, 0x38000
    buffer_load_dwordx4 v19, s[40:43], s37 offen lds
    s_waitcnt vmcnt(16)
    s_barrier
    ds_read_b64_tr_b16 v[192:193], v20 offset:16384
    ds_read_b64_tr_b16 v[194:195], v20 offset:17408
    ds_read_b64_tr_b16 v[196:197], v21 offset:16384
    ds_read_b64_tr_b16 v[198:199], v21 offset:17408
    ds_read_b64_tr_b16 v[200:201], v22 offset:16384
    ds_read_b64_tr_b16 v[202:203], v22 offset:17408
    ds_read_b64_tr_b16 v[204:205], v23 offset:16384
    ds_read_b64_tr_b16 v[206:207], v23 offset:17408
    ds_read_b64_tr_b16 v[208:209], v24 offset:16384
    ds_read_b64_tr_b16 v[210:211], v24 offset:17408
    ds_read_b64_tr_b16 v[212:213], v25 offset:16384
    ds_read_b64_tr_b16 v[214:215], v25 offset:17408
    s_waitcnt lgkmcnt(4)
    ds_read_b64_tr_b16 v[216:217], v26 offset:16384
    ds_read_b64_tr_b16 v[218:219], v26 offset:17408
    ds_read_b64_tr_b16 v[220:221], v27 offset:16384
    ds_read_b64_tr_b16 v[222:223], v27 offset:17408
    s_waitcnt lgkmcnt(0)
    s_barrier
    s_add_u32 m0, s28, 16384
    s_add_u32 s37, s3, 0x100000
    buffer_load_dwordx4 v16, s[40:43], s37 offen lds
    s_add_u32 m0, s28, 17408
    s_add_u32 s37, s3, 0x108000
    buffer_load_dwordx4 v17, s[40:43], s37 offen lds
    s_add_u32 m0, s28, 18432
    s_add_u32 s37, s3, 0x110000
    buffer_load_dwordx4 v18, s[40:43], s37 offen lds
    s_add_u32 m0, s28, 19456
    s_add_u32 s37, s3, 0x118000
    buffer_load_dwordx4 v19, s[40:43], s37 offen lds
    s_add_u32 m0, s28, 20480
    s_add_u32 s37, s3, 0x120000
    buffer_load_dwordx4 v16, s[40:43], s37 offen lds
    s_add_u32 m0, s28, 21504
    s_add_u32 s37, s3, 0x128000
    buffer_load_dwordx4 v17, s[40:43], s37 offen lds
    s_add_u32 m0, s28, 22528
    s_add_u32 s37, s3, 0x130000
    buffer_load_dwordx4 v18, s[40:43], s37 offen lds
    s_add_u32 m0, s28, 23552
    s_add_u32 s37, s3, 0x138000
    buffer_load_dwordx4 v19, s[40:43], s37 offen lds
    s_waitcnt vmcnt(16)
    s_barrier
    ds_read_b64_tr_b16 v[224:225], v20 offset:0
    ds_read_b64_tr_b16 v[226:227], v20 offset:1024
    ds_read_b64_tr_b16 v[228:229], v21 offset:0
    ds_read_b64_tr_b16 v[230:231], v21 offset:1024
    ds_read_b64_tr_b16 v[232:233], v22 offset:0
    ds_read_b64_tr_b16 v[234:235], v22 offset:1024
    ds_read_b64_tr_b16 v[236:237], v23 offset:0
    ds_read_b64_tr_b16 v[238:239], v23 offset:1024
    ds_read_b64_tr_b16 v[240:241], v24 offset:0
    ds_read_b64_tr_b16 v[242:243], v24 offset:1024
    ds_read_b64_tr_b16 v[244:245], v25 offset:0
    ds_read_b64_tr_b16 v[246:247], v25 offset:1024
    s_waitcnt lgkmcnt(4)
    ds_read_b64_tr_b16 v[248:249], v26 offset:0
    ds_read_b64_tr_b16 v[250:251], v26 offset:1024
    ds_read_b64_tr_b16 v[252:253], v27 offset:0
    ds_read_b64_tr_b16 v[254:255], v27 offset:1024
    s_waitcnt lgkmcnt(0)
    s_barrier
    s_add_u32 m0, s28, 0
    s_add_u32 s37, s3, 0x200000
    buffer_load_dwordx4 v16, s[40:43], s37 offen lds
    s_add_u32 m0, s28, 1024
    s_add_u32 s37, s3, 0x208000
    buffer_load_dwordx4 v17, s[40:43], s37 offen lds
    s_add_u32 m0, s28, 2048
    s_add_u32 s37, s3, 0x210000
    buffer_load_dwordx4 v18, s[40:43], s37 offen lds
    s_add_u32 m0, s28, 3072
    s_add_u32 s37, s3, 0x218000
    buffer_load_dwordx4 v19, s[40:43], s37 offen lds
    s_add_u32 m0, s28, 4096
    s_add_u32 s37, s3, 0x220000
    buffer_load_dwordx4 v16, s[40:43], s37 offen lds
    s_add_u32 m0, s28, 5120
    s_add_u32 s37, s3, 0x228000
    buffer_load_dwordx4 v17, s[40:43], s37 offen lds
    s_add_u32 m0, s28, 6144
    s_add_u32 s37, s3, 0x230000
    buffer_load_dwordx4 v18, s[40:43], s37 offen lds
    s_add_u32 m0, s28, 7168
    s_add_u32 s37, s3, 0x238000
    buffer_load_dwordx4 v19, s[40:43], s37 offen lds
    s_waitcnt vmcnt(16)
    s_barrier
    ds_read_b64_tr_b16 a[128:129], v20 offset:8192
    ds_read_b64_tr_b16 a[130:131], v20 offset:9216
    ds_read_b64_tr_b16 a[132:133], v21 offset:8192
    ds_read_b64_tr_b16 a[134:135], v21 offset:9216
    ds_read_b64_tr_b16 a[136:137], v22 offset:8192
    ds_read_b64_tr_b16 a[138:139], v22 offset:9216
    ds_read_b64_tr_b16 a[140:141], v23 offset:8192
    ds_read_b64_tr_b16 a[142:143], v23 offset:9216
    ds_read_b64_tr_b16 a[144:145], v24 offset:8192
    ds_read_b64_tr_b16 a[146:147], v24 offset:9216
    ds_read_b64_tr_b16 a[148:149], v25 offset:8192
    ds_read_b64_tr_b16 a[150:151], v25 offset:9216
    s_waitcnt lgkmcnt(4)
    ds_read_b64_tr_b16 a[152:153], v26 offset:8192
    ds_read_b64_tr_b16 a[154:155], v26 offset:9216
    ds_read_b64_tr_b16 a[156:157], v27 offset:8192
    ds_read_b64_tr_b16 a[158:159], v27 offset:9216
    s_waitcnt lgkmcnt(0)
    s_barrier
    s_add_u32 m0, s28, 8192
    s_add_u32 s37, s3, 0x300000
    buffer_load_dwordx4 v16, s[40:43], s37 offen lds
    s_add_u32 m0, s28, 9216
    s_add_u32 s37, s3, 0x308000
    buffer_load_dwordx4 v17, s[40:43], s37 offen lds
    s_add_u32 m0, s28, 10240
    s_add_u32 s37, s3, 0x310000
    buffer_load_dwordx4 v18, s[40:43], s37 offen lds
    s_add_u32 m0, s28, 11264
    s_add_u32 s37, s3, 0x318000
    buffer_load_dwordx4 v19, s[40:43], s37 offen lds
    s_add_u32 m0, s28, 12288
    s_add_u32 s37, s3, 0x320000
    buffer_load_dwordx4 v16, s[40:43], s37 offen lds
    s_add_u32 m0, s28, 13312
    s_add_u32 s37, s3, 0x328000
    buffer_load_dwordx4 v17, s[40:43], s37 offen lds
    s_add_u32 m0, s28, 14336
    s_add_u32 s37, s3, 0x330000
    buffer_load_dwordx4 v18, s[40:43], s37 offen lds
    s_add_u32 m0, s28, 15360
    s_add_u32 s37, s3, 0x338000
    buffer_load_dwordx4 v19, s[40:43], s37 offen lds
    s_waitcnt vmcnt(16)
    s_barrier
    ds_read_b64_tr_b16 a[160:161], v20 offset:16384
    ds_read_b64_tr_b16 a[162:163], v20 offset:17408
    ds_read_b64_tr_b16 a[164:165], v21 offset:16384
    ds_read_b64_tr_b16 a[166:167], v21 offset:17408
    ds_read_b64_tr_b16 a[168:169], v22 offset:16384
    ds_read_b64_tr_b16 a[170:171], v22 offset:17408
    ds_read_b64_tr_b16 a[172:173], v23 offset:16384
    ds_read_b64_tr_b16 a[174:175], v23 offset:17408
    ds_read_b64_tr_b16 a[176:177], v24 offset:16384
    ds_read_b64_tr_b16 a[178:179], v24 offset:17408
    ds_read_b64_tr_b16 a[180:181], v25 offset:16384
    ds_read_b64_tr_b16 a[182:183], v25 offset:17408
    s_waitcnt lgkmcnt(4)
    ds_read_b64_tr_b16 a[184:185], v26 offset:16384
    ds_read_b64_tr_b16 a[186:187], v26 offset:17408
    ds_read_b64_tr_b16 a[188:189], v27 offset:16384
    ds_read_b64_tr_b16 a[190:191], v27 offset:17408
    s_waitcnt lgkmcnt(0)
    s_barrier
    s_add_u32 m0, s28, 16384
    s_add_u32 s37, s3, 0x0
    buffer_load_dwordx4 v16, s[96:99], s37 offen lds
    s_add_u32 m0, s28, 17408
    s_add_u32 s37, s3, 0x8000
    buffer_load_dwordx4 v17, s[96:99], s37 offen lds
    s_add_u32 m0, s28, 18432
    s_add_u32 s37, s3, 0x10000
    buffer_load_dwordx4 v18, s[96:99], s37 offen lds
    s_add_u32 m0, s28, 19456
    s_add_u32 s37, s3, 0x18000
    buffer_load_dwordx4 v19, s[96:99], s37 offen lds
    s_add_u32 m0, s28, 20480
    s_add_u32 s37, s3, 0x20000
    buffer_load_dwordx4 v16, s[96:99], s37 offen lds
    s_add_u32 m0, s28, 21504
    s_add_u32 s37, s3, 0x28000
    buffer_load_dwordx4 v17, s[96:99], s37 offen lds
    s_add_u32 m0, s28, 22528
    s_add_u32 s37, s3, 0x30000
    buffer_load_dwordx4 v18, s[96:99], s37 offen lds
    s_add_u32 m0, s28, 23552
    s_add_u32 s37, s3, 0x38000
    buffer_load_dwordx4 v19, s[96:99], s37 offen lds
    s_waitcnt vmcnt(16)
    s_barrier
    ds_read_b64_tr_b16 a[192:193], v20 offset:0
    ds_read_b64_tr_b16 a[194:195], v20 offset:1024
    ds_read_b64_tr_b16 a[196:197], v21 offset:0
    ds_read_b64_tr_b16 a[198:199], v21 offset:1024
    ds_read_b64_tr_b16 a[200:201], v22 offset:0
    ds_read_b64_tr_b16 a[202:203], v22 offset:1024
    ds_read_b64_tr_b16 a[204:205], v23 offset:0
    ds_read_b64_tr_b16 a[206:207], v23 offset:1024
    ds_read_b64_tr_b16 a[208:209], v24 offset:0
    ds_read_b64_tr_b16 a[210:211], v24 offset:1024
    ds_read_b64_tr_b16 a[212:213], v25 offset:0
    ds_read_b64_tr_b16 a[214:215], v25 offset:1024
    s_waitcnt lgkmcnt(4)
    ds_read_b64_tr_b16 a[216:217], v26 offset:0
    ds_read_b64_tr_b16 a[218:219], v26 offset:1024
    ds_read_b64_tr_b16 a[220:221], v27 offset:0
    ds_read_b64_tr_b16 a[222:223], v27 offset:1024
    s_waitcnt lgkmcnt(0)
    s_barrier
    s_add_u32 m0, s28, 0
    s_add_u32 s37, s3, 0x100000
    buffer_load_dwordx4 v16, s[96:99], s37 offen lds
    s_add_u32 m0, s28, 1024
    s_add_u32 s37, s3, 0x108000
    buffer_load_dwordx4 v17, s[96:99], s37 offen lds
    s_add_u32 m0, s28, 2048
    s_add_u32 s37, s3, 0x110000
    buffer_load_dwordx4 v18, s[96:99], s37 offen lds
    s_add_u32 m0, s28, 3072
    s_add_u32 s37, s3, 0x118000
    buffer_load_dwordx4 v19, s[96:99], s37 offen lds
    s_add_u32 m0, s28, 4096
    s_add_u32 s37, s3, 0x120000
    buffer_load_dwordx4 v16, s[96:99], s37 offen lds
    s_add_u32 m0, s28, 5120
    s_add_u32 s37, s3, 0x128000
    buffer_load_dwordx4 v17, s[96:99], s37 offen lds
    s_add_u32 m0, s28, 6144
    s_add_u32 s37, s3, 0x130000
    buffer_load_dwordx4 v18, s[96:99], s37 offen lds
    s_add_u32 m0, s28, 7168
    s_add_u32 s37, s3, 0x138000
    buffer_load_dwordx4 v19, s[96:99], s37 offen lds
    s_waitcnt vmcnt(16)
    s_barrier
    ds_read_b64_tr_b16 a[224:225], v20 offset:8192
    ds_read_b64_tr_b16 a[226:227], v20 offset:9216
    ds_read_b64_tr_b16 a[228:229], v21 offset:8192
    ds_read_b64_tr_b16 a[230:231], v21 offset:9216
    ds_read_b64_tr_b16 a[232:233], v22 offset:8192
    ds_read_b64_tr_b16 a[234:235], v22 offset:9216
    ds_read_b64_tr_b16 a[236:237], v23 offset:8192
    ds_read_b64_tr_b16 a[238:239], v23 offset:9216
    ds_read_b64_tr_b16 a[240:241], v24 offset:8192
    ds_read_b64_tr_b16 a[242:243], v24 offset:9216
    ds_read_b64_tr_b16 a[244:245], v25 offset:8192
    ds_read_b64_tr_b16 a[246:247], v25 offset:9216
    s_waitcnt lgkmcnt(4)
    ds_read_b64_tr_b16 a[248:249], v26 offset:8192
    ds_read_b64_tr_b16 a[250:251], v26 offset:9216
    ds_read_b64_tr_b16 a[252:253], v27 offset:8192
    ds_read_b64_tr_b16 a[254:255], v27 offset:9216
    s_waitcnt lgkmcnt(0)
    s_barrier
    s_add_u32 m0, s28, 8192
    s_add_u32 s37, s3, 0x200000
    buffer_load_dwordx4 v16, s[96:99], s37 offen lds
    s_add_u32 m0, s28, 9216
    s_add_u32 s37, s3, 0x208000
    buffer_load_dwordx4 v17, s[96:99], s37 offen lds
    s_add_u32 m0, s28, 10240
    s_add_u32 s37, s3, 0x210000
    buffer_load_dwordx4 v18, s[96:99], s37 offen lds
    s_add_u32 m0, s28, 11264
    s_add_u32 s37, s3, 0x218000
    buffer_load_dwordx4 v19, s[96:99], s37 offen lds
    s_add_u32 m0, s28, 12288
    s_add_u32 s37, s3, 0x220000
    buffer_load_dwordx4 v16, s[96:99], s37 offen lds
    s_add_u32 m0, s28, 13312
    s_add_u32 s37, s3, 0x228000
    buffer_load_dwordx4 v17, s[96:99], s37 offen lds
    s_add_u32 m0, s28, 14336
    s_add_u32 s37, s3, 0x230000
    buffer_load_dwordx4 v18, s[96:99], s37 offen lds
    s_add_u32 m0, s28, 15360
    s_add_u32 s37, s3, 0x238000
    buffer_load_dwordx4 v19, s[96:99], s37 offen lds
    s_waitcnt vmcnt(16)
    s_barrier
    ds_read_b64_tr_b16 a[0:1], v20 offset:16384
    ds_read_b64_tr_b16 a[2:3], v20 offset:17408
    ds_read_b64_tr_b16 a[4:5], v21 offset:16384
    ds_read_b64_tr_b16 a[6:7], v21 offset:17408
    ds_read_b64_tr_b16 a[8:9], v22 offset:16384
    ds_read_b64_tr_b16 a[10:11], v22 offset:17408
    ds_read_b64_tr_b16 a[12:13], v23 offset:16384
    ds_read_b64_tr_b16 a[14:15], v23 offset:17408
    ds_read_b64_tr_b16 a[16:17], v24 offset:16384
    ds_read_b64_tr_b16 a[18:19], v24 offset:17408
    ds_read_b64_tr_b16 a[20:21], v25 offset:16384
    ds_read_b64_tr_b16 a[22:23], v25 offset:17408
    s_waitcnt lgkmcnt(4)
    ds_read_b64_tr_b16 a[24:25], v26 offset:16384
    ds_read_b64_tr_b16 a[26:27], v26 offset:17408
    ds_read_b64_tr_b16 a[28:29], v27 offset:16384
    ds_read_b64_tr_b16 a[30:31], v27 offset:17408
    s_waitcnt lgkmcnt(0)
    s_barrier
    s_add_u32 m0, s28, 16384
    s_add_u32 s37, s3, 0x300000
    buffer_load_dwordx4 v16, s[96:99], s37 offen lds
    s_add_u32 m0, s28, 17408
    s_add_u32 s37, s3, 0x308000
    buffer_load_dwordx4 v17, s[96:99], s37 offen lds
    s_add_u32 m0, s28, 18432
    s_add_u32 s37, s3, 0x310000
    buffer_load_dwordx4 v18, s[96:99], s37 offen lds
    s_add_u32 m0, s28, 19456
    s_add_u32 s37, s3, 0x318000
    buffer_load_dwordx4 v19, s[96:99], s37 offen lds
    s_add_u32 m0, s28, 20480
    s_add_u32 s37, s3, 0x320000
    buffer_load_dwordx4 v16, s[96:99], s37 offen lds
    s_add_u32 m0, s28, 21504
    s_add_u32 s37, s3, 0x328000
    buffer_load_dwordx4 v17, s[96:99], s37 offen lds
    s_add_u32 m0, s28, 22528
    s_add_u32 s37, s3, 0x330000
    buffer_load_dwordx4 v18, s[96:99], s37 offen lds
    s_add_u32 m0, s28, 23552
    s_add_u32 s37, s3, 0x338000
    buffer_load_dwordx4 v19, s[96:99], s37 offen lds
    s_waitcnt vmcnt(16)
    s_barrier
    ds_read_b64_tr_b16 a[32:33], v20 offset:0
    ds_read_b64_tr_b16 a[34:35], v20 offset:1024
    ds_read_b64_tr_b16 a[36:37], v21 offset:0
    ds_read_b64_tr_b16 a[38:39], v21 offset:1024
    ds_read_b64_tr_b16 a[40:41], v22 offset:0
    ds_read_b64_tr_b16 a[42:43], v22 offset:1024
    ds_read_b64_tr_b16 a[44:45], v23 offset:0
    ds_read_b64_tr_b16 a[46:47], v23 offset:1024
    ds_read_b64_tr_b16 a[48:49], v24 offset:0
    ds_read_b64_tr_b16 a[50:51], v24 offset:1024
    ds_read_b64_tr_b16 a[52:53], v25 offset:0
    ds_read_b64_tr_b16 a[54:55], v25 offset:1024
    s_waitcnt lgkmcnt(4)
    ds_read_b64_tr_b16 a[56:57], v26 offset:0
    ds_read_b64_tr_b16 a[58:59], v26 offset:1024
    ds_read_b64_tr_b16 a[60:61], v27 offset:0
    ds_read_b64_tr_b16 a[62:63], v27 offset:1024
    s_waitcnt lgkmcnt(0)
    s_barrier
    s_waitcnt vmcnt(8)
    s_barrier
    ds_read_b64_tr_b16 a[64:65], v20 offset:8192
    ds_read_b64_tr_b16 a[66:67], v20 offset:9216
    ds_read_b64_tr_b16 a[68:69], v21 offset:8192
    ds_read_b64_tr_b16 a[70:71], v21 offset:9216
    ds_read_b64_tr_b16 a[72:73], v22 offset:8192
    ds_read_b64_tr_b16 a[74:75], v22 offset:9216
    ds_read_b64_tr_b16 a[76:77], v23 offset:8192
    ds_read_b64_tr_b16 a[78:79], v23 offset:9216
    ds_read_b64_tr_b16 a[80:81], v24 offset:8192
    ds_read_b64_tr_b16 a[82:83], v24 offset:9216
    ds_read_b64_tr_b16 a[84:85], v25 offset:8192
    ds_read_b64_tr_b16 a[86:87], v25 offset:9216
    s_waitcnt lgkmcnt(4)
    ds_read_b64_tr_b16 a[88:89], v26 offset:8192
    ds_read_b64_tr_b16 a[90:91], v26 offset:9216
    ds_read_b64_tr_b16 a[92:93], v27 offset:8192
    ds_read_b64_tr_b16 a[94:95], v27 offset:9216
    s_waitcnt lgkmcnt(0)
    s_barrier
    s_waitcnt vmcnt(0)
    s_barrier
    ds_read_b64_tr_b16 a[96:97], v20 offset:16384
    ds_read_b64_tr_b16 a[98:99], v20 offset:17408
    ds_read_b64_tr_b16 a[100:101], v21 offset:16384
    ds_read_b64_tr_b16 a[102:103], v21 offset:17408
    ds_read_b64_tr_b16 a[104:105], v22 offset:16384
    ds_read_b64_tr_b16 a[106:107], v22 offset:17408
    ds_read_b64_tr_b16 a[108:109], v23 offset:16384
    ds_read_b64_tr_b16 a[110:111], v23 offset:17408
    ds_read_b64_tr_b16 a[112:113], v24 offset:16384
    ds_read_b64_tr_b16 a[114:115], v24 offset:17408
    ds_read_b64_tr_b16 a[116:117], v25 offset:16384
    ds_read_b64_tr_b16 a[118:119], v25 offset:17408
    s_waitcnt lgkmcnt(4)
    ds_read_b64_tr_b16 a[120:121], v26 offset:16384
    ds_read_b64_tr_b16 a[122:123], v26 offset:17408
    ds_read_b64_tr_b16 a[124:125], v27 offset:16384
    ds_read_b64_tr_b16 a[126:127], v27 offset:17408
    s_waitcnt lgkmcnt(0)
    s_barrier
    v_lshrrev_b32 v15, 2, v1
    v_and_b32 v15, 127, v15
L_WHS:
    buffer_load_dword v14, v15, s[16:19], 0 offen offset:128 sc1
    s_add_u32 s32, s32, 1
    s_cmp_gt_u32 s32, 200000
    s_cbranch_scc1 L_WHS_done
    s_waitcnt vmcnt(0)
    v_cmp_eq_u32 vcc, 0, v14
    s_cbranch_vccnz L_WHS
L_WHS_done:
    s_lshr_b32 s36, s21, 1
    s_lshl_b32 s36, s36, 14
    s_xor_b32 s37, s36, 16384
    v_add_u32 v80, s36, v5
    v_add_u32 v81, s37, v5
    v_add_u32 v82, s36, v6
    v_add_u32 v83, s37, v6
    s_mov_b32 s25, 0x40000000
L_P1:
    s_waitcnt vmcnt(6)
    v_mov_b32 v16, 0
    v_mov_b32 v17, 0
    v_dot2_f32_bf16 v16, v96, s4, v16
    v_dot2_f32_bf16 v17, v96, v96, v17
    v_dot2_f32_bf16 v16, v97, s4, v16
    v_dot2_f32_bf16 v17, v97, v97, v17
    v_dot2_f32_bf16 v16, v98, s4, v16
    v_dot2_f32_bf16 v17, v98, v98, v17
    v_dot2_f32_bf16 v16, v99, s4, v16
    v_dot2_f32_bf16 v17, v99, v99, v17
    v_dot2_f32_bf16 v16, v100, s4, v16
    v_dot2_f32_bf16 v17, v100, v100, v17
    v_dot2_f32_bf16 v16, v101, s4, v16
    v_dot2_f32_bf16 v17, v101, v101, v17
    v_dot2_f32_bf16 v16, v102, s4, v16
    v_dot2_f32_bf16 v17, v102, v102, v17
    v_dot2_f32_bf16 v16, v103, s4, v16
    v_dot2_f32_bf16 v17, v103, v103, v17
    v_dot2_f32_bf16 v16, v104, s4, v16
    v_dot2_f32_bf16 v17, v104, v104, v17
    v_dot2_f32_bf16 v16, v105, s4, v16
    v_dot2_f32_bf16 v17, v105, v105, v17
    v_dot2_f32_bf16 v16, v106, s4, v16
    v_dot2_f32_bf16 v17, v106, v106, v17
    v_dot2_f32_bf16 v16, v107, s4, v16
    v_dot2_f32_bf16 v17, v107, v107, v17
    v_dot2_f32_bf16 v16, v108, s4, v16
    v_dot2_f32_bf16 v17, v108, v108, v17
    v_dot2_f32_bf16 v16, v109, s4, v16
    v_dot2_f32_bf16 v17, v109, v109, v17
    v_dot2_f32_bf16 v16, v110, s4, v16
    v_dot2_f32_bf16 v17, v110, v110, v17
    v_dot2_f32_bf16 v16, v111, s4, v16
    v_dot2_f32_bf16 v17, v111, v111, v17
    v_dot2_f32_bf16 v16, v112, s4, v16
    v_dot2_f32_bf16 v17, v112, v112, v17
    v_dot2_f32_bf16 v16, v113, s4, v16
    v_dot2_f32_bf16 v17, v113, v113, v17
    v_dot2_f32_bf16 v16, v114, s4, v16
    v_dot2_f32_bf16 v17, v114, v114, v17
    v_dot2_f32_bf16 v16, v115, s4, v16
    v_dot2_f32_bf16 v17, v115, v115, v17
    v_dot2_f32_bf16 v16, v116, s4, v16
    v_dot2_f32_bf16 v17, v116, v116, v17
    v_dot2_f32_bf16 v16, v117, s4, v16
    v_dot2_f32_bf16 v17, v117, v117, v17
    v_dot2_f32_bf16 v16, v118, s4, v16
    v_dot2_f32_bf16 v17, v118, v118, v17
    v_dot2_f32_bf16 v16, v119, s4, v16
    v_dot2_f32_bf16 v17, v119, v119, v17
    v_dot2_f32_bf16 v16, v120, s4, v16
    v_dot2_f32_bf16 v17, v120, v120, v17
    v_dot2_f32_bf16 v16, v121, s4, v16
    v_dot2_f32_bf16 v17, v121, v121, v17
    v_dot2_f32_bf16 v16, v122, s4, v16
    v_dot2_f32_bf16 v17, v122, v122, v17
    v_dot2_f32_bf16 v16, v123, s4, v16
    v_dot2_f32_bf16 v17, v123, v123, v17
    v_dot2_f32_bf16 v16, v124, s4, v16
    v_dot2_f32_bf16 v17, v124, v124, v17
    v_dot2_f32_bf16 v16, v125, s4, v16
    v_dot2_f32_bf16 v17, v125, v125, v17
    v_dot2_f32_bf16 v16, v126, s4, v16
    v_dot2_f32_bf16 v17, v126, v126, v17
    v_dot2_f32_bf16 v16, v127, s4, v16
    v_dot2_f32_bf16 v17, v127, v127, v17
    s_nop 3
    v_add_f32_dpp v16, v16, v16 quad_perm:[1,0,3,2] row_mask:0xf bank_mask:0xf
    v_add_f32_dpp v17, v17, v17 quad_perm:[1,0,3,2] row_mask:0xf bank_mask:0xf
    s_nop 0
    v_add_f32_dpp v16, v16, v16 quad_perm:[2,3,0,1] row_mask:0xf bank_mask:0xf
    v_add_f32_dpp v17, v17, v17 quad_perm:[2,3,0,1] row_mask:0xf bank_mask:0xf
    s_nop 0
    v_add_f32_dpp v16, v16, v16 row_half_mirror row_mask:0xf bank_mask:0xf
    v_add_f32_dpp v17, v17, v17 row_half_mirror row_mask:0xf bank_mask:0xf
    v_mul_f32 v16, 0x3b000000, v16
    v_mul_f32 v17, 0x3b000000, v17
    v_fma_f32 v17, -v16, v16, v17
    v_max_f32 v17, 0, v17
    v_cvt_pk_bf16_f32 v14, v16, v17
    v_lshlrev_b32 v16, 16, v14
    v_and_b32 v17, 0xffff0000, v14
    v_add_f32 v17, 0x3727c5ac, v17
    v_cvt_pk_bf16_f32 v14, v17, v17
    v_lshlrev_b32 v17, 16, v14
    v_sqrt_f32 v17, v17
    s_nop 0
    v_cvt_pk_bf16_f32 v14, v17, v17
    v_lshlrev_b32 v17, 16, v14
    v_rcp_f32 v17, v17
    v_lshlrev_b32 v18, 16, v96
    v_and_b32 v19, 0xffff0000, v96
    v_sub_f32 v18, v18, v16
    v_sub_f32 v19, v19, v16
    v_cvt_pk_bf16_f32 v96, v18, v19
    v_lshlrev_b32 v18, 16, v96
    v_and_b32 v19, 0xffff0000, v96
    v_mul_f32 v18, v18, v17
    v_mul_f32 v19, v19, v17
    v_cvt_pk_bf16_f32 v96, v18, v19
    v_lshlrev_b32 v18, 16, v97
    v_and_b32 v19, 0xffff0000, v97
    v_sub_f32 v18, v18, v16
    v_sub_f32 v19, v19, v16
    v_cvt_pk_bf16_f32 v97, v18, v19
    v_lshlrev_b32 v18, 16, v97
    v_and_b32 v19, 0xffff0000, v97
    v_mul_f32 v18, v18, v17
    v_mul_f32 v19, v19, v17
    v_cvt_pk_bf16_f32 v97, v18, v19
    v_lshlrev_b32 v18, 16, v98
    v_and_b32 v19, 0xffff0000, v98
    v_sub_f32 v18, v18, v16
    v_sub_f32 v19, v19, v16
    v_cvt_pk_bf16_f32 v98, v18, v19
    v_lshlrev_b32 v18, 16, v98
    v_and_b32 v19, 0xffff0000, v98
    v_mul_f32 v18, v18, v17
    v_mul_f32 v19, v19, v17
    v_cvt_pk_bf16_f32 v98, v18, v19
    v_lshlrev_b32 v18, 16, v99
    v_and_b32 v19, 0xffff0000, v99
    v_sub_f32 v18, v18, v16
    v_sub_f32 v19, v19, v16
    v_cvt_pk_bf16_f32 v99, v18, v19
    v_lshlrev_b32 v18, 16, v99
    v_and_b32 v19, 0xffff0000, v99
    v_mul_f32 v18, v18, v17
    v_mul_f32 v19, v19, v17
    v_cvt_pk_bf16_f32 v99, v18, v19
    ds_write_b128 v4, v[96:99] offset:0
    v_lshlrev_b32 v18, 16, v100
    v_and_b32 v19, 0xffff0000, v100
    v_sub_f32 v18, v18, v16
    v_sub_f32 v19, v19, v16
    v_cvt_pk_bf16_f32 v100, v18, v19
    v_lshlrev_b32 v18, 16, v100
    v_and_b32 v19, 0xffff0000, v100
    v_mul_f32 v18, v18, v17
    v_mul_f32 v19, v19, v17
    v_cvt_pk_bf16_f32 v100, v18, v19
    v_lshlrev_b32 v18, 16, v101
    v_and_b32 v19, 0xffff0000, v101
    v_sub_f32 v18, v18, v16
    v_sub_f32 v19, v19, v16
    v_cvt_pk_bf16_f32 v101, v18, v19
    v_lshlrev_b32 v18, 16, v101
    v_and_b32 v19, 0xffff0000, v101
    v_mul_f32 v18, v18, v17
    v_mul_f32 v19, v19, v17
    v_cvt_pk_bf16_f32 v101, v18, v19
    v_lshlrev_b32 v18, 16, v102
    v_and_b32 v19, 0xffff0000, v102
    v_sub_f32 v18, v18, v16
    v_sub_f32 v19, v19, v16
    v_cvt_pk_bf16_f32 v102, v18, v19
    v_lshlrev_b32 v18, 16, v102
    v_and_b32 v19, 0xffff0000, v102
    v_mul_f32 v18, v18, v17
    v_mul_f32 v19, v19, v17
    v_cvt_pk_bf16_f32 v102, v18, v19
    v_lshlrev_b32 v18, 16, v103
    v_and_b32 v19, 0xffff0000, v103
    v_sub_f32 v18, v18, v16
    v_sub_f32 v19, v19, v16
    v_cvt_pk_bf16_f32 v103, v18, v19
    v_lshlrev_b32 v18, 16, v103
    v_and_b32 v19, 0xffff0000, v103
    v_mul_f32 v18, v18, v17
    v_mul_f32 v19, v19, v17
    v_cvt_pk_bf16_f32 v103, v18, v19
    ds_write_b128 v4, v[100:103] offset:2048
    v_lshlrev_b32 v18, 16, v104
    v_and_b32 v19, 0xffff0000, v104
    v_sub_f32 v18, v18, v16
    v_sub_f32 v19, v19, v16
    v_cvt_pk_bf16_f32 v104, v18, v19
    v_lshlrev_b32 v18, 16, v104
    v_and_b32 v19, 0xffff0000, v104
    v_mul_f32 v18, v18, v17
    v_mul_f32 v19, v19, v17
    v_cvt_pk_bf16_f32 v104, v18, v19
    v_lshlrev_b32 v18, 16, v105
    v_and_b32 v19, 0xffff0000, v105
    v_sub_f32 v18, v18, v16
    v_sub_f32 v19, v19, v16
    v_cvt_pk_bf16_f32 v105, v18, v19
    v_lshlrev_b32 v18, 16, v105
    v_and_b32 v19, 0xffff0000, v105
    v_mul_f32 v18, v18, v17
    v_mul_f32 v19, v19, v17
    v_cvt_pk_bf16_f32 v105, v18, v19
    v_lshlrev_b32 v18, 16, v106
    v_and_b32 v19, 0xffff0000, v106
    v_sub_f32 v18, v18, v16
    v_sub_f32 v19, v19, v16
    v_cvt_pk_bf16_f32 v106, v18, v19
    v_lshlrev_b32 v18, 16, v106
    v_and_b32 v19, 0xffff0000, v106
    v_mul_f32 v18, v18, v17
    v_mul_f32 v19, v19, v17
    v_cvt_pk_bf16_f32 v106, v18, v19
    v_lshlrev_b32 v18, 16, v107
    v_and_b32 v19, 0xffff0000, v107
    v_sub_f32 v18, v18, v16
    v_sub_f32 v19, v19, v16
    v_cvt_pk_bf16_f32 v107, v18, v19
    v_lshlrev_b32 v18, 16, v107
    v_and_b32 v19, 0xffff0000, v107
    v_mul_f32 v18, v18, v17
    v_mul_f32 v19, v19, v17
    v_cvt_pk_bf16_f32 v107, v18, v19
    ds_write_b128 v4, v[104:107] offset:4096
    v_lshlrev_b32 v18, 16, v108
    v_and_b32 v19, 0xffff0000, v108
    v_sub_f32 v18, v18, v16
    v_sub_f32 v19, v19, v16
    v_cvt_pk_bf16_f32 v108, v18, v19
    v_lshlrev_b32 v18, 16, v108
    v_and_b32 v19, 0xffff0000, v108
    v_mul_f32 v18, v18, v17
    v_mul_f32 v19, v19, v17
    v_cvt_pk_bf16_f32 v108, v18, v19
    v_lshlrev_b32 v18, 16, v109
    v_and_b32 v19, 0xffff0000, v109
    v_sub_f32 v18, v18, v16
    v_sub_f32 v19, v19, v16
    v_cvt_pk_bf16_f32 v109, v18, v19
    v_lshlrev_b32 v18, 16, v109
    v_and_b32 v19, 0xffff0000, v109
    v_mul_f32 v18, v18, v17
    v_mul_f32 v19, v19, v17
    v_cvt_pk_bf16_f32 v109, v18, v19
    v_lshlrev_b32 v18, 16, v110
    v_and_b32 v19, 0xffff0000, v110
    v_sub_f32 v18, v18, v16
    v_sub_f32 v19, v19, v16
    v_cvt_pk_bf16_f32 v110, v18, v19
    v_lshlrev_b32 v18, 16, v110
    v_and_b32 v19, 0xffff0000, v110
    v_mul_f32 v18, v18, v17
    v_mul_f32 v19, v19, v17
    v_cvt_pk_bf16_f32 v110, v18, v19
    v_lshlrev_b32 v18, 16, v111
    v_and_b32 v19, 0xffff0000, v111
    v_sub_f32 v18, v18, v16
    v_sub_f32 v19, v19, v16
    v_cvt_pk_bf16_f32 v111, v18, v19
    v_lshlrev_b32 v18, 16, v111
    v_and_b32 v19, 0xffff0000, v111
    v_mul_f32 v18, v18, v17
    v_mul_f32 v19, v19, v17
    v_cvt_pk_bf16_f32 v111, v18, v19
    ds_write_b128 v4, v[108:111] offset:6144
    v_lshlrev_b32 v18, 16, v112
    v_and_b32 v19, 0xffff0000, v112
    v_sub_f32 v18, v18, v16
    v_sub_f32 v19, v19, v16
    v_cvt_pk_bf16_f32 v112, v18, v19
    v_lshlrev_b32 v18, 16, v112
    v_and_b32 v19, 0xffff0000, v112
    v_mul_f32 v18, v18, v17
    v_mul_f32 v19, v19, v17
    v_cvt_pk_bf16_f32 v112, v18, v19
    v_lshlrev_b32 v18, 16, v113
    v_and_b32 v19, 0xffff0000, v113
    v_sub_f32 v18, v18, v16
    v_sub_f32 v19, v19, v16
    v_cvt_pk_bf16_f32 v113, v18, v19
    v_lshlrev_b32 v18, 16, v113
    v_and_b32 v19, 0xffff0000, v113
    v_mul_f32 v18, v18, v17
    v_mul_f32 v19, v19, v17
    v_cvt_pk_bf16_f32 v113, v18, v19
    v_lshlrev_b32 v18, 16, v114
    v_and_b32 v19, 0xffff0000, v114
    v_sub_f32 v18, v18, v16
    v_sub_f32 v19, v19, v16
    v_cvt_pk_bf16_f32 v114, v18, v19
    v_lshlrev_b32 v18, 16, v114
    v_and_b32 v19, 0xffff0000, v114
    v_mul_f32 v18, v18, v17
    v_mul_f32 v19, v19, v17
    v_cvt_pk_bf16_f32 v114, v18, v19
    v_lshlrev_b32 v18, 16, v115
    v_and_b32 v19, 0xffff0000, v115
    v_sub_f32 v18, v18, v16
    v_sub_f32 v19, v19, v16
    v_cvt_pk_bf16_f32 v115, v18, v19
    v_lshlrev_b32 v18, 16, v115
    v_and_b32 v19, 0xffff0000, v115
    v_mul_f32 v18, v18, v17
    v_mul_f32 v19, v19, v17
    v_cvt_pk_bf16_f32 v115, v18, v19
    ds_write_b128 v4, v[112:115] offset:8192
    v_lshlrev_b32 v18, 16, v116
    v_and_b32 v19, 0xffff0000, v116
    v_sub_f32 v18, v18, v16
    v_sub_f32 v19, v19, v16
    v_cvt_pk_bf16_f32 v116, v18, v19
    v_lshlrev_b32 v18, 16, v116
    v_and_b32 v19, 0xffff0000, v116
    v_mul_f32 v18, v18, v17
    v_mul_f32 v19, v19, v17
    v_cvt_pk_bf16_f32 v116, v18, v19
    v_lshlrev_b32 v18, 16, v117
    v_and_b32 v19, 0xffff0000, v117
    v_sub_f32 v18, v18, v16
    v_sub_f32 v19, v19, v16
    v_cvt_pk_bf16_f32 v117, v18, v19
    v_lshlrev_b32 v18, 16, v117
    v_and_b32 v19, 0xffff0000, v117
    v_mul_f32 v18, v18, v17
    v_mul_f32 v19, v19, v17
    v_cvt_pk_bf16_f32 v117, v18, v19
    v_lshlrev_b32 v18, 16, v118
    v_and_b32 v19, 0xffff0000, v118
    v_sub_f32 v18, v18, v16
    v_sub_f32 v19, v19, v16
    v_cvt_pk_bf16_f32 v118, v18, v19
    v_lshlrev_b32 v18, 16, v118
    v_and_b32 v19, 0xffff0000, v118
    v_mul_f32 v18, v18, v17
    v_mul_f32 v19, v19, v17
    v_cvt_pk_bf16_f32 v118, v18, v19
    v_lshlrev_b32 v18, 16, v119
    v_and_b32 v19, 0xffff0000, v119
    v_sub_f32 v18, v18, v16
    v_sub_f32 v19, v19, v16
    v_cvt_pk_bf16_f32 v119, v18, v19
    v_lshlrev_b32 v18, 16, v119
    v_and_b32 v19, 0xffff0000, v119
    v_mul_f32 v18, v18, v17
    v_mul_f32 v19, v19, v17
    v_cvt_pk_bf16_f32 v119, v18, v19
    ds_write_b128 v4, v[116:119] offset:10240
    v_lshlrev_b32 v18, 16, v120
    v_and_b32 v19, 0xffff0000, v120
    v_sub_f32 v18, v18, v16
    v_sub_f32 v19, v19, v16
    v_cvt_pk_bf16_f32 v120, v18, v19
    v_lshlrev_b32 v18, 16, v120
    v_and_b32 v19, 0xffff0000, v120
    v_mul_f32 v18, v18, v17
    v_mul_f32 v19, v19, v17
    v_cvt_pk_bf16_f32 v120, v18, v19
    v_lshlrev_b32 v18, 16, v121
    v_and_b32 v19, 0xffff0000, v121
    v_sub_f32 v18, v18, v16
    v_sub_f32 v19, v19, v16
    v_cvt_pk_bf16_f32 v121, v18, v19
    v_lshlrev_b32 v18, 16, v121
    v_and_b32 v19, 0xffff0000, v121
    v_mul_f32 v18, v18, v17
    v_mul_f32 v19, v19, v17
    v_cvt_pk_bf16_f32 v121, v18, v19
    v_lshlrev_b32 v18, 16, v122
    v_and_b32 v19, 0xffff0000, v122
    v_sub_f32 v18, v18, v16
    v_sub_f32 v19, v19, v16
    v_cvt_pk_bf16_f32 v122, v18, v19
    v_lshlrev_b32 v18, 16, v122
    v_and_b32 v19, 0xffff0000, v122
    v_mul_f32 v18, v18, v17
    v_mul_f32 v19, v19, v17
    v_cvt_pk_bf16_f32 v122, v18, v19
    v_lshlrev_b32 v18, 16, v123
    v_and_b32 v19, 0xffff0000, v123
    v_sub_f32 v18, v18, v16
    v_sub_f32 v19, v19, v16
    v_cvt_pk_bf16_f32 v123, v18, v19
    v_lshlrev_b32 v18, 16, v123
    v_and_b32 v19, 0xffff0000, v123
    v_mul_f32 v18, v18, v17
    v_mul_f32 v19, v19, v17
    v_cvt_pk_bf16_f32 v123, v18, v19
    ds_write_b128 v4, v[120:123] offset:12288
    v_lshlrev_b32 v18, 16, v124
    v_and_b32 v19, 0xffff0000, v124
    v_sub_f32 v18, v18, v16
    v_sub_f32 v19, v19, v16
    v_cvt_pk_bf16_f32 v124, v18, v19
    v_lshlrev_b32 v18, 16, v124
    v_and_b32 v19, 0xffff0000, v124
    v_mul_f32 v18, v18, v17
    v_mul_f32 v19, v19, v17
    v_cvt_pk_bf16_f32 v124, v18, v19
    v_lshlrev_b32 v18, 16, v125
    v_and_b32 v19, 0xffff0000, v125
    v_sub_f32 v18, v18, v16
    v_sub_f32 v19, v19, v16
    v_cvt_pk_bf16_f32 v125, v18, v19
    v_lshlrev_b32 v18, 16, v125
    v_and_b32 v19, 0xffff0000, v125
    v_mul_f32 v18, v18, v17
    v_mul_f32 v19, v19, v17
    v_cvt_pk_bf16_f32 v125, v18, v19
    v_lshlrev_b32 v18, 16, v126
    v_and_b32 v19, 0xffff0000, v126
    v_sub_f32 v18, v18, v16
    v_sub_f32 v19, v19, v16
    v_cvt_pk_bf16_f32 v126, v18, v19
    v_lshlrev_b32 v18, 16, v126
    v_and_b32 v19, 0xffff0000, v126
    v_mul_f32 v18, v18, v17
    v_mul_f32 v19, v19, v17
    v_cvt_pk_bf16_f32 v126, v18, v19
    v_lshlrev_b32 v18, 16, v127
    v_and_b32 v19, 0xffff0000, v127
    v_sub_f32 v18, v18, v16
    v_sub_f32 v19, v19, v16
    v_cvt_pk_bf16_f32 v127, v18, v19
    v_lshlrev_b32 v18, 16, v127
    v_and_b32 v19, 0xffff0000, v127
    v_mul_f32 v18, v18, v17
    v_mul_f32 v19, v19, v17
    v_cvt_pk_bf16_f32 v127, v18, v19
    ds_write_b128 v4, v[124:127] offset:14336
    s_waitcnt vmcnt(0) lgkmcnt(0)
    s_barrier
    v_cmp_ne_u32 vcc, 0, v0
    v_mov_b32 v15, 0x40000000
    v_mov_b32 v14, 1
    v_cndmask_b32 v15, v0, v15, vcc
    buffer_store_dword v14, v15, s[8:11], s25 offen sc1
    s_add_u32 s24, s23, 6
    s_min_u32 s24, s24, 63
    s_lshl_b32 s36, s24, 15
    buffer_load_dwordx4 v[96:99], v3, s[12:15], s36 offen offset:0
    buffer_load_dwordx4 v[100:103], v3, s[12:15], s36 offen offset:128
    buffer_load_dwordx4 v[104:107], v3, s[12:15], s36 offen offset:256
    buffer_load_dwordx4 v[108:111], v3, s[12:15], s36 offen offset:384
    buffer_load_dwordx4 v[112:115], v3, s[12:15], s36 offen offset:512
    buffer_load_dwordx4 v[116:119], v3, s[12:15], s36 offen offset:640
    buffer_load_dwordx4 v[120:123], v3, s[12:15], s36 offen offset:768
    buffer_load_dwordx4 v[124:127], v3, s[12:15], s36 offen offset:896
    ds_read_b128 v[64:67], v80 offset:0
    ds_read_b128 v[68:71], v81 offset:0
    ds_read_b128 v[72:75], v82 offset:1024
    ds_read_b128 v[76:79], v83 offset:1024
    s_waitcnt lgkmcnt(2)
    v_mfma_f32_16x16x32_bf16 v[32:35], a[128:131], v[64:67], 0
    v_mfma_f32_16x16x32_bf16 v[36:39], a[128:131], v[68:71], 0
    v_mfma_f32_16x16x32_bf16 v[40:43], a[132:135], v[64:67], 0
    v_mfma_f32_16x16x32_bf16 v[44:47], a[132:135], v[68:71], 0
    v_mfma_f32_16x16x32_bf16 v[48:51], v[64:67], v[128:131], 0
    v_mfma_f32_16x16x32_bf16 v[56:59], v[68:71], v[128:131], 0
    v_mfma_f32_16x16x32_bf16 v[52:55], v[64:67], v[132:135], 0
    v_mfma_f32_16x16x32_bf16 v[60:63], v[68:71], v[132:135], 0
    v_mfma_f32_16x16x32_bf16 v[16:19], a[0:3], v[64:67], 0
    v_mfma_f32_16x16x32_bf16 v[20:23], a[0:3], v[68:71], 0
    v_mfma_f32_16x16x32_bf16 v[24:27], a[4:7], v[64:67], 0
    v_mfma_f32_16x16x32_bf16 v[28:31], a[4:7], v[68:71], 0
    ds_read_b128 v[64:67], v80 offset:2048
    ds_read_b128 v[68:71], v81 offset:2048
    s_waitcnt lgkmcnt(2)
    v_mfma_f32_16x16x32_bf16 v[32:35], a[136:139], v[72:75], v[32:35]
    v_mfma_f32_16x16x32_bf16 v[36:39], a[136:139], v[76:79], v[36:39]
    v_mfma_f32_16x16x32_bf16 v[40:43], a[140:143], v[72:75], v[40:43]
    v_mfma_f32_16x16x32_bf16 v[44:47], a[140:143], v[76:79], v[44:47]
    v_mfma_f32_16x16x32_bf16 v[48:51], v[72:75], v[136:139], v[48:51]
    v_mfma_f32_16x16x32_bf16 v[56:59], v[76:79], v[136:139], v[56:59]
    v_mfma_f32_16x16x32_bf16 v[52:55], v[72:75], v[140:143], v[52:55]
    v_mfma_f32_16x16x32_bf16 v[60:63], v[76:79], v[140:143], v[60:63]
    v_mfma_f32_16x16x32_bf16 v[16:19], a[8:11], v[72:75], v[16:19]
    v_mfma_f32_16x16x32_bf16 v[20:23], a[8:11], v[76:79], v[20:23]
    v_mfma_f32_16x16x32_bf16 v[24:27], a[12:15], v[72:75], v[24:27]
    v_mfma_f32_16x16x32_bf16 v[28:31], a[12:15], v[76:79], v[28:31]
    ds_read_b128 v[72:75], v82 offset:3072
    ds_read_b128 v[76:79], v83 offset:3072
    s_waitcnt lgkmcnt(2)
    v_mfma_f32_16x16x32_bf16 v[32:35], a[144:147], v[64:67], v[32:35]
    v_mfma_f32_16x16x32_bf16 v[36:39], a[144:147], v[68:71], v[36:39]
    v_mfma_f32_16x16x32_bf16 v[40:43], a[148:151], v[64:67], v[40:43]
    v_mfma_f32_16x16x32_bf16 v[44:47], a[148:151], v[68:71], v[44:47]
    v_mfma_f32_16x16x32_bf16 v[48:51], v[64:67], v[144:147], v[48:51]
    v_mfma_f32_16x16x32_bf16 v[56:59], v[68:71], v[144:147], v[56:59]
    v_mfma_f32_16x16x32_bf16 v[52:55], v[64:67], v[148:151], v[52:55]
    v_mfma_f32_16x16x32_bf16 v[60:63], v[68:71], v[148:151], v[60:63]
    v_mfma_f32_16x16x32_bf16 v[16:19], a[16:19], v[64:67], v[16:19]
    v_mfma_f32_16x16x32_bf16 v[20:23], a[16:19], v[68:71], v[20:23]
    v_mfma_f32_16x16x32_bf16 v[24:27], a[20:23], v[64:67], v[24:27]
    v_mfma_f32_16x16x32_bf16 v[28:31], a[20:23], v[68:71], v[28:31]
    ds_read_b128 v[64:67], v80 offset:4096
    ds_read_b128 v[68:71], v81 offset:4096
    s_waitcnt lgkmcnt(2)
    v_mfma_f32_16x16x32_bf16 v[32:35], a[152:155], v[72:75], v[32:35]
    v_mfma_f32_16x16x32_bf16 v[36:39], a[152:155], v[76:79], v[36:39]
    v_mfma_f32_16x16x32_bf16 v[40:43], a[156:159], v[72:75], v[40:43]
    v_mfma_f32_16x16x32_bf16 v[44:47], a[156:159], v[76:79], v[44:47]
    v_mfma_f32_16x16x32_bf16 v[48:51], v[72:75], v[152:155], v[48:51]
    v_mfma_f32_16x16x32_bf16 v[56:59], v[76:79], v[152:155], v[56:59]
    v_mfma_f32_16x16x32_bf16 v[52:55], v[72:75], v[156:159], v[52:55]
    v_mfma_f32_16x16x32_bf16 v[60:63], v[76:79], v[156:159], v[60:63]
    v_mfma_f32_16x16x32_bf16 v[16:19], a[24:27], v[72:75], v[16:19]
    v_mfma_f32_16x16x32_bf16 v[20:23], a[24:27], v[76:79], v[20:23]
    v_mfma_f32_16x16x32_bf16 v[24:27], a[28:31], v[72:75], v[24:27]
    v_mfma_f32_16x16x32_bf16 v[28:31], a[28:31], v[76:79], v[28:31]
    ds_read_b128 v[72:75], v82 offset:5120
    ds_read_b128 v[76:79], v83 offset:5120
    s_waitcnt lgkmcnt(2)
    v_mfma_f32_16x16x32_bf16 v[32:35], a[160:163], v[64:67], v[32:35]
    v_mfma_f32_16x16x32_bf16 v[36:39], a[160:163], v[68:71], v[36:39]
    v_mfma_f32_16x16x32_bf16 v[40:43], a[164:167], v[64:67], v[40:43]
    v_mfma_f32_16x16x32_bf16 v[44:47], a[164:167], v[68:71], v[44:47]
    v_mfma_f32_16x16x32_bf16 v[48:51], v[64:67], v[160:163], v[48:51]
    v_mfma_f32_16x16x32_bf16 v[56:59], v[68:71], v[160:163], v[56:59]
    v_mfma_f32_16x16x32_bf16 v[52:55], v[64:67], v[164:167], v[52:55]
    v_mfma_f32_16x16x32_bf16 v[60:63], v[68:71], v[164:167], v[60:63]
    v_mfma_f32_16x16x32_bf16 v[16:19], a[32:35], v[64:67], v[16:19]
    v_mfma_f32_16x16x32_bf16 v[20:23], a[32:35], v[68:71], v[20:23]
    v_mfma_f32_16x16x32_bf16 v[24:27], a[36:39], v[64:67], v[24:27]
    v_mfma_f32_16x16x32_bf16 v[28:31], a[36:39], v[68:71], v[28:31]
    ds_read_b128 v[64:67], v80 offset:6144
    ds_read_b128 v[68:71], v81 offset:6144
    s_waitcnt lgkmcnt(2)
    v_mfma_f32_16x16x32_bf16 v[32:35], a[168:171], v[72:75], v[32:35]
    v_mfma_f32_16x16x32_bf16 v[36:39], a[168:171], v[76:79], v[36:39]
    v_mfma_f32_16x16x32_bf16 v[40:43], a[172:175], v[72:75], v[40:43]
    v_mfma_f32_16x16x32_bf16 v[44:47], a[172:175], v[76:79], v[44:47]
    v_mfma_f32_16x16x32_bf16 v[48:51], v[72:75], v[168:171], v[48:51]
    v_mfma_f32_16x16x32_bf16 v[56:59], v[76:79], v[168:171], v[56:59]
    v_mfma_f32_16x16x32_bf16 v[52:55], v[72:75], v[172:175], v[52:55]
    v_mfma_f32_16x16x32_bf16 v[60:63], v[76:79], v[172:175], v[60:63]
    v_mfma_f32_16x16x32_bf16 v[16:19], a[40:43], v[72:75], v[16:19]
    v_mfma_f32_16x16x32_bf16 v[20:23], a[40:43], v[76:79], v[20:23]
    v_mfma_f32_16x16x32_bf16 v[24:27], a[44:47], v[72:75], v[24:27]
    v_mfma_f32_16x16x32_bf16 v[28:31], a[44:47], v[76:79], v[28:31]
    ds_read_b128 v[72:75], v82 offset:7168
    ds_read_b128 v[76:79], v83 offset:7168
    s_waitcnt lgkmcnt(2)
    v_mfma_f32_16x16x32_bf16 v[32:35], a[176:179], v[64:67], v[32:35]
    v_mfma_f32_16x16x32_bf16 v[36:39], a[176:179], v[68:71], v[36:39]
    v_mfma_f32_16x16x32_bf16 v[40:43], a[180:183], v[64:67], v[40:43]
    v_mfma_f32_16x16x32_bf16 v[44:47], a[180:183], v[68:71], v[44:47]
    v_mfma_f32_16x16x32_bf16 v[48:51], v[64:67], v[176:179], v[48:51]
    v_mfma_f32_16x16x32_bf16 v[56:59], v[68:71], v[176:179], v[56:59]
    v_mfma_f32_16x16x32_bf16 v[52:55], v[64:67], v[180:183], v[52:55]
    v_mfma_f32_16x16x32_bf16 v[60:63], v[68:71], v[180:183], v[60:63]
    v_mfma_f32_16x16x32_bf16 v[16:19], a[48:51], v[64:67], v[16:19]
    v_mfma_f32_16x16x32_bf16 v[20:23], a[48:51], v[68:71], v[20:23]
    v_mfma_f32_16x16x32_bf16 v[24:27], a[52:55], v[64:67], v[24:27]
    v_mfma_f32_16x16x32_bf16 v[28:31], a[52:55], v[68:71], v[28:31]
    ds_read_b128 v[64:67], v80 offset:8192
    ds_read_b128 v[68:71], v81 offset:8192
    s_waitcnt lgkmcnt(2)
    v_mfma_f32_16x16x32_bf16 v[32:35], a[184:187], v[72:75], v[32:35]
    v_mfma_f32_16x16x32_bf16 v[36:39], a[184:187], v[76:79], v[36:39]
    v_mfma_f32_16x16x32_bf16 v[40:43], a[188:191], v[72:75], v[40:43]
    v_mfma_f32_16x16x32_bf16 v[44:47], a[188:191], v[76:79], v[44:47]
    v_mfma_f32_16x16x32_bf16 v[48:51], v[72:75], v[184:187], v[48:51]
    v_mfma_f32_16x16x32_bf16 v[56:59], v[76:79], v[184:187], v[56:59]
    v_mfma_f32_16x16x32_bf16 v[52:55], v[72:75], v[188:191], v[52:55]
    v_mfma_f32_16x16x32_bf16 v[60:63], v[76:79], v[188:191], v[60:63]
    v_mfma_f32_16x16x32_bf16 v[16:19], a[56:59], v[72:75], v[16:19]
    v_mfma_f32_16x16x32_bf16 v[20:23], a[56:59], v[76:79], v[20:23]
    v_mfma_f32_16x16x32_bf16 v[24:27], a[60:63], v[72:75], v[24:27]
    v_mfma_f32_16x16x32_bf16 v[28:31], a[60:63], v[76:79], v[28:31]
    ds_read_b128 v[72:75], v82 offset:9216
    ds_read_b128 v[76:79], v83 offset:9216
    s_waitcnt lgkmcnt(2)
    v_mfma_f32_16x16x32_bf16 v[32:35], a[192:195], v[64:67], v[32:35]
    v_mfma_f32_16x16x32_bf16 v[36:39], a[192:195], v[68:71], v[36:39]
    v_mfma_f32_16x16x32_bf16 v[40:43], a[196:199], v[64:67], v[40:43]
    v_mfma_f32_16x16x32_bf16 v[44:47], a[196:199], v[68:71], v[44:47]
    v_mfma_f32_16x16x32_bf16 v[48:51], v[64:67], v[192:195], v[48:51]
    v_mfma_f32_16x16x32_bf16 v[56:59], v[68:71], v[192:195], v[56:59]
    v_mfma_f32_16x16x32_bf16 v[52:55], v[64:67], v[196:199], v[52:55]
    v_mfma_f32_16x16x32_bf16 v[60:63], v[68:71], v[196:199], v[60:63]
    v_mfma_f32_16x16x32_bf16 v[16:19], a[64:67], v[64:67], v[16:19]
    v_mfma_f32_16x16x32_bf16 v[20:23], a[64:67], v[68:71], v[20:23]
    v_mfma_f32_16x16x32_bf16 v[24:27], a[68:71], v[64:67], v[24:27]
    v_mfma_f32_16x16x32_bf16 v[28:31], a[68:71], v[68:71], v[28:31]
    ds_read_b128 v[64:67], v80 offset:10240
    ds_read_b128 v[68:71], v81 offset:10240
    s_waitcnt lgkmcnt(2)
    v_mfma_f32_16x16x32_bf16 v[32:35], a[200:203], v[72:75], v[32:35]
    v_mfma_f32_16x16x32_bf16 v[36:39], a[200:203], v[76:79], v[36:39]
    v_mfma_f32_16x16x32_bf16 v[40:43], a[204:207], v[72:75], v[40:43]
    v_mfma_f32_16x16x32_bf16 v[44:47], a[204:207], v[76:79], v[44:47]
    v_mfma_f32_16x16x32_bf16 v[48:51], v[72:75], v[200:203], v[48:51]
    v_mfma_f32_16x16x32_bf16 v[56:59], v[76:79], v[200:203], v[56:59]
    v_mfma_f32_16x16x32_bf16 v[52:55], v[72:75], v[204:207], v[52:55]
    v_mfma_f32_16x16x32_bf16 v[60:63], v[76:79], v[204:207], v[60:63]
    v_mfma_f32_16x16x32_bf16 v[16:19], a[72:75], v[72:75], v[16:19]
    v_mfma_f32_16x16x32_bf16 v[20:23], a[72:75], v[76:79], v[20:23]
    v_mfma_f32_16x16x32_bf16 v[24:27], a[76:79], v[72:75], v[24:27]
    v_mfma_f32_16x16x32_bf16 v[28:31], a[76:79], v[76:79], v[28:31]
    ds_read_b128 v[72:75], v82 offset:11264
    ds_read_b128 v[76:79], v83 offset:11264
    s_waitcnt lgkmcnt(2)
    v_mfma_f32_16x16x32_bf16 v[32:35], a[208:211], v[64:67], v[32:35]
    v_mfma_f32_16x16x32_bf16 v[36:39], a[208:211], v[68:71], v[36:39]
    v_mfma_f32_16x16x32_bf16 v[40:43], a[212:215], v[64:67], v[40:43]
    v_mfma_f32_16x16x32_bf16 v[44:47], a[212:215], v[68:71], v[44:47]
    v_mfma_f32_16x16x32_bf16 v[48:51], v[64:67], v[208:211], v[48:51]
    v_mfma_f32_16x16x32_bf16 v[56:59], v[68:71], v[208:211], v[56:59]
    v_mfma_f32_16x16x32_bf16 v[52:55], v[64:67], v[212:215], v[52:55]
    v_mfma_f32_16x16x32_bf16 v[60:63], v[68:71], v[212:215], v[60:63]
    v_mfma_f32_16x16x32_bf16 v[16:19], a[80:83], v[64:67], v[16:19]
    v_mfma_f32_16x16x32_bf16 v[20:23], a[80:83], v[68:71], v[20:23]
    v_mfma_f32_16x16x32_bf16 v[24:27], a[84:87], v[64:67], v[24:27]
    v_mfma_f32_16x16x32_bf16 v[28:31], a[84:87], v[68:71], v[28:31]
    ds_read_b128 v[64:67], v80 offset:12288
    ds_read_b128 v[68:71], v81 offset:12288
    s_waitcnt lgkmcnt(2)
    v_mfma_f32_16x16x32_bf16 v[32:35], a[216:219], v[72:75], v[32:35]
    v_mfma_f32_16x16x32_bf16 v[36:39], a[216:219], v[76:79], v[36:39]
    v_mfma_f32_16x16x32_bf16 v[40:43], a[220:223], v[72:75], v[40:43]
    v_mfma_f32_16x16x32_bf16 v[44:47], a[220:223], v[76:79], v[44:47]
    v_mfma_f32_16x16x32_bf16 v[48:51], v[72:75], v[216:219], v[48:51]
    v_mfma_f32_16x16x32_bf16 v[56:59], v[76:79], v[216:219], v[56:59]
    v_mfma_f32_16x16x32_bf16 v[52:55], v[72:75], v[220:223], v[52:55]
    v_mfma_f32_16x16x32_bf16 v[60:63], v[76:79], v[220:223], v[60:63]
    v_mfma_f32_16x16x32_bf16 v[16:19], a[88:91], v[72:75], v[16:19]
    v_mfma_f32_16x16x32_bf16 v[20:23], a[88:91], v[76:79], v[20:23]
    v_mfma_f32_16x16x32_bf16 v[24:27], a[92:95], v[72:75], v[24:27]
    v_mfma_f32_16x16x32_bf16 v[28:31], a[92:95], v[76:79], v[28:31]
    ds_read_b128 v[72:75], v82 offset:13312
    ds_read_b128 v[76:79], v83 offset:13312
    s_waitcnt lgkmcnt(2)
    v_mfma_f32_16x16x32_bf16 v[32:35], a[224:227], v[64:67], v[32:35]
    v_mfma_f32_16x16x32_bf16 v[36:39], a[224:227], v[68:71], v[36:39]
    v_mfma_f32_16x16x32_bf16 v[40:43], a[228:231], v[64:67], v[40:43]
    v_mfma_f32_16x16x32_bf16 v[44:47], a[228:231], v[68:71], v[44:47]
    v_mfma_f32_16x16x32_bf16 v[48:51], v[64:67], v[224:227], v[48:51]
    v_mfma_f32_16x16x32_bf16 v[56:59], v[68:71], v[224:227], v[56:59]
    v_mfma_f32_16x16x32_bf16 v[52:55], v[64:67], v[228:231], v[52:55]
    v_mfma_f32_16x16x32_bf16 v[60:63], v[68:71], v[228:231], v[60:63]
    v_mfma_f32_16x16x32_bf16 v[16:19], a[96:99], v[64:67], v[16:19]
    v_mfma_f32_16x16x32_bf16 v[20:23], a[96:99], v[68:71], v[20:23]
    v_mfma_f32_16x16x32_bf16 v[24:27], a[100:103], v[64:67], v[24:27]
    v_mfma_f32_16x16x32_bf16 v[28:31], a[100:103], v[68:71], v[28:31]
    ds_read_b128 v[64:67], v80 offset:14336
    ds_read_b128 v[68:71], v81 offset:14336
    s_waitcnt lgkmcnt(2)
    v_mfma_f32_16x16x32_bf16 v[32:35], a[232:235], v[72:75], v[32:35]
    v_mfma_f32_16x16x32_bf16 v[36:39], a[232:235], v[76:79], v[36:39]
    v_mfma_f32_16x16x32_bf16 v[40:43], a[236:239], v[72:75], v[40:43]
    v_mfma_f32_16x16x32_bf16 v[44:47], a[236:239], v[76:79], v[44:47]
    v_mfma_f32_16x16x32_bf16 v[48:51], v[72:75], v[232:235], v[48:51]
    v_mfma_f32_16x16x32_bf16 v[56:59], v[76:79], v[232:235], v[56:59]
    v_mfma_f32_16x16x32_bf16 v[52:55], v[72:75], v[236:239], v[52:55]
    v_mfma_f32_16x16x32_bf16 v[60:63], v[76:79], v[236:239], v[60:63]
    v_mfma_f32_16x16x32_bf16 v[16:19], a[104:107], v[72:75], v[16:19]
    v_mfma_f32_16x16x32_bf16 v[20:23], a[104:107], v[76:79], v[20:23]
    v_mfma_f32_16x16x32_bf16 v[24:27], a[108:111], v[72:75], v[24:27]
    v_mfma_f32_16x16x32_bf16 v[28:31], a[108:111], v[76:79], v[28:31]
    ds_read_b128 v[72:75], v82 offset:15360
    ds_read_b128 v[76:79], v83 offset:15360
    s_waitcnt lgkmcnt(2)
    v_mfma_f32_16x16x32_bf16 v[32:35], a[240:243], v[64:67], v[32:35]
    v_mfma_f32_16x16x32_bf16 v[36:39], a[240:243], v[68:71], v[36:39]
    v_mfma_f32_16x16x32_bf16 v[40:43], a[244:247], v[64:67], v[40:43]
    v_mfma_f32_16x16x32_bf16 v[44:47], a[244:247], v[68:71], v[44:47]
    v_mfma_f32_16x16x32_bf16 v[48:51], v[64:67], v[240:243], v[48:51]
    v_mfma_f32_16x16x32_bf16 v[56:59], v[68:71], v[240:243], v[56:59]
    v_mfma_f32_16x16x32_bf16 v[52:55], v[64:67], v[244:247], v[52:55]
    v_mfma_f32_16x16x32_bf16 v[60:63], v[68:71], v[244:247], v[60:63]
    v_mfma_f32_16x16x32_bf16 v[16:19], a[112:115], v[64:67], v[16:19]
    v_mfma_f32_16x16x32_bf16 v[20:23], a[112:115], v[68:71], v[20:23]
    v_mfma_f32_16x16x32_bf16 v[24:27], a[116:119], v[64:67], v[24:27]
    v_mfma_f32_16x16x32_bf16 v[28:31], a[116:119], v[68:71], v[28:31]
    s_waitcnt lgkmcnt(0)
    v_mfma_f32_16x16x32_bf16 v[32:35], a[248:251], v[72:75], v[32:35]
    v_mfma_f32_16x16x32_bf16 v[36:39], a[248:251], v[76:79], v[36:39]
    v_mfma_f32_16x16x32_bf16 v[40:43], a[252:255], v[72:75], v[40:43]
    v_mfma_f32_16x16x32_bf16 v[44:47], a[252:255], v[76:79], v[44:47]
    v_mfma_f32_16x16x32_bf16 v[48:51], v[72:75], v[248:251], v[48:51]
    v_mfma_f32_16x16x32_bf16 v[56:59], v[76:79], v[248:251], v[56:59]
    v_mfma_f32_16x16x32_bf16 v[52:55], v[72:75], v[252:255], v[52:55]
    v_mfma_f32_16x16x32_bf16 v[60:63], v[76:79], v[252:255], v[60:63]
    v_mfma_f32_16x16x32_bf16 v[16:19], a[120:123], v[72:75], v[16:19]
    v_mfma_f32_16x16x32_bf16 v[20:23], a[120:123], v[76:79], v[20:23]
    v_mfma_f32_16x16x32_bf16 v[24:27], a[124:127], v[72:75], v[24:27]
    v_mfma_f32_16x16x32_bf16 v[28:31], a[124:127], v[76:79], v[28:31]
    s_barrier
    v_mul_f32 v32, s33, v32
    v_mul_f32 v33, s33, v33
    v_mul_f32 v34, s33, v34
    v_mul_f32 v35, s33, v35
    v_mul_f32 v36, s33, v36
    v_mul_f32 v37, s33, v37
    v_mul_f32 v38, s33, v38
    v_mul_f32 v39, s33, v39
    v_mul_f32 v40, s33, v40
    v_mul_f32 v41, s33, v41
    v_mul_f32 v42, s33, v42
    v_mul_f32 v43, s33, v43
    v_mul_f32 v44, s33, v44
    v_mul_f32 v45, s33, v45
    v_mul_f32 v46, s33, v46
    v_mul_f32 v47, s33, v47
    v_cvt_pk_bf16_f32 v64, v32, v40
    v_cvt_pk_bf16_f32 v65, v33, v41
    v_cvt_pk_bf16_f32 v66, v34, v42
    v_cvt_pk_bf16_f32 v67, v35, v43
    v_cvt_pk_bf16_f32 v68, v36, v44
    v_cvt_pk_bf16_f32 v69, v37, v45
    v_cvt_pk_bf16_f32 v70, v38, v46
    v_cvt_pk_bf16_f32 v71, v39, v47
    v_cvt_pk_bf16_f32 v72, v48, v49
    v_cvt_pk_bf16_f32 v73, v50, v51
    v_cvt_pk_bf16_f32 v74, v56, v57
    v_cvt_pk_bf16_f32 v75, v58, v59
    v_cvt_pk_bf16_f32 v76, v52, v53
    v_cvt_pk_bf16_f32 v77, v54, v55
    v_cvt_pk_bf16_f32 v78, v60, v61
    v_cvt_pk_bf16_f32 v79, v62, v63
    v_cvt_pk_bf16_f32 v84, v16, v24
    v_cvt_pk_bf16_f32 v85, v17, v25
    v_cvt_pk_bf16_f32 v86, v18, v26
    v_cvt_pk_bf16_f32 v87, v19, v27
    v_cvt_pk_bf16_f32 v88, v20, v28
    v_cvt_pk_bf16_f32 v89, v21, v29
    v_cvt_pk_bf16_f32 v90, v22, v30
    v_cvt_pk_bf16_f32 v91, v23, v31
    s_mul_i32 s24, s23, 0x82000
    s_lshl_b32 s36, s20, 14
    s_add_u32 s24, s24, s36
    s_add_u32 s24, s24, 0x1000000
    s_lshr_b32 s36, s21, 1
    s_lshl_b32 s36, s36, 12
    s_xor_b32 s37, s36, 4096
    s_add_u32 s36, s36, s24
    s_add_u32 s37, s37, s24
    buffer_store_dwordx4 v[64:67], v9, s[8:11], s36 offen sc1
    buffer_store_dwordx4 v[68:71], v9, s[8:11], s37 offen sc1
    s_add_u32 s24, s24, 8192
    buffer_store_dwordx4 v[72:75], v2, s[8:11], s24 offen sc1
    buffer_store_dwordx4 v[76:79], v2, s[8:11], s24 offen offset:1024 sc1
    s_add_u32 s36, s36, 0x7000000
    s_add_u32 s37, s37, 0x7000000
    buffer_store_dwordx4 v[84:87], v9, s[8:11], s36 offen sc1
    buffer_store_dwordx4 v[88:91], v9, s[8:11], s37 offen sc1
    s_lshl_b32 s25, s20, 8
    s_lshl_b32 s36, s23, 2
    s_add_u32 s25, s25, s36
    s_add_u32 s25, s25, 0x190000
    s_cmp_ge_u32 s23, 6
    s_cbranch_scc1 L_P1_defer
    s_waitcnt vmcnt(0)
    s_barrier
    v_cmp_ne_u32 vcc, 0, v0
    v_mov_b32 v15, 0x40000000
    v_mov_b32 v14, 1
    v_cndmask_b32 v15, v0, v15, vcc
    buffer_store_dword v14, v15, s[8:11], s25 offen sc1
L_P1_defer:
    s_add_u32 s23, s23, 6
    s_cmp_lt_u32 s23, 64
    s_cbranch_scc1 L_P1
    v_mov_b32 v20, -1
    v_mov_b32 v21, -1
    v_mov_b32 v22, -1
    v_mov_b32 v23, -1
    s_lshl_b32 s24, s22, 21
    s_lshl_b32 s36, s20, 15
    s_add_u32 s24, s24, s36
    s_add_u32 s36, s24, 0x4000000
    buffer_store_dwordx4 v[20:23], v11, s[8:11], s36 offen sc1
    s_add_u32 s36, s24, 0x4001000
    buffer_store_dwordx4 v[20:23], v11, s[8:11], s36 offen sc1
    s_add_u32 s36, s24, 0x4002000
    buffer_store_dwordx4 v[20:23], v11, s[8:11], s36 offen sc1
    s_add_u32 s36, s24, 0x4003000
    buffer_store_dwordx4 v[20:23], v11, s[8:11], s36 offen sc1
    s_add_u32 s36, s24, 0x4004000
    buffer_store_dwordx4 v[20:23], v11, s[8:11], s36 offen sc1
    s_add_u32 s36, s24, 0x4005000
    buffer_store_dwordx4 v[20:23], v11, s[8:11], s36 offen sc1
    s_add_u32 s36, s24, 0x4006000
    buffer_store_dwordx4 v[20:23], v11, s[8:11], s36 offen sc1
    s_add_u32 s36, s24, 0x4007000
    buffer_store_dwordx4 v[20:23], v11, s[8:11], s36 offen sc1
    s_add_u32 s36, s24, 0x4100000
    buffer_store_dwordx4 v[20:23], v11, s[8:11], s36 offen sc1
    s_add_u32 s36, s24, 0x4101000
    buffer_store_dwordx4 v[20:23], v11, s[8:11], s36 offen sc1
    s_add_u32 s36, s24, 0x4102000
    buffer_store_dwordx4 v[20:23], v11, s[8:11], s36 offen sc1
    s_add_u32 s36, s24, 0x4103000
    buffer_store_dwordx4 v[20:23], v11, s[8:11], s36 offen sc1
    s_add_u32 s36, s24, 0x4104000
    buffer_store_dwordx4 v[20:23], v11, s[8:11], s36 offen sc1
    s_add_u32 s36, s24, 0x4105000
    buffer_store_dwordx4 v[20:23], v11, s[8:11], s36 offen sc1
    s_add_u32 s36, s24, 0x4106000
    buffer_store_dwordx4 v[20:23], v11, s[8:11], s36 offen sc1
    s_add_u32 s36, s24, 0x4107000
    buffer_store_dwordx4 v[20:23], v11, s[8:11], s36 offen sc1
    s_waitcnt vmcnt(0)
    s_barrier
    v_cmp_ne_u32 vcc, 0, v0
    v_mov_b32 v15, 0x40000000
    v_mov_b32 v14, 1
    v_cndmask_b32 v15, v0, v15, vcc
    buffer_store_dword v14, v15, s[8:11], s25 offen sc1
    s_lshl_b32 s25, s22, 7
    s_lshl_b32 s36, s20, 2
    s_add_u32 s36, s36, s25
    s_add_u32 s36, s36, 0x192000
    v_cmp_ne_u32 vcc, 0, v0
    v_mov_b32 v15, 0x40000000
    v_mov_b32 v14, 1
    v_cndmask_b32 v15, v0, v15, vcc
    buffer_store_dword v14, v15, s[8:11], s36 offen sc1
    s_mov_b32 s96, s54
    s_and_b32 s97, s55, 0xffff
    s_mov_b32 s98, 0x400000
    s_mov_b32 s99, 0x20000
    v_mov_b32 v15, 0x0
    v_bfe_u32 v14, v0, 0, 1
    s_mov_b32 s38, 0x10
    v_mad_u32_u24 v15, v14, s38, v15
    v_bfe_u32 v14, v0, 1, 1
    s_mov_b32 s38, 0x20
    v_mad_u32_u24 v15, v14, s38, v15
    v_bfe_u32 v14, v0, 2, 1
    s_mov_b32 s38, 0x40
    v_mad_u32_u24 v15, v14, s38, v15
    v_bfe_u32 v14, v0, 3, 1
    s_mov_b32 s38, 0x80
    v_mad_u32_u24 v15, v14, s38, v15
    v_bfe_u32 v14, v0, 4, 1
    s_mov_b32 s38, 0x1000
    v_mad_u32_u24 v15, v14, s38, v15
    v_bfe_u32 v14, v0, 5, 1
    s_mov_b32 s38, 0x2000
    v_mad_u32_u24 v15, v14, s38, v15
    v_bfe_u32 v14, v0, 6, 1
    s_mov_b32 s38, 0x100
    v_mad_u32_u24 v15, v14, s38, v15
    v_bfe_u32 v14, v0, 7, 1
    s_mov_b32 s38, 0x200
    v_mad_u32_u24 v15, v14, s38, v15
    s_lshl_b32 s36, s20, 17
    s_add_u32 s37, s36, 0x0
    buffer_load_dwordx4 v[16:19], v15, s[96:99], s37 offen
    s_add_u32 s37, s36, 0x4000
    buffer_load_dwordx4 v[20:23], v15, s[96:99], s37 offen
    s_add_u32 s37, s36, 0x400
    buffer_load_dwordx4 v[24:27], v15, s[96:99], s37 offen
    s_add_u32 s37, s36, 0x4400
    buffer_load_dwordx4 v[28:31], v15, s[96:99], s37 offen
    s_add_u32 s37, s36, 0x800
    buffer_load_dwordx4 v[32:35], v15, s[96:99], s37 offen
    s_add_u32 s37, s36, 0x4800
    buffer_load_dwordx4 v[36:39], v15, s[96:99], s37 offen
    s_add_u32 s37, s36, 0xc00
    buffer_load_dwordx4 v[40:43], v15, s[96:99], s37 offen
    s_add_u32 s37, s36, 0x4c00
    buffer_load_dwordx4 v[44:47], v15, s[96:99], s37 offen
    s_add_u32 s37, s36, 0x8000
    buffer_load_dwordx4 v[48:51], v15, s[96:99], s37 offen
    s_add_u32 s37, s36, 0xc000
    buffer_load_dwordx4 v[52:55], v15, s[96:99], s37 offen
    s_add_u32 s37, s36, 0x8400
    buffer_load_dwordx4 v[56:59], v15, s[96:99], s37 offen
    s_add_u32 s37, s36, 0xc400
    buffer_load_dwordx4 v[60:63], v15, s[96:99], s37 offen
    s_add_u32 s37, s36, 0x8800
    buffer_load_dwordx4 v[64:67], v15, s[96:99], s37 offen
    s_add_u32 s37, s36, 0xc800
    buffer_load_dwordx4 v[68:71], v15, s[96:99], s37 offen
    s_add_u32 s37, s36, 0x8c00
    buffer_load_dwordx4 v[72:75], v15, s[96:99], s37 offen
    s_add_u32 s37, s36, 0xcc00
    buffer_load_dwordx4 v[76:79], v15, s[96:99], s37 offen
    s_add_u32 s37, s36, 0x10000
    buffer_load_dwordx4 v[80:83], v15, s[96:99], s37 offen
    s_add_u32 s37, s36, 0x14000
    buffer_load_dwordx4 v[84:87], v15, s[96:99], s37 offen
    s_add_u32 s37, s36, 0x10400
    buffer_load_dwordx4 v[88:91], v15, s[96:99], s37 offen
    s_add_u32 s37, s36, 0x14400
    buffer_load_dwordx4 v[92:95], v15, s[96:99], s37 offen
    s_add_u32 s37, s36, 0x10800
    buffer_load_dwordx4 v[96:99], v15, s[96:99], s37 offen
    s_add_u32 s37, s36, 0x14800
    buffer_load_dwordx4 v[100:103], v15, s[96:99], s37 offen
    s_add_u32 s37, s36, 0x10c00
    buffer_load_dwordx4 v[104:107], v15, s[96:99], s37 offen
    s_add_u32 s37, s36, 0x14c00
    buffer_load_dwordx4 v[108:111], v15, s[96:99], s37 offen
    s_waitcnt vmcnt(16)
    v_perm_b32 v112, v20, v16, s34
    v_perm_b32 v113, v28, v24, s34
    v_perm_b32 v114, v36, v32, s34
    v_perm_b32 v115, v44, v40, s34
    ds_write_b128 v7, v[112:115] offset:0
    v_perm_b32 v116, v20, v16, s35
    v_perm_b32 v117, v28, v24, s35
    v_perm_b32 v118, v36, v32, s35
    v_perm_b32 v119, v44, v40, s35
    ds_write_b128 v7, v[116:119] offset:1024
    v_perm_b32 v120, v21, v17, s34
    v_perm_b32 v121, v29, v25, s34
    v_perm_b32 v122, v37, v33, s34
    v_perm_b32 v123, v45, v41, s34
    ds_write_b128 v7, v[120:123] offset:2048
    v_perm_b32 v124, v21, v17, s35
    v_perm_b32 v125, v29, v25, s35
    v_perm_b32 v126, v37, v33, s35
    v_perm_b32 v127, v45, v41, s35
    ds_write_b128 v7, v[124:127] offset:3072
    s_waitcnt lgkmcnt(0)
    v_perm_b32 v112, v22, v18, s34
    v_perm_b32 v113, v30, v26, s34
    v_perm_b32 v114, v38, v34, s34
    v_perm_b32 v115, v46, v42, s34
    ds_write_b128 v7, v[112:115] offset:4096
    v_perm_b32 v116, v22, v18, s35
    v_perm_b32 v117, v30, v26, s35
    v_perm_b32 v118, v38, v34, s35
    v_perm_b32 v119, v46, v42, s35
    ds_write_b128 v7, v[116:119] offset:5120
    v_perm_b32 v120, v23, v19, s34
    v_perm_b32 v121, v31, v27, s34
    v_perm_b32 v122, v39, v35, s34
    v_perm_b32 v123, v47, v43, s34
    ds_write_b128 v7, v[120:123] offset:6144
    v_perm_b32 v124, v23, v19, s35
    v_perm_b32 v125, v31, v27, s35
    v_perm_b32 v126, v39, v35, s35
    v_perm_b32 v127, v47, v43, s35
    ds_write_b128 v7, v[124:127] offset:7168
    s_waitcnt lgkmcnt(0)
    s_add_u32 s37, s36, 0x18000
    buffer_load_dwordx4 v[16:19], v15, s[96:99], s37 offen
    s_add_u32 s37, s36, 0x1c000
    buffer_load_dwordx4 v[20:23], v15, s[96:99], s37 offen
    s_add_u32 s37, s36, 0x18400
    buffer_load_dwordx4 v[24:27], v15, s[96:99], s37 offen
    s_add_u32 s37, s36, 0x1c400
    buffer_load_dwordx4 v[28:31], v15, s[96:99], s37 offen
    s_add_u32 s37, s36, 0x18800
    buffer_load_dwordx4 v[32:35], v15, s[96:99], s37 offen
    s_add_u32 s37, s36, 0x1c800
    buffer_load_dwordx4 v[36:39], v15, s[96:99], s37 offen
    s_add_u32 s37, s36, 0x18c00
    buffer_load_dwordx4 v[40:43], v15, s[96:99], s37 offen
    s_add_u32 s37, s36, 0x1cc00
    buffer_load_dwordx4 v[44:47], v15, s[96:99], s37 offen
    s_waitcnt vmcnt(16)
    v_perm_b32 v112, v52, v48, s34
    v_perm_b32 v113, v60, v56, s34
    v_perm_b32 v114, v68, v64, s34
    v_perm_b32 v115, v76, v72, s34
    ds_write_b128 v7, v[112:115] offset:8192
    v_perm_b32 v116, v52, v48, s35
    v_perm_b32 v117, v60, v56, s35
    v_perm_b32 v118, v68, v64, s35
    v_perm_b32 v119, v76, v72, s35
    ds_write_b128 v7, v[116:119] offset:9216
    v_perm_b32 v120, v53, v49, s34
    v_perm_b32 v121, v61, v57, s34
    v_perm_b32 v122, v69, v65, s34
    v_perm_b32 v123, v77, v73, s34
    ds_write_b128 v7, v[120:123] offset:10240
    v_perm_b32 v124, v53, v49, s35
    v_perm_b32 v125, v61, v57, s35
    v_perm_b32 v126, v69, v65, s35
    v_perm_b32 v127, v77, v73, s35
    ds_write_b128 v7, v[124:127] offset:11264
    s_waitcnt lgkmcnt(0)
    v_perm_b32 v112, v54, v50, s34
    v_perm_b32 v113, v62, v58, s34
    v_perm_b32 v114, v70, v66, s34
    v_perm_b32 v115, v78, v74, s34
    ds_write_b128 v7, v[112:115] offset:12288
    v_perm_b32 v116, v54, v50, s35
    v_perm_b32 v117, v62, v58, s35
    v_perm_b32 v118, v70, v66, s35
    v_perm_b32 v119, v78, v74, s35
    ds_write_b128 v7, v[116:119] offset:13312
    v_perm_b32 v120, v55, v51, s34
    v_perm_b32 v121, v63, v59, s34
    v_perm_b32 v122, v71, v67, s34
    v_perm_b32 v123, v79, v75, s34
    ds_write_b128 v7, v[120:123] offset:14336
    v_perm_b32 v124, v55, v51, s35
    v_perm_b32 v125, v63, v59, s35
    v_perm_b32 v126, v71, v67, s35
    v_perm_b32 v127, v79, v75, s35
    ds_write_b128 v7, v[124:127] offset:15360
    s_waitcnt lgkmcnt(0)
    s_waitcnt vmcnt(8)
    v_perm_b32 v112, v84, v80, s34
    v_perm_b32 v113, v92, v88, s34
    v_perm_b32 v114, v100, v96, s34
    v_perm_b32 v115, v108, v104, s34
    ds_write_b128 v7, v[112:115] offset:16384
    v_perm_b32 v116, v84, v80, s35
    v_perm_b32 v117, v92, v88, s35
    v_perm_b32 v118, v100, v96, s35
    v_perm_b32 v119, v108, v104, s35
    ds_write_b128 v7, v[116:119] offset:17408
    v_perm_b32 v120, v85, v81, s34
    v_perm_b32 v121, v93, v89, s34
    v_perm_b32 v122, v101, v97, s34
    v_perm_b32 v123, v109, v105, s34
    ds_write_b128 v7, v[120:123] offset:18432
    v_perm_b32 v124, v85, v81, s35
    v_perm_b32 v125, v93, v89, s35
    v_perm_b32 v126, v101, v97, s35
    v_perm_b32 v127, v109, v105, s35
    ds_write_b128 v7, v[124:127] offset:19456
    s_waitcnt lgkmcnt(0)
    v_perm_b32 v112, v86, v82, s34
    v_perm_b32 v113, v94, v90, s34
    v_perm_b32 v114, v102, v98, s34
    v_perm_b32 v115, v110, v106, s34
    ds_write_b128 v7, v[112:115] offset:20480
    v_perm_b32 v116, v86, v82, s35
    v_perm_b32 v117, v94, v90, s35
    v_perm_b32 v118, v102, v98, s35
    v_perm_b32 v119, v110, v106, s35
    ds_write_b128 v7, v[116:119] offset:21504
    v_perm_b32 v120, v87, v83, s34
    v_perm_b32 v121, v95, v91, s34
    v_perm_b32 v122, v103, v99, s34
    v_perm_b32 v123, v111, v107, s34
    ds_write_b128 v7, v[120:123] offset:22528
    v_perm_b32 v124, v87, v83, s35
    v_perm_b32 v125, v95, v91, s35
    v_perm_b32 v126, v103, v99, s35
    v_perm_b32 v127, v111, v107, s35
    ds_write_b128 v7, v[124:127] offset:23552
    s_waitcnt lgkmcnt(0)
    s_waitcnt vmcnt(0)
    v_perm_b32 v112, v20, v16, s34
    v_perm_b32 v113, v28, v24, s34
    v_perm_b32 v114, v36, v32, s34
    v_perm_b32 v115, v44, v40, s34
    ds_write_b128 v7, v[112:115] offset:24576
    v_perm_b32 v116, v20, v16, s35
    v_perm_b32 v117, v28, v24, s35
    v_perm_b32 v118, v36, v32, s35
    v_perm_b32 v119, v44, v40, s35
    ds_write_b128 v7, v[116:119] offset:25600
    v_perm_b32 v120, v21, v17, s34
    v_perm_b32 v121, v29, v25, s34
    v_perm_b32 v122, v37, v33, s34
    v_perm_b32 v123, v45, v41, s34
    ds_write_b128 v7, v[120:123] offset:26624
    v_perm_b32 v124, v21, v17, s35
    v_perm_b32 v125, v29, v25, s35
    v_perm_b32 v126, v37, v33, s35
    v_perm_b32 v127, v45, v41, s35
    ds_write_b128 v7, v[124:127] offset:27648
    s_waitcnt lgkmcnt(0)
    v_perm_b32 v112, v22, v18, s34
    v_perm_b32 v113, v30, v26, s34
    v_perm_b32 v114, v38, v34, s34
    v_perm_b32 v115, v46, v42, s34
    ds_write_b128 v7, v[112:115] offset:28672
    v_perm_b32 v116, v22, v18, s35
    v_perm_b32 v117, v30, v26, s35
    v_perm_b32 v118, v38, v34, s35
    v_perm_b32 v119, v46, v42, s35
    ds_write_b128 v7, v[116:119] offset:29696
    v_perm_b32 v120, v23, v19, s34
    v_perm_b32 v121, v31, v27, s34
    v_perm_b32 v122, v39, v35, s34
    v_perm_b32 v123, v47, v43, s34
    ds_write_b128 v7, v[120:123] offset:30720
    v_perm_b32 v124, v23, v19, s35
    v_perm_b32 v125, v31, v27, s35
    v_perm_b32 v126, v39, v35, s35
    v_perm_b32 v127, v47, v43, s35
    ds_write_b128 v7, v[124:127] offset:31744
    s_waitcnt lgkmcnt(0)
    s_lshl_b32 s25, s22, 7
    s_add_u32 s25, s25, 0x192000
    v_lshrrev_b32 v15, 2, v1
    v_and_b32 v15, 127, v15
L_TPI:
    buffer_load_dword v14, v15, s[8:11], s25 offen sc1
    s_add_u32 s32, s32, 1
    s_cmp_gt_u32 s32, 200000
    s_waitcnt vmcnt(0)
    s_cbranch_scc1 L_TPI_ok
    v_cmp_eq_u32 vcc, 0, v14
    s_cbranch_vccz L_TPI_ok
    s_sleep 8
    s_branch L_TPI
L_TPI_ok:
    s_mov_b32 s23, s22
    s_mov_b32 s29, 0
L_P2:
    s_and_b32 s36, s29, 1
    s_lshl_b32 s36, s36, 20
    s_lshl_b32 s26, s22, 21
    s_add_u32 s26, s26, s36
    s_add_u32 s26, s26, 0x4000000
    s_bfe_u32 s27, s29, 0x10001
    s_mul_i32 s24, s23, 0x82000
    s_lshl_b32 s36, s20, 14
    s_add_u32 s24, s24, s36
    s_add_u32 s24, s24, 0x1000000
    s_add_u32 s36, s24, 0
    s_add_u32 s37, s36, 0x7000000
    buffer_load_dwordx4 v[48:51], v1, s[8:11], s36 offen offset:0 sc1
    buffer_load_dwordx4 v[16:19], v1, s[8:11], s37 offen offset:0 sc1
    buffer_load_dwordx4 v[52:55], v1, s[8:11], s36 offen offset:1024 sc1
    buffer_load_dwordx4 v[20:23], v1, s[8:11], s37 offen offset:1024 sc1
    buffer_load_dwordx4 v[56:59], v1, s[8:11], s36 offen offset:2048 sc1
    buffer_load_dwordx4 v[24:27], v1, s[8:11], s37 offen offset:2048 sc1
    buffer_load_dwordx4 v[60:63], v1, s[8:11], s36 offen offset:3072 sc1
    buffer_load_dwordx4 v[28:31], v1, s[8:11], s37 offen offset:3072 sc1
    s_add_u32 s36, s24, 4096
    s_add_u32 s37, s36, 0x7000000
    buffer_load_dwordx4 v[64:67], v1, s[8:11], s36 offen offset:0 sc1
    buffer_load_dwordx4 v[32:35], v1, s[8:11], s37 offen offset:0 sc1
    buffer_load_dwordx4 v[68:71], v1, s[8:11], s36 offen offset:1024 sc1
    buffer_load_dwordx4 v[36:39], v1, s[8:11], s37 offen offset:1024 sc1
    buffer_load_dwordx4 v[72:75], v1, s[8:11], s36 offen offset:2048 sc1
    buffer_load_dwordx4 v[40:43], v1, s[8:11], s37 offen offset:2048 sc1
    buffer_load_dwordx4 v[76:79], v1, s[8:11], s36 offen offset:3072 sc1
    buffer_load_dwordx4 v[44:47], v1, s[8:11], s37 offen offset:3072 sc1
    s_add_u32 s24, s24, 8192
    buffer_load_dwordx4 v[120:123], v2, s[8:11], s24 offen sc1
    buffer_load_dwordx4 v[124:127], v2, s[8:11], s24 offen offset:1024 sc1
    s_waitcnt vmcnt(0)
    s_cmp_lt_u32 s21, 2
    s_cbranch_scc1 L_P2_noswap
    v_swap_b32 v120, v122
    v_swap_b32 v121, v123
    v_swap_b32 v124, v126
    v_swap_b32 v125, v127
L_P2_noswap:
    s_nop 1
    v_mfma_f32_16x16x32_bf16 v[80:83], v[48:51], v[16:19], 0
    v_mfma_f32_16x16x32_bf16 v[80:83], v[52:55], v[20:23], v[80:83]
    v_mfma_f32_16x16x32_bf16 v[80:83], v[56:59], v[24:27], v[80:83]
    v_mfma_f32_16x16x32_bf16 v[80:83], v[60:63], v[28:31], v[80:83]
    v_mfma_f32_16x16x32_bf16 v[84:87], v[48:51], v[32:35], 0
    v_mfma_f32_16x16x32_bf16 v[84:87], v[52:55], v[36:39], v[84:87]
    v_mfma_f32_16x16x32_bf16 v[84:87], v[56:59], v[40:43], v[84:87]
    v_mfma_f32_16x16x32_bf16 v[84:87], v[60:63], v[44:47], v[84:87]
    v_mfma_f32_16x16x32_bf16 v[88:91], v[64:67], v[32:35], 0
    v_mfma_f32_16x16x32_bf16 v[88:91], v[68:71], v[36:39], v[88:91]
    v_mfma_f32_16x16x32_bf16 v[88:91], v[72:75], v[40:43], v[88:91]
    v_mfma_f32_16x16x32_bf16 v[88:91], v[76:79], v[44:47], v[88:91]
    s_lshl_b32 s24, s23, 13
    s_add_u32 s24, s24, 0x100000
    s_max_u32 s25, s23, 1
    s_lshl_b32 s25, s25, 13
    s_add_u32 s25, s25, 0xfe000
L_P2_far:
    buffer_load_dword v14, v2, s[8:11], s25 offen sc1
    s_add_u32 s32, s32, 1
    s_cmp_gt_u32 s32, 200000
    s_waitcnt vmcnt(0)
    s_cbranch_scc1 L_P2_poll
    v_cmp_eq_u32 vcc, -1, v14
    s_cbranch_vccz L_P2_poll
    s_sleep 12
    s_branch L_P2_far
L_P2_poll:
    buffer_load_dwordx4 v[48:51], v2, s[8:11], s24 offen sc1
    buffer_load_dwordx4 v[52:55], v2, s[8:11], s24 offen offset:1024 sc1
    s_add_u32 s32, s32, 1
    s_cmp_gt_u32 s32, 200000
    s_waitcnt vmcnt(0)
    v_max3_u32 v14, v48, v49, v50
    v_max3_u32 v15, v51, v52, v53
    v_max3_u32 v14, v14, v54, v55
    v_max_u32 v14, v14, v15
    s_cbranch_scc1 L_P2_got
    v_cmp_eq_u32 vcc, -1, v14
    s_cbranch_vccnz L_P2_poll
L_P2_got:
    ds_write_b128 v2, v[48:51] offset:20480
    ds_write_b128 v2, v[52:55] offset:21504
    s_waitcnt lgkmcnt(0)
    s_barrier
    ds_read_b128 v[48:51], v8 offset:0
    ds_read_b128 v[52:55], v8 offset:2048
    ds_read_b128 v[56:59], v8 offset:4096
    ds_read_b128 v[60:63], v8 offset:6144
    ds_read_b128 v[64:67], v8 offset:512
    s_waitcnt lgkmcnt(4)
    v_mfma_f32_16x16x32_bf16 v[100:103], a[128:131], v[48:51], 0
    v_mfma_f32_16x16x32_bf16 v[104:107], a[132:135], v[48:51], 0
    v_mfma_f32_16x16x32_bf16 v[108:111], v[48:51], v[128:131], 0
    v_mfma_f32_16x16x32_bf16 v[112:115], v[48:51], v[132:135], 0
    ds_read_b128 v[68:71], v8 offset:2560
    s_waitcnt lgkmcnt(4)
    v_mfma_f32_16x16x32_bf16 v[100:103], a[136:139], v[52:55], v[100:103]
    v_mfma_f32_16x16x32_bf16 v[104:107], a[140:143], v[52:55], v[104:107]
    v_mfma_f32_16x16x32_bf16 v[108:111], v[52:55], v[136:139], v[108:111]
    v_mfma_f32_16x16x32_bf16 v[112:115], v[52:55], v[140:143], v[112:115]
    ds_read_b128 v[72:75], v8 offset:4608
    s_waitcnt lgkmcnt(4)
    v_mfma_f32_16x16x32_bf16 v[100:103], a[144:147], v[56:59], v[100:103]
    v_mfma_f32_16x16x32_bf16 v[104:107], a[148:151], v[56:59], v[104:107]
    v_mfma_f32_16x16x32_bf16 v[108:111], v[56:59], v[144:147], v[108:111]
    v_mfma_f32_16x16x32_bf16 v[112:115], v[56:59], v[148:151], v[112:115]
    ds_read_b128 v[76:79], v8 offset:6656
    s_waitcnt lgkmcnt(4)
    v_mfma_f32_16x16x32_bf16 v[100:103], a[152:155], v[60:63], v[100:103]
    v_mfma_f32_16x16x32_bf16 v[104:107], a[156:159], v[60:63], v[104:107]
    v_mfma_f32_16x16x32_bf16 v[108:111], v[60:63], v[152:155], v[108:111]
    v_mfma_f32_16x16x32_bf16 v[112:115], v[60:63], v[156:159], v[112:115]
    ds_read_b128 v[48:51], v8 offset:1024
    s_waitcnt lgkmcnt(4)
    v_mfma_f32_16x16x32_bf16 v[100:103], a[160:163], v[64:67], v[100:103]
    v_mfma_f32_16x16x32_bf16 v[104:107], a[164:167], v[64:67], v[104:107]
    v_mfma_f32_16x16x32_bf16 v[108:111], v[64:67], v[160:163], v[108:111]
    v_mfma_f32_16x16x32_bf16 v[112:115], v[64:67], v[164:167], v[112:115]
    ds_read_b128 v[52:55], v8 offset:3072
    s_waitcnt lgkmcnt(4)
    v_mfma_f32_16x16x32_bf16 v[100:103], a[168:171], v[68:71], v[100:103]
    v_mfma_f32_16x16x32_bf16 v[104:107], a[172:175], v[68:71], v[104:107]
    v_mfma_f32_16x16x32_bf16 v[108:111], v[68:71], v[168:171], v[108:111]
    v_mfma_f32_16x16x32_bf16 v[112:115], v[68:71], v[172:175], v[112:115]
    ds_read_b128 v[56:59], v8 offset:5120
    s_waitcnt lgkmcnt(4)
    v_mfma_f32_16x16x32_bf16 v[100:103], a[176:179], v[72:75], v[100:103]
    v_mfma_f32_16x16x32_bf16 v[104:107], a[180:183], v[72:75], v[104:107]
    v_mfma_f32_16x16x32_bf16 v[108:111], v[72:75], v[176:179], v[108:111]
    v_mfma_f32_16x16x32_bf16 v[112:115], v[72:75], v[180:183], v[112:115]
    ds_read_b128 v[60:63], v8 offset:7168
    s_waitcnt lgkmcnt(4)
    v_mfma_f32_16x16x32_bf16 v[100:103], a[184:187], v[76:79], v[100:103]
    v_mfma_f32_16x16x32_bf16 v[104:107], a[188:191], v[76:79], v[104:107]
    v_mfma_f32_16x16x32_bf16 v[108:111], v[76:79], v[184:187], v[108:111]
    v_mfma_f32_16x16x32_bf16 v[112:115], v[76:79], v[188:191], v[112:115]
    ds_read_b128 v[64:67], v8 offset:1536
    s_waitcnt lgkmcnt(4)
    v_mfma_f32_16x16x32_bf16 v[100:103], a[192:195], v[48:51], v[100:103]
    v_mfma_f32_16x16x32_bf16 v[104:107], a[196:199], v[48:51], v[104:107]
    v_mfma_f32_16x16x32_bf16 v[108:111], v[48:51], v[192:195], v[108:111]
    v_mfma_f32_16x16x32_bf16 v[112:115], v[48:51], v[196:199], v[112:115]
    ds_read_b128 v[68:71], v8 offset:3584
    s_waitcnt lgkmcnt(4)
    v_mfma_f32_16x16x32_bf16 v[100:103], a[200:203], v[52:55], v[100:103]
    v_mfma_f32_16x16x32_bf16 v[104:107], a[204:207], v[52:55], v[104:107]
    v_mfma_f32_16x16x32_bf16 v[108:111], v[52:55], v[200:203], v[108:111]
    v_mfma_f32_16x16x32_bf16 v[112:115], v[52:55], v[204:207], v[112:115]
    ds_read_b128 v[72:75], v8 offset:5632
    s_waitcnt lgkmcnt(4)
    v_mfma_f32_16x16x32_bf16 v[100:103], a[208:211], v[56:59], v[100:103]
    v_mfma_f32_16x16x32_bf16 v[104:107], a[212:215], v[56:59], v[104:107]
    v_mfma_f32_16x16x32_bf16 v[108:111], v[56:59], v[208:211], v[108:111]
    v_mfma_f32_16x16x32_bf16 v[112:115], v[56:59], v[212:215], v[112:115]
    ds_read_b128 v[76:79], v8 offset:7680
    s_waitcnt lgkmcnt(4)
    v_mfma_f32_16x16x32_bf16 v[100:103], a[216:219], v[60:63], v[100:103]
    v_mfma_f32_16x16x32_bf16 v[104:107], a[220:223], v[60:63], v[104:107]
    v_mfma_f32_16x16x32_bf16 v[108:111], v[60:63], v[216:219], v[108:111]
    v_mfma_f32_16x16x32_bf16 v[112:115], v[60:63], v[220:223], v[112:115]
    s_waitcnt lgkmcnt(3)
    v_mfma_f32_16x16x32_bf16 v[100:103], a[224:227], v[64:67], v[100:103]
    v_mfma_f32_16x16x32_bf16 v[104:107], a[228:231], v[64:67], v[104:107]
    v_mfma_f32_16x16x32_bf16 v[108:111], v[64:67], v[224:227], v[108:111]
    v_mfma_f32_16x16x32_bf16 v[112:115], v[64:67], v[228:231], v[112:115]
    s_waitcnt lgkmcnt(2)
    v_mfma_f32_16x16x32_bf16 v[100:103], a[232:235], v[68:71], v[100:103]
    v_mfma_f32_16x16x32_bf16 v[104:107], a[236:239], v[68:71], v[104:107]
    v_mfma_f32_16x16x32_bf16 v[108:111], v[68:71], v[232:235], v[108:111]
    v_mfma_f32_16x16x32_bf16 v[112:115], v[68:71], v[236:239], v[112:115]
    s_waitcnt lgkmcnt(1)
    v_mfma_f32_16x16x32_bf16 v[100:103], a[240:243], v[72:75], v[100:103]
    v_mfma_f32_16x16x32_bf16 v[104:107], a[244:247], v[72:75], v[104:107]
    v_mfma_f32_16x16x32_bf16 v[108:111], v[72:75], v[240:243], v[108:111]
    v_mfma_f32_16x16x32_bf16 v[112:115], v[72:75], v[244:247], v[112:115]
    s_waitcnt lgkmcnt(0)
    v_mfma_f32_16x16x32_bf16 v[100:103], a[248:251], v[76:79], v[100:103]
    v_mfma_f32_16x16x32_bf16 v[104:107], a[252:255], v[76:79], v[104:107]
    v_mfma_f32_16x16x32_bf16 v[108:111], v[76:79], v[248:251], v[108:111]
    v_mfma_f32_16x16x32_bf16 v[112:115], v[76:79], v[252:255], v[112:115]
    s_nop 4
    v_mul_f32 v100, s33, v100
    v_mul_f32 v101, s33, v101
    v_mul_f32 v102, s33, v102
    v_mul_f32 v103, s33, v103
    v_mul_f32 v104, s33, v104
    v_mul_f32 v105, s33, v105
    v_mul_f32 v106, s33, v106
    v_mul_f32 v107, s33, v107
    v_cvt_pk_bf16_f32 v48, v100, v104
    v_cvt_pk_bf16_f32 v49, v101, v105
    v_cvt_pk_bf16_f32 v50, v102, v106
    v_cvt_pk_bf16_f32 v51, v103, v107
    ds_write_b128 v9, v[48:51] offset:16384
    v_cvt_pk_bf16_f32 v116, v108, v109
    v_cvt_pk_bf16_f32 v117, v110, v111
    v_cvt_pk_bf16_f32 v118, v112, v113
    v_cvt_pk_bf16_f32 v119, v114, v115
    s_waitcnt lgkmcnt(0)
    s_barrier
    ds_read_b128 v[64:67], v1 offset:16384
    ds_read_b128 v[68:71], v1 offset:17408
    ds_read_b128 v[72:75], v1 offset:18432
    ds_read_b128 v[76:79], v1 offset:19456
    v_cndmask_b32 v80, v13, v80, s[64:65]
    v_cndmask_b32 v81, v13, v81, s[66:67]
    v_cndmask_b32 v82, v13, v82, s[68:69]
    v_cndmask_b32 v83, v13, v83, s[70:71]
    v_cndmask_b32 v88, v13, v88, s[64:65]
    v_cndmask_b32 v89, v13, v89, s[66:67]
    v_cndmask_b32 v90, v13, v90, s[68:69]
    v_cndmask_b32 v91, v13, v91, s[70:71]
    s_waitcnt lgkmcnt(0)
    v_mfma_f32_16x16x32_bf16 v[92:95], v[64:67], v[16:19], 0
    v_mfma_f32_16x16x32_bf16 v[92:95], v[68:71], v[20:23], v[92:95]
    v_mfma_f32_16x16x32_bf16 v[92:95], v[72:75], v[24:27], v[92:95]
    v_mfma_f32_16x16x32_bf16 v[92:95], v[76:79], v[28:31], v[92:95]
    v_mfma_f32_16x16x32_bf16 v[96:99], v[64:67], v[32:35], 0
    v_mfma_f32_16x16x32_bf16 v[96:99], v[68:71], v[36:39], v[96:99]
    v_mfma_f32_16x16x32_bf16 v[96:99], v[72:75], v[40:43], v[96:99]
    v_mfma_f32_16x16x32_bf16 v[96:99], v[76:79], v[44:47], v[96:99]
    s_nop 3
    v_cndmask_b32 v92, v13, v92, s[72:73]
    v_cndmask_b32 v93, v13, v93, s[72:73]
    v_cndmask_b32 v94, v13, v94, s[72:73]
    v_cndmask_b32 v95, v13, v95, s[72:73]
    v_cndmask_b32 v96, v13, v96, s[72:73]
    v_cndmask_b32 v97, v13, v97, s[72:73]
    v_cndmask_b32 v98, v13, v98, s[72:73]
    v_cndmask_b32 v99, v13, v99, s[72:73]
    v_max_f32 v48, v80, v81
    v_max3_f32 v48, v48, v82, v83
    v_max3_f32 v48, v48, v92, v93
    v_max3_f32 v48, v48, v94, v95
    v_max_f32 v49, v84, v85
    v_max3_f32 v49, v49, v86, v87
    v_max3_f32 v49, v49, v88, v89
    v_max3_f32 v49, v49, v90, v91
    v_max3_f32 v49, v49, v96, v97
    v_max3_f32 v49, v49, v98, v99
    v_mov_b32 v14, v48
    s_nop 1
    v_permlane16_swap_b32 v48, v14
    v_max_f32 v48, v48, v14
    v_mov_b32 v14, v49
    s_nop 1
    v_permlane16_swap_b32 v49, v14
    v_max_f32 v49, v49, v14
    v_mov_b32 v14, v48
    s_nop 1
    v_permlane32_swap_b32 v48, v14
    v_max_f32 v48, v48, v14
    v_mov_b32 v14, v49
    s_nop 1
    v_permlane32_swap_b32 v49, v14
    v_max_f32 v49, v49, v14
    v_sub_f32 v80, v80, v48
    v_exp_f32 v80, v80
    v_sub_f32 v81, v81, v48
    v_exp_f32 v81, v81
    v_sub_f32 v82, v82, v48
    v_exp_f32 v82, v82
    v_sub_f32 v83, v83, v48
    v_exp_f32 v83, v83
    v_sub_f32 v92, v92, v48
    v_exp_f32 v92, v92
    v_sub_f32 v93, v93, v48
    v_exp_f32 v93, v93
    v_sub_f32 v94, v94, v48
    v_exp_f32 v94, v94
    v_sub_f32 v95, v95, v48
    v_exp_f32 v95, v95
    v_sub_f32 v84, v84, v49
    v_exp_f32 v84, v84
    v_sub_f32 v85, v85, v49
    v_exp_f32 v85, v85
    v_sub_f32 v86, v86, v49
    v_exp_f32 v86, v86
    v_sub_f32 v87, v87, v49
    v_exp_f32 v87, v87
    v_sub_f32 v88, v88, v49
    v_exp_f32 v88, v88
    v_sub_f32 v89, v89, v49
    v_exp_f32 v89, v89
    v_sub_f32 v90, v90, v49
    v_exp_f32 v90, v90
    v_sub_f32 v91, v91, v49
    v_exp_f32 v91, v91
    v_sub_f32 v96, v96, v49
    v_exp_f32 v96, v96
    v_sub_f32 v97, v97, v49
    v_exp_f32 v97, v97
    v_sub_f32 v98, v98, v49
    v_exp_f32 v98, v98
    v_sub_f32 v99, v99, v49
    v_exp_f32 v99, v99
    v_cvt_pk_bf16_f32 v16, v80, v81
    v_cvt_pk_bf16_f32 v17, v82, v83
    v_mov_b64 v[18:19], 0
    v_cvt_pk_bf16_f32 v20, v84, v85
    v_cvt_pk_bf16_f32 v21, v86, v87
    v_cvt_pk_bf16_f32 v22, v88, v89
    v_cvt_pk_bf16_f32 v23, v90, v91
    v_cvt_pk_bf16_f32 v24, v92, v93
    v_cvt_pk_bf16_f32 v25, v94, v95
    v_cvt_pk_bf16_f32 v26, v96, v97
    v_cvt_pk_bf16_f32 v27, v98, v99
    v_mov_b64 v[28:29], s[4:5]
    v_mov_b64 v[30:31], s[4:5]
    s_nop 1
    v_mfma_f32_16x16x32_bf16 v[32:35], v[28:31], v[16:19], 0
    v_mfma_f32_16x16x32_bf16 v[40:43], v[120:123], v[16:19], 0
    v_mfma_f32_16x16x32_bf16 v[44:47], v[124:127], v[16:19], 0
    v_mfma_f32_16x16x32_bf16 v[36:39], v[28:31], v[20:23], 0
    v_mfma_f32_16x16x32_bf16 v[48:51], v[120:123], v[20:23], 0
    v_mfma_f32_16x16x32_bf16 v[52:55], v[124:127], v[20:23], 0
    s_nop 0
    v_mfma_f32_16x16x16_bf16 v[32:35], v[28:29], v[24:25], v[32:35]
    v_mfma_f32_16x16x16_bf16 v[40:43], v[116:117], v[24:25], v[40:43]
    v_mfma_f32_16x16x16_bf16 v[44:47], v[118:119], v[24:25], v[44:47]
    v_mfma_f32_16x16x16_bf16 v[36:39], v[28:29], v[26:27], v[36:39]
    v_mfma_f32_16x16x16_bf16 v[48:51], v[116:117], v[26:27], v[48:51]
    v_mfma_f32_16x16x16_bf16 v[52:55], v[118:119], v[26:27], v[52:55]
    s_nop 2
    v_rcp_f32 v14, v32
    s_nop 0
    v_mul_f32 v40, v40, v14
    v_mul_f32 v41, v41, v14
    v_mul_f32 v42, v42, v14
    v_mul_f32 v43, v43, v14
    v_mul_f32 v44, v44, v14
    v_mul_f32 v45, v45, v14
    v_mul_f32 v46, v46, v14
    v_mul_f32 v47, v47, v14
    v_cvt_pk_bf16_f32 v56, v40, v44
    v_cvt_pk_bf16_f32 v57, v41, v45
    v_cvt_pk_bf16_f32 v58, v42, v46
    v_cvt_pk_bf16_f32 v59, v43, v47
    ds_write_b128 v9, v[56:59] offset:0
    v_rcp_f32 v14, v36
    s_nop 0
    v_mul_f32 v48, v48, v14
    v_mul_f32 v49, v49, v14
    v_mul_f32 v50, v50, v14
    v_mul_f32 v51, v51, v14
    v_mul_f32 v52, v52, v14
    v_mul_f32 v53, v53, v14
    v_mul_f32 v54, v54, v14
    v_mul_f32 v55, v55, v14
    v_cvt_pk_bf16_f32 v60, v48, v52
    v_cvt_pk_bf16_f32 v61, v49, v53
    v_cvt_pk_bf16_f32 v62, v50, v54
    v_cvt_pk_bf16_f32 v63, v51, v55
    ds_write_b128 v9, v[60:63] offset:4096
    s_waitcnt lgkmcnt(0)
    s_barrier
    ds_read_b128 v[16:19], v1 offset:0
    ds_read_b128 v[20:23], v1 offset:1024
    ds_read_b128 v[24:27], v1 offset:2048
    ds_read_b128 v[28:31], v1 offset:3072
    ds_read_b128 v[32:35], v1 offset:4096
    ds_read_b128 v[36:39], v1 offset:5120
    ds_read_b128 v[40:43], v1 offset:6144
    ds_read_b128 v[44:47], v1 offset:7168
    ds_read_b128 v[48:51], v7 offset:0
    ds_read_b128 v[52:55], v7 offset:1024
    ds_read_b128 v[56:59], v7 offset:2048
    ds_read_b128 v[60:63], v7 offset:3072
    s_waitcnt lgkmcnt(3)
    v_mfma_f32_16x16x32_bf16 v[64:67], v[16:19], v[48:51], 0
    v_mfma_f32_16x16x32_bf16 v[96:99], v[32:35], v[48:51], 0
    ds_read_b128 v[48:51], v7 offset:4096
    s_waitcnt lgkmcnt(3)
    v_mfma_f32_16x16x32_bf16 v[68:71], v[16:19], v[52:55], 0
    v_mfma_f32_16x16x32_bf16 v[100:103], v[32:35], v[52:55], 0
    ds_read_b128 v[52:55], v7 offset:5120
    s_waitcnt lgkmcnt(3)
    v_mfma_f32_16x16x32_bf16 v[72:75], v[16:19], v[56:59], 0
    v_mfma_f32_16x16x32_bf16 v[104:107], v[32:35], v[56:59], 0
    ds_read_b128 v[56:59], v7 offset:6144
    s_waitcnt lgkmcnt(3)
    v_mfma_f32_16x16x32_bf16 v[76:79], v[16:19], v[60:63], 0
    v_mfma_f32_16x16x32_bf16 v[108:111], v[32:35], v[60:63], 0
    ds_read_b128 v[60:63], v7 offset:7168
    s_waitcnt lgkmcnt(3)
    v_mfma_f32_16x16x32_bf16 v[80:83], v[16:19], v[48:51], 0
    v_mfma_f32_16x16x32_bf16 v[112:115], v[32:35], v[48:51], 0
    ds_read_b128 v[48:51], v7 offset:8192
    s_waitcnt lgkmcnt(3)
    v_mfma_f32_16x16x32_bf16 v[84:87], v[16:19], v[52:55], 0
    v_mfma_f32_16x16x32_bf16 v[116:119], v[32:35], v[52:55], 0
    ds_read_b128 v[52:55], v7 offset:9216
    s_waitcnt lgkmcnt(3)
    v_mfma_f32_16x16x32_bf16 v[88:91], v[16:19], v[56:59], 0
    v_mfma_f32_16x16x32_bf16 v[120:123], v[32:35], v[56:59], 0
    ds_read_b128 v[56:59], v7 offset:10240
    s_waitcnt lgkmcnt(3)
    v_mfma_f32_16x16x32_bf16 v[92:95], v[16:19], v[60:63], 0
    v_mfma_f32_16x16x32_bf16 v[124:127], v[32:35], v[60:63], 0
    ds_read_b128 v[60:63], v7 offset:11264
    s_waitcnt lgkmcnt(3)
    v_mfma_f32_16x16x32_bf16 v[64:67], v[20:23], v[48:51], v[64:67]
    v_mfma_f32_16x16x32_bf16 v[96:99], v[36:39], v[48:51], v[96:99]
    ds_read_b128 v[48:51], v7 offset:12288
    s_waitcnt lgkmcnt(3)
    v_mfma_f32_16x16x32_bf16 v[68:71], v[20:23], v[52:55], v[68:71]
    v_mfma_f32_16x16x32_bf16 v[100:103], v[36:39], v[52:55], v[100:103]
    ds_read_b128 v[52:55], v7 offset:13312
    s_waitcnt lgkmcnt(3)
    v_mfma_f32_16x16x32_bf16 v[72:75], v[20:23], v[56:59], v[72:75]
    v_mfma_f32_16x16x32_bf16 v[104:107], v[36:39], v[56:59], v[104:107]
    ds_read_b128 v[56:59], v7 offset:14336
    s_waitcnt lgkmcnt(3)
    v_mfma_f32_16x16x32_bf16 v[76:79], v[20:23], v[60:63], v[76:79]
    v_mfma_f32_16x16x32_bf16 v[108:111], v[36:39], v[60:63], v[108:111]
    ds_read_b128 v[60:63], v7 offset:15360
    s_waitcnt lgkmcnt(3)
    v_mfma_f32_16x16x32_bf16 v[80:83], v[20:23], v[48:51], v[80:83]
    v_mfma_f32_16x16x32_bf16 v[112:115], v[36:39], v[48:51], v[112:115]
    ds_read_b128 v[48:51], v7 offset:16384
    s_waitcnt lgkmcnt(3)
    v_mfma_f32_16x16x32_bf16 v[84:87], v[20:23], v[52:55], v[84:87]
    v_mfma_f32_16x16x32_bf16 v[116:119], v[36:39], v[52:55], v[116:119]
    ds_read_b128 v[52:55], v7 offset:17408
    s_waitcnt lgkmcnt(3)
    v_mfma_f32_16x16x32_bf16 v[88:91], v[20:23], v[56:59], v[88:91]
    v_mfma_f32_16x16x32_bf16 v[120:123], v[36:39], v[56:59], v[120:123]
    ds_read_b128 v[56:59], v7 offset:18432
    s_waitcnt lgkmcnt(3)
    v_mfma_f32_16x16x32_bf16 v[92:95], v[20:23], v[60:63], v[92:95]
    v_mfma_f32_16x16x32_bf16 v[124:127], v[36:39], v[60:63], v[124:127]
    ds_read_b128 v[60:63], v7 offset:19456
    s_waitcnt lgkmcnt(3)
    v_mfma_f32_16x16x32_bf16 v[64:67], v[24:27], v[48:51], v[64:67]
    v_mfma_f32_16x16x32_bf16 v[96:99], v[40:43], v[48:51], v[96:99]
    ds_read_b128 v[48:51], v7 offset:20480
    s_waitcnt lgkmcnt(3)
    v_mfma_f32_16x16x32_bf16 v[68:71], v[24:27], v[52:55], v[68:71]
    v_mfma_f32_16x16x32_bf16 v[100:103], v[40:43], v[52:55], v[100:103]
    ds_read_b128 v[52:55], v7 offset:21504
    s_waitcnt lgkmcnt(3)
    v_mfma_f32_16x16x32_bf16 v[72:75], v[24:27], v[56:59], v[72:75]
    v_mfma_f32_16x16x32_bf16 v[104:107], v[40:43], v[56:59], v[104:107]
    ds_read_b128 v[56:59], v7 offset:22528
    s_waitcnt lgkmcnt(3)
    v_mfma_f32_16x16x32_bf16 v[76:79], v[24:27], v[60:63], v[76:79]
    v_mfma_f32_16x16x32_bf16 v[108:111], v[40:43], v[60:63], v[108:111]
    ds_read_b128 v[60:63], v7 offset:23552
    s_waitcnt lgkmcnt(3)
    v_mfma_f32_16x16x32_bf16 v[80:83], v[24:27], v[48:51], v[80:83]
    v_mfma_f32_16x16x32_bf16 v[112:115], v[40:43], v[48:51], v[112:115]
    ds_read_b128 v[48:51], v7 offset:24576
    s_waitcnt lgkmcnt(3)
    v_mfma_f32_16x16x32_bf16 v[84:87], v[24:27], v[52:55], v[84:87]
    v_mfma_f32_16x16x32_bf16 v[116:119], v[40:43], v[52:55], v[116:119]
    ds_read_b128 v[52:55], v7 offset:25600
    s_waitcnt lgkmcnt(3)
    v_mfma_f32_16x16x32_bf16 v[88:91], v[24:27], v[56:59], v[88:91]
    v_mfma_f32_16x16x32_bf16 v[120:123], v[40:43], v[56:59], v[120:123]
    ds_read_b128 v[56:59], v7 offset:26624
    s_waitcnt lgkmcnt(3)
    v_mfma_f32_16x16x32_bf16 v[92:95], v[24:27], v[60:63], v[92:95]
    v_mfma_f32_16x16x32_bf16 v[124:127], v[40:43], v[60:63], v[124:127]
    ds_read_b128 v[60:63], v7 offset:27648
    s_waitcnt lgkmcnt(3)
    v_mfma_f32_16x16x32_bf16 v[64:67], v[28:31], v[48:51], v[64:67]
    v_mfma_f32_16x16x32_bf16 v[96:99], v[44:47], v[48:51], v[96:99]
    ds_read_b128 v[48:51], v7 offset:28672
    s_waitcnt lgkmcnt(3)
    v_mfma_f32_16x16x32_bf16 v[68:71], v[28:31], v[52:55], v[68:71]
    v_mfma_f32_16x16x32_bf16 v[100:103], v[44:47], v[52:55], v[100:103]
    ds_read_b128 v[52:55], v7 offset:29696
    s_waitcnt lgkmcnt(3)
    v_mfma_f32_16x16x32_bf16 v[72:75], v[28:31], v[56:59], v[72:75]
    v_mfma_f32_16x16x32_bf16 v[104:107], v[44:47], v[56:59], v[104:107]
    ds_read_b128 v[56:59], v7 offset:30720
    s_waitcnt lgkmcnt(3)
    v_mfma_f32_16x16x32_bf16 v[76:79], v[28:31], v[60:63], v[76:79]
    v_mfma_f32_16x16x32_bf16 v[108:111], v[44:47], v[60:63], v[108:111]
    ds_read_b128 v[60:63], v7 offset:31744
    s_waitcnt lgkmcnt(3)
    v_mfma_f32_16x16x32_bf16 v[80:83], v[28:31], v[48:51], v[80:83]
    v_mfma_f32_16x16x32_bf16 v[112:115], v[44:47], v[48:51], v[112:115]
    s_waitcnt lgkmcnt(2)
    v_mfma_f32_16x16x32_bf16 v[84:87], v[28:31], v[52:55], v[84:87]
    v_mfma_f32_16x16x32_bf16 v[116:119], v[44:47], v[52:55], v[116:119]
    s_waitcnt lgkmcnt(1)
    v_mfma_f32_16x16x32_bf16 v[88:91], v[28:31], v[56:59], v[88:91]
    v_mfma_f32_16x16x32_bf16 v[120:123], v[44:47], v[56:59], v[120:123]
    s_waitcnt lgkmcnt(0)
    v_mfma_f32_16x16x32_bf16 v[92:95], v[28:31], v[60:63], v[92:95]
    v_mfma_f32_16x16x32_bf16 v[124:127], v[44:47], v[60:63], v[124:127]
    s_lshl_b32 s36, s20, 10
    s_add_u32 s24, s26, s36
    v_cvt_pk_bf16_f32 v16, v64, v68
    v_cvt_pk_bf16_f32 v17, v72, v76
    v_cvt_pk_bf16_f32 v18, v80, v84
    s_nop 1
    v_cvt_pk_bf16_f32 v19, v88, v92
    v_and_or_b32 v16, v16, -2, s27
    s_add_u32 s36, s24, 0x0
    buffer_store_dwordx4 v[16:19], v10, s[8:11], s36 offen sc1
    v_cvt_pk_bf16_f32 v20, v65, v69
    v_cvt_pk_bf16_f32 v21, v73, v77
    v_cvt_pk_bf16_f32 v22, v81, v85
    v_cvt_pk_bf16_f32 v23, v89, v93
    v_and_or_b32 v20, v20, -2, s27
    s_add_u32 s36, s24, 0x8000
    buffer_store_dwordx4 v[20:23], v10, s[8:11], s36 offen sc1
    v_cvt_pk_bf16_f32 v24, v66, v70
    v_cvt_pk_bf16_f32 v25, v74, v78
    v_cvt_pk_bf16_f32 v26, v82, v86
    v_cvt_pk_bf16_f32 v27, v90, v94
    v_and_or_b32 v24, v24, -2, s27
    s_add_u32 s36, s24, 0x10000
    buffer_store_dwordx4 v[24:27], v10, s[8:11], s36 offen sc1
    v_cvt_pk_bf16_f32 v28, v67, v71
    v_cvt_pk_bf16_f32 v29, v75, v79
    v_cvt_pk_bf16_f32 v30, v83, v87
    v_cvt_pk_bf16_f32 v31, v91, v95
    v_and_or_b32 v28, v28, -2, s27
    s_add_u32 s36, s24, 0x18000
    buffer_store_dwordx4 v[28:31], v10, s[8:11], s36 offen sc1
    v_cvt_pk_bf16_f32 v32, v96, v100
    v_cvt_pk_bf16_f32 v33, v104, v108
    v_cvt_pk_bf16_f32 v34, v112, v116
    v_cvt_pk_bf16_f32 v35, v120, v124
    v_and_or_b32 v32, v32, -2, s27
    s_add_u32 s36, s24, 0x80000
    buffer_store_dwordx4 v[32:35], v10, s[8:11], s36 offen sc1
    v_cvt_pk_bf16_f32 v36, v97, v101
    v_cvt_pk_bf16_f32 v37, v105, v109
    v_cvt_pk_bf16_f32 v38, v113, v117
    v_cvt_pk_bf16_f32 v39, v121, v125
    v_and_or_b32 v36, v36, -2, s27
    s_add_u32 s36, s24, 0x88000
    buffer_store_dwordx4 v[36:39], v10, s[8:11], s36 offen sc1
    v_cvt_pk_bf16_f32 v40, v98, v102
    v_cvt_pk_bf16_f32 v41, v106, v110
    v_cvt_pk_bf16_f32 v42, v114, v118
    v_cvt_pk_bf16_f32 v43, v122, v126
    v_and_or_b32 v40, v40, -2, s27
    s_add_u32 s36, s24, 0x90000
    buffer_store_dwordx4 v[40:43], v10, s[8:11], s36 offen sc1
    v_cvt_pk_bf16_f32 v44, v99, v103
    v_cvt_pk_bf16_f32 v45, v107, v111
    v_cvt_pk_bf16_f32 v46, v115, v119
    v_cvt_pk_bf16_f32 v47, v123, v127
    v_and_or_b32 v44, v44, -2, s27
    s_add_u32 s36, s24, 0x98000
    buffer_store_dwordx4 v[44:47], v10, s[8:11], s36 offen sc1
    s_lshl_b32 s24, s23, 5
    s_add_u32 s24, s24, s20
    s_lshl_b32 s24, s24, 10
    buffer_load_dword v52, v12, s[12:15], s24 offen
    buffer_load_dword v53, v12, s[92:95], 0 offen
    v_and_b32 v15, 15, v0
    v_mov_b32 v48, 0
    v_mov_b32 v14, 0x3f80
    v_cmp_eq_u32 vcc, 0, v15
    s_nop 1
    v_cndmask_b32 v48, v48, v14, vcc
    v_mov_b32 v14, 0x3f800000
    v_cmp_eq_u32 vcc, 1, v15
    s_nop 1
    v_cndmask_b32 v48, v48, v14, vcc
    v_mov_b32 v49, 0
    v_mov_b32 v14, 0x3f80
    v_cmp_eq_u32 vcc, 4, v15
    s_nop 1
    v_cndmask_b32 v49, v49, v14, vcc
    v_mov_b32 v14, 0x3f800000
    v_cmp_eq_u32 vcc, 5, v15
    s_nop 1
    v_cndmask_b32 v49, v49, v14, vcc
    v_mov_b32 v50, 0
    v_mov_b32 v14, 0x3f80
    v_cmp_eq_u32 vcc, 8, v15
    s_nop 1
    v_cndmask_b32 v50, v50, v14, vcc
    v_mov_b32 v14, 0x3f800000
    v_cmp_eq_u32 vcc, 9, v15
    s_nop 1
    v_cndmask_b32 v50, v50, v14, vcc
    v_mov_b32 v51, 0
    v_mov_b32 v14, 0x3f80
    v_cmp_eq_u32 vcc, 12, v15
    s_nop 1
    v_cndmask_b32 v51, v51, v14, vcc
    v_mov_b32 v14, 0x3f800000
    v_cmp_eq_u32 vcc, 13, v15
    s_nop 1
    v_cndmask_b32 v51, v51, v14, vcc
    s_lshl_b32 s25, s20, 15
    s_add_u32 s25, s25, s26
L_P3_poll:
    s_add_u32 s36, s25, 0
    buffer_load_dwordx4 v[80:83], v11, s[8:11], s36 offen sc1
    s_add_u32 s36, s25, 4096
    buffer_load_dwordx4 v[84:87], v11, s[8:11], s36 offen sc1
    s_add_u32 s36, s25, 8192
    buffer_load_dwordx4 v[88:91], v11, s[8:11], s36 offen sc1
    s_add_u32 s36, s25, 12288
    buffer_load_dwordx4 v[92:95], v11, s[8:11], s36 offen sc1
    s_add_u32 s36, s25, 16384
    buffer_load_dwordx4 v[96:99], v11, s[8:11], s36 offen sc1
    s_add_u32 s36, s25, 20480
    buffer_load_dwordx4 v[100:103], v11, s[8:11], s36 offen sc1
    s_add_u32 s36, s25, 24576
    buffer_load_dwordx4 v[104:107], v11, s[8:11], s36 offen sc1
    s_add_u32 s36, s25, 28672
    buffer_load_dwordx4 v[108:111], v11, s[8:11], s36 offen sc1
    s_mov_b64 exec, -1
    s_add_u32 s32, s32, 1
    s_cmp_gt_u32 s32, 200000
    s_waitcnt vmcnt(7)
    v_mfma_f32_16x16x32_bf16 v[56:59], v[48:51], v[80:83], 0
    s_waitcnt vmcnt(6)
    v_mfma_f32_16x16x32_bf16 v[56:59], v[48:51], v[84:87], v[56:59]
    v_bitop3_b32 v60, v80, v84, s27 bitop3:0x7e
    s_waitcnt vmcnt(5)
    v_mfma_f32_16x16x32_bf16 v[56:59], v[48:51], v[88:91], v[56:59]
    s_waitcnt vmcnt(4)
    v_mfma_f32_16x16x32_bf16 v[56:59], v[48:51], v[92:95], v[56:59]
    v_bitop3_b32 v61, v88, v92, s27 bitop3:0x7e
    s_waitcnt vmcnt(3)
    v_mfma_f32_16x16x32_bf16 v[56:59], v[48:51], v[96:99], v[56:59]
    s_waitcnt vmcnt(2)
    v_mfma_f32_16x16x32_bf16 v[56:59], v[48:51], v[100:103], v[56:59]
    v_bitop3_b32 v62, v96, v100, s27 bitop3:0x7e
    s_waitcnt vmcnt(1)
    v_mfma_f32_16x16x32_bf16 v[56:59], v[48:51], v[104:107], v[56:59]
    s_waitcnt vmcnt(0)
    v_mfma_f32_16x16x32_bf16 v[56:59], v[48:51], v[108:111], v[56:59]
    v_bitop3_b32 v63, v104, v108, s27 bitop3:0x7e
    v_or3_b32 v14, v60, v61, v62
    v_bitop3_b32 v14, v14, v63, 1 bitop3:0xa8
    s_cbranch_scc1 L_P3_got
    v_cmp_ne_u32 vcc, 0, v14
    s_cbranch_vccz L_P3_got
    s_mov_b64 exec, vcc
    s_branch L_P3_poll
L_P3_got:
    s_nop 4
    v_cvt_pk_bf16_f32 v62, v56, v57
    v_lshlrev_b32 v65, 16, v62
    v_and_b32 v66, 0xffff0000, v62
    v_lshlrev_b32 v60, 16, v52
    v_and_b32 v61, 0xffff0000, v52
    v_add_f32 v60, v60, v65
    v_add_f32 v61, v61, v66
    v_cvt_pk_bf16_f32 v62, v60, v61
    v_lshlrev_b32 v60, 16, v62
    v_and_b32 v61, 0xffff0000, v62
    v_add_f32 v63, v60, v61
    v_mul_f32 v64, v60, v60
    v_fmac_f32 v64, v61, v61
    v_add_f32_dpp v63, v63, v63 quad_perm:[1,0,3,2] row_mask:0xf bank_mask:0xf
    s_nop 0
    v_add_f32_dpp v64, v64, v64 quad_perm:[1,0,3,2] row_mask:0xf bank_mask:0xf
    v_add_f32_dpp v63, v63, v63 quad_perm:[2,3,0,1] row_mask:0xf bank_mask:0xf
    s_nop 0
    v_add_f32_dpp v64, v64, v64 quad_perm:[2,3,0,1] row_mask:0xf bank_mask:0xf
    v_add_f32_dpp v63, v63, v63 row_half_mirror row_mask:0xf bank_mask:0xf
    s_nop 0
    v_add_f32_dpp v64, v64, v64 row_half_mirror row_mask:0xf bank_mask:0xf
    v_add_f32_dpp v63, v63, v63 row_mirror row_mask:0xf bank_mask:0xf
    s_nop 0
    v_add_f32_dpp v64, v64, v64 row_mirror row_mask:0xf bank_mask:0xf
    v_mov_b32 v14, v63
    s_nop 1
    v_permlane16_swap_b32 v63, v14
    v_add_f32 v63, v63, v14
    v_mov_b32 v14, v64
    s_nop 1
    v_permlane16_swap_b32 v64, v14
    v_add_f32 v64, v64, v14
    v_mov_b32 v14, v63
    s_nop 1
    v_permlane32_swap_b32 v63, v14
    v_add_f32 v63, v63, v14
    v_mov_b32 v14, v64
    s_nop 1
    v_permlane32_swap_b32 v64, v14
    v_add_f32 v64, v64, v14
    v_mov_b32 v15, s21
    v_lshlrev_b32 v15, 3, v15
    v_add_u32 v15, 28672, v15
    ds_write2_b32 v15, v63, v64 offset0:0 offset1:1
    s_add_u32 s36, s24, 0x400000
    buffer_store_dword v62, v12, s[8:11], s36 offen sc1
    s_waitcnt lgkmcnt(0)
    s_barrier
    v_mov_b32 v15, 28672
    ds_read_b128 v[68:71], v15
    ds_read_b128 v[72:75], v15 offset:16
    s_waitcnt lgkmcnt(0)
    v_add_f32 v63, v68, v70
    v_add_f32 v63, v63, v72
    v_add_f32 v63, v63, v74
    v_mul_f32 v63, 0x3b000000, v63
    v_add_f32 v64, v69, v71
    v_add_f32 v64, v64, v73
    v_add_f32 v64, v64, v75
    v_mul_f32 v64, 0x3b000000, v64
    v_fma_f32 v64, -v63, v63, v64
    v_max_f32 v64, 0, v64
    v_cvt_pk_bf16_f32 v14, v63, v64
    v_lshlrev_b32 v63, 16, v14
    v_and_b32 v64, 0xffff0000, v14
    v_add_f32 v64, 0x3727c5ac, v64
    v_cvt_pk_bf16_f32 v14, v64, v64
    v_lshlrev_b32 v64, 16, v14
    v_sqrt_f32 v64, v64
    s_nop 0
    v_cvt_pk_bf16_f32 v14, v64, v64
    v_lshlrev_b32 v64, 16, v14
    v_rcp_f32 v64, v64
    v_sub_f32 v65, v60, v63
    v_sub_f32 v66, v61, v63
    v_cvt_pk_bf16_f32 v14, v65, v66
    v_lshlrev_b32 v65, 16, v14
    v_and_b32 v66, 0xffff0000, v14
    v_mul_f32 v65, v65, v64
    v_mul_f32 v66, v66, v64
    v_cvt_pk_bf16_f32 v67, v65, v66
    v_lshlrev_b32 v65, 16, v67
    v_and_b32 v66, 0xffff0000, v67
    v_lshlrev_b32 v68, 16, v53
    v_and_b32 v69, 0xffff0000, v53
    v_mul_f32 v63, v65, v68
    v_fmac_f32 v63, v66, v69
    s_nop 1
    v_add_f32_dpp v63, v63, v63 quad_perm:[1,0,3,2] row_mask:0xf bank_mask:0xf
    s_nop 1
    v_add_f32_dpp v63, v63, v63 quad_perm:[2,3,0,1] row_mask:0xf bank_mask:0xf
    s_nop 1
    v_add_f32_dpp v63, v63, v63 row_half_mirror row_mask:0xf bank_mask:0xf
    s_nop 1
    v_add_f32_dpp v63, v63, v63 row_mirror row_mask:0xf bank_mask:0xf
    v_mov_b32 v14, v63
    s_nop 1
    v_permlane16_swap_b32 v63, v14
    v_add_f32 v63, v63, v14
    v_mov_b32 v14, v63
    s_nop 1
    v_permlane32_swap_b32 v63, v14
    v_add_f32 v63, v63, v14
    s_lshr_b32 s25, s24, 6
    s_lshl_b32 s37, s21, 2
    s_add_u32 s25, s25, s37
    s_add_u32 s36, s25, 0x194000
    v_cmp_ne_u32 vcc, 0, v1
    v_mov_b32 v15, 0x40000000
    s_nop 0
    v_cndmask_b32 v15, v1, v15, vcc
    buffer_store_dword v63, v15, s[8:11], s36 offen sc1
    v_add_f32 v60, v60, v65
    v_add_f32 v61, v61, v66
    v_cvt_pk_bf16_f32 v62, v60, v61
    buffer_store_dword v62, v12, s[60:63], s24 offen sc1
    s_add_u32 s36, s24, 0x600000
    buffer_store_dword v67, v12, s[8:11], s36 offen sc1
    v_mov_b32 v14, 0
    s_add_u32 s36, s25, 0x1b8000
    s_waitcnt vmcnt(0)
    buffer_store_dword v14, v15, s[8:11], s36 offen sc1
    s_add_u32 s29, s29, 1
    s_barrier
    s_add_u32 s23, s23, 6
    s_cmp_lt_u32 s23, 64
    s_cbranch_scc1 L_P2
    s_branch L_end
L_mlp:
    s_lshr_b32 s20, s2, 3
    s_mov_b32 s34, 0x05040100
    s_mov_b32 s35, 0x07060302
    s_mov_b32 s32, 0
    s_mov_b32 s64, s84
    s_and_b32 s65, s85, 0xffff
    s_mov_b32 s66, 0x1c0000
    s_mov_b32 s67, 0x20000
    s_mov_b32 s68, s86
    s_and_b32 s69, s87, 0xffff
    s_mov_b32 s70, 0x1c0000
    s_mov_b32 s71, 0x20000
    s_mov_b32 s76, s88
    s_and_b32 s77, s89, 0xffff
    s_mov_b32 s78, 0x1c0000
    s_mov_b32 s79, 0x20000
    v_and_b32 v3, 31, v0
    v_lshlrev_b32 v3, 2, v3
L_M_hs:
    buffer_load_dword v5, v3, s[16:19], 0 offen offset:128 sc1
    s_add_u32 s32, s32, 1
    s_cmp_gt_u32 s32, 200000
    s_waitcnt vmcnt(0)
    s_cbranch_scc1 L_M_hs_ok
    v_cmp_eq_u32 vcc, 0, v5
    s_cbranch_vccz L_M_hs_ok
    s_sleep 16
    s_branch L_M_hs
L_M_hs_ok:
    v_lshlrev_b32 v3, 4, v0
L_M00_rp:
    s_mov_b32 s36, 0x194000
    buffer_load_dwordx4 v[16:19], v3, s[8:11], s36 offen sc1
    s_add_u32 s32, s32, 1
    v_mov_b32 v5, 0
    s_waitcnt vmcnt(0)
    v_max3_u32 v5, v5, v16, v17
    v_max3_u32 v5, v5, v18, v19
    s_cmp_gt_u32 s32, 200000
    s_cbranch_scc1 L_M00_rp_ok
    v_cmp_eq_u32 vcc, -1, v5
    s_cbranch_vccz L_M00_rp_ok
    s_sleep 64
    s_branch L_M00_rp
L_M00_rp_ok:
    v_add_f32 v16, v16, v17
    v_add_f32 v18, v18, v19
    v_add_f32 v16, v16, v18
    v_cvt_pk_bf16_f32 v5, v16, v16
    v_lshlrev_b32 v16, 16, v5
    v_ashrrev_i32 v5, 31, v16
    v_or_b32 v5, 0x80000000, v5
    v_xor_b32 v5, v5, v16
    v_and_b32 v5, 0xffff0000, v5
    v_sub_u32 v6, 2047, v0
    v_or_b32 v120, v5, v6
    v_lshrrev_b32 v1, 5, v0
    v_and_b32 v2, 31, v0
    s_mov_b32 s36, 229376
    v_mul_lo_u32 v4, v1, s36
    v_lshl_add_u32 v4, v2, 2, v4
    v_mov_b32 v5, 0x40000000
    v_cmp_lt_u32 vcc, 27, v2
    s_nop 1
    v_cndmask_b32 v4, v4, v5, vcc
    s_mul_i32 s23, s20, 112
    s_add_u32 s36, s23, 0
    buffer_load_dword v16, v4, s[64:67], s36 offen
    s_add_u32 s36, s23, 3584
    buffer_load_dword v17, v4, s[64:67], s36 offen
    s_add_u32 s36, s23, 7168
    buffer_load_dword v18, v4, s[64:67], s36 offen
    s_add_u32 s36, s23, 10752
    buffer_load_dword v19, v4, s[64:67], s36 offen
    s_add_u32 s36, s23, 14336
    buffer_load_dword v20, v4, s[64:67], s36 offen
    s_add_u32 s36, s23, 17920
    buffer_load_dword v21, v4, s[64:67], s36 offen
    s_add_u32 s36, s23, 21504
    buffer_load_dword v22, v4, s[64:67], s36 offen
    s_add_u32 s36, s23, 25088
    buffer_load_dword v23, v4, s[64:67], s36 offen
    s_add_u32 s36, s23, 28672
    buffer_load_dword v24, v4, s[64:67], s36 offen
    s_add_u32 s36, s23, 32256
    buffer_load_dword v25, v4, s[64:67], s36 offen
    s_add_u32 s36, s23, 35840
    buffer_load_dword v26, v4, s[64:67], s36 offen
    s_add_u32 s36, s23, 39424
    buffer_load_dword v27, v4, s[64:67], s36 offen
    s_add_u32 s36, s23, 43008
    buffer_load_dword v28, v4, s[64:67], s36 offen
    s_add_u32 s36, s23, 46592
    buffer_load_dword v29, v4, s[64:67], s36 offen
    s_add_u32 s36, s23, 50176
    buffer_load_dword v30, v4, s[64:67], s36 offen
    s_add_u32 s36, s23, 53760
    buffer_load_dword v31, v4, s[64:67], s36 offen
    s_add_u32 s36, s23, 57344
    buffer_load_dword v32, v4, s[64:67], s36 offen
    s_add_u32 s36, s23, 60928
    buffer_load_dword v33, v4, s[64:67], s36 offen
    s_add_u32 s36, s23, 64512
    buffer_load_dword v34, v4, s[64:67], s36 offen
    s_add_u32 s36, s23, 68096
    buffer_load_dword v35, v4, s[64:67], s36 offen
    s_add_u32 s36, s23, 71680
    buffer_load_dword v36, v4, s[64:67], s36 offen
    s_add_u32 s36, s23, 75264
    buffer_load_dword v37, v4, s[64:67], s36 offen
    s_add_u32 s36, s23, 78848
    buffer_load_dword v38, v4, s[64:67], s36 offen
    s_add_u32 s36, s23, 82432
    buffer_load_dword v39, v4, s[64:67], s36 offen
    s_add_u32 s36, s23, 86016
    buffer_load_dword v40, v4, s[64:67], s36 offen
    s_add_u32 s36, s23, 89600
    buffer_load_dword v41, v4, s[64:67], s36 offen
    s_add_u32 s36, s23, 93184
    buffer_load_dword v42, v4, s[64:67], s36 offen
    s_add_u32 s36, s23, 96768
    buffer_load_dword v43, v4, s[64:67], s36 offen
    s_add_u32 s36, s23, 100352
    buffer_load_dword v44, v4, s[64:67], s36 offen
    s_add_u32 s36, s23, 103936
    buffer_load_dword v45, v4, s[64:67], s36 offen
    s_add_u32 s36, s23, 107520
    buffer_load_dword v46, v4, s[64:67], s36 offen
    s_add_u32 s36, s23, 111104
    buffer_load_dword v47, v4, s[64:67], s36 offen
    s_waitcnt vmcnt(0)
    v_perm_b32 v128, v17, v16, s34
    v_perm_b32 v129, v19, v18, s34
    v_perm_b32 v130, v21, v20, s34
    v_perm_b32 v131, v23, v22, s34
    v_perm_b32 v132, v25, v24, s34
    v_perm_b32 v133, v27, v26, s34
    v_perm_b32 v134, v29, v28, s34
    v_perm_b32 v135, v31, v30, s34
    v_perm_b32 v136, v33, v32, s34
    v_perm_b32 v137, v35, v34, s34
    v_perm_b32 v138, v37, v36, s34
    v_perm_b32 v139, v39, v38, s34
    v_perm_b32 v140, v41, v40, s34
    v_perm_b32 v141, v43, v42, s34
    v_perm_b32 v142, v45, v44, s34
    v_perm_b32 v143, v47, v46, s34
    v_perm_b32 v160, v17, v16, s35
    v_perm_b32 v161, v19, v18, s35
    v_perm_b32 v162, v21, v20, s35
    v_perm_b32 v163, v23, v22, s35
    v_perm_b32 v164, v25, v24, s35
    v_perm_b32 v165, v27, v26, s35
    v_perm_b32 v166, v29, v28, s35
    v_perm_b32 v167, v31, v30, s35
    v_perm_b32 v168, v33, v32, s35
    v_perm_b32 v169, v35, v34, s35
    v_perm_b32 v170, v37, v36, s35
    v_perm_b32 v171, v39, v38, s35
    v_perm_b32 v172, v41, v40, s35
    v_perm_b32 v173, v43, v42, s35
    v_perm_b32 v174, v45, v44, s35
    v_perm_b32 v175, v47, v46, s35
    s_add_u32 s36, s23, 114688
    buffer_load_dword v16, v4, s[64:67], s36 offen
    s_add_u32 s36, s23, 118272
    buffer_load_dword v17, v4, s[64:67], s36 offen
    s_add_u32 s36, s23, 121856
    buffer_load_dword v18, v4, s[64:67], s36 offen
    s_add_u32 s36, s23, 125440
    buffer_load_dword v19, v4, s[64:67], s36 offen
    s_add_u32 s36, s23, 129024
    buffer_load_dword v20, v4, s[64:67], s36 offen
    s_add_u32 s36, s23, 132608
    buffer_load_dword v21, v4, s[64:67], s36 offen
    s_add_u32 s36, s23, 136192
    buffer_load_dword v22, v4, s[64:67], s36 offen
    s_add_u32 s36, s23, 139776
    buffer_load_dword v23, v4, s[64:67], s36 offen
    s_add_u32 s36, s23, 143360
    buffer_load_dword v24, v4, s[64:67], s36 offen
    s_add_u32 s36, s23, 146944
    buffer_load_dword v25, v4, s[64:67], s36 offen
    s_add_u32 s36, s23, 150528
    buffer_load_dword v26, v4, s[64:67], s36 offen
    s_add_u32 s36, s23, 154112
    buffer_load_dword v27, v4, s[64:67], s36 offen
    s_add_u32 s36, s23, 157696
    buffer_load_dword v28, v4, s[64:67], s36 offen
    s_add_u32 s36, s23, 161280
    buffer_load_dword v29, v4, s[64:67], s36 offen
    s_add_u32 s36, s23, 164864
    buffer_load_dword v30, v4, s[64:67], s36 offen
    s_add_u32 s36, s23, 168448
    buffer_load_dword v31, v4, s[64:67], s36 offen
    s_add_u32 s36, s23, 172032
    buffer_load_dword v32, v4, s[64:67], s36 offen
    s_add_u32 s36, s23, 175616
    buffer_load_dword v33, v4, s[64:67], s36 offen
    s_add_u32 s36, s23, 179200
    buffer_load_dword v34, v4, s[64:67], s36 offen
    s_add_u32 s36, s23, 182784
    buffer_load_dword v35, v4, s[64:67], s36 offen
    s_add_u32 s36, s23, 186368
    buffer_load_dword v36, v4, s[64:67], s36 offen
    s_add_u32 s36, s23, 189952
    buffer_load_dword v37, v4, s[64:67], s36 offen
    s_add_u32 s36, s23, 193536
    buffer_load_dword v38, v4, s[64:67], s36 offen
    s_add_u32 s36, s23, 197120
    buffer_load_dword v39, v4, s[64:67], s36 offen
    s_add_u32 s36, s23, 200704
    buffer_load_dword v40, v4, s[64:67], s36 offen
    s_add_u32 s36, s23, 204288
    buffer_load_dword v41, v4, s[64:67], s36 offen
    s_add_u32 s36, s23, 207872
    buffer_load_dword v42, v4, s[64:67], s36 offen
    s_add_u32 s36, s23, 211456
    buffer_load_dword v43, v4, s[64:67], s36 offen
    s_add_u32 s36, s23, 215040
    buffer_load_dword v44, v4, s[64:67], s36 offen
    s_add_u32 s36, s23, 218624
    buffer_load_dword v45, v4, s[64:67], s36 offen
    s_add_u32 s36, s23, 222208
    buffer_load_dword v46, v4, s[64:67], s36 offen
    s_add_u32 s36, s23, 225792
    buffer_load_dword v47, v4, s[64:67], s36 offen
    s_waitcnt vmcnt(0)
    v_perm_b32 v144, v17, v16, s34
    v_perm_b32 v145, v19, v18, s34
    v_perm_b32 v146, v21, v20, s34
    v_perm_b32 v147, v23, v22, s34
    v_perm_b32 v148, v25, v24, s34
    v_perm_b32 v149, v27, v26, s34
    v_perm_b32 v150, v29, v28, s34
    v_perm_b32 v151, v31, v30, s34
    v_perm_b32 v152, v33, v32, s34
    v_perm_b32 v153, v35, v34, s34
    v_perm_b32 v154, v37, v36, s34
    v_perm_b32 v155, v39, v38, s34
    v_perm_b32 v156, v41, v40, s34
    v_perm_b32 v157, v43, v42, s34
    v_perm_b32 v158, v45, v44, s34
    v_perm_b32 v159, v47, v46, s34
    v_perm_b32 v176, v17, v16, s35
    v_perm_b32 v177, v19, v18, s35
    v_perm_b32 v178, v21, v20, s35
    v_perm_b32 v179, v23, v22, s35
    v_perm_b32 v180, v25, v24, s35
    v_perm_b32 v181, v27, v26, s35
    v_perm_b32 v182, v29, v28, s35
    v_perm_b32 v183, v31, v30, s35
    v_perm_b32 v184, v33, v32, s35
    v_perm_b32 v185, v35, v34, s35
    v_perm_b32 v186, v37, v36, s35
    v_perm_b32 v187, v39, v38, s35
    v_perm_b32 v188, v41, v40, s35
    v_perm_b32 v189, v43, v42, s35
    v_perm_b32 v190, v45, v44, s35
    v_perm_b32 v191, v47, v46, s35
    s_add_u32 s36, s23, 0
    buffer_load_dword v16, v4, s[68:71], s36 offen
    s_add_u32 s36, s23, 3584
    buffer_load_dword v17, v4, s[68:71], s36 offen
    s_add_u32 s36, s23, 7168
    buffer_load_dword v18, v4, s[68:71], s36 offen
    s_add_u32 s36, s23, 10752
    buffer_load_dword v19, v4, s[68:71], s36 offen
    s_add_u32 s36, s23, 14336
    buffer_load_dword v20, v4, s[68:71], s36 offen
    s_add_u32 s36, s23, 17920
    buffer_load_dword v21, v4, s[68:71], s36 offen
    s_add_u32 s36, s23, 21504
    buffer_load_dword v22, v4, s[68:71], s36 offen
    s_add_u32 s36, s23, 25088
    buffer_load_dword v23, v4, s[68:71], s36 offen
    s_add_u32 s36, s23, 28672
    buffer_load_dword v24, v4, s[68:71], s36 offen
    s_add_u32 s36, s23, 32256
    buffer_load_dword v25, v4, s[68:71], s36 offen
    s_add_u32 s36, s23, 35840
    buffer_load_dword v26, v4, s[68:71], s36 offen
    s_add_u32 s36, s23, 39424
    buffer_load_dword v27, v4, s[68:71], s36 offen
    s_add_u32 s36, s23, 43008
    buffer_load_dword v28, v4, s[68:71], s36 offen
    s_add_u32 s36, s23, 46592
    buffer_load_dword v29, v4, s[68:71], s36 offen
    s_add_u32 s36, s23, 50176
    buffer_load_dword v30, v4, s[68:71], s36 offen
    s_add_u32 s36, s23, 53760
    buffer_load_dword v31, v4, s[68:71], s36 offen
    s_add_u32 s36, s23, 57344
    buffer_load_dword v32, v4, s[68:71], s36 offen
    s_add_u32 s36, s23, 60928
    buffer_load_dword v33, v4, s[68:71], s36 offen
    s_add_u32 s36, s23, 64512
    buffer_load_dword v34, v4, s[68:71], s36 offen
    s_add_u32 s36, s23, 68096
    buffer_load_dword v35, v4, s[68:71], s36 offen
    s_add_u32 s36, s23, 71680
    buffer_load_dword v36, v4, s[68:71], s36 offen
    s_add_u32 s36, s23, 75264
    buffer_load_dword v37, v4, s[68:71], s36 offen
    s_add_u32 s36, s23, 78848
    buffer_load_dword v38, v4, s[68:71], s36 offen
    s_add_u32 s36, s23, 82432
    buffer_load_dword v39, v4, s[68:71], s36 offen
    s_add_u32 s36, s23, 86016
    buffer_load_dword v40, v4, s[68:71], s36 offen
    s_add_u32 s36, s23, 89600
    buffer_load_dword v41, v4, s[68:71], s36 offen
    s_add_u32 s36, s23, 93184
    buffer_load_dword v42, v4, s[68:71], s36 offen
    s_add_u32 s36, s23, 96768
    buffer_load_dword v43, v4, s[68:71], s36 offen
    s_add_u32 s36, s23, 100352
    buffer_load_dword v44, v4, s[68:71], s36 offen
    s_add_u32 s36, s23, 103936
    buffer_load_dword v45, v4, s[68:71], s36 offen
    s_add_u32 s36, s23, 107520
    buffer_load_dword v46, v4, s[68:71], s36 offen
    s_add_u32 s36, s23, 111104
    buffer_load_dword v47, v4, s[68:71], s36 offen
    s_waitcnt vmcnt(0)
    v_perm_b32 v192, v17, v16, s34
    v_perm_b32 v193, v19, v18, s34
    v_perm_b32 v194, v21, v20, s34
    v_perm_b32 v195, v23, v22, s34
    v_perm_b32 v196, v25, v24, s34
    v_perm_b32 v197, v27, v26, s34
    v_perm_b32 v198, v29, v28, s34
    v_perm_b32 v199, v31, v30, s34
    v_perm_b32 v200, v33, v32, s34
    v_perm_b32 v201, v35, v34, s34
    v_perm_b32 v202, v37, v36, s34
    v_perm_b32 v203, v39, v38, s34
    v_perm_b32 v204, v41, v40, s34
    v_perm_b32 v205, v43, v42, s34
    v_perm_b32 v206, v45, v44, s34
    v_perm_b32 v207, v47, v46, s34
    v_perm_b32 v224, v17, v16, s35
    v_perm_b32 v225, v19, v18, s35
    v_perm_b32 v226, v21, v20, s35
    v_perm_b32 v227, v23, v22, s35
    v_perm_b32 v228, v25, v24, s35
    v_perm_b32 v229, v27, v26, s35
    v_perm_b32 v230, v29, v28, s35
    v_perm_b32 v231, v31, v30, s35
    v_perm_b32 v232, v33, v32, s35
    v_perm_b32 v233, v35, v34, s35
    v_perm_b32 v234, v37, v36, s35
    v_perm_b32 v235, v39, v38, s35
    v_perm_b32 v236, v41, v40, s35
    v_perm_b32 v237, v43, v42, s35
    v_perm_b32 v238, v45, v44, s35
    v_perm_b32 v239, v47, v46, s35
    s_add_u32 s36, s23, 114688
    buffer_load_dword v16, v4, s[68:71], s36 offen
    s_add_u32 s36, s23, 118272
    buffer_load_dword v17, v4, s[68:71], s36 offen
    s_add_u32 s36, s23, 121856
    buffer_load_dword v18, v4, s[68:71], s36 offen
    s_add_u32 s36, s23, 125440
    buffer_load_dword v19, v4, s[68:71], s36 offen
    s_add_u32 s36, s23, 129024
    buffer_load_dword v20, v4, s[68:71], s36 offen
    s_add_u32 s36, s23, 132608
    buffer_load_dword v21, v4, s[68:71], s36 offen
    s_add_u32 s36, s23, 136192
    buffer_load_dword v22, v4, s[68:71], s36 offen
    s_add_u32 s36, s23, 139776
    buffer_load_dword v23, v4, s[68:71], s36 offen
    s_add_u32 s36, s23, 143360
    buffer_load_dword v24, v4, s[68:71], s36 offen
    s_add_u32 s36, s23, 146944
    buffer_load_dword v25, v4, s[68:71], s36 offen
    s_add_u32 s36, s23, 150528
    buffer_load_dword v26, v4, s[68:71], s36 offen
    s_add_u32 s36, s23, 154112
    buffer_load_dword v27, v4, s[68:71], s36 offen
    s_add_u32 s36, s23, 157696
    buffer_load_dword v28, v4, s[68:71], s36 offen
    s_add_u32 s36, s23, 161280
    buffer_load_dword v29, v4, s[68:71], s36 offen
    s_add_u32 s36, s23, 164864
    buffer_load_dword v30, v4, s[68:71], s36 offen
    s_add_u32 s36, s23, 168448
    buffer_load_dword v31, v4, s[68:71], s36 offen
    s_add_u32 s36, s23, 172032
    buffer_load_dword v32, v4, s[68:71], s36 offen
    s_add_u32 s36, s23, 175616
    buffer_load_dword v33, v4, s[68:71], s36 offen
    s_add_u32 s36, s23, 179200
    buffer_load_dword v34, v4, s[68:71], s36 offen
    s_add_u32 s36, s23, 182784
    buffer_load_dword v35, v4, s[68:71], s36 offen
    s_add_u32 s36, s23, 186368
    buffer_load_dword v36, v4, s[68:71], s36 offen
    s_add_u32 s36, s23, 189952
    buffer_load_dword v37, v4, s[68:71], s36 offen
    s_add_u32 s36, s23, 193536
    buffer_load_dword v38, v4, s[68:71], s36 offen
    s_add_u32 s36, s23, 197120
    buffer_load_dword v39, v4, s[68:71], s36 offen
    s_add_u32 s36, s23, 200704
    buffer_load_dword v40, v4, s[68:71], s36 offen
    s_add_u32 s36, s23, 204288
    buffer_load_dword v41, v4, s[68:71], s36 offen
    s_add_u32 s36, s23, 207872
    buffer_load_dword v42, v4, s[68:71], s36 offen
    s_add_u32 s36, s23, 211456
    buffer_load_dword v43, v4, s[68:71], s36 offen
    s_add_u32 s36, s23, 215040
    buffer_load_dword v44, v4, s[68:71], s36 offen
    s_add_u32 s36, s23, 218624
    buffer_load_dword v45, v4, s[68:71], s36 offen
    s_add_u32 s36, s23, 222208
    buffer_load_dword v46, v4, s[68:71], s36 offen
    s_add_u32 s36, s23, 225792
    buffer_load_dword v47, v4, s[68:71], s36 offen
    s_waitcnt vmcnt(0)
    v_perm_b32 v208, v17, v16, s34
    v_perm_b32 v209, v19, v18, s34
    v_perm_b32 v210, v21, v20, s34
    v_perm_b32 v211, v23, v22, s34
    v_perm_b32 v212, v25, v24, s34
    v_perm_b32 v213, v27, v26, s34
    v_perm_b32 v214, v29, v28, s34
    v_perm_b32 v215, v31, v30, s34
    v_perm_b32 v216, v33, v32, s34
    v_perm_b32 v217, v35, v34, s34
    v_perm_b32 v218, v37, v36, s34
    v_perm_b32 v219, v39, v38, s34
    v_perm_b32 v220, v41, v40, s34
    v_perm_b32 v221, v43, v42, s34
    v_perm_b32 v222, v45, v44, s34
    v_perm_b32 v223, v47, v46, s34
    v_perm_b32 v240, v17, v16, s35
    v_perm_b32 v241, v19, v18, s35
    v_perm_b32 v242, v21, v20, s35
    v_perm_b32 v243, v23, v22, s35
    v_perm_b32 v244, v25, v24, s35
    v_perm_b32 v245, v27, v26, s35
    v_perm_b32 v246, v29, v28, s35
    v_perm_b32 v247, v31, v30, s35
    v_perm_b32 v248, v33, v32, s35
    v_perm_b32 v249, v35, v34, s35
    v_perm_b32 v250, v37, v36, s35
    v_perm_b32 v251, v39, v38, s35
    v_perm_b32 v252, v41, v40, s35
    v_perm_b32 v253, v43, v42, s35
    v_perm_b32 v254, v45, v44, s35
    v_perm_b32 v255, v47, v46, s35
    v_lshrrev_b32 v3, 3, v0
    v_mul_u32_u24 v4, 57344, v3
    v_and_b32 v3, 7, v0
    v_lshl_add_u32 v4, v3, 2, v4
    s_lshl_b32 s37, s20, 5
    s_add_u32 s36, s37, 0
    buffer_load_dword v16, v4, s[76:79], s36 offen
    s_add_u32 s36, s37, 1024
    buffer_load_dword v17, v4, s[76:79], s36 offen
    s_add_u32 s36, s37, 2048
    buffer_load_dword v18, v4, s[76:79], s36 offen
    s_add_u32 s36, s37, 3072
    buffer_load_dword v19, v4, s[76:79], s36 offen
    s_add_u32 s36, s37, 4096
    buffer_load_dword v20, v4, s[76:79], s36 offen
    s_add_u32 s36, s37, 5120
    buffer_load_dword v21, v4, s[76:79], s36 offen
    s_add_u32 s36, s37, 6144
    buffer_load_dword v22, v4, s[76:79], s36 offen
    s_add_u32 s36, s37, 7168
    buffer_load_dword v23, v4, s[76:79], s36 offen
    s_add_u32 s36, s37, 8192
    buffer_load_dword v24, v4, s[76:79], s36 offen
    s_add_u32 s36, s37, 9216
    buffer_load_dword v25, v4, s[76:79], s36 offen
    s_add_u32 s36, s37, 10240
    buffer_load_dword v26, v4, s[76:79], s36 offen
    s_add_u32 s36, s37, 11264
    buffer_load_dword v27, v4, s[76:79], s36 offen
    s_add_u32 s36, s37, 12288
    buffer_load_dword v28, v4, s[76:79], s36 offen
    s_add_u32 s36, s37, 13312
    buffer_load_dword v29, v4, s[76:79], s36 offen
    s_add_u32 s36, s37, 14336
    buffer_load_dword v30, v4, s[76:79], s36 offen
    s_add_u32 s36, s37, 15360
    buffer_load_dword v31, v4, s[76:79], s36 offen
    s_add_u32 s36, s37, 16384
    buffer_load_dword v32, v4, s[76:79], s36 offen
    s_add_u32 s36, s37, 17408
    buffer_load_dword v33, v4, s[76:79], s36 offen
    s_add_u32 s36, s37, 18432
    buffer_load_dword v34, v4, s[76:79], s36 offen
    s_add_u32 s36, s37, 19456
    buffer_load_dword v35, v4, s[76:79], s36 offen
    s_add_u32 s36, s37, 20480
    buffer_load_dword v36, v4, s[76:79], s36 offen
    s_add_u32 s36, s37, 21504
    buffer_load_dword v37, v4, s[76:79], s36 offen
    s_add_u32 s36, s37, 22528
    buffer_load_dword v38, v4, s[76:79], s36 offen
    s_add_u32 s36, s37, 23552
    buffer_load_dword v39, v4, s[76:79], s36 offen
    s_add_u32 s36, s37, 24576
    buffer_load_dword v40, v4, s[76:79], s36 offen
    s_add_u32 s36, s37, 25600
    buffer_load_dword v41, v4, s[76:79], s36 offen
    s_add_u32 s36, s37, 26624
    buffer_load_dword v42, v4, s[76:79], s36 offen
    s_add_u32 s36, s37, 27648
    buffer_load_dword v43, v4, s[76:79], s36 offen
    s_waitcnt vmcnt(0)
    v_perm_b32 v64, v17, v16, s34
    v_perm_b32 v65, v19, v18, s34
    v_perm_b32 v66, v21, v20, s34
    v_perm_b32 v67, v23, v22, s34
    v_perm_b32 v68, v25, v24, s34
    v_perm_b32 v69, v27, v26, s34
    v_perm_b32 v70, v29, v28, s34
    v_perm_b32 v71, v31, v30, s34
    v_perm_b32 v72, v33, v32, s34
    v_perm_b32 v73, v35, v34, s34
    v_perm_b32 v74, v37, v36, s34
    v_perm_b32 v75, v39, v38, s34
    v_perm_b32 v76, v41, v40, s34
    v_perm_b32 v77, v43, v42, s34
    v_perm_b32 v92, v17, v16, s35
    v_perm_b32 v93, v19, v18, s35
    v_perm_b32 v94, v21, v20, s35
    v_perm_b32 v95, v23, v22, s35
    v_perm_b32 v96, v25, v24, s35
    v_perm_b32 v97, v27, v26, s35
    v_perm_b32 v98, v29, v28, s35
    v_perm_b32 v99, v31, v30, s35
    v_perm_b32 v100, v33, v32, s35
    v_perm_b32 v101, v35, v34, s35
    v_perm_b32 v102, v37, v36, s35
    v_perm_b32 v103, v39, v38, s35
    v_perm_b32 v104, v41, v40, s35
    v_perm_b32 v105, v43, v42, s35
    s_add_u32 s36, s37, 28672
    buffer_load_dword v16, v4, s[76:79], s36 offen
    s_add_u32 s36, s37, 29696
    buffer_load_dword v17, v4, s[76:79], s36 offen
    s_add_u32 s36, s37, 30720
    buffer_load_dword v18, v4, s[76:79], s36 offen
    s_add_u32 s36, s37, 31744
    buffer_load_dword v19, v4, s[76:79], s36 offen
    s_add_u32 s36, s37, 32768
    buffer_load_dword v20, v4, s[76:79], s36 offen
    s_add_u32 s36, s37, 33792
    buffer_load_dword v21, v4, s[76:79], s36 offen
    s_add_u32 s36, s37, 34816
    buffer_load_dword v22, v4, s[76:79], s36 offen
    s_add_u32 s36, s37, 35840
    buffer_load_dword v23, v4, s[76:79], s36 offen
    s_add_u32 s36, s37, 36864
    buffer_load_dword v24, v4, s[76:79], s36 offen
    s_add_u32 s36, s37, 37888
    buffer_load_dword v25, v4, s[76:79], s36 offen
    s_add_u32 s36, s37, 38912
    buffer_load_dword v26, v4, s[76:79], s36 offen
    s_add_u32 s36, s37, 39936
    buffer_load_dword v27, v4, s[76:79], s36 offen
    s_add_u32 s36, s37, 40960
    buffer_load_dword v28, v4, s[76:79], s36 offen
    s_add_u32 s36, s37, 41984
    buffer_load_dword v29, v4, s[76:79], s36 offen
    s_add_u32 s36, s37, 43008
    buffer_load_dword v30, v4, s[76:79], s36 offen
    s_add_u32 s36, s37, 44032
    buffer_load_dword v31, v4, s[76:79], s36 offen
    s_add_u32 s36, s37, 45056
    buffer_load_dword v32, v4, s[76:79], s36 offen
    s_add_u32 s36, s37, 46080
    buffer_load_dword v33, v4, s[76:79], s36 offen
    s_add_u32 s36, s37, 47104
    buffer_load_dword v34, v4, s[76:79], s36 offen
    s_add_u32 s36, s37, 48128
    buffer_load_dword v35, v4, s[76:79], s36 offen
    s_add_u32 s36, s37, 49152
    buffer_load_dword v36, v4, s[76:79], s36 offen
    s_add_u32 s36, s37, 50176
    buffer_load_dword v37, v4, s[76:79], s36 offen
    s_add_u32 s36, s37, 51200
    buffer_load_dword v38, v4, s[76:79], s36 offen
    s_add_u32 s36, s37, 52224
    buffer_load_dword v39, v4, s[76:79], s36 offen
    s_add_u32 s36, s37, 53248
    buffer_load_dword v40, v4, s[76:79], s36 offen
    s_add_u32 s36, s37, 54272
    buffer_load_dword v41, v4, s[76:79], s36 offen
    s_add_u32 s36, s37, 55296
    buffer_load_dword v42, v4, s[76:79], s36 offen
    s_add_u32 s36, s37, 56320
    buffer_load_dword v43, v4, s[76:79], s36 offen
    s_waitcnt vmcnt(0)
    v_perm_b32 v78, v17, v16, s34
    v_perm_b32 v79, v19, v18, s34
    v_perm_b32 v80, v21, v20, s34
    v_perm_b32 v81, v23, v22, s34
    v_perm_b32 v82, v25, v24, s34
    v_perm_b32 v83, v27, v26, s34
    v_perm_b32 v84, v29, v28, s34
    v_perm_b32 v85, v31, v30, s34
    v_perm_b32 v86, v33, v32, s34
    v_perm_b32 v87, v35, v34, s34
    v_perm_b32 v88, v37, v36, s34
    v_perm_b32 v89, v39, v38, s34
    v_perm_b32 v90, v41, v40, s34
    v_perm_b32 v91, v43, v42, s34
    v_perm_b32 v106, v17, v16, s35
    v_perm_b32 v107, v19, v18, s35
    v_perm_b32 v108, v21, v20, s35
    v_perm_b32 v109, v23, v22, s35
    v_perm_b32 v110, v25, v24, s35
    v_perm_b32 v111, v27, v26, s35
    v_perm_b32 v112, v29, v28, s35
    v_perm_b32 v113, v31, v30, s35
    v_perm_b32 v114, v33, v32, s35
    v_perm_b32 v115, v35, v34, s35
    v_perm_b32 v116, v37, v36, s35
    v_perm_b32 v117, v39, v38, s35
    v_perm_b32 v118, v41, v40, s35
    v_perm_b32 v119, v43, v42, s35
    s_mov_b32 s24, 0
    s_mov_b64 s[28:29], 0
    v_mov_b32 v12, 0x40000000
    v_mov_b32 v13, 0
    v_lshlrev_b32 v3, 4, v0
L_M06_rp:
    s_mov_b32 s36, 0x19a000
    buffer_load_dwordx4 v[40:43], v3, s[8:11], s36 offen sc1
    s_add_u32 s32, s32, 1
    v_mov_b32 v5, 0
    s_waitcnt vmcnt(0)
    v_max3_u32 v5, v5, v40, v41
    v_max3_u32 v5, v5, v42, v43
    s_cmp_gt_u32 s32, 200000
    s_cbranch_scc1 L_M06_rp_ok
    v_cmp_eq_u32 vcc, -1, v5
    s_cbranch_vccz L_M06_rp_ok
    s_sleep 32
    s_branch L_M06_rp
L_M06_rp_ok:
    v_add_f32 v40, v40, v41
    v_add_f32 v42, v42, v43
    v_add_f32 v40, v40, v42
    v_cvt_pk_bf16_f32 v5, v40, v40
    v_lshlrev_b32 v40, 16, v5
    v_ashrrev_i32 v5, 31, v40
    v_or_b32 v5, 0x80000000, v5
    v_xor_b32 v5, v5, v40
    v_and_b32 v5, 0xffff0000, v5
    v_sub_u32 v6, 511, v0
    v_or_b32 v126, v5, v6
    v_lshlrev_b32 v3, 4, v0
L_M01_rp:
    s_mov_b32 s36, 0x195000
    buffer_load_dwordx4 v[20:23], v3, s[8:11], s36 offen sc1
    s_mov_b32 s36, 0x196000
    buffer_load_dwordx4 v[24:27], v3, s[8:11], s36 offen sc1
    s_mov_b32 s36, 0x197000
    buffer_load_dwordx4 v[28:31], v3, s[8:11], s36 offen sc1
    s_mov_b32 s36, 0x198000
    buffer_load_dwordx4 v[32:35], v3, s[8:11], s36 offen sc1
    s_mov_b32 s36, 0x199000
    buffer_load_dwordx4 v[36:39], v3, s[8:11], s36 offen sc1
    s_add_u32 s32, s32, 1
    v_mov_b32 v5, 0
    s_waitcnt vmcnt(0)
    v_max3_u32 v5, v5, v20, v21
    v_max3_u32 v5, v5, v22, v23
    v_max3_u32 v5, v5, v24, v25
    v_max3_u32 v5, v5, v26, v27
    v_max3_u32 v5, v5, v28, v29
    v_max3_u32 v5, v5, v30, v31
    v_max3_u32 v5, v5, v32, v33
    v_max3_u32 v5, v5, v34, v35
    v_max3_u32 v5, v5, v36, v37
    v_max3_u32 v5, v5, v38, v39
    s_cmp_gt_u32 s32, 200000
    s_cbranch_scc1 L_M01_rp_ok
    v_cmp_eq_u32 vcc, -1, v5
    s_cbranch_vccz L_M01_rp_ok
    s_sleep 8
    s_branch L_M01_rp
L_M01_rp_ok:
    v_add_f32 v20, v20, v21
    v_add_f32 v22, v22, v23
    v_add_f32 v20, v20, v22
    v_cvt_pk_bf16_f32 v5, v20, v20
    v_lshlrev_b32 v20, 16, v5
    v_ashrrev_i32 v5, 31, v20
    v_or_b32 v5, 0x80000000, v5
    v_xor_b32 v5, v5, v20
    v_and_b32 v5, 0xffff0000, v5
    v_sub_u32 v6, 1791, v0
    v_or_b32 v121, v5, v6
    v_add_f32 v24, v24, v25
    v_add_f32 v26, v26, v27
    v_add_f32 v24, v24, v26
    v_cvt_pk_bf16_f32 v5, v24, v24
    v_lshlrev_b32 v24, 16, v5
    v_ashrrev_i32 v5, 31, v24
    v_or_b32 v5, 0x80000000, v5
    v_xor_b32 v5, v5, v24
    v_and_b32 v5, 0xffff0000, v5
    v_sub_u32 v6, 1535, v0
    v_or_b32 v122, v5, v6
    v_add_f32 v28, v28, v29
    v_add_f32 v30, v30, v31
    v_add_f32 v28, v28, v30
    v_cvt_pk_bf16_f32 v5, v28, v28
    v_lshlrev_b32 v28, 16, v5
    v_ashrrev_i32 v5, 31, v28
    v_or_b32 v5, 0x80000000, v5
    v_xor_b32 v5, v5, v28
    v_and_b32 v5, 0xffff0000, v5
    v_sub_u32 v6, 1279, v0
    v_or_b32 v123, v5, v6
    v_add_f32 v32, v32, v33
    v_add_f32 v34, v34, v35
    v_add_f32 v32, v32, v34
    v_cvt_pk_bf16_f32 v5, v32, v32
    v_lshlrev_b32 v32, 16, v5
    v_ashrrev_i32 v5, 31, v32
    v_or_b32 v5, 0x80000000, v5
    v_xor_b32 v5, v5, v32
    v_and_b32 v5, 0xffff0000, v5
    v_sub_u32 v6, 1023, v0
    v_or_b32 v124, v5, v6
    v_add_f32 v36, v36, v37
    v_add_f32 v38, v38, v39
    v_add_f32 v36, v36, v38
    v_cvt_pk_bf16_f32 v5, v36, v36
    v_lshlrev_b32 v36, 16, v5
    v_ashrrev_i32 v5, 31, v36
    v_or_b32 v5, 0x80000000, v5
    v_xor_b32 v5, v5, v36
    v_and_b32 v5, 0xffff0000, v5
    v_sub_u32 v6, 767, v0
    v_or_b32 v125, v5, v6
    v_max_u32 v5, v120, v121
    v_min_u32 v6, v120, v121
    v_med3_u32 v6, v5, v6, v122
    v_max_u32 v5, v5, v122
    v_med3_u32 v6, v5, v6, v123
    v_max_u32 v5, v5, v123
    v_med3_u32 v6, v5, v6, v124
    v_max_u32 v5, v5, v124
    v_med3_u32 v6, v5, v6, v125
    v_max_u32 v5, v5, v125
    v_med3_u32 v6, v5, v6, v126
    v_max_u32 v5, v5, v126
    v_mov_b32 v120, v5
    v_mov_b32 v121, v6
    s_mov_b32 s25, 32
L_M_round:
    v_lshlrev_b32 v3, 4, v0
    v_cmp_gt_u32 s[74:75], s25, v0
L_M7_rp:
    s_mov_b32 s36, 0x19b000
    buffer_load_dwordx4 v[44:47], v3, s[8:11], s36 offen sc1
    s_add_u32 s32, s32, 1
    v_mov_b32 v5, 0
    s_waitcnt vmcnt(0)
    v_max3_u32 v5, v5, v44, v45
    v_max3_u32 v5, v5, v46, v47
    v_cndmask_b32 v5, 0, v5, s[74:75]
    s_cmp_gt_u32 s32, 200000
    s_cbranch_scc1 L_M7_rp_ok
    v_cmp_eq_u32 vcc, -1, v5
    s_cbranch_vccnz L_M7_rp
L_M7_rp_ok:
    v_add_f32 v44, v44, v45
    v_add_f32 v46, v46, v47
    v_add_f32 v44, v44, v46
    v_cvt_pk_bf16_f32 v5, v44, v44
    v_lshlrev_b32 v44, 16, v5
    v_ashrrev_i32 v5, 31, v44
    v_or_b32 v5, 0x80000000, v5
    v_xor_b32 v5, v5, v44
    v_and_b32 v5, 0xffff0000, v5
    v_sub_u32 v6, 255, v0
    v_or_b32 v127, v5, v6
    v_cndmask_b32 v127, 0, v127, s[74:75]
    v_max_u32 v5, v120, v127
    v_med3_u32 v6, v120, v121, v127
    s_nop 0
    v_mov_b32_dpp v7, v5 quad_perm:[1,0,3,2] row_mask:0xf bank_mask:0xf
    v_mov_b32_dpp v8, v6 quad_perm:[1,0,3,2] row_mask:0xf bank_mask:0xf
    v_min_u32 v9, v5, v7
    v_max_u32 v5, v5, v7
    v_max3_u32 v6, v6, v8, v9
    s_nop 0
    v_mov_b32_dpp v7, v5 quad_perm:[2,3,0,1] row_mask:0xf bank_mask:0xf
    v_mov_b32_dpp v8, v6 quad_perm:[2,3,0,1] row_mask:0xf bank_mask:0xf
    v_min_u32 v9, v5, v7
    v_max_u32 v5, v5, v7
    v_max3_u32 v6, v6, v8, v9
    s_nop 0
    v_mov_b32_dpp v7, v5 row_half_mirror row_mask:0xf bank_mask:0xf
    v_mov_b32_dpp v8, v6 row_half_mirror row_mask:0xf bank_mask:0xf
    v_min_u32 v9, v5, v7
    v_max_u32 v5, v5, v7
    v_max3_u32 v6, v6, v8, v9
    s_nop 0
    v_mov_b32_dpp v7, v5 row_mirror row_mask:0xf bank_mask:0xf
    v_mov_b32_dpp v8, v6 row_mirror row_mask:0xf bank_mask:0xf
    v_min_u32 v9, v5, v7
    v_max_u32 v5, v5, v7
    v_max3_u32 v6, v6, v8, v9
    v_lshrrev_b32 v9, 4, v0
    v_lshlrev_b32 v9, 3, v9
    s_barrier
    ds_write2_b32 v9, v5, v6 offset0:0 offset1:1
    v_and_b32 v9, 15, v0
    v_lshlrev_b32 v9, 3, v9
    s_waitcnt lgkmcnt(0)
    s_barrier
    ds_read2_b32 v[10:11], v9 offset0:0 offset1:1
    s_waitcnt lgkmcnt(0)
    v_mov_b32 v5, v10
    v_mov_b32 v6, v11
    s_nop 0
    v_mov_b32_dpp v7, v5 quad_perm:[1,0,3,2] row_mask:0xf bank_mask:0xf
    v_mov_b32_dpp v8, v6 quad_perm:[1,0,3,2] row_mask:0xf bank_mask:0xf
    v_min_u32 v9, v5, v7
    v_max_u32 v5, v5, v7
    v_max3_u32 v6, v6, v8, v9
    s_nop 0
    v_mov_b32_dpp v7, v5 quad_perm:[2,3,0,1] row_mask:0xf bank_mask:0xf
    v_mov_b32_dpp v8, v6 quad_perm:[2,3,0,1] row_mask:0xf bank_mask:0xf
    v_min_u32 v9, v5, v7
    v_max_u32 v5, v5, v7
    v_max3_u32 v6, v6, v8, v9
    s_nop 0
    v_mov_b32_dpp v7, v5 row_half_mirror row_mask:0xf bank_mask:0xf
    v_mov_b32_dpp v8, v6 row_half_mirror row_mask:0xf bank_mask:0xf
    v_min_u32 v9, v5, v7
    v_max_u32 v5, v5, v7
    v_max3_u32 v6, v6, v8, v9
    s_nop 0
    v_mov_b32_dpp v7, v5 row_mirror row_mask:0xf bank_mask:0xf
    v_mov_b32_dpp v8, v6 row_mirror row_mask:0xf bank_mask:0xf
    v_min_u32 v9, v5, v7
    v_max_u32 v5, v5, v7
    v_max3_u32 v6, v6, v8, v9
    v_readfirstlane_b32 s26, v5
    v_readfirstlane_b32 s27, v6
    s_nop 3
    s_cmp_eq_u64 s[26:27], s[28:29]
    s_cbranch_scc1 L_M_next
    s_mov_b64 s[28:29], s[26:27]
    s_and_b32 s36, s26, 0x7ff
    s_sub_u32 s30, 2047, s36
    s_and_b32 s36, s26, 0xffff0000
    s_xor_b32 s37, s36, 0x80000000
    s_xor_b32 s40, s36, 0xffff0000
    s_bitcmp1_b32 s36, 31
    s_cselect_b32 s40, s37, s40
    s_and_b32 s36, s27, 0x7ff
    s_sub_u32 s31, 2047, s36
    s_and_b32 s36, s27, 0xffff0000
    s_xor_b32 s37, s36, 0x80000000
    s_xor_b32 s41, s36, 0xffff0000
    s_bitcmp1_b32 s36, 31
    s_cselect_b32 s41, s37, s41
    v_mov_b32 v8, 0
L_M_rows:
    s_lshl_b32 s36, s30, 4
    s_add_u32 s36, s36, 0x1b8000
    buffer_load_dwordx4 v[16:19], v8, s[8:11], s36 offen sc1
    s_lshl_b32 s36, s31, 4
    s_add_u32 s36, s36, 0x1b8000
    buffer_load_dwordx4 v[20:23], v8, s[8:11], s36 offen sc1
    s_add_u32 s32, s32, 1
    s_cmp_gt_u32 s32, 200000
    s_waitcnt vmcnt(0)
    v_or3_b32 v5, v16, v17, v18
    v_or3_b32 v5, v5, v19, v20
    v_or3_b32 v5, v5, v21, v22
    v_or_b32 v5, v5, v23
    s_cbranch_scc1 L_M_rows_ok
    v_cmp_ne_u32 vcc, 0, v5
    s_cbranch_vccnz L_M_rows
L_M_rows_ok:
    v_bfe_u32 v9, v0, 6, 1
    v_cmp_ne_u32 vcc, 0, v9
    v_mov_b32 v5, s30
    v_mov_b32 v6, s31
    v_cndmask_b32 v7, v5, v6, vcc
    v_lshlrev_b32 v7, 10, v7
    v_and_b32 v8, 63, v0
    v_lshl_add_u32 v7, v8, 4, v7
    s_mov_b32 s37, 0x600000
    buffer_load_dwordx4 v[16:19], v7, s[8:11], s37 offen sc1
    v_bfe_u32 v9, v0, 3, 1
    v_cmp_ne_u32 vcc, 0, v9
    s_nop 1
    v_cndmask_b32 v12, v5, v6, vcc
    v_mov_b32 v5, s40
    v_mov_b32 v6, s41
    v_cndmask_b32 v11, v5, v6, vcc
    v_lshlrev_b32 v12, 10, v12
    v_and_b32 v3, 7, v0
    v_lshl_add_u32 v12, v3, 2, v12
    s_lshl_b32 s36, s20, 5
    v_add_u32 v12, s36, v12
    v_mov_b32 v7, 0x40000000
    v_cmp_lt_u32 vcc, 15, v0
    s_nop 1
    v_cndmask_b32 v12, v12, v7, vcc
    s_mov_b32 s36, 0x400000
    buffer_load_dword v14, v12, s[8:11], s36 offen sc1
    buffer_load_dword v15, v12, s[8:11], s37 offen sc1
    v_and_b32 v8, 127, v0
    v_lshlrev_b32 v8, 4, v8
    s_waitcnt vmcnt(2)
    ds_write_b128 v8, v[16:19] offset:4096
    s_waitcnt lgkmcnt(0)
    s_barrier
    v_mov_b64 v[48:49], 0
    v_mov_b64 v[50:51], 0
    v_mov_b64 v[52:53], 0
    v_mov_b64 v[54:55], 0
    v_lshlrev_b32 v8, 7, v1
    ds_read_b128 v[16:19], v8 offset:4096
    ds_read_b128 v[20:23], v8 offset:4112
    ds_read_b128 v[24:27], v8 offset:4128
    ds_read_b128 v[28:31], v8 offset:4144
    ds_read_b128 v[32:35], v8 offset:5120
    ds_read_b128 v[36:39], v8 offset:5136
    ds_read_b128 v[40:43], v8 offset:5152
    ds_read_b128 v[44:47], v8 offset:5168
    s_waitcnt lgkmcnt(0)
    v_dot2_f32_bf16 v48, v16, v128, v48
    v_dot2_f32_bf16 v49, v16, v160, v49
    v_dot2_f32_bf16 v50, v32, v128, v50
    v_dot2_f32_bf16 v51, v32, v160, v51
    v_dot2_f32_bf16 v52, v16, v192, v52
    v_dot2_f32_bf16 v53, v16, v224, v53
    v_dot2_f32_bf16 v54, v32, v192, v54
    v_dot2_f32_bf16 v55, v32, v224, v55
    v_dot2_f32_bf16 v48, v17, v129, v48
    v_dot2_f32_bf16 v49, v17, v161, v49
    v_dot2_f32_bf16 v50, v33, v129, v50
    v_dot2_f32_bf16 v51, v33, v161, v51
    v_dot2_f32_bf16 v52, v17, v193, v52
    v_dot2_f32_bf16 v53, v17, v225, v53
    v_dot2_f32_bf16 v54, v33, v193, v54
    v_dot2_f32_bf16 v55, v33, v225, v55
    v_dot2_f32_bf16 v48, v18, v130, v48
    v_dot2_f32_bf16 v49, v18, v162, v49
    v_dot2_f32_bf16 v50, v34, v130, v50
    v_dot2_f32_bf16 v51, v34, v162, v51
    v_dot2_f32_bf16 v52, v18, v194, v52
    v_dot2_f32_bf16 v53, v18, v226, v53
    v_dot2_f32_bf16 v54, v34, v194, v54
    v_dot2_f32_bf16 v55, v34, v226, v55
    v_dot2_f32_bf16 v48, v19, v131, v48
    v_dot2_f32_bf16 v49, v19, v163, v49
    v_dot2_f32_bf16 v50, v35, v131, v50
    v_dot2_f32_bf16 v51, v35, v163, v51
    v_dot2_f32_bf16 v52, v19, v195, v52
    v_dot2_f32_bf16 v53, v19, v227, v53
    v_dot2_f32_bf16 v54, v35, v195, v54
    v_dot2_f32_bf16 v55, v35, v227, v55
    v_dot2_f32_bf16 v48, v20, v132, v48
    v_dot2_f32_bf16 v49, v20, v164, v49
    v_dot2_f32_bf16 v50, v36, v132, v50
    v_dot2_f32_bf16 v51, v36, v164, v51
    v_dot2_f32_bf16 v52, v20, v196, v52
    v_dot2_f32_bf16 v53, v20, v228, v53
    v_dot2_f32_bf16 v54, v36, v196, v54
    v_dot2_f32_bf16 v55, v36, v228, v55
    v_dot2_f32_bf16 v48, v21, v133, v48
    v_dot2_f32_bf16 v49, v21, v165, v49
    v_dot2_f32_bf16 v50, v37, v133, v50
    v_dot2_f32_bf16 v51, v37, v165, v51
    v_dot2_f32_bf16 v52, v21, v197, v52
    v_dot2_f32_bf16 v53, v21, v229, v53
    v_dot2_f32_bf16 v54, v37, v197, v54
    v_dot2_f32_bf16 v55, v37, v229, v55
    v_dot2_f32_bf16 v48, v22, v134, v48
    v_dot2_f32_bf16 v49, v22, v166, v49
    v_dot2_f32_bf16 v50, v38, v134, v50
    v_dot2_f32_bf16 v51, v38, v166, v51
    v_dot2_f32_bf16 v52, v22, v198, v52
    v_dot2_f32_bf16 v53, v22, v230, v53
    v_dot2_f32_bf16 v54, v38, v198, v54
    v_dot2_f32_bf16 v55, v38, v230, v55
    v_dot2_f32_bf16 v48, v23, v135, v48
    v_dot2_f32_bf16 v49, v23, v167, v49
    v_dot2_f32_bf16 v50, v39, v135, v50
    v_dot2_f32_bf16 v51, v39, v167, v51
    v_dot2_f32_bf16 v52, v23, v199, v52
    v_dot2_f32_bf16 v53, v23, v231, v53
    v_dot2_f32_bf16 v54, v39, v199, v54
    v_dot2_f32_bf16 v55, v39, v231, v55
    v_dot2_f32_bf16 v48, v24, v136, v48
    v_dot2_f32_bf16 v49, v24, v168, v49
    v_dot2_f32_bf16 v50, v40, v136, v50
    v_dot2_f32_bf16 v51, v40, v168, v51
    v_dot2_f32_bf16 v52, v24, v200, v52
    v_dot2_f32_bf16 v53, v24, v232, v53
    v_dot2_f32_bf16 v54, v40, v200, v54
    v_dot2_f32_bf16 v55, v40, v232, v55
    v_dot2_f32_bf16 v48, v25, v137, v48
    v_dot2_f32_bf16 v49, v25, v169, v49
    v_dot2_f32_bf16 v50, v41, v137, v50
    v_dot2_f32_bf16 v51, v41, v169, v51
    v_dot2_f32_bf16 v52, v25, v201, v52
    v_dot2_f32_bf16 v53, v25, v233, v53
    v_dot2_f32_bf16 v54, v41, v201, v54
    v_dot2_f32_bf16 v55, v41, v233, v55
    v_dot2_f32_bf16 v48, v26, v138, v48
    v_dot2_f32_bf16 v49, v26, v170, v49
    v_dot2_f32_bf16 v50, v42, v138, v50
    v_dot2_f32_bf16 v51, v42, v170, v51
    v_dot2_f32_bf16 v52, v26, v202, v52
    v_dot2_f32_bf16 v53, v26, v234, v53
    v_dot2_f32_bf16 v54, v42, v202, v54
    v_dot2_f32_bf16 v55, v42, v234, v55
    v_dot2_f32_bf16 v48, v27, v139, v48
    v_dot2_f32_bf16 v49, v27, v171, v49
    v_dot2_f32_bf16 v50, v43, v139, v50
    v_dot2_f32_bf16 v51, v43, v171, v51
    v_dot2_f32_bf16 v52, v27, v203, v52
    v_dot2_f32_bf16 v53, v27, v235, v53
    v_dot2_f32_bf16 v54, v43, v203, v54
    v_dot2_f32_bf16 v55, v43, v235, v55
    v_dot2_f32_bf16 v48, v28, v140, v48
    v_dot2_f32_bf16 v49, v28, v172, v49
    v_dot2_f32_bf16 v50, v44, v140, v50
    v_dot2_f32_bf16 v51, v44, v172, v51
    v_dot2_f32_bf16 v52, v28, v204, v52
    v_dot2_f32_bf16 v53, v28, v236, v53
    v_dot2_f32_bf16 v54, v44, v204, v54
    v_dot2_f32_bf16 v55, v44, v236, v55
    v_dot2_f32_bf16 v48, v29, v141, v48
    v_dot2_f32_bf16 v49, v29, v173, v49
    v_dot2_f32_bf16 v50, v45, v141, v50
    v_dot2_f32_bf16 v51, v45, v173, v51
    v_dot2_f32_bf16 v52, v29, v205, v52
    v_dot2_f32_bf16 v53, v29, v237, v53
    v_dot2_f32_bf16 v54, v45, v205, v54
    v_dot2_f32_bf16 v55, v45, v237, v55
    v_dot2_f32_bf16 v48, v30, v142, v48
    v_dot2_f32_bf16 v49, v30, v174, v49
    v_dot2_f32_bf16 v50, v46, v142, v50
    v_dot2_f32_bf16 v51, v46, v174, v51
    v_dot2_f32_bf16 v52, v30, v206, v52
    v_dot2_f32_bf16 v53, v30, v238, v53
    v_dot2_f32_bf16 v54, v46, v206, v54
    v_dot2_f32_bf16 v55, v46, v238, v55
    v_dot2_f32_bf16 v48, v31, v143, v48
    v_dot2_f32_bf16 v49, v31, v175, v49
    v_dot2_f32_bf16 v50, v47, v143, v50
    v_dot2_f32_bf16 v51, v47, v175, v51
    v_dot2_f32_bf16 v52, v31, v207, v52
    v_dot2_f32_bf16 v53, v31, v239, v53
    v_dot2_f32_bf16 v54, v47, v207, v54
    v_dot2_f32_bf16 v55, v47, v239, v55
    ds_read_b128 v[16:19], v8 offset:4160
    ds_read_b128 v[20:23], v8 offset:4176
    ds_read_b128 v[24:27], v8 offset:4192
    ds_read_b128 v[28:31], v8 offset:4208
    ds_read_b128 v[32:35], v8 offset:5184
    ds_read_b128 v[36:39], v8 offset:5200
    ds_read_b128 v[40:43], v8 offset:5216
    ds_read_b128 v[44:47], v8 offset:5232
    s_waitcnt lgkmcnt(0)
    v_dot2_f32_bf16 v48, v16, v144, v48
    v_dot2_f32_bf16 v49, v16, v176, v49
    v_dot2_f32_bf16 v50, v32, v144, v50
    v_dot2_f32_bf16 v51, v32, v176, v51
    v_dot2_f32_bf16 v52, v16, v208, v52
    v_dot2_f32_bf16 v53, v16, v240, v53
    v_dot2_f32_bf16 v54, v32, v208, v54
    v_dot2_f32_bf16 v55, v32, v240, v55
    v_dot2_f32_bf16 v48, v17, v145, v48
    v_dot2_f32_bf16 v49, v17, v177, v49
    v_dot2_f32_bf16 v50, v33, v145, v50
    v_dot2_f32_bf16 v51, v33, v177, v51
    v_dot2_f32_bf16 v52, v17, v209, v52
    v_dot2_f32_bf16 v53, v17, v241, v53
    v_dot2_f32_bf16 v54, v33, v209, v54
    v_dot2_f32_bf16 v55, v33, v241, v55
    v_dot2_f32_bf16 v48, v18, v146, v48
    v_dot2_f32_bf16 v49, v18, v178, v49
    v_dot2_f32_bf16 v50, v34, v146, v50
    v_dot2_f32_bf16 v51, v34, v178, v51
    v_dot2_f32_bf16 v52, v18, v210, v52
    v_dot2_f32_bf16 v53, v18, v242, v53
    v_dot2_f32_bf16 v54, v34, v210, v54
    v_dot2_f32_bf16 v55, v34, v242, v55
    v_dot2_f32_bf16 v48, v19, v147, v48
    v_dot2_f32_bf16 v49, v19, v179, v49
    v_dot2_f32_bf16 v50, v35, v147, v50
    v_dot2_f32_bf16 v51, v35, v179, v51
    v_dot2_f32_bf16 v52, v19, v211, v52
    v_dot2_f32_bf16 v53, v19, v243, v53
    v_dot2_f32_bf16 v54, v35, v211, v54
    v_dot2_f32_bf16 v55, v35, v243, v55
    v_dot2_f32_bf16 v48, v20, v148, v48
    v_dot2_f32_bf16 v49, v20, v180, v49
    v_dot2_f32_bf16 v50, v36, v148, v50
    v_dot2_f32_bf16 v51, v36, v180, v51
    v_dot2_f32_bf16 v52, v20, v212, v52
    v_dot2_f32_bf16 v53, v20, v244, v53
    v_dot2_f32_bf16 v54, v36, v212, v54
    v_dot2_f32_bf16 v55, v36, v244, v55
    v_dot2_f32_bf16 v48, v21, v149, v48
    v_dot2_f32_bf16 v49, v21, v181, v49
    v_dot2_f32_bf16 v50, v37, v149, v50
    v_dot2_f32_bf16 v51, v37, v181, v51
    v_dot2_f32_bf16 v52, v21, v213, v52
    v_dot2_f32_bf16 v53, v21, v245, v53
    v_dot2_f32_bf16 v54, v37, v213, v54
    v_dot2_f32_bf16 v55, v37, v245, v55
    v_dot2_f32_bf16 v48, v22, v150, v48
    v_dot2_f32_bf16 v49, v22, v182, v49
    v_dot2_f32_bf16 v50, v38, v150, v50
    v_dot2_f32_bf16 v51, v38, v182, v51
    v_dot2_f32_bf16 v52, v22, v214, v52
    v_dot2_f32_bf16 v53, v22, v246, v53
    v_dot2_f32_bf16 v54, v38, v214, v54
    v_dot2_f32_bf16 v55, v38, v246, v55
    v_dot2_f32_bf16 v48, v23, v151, v48
    v_dot2_f32_bf16 v49, v23, v183, v49
    v_dot2_f32_bf16 v50, v39, v151, v50
    v_dot2_f32_bf16 v51, v39, v183, v51
    v_dot2_f32_bf16 v52, v23, v215, v52
    v_dot2_f32_bf16 v53, v23, v247, v53
    v_dot2_f32_bf16 v54, v39, v215, v54
    v_dot2_f32_bf16 v55, v39, v247, v55
    v_dot2_f32_bf16 v48, v24, v152, v48
    v_dot2_f32_bf16 v49, v24, v184, v49
    v_dot2_f32_bf16 v50, v40, v152, v50
    v_dot2_f32_bf16 v51, v40, v184, v51
    v_dot2_f32_bf16 v52, v24, v216, v52
    v_dot2_f32_bf16 v53, v24, v248, v53
    v_dot2_f32_bf16 v54, v40, v216, v54
    v_dot2_f32_bf16 v55, v40, v248, v55
    v_dot2_f32_bf16 v48, v25, v153, v48
    v_dot2_f32_bf16 v49, v25, v185, v49
    v_dot2_f32_bf16 v50, v41, v153, v50
    v_dot2_f32_bf16 v51, v41, v185, v51
    v_dot2_f32_bf16 v52, v25, v217, v52
    v_dot2_f32_bf16 v53, v25, v249, v53
    v_dot2_f32_bf16 v54, v41, v217, v54
    v_dot2_f32_bf16 v55, v41, v249, v55
    v_dot2_f32_bf16 v48, v26, v154, v48
    v_dot2_f32_bf16 v49, v26, v186, v49
    v_dot2_f32_bf16 v50, v42, v154, v50
    v_dot2_f32_bf16 v51, v42, v186, v51
    v_dot2_f32_bf16 v52, v26, v218, v52
    v_dot2_f32_bf16 v53, v26, v250, v53
    v_dot2_f32_bf16 v54, v42, v218, v54
    v_dot2_f32_bf16 v55, v42, v250, v55
    v_dot2_f32_bf16 v48, v27, v155, v48
    v_dot2_f32_bf16 v49, v27, v187, v49
    v_dot2_f32_bf16 v50, v43, v155, v50
    v_dot2_f32_bf16 v51, v43, v187, v51
    v_dot2_f32_bf16 v52, v27, v219, v52
    v_dot2_f32_bf16 v53, v27, v251, v53
    v_dot2_f32_bf16 v54, v43, v219, v54
    v_dot2_f32_bf16 v55, v43, v251, v55
    v_dot2_f32_bf16 v48, v28, v156, v48
    v_dot2_f32_bf16 v49, v28, v188, v49
    v_dot2_f32_bf16 v50, v44, v156, v50
    v_dot2_f32_bf16 v51, v44, v188, v51
    v_dot2_f32_bf16 v52, v28, v220, v52
    v_dot2_f32_bf16 v53, v28, v252, v53
    v_dot2_f32_bf16 v54, v44, v220, v54
    v_dot2_f32_bf16 v55, v44, v252, v55
    v_dot2_f32_bf16 v48, v29, v157, v48
    v_dot2_f32_bf16 v49, v29, v189, v49
    v_dot2_f32_bf16 v50, v45, v157, v50
    v_dot2_f32_bf16 v51, v45, v189, v51
    v_dot2_f32_bf16 v52, v29, v221, v52
    v_dot2_f32_bf16 v53, v29, v253, v53
    v_dot2_f32_bf16 v54, v45, v221, v54
    v_dot2_f32_bf16 v55, v45, v253, v55
    v_dot2_f32_bf16 v48, v30, v158, v48
    v_dot2_f32_bf16 v49, v30, v190, v49
    v_dot2_f32_bf16 v50, v46, v158, v50
    v_dot2_f32_bf16 v51, v46, v190, v51
    v_dot2_f32_bf16 v52, v30, v222, v52
    v_dot2_f32_bf16 v53, v30, v254, v53
    v_dot2_f32_bf16 v54, v46, v222, v54
    v_dot2_f32_bf16 v55, v46, v254, v55
    v_dot2_f32_bf16 v48, v31, v159, v48
    v_dot2_f32_bf16 v49, v31, v191, v49
    v_dot2_f32_bf16 v50, v47, v159, v50
    v_dot2_f32_bf16 v51, v47, v191, v51
    v_dot2_f32_bf16 v52, v31, v223, v52
    v_dot2_f32_bf16 v53, v31, v255, v53
    v_dot2_f32_bf16 v54, v47, v223, v54
    v_dot2_f32_bf16 v55, v47, v255, v55
    s_nop 3
    v_lshlrev_b32 v7, 5, v0
    ds_write_b128 v7, v[48:51] offset:8192
    ds_write_b128 v7, v[52:55] offset:8208
    s_waitcnt lgkmcnt(0)
    s_barrier
    v_lshlrev_b32 v7, 5, v2
    v_bfe_u32 v8, v0, 5, 1
    v_lshl_add_u32 v7, v8, 3, v7
    ds_read_b64 v[16:17], v7 offset:8192
    ds_read_b64 v[18:19], v7 offset:8208
    ds_read_b64 v[20:21], v7 offset:9216
    ds_read_b64 v[22:23], v7 offset:9232
    ds_read_b64 v[24:25], v7 offset:10240
    ds_read_b64 v[26:27], v7 offset:10256
    ds_read_b64 v[28:29], v7 offset:11264
    ds_read_b64 v[30:31], v7 offset:11280
    s_waitcnt lgkmcnt(0)
    ds_read_b64 v[32:33], v7 offset:12288
    ds_read_b64 v[34:35], v7 offset:12304
    ds_read_b64 v[36:37], v7 offset:13312
    ds_read_b64 v[38:39], v7 offset:13328
    ds_read_b64 v[40:41], v7 offset:14336
    ds_read_b64 v[42:43], v7 offset:14352
    ds_read_b64 v[44:45], v7 offset:15360
    ds_read_b64 v[46:47], v7 offset:15376
    s_waitcnt lgkmcnt(0)
    v_add_f32 v16, v16, v20
    v_add_f32 v16, v16, v24
    v_add_f32 v16, v16, v28
    v_add_f32 v16, v16, v32
    v_add_f32 v16, v16, v36
    v_add_f32 v16, v16, v40
    v_add_f32 v16, v16, v44
    v_cvt_pk_bf16_f32 v5, v16, v16
    v_lshlrev_b32 v16, 16, v5
    v_add_f32 v17, v17, v21
    v_add_f32 v17, v17, v25
    v_add_f32 v17, v17, v29
    v_add_f32 v17, v17, v33
    v_add_f32 v17, v17, v37
    v_add_f32 v17, v17, v41
    v_add_f32 v17, v17, v45
    v_cvt_pk_bf16_f32 v5, v17, v17
    v_lshlrev_b32 v17, 16, v5
    v_add_f32 v18, v18, v22
    v_add_f32 v18, v18, v26
    v_add_f32 v18, v18, v30
    v_add_f32 v18, v18, v34
    v_add_f32 v18, v18, v38
    v_add_f32 v18, v18, v42
    v_add_f32 v18, v18, v46
    v_cvt_pk_bf16_f32 v5, v18, v18
    v_lshlrev_b32 v18, 16, v5
    v_add_f32 v19, v19, v23
    v_add_f32 v19, v19, v27
    v_add_f32 v19, v19, v31
    v_add_f32 v19, v19, v35
    v_add_f32 v19, v19, v39
    v_add_f32 v19, v19, v43
    v_add_f32 v19, v19, v47
    v_cvt_pk_bf16_f32 v5, v19, v19
    v_lshlrev_b32 v19, 16, v5
    v_mul_f32 v6, 0xbfb8aa3b, v16
    v_exp_f32 v6, v6
    s_nop 0
    v_add_f32 v6, 1.0, v6
    v_rcp_f32 v6, v6
    s_nop 0
    v_mul_f32 v16, v16, v6
    v_cvt_pk_bf16_f32 v5, v16, v16
    v_lshlrev_b32 v16, 16, v5
    v_mul_f32 v16, v16, v18
    v_mul_f32 v6, 0xbfb8aa3b, v17
    v_exp_f32 v6, v6
    s_nop 0
    v_add_f32 v6, 1.0, v6
    v_rcp_f32 v6, v6
    s_nop 0
    v_mul_f32 v17, v17, v6
    v_cvt_pk_bf16_f32 v5, v17, v17
    v_lshlrev_b32 v17, 16, v5
    v_mul_f32 v17, v17, v19
    v_cvt_pk_bf16_f32 v16, v16, v17
    v_mul_u32_u24 v8, 3584, v8
    v_lshl_add_u32 v7, v2, 2, v8
    v_mov_b32 v6, 0x40000000
    v_cmp_lt_u32 vcc, 27, v2
    s_nop 1
    v_cndmask_b32 v7, v7, v6, vcc
    v_cmp_lt_u32 vcc, 63, v0
    s_nop 1
    v_cndmask_b32 v7, v7, v6, vcc
    s_mul_i32 s37, s24, 8192
    s_add_u32 s37, s37, 0x1b0000
    s_add_u32 s36, s37, s23
    buffer_store_dword v16, v7, s[8:11], s36 offen sc1
    v_lshlrev_b32 v7, 4, v0
    v_add_u32 v8, 4096, v7
    v_cmp_lt_u32 vcc, 191, v0
    s_nop 1
    v_cndmask_b32 v8, v8, v6, vcc
L_M_act:
    buffer_load_dwordx4 v[20:23], v7, s[8:11], s37 offen sc1
    buffer_load_dwordx4 v[24:27], v8, s[8:11], s37 offen sc1
    s_add_u32 s32, s32, 1
    s_cmp_gt_u32 s32, 200000
    s_waitcnt vmcnt(0)
    v_max3_u32 v5, v20, v21, v22
    v_max3_u32 v5, v5, v23, v24
    v_max3_u32 v5, v5, v25, v26
    v_max_u32 v5, v5, v27
    s_cbranch_scc1 L_M_act_ok
    v_cmp_eq_u32 vcc, -1, v5
    s_cbranch_vccnz L_M_act
L_M_act_ok:
    ds_write_b128 v7, v[20:23] offset:16384
    ds_write_b128 v7, v[24:27] offset:20480
    s_waitcnt lgkmcnt(0)
    s_barrier
    v_lshrrev_b32 v7, 3, v0
    v_mul_u32_u24 v7, 112, v7
    v_mov_b64 v[48:49], 0
    v_mov_b64 v[50:51], 0
    ds_read_b128 v[16:19], v7 offset:16384
    ds_read_b128 v[20:23], v7 offset:16400
    ds_read_b128 v[24:27], v7 offset:16416
    ds_read_b128 v[28:31], v7 offset:16432
    ds_read_b128 v[32:35], v7 offset:16448
    ds_read_b128 v[36:39], v7 offset:16464
    ds_read_b128 v[40:43], v7 offset:16480
    s_waitcnt lgkmcnt(0)
    v_dot2_f32_bf16 v48, v16, v64, v48
    v_dot2_f32_bf16 v49, v16, v92, v49
    v_dot2_f32_bf16 v48, v17, v65, v48
    v_dot2_f32_bf16 v49, v17, v93, v49
    v_dot2_f32_bf16 v48, v18, v66, v48
    v_dot2_f32_bf16 v49, v18, v94, v49
    v_dot2_f32_bf16 v48, v19, v67, v48
    v_dot2_f32_bf16 v49, v19, v95, v49
    v_dot2_f32_bf16 v48, v20, v68, v48
    v_dot2_f32_bf16 v49, v20, v96, v49
    v_dot2_f32_bf16 v48, v21, v69, v48
    v_dot2_f32_bf16 v49, v21, v97, v49
    v_dot2_f32_bf16 v48, v22, v70, v48
    v_dot2_f32_bf16 v49, v22, v98, v49
    v_dot2_f32_bf16 v48, v23, v71, v48
    v_dot2_f32_bf16 v49, v23, v99, v49
    v_dot2_f32_bf16 v48, v24, v72, v48
    v_dot2_f32_bf16 v49, v24, v100, v49
    v_dot2_f32_bf16 v48, v25, v73, v48
    v_dot2_f32_bf16 v49, v25, v101, v49
    v_dot2_f32_bf16 v48, v26, v74, v48
    v_dot2_f32_bf16 v49, v26, v102, v49
    v_dot2_f32_bf16 v48, v27, v75, v48
    v_dot2_f32_bf16 v49, v27, v103, v49
    v_dot2_f32_bf16 v48, v28, v76, v48
    v_dot2_f32_bf16 v49, v28, v104, v49
    v_dot2_f32_bf16 v48, v29, v77, v48
    v_dot2_f32_bf16 v49, v29, v105, v49
    v_dot2_f32_bf16 v48, v30, v78, v48
    v_dot2_f32_bf16 v49, v30, v106, v49
    v_dot2_f32_bf16 v48, v31, v79, v48
    v_dot2_f32_bf16 v49, v31, v107, v49
    v_dot2_f32_bf16 v48, v32, v80, v48
    v_dot2_f32_bf16 v49, v32, v108, v49
    v_dot2_f32_bf16 v48, v33, v81, v48
    v_dot2_f32_bf16 v49, v33, v109, v49
    v_dot2_f32_bf16 v48, v34, v82, v48
    v_dot2_f32_bf16 v49, v34, v110, v49
    v_dot2_f32_bf16 v48, v35, v83, v48
    v_dot2_f32_bf16 v49, v35, v111, v49
    v_dot2_f32_bf16 v48, v36, v84, v48
    v_dot2_f32_bf16 v49, v36, v112, v49
    v_dot2_f32_bf16 v48, v37, v85, v48
    v_dot2_f32_bf16 v49, v37, v113, v49
    v_dot2_f32_bf16 v48, v38, v86, v48
    v_dot2_f32_bf16 v49, v38, v114, v49
    v_dot2_f32_bf16 v48, v39, v87, v48
    v_dot2_f32_bf16 v49, v39, v115, v49
    v_dot2_f32_bf16 v48, v40, v88, v48
    v_dot2_f32_bf16 v49, v40, v116, v49
    v_dot2_f32_bf16 v48, v41, v89, v48
    v_dot2_f32_bf16 v49, v41, v117, v49
    v_dot2_f32_bf16 v48, v42, v90, v48
    v_dot2_f32_bf16 v49, v42, v118, v49
    v_dot2_f32_bf16 v48, v43, v91, v48
    v_dot2_f32_bf16 v49, v43, v119, v49
    ds_read_b128 v[16:19], v7 offset:19968
    ds_read_b128 v[20:23], v7 offset:19984
    ds_read_b128 v[24:27], v7 offset:20000
    ds_read_b128 v[28:31], v7 offset:20016
    ds_read_b128 v[32:35], v7 offset:20032
    ds_read_b128 v[36:39], v7 offset:20048
    ds_read_b128 v[40:43], v7 offset:20064
    s_waitcnt lgkmcnt(0)
    v_dot2_f32_bf16 v50, v16, v64, v50
    v_dot2_f32_bf16 v51, v16, v92, v51
    v_dot2_f32_bf16 v50, v17, v65, v50
    v_dot2_f32_bf16 v51, v17, v93, v51
    v_dot2_f32_bf16 v50, v18, v66, v50
    v_dot2_f32_bf16 v51, v18, v94, v51
    v_dot2_f32_bf16 v50, v19, v67, v50
    v_dot2_f32_bf16 v51, v19, v95, v51
    v_dot2_f32_bf16 v50, v20, v68, v50
    v_dot2_f32_bf16 v51, v20, v96, v51
    v_dot2_f32_bf16 v50, v21, v69, v50
    v_dot2_f32_bf16 v51, v21, v97, v51
    v_dot2_f32_bf16 v50, v22, v70, v50
    v_dot2_f32_bf16 v51, v22, v98, v51
    v_dot2_f32_bf16 v50, v23, v71, v50
    v_dot2_f32_bf16 v51, v23, v99, v51
    v_dot2_f32_bf16 v50, v24, v72, v50
    v_dot2_f32_bf16 v51, v24, v100, v51
    v_dot2_f32_bf16 v50, v25, v73, v50
    v_dot2_f32_bf16 v51, v25, v101, v51
    v_dot2_f32_bf16 v50, v26, v74, v50
    v_dot2_f32_bf16 v51, v26, v102, v51
    v_dot2_f32_bf16 v50, v27, v75, v50
    v_dot2_f32_bf16 v51, v27, v103, v51
    v_dot2_f32_bf16 v50, v28, v76, v50
    v_dot2_f32_bf16 v51, v28, v104, v51
    v_dot2_f32_bf16 v50, v29, v77, v50
    v_dot2_f32_bf16 v51, v29, v105, v51
    v_dot2_f32_bf16 v50, v30, v78, v50
    v_dot2_f32_bf16 v51, v30, v106, v51
    v_dot2_f32_bf16 v50, v31, v79, v50
    v_dot2_f32_bf16 v51, v31, v107, v51
    v_dot2_f32_bf16 v50, v32, v80, v50
    v_dot2_f32_bf16 v51, v32, v108, v51
    v_dot2_f32_bf16 v50, v33, v81, v50
    v_dot2_f32_bf16 v51, v33, v109, v51
    v_dot2_f32_bf16 v50, v34, v82, v50
    v_dot2_f32_bf16 v51, v34, v110, v51
    v_dot2_f32_bf16 v50, v35, v83, v50
    v_dot2_f32_bf16 v51, v35, v111, v51
    v_dot2_f32_bf16 v50, v36, v84, v50
    v_dot2_f32_bf16 v51, v36, v112, v51
    v_dot2_f32_bf16 v50, v37, v85, v50
    v_dot2_f32_bf16 v51, v37, v113, v51
    v_dot2_f32_bf16 v50, v38, v86, v50
    v_dot2_f32_bf16 v51, v38, v114, v51
    v_dot2_f32_bf16 v50, v39, v87, v50
    v_dot2_f32_bf16 v51, v39, v115, v51
    v_dot2_f32_bf16 v50, v40, v88, v50
    v_dot2_f32_bf16 v51, v40, v116, v51
    v_dot2_f32_bf16 v50, v41, v89, v50
    v_dot2_f32_bf16 v51, v41, v117, v51
    v_dot2_f32_bf16 v50, v42, v90, v50
    v_dot2_f32_bf16 v51, v42, v118, v51
    v_dot2_f32_bf16 v50, v43, v91, v50
    v_dot2_f32_bf16 v51, v43, v119, v51
    s_nop 3
    v_add_f32_dpp v48, v48, v48 row_ror:8 row_mask:0xf bank_mask:0xf
    v_add_f32_dpp v49, v49, v49 row_ror:8 row_mask:0xf bank_mask:0xf
    v_add_f32_dpp v50, v50, v50 row_ror:8 row_mask:0xf bank_mask:0xf
    v_add_f32_dpp v51, v51, v51 row_ror:8 row_mask:0xf bank_mask:0xf
    v_mov_b32 v5, v48
    s_nop 1
    v_permlane16_swap_b32 v48, v5
    v_add_f32 v48, v48, v5
    v_mov_b32 v5, v49
    s_nop 1
    v_permlane16_swap_b32 v49, v5
    v_add_f32 v49, v49, v5
    v_mov_b32 v5, v50
    s_nop 1
    v_permlane16_swap_b32 v50, v5
    v_add_f32 v50, v50, v5
    v_mov_b32 v5, v51
    s_nop 1
    v_permlane16_swap_b32 v51, v5
    v_add_f32 v51, v51, v5
    v_mov_b32 v5, v48
    s_nop 1
    v_permlane32_swap_b32 v48, v5
    v_add_f32 v48, v48, v5
    v_mov_b32 v5, v49
    s_nop 1
    v_permlane32_swap_b32 v49, v5
    v_add_f32 v49, v49, v5
    v_mov_b32 v5, v50
    s_nop 1
    v_permlane32_swap_b32 v50, v5
    v_add_f32 v50, v50, v5
    v_mov_b32 v5, v51
    s_nop 1
    v_permlane32_swap_b32 v51, v5
    v_add_f32 v51, v51, v5
    v_lshrrev_b32 v7, 6, v0
    v_lshlrev_b32 v7, 7, v7
    v_lshl_add_u32 v7, v3, 4, v7
    ds_write_b128 v7, v[48:51] offset:1024
    s_waitcnt lgkmcnt(0)
    s_barrier
    v_lshlrev_b32 v7, 4, v3
    v_lshl_add_u32 v7, v9, 3, v7
    ds_read_b64 v[16:17], v7 offset:1024
    ds_read_b64 v[18:19], v7 offset:1152
    ds_read_b64 v[20:21], v7 offset:1280
    ds_read_b64 v[22:23], v7 offset:1408
    v_mul_f32 v10, 0xbfb8aa3b, v11
    v_exp_f32 v10, v10
    s_nop 0
    v_add_f32 v10, 1.0, v10
    v_rcp_f32 v10, v10
    s_nop 0
    v_cvt_pk_bf16_f32 v5, v10, v10
    v_lshlrev_b32 v10, 16, v5
    s_waitcnt lgkmcnt(0)
    v_lshlrev_b32 v24, 16, v15
    v_and_b32 v25, 0xffff0000, v15
    v_lshlrev_b32 v26, 16, v14
    v_and_b32 v27, 0xffff0000, v14
    v_add_f32 v16, v16, v18
    v_add_f32 v20, v20, v22
    v_add_f32 v16, v16, v20
    v_cvt_pk_bf16_f32 v5, v16, v16
    v_lshlrev_b32 v16, 16, v5
    v_mul_f32 v16, v16, v10
    v_cvt_pk_bf16_f32 v5, v16, v16
    v_lshlrev_b32 v16, 16, v5
    v_add_f32 v16, v16, v24
    v_cvt_pk_bf16_f32 v5, v16, v16
    v_lshlrev_b32 v16, 16, v5
    v_add_f32 v16, v16, v26
    v_add_f32 v17, v17, v19
    v_add_f32 v21, v21, v23
    v_add_f32 v17, v17, v21
    v_cvt_pk_bf16_f32 v5, v17, v17
    v_lshlrev_b32 v17, 16, v5
    v_mul_f32 v17, v17, v10
    v_cvt_pk_bf16_f32 v5, v17, v17
    v_lshlrev_b32 v17, 16, v5
    v_add_f32 v17, v17, v25
    v_cvt_pk_bf16_f32 v5, v17, v17
    v_lshlrev_b32 v17, 16, v5
    v_add_f32 v17, v17, v27
    v_cvt_pk_bf16_f32 v13, v16, v17
L_M_next:
    s_add_u32 s24, s24, 1
    s_mov_b32 s25, 192
    s_cmp_eq_u32 s24, 1
    s_cbranch_scc1 L_M_round
    s_mov_b32 s25, 256
    s_cmp_eq_u32 s24, 2
    s_cbranch_scc1 L_M_round
    buffer_store_dword v13, v12, s[60:63], 0 offen sc1
L_end:
    s_endpgm
.section .rodata,"a"
.p2align 6
.amdhsa_kernel sequential_preLN__memory_aug_recurrent_mem_tr__moe_arch_mod__prompt_kernel
  .amdhsa_next_free_vgpr 512
  .amdhsa_next_free_sgpr 102
  .amdhsa_accum_offset 256
  .amdhsa_group_segment_fixed_size 0
  .amdhsa_kernarg_size 120
  .amdhsa_user_sgpr_count 2
  .amdhsa_user_sgpr_kernarg_segment_ptr 1
  .amdhsa_system_sgpr_workgroup_id_x 1
.end_amdhsa_kernel
```

```asm
; @launch grid=(256,1,1) block=(256,1,1) lds=163840
.amdgcn_target "amdgcn-amd-amdhsa--gfx950"
.text
.globl sequential_preLN__memory_aug_recurrent_mem_tr__moe_arch_mod__prompt_kernel
.p2align 8
.type sequential_preLN__memory_aug_recurrent_mem_tr__moe_arch_mod__prompt_kernel,@function
sequential_preLN__memory_aug_recurrent_mem_tr__moe_arch_mod__prompt_kernel:
    s_cmp_ge_u32 s2, 256
    s_cbranch_scc1 L_end
    s_load_dwordx8 s[44:51], s[0:1], 0
    s_load_dwordx4 s[52:55], s[0:1], 32
    s_load_dwordx4 s[56:59], s[0:1], 104
    s_load_dwordx2 s[80:81], s[0:1], 64
    s_load_dwordx2 s[82:83], s[0:1], 96
    s_load_dwordx4 s[84:87], s[0:1], 72
    s_load_dwordx2 s[88:89], s[0:1], 88
    v_lshrrev_b32 v1, 6, v0
    s_nop 0
    v_readfirstlane_b32 s21, v1
    s_waitcnt lgkmcnt(0)
    s_mov_b32 s8, s58
    s_and_b32 s9, s59, 0xffff
    s_mov_b32 s10, 0x10000000
    s_mov_b32 s11, 0x20000
    s_mov_b32 s16, s56
    s_and_b32 s17, s57, 0xffff
    s_mov_b32 s18, 0x100
    s_mov_b32 s19, 0x20000
    s_and_b32 s3, s2, 7
    s_cmp_lg_u32 s3, 0
    s_cbranch_scc1 L_worker
    s_lshr_b32 s20, s2, 3
    v_mov_b32 v1, 0x4444
    v_bfe_u32 v14, v0, 1, 1
    s_mov_b32 s38, 0xaaaa
    v_mad_u32_u24 v1, v14, s38, v1
    v_mov_b32 v3, 0x0
    v_bfe_u32 v14, v0, 0, 1
    s_mov_b32 s38, 0x10
    v_mad_u32_u24 v3, v14, s38, v3
    v_bfe_u32 v14, v0, 1, 1
    s_mov_b32 s38, 0x20
    v_mad_u32_u24 v3, v14, s38, v3
    v_bfe_u32 v14, v0, 2, 1
    s_mov_b32 s38, 0x40
    v_mad_u32_u24 v3, v14, s38, v3
    v_bfe_u32 v14, v0, 3, 1
    s_mov_b32 s38, 0x80
    v_mad_u32_u24 v3, v14, s38, v3
    v_bfe_u32 v14, v0, 4, 1
    s_mov_b32 s38, 0x100
    v_mad_u32_u24 v3, v14, s38, v3
    v_bfe_u32 v14, v0, 5, 1
    s_mov_b32 s38, 0x200
    v_mad_u32_u24 v3, v14, s38, v3
    v_mov_b32 v2, 0x0
    v_bfe_u32 v14, v0, 0, 1
    s_mov_b32 s38, 0x10
    v_mad_u32_u24 v2, v14, s38, v2
    v_bfe_u32 v14, v0, 1, 1
    s_mov_b32 s38, 0x20
    v_mad_u32_u24 v2, v14, s38, v2
    v_bfe_u32 v14, v0, 2, 1
    s_mov_b32 s38, 0x40
    v_mad_u32_u24 v2, v14, s38, v2
    v_bfe_u32 v14, v0, 3, 1
    s_mov_b32 s38, 0x80
    v_mad_u32_u24 v2, v14, s38, v2
    v_bfe_u32 v14, v0, 4, 1
    s_mov_b32 s38, 0x100
    v_mad_u32_u24 v2, v14, s38, v2
    v_bfe_u32 v14, v0, 5, 1
    s_mov_b32 s38, 0x200
    v_mad_u32_u24 v2, v14, s38, v2
    v_bfe_u32 v14, v0, 6, 1
    s_mov_b32 s38, 0x800
    v_mad_u32_u24 v2, v14, s38, v2
    v_bfe_u32 v14, v0, 7, 1
    s_mov_b32 s38, 0x1000
    v_mad_u32_u24 v2, v14, s38, v2
    v_mov_b32 v4, 0x8000
    v_bfe_u32 v14, v0, 0, 1
    s_mov_b32 s38, 0x10
    v_mad_u32_u24 v4, v14, s38, v4
    v_bfe_u32 v14, v0, 1, 1
    s_mov_b32 s38, 0x20
    v_mad_u32_u24 v4, v14, s38, v4
    v_bfe_u32 v14, v0, 2, 1
    s_mov_b32 s38, 0x40
    v_mad_u32_u24 v4, v14, s38, v4
    v_bfe_u32 v14, v0, 3, 1
    s_mov_b32 s38, 0x80
    v_mad_u32_u24 v4, v14, s38, v4
    v_bfe_u32 v14, v0, 4, 1
    s_mov_b32 s38, 0x100
    v_mad_u32_u24 v4, v14, s38, v4
    v_bfe_u32 v14, v0, 5, 1
    s_mov_b32 s38, 0x200
    v_mad_u32_u24 v4, v14, s38, v4
    v_bfe_u32 v14, v0, 6, 1
    s_mov_b32 s38, 0x8000
    v_mad_u32_u24 v4, v14, s38, v4
    v_bfe_u32 v14, v0, 7, 1
    s_mov_b32 s38, 0x10000
    v_mad_u32_u24 v4, v14, s38, v4
    v_mov_b32 v5, 0x4000
    v_bfe_u32 v14, v0, 0, 1
    s_mov_b32 s38, 0x4
    v_mad_u32_u24 v5, v14, s38, v5
    v_bfe_u32 v14, v0, 1, 1
    s_mov_b32 s38, 0x8
    v_mad_u32_u24 v5, v14, s38, v5
    v_bfe_u32 v14, v0, 2, 1
    s_mov_b32 s38, 0x10
    v_mad_u32_u24 v5, v14, s38, v5
    v_bfe_u32 v14, v0, 3, 1
    s_mov_b32 s38, 0x20
    v_mad_u32_u24 v5, v14, s38, v5
    v_bfe_u32 v14, v0, 4, 1
    s_mov_b32 s38, 0x240
    v_mad_u32_u24 v5, v14, s38, v5
    v_bfe_u32 v14, v0, 5, 1
    s_mov_b32 s38, 0x480
    v_mad_u32_u24 v5, v14, s38, v5
    v_bfe_u32 v14, v0, 6, 1
    s_mov_b32 s38, 0x40
    v_mad_u32_u24 v5, v14, s38, v5
    v_bfe_u32 v14, v0, 7, 1
    s_mov_b32 s38, 0x80
    v_mad_u32_u24 v5, v14, s38, v5
    v_mov_b32 v6, 0x4000
    v_bfe_u32 v14, v0, 0, 1
    s_mov_b32 s38, 0x120
    v_mad_u32_u24 v6, v14, s38, v6
    v_bfe_u32 v14, v0, 2, 1
    s_mov_b32 s38, 0x240
    v_mad_u32_u24 v6, v14, s38, v6
    v_bfe_u32 v14, v0, 3, 1
    s_mov_b32 s38, 0x480
    v_mad_u32_u24 v6, v14, s38, v6
    v_bfe_u32 v14, v0, 4, 1
    s_mov_b32 s38, 0x10
    v_mad_u32_u24 v6, v14, s38, v6
    v_bfe_u32 v14, v0, 5, 1
    s_mov_b32 s38, 0x20
    v_mad_u32_u24 v6, v14, s38, v6
    v_add_u32 v7, 2304, v5
    v_xor_b32 v8, 0x1000, v2
    v_mov_b32 v13, 0x0
    v_bfe_u32 v14, v0, 0, 1
    s_mov_b32 s38, 0x4
    v_mad_u32_u24 v13, v14, s38, v13
    v_bfe_u32 v14, v0, 1, 1
    s_mov_b32 s38, 0x8
    v_mad_u32_u24 v13, v14, s38, v13
    v_bfe_u32 v14, v0, 2, 1
    s_mov_b32 s38, 0x10
    v_mad_u32_u24 v13, v14, s38, v13
    v_bfe_u32 v14, v0, 3, 1
    s_mov_b32 s38, 0x20
    v_mad_u32_u24 v13, v14, s38, v13
    v_bfe_u32 v14, v0, 4, 1
    s_mov_b32 s38, 0x40
    v_mad_u32_u24 v13, v14, s38, v13
    v_mov_b32 v24, 0x0
    v_bfe_u32 v14, v0, 3, 1
    s_mov_b32 s38, 0x1
    v_mad_u32_u24 v24, v14, s38, v24
    v_bfe_u32 v14, v0, 4, 1
    s_mov_b32 s38, 0x2
    v_mad_u32_u24 v24, v14, s38, v24
    v_bfe_u32 v14, v0, 5, 1
    s_mov_b32 s38, 0x4
    v_mad_u32_u24 v24, v14, s38, v24
    v_bfe_u32 v14, v0, 6, 1
    s_mov_b32 s38, 0x8
    v_mad_u32_u24 v24, v14, s38, v24
    v_bfe_u32 v14, v0, 7, 1
    s_mov_b32 s38, 0x10
    v_mad_u32_u24 v24, v14, s38, v24
    v_add_u32 v24, s20, v24
    v_and_b32 v24, 31, v24
    v_lshlrev_b32 v24, 6, v24
    v_mov_b32 v9, 0x0
    v_bfe_u32 v14, v0, 0, 1
    s_mov_b32 s38, 0x8
    v_mad_u32_u24 v9, v14, s38, v9
    v_bfe_u32 v14, v0, 1, 1
    s_mov_b32 s38, 0x10
    v_mad_u32_u24 v9, v14, s38, v9
    v_bfe_u32 v14, v0, 2, 1
    s_mov_b32 s38, 0x20
    v_mad_u32_u24 v9, v14, s38, v9
    v_bfe_u32 v14, v0, 3, 1
    s_mov_b32 s38, 0x2000
    v_mad_u32_u24 v9, v14, s38, v9
    v_bfe_u32 v14, v0, 4, 1
    s_mov_b32 s38, 0x4000
    v_mad_u32_u24 v9, v14, s38, v9
    v_bfe_u32 v14, v0, 5, 1
    s_mov_b32 s38, 0x8000
    v_mad_u32_u24 v9, v14, s38, v9
    v_bfe_u32 v14, v0, 6, 1
    s_mov_b32 s38, 0x10000
    v_mad_u32_u24 v9, v14, s38, v9
    v_bfe_u32 v14, v0, 7, 1
    s_mov_b32 s38, 0x20000
    v_mad_u32_u24 v9, v14, s38, v9
    v_add_u32 v9, v9, v24
    v_mov_b32 v10, 0x80000
    v_bfe_u32 v14, v0, 0, 1
    s_mov_b32 s38, 0x8
    v_mad_u32_u24 v10, v14, s38, v10
    v_bfe_u32 v14, v0, 1, 1
    s_mov_b32 s38, 0x20
    v_mad_u32_u24 v10, v14, s38, v10
    v_bfe_u32 v14, v0, 4, 1
    s_mov_b32 s38, 0x10
    v_mad_u32_u24 v10, v14, s38, v10
    v_bfe_u32 v14, v0, 5, 1
    s_mov_b32 s38, 0x4
    v_mad_u32_u24 v10, v14, s38, v10
    v_bfe_u32 v14, v0, 6, 1
    s_mov_b32 s38, 0x800
    v_mad_u32_u24 v10, v14, s38, v10
    v_bfe_u32 v14, v0, 7, 1
    s_mov_b32 s38, 0x1000
    v_mad_u32_u24 v10, v14, s38, v10
    v_mov_b32 v25, s20
    v_mov_b32 v24, 0x0
    v_bfe_u32 v14, v25, 0, 1
    s_mov_b32 s38, 0x100
    v_mad_u32_u24 v24, v14, s38, v24
    v_bfe_u32 v14, v25, 1, 1
    s_mov_b32 s38, 0x40
    v_mad_u32_u24 v24, v14, s38, v24
    v_bfe_u32 v14, v25, 2, 1
    s_mov_b32 s38, 0x80
    v_mad_u32_u24 v24, v14, s38, v24
    v_bfe_u32 v14, v25, 3, 1
    s_mov_b32 s38, 0x200
    v_mad_u32_u24 v24, v14, s38, v24
    v_bfe_u32 v14, v25, 4, 1
    s_mov_b32 s38, 0x400
    v_mad_u32_u24 v24, v14, s38, v24
    v_add_u32 v10, v24, v10
    v_and_b32 v24, 12, v0
    v_cmp_ne_u32 vcc, 0, v24
    v_mov_b32 v24, 0x40000000
    s_nop 0
    v_cndmask_b32 v10, v10, v24, vcc
    s_lshl_b32 s6, s20, 13
    s_add_u32 s6, s6, 0x0
    s_mov_b32 s26, 4096
    v_and_b32 v24, 15, v0
    v_mov_b32 v16, 0
    v_mov_b32 v25, 0x3f80
    v_cmp_eq_u32 vcc, 0, v24
    s_nop 1
    v_cndmask_b32 v16, v16, v25, vcc
    v_mov_b32 v25, 0x3f800000
    v_cmp_eq_u32 vcc, 1, v24
    s_nop 1
    v_cndmask_b32 v16, v16, v25, vcc
    v_mov_b32 v17, 0
    v_mov_b32 v25, 0x3f80
    v_cmp_eq_u32 vcc, 4, v24
    s_nop 1
    v_cndmask_b32 v17, v17, v25, vcc
    v_mov_b32 v25, 0x3f800000
    v_cmp_eq_u32 vcc, 5, v24
    s_nop 1
    v_cndmask_b32 v17, v17, v25, vcc
    v_mov_b32 v18, 0
    v_mov_b32 v25, 0x3f80
    v_cmp_eq_u32 vcc, 8, v24
    s_nop 1
    v_cndmask_b32 v18, v18, v25, vcc
    v_mov_b32 v25, 0x3f800000
    v_cmp_eq_u32 vcc, 9, v24
    s_nop 1
    v_cndmask_b32 v18, v18, v25, vcc
    v_mov_b32 v19, 0
    v_mov_b32 v25, 0x3f80
    v_cmp_eq_u32 vcc, 12, v24
    s_nop 1
    v_cndmask_b32 v19, v19, v25, vcc
    v_mov_b32 v25, 0x3f800000
    v_cmp_eq_u32 vcc, 13, v24
    s_nop 1
    v_cndmask_b32 v19, v19, v25, vcc
    ds_write_b128 v3, v[16:19] offset:23040
    s_mov_b32 s34, 0x05040100
    s_mov_b32 s35, 0x07060302
    s_mov_b32 s33, 0x3e0293ee
    s_mov_b32 s40, 0x4e800000
    s_mov_b32 s32, 0
    s_mov_b32 s4, 0x3f803f80
    s_mov_b32 s5, 0x3f803f80
    s_lshl_b32 s36, s20, 14
    s_lshr_b32 s37, s21, 1
    s_lshl_b32 s37, s37, 12
    s_add_u32 s25, s36, s37
    s_lshl_b32 s37, s21, 11
    s_add_u32 s39, s36, s37
    s_add_u32 s39, s39, 8192
    v_mov_b32 v11, 0x0
    v_bfe_u32 v14, v0, 0, 1
    s_mov_b32 s38, 0x4
    v_mad_u32_u24 v11, v14, s38, v11
    v_bfe_u32 v14, v0, 1, 1
    s_mov_b32 s38, 0x8
    v_mad_u32_u24 v11, v14, s38, v11
    v_bfe_u32 v14, v0, 2, 1
    s_mov_b32 s38, 0x10
    v_mad_u32_u24 v11, v14, s38, v11
    v_bfe_u32 v14, v0, 3, 1
    s_mov_b32 s38, 0x20
    v_mad_u32_u24 v11, v14, s38, v11
    v_bfe_u32 v14, v0, 4, 1
    s_mov_b32 s38, 0x800
    v_mad_u32_u24 v11, v14, s38, v11
    v_bfe_u32 v14, v0, 5, 1
    s_mov_b32 s38, 0x1000
    v_mad_u32_u24 v11, v14, s38, v11
    v_bfe_u32 v14, v0, 6, 1
    s_mov_b32 s38, 0x100
    v_mad_u32_u24 v11, v14, s38, v11
    v_bfe_u32 v14, v0, 7, 1
    s_mov_b32 s38, 0x200
    v_mad_u32_u24 v11, v14, s38, v11
    s_mov_b32 s96, s48
    s_and_b32 s97, s49, 0xffff
    s_mov_b32 s98, 0x400000
    s_mov_b32 s99, 0x20000
    s_mov_b32 s88, s50
    s_and_b32 s89, s51, 0xffff
    s_mov_b32 s90, 0x400000
    s_mov_b32 s91, 0x20000
    s_mov_b32 s60, s52
    s_and_b32 s61, s53, 0xffff
    s_mov_b32 s62, 0x400000
    s_mov_b32 s63, 0x20000
    s_mov_b32 s92, s54
    s_and_b32 s93, s55, 0xffff
    s_mov_b32 s94, 0x400000
    s_mov_b32 s95, 0x20000
    s_lshl_b32 s29, s20, 17
    v_mov_b32 v16, 0x0
    v_bfe_u32 v14, v0, 0, 1
    s_mov_b32 s38, 0x10
    v_mad_u32_u24 v16, v14, s38, v16
    v_bfe_u32 v14, v0, 1, 1
    s_mov_b32 s38, 0x20
    v_mad_u32_u24 v16, v14, s38, v16
    v_bfe_u32 v14, v0, 2, 1
    s_mov_b32 s38, 0x40
    v_mad_u32_u24 v16, v14, s38, v16
    v_bfe_u32 v14, v0, 3, 1
    s_mov_b32 s38, 0x80
    v_mad_u32_u24 v16, v14, s38, v16
    v_bfe_u32 v14, v0, 4, 1
    s_mov_b32 s38, 0x2000
    v_mad_u32_u24 v16, v14, s38, v16
    v_bfe_u32 v14, v0, 5, 1
    s_mov_b32 s38, 0x4000
    v_mad_u32_u24 v16, v14, s38, v16
    v_bfe_u32 v14, v0, 6, 1
    s_mov_b32 s38, 0x40000
    v_mad_u32_u24 v16, v14, s38, v16
    v_bfe_u32 v14, v0, 7, 1
    s_mov_b32 s38, 0x80000
    v_mad_u32_u24 v16, v14, s38, v16
    v_mov_b32 v28, 0x0
    v_bfe_u32 v14, v0, 4, 1
    s_mov_b32 s38, 0x20
    v_mad_u32_u24 v28, v14, s38, v28
    v_xor_b32 v16, v16, v28
    v_xor_b32 v17, 64, v16
    v_xor_b32 v18, 128, v16
    v_xor_b32 v19, 192, v16
    v_mov_b32 v20, 0x0
    v_bfe_u32 v14, v0, 0, 1
    s_mov_b32 s38, 0x8
    v_mad_u32_u24 v20, v14, s38, v20
    v_bfe_u32 v14, v0, 1, 1
    s_mov_b32 s38, 0x10
    v_mad_u32_u24 v20, v14, s38, v20
    v_bfe_u32 v14, v0, 2, 1
    s_mov_b32 s38, 0x100
    v_mad_u32_u24 v20, v14, s38, v20
    v_bfe_u32 v14, v0, 3, 1
    s_mov_b32 s38, 0x800
    v_mad_u32_u24 v20, v14, s38, v20
    v_bfe_u32 v14, v0, 4, 1
    s_mov_b32 s38, 0x400
    v_mad_u32_u24 v20, v14, s38, v20
    v_bfe_u32 v14, v0, 5, 1
    s_mov_b32 s38, 0x1000
    v_mad_u32_u24 v20, v14, s38, v20
    v_mov_b32 v28, 0x0
    v_bfe_u32 v14, v0, 2, 1
    s_mov_b32 s38, 0x20
    v_mad_u32_u24 v28, v14, s38, v28
    v_bfe_u32 v14, v0, 3, 1
    s_mov_b32 s38, 0x80
    v_mad_u32_u24 v28, v14, s38, v28
    v_bfe_u32 v14, v0, 4, 1
    s_mov_b32 s38, 0x40
    v_mad_u32_u24 v28, v14, s38, v28
    v_mov_b32 v29, 0x0
    v_bfe_u32 v14, v0, 6, 1
    s_mov_b32 s38, 0x40
    v_mad_u32_u24 v29, v14, s38, v29
    v_bfe_u32 v14, v0, 7, 1
    s_mov_b32 s38, 0x80
    v_mad_u32_u24 v29, v14, s38, v29
    v_xor_b32 v28, v28, v29
    v_add_u32 v28, v28, v20
    s_xor_b32 s36, s21, 0
    s_add_u32 s36, s36, 1
    s_lshl_b32 s36, s36, 15
    v_add_u32 v20, s36, v28
    v_xor_b32 v21, 32, v20
    s_xor_b32 s36, s21, 1
    s_add_u32 s36, s36, 1
    s_lshl_b32 s36, s36, 15
    v_add_u32 v22, s36, v28
    v_xor_b32 v23, 32, v22
    s_xor_b32 s36, s21, 2
    s_add_u32 s36, s36, 1
    s_lshl_b32 s36, s36, 15
    v_add_u32 v24, s36, v28
    v_xor_b32 v25, 32, v24
    s_xor_b32 s36, s21, 3
    s_add_u32 s36, s36, 1
    s_lshl_b32 s36, s36, 15
    v_add_u32 v26, s36, v28
    v_xor_b32 v27, 32, v26
    s_add_u32 s28, s21, 1
    s_lshl_b32 s28, s28, 15
    s_lshl_b32 s3, s20, 8
    s_add_u32 m0, s28, 0
    s_add_u32 s37, s3, 0x0
    buffer_load_dwordx4 v16, s[60:63], s37 offen nt lds
    s_add_u32 m0, s28, 1024
    s_add_u32 s37, s3, 0x8000
    buffer_load_dwordx4 v17, s[60:63], s37 offen nt lds
    s_add_u32 m0, s28, 2048
    s_add_u32 s37, s3, 0x10000
    buffer_load_dwordx4 v18, s[60:63], s37 offen nt lds
    s_add_u32 m0, s28, 3072
    s_add_u32 s37, s3, 0x18000
    buffer_load_dwordx4 v19, s[60:63], s37 offen nt lds
    s_add_u32 m0, s28, 4096
    s_add_u32 s37, s3, 0x20000
    buffer_load_dwordx4 v16, s[60:63], s37 offen nt lds
    s_add_u32 m0, s28, 5120
    s_add_u32 s37, s3, 0x28000
    buffer_load_dwordx4 v17, s[60:63], s37 offen nt lds
    s_add_u32 m0, s28, 6144
    s_add_u32 s37, s3, 0x30000
    buffer_load_dwordx4 v18, s[60:63], s37 offen nt lds
    s_add_u32 m0, s28, 7168
    s_add_u32 s37, s3, 0x38000
    buffer_load_dwordx4 v19, s[60:63], s37 offen nt lds
    s_mov_b32 s12, s46
    s_and_b32 s13, s47, 0xffff
    s_mov_b32 s14, 0x2000
    s_mov_b32 s15, 0x20000
    v_mov_b32 v104, 0x0
    v_bfe_u32 v14, v0, 0, 1
    s_mov_b32 s38, 0x8
    v_mad_u32_u24 v104, v14, s38, v104
    v_bfe_u32 v14, v0, 1, 1
    s_mov_b32 s38, 0x10
    v_mad_u32_u24 v104, v14, s38, v104
    v_bfe_u32 v14, v0, 2, 1
    s_mov_b32 s38, 0x10000
    v_mad_u32_u24 v104, v14, s38, v104
    v_bfe_u32 v14, v0, 3, 1
    s_mov_b32 s38, 0x10000
    v_mad_u32_u24 v104, v14, s38, v104
    v_bfe_u32 v14, v0, 4, 1
    s_mov_b32 s38, 0x400
    v_mad_u32_u24 v104, v14, s38, v104
    v_bfe_u32 v14, v0, 5, 1
    s_mov_b32 s38, 0x4
    v_mad_u32_u24 v104, v14, s38, v104
    v_bfe_u32 v14, v0, 6, 1
    s_mov_b32 s38, 0x40
    v_mad_u32_u24 v104, v14, s38, v104
    v_bfe_u32 v14, v0, 7, 1
    s_mov_b32 s38, 0x80
    v_mad_u32_u24 v104, v14, s38, v104
    v_mov_b32 v106, s20
    v_mov_b32 v105, 0x0
    v_bfe_u32 v14, v106, 0, 1
    s_mov_b32 s38, 0x20
    v_mad_u32_u24 v105, v14, s38, v105
    v_bfe_u32 v14, v106, 1, 1
    s_mov_b32 s38, 0x800
    v_mad_u32_u24 v105, v14, s38, v105
    v_bfe_u32 v14, v106, 2, 1
    s_mov_b32 s38, 0x1000
    v_mad_u32_u24 v105, v14, s38, v105
    v_bfe_u32 v14, v106, 3, 1
    s_mov_b32 s38, 0x100
    v_mad_u32_u24 v105, v14, s38, v105
    v_bfe_u32 v14, v106, 4, 1
    s_mov_b32 s38, 0x200
    v_mad_u32_u24 v105, v14, s38, v105
    v_add_u32 v104, v104, v105
    buffer_load_dword v12, v104, s[12:15], 0 offen
    v_mov_b32 v100, -1
    v_mov_b32 v101, -1
    v_mov_b32 v102, -1
    v_mov_b32 v103, -1
    buffer_store_dwordx4 v[100:103], v2, s[8:11], s6 offen sc1
    buffer_store_dwordx4 v[100:103], v2, s[8:11], s6 offen offset:1024 sc1
    s_lshl_b32 s36, s20, 14
    s_add_u32 s36, s36, 0x100000
    s_add_u32 s37, s36, 0x2000
    buffer_store_dwordx4 v[100:103], v2, s[8:11], s36 offen sc1
    buffer_store_dwordx4 v[100:103], v2, s[8:11], s36 offen offset:1024 sc1
    buffer_store_dwordx4 v[100:103], v2, s[8:11], s37 offen sc1
    buffer_store_dwordx4 v[100:103], v2, s[8:11], s37 offen offset:1024 sc1
    s_mul_i32 s36, s20, 0x104000
    s_add_u32 s36, s36, 0x1102000
    s_add_u32 s37, s36, 0x82000
    buffer_store_dwordx4 v[100:103], v2, s[8:11], s36 offen sc1
    buffer_store_dwordx4 v[100:103], v2, s[8:11], s36 offen offset:1024 sc1
    buffer_store_dwordx4 v[100:103], v2, s[8:11], s37 offen sc1
    buffer_store_dwordx4 v[100:103], v2, s[8:11], s37 offen offset:1024 sc1
    v_lshlrev_b32 v104, 2, v0
    s_lshl_b32 s36, s20, 10
    s_add_u32 s37, s36, 0x194000
    buffer_store_dword v100, v104, s[8:11], s37 offen sc1
    s_add_u32 s37, s36, 0x1b0000
    buffer_store_dword v100, v104, s[8:11], s37 offen sc1
    s_add_u32 s37, s36, 0x1b8000
    buffer_store_dword v100, v104, s[8:11], s37 offen sc1
    v_mov_b32 v105, 0x40000000
    v_cmp_lt_u32 vcc, 63, v0
    s_nop 1
    v_cndmask_b32 v104, v104, v105, vcc
    v_mov_b32 v105, 0
    s_lshl_b32 s36, s20, 8
    s_add_u32 s36, s36, 0x190000
    s_add_u32 s37, s36, 0x2000
    s_lshl_b32 s38, s20, 2
    s_add_u32 s38, s38, 0x80000
    s_lshl_b32 s7, s21, 7
    s_add_u32 s38, s38, s7
    buffer_store_dword v105, off, s[8:11], s38 sc1
    buffer_store_dword v105, v104, s[8:11], s36 offen sc1
    buffer_store_dword v105, v104, s[8:11], s37 offen sc1
    s_add_u32 m0, s28, 8192
    s_add_u32 s37, s3, 0x100000
    buffer_load_dwordx4 v16, s[60:63], s37 offen nt lds
    s_add_u32 m0, s28, 9216
    s_add_u32 s37, s3, 0x108000
    buffer_load_dwordx4 v17, s[60:63], s37 offen nt lds
    s_add_u32 m0, s28, 10240
    s_add_u32 s37, s3, 0x110000
    buffer_load_dwordx4 v18, s[60:63], s37 offen nt lds
    s_add_u32 m0, s28, 11264
    s_add_u32 s37, s3, 0x118000
    buffer_load_dwordx4 v19, s[60:63], s37 offen nt lds
    s_add_u32 m0, s28, 12288
    s_add_u32 s37, s3, 0x120000
    buffer_load_dwordx4 v16, s[60:63], s37 offen nt lds
    s_add_u32 m0, s28, 13312
    s_add_u32 s37, s3, 0x128000
    buffer_load_dwordx4 v17, s[60:63], s37 offen nt lds
    s_add_u32 m0, s28, 14336
    s_add_u32 s37, s3, 0x130000
    buffer_load_dwordx4 v18, s[60:63], s37 offen nt lds
    s_add_u32 m0, s28, 15360
    s_add_u32 s37, s3, 0x138000
    buffer_load_dwordx4 v19, s[60:63], s37 offen nt lds
    s_add_u32 m0, s28, 16384
    s_add_u32 s37, s3, 0x200000
    buffer_load_dwordx4 v16, s[60:63], s37 offen nt lds
    s_add_u32 m0, s28, 17408
    s_add_u32 s37, s3, 0x208000
    buffer_load_dwordx4 v17, s[60:63], s37 offen nt lds
    s_add_u32 m0, s28, 18432
    s_add_u32 s37, s3, 0x210000
    buffer_load_dwordx4 v18, s[60:63], s37 offen nt lds
    s_add_u32 m0, s28, 19456
    s_add_u32 s37, s3, 0x218000
    buffer_load_dwordx4 v19, s[60:63], s37 offen nt lds
    s_add_u32 m0, s28, 20480
    s_add_u32 s37, s3, 0x220000
    buffer_load_dwordx4 v16, s[60:63], s37 offen nt lds
    s_add_u32 m0, s28, 21504
    s_add_u32 s37, s3, 0x228000
    buffer_load_dwordx4 v17, s[60:63], s37 offen nt lds
    s_add_u32 m0, s28, 22528
    s_add_u32 s37, s3, 0x230000
    buffer_load_dwordx4 v18, s[60:63], s37 offen nt lds
    s_add_u32 m0, s28, 23552
    s_add_u32 s37, s3, 0x238000
    buffer_load_dwordx4 v19, s[60:63], s37 offen nt lds
    s_xor_b32 s36, s21, 0
    s_lshl_b32 s36, s36, 15
    s_add_u32 s36, s36, s29
    s_add_u32 s37, s36, 0x0
    buffer_load_dword v32, v11, s[92:95], s37 offen
    s_add_u32 s37, s36, 0x4000
    buffer_load_dword v33, v11, s[92:95], s37 offen
    s_add_u32 s37, s36, 0x400
    buffer_load_dword v34, v11, s[92:95], s37 offen
    s_add_u32 s37, s36, 0x4400
    buffer_load_dword v35, v11, s[92:95], s37 offen
    s_add_u32 s37, s36, 0x2000
    buffer_load_dword v36, v11, s[92:95], s37 offen
    s_add_u32 s37, s36, 0x6000
    buffer_load_dword v37, v11, s[92:95], s37 offen
    s_add_u32 s37, s36, 0x2400
    buffer_load_dword v38, v11, s[92:95], s37 offen
    s_add_u32 s37, s36, 0x6400
    buffer_load_dword v39, v11, s[92:95], s37 offen
    s_add_u32 s37, s36, 0x40
    buffer_load_dword v40, v11, s[92:95], s37 offen
    s_add_u32 s37, s36, 0x4040
    buffer_load_dword v41, v11, s[92:95], s37 offen
    s_add_u32 s37, s36, 0x440
    buffer_load_dword v42, v11, s[92:95], s37 offen
    s_add_u32 s37, s36, 0x4440
    buffer_load_dword v43, v11, s[92:95], s37 offen
    s_add_u32 s37, s36, 0x2040
    buffer_load_dword v44, v11, s[92:95], s37 offen
    s_add_u32 s37, s36, 0x6040
    buffer_load_dword v45, v11, s[92:95], s37 offen
    s_add_u32 s37, s36, 0x2440
    buffer_load_dword v46, v11, s[92:95], s37 offen
    s_add_u32 s37, s36, 0x6440
    buffer_load_dword v47, v11, s[92:95], s37 offen
    s_waitcnt vmcnt(49)
    s_barrier
    ds_read_b64_tr_b16 a[160:161], v20 offset:0
    ds_read_b64_tr_b16 a[162:163], v20 offset:512
    ds_read_b64_tr_b16 a[168:169], v21 offset:0
    ds_read_b64_tr_b16 a[170:171], v21 offset:512
    ds_read_b64_tr_b16 a[192:193], v22 offset:0
    ds_read_b64_tr_b16 a[194:195], v22 offset:512
    ds_read_b64_tr_b16 a[200:201], v23 offset:0
    ds_read_b64_tr_b16 a[202:203], v23 offset:512
    ds_read_b64_tr_b16 a[224:225], v24 offset:0
    ds_read_b64_tr_b16 a[226:227], v24 offset:512
    ds_read_b64_tr_b16 a[232:233], v25 offset:0
    ds_read_b64_tr_b16 a[234:235], v25 offset:512
    s_waitcnt lgkmcnt(4)
    ds_read_b64_tr_b16 v[128:129], v26 offset:0
    ds_read_b64_tr_b16 v[130:131], v26 offset:512
    ds_read_b64_tr_b16 v[136:137], v27 offset:0
    ds_read_b64_tr_b16 v[138:139], v27 offset:512
    s_waitcnt lgkmcnt(0)
    s_barrier
    s_add_u32 m0, s28, 0
    s_add_u32 s37, s3, 0x300000
    buffer_load_dwordx4 v16, s[60:63], s37 offen nt lds
    s_add_u32 m0, s28, 1024
    s_add_u32 s37, s3, 0x308000
    buffer_load_dwordx4 v17, s[60:63], s37 offen nt lds
    s_add_u32 m0, s28, 2048
    s_add_u32 s37, s3, 0x310000
    buffer_load_dwordx4 v18, s[60:63], s37 offen nt lds
    s_add_u32 m0, s28, 3072
    s_add_u32 s37, s3, 0x318000
    buffer_load_dwordx4 v19, s[60:63], s37 offen nt lds
    s_add_u32 m0, s28, 4096
    s_add_u32 s37, s3, 0x320000
    buffer_load_dwordx4 v16, s[60:63], s37 offen nt lds
    s_add_u32 m0, s28, 5120
    s_add_u32 s37, s3, 0x328000
    buffer_load_dwordx4 v17, s[60:63], s37 offen nt lds
    s_add_u32 m0, s28, 6144
    s_add_u32 s37, s3, 0x330000
    buffer_load_dwordx4 v18, s[60:63], s37 offen nt lds
    s_add_u32 m0, s28, 7168
    s_add_u32 s37, s3, 0x338000
    buffer_load_dwordx4 v19, s[60:63], s37 offen nt lds
    s_waitcnt vmcnt(40)
    s_mov_b32 s36, 0x1000000
    buffer_store_dword v12, v10, s[8:11], s36 offen sc1
    s_xor_b32 s36, s21, 0
    s_lshl_b32 s36, s36, 15
    s_add_u32 s36, s36, s29
    s_add_u32 s37, s36, 0x80
    buffer_load_dword v48, v11, s[92:95], s37 offen
    s_add_u32 s37, s36, 0x4080
    buffer_load_dword v49, v11, s[92:95], s37 offen
    s_add_u32 s37, s36, 0x480
    buffer_load_dword v50, v11, s[92:95], s37 offen
    s_add_u32 s37, s36, 0x4480
    buffer_load_dword v51, v11, s[92:95], s37 offen
    s_add_u32 s37, s36, 0x2080
    buffer_load_dword v52, v11, s[92:95], s37 offen
    s_add_u32 s37, s36, 0x6080
    buffer_load_dword v53, v11, s[92:95], s37 offen
    s_add_u32 s37, s36, 0x2480
    buffer_load_dword v54, v11, s[92:95], s37 offen
    s_add_u32 s37, s36, 0x6480
    buffer_load_dword v55, v11, s[92:95], s37 offen
    s_add_u32 s37, s36, 0xc0
    buffer_load_dword v56, v11, s[92:95], s37 offen
    s_add_u32 s37, s36, 0x40c0
    buffer_load_dword v57, v11, s[92:95], s37 offen
    s_add_u32 s37, s36, 0x4c0
    buffer_load_dword v58, v11, s[92:95], s37 offen
    s_add_u32 s37, s36, 0x44c0
    buffer_load_dword v59, v11, s[92:95], s37 offen
    s_add_u32 s37, s36, 0x20c0
    buffer_load_dword v60, v11, s[92:95], s37 offen
    s_add_u32 s37, s36, 0x60c0
    buffer_load_dword v61, v11, s[92:95], s37 offen
    s_add_u32 s37, s36, 0x24c0
    buffer_load_dword v62, v11, s[92:95], s37 offen
    s_add_u32 s37, s36, 0x64c0
    buffer_load_dword v63, v11, s[92:95], s37 offen
    s_waitcnt vmcnt(49)
    s_barrier
    ds_read_b64_tr_b16 a[164:165], v20 offset:8192
    ds_read_b64_tr_b16 a[166:167], v20 offset:8704
    ds_read_b64_tr_b16 a[172:173], v21 offset:8192
    ds_read_b64_tr_b16 a[174:175], v21 offset:8704
    ds_read_b64_tr_b16 a[196:197], v22 offset:8192
    ds_read_b64_tr_b16 a[198:199], v22 offset:8704
    ds_read_b64_tr_b16 a[204:205], v23 offset:8192
    ds_read_b64_tr_b16 a[206:207], v23 offset:8704
    ds_read_b64_tr_b16 a[228:229], v24 offset:8192
    ds_read_b64_tr_b16 a[230:231], v24 offset:8704
    ds_read_b64_tr_b16 a[236:237], v25 offset:8192
    ds_read_b64_tr_b16 a[238:239], v25 offset:8704
    s_waitcnt lgkmcnt(4)
    ds_read_b64_tr_b16 v[132:133], v26 offset:8192
    ds_read_b64_tr_b16 v[134:135], v26 offset:8704
    ds_read_b64_tr_b16 v[140:141], v27 offset:8192
    ds_read_b64_tr_b16 v[142:143], v27 offset:8704
    s_waitcnt lgkmcnt(0)
    s_barrier
    s_add_u32 m0, s28, 8192
    s_add_u32 s37, s3, 0x0
    buffer_load_dwordx4 v16, s[88:91], s37 offen nt lds
    s_add_u32 m0, s28, 9216
    s_add_u32 s37, s3, 0x8000
    buffer_load_dwordx4 v17, s[88:91], s37 offen nt lds
    s_add_u32 m0, s28, 10240
    s_add_u32 s37, s3, 0x10000
    buffer_load_dwordx4 v18, s[88:91], s37 offen nt lds
    s_add_u32 m0, s28, 11264
    s_add_u32 s37, s3, 0x18000
    buffer_load_dwordx4 v19, s[88:91], s37 offen nt lds
    s_add_u32 m0, s28, 12288
    s_add_u32 s37, s3, 0x20000
    buffer_load_dwordx4 v16, s[88:91], s37 offen nt lds
    s_add_u32 m0, s28, 13312
    s_add_u32 s37, s3, 0x28000
    buffer_load_dwordx4 v17, s[88:91], s37 offen nt lds
    s_add_u32 m0, s28, 14336
    s_add_u32 s37, s3, 0x30000
    buffer_load_dwordx4 v18, s[88:91], s37 offen nt lds
    s_add_u32 m0, s28, 15360
    s_add_u32 s37, s3, 0x38000
    buffer_load_dwordx4 v19, s[88:91], s37 offen nt lds
    s_waitcnt vmcnt(33)
    v_perm_b32 v120, v33, v32, s34
    v_perm_b32 v121, v33, v32, s35
    v_perm_b32 v122, v35, v34, s34
    v_perm_b32 v123, v35, v34, s35
    v_perm_b32 v124, v37, v36, s34
    v_perm_b32 v125, v37, v36, s35
    v_perm_b32 v126, v39, v38, s34
    v_perm_b32 v127, v39, v38, s35
    ds_write_b128 v4, v[120:123] offset:24576
    ds_write_b128 v4, v[124:127] offset:25600
    s_waitcnt lgkmcnt(0)
    v_perm_b32 v120, v41, v40, s34
    v_perm_b32 v121, v41, v40, s35
    v_perm_b32 v122, v43, v42, s34
    v_perm_b32 v123, v43, v42, s35
    v_perm_b32 v124, v45, v44, s34
    v_perm_b32 v125, v45, v44, s35
    v_perm_b32 v126, v47, v46, s34
    v_perm_b32 v127, v47, v46, s35
    ds_write_b128 v4, v[120:123] offset:26624
    ds_write_b128 v4, v[124:127] offset:27648
    s_waitcnt lgkmcnt(0)
    s_xor_b32 s36, s21, 1
    s_lshl_b32 s36, s36, 15
    s_add_u32 s36, s36, s29
    s_add_u32 s37, s36, 0x0
    buffer_load_dword v80, v11, s[92:95], s37 offen
    s_add_u32 s37, s36, 0x4000
    buffer_load_dword v81, v11, s[92:95], s37 offen
    s_add_u32 s37, s36, 0x400
    buffer_load_dword v82, v11, s[92:95], s37 offen
    s_add_u32 s37, s36, 0x4400
    buffer_load_dword v83, v11, s[92:95], s37 offen
    s_add_u32 s37, s36, 0x2000
    buffer_load_dword v84, v11, s[92:95], s37 offen
    s_add_u32 s37, s36, 0x6000
    buffer_load_dword v85, v11, s[92:95], s37 offen
    s_add_u32 s37, s36, 0x2400
    buffer_load_dword v86, v11, s[92:95], s37 offen
    s_add_u32 s37, s36, 0x6400
    buffer_load_dword v87, v11, s[92:95], s37 offen
    s_add_u32 s37, s36, 0x40
    buffer_load_dword v88, v11, s[92:95], s37 offen
    s_add_u32 s37, s36, 0x4040
    buffer_load_dword v89, v11, s[92:95], s37 offen
    s_add_u32 s37, s36, 0x440
    buffer_load_dword v90, v11, s[92:95], s37 offen
    s_add_u32 s37, s36, 0x4440
    buffer_load_dword v91, v11, s[92:95], s37 offen
    s_add_u32 s37, s36, 0x2040
    buffer_load_dword v92, v11, s[92:95], s37 offen
    s_add_u32 s37, s36, 0x6040
    buffer_load_dword v93, v11, s[92:95], s37 offen
    s_add_u32 s37, s36, 0x2440
    buffer_load_dword v94, v11, s[92:95], s37 offen
    s_add_u32 s37, s36, 0x6440
    buffer_load_dword v95, v11, s[92:95], s37 offen
    s_barrier
    ds_read_b64_tr_b16 a[176:177], v20 offset:16384
    ds_read_b64_tr_b16 a[178:179], v20 offset:16896
    ds_read_b64_tr_b16 a[184:185], v21 offset:16384
    ds_read_b64_tr_b16 a[186:187], v21 offset:16896
    ds_read_b64_tr_b16 a[208:209], v22 offset:16384
    ds_read_b64_tr_b16 a[210:211], v22 offset:16896
    ds_read_b64_tr_b16 a[216:217], v23 offset:16384
    ds_read_b64_tr_b16 a[218:219], v23 offset:16896
    ds_read_b64_tr_b16 a[240:241], v24 offset:16384
    ds_read_b64_tr_b16 a[242:243], v24 offset:16896
    ds_read_b64_tr_b16 a[248:249], v25 offset:16384
    ds_read_b64_tr_b16 a[250:251], v25 offset:16896
    s_waitcnt lgkmcnt(4)
    ds_read_b64_tr_b16 v[144:145], v26 offset:16384
    ds_read_b64_tr_b16 v[146:147], v26 offset:16896
    ds_read_b64_tr_b16 v[152:153], v27 offset:16384
    ds_read_b64_tr_b16 v[154:155], v27 offset:16896
    s_waitcnt lgkmcnt(0)
    s_barrier
    s_add_u32 m0, s28, 16384
    s_add_u32 s37, s3, 0x100000
    buffer_load_dwordx4 v16, s[88:91], s37 offen nt lds
    s_add_u32 m0, s28, 17408
    s_add_u32 s37, s3, 0x108000
    buffer_load_dwordx4 v17, s[88:91], s37 offen nt lds
    s_add_u32 m0, s28, 18432
    s_add_u32 s37, s3, 0x110000
    buffer_load_dwordx4 v18, s[88:91], s37 offen nt lds
    s_add_u32 m0, s28, 19456
    s_add_u32 s37, s3, 0x118000
    buffer_load_dwordx4 v19, s[88:91], s37 offen nt lds
    s_add_u32 m0, s28, 20480
    s_add_u32 s37, s3, 0x120000
    buffer_load_dwordx4 v16, s[88:91], s37 offen nt lds
    s_add_u32 m0, s28, 21504
    s_add_u32 s37, s3, 0x128000
    buffer_load_dwordx4 v17, s[88:91], s37 offen nt lds
    s_add_u32 m0, s28, 22528
    s_add_u32 s37, s3, 0x130000
    buffer_load_dwordx4 v18, s[88:91], s37 offen nt lds
    s_add_u32 m0, s28, 23552
    s_add_u32 s37, s3, 0x138000
    buffer_load_dwordx4 v19, s[88:91], s37 offen nt lds
    s_waitcnt vmcnt(48)
    s_barrier
    s_getreg_b32 s36, hwreg(HW_REG_XCC_ID)
    s_and_b32 s36, s36, 15
    s_or_b32 s36, s36, 0x100
    v_mov_b32 v30, s36
    s_lshl_b32 s37, s20, 2
    v_lshlrev_b32 v31, 20, v0
    buffer_store_dword v30, v31, s[16:19], s37 offen offset:128 sc1
    s_waitcnt vmcnt(33)
    v_perm_b32 v120, v49, v48, s34
    v_perm_b32 v121, v49, v48, s35
    v_perm_b32 v122, v51, v50, s34
    v_perm_b32 v123, v51, v50, s35
    v_perm_b32 v124, v53, v52, s34
    v_perm_b32 v125, v53, v52, s35
    v_perm_b32 v126, v55, v54, s34
    v_perm_b32 v127, v55, v54, s35
    ds_write_b128 v4, v[120:123] offset:28672
    ds_write_b128 v4, v[124:127] offset:29696
    s_waitcnt lgkmcnt(0)
    v_perm_b32 v120, v57, v56, s34
    v_perm_b32 v121, v57, v56, s35
    v_perm_b32 v122, v59, v58, s34
    v_perm_b32 v123, v59, v58, s35
    v_perm_b32 v124, v61, v60, s34
    v_perm_b32 v125, v61, v60, s35
    v_perm_b32 v126, v63, v62, s34
    v_perm_b32 v127, v63, v62, s35
    ds_write_b128 v4, v[120:123] offset:30720
    ds_write_b128 v4, v[124:127] offset:31744
    s_waitcnt lgkmcnt(0)
    s_xor_b32 s36, s21, 1
    s_lshl_b32 s36, s36, 15
    s_add_u32 s36, s36, s29
    s_add_u32 s37, s36, 0x80
    buffer_load_dword v32, v11, s[92:95], s37 offen
    s_add_u32 s37, s36, 0x4080
    buffer_load_dword v33, v11, s[92:95], s37 offen
    s_add_u32 s37, s36, 0x480
    buffer_load_dword v34, v11, s[92:95], s37 offen
    s_add_u32 s37, s36, 0x4480
    buffer_load_dword v35, v11, s[92:95], s37 offen
    s_add_u32 s37, s36, 0x2080
    buffer_load_dword v36, v11, s[92:95], s37 offen
    s_add_u32 s37, s36, 0x6080
    buffer_load_dword v37, v11, s[92:95], s37 offen
    s_add_u32 s37, s36, 0x2480
    buffer_load_dword v38, v11, s[92:95], s37 offen
    s_add_u32 s37, s36, 0x6480
    buffer_load_dword v39, v11, s[92:95], s37 offen
    s_add_u32 s37, s36, 0xc0
    buffer_load_dword v40, v11, s[92:95], s37 offen
    s_add_u32 s37, s36, 0x40c0
    buffer_load_dword v41, v11, s[92:95], s37 offen
    s_add_u32 s37, s36, 0x4c0
    buffer_load_dword v42, v11, s[92:95], s37 offen
    s_add_u32 s37, s36, 0x44c0
    buffer_load_dword v43, v11, s[92:95], s37 offen
    s_add_u32 s37, s36, 0x20c0
    buffer_load_dword v44, v11, s[92:95], s37 offen
    s_add_u32 s37, s36, 0x60c0
    buffer_load_dword v45, v11, s[92:95], s37 offen
    s_add_u32 s37, s36, 0x24c0
    buffer_load_dword v46, v11, s[92:95], s37 offen
    s_add_u32 s37, s36, 0x64c0
    buffer_load_dword v47, v11, s[92:95], s37 offen
    s_barrier
    ds_read_b64_tr_b16 a[180:181], v20 offset:0
    ds_read_b64_tr_b16 a[182:183], v20 offset:512
    ds_read_b64_tr_b16 a[188:189], v21 offset:0
    ds_read_b64_tr_b16 a[190:191], v21 offset:512
    ds_read_b64_tr_b16 a[212:213], v22 offset:0
    ds_read_b64_tr_b16 a[214:215], v22 offset:512
    ds_read_b64_tr_b16 a[220:221], v23 offset:0
    ds_read_b64_tr_b16 a[222:223], v23 offset:512
    ds_read_b64_tr_b16 a[244:245], v24 offset:0
    ds_read_b64_tr_b16 a[246:247], v24 offset:512
    ds_read_b64_tr_b16 a[252:253], v25 offset:0
    ds_read_b64_tr_b16 a[254:255], v25 offset:512
    s_waitcnt lgkmcnt(4)
    ds_read_b64_tr_b16 v[148:149], v26 offset:0
    ds_read_b64_tr_b16 v[150:151], v26 offset:512
    ds_read_b64_tr_b16 v[156:157], v27 offset:0
    ds_read_b64_tr_b16 v[158:159], v27 offset:512
    s_waitcnt lgkmcnt(0)
    s_barrier
    s_add_u32 m0, s28, 0
    s_add_u32 s37, s3, 0x200000
    buffer_load_dwordx4 v16, s[88:91], s37 offen nt lds
    s_add_u32 m0, s28, 1024
    s_add_u32 s37, s3, 0x208000
    buffer_load_dwordx4 v17, s[88:91], s37 offen nt lds
    s_add_u32 m0, s28, 2048
    s_add_u32 s37, s3, 0x210000
    buffer_load_dwordx4 v18, s[88:91], s37 offen nt lds
    s_add_u32 m0, s28, 3072
    s_add_u32 s37, s3, 0x218000
    buffer_load_dwordx4 v19, s[88:91], s37 offen nt lds
    s_add_u32 m0, s28, 4096
    s_add_u32 s37, s3, 0x220000
    buffer_load_dwordx4 v16, s[88:91], s37 offen nt lds
    s_add_u32 m0, s28, 5120
    s_add_u32 s37, s3, 0x228000
    buffer_load_dwordx4 v17, s[88:91], s37 offen nt lds
    s_add_u32 m0, s28, 6144
    s_add_u32 s37, s3, 0x230000
    buffer_load_dwordx4 v18, s[88:91], s37 offen nt lds
    s_add_u32 m0, s28, 7168
    s_add_u32 s37, s3, 0x238000
    buffer_load_dwordx4 v19, s[88:91], s37 offen nt lds
    s_waitcnt vmcnt(33)
    v_perm_b32 v160, v81, v80, s34
    v_perm_b32 v161, v81, v80, s35
    v_perm_b32 v162, v83, v82, s34
    v_perm_b32 v163, v83, v82, s35
    v_perm_b32 v164, v85, v84, s34
    v_perm_b32 v165, v85, v84, s35
    v_perm_b32 v166, v87, v86, s34
    v_perm_b32 v167, v87, v86, s35
    v_perm_b32 v168, v89, v88, s34
    v_perm_b32 v169, v89, v88, s35
    v_perm_b32 v170, v91, v90, s34
    v_perm_b32 v171, v91, v90, s35
    v_perm_b32 v172, v93, v92, s34
    v_perm_b32 v173, v93, v92, s35
    v_perm_b32 v174, v95, v94, s34
    v_perm_b32 v175, v95, v94, s35
    s_xor_b32 s36, s21, 2
    s_lshl_b32 s36, s36, 15
    s_add_u32 s36, s36, s29
    s_add_u32 s37, s36, 0x0
    buffer_load_dword v48, v11, s[92:95], s37 offen
    s_add_u32 s37, s36, 0x4000
    buffer_load_dword v49, v11, s[92:95], s37 offen
    s_add_u32 s37, s36, 0x400
    buffer_load_dword v50, v11, s[92:95], s37 offen
    s_add_u32 s37, s36, 0x4400
    buffer_load_dword v51, v11, s[92:95], s37 offen
    s_add_u32 s37, s36, 0x2000
    buffer_load_dword v52, v11, s[92:95], s37 offen
    s_add_u32 s37, s36, 0x6000
    buffer_load_dword v53, v11, s[92:95], s37 offen
    s_add_u32 s37, s36, 0x2400
    buffer_load_dword v54, v11, s[92:95], s37 offen
    s_add_u32 s37, s36, 0x6400
    buffer_load_dword v55, v11, s[92:95], s37 offen
    s_add_u32 s37, s36, 0x40
    buffer_load_dword v56, v11, s[92:95], s37 offen
    s_add_u32 s37, s36, 0x4040
    buffer_load_dword v57, v11, s[92:95], s37 offen
    s_add_u32 s37, s36, 0x440
    buffer_load_dword v58, v11, s[92:95], s37 offen
    s_add_u32 s37, s36, 0x4440
    buffer_load_dword v59, v11, s[92:95], s37 offen
    s_add_u32 s37, s36, 0x2040
    buffer_load_dword v60, v11, s[92:95], s37 offen
    s_add_u32 s37, s36, 0x6040
    buffer_load_dword v61, v11, s[92:95], s37 offen
    s_add_u32 s37, s36, 0x2440
    buffer_load_dword v62, v11, s[92:95], s37 offen
    s_add_u32 s37, s36, 0x6440
    buffer_load_dword v63, v11, s[92:95], s37 offen
    s_barrier
    ds_read_b64_tr_b16 v[64:65], v20 offset:8192
    ds_read_b64_tr_b16 v[66:67], v20 offset:8704
    ds_read_b64_tr_b16 v[72:73], v21 offset:8192
    ds_read_b64_tr_b16 v[74:75], v21 offset:8704
    ds_read_b64_tr_b16 v[96:97], v22 offset:8192
    ds_read_b64_tr_b16 v[98:99], v22 offset:8704
    ds_read_b64_tr_b16 v[104:105], v23 offset:8192
    ds_read_b64_tr_b16 v[106:107], v23 offset:8704
    ds_read_b64_tr_b16 a[112:113], v24 offset:8192
    ds_read_b64_tr_b16 a[114:115], v24 offset:8704
    ds_read_b64_tr_b16 a[120:121], v25 offset:8192
    ds_read_b64_tr_b16 a[122:123], v25 offset:8704
    s_waitcnt lgkmcnt(4)
    ds_read_b64_tr_b16 a[144:145], v26 offset:8192
    ds_read_b64_tr_b16 a[146:147], v26 offset:8704
    ds_read_b64_tr_b16 a[152:153], v27 offset:8192
    ds_read_b64_tr_b16 a[154:155], v27 offset:8704
    s_waitcnt lgkmcnt(0)
    s_barrier
    s_add_u32 m0, s28, 8192
    s_add_u32 s37, s3, 0x300000
    buffer_load_dwordx4 v16, s[88:91], s37 offen nt lds
    s_add_u32 m0, s28, 9216
    s_add_u32 s37, s3, 0x308000
    buffer_load_dwordx4 v17, s[88:91], s37 offen nt lds
    s_add_u32 m0, s28, 10240
    s_add_u32 s37, s3, 0x310000
    buffer_load_dwordx4 v18, s[88:91], s37 offen nt lds
    s_add_u32 m0, s28, 11264
    s_add_u32 s37, s3, 0x318000
    buffer_load_dwordx4 v19, s[88:91], s37 offen nt lds
    s_add_u32 m0, s28, 12288
    s_add_u32 s37, s3, 0x320000
    buffer_load_dwordx4 v16, s[88:91], s37 offen nt lds
    s_add_u32 m0, s28, 13312
    s_add_u32 s37, s3, 0x328000
    buffer_load_dwordx4 v17, s[88:91], s37 offen nt lds
    s_add_u32 m0, s28, 14336
    s_add_u32 s37, s3, 0x330000
    buffer_load_dwordx4 v18, s[88:91], s37 offen nt lds
    s_add_u32 m0, s28, 15360
    s_add_u32 s37, s3, 0x338000
    buffer_load_dwordx4 v19, s[88:91], s37 offen nt lds
    s_waitcnt vmcnt(32)
    v_perm_b32 v176, v33, v32, s34
    v_perm_b32 v177, v33, v32, s35
    v_perm_b32 v178, v35, v34, s34
    v_perm_b32 v179, v35, v34, s35
    v_perm_b32 v180, v37, v36, s34
    v_perm_b32 v181, v37, v36, s35
    v_perm_b32 v182, v39, v38, s34
    v_perm_b32 v183, v39, v38, s35
    v_perm_b32 v184, v41, v40, s34
    v_perm_b32 v185, v41, v40, s35
    v_perm_b32 v186, v43, v42, s34
    v_perm_b32 v187, v43, v42, s35
    v_perm_b32 v188, v45, v44, s34
    v_perm_b32 v189, v45, v44, s35
    v_perm_b32 v190, v47, v46, s34
    v_perm_b32 v191, v47, v46, s35
    s_xor_b32 s36, s21, 2
    s_lshl_b32 s36, s36, 15
    s_add_u32 s36, s36, s29
    s_add_u32 s37, s36, 0x80
    buffer_load_dword v80, v11, s[92:95], s37 offen
    s_add_u32 s37, s36, 0x4080
    buffer_load_dword v81, v11, s[92:95], s37 offen
    s_add_u32 s37, s36, 0x480
    buffer_load_dword v82, v11, s[92:95], s37 offen
    s_add_u32 s37, s36, 0x4480
    buffer_load_dword v83, v11, s[92:95], s37 offen
    s_add_u32 s37, s36, 0x2080
    buffer_load_dword v84, v11, s[92:95], s37 offen
    s_add_u32 s37, s36, 0x6080
    buffer_load_dword v85, v11, s[92:95], s37 offen
    s_add_u32 s37, s36, 0x2480
    buffer_load_dword v86, v11, s[92:95], s37 offen
    s_add_u32 s37, s36, 0x6480
    buffer_load_dword v87, v11, s[92:95], s37 offen
    s_add_u32 s37, s36, 0xc0
    buffer_load_dword v88, v11, s[92:95], s37 offen
    s_add_u32 s37, s36, 0x40c0
    buffer_load_dword v89, v11, s[92:95], s37 offen
    s_add_u32 s37, s36, 0x4c0
    buffer_load_dword v90, v11, s[92:95], s37 offen
    s_add_u32 s37, s36, 0x44c0
    buffer_load_dword v91, v11, s[92:95], s37 offen
    s_add_u32 s37, s36, 0x20c0
    buffer_load_dword v92, v11, s[92:95], s37 offen
    s_add_u32 s37, s36, 0x60c0
    buffer_load_dword v93, v11, s[92:95], s37 offen
    s_add_u32 s37, s36, 0x24c0
    buffer_load_dword v94, v11, s[92:95], s37 offen
    s_add_u32 s37, s36, 0x64c0
    buffer_load_dword v95, v11, s[92:95], s37 offen
    s_barrier
    ds_read_b64_tr_b16 v[68:69], v20 offset:16384
    ds_read_b64_tr_b16 v[70:71], v20 offset:16896
    ds_read_b64_tr_b16 v[76:77], v21 offset:16384
    ds_read_b64_tr_b16 v[78:79], v21 offset:16896
    ds_read_b64_tr_b16 v[100:101], v22 offset:16384
    ds_read_b64_tr_b16 v[102:103], v22 offset:16896
    ds_read_b64_tr_b16 v[108:109], v23 offset:16384
    ds_read_b64_tr_b16 v[110:111], v23 offset:16896
    ds_read_b64_tr_b16 a[116:117], v24 offset:16384
    ds_read_b64_tr_b16 a[118:119], v24 offset:16896
    ds_read_b64_tr_b16 a[124:125], v25 offset:16384
    ds_read_b64_tr_b16 a[126:127], v25 offset:16896
    s_waitcnt lgkmcnt(4)
    ds_read_b64_tr_b16 a[148:149], v26 offset:16384
    ds_read_b64_tr_b16 a[150:151], v26 offset:16896
    ds_read_b64_tr_b16 a[156:157], v27 offset:16384
    ds_read_b64_tr_b16 a[158:159], v27 offset:16896
    s_waitcnt lgkmcnt(0)
    s_barrier
    s_add_u32 m0, s28, 16384
    s_add_u32 s37, s3, 0x0
    buffer_load_dwordx4 v16, s[96:99], s37 offen nt lds
    s_add_u32 m0, s28, 17408
    s_add_u32 s37, s3, 0x8000
    buffer_load_dwordx4 v17, s[96:99], s37 offen nt lds
    s_add_u32 m0, s28, 18432
    s_add_u32 s37, s3, 0x10000
    buffer_load_dwordx4 v18, s[96:99], s37 offen nt lds
    s_add_u32 m0, s28, 19456
    s_add_u32 s37, s3, 0x18000
    buffer_load_dwordx4 v19, s[96:99], s37 offen nt lds
    s_add_u32 m0, s28, 20480
    s_add_u32 s37, s3, 0x20000
    buffer_load_dwordx4 v16, s[96:99], s37 offen nt lds
    s_add_u32 m0, s28, 21504
    s_add_u32 s37, s3, 0x28000
    buffer_load_dwordx4 v17, s[96:99], s37 offen nt lds
    s_add_u32 m0, s28, 22528
    s_add_u32 s37, s3, 0x30000
    buffer_load_dwordx4 v18, s[96:99], s37 offen nt lds
    s_add_u32 m0, s28, 23552
    s_add_u32 s37, s3, 0x38000
    buffer_load_dwordx4 v19, s[96:99], s37 offen nt lds
    s_waitcnt vmcnt(32)
    v_perm_b32 v192, v49, v48, s34
    v_perm_b32 v193, v49, v48, s35
    v_perm_b32 v194, v51, v50, s34
    v_perm_b32 v195, v51, v50, s35
    v_perm_b32 v196, v53, v52, s34
    v_perm_b32 v197, v53, v52, s35
    v_perm_b32 v198, v55, v54, s34
    v_perm_b32 v199, v55, v54, s35
    v_perm_b32 v200, v57, v56, s34
    v_perm_b32 v201, v57, v56, s35
    v_perm_b32 v202, v59, v58, s34
    v_perm_b32 v203, v59, v58, s35
    v_perm_b32 v204, v61, v60, s34
    v_perm_b32 v205, v61, v60, s35
    v_perm_b32 v206, v63, v62, s34
    v_perm_b32 v207, v63, v62, s35
    s_xor_b32 s36, s21, 3
    s_lshl_b32 s36, s36, 15
    s_add_u32 s36, s36, s29
    s_add_u32 s37, s36, 0x0
    buffer_load_dword v32, v11, s[92:95], s37 offen
    s_add_u32 s37, s36, 0x4000
    buffer_load_dword v33, v11, s[92:95], s37 offen
    s_add_u32 s37, s36, 0x400
    buffer_load_dword v34, v11, s[92:95], s37 offen
    s_add_u32 s37, s36, 0x4400
    buffer_load_dword v35, v11, s[92:95], s37 offen
    s_add_u32 s37, s36, 0x2000
    buffer_load_dword v36, v11, s[92:95], s37 offen
    s_add_u32 s37, s36, 0x6000
    buffer_load_dword v37, v11, s[92:95], s37 offen
    s_add_u32 s37, s36, 0x2400
    buffer_load_dword v38, v11, s[92:95], s37 offen
    s_add_u32 s37, s36, 0x6400
    buffer_load_dword v39, v11, s[92:95], s37 offen
    s_add_u32 s37, s36, 0x40
    buffer_load_dword v40, v11, s[92:95], s37 offen
    s_add_u32 s37, s36, 0x4040
    buffer_load_dword v41, v11, s[92:95], s37 offen
    s_add_u32 s37, s36, 0x440
    buffer_load_dword v42, v11, s[92:95], s37 offen
    s_add_u32 s37, s36, 0x4440
    buffer_load_dword v43, v11, s[92:95], s37 offen
    s_add_u32 s37, s36, 0x2040
    buffer_load_dword v44, v11, s[92:95], s37 offen
    s_add_u32 s37, s36, 0x6040
    buffer_load_dword v45, v11, s[92:95], s37 offen
    s_add_u32 s37, s36, 0x2440
    buffer_load_dword v46, v11, s[92:95], s37 offen
    s_add_u32 s37, s36, 0x6440
    buffer_load_dword v47, v11, s[92:95], s37 offen
    s_barrier
    ds_read_b64_tr_b16 a[80:81], v20 offset:0
    ds_read_b64_tr_b16 a[82:83], v20 offset:512
    ds_read_b64_tr_b16 a[88:89], v21 offset:0
    ds_read_b64_tr_b16 a[90:91], v21 offset:512
    ds_read_b64_tr_b16 a[96:97], v22 offset:0
    ds_read_b64_tr_b16 a[98:99], v22 offset:512
    ds_read_b64_tr_b16 a[104:105], v23 offset:0
    ds_read_b64_tr_b16 a[106:107], v23 offset:512
    ds_read_b64_tr_b16 a[128:129], v24 offset:0
    ds_read_b64_tr_b16 a[130:131], v24 offset:512
    ds_read_b64_tr_b16 a[136:137], v25 offset:0
    ds_read_b64_tr_b16 a[138:139], v25 offset:512
    s_waitcnt lgkmcnt(4)
    ds_read_b64_tr_b16 v[112:113], v26 offset:0
    ds_read_b64_tr_b16 v[114:115], v26 offset:512
    ds_read_b64_tr_b16 v[120:121], v27 offset:0
    ds_read_b64_tr_b16 v[122:123], v27 offset:512
    s_waitcnt lgkmcnt(0)
    s_barrier
    s_add_u32 m0, s28, 0
    s_add_u32 s37, s3, 0x100000
    buffer_load_dwordx4 v16, s[96:99], s37 offen nt lds
    s_add_u32 m0, s28, 1024
    s_add_u32 s37, s3, 0x108000
    buffer_load_dwordx4 v17, s[96:99], s37 offen nt lds
    s_add_u32 m0, s28, 2048
    s_add_u32 s37, s3, 0x110000
    buffer_load_dwordx4 v18, s[96:99], s37 offen nt lds
    s_add_u32 m0, s28, 3072
    s_add_u32 s37, s3, 0x118000
    buffer_load_dwordx4 v19, s[96:99], s37 offen nt lds
    s_add_u32 m0, s28, 4096
    s_add_u32 s37, s3, 0x120000
    buffer_load_dwordx4 v16, s[96:99], s37 offen nt lds
    s_add_u32 m0, s28, 5120
    s_add_u32 s37, s3, 0x128000
    buffer_load_dwordx4 v17, s[96:99], s37 offen nt lds
    s_add_u32 m0, s28, 6144
    s_add_u32 s37, s3, 0x130000
    buffer_load_dwordx4 v18, s[96:99], s37 offen nt lds
    s_add_u32 m0, s28, 7168
    s_add_u32 s37, s3, 0x138000
    buffer_load_dwordx4 v19, s[96:99], s37 offen nt lds
    s_waitcnt vmcnt(32)
    v_perm_b32 v208, v81, v80, s34
    v_perm_b32 v209, v81, v80, s35
    v_perm_b32 v210, v83, v82, s34
    v_perm_b32 v211, v83, v82, s35
    v_perm_b32 v212, v85, v84, s34
    v_perm_b32 v213, v85, v84, s35
    v_perm_b32 v214, v87, v86, s34
    v_perm_b32 v215, v87, v86, s35
    v_perm_b32 v216, v89, v88, s34
    v_perm_b32 v217, v89, v88, s35
    v_perm_b32 v218, v91, v90, s34
    v_perm_b32 v219, v91, v90, s35
    v_perm_b32 v220, v93, v92, s34
    v_perm_b32 v221, v93, v92, s35
    v_perm_b32 v222, v95, v94, s34
    v_perm_b32 v223, v95, v94, s35
    s_xor_b32 s36, s21, 3
    s_lshl_b32 s36, s36, 15
    s_add_u32 s36, s36, s29
    s_add_u32 s37, s36, 0x80
    buffer_load_dword v48, v11, s[92:95], s37 offen
    s_add_u32 s37, s36, 0x4080
    buffer_load_dword v49, v11, s[92:95], s37 offen
    s_add_u32 s37, s36, 0x480
    buffer_load_dword v50, v11, s[92:95], s37 offen
    s_add_u32 s37, s36, 0x4480
    buffer_load_dword v51, v11, s[92:95], s37 offen
    s_add_u32 s37, s36, 0x2080
    buffer_load_dword v52, v11, s[92:95], s37 offen
    s_add_u32 s37, s36, 0x6080
    buffer_load_dword v53, v11, s[92:95], s37 offen
    s_add_u32 s37, s36, 0x2480
    buffer_load_dword v54, v11, s[92:95], s37 offen
    s_add_u32 s37, s36, 0x6480
    buffer_load_dword v55, v11, s[92:95], s37 offen
    s_add_u32 s37, s36, 0xc0
    buffer_load_dword v56, v11, s[92:95], s37 offen
    s_add_u32 s37, s36, 0x40c0
    buffer_load_dword v57, v11, s[92:95], s37 offen
    s_add_u32 s37, s36, 0x4c0
    buffer_load_dword v58, v11, s[92:95], s37 offen
    s_add_u32 s37, s36, 0x44c0
    buffer_load_dword v59, v11, s[92:95], s37 offen
    s_add_u32 s37, s36, 0x20c0
    buffer_load_dword v60, v11, s[92:95], s37 offen
    s_add_u32 s37, s36, 0x60c0
    buffer_load_dword v61, v11, s[92:95], s37 offen
    s_add_u32 s37, s36, 0x24c0
    buffer_load_dword v62, v11, s[92:95], s37 offen
    s_add_u32 s37, s36, 0x64c0
    buffer_load_dword v63, v11, s[92:95], s37 offen
    s_barrier
    ds_read_b64_tr_b16 a[84:85], v20 offset:8192
    ds_read_b64_tr_b16 a[86:87], v20 offset:8704
    ds_read_b64_tr_b16 a[92:93], v21 offset:8192
    ds_read_b64_tr_b16 a[94:95], v21 offset:8704
    ds_read_b64_tr_b16 a[100:101], v22 offset:8192
    ds_read_b64_tr_b16 a[102:103], v22 offset:8704
    ds_read_b64_tr_b16 a[108:109], v23 offset:8192
    ds_read_b64_tr_b16 a[110:111], v23 offset:8704
    ds_read_b64_tr_b16 a[132:133], v24 offset:8192
    ds_read_b64_tr_b16 a[134:135], v24 offset:8704
    ds_read_b64_tr_b16 a[140:141], v25 offset:8192
    ds_read_b64_tr_b16 a[142:143], v25 offset:8704
    s_waitcnt lgkmcnt(4)
    ds_read_b64_tr_b16 v[116:117], v26 offset:8192
    ds_read_b64_tr_b16 v[118:119], v26 offset:8704
    ds_read_b64_tr_b16 v[124:125], v27 offset:8192
    ds_read_b64_tr_b16 v[126:127], v27 offset:8704
    s_waitcnt lgkmcnt(0)
    s_barrier
    s_add_u32 m0, s28, 8192
    s_add_u32 s37, s3, 0x200000
    buffer_load_dwordx4 v16, s[96:99], s37 offen nt lds
    s_add_u32 m0, s28, 9216
    s_add_u32 s37, s3, 0x208000
    buffer_load_dwordx4 v17, s[96:99], s37 offen nt lds
    s_add_u32 m0, s28, 10240
    s_add_u32 s37, s3, 0x210000
    buffer_load_dwordx4 v18, s[96:99], s37 offen nt lds
    s_add_u32 m0, s28, 11264
    s_add_u32 s37, s3, 0x218000
    buffer_load_dwordx4 v19, s[96:99], s37 offen nt lds
    s_add_u32 m0, s28, 12288
    s_add_u32 s37, s3, 0x220000
    buffer_load_dwordx4 v16, s[96:99], s37 offen nt lds
    s_add_u32 m0, s28, 13312
    s_add_u32 s37, s3, 0x228000
    buffer_load_dwordx4 v17, s[96:99], s37 offen nt lds
    s_add_u32 m0, s28, 14336
    s_add_u32 s37, s3, 0x230000
    buffer_load_dwordx4 v18, s[96:99], s37 offen nt lds
    s_add_u32 m0, s28, 15360
    s_add_u32 s37, s3, 0x238000
    buffer_load_dwordx4 v19, s[96:99], s37 offen nt lds
    s_waitcnt vmcnt(32)
    v_perm_b32 v224, v33, v32, s34
    v_perm_b32 v225, v33, v32, s35
    v_perm_b32 v226, v35, v34, s34
    v_perm_b32 v227, v35, v34, s35
    v_perm_b32 v228, v37, v36, s34
    v_perm_b32 v229, v37, v36, s35
    v_perm_b32 v230, v39, v38, s34
    v_perm_b32 v231, v39, v38, s35
    v_perm_b32 v232, v41, v40, s34
    v_perm_b32 v233, v41, v40, s35
    v_perm_b32 v234, v43, v42, s34
    v_perm_b32 v235, v43, v42, s35
    v_perm_b32 v236, v45, v44, s34
    v_perm_b32 v237, v45, v44, s35
    v_perm_b32 v238, v47, v46, s34
    v_perm_b32 v239, v47, v46, s35
    s_barrier
    ds_read_b64_tr_b16 v[32:33], v20 offset:16384
    ds_read_b64_tr_b16 v[34:35], v20 offset:16896
    ds_read_b64_tr_b16 v[40:41], v21 offset:16384
    ds_read_b64_tr_b16 v[42:43], v21 offset:16896
    ds_read_b64_tr_b16 a[0:1], v22 offset:16384
    ds_read_b64_tr_b16 a[2:3], v22 offset:16896
    ds_read_b64_tr_b16 a[8:9], v23 offset:16384
    ds_read_b64_tr_b16 a[10:11], v23 offset:16896
    ds_read_b64_tr_b16 a[32:33], v24 offset:16384
    ds_read_b64_tr_b16 a[34:35], v24 offset:16896
    ds_read_b64_tr_b16 a[40:41], v25 offset:16384
    ds_read_b64_tr_b16 a[42:43], v25 offset:16896
    s_waitcnt lgkmcnt(4)
    ds_read_b64_tr_b16 a[64:65], v26 offset:16384
    ds_read_b64_tr_b16 a[66:67], v26 offset:16896
    ds_read_b64_tr_b16 a[72:73], v27 offset:16384
    ds_read_b64_tr_b16 a[74:75], v27 offset:16896
    s_waitcnt lgkmcnt(0)
    s_barrier
    s_add_u32 m0, s28, 16384
    s_add_u32 s37, s3, 0x300000
    buffer_load_dwordx4 v16, s[96:99], s37 offen nt lds
    s_add_u32 m0, s28, 17408
    s_add_u32 s37, s3, 0x308000
    buffer_load_dwordx4 v17, s[96:99], s37 offen nt lds
    s_add_u32 m0, s28, 18432
    s_add_u32 s37, s3, 0x310000
    buffer_load_dwordx4 v18, s[96:99], s37 offen nt lds
    s_add_u32 m0, s28, 19456
    s_add_u32 s37, s3, 0x318000
    buffer_load_dwordx4 v19, s[96:99], s37 offen nt lds
    s_add_u32 m0, s28, 20480
    s_add_u32 s37, s3, 0x320000
    buffer_load_dwordx4 v16, s[96:99], s37 offen nt lds
    s_add_u32 m0, s28, 21504
    s_add_u32 s37, s3, 0x328000
    buffer_load_dwordx4 v17, s[96:99], s37 offen nt lds
    s_add_u32 m0, s28, 22528
    s_add_u32 s37, s3, 0x330000
    buffer_load_dwordx4 v18, s[96:99], s37 offen nt lds
    s_add_u32 m0, s28, 23552
    s_add_u32 s37, s3, 0x338000
    buffer_load_dwordx4 v19, s[96:99], s37 offen nt lds
    s_waitcnt vmcnt(16)
    v_perm_b32 v240, v49, v48, s34
    v_perm_b32 v241, v49, v48, s35
    v_perm_b32 v242, v51, v50, s34
    v_perm_b32 v243, v51, v50, s35
    v_perm_b32 v244, v53, v52, s34
    v_perm_b32 v245, v53, v52, s35
    v_perm_b32 v246, v55, v54, s34
    v_perm_b32 v247, v55, v54, s35
    v_perm_b32 v248, v57, v56, s34
    v_perm_b32 v249, v57, v56, s35
    v_perm_b32 v250, v59, v58, s34
    v_perm_b32 v251, v59, v58, s35
    v_perm_b32 v252, v61, v60, s34
    v_perm_b32 v253, v61, v60, s35
    v_perm_b32 v254, v63, v62, s34
    v_perm_b32 v255, v63, v62, s35
    s_barrier
    ds_read_b64_tr_b16 v[36:37], v20 offset:0
    ds_read_b64_tr_b16 v[38:39], v20 offset:512
    ds_read_b64_tr_b16 v[44:45], v21 offset:0
    ds_read_b64_tr_b16 v[46:47], v21 offset:512
    ds_read_b64_tr_b16 a[4:5], v22 offset:0
    ds_read_b64_tr_b16 a[6:7], v22 offset:512
    ds_read_b64_tr_b16 a[12:13], v23 offset:0
    ds_read_b64_tr_b16 a[14:15], v23 offset:512
    ds_read_b64_tr_b16 a[36:37], v24 offset:0
    ds_read_b64_tr_b16 a[38:39], v24 offset:512
    ds_read_b64_tr_b16 a[44:45], v25 offset:0
    ds_read_b64_tr_b16 a[46:47], v25 offset:512
    s_waitcnt lgkmcnt(4)
    ds_read_b64_tr_b16 a[68:69], v26 offset:0
    ds_read_b64_tr_b16 a[70:71], v26 offset:512
    ds_read_b64_tr_b16 a[76:77], v27 offset:0
    ds_read_b64_tr_b16 a[78:79], v27 offset:512
    s_waitcnt lgkmcnt(0)
    s_barrier
    s_waitcnt vmcnt(8)
    s_barrier
    ds_read_b64_tr_b16 v[48:49], v20 offset:8192
    ds_read_b64_tr_b16 v[50:51], v20 offset:8704
    ds_read_b64_tr_b16 v[56:57], v21 offset:8192
    ds_read_b64_tr_b16 v[58:59], v21 offset:8704
    ds_read_b64_tr_b16 a[16:17], v22 offset:8192
    ds_read_b64_tr_b16 a[18:19], v22 offset:8704
    ds_read_b64_tr_b16 a[24:25], v23 offset:8192
    ds_read_b64_tr_b16 a[26:27], v23 offset:8704
    ds_read_b64_tr_b16 a[48:49], v24 offset:8192
    ds_read_b64_tr_b16 a[50:51], v24 offset:8704
    ds_read_b64_tr_b16 a[56:57], v25 offset:8192
    ds_read_b64_tr_b16 a[58:59], v25 offset:8704
    s_waitcnt lgkmcnt(4)
    ds_read_b64_tr_b16 v[80:81], v26 offset:8192
    ds_read_b64_tr_b16 v[82:83], v26 offset:8704
    ds_read_b64_tr_b16 v[88:89], v27 offset:8192
    ds_read_b64_tr_b16 v[90:91], v27 offset:8704
    s_waitcnt lgkmcnt(0)
    s_barrier
    s_waitcnt vmcnt(0)
    s_barrier
    ds_read_b64_tr_b16 v[52:53], v20 offset:16384
    ds_read_b64_tr_b16 v[54:55], v20 offset:16896
    ds_read_b64_tr_b16 v[60:61], v21 offset:16384
    ds_read_b64_tr_b16 v[62:63], v21 offset:16896
    ds_read_b64_tr_b16 a[20:21], v22 offset:16384
    ds_read_b64_tr_b16 a[22:23], v22 offset:16896
    ds_read_b64_tr_b16 a[28:29], v23 offset:16384
    ds_read_b64_tr_b16 a[30:31], v23 offset:16896
    ds_read_b64_tr_b16 a[52:53], v24 offset:16384
    ds_read_b64_tr_b16 a[54:55], v24 offset:16896
    ds_read_b64_tr_b16 a[60:61], v25 offset:16384
    ds_read_b64_tr_b16 a[62:63], v25 offset:16896
    s_waitcnt lgkmcnt(4)
    ds_read_b64_tr_b16 v[84:85], v26 offset:16384
    ds_read_b64_tr_b16 v[86:87], v26 offset:16896
    ds_read_b64_tr_b16 v[92:93], v27 offset:16384
    ds_read_b64_tr_b16 v[94:95], v27 offset:16896
    s_waitcnt lgkmcnt(0)
    s_barrier
    ds_write_b128 v4, v[32:35] offset:0
    ds_write_b128 v4, v[36:39] offset:1024
    ds_write_b128 v4, v[40:43] offset:2048
    ds_write_b128 v4, v[44:47] offset:3072
    ds_write_b128 v4, v[48:51] offset:4096
    ds_write_b128 v4, v[52:55] offset:5120
    ds_write_b128 v4, v[56:59] offset:6144
    ds_write_b128 v4, v[60:63] offset:7168
    s_waitcnt lgkmcnt(0)
    ds_write_b128 v4, v[64:67] offset:8192
    ds_write_b128 v4, v[68:71] offset:9216
    ds_write_b128 v4, v[72:75] offset:10240
    ds_write_b128 v4, v[76:79] offset:11264
    ds_write_b128 v4, v[80:83] offset:12288
    ds_write_b128 v4, v[84:87] offset:13312
    ds_write_b128 v4, v[88:91] offset:14336
    ds_write_b128 v4, v[92:95] offset:15360
    s_waitcnt lgkmcnt(0)
    ds_write_b128 v4, v[96:99] offset:16384
    ds_write_b128 v4, v[100:103] offset:17408
    ds_write_b128 v4, v[104:107] offset:18432
    ds_write_b128 v4, v[108:111] offset:19456
    ds_write_b128 v4, v[112:115] offset:20480
    ds_write_b128 v4, v[116:119] offset:21504
    ds_write_b128 v4, v[120:123] offset:22528
    ds_write_b128 v4, v[124:127] offset:23552
    s_waitcnt lgkmcnt(0)
    s_waitcnt lgkmcnt(0)
    v_mov_b32 v24, 0x0
    v_bfe_u32 v14, v0, 0, 1
    s_mov_b32 s38, 0x80
    v_mad_u32_u24 v24, v14, s38, v24
    v_bfe_u32 v14, v0, 1, 1
    s_mov_b32 s38, 0x100
    v_mad_u32_u24 v24, v14, s38, v24
    v_bfe_u32 v14, v0, 2, 1
    s_mov_b32 s38, 0x200
    v_mad_u32_u24 v24, v14, s38, v24
    v_bfe_u32 v14, v0, 3, 1
    s_mov_b32 s38, 0x400
    v_mad_u32_u24 v24, v14, s38, v24
    v_bfe_u32 v14, v0, 4, 1
    s_mov_b32 s38, 0x800
    v_mad_u32_u24 v24, v14, s38, v24
    v_bfe_u32 v14, v0, 6, 1
    s_mov_b32 s38, 0x1000
    v_mad_u32_u24 v24, v14, s38, v24
    v_bfe_u32 v14, v0, 7, 1
    s_mov_b32 s38, 0x2000
    v_mad_u32_u24 v24, v14, s38, v24
    s_lshl_b32 s36, s20, 14
    v_add_u32 v24, s36, v24
    s_lshl_b32 s36, s20, 8
    s_lshr_b32 s37, s21, 1
    s_lshl_b32 s37, s37, 7
    s_add_u32 s36, s36, s37
    s_add_u32 s36, s36, 0x102000
    v_and_b32 v14, 63, v0
    v_mov_b32 v25, 0x40000000
    v_cmp_lt_u32 vcc, 32, v14
    s_nop 1
    v_cndmask_b32 v24, v24, v25, vcc
    v_mov_b32 v25, s36
    v_cmp_eq_u32 vcc, 32, v14
    s_nop 1
    v_cndmask_b32 v0, v24, v25, vcc
    v_lshrrev_b32 v25, 2, v3
    v_and_b32 v25, 127, v25
L_HS:
    buffer_load_dword v24, v25, s[16:19], 0 offen offset:128 sc1
    s_add_u32 s32, s32, 1
    s_cmp_gt_u32 s32, 200000
    s_cbranch_scc1 L_slow_start
    s_waitcnt vmcnt(0)
    v_cmp_eq_u32 vcc, 0, v24
    s_cbranch_vccnz L_HS
    v_readfirstlane_b32 s36, v24
    s_nop 1
    v_cmp_ne_u32 vcc, s36, v24
    s_cbranch_vccnz L_slow_start
    s_branch L_fast_start
L_fast_start:
    s_mov_b32 s22, 0
    s_mov_b32 s23, 0x1000000
    s_mov_b32 s27, 0
    s_mov_b32 s31, 0x80000
    s_mov_b32 s61, 0x40000000
    s_mov_b32 s91, 0
    ds_read_b128 v[104:107], v4 offset:0
    ds_read_b128 v[108:111], v4 offset:1024
    ds_read_b128 v[112:115], v4 offset:2048
    ds_read_b128 v[116:119], v4 offset:3072
    ds_read_b128 v[88:91], v4 offset:4096
    ds_read_b128 v[92:95], v4 offset:5120
    ds_read_b128 v[96:99], v4 offset:6144
    ds_read_b128 v[100:103], v4 offset:7168
    ds_read_b128 v[72:75], v4 offset:8192
    ds_read_b128 v[76:79], v4 offset:9216
    ds_read_b128 v[80:83], v4 offset:10240
    ds_read_b128 v[84:87], v4 offset:11264
    v_mov_b64 v[48:49], 0
    v_mov_b64 v[50:51], 0
    v_mov_b64 v[52:53], 0
    v_mov_b64 v[54:55], 0
    v_mov_b64 v[56:57], 0
    v_mov_b64 v[58:59], 0
    v_mov_b64 v[60:61], 0
    v_mov_b64 v[62:63], 0
    v_mov_b64 v[64:65], 0
    v_mov_b64 v[66:67], 0
    v_mov_b64 v[68:69], 0
    v_mov_b64 v[70:71], 0
    s_mov_b64 s[62:63], 0
    s_add_u32 s7, s23, 0x80000
    buffer_load_dwordx4 v[16:19], v2, s[8:11], s7 offen sc1
    buffer_load_dwordx4 v[20:23], v2, s[8:11], s7 offen offset:1024 sc1
L_fast_step:
    s_lshr_b64 s[36:37], s[62:63], s22
    s_andn2_b32 s36, 3, s36
    s_cbranch_scc1 L_fast_refresh
    s_add_u32 s24, s23, 0x82000
    s_add_u32 s29, s23, s25
    s_add_u32 s30, s23, s39
    s_xor_b32 s28, s27, 1
    s_add_u32 s90, s22, 1
    v_xor_b32 v28, 0x800, v2
    v_xor_b32 v44, 0x1800, v2
    s_nop 11
    buffer_load_dwordx4 v[120:123], v2, s[8:11], s7 offen sc1
    buffer_load_dwordx4 v[124:127], v2, s[8:11], s7 offen offset:1024 sc1
L_fast_waitm:
    s_waitcnt vmcnt(3) lgkmcnt(0)
L_fast_gotm:
    v_smfmac_f32_16x16x64_bf16 v[48:51], v[16:19], v[104:111], v1
    v_max3_u32 v14, v16, v17, v18
    s_waitcnt vmcnt(2)
    v_smfmac_f32_16x16x64_bf16 v[52:55], v[16:19], v[112:119], v1
    v_max3_u32 v24, v19, v20, v21
    v_max3_u32 v14, v14, v22, v23
    v_max_u32 v14, v14, v24
    v_cmp_eq_u32 vcc, -1, v14
    v_smfmac_f32_16x16x64_bf16 v[48:51], v[20:23], v[88:95], v1
    ds_write_b128 v2, v[16:19] offset:0
    s_cbranch_vccnz L_fast_retrym
L_fast_okm:
    v_smfmac_f32_16x16x64_bf16 v[52:55], v[20:23], v[96:103], v1
    ds_write_b128 v2, v[20:23] offset:1024
    v_smfmac_f32_16x16x64_bf16 v[56:59], v[16:19], v[72:79], v1
    buffer_load_dwordx4 v[104:107], v3, s[8:11], s29 offen offset:0 sc1
    v_smfmac_f32_16x16x64_bf16 v[60:63], v[16:19], v[80:87], v1
    buffer_load_dwordx4 v[108:111], v3, s[8:11], s29 offen offset:1024 sc1
    v_smfmac_f32_16x16x64_bf16 v[56:59], v[20:23], a[80:87], v1
    buffer_load_dwordx4 v[112:115], v3, s[8:11], s29 offen offset:2048 sc1
    v_smfmac_f32_16x16x64_bf16 v[60:63], v[20:23], a[88:95], v1
    s_waitcnt lgkmcnt(0)
    s_barrier
    ds_read_b128 v[24:27], v28 offset:0
    v_smfmac_f32_16x16x64_bf16 v[64:67], v[16:19], a[160:167], v1
    ds_read_b128 v[28:31], v28 offset:1024
    v_smfmac_f32_16x16x64_bf16 v[68:71], v[16:19], a[168:175], v1
    buffer_load_dwordx4 v[116:119], v3, s[8:11], s29 offen offset:3072 sc1
    v_smfmac_f32_16x16x64_bf16 v[64:67], v[20:23], a[176:183], v1
    ds_read_b128 v[32:35], v8 offset:0
    v_smfmac_f32_16x16x64_bf16 v[68:71], v[20:23], a[184:191], v1
    ds_read_b128 v[36:39], v8 offset:1024
    s_waitcnt lgkmcnt(3)
    v_smfmac_f32_16x16x64_bf16 v[48:51], v[24:27], a[0:7], v1
    buffer_load_dwordx4 v[120:123], v3, s[8:11], s30 offen offset:0 sc1
    v_smfmac_f32_16x16x64_bf16 v[52:55], v[24:27], a[8:15], v1
    ds_read_b128 v[40:43], v44 offset:0
    s_waitcnt lgkmcnt(3)
    v_smfmac_f32_16x16x64_bf16 v[48:51], v[28:31], a[16:23], v1
    buffer_load_dwordx4 v[124:127], v3, s[8:11], s30 offen offset:1024 sc1
    v_smfmac_f32_16x16x64_bf16 v[52:55], v[28:31], a[24:31], v1
    ds_read_b128 v[44:47], v44 offset:1024
    s_waitcnt lgkmcnt(2)
    v_smfmac_f32_16x16x64_bf16 v[48:51], v[32:35], a[32:39], v1
    v_smfmac_f32_16x16x64_bf16 v[52:55], v[32:35], a[40:47], v1
    ds_read_b128 v[88:91], v4 offset:12288
    v_smfmac_f32_16x16x64_bf16 v[48:51], v[36:39], a[48:55], v1
    ds_read_b128 v[92:95], v4 offset:13312
    s_waitcnt lgkmcnt(2)
    v_smfmac_f32_16x16x64_bf16 v[52:55], v[36:39], a[56:63], v1
    ds_read_b128 v[96:99], v4 offset:14336
    v_smfmac_f32_16x16x64_bf16 v[48:51], v[40:43], a[64:71], v1
    ds_read_b128 v[100:103], v4 offset:15360
    v_smfmac_f32_16x16x64_bf16 v[52:55], v[40:43], a[72:79], v1
    buffer_load_dword v15, v0, s[8:11], s24 offen sc1
    v_smfmac_f32_16x16x64_bf16 v[56:59], v[28:31], a[96:103], v1
    ds_read_b128 v[72:75], v4 offset:16384
    v_smfmac_f32_16x16x64_bf16 v[60:63], v[28:31], a[104:111], v1
    ds_read_b128 v[76:79], v4 offset:17408
    s_waitcnt lgkmcnt(2)
    v_smfmac_f32_16x16x64_bf16 v[48:51], v[44:47], v[88:95], v1
    ds_read_b128 v[80:83], v4 offset:18432
    v_smfmac_f32_16x16x64_bf16 v[52:55], v[44:47], v[96:103], v1
    ds_read_b128 v[84:87], v4 offset:19456
    v_smfmac_f32_16x16x64_bf16 v[56:59], v[32:35], a[112:119], v1
    ds_read_b128 v[88:91], v4 offset:20480
    v_smfmac_f32_16x16x64_bf16 v[60:63], v[32:35], a[120:127], v1
    ds_read_b128 v[92:95], v4 offset:21504
    v_smfmac_f32_16x16x64_bf16 v[56:59], v[36:39], a[128:135], v1
    ds_read_b128 v[96:99], v4 offset:22528
    v_add_f32 v48, v48, v50
    v_add_f32 v49, v49, v51
    v_smfmac_f32_16x16x64_bf16 v[60:63], v[36:39], a[136:143], v1
    ds_read_b128 v[100:103], v4 offset:23552
    v_add_f32 v52, v52, v54
    v_add_f32 v53, v53, v55
    v_smfmac_f32_16x16x64_bf16 v[56:59], v[40:43], a[144:151], v1
    s_waitcnt lgkmcnt(4)
    v_cvt_pk_bf16_f32 v50, v48, v52
    v_cvt_pk_bf16_f32 v51, v49, v53
    v_smfmac_f32_16x16x64_bf16 v[60:63], v[40:43], a[152:159], v1
    ds_write2_b32 v5, v50, v51 offset0:0 offset1:72
    v_smfmac_f32_16x16x64_bf16 v[56:59], v[24:27], v[72:79], v1
    buffer_store_dword v12, v10, s[8:11], s31 offen sc1
    v_smfmac_f32_16x16x64_bf16 v[60:63], v[24:27], v[80:87], v1
    s_waitcnt lgkmcnt(1)
    v_smfmac_f32_16x16x64_bf16 v[56:59], v[44:47], v[88:95], v1
    v_smfmac_f32_16x16x64_bf16 v[60:63], v[44:47], v[96:103], v1
    s_waitcnt lgkmcnt(0)
    s_barrier
    v_smfmac_f32_16x16x64_bf16 v[64:67], v[24:27], a[192:199], v1
    ds_read_b128 v[72:75], v6 offset:0
    v_smfmac_f32_16x16x64_bf16 v[68:71], v[24:27], a[200:207], v1
    ds_read_b128 v[76:79], v6 offset:64
    s_nop 0
    v_add_f32 v56, v56, v58
    v_smfmac_f32_16x16x64_bf16 v[64:67], v[28:31], a[208:215], v1
    ds_read_b128 v[80:83], v6 offset:128
    v_add_f32 v57, v57, v59
    v_smfmac_f32_16x16x64_bf16 v[68:71], v[28:31], a[216:223], v1
    ds_read_b128 v[84:87], v6 offset:192
    v_add_f32 v60, v60, v62
    v_add_f32 v61, v61, v63
    s_waitcnt vmcnt(2) lgkmcnt(3)
    v_mfma_f32_16x16x32_bf16 v[48:51], v[104:107], v[72:75], 0
    s_waitcnt lgkmcnt(2)
    v_cvt_pk_bf16_f32 v58, v56, v60
    v_cvt_pk_bf16_f32 v59, v57, v61
    v_mfma_f32_16x16x32_bf16 v[48:51], v[108:111], v[76:79], v[48:51]
    ds_write2_b32 v7, v58, v59 offset0:0 offset1:72
    s_waitcnt lgkmcnt(2)
    v_mfma_f32_16x16x32_bf16 v[48:51], v[112:115], v[80:83], v[48:51]
    s_waitcnt lgkmcnt(1)
    v_mov_b64 v[104:105], s[4:5]
    v_mov_b64 v[106:107], s[4:5]
    v_mfma_f32_16x16x32_bf16 v[48:51], v[116:119], v[84:87], v[48:51]
    v_mov_b64 v[16:17], 0
    v_mov_b64 v[18:19], 0
    v_smfmac_f32_16x16x64_bf16 v[64:67], v[32:35], a[224:231], v1
    v_mov_b32 v113, 0
    v_smfmac_f32_16x16x64_bf16 v[68:71], v[32:35], a[232:239], v1
    s_waitcnt lgkmcnt(0)
    s_barrier
    v_mov_b32 v115, 0
    v_smfmac_f32_16x16x64_bf16 v[64:67], v[36:39], a[240:247], v1
    ds_read_b128 v[88:91], v6 offset:2304
    v_exp_f32 v48, v48
    v_smfmac_f32_16x16x64_bf16 v[68:71], v[36:39], a[248:255], v1
    ds_read_b128 v[92:95], v6 offset:2368
    v_exp_f32 v49, v49
    v_smfmac_f32_16x16x64_bf16 v[64:67], v[40:43], v[128:135], v1
    ds_read_b128 v[96:99], v6 offset:2432
    v_exp_f32 v50, v50
    v_smfmac_f32_16x16x64_bf16 v[68:71], v[40:43], v[136:143], v1
    ds_read_b128 v[100:103], v6 offset:2496
    v_exp_f32 v51, v51
    s_waitcnt lgkmcnt(3)
    v_mfma_f32_16x16x32_bf16 v[52:55], v[88:91], v[72:75], 0
    s_waitcnt lgkmcnt(2)
    v_cvt_pk_bf16_f32 v108, v48, v49
    v_cvt_pk_bf16_f32 v109, v50, v51
    v_mfma_f32_16x16x32_bf16 v[52:55], v[92:95], v[76:79], v[52:55]
    ds_write_b64 v2, v[108:109] offset:8192
    s_waitcnt lgkmcnt(2)
    v_mfma_f32_16x16x32_bf16 v[52:55], v[96:99], v[80:83], v[52:55]
    s_waitcnt lgkmcnt(1)
    v_mov_b32 v117, 0
    v_mov_b64 v[20:21], 0
    v_mfma_f32_16x16x32_bf16 v[52:55], v[100:103], v[84:87], v[52:55]
    v_mov_b64 v[22:23], 0
    v_mov_b64 v[24:25], 0
    v_smfmac_f32_16x16x64_bf16 v[64:67], v[44:47], v[144:151], v1
    ds_read_b128 v[88:91], v4 offset:24576
    v_smfmac_f32_16x16x64_bf16 v[68:71], v[44:47], v[152:159], v1
    s_waitcnt lgkmcnt(1)
    s_barrier
    ds_read_b64 v[110:111], v8 offset:8192
    ds_read_b128 v[92:95], v4 offset:25600
    v_mul_f32 v52, s33, v52
    v_mul_f32 v53, s33, v53
    v_exp_f32 v52, v52
    v_exp_f32 v53, v53
    s_nop 0
    v_cvt_pk_bf16_f32 v112, v52, v53
    v_add_f32 v64, v64, v66
    v_add_f32 v65, v65, v67
    s_waitcnt lgkmcnt(1)
    v_mfma_f32_16x16x32_bf16 v[48:51], v[104:107], v[108:111], 0
    v_cvt_pk_bf16_f32 v114, v64, v65
    v_add_f32 v68, v68, v70
    v_mfma_f32_16x16x32_bf16 v[56:59], v[120:123], v[108:111], 0
    v_add_f32 v69, v69, v71
    v_cvt_pk_bf16_f32 v116, v68, v69
    v_mfma_f32_16x16x32_bf16 v[60:63], v[124:127], v[108:111], 0
    ds_read_b128 v[96:99], v4 offset:26624
    v_mov_b64 v[26:27], 0
    v_mfma_f32_16x16x16_bf16 v[48:51], v[104:105], v[112:113], v[48:51]
    ds_read_b128 v[100:103], v4 offset:27648
    v_mov_b64 v[28:29], 0
    v_mfma_f32_16x16x16_bf16 v[56:59], v[114:115], v[112:113], v[56:59]
    v_mov_b64 v[30:31], 0
    v_mfma_f32_16x16x16_bf16 v[60:63], v[116:117], v[112:113], v[60:63]
    s_nop 2
    v_rcp_f32 v118, v48
    s_nop 0
    v_max_f32 v14, v118, v48
    v_cmp_nge_f32 vcc, s40, v14
    v_pk_mul_f32 v[56:57], v[56:57], v[118:119] op_sel_hi:[1,0]
    v_pk_mul_f32 v[58:59], v[58:59], v[118:119] op_sel_hi:[1,0]
    v_pk_mul_f32 v[60:61], v[60:61], v[118:119] op_sel_hi:[1,0]
    v_pk_mul_f32 v[62:63], v[62:63], v[118:119] op_sel_hi:[1,0]
    v_cvt_pk_bf16_f32 v52, v56, v60
    v_cvt_pk_bf16_f32 v53, v57, v61
    v_cvt_pk_bf16_f32 v54, v58, v62
    v_cvt_pk_bf16_f32 v55, v59, v63
L_fast_rejoin:
    ds_write_b128 v2, v[52:55] offset:9216
    s_waitcnt lgkmcnt(1)
    v_smfmac_f32_16x16x64_bf16 v[16:19], v[52:55], v[88:95], v1
    ds_read_b128 v[72:75], v4 offset:28672
    v_xor_b32 v32, 0x800, v2
    v_smfmac_f32_16x16x64_bf16 v[20:23], v[52:55], v[96:103], v1
    ds_read_b128 v[76:79], v4 offset:29696
    v_xor_b32 v40, 0x1800, v2
    s_waitcnt lgkmcnt(2)
    s_barrier
    ds_read_b128 v[32:35], v32 offset:9216
    ds_read_b128 v[36:39], v8 offset:9216
    ds_read_b128 v[40:43], v40 offset:9216
    ds_read_b128 v[80:83], v4 offset:30720
    ds_read_b128 v[84:87], v4 offset:31744
    s_waitcnt lgkmcnt(4)
    v_smfmac_f32_16x16x64_bf16 v[16:19], v[32:35], v[160:167], v1
    s_waitcnt lgkmcnt(3)
    v_smfmac_f32_16x16x64_bf16 v[16:19], v[36:39], v[192:199], v1
    s_waitcnt lgkmcnt(2)
    v_smfmac_f32_16x16x64_bf16 v[16:19], v[40:43], v[224:231], v1
    s_cmp_lg_u64 vcc, 0
    s_cselect_b32 s60, s28, s27
    v_smfmac_f32_16x16x64_bf16 v[20:23], v[32:35], v[168:175], v1
    ds_read_b128 v[64:67], v3 offset:23040
    s_waitcnt lgkmcnt(1)
    v_smfmac_f32_16x16x64_bf16 v[20:23], v[36:39], v[200:207], v1
    s_nop 1
    v_smfmac_f32_16x16x64_bf16 v[20:23], v[40:43], v[232:239], v1
    v_cvt_pk_bf16_f32 v56, v16, v18
    v_smfmac_f32_16x16x64_bf16 v[24:27], v[52:55], v[72:79], v1
    v_cvt_pk_bf16_f32 v57, v17, v19
    v_and_or_b32 v56, v56, -2, s60
    v_smfmac_f32_16x16x64_bf16 v[24:27], v[32:35], v[176:183], v1
    buffer_store_dwordx2 v[56:57], v9, s[8:11], 0 offen offset:0
    v_smfmac_f32_16x16x64_bf16 v[24:27], v[36:39], v[208:215], v1
    s_nop 0
    v_cvt_pk_bf16_f32 v58, v20, v22
    v_smfmac_f32_16x16x64_bf16 v[24:27], v[40:43], v[240:247], v1
    v_cvt_pk_bf16_f32 v59, v21, v23
    v_and_or_b32 v58, v58, -2, s60
    v_smfmac_f32_16x16x64_bf16 v[28:31], v[52:55], v[80:87], v1
    buffer_store_dwordx2 v[58:59], v9, s[8:11], 0 offen offset:2048
    v_smfmac_f32_16x16x64_bf16 v[28:31], v[32:35], v[184:191], v1
    s_nop 1
    v_smfmac_f32_16x16x64_bf16 v[28:31], v[36:39], v[216:223], v1
    v_cvt_pk_bf16_f32 v60, v24, v26
    v_smfmac_f32_16x16x64_bf16 v[28:31], v[40:43], v[248:255], v1
    v_cvt_pk_bf16_f32 v61, v25, v27
    v_and_or_b32 v60, v60, -2, s60
    buffer_store_dwordx2 v[60:61], v9, s[8:11], s26 offen offset:0
    s_nop 4
    v_cvt_pk_bf16_f32 v62, v28, v30
    v_cvt_pk_bf16_f32 v63, v29, v31
    v_and_or_b32 v62, v62, -2, s60
    buffer_store_dwordx2 v[62:63], v9, s[8:11], s26 offen offset:2048
L_fast_stored:
    s_cmp_lg_u32 s60, s27
    s_cbranch_scc1 L_fast_safe
    ds_read_b128 v[104:107], v4 offset:0
    ds_read_b128 v[108:111], v4 offset:1024
    ds_read_b128 v[112:115], v4 offset:2048
    ds_read_b128 v[116:119], v4 offset:3072
    ds_read_b128 v[88:91], v4 offset:4096
    ds_read_b128 v[92:95], v4 offset:5120
    ds_read_b128 v[96:99], v4 offset:6144
    ds_read_b128 v[100:103], v4 offset:7168
    ds_read_b128 v[72:75], v4 offset:8192
    ds_read_b128 v[76:79], v4 offset:9216
    ds_read_b128 v[80:83], v4 offset:10240
    ds_read_b128 v[84:87], v4 offset:11264
    s_cmp_lt_u32 s21, 1
    s_cbranch_scc1 L_fast_pollp
    s_nop 7
    s_cmp_lt_u32 s21, 2
    s_cbranch_scc1 L_fast_pollp
    s_nop 7
    s_cmp_lt_u32 s21, 3
    s_cbranch_scc1 L_fast_pollp
    s_nop 7
L_fast_pollp:
    buffer_load_dwordx4 v[120:123], v2, s[8:11], s6 offen sc1
    buffer_load_dwordx4 v[124:127], v2, s[8:11], s6 offen offset:1024 sc1
    v_mov_b64 v[48:49], 0
    v_mov_b64 v[50:51], 0
    v_mov_b64 v[52:53], 0
    v_mov_b64 v[54:55], 0
    v_mov_b64 v[56:57], 0
    v_mov_b64 v[58:59], 0
    v_mov_b64 v[60:61], 0
    v_mov_b64 v[62:63], 0
    s_nop 15
    s_nop 11
    buffer_load_dwordx4 v[32:35], v2, s[8:11], s6 offen sc1
    buffer_load_dwordx4 v[36:39], v2, s[8:11], s6 offen offset:1024 sc1
    s_add_u32 s7, s24, 0x80000
    s_waitcnt vmcnt(3) lgkmcnt(0)
    v_mfma_f32_16x16x32_bf16 v[68:71], v[64:67], v[120:123], 0
    v_bitop3_b32 v14, v120, v122, s27 bitop3:0x7e
    s_waitcnt vmcnt(2)
    v_mfma_f32_16x16x32_bf16 v[68:71], v[64:67], v[124:127], v[68:71]
    v_bitop3_b32 v11, v124, v126, s27 bitop3:0x7e
    v_bitop3_b32 v14, v14, v11, 1 bitop3:0xa8
    v_cmp_ne_u32 vcc, 0, v14
    s_nop 2
    s_cmp_eq_u64 vcc, 0
    s_cselect_b32 s36, s24, s61
    v_add_f32_dpp v68, v68, v68 row_ror:8 row_mask:0xf bank_mask:0xf
    v_add_f32_dpp v69, v69, v69 row_ror:8 row_mask:0xf bank_mask:0xf
    s_nop 0
    v_add_f32_dpp v68, v68, v68 row_ror:4 row_mask:0xf bank_mask:0xf
    v_add_f32_dpp v69, v69, v69 row_ror:4 row_mask:0xf bank_mask:0xf
    v_cvt_pk_bf16_f32 v12, v68, v69
    buffer_store_dword v12, v10, s[8:11], s36 offen
    s_cbranch_scc0 L_fast_retryp
L_fast_gotp:
    s_mov_b32 s23, s24
    s_add_u32 s31, s31, 0x2000
    s_mov_b32 s22, s90
    s_mov_b32 s27, s28
    v_mov_b64 v[64:65], 0
    v_mov_b64 v[66:67], 0
    v_mov_b64 v[68:69], 0
    v_mov_b64 v[70:71], 0
    s_nop 15
    s_nop 15
    s_nop 15
    s_nop 3
    buffer_load_dwordx4 v[16:19], v2, s[8:11], s7 offen sc1
    buffer_load_dwordx4 v[20:23], v2, s[8:11], s7 offen offset:1024 sc1
    s_cmp_lt_u32 s22, 63
    s_cbranch_scc1 L_fast_step
    buffer_store_dword v12, v10, s[8:11], s31 offen sc1
    s_branch L_fast_done
L_fast_retrym:
    s_add_u32 s32, s32, 1
    s_cmp_gt_u32 s32, 200000
    s_cbranch_scc1 L_fast_okm
    s_waitcnt vmcnt(0) lgkmcnt(0)
    v_mov_b64 v[16:17], v[120:121]
    v_mov_b64 v[18:19], v[122:123]
    v_mov_b64 v[20:21], v[124:125]
    v_mov_b64 v[22:23], v[126:127]
    buffer_load_dwordx4 v[120:123], v2, s[8:11], s7 offen sc1
    buffer_load_dwordx4 v[124:127], v2, s[8:11], s7 offen offset:1024 sc1
    v_mov_b64 v[48:49], 0
    v_mov_b64 v[50:51], 0
    v_mov_b64 v[52:53], 0
    v_mov_b64 v[54:55], 0
    s_branch L_fast_waitm
L_fast_retryp:
    s_add_u32 s32, s32, 1
    buffer_load_dwordx4 v[120:123], v2, s[8:11], s6 offen sc1
    buffer_load_dwordx4 v[124:127], v2, s[8:11], s6 offen offset:1024 sc1
    s_waitcnt vmcnt(4) lgkmcnt(0)
    v_mfma_f32_16x16x32_bf16 v[68:71], v[64:67], v[32:35], 0
    v_bitop3_b32 v14, v32, v34, s27 bitop3:0x7e
    s_waitcnt vmcnt(3)
    v_mfma_f32_16x16x32_bf16 v[68:71], v[64:67], v[36:39], v[68:71]
    v_bitop3_b32 v11, v36, v38, s27 bitop3:0x7e
    v_bitop3_b32 v14, v14, v11, 1 bitop3:0xa8
    v_cmp_ne_u32 vcc, 0, v14
    s_nop 2
    s_cmp_eq_u64 vcc, 0
    s_cselect_b32 s36, s24, s61
    v_add_f32_dpp v68, v68, v68 row_ror:8 row_mask:0xf bank_mask:0xf
    v_add_f32_dpp v69, v69, v69 row_ror:8 row_mask:0xf bank_mask:0xf
    s_nop 0
    v_add_f32_dpp v68, v68, v68 row_ror:4 row_mask:0xf bank_mask:0xf
    v_add_f32_dpp v69, v69, v69 row_ror:4 row_mask:0xf bank_mask:0xf
    v_cvt_pk_bf16_f32 v12, v68, v69
    buffer_store_dword v12, v10, s[8:11], s36 offen
    s_cbranch_scc1 L_fast_gotp
    buffer_load_dwordx4 v[32:35], v2, s[8:11], s6 offen sc1
    buffer_load_dwordx4 v[36:39], v2, s[8:11], s6 offen offset:1024 sc1
    s_waitcnt vmcnt(4) lgkmcnt(0)
    v_mfma_f32_16x16x32_bf16 v[68:71], v[64:67], v[120:123], 0
    v_bitop3_b32 v14, v120, v122, s27 bitop3:0x7e
    s_waitcnt vmcnt(3)
    v_mfma_f32_16x16x32_bf16 v[68:71], v[64:67], v[124:127], v[68:71]
    v_bitop3_b32 v11, v124, v126, s27 bitop3:0x7e
    v_bitop3_b32 v14, v14, v11, 1 bitop3:0xa8
    v_cmp_ne_u32 vcc, 0, v14
    s_nop 2
    s_cmp_eq_u64 vcc, 0
    s_cselect_b32 s36, s24, s61
    v_add_f32_dpp v68, v68, v68 row_ror:8 row_mask:0xf bank_mask:0xf
    v_add_f32_dpp v69, v69, v69 row_ror:8 row_mask:0xf bank_mask:0xf
    s_nop 0
    v_add_f32_dpp v68, v68, v68 row_ror:4 row_mask:0xf bank_mask:0xf
    v_add_f32_dpp v69, v69, v69 row_ror:4 row_mask:0xf bank_mask:0xf
    v_cvt_pk_bf16_f32 v12, v68, v69
    buffer_store_dword v12, v10, s[8:11], s36 offen
    s_cbranch_scc1 L_fast_gotp
    s_cmp_le_u32 s32, 200000
    s_cbranch_scc1 L_fast_retryp
    s_mov_b32 s36, s24
    buffer_store_dword v12, v10, s[8:11], s36 offen
    s_branch L_fast_gotp
L_fast_refresh:
    v_lshrrev_b32 v14, 2, v3
    s_lshl_b32 s36, s20, 8
    s_add_u32 s36, s36, 0x190000
    buffer_load_dword v14, v14, s[8:11], s36 offen sc1
    s_add_u32 s32, s32, 1
    s_waitcnt vmcnt(0)
    v_cmp_ne_u32 s[62:63], 0, v14
    s_nop 3
    s_cmp_le_u32 s32, 200000
    s_cbranch_scc1 L_fast_step
    s_mov_b64 s[62:63], -1
    s_branch L_fast_step
L_fast_safe:
    s_nop 11
    s_waitcnt vmcnt(0) lgkmcnt(0)
    s_barrier
    ds_read_b128 v[72:75], v6 offset:0
    ds_read_b128 v[88:91], v6 offset:2304
    ds_read_b128 v[76:79], v6 offset:64
    ds_read_b128 v[92:95], v6 offset:2368
    ds_read_b128 v[80:83], v6 offset:128
    ds_read_b128 v[96:99], v6 offset:2432
    ds_read_b128 v[84:87], v6 offset:192
    ds_read_b128 v[100:103], v6 offset:2496
    s_xor_b32 s36, s25, 0x1000
    s_add_u32 s36, s36, s23
    buffer_load_dwordx4 v[16:19], v3, s[8:11], s29 offen offset:0 sc1
    buffer_load_dwordx4 v[32:35], v3, s[8:11], s36 offen offset:0 sc1
    buffer_load_dwordx4 v[20:23], v3, s[8:11], s29 offen offset:1024 sc1
    buffer_load_dwordx4 v[36:39], v3, s[8:11], s36 offen offset:1024 sc1
    buffer_load_dwordx4 v[24:27], v3, s[8:11], s29 offen offset:2048 sc1
    buffer_load_dwordx4 v[40:43], v3, s[8:11], s36 offen offset:2048 sc1
    buffer_load_dwordx4 v[28:31], v3, s[8:11], s29 offen offset:3072 sc1
    buffer_load_dwordx4 v[44:47], v3, s[8:11], s36 offen offset:3072 sc1
    s_waitcnt vmcnt(0) lgkmcnt(0)
    v_mfma_f32_16x16x32_bf16 v[48:51], v[16:19], v[72:75], 0
    v_mfma_f32_16x16x32_bf16 v[48:51], v[20:23], v[76:79], v[48:51]
    v_mfma_f32_16x16x32_bf16 v[48:51], v[24:27], v[80:83], v[48:51]
    v_mfma_f32_16x16x32_bf16 v[48:51], v[28:31], v[84:87], v[48:51]
    v_mfma_f32_16x16x32_bf16 v[52:55], v[32:35], v[72:75], 0
    v_mfma_f32_16x16x32_bf16 v[52:55], v[36:39], v[76:79], v[52:55]
    v_mfma_f32_16x16x32_bf16 v[52:55], v[40:43], v[80:83], v[52:55]
    v_mfma_f32_16x16x32_bf16 v[52:55], v[44:47], v[84:87], v[52:55]
    v_mfma_f32_16x16x32_bf16 v[56:59], v[88:91], v[72:75], 0
    v_mfma_f32_16x16x32_bf16 v[56:59], v[92:95], v[76:79], v[56:59]
    v_mfma_f32_16x16x32_bf16 v[56:59], v[96:99], v[80:83], v[56:59]
    v_mfma_f32_16x16x32_bf16 v[56:59], v[100:103], v[84:87], v[56:59]
    s_nop 7
    v_mul_f32 v56, s33, v56
    v_mul_f32 v57, s33, v57
    v_max3_f32 v16, v48, v49, v50
    v_max3_f32 v16, v16, v51, v52
    v_max3_f32 v16, v16, v53, v54
    v_max3_f32 v16, v16, v55, v56
    v_max_f32 v16, v16, v57
    v_mov_b32 v17, v16
    s_nop 1
    v_permlane16_swap_b32 v16, v17
    v_max_f32 v16, v16, v17
    v_mov_b32 v17, v16
    s_nop 1
    v_permlane32_swap_b32 v16, v17
    v_max_f32 v16, v16, v17
    v_sub_f32 v48, v48, v16
    v_exp_f32 v48, v48
    v_sub_f32 v49, v49, v16
    v_exp_f32 v49, v49
    v_sub_f32 v50, v50, v16
    v_exp_f32 v50, v50
    v_sub_f32 v51, v51, v16
    v_exp_f32 v51, v51
    v_sub_f32 v52, v52, v16
    v_exp_f32 v52, v52
    v_sub_f32 v53, v53, v16
    v_exp_f32 v53, v53
    v_sub_f32 v54, v54, v16
    v_exp_f32 v54, v54
    v_sub_f32 v55, v55, v16
    v_exp_f32 v55, v55
    v_sub_f32 v56, v56, v16
    v_exp_f32 v56, v56
    v_sub_f32 v57, v57, v16
    v_exp_f32 v57, v57
    v_cvt_pk_bf16_f32 v108, v48, v49
    v_cvt_pk_bf16_f32 v109, v50, v51
    v_cvt_pk_bf16_f32 v110, v52, v53
    v_cvt_pk_bf16_f32 v111, v54, v55
    v_cvt_pk_bf16_f32 v112, v56, v57
    s_nop 0
    v_mfma_f32_16x16x32_bf16 v[48:51], v[104:107], v[108:111], 0
    v_mfma_f32_16x16x32_bf16 v[56:59], v[120:123], v[108:111], 0
    v_mfma_f32_16x16x32_bf16 v[60:63], v[124:127], v[108:111], 0
    s_nop 3
    v_mfma_f32_16x16x16_bf16 v[48:51], v[104:105], v[112:113], v[48:51]
    v_mfma_f32_16x16x16_bf16 v[56:59], v[114:115], v[112:113], v[56:59]
    v_mfma_f32_16x16x16_bf16 v[60:63], v[116:117], v[112:113], v[60:63]
    s_nop 5
    v_rcp_f32 v118, v48
    s_nop 0
    v_mul_f32 v56, v56, v118
    v_mul_f32 v57, v57, v118
    v_mul_f32 v58, v58, v118
    v_mul_f32 v59, v59, v118
    v_mul_f32 v60, v60, v118
    v_mul_f32 v61, v61, v118
    v_mul_f32 v62, v62, v118
    v_mul_f32 v63, v63, v118
    v_cvt_pk_bf16_f32 v52, v56, v60
    v_cvt_pk_bf16_f32 v53, v57, v61
    v_cvt_pk_bf16_f32 v54, v58, v62
    v_cvt_pk_bf16_f32 v55, v59, v63
    ds_read_b128 v[88:91], v4 offset:24576
    ds_read_b128 v[92:95], v4 offset:25600
    ds_read_b128 v[96:99], v4 offset:26624
    ds_read_b128 v[100:103], v4 offset:27648
    v_mov_b32 v16, 0
    v_mov_b32 v17, 0
    v_mov_b32 v18, 0
    v_mov_b32 v19, 0
    v_mov_b32 v20, 0
    v_mov_b32 v21, 0
    v_mov_b32 v22, 0
    v_mov_b32 v23, 0
    v_mov_b32 v24, 0
    v_mov_b32 v25, 0
    v_mov_b32 v26, 0
    v_mov_b32 v27, 0
    v_mov_b32 v28, 0
    v_mov_b32 v29, 0
    v_mov_b32 v30, 0
    v_mov_b32 v31, 0
    s_mov_b64 vcc, 0
    s_branch L_fast_rejoin
L_fast_done:
    s_branch L_end
L_slow_start:
    s_mov_b32 s22, 0
    s_mov_b32 s23, 0x1000000
    s_mov_b32 s27, 0
    s_mov_b32 s31, 0x80000
    s_mov_b32 s61, 0x40000000
    s_mov_b32 s91, 0
    ds_read_b128 v[104:107], v4 offset:0
    ds_read_b128 v[108:111], v4 offset:1024
    ds_read_b128 v[112:115], v4 offset:2048
    ds_read_b128 v[116:119], v4 offset:3072
    ds_read_b128 v[88:91], v4 offset:4096
    ds_read_b128 v[92:95], v4 offset:5120
    ds_read_b128 v[96:99], v4 offset:6144
    ds_read_b128 v[100:103], v4 offset:7168
    ds_read_b128 v[72:75], v4 offset:8192
    ds_read_b128 v[76:79], v4 offset:9216
    ds_read_b128 v[80:83], v4 offset:10240
    ds_read_b128 v[84:87], v4 offset:11264
    v_mov_b64 v[48:49], 0
    v_mov_b64 v[50:51], 0
    v_mov_b64 v[52:53], 0
    v_mov_b64 v[54:55], 0
    v_mov_b64 v[56:57], 0
    v_mov_b64 v[58:59], 0
    v_mov_b64 v[60:61], 0
    v_mov_b64 v[62:63], 0
    v_mov_b64 v[64:65], 0
    v_mov_b64 v[66:67], 0
    v_mov_b64 v[68:69], 0
    v_mov_b64 v[70:71], 0
    s_mov_b64 s[62:63], 0
    s_add_u32 s7, s23, 0x80000
    buffer_load_dwordx4 v[16:19], v2, s[8:11], s7 offen sc1
    buffer_load_dwordx4 v[20:23], v2, s[8:11], s7 offen offset:1024 sc1
L_slow_step:
    s_lshr_b64 s[36:37], s[62:63], s22
    s_andn2_b32 s36, 3, s36
    s_cbranch_scc1 L_slow_refresh
    s_add_u32 s24, s23, 0x82000
    s_add_u32 s29, s23, s25
    s_add_u32 s30, s23, s39
    s_xor_b32 s28, s27, 1
    s_add_u32 s90, s22, 1
    v_xor_b32 v28, 0x800, v2
    v_xor_b32 v44, 0x1800, v2
    s_nop 11
    buffer_load_dwordx4 v[120:123], v2, s[8:11], s7 offen sc1
    buffer_load_dwordx4 v[124:127], v2, s[8:11], s7 offen offset:1024 sc1
L_slow_waitm:
    s_waitcnt vmcnt(3) lgkmcnt(0)
L_slow_gotm:
    v_smfmac_f32_16x16x64_bf16 v[48:51], v[16:19], v[104:111], v1
    v_max3_u32 v14, v16, v17, v18
    s_waitcnt vmcnt(2)
    v_smfmac_f32_16x16x64_bf16 v[52:55], v[16:19], v[112:119], v1
    v_max3_u32 v24, v19, v20, v21
    v_max3_u32 v14, v14, v22, v23
    v_max_u32 v14, v14, v24
    v_cmp_eq_u32 vcc, -1, v14
    v_smfmac_f32_16x16x64_bf16 v[48:51], v[20:23], v[88:95], v1
    ds_write_b128 v2, v[16:19] offset:0
    s_cbranch_vccnz L_slow_retrym
L_slow_okm:
    v_smfmac_f32_16x16x64_bf16 v[52:55], v[20:23], v[96:103], v1
    ds_write_b128 v2, v[20:23] offset:1024
    v_smfmac_f32_16x16x64_bf16 v[56:59], v[16:19], v[72:79], v1
    buffer_load_dwordx4 v[104:107], v3, s[8:11], s29 offen offset:0 sc1
    v_smfmac_f32_16x16x64_bf16 v[60:63], v[16:19], v[80:87], v1
    buffer_load_dwordx4 v[108:111], v3, s[8:11], s29 offen offset:1024 sc1
    v_smfmac_f32_16x16x64_bf16 v[56:59], v[20:23], a[80:87], v1
    buffer_load_dwordx4 v[112:115], v3, s[8:11], s29 offen offset:2048 sc1
    v_smfmac_f32_16x16x64_bf16 v[60:63], v[20:23], a[88:95], v1
    s_waitcnt lgkmcnt(0)
    s_barrier
    ds_read_b128 v[24:27], v28 offset:0
    v_smfmac_f32_16x16x64_bf16 v[64:67], v[16:19], a[160:167], v1
    ds_read_b128 v[28:31], v28 offset:1024
    v_smfmac_f32_16x16x64_bf16 v[68:71], v[16:19], a[168:175], v1
    buffer_load_dwordx4 v[116:119], v3, s[8:11], s29 offen offset:3072 sc1
    v_smfmac_f32_16x16x64_bf16 v[64:67], v[20:23], a[176:183], v1
    ds_read_b128 v[32:35], v8 offset:0
    v_smfmac_f32_16x16x64_bf16 v[68:71], v[20:23], a[184:191], v1
    ds_read_b128 v[36:39], v8 offset:1024
    s_waitcnt lgkmcnt(3)
    v_smfmac_f32_16x16x64_bf16 v[48:51], v[24:27], a[0:7], v1
    buffer_load_dwordx4 v[120:123], v3, s[8:11], s30 offen offset:0 sc1
    v_smfmac_f32_16x16x64_bf16 v[52:55], v[24:27], a[8:15], v1
    ds_read_b128 v[40:43], v44 offset:0
    s_waitcnt lgkmcnt(3)
    v_smfmac_f32_16x16x64_bf16 v[48:51], v[28:31], a[16:23], v1
    buffer_load_dwordx4 v[124:127], v3, s[8:11], s30 offen offset:1024 sc1
    v_smfmac_f32_16x16x64_bf16 v[52:55], v[28:31], a[24:31], v1
    ds_read_b128 v[44:47], v44 offset:1024
    s_waitcnt lgkmcnt(2)
    v_smfmac_f32_16x16x64_bf16 v[48:51], v[32:35], a[32:39], v1
    v_smfmac_f32_16x16x64_bf16 v[52:55], v[32:35], a[40:47], v1
    ds_read_b128 v[88:91], v4 offset:12288
    v_smfmac_f32_16x16x64_bf16 v[48:51], v[36:39], a[48:55], v1
    ds_read_b128 v[92:95], v4 offset:13312
    s_waitcnt lgkmcnt(2)
    v_smfmac_f32_16x16x64_bf16 v[52:55], v[36:39], a[56:63], v1
    ds_read_b128 v[96:99], v4 offset:14336
    v_smfmac_f32_16x16x64_bf16 v[48:51], v[40:43], a[64:71], v1
    ds_read_b128 v[100:103], v4 offset:15360
    v_smfmac_f32_16x16x64_bf16 v[52:55], v[40:43], a[72:79], v1
    buffer_load_dword v15, v0, s[8:11], s24 offen sc1
    v_smfmac_f32_16x16x64_bf16 v[56:59], v[28:31], a[96:103], v1
    ds_read_b128 v[72:75], v4 offset:16384
    v_smfmac_f32_16x16x64_bf16 v[60:63], v[28:31], a[104:111], v1
    ds_read_b128 v[76:79], v4 offset:17408
    s_waitcnt lgkmcnt(2)
    v_smfmac_f32_16x16x64_bf16 v[48:51], v[44:47], v[88:95], v1
    ds_read_b128 v[80:83], v4 offset:18432
    v_smfmac_f32_16x16x64_bf16 v[52:55], v[44:47], v[96:103], v1
    ds_read_b128 v[84:87], v4 offset:19456
    v_smfmac_f32_16x16x64_bf16 v[56:59], v[32:35], a[112:119], v1
    ds_read_b128 v[88:91], v4 offset:20480
    v_smfmac_f32_16x16x64_bf16 v[60:63], v[32:35], a[120:127], v1
    ds_read_b128 v[92:95], v4 offset:21504
    v_smfmac_f32_16x16x64_bf16 v[56:59], v[36:39], a[128:135], v1
    ds_read_b128 v[96:99], v4 offset:22528
    v_add_f32 v48, v48, v50
    v_add_f32 v49, v49, v51
    v_smfmac_f32_16x16x64_bf16 v[60:63], v[36:39], a[136:143], v1
    ds_read_b128 v[100:103], v4 offset:23552
    v_add_f32 v52, v52, v54
    v_add_f32 v53, v53, v55
    v_smfmac_f32_16x16x64_bf16 v[56:59], v[40:43], a[144:151], v1
    s_waitcnt lgkmcnt(4)
    v_cvt_pk_bf16_f32 v50, v48, v52
    v_cvt_pk_bf16_f32 v51, v49, v53
    v_smfmac_f32_16x16x64_bf16 v[60:63], v[40:43], a[152:159], v1
    ds_write2_b32 v5, v50, v51 offset0:0 offset1:72
    v_smfmac_f32_16x16x64_bf16 v[56:59], v[24:27], v[72:79], v1
    buffer_store_dword v12, v10, s[8:11], s31 offen sc1
    v_smfmac_f32_16x16x64_bf16 v[60:63], v[24:27], v[80:87], v1
    s_waitcnt lgkmcnt(1)
    v_smfmac_f32_16x16x64_bf16 v[56:59], v[44:47], v[88:95], v1
    v_smfmac_f32_16x16x64_bf16 v[60:63], v[44:47], v[96:103], v1
    s_waitcnt lgkmcnt(0)
    s_barrier
    v_smfmac_f32_16x16x64_bf16 v[64:67], v[24:27], a[192:199], v1
    ds_read_b128 v[72:75], v6 offset:0
    v_smfmac_f32_16x16x64_bf16 v[68:71], v[24:27], a[200:207], v1
    ds_read_b128 v[76:79], v6 offset:64
    s_nop 0
    v_add_f32 v56, v56, v58
    v_smfmac_f32_16x16x64_bf16 v[64:67], v[28:31], a[208:215], v1
    ds_read_b128 v[80:83], v6 offset:128
    v_add_f32 v57, v57, v59
    v_smfmac_f32_16x16x64_bf16 v[68:71], v[28:31], a[216:223], v1
    ds_read_b128 v[84:87], v6 offset:192
    v_add_f32 v60, v60, v62
    v_add_f32 v61, v61, v63
    s_waitcnt vmcnt(2) lgkmcnt(3)
    v_mfma_f32_16x16x32_bf16 v[48:51], v[104:107], v[72:75], 0
    s_waitcnt lgkmcnt(2)
    v_cvt_pk_bf16_f32 v58, v56, v60
    v_cvt_pk_bf16_f32 v59, v57, v61
    v_mfma_f32_16x16x32_bf16 v[48:51], v[108:111], v[76:79], v[48:51]
    ds_write2_b32 v7, v58, v59 offset0:0 offset1:72
    s_waitcnt lgkmcnt(2)
    v_mfma_f32_16x16x32_bf16 v[48:51], v[112:115], v[80:83], v[48:51]
    s_waitcnt lgkmcnt(1)
    v_mov_b64 v[104:105], s[4:5]
    v_mov_b64 v[106:107], s[4:5]
    v_mfma_f32_16x16x32_bf16 v[48:51], v[116:119], v[84:87], v[48:51]
    v_mov_b64 v[16:17], 0
    v_mov_b64 v[18:19], 0
    v_smfmac_f32_16x16x64_bf16 v[64:67], v[32:35], a[224:231], v1
    v_mov_b32 v113, 0
    v_smfmac_f32_16x16x64_bf16 v[68:71], v[32:35], a[232:239], v1
    s_waitcnt lgkmcnt(0)
    s_barrier
    v_mov_b32 v115, 0
    v_smfmac_f32_16x16x64_bf16 v[64:67], v[36:39], a[240:247], v1
    ds_read_b128 v[88:91], v6 offset:2304
    v_exp_f32 v48, v48
    v_smfmac_f32_16x16x64_bf16 v[68:71], v[36:39], a[248:255], v1
    ds_read_b128 v[92:95], v6 offset:2368
    v_exp_f32 v49, v49
    v_smfmac_f32_16x16x64_bf16 v[64:67], v[40:43], v[128:135], v1
    ds_read_b128 v[96:99], v6 offset:2432
    v_exp_f32 v50, v50
    v_smfmac_f32_16x16x64_bf16 v[68:71], v[40:43], v[136:143], v1
    ds_read_b128 v[100:103], v6 offset:2496
    v_exp_f32 v51, v51
    s_waitcnt lgkmcnt(3)
    v_mfma_f32_16x16x32_bf16 v[52:55], v[88:91], v[72:75], 0
    s_waitcnt lgkmcnt(2)
    v_cvt_pk_bf16_f32 v108, v48, v49
    v_cvt_pk_bf16_f32 v109, v50, v51
    v_mfma_f32_16x16x32_bf16 v[52:55], v[92:95], v[76:79], v[52:55]
    ds_write_b64 v2, v[108:109] offset:8192
    s_waitcnt lgkmcnt(2)
    v_mfma_f32_16x16x32_bf16 v[52:55], v[96:99], v[80:83], v[52:55]
    s_waitcnt lgkmcnt(1)
    v_mov_b32 v117, 0
    v_mov_b64 v[20:21], 0
    v_mfma_f32_16x16x32_bf16 v[52:55], v[100:103], v[84:87], v[52:55]
    v_mov_b64 v[22:23], 0
    v_mov_b64 v[24:25], 0
    v_smfmac_f32_16x16x64_bf16 v[64:67], v[44:47], v[144:151], v1
    ds_read_b128 v[88:91], v4 offset:24576
    v_smfmac_f32_16x16x64_bf16 v[68:71], v[44:47], v[152:159], v1
    s_waitcnt lgkmcnt(1)
    s_barrier
    ds_read_b64 v[110:111], v8 offset:8192
    ds_read_b128 v[92:95], v4 offset:25600
    v_mul_f32 v52, s33, v52
    v_mul_f32 v53, s33, v53
    v_exp_f32 v52, v52
    v_exp_f32 v53, v53
    s_nop 0
    v_cvt_pk_bf16_f32 v112, v52, v53
    v_add_f32 v64, v64, v66
    v_add_f32 v65, v65, v67
    s_waitcnt lgkmcnt(1)
    v_mfma_f32_16x16x32_bf16 v[48:51], v[104:107], v[108:111], 0
    v_cvt_pk_bf16_f32 v114, v64, v65
    v_add_f32 v68, v68, v70
    v_mfma_f32_16x16x32_bf16 v[56:59], v[120:123], v[108:111], 0
    v_add_f32 v69, v69, v71
    v_cvt_pk_bf16_f32 v116, v68, v69
    v_mfma_f32_16x16x32_bf16 v[60:63], v[124:127], v[108:111], 0
    ds_read_b128 v[96:99], v4 offset:26624
    v_mov_b64 v[26:27], 0
    v_mfma_f32_16x16x16_bf16 v[48:51], v[104:105], v[112:113], v[48:51]
    ds_read_b128 v[100:103], v4 offset:27648
    v_mov_b64 v[28:29], 0
    v_mfma_f32_16x16x16_bf16 v[56:59], v[114:115], v[112:113], v[56:59]
    v_mov_b64 v[30:31], 0
    v_mfma_f32_16x16x16_bf16 v[60:63], v[116:117], v[112:113], v[60:63]
    s_nop 2
    v_rcp_f32 v118, v48
    s_nop 0
    v_max_f32 v14, v118, v48
    v_cmp_nge_f32 vcc, s40, v14
    v_pk_mul_f32 v[56:57], v[56:57], v[118:119] op_sel_hi:[1,0]
    v_pk_mul_f32 v[58:59], v[58:59], v[118:119] op_sel_hi:[1,0]
    v_pk_mul_f32 v[60:61], v[60:61], v[118:119] op_sel_hi:[1,0]
    v_pk_mul_f32 v[62:63], v[62:63], v[118:119] op_sel_hi:[1,0]
    v_cvt_pk_bf16_f32 v52, v56, v60
    v_cvt_pk_bf16_f32 v53, v57, v61
    v_cvt_pk_bf16_f32 v54, v58, v62
    v_cvt_pk_bf16_f32 v55, v59, v63
L_slow_rejoin:
    ds_write_b128 v2, v[52:55] offset:9216
    s_waitcnt lgkmcnt(1)
    v_smfmac_f32_16x16x64_bf16 v[16:19], v[52:55], v[88:95], v1
    ds_read_b128 v[72:75], v4 offset:28672
    v_xor_b32 v32, 0x800, v2
    v_smfmac_f32_16x16x64_bf16 v[20:23], v[52:55], v[96:103], v1
    ds_read_b128 v[76:79], v4 offset:29696
    v_xor_b32 v40, 0x1800, v2
    s_waitcnt lgkmcnt(2)
    s_barrier
    ds_read_b128 v[32:35], v32 offset:9216
    ds_read_b128 v[36:39], v8 offset:9216
    ds_read_b128 v[40:43], v40 offset:9216
    ds_read_b128 v[80:83], v4 offset:30720
    ds_read_b128 v[84:87], v4 offset:31744
    s_waitcnt lgkmcnt(4)
    v_smfmac_f32_16x16x64_bf16 v[16:19], v[32:35], v[160:167], v1
    s_waitcnt lgkmcnt(3)
    v_smfmac_f32_16x16x64_bf16 v[16:19], v[36:39], v[192:199], v1
    s_waitcnt lgkmcnt(2)
    v_smfmac_f32_16x16x64_bf16 v[16:19], v[40:43], v[224:231], v1
    s_cmp_lg_u64 vcc, 0
    s_cselect_b32 s60, s28, s27
    v_smfmac_f32_16x16x64_bf16 v[20:23], v[32:35], v[168:175], v1
    ds_read_b128 v[64:67], v3 offset:23040
    s_waitcnt lgkmcnt(1)
    v_smfmac_f32_16x16x64_bf16 v[20:23], v[36:39], v[200:207], v1
    s_nop 1
    v_smfmac_f32_16x16x64_bf16 v[20:23], v[40:43], v[232:239], v1
    v_cvt_pk_bf16_f32 v56, v16, v18
    v_smfmac_f32_16x16x64_bf16 v[24:27], v[52:55], v[72:79], v1
    v_cvt_pk_bf16_f32 v57, v17, v19
    v_and_or_b32 v56, v56, -2, s60
    v_smfmac_f32_16x16x64_bf16 v[24:27], v[32:35], v[176:183], v1
    buffer_store_dwordx2 v[56:57], v9, s[8:11], 0 offen offset:0 sc1
    v_smfmac_f32_16x16x64_bf16 v[24:27], v[36:39], v[208:215], v1
    s_nop 0
    v_cvt_pk_bf16_f32 v58, v20, v22
    v_smfmac_f32_16x16x64_bf16 v[24:27], v[40:43], v[240:247], v1
    v_cvt_pk_bf16_f32 v59, v21, v23
    v_and_or_b32 v58, v58, -2, s60
    v_smfmac_f32_16x16x64_bf16 v[28:31], v[52:55], v[80:87], v1
    buffer_store_dwordx2 v[58:59], v9, s[8:11], 0 offen offset:2048 sc1
    v_smfmac_f32_16x16x64_bf16 v[28:31], v[32:35], v[184:191], v1
    s_nop 1
    v_smfmac_f32_16x16x64_bf16 v[28:31], v[36:39], v[216:223], v1
    v_cvt_pk_bf16_f32 v60, v24, v26
    v_smfmac_f32_16x16x64_bf16 v[28:31], v[40:43], v[248:255], v1
    v_cvt_pk_bf16_f32 v61, v25, v27
    v_and_or_b32 v60, v60, -2, s60
    buffer_store_dwordx2 v[60:61], v9, s[8:11], s26 offen offset:0 sc1
    s_nop 4
    v_cvt_pk_bf16_f32 v62, v28, v30
    v_cvt_pk_bf16_f32 v63, v29, v31
    v_and_or_b32 v62, v62, -2, s60
    buffer_store_dwordx2 v[62:63], v9, s[8:11], s26 offen offset:2048 sc1
L_slow_stored:
    s_cmp_lg_u32 s60, s27
    s_cbranch_scc1 L_slow_safe
    ds_read_b128 v[104:107], v4 offset:0
    ds_read_b128 v[108:111], v4 offset:1024
    ds_read_b128 v[112:115], v4 offset:2048
    ds_read_b128 v[116:119], v4 offset:3072
    ds_read_b128 v[88:91], v4 offset:4096
    ds_read_b128 v[92:95], v4 offset:5120
    ds_read_b128 v[96:99], v4 offset:6144
    ds_read_b128 v[100:103], v4 offset:7168
    ds_read_b128 v[72:75], v4 offset:8192
    ds_read_b128 v[76:79], v4 offset:9216
    ds_read_b128 v[80:83], v4 offset:10240
    ds_read_b128 v[84:87], v4 offset:11264
    s_cmp_lt_u32 s21, 1
    s_cbranch_scc1 L_slow_pollp
    s_nop 7
    s_cmp_lt_u32 s21, 2
    s_cbranch_scc1 L_slow_pollp
    s_nop 7
    s_cmp_lt_u32 s21, 3
    s_cbranch_scc1 L_slow_pollp
    s_nop 7
L_slow_pollp:
    buffer_load_dwordx4 v[120:123], v2, s[8:11], s6 offen sc1
    buffer_load_dwordx4 v[124:127], v2, s[8:11], s6 offen offset:1024 sc1
    v_mov_b64 v[48:49], 0
    v_mov_b64 v[50:51], 0
    v_mov_b64 v[52:53], 0
    v_mov_b64 v[54:55], 0
    v_mov_b64 v[56:57], 0
    v_mov_b64 v[58:59], 0
    v_mov_b64 v[60:61], 0
    v_mov_b64 v[62:63], 0
    s_nop 15
    s_nop 11
    buffer_load_dwordx4 v[32:35], v2, s[8:11], s6 offen sc1
    buffer_load_dwordx4 v[36:39], v2, s[8:11], s6 offen offset:1024 sc1
    s_add_u32 s7, s24, 0x80000
    s_waitcnt vmcnt(3) lgkmcnt(0)
    v_mfma_f32_16x16x32_bf16 v[68:71], v[64:67], v[120:123], 0
    v_bitop3_b32 v14, v120, v122, s27 bitop3:0x7e
    s_waitcnt vmcnt(2)
    v_mfma_f32_16x16x32_bf16 v[68:71], v[64:67], v[124:127], v[68:71]
    v_bitop3_b32 v11, v124, v126, s27 bitop3:0x7e
    v_bitop3_b32 v14, v14, v11, 1 bitop3:0xa8
    v_cmp_ne_u32 vcc, 0, v14
    s_nop 2
    s_cmp_eq_u64 vcc, 0
    s_cselect_b32 s36, s24, s61
    v_add_f32_dpp v68, v68, v68 row_ror:8 row_mask:0xf bank_mask:0xf
    v_add_f32_dpp v69, v69, v69 row_ror:8 row_mask:0xf bank_mask:0xf
    s_nop 0
    v_add_f32_dpp v68, v68, v68 row_ror:4 row_mask:0xf bank_mask:0xf
    v_add_f32_dpp v69, v69, v69 row_ror:4 row_mask:0xf bank_mask:0xf
    v_cvt_pk_bf16_f32 v12, v68, v69
    buffer_store_dword v12, v10, s[8:11], s36 offen sc1
    s_cbranch_scc0 L_slow_retryp
L_slow_gotp:
    s_mov_b32 s23, s24
    s_add_u32 s31, s31, 0x2000
    s_mov_b32 s22, s90
    s_mov_b32 s27, s28
    v_mov_b64 v[64:65], 0
    v_mov_b64 v[66:67], 0
    v_mov_b64 v[68:69], 0
    v_mov_b64 v[70:71], 0
    s_nop 15
    s_nop 15
    s_nop 15
    s_nop 3
    buffer_load_dwordx4 v[16:19], v2, s[8:11], s7 offen sc1
    buffer_load_dwordx4 v[20:23], v2, s[8:11], s7 offen offset:1024 sc1
    s_cmp_lt_u32 s22, 63
    s_cbranch_scc1 L_slow_step
    buffer_store_dword v12, v10, s[8:11], s31 offen sc1
    s_branch L_slow_done
L_slow_retrym:
    s_add_u32 s32, s32, 1
    s_cmp_gt_u32 s32, 200000
    s_cbranch_scc1 L_slow_okm
    s_waitcnt vmcnt(0) lgkmcnt(0)
    v_mov_b64 v[16:17], v[120:121]
    v_mov_b64 v[18:19], v[122:123]
    v_mov_b64 v[20:21], v[124:125]
    v_mov_b64 v[22:23], v[126:127]
    buffer_load_dwordx4 v[120:123], v2, s[8:11], s7 offen sc1
    buffer_load_dwordx4 v[124:127], v2, s[8:11], s7 offen offset:1024 sc1
    v_mov_b64 v[48:49], 0
    v_mov_b64 v[50:51], 0
    v_mov_b64 v[52:53], 0
    v_mov_b64 v[54:55], 0
    s_branch L_slow_waitm
L_slow_retryp:
    s_add_u32 s32, s32, 1
    buffer_load_dwordx4 v[120:123], v2, s[8:11], s6 offen sc1
    buffer_load_dwordx4 v[124:127], v2, s[8:11], s6 offen offset:1024 sc1
    s_waitcnt vmcnt(4) lgkmcnt(0)
    v_mfma_f32_16x16x32_bf16 v[68:71], v[64:67], v[32:35], 0
    v_bitop3_b32 v14, v32, v34, s27 bitop3:0x7e
    s_waitcnt vmcnt(3)
    v_mfma_f32_16x16x32_bf16 v[68:71], v[64:67], v[36:39], v[68:71]
    v_bitop3_b32 v11, v36, v38, s27 bitop3:0x7e
    v_bitop3_b32 v14, v14, v11, 1 bitop3:0xa8
    v_cmp_ne_u32 vcc, 0, v14
    s_nop 2
    s_cmp_eq_u64 vcc, 0
    s_cselect_b32 s36, s24, s61
    v_add_f32_dpp v68, v68, v68 row_ror:8 row_mask:0xf bank_mask:0xf
    v_add_f32_dpp v69, v69, v69 row_ror:8 row_mask:0xf bank_mask:0xf
    s_nop 0
    v_add_f32_dpp v68, v68, v68 row_ror:4 row_mask:0xf bank_mask:0xf
    v_add_f32_dpp v69, v69, v69 row_ror:4 row_mask:0xf bank_mask:0xf
    v_cvt_pk_bf16_f32 v12, v68, v69
    buffer_store_dword v12, v10, s[8:11], s36 offen sc1
    s_cbranch_scc1 L_slow_gotp
    buffer_load_dwordx4 v[32:35], v2, s[8:11], s6 offen sc1
    buffer_load_dwordx4 v[36:39], v2, s[8:11], s6 offen offset:1024 sc1
    s_waitcnt vmcnt(4) lgkmcnt(0)
    v_mfma_f32_16x16x32_bf16 v[68:71], v[64:67], v[120:123], 0
    v_bitop3_b32 v14, v120, v122, s27 bitop3:0x7e
    s_waitcnt vmcnt(3)
    v_mfma_f32_16x16x32_bf16 v[68:71], v[64:67], v[124:127], v[68:71]
    v_bitop3_b32 v11, v124, v126, s27 bitop3:0x7e
    v_bitop3_b32 v14, v14, v11, 1 bitop3:0xa8
    v_cmp_ne_u32 vcc, 0, v14
    s_nop 2
    s_cmp_eq_u64 vcc, 0
    s_cselect_b32 s36, s24, s61
    v_add_f32_dpp v68, v68, v68 row_ror:8 row_mask:0xf bank_mask:0xf
    v_add_f32_dpp v69, v69, v69 row_ror:8 row_mask:0xf bank_mask:0xf
    s_nop 0
    v_add_f32_dpp v68, v68, v68 row_ror:4 row_mask:0xf bank_mask:0xf
    v_add_f32_dpp v69, v69, v69 row_ror:4 row_mask:0xf bank_mask:0xf
    v_cvt_pk_bf16_f32 v12, v68, v69
    buffer_store_dword v12, v10, s[8:11], s36 offen sc1
    s_cbranch_scc1 L_slow_gotp
    s_cmp_le_u32 s32, 200000
    s_cbranch_scc1 L_slow_retryp
    s_mov_b32 s36, s24
    buffer_store_dword v12, v10, s[8:11], s36 offen sc1
    s_branch L_slow_gotp
L_slow_refresh:
    v_lshrrev_b32 v14, 2, v3
    s_lshl_b32 s36, s20, 8
    s_add_u32 s36, s36, 0x190000
    buffer_load_dword v14, v14, s[8:11], s36 offen sc1
    s_add_u32 s32, s32, 1
    s_waitcnt vmcnt(0)
    v_cmp_ne_u32 s[62:63], 0, v14
    s_nop 3
    s_cmp_le_u32 s32, 200000
    s_cbranch_scc1 L_slow_step
    s_mov_b64 s[62:63], -1
    s_branch L_slow_step
L_slow_safe:
    s_nop 11
    s_waitcnt vmcnt(0) lgkmcnt(0)
    s_barrier
    ds_read_b128 v[72:75], v6 offset:0
    ds_read_b128 v[88:91], v6 offset:2304
    ds_read_b128 v[76:79], v6 offset:64
    ds_read_b128 v[92:95], v6 offset:2368
    ds_read_b128 v[80:83], v6 offset:128
    ds_read_b128 v[96:99], v6 offset:2432
    ds_read_b128 v[84:87], v6 offset:192
    ds_read_b128 v[100:103], v6 offset:2496
    s_xor_b32 s36, s25, 0x1000
    s_add_u32 s36, s36, s23
    buffer_load_dwordx4 v[16:19], v3, s[8:11], s29 offen offset:0 sc1
    buffer_load_dwordx4 v[32:35], v3, s[8:11], s36 offen offset:0 sc1
    buffer_load_dwordx4 v[20:23], v3, s[8:11], s29 offen offset:1024 sc1
    buffer_load_dwordx4 v[36:39], v3, s[8:11], s36 offen offset:1024 sc1
    buffer_load_dwordx4 v[24:27], v3, s[8:11], s29 offen offset:2048 sc1
    buffer_load_dwordx4 v[40:43], v3, s[8:11], s36 offen offset:2048 sc1
    buffer_load_dwordx4 v[28:31], v3, s[8:11], s29 offen offset:3072 sc1
    buffer_load_dwordx4 v[44:47], v3, s[8:11], s36 offen offset:3072 sc1
    s_waitcnt vmcnt(0) lgkmcnt(0)
    v_mfma_f32_16x16x32_bf16 v[48:51], v[16:19], v[72:75], 0
    v_mfma_f32_16x16x32_bf16 v[48:51], v[20:23], v[76:79], v[48:51]
    v_mfma_f32_16x16x32_bf16 v[48:51], v[24:27], v[80:83], v[48:51]
    v_mfma_f32_16x16x32_bf16 v[48:51], v[28:31], v[84:87], v[48:51]
    v_mfma_f32_16x16x32_bf16 v[52:55], v[32:35], v[72:75], 0
    v_mfma_f32_16x16x32_bf16 v[52:55], v[36:39], v[76:79], v[52:55]
    v_mfma_f32_16x16x32_bf16 v[52:55], v[40:43], v[80:83], v[52:55]
    v_mfma_f32_16x16x32_bf16 v[52:55], v[44:47], v[84:87], v[52:55]
    v_mfma_f32_16x16x32_bf16 v[56:59], v[88:91], v[72:75], 0
    v_mfma_f32_16x16x32_bf16 v[56:59], v[92:95], v[76:79], v[56:59]
    v_mfma_f32_16x16x32_bf16 v[56:59], v[96:99], v[80:83], v[56:59]
    v_mfma_f32_16x16x32_bf16 v[56:59], v[100:103], v[84:87], v[56:59]
    s_nop 7
    v_mul_f32 v56, s33, v56
    v_mul_f32 v57, s33, v57
    v_max3_f32 v16, v48, v49, v50
    v_max3_f32 v16, v16, v51, v52
    v_max3_f32 v16, v16, v53, v54
    v_max3_f32 v16, v16, v55, v56
    v_max_f32 v16, v16, v57
    v_mov_b32 v17, v16
    s_nop 1
    v_permlane16_swap_b32 v16, v17
    v_max_f32 v16, v16, v17
    v_mov_b32 v17, v16
    s_nop 1
    v_permlane32_swap_b32 v16, v17
    v_max_f32 v16, v16, v17
    v_sub_f32 v48, v48, v16
    v_exp_f32 v48, v48
    v_sub_f32 v49, v49, v16
    v_exp_f32 v49, v49
    v_sub_f32 v50, v50, v16
    v_exp_f32 v50, v50
    v_sub_f32 v51, v51, v16
    v_exp_f32 v51, v51
    v_sub_f32 v52, v52, v16
    v_exp_f32 v52, v52
    v_sub_f32 v53, v53, v16
    v_exp_f32 v53, v53
    v_sub_f32 v54, v54, v16
    v_exp_f32 v54, v54
    v_sub_f32 v55, v55, v16
    v_exp_f32 v55, v55
    v_sub_f32 v56, v56, v16
    v_exp_f32 v56, v56
    v_sub_f32 v57, v57, v16
    v_exp_f32 v57, v57
    v_cvt_pk_bf16_f32 v108, v48, v49
    v_cvt_pk_bf16_f32 v109, v50, v51
    v_cvt_pk_bf16_f32 v110, v52, v53
    v_cvt_pk_bf16_f32 v111, v54, v55
    v_cvt_pk_bf16_f32 v112, v56, v57
    s_nop 0
    v_mfma_f32_16x16x32_bf16 v[48:51], v[104:107], v[108:111], 0
    v_mfma_f32_16x16x32_bf16 v[56:59], v[120:123], v[108:111], 0
    v_mfma_f32_16x16x32_bf16 v[60:63], v[124:127], v[108:111], 0
    s_nop 3
    v_mfma_f32_16x16x16_bf16 v[48:51], v[104:105], v[112:113], v[48:51]
    v_mfma_f32_16x16x16_bf16 v[56:59], v[114:115], v[112:113], v[56:59]
    v_mfma_f32_16x16x16_bf16 v[60:63], v[116:117], v[112:113], v[60:63]
    s_nop 5
    v_rcp_f32 v118, v48
    s_nop 0
    v_mul_f32 v56, v56, v118
    v_mul_f32 v57, v57, v118
    v_mul_f32 v58, v58, v118
    v_mul_f32 v59, v59, v118
    v_mul_f32 v60, v60, v118
    v_mul_f32 v61, v61, v118
    v_mul_f32 v62, v62, v118
    v_mul_f32 v63, v63, v118
    v_cvt_pk_bf16_f32 v52, v56, v60
    v_cvt_pk_bf16_f32 v53, v57, v61
    v_cvt_pk_bf16_f32 v54, v58, v62
    v_cvt_pk_bf16_f32 v55, v59, v63
    ds_read_b128 v[88:91], v4 offset:24576
    ds_read_b128 v[92:95], v4 offset:25600
    ds_read_b128 v[96:99], v4 offset:26624
    ds_read_b128 v[100:103], v4 offset:27648
    v_mov_b32 v16, 0
    v_mov_b32 v17, 0
    v_mov_b32 v18, 0
    v_mov_b32 v19, 0
    v_mov_b32 v20, 0
    v_mov_b32 v21, 0
    v_mov_b32 v22, 0
    v_mov_b32 v23, 0
    v_mov_b32 v24, 0
    v_mov_b32 v25, 0
    v_mov_b32 v26, 0
    v_mov_b32 v27, 0
    v_mov_b32 v28, 0
    v_mov_b32 v29, 0
    v_mov_b32 v30, 0
    v_mov_b32 v31, 0
    s_mov_b64 vcc, 0
    s_branch L_slow_rejoin
L_slow_done:
    s_branch L_end
L_worker:
    s_mov_b32 s12, s44
    s_and_b32 s13, s45, 0xffff
    s_mov_b32 s14, 0x200000
    s_mov_b32 s15, 0x20000
    s_mov_b32 s60, s82
    s_and_b32 s61, s83, 0xffff
    s_mov_b32 s62, 0x200000
    s_mov_b32 s63, 0x20000
    s_cmp_eq_u32 s3, 7
    s_cbranch_scc1 L_mlp
    s_mov_b32 s92, s80
    s_and_b32 s93, s81, 0xffff
    s_mov_b32 s94, 0x400
    s_mov_b32 s95, 0x20000
    s_and_b32 s36, s2, 7
    s_sub_u32 s36, s36, 1
    s_lshl_b32 s36, s36, 5
    s_lshr_b32 s37, s2, 3
    s_add_u32 s36, s36, s37
    s_mul_i32 s20, s36, 10923
    s_lshr_b32 s20, s20, 16
    s_mul_i32 s37, s20, 6
    s_sub_u32 s22, s36, s37
    v_mov_b32 v1, 0x0
    v_bfe_u32 v14, v0, 0, 1
    s_mov_b32 s38, 0x10
    v_mad_u32_u24 v1, v14, s38, v1
    v_bfe_u32 v14, v0, 1, 1
    s_mov_b32 s38, 0x20
    v_mad_u32_u24 v1, v14, s38, v1
    v_bfe_u32 v14, v0, 2, 1
    s_mov_b32 s38, 0x40
    v_mad_u32_u24 v1, v14, s38, v1
    v_bfe_u32 v14, v0, 3, 1
    s_mov_b32 s38, 0x80
    v_mad_u32_u24 v1, v14, s38, v1
    v_bfe_u32 v14, v0, 4, 1
    s_mov_b32 s38, 0x100
    v_mad_u32_u24 v1, v14, s38, v1
    v_bfe_u32 v14, v0, 5, 1
    s_mov_b32 s38, 0x200
    v_mad_u32_u24 v1, v14, s38, v1
    v_mov_b32 v2, 0x0
    v_bfe_u32 v14, v0, 0, 1
    s_mov_b32 s38, 0x10
    v_mad_u32_u24 v2, v14, s38, v2
    v_bfe_u32 v14, v0, 1, 1
    s_mov_b32 s38, 0x20
    v_mad_u32_u24 v2, v14, s38, v2
    v_bfe_u32 v14, v0, 2, 1
    s_mov_b32 s38, 0x40
    v_mad_u32_u24 v2, v14, s38, v2
    v_bfe_u32 v14, v0, 3, 1
    s_mov_b32 s38, 0x80
    v_mad_u32_u24 v2, v14, s38, v2
    v_bfe_u32 v14, v0, 4, 1
    s_mov_b32 s38, 0x100
    v_mad_u32_u24 v2, v14, s38, v2
    v_bfe_u32 v14, v0, 5, 1
    s_mov_b32 s38, 0x200
    v_mad_u32_u24 v2, v14, s38, v2
    v_bfe_u32 v14, v0, 6, 1
    s_mov_b32 s38, 0x800
    v_mad_u32_u24 v2, v14, s38, v2
    v_bfe_u32 v14, v0, 7, 1
    s_mov_b32 s38, 0x1000
    v_mad_u32_u24 v2, v14, s38, v2
    v_mov_b32 v9, 0x0
    v_bfe_u32 v14, v0, 0, 1
    s_mov_b32 s38, 0x10
    v_mad_u32_u24 v9, v14, s38, v9
    v_bfe_u32 v14, v0, 1, 1
    s_mov_b32 s38, 0x20
    v_mad_u32_u24 v9, v14, s38, v9
    v_bfe_u32 v14, v0, 2, 1
    s_mov_b32 s38, 0x40
    v_mad_u32_u24 v9, v14, s38, v9
    v_bfe_u32 v14, v0, 3, 1
    s_mov_b32 s38, 0x80
    v_mad_u32_u24 v9, v14, s38, v9
    v_bfe_u32 v14, v0, 4, 1
    s_mov_b32 s38, 0x100
    v_mad_u32_u24 v9, v14, s38, v9
    v_bfe_u32 v14, v0, 5, 1
    s_mov_b32 s38, 0x200
    v_mad_u32_u24 v9, v14, s38, v9
    v_bfe_u32 v14, v0, 6, 1
    s_mov_b32 s38, 0x400
    v_mad_u32_u24 v9, v14, s38, v9
    v_bfe_u32 v14, v0, 7, 1
    s_mov_b32 s38, 0x800
    v_mad_u32_u24 v9, v14, s38, v9
    v_mov_b32 v7, 0x8000
    v_bfe_u32 v14, v0, 0, 1
    s_mov_b32 s38, 0x10
    v_mad_u32_u24 v7, v14, s38, v7
    v_bfe_u32 v14, v0, 1, 1
    s_mov_b32 s38, 0x20
    v_mad_u32_u24 v7, v14, s38, v7
    v_bfe_u32 v14, v0, 2, 1
    s_mov_b32 s38, 0x40
    v_mad_u32_u24 v7, v14, s38, v7
    v_bfe_u32 v14, v0, 3, 1
    s_mov_b32 s38, 0x80
    v_mad_u32_u24 v7, v14, s38, v7
    v_bfe_u32 v14, v0, 4, 1
    s_mov_b32 s38, 0x100
    v_mad_u32_u24 v7, v14, s38, v7
    v_bfe_u32 v14, v0, 5, 1
    s_mov_b32 s38, 0x200
    v_mad_u32_u24 v7, v14, s38, v7
    v_bfe_u32 v14, v0, 6, 1
    s_mov_b32 s38, 0x8000
    v_mad_u32_u24 v7, v14, s38, v7
    v_bfe_u32 v14, v0, 7, 1
    s_mov_b32 s38, 0x10000
    v_mad_u32_u24 v7, v14, s38, v7
    v_mov_b32 v3, 0x0
    v_bfe_u32 v14, v0, 0, 1
    s_mov_b32 s38, 0x10
    v_mad_u32_u24 v3, v14, s38, v3
    v_bfe_u32 v14, v0, 1, 1
    s_mov_b32 s38, 0x20
    v_mad_u32_u24 v3, v14, s38, v3
    v_bfe_u32 v14, v0, 2, 1
    s_mov_b32 s38, 0x40
    v_mad_u32_u24 v3, v14, s38, v3
    v_bfe_u32 v14, v0, 3, 1
    s_mov_b32 s38, 0x400
    v_mad_u32_u24 v3, v14, s38, v3
    v_bfe_u32 v14, v0, 4, 1
    s_mov_b32 s38, 0x800
    v_mad_u32_u24 v3, v14, s38, v3
    v_bfe_u32 v14, v0, 5, 1
    s_mov_b32 s38, 0x1000
    v_mad_u32_u24 v3, v14, s38, v3
    v_bfe_u32 v14, v0, 6, 1
    s_mov_b32 s38, 0x2000
    v_mad_u32_u24 v3, v14, s38, v3
    v_bfe_u32 v14, v0, 7, 1
    s_mov_b32 s38, 0x4000
    v_mad_u32_u24 v3, v14, s38, v3
    v_mov_b32 v4, 0x0
    v_bfe_u32 v14, v0, 0, 1
    s_mov_b32 s38, 0x100
    v_mad_u32_u24 v4, v14, s38, v4
    v_bfe_u32 v14, v0, 1, 1
    s_mov_b32 s38, 0x200
    v_mad_u32_u24 v4, v14, s38, v4
    v_bfe_u32 v14, v0, 2, 1
    s_mov_b32 s38, 0x400
    v_mad_u32_u24 v4, v14, s38, v4
    v_bfe_u32 v14, v0, 6, 1
    s_mov_b32 s38, 0x80
    v_mad_u32_u24 v4, v14, s38, v4
    v_bfe_u32 v14, v0, 7, 1
    s_mov_b32 s38, 0x4000
    v_mad_u32_u24 v4, v14, s38, v4
    v_lshrrev_b32 v15, 3, v0
    v_xor_b32 v15, v15, v0
    v_and_b32 v15, 7, v15
    v_lshl_add_u32 v4, v15, 4, v4
    v_bfe_u32 v15, v0, 4, 2
    v_lshlrev_b32 v15, 4, v15
    v_xor_b32 v5, v15, v1
    v_xor_b32 v6, 64, v5
    v_mov_b32 v8, 0x5000
    v_bfe_u32 v14, v0, 0, 1
    s_mov_b32 s38, 0x10
    v_mad_u32_u24 v8, v14, s38, v8
    v_bfe_u32 v14, v0, 1, 1
    s_mov_b32 s38, 0x40
    v_mad_u32_u24 v8, v14, s38, v8
    v_bfe_u32 v14, v0, 2, 1
    s_mov_b32 s38, 0x80
    v_mad_u32_u24 v8, v14, s38, v8
    v_bfe_u32 v14, v0, 4, 1
    s_mov_b32 s38, 0x20
    v_mad_u32_u24 v8, v14, s38, v8
    v_bfe_u32 v14, v0, 5, 1
    s_mov_b32 s38, 0x100
    v_mad_u32_u24 v8, v14, s38, v8
    v_mov_b32 v10, 0x0
    v_bfe_u32 v14, v0, 0, 1
    s_mov_b32 s38, 0x10
    v_mad_u32_u24 v10, v14, s38, v10
    v_bfe_u32 v14, v0, 1, 1
    s_mov_b32 s38, 0x20
    v_mad_u32_u24 v10, v14, s38, v10
    v_bfe_u32 v14, v0, 2, 1
    s_mov_b32 s38, 0x40
    v_mad_u32_u24 v10, v14, s38, v10
    v_bfe_u32 v14, v0, 3, 1
    s_mov_b32 s38, 0x80
    v_mad_u32_u24 v10, v14, s38, v10
    v_bfe_u32 v14, v0, 4, 1
    s_mov_b32 s38, 0x20000
    v_mad_u32_u24 v10, v14, s38, v10
    v_bfe_u32 v14, v0, 5, 1
    s_mov_b32 s38, 0x40000
    v_mad_u32_u24 v10, v14, s38, v10
    v_bfe_u32 v14, v0, 6, 1
    s_mov_b32 s38, 0x100
    v_mad_u32_u24 v10, v14, s38, v10
    v_bfe_u32 v14, v0, 7, 1
    s_mov_b32 s38, 0x200
    v_mad_u32_u24 v10, v14, s38, v10
    v_mov_b32 v11, 0x0
    v_bfe_u32 v14, v0, 0, 1
    s_mov_b32 s38, 0x10
    v_mad_u32_u24 v11, v14, s38, v11
    v_bfe_u32 v14, v0, 1, 1
    s_mov_b32 s38, 0x20
    v_mad_u32_u24 v11, v14, s38, v11
    v_bfe_u32 v14, v0, 2, 1
    s_mov_b32 s38, 0x40
    v_mad_u32_u24 v11, v14, s38, v11
    v_bfe_u32 v14, v0, 3, 1
    s_mov_b32 s38, 0x80
    v_mad_u32_u24 v11, v14, s38, v11
    v_bfe_u32 v14, v0, 4, 1
    s_mov_b32 s38, 0x400
    v_mad_u32_u24 v11, v14, s38, v11
    v_bfe_u32 v14, v0, 5, 1
    s_mov_b32 s38, 0x800
    v_mad_u32_u24 v11, v14, s38, v11
    v_bfe_u32 v14, v0, 6, 1
    s_mov_b32 s38, 0x100
    v_mad_u32_u24 v11, v14, s38, v11
    v_bfe_u32 v14, v0, 7, 1
    s_mov_b32 s38, 0x200
    v_mad_u32_u24 v11, v14, s38, v11
    v_mov_b32 v12, 0x0
    v_bfe_u32 v14, v0, 0, 1
    s_mov_b32 s38, 0x10
    v_mad_u32_u24 v12, v14, s38, v12
    v_bfe_u32 v14, v0, 1, 1
    s_mov_b32 s38, 0x20
    v_mad_u32_u24 v12, v14, s38, v12
    v_bfe_u32 v14, v0, 2, 1
    s_mov_b32 s38, 0x40
    v_mad_u32_u24 v12, v14, s38, v12
    v_bfe_u32 v14, v0, 3, 1
    s_mov_b32 s38, 0x80
    v_mad_u32_u24 v12, v14, s38, v12
    v_bfe_u32 v14, v0, 4, 1
    s_mov_b32 s38, 0x4
    v_mad_u32_u24 v12, v14, s38, v12
    v_bfe_u32 v14, v0, 5, 1
    s_mov_b32 s38, 0x8
    v_mad_u32_u24 v12, v14, s38, v12
    v_bfe_u32 v14, v0, 6, 1
    s_mov_b32 s38, 0x100
    v_mad_u32_u24 v12, v14, s38, v12
    v_bfe_u32 v14, v0, 7, 1
    s_mov_b32 s38, 0x200
    v_mad_u32_u24 v12, v14, s38, v12
    v_mov_b32 v13, 0xf149f2ca
    v_and_b32 v14, 15, v0
    v_bfe_u32 v15, v0, 4, 2
    v_cmp_gt_u32 s[72:73], 2, v15
    v_lshlrev_b32 v15, 2, v15
    v_cmp_le_u32 s[64:65], v15, v14
    v_add_u32 v15, 1, v15
    v_cmp_le_u32 s[66:67], v15, v14
    v_add_u32 v15, 1, v15
    v_cmp_le_u32 s[68:69], v15, v14
    v_add_u32 v15, 1, v15
    v_cmp_le_u32 s[70:71], v15, v14
    v_add_u32 v15, 1, v15
    s_mov_b32 s34, 0x05040100
    s_mov_b32 s35, 0x07060302
    s_mov_b32 s33, 0x3e0293ee
    s_mov_b32 s32, 0
    s_mov_b32 s4, 0x3f803f80
    s_mov_b32 s5, 0x3f803f80
    s_mov_b32 s23, s22
    s_mov_b32 s96, s54
    s_and_b32 s97, s55, 0xffff
    s_mov_b32 s98, 0x400000
    s_mov_b32 s99, 0x20000
    s_lshl_b32 s3, s20, 17
    s_and_b32 s28, s22, 3
    s_lshl_b32 s28, s28, 15
    s_add_u32 s3, s3, s28
    v_lshlrev_b32 v30, 7, v0
    buffer_load_dword v31, v30, s[96:99], s3 offen
    s_lshl_b32 s36, s23, 15
    buffer_load_dwordx4 v[96:99], v3, s[12:15], s36 offen offset:0
    buffer_load_dwordx4 v[100:103], v3, s[12:15], s36 offen offset:128
    buffer_load_dwordx4 v[104:107], v3, s[12:15], s36 offen offset:256
    buffer_load_dwordx4 v[108:111], v3, s[12:15], s36 offen offset:384
    buffer_load_dwordx4 v[112:115], v3, s[12:15], s36 offen offset:512
    buffer_load_dwordx4 v[116:119], v3, s[12:15], s36 offen offset:640
    buffer_load_dwordx4 v[120:123], v3, s[12:15], s36 offen offset:768
    buffer_load_dwordx4 v[124:127], v3, s[12:15], s36 offen offset:896
    s_mov_b32 s76, s52
    s_and_b32 s77, s53, 0xffff
    s_mov_b32 s78, 0x400000
    s_mov_b32 s79, 0x20000
    s_mov_b32 s40, s50
    s_and_b32 s41, s51, 0xffff
    s_mov_b32 s42, 0x400000
    s_mov_b32 s43, 0x20000
    s_mov_b32 s96, s48
    s_and_b32 s97, s49, 0xffff
    s_mov_b32 s98, 0x400000
    s_mov_b32 s99, 0x20000
    v_mov_b32 v16, 0x0
    v_bfe_u32 v14, v0, 0, 1
    s_mov_b32 s38, 0x10
    v_mad_u32_u24 v16, v14, s38, v16
    v_bfe_u32 v14, v0, 1, 1
    s_mov_b32 s38, 0x20
    v_mad_u32_u24 v16, v14, s38, v16
    v_bfe_u32 v14, v0, 2, 1
    s_mov_b32 s38, 0x40
    v_mad_u32_u24 v16, v14, s38, v16
    v_bfe_u32 v14, v0, 3, 1
    s_mov_b32 s38, 0x80
    v_mad_u32_u24 v16, v14, s38, v16
    v_bfe_u32 v14, v0, 4, 1
    s_mov_b32 s38, 0x2000
    v_mad_u32_u24 v16, v14, s38, v16
    v_bfe_u32 v14, v0, 5, 1
    s_mov_b32 s38, 0x4000
    v_mad_u32_u24 v16, v14, s38, v16
    v_bfe_u32 v14, v0, 6, 1
    s_mov_b32 s38, 0x40000
    v_mad_u32_u24 v16, v14, s38, v16
    v_bfe_u32 v14, v0, 7, 1
    s_mov_b32 s38, 0x80000
    v_mad_u32_u24 v16, v14, s38, v16
    v_mov_b32 v28, 0x0
    v_bfe_u32 v14, v0, 4, 1
    s_mov_b32 s38, 0x20
    v_mad_u32_u24 v28, v14, s38, v28
    v_bfe_u32 v14, v0, 5, 1
    s_mov_b32 s38, 0x40
    v_mad_u32_u24 v28, v14, s38, v28
    v_xor_b32 v16, v16, v28
    v_xor_b32 v17, 0, v16
    v_xor_b32 v18, 128, v16
    v_xor_b32 v19, 128, v16
    v_mov_b32 v20, 0x0
    v_bfe_u32 v14, v0, 0, 1
    s_mov_b32 s38, 0x8
    v_mad_u32_u24 v20, v14, s38, v20
    v_bfe_u32 v14, v0, 1, 1
    s_mov_b32 s38, 0x10
    v_mad_u32_u24 v20, v14, s38, v20
    v_bfe_u32 v14, v0, 2, 1
    s_mov_b32 s38, 0x100
    v_mad_u32_u24 v20, v14, s38, v20
    v_bfe_u32 v14, v0, 3, 1
    s_mov_b32 s38, 0x200
    v_mad_u32_u24 v20, v14, s38, v20
    v_bfe_u32 v14, v0, 4, 1
    s_mov_b32 s38, 0x800
    v_mad_u32_u24 v20, v14, s38, v20
    v_bfe_u32 v14, v0, 5, 1
    s_mov_b32 s38, 0x1000
    v_mad_u32_u24 v20, v14, s38, v20
    v_mov_b32 v28, 0x0
    v_bfe_u32 v14, v0, 2, 1
    s_mov_b32 s38, 0x20
    v_mad_u32_u24 v28, v14, s38, v28
    v_bfe_u32 v14, v0, 3, 1
    s_mov_b32 s38, 0x40
    v_mad_u32_u24 v28, v14, s38, v28
    v_bfe_u32 v14, v0, 4, 1
    s_mov_b32 s38, 0x80
    v_mad_u32_u24 v28, v14, s38, v28
    v_mov_b32 v29, 0x0
    v_bfe_u32 v14, v0, 6, 1
    s_mov_b32 s38, 0x40
    v_mad_u32_u24 v29, v14, s38, v29
    v_bfe_u32 v14, v0, 7, 1
    s_mov_b32 s38, 0x80
    v_mad_u32_u24 v29, v14, s38, v29
    v_xor_b32 v28, v28, v29
    v_add_u32 v28, v28, v20
    v_add_u32 v20, 0x8000, v28
    v_xor_b32 v21, 32, v20
    v_add_u32 v22, 0x10000, v28
    v_xor_b32 v23, 32, v22
    v_add_u32 v24, 0x18000, v28
    v_xor_b32 v25, 32, v24
    v_add_u32 v26, 0x20000, v28
    v_xor_b32 v27, 32, v26
    s_add_u32 s28, s21, 1
    s_lshl_b32 s28, s28, 15
    s_lshl_b32 s3, s20, 8
    s_add_u32 m0, s28, 0
    s_add_u32 s37, s3, 0x0
    buffer_load_dwordx4 v16, s[76:79], s37 offen lds
    s_add_u32 m0, s28, 1024
    s_add_u32 s37, s3, 0x8000
    buffer_load_dwordx4 v17, s[76:79], s37 offen lds
    s_add_u32 m0, s28, 2048
    s_add_u32 s37, s3, 0x10000
    buffer_load_dwordx4 v18, s[76:79], s37 offen lds
    s_add_u32 m0, s28, 3072
    s_add_u32 s37, s3, 0x18000
    buffer_load_dwordx4 v19, s[76:79], s37 offen lds
    s_add_u32 m0, s28, 4096
    s_add_u32 s37, s3, 0x20000
    buffer_load_dwordx4 v16, s[76:79], s37 offen lds
    s_add_u32 m0, s28, 5120
    s_add_u32 s37, s3, 0x28000
    buffer_load_dwordx4 v17, s[76:79], s37 offen lds
    s_add_u32 m0, s28, 6144
    s_add_u32 s37, s3, 0x30000
    buffer_load_dwordx4 v18, s[76:79], s37 offen lds
    s_add_u32 m0, s28, 7168
    s_add_u32 s37, s3, 0x38000
    buffer_load_dwordx4 v19, s[76:79], s37 offen lds
    s_add_u32 m0, s28, 8192
    s_add_u32 s37, s3, 0x100000
    buffer_load_dwordx4 v16, s[76:79], s37 offen lds
    s_add_u32 m0, s28, 9216
    s_add_u32 s37, s3, 0x108000
    buffer_load_dwordx4 v17, s[76:79], s37 offen lds
    s_add_u32 m0, s28, 10240
    s_add_u32 s37, s3, 0x110000
    buffer_load_dwordx4 v18, s[76:79], s37 offen lds
    s_add_u32 m0, s28, 11264
    s_add_u32 s37, s3, 0x118000
    buffer_load_dwordx4 v19, s[76:79], s37 offen lds
    s_add_u32 m0, s28, 12288
    s_add_u32 s37, s3, 0x120000
    buffer_load_dwordx4 v16, s[76:79], s37 offen lds
    s_add_u32 m0, s28, 13312
    s_add_u32 s37, s3, 0x128000
    buffer_load_dwordx4 v17, s[76:79], s37 offen lds
    s_add_u32 m0, s28, 14336
    s_add_u32 s37, s3, 0x130000
    buffer_load_dwordx4 v18, s[76:79], s37 offen lds
    s_add_u32 m0, s28, 15360
    s_add_u32 s37, s3, 0x138000
    buffer_load_dwordx4 v19, s[76:79], s37 offen lds
    s_add_u32 m0, s28, 16384
    s_add_u32 s37, s3, 0x200000
    buffer_load_dwordx4 v16, s[76:79], s37 offen lds
    s_add_u32 m0, s28, 17408
    s_add_u32 s37, s3, 0x208000
    buffer_load_dwordx4 v17, s[76:79], s37 offen lds
    s_add_u32 m0, s28, 18432
    s_add_u32 s37, s3, 0x210000
    buffer_load_dwordx4 v18, s[76:79], s37 offen lds
    s_add_u32 m0, s28, 19456
    s_add_u32 s37, s3, 0x218000
    buffer_load_dwordx4 v19, s[76:79], s37 offen lds
    s_add_u32 m0, s28, 20480
    s_add_u32 s37, s3, 0x220000
    buffer_load_dwordx4 v16, s[76:79], s37 offen lds
    s_add_u32 m0, s28, 21504
    s_add_u32 s37, s3, 0x228000
    buffer_load_dwordx4 v17, s[76:79], s37 offen lds
    s_add_u32 m0, s28, 22528
    s_add_u32 s37, s3, 0x230000
    buffer_load_dwordx4 v18, s[76:79], s37 offen lds
    s_add_u32 m0, s28, 23552
    s_add_u32 s37, s3, 0x238000
    buffer_load_dwordx4 v19, s[76:79], s37 offen lds
    s_waitcnt vmcnt(16)
    s_barrier
    ds_read_b64_tr_b16 v[128:129], v20 offset:0
    ds_read_b64_tr_b16 v[130:131], v20 offset:1024
    ds_read_b64_tr_b16 v[132:133], v21 offset:0
    ds_read_b64_tr_b16 v[134:135], v21 offset:1024
    ds_read_b64_tr_b16 v[136:137], v22 offset:0
    ds_read_b64_tr_b16 v[138:139], v22 offset:1024
    ds_read_b64_tr_b16 v[140:141], v23 offset:0
    ds_read_b64_tr_b16 v[142:143], v23 offset:1024
    ds_read_b64_tr_b16 v[144:145], v24 offset:0
    ds_read_b64_tr_b16 v[146:147], v24 offset:1024
    ds_read_b64_tr_b16 v[148:149], v25 offset:0
    ds_read_b64_tr_b16 v[150:151], v25 offset:1024
    s_waitcnt lgkmcnt(4)
    ds_read_b64_tr_b16 v[152:153], v26 offset:0
    ds_read_b64_tr_b16 v[154:155], v26 offset:1024
    ds_read_b64_tr_b16 v[156:157], v27 offset:0
    ds_read_b64_tr_b16 v[158:159], v27 offset:1024
    s_waitcnt lgkmcnt(0)
    s_barrier
    s_add_u32 m0, s28, 0
    s_add_u32 s37, s3, 0x300000
    buffer_load_dwordx4 v16, s[76:79], s37 offen lds
    s_add_u32 m0, s28, 1024
    s_add_u32 s37, s3, 0x308000
    buffer_load_dwordx4 v17, s[76:79], s37 offen lds
    s_add_u32 m0, s28, 2048
    s_add_u32 s37, s3, 0x310000
    buffer_load_dwordx4 v18, s[76:79], s37 offen lds
    s_add_u32 m0, s28, 3072
    s_add_u32 s37, s3, 0x318000
    buffer_load_dwordx4 v19, s[76:79], s37 offen lds
    s_add_u32 m0, s28, 4096
    s_add_u32 s37, s3, 0x320000
    buffer_load_dwordx4 v16, s[76:79], s37 offen lds
    s_add_u32 m0, s28, 5120
    s_add_u32 s37, s3, 0x328000
    buffer_load_dwordx4 v17, s[76:79], s37 offen lds
    s_add_u32 m0, s28, 6144
    s_add_u32 s37, s3, 0x330000
    buffer_load_dwordx4 v18, s[76:79], s37 offen lds
    s_add_u32 m0, s28, 7168
    s_add_u32 s37, s3, 0x338000
    buffer_load_dwordx4 v19, s[76:79], s37 offen lds
    s_waitcnt vmcnt(16)
    s_barrier
    ds_read_b64_tr_b16 v[160:161], v20 offset:8192
    ds_read_b64_tr_b16 v[162:163], v20 offset:9216
    ds_read_b64_tr_b16 v[164:165], v21 offset:8192
    ds_read_b64_tr_b16 v[166:167], v21 offset:9216
    ds_read_b64_tr_b16 v[168:169], v22 offset:8192
    ds_read_b64_tr_b16 v[170:171], v22 offset:9216
    ds_read_b64_tr_b16 v[172:173], v23 offset:8192
    ds_read_b64_tr_b16 v[174:175], v23 offset:9216
    ds_read_b64_tr_b16 v[176:177], v24 offset:8192
    ds_read_b64_tr_b16 v[178:179], v24 offset:9216
    ds_read_b64_tr_b16 v[180:181], v25 offset:8192
    ds_read_b64_tr_b16 v[182:183], v25 offset:9216
    s_waitcnt lgkmcnt(4)
    ds_read_b64_tr_b16 v[184:185], v26 offset:8192
    ds_read_b64_tr_b16 v[186:187], v26 offset:9216
    ds_read_b64_tr_b16 v[188:189], v27 offset:8192
    ds_read_b64_tr_b16 v[190:191], v27 offset:9216
    s_waitcnt lgkmcnt(0)
    s_barrier
    s_add_u32 m0, s28, 8192
    s_add_u32 s37, s3, 0x0
    buffer_load_dwordx4 v16, s[40:43], s37 offen lds
    s_add_u32 m0, s28, 9216
    s_add_u32 s37, s3, 0x8000
    buffer_load_dwordx4 v17, s[40:43], s37 offen lds
    s_add_u32 m0, s28, 10240
    s_add_u32 s37, s3, 0x10000
    buffer_load_dwordx4 v18, s[40:43], s37 offen lds
    s_add_u32 m0, s28, 11264
    s_add_u32 s37, s3, 0x18000
    buffer_load_dwordx4 v19, s[40:43], s37 offen lds
    s_add_u32 m0, s28, 12288
    s_add_u32 s37, s3, 0x20000
    buffer_load_dwordx4 v16, s[40:43], s37 offen lds
    s_add_u32 m0, s28, 13312
    s_add_u32 s37, s3, 0x28000
    buffer_load_dwordx4 v17, s[40:43], s37 offen lds
    s_add_u32 m0, s28, 14336
    s_add_u32 s37, s3, 0x30000
    buffer_load_dwordx4 v18, s[40:43], s37 offen lds
    s_add_u32 m0, s28, 15360
    s_add_u32 s37, s3, 0x38000
    buffer_load_dwordx4 v19, s[40:43], s37 offen lds
    s_waitcnt vmcnt(16)
    s_barrier
    ds_read_b64_tr_b16 v[192:193], v20 offset:16384
    ds_read_b64_tr_b16 v[194:195], v20 offset:17408
    ds_read_b64_tr_b16 v[196:197], v21 offset:16384
    ds_read_b64_tr_b16 v[198:199], v21 offset:17408
    ds_read_b64_tr_b16 v[200:201], v22 offset:16384
    ds_read_b64_tr_b16 v[202:203], v22 offset:17408
    ds_read_b64_tr_b16 v[204:205], v23 offset:16384
    ds_read_b64_tr_b16 v[206:207], v23 offset:17408
    ds_read_b64_tr_b16 v[208:209], v24 offset:16384
    ds_read_b64_tr_b16 v[210:211], v24 offset:17408
    ds_read_b64_tr_b16 v[212:213], v25 offset:16384
    ds_read_b64_tr_b16 v[214:215], v25 offset:17408
    s_waitcnt lgkmcnt(4)
    ds_read_b64_tr_b16 v[216:217], v26 offset:16384
    ds_read_b64_tr_b16 v[218:219], v26 offset:17408
    ds_read_b64_tr_b16 v[220:221], v27 offset:16384
    ds_read_b64_tr_b16 v[222:223], v27 offset:17408
    s_waitcnt lgkmcnt(0)
    s_barrier
    s_add_u32 m0, s28, 16384
    s_add_u32 s37, s3, 0x100000
    buffer_load_dwordx4 v16, s[40:43], s37 offen lds
    s_add_u32 m0, s28, 17408
    s_add_u32 s37, s3, 0x108000
    buffer_load_dwordx4 v17, s[40:43], s37 offen lds
    s_add_u32 m0, s28, 18432
    s_add_u32 s37, s3, 0x110000
    buffer_load_dwordx4 v18, s[40:43], s37 offen lds
    s_add_u32 m0, s28, 19456
    s_add_u32 s37, s3, 0x118000
    buffer_load_dwordx4 v19, s[40:43], s37 offen lds
    s_add_u32 m0, s28, 20480
    s_add_u32 s37, s3, 0x120000
    buffer_load_dwordx4 v16, s[40:43], s37 offen lds
    s_add_u32 m0, s28, 21504
    s_add_u32 s37, s3, 0x128000
    buffer_load_dwordx4 v17, s[40:43], s37 offen lds
    s_add_u32 m0, s28, 22528
    s_add_u32 s37, s3, 0x130000
    buffer_load_dwordx4 v18, s[40:43], s37 offen lds
    s_add_u32 m0, s28, 23552
    s_add_u32 s37, s3, 0x138000
    buffer_load_dwordx4 v19, s[40:43], s37 offen lds
    s_waitcnt vmcnt(16)
    s_barrier
    ds_read_b64_tr_b16 v[224:225], v20 offset:0
    ds_read_b64_tr_b16 v[226:227], v20 offset:1024
    ds_read_b64_tr_b16 v[228:229], v21 offset:0
    ds_read_b64_tr_b16 v[230:231], v21 offset:1024
    ds_read_b64_tr_b16 v[232:233], v22 offset:0
    ds_read_b64_tr_b16 v[234:235], v22 offset:1024
    ds_read_b64_tr_b16 v[236:237], v23 offset:0
    ds_read_b64_tr_b16 v[238:239], v23 offset:1024
    ds_read_b64_tr_b16 v[240:241], v24 offset:0
    ds_read_b64_tr_b16 v[242:243], v24 offset:1024
    ds_read_b64_tr_b16 v[244:245], v25 offset:0
    ds_read_b64_tr_b16 v[246:247], v25 offset:1024
    s_waitcnt lgkmcnt(4)
    ds_read_b64_tr_b16 v[248:249], v26 offset:0
    ds_read_b64_tr_b16 v[250:251], v26 offset:1024
    ds_read_b64_tr_b16 v[252:253], v27 offset:0
    ds_read_b64_tr_b16 v[254:255], v27 offset:1024
    s_waitcnt lgkmcnt(0)
    s_barrier
    s_add_u32 m0, s28, 0
    s_add_u32 s37, s3, 0x200000
    buffer_load_dwordx4 v16, s[40:43], s37 offen lds
    s_add_u32 m0, s28, 1024
    s_add_u32 s37, s3, 0x208000
    buffer_load_dwordx4 v17, s[40:43], s37 offen lds
    s_add_u32 m0, s28, 2048
    s_add_u32 s37, s3, 0x210000
    buffer_load_dwordx4 v18, s[40:43], s37 offen lds
    s_add_u32 m0, s28, 3072
    s_add_u32 s37, s3, 0x218000
    buffer_load_dwordx4 v19, s[40:43], s37 offen lds
    s_add_u32 m0, s28, 4096
    s_add_u32 s37, s3, 0x220000
    buffer_load_dwordx4 v16, s[40:43], s37 offen lds
    s_add_u32 m0, s28, 5120
    s_add_u32 s37, s3, 0x228000
    buffer_load_dwordx4 v17, s[40:43], s37 offen lds
    s_add_u32 m0, s28, 6144
    s_add_u32 s37, s3, 0x230000
    buffer_load_dwordx4 v18, s[40:43], s37 offen lds
    s_add_u32 m0, s28, 7168
    s_add_u32 s37, s3, 0x238000
    buffer_load_dwordx4 v19, s[40:43], s37 offen lds
    s_waitcnt vmcnt(16)
    s_barrier
    ds_read_b64_tr_b16 a[128:129], v20 offset:8192
    ds_read_b64_tr_b16 a[130:131], v20 offset:9216
    ds_read_b64_tr_b16 a[132:133], v21 offset:8192
    ds_read_b64_tr_b16 a[134:135], v21 offset:9216
    ds_read_b64_tr_b16 a[136:137], v22 offset:8192
    ds_read_b64_tr_b16 a[138:139], v22 offset:9216
    ds_read_b64_tr_b16 a[140:141], v23 offset:8192
    ds_read_b64_tr_b16 a[142:143], v23 offset:9216
    ds_read_b64_tr_b16 a[144:145], v24 offset:8192
    ds_read_b64_tr_b16 a[146:147], v24 offset:9216
    ds_read_b64_tr_b16 a[148:149], v25 offset:8192
    ds_read_b64_tr_b16 a[150:151], v25 offset:9216
    s_waitcnt lgkmcnt(4)
    ds_read_b64_tr_b16 a[152:153], v26 offset:8192
    ds_read_b64_tr_b16 a[154:155], v26 offset:9216
    ds_read_b64_tr_b16 a[156:157], v27 offset:8192
    ds_read_b64_tr_b16 a[158:159], v27 offset:9216
    s_waitcnt lgkmcnt(0)
    s_barrier
    s_add_u32 m0, s28, 8192
    s_add_u32 s37, s3, 0x300000
    buffer_load_dwordx4 v16, s[40:43], s37 offen lds
    s_add_u32 m0, s28, 9216
    s_add_u32 s37, s3, 0x308000
    buffer_load_dwordx4 v17, s[40:43], s37 offen lds
    s_add_u32 m0, s28, 10240
    s_add_u32 s37, s3, 0x310000
    buffer_load_dwordx4 v18, s[40:43], s37 offen lds
    s_add_u32 m0, s28, 11264
    s_add_u32 s37, s3, 0x318000
    buffer_load_dwordx4 v19, s[40:43], s37 offen lds
    s_add_u32 m0, s28, 12288
    s_add_u32 s37, s3, 0x320000
    buffer_load_dwordx4 v16, s[40:43], s37 offen lds
    s_add_u32 m0, s28, 13312
    s_add_u32 s37, s3, 0x328000
    buffer_load_dwordx4 v17, s[40:43], s37 offen lds
    s_add_u32 m0, s28, 14336
    s_add_u32 s37, s3, 0x330000
    buffer_load_dwordx4 v18, s[40:43], s37 offen lds
    s_add_u32 m0, s28, 15360
    s_add_u32 s37, s3, 0x338000
    buffer_load_dwordx4 v19, s[40:43], s37 offen lds
    s_waitcnt vmcnt(16)
    s_barrier
    ds_read_b64_tr_b16 a[160:161], v20 offset:16384
    ds_read_b64_tr_b16 a[162:163], v20 offset:17408
    ds_read_b64_tr_b16 a[164:165], v21 offset:16384
    ds_read_b64_tr_b16 a[166:167], v21 offset:17408
    ds_read_b64_tr_b16 a[168:169], v22 offset:16384
    ds_read_b64_tr_b16 a[170:171], v22 offset:17408
    ds_read_b64_tr_b16 a[172:173], v23 offset:16384
    ds_read_b64_tr_b16 a[174:175], v23 offset:17408
    ds_read_b64_tr_b16 a[176:177], v24 offset:16384
    ds_read_b64_tr_b16 a[178:179], v24 offset:17408
    ds_read_b64_tr_b16 a[180:181], v25 offset:16384
    ds_read_b64_tr_b16 a[182:183], v25 offset:17408
    s_waitcnt lgkmcnt(4)
    ds_read_b64_tr_b16 a[184:185], v26 offset:16384
    ds_read_b64_tr_b16 a[186:187], v26 offset:17408
    ds_read_b64_tr_b16 a[188:189], v27 offset:16384
    ds_read_b64_tr_b16 a[190:191], v27 offset:17408
    s_waitcnt lgkmcnt(0)
    s_barrier
    s_add_u32 m0, s28, 16384
    s_add_u32 s37, s3, 0x0
    buffer_load_dwordx4 v16, s[96:99], s37 offen lds
    s_add_u32 m0, s28, 17408
    s_add_u32 s37, s3, 0x8000
    buffer_load_dwordx4 v17, s[96:99], s37 offen lds
    s_add_u32 m0, s28, 18432
    s_add_u32 s37, s3, 0x10000
    buffer_load_dwordx4 v18, s[96:99], s37 offen lds
    s_add_u32 m0, s28, 19456
    s_add_u32 s37, s3, 0x18000
    buffer_load_dwordx4 v19, s[96:99], s37 offen lds
    s_add_u32 m0, s28, 20480
    s_add_u32 s37, s3, 0x20000
    buffer_load_dwordx4 v16, s[96:99], s37 offen lds
    s_add_u32 m0, s28, 21504
    s_add_u32 s37, s3, 0x28000
    buffer_load_dwordx4 v17, s[96:99], s37 offen lds
    s_add_u32 m0, s28, 22528
    s_add_u32 s37, s3, 0x30000
    buffer_load_dwordx4 v18, s[96:99], s37 offen lds
    s_add_u32 m0, s28, 23552
    s_add_u32 s37, s3, 0x38000
    buffer_load_dwordx4 v19, s[96:99], s37 offen lds
    s_waitcnt vmcnt(16)
    s_barrier
    ds_read_b64_tr_b16 a[192:193], v20 offset:0
    ds_read_b64_tr_b16 a[194:195], v20 offset:1024
    ds_read_b64_tr_b16 a[196:197], v21 offset:0
    ds_read_b64_tr_b16 a[198:199], v21 offset:1024
    ds_read_b64_tr_b16 a[200:201], v22 offset:0
    ds_read_b64_tr_b16 a[202:203], v22 offset:1024
    ds_read_b64_tr_b16 a[204:205], v23 offset:0
    ds_read_b64_tr_b16 a[206:207], v23 offset:1024
    ds_read_b64_tr_b16 a[208:209], v24 offset:0
    ds_read_b64_tr_b16 a[210:211], v24 offset:1024
    ds_read_b64_tr_b16 a[212:213], v25 offset:0
    ds_read_b64_tr_b16 a[214:215], v25 offset:1024
    s_waitcnt lgkmcnt(4)
    ds_read_b64_tr_b16 a[216:217], v26 offset:0
    ds_read_b64_tr_b16 a[218:219], v26 offset:1024
    ds_read_b64_tr_b16 a[220:221], v27 offset:0
    ds_read_b64_tr_b16 a[222:223], v27 offset:1024
    s_waitcnt lgkmcnt(0)
    s_barrier
    s_add_u32 m0, s28, 0
    s_add_u32 s37, s3, 0x100000
    buffer_load_dwordx4 v16, s[96:99], s37 offen lds
    s_add_u32 m0, s28, 1024
    s_add_u32 s37, s3, 0x108000
    buffer_load_dwordx4 v17, s[96:99], s37 offen lds
    s_add_u32 m0, s28, 2048
    s_add_u32 s37, s3, 0x110000
    buffer_load_dwordx4 v18, s[96:99], s37 offen lds
    s_add_u32 m0, s28, 3072
    s_add_u32 s37, s3, 0x118000
    buffer_load_dwordx4 v19, s[96:99], s37 offen lds
    s_add_u32 m0, s28, 4096
    s_add_u32 s37, s3, 0x120000
    buffer_load_dwordx4 v16, s[96:99], s37 offen lds
    s_add_u32 m0, s28, 5120
    s_add_u32 s37, s3, 0x128000
    buffer_load_dwordx4 v17, s[96:99], s37 offen lds
    s_add_u32 m0, s28, 6144
    s_add_u32 s37, s3, 0x130000
    buffer_load_dwordx4 v18, s[96:99], s37 offen lds
    s_add_u32 m0, s28, 7168
    s_add_u32 s37, s3, 0x138000
    buffer_load_dwordx4 v19, s[96:99], s37 offen lds
    s_waitcnt vmcnt(16)
    s_barrier
    ds_read_b64_tr_b16 a[224:225], v20 offset:8192
    ds_read_b64_tr_b16 a[226:227], v20 offset:9216
    ds_read_b64_tr_b16 a[228:229], v21 offset:8192
    ds_read_b64_tr_b16 a[230:231], v21 offset:9216
    ds_read_b64_tr_b16 a[232:233], v22 offset:8192
    ds_read_b64_tr_b16 a[234:235], v22 offset:9216
    ds_read_b64_tr_b16 a[236:237], v23 offset:8192
    ds_read_b64_tr_b16 a[238:239], v23 offset:9216
    ds_read_b64_tr_b16 a[240:241], v24 offset:8192
    ds_read_b64_tr_b16 a[242:243], v24 offset:9216
    ds_read_b64_tr_b16 a[244:245], v25 offset:8192
    ds_read_b64_tr_b16 a[246:247], v25 offset:9216
    s_waitcnt lgkmcnt(4)
    ds_read_b64_tr_b16 a[248:249], v26 offset:8192
    ds_read_b64_tr_b16 a[250:251], v26 offset:9216
    ds_read_b64_tr_b16 a[252:253], v27 offset:8192
    ds_read_b64_tr_b16 a[254:255], v27 offset:9216
    s_waitcnt lgkmcnt(0)
    s_barrier
    s_add_u32 m0, s28, 8192
    s_add_u32 s37, s3, 0x200000
    buffer_load_dwordx4 v16, s[96:99], s37 offen lds
    s_add_u32 m0, s28, 9216
    s_add_u32 s37, s3, 0x208000
    buffer_load_dwordx4 v17, s[96:99], s37 offen lds
    s_add_u32 m0, s28, 10240
    s_add_u32 s37, s3, 0x210000
    buffer_load_dwordx4 v18, s[96:99], s37 offen lds
    s_add_u32 m0, s28, 11264
    s_add_u32 s37, s3, 0x218000
    buffer_load_dwordx4 v19, s[96:99], s37 offen lds
    s_add_u32 m0, s28, 12288
    s_add_u32 s37, s3, 0x220000
    buffer_load_dwordx4 v16, s[96:99], s37 offen lds
    s_add_u32 m0, s28, 13312
    s_add_u32 s37, s3, 0x228000
    buffer_load_dwordx4 v17, s[96:99], s37 offen lds
    s_add_u32 m0, s28, 14336
    s_add_u32 s37, s3, 0x230000
    buffer_load_dwordx4 v18, s[96:99], s37 offen lds
    s_add_u32 m0, s28, 15360
    s_add_u32 s37, s3, 0x238000
    buffer_load_dwordx4 v19, s[96:99], s37 offen lds
    s_waitcnt vmcnt(16)
    s_barrier
    ds_read_b64_tr_b16 a[0:1], v20 offset:16384
    ds_read_b64_tr_b16 a[2:3], v20 offset:17408
    ds_read_b64_tr_b16 a[4:5], v21 offset:16384
    ds_read_b64_tr_b16 a[6:7], v21 offset:17408
    ds_read_b64_tr_b16 a[8:9], v22 offset:16384
    ds_read_b64_tr_b16 a[10:11], v22 offset:17408
    ds_read_b64_tr_b16 a[12:13], v23 offset:16384
    ds_read_b64_tr_b16 a[14:15], v23 offset:17408
    ds_read_b64_tr_b16 a[16:17], v24 offset:16384
    ds_read_b64_tr_b16 a[18:19], v24 offset:17408
    ds_read_b64_tr_b16 a[20:21], v25 offset:16384
    ds_read_b64_tr_b16 a[22:23], v25 offset:17408
    s_waitcnt lgkmcnt(4)
    ds_read_b64_tr_b16 a[24:25], v26 offset:16384
    ds_read_b64_tr_b16 a[26:27], v26 offset:17408
    ds_read_b64_tr_b16 a[28:29], v27 offset:16384
    ds_read_b64_tr_b16 a[30:31], v27 offset:17408
    s_waitcnt lgkmcnt(0)
    s_barrier
    s_add_u32 m0, s28, 16384
    s_add_u32 s37, s3, 0x300000
    buffer_load_dwordx4 v16, s[96:99], s37 offen lds
    s_add_u32 m0, s28, 17408
    s_add_u32 s37, s3, 0x308000
    buffer_load_dwordx4 v17, s[96:99], s37 offen lds
    s_add_u32 m0, s28, 18432
    s_add_u32 s37, s3, 0x310000
    buffer_load_dwordx4 v18, s[96:99], s37 offen lds
    s_add_u32 m0, s28, 19456
    s_add_u32 s37, s3, 0x318000
    buffer_load_dwordx4 v19, s[96:99], s37 offen lds
    s_add_u32 m0, s28, 20480
    s_add_u32 s37, s3, 0x320000
    buffer_load_dwordx4 v16, s[96:99], s37 offen lds
    s_add_u32 m0, s28, 21504
    s_add_u32 s37, s3, 0x328000
    buffer_load_dwordx4 v17, s[96:99], s37 offen lds
    s_add_u32 m0, s28, 22528
    s_add_u32 s37, s3, 0x330000
    buffer_load_dwordx4 v18, s[96:99], s37 offen lds
    s_add_u32 m0, s28, 23552
    s_add_u32 s37, s3, 0x338000
    buffer_load_dwordx4 v19, s[96:99], s37 offen lds
    s_waitcnt vmcnt(16)
    s_barrier
    ds_read_b64_tr_b16 a[32:33], v20 offset:0
    ds_read_b64_tr_b16 a[34:35], v20 offset:1024
    ds_read_b64_tr_b16 a[36:37], v21 offset:0
    ds_read_b64_tr_b16 a[38:39], v21 offset:1024
    ds_read_b64_tr_b16 a[40:41], v22 offset:0
    ds_read_b64_tr_b16 a[42:43], v22 offset:1024
    ds_read_b64_tr_b16 a[44:45], v23 offset:0
    ds_read_b64_tr_b16 a[46:47], v23 offset:1024
    ds_read_b64_tr_b16 a[48:49], v24 offset:0
    ds_read_b64_tr_b16 a[50:51], v24 offset:1024
    ds_read_b64_tr_b16 a[52:53], v25 offset:0
    ds_read_b64_tr_b16 a[54:55], v25 offset:1024
    s_waitcnt lgkmcnt(4)
    ds_read_b64_tr_b16 a[56:57], v26 offset:0
    ds_read_b64_tr_b16 a[58:59], v26 offset:1024
    ds_read_b64_tr_b16 a[60:61], v27 offset:0
    ds_read_b64_tr_b16 a[62:63], v27 offset:1024
    s_waitcnt lgkmcnt(0)
    s_barrier
    s_waitcnt vmcnt(8)
    s_barrier
    ds_read_b64_tr_b16 a[64:65], v20 offset:8192
    ds_read_b64_tr_b16 a[66:67], v20 offset:9216
    ds_read_b64_tr_b16 a[68:69], v21 offset:8192
    ds_read_b64_tr_b16 a[70:71], v21 offset:9216
    ds_read_b64_tr_b16 a[72:73], v22 offset:8192
    ds_read_b64_tr_b16 a[74:75], v22 offset:9216
    ds_read_b64_tr_b16 a[76:77], v23 offset:8192
    ds_read_b64_tr_b16 a[78:79], v23 offset:9216
    ds_read_b64_tr_b16 a[80:81], v24 offset:8192
    ds_read_b64_tr_b16 a[82:83], v24 offset:9216
    ds_read_b64_tr_b16 a[84:85], v25 offset:8192
    ds_read_b64_tr_b16 a[86:87], v25 offset:9216
    s_waitcnt lgkmcnt(4)
    ds_read_b64_tr_b16 a[88:89], v26 offset:8192
    ds_read_b64_tr_b16 a[90:91], v26 offset:9216
    ds_read_b64_tr_b16 a[92:93], v27 offset:8192
    ds_read_b64_tr_b16 a[94:95], v27 offset:9216
    s_waitcnt lgkmcnt(0)
    s_barrier
    s_waitcnt vmcnt(0)
    s_barrier
    ds_read_b64_tr_b16 a[96:97], v20 offset:16384
    ds_read_b64_tr_b16 a[98:99], v20 offset:17408
    ds_read_b64_tr_b16 a[100:101], v21 offset:16384
    ds_read_b64_tr_b16 a[102:103], v21 offset:17408
    ds_read_b64_tr_b16 a[104:105], v22 offset:16384
    ds_read_b64_tr_b16 a[106:107], v22 offset:17408
    ds_read_b64_tr_b16 a[108:109], v23 offset:16384
    ds_read_b64_tr_b16 a[110:111], v23 offset:17408
    ds_read_b64_tr_b16 a[112:113], v24 offset:16384
    ds_read_b64_tr_b16 a[114:115], v24 offset:17408
    ds_read_b64_tr_b16 a[116:117], v25 offset:16384
    ds_read_b64_tr_b16 a[118:119], v25 offset:17408
    s_waitcnt lgkmcnt(4)
    ds_read_b64_tr_b16 a[120:121], v26 offset:16384
    ds_read_b64_tr_b16 a[122:123], v26 offset:17408
    ds_read_b64_tr_b16 a[124:125], v27 offset:16384
    ds_read_b64_tr_b16 a[126:127], v27 offset:17408
    s_waitcnt lgkmcnt(0)
    s_barrier
    v_lshrrev_b32 v15, 2, v1
    v_and_b32 v15, 127, v15
L_WHS:
    buffer_load_dword v14, v15, s[16:19], 0 offen offset:128 sc1
    s_add_u32 s32, s32, 1
    s_cmp_gt_u32 s32, 200000
    s_cbranch_scc1 L_WHS_done
    s_waitcnt vmcnt(0)
    v_cmp_eq_u32 vcc, 0, v14
    s_cbranch_vccnz L_WHS
L_WHS_done:
    s_lshr_b32 s36, s21, 1
    s_lshl_b32 s36, s36, 14
    s_xor_b32 s37, s36, 16384
    v_add_u32 v80, s36, v5
    v_add_u32 v81, s37, v5
    v_add_u32 v82, s36, v6
    v_add_u32 v83, s37, v6
    s_mov_b32 s25, 0x40000000
L_P1:
    s_waitcnt vmcnt(6)
    v_mov_b32 v16, 0
    v_mov_b32 v17, 0
    v_dot2_f32_bf16 v16, v96, s4, v16
    v_dot2_f32_bf16 v17, v96, v96, v17
    v_dot2_f32_bf16 v16, v97, s4, v16
    v_dot2_f32_bf16 v17, v97, v97, v17
    v_dot2_f32_bf16 v16, v98, s4, v16
    v_dot2_f32_bf16 v17, v98, v98, v17
    v_dot2_f32_bf16 v16, v99, s4, v16
    v_dot2_f32_bf16 v17, v99, v99, v17
    v_dot2_f32_bf16 v16, v100, s4, v16
    v_dot2_f32_bf16 v17, v100, v100, v17
    v_dot2_f32_bf16 v16, v101, s4, v16
    v_dot2_f32_bf16 v17, v101, v101, v17
    v_dot2_f32_bf16 v16, v102, s4, v16
    v_dot2_f32_bf16 v17, v102, v102, v17
    v_dot2_f32_bf16 v16, v103, s4, v16
    v_dot2_f32_bf16 v17, v103, v103, v17
    v_dot2_f32_bf16 v16, v104, s4, v16
    v_dot2_f32_bf16 v17, v104, v104, v17
    v_dot2_f32_bf16 v16, v105, s4, v16
    v_dot2_f32_bf16 v17, v105, v105, v17
    v_dot2_f32_bf16 v16, v106, s4, v16
    v_dot2_f32_bf16 v17, v106, v106, v17
    v_dot2_f32_bf16 v16, v107, s4, v16
    v_dot2_f32_bf16 v17, v107, v107, v17
    v_dot2_f32_bf16 v16, v108, s4, v16
    v_dot2_f32_bf16 v17, v108, v108, v17
    v_dot2_f32_bf16 v16, v109, s4, v16
    v_dot2_f32_bf16 v17, v109, v109, v17
    v_dot2_f32_bf16 v16, v110, s4, v16
    v_dot2_f32_bf16 v17, v110, v110, v17
    v_dot2_f32_bf16 v16, v111, s4, v16
    v_dot2_f32_bf16 v17, v111, v111, v17
    v_dot2_f32_bf16 v16, v112, s4, v16
    v_dot2_f32_bf16 v17, v112, v112, v17
    v_dot2_f32_bf16 v16, v113, s4, v16
    v_dot2_f32_bf16 v17, v113, v113, v17
    v_dot2_f32_bf16 v16, v114, s4, v16
    v_dot2_f32_bf16 v17, v114, v114, v17
    v_dot2_f32_bf16 v16, v115, s4, v16
    v_dot2_f32_bf16 v17, v115, v115, v17
    v_dot2_f32_bf16 v16, v116, s4, v16
    v_dot2_f32_bf16 v17, v116, v116, v17
    v_dot2_f32_bf16 v16, v117, s4, v16
    v_dot2_f32_bf16 v17, v117, v117, v17
    v_dot2_f32_bf16 v16, v118, s4, v16
    v_dot2_f32_bf16 v17, v118, v118, v17
    v_dot2_f32_bf16 v16, v119, s4, v16
    v_dot2_f32_bf16 v17, v119, v119, v17
    v_dot2_f32_bf16 v16, v120, s4, v16
    v_dot2_f32_bf16 v17, v120, v120, v17
    v_dot2_f32_bf16 v16, v121, s4, v16
    v_dot2_f32_bf16 v17, v121, v121, v17
    v_dot2_f32_bf16 v16, v122, s4, v16
    v_dot2_f32_bf16 v17, v122, v122, v17
    v_dot2_f32_bf16 v16, v123, s4, v16
    v_dot2_f32_bf16 v17, v123, v123, v17
    v_dot2_f32_bf16 v16, v124, s4, v16
    v_dot2_f32_bf16 v17, v124, v124, v17
    v_dot2_f32_bf16 v16, v125, s4, v16
    v_dot2_f32_bf16 v17, v125, v125, v17
    v_dot2_f32_bf16 v16, v126, s4, v16
    v_dot2_f32_bf16 v17, v126, v126, v17
    v_dot2_f32_bf16 v16, v127, s4, v16
    v_dot2_f32_bf16 v17, v127, v127, v17
    s_nop 3
    v_add_f32_dpp v16, v16, v16 quad_perm:[1,0,3,2] row_mask:0xf bank_mask:0xf
    v_add_f32_dpp v17, v17, v17 quad_perm:[1,0,3,2] row_mask:0xf bank_mask:0xf
    s_nop 0
    v_add_f32_dpp v16, v16, v16 quad_perm:[2,3,0,1] row_mask:0xf bank_mask:0xf
    v_add_f32_dpp v17, v17, v17 quad_perm:[2,3,0,1] row_mask:0xf bank_mask:0xf
    s_nop 0
    v_add_f32_dpp v16, v16, v16 row_half_mirror row_mask:0xf bank_mask:0xf
    v_add_f32_dpp v17, v17, v17 row_half_mirror row_mask:0xf bank_mask:0xf
    v_mul_f32 v16, 0x3b000000, v16
    v_mul_f32 v17, 0x3b000000, v17
    v_fma_f32 v17, -v16, v16, v17
    v_max_f32 v17, 0, v17
    v_cvt_pk_bf16_f32 v14, v16, v17
    v_lshlrev_b32 v16, 16, v14
    v_and_b32 v17, 0xffff0000, v14
    v_add_f32 v17, 0x3727c5ac, v17
    v_cvt_pk_bf16_f32 v14, v17, v17
    v_lshlrev_b32 v17, 16, v14
    v_sqrt_f32 v17, v17
    s_nop 0
    v_cvt_pk_bf16_f32 v14, v17, v17
    v_lshlrev_b32 v17, 16, v14
    v_rcp_f32 v17, v17
    v_lshlrev_b32 v18, 16, v96
    v_and_b32 v19, 0xffff0000, v96
    v_sub_f32 v18, v18, v16
    v_sub_f32 v19, v19, v16
    v_cvt_pk_bf16_f32 v96, v18, v19
    v_lshlrev_b32 v18, 16, v96
    v_and_b32 v19, 0xffff0000, v96
    v_mul_f32 v18, v18, v17
    v_mul_f32 v19, v19, v17
    v_cvt_pk_bf16_f32 v96, v18, v19
    v_lshlrev_b32 v18, 16, v97
    v_and_b32 v19, 0xffff0000, v97
    v_sub_f32 v18, v18, v16
    v_sub_f32 v19, v19, v16
    v_cvt_pk_bf16_f32 v97, v18, v19
    v_lshlrev_b32 v18, 16, v97
    v_and_b32 v19, 0xffff0000, v97
    v_mul_f32 v18, v18, v17
    v_mul_f32 v19, v19, v17
    v_cvt_pk_bf16_f32 v97, v18, v19
    v_lshlrev_b32 v18, 16, v98
    v_and_b32 v19, 0xffff0000, v98
    v_sub_f32 v18, v18, v16
    v_sub_f32 v19, v19, v16
    v_cvt_pk_bf16_f32 v98, v18, v19
    v_lshlrev_b32 v18, 16, v98
    v_and_b32 v19, 0xffff0000, v98
    v_mul_f32 v18, v18, v17
    v_mul_f32 v19, v19, v17
    v_cvt_pk_bf16_f32 v98, v18, v19
    v_lshlrev_b32 v18, 16, v99
    v_and_b32 v19, 0xffff0000, v99
    v_sub_f32 v18, v18, v16
    v_sub_f32 v19, v19, v16
    v_cvt_pk_bf16_f32 v99, v18, v19
    v_lshlrev_b32 v18, 16, v99
    v_and_b32 v19, 0xffff0000, v99
    v_mul_f32 v18, v18, v17
    v_mul_f32 v19, v19, v17
    v_cvt_pk_bf16_f32 v99, v18, v19
    ds_write_b128 v4, v[96:99] offset:0
    v_lshlrev_b32 v18, 16, v100
    v_and_b32 v19, 0xffff0000, v100
    v_sub_f32 v18, v18, v16
    v_sub_f32 v19, v19, v16
    v_cvt_pk_bf16_f32 v100, v18, v19
    v_lshlrev_b32 v18, 16, v100
    v_and_b32 v19, 0xffff0000, v100
    v_mul_f32 v18, v18, v17
    v_mul_f32 v19, v19, v17
    v_cvt_pk_bf16_f32 v100, v18, v19
    v_lshlrev_b32 v18, 16, v101
    v_and_b32 v19, 0xffff0000, v101
    v_sub_f32 v18, v18, v16
    v_sub_f32 v19, v19, v16
    v_cvt_pk_bf16_f32 v101, v18, v19
    v_lshlrev_b32 v18, 16, v101
    v_and_b32 v19, 0xffff0000, v101
    v_mul_f32 v18, v18, v17
    v_mul_f32 v19, v19, v17
    v_cvt_pk_bf16_f32 v101, v18, v19
    v_lshlrev_b32 v18, 16, v102
    v_and_b32 v19, 0xffff0000, v102
    v_sub_f32 v18, v18, v16
    v_sub_f32 v19, v19, v16
    v_cvt_pk_bf16_f32 v102, v18, v19
    v_lshlrev_b32 v18, 16, v102
    v_and_b32 v19, 0xffff0000, v102
    v_mul_f32 v18, v18, v17
    v_mul_f32 v19, v19, v17
    v_cvt_pk_bf16_f32 v102, v18, v19
    v_lshlrev_b32 v18, 16, v103
    v_and_b32 v19, 0xffff0000, v103
    v_sub_f32 v18, v18, v16
    v_sub_f32 v19, v19, v16
    v_cvt_pk_bf16_f32 v103, v18, v19
    v_lshlrev_b32 v18, 16, v103
    v_and_b32 v19, 0xffff0000, v103
    v_mul_f32 v18, v18, v17
    v_mul_f32 v19, v19, v17
    v_cvt_pk_bf16_f32 v103, v18, v19
    ds_write_b128 v4, v[100:103] offset:2048
    v_lshlrev_b32 v18, 16, v104
    v_and_b32 v19, 0xffff0000, v104
    v_sub_f32 v18, v18, v16
    v_sub_f32 v19, v19, v16
    v_cvt_pk_bf16_f32 v104, v18, v19
    v_lshlrev_b32 v18, 16, v104
    v_and_b32 v19, 0xffff0000, v104
    v_mul_f32 v18, v18, v17
    v_mul_f32 v19, v19, v17
    v_cvt_pk_bf16_f32 v104, v18, v19
    v_lshlrev_b32 v18, 16, v105
    v_and_b32 v19, 0xffff0000, v105
    v_sub_f32 v18, v18, v16
    v_sub_f32 v19, v19, v16
    v_cvt_pk_bf16_f32 v105, v18, v19
    v_lshlrev_b32 v18, 16, v105
    v_and_b32 v19, 0xffff0000, v105
    v_mul_f32 v18, v18, v17
    v_mul_f32 v19, v19, v17
    v_cvt_pk_bf16_f32 v105, v18, v19
    v_lshlrev_b32 v18, 16, v106
    v_and_b32 v19, 0xffff0000, v106
    v_sub_f32 v18, v18, v16
    v_sub_f32 v19, v19, v16
    v_cvt_pk_bf16_f32 v106, v18, v19
    v_lshlrev_b32 v18, 16, v106
    v_and_b32 v19, 0xffff0000, v106
    v_mul_f32 v18, v18, v17
    v_mul_f32 v19, v19, v17
    v_cvt_pk_bf16_f32 v106, v18, v19
    v_lshlrev_b32 v18, 16, v107
    v_and_b32 v19, 0xffff0000, v107
    v_sub_f32 v18, v18, v16
    v_sub_f32 v19, v19, v16
    v_cvt_pk_bf16_f32 v107, v18, v19
    v_lshlrev_b32 v18, 16, v107
    v_and_b32 v19, 0xffff0000, v107
    v_mul_f32 v18, v18, v17
    v_mul_f32 v19, v19, v17
    v_cvt_pk_bf16_f32 v107, v18, v19
    ds_write_b128 v4, v[104:107] offset:4096
    v_lshlrev_b32 v18, 16, v108
    v_and_b32 v19, 0xffff0000, v108
    v_sub_f32 v18, v18, v16
    v_sub_f32 v19, v19, v16
    v_cvt_pk_bf16_f32 v108, v18, v19
    v_lshlrev_b32 v18, 16, v108
    v_and_b32 v19, 0xffff0000, v108
    v_mul_f32 v18, v18, v17
    v_mul_f32 v19, v19, v17
    v_cvt_pk_bf16_f32 v108, v18, v19
    v_lshlrev_b32 v18, 16, v109
    v_and_b32 v19, 0xffff0000, v109
    v_sub_f32 v18, v18, v16
    v_sub_f32 v19, v19, v16
    v_cvt_pk_bf16_f32 v109, v18, v19
    v_lshlrev_b32 v18, 16, v109
    v_and_b32 v19, 0xffff0000, v109
    v_mul_f32 v18, v18, v17
    v_mul_f32 v19, v19, v17
    v_cvt_pk_bf16_f32 v109, v18, v19
    v_lshlrev_b32 v18, 16, v110
    v_and_b32 v19, 0xffff0000, v110
    v_sub_f32 v18, v18, v16
    v_sub_f32 v19, v19, v16
    v_cvt_pk_bf16_f32 v110, v18, v19
    v_lshlrev_b32 v18, 16, v110
    v_and_b32 v19, 0xffff0000, v110
    v_mul_f32 v18, v18, v17
    v_mul_f32 v19, v19, v17
    v_cvt_pk_bf16_f32 v110, v18, v19
    v_lshlrev_b32 v18, 16, v111
    v_and_b32 v19, 0xffff0000, v111
    v_sub_f32 v18, v18, v16
    v_sub_f32 v19, v19, v16
    v_cvt_pk_bf16_f32 v111, v18, v19
    v_lshlrev_b32 v18, 16, v111
    v_and_b32 v19, 0xffff0000, v111
    v_mul_f32 v18, v18, v17
    v_mul_f32 v19, v19, v17
    v_cvt_pk_bf16_f32 v111, v18, v19
    ds_write_b128 v4, v[108:111] offset:6144
    v_lshlrev_b32 v18, 16, v112
    v_and_b32 v19, 0xffff0000, v112
    v_sub_f32 v18, v18, v16
    v_sub_f32 v19, v19, v16
    v_cvt_pk_bf16_f32 v112, v18, v19
    v_lshlrev_b32 v18, 16, v112
    v_and_b32 v19, 0xffff0000, v112
    v_mul_f32 v18, v18, v17
    v_mul_f32 v19, v19, v17
    v_cvt_pk_bf16_f32 v112, v18, v19
    v_lshlrev_b32 v18, 16, v113
    v_and_b32 v19, 0xffff0000, v113
    v_sub_f32 v18, v18, v16
    v_sub_f32 v19, v19, v16
    v_cvt_pk_bf16_f32 v113, v18, v19
    v_lshlrev_b32 v18, 16, v113
    v_and_b32 v19, 0xffff0000, v113
    v_mul_f32 v18, v18, v17
    v_mul_f32 v19, v19, v17
    v_cvt_pk_bf16_f32 v113, v18, v19
    v_lshlrev_b32 v18, 16, v114
    v_and_b32 v19, 0xffff0000, v114
    v_sub_f32 v18, v18, v16
    v_sub_f32 v19, v19, v16
    v_cvt_pk_bf16_f32 v114, v18, v19
    v_lshlrev_b32 v18, 16, v114
    v_and_b32 v19, 0xffff0000, v114
    v_mul_f32 v18, v18, v17
    v_mul_f32 v19, v19, v17
    v_cvt_pk_bf16_f32 v114, v18, v19
    v_lshlrev_b32 v18, 16, v115
    v_and_b32 v19, 0xffff0000, v115
    v_sub_f32 v18, v18, v16
    v_sub_f32 v19, v19, v16
    v_cvt_pk_bf16_f32 v115, v18, v19
    v_lshlrev_b32 v18, 16, v115
    v_and_b32 v19, 0xffff0000, v115
    v_mul_f32 v18, v18, v17
    v_mul_f32 v19, v19, v17
    v_cvt_pk_bf16_f32 v115, v18, v19
    ds_write_b128 v4, v[112:115] offset:8192
    v_lshlrev_b32 v18, 16, v116
    v_and_b32 v19, 0xffff0000, v116
    v_sub_f32 v18, v18, v16
    v_sub_f32 v19, v19, v16
    v_cvt_pk_bf16_f32 v116, v18, v19
    v_lshlrev_b32 v18, 16, v116
    v_and_b32 v19, 0xffff0000, v116
    v_mul_f32 v18, v18, v17
    v_mul_f32 v19, v19, v17
    v_cvt_pk_bf16_f32 v116, v18, v19
    v_lshlrev_b32 v18, 16, v117
    v_and_b32 v19, 0xffff0000, v117
    v_sub_f32 v18, v18, v16
    v_sub_f32 v19, v19, v16
    v_cvt_pk_bf16_f32 v117, v18, v19
    v_lshlrev_b32 v18, 16, v117
    v_and_b32 v19, 0xffff0000, v117
    v_mul_f32 v18, v18, v17
    v_mul_f32 v19, v19, v17
    v_cvt_pk_bf16_f32 v117, v18, v19
    v_lshlrev_b32 v18, 16, v118
    v_and_b32 v19, 0xffff0000, v118
    v_sub_f32 v18, v18, v16
    v_sub_f32 v19, v19, v16
    v_cvt_pk_bf16_f32 v118, v18, v19
    v_lshlrev_b32 v18, 16, v118
    v_and_b32 v19, 0xffff0000, v118
    v_mul_f32 v18, v18, v17
    v_mul_f32 v19, v19, v17
    v_cvt_pk_bf16_f32 v118, v18, v19
    v_lshlrev_b32 v18, 16, v119
    v_and_b32 v19, 0xffff0000, v119
    v_sub_f32 v18, v18, v16
    v_sub_f32 v19, v19, v16
    v_cvt_pk_bf16_f32 v119, v18, v19
    v_lshlrev_b32 v18, 16, v119
    v_and_b32 v19, 0xffff0000, v119
    v_mul_f32 v18, v18, v17
    v_mul_f32 v19, v19, v17
    v_cvt_pk_bf16_f32 v119, v18, v19
    ds_write_b128 v4, v[116:119] offset:10240
    v_lshlrev_b32 v18, 16, v120
    v_and_b32 v19, 0xffff0000, v120
    v_sub_f32 v18, v18, v16
    v_sub_f32 v19, v19, v16
    v_cvt_pk_bf16_f32 v120, v18, v19
    v_lshlrev_b32 v18, 16, v120
    v_and_b32 v19, 0xffff0000, v120
    v_mul_f32 v18, v18, v17
    v_mul_f32 v19, v19, v17
    v_cvt_pk_bf16_f32 v120, v18, v19
    v_lshlrev_b32 v18, 16, v121
    v_and_b32 v19, 0xffff0000, v121
    v_sub_f32 v18, v18, v16
    v_sub_f32 v19, v19, v16
    v_cvt_pk_bf16_f32 v121, v18, v19
    v_lshlrev_b32 v18, 16, v121
    v_and_b32 v19, 0xffff0000, v121
    v_mul_f32 v18, v18, v17
    v_mul_f32 v19, v19, v17
    v_cvt_pk_bf16_f32 v121, v18, v19
    v_lshlrev_b32 v18, 16, v122
    v_and_b32 v19, 0xffff0000, v122
    v_sub_f32 v18, v18, v16
    v_sub_f32 v19, v19, v16
    v_cvt_pk_bf16_f32 v122, v18, v19
    v_lshlrev_b32 v18, 16, v122
    v_and_b32 v19, 0xffff0000, v122
    v_mul_f32 v18, v18, v17
    v_mul_f32 v19, v19, v17
    v_cvt_pk_bf16_f32 v122, v18, v19
    v_lshlrev_b32 v18, 16, v123
    v_and_b32 v19, 0xffff0000, v123
    v_sub_f32 v18, v18, v16
    v_sub_f32 v19, v19, v16
    v_cvt_pk_bf16_f32 v123, v18, v19
    v_lshlrev_b32 v18, 16, v123
    v_and_b32 v19, 0xffff0000, v123
    v_mul_f32 v18, v18, v17
    v_mul_f32 v19, v19, v17
    v_cvt_pk_bf16_f32 v123, v18, v19
    ds_write_b128 v4, v[120:123] offset:12288
    v_lshlrev_b32 v18, 16, v124
    v_and_b32 v19, 0xffff0000, v124
    v_sub_f32 v18, v18, v16
    v_sub_f32 v19, v19, v16
    v_cvt_pk_bf16_f32 v124, v18, v19
    v_lshlrev_b32 v18, 16, v124
    v_and_b32 v19, 0xffff0000, v124
    v_mul_f32 v18, v18, v17
    v_mul_f32 v19, v19, v17
    v_cvt_pk_bf16_f32 v124, v18, v19
    v_lshlrev_b32 v18, 16, v125
    v_and_b32 v19, 0xffff0000, v125
    v_sub_f32 v18, v18, v16
    v_sub_f32 v19, v19, v16
    v_cvt_pk_bf16_f32 v125, v18, v19
    v_lshlrev_b32 v18, 16, v125
    v_and_b32 v19, 0xffff0000, v125
    v_mul_f32 v18, v18, v17
    v_mul_f32 v19, v19, v17
    v_cvt_pk_bf16_f32 v125, v18, v19
    v_lshlrev_b32 v18, 16, v126
    v_and_b32 v19, 0xffff0000, v126
    v_sub_f32 v18, v18, v16
    v_sub_f32 v19, v19, v16
    v_cvt_pk_bf16_f32 v126, v18, v19
    v_lshlrev_b32 v18, 16, v126
    v_and_b32 v19, 0xffff0000, v126
    v_mul_f32 v18, v18, v17
    v_mul_f32 v19, v19, v17
    v_cvt_pk_bf16_f32 v126, v18, v19
    v_lshlrev_b32 v18, 16, v127
    v_and_b32 v19, 0xffff0000, v127
    v_sub_f32 v18, v18, v16
    v_sub_f32 v19, v19, v16
    v_cvt_pk_bf16_f32 v127, v18, v19
    v_lshlrev_b32 v18, 16, v127
    v_and_b32 v19, 0xffff0000, v127
    v_mul_f32 v18, v18, v17
    v_mul_f32 v19, v19, v17
    v_cvt_pk_bf16_f32 v127, v18, v19
    ds_write_b128 v4, v[124:127] offset:14336
    s_waitcnt vmcnt(0) lgkmcnt(0)
    s_barrier
    v_cmp_ne_u32 vcc, 0, v0
    v_mov_b32 v15, 0x40000000
    v_mov_b32 v14, 1
    v_cndmask_b32 v15, v0, v15, vcc
    buffer_store_dword v14, v15, s[8:11], s25 offen sc1
    s_add_u32 s24, s23, 6
    s_min_u32 s24, s24, 63
    s_lshl_b32 s36, s24, 15
    buffer_load_dwordx4 v[96:99], v3, s[12:15], s36 offen offset:0
    buffer_load_dwordx4 v[100:103], v3, s[12:15], s36 offen offset:128
    buffer_load_dwordx4 v[104:107], v3, s[12:15], s36 offen offset:256
    buffer_load_dwordx4 v[108:111], v3, s[12:15], s36 offen offset:384
    buffer_load_dwordx4 v[112:115], v3, s[12:15], s36 offen offset:512
    buffer_load_dwordx4 v[116:119], v3, s[12:15], s36 offen offset:640
    buffer_load_dwordx4 v[120:123], v3, s[12:15], s36 offen offset:768
    buffer_load_dwordx4 v[124:127], v3, s[12:15], s36 offen offset:896
    ds_read_b128 v[64:67], v80 offset:0
    ds_read_b128 v[68:71], v81 offset:0
    ds_read_b128 v[72:75], v82 offset:1024
    ds_read_b128 v[76:79], v83 offset:1024
    s_waitcnt lgkmcnt(2)
    v_mfma_f32_16x16x32_bf16 v[32:35], a[128:131], v[64:67], 0
    v_mfma_f32_16x16x32_bf16 v[36:39], a[128:131], v[68:71], 0
    v_mfma_f32_16x16x32_bf16 v[40:43], a[132:135], v[64:67], 0
    v_mfma_f32_16x16x32_bf16 v[44:47], a[132:135], v[68:71], 0
    v_mfma_f32_16x16x32_bf16 v[48:51], v[64:67], v[128:131], 0
    v_mfma_f32_16x16x32_bf16 v[56:59], v[68:71], v[128:131], 0
    v_mfma_f32_16x16x32_bf16 v[52:55], v[64:67], v[132:135], 0
    v_mfma_f32_16x16x32_bf16 v[60:63], v[68:71], v[132:135], 0
    v_mfma_f32_16x16x32_bf16 v[16:19], a[0:3], v[64:67], 0
    v_mfma_f32_16x16x32_bf16 v[20:23], a[0:3], v[68:71], 0
    v_mfma_f32_16x16x32_bf16 v[24:27], a[4:7], v[64:67], 0
    v_mfma_f32_16x16x32_bf16 v[28:31], a[4:7], v[68:71], 0
    ds_read_b128 v[64:67], v80 offset:2048
    ds_read_b128 v[68:71], v81 offset:2048
    s_waitcnt lgkmcnt(2)
    v_mfma_f32_16x16x32_bf16 v[32:35], a[136:139], v[72:75], v[32:35]
    v_mfma_f32_16x16x32_bf16 v[36:39], a[136:139], v[76:79], v[36:39]
    v_mfma_f32_16x16x32_bf16 v[40:43], a[140:143], v[72:75], v[40:43]
    v_mfma_f32_16x16x32_bf16 v[44:47], a[140:143], v[76:79], v[44:47]
    v_mfma_f32_16x16x32_bf16 v[48:51], v[72:75], v[136:139], v[48:51]
    v_mfma_f32_16x16x32_bf16 v[56:59], v[76:79], v[136:139], v[56:59]
    v_mfma_f32_16x16x32_bf16 v[52:55], v[72:75], v[140:143], v[52:55]
    v_mfma_f32_16x16x32_bf16 v[60:63], v[76:79], v[140:143], v[60:63]
    v_mfma_f32_16x16x32_bf16 v[16:19], a[8:11], v[72:75], v[16:19]
    v_mfma_f32_16x16x32_bf16 v[20:23], a[8:11], v[76:79], v[20:23]
    v_mfma_f32_16x16x32_bf16 v[24:27], a[12:15], v[72:75], v[24:27]
    v_mfma_f32_16x16x32_bf16 v[28:31], a[12:15], v[76:79], v[28:31]
    ds_read_b128 v[72:75], v82 offset:3072
    ds_read_b128 v[76:79], v83 offset:3072
    s_waitcnt lgkmcnt(2)
    v_mfma_f32_16x16x32_bf16 v[32:35], a[144:147], v[64:67], v[32:35]
    v_mfma_f32_16x16x32_bf16 v[36:39], a[144:147], v[68:71], v[36:39]
    v_mfma_f32_16x16x32_bf16 v[40:43], a[148:151], v[64:67], v[40:43]
    v_mfma_f32_16x16x32_bf16 v[44:47], a[148:151], v[68:71], v[44:47]
    v_mfma_f32_16x16x32_bf16 v[48:51], v[64:67], v[144:147], v[48:51]
    v_mfma_f32_16x16x32_bf16 v[56:59], v[68:71], v[144:147], v[56:59]
    v_mfma_f32_16x16x32_bf16 v[52:55], v[64:67], v[148:151], v[52:55]
    v_mfma_f32_16x16x32_bf16 v[60:63], v[68:71], v[148:151], v[60:63]
    v_mfma_f32_16x16x32_bf16 v[16:19], a[16:19], v[64:67], v[16:19]
    v_mfma_f32_16x16x32_bf16 v[20:23], a[16:19], v[68:71], v[20:23]
    v_mfma_f32_16x16x32_bf16 v[24:27], a[20:23], v[64:67], v[24:27]
    v_mfma_f32_16x16x32_bf16 v[28:31], a[20:23], v[68:71], v[28:31]
    ds_read_b128 v[64:67], v80 offset:4096
    ds_read_b128 v[68:71], v81 offset:4096
    s_waitcnt lgkmcnt(2)
    v_mfma_f32_16x16x32_bf16 v[32:35], a[152:155], v[72:75], v[32:35]
    v_mfma_f32_16x16x32_bf16 v[36:39], a[152:155], v[76:79], v[36:39]
    v_mfma_f32_16x16x32_bf16 v[40:43], a[156:159], v[72:75], v[40:43]
    v_mfma_f32_16x16x32_bf16 v[44:47], a[156:159], v[76:79], v[44:47]
    v_mfma_f32_16x16x32_bf16 v[48:51], v[72:75], v[152:155], v[48:51]
    v_mfma_f32_16x16x32_bf16 v[56:59], v[76:79], v[152:155], v[56:59]
    v_mfma_f32_16x16x32_bf16 v[52:55], v[72:75], v[156:159], v[52:55]
    v_mfma_f32_16x16x32_bf16 v[60:63], v[76:79], v[156:159], v[60:63]
    v_mfma_f32_16x16x32_bf16 v[16:19], a[24:27], v[72:75], v[16:19]
    v_mfma_f32_16x16x32_bf16 v[20:23], a[24:27], v[76:79], v[20:23]
    v_mfma_f32_16x16x32_bf16 v[24:27], a[28:31], v[72:75], v[24:27]
    v_mfma_f32_16x16x32_bf16 v[28:31], a[28:31], v[76:79], v[28:31]
    ds_read_b128 v[72:75], v82 offset:5120
    ds_read_b128 v[76:79], v83 offset:5120
    s_waitcnt lgkmcnt(2)
    v_mfma_f32_16x16x32_bf16 v[32:35], a[160:163], v[64:67], v[32:35]
    v_mfma_f32_16x16x32_bf16 v[36:39], a[160:163], v[68:71], v[36:39]
    v_mfma_f32_16x16x32_bf16 v[40:43], a[164:167], v[64:67], v[40:43]
    v_mfma_f32_16x16x32_bf16 v[44:47], a[164:167], v[68:71], v[44:47]
    v_mfma_f32_16x16x32_bf16 v[48:51], v[64:67], v[160:163], v[48:51]
    v_mfma_f32_16x16x32_bf16 v[56:59], v[68:71], v[160:163], v[56:59]
    v_mfma_f32_16x16x32_bf16 v[52:55], v[64:67], v[164:167], v[52:55]
    v_mfma_f32_16x16x32_bf16 v[60:63], v[68:71], v[164:167], v[60:63]
    v_mfma_f32_16x16x32_bf16 v[16:19], a[32:35], v[64:67], v[16:19]
    v_mfma_f32_16x16x32_bf16 v[20:23], a[32:35], v[68:71], v[20:23]
    v_mfma_f32_16x16x32_bf16 v[24:27], a[36:39], v[64:67], v[24:27]
    v_mfma_f32_16x16x32_bf16 v[28:31], a[36:39], v[68:71], v[28:31]
    ds_read_b128 v[64:67], v80 offset:6144
    ds_read_b128 v[68:71], v81 offset:6144
    s_waitcnt lgkmcnt(2)
    v_mfma_f32_16x16x32_bf16 v[32:35], a[168:171], v[72:75], v[32:35]
    v_mfma_f32_16x16x32_bf16 v[36:39], a[168:171], v[76:79], v[36:39]
    v_mfma_f32_16x16x32_bf16 v[40:43], a[172:175], v[72:75], v[40:43]
    v_mfma_f32_16x16x32_bf16 v[44:47], a[172:175], v[76:79], v[44:47]
    v_mfma_f32_16x16x32_bf16 v[48:51], v[72:75], v[168:171], v[48:51]
    v_mfma_f32_16x16x32_bf16 v[56:59], v[76:79], v[168:171], v[56:59]
    v_mfma_f32_16x16x32_bf16 v[52:55], v[72:75], v[172:175], v[52:55]
    v_mfma_f32_16x16x32_bf16 v[60:63], v[76:79], v[172:175], v[60:63]
    v_mfma_f32_16x16x32_bf16 v[16:19], a[40:43], v[72:75], v[16:19]
    v_mfma_f32_16x16x32_bf16 v[20:23], a[40:43], v[76:79], v[20:23]
    v_mfma_f32_16x16x32_bf16 v[24:27], a[44:47], v[72:75], v[24:27]
    v_mfma_f32_16x16x32_bf16 v[28:31], a[44:47], v[76:79], v[28:31]
    ds_read_b128 v[72:75], v82 offset:7168
    ds_read_b128 v[76:79], v83 offset:7168
    s_waitcnt lgkmcnt(2)
    v_mfma_f32_16x16x32_bf16 v[32:35], a[176:179], v[64:67], v[32:35]
    v_mfma_f32_16x16x32_bf16 v[36:39], a[176:179], v[68:71], v[36:39]
    v_mfma_f32_16x16x32_bf16 v[40:43], a[180:183], v[64:67], v[40:43]
    v_mfma_f32_16x16x32_bf16 v[44:47], a[180:183], v[68:71], v[44:47]
    v_mfma_f32_16x16x32_bf16 v[48:51], v[64:67], v[176:179], v[48:51]
    v_mfma_f32_16x16x32_bf16 v[56:59], v[68:71], v[176:179], v[56:59]
    v_mfma_f32_16x16x32_bf16 v[52:55], v[64:67], v[180:183], v[52:55]
    v_mfma_f32_16x16x32_bf16 v[60:63], v[68:71], v[180:183], v[60:63]
    v_mfma_f32_16x16x32_bf16 v[16:19], a[48:51], v[64:67], v[16:19]
    v_mfma_f32_16x16x32_bf16 v[20:23], a[48:51], v[68:71], v[20:23]
    v_mfma_f32_16x16x32_bf16 v[24:27], a[52:55], v[64:67], v[24:27]
    v_mfma_f32_16x16x32_bf16 v[28:31], a[52:55], v[68:71], v[28:31]
    ds_read_b128 v[64:67], v80 offset:8192
    ds_read_b128 v[68:71], v81 offset:8192
    s_waitcnt lgkmcnt(2)
    v_mfma_f32_16x16x32_bf16 v[32:35], a[184:187], v[72:75], v[32:35]
    v_mfma_f32_16x16x32_bf16 v[36:39], a[184:187], v[76:79], v[36:39]
    v_mfma_f32_16x16x32_bf16 v[40:43], a[188:191], v[72:75], v[40:43]
    v_mfma_f32_16x16x32_bf16 v[44:47], a[188:191], v[76:79], v[44:47]
    v_mfma_f32_16x16x32_bf16 v[48:51], v[72:75], v[184:187], v[48:51]
    v_mfma_f32_16x16x32_bf16 v[56:59], v[76:79], v[184:187], v[56:59]
    v_mfma_f32_16x16x32_bf16 v[52:55], v[72:75], v[188:191], v[52:55]
    v_mfma_f32_16x16x32_bf16 v[60:63], v[76:79], v[188:191], v[60:63]
    v_mfma_f32_16x16x32_bf16 v[16:19], a[56:59], v[72:75], v[16:19]
    v_mfma_f32_16x16x32_bf16 v[20:23], a[56:59], v[76:79], v[20:23]
    v_mfma_f32_16x16x32_bf16 v[24:27], a[60:63], v[72:75], v[24:27]
    v_mfma_f32_16x16x32_bf16 v[28:31], a[60:63], v[76:79], v[28:31]
    ds_read_b128 v[72:75], v82 offset:9216
    ds_read_b128 v[76:79], v83 offset:9216
    s_waitcnt lgkmcnt(2)
    v_mfma_f32_16x16x32_bf16 v[32:35], a[192:195], v[64:67], v[32:35]
    v_mfma_f32_16x16x32_bf16 v[36:39], a[192:195], v[68:71], v[36:39]
    v_mfma_f32_16x16x32_bf16 v[40:43], a[196:199], v[64:67], v[40:43]
    v_mfma_f32_16x16x32_bf16 v[44:47], a[196:199], v[68:71], v[44:47]
    v_mfma_f32_16x16x32_bf16 v[48:51], v[64:67], v[192:195], v[48:51]
    v_mfma_f32_16x16x32_bf16 v[56:59], v[68:71], v[192:195], v[56:59]
    v_mfma_f32_16x16x32_bf16 v[52:55], v[64:67], v[196:199], v[52:55]
    v_mfma_f32_16x16x32_bf16 v[60:63], v[68:71], v[196:199], v[60:63]
    v_mfma_f32_16x16x32_bf16 v[16:19], a[64:67], v[64:67], v[16:19]
    v_mfma_f32_16x16x32_bf16 v[20:23], a[64:67], v[68:71], v[20:23]
    v_mfma_f32_16x16x32_bf16 v[24:27], a[68:71], v[64:67], v[24:27]
    v_mfma_f32_16x16x32_bf16 v[28:31], a[68:71], v[68:71], v[28:31]
    ds_read_b128 v[64:67], v80 offset:10240
    ds_read_b128 v[68:71], v81 offset:10240
    s_waitcnt lgkmcnt(2)
    v_mfma_f32_16x16x32_bf16 v[32:35], a[200:203], v[72:75], v[32:35]
    v_mfma_f32_16x16x32_bf16 v[36:39], a[200:203], v[76:79], v[36:39]
    v_mfma_f32_16x16x32_bf16 v[40:43], a[204:207], v[72:75], v[40:43]
    v_mfma_f32_16x16x32_bf16 v[44:47], a[204:207], v[76:79], v[44:47]
    v_mfma_f32_16x16x32_bf16 v[48:51], v[72:75], v[200:203], v[48:51]
    v_mfma_f32_16x16x32_bf16 v[56:59], v[76:79], v[200:203], v[56:59]
    v_mfma_f32_16x16x32_bf16 v[52:55], v[72:75], v[204:207], v[52:55]
    v_mfma_f32_16x16x32_bf16 v[60:63], v[76:79], v[204:207], v[60:63]
    v_mfma_f32_16x16x32_bf16 v[16:19], a[72:75], v[72:75], v[16:19]
    v_mfma_f32_16x16x32_bf16 v[20:23], a[72:75], v[76:79], v[20:23]
    v_mfma_f32_16x16x32_bf16 v[24:27], a[76:79], v[72:75], v[24:27]
    v_mfma_f32_16x16x32_bf16 v[28:31], a[76:79], v[76:79], v[28:31]
    ds_read_b128 v[72:75], v82 offset:11264
    ds_read_b128 v[76:79], v83 offset:11264
    s_waitcnt lgkmcnt(2)
    v_mfma_f32_16x16x32_bf16 v[32:35], a[208:211], v[64:67], v[32:35]
    v_mfma_f32_16x16x32_bf16 v[36:39], a[208:211], v[68:71], v[36:39]
    v_mfma_f32_16x16x32_bf16 v[40:43], a[212:215], v[64:67], v[40:43]
    v_mfma_f32_16x16x32_bf16 v[44:47], a[212:215], v[68:71], v[44:47]
    v_mfma_f32_16x16x32_bf16 v[48:51], v[64:67], v[208:211], v[48:51]
    v_mfma_f32_16x16x32_bf16 v[56:59], v[68:71], v[208:211], v[56:59]
    v_mfma_f32_16x16x32_bf16 v[52:55], v[64:67], v[212:215], v[52:55]
    v_mfma_f32_16x16x32_bf16 v[60:63], v[68:71], v[212:215], v[60:63]
    v_mfma_f32_16x16x32_bf16 v[16:19], a[80:83], v[64:67], v[16:19]
    v_mfma_f32_16x16x32_bf16 v[20:23], a[80:83], v[68:71], v[20:23]
    v_mfma_f32_16x16x32_bf16 v[24:27], a[84:87], v[64:67], v[24:27]
    v_mfma_f32_16x16x32_bf16 v[28:31], a[84:87], v[68:71], v[28:31]
    ds_read_b128 v[64:67], v80 offset:12288
    ds_read_b128 v[68:71], v81 offset:12288
    s_waitcnt lgkmcnt(2)
    v_mfma_f32_16x16x32_bf16 v[32:35], a[216:219], v[72:75], v[32:35]
    v_mfma_f32_16x16x32_bf16 v[36:39], a[216:219], v[76:79], v[36:39]
    v_mfma_f32_16x16x32_bf16 v[40:43], a[220:223], v[72:75], v[40:43]
    v_mfma_f32_16x16x32_bf16 v[44:47], a[220:223], v[76:79], v[44:47]
    v_mfma_f32_16x16x32_bf16 v[48:51], v[72:75], v[216:219], v[48:51]
    v_mfma_f32_16x16x32_bf16 v[56:59], v[76:79], v[216:219], v[56:59]
    v_mfma_f32_16x16x32_bf16 v[52:55], v[72:75], v[220:223], v[52:55]
    v_mfma_f32_16x16x32_bf16 v[60:63], v[76:79], v[220:223], v[60:63]
    v_mfma_f32_16x16x32_bf16 v[16:19], a[88:91], v[72:75], v[16:19]
    v_mfma_f32_16x16x32_bf16 v[20:23], a[88:91], v[76:79], v[20:23]
    v_mfma_f32_16x16x32_bf16 v[24:27], a[92:95], v[72:75], v[24:27]
    v_mfma_f32_16x16x32_bf16 v[28:31], a[92:95], v[76:79], v[28:31]
    ds_read_b128 v[72:75], v82 offset:13312
    ds_read_b128 v[76:79], v83 offset:13312
    s_waitcnt lgkmcnt(2)
    v_mfma_f32_16x16x32_bf16 v[32:35], a[224:227], v[64:67], v[32:35]
    v_mfma_f32_16x16x32_bf16 v[36:39], a[224:227], v[68:71], v[36:39]
    v_mfma_f32_16x16x32_bf16 v[40:43], a[228:231], v[64:67], v[40:43]
    v_mfma_f32_16x16x32_bf16 v[44:47], a[228:231], v[68:71], v[44:47]
    v_mfma_f32_16x16x32_bf16 v[48:51], v[64:67], v[224:227], v[48:51]
    v_mfma_f32_16x16x32_bf16 v[56:59], v[68:71], v[224:227], v[56:59]
    v_mfma_f32_16x16x32_bf16 v[52:55], v[64:67], v[228:231], v[52:55]
    v_mfma_f32_16x16x32_bf16 v[60:63], v[68:71], v[228:231], v[60:63]
    v_mfma_f32_16x16x32_bf16 v[16:19], a[96:99], v[64:67], v[16:19]
    v_mfma_f32_16x16x32_bf16 v[20:23], a[96:99], v[68:71], v[20:23]
    v_mfma_f32_16x16x32_bf16 v[24:27], a[100:103], v[64:67], v[24:27]
    v_mfma_f32_16x16x32_bf16 v[28:31], a[100:103], v[68:71], v[28:31]
    ds_read_b128 v[64:67], v80 offset:14336
    ds_read_b128 v[68:71], v81 offset:14336
    s_waitcnt lgkmcnt(2)
    v_mfma_f32_16x16x32_bf16 v[32:35], a[232:235], v[72:75], v[32:35]
    v_mfma_f32_16x16x32_bf16 v[36:39], a[232:235], v[76:79], v[36:39]
    v_mfma_f32_16x16x32_bf16 v[40:43], a[236:239], v[72:75], v[40:43]
    v_mfma_f32_16x16x32_bf16 v[44:47], a[236:239], v[76:79], v[44:47]
    v_mfma_f32_16x16x32_bf16 v[48:51], v[72:75], v[232:235], v[48:51]
    v_mfma_f32_16x16x32_bf16 v[56:59], v[76:79], v[232:235], v[56:59]
    v_mfma_f32_16x16x32_bf16 v[52:55], v[72:75], v[236:239], v[52:55]
    v_mfma_f32_16x16x32_bf16 v[60:63], v[76:79], v[236:239], v[60:63]
    v_mfma_f32_16x16x32_bf16 v[16:19], a[104:107], v[72:75], v[16:19]
    v_mfma_f32_16x16x32_bf16 v[20:23], a[104:107], v[76:79], v[20:23]
    v_mfma_f32_16x16x32_bf16 v[24:27], a[108:111], v[72:75], v[24:27]
    v_mfma_f32_16x16x32_bf16 v[28:31], a[108:111], v[76:79], v[28:31]
    ds_read_b128 v[72:75], v82 offset:15360
    ds_read_b128 v[76:79], v83 offset:15360
    s_waitcnt lgkmcnt(2)
    v_mfma_f32_16x16x32_bf16 v[32:35], a[240:243], v[64:67], v[32:35]
    v_mfma_f32_16x16x32_bf16 v[36:39], a[240:243], v[68:71], v[36:39]
    v_mfma_f32_16x16x32_bf16 v[40:43], a[244:247], v[64:67], v[40:43]
    v_mfma_f32_16x16x32_bf16 v[44:47], a[244:247], v[68:71], v[44:47]
    v_mfma_f32_16x16x32_bf16 v[48:51], v[64:67], v[240:243], v[48:51]
    v_mfma_f32_16x16x32_bf16 v[56:59], v[68:71], v[240:243], v[56:59]
    v_mfma_f32_16x16x32_bf16 v[52:55], v[64:67], v[244:247], v[52:55]
    v_mfma_f32_16x16x32_bf16 v[60:63], v[68:71], v[244:247], v[60:63]
    v_mfma_f32_16x16x32_bf16 v[16:19], a[112:115], v[64:67], v[16:19]
    v_mfma_f32_16x16x32_bf16 v[20:23], a[112:115], v[68:71], v[20:23]
    v_mfma_f32_16x16x32_bf16 v[24:27], a[116:119], v[64:67], v[24:27]
    v_mfma_f32_16x16x32_bf16 v[28:31], a[116:119], v[68:71], v[28:31]
    s_waitcnt lgkmcnt(0)
    v_mfma_f32_16x16x32_bf16 v[32:35], a[248:251], v[72:75], v[32:35]
    v_mfma_f32_16x16x32_bf16 v[36:39], a[248:251], v[76:79], v[36:39]
    v_mfma_f32_16x16x32_bf16 v[40:43], a[252:255], v[72:75], v[40:43]
    v_mfma_f32_16x16x32_bf16 v[44:47], a[252:255], v[76:79], v[44:47]
    v_mfma_f32_16x16x32_bf16 v[48:51], v[72:75], v[248:251], v[48:51]
    v_mfma_f32_16x16x32_bf16 v[56:59], v[76:79], v[248:251], v[56:59]
    v_mfma_f32_16x16x32_bf16 v[52:55], v[72:75], v[252:255], v[52:55]
    v_mfma_f32_16x16x32_bf16 v[60:63], v[76:79], v[252:255], v[60:63]
    v_mfma_f32_16x16x32_bf16 v[16:19], a[120:123], v[72:75], v[16:19]
    v_mfma_f32_16x16x32_bf16 v[20:23], a[120:123], v[76:79], v[20:23]
    v_mfma_f32_16x16x32_bf16 v[24:27], a[124:127], v[72:75], v[24:27]
    v_mfma_f32_16x16x32_bf16 v[28:31], a[124:127], v[76:79], v[28:31]
    s_barrier
    v_mul_f32 v32, s33, v32
    v_mul_f32 v33, s33, v33
    v_mul_f32 v34, s33, v34
    v_mul_f32 v35, s33, v35
    v_mul_f32 v36, s33, v36
    v_mul_f32 v37, s33, v37
    v_mul_f32 v38, s33, v38
    v_mul_f32 v39, s33, v39
    v_mul_f32 v40, s33, v40
    v_mul_f32 v41, s33, v41
    v_mul_f32 v42, s33, v42
    v_mul_f32 v43, s33, v43
    v_mul_f32 v44, s33, v44
    v_mul_f32 v45, s33, v45
    v_mul_f32 v46, s33, v46
    v_mul_f32 v47, s33, v47
    v_cvt_pk_bf16_f32 v64, v32, v40
    v_cvt_pk_bf16_f32 v65, v33, v41
    v_cvt_pk_bf16_f32 v66, v34, v42
    v_cvt_pk_bf16_f32 v67, v35, v43
    v_cvt_pk_bf16_f32 v68, v36, v44
    v_cvt_pk_bf16_f32 v69, v37, v45
    v_cvt_pk_bf16_f32 v70, v38, v46
    v_cvt_pk_bf16_f32 v71, v39, v47
    v_cvt_pk_bf16_f32 v72, v48, v49
    v_cvt_pk_bf16_f32 v73, v50, v51
    v_cvt_pk_bf16_f32 v74, v56, v57
    v_cvt_pk_bf16_f32 v75, v58, v59
    v_cvt_pk_bf16_f32 v76, v52, v53
    v_cvt_pk_bf16_f32 v77, v54, v55
    v_cvt_pk_bf16_f32 v78, v60, v61
    v_cvt_pk_bf16_f32 v79, v62, v63
    v_cvt_pk_bf16_f32 v84, v16, v24
    v_cvt_pk_bf16_f32 v85, v17, v25
    v_cvt_pk_bf16_f32 v86, v18, v26
    v_cvt_pk_bf16_f32 v87, v19, v27
    v_cvt_pk_bf16_f32 v88, v20, v28
    v_cvt_pk_bf16_f32 v89, v21, v29
    v_cvt_pk_bf16_f32 v90, v22, v30
    v_cvt_pk_bf16_f32 v91, v23, v31
    s_mul_i32 s24, s23, 0x82000
    s_lshl_b32 s36, s20, 14
    s_add_u32 s24, s24, s36
    s_add_u32 s24, s24, 0x1000000
    s_lshr_b32 s36, s21, 1
    s_lshl_b32 s36, s36, 12
    s_xor_b32 s37, s36, 4096
    s_add_u32 s36, s36, s24
    s_add_u32 s37, s37, s24
    buffer_store_dwordx4 v[64:67], v9, s[8:11], s36 offen sc1
    buffer_store_dwordx4 v[68:71], v9, s[8:11], s37 offen sc1
    s_add_u32 s24, s24, 8192
    buffer_store_dwordx4 v[72:75], v2, s[8:11], s24 offen sc1
    buffer_store_dwordx4 v[76:79], v2, s[8:11], s24 offen offset:1024 sc1
    s_add_u32 s36, s36, 0x7000000
    s_add_u32 s37, s37, 0x7000000
    buffer_store_dwordx4 v[84:87], v9, s[8:11], s36 offen sc1
    buffer_store_dwordx4 v[88:91], v9, s[8:11], s37 offen sc1
    s_lshl_b32 s25, s20, 8
    s_lshl_b32 s36, s23, 2
    s_add_u32 s25, s25, s36
    s_add_u32 s25, s25, 0x190000
    s_cmp_ge_u32 s23, 6
    s_cbranch_scc1 L_P1_defer
    s_waitcnt vmcnt(0)
    s_barrier
    v_cmp_ne_u32 vcc, 0, v0
    v_mov_b32 v15, 0x40000000
    v_mov_b32 v14, 1
    v_cndmask_b32 v15, v0, v15, vcc
    buffer_store_dword v14, v15, s[8:11], s25 offen sc1
L_P1_defer:
    s_add_u32 s23, s23, 6
    s_cmp_lt_u32 s23, 64
    s_cbranch_scc1 L_P1
    v_mov_b32 v20, -1
    v_mov_b32 v21, -1
    v_mov_b32 v22, -1
    v_mov_b32 v23, -1
    s_lshl_b32 s24, s22, 21
    s_lshl_b32 s36, s20, 15
    s_add_u32 s24, s24, s36
    s_add_u32 s36, s24, 0x4000000
    buffer_store_dwordx4 v[20:23], v11, s[8:11], s36 offen sc1
    s_add_u32 s36, s24, 0x4001000
    buffer_store_dwordx4 v[20:23], v11, s[8:11], s36 offen sc1
    s_add_u32 s36, s24, 0x4002000
    buffer_store_dwordx4 v[20:23], v11, s[8:11], s36 offen sc1
    s_add_u32 s36, s24, 0x4003000
    buffer_store_dwordx4 v[20:23], v11, s[8:11], s36 offen sc1
    s_add_u32 s36, s24, 0x4004000
    buffer_store_dwordx4 v[20:23], v11, s[8:11], s36 offen sc1
    s_add_u32 s36, s24, 0x4005000
    buffer_store_dwordx4 v[20:23], v11, s[8:11], s36 offen sc1
    s_add_u32 s36, s24, 0x4006000
    buffer_store_dwordx4 v[20:23], v11, s[8:11], s36 offen sc1
    s_add_u32 s36, s24, 0x4007000
    buffer_store_dwordx4 v[20:23], v11, s[8:11], s36 offen sc1
    s_add_u32 s36, s24, 0x4100000
    buffer_store_dwordx4 v[20:23], v11, s[8:11], s36 offen sc1
    s_add_u32 s36, s24, 0x4101000
    buffer_store_dwordx4 v[20:23], v11, s[8:11], s36 offen sc1
    s_add_u32 s36, s24, 0x4102000
    buffer_store_dwordx4 v[20:23], v11, s[8:11], s36 offen sc1
    s_add_u32 s36, s24, 0x4103000
    buffer_store_dwordx4 v[20:23], v11, s[8:11], s36 offen sc1
    s_add_u32 s36, s24, 0x4104000
    buffer_store_dwordx4 v[20:23], v11, s[8:11], s36 offen sc1
    s_add_u32 s36, s24, 0x4105000
    buffer_store_dwordx4 v[20:23], v11, s[8:11], s36 offen sc1
    s_add_u32 s36, s24, 0x4106000
    buffer_store_dwordx4 v[20:23], v11, s[8:11], s36 offen sc1
    s_add_u32 s36, s24, 0x4107000
    buffer_store_dwordx4 v[20:23], v11, s[8:11], s36 offen sc1
    s_waitcnt vmcnt(0)
    s_barrier
    v_cmp_ne_u32 vcc, 0, v0
    v_mov_b32 v15, 0x40000000
    v_mov_b32 v14, 1
    v_cndmask_b32 v15, v0, v15, vcc
    buffer_store_dword v14, v15, s[8:11], s25 offen sc1
    s_lshl_b32 s25, s22, 7
    s_lshl_b32 s36, s20, 2
    s_add_u32 s36, s36, s25
    s_add_u32 s36, s36, 0x192000
    v_cmp_ne_u32 vcc, 0, v0
    v_mov_b32 v15, 0x40000000
    v_mov_b32 v14, 1
    v_cndmask_b32 v15, v0, v15, vcc
    buffer_store_dword v14, v15, s[8:11], s36 offen sc1
    s_mov_b32 s96, s54
    s_and_b32 s97, s55, 0xffff
    s_mov_b32 s98, 0x400000
    s_mov_b32 s99, 0x20000
    v_mov_b32 v15, 0x0
    v_bfe_u32 v14, v0, 0, 1
    s_mov_b32 s38, 0x10
    v_mad_u32_u24 v15, v14, s38, v15
    v_bfe_u32 v14, v0, 1, 1
    s_mov_b32 s38, 0x20
    v_mad_u32_u24 v15, v14, s38, v15
    v_bfe_u32 v14, v0, 2, 1
    s_mov_b32 s38, 0x40
    v_mad_u32_u24 v15, v14, s38, v15
    v_bfe_u32 v14, v0, 3, 1
    s_mov_b32 s38, 0x80
    v_mad_u32_u24 v15, v14, s38, v15
    v_bfe_u32 v14, v0, 4, 1
    s_mov_b32 s38, 0x1000
    v_mad_u32_u24 v15, v14, s38, v15
    v_bfe_u32 v14, v0, 5, 1
    s_mov_b32 s38, 0x2000
    v_mad_u32_u24 v15, v14, s38, v15
    v_bfe_u32 v14, v0, 6, 1
    s_mov_b32 s38, 0x100
    v_mad_u32_u24 v15, v14, s38, v15
    v_bfe_u32 v14, v0, 7, 1
    s_mov_b32 s38, 0x200
    v_mad_u32_u24 v15, v14, s38, v15
    s_lshl_b32 s36, s20, 17
    s_add_u32 s37, s36, 0x0
    buffer_load_dwordx4 v[16:19], v15, s[96:99], s37 offen
    s_add_u32 s37, s36, 0x4000
    buffer_load_dwordx4 v[20:23], v15, s[96:99], s37 offen
    s_add_u32 s37, s36, 0x400
    buffer_load_dwordx4 v[24:27], v15, s[96:99], s37 offen
    s_add_u32 s37, s36, 0x4400
    buffer_load_dwordx4 v[28:31], v15, s[96:99], s37 offen
    s_add_u32 s37, s36, 0x800
    buffer_load_dwordx4 v[32:35], v15, s[96:99], s37 offen
    s_add_u32 s37, s36, 0x4800
    buffer_load_dwordx4 v[36:39], v15, s[96:99], s37 offen
    s_add_u32 s37, s36, 0xc00
    buffer_load_dwordx4 v[40:43], v15, s[96:99], s37 offen
    s_add_u32 s37, s36, 0x4c00
    buffer_load_dwordx4 v[44:47], v15, s[96:99], s37 offen
    s_add_u32 s37, s36, 0x8000
    buffer_load_dwordx4 v[48:51], v15, s[96:99], s37 offen
    s_add_u32 s37, s36, 0xc000
    buffer_load_dwordx4 v[52:55], v15, s[96:99], s37 offen
    s_add_u32 s37, s36, 0x8400
    buffer_load_dwordx4 v[56:59], v15, s[96:99], s37 offen
    s_add_u32 s37, s36, 0xc400
    buffer_load_dwordx4 v[60:63], v15, s[96:99], s37 offen
    s_add_u32 s37, s36, 0x8800
    buffer_load_dwordx4 v[64:67], v15, s[96:99], s37 offen
    s_add_u32 s37, s36, 0xc800
    buffer_load_dwordx4 v[68:71], v15, s[96:99], s37 offen
    s_add_u32 s37, s36, 0x8c00
    buffer_load_dwordx4 v[72:75], v15, s[96:99], s37 offen
    s_add_u32 s37, s36, 0xcc00
    buffer_load_dwordx4 v[76:79], v15, s[96:99], s37 offen
    s_add_u32 s37, s36, 0x10000
    buffer_load_dwordx4 v[80:83], v15, s[96:99], s37 offen
    s_add_u32 s37, s36, 0x14000
    buffer_load_dwordx4 v[84:87], v15, s[96:99], s37 offen
    s_add_u32 s37, s36, 0x10400
    buffer_load_dwordx4 v[88:91], v15, s[96:99], s37 offen
    s_add_u32 s37, s36, 0x14400
    buffer_load_dwordx4 v[92:95], v15, s[96:99], s37 offen
    s_add_u32 s37, s36, 0x10800
    buffer_load_dwordx4 v[96:99], v15, s[96:99], s37 offen
    s_add_u32 s37, s36, 0x14800
    buffer_load_dwordx4 v[100:103], v15, s[96:99], s37 offen
    s_add_u32 s37, s36, 0x10c00
    buffer_load_dwordx4 v[104:107], v15, s[96:99], s37 offen
    s_add_u32 s37, s36, 0x14c00
    buffer_load_dwordx4 v[108:111], v15, s[96:99], s37 offen
    s_waitcnt vmcnt(16)
    v_perm_b32 v112, v20, v16, s34
    v_perm_b32 v113, v28, v24, s34
    v_perm_b32 v114, v36, v32, s34
    v_perm_b32 v115, v44, v40, s34
    ds_write_b128 v7, v[112:115] offset:0
    v_perm_b32 v116, v20, v16, s35
    v_perm_b32 v117, v28, v24, s35
    v_perm_b32 v118, v36, v32, s35
    v_perm_b32 v119, v44, v40, s35
    ds_write_b128 v7, v[116:119] offset:1024
    v_perm_b32 v120, v21, v17, s34
    v_perm_b32 v121, v29, v25, s34
    v_perm_b32 v122, v37, v33, s34
    v_perm_b32 v123, v45, v41, s34
    ds_write_b128 v7, v[120:123] offset:2048
    v_perm_b32 v124, v21, v17, s35
    v_perm_b32 v125, v29, v25, s35
    v_perm_b32 v126, v37, v33, s35
    v_perm_b32 v127, v45, v41, s35
    ds_write_b128 v7, v[124:127] offset:3072
    s_waitcnt lgkmcnt(0)
    v_perm_b32 v112, v22, v18, s34
    v_perm_b32 v113, v30, v26, s34
    v_perm_b32 v114, v38, v34, s34
    v_perm_b32 v115, v46, v42, s34
    ds_write_b128 v7, v[112:115] offset:4096
    v_perm_b32 v116, v22, v18, s35
    v_perm_b32 v117, v30, v26, s35
    v_perm_b32 v118, v38, v34, s35
    v_perm_b32 v119, v46, v42, s35
    ds_write_b128 v7, v[116:119] offset:5120
    v_perm_b32 v120, v23, v19, s34
    v_perm_b32 v121, v31, v27, s34
    v_perm_b32 v122, v39, v35, s34
    v_perm_b32 v123, v47, v43, s34
    ds_write_b128 v7, v[120:123] offset:6144
    v_perm_b32 v124, v23, v19, s35
    v_perm_b32 v125, v31, v27, s35
    v_perm_b32 v126, v39, v35, s35
    v_perm_b32 v127, v47, v43, s35
    ds_write_b128 v7, v[124:127] offset:7168
    s_waitcnt lgkmcnt(0)
    s_add_u32 s37, s36, 0x18000
    buffer_load_dwordx4 v[16:19], v15, s[96:99], s37 offen
    s_add_u32 s37, s36, 0x1c000
    buffer_load_dwordx4 v[20:23], v15, s[96:99], s37 offen
    s_add_u32 s37, s36, 0x18400
    buffer_load_dwordx4 v[24:27], v15, s[96:99], s37 offen
    s_add_u32 s37, s36, 0x1c400
    buffer_load_dwordx4 v[28:31], v15, s[96:99], s37 offen
    s_add_u32 s37, s36, 0x18800
    buffer_load_dwordx4 v[32:35], v15, s[96:99], s37 offen
    s_add_u32 s37, s36, 0x1c800
    buffer_load_dwordx4 v[36:39], v15, s[96:99], s37 offen
    s_add_u32 s37, s36, 0x18c00
    buffer_load_dwordx4 v[40:43], v15, s[96:99], s37 offen
    s_add_u32 s37, s36, 0x1cc00
    buffer_load_dwordx4 v[44:47], v15, s[96:99], s37 offen
    s_waitcnt vmcnt(16)
    v_perm_b32 v112, v52, v48, s34
    v_perm_b32 v113, v60, v56, s34
    v_perm_b32 v114, v68, v64, s34
    v_perm_b32 v115, v76, v72, s34
    ds_write_b128 v7, v[112:115] offset:8192
    v_perm_b32 v116, v52, v48, s35
    v_perm_b32 v117, v60, v56, s35
    v_perm_b32 v118, v68, v64, s35
    v_perm_b32 v119, v76, v72, s35
    ds_write_b128 v7, v[116:119] offset:9216
    v_perm_b32 v120, v53, v49, s34
    v_perm_b32 v121, v61, v57, s34
    v_perm_b32 v122, v69, v65, s34
    v_perm_b32 v123, v77, v73, s34
    ds_write_b128 v7, v[120:123] offset:10240
    v_perm_b32 v124, v53, v49, s35
    v_perm_b32 v125, v61, v57, s35
    v_perm_b32 v126, v69, v65, s35
    v_perm_b32 v127, v77, v73, s35
    ds_write_b128 v7, v[124:127] offset:11264
    s_waitcnt lgkmcnt(0)
    v_perm_b32 v112, v54, v50, s34
    v_perm_b32 v113, v62, v58, s34
    v_perm_b32 v114, v70, v66, s34
    v_perm_b32 v115, v78, v74, s34
    ds_write_b128 v7, v[112:115] offset:12288
    v_perm_b32 v116, v54, v50, s35
    v_perm_b32 v117, v62, v58, s35
    v_perm_b32 v118, v70, v66, s35
    v_perm_b32 v119, v78, v74, s35
    ds_write_b128 v7, v[116:119] offset:13312
    v_perm_b32 v120, v55, v51, s34
    v_perm_b32 v121, v63, v59, s34
    v_perm_b32 v122, v71, v67, s34
    v_perm_b32 v123, v79, v75, s34
    ds_write_b128 v7, v[120:123] offset:14336
    v_perm_b32 v124, v55, v51, s35
    v_perm_b32 v125, v63, v59, s35
    v_perm_b32 v126, v71, v67, s35
    v_perm_b32 v127, v79, v75, s35
    ds_write_b128 v7, v[124:127] offset:15360
    s_waitcnt lgkmcnt(0)
    s_waitcnt vmcnt(8)
    v_perm_b32 v112, v84, v80, s34
    v_perm_b32 v113, v92, v88, s34
    v_perm_b32 v114, v100, v96, s34
    v_perm_b32 v115, v108, v104, s34
    ds_write_b128 v7, v[112:115] offset:16384
    v_perm_b32 v116, v84, v80, s35
    v_perm_b32 v117, v92, v88, s35
    v_perm_b32 v118, v100, v96, s35
    v_perm_b32 v119, v108, v104, s35
    ds_write_b128 v7, v[116:119] offset:17408
    v_perm_b32 v120, v85, v81, s34
    v_perm_b32 v121, v93, v89, s34
    v_perm_b32 v122, v101, v97, s34
    v_perm_b32 v123, v109, v105, s34
    ds_write_b128 v7, v[120:123] offset:18432
    v_perm_b32 v124, v85, v81, s35
    v_perm_b32 v125, v93, v89, s35
    v_perm_b32 v126, v101, v97, s35
    v_perm_b32 v127, v109, v105, s35
    ds_write_b128 v7, v[124:127] offset:19456
    s_waitcnt lgkmcnt(0)
    v_perm_b32 v112, v86, v82, s34
    v_perm_b32 v113, v94, v90, s34
    v_perm_b32 v114, v102, v98, s34
    v_perm_b32 v115, v110, v106, s34
    ds_write_b128 v7, v[112:115] offset:20480
    v_perm_b32 v116, v86, v82, s35
    v_perm_b32 v117, v94, v90, s35
    v_perm_b32 v118, v102, v98, s35
    v_perm_b32 v119, v110, v106, s35
    ds_write_b128 v7, v[116:119] offset:21504
    v_perm_b32 v120, v87, v83, s34
    v_perm_b32 v121, v95, v91, s34
    v_perm_b32 v122, v103, v99, s34
    v_perm_b32 v123, v111, v107, s34
    ds_write_b128 v7, v[120:123] offset:22528
    v_perm_b32 v124, v87, v83, s35
    v_perm_b32 v125, v95, v91, s35
    v_perm_b32 v126, v103, v99, s35
    v_perm_b32 v127, v111, v107, s35
    ds_write_b128 v7, v[124:127] offset:23552
    s_waitcnt lgkmcnt(0)
    s_waitcnt vmcnt(0)
    v_perm_b32 v112, v20, v16, s34
    v_perm_b32 v113, v28, v24, s34
    v_perm_b32 v114, v36, v32, s34
    v_perm_b32 v115, v44, v40, s34
    ds_write_b128 v7, v[112:115] offset:24576
    v_perm_b32 v116, v20, v16, s35
    v_perm_b32 v117, v28, v24, s35
    v_perm_b32 v118, v36, v32, s35
    v_perm_b32 v119, v44, v40, s35
    ds_write_b128 v7, v[116:119] offset:25600
    v_perm_b32 v120, v21, v17, s34
    v_perm_b32 v121, v29, v25, s34
    v_perm_b32 v122, v37, v33, s34
    v_perm_b32 v123, v45, v41, s34
    ds_write_b128 v7, v[120:123] offset:26624
    v_perm_b32 v124, v21, v17, s35
    v_perm_b32 v125, v29, v25, s35
    v_perm_b32 v126, v37, v33, s35
    v_perm_b32 v127, v45, v41, s35
    ds_write_b128 v7, v[124:127] offset:27648
    s_waitcnt lgkmcnt(0)
    v_perm_b32 v112, v22, v18, s34
    v_perm_b32 v113, v30, v26, s34
    v_perm_b32 v114, v38, v34, s34
    v_perm_b32 v115, v46, v42, s34
    ds_write_b128 v7, v[112:115] offset:28672
    v_perm_b32 v116, v22, v18, s35
    v_perm_b32 v117, v30, v26, s35
    v_perm_b32 v118, v38, v34, s35
    v_perm_b32 v119, v46, v42, s35
    ds_write_b128 v7, v[116:119] offset:29696
    v_perm_b32 v120, v23, v19, s34
    v_perm_b32 v121, v31, v27, s34
    v_perm_b32 v122, v39, v35, s34
    v_perm_b32 v123, v47, v43, s34
    ds_write_b128 v7, v[120:123] offset:30720
    v_perm_b32 v124, v23, v19, s35
    v_perm_b32 v125, v31, v27, s35
    v_perm_b32 v126, v39, v35, s35
    v_perm_b32 v127, v47, v43, s35
    ds_write_b128 v7, v[124:127] offset:31744
    s_waitcnt lgkmcnt(0)
    s_lshl_b32 s25, s22, 7
    s_add_u32 s25, s25, 0x192000
    v_lshrrev_b32 v15, 2, v1
    v_and_b32 v15, 127, v15
L_TPI:
    buffer_load_dword v14, v15, s[8:11], s25 offen sc1
    s_add_u32 s32, s32, 1
    s_cmp_gt_u32 s32, 200000
    s_waitcnt vmcnt(0)
    s_cbranch_scc1 L_TPI_ok
    v_cmp_eq_u32 vcc, 0, v14
    s_cbranch_vccz L_TPI_ok
    s_sleep 8
    s_branch L_TPI
L_TPI_ok:
    s_mov_b32 s23, s22
    s_mov_b32 s29, 0
L_P2:
    s_and_b32 s36, s29, 1
    s_lshl_b32 s36, s36, 20
    s_lshl_b32 s26, s22, 21
    s_add_u32 s26, s26, s36
    s_add_u32 s26, s26, 0x4000000
    s_bfe_u32 s27, s29, 0x10001
    s_mul_i32 s24, s23, 0x82000
    s_lshl_b32 s36, s20, 14
    s_add_u32 s24, s24, s36
    s_add_u32 s24, s24, 0x1000000
    s_add_u32 s36, s24, 0
    s_add_u32 s37, s36, 0x7000000
    buffer_load_dwordx4 v[48:51], v1, s[8:11], s36 offen offset:0 sc1
    buffer_load_dwordx4 v[16:19], v1, s[8:11], s37 offen offset:0 sc1
    buffer_load_dwordx4 v[52:55], v1, s[8:11], s36 offen offset:1024 sc1
    buffer_load_dwordx4 v[20:23], v1, s[8:11], s37 offen offset:1024 sc1
    buffer_load_dwordx4 v[56:59], v1, s[8:11], s36 offen offset:2048 sc1
    buffer_load_dwordx4 v[24:27], v1, s[8:11], s37 offen offset:2048 sc1
    buffer_load_dwordx4 v[60:63], v1, s[8:11], s36 offen offset:3072 sc1
    buffer_load_dwordx4 v[28:31], v1, s[8:11], s37 offen offset:3072 sc1
    s_add_u32 s36, s24, 4096
    s_add_u32 s37, s36, 0x7000000
    buffer_load_dwordx4 v[64:67], v1, s[8:11], s36 offen offset:0 sc1
    buffer_load_dwordx4 v[32:35], v1, s[8:11], s37 offen offset:0 sc1
    buffer_load_dwordx4 v[68:71], v1, s[8:11], s36 offen offset:1024 sc1
    buffer_load_dwordx4 v[36:39], v1, s[8:11], s37 offen offset:1024 sc1
    buffer_load_dwordx4 v[72:75], v1, s[8:11], s36 offen offset:2048 sc1
    buffer_load_dwordx4 v[40:43], v1, s[8:11], s37 offen offset:2048 sc1
    buffer_load_dwordx4 v[76:79], v1, s[8:11], s36 offen offset:3072 sc1
    buffer_load_dwordx4 v[44:47], v1, s[8:11], s37 offen offset:3072 sc1
    s_add_u32 s24, s24, 8192
    buffer_load_dwordx4 v[120:123], v2, s[8:11], s24 offen sc1
    buffer_load_dwordx4 v[124:127], v2, s[8:11], s24 offen offset:1024 sc1
    s_waitcnt vmcnt(0)
    s_cmp_lt_u32 s21, 2
    s_cbranch_scc1 L_P2_noswap
    v_swap_b32 v120, v122
    v_swap_b32 v121, v123
    v_swap_b32 v124, v126
    v_swap_b32 v125, v127
L_P2_noswap:
    s_nop 1
    v_mfma_f32_16x16x32_bf16 v[80:83], v[48:51], v[16:19], 0
    v_mfma_f32_16x16x32_bf16 v[80:83], v[52:55], v[20:23], v[80:83]
    v_mfma_f32_16x16x32_bf16 v[80:83], v[56:59], v[24:27], v[80:83]
    v_mfma_f32_16x16x32_bf16 v[80:83], v[60:63], v[28:31], v[80:83]
    v_mfma_f32_16x16x32_bf16 v[84:87], v[48:51], v[32:35], 0
    v_mfma_f32_16x16x32_bf16 v[84:87], v[52:55], v[36:39], v[84:87]
    v_mfma_f32_16x16x32_bf16 v[84:87], v[56:59], v[40:43], v[84:87]
    v_mfma_f32_16x16x32_bf16 v[84:87], v[60:63], v[44:47], v[84:87]
    v_mfma_f32_16x16x32_bf16 v[88:91], v[64:67], v[32:35], 0
    v_mfma_f32_16x16x32_bf16 v[88:91], v[68:71], v[36:39], v[88:91]
    v_mfma_f32_16x16x32_bf16 v[88:91], v[72:75], v[40:43], v[88:91]
    v_mfma_f32_16x16x32_bf16 v[88:91], v[76:79], v[44:47], v[88:91]
    s_lshl_b32 s24, s23, 13
    s_add_u32 s24, s24, 0x100000
    s_max_u32 s25, s23, 1
    s_lshl_b32 s25, s25, 13
    s_add_u32 s25, s25, 0xfe000
L_P2_far:
    buffer_load_dword v14, v2, s[8:11], s25 offen sc1
    s_add_u32 s32, s32, 1
    s_cmp_gt_u32 s32, 200000
    s_waitcnt vmcnt(0)
    s_cbranch_scc1 L_P2_poll
    v_cmp_eq_u32 vcc, -1, v14
    s_cbranch_vccz L_P2_poll
    s_sleep 12
    s_branch L_P2_far
L_P2_poll:
    buffer_load_dwordx4 v[48:51], v2, s[8:11], s24 offen sc1
    buffer_load_dwordx4 v[52:55], v2, s[8:11], s24 offen offset:1024 sc1
    s_add_u32 s32, s32, 1
    s_cmp_gt_u32 s32, 200000
    s_waitcnt vmcnt(0)
    v_max3_u32 v14, v48, v49, v50
    v_max3_u32 v15, v51, v52, v53
    v_max3_u32 v14, v14, v54, v55
    v_max_u32 v14, v14, v15
    s_cbranch_scc1 L_P2_got
    v_cmp_eq_u32 vcc, -1, v14
    s_cbranch_vccnz L_P2_poll
L_P2_got:
    ds_write_b128 v2, v[48:51] offset:20480
    ds_write_b128 v2, v[52:55] offset:21504
    s_waitcnt lgkmcnt(0)
    s_barrier
    ds_read_b128 v[48:51], v8 offset:0
    ds_read_b128 v[52:55], v8 offset:2048
    ds_read_b128 v[56:59], v8 offset:4096
    ds_read_b128 v[60:63], v8 offset:6144
    ds_read_b128 v[64:67], v8 offset:512
    s_waitcnt lgkmcnt(4)
    v_mfma_f32_16x16x32_bf16 v[100:103], a[128:131], v[48:51], 0
    v_mfma_f32_16x16x32_bf16 v[104:107], a[132:135], v[48:51], 0
    v_mfma_f32_16x16x32_bf16 v[108:111], v[48:51], v[128:131], 0
    v_mfma_f32_16x16x32_bf16 v[112:115], v[48:51], v[132:135], 0
    ds_read_b128 v[68:71], v8 offset:2560
    s_waitcnt lgkmcnt(4)
    v_mfma_f32_16x16x32_bf16 v[100:103], a[136:139], v[52:55], v[100:103]
    v_mfma_f32_16x16x32_bf16 v[104:107], a[140:143], v[52:55], v[104:107]
    v_mfma_f32_16x16x32_bf16 v[108:111], v[52:55], v[136:139], v[108:111]
    v_mfma_f32_16x16x32_bf16 v[112:115], v[52:55], v[140:143], v[112:115]
    ds_read_b128 v[72:75], v8 offset:4608
    s_waitcnt lgkmcnt(4)
    v_mfma_f32_16x16x32_bf16 v[100:103], a[144:147], v[56:59], v[100:103]
    v_mfma_f32_16x16x32_bf16 v[104:107], a[148:151], v[56:59], v[104:107]
    v_mfma_f32_16x16x32_bf16 v[108:111], v[56:59], v[144:147], v[108:111]
    v_mfma_f32_16x16x32_bf16 v[112:115], v[56:59], v[148:151], v[112:115]
    ds_read_b128 v[76:79], v8 offset:6656
    s_waitcnt lgkmcnt(4)
    v_mfma_f32_16x16x32_bf16 v[100:103], a[152:155], v[60:63], v[100:103]
    v_mfma_f32_16x16x32_bf16 v[104:107], a[156:159], v[60:63], v[104:107]
    v_mfma_f32_16x16x32_bf16 v[108:111], v[60:63], v[152:155], v[108:111]
    v_mfma_f32_16x16x32_bf16 v[112:115], v[60:63], v[156:159], v[112:115]
    ds_read_b128 v[48:51], v8 offset:1024
    s_waitcnt lgkmcnt(4)
    v_mfma_f32_16x16x32_bf16 v[100:103], a[160:163], v[64:67], v[100:103]
    v_mfma_f32_16x16x32_bf16 v[104:107], a[164:167], v[64:67], v[104:107]
    v_mfma_f32_16x16x32_bf16 v[108:111], v[64:67], v[160:163], v[108:111]
    v_mfma_f32_16x16x32_bf16 v[112:115], v[64:67], v[164:167], v[112:115]
    ds_read_b128 v[52:55], v8 offset:3072
    s_waitcnt lgkmcnt(4)
    v_mfma_f32_16x16x32_bf16 v[100:103], a[168:171], v[68:71], v[100:103]
    v_mfma_f32_16x16x32_bf16 v[104:107], a[172:175], v[68:71], v[104:107]
    v_mfma_f32_16x16x32_bf16 v[108:111], v[68:71], v[168:171], v[108:111]
    v_mfma_f32_16x16x32_bf16 v[112:115], v[68:71], v[172:175], v[112:115]
    ds_read_b128 v[56:59], v8 offset:5120
    s_waitcnt lgkmcnt(4)
    v_mfma_f32_16x16x32_bf16 v[100:103], a[176:179], v[72:75], v[100:103]
    v_mfma_f32_16x16x32_bf16 v[104:107], a[180:183], v[72:75], v[104:107]
    v_mfma_f32_16x16x32_bf16 v[108:111], v[72:75], v[176:179], v[108:111]
    v_mfma_f32_16x16x32_bf16 v[112:115], v[72:75], v[180:183], v[112:115]
    ds_read_b128 v[60:63], v8 offset:7168
    s_waitcnt lgkmcnt(4)
    v_mfma_f32_16x16x32_bf16 v[100:103], a[184:187], v[76:79], v[100:103]
    v_mfma_f32_16x16x32_bf16 v[104:107], a[188:191], v[76:79], v[104:107]
    v_mfma_f32_16x16x32_bf16 v[108:111], v[76:79], v[184:187], v[108:111]
    v_mfma_f32_16x16x32_bf16 v[112:115], v[76:79], v[188:191], v[112:115]
    ds_read_b128 v[64:67], v8 offset:1536
    s_waitcnt lgkmcnt(4)
    v_mfma_f32_16x16x32_bf16 v[100:103], a[192:195], v[48:51], v[100:103]
    v_mfma_f32_16x16x32_bf16 v[104:107], a[196:199], v[48:51], v[104:107]
    v_mfma_f32_16x16x32_bf16 v[108:111], v[48:51], v[192:195], v[108:111]
    v_mfma_f32_16x16x32_bf16 v[112:115], v[48:51], v[196:199], v[112:115]
    ds_read_b128 v[68:71], v8 offset:3584
    s_waitcnt lgkmcnt(4)
    v_mfma_f32_16x16x32_bf16 v[100:103], a[200:203], v[52:55], v[100:103]
    v_mfma_f32_16x16x32_bf16 v[104:107], a[204:207], v[52:55], v[104:107]
    v_mfma_f32_16x16x32_bf16 v[108:111], v[52:55], v[200:203], v[108:111]
    v_mfma_f32_16x16x32_bf16 v[112:115], v[52:55], v[204:207], v[112:115]
    ds_read_b128 v[72:75], v8 offset:5632
    s_waitcnt lgkmcnt(4)
    v_mfma_f32_16x16x32_bf16 v[100:103], a[208:211], v[56:59], v[100:103]
    v_mfma_f32_16x16x32_bf16 v[104:107], a[212:215], v[56:59], v[104:107]
    v_mfma_f32_16x16x32_bf16 v[108:111], v[56:59], v[208:211], v[108:111]
    v_mfma_f32_16x16x32_bf16 v[112:115], v[56:59], v[212:215], v[112:115]
    ds_read_b128 v[76:79], v8 offset:7680
    s_waitcnt lgkmcnt(4)
    v_mfma_f32_16x16x32_bf16 v[100:103], a[216:219], v[60:63], v[100:103]
    v_mfma_f32_16x16x32_bf16 v[104:107], a[220:223], v[60:63], v[104:107]
    v_mfma_f32_16x16x32_bf16 v[108:111], v[60:63], v[216:219], v[108:111]
    v_mfma_f32_16x16x32_bf16 v[112:115], v[60:63], v[220:223], v[112:115]
    s_waitcnt lgkmcnt(3)
    v_mfma_f32_16x16x32_bf16 v[100:103], a[224:227], v[64:67], v[100:103]
    v_mfma_f32_16x16x32_bf16 v[104:107], a[228:231], v[64:67], v[104:107]
    v_mfma_f32_16x16x32_bf16 v[108:111], v[64:67], v[224:227], v[108:111]
    v_mfma_f32_16x16x32_bf16 v[112:115], v[64:67], v[228:231], v[112:115]
    s_waitcnt lgkmcnt(2)
    v_mfma_f32_16x16x32_bf16 v[100:103], a[232:235], v[68:71], v[100:103]
    v_mfma_f32_16x16x32_bf16 v[104:107], a[236:239], v[68:71], v[104:107]
    v_mfma_f32_16x16x32_bf16 v[108:111], v[68:71], v[232:235], v[108:111]
    v_mfma_f32_16x16x32_bf16 v[112:115], v[68:71], v[236:239], v[112:115]
    s_waitcnt lgkmcnt(1)
    v_mfma_f32_16x16x32_bf16 v[100:103], a[240:243], v[72:75], v[100:103]
    v_mfma_f32_16x16x32_bf16 v[104:107], a[244:247], v[72:75], v[104:107]
    v_mfma_f32_16x16x32_bf16 v[108:111], v[72:75], v[240:243], v[108:111]
    v_mfma_f32_16x16x32_bf16 v[112:115], v[72:75], v[244:247], v[112:115]
    s_waitcnt lgkmcnt(0)
    v_mfma_f32_16x16x32_bf16 v[100:103], a[248:251], v[76:79], v[100:103]
    v_mfma_f32_16x16x32_bf16 v[104:107], a[252:255], v[76:79], v[104:107]
    v_mfma_f32_16x16x32_bf16 v[108:111], v[76:79], v[248:251], v[108:111]
    v_mfma_f32_16x16x32_bf16 v[112:115], v[76:79], v[252:255], v[112:115]
    s_nop 4
    v_mul_f32 v100, s33, v100
    v_mul_f32 v101, s33, v101
    v_mul_f32 v102, s33, v102
    v_mul_f32 v103, s33, v103
    v_mul_f32 v104, s33, v104
    v_mul_f32 v105, s33, v105
    v_mul_f32 v106, s33, v106
    v_mul_f32 v107, s33, v107
    v_cvt_pk_bf16_f32 v48, v100, v104
    v_cvt_pk_bf16_f32 v49, v101, v105
    v_cvt_pk_bf16_f32 v50, v102, v106
    v_cvt_pk_bf16_f32 v51, v103, v107
    ds_write_b128 v9, v[48:51] offset:16384
    v_cvt_pk_bf16_f32 v116, v108, v109
    v_cvt_pk_bf16_f32 v117, v110, v111
    v_cvt_pk_bf16_f32 v118, v112, v113
    v_cvt_pk_bf16_f32 v119, v114, v115
    s_waitcnt lgkmcnt(0)
    s_barrier
    ds_read_b128 v[64:67], v1 offset:16384
    ds_read_b128 v[68:71], v1 offset:17408
    ds_read_b128 v[72:75], v1 offset:18432
    ds_read_b128 v[76:79], v1 offset:19456
    v_cndmask_b32 v80, v13, v80, s[64:65]
    v_cndmask_b32 v81, v13, v81, s[66:67]
    v_cndmask_b32 v82, v13, v82, s[68:69]
    v_cndmask_b32 v83, v13, v83, s[70:71]
    v_cndmask_b32 v88, v13, v88, s[64:65]
    v_cndmask_b32 v89, v13, v89, s[66:67]
    v_cndmask_b32 v90, v13, v90, s[68:69]
    v_cndmask_b32 v91, v13, v91, s[70:71]
    s_waitcnt lgkmcnt(0)
    v_mfma_f32_16x16x32_bf16 v[92:95], v[64:67], v[16:19], 0
    v_mfma_f32_16x16x32_bf16 v[92:95], v[68:71], v[20:23], v[92:95]
    v_mfma_f32_16x16x32_bf16 v[92:95], v[72:75], v[24:27], v[92:95]
    v_mfma_f32_16x16x32_bf16 v[92:95], v[76:79], v[28:31], v[92:95]
    v_mfma_f32_16x16x32_bf16 v[96:99], v[64:67], v[32:35], 0
    v_mfma_f32_16x16x32_bf16 v[96:99], v[68:71], v[36:39], v[96:99]
    v_mfma_f32_16x16x32_bf16 v[96:99], v[72:75], v[40:43], v[96:99]
    v_mfma_f32_16x16x32_bf16 v[96:99], v[76:79], v[44:47], v[96:99]
    s_nop 3
    v_cndmask_b32 v92, v13, v92, s[72:73]
    v_cndmask_b32 v93, v13, v93, s[72:73]
    v_cndmask_b32 v94, v13, v94, s[72:73]
    v_cndmask_b32 v95, v13, v95, s[72:73]
    v_cndmask_b32 v96, v13, v96, s[72:73]
    v_cndmask_b32 v97, v13, v97, s[72:73]
    v_cndmask_b32 v98, v13, v98, s[72:73]
    v_cndmask_b32 v99, v13, v99, s[72:73]
    v_max_f32 v48, v80, v81
    v_max3_f32 v48, v48, v82, v83
    v_max3_f32 v48, v48, v92, v93
    v_max3_f32 v48, v48, v94, v95
    v_max_f32 v49, v84, v85
    v_max3_f32 v49, v49, v86, v87
    v_max3_f32 v49, v49, v88, v89
    v_max3_f32 v49, v49, v90, v91
    v_max3_f32 v49, v49, v96, v97
    v_max3_f32 v49, v49, v98, v99
    v_mov_b32 v14, v48
    s_nop 1
    v_permlane16_swap_b32 v48, v14
    v_max_f32 v48, v48, v14
    v_mov_b32 v14, v49
    s_nop 1
    v_permlane16_swap_b32 v49, v14
    v_max_f32 v49, v49, v14
    v_mov_b32 v14, v48
    s_nop 1
    v_permlane32_swap_b32 v48, v14
    v_max_f32 v48, v48, v14
    v_mov_b32 v14, v49
    s_nop 1
    v_permlane32_swap_b32 v49, v14
    v_max_f32 v49, v49, v14
    v_sub_f32 v80, v80, v48
    v_exp_f32 v80, v80
    v_sub_f32 v81, v81, v48
    v_exp_f32 v81, v81
    v_sub_f32 v82, v82, v48
    v_exp_f32 v82, v82
    v_sub_f32 v83, v83, v48
    v_exp_f32 v83, v83
    v_sub_f32 v92, v92, v48
    v_exp_f32 v92, v92
    v_sub_f32 v93, v93, v48
    v_exp_f32 v93, v93
    v_sub_f32 v94, v94, v48
    v_exp_f32 v94, v94
    v_sub_f32 v95, v95, v48
    v_exp_f32 v95, v95
    v_sub_f32 v84, v84, v49
    v_exp_f32 v84, v84
    v_sub_f32 v85, v85, v49
    v_exp_f32 v85, v85
    v_sub_f32 v86, v86, v49
    v_exp_f32 v86, v86
    v_sub_f32 v87, v87, v49
    v_exp_f32 v87, v87
    v_sub_f32 v88, v88, v49
    v_exp_f32 v88, v88
    v_sub_f32 v89, v89, v49
    v_exp_f32 v89, v89
    v_sub_f32 v90, v90, v49
    v_exp_f32 v90, v90
    v_sub_f32 v91, v91, v49
    v_exp_f32 v91, v91
    v_sub_f32 v96, v96, v49
    v_exp_f32 v96, v96
    v_sub_f32 v97, v97, v49
    v_exp_f32 v97, v97
    v_sub_f32 v98, v98, v49
    v_exp_f32 v98, v98
    v_sub_f32 v99, v99, v49
    v_exp_f32 v99, v99
    v_cvt_pk_bf16_f32 v16, v80, v81
    v_cvt_pk_bf16_f32 v17, v82, v83
    v_mov_b64 v[18:19], 0
    v_cvt_pk_bf16_f32 v20, v84, v85
    v_cvt_pk_bf16_f32 v21, v86, v87
    v_cvt_pk_bf16_f32 v22, v88, v89
    v_cvt_pk_bf16_f32 v23, v90, v91
    v_cvt_pk_bf16_f32 v24, v92, v93
    v_cvt_pk_bf16_f32 v25, v94, v95
    v_cvt_pk_bf16_f32 v26, v96, v97
    v_cvt_pk_bf16_f32 v27, v98, v99
    v_mov_b64 v[28:29], s[4:5]
    v_mov_b64 v[30:31], s[4:5]
    s_nop 1
    v_mfma_f32_16x16x32_bf16 v[32:35], v[28:31], v[16:19], 0
    v_mfma_f32_16x16x32_bf16 v[40:43], v[120:123], v[16:19], 0
    v_mfma_f32_16x16x32_bf16 v[44:47], v[124:127], v[16:19], 0
    v_mfma_f32_16x16x32_bf16 v[36:39], v[28:31], v[20:23], 0
    v_mfma_f32_16x16x32_bf16 v[48:51], v[120:123], v[20:23], 0
    v_mfma_f32_16x16x32_bf16 v[52:55], v[124:127], v[20:23], 0
    s_nop 0
    v_mfma_f32_16x16x16_bf16 v[32:35], v[28:29], v[24:25], v[32:35]
    v_mfma_f32_16x16x16_bf16 v[40:43], v[116:117], v[24:25], v[40:43]
    v_mfma_f32_16x16x16_bf16 v[44:47], v[118:119], v[24:25], v[44:47]
    v_mfma_f32_16x16x16_bf16 v[36:39], v[28:29], v[26:27], v[36:39]
    v_mfma_f32_16x16x16_bf16 v[48:51], v[116:117], v[26:27], v[48:51]
    v_mfma_f32_16x16x16_bf16 v[52:55], v[118:119], v[26:27], v[52:55]
    s_nop 2
    v_rcp_f32 v14, v32
    s_nop 0
    v_mul_f32 v40, v40, v14
    v_mul_f32 v41, v41, v14
    v_mul_f32 v42, v42, v14
    v_mul_f32 v43, v43, v14
    v_mul_f32 v44, v44, v14
    v_mul_f32 v45, v45, v14
    v_mul_f32 v46, v46, v14
    v_mul_f32 v47, v47, v14
    v_cvt_pk_bf16_f32 v56, v40, v44
    v_cvt_pk_bf16_f32 v57, v41, v45
    v_cvt_pk_bf16_f32 v58, v42, v46
    v_cvt_pk_bf16_f32 v59, v43, v47
    ds_write_b128 v9, v[56:59] offset:0
    v_rcp_f32 v14, v36
    s_nop 0
    v_mul_f32 v48, v48, v14
    v_mul_f32 v49, v49, v14
    v_mul_f32 v50, v50, v14
    v_mul_f32 v51, v51, v14
    v_mul_f32 v52, v52, v14
    v_mul_f32 v53, v53, v14
    v_mul_f32 v54, v54, v14
    v_mul_f32 v55, v55, v14
    v_cvt_pk_bf16_f32 v60, v48, v52
    v_cvt_pk_bf16_f32 v61, v49, v53
    v_cvt_pk_bf16_f32 v62, v50, v54
    v_cvt_pk_bf16_f32 v63, v51, v55
    ds_write_b128 v9, v[60:63] offset:4096
    s_waitcnt lgkmcnt(0)
    s_barrier
    ds_read_b128 v[16:19], v1 offset:0
    ds_read_b128 v[20:23], v1 offset:1024
    ds_read_b128 v[24:27], v1 offset:2048
    ds_read_b128 v[28:31], v1 offset:3072
    ds_read_b128 v[32:35], v1 offset:4096
    ds_read_b128 v[36:39], v1 offset:5120
    ds_read_b128 v[40:43], v1 offset:6144
    ds_read_b128 v[44:47], v1 offset:7168
    ds_read_b128 v[48:51], v7 offset:0
    ds_read_b128 v[52:55], v7 offset:1024
    ds_read_b128 v[56:59], v7 offset:2048
    ds_read_b128 v[60:63], v7 offset:3072
    s_waitcnt lgkmcnt(3)
    v_mfma_f32_16x16x32_bf16 v[64:67], v[16:19], v[48:51], 0
    v_mfma_f32_16x16x32_bf16 v[96:99], v[32:35], v[48:51], 0
    ds_read_b128 v[48:51], v7 offset:4096
    s_waitcnt lgkmcnt(3)
    v_mfma_f32_16x16x32_bf16 v[68:71], v[16:19], v[52:55], 0
    v_mfma_f32_16x16x32_bf16 v[100:103], v[32:35], v[52:55], 0
    ds_read_b128 v[52:55], v7 offset:5120
    s_waitcnt lgkmcnt(3)
    v_mfma_f32_16x16x32_bf16 v[72:75], v[16:19], v[56:59], 0
    v_mfma_f32_16x16x32_bf16 v[104:107], v[32:35], v[56:59], 0
    ds_read_b128 v[56:59], v7 offset:6144
    s_waitcnt lgkmcnt(3)
    v_mfma_f32_16x16x32_bf16 v[76:79], v[16:19], v[60:63], 0
    v_mfma_f32_16x16x32_bf16 v[108:111], v[32:35], v[60:63], 0
    ds_read_b128 v[60:63], v7 offset:7168
    s_waitcnt lgkmcnt(3)
    v_mfma_f32_16x16x32_bf16 v[80:83], v[16:19], v[48:51], 0
    v_mfma_f32_16x16x32_bf16 v[112:115], v[32:35], v[48:51], 0
    ds_read_b128 v[48:51], v7 offset:8192
    s_waitcnt lgkmcnt(3)
    v_mfma_f32_16x16x32_bf16 v[84:87], v[16:19], v[52:55], 0
    v_mfma_f32_16x16x32_bf16 v[116:119], v[32:35], v[52:55], 0
    ds_read_b128 v[52:55], v7 offset:9216
    s_waitcnt lgkmcnt(3)
    v_mfma_f32_16x16x32_bf16 v[88:91], v[16:19], v[56:59], 0
    v_mfma_f32_16x16x32_bf16 v[120:123], v[32:35], v[56:59], 0
    ds_read_b128 v[56:59], v7 offset:10240
    s_waitcnt lgkmcnt(3)
    v_mfma_f32_16x16x32_bf16 v[92:95], v[16:19], v[60:63], 0
    v_mfma_f32_16x16x32_bf16 v[124:127], v[32:35], v[60:63], 0
    ds_read_b128 v[60:63], v7 offset:11264
    s_waitcnt lgkmcnt(3)
    v_mfma_f32_16x16x32_bf16 v[64:67], v[20:23], v[48:51], v[64:67]
    v_mfma_f32_16x16x32_bf16 v[96:99], v[36:39], v[48:51], v[96:99]
    ds_read_b128 v[48:51], v7 offset:12288
    s_waitcnt lgkmcnt(3)
    v_mfma_f32_16x16x32_bf16 v[68:71], v[20:23], v[52:55], v[68:71]
    v_mfma_f32_16x16x32_bf16 v[100:103], v[36:39], v[52:55], v[100:103]
    ds_read_b128 v[52:55], v7 offset:13312
    s_waitcnt lgkmcnt(3)
    v_mfma_f32_16x16x32_bf16 v[72:75], v[20:23], v[56:59], v[72:75]
    v_mfma_f32_16x16x32_bf16 v[104:107], v[36:39], v[56:59], v[104:107]
    ds_read_b128 v[56:59], v7 offset:14336
    s_waitcnt lgkmcnt(3)
    v_mfma_f32_16x16x32_bf16 v[76:79], v[20:23], v[60:63], v[76:79]
    v_mfma_f32_16x16x32_bf16 v[108:111], v[36:39], v[60:63], v[108:111]
    ds_read_b128 v[60:63], v7 offset:15360
    s_waitcnt lgkmcnt(3)
    v_mfma_f32_16x16x32_bf16 v[80:83], v[20:23], v[48:51], v[80:83]
    v_mfma_f32_16x16x32_bf16 v[112:115], v[36:39], v[48:51], v[112:115]
    ds_read_b128 v[48:51], v7 offset:16384
    s_waitcnt lgkmcnt(3)
    v_mfma_f32_16x16x32_bf16 v[84:87], v[20:23], v[52:55], v[84:87]
    v_mfma_f32_16x16x32_bf16 v[116:119], v[36:39], v[52:55], v[116:119]
    ds_read_b128 v[52:55], v7 offset:17408
    s_waitcnt lgkmcnt(3)
    v_mfma_f32_16x16x32_bf16 v[88:91], v[20:23], v[56:59], v[88:91]
    v_mfma_f32_16x16x32_bf16 v[120:123], v[36:39], v[56:59], v[120:123]
    ds_read_b128 v[56:59], v7 offset:18432
    s_waitcnt lgkmcnt(3)
    v_mfma_f32_16x16x32_bf16 v[92:95], v[20:23], v[60:63], v[92:95]
    v_mfma_f32_16x16x32_bf16 v[124:127], v[36:39], v[60:63], v[124:127]
    ds_read_b128 v[60:63], v7 offset:19456
    s_waitcnt lgkmcnt(3)
    v_mfma_f32_16x16x32_bf16 v[64:67], v[24:27], v[48:51], v[64:67]
    v_mfma_f32_16x16x32_bf16 v[96:99], v[40:43], v[48:51], v[96:99]
    ds_read_b128 v[48:51], v7 offset:20480
    s_waitcnt lgkmcnt(3)
    v_mfma_f32_16x16x32_bf16 v[68:71], v[24:27], v[52:55], v[68:71]
    v_mfma_f32_16x16x32_bf16 v[100:103], v[40:43], v[52:55], v[100:103]
    ds_read_b128 v[52:55], v7 offset:21504
    s_waitcnt lgkmcnt(3)
    v_mfma_f32_16x16x32_bf16 v[72:75], v[24:27], v[56:59], v[72:75]
    v_mfma_f32_16x16x32_bf16 v[104:107], v[40:43], v[56:59], v[104:107]
    ds_read_b128 v[56:59], v7 offset:22528
    s_waitcnt lgkmcnt(3)
    v_mfma_f32_16x16x32_bf16 v[76:79], v[24:27], v[60:63], v[76:79]
    v_mfma_f32_16x16x32_bf16 v[108:111], v[40:43], v[60:63], v[108:111]
    ds_read_b128 v[60:63], v7 offset:23552
    s_waitcnt lgkmcnt(3)
    v_mfma_f32_16x16x32_bf16 v[80:83], v[24:27], v[48:51], v[80:83]
    v_mfma_f32_16x16x32_bf16 v[112:115], v[40:43], v[48:51], v[112:115]
    ds_read_b128 v[48:51], v7 offset:24576
    s_waitcnt lgkmcnt(3)
    v_mfma_f32_16x16x32_bf16 v[84:87], v[24:27], v[52:55], v[84:87]
    v_mfma_f32_16x16x32_bf16 v[116:119], v[40:43], v[52:55], v[116:119]
    ds_read_b128 v[52:55], v7 offset:25600
    s_waitcnt lgkmcnt(3)
    v_mfma_f32_16x16x32_bf16 v[88:91], v[24:27], v[56:59], v[88:91]
    v_mfma_f32_16x16x32_bf16 v[120:123], v[40:43], v[56:59], v[120:123]
    ds_read_b128 v[56:59], v7 offset:26624
    s_waitcnt lgkmcnt(3)
    v_mfma_f32_16x16x32_bf16 v[92:95], v[24:27], v[60:63], v[92:95]
    v_mfma_f32_16x16x32_bf16 v[124:127], v[40:43], v[60:63], v[124:127]
    ds_read_b128 v[60:63], v7 offset:27648
    s_waitcnt lgkmcnt(3)
    v_mfma_f32_16x16x32_bf16 v[64:67], v[28:31], v[48:51], v[64:67]
    v_mfma_f32_16x16x32_bf16 v[96:99], v[44:47], v[48:51], v[96:99]
    ds_read_b128 v[48:51], v7 offset:28672
    s_waitcnt lgkmcnt(3)
    v_mfma_f32_16x16x32_bf16 v[68:71], v[28:31], v[52:55], v[68:71]
    v_mfma_f32_16x16x32_bf16 v[100:103], v[44:47], v[52:55], v[100:103]
    ds_read_b128 v[52:55], v7 offset:29696
    s_waitcnt lgkmcnt(3)
    v_mfma_f32_16x16x32_bf16 v[72:75], v[28:31], v[56:59], v[72:75]
    v_mfma_f32_16x16x32_bf16 v[104:107], v[44:47], v[56:59], v[104:107]
    ds_read_b128 v[56:59], v7 offset:30720
    s_waitcnt lgkmcnt(3)
    v_mfma_f32_16x16x32_bf16 v[76:79], v[28:31], v[60:63], v[76:79]
    v_mfma_f32_16x16x32_bf16 v[108:111], v[44:47], v[60:63], v[108:111]
    ds_read_b128 v[60:63], v7 offset:31744
    s_waitcnt lgkmcnt(3)
    v_mfma_f32_16x16x32_bf16 v[80:83], v[28:31], v[48:51], v[80:83]
    v_mfma_f32_16x16x32_bf16 v[112:115], v[44:47], v[48:51], v[112:115]
    s_waitcnt lgkmcnt(2)
    v_mfma_f32_16x16x32_bf16 v[84:87], v[28:31], v[52:55], v[84:87]
    v_mfma_f32_16x16x32_bf16 v[116:119], v[44:47], v[52:55], v[116:119]
    s_waitcnt lgkmcnt(1)
    v_mfma_f32_16x16x32_bf16 v[88:91], v[28:31], v[56:59], v[88:91]
    v_mfma_f32_16x16x32_bf16 v[120:123], v[44:47], v[56:59], v[120:123]
    s_waitcnt lgkmcnt(0)
    v_mfma_f32_16x16x32_bf16 v[92:95], v[28:31], v[60:63], v[92:95]
    v_mfma_f32_16x16x32_bf16 v[124:127], v[44:47], v[60:63], v[124:127]
    s_lshl_b32 s36, s20, 10
    s_add_u32 s24, s26, s36
    v_cvt_pk_bf16_f32 v16, v64, v68
    v_cvt_pk_bf16_f32 v17, v72, v76
    v_cvt_pk_bf16_f32 v18, v80, v84
    s_nop 1
    v_cvt_pk_bf16_f32 v19, v88, v92
    v_and_or_b32 v16, v16, -2, s27
    s_add_u32 s36, s24, 0x0
    buffer_store_dwordx4 v[16:19], v10, s[8:11], s36 offen sc1
    v_cvt_pk_bf16_f32 v20, v65, v69
    v_cvt_pk_bf16_f32 v21, v73, v77
    v_cvt_pk_bf16_f32 v22, v81, v85
    v_cvt_pk_bf16_f32 v23, v89, v93
    v_and_or_b32 v20, v20, -2, s27
    s_add_u32 s36, s24, 0x8000
    buffer_store_dwordx4 v[20:23], v10, s[8:11], s36 offen sc1
    v_cvt_pk_bf16_f32 v24, v66, v70
    v_cvt_pk_bf16_f32 v25, v74, v78
    v_cvt_pk_bf16_f32 v26, v82, v86
    v_cvt_pk_bf16_f32 v27, v90, v94
    v_and_or_b32 v24, v24, -2, s27
    s_add_u32 s36, s24, 0x10000
    buffer_store_dwordx4 v[24:27], v10, s[8:11], s36 offen sc1
    v_cvt_pk_bf16_f32 v28, v67, v71
    v_cvt_pk_bf16_f32 v29, v75, v79
    v_cvt_pk_bf16_f32 v30, v83, v87
    v_cvt_pk_bf16_f32 v31, v91, v95
    v_and_or_b32 v28, v28, -2, s27
    s_add_u32 s36, s24, 0x18000
    buffer_store_dwordx4 v[28:31], v10, s[8:11], s36 offen sc1
    v_cvt_pk_bf16_f32 v32, v96, v100
    v_cvt_pk_bf16_f32 v33, v104, v108
    v_cvt_pk_bf16_f32 v34, v112, v116
    v_cvt_pk_bf16_f32 v35, v120, v124
    v_and_or_b32 v32, v32, -2, s27
    s_add_u32 s36, s24, 0x80000
    buffer_store_dwordx4 v[32:35], v10, s[8:11], s36 offen sc1
    v_cvt_pk_bf16_f32 v36, v97, v101
    v_cvt_pk_bf16_f32 v37, v105, v109
    v_cvt_pk_bf16_f32 v38, v113, v117
    v_cvt_pk_bf16_f32 v39, v121, v125
    v_and_or_b32 v36, v36, -2, s27
    s_add_u32 s36, s24, 0x88000
    buffer_store_dwordx4 v[36:39], v10, s[8:11], s36 offen sc1
    v_cvt_pk_bf16_f32 v40, v98, v102
    v_cvt_pk_bf16_f32 v41, v106, v110
    v_cvt_pk_bf16_f32 v42, v114, v118
    v_cvt_pk_bf16_f32 v43, v122, v126
    v_and_or_b32 v40, v40, -2, s27
    s_add_u32 s36, s24, 0x90000
    buffer_store_dwordx4 v[40:43], v10, s[8:11], s36 offen sc1
    v_cvt_pk_bf16_f32 v44, v99, v103
    v_cvt_pk_bf16_f32 v45, v107, v111
    v_cvt_pk_bf16_f32 v46, v115, v119
    v_cvt_pk_bf16_f32 v47, v123, v127
    v_and_or_b32 v44, v44, -2, s27
    s_add_u32 s36, s24, 0x98000
    buffer_store_dwordx4 v[44:47], v10, s[8:11], s36 offen sc1
    s_lshl_b32 s24, s23, 5
    s_add_u32 s24, s24, s20
    s_lshl_b32 s24, s24, 10
    buffer_load_dword v52, v12, s[12:15], s24 offen
    buffer_load_dword v53, v12, s[92:95], 0 offen
    v_and_b32 v15, 15, v0
    v_mov_b32 v48, 0
    v_mov_b32 v14, 0x3f80
    v_cmp_eq_u32 vcc, 0, v15
    s_nop 1
    v_cndmask_b32 v48, v48, v14, vcc
    v_mov_b32 v14, 0x3f800000
    v_cmp_eq_u32 vcc, 1, v15
    s_nop 1
    v_cndmask_b32 v48, v48, v14, vcc
    v_mov_b32 v49, 0
    v_mov_b32 v14, 0x3f80
    v_cmp_eq_u32 vcc, 4, v15
    s_nop 1
    v_cndmask_b32 v49, v49, v14, vcc
    v_mov_b32 v14, 0x3f800000
    v_cmp_eq_u32 vcc, 5, v15
    s_nop 1
    v_cndmask_b32 v49, v49, v14, vcc
    v_mov_b32 v50, 0
    v_mov_b32 v14, 0x3f80
    v_cmp_eq_u32 vcc, 8, v15
    s_nop 1
    v_cndmask_b32 v50, v50, v14, vcc
    v_mov_b32 v14, 0x3f800000
    v_cmp_eq_u32 vcc, 9, v15
    s_nop 1
    v_cndmask_b32 v50, v50, v14, vcc
    v_mov_b32 v51, 0
    v_mov_b32 v14, 0x3f80
    v_cmp_eq_u32 vcc, 12, v15
    s_nop 1
    v_cndmask_b32 v51, v51, v14, vcc
    v_mov_b32 v14, 0x3f800000
    v_cmp_eq_u32 vcc, 13, v15
    s_nop 1
    v_cndmask_b32 v51, v51, v14, vcc
    s_lshl_b32 s25, s20, 15
    s_add_u32 s25, s25, s26
L_P3_poll:
    s_add_u32 s36, s25, 0
    buffer_load_dwordx4 v[80:83], v11, s[8:11], s36 offen sc1
    s_add_u32 s36, s25, 4096
    buffer_load_dwordx4 v[84:87], v11, s[8:11], s36 offen sc1
    s_add_u32 s36, s25, 8192
    buffer_load_dwordx4 v[88:91], v11, s[8:11], s36 offen sc1
    s_add_u32 s36, s25, 12288
    buffer_load_dwordx4 v[92:95], v11, s[8:11], s36 offen sc1
    s_add_u32 s36, s25, 16384
    buffer_load_dwordx4 v[96:99], v11, s[8:11], s36 offen sc1
    s_add_u32 s36, s25, 20480
    buffer_load_dwordx4 v[100:103], v11, s[8:11], s36 offen sc1
    s_add_u32 s36, s25, 24576
    buffer_load_dwordx4 v[104:107], v11, s[8:11], s36 offen sc1
    s_add_u32 s36, s25, 28672
    buffer_load_dwordx4 v[108:111], v11, s[8:11], s36 offen sc1
    s_mov_b64 exec, -1
    s_add_u32 s32, s32, 1
    s_cmp_gt_u32 s32, 200000
    s_waitcnt vmcnt(7)
    v_mfma_f32_16x16x32_bf16 v[56:59], v[48:51], v[80:83], 0
    s_waitcnt vmcnt(6)
    v_mfma_f32_16x16x32_bf16 v[56:59], v[48:51], v[84:87], v[56:59]
    v_bitop3_b32 v60, v80, v84, s27 bitop3:0x7e
    s_waitcnt vmcnt(5)
    v_mfma_f32_16x16x32_bf16 v[56:59], v[48:51], v[88:91], v[56:59]
    s_waitcnt vmcnt(4)
    v_mfma_f32_16x16x32_bf16 v[56:59], v[48:51], v[92:95], v[56:59]
    v_bitop3_b32 v61, v88, v92, s27 bitop3:0x7e
    s_waitcnt vmcnt(3)
    v_mfma_f32_16x16x32_bf16 v[56:59], v[48:51], v[96:99], v[56:59]
    s_waitcnt vmcnt(2)
    v_mfma_f32_16x16x32_bf16 v[56:59], v[48:51], v[100:103], v[56:59]
    v_bitop3_b32 v62, v96, v100, s27 bitop3:0x7e
    s_waitcnt vmcnt(1)
    v_mfma_f32_16x16x32_bf16 v[56:59], v[48:51], v[104:107], v[56:59]
    s_waitcnt vmcnt(0)
    v_mfma_f32_16x16x32_bf16 v[56:59], v[48:51], v[108:111], v[56:59]
    v_bitop3_b32 v63, v104, v108, s27 bitop3:0x7e
    v_or3_b32 v14, v60, v61, v62
    v_bitop3_b32 v14, v14, v63, 1 bitop3:0xa8
    s_cbranch_scc1 L_P3_got
    v_cmp_ne_u32 vcc, 0, v14
    s_cbranch_vccz L_P3_got
    s_mov_b64 exec, vcc
    s_branch L_P3_poll
L_P3_got:
    s_nop 4
    v_cvt_pk_bf16_f32 v62, v56, v57
    v_lshlrev_b32 v65, 16, v62
    v_and_b32 v66, 0xffff0000, v62
    v_lshlrev_b32 v60, 16, v52
    v_and_b32 v61, 0xffff0000, v52
    v_add_f32 v60, v60, v65
    v_add_f32 v61, v61, v66
    v_cvt_pk_bf16_f32 v62, v60, v61
    v_lshlrev_b32 v60, 16, v62
    v_and_b32 v61, 0xffff0000, v62
    v_add_f32 v63, v60, v61
    v_mul_f32 v64, v60, v60
    v_fmac_f32 v64, v61, v61
    v_add_f32_dpp v63, v63, v63 quad_perm:[1,0,3,2] row_mask:0xf bank_mask:0xf
    s_nop 0
    v_add_f32_dpp v64, v64, v64 quad_perm:[1,0,3,2] row_mask:0xf bank_mask:0xf
    v_add_f32_dpp v63, v63, v63 quad_perm:[2,3,0,1] row_mask:0xf bank_mask:0xf
    s_nop 0
    v_add_f32_dpp v64, v64, v64 quad_perm:[2,3,0,1] row_mask:0xf bank_mask:0xf
    v_add_f32_dpp v63, v63, v63 row_half_mirror row_mask:0xf bank_mask:0xf
    s_nop 0
    v_add_f32_dpp v64, v64, v64 row_half_mirror row_mask:0xf bank_mask:0xf
    v_add_f32_dpp v63, v63, v63 row_mirror row_mask:0xf bank_mask:0xf
    s_nop 0
    v_add_f32_dpp v64, v64, v64 row_mirror row_mask:0xf bank_mask:0xf
    v_mov_b32 v14, v63
    s_nop 1
    v_permlane16_swap_b32 v63, v14
    v_add_f32 v63, v63, v14
    v_mov_b32 v14, v64
    s_nop 1
    v_permlane16_swap_b32 v64, v14
    v_add_f32 v64, v64, v14
    v_mov_b32 v14, v63
    s_nop 1
    v_permlane32_swap_b32 v63, v14
    v_add_f32 v63, v63, v14
    v_mov_b32 v14, v64
    s_nop 1
    v_permlane32_swap_b32 v64, v14
    v_add_f32 v64, v64, v14
    v_mov_b32 v15, s21
    v_lshlrev_b32 v15, 3, v15
    v_add_u32 v15, 28672, v15
    ds_write2_b32 v15, v63, v64 offset0:0 offset1:1
    s_add_u32 s36, s24, 0x400000
    buffer_store_dword v62, v12, s[8:11], s36 offen sc1
    s_waitcnt lgkmcnt(0)
    s_barrier
    v_mov_b32 v15, 28672
    ds_read_b128 v[68:71], v15
    ds_read_b128 v[72:75], v15 offset:16
    s_waitcnt lgkmcnt(0)
    v_add_f32 v63, v68, v70
    v_add_f32 v63, v63, v72
    v_add_f32 v63, v63, v74
    v_mul_f32 v63, 0x3b000000, v63
    v_add_f32 v64, v69, v71
    v_add_f32 v64, v64, v73
    v_add_f32 v64, v64, v75
    v_mul_f32 v64, 0x3b000000, v64
    v_fma_f32 v64, -v63, v63, v64
    v_max_f32 v64, 0, v64
    v_cvt_pk_bf16_f32 v14, v63, v64
    v_lshlrev_b32 v63, 16, v14
    v_and_b32 v64, 0xffff0000, v14
    v_add_f32 v64, 0x3727c5ac, v64
    v_cvt_pk_bf16_f32 v14, v64, v64
    v_lshlrev_b32 v64, 16, v14
    v_sqrt_f32 v64, v64
    s_nop 0
    v_cvt_pk_bf16_f32 v14, v64, v64
    v_lshlrev_b32 v64, 16, v14
    v_rcp_f32 v64, v64
    v_sub_f32 v65, v60, v63
    v_sub_f32 v66, v61, v63
    v_cvt_pk_bf16_f32 v14, v65, v66
    v_lshlrev_b32 v65, 16, v14
    v_and_b32 v66, 0xffff0000, v14
    v_mul_f32 v65, v65, v64
    v_mul_f32 v66, v66, v64
    v_cvt_pk_bf16_f32 v67, v65, v66
    v_lshlrev_b32 v65, 16, v67
    v_and_b32 v66, 0xffff0000, v67
    v_lshlrev_b32 v68, 16, v53
    v_and_b32 v69, 0xffff0000, v53
    v_mul_f32 v63, v65, v68
    v_fmac_f32 v63, v66, v69
    s_nop 1
    v_add_f32_dpp v63, v63, v63 quad_perm:[1,0,3,2] row_mask:0xf bank_mask:0xf
    s_nop 1
    v_add_f32_dpp v63, v63, v63 quad_perm:[2,3,0,1] row_mask:0xf bank_mask:0xf
    s_nop 1
    v_add_f32_dpp v63, v63, v63 row_half_mirror row_mask:0xf bank_mask:0xf
    s_nop 1
    v_add_f32_dpp v63, v63, v63 row_mirror row_mask:0xf bank_mask:0xf
    v_mov_b32 v14, v63
    s_nop 1
    v_permlane16_swap_b32 v63, v14
    v_add_f32 v63, v63, v14
    v_mov_b32 v14, v63
    s_nop 1
    v_permlane32_swap_b32 v63, v14
    v_add_f32 v63, v63, v14
    s_lshr_b32 s25, s24, 6
    s_lshl_b32 s37, s21, 2
    s_add_u32 s25, s25, s37
    s_add_u32 s36, s25, 0x194000
    v_cmp_ne_u32 vcc, 0, v1
    v_mov_b32 v15, 0x40000000
    s_nop 0
    v_cndmask_b32 v15, v1, v15, vcc
    buffer_store_dword v63, v15, s[8:11], s36 offen sc1
    v_add_f32 v60, v60, v65
    v_add_f32 v61, v61, v66
    v_cvt_pk_bf16_f32 v62, v60, v61
    buffer_store_dword v62, v12, s[60:63], s24 offen sc1
    s_add_u32 s36, s24, 0x600000
    buffer_store_dword v67, v12, s[8:11], s36 offen sc1
    v_mov_b32 v14, 0
    s_add_u32 s36, s25, 0x1b8000
    s_waitcnt vmcnt(0)
    buffer_store_dword v14, v15, s[8:11], s36 offen sc1
    s_add_u32 s29, s29, 1
    s_barrier
    s_add_u32 s23, s23, 6
    s_cmp_lt_u32 s23, 64
    s_cbranch_scc1 L_P2
    s_branch L_end
L_mlp:
    s_lshr_b32 s20, s2, 3
    s_mov_b32 s34, 0x05040100
    s_mov_b32 s35, 0x07060302
    s_mov_b32 s32, 0
    s_mov_b32 s64, s84
    s_and_b32 s65, s85, 0xffff
    s_mov_b32 s66, 0x1c0000
    s_mov_b32 s67, 0x20000
    s_mov_b32 s68, s86
    s_and_b32 s69, s87, 0xffff
    s_mov_b32 s70, 0x1c0000
    s_mov_b32 s71, 0x20000
    s_mov_b32 s76, s88
    s_and_b32 s77, s89, 0xffff
    s_mov_b32 s78, 0x1c0000
    s_mov_b32 s79, 0x20000
    v_and_b32 v3, 31, v0
    v_lshlrev_b32 v3, 2, v3
L_M_hs:
    buffer_load_dword v5, v3, s[16:19], 0 offen offset:128 sc1
    s_add_u32 s32, s32, 1
    s_cmp_gt_u32 s32, 200000
    s_waitcnt vmcnt(0)
    s_cbranch_scc1 L_M_hs_ok
    v_cmp_eq_u32 vcc, 0, v5
    s_cbranch_vccz L_M_hs_ok
    s_sleep 16
    s_branch L_M_hs
L_M_hs_ok:
    v_lshlrev_b32 v3, 4, v0
L_M00_rp:
    s_mov_b32 s36, 0x194000
    buffer_load_dwordx4 v[16:19], v3, s[8:11], s36 offen sc1
    s_add_u32 s32, s32, 1
    v_mov_b32 v5, 0
    s_waitcnt vmcnt(0)
    v_max3_u32 v5, v5, v16, v17
    v_max3_u32 v5, v5, v18, v19
    s_cmp_gt_u32 s32, 200000
    s_cbranch_scc1 L_M00_rp_ok
    v_cmp_eq_u32 vcc, -1, v5
    s_cbranch_vccz L_M00_rp_ok
    s_sleep 64
    s_branch L_M00_rp
L_M00_rp_ok:
    v_add_f32 v16, v16, v17
    v_add_f32 v18, v18, v19
    v_add_f32 v16, v16, v18
    v_cvt_pk_bf16_f32 v5, v16, v16
    v_lshlrev_b32 v16, 16, v5
    v_ashrrev_i32 v5, 31, v16
    v_or_b32 v5, 0x80000000, v5
    v_xor_b32 v5, v5, v16
    v_and_b32 v5, 0xffff0000, v5
    v_sub_u32 v6, 2047, v0
    v_or_b32 v120, v5, v6
    v_lshrrev_b32 v1, 5, v0
    v_and_b32 v2, 31, v0
    s_mov_b32 s36, 229376
    v_mul_lo_u32 v4, v1, s36
    v_lshl_add_u32 v4, v2, 2, v4
    v_mov_b32 v5, 0x40000000
    v_cmp_lt_u32 vcc, 27, v2
    s_nop 1
    v_cndmask_b32 v4, v4, v5, vcc
    s_mul_i32 s23, s20, 112
    s_add_u32 s36, s23, 0
    buffer_load_dword v16, v4, s[64:67], s36 offen
    s_add_u32 s36, s23, 3584
    buffer_load_dword v17, v4, s[64:67], s36 offen
    s_add_u32 s36, s23, 7168
    buffer_load_dword v18, v4, s[64:67], s36 offen
    s_add_u32 s36, s23, 10752
    buffer_load_dword v19, v4, s[64:67], s36 offen
    s_add_u32 s36, s23, 14336
    buffer_load_dword v20, v4, s[64:67], s36 offen
    s_add_u32 s36, s23, 17920
    buffer_load_dword v21, v4, s[64:67], s36 offen
    s_add_u32 s36, s23, 21504
    buffer_load_dword v22, v4, s[64:67], s36 offen
    s_add_u32 s36, s23, 25088
    buffer_load_dword v23, v4, s[64:67], s36 offen
    s_add_u32 s36, s23, 28672
    buffer_load_dword v24, v4, s[64:67], s36 offen
    s_add_u32 s36, s23, 32256
    buffer_load_dword v25, v4, s[64:67], s36 offen
    s_add_u32 s36, s23, 35840
    buffer_load_dword v26, v4, s[64:67], s36 offen
    s_add_u32 s36, s23, 39424
    buffer_load_dword v27, v4, s[64:67], s36 offen
    s_add_u32 s36, s23, 43008
    buffer_load_dword v28, v4, s[64:67], s36 offen
    s_add_u32 s36, s23, 46592
    buffer_load_dword v29, v4, s[64:67], s36 offen
    s_add_u32 s36, s23, 50176
    buffer_load_dword v30, v4, s[64:67], s36 offen
    s_add_u32 s36, s23, 53760
    buffer_load_dword v31, v4, s[64:67], s36 offen
    s_add_u32 s36, s23, 57344
    buffer_load_dword v32, v4, s[64:67], s36 offen
    s_add_u32 s36, s23, 60928
    buffer_load_dword v33, v4, s[64:67], s36 offen
    s_add_u32 s36, s23, 64512
    buffer_load_dword v34, v4, s[64:67], s36 offen
    s_add_u32 s36, s23, 68096
    buffer_load_dword v35, v4, s[64:67], s36 offen
    s_add_u32 s36, s23, 71680
    buffer_load_dword v36, v4, s[64:67], s36 offen
    s_add_u32 s36, s23, 75264
    buffer_load_dword v37, v4, s[64:67], s36 offen
    s_add_u32 s36, s23, 78848
    buffer_load_dword v38, v4, s[64:67], s36 offen
    s_add_u32 s36, s23, 82432
    buffer_load_dword v39, v4, s[64:67], s36 offen
    s_add_u32 s36, s23, 86016
    buffer_load_dword v40, v4, s[64:67], s36 offen
    s_add_u32 s36, s23, 89600
    buffer_load_dword v41, v4, s[64:67], s36 offen
    s_add_u32 s36, s23, 93184
    buffer_load_dword v42, v4, s[64:67], s36 offen
    s_add_u32 s36, s23, 96768
    buffer_load_dword v43, v4, s[64:67], s36 offen
    s_add_u32 s36, s23, 100352
    buffer_load_dword v44, v4, s[64:67], s36 offen
    s_add_u32 s36, s23, 103936
    buffer_load_dword v45, v4, s[64:67], s36 offen
    s_add_u32 s36, s23, 107520
    buffer_load_dword v46, v4, s[64:67], s36 offen
    s_add_u32 s36, s23, 111104
    buffer_load_dword v47, v4, s[64:67], s36 offen
    s_waitcnt vmcnt(0)
    v_perm_b32 v128, v17, v16, s34
    v_perm_b32 v129, v19, v18, s34
    v_perm_b32 v130, v21, v20, s34
    v_perm_b32 v131, v23, v22, s34
    v_perm_b32 v132, v25, v24, s34
    v_perm_b32 v133, v27, v26, s34
    v_perm_b32 v134, v29, v28, s34
    v_perm_b32 v135, v31, v30, s34
    v_perm_b32 v136, v33, v32, s34
    v_perm_b32 v137, v35, v34, s34
    v_perm_b32 v138, v37, v36, s34
    v_perm_b32 v139, v39, v38, s34
    v_perm_b32 v140, v41, v40, s34
    v_perm_b32 v141, v43, v42, s34
    v_perm_b32 v142, v45, v44, s34
    v_perm_b32 v143, v47, v46, s34
    v_perm_b32 v160, v17, v16, s35
    v_perm_b32 v161, v19, v18, s35
    v_perm_b32 v162, v21, v20, s35
    v_perm_b32 v163, v23, v22, s35
    v_perm_b32 v164, v25, v24, s35
    v_perm_b32 v165, v27, v26, s35
    v_perm_b32 v166, v29, v28, s35
    v_perm_b32 v167, v31, v30, s35
    v_perm_b32 v168, v33, v32, s35
    v_perm_b32 v169, v35, v34, s35
    v_perm_b32 v170, v37, v36, s35
    v_perm_b32 v171, v39, v38, s35
    v_perm_b32 v172, v41, v40, s35
    v_perm_b32 v173, v43, v42, s35
    v_perm_b32 v174, v45, v44, s35
    v_perm_b32 v175, v47, v46, s35
    s_add_u32 s36, s23, 114688
    buffer_load_dword v16, v4, s[64:67], s36 offen
    s_add_u32 s36, s23, 118272
    buffer_load_dword v17, v4, s[64:67], s36 offen
    s_add_u32 s36, s23, 121856
    buffer_load_dword v18, v4, s[64:67], s36 offen
    s_add_u32 s36, s23, 125440
    buffer_load_dword v19, v4, s[64:67], s36 offen
    s_add_u32 s36, s23, 129024
    buffer_load_dword v20, v4, s[64:67], s36 offen
    s_add_u32 s36, s23, 132608
    buffer_load_dword v21, v4, s[64:67], s36 offen
    s_add_u32 s36, s23, 136192
    buffer_load_dword v22, v4, s[64:67], s36 offen
    s_add_u32 s36, s23, 139776
    buffer_load_dword v23, v4, s[64:67], s36 offen
    s_add_u32 s36, s23, 143360
    buffer_load_dword v24, v4, s[64:67], s36 offen
    s_add_u32 s36, s23, 146944
    buffer_load_dword v25, v4, s[64:67], s36 offen
    s_add_u32 s36, s23, 150528
    buffer_load_dword v26, v4, s[64:67], s36 offen
    s_add_u32 s36, s23, 154112
    buffer_load_dword v27, v4, s[64:67], s36 offen
    s_add_u32 s36, s23, 157696
    buffer_load_dword v28, v4, s[64:67], s36 offen
    s_add_u32 s36, s23, 161280
    buffer_load_dword v29, v4, s[64:67], s36 offen
    s_add_u32 s36, s23, 164864
    buffer_load_dword v30, v4, s[64:67], s36 offen
    s_add_u32 s36, s23, 168448
    buffer_load_dword v31, v4, s[64:67], s36 offen
    s_add_u32 s36, s23, 172032
    buffer_load_dword v32, v4, s[64:67], s36 offen
    s_add_u32 s36, s23, 175616
    buffer_load_dword v33, v4, s[64:67], s36 offen
    s_add_u32 s36, s23, 179200
    buffer_load_dword v34, v4, s[64:67], s36 offen
    s_add_u32 s36, s23, 182784
    buffer_load_dword v35, v4, s[64:67], s36 offen
    s_add_u32 s36, s23, 186368
    buffer_load_dword v36, v4, s[64:67], s36 offen
    s_add_u32 s36, s23, 189952
    buffer_load_dword v37, v4, s[64:67], s36 offen
    s_add_u32 s36, s23, 193536
    buffer_load_dword v38, v4, s[64:67], s36 offen
    s_add_u32 s36, s23, 197120
    buffer_load_dword v39, v4, s[64:67], s36 offen
    s_add_u32 s36, s23, 200704
    buffer_load_dword v40, v4, s[64:67], s36 offen
    s_add_u32 s36, s23, 204288
    buffer_load_dword v41, v4, s[64:67], s36 offen
    s_add_u32 s36, s23, 207872
    buffer_load_dword v42, v4, s[64:67], s36 offen
    s_add_u32 s36, s23, 211456
    buffer_load_dword v43, v4, s[64:67], s36 offen
    s_add_u32 s36, s23, 215040
    buffer_load_dword v44, v4, s[64:67], s36 offen
    s_add_u32 s36, s23, 218624
    buffer_load_dword v45, v4, s[64:67], s36 offen
    s_add_u32 s36, s23, 222208
    buffer_load_dword v46, v4, s[64:67], s36 offen
    s_add_u32 s36, s23, 225792
    buffer_load_dword v47, v4, s[64:67], s36 offen
    s_waitcnt vmcnt(0)
    v_perm_b32 v144, v17, v16, s34
    v_perm_b32 v145, v19, v18, s34
    v_perm_b32 v146, v21, v20, s34
    v_perm_b32 v147, v23, v22, s34
    v_perm_b32 v148, v25, v24, s34
    v_perm_b32 v149, v27, v26, s34
    v_perm_b32 v150, v29, v28, s34
    v_perm_b32 v151, v31, v30, s34
    v_perm_b32 v152, v33, v32, s34
    v_perm_b32 v153, v35, v34, s34
    v_perm_b32 v154, v37, v36, s34
    v_perm_b32 v155, v39, v38, s34
    v_perm_b32 v156, v41, v40, s34
    v_perm_b32 v157, v43, v42, s34
    v_perm_b32 v158, v45, v44, s34
    v_perm_b32 v159, v47, v46, s34
    v_perm_b32 v176, v17, v16, s35
    v_perm_b32 v177, v19, v18, s35
    v_perm_b32 v178, v21, v20, s35
    v_perm_b32 v179, v23, v22, s35
    v_perm_b32 v180, v25, v24, s35
    v_perm_b32 v181, v27, v26, s35
    v_perm_b32 v182, v29, v28, s35
    v_perm_b32 v183, v31, v30, s35
    v_perm_b32 v184, v33, v32, s35
    v_perm_b32 v185, v35, v34, s35
    v_perm_b32 v186, v37, v36, s35
    v_perm_b32 v187, v39, v38, s35
    v_perm_b32 v188, v41, v40, s35
    v_perm_b32 v189, v43, v42, s35
    v_perm_b32 v190, v45, v44, s35
    v_perm_b32 v191, v47, v46, s35
    s_add_u32 s36, s23, 0
    buffer_load_dword v16, v4, s[68:71], s36 offen
    s_add_u32 s36, s23, 3584
    buffer_load_dword v17, v4, s[68:71], s36 offen
    s_add_u32 s36, s23, 7168
    buffer_load_dword v18, v4, s[68:71], s36 offen
    s_add_u32 s36, s23, 10752
    buffer_load_dword v19, v4, s[68:71], s36 offen
    s_add_u32 s36, s23, 14336
    buffer_load_dword v20, v4, s[68:71], s36 offen
    s_add_u32 s36, s23, 17920
    buffer_load_dword v21, v4, s[68:71], s36 offen
    s_add_u32 s36, s23, 21504
    buffer_load_dword v22, v4, s[68:71], s36 offen
    s_add_u32 s36, s23, 25088
    buffer_load_dword v23, v4, s[68:71], s36 offen
    s_add_u32 s36, s23, 28672
    buffer_load_dword v24, v4, s[68:71], s36 offen
    s_add_u32 s36, s23, 32256
    buffer_load_dword v25, v4, s[68:71], s36 offen
    s_add_u32 s36, s23, 35840
    buffer_load_dword v26, v4, s[68:71], s36 offen
    s_add_u32 s36, s23, 39424
    buffer_load_dword v27, v4, s[68:71], s36 offen
    s_add_u32 s36, s23, 43008
    buffer_load_dword v28, v4, s[68:71], s36 offen
    s_add_u32 s36, s23, 46592
    buffer_load_dword v29, v4, s[68:71], s36 offen
    s_add_u32 s36, s23, 50176
    buffer_load_dword v30, v4, s[68:71], s36 offen
    s_add_u32 s36, s23, 53760
    buffer_load_dword v31, v4, s[68:71], s36 offen
    s_add_u32 s36, s23, 57344
    buffer_load_dword v32, v4, s[68:71], s36 offen
    s_add_u32 s36, s23, 60928
    buffer_load_dword v33, v4, s[68:71], s36 offen
    s_add_u32 s36, s23, 64512
    buffer_load_dword v34, v4, s[68:71], s36 offen
    s_add_u32 s36, s23, 68096
    buffer_load_dword v35, v4, s[68:71], s36 offen
    s_add_u32 s36, s23, 71680
    buffer_load_dword v36, v4, s[68:71], s36 offen
    s_add_u32 s36, s23, 75264
    buffer_load_dword v37, v4, s[68:71], s36 offen
    s_add_u32 s36, s23, 78848
    buffer_load_dword v38, v4, s[68:71], s36 offen
    s_add_u32 s36, s23, 82432
    buffer_load_dword v39, v4, s[68:71], s36 offen
    s_add_u32 s36, s23, 86016
    buffer_load_dword v40, v4, s[68:71], s36 offen
    s_add_u32 s36, s23, 89600
    buffer_load_dword v41, v4, s[68:71], s36 offen
    s_add_u32 s36, s23, 93184
    buffer_load_dword v42, v4, s[68:71], s36 offen
    s_add_u32 s36, s23, 96768
    buffer_load_dword v43, v4, s[68:71], s36 offen
    s_add_u32 s36, s23, 100352
    buffer_load_dword v44, v4, s[68:71], s36 offen
    s_add_u32 s36, s23, 103936
    buffer_load_dword v45, v4, s[68:71], s36 offen
    s_add_u32 s36, s23, 107520
    buffer_load_dword v46, v4, s[68:71], s36 offen
    s_add_u32 s36, s23, 111104
    buffer_load_dword v47, v4, s[68:71], s36 offen
    s_waitcnt vmcnt(0)
    v_perm_b32 v192, v17, v16, s34
    v_perm_b32 v193, v19, v18, s34
    v_perm_b32 v194, v21, v20, s34
    v_perm_b32 v195, v23, v22, s34
    v_perm_b32 v196, v25, v24, s34
    v_perm_b32 v197, v27, v26, s34
    v_perm_b32 v198, v29, v28, s34
    v_perm_b32 v199, v31, v30, s34
    v_perm_b32 v200, v33, v32, s34
    v_perm_b32 v201, v35, v34, s34
    v_perm_b32 v202, v37, v36, s34
    v_perm_b32 v203, v39, v38, s34
    v_perm_b32 v204, v41, v40, s34
    v_perm_b32 v205, v43, v42, s34
    v_perm_b32 v206, v45, v44, s34
    v_perm_b32 v207, v47, v46, s34
    v_perm_b32 v224, v17, v16, s35
    v_perm_b32 v225, v19, v18, s35
    v_perm_b32 v226, v21, v20, s35
    v_perm_b32 v227, v23, v22, s35
    v_perm_b32 v228, v25, v24, s35
    v_perm_b32 v229, v27, v26, s35
    v_perm_b32 v230, v29, v28, s35
    v_perm_b32 v231, v31, v30, s35
    v_perm_b32 v232, v33, v32, s35
    v_perm_b32 v233, v35, v34, s35
    v_perm_b32 v234, v37, v36, s35
    v_perm_b32 v235, v39, v38, s35
    v_perm_b32 v236, v41, v40, s35
    v_perm_b32 v237, v43, v42, s35
    v_perm_b32 v238, v45, v44, s35
    v_perm_b32 v239, v47, v46, s35
    s_add_u32 s36, s23, 114688
    buffer_load_dword v16, v4, s[68:71], s36 offen
    s_add_u32 s36, s23, 118272
    buffer_load_dword v17, v4, s[68:71], s36 offen
    s_add_u32 s36, s23, 121856
    buffer_load_dword v18, v4, s[68:71], s36 offen
    s_add_u32 s36, s23, 125440
    buffer_load_dword v19, v4, s[68:71], s36 offen
    s_add_u32 s36, s23, 129024
    buffer_load_dword v20, v4, s[68:71], s36 offen
    s_add_u32 s36, s23, 132608
    buffer_load_dword v21, v4, s[68:71], s36 offen
    s_add_u32 s36, s23, 136192
    buffer_load_dword v22, v4, s[68:71], s36 offen
    s_add_u32 s36, s23, 139776
    buffer_load_dword v23, v4, s[68:71], s36 offen
    s_add_u32 s36, s23, 143360
    buffer_load_dword v24, v4, s[68:71], s36 offen
    s_add_u32 s36, s23, 146944
    buffer_load_dword v25, v4, s[68:71], s36 offen
    s_add_u32 s36, s23, 150528
    buffer_load_dword v26, v4, s[68:71], s36 offen
    s_add_u32 s36, s23, 154112
    buffer_load_dword v27, v4, s[68:71], s36 offen
    s_add_u32 s36, s23, 157696
    buffer_load_dword v28, v4, s[68:71], s36 offen
    s_add_u32 s36, s23, 161280
    buffer_load_dword v29, v4, s[68:71], s36 offen
    s_add_u32 s36, s23, 164864
    buffer_load_dword v30, v4, s[68:71], s36 offen
    s_add_u32 s36, s23, 168448
    buffer_load_dword v31, v4, s[68:71], s36 offen
    s_add_u32 s36, s23, 172032
    buffer_load_dword v32, v4, s[68:71], s36 offen
    s_add_u32 s36, s23, 175616
    buffer_load_dword v33, v4, s[68:71], s36 offen
    s_add_u32 s36, s23, 179200
    buffer_load_dword v34, v4, s[68:71], s36 offen
    s_add_u32 s36, s23, 182784
    buffer_load_dword v35, v4, s[68:71], s36 offen
    s_add_u32 s36, s23, 186368
    buffer_load_dword v36, v4, s[68:71], s36 offen
    s_add_u32 s36, s23, 189952
    buffer_load_dword v37, v4, s[68:71], s36 offen
    s_add_u32 s36, s23, 193536
    buffer_load_dword v38, v4, s[68:71], s36 offen
    s_add_u32 s36, s23, 197120
    buffer_load_dword v39, v4, s[68:71], s36 offen
    s_add_u32 s36, s23, 200704
    buffer_load_dword v40, v4, s[68:71], s36 offen
    s_add_u32 s36, s23, 204288
    buffer_load_dword v41, v4, s[68:71], s36 offen
    s_add_u32 s36, s23, 207872
    buffer_load_dword v42, v4, s[68:71], s36 offen
    s_add_u32 s36, s23, 211456
    buffer_load_dword v43, v4, s[68:71], s36 offen
    s_add_u32 s36, s23, 215040
    buffer_load_dword v44, v4, s[68:71], s36 offen
    s_add_u32 s36, s23, 218624
    buffer_load_dword v45, v4, s[68:71], s36 offen
    s_add_u32 s36, s23, 222208
    buffer_load_dword v46, v4, s[68:71], s36 offen
    s_add_u32 s36, s23, 225792
    buffer_load_dword v47, v4, s[68:71], s36 offen
    s_waitcnt vmcnt(0)
    v_perm_b32 v208, v17, v16, s34
    v_perm_b32 v209, v19, v18, s34
    v_perm_b32 v210, v21, v20, s34
    v_perm_b32 v211, v23, v22, s34
    v_perm_b32 v212, v25, v24, s34
    v_perm_b32 v213, v27, v26, s34
    v_perm_b32 v214, v29, v28, s34
    v_perm_b32 v215, v31, v30, s34
    v_perm_b32 v216, v33, v32, s34
    v_perm_b32 v217, v35, v34, s34
    v_perm_b32 v218, v37, v36, s34
    v_perm_b32 v219, v39, v38, s34
    v_perm_b32 v220, v41, v40, s34
    v_perm_b32 v221, v43, v42, s34
    v_perm_b32 v222, v45, v44, s34
    v_perm_b32 v223, v47, v46, s34
    v_perm_b32 v240, v17, v16, s35
    v_perm_b32 v241, v19, v18, s35
    v_perm_b32 v242, v21, v20, s35
    v_perm_b32 v243, v23, v22, s35
    v_perm_b32 v244, v25, v24, s35
    v_perm_b32 v245, v27, v26, s35
    v_perm_b32 v246, v29, v28, s35
    v_perm_b32 v247, v31, v30, s35
    v_perm_b32 v248, v33, v32, s35
    v_perm_b32 v249, v35, v34, s35
    v_perm_b32 v250, v37, v36, s35
    v_perm_b32 v251, v39, v38, s35
    v_perm_b32 v252, v41, v40, s35
    v_perm_b32 v253, v43, v42, s35
    v_perm_b32 v254, v45, v44, s35
    v_perm_b32 v255, v47, v46, s35
    v_lshrrev_b32 v3, 3, v0
    v_mul_u32_u24 v4, 57344, v3
    v_and_b32 v3, 7, v0
    v_lshl_add_u32 v4, v3, 2, v4
    s_lshl_b32 s37, s20, 5
    s_add_u32 s36, s37, 0
    buffer_load_dword v16, v4, s[76:79], s36 offen
    s_add_u32 s36, s37, 1024
    buffer_load_dword v17, v4, s[76:79], s36 offen
    s_add_u32 s36, s37, 2048
    buffer_load_dword v18, v4, s[76:79], s36 offen
    s_add_u32 s36, s37, 3072
    buffer_load_dword v19, v4, s[76:79], s36 offen
    s_add_u32 s36, s37, 4096
    buffer_load_dword v20, v4, s[76:79], s36 offen
    s_add_u32 s36, s37, 5120
    buffer_load_dword v21, v4, s[76:79], s36 offen
    s_add_u32 s36, s37, 6144
    buffer_load_dword v22, v4, s[76:79], s36 offen
    s_add_u32 s36, s37, 7168
    buffer_load_dword v23, v4, s[76:79], s36 offen
    s_add_u32 s36, s37, 8192
    buffer_load_dword v24, v4, s[76:79], s36 offen
    s_add_u32 s36, s37, 9216
    buffer_load_dword v25, v4, s[76:79], s36 offen
    s_add_u32 s36, s37, 10240
    buffer_load_dword v26, v4, s[76:79], s36 offen
    s_add_u32 s36, s37, 11264
    buffer_load_dword v27, v4, s[76:79], s36 offen
    s_add_u32 s36, s37, 12288
    buffer_load_dword v28, v4, s[76:79], s36 offen
    s_add_u32 s36, s37, 13312
    buffer_load_dword v29, v4, s[76:79], s36 offen
    s_add_u32 s36, s37, 14336
    buffer_load_dword v30, v4, s[76:79], s36 offen
    s_add_u32 s36, s37, 15360
    buffer_load_dword v31, v4, s[76:79], s36 offen
    s_add_u32 s36, s37, 16384
    buffer_load_dword v32, v4, s[76:79], s36 offen
    s_add_u32 s36, s37, 17408
    buffer_load_dword v33, v4, s[76:79], s36 offen
    s_add_u32 s36, s37, 18432
    buffer_load_dword v34, v4, s[76:79], s36 offen
    s_add_u32 s36, s37, 19456
    buffer_load_dword v35, v4, s[76:79], s36 offen
    s_add_u32 s36, s37, 20480
    buffer_load_dword v36, v4, s[76:79], s36 offen
    s_add_u32 s36, s37, 21504
    buffer_load_dword v37, v4, s[76:79], s36 offen
    s_add_u32 s36, s37, 22528
    buffer_load_dword v38, v4, s[76:79], s36 offen
    s_add_u32 s36, s37, 23552
    buffer_load_dword v39, v4, s[76:79], s36 offen
    s_add_u32 s36, s37, 24576
    buffer_load_dword v40, v4, s[76:79], s36 offen
    s_add_u32 s36, s37, 25600
    buffer_load_dword v41, v4, s[76:79], s36 offen
    s_add_u32 s36, s37, 26624
    buffer_load_dword v42, v4, s[76:79], s36 offen
    s_add_u32 s36, s37, 27648
    buffer_load_dword v43, v4, s[76:79], s36 offen
    s_waitcnt vmcnt(0)
    v_perm_b32 v64, v17, v16, s34
    v_perm_b32 v65, v19, v18, s34
    v_perm_b32 v66, v21, v20, s34
    v_perm_b32 v67, v23, v22, s34
    v_perm_b32 v68, v25, v24, s34
    v_perm_b32 v69, v27, v26, s34
    v_perm_b32 v70, v29, v28, s34
    v_perm_b32 v71, v31, v30, s34
    v_perm_b32 v72, v33, v32, s34
    v_perm_b32 v73, v35, v34, s34
    v_perm_b32 v74, v37, v36, s34
    v_perm_b32 v75, v39, v38, s34
    v_perm_b32 v76, v41, v40, s34
    v_perm_b32 v77, v43, v42, s34
    v_perm_b32 v92, v17, v16, s35
    v_perm_b32 v93, v19, v18, s35
    v_perm_b32 v94, v21, v20, s35
    v_perm_b32 v95, v23, v22, s35
    v_perm_b32 v96, v25, v24, s35
    v_perm_b32 v97, v27, v26, s35
    v_perm_b32 v98, v29, v28, s35
    v_perm_b32 v99, v31, v30, s35
    v_perm_b32 v100, v33, v32, s35
    v_perm_b32 v101, v35, v34, s35
    v_perm_b32 v102, v37, v36, s35
    v_perm_b32 v103, v39, v38, s35
    v_perm_b32 v104, v41, v40, s35
    v_perm_b32 v105, v43, v42, s35
    s_add_u32 s36, s37, 28672
    buffer_load_dword v16, v4, s[76:79], s36 offen
    s_add_u32 s36, s37, 29696
    buffer_load_dword v17, v4, s[76:79], s36 offen
    s_add_u32 s36, s37, 30720
    buffer_load_dword v18, v4, s[76:79], s36 offen
    s_add_u32 s36, s37, 31744
    buffer_load_dword v19, v4, s[76:79], s36 offen
    s_add_u32 s36, s37, 32768
    buffer_load_dword v20, v4, s[76:79], s36 offen
    s_add_u32 s36, s37, 33792
    buffer_load_dword v21, v4, s[76:79], s36 offen
    s_add_u32 s36, s37, 34816
    buffer_load_dword v22, v4, s[76:79], s36 offen
    s_add_u32 s36, s37, 35840
    buffer_load_dword v23, v4, s[76:79], s36 offen
    s_add_u32 s36, s37, 36864
    buffer_load_dword v24, v4, s[76:79], s36 offen
    s_add_u32 s36, s37, 37888
    buffer_load_dword v25, v4, s[76:79], s36 offen
    s_add_u32 s36, s37, 38912
    buffer_load_dword v26, v4, s[76:79], s36 offen
    s_add_u32 s36, s37, 39936
    buffer_load_dword v27, v4, s[76:79], s36 offen
    s_add_u32 s36, s37, 40960
    buffer_load_dword v28, v4, s[76:79], s36 offen
    s_add_u32 s36, s37, 41984
    buffer_load_dword v29, v4, s[76:79], s36 offen
    s_add_u32 s36, s37, 43008
    buffer_load_dword v30, v4, s[76:79], s36 offen
    s_add_u32 s36, s37, 44032
    buffer_load_dword v31, v4, s[76:79], s36 offen
    s_add_u32 s36, s37, 45056
    buffer_load_dword v32, v4, s[76:79], s36 offen
    s_add_u32 s36, s37, 46080
    buffer_load_dword v33, v4, s[76:79], s36 offen
    s_add_u32 s36, s37, 47104
    buffer_load_dword v34, v4, s[76:79], s36 offen
    s_add_u32 s36, s37, 48128
    buffer_load_dword v35, v4, s[76:79], s36 offen
    s_add_u32 s36, s37, 49152
    buffer_load_dword v36, v4, s[76:79], s36 offen
    s_add_u32 s36, s37, 50176
    buffer_load_dword v37, v4, s[76:79], s36 offen
    s_add_u32 s36, s37, 51200
    buffer_load_dword v38, v4, s[76:79], s36 offen
    s_add_u32 s36, s37, 52224
    buffer_load_dword v39, v4, s[76:79], s36 offen
    s_add_u32 s36, s37, 53248
    buffer_load_dword v40, v4, s[76:79], s36 offen
    s_add_u32 s36, s37, 54272
    buffer_load_dword v41, v4, s[76:79], s36 offen
    s_add_u32 s36, s37, 55296
    buffer_load_dword v42, v4, s[76:79], s36 offen
    s_add_u32 s36, s37, 56320
    buffer_load_dword v43, v4, s[76:79], s36 offen
    s_waitcnt vmcnt(0)
    v_perm_b32 v78, v17, v16, s34
    v_perm_b32 v79, v19, v18, s34
    v_perm_b32 v80, v21, v20, s34
    v_perm_b32 v81, v23, v22, s34
    v_perm_b32 v82, v25, v24, s34
    v_perm_b32 v83, v27, v26, s34
    v_perm_b32 v84, v29, v28, s34
    v_perm_b32 v85, v31, v30, s34
    v_perm_b32 v86, v33, v32, s34
    v_perm_b32 v87, v35, v34, s34
    v_perm_b32 v88, v37, v36, s34
    v_perm_b32 v89, v39, v38, s34
    v_perm_b32 v90, v41, v40, s34
    v_perm_b32 v91, v43, v42, s34
    v_perm_b32 v106, v17, v16, s35
    v_perm_b32 v107, v19, v18, s35
    v_perm_b32 v108, v21, v20, s35
    v_perm_b32 v109, v23, v22, s35
    v_perm_b32 v110, v25, v24, s35
    v_perm_b32 v111, v27, v26, s35
    v_perm_b32 v112, v29, v28, s35
    v_perm_b32 v113, v31, v30, s35
    v_perm_b32 v114, v33, v32, s35
    v_perm_b32 v115, v35, v34, s35
    v_perm_b32 v116, v37, v36, s35
    v_perm_b32 v117, v39, v38, s35
    v_perm_b32 v118, v41, v40, s35
    v_perm_b32 v119, v43, v42, s35
    s_mov_b32 s24, 0
    s_mov_b64 s[28:29], 0
    v_mov_b32 v12, 0x40000000
    v_mov_b32 v13, 0
    v_lshlrev_b32 v3, 4, v0
L_M06_rp:
    s_mov_b32 s36, 0x19a000
    buffer_load_dwordx4 v[40:43], v3, s[8:11], s36 offen sc1
    s_add_u32 s32, s32, 1
    v_mov_b32 v5, 0
    s_waitcnt vmcnt(0)
    v_max3_u32 v5, v5, v40, v41
    v_max3_u32 v5, v5, v42, v43
    s_cmp_gt_u32 s32, 200000
    s_cbranch_scc1 L_M06_rp_ok
    v_cmp_eq_u32 vcc, -1, v5
    s_cbranch_vccz L_M06_rp_ok
    s_sleep 32
    s_branch L_M06_rp
L_M06_rp_ok:
    v_add_f32 v40, v40, v41
    v_add_f32 v42, v42, v43
    v_add_f32 v40, v40, v42
    v_cvt_pk_bf16_f32 v5, v40, v40
    v_lshlrev_b32 v40, 16, v5
    v_ashrrev_i32 v5, 31, v40
    v_or_b32 v5, 0x80000000, v5
    v_xor_b32 v5, v5, v40
    v_and_b32 v5, 0xffff0000, v5
    v_sub_u32 v6, 511, v0
    v_or_b32 v126, v5, v6
    v_lshlrev_b32 v3, 4, v0
L_M01_rp:
    s_mov_b32 s36, 0x195000
    buffer_load_dwordx4 v[20:23], v3, s[8:11], s36 offen sc1
    s_mov_b32 s36, 0x196000
    buffer_load_dwordx4 v[24:27], v3, s[8:11], s36 offen sc1
    s_mov_b32 s36, 0x197000
    buffer_load_dwordx4 v[28:31], v3, s[8:11], s36 offen sc1
    s_mov_b32 s36, 0x198000
    buffer_load_dwordx4 v[32:35], v3, s[8:11], s36 offen sc1
    s_mov_b32 s36, 0x199000
    buffer_load_dwordx4 v[36:39], v3, s[8:11], s36 offen sc1
    s_add_u32 s32, s32, 1
    v_mov_b32 v5, 0
    s_waitcnt vmcnt(0)
    v_max3_u32 v5, v5, v20, v21
    v_max3_u32 v5, v5, v22, v23
    v_max3_u32 v5, v5, v24, v25
    v_max3_u32 v5, v5, v26, v27
    v_max3_u32 v5, v5, v28, v29
    v_max3_u32 v5, v5, v30, v31
    v_max3_u32 v5, v5, v32, v33
    v_max3_u32 v5, v5, v34, v35
    v_max3_u32 v5, v5, v36, v37
    v_max3_u32 v5, v5, v38, v39
    s_cmp_gt_u32 s32, 200000
    s_cbranch_scc1 L_M01_rp_ok
    v_cmp_eq_u32 vcc, -1, v5
    s_cbranch_vccz L_M01_rp_ok
    s_sleep 8
    s_branch L_M01_rp
L_M01_rp_ok:
    v_add_f32 v20, v20, v21
    v_add_f32 v22, v22, v23
    v_add_f32 v20, v20, v22
    v_cvt_pk_bf16_f32 v5, v20, v20
    v_lshlrev_b32 v20, 16, v5
    v_ashrrev_i32 v5, 31, v20
    v_or_b32 v5, 0x80000000, v5
    v_xor_b32 v5, v5, v20
    v_and_b32 v5, 0xffff0000, v5
    v_sub_u32 v6, 1791, v0
    v_or_b32 v121, v5, v6
    v_add_f32 v24, v24, v25
    v_add_f32 v26, v26, v27
    v_add_f32 v24, v24, v26
    v_cvt_pk_bf16_f32 v5, v24, v24
    v_lshlrev_b32 v24, 16, v5
    v_ashrrev_i32 v5, 31, v24
    v_or_b32 v5, 0x80000000, v5
    v_xor_b32 v5, v5, v24
    v_and_b32 v5, 0xffff0000, v5
    v_sub_u32 v6, 1535, v0
    v_or_b32 v122, v5, v6
    v_add_f32 v28, v28, v29
    v_add_f32 v30, v30, v31
    v_add_f32 v28, v28, v30
    v_cvt_pk_bf16_f32 v5, v28, v28
    v_lshlrev_b32 v28, 16, v5
    v_ashrrev_i32 v5, 31, v28
    v_or_b32 v5, 0x80000000, v5
    v_xor_b32 v5, v5, v28
    v_and_b32 v5, 0xffff0000, v5
    v_sub_u32 v6, 1279, v0
    v_or_b32 v123, v5, v6
    v_add_f32 v32, v32, v33
    v_add_f32 v34, v34, v35
    v_add_f32 v32, v32, v34
    v_cvt_pk_bf16_f32 v5, v32, v32
    v_lshlrev_b32 v32, 16, v5
    v_ashrrev_i32 v5, 31, v32
    v_or_b32 v5, 0x80000000, v5
    v_xor_b32 v5, v5, v32
    v_and_b32 v5, 0xffff0000, v5
    v_sub_u32 v6, 1023, v0
    v_or_b32 v124, v5, v6
    v_add_f32 v36, v36, v37
    v_add_f32 v38, v38, v39
    v_add_f32 v36, v36, v38
    v_cvt_pk_bf16_f32 v5, v36, v36
    v_lshlrev_b32 v36, 16, v5
    v_ashrrev_i32 v5, 31, v36
    v_or_b32 v5, 0x80000000, v5
    v_xor_b32 v5, v5, v36
    v_and_b32 v5, 0xffff0000, v5
    v_sub_u32 v6, 767, v0
    v_or_b32 v125, v5, v6
    v_max_u32 v5, v120, v121
    v_min_u32 v6, v120, v121
    v_med3_u32 v6, v5, v6, v122
    v_max_u32 v5, v5, v122
    v_med3_u32 v6, v5, v6, v123
    v_max_u32 v5, v5, v123
    v_med3_u32 v6, v5, v6, v124
    v_max_u32 v5, v5, v124
    v_med3_u32 v6, v5, v6, v125
    v_max_u32 v5, v5, v125
    v_med3_u32 v6, v5, v6, v126
    v_max_u32 v5, v5, v126
    v_mov_b32 v120, v5
    v_mov_b32 v121, v6
    s_mov_b32 s25, 32
L_M_round:
    v_lshlrev_b32 v3, 4, v0
    v_cmp_gt_u32 s[74:75], s25, v0
L_M7_rp:
    s_mov_b32 s36, 0x19b000
    buffer_load_dwordx4 v[44:47], v3, s[8:11], s36 offen sc1
    s_add_u32 s32, s32, 1
    v_mov_b32 v5, 0
    s_waitcnt vmcnt(0)
    v_max3_u32 v5, v5, v44, v45
    v_max3_u32 v5, v5, v46, v47
    v_cndmask_b32 v5, 0, v5, s[74:75]
    s_cmp_gt_u32 s32, 200000
    s_cbranch_scc1 L_M7_rp_ok
    v_cmp_eq_u32 vcc, -1, v5
    s_cbranch_vccnz L_M7_rp
L_M7_rp_ok:
    v_add_f32 v44, v44, v45
    v_add_f32 v46, v46, v47
    v_add_f32 v44, v44, v46
    v_cvt_pk_bf16_f32 v5, v44, v44
    v_lshlrev_b32 v44, 16, v5
    v_ashrrev_i32 v5, 31, v44
    v_or_b32 v5, 0x80000000, v5
    v_xor_b32 v5, v5, v44
    v_and_b32 v5, 0xffff0000, v5
    v_sub_u32 v6, 255, v0
    v_or_b32 v127, v5, v6
    v_cndmask_b32 v127, 0, v127, s[74:75]
    v_max_u32 v5, v120, v127
    v_med3_u32 v6, v120, v121, v127
    s_nop 0
    v_mov_b32_dpp v7, v5 quad_perm:[1,0,3,2] row_mask:0xf bank_mask:0xf
    v_mov_b32_dpp v8, v6 quad_perm:[1,0,3,2] row_mask:0xf bank_mask:0xf
    v_min_u32 v9, v5, v7
    v_max_u32 v5, v5, v7
    v_max3_u32 v6, v6, v8, v9
    s_nop 0
    v_mov_b32_dpp v7, v5 quad_perm:[2,3,0,1] row_mask:0xf bank_mask:0xf
    v_mov_b32_dpp v8, v6 quad_perm:[2,3,0,1] row_mask:0xf bank_mask:0xf
    v_min_u32 v9, v5, v7
    v_max_u32 v5, v5, v7
    v_max3_u32 v6, v6, v8, v9
    s_nop 0
    v_mov_b32_dpp v7, v5 row_half_mirror row_mask:0xf bank_mask:0xf
    v_mov_b32_dpp v8, v6 row_half_mirror row_mask:0xf bank_mask:0xf
    v_min_u32 v9, v5, v7
    v_max_u32 v5, v5, v7
    v_max3_u32 v6, v6, v8, v9
    s_nop 0
    v_mov_b32_dpp v7, v5 row_mirror row_mask:0xf bank_mask:0xf
    v_mov_b32_dpp v8, v6 row_mirror row_mask:0xf bank_mask:0xf
    v_min_u32 v9, v5, v7
    v_max_u32 v5, v5, v7
    v_max3_u32 v6, v6, v8, v9
    v_lshrrev_b32 v9, 4, v0
    v_lshlrev_b32 v9, 3, v9
    s_barrier
    ds_write2_b32 v9, v5, v6 offset0:0 offset1:1
    v_and_b32 v9, 15, v0
    v_lshlrev_b32 v9, 3, v9
    s_waitcnt lgkmcnt(0)
    s_barrier
    ds_read2_b32 v[10:11], v9 offset0:0 offset1:1
    s_waitcnt lgkmcnt(0)
    v_mov_b32 v5, v10
    v_mov_b32 v6, v11
    s_nop 0
    v_mov_b32_dpp v7, v5 quad_perm:[1,0,3,2] row_mask:0xf bank_mask:0xf
    v_mov_b32_dpp v8, v6 quad_perm:[1,0,3,2] row_mask:0xf bank_mask:0xf
    v_min_u32 v9, v5, v7
    v_max_u32 v5, v5, v7
    v_max3_u32 v6, v6, v8, v9
    s_nop 0
    v_mov_b32_dpp v7, v5 quad_perm:[2,3,0,1] row_mask:0xf bank_mask:0xf
    v_mov_b32_dpp v8, v6 quad_perm:[2,3,0,1] row_mask:0xf bank_mask:0xf
    v_min_u32 v9, v5, v7
    v_max_u32 v5, v5, v7
    v_max3_u32 v6, v6, v8, v9
    s_nop 0
    v_mov_b32_dpp v7, v5 row_half_mirror row_mask:0xf bank_mask:0xf
    v_mov_b32_dpp v8, v6 row_half_mirror row_mask:0xf bank_mask:0xf
    v_min_u32 v9, v5, v7
    v_max_u32 v5, v5, v7
    v_max3_u32 v6, v6, v8, v9
    s_nop 0
    v_mov_b32_dpp v7, v5 row_mirror row_mask:0xf bank_mask:0xf
    v_mov_b32_dpp v8, v6 row_mirror row_mask:0xf bank_mask:0xf
    v_min_u32 v9, v5, v7
    v_max_u32 v5, v5, v7
    v_max3_u32 v6, v6, v8, v9
    v_readfirstlane_b32 s26, v5
    v_readfirstlane_b32 s27, v6
    s_nop 3
    s_cmp_eq_u64 s[26:27], s[28:29]
    s_cbranch_scc1 L_M_next
    s_mov_b64 s[28:29], s[26:27]
    s_and_b32 s36, s26, 0x7ff
    s_sub_u32 s30, 2047, s36
    s_and_b32 s36, s26, 0xffff0000
    s_xor_b32 s37, s36, 0x80000000
    s_xor_b32 s40, s36, 0xffff0000
    s_bitcmp1_b32 s36, 31
    s_cselect_b32 s40, s37, s40
    s_and_b32 s36, s27, 0x7ff
    s_sub_u32 s31, 2047, s36
    s_and_b32 s36, s27, 0xffff0000
    s_xor_b32 s37, s36, 0x80000000
    s_xor_b32 s41, s36, 0xffff0000
    s_bitcmp1_b32 s36, 31
    s_cselect_b32 s41, s37, s41
    v_mov_b32 v8, 0
L_M_rows:
    s_lshl_b32 s36, s30, 4
    s_add_u32 s36, s36, 0x1b8000
    buffer_load_dwordx4 v[16:19], v8, s[8:11], s36 offen sc1
    s_lshl_b32 s36, s31, 4
    s_add_u32 s36, s36, 0x1b8000
    buffer_load_dwordx4 v[20:23], v8, s[8:11], s36 offen sc1
    s_add_u32 s32, s32, 1
    s_cmp_gt_u32 s32, 200000
    s_waitcnt vmcnt(0)
    v_or3_b32 v5, v16, v17, v18
    v_or3_b32 v5, v5, v19, v20
    v_or3_b32 v5, v5, v21, v22
    v_or_b32 v5, v5, v23
    s_cbranch_scc1 L_M_rows_ok
    v_cmp_ne_u32 vcc, 0, v5
    s_cbranch_vccnz L_M_rows
L_M_rows_ok:
    v_bfe_u32 v9, v0, 6, 1
    v_cmp_ne_u32 vcc, 0, v9
    v_mov_b32 v5, s30
    v_mov_b32 v6, s31
    v_cndmask_b32 v7, v5, v6, vcc
    v_lshlrev_b32 v7, 10, v7
    v_and_b32 v8, 63, v0
    v_lshl_add_u32 v7, v8, 4, v7
    s_mov_b32 s37, 0x600000
    buffer_load_dwordx4 v[16:19], v7, s[8:11], s37 offen sc1
    v_bfe_u32 v9, v0, 3, 1
    v_cmp_ne_u32 vcc, 0, v9
    s_nop 1
    v_cndmask_b32 v12, v5, v6, vcc
    v_mov_b32 v5, s40
    v_mov_b32 v6, s41
    v_cndmask_b32 v11, v5, v6, vcc
    v_lshlrev_b32 v12, 10, v12
    v_and_b32 v3, 7, v0
    v_lshl_add_u32 v12, v3, 2, v12
    s_lshl_b32 s36, s20, 5
    v_add_u32 v12, s36, v12
    v_mov_b32 v7, 0x40000000
    v_cmp_lt_u32 vcc, 15, v0
    s_nop 1
    v_cndmask_b32 v12, v12, v7, vcc
    s_mov_b32 s36, 0x400000
    buffer_load_dword v14, v12, s[8:11], s36 offen sc1
    buffer_load_dword v15, v12, s[8:11], s37 offen sc1
    v_and_b32 v8, 127, v0
    v_lshlrev_b32 v8, 4, v8
    s_waitcnt vmcnt(2)
    ds_write_b128 v8, v[16:19] offset:4096
    s_waitcnt lgkmcnt(0)
    s_barrier
    v_mov_b64 v[48:49], 0
    v_mov_b64 v[50:51], 0
    v_mov_b64 v[52:53], 0
    v_mov_b64 v[54:55], 0
    v_lshlrev_b32 v8, 7, v1
    ds_read_b128 v[16:19], v8 offset:4096
    ds_read_b128 v[20:23], v8 offset:4112
    ds_read_b128 v[24:27], v8 offset:4128
    ds_read_b128 v[28:31], v8 offset:4144
    ds_read_b128 v[32:35], v8 offset:5120
    ds_read_b128 v[36:39], v8 offset:5136
    ds_read_b128 v[40:43], v8 offset:5152
    ds_read_b128 v[44:47], v8 offset:5168
    s_waitcnt lgkmcnt(0)
    v_dot2_f32_bf16 v48, v16, v128, v48
    v_dot2_f32_bf16 v49, v16, v160, v49
    v_dot2_f32_bf16 v50, v32, v128, v50
    v_dot2_f32_bf16 v51, v32, v160, v51
    v_dot2_f32_bf16 v52, v16, v192, v52
    v_dot2_f32_bf16 v53, v16, v224, v53
    v_dot2_f32_bf16 v54, v32, v192, v54
    v_dot2_f32_bf16 v55, v32, v224, v55
    v_dot2_f32_bf16 v48, v17, v129, v48
    v_dot2_f32_bf16 v49, v17, v161, v49
    v_dot2_f32_bf16 v50, v33, v129, v50
    v_dot2_f32_bf16 v51, v33, v161, v51
    v_dot2_f32_bf16 v52, v17, v193, v52
    v_dot2_f32_bf16 v53, v17, v225, v53
    v_dot2_f32_bf16 v54, v33, v193, v54
    v_dot2_f32_bf16 v55, v33, v225, v55
    v_dot2_f32_bf16 v48, v18, v130, v48
    v_dot2_f32_bf16 v49, v18, v162, v49
    v_dot2_f32_bf16 v50, v34, v130, v50
    v_dot2_f32_bf16 v51, v34, v162, v51
    v_dot2_f32_bf16 v52, v18, v194, v52
    v_dot2_f32_bf16 v53, v18, v226, v53
    v_dot2_f32_bf16 v54, v34, v194, v54
    v_dot2_f32_bf16 v55, v34, v226, v55
    v_dot2_f32_bf16 v48, v19, v131, v48
    v_dot2_f32_bf16 v49, v19, v163, v49
    v_dot2_f32_bf16 v50, v35, v131, v50
    v_dot2_f32_bf16 v51, v35, v163, v51
    v_dot2_f32_bf16 v52, v19, v195, v52
    v_dot2_f32_bf16 v53, v19, v227, v53
    v_dot2_f32_bf16 v54, v35, v195, v54
    v_dot2_f32_bf16 v55, v35, v227, v55
    v_dot2_f32_bf16 v48, v20, v132, v48
    v_dot2_f32_bf16 v49, v20, v164, v49
    v_dot2_f32_bf16 v50, v36, v132, v50
    v_dot2_f32_bf16 v51, v36, v164, v51
    v_dot2_f32_bf16 v52, v20, v196, v52
    v_dot2_f32_bf16 v53, v20, v228, v53
    v_dot2_f32_bf16 v54, v36, v196, v54
    v_dot2_f32_bf16 v55, v36, v228, v55
    v_dot2_f32_bf16 v48, v21, v133, v48
    v_dot2_f32_bf16 v49, v21, v165, v49
    v_dot2_f32_bf16 v50, v37, v133, v50
    v_dot2_f32_bf16 v51, v37, v165, v51
    v_dot2_f32_bf16 v52, v21, v197, v52
    v_dot2_f32_bf16 v53, v21, v229, v53
    v_dot2_f32_bf16 v54, v37, v197, v54
    v_dot2_f32_bf16 v55, v37, v229, v55
    v_dot2_f32_bf16 v48, v22, v134, v48
    v_dot2_f32_bf16 v49, v22, v166, v49
    v_dot2_f32_bf16 v50, v38, v134, v50
    v_dot2_f32_bf16 v51, v38, v166, v51
    v_dot2_f32_bf16 v52, v22, v198, v52
    v_dot2_f32_bf16 v53, v22, v230, v53
    v_dot2_f32_bf16 v54, v38, v198, v54
    v_dot2_f32_bf16 v55, v38, v230, v55
    v_dot2_f32_bf16 v48, v23, v135, v48
    v_dot2_f32_bf16 v49, v23, v167, v49
    v_dot2_f32_bf16 v50, v39, v135, v50
    v_dot2_f32_bf16 v51, v39, v167, v51
    v_dot2_f32_bf16 v52, v23, v199, v52
    v_dot2_f32_bf16 v53, v23, v231, v53
    v_dot2_f32_bf16 v54, v39, v199, v54
    v_dot2_f32_bf16 v55, v39, v231, v55
    v_dot2_f32_bf16 v48, v24, v136, v48
    v_dot2_f32_bf16 v49, v24, v168, v49
    v_dot2_f32_bf16 v50, v40, v136, v50
    v_dot2_f32_bf16 v51, v40, v168, v51
    v_dot2_f32_bf16 v52, v24, v200, v52
    v_dot2_f32_bf16 v53, v24, v232, v53
    v_dot2_f32_bf16 v54, v40, v200, v54
    v_dot2_f32_bf16 v55, v40, v232, v55
    v_dot2_f32_bf16 v48, v25, v137, v48
    v_dot2_f32_bf16 v49, v25, v169, v49
    v_dot2_f32_bf16 v50, v41, v137, v50
    v_dot2_f32_bf16 v51, v41, v169, v51
    v_dot2_f32_bf16 v52, v25, v201, v52
    v_dot2_f32_bf16 v53, v25, v233, v53
    v_dot2_f32_bf16 v54, v41, v201, v54
    v_dot2_f32_bf16 v55, v41, v233, v55
    v_dot2_f32_bf16 v48, v26, v138, v48
    v_dot2_f32_bf16 v49, v26, v170, v49
    v_dot2_f32_bf16 v50, v42, v138, v50
    v_dot2_f32_bf16 v51, v42, v170, v51
    v_dot2_f32_bf16 v52, v26, v202, v52
    v_dot2_f32_bf16 v53, v26, v234, v53
    v_dot2_f32_bf16 v54, v42, v202, v54
    v_dot2_f32_bf16 v55, v42, v234, v55
    v_dot2_f32_bf16 v48, v27, v139, v48
    v_dot2_f32_bf16 v49, v27, v171, v49
    v_dot2_f32_bf16 v50, v43, v139, v50
    v_dot2_f32_bf16 v51, v43, v171, v51
    v_dot2_f32_bf16 v52, v27, v203, v52
    v_dot2_f32_bf16 v53, v27, v235, v53
    v_dot2_f32_bf16 v54, v43, v203, v54
    v_dot2_f32_bf16 v55, v43, v235, v55
    v_dot2_f32_bf16 v48, v28, v140, v48
    v_dot2_f32_bf16 v49, v28, v172, v49
    v_dot2_f32_bf16 v50, v44, v140, v50
    v_dot2_f32_bf16 v51, v44, v172, v51
    v_dot2_f32_bf16 v52, v28, v204, v52
    v_dot2_f32_bf16 v53, v28, v236, v53
    v_dot2_f32_bf16 v54, v44, v204, v54
    v_dot2_f32_bf16 v55, v44, v236, v55
    v_dot2_f32_bf16 v48, v29, v141, v48
    v_dot2_f32_bf16 v49, v29, v173, v49
    v_dot2_f32_bf16 v50, v45, v141, v50
    v_dot2_f32_bf16 v51, v45, v173, v51
    v_dot2_f32_bf16 v52, v29, v205, v52
    v_dot2_f32_bf16 v53, v29, v237, v53
    v_dot2_f32_bf16 v54, v45, v205, v54
    v_dot2_f32_bf16 v55, v45, v237, v55
    v_dot2_f32_bf16 v48, v30, v142, v48
    v_dot2_f32_bf16 v49, v30, v174, v49
    v_dot2_f32_bf16 v50, v46, v142, v50
    v_dot2_f32_bf16 v51, v46, v174, v51
    v_dot2_f32_bf16 v52, v30, v206, v52
    v_dot2_f32_bf16 v53, v30, v238, v53
    v_dot2_f32_bf16 v54, v46, v206, v54
    v_dot2_f32_bf16 v55, v46, v238, v55
    v_dot2_f32_bf16 v48, v31, v143, v48
    v_dot2_f32_bf16 v49, v31, v175, v49
    v_dot2_f32_bf16 v50, v47, v143, v50
    v_dot2_f32_bf16 v51, v47, v175, v51
    v_dot2_f32_bf16 v52, v31, v207, v52
    v_dot2_f32_bf16 v53, v31, v239, v53
    v_dot2_f32_bf16 v54, v47, v207, v54
    v_dot2_f32_bf16 v55, v47, v239, v55
    ds_read_b128 v[16:19], v8 offset:4160
    ds_read_b128 v[20:23], v8 offset:4176
    ds_read_b128 v[24:27], v8 offset:4192
    ds_read_b128 v[28:31], v8 offset:4208
    ds_read_b128 v[32:35], v8 offset:5184
    ds_read_b128 v[36:39], v8 offset:5200
    ds_read_b128 v[40:43], v8 offset:5216
    ds_read_b128 v[44:47], v8 offset:5232
    s_waitcnt lgkmcnt(0)
    v_dot2_f32_bf16 v48, v16, v144, v48
    v_dot2_f32_bf16 v49, v16, v176, v49
    v_dot2_f32_bf16 v50, v32, v144, v50
    v_dot2_f32_bf16 v51, v32, v176, v51
    v_dot2_f32_bf16 v52, v16, v208, v52
    v_dot2_f32_bf16 v53, v16, v240, v53
    v_dot2_f32_bf16 v54, v32, v208, v54
    v_dot2_f32_bf16 v55, v32, v240, v55
    v_dot2_f32_bf16 v48, v17, v145, v48
    v_dot2_f32_bf16 v49, v17, v177, v49
    v_dot2_f32_bf16 v50, v33, v145, v50
    v_dot2_f32_bf16 v51, v33, v177, v51
    v_dot2_f32_bf16 v52, v17, v209, v52
    v_dot2_f32_bf16 v53, v17, v241, v53
    v_dot2_f32_bf16 v54, v33, v209, v54
    v_dot2_f32_bf16 v55, v33, v241, v55
    v_dot2_f32_bf16 v48, v18, v146, v48
    v_dot2_f32_bf16 v49, v18, v178, v49
    v_dot2_f32_bf16 v50, v34, v146, v50
    v_dot2_f32_bf16 v51, v34, v178, v51
    v_dot2_f32_bf16 v52, v18, v210, v52
    v_dot2_f32_bf16 v53, v18, v242, v53
    v_dot2_f32_bf16 v54, v34, v210, v54
    v_dot2_f32_bf16 v55, v34, v242, v55
    v_dot2_f32_bf16 v48, v19, v147, v48
    v_dot2_f32_bf16 v49, v19, v179, v49
    v_dot2_f32_bf16 v50, v35, v147, v50
    v_dot2_f32_bf16 v51, v35, v179, v51
    v_dot2_f32_bf16 v52, v19, v211, v52
    v_dot2_f32_bf16 v53, v19, v243, v53
    v_dot2_f32_bf16 v54, v35, v211, v54
    v_dot2_f32_bf16 v55, v35, v243, v55
    v_dot2_f32_bf16 v48, v20, v148, v48
    v_dot2_f32_bf16 v49, v20, v180, v49
    v_dot2_f32_bf16 v50, v36, v148, v50
    v_dot2_f32_bf16 v51, v36, v180, v51
    v_dot2_f32_bf16 v52, v20, v212, v52
    v_dot2_f32_bf16 v53, v20, v244, v53
    v_dot2_f32_bf16 v54, v36, v212, v54
    v_dot2_f32_bf16 v55, v36, v244, v55
    v_dot2_f32_bf16 v48, v21, v149, v48
    v_dot2_f32_bf16 v49, v21, v181, v49
    v_dot2_f32_bf16 v50, v37, v149, v50
    v_dot2_f32_bf16 v51, v37, v181, v51
    v_dot2_f32_bf16 v52, v21, v213, v52
    v_dot2_f32_bf16 v53, v21, v245, v53
    v_dot2_f32_bf16 v54, v37, v213, v54
    v_dot2_f32_bf16 v55, v37, v245, v55
    v_dot2_f32_bf16 v48, v22, v150, v48
    v_dot2_f32_bf16 v49, v22, v182, v49
    v_dot2_f32_bf16 v50, v38, v150, v50
    v_dot2_f32_bf16 v51, v38, v182, v51
    v_dot2_f32_bf16 v52, v22, v214, v52
    v_dot2_f32_bf16 v53, v22, v246, v53
    v_dot2_f32_bf16 v54, v38, v214, v54
    v_dot2_f32_bf16 v55, v38, v246, v55
    v_dot2_f32_bf16 v48, v23, v151, v48
    v_dot2_f32_bf16 v49, v23, v183, v49
    v_dot2_f32_bf16 v50, v39, v151, v50
    v_dot2_f32_bf16 v51, v39, v183, v51
    v_dot2_f32_bf16 v52, v23, v215, v52
    v_dot2_f32_bf16 v53, v23, v247, v53
    v_dot2_f32_bf16 v54, v39, v215, v54
    v_dot2_f32_bf16 v55, v39, v247, v55
    v_dot2_f32_bf16 v48, v24, v152, v48
    v_dot2_f32_bf16 v49, v24, v184, v49
    v_dot2_f32_bf16 v50, v40, v152, v50
    v_dot2_f32_bf16 v51, v40, v184, v51
    v_dot2_f32_bf16 v52, v24, v216, v52
    v_dot2_f32_bf16 v53, v24, v248, v53
    v_dot2_f32_bf16 v54, v40, v216, v54
    v_dot2_f32_bf16 v55, v40, v248, v55
    v_dot2_f32_bf16 v48, v25, v153, v48
    v_dot2_f32_bf16 v49, v25, v185, v49
    v_dot2_f32_bf16 v50, v41, v153, v50
    v_dot2_f32_bf16 v51, v41, v185, v51
    v_dot2_f32_bf16 v52, v25, v217, v52
    v_dot2_f32_bf16 v53, v25, v249, v53
    v_dot2_f32_bf16 v54, v41, v217, v54
    v_dot2_f32_bf16 v55, v41, v249, v55
    v_dot2_f32_bf16 v48, v26, v154, v48
    v_dot2_f32_bf16 v49, v26, v186, v49
    v_dot2_f32_bf16 v50, v42, v154, v50
    v_dot2_f32_bf16 v51, v42, v186, v51
    v_dot2_f32_bf16 v52, v26, v218, v52
    v_dot2_f32_bf16 v53, v26, v250, v53
    v_dot2_f32_bf16 v54, v42, v218, v54
    v_dot2_f32_bf16 v55, v42, v250, v55
    v_dot2_f32_bf16 v48, v27, v155, v48
    v_dot2_f32_bf16 v49, v27, v187, v49
    v_dot2_f32_bf16 v50, v43, v155, v50
    v_dot2_f32_bf16 v51, v43, v187, v51
    v_dot2_f32_bf16 v52, v27, v219, v52
    v_dot2_f32_bf16 v53, v27, v251, v53
    v_dot2_f32_bf16 v54, v43, v219, v54
    v_dot2_f32_bf16 v55, v43, v251, v55
    v_dot2_f32_bf16 v48, v28, v156, v48
    v_dot2_f32_bf16 v49, v28, v188, v49
    v_dot2_f32_bf16 v50, v44, v156, v50
    v_dot2_f32_bf16 v51, v44, v188, v51
    v_dot2_f32_bf16 v52, v28, v220, v52
    v_dot2_f32_bf16 v53, v28, v252, v53
    v_dot2_f32_bf16 v54, v44, v220, v54
    v_dot2_f32_bf16 v55, v44, v252, v55
    v_dot2_f32_bf16 v48, v29, v157, v48
    v_dot2_f32_bf16 v49, v29, v189, v49
    v_dot2_f32_bf16 v50, v45, v157, v50
    v_dot2_f32_bf16 v51, v45, v189, v51
    v_dot2_f32_bf16 v52, v29, v221, v52
    v_dot2_f32_bf16 v53, v29, v253, v53
    v_dot2_f32_bf16 v54, v45, v221, v54
    v_dot2_f32_bf16 v55, v45, v253, v55
    v_dot2_f32_bf16 v48, v30, v158, v48
    v_dot2_f32_bf16 v49, v30, v190, v49
    v_dot2_f32_bf16 v50, v46, v158, v50
    v_dot2_f32_bf16 v51, v46, v190, v51
    v_dot2_f32_bf16 v52, v30, v222, v52
    v_dot2_f32_bf16 v53, v30, v254, v53
    v_dot2_f32_bf16 v54, v46, v222, v54
    v_dot2_f32_bf16 v55, v46, v254, v55
    v_dot2_f32_bf16 v48, v31, v159, v48
    v_dot2_f32_bf16 v49, v31, v191, v49
    v_dot2_f32_bf16 v50, v47, v159, v50
    v_dot2_f32_bf16 v51, v47, v191, v51
    v_dot2_f32_bf16 v52, v31, v223, v52
    v_dot2_f32_bf16 v53, v31, v255, v53
    v_dot2_f32_bf16 v54, v47, v223, v54
    v_dot2_f32_bf16 v55, v47, v255, v55
    s_nop 3
    v_lshlrev_b32 v7, 5, v0
    ds_write_b128 v7, v[48:51] offset:8192
    ds_write_b128 v7, v[52:55] offset:8208
    s_waitcnt lgkmcnt(0)
    s_barrier
    v_lshlrev_b32 v7, 5, v2
    v_bfe_u32 v8, v0, 5, 1
    v_lshl_add_u32 v7, v8, 3, v7
    ds_read_b64 v[16:17], v7 offset:8192
    ds_read_b64 v[18:19], v7 offset:8208
    ds_read_b64 v[20:21], v7 offset:9216
    ds_read_b64 v[22:23], v7 offset:9232
    ds_read_b64 v[24:25], v7 offset:10240
    ds_read_b64 v[26:27], v7 offset:10256
    ds_read_b64 v[28:29], v7 offset:11264
    ds_read_b64 v[30:31], v7 offset:11280
    s_waitcnt lgkmcnt(0)
    ds_read_b64 v[32:33], v7 offset:12288
    ds_read_b64 v[34:35], v7 offset:12304
    ds_read_b64 v[36:37], v7 offset:13312
    ds_read_b64 v[38:39], v7 offset:13328
    ds_read_b64 v[40:41], v7 offset:14336
    ds_read_b64 v[42:43], v7 offset:14352
    ds_read_b64 v[44:45], v7 offset:15360
    ds_read_b64 v[46:47], v7 offset:15376
    s_waitcnt lgkmcnt(0)
    v_add_f32 v16, v16, v20
    v_add_f32 v16, v16, v24
    v_add_f32 v16, v16, v28
    v_add_f32 v16, v16, v32
    v_add_f32 v16, v16, v36
    v_add_f32 v16, v16, v40
    v_add_f32 v16, v16, v44
    v_cvt_pk_bf16_f32 v5, v16, v16
    v_lshlrev_b32 v16, 16, v5
    v_add_f32 v17, v17, v21
    v_add_f32 v17, v17, v25
    v_add_f32 v17, v17, v29
    v_add_f32 v17, v17, v33
    v_add_f32 v17, v17, v37
    v_add_f32 v17, v17, v41
    v_add_f32 v17, v17, v45
    v_cvt_pk_bf16_f32 v5, v17, v17
    v_lshlrev_b32 v17, 16, v5
    v_add_f32 v18, v18, v22
    v_add_f32 v18, v18, v26
    v_add_f32 v18, v18, v30
    v_add_f32 v18, v18, v34
    v_add_f32 v18, v18, v38
    v_add_f32 v18, v18, v42
    v_add_f32 v18, v18, v46
    v_cvt_pk_bf16_f32 v5, v18, v18
    v_lshlrev_b32 v18, 16, v5
    v_add_f32 v19, v19, v23
    v_add_f32 v19, v19, v27
    v_add_f32 v19, v19, v31
    v_add_f32 v19, v19, v35
    v_add_f32 v19, v19, v39
    v_add_f32 v19, v19, v43
    v_add_f32 v19, v19, v47
    v_cvt_pk_bf16_f32 v5, v19, v19
    v_lshlrev_b32 v19, 16, v5
    v_mul_f32 v6, 0xbfb8aa3b, v16
    v_exp_f32 v6, v6
    s_nop 0
    v_add_f32 v6, 1.0, v6
    v_rcp_f32 v6, v6
    s_nop 0
    v_mul_f32 v16, v16, v6
    v_cvt_pk_bf16_f32 v5, v16, v16
    v_lshlrev_b32 v16, 16, v5
    v_mul_f32 v16, v16, v18
    v_mul_f32 v6, 0xbfb8aa3b, v17
    v_exp_f32 v6, v6
    s_nop 0
    v_add_f32 v6, 1.0, v6
    v_rcp_f32 v6, v6
    s_nop 0
    v_mul_f32 v17, v17, v6
    v_cvt_pk_bf16_f32 v5, v17, v17
    v_lshlrev_b32 v17, 16, v5
    v_mul_f32 v17, v17, v19
    v_cvt_pk_bf16_f32 v16, v16, v17
    v_mul_u32_u24 v8, 3584, v8
    v_lshl_add_u32 v7, v2, 2, v8
    v_mov_b32 v6, 0x40000000
    v_cmp_lt_u32 vcc, 27, v2
    s_nop 1
    v_cndmask_b32 v7, v7, v6, vcc
    v_cmp_lt_u32 vcc, 63, v0
    s_nop 1
    v_cndmask_b32 v7, v7, v6, vcc
    s_mul_i32 s37, s24, 8192
    s_add_u32 s37, s37, 0x1b0000
    s_add_u32 s36, s37, s23
    buffer_store_dword v16, v7, s[8:11], s36 offen sc1
    v_lshlrev_b32 v7, 4, v0
    v_add_u32 v8, 4096, v7
    v_cmp_lt_u32 vcc, 191, v0
    s_nop 1
    v_cndmask_b32 v8, v8, v6, vcc
L_M_act:
    buffer_load_dwordx4 v[20:23], v7, s[8:11], s37 offen sc1
    buffer_load_dwordx4 v[24:27], v8, s[8:11], s37 offen sc1
    s_add_u32 s32, s32, 1
    s_cmp_gt_u32 s32, 200000
    s_waitcnt vmcnt(0)
    v_max3_u32 v5, v20, v21, v22
    v_max3_u32 v5, v5, v23, v24
    v_max3_u32 v5, v5, v25, v26
    v_max_u32 v5, v5, v27
    s_cbranch_scc1 L_M_act_ok
    v_cmp_eq_u32 vcc, -1, v5
    s_cbranch_vccnz L_M_act
L_M_act_ok:
    ds_write_b128 v7, v[20:23] offset:16384
    ds_write_b128 v7, v[24:27] offset:20480
    s_waitcnt lgkmcnt(0)
    s_barrier
    v_lshrrev_b32 v7, 3, v0
    v_mul_u32_u24 v7, 112, v7
    v_mov_b64 v[48:49], 0
    v_mov_b64 v[50:51], 0
    ds_read_b128 v[16:19], v7 offset:16384
    ds_read_b128 v[20:23], v7 offset:16400
    ds_read_b128 v[24:27], v7 offset:16416
    ds_read_b128 v[28:31], v7 offset:16432
    ds_read_b128 v[32:35], v7 offset:16448
    ds_read_b128 v[36:39], v7 offset:16464
    ds_read_b128 v[40:43], v7 offset:16480
    s_waitcnt lgkmcnt(0)
    v_dot2_f32_bf16 v48, v16, v64, v48
    v_dot2_f32_bf16 v49, v16, v92, v49
    v_dot2_f32_bf16 v48, v17, v65, v48
    v_dot2_f32_bf16 v49, v17, v93, v49
    v_dot2_f32_bf16 v48, v18, v66, v48
    v_dot2_f32_bf16 v49, v18, v94, v49
    v_dot2_f32_bf16 v48, v19, v67, v48
    v_dot2_f32_bf16 v49, v19, v95, v49
    v_dot2_f32_bf16 v48, v20, v68, v48
    v_dot2_f32_bf16 v49, v20, v96, v49
    v_dot2_f32_bf16 v48, v21, v69, v48
    v_dot2_f32_bf16 v49, v21, v97, v49
    v_dot2_f32_bf16 v48, v22, v70, v48
    v_dot2_f32_bf16 v49, v22, v98, v49
    v_dot2_f32_bf16 v48, v23, v71, v48
    v_dot2_f32_bf16 v49, v23, v99, v49
    v_dot2_f32_bf16 v48, v24, v72, v48
    v_dot2_f32_bf16 v49, v24, v100, v49
    v_dot2_f32_bf16 v48, v25, v73, v48
    v_dot2_f32_bf16 v49, v25, v101, v49
    v_dot2_f32_bf16 v48, v26, v74, v48
    v_dot2_f32_bf16 v49, v26, v102, v49
    v_dot2_f32_bf16 v48, v27, v75, v48
    v_dot2_f32_bf16 v49, v27, v103, v49
    v_dot2_f32_bf16 v48, v28, v76, v48
    v_dot2_f32_bf16 v49, v28, v104, v49
    v_dot2_f32_bf16 v48, v29, v77, v48
    v_dot2_f32_bf16 v49, v29, v105, v49
    v_dot2_f32_bf16 v48, v30, v78, v48
    v_dot2_f32_bf16 v49, v30, v106, v49
    v_dot2_f32_bf16 v48, v31, v79, v48
    v_dot2_f32_bf16 v49, v31, v107, v49
    v_dot2_f32_bf16 v48, v32, v80, v48
    v_dot2_f32_bf16 v49, v32, v108, v49
    v_dot2_f32_bf16 v48, v33, v81, v48
    v_dot2_f32_bf16 v49, v33, v109, v49
    v_dot2_f32_bf16 v48, v34, v82, v48
    v_dot2_f32_bf16 v49, v34, v110, v49
    v_dot2_f32_bf16 v48, v35, v83, v48
    v_dot2_f32_bf16 v49, v35, v111, v49
    v_dot2_f32_bf16 v48, v36, v84, v48
    v_dot2_f32_bf16 v49, v36, v112, v49
    v_dot2_f32_bf16 v48, v37, v85, v48
    v_dot2_f32_bf16 v49, v37, v113, v49
    v_dot2_f32_bf16 v48, v38, v86, v48
    v_dot2_f32_bf16 v49, v38, v114, v49
    v_dot2_f32_bf16 v48, v39, v87, v48
    v_dot2_f32_bf16 v49, v39, v115, v49
    v_dot2_f32_bf16 v48, v40, v88, v48
    v_dot2_f32_bf16 v49, v40, v116, v49
    v_dot2_f32_bf16 v48, v41, v89, v48
    v_dot2_f32_bf16 v49, v41, v117, v49
    v_dot2_f32_bf16 v48, v42, v90, v48
    v_dot2_f32_bf16 v49, v42, v118, v49
    v_dot2_f32_bf16 v48, v43, v91, v48
    v_dot2_f32_bf16 v49, v43, v119, v49
    ds_read_b128 v[16:19], v7 offset:19968
    ds_read_b128 v[20:23], v7 offset:19984
    ds_read_b128 v[24:27], v7 offset:20000
    ds_read_b128 v[28:31], v7 offset:20016
    ds_read_b128 v[32:35], v7 offset:20032
    ds_read_b128 v[36:39], v7 offset:20048
    ds_read_b128 v[40:43], v7 offset:20064
    s_waitcnt lgkmcnt(0)
    v_dot2_f32_bf16 v50, v16, v64, v50
    v_dot2_f32_bf16 v51, v16, v92, v51
    v_dot2_f32_bf16 v50, v17, v65, v50
    v_dot2_f32_bf16 v51, v17, v93, v51
    v_dot2_f32_bf16 v50, v18, v66, v50
    v_dot2_f32_bf16 v51, v18, v94, v51
    v_dot2_f32_bf16 v50, v19, v67, v50
    v_dot2_f32_bf16 v51, v19, v95, v51
    v_dot2_f32_bf16 v50, v20, v68, v50
    v_dot2_f32_bf16 v51, v20, v96, v51
    v_dot2_f32_bf16 v50, v21, v69, v50
    v_dot2_f32_bf16 v51, v21, v97, v51
    v_dot2_f32_bf16 v50, v22, v70, v50
    v_dot2_f32_bf16 v51, v22, v98, v51
    v_dot2_f32_bf16 v50, v23, v71, v50
    v_dot2_f32_bf16 v51, v23, v99, v51
    v_dot2_f32_bf16 v50, v24, v72, v50
    v_dot2_f32_bf16 v51, v24, v100, v51
    v_dot2_f32_bf16 v50, v25, v73, v50
    v_dot2_f32_bf16 v51, v25, v101, v51
    v_dot2_f32_bf16 v50, v26, v74, v50
    v_dot2_f32_bf16 v51, v26, v102, v51
    v_dot2_f32_bf16 v50, v27, v75, v50
    v_dot2_f32_bf16 v51, v27, v103, v51
    v_dot2_f32_bf16 v50, v28, v76, v50
    v_dot2_f32_bf16 v51, v28, v104, v51
    v_dot2_f32_bf16 v50, v29, v77, v50
    v_dot2_f32_bf16 v51, v29, v105, v51
    v_dot2_f32_bf16 v50, v30, v78, v50
    v_dot2_f32_bf16 v51, v30, v106, v51
    v_dot2_f32_bf16 v50, v31, v79, v50
    v_dot2_f32_bf16 v51, v31, v107, v51
    v_dot2_f32_bf16 v50, v32, v80, v50
    v_dot2_f32_bf16 v51, v32, v108, v51
    v_dot2_f32_bf16 v50, v33, v81, v50
    v_dot2_f32_bf16 v51, v33, v109, v51
    v_dot2_f32_bf16 v50, v34, v82, v50
    v_dot2_f32_bf16 v51, v34, v110, v51
    v_dot2_f32_bf16 v50, v35, v83, v50
    v_dot2_f32_bf16 v51, v35, v111, v51
    v_dot2_f32_bf16 v50, v36, v84, v50
    v_dot2_f32_bf16 v51, v36, v112, v51
    v_dot2_f32_bf16 v50, v37, v85, v50
    v_dot2_f32_bf16 v51, v37, v113, v51
    v_dot2_f32_bf16 v50, v38, v86, v50
    v_dot2_f32_bf16 v51, v38, v114, v51
    v_dot2_f32_bf16 v50, v39, v87, v50
    v_dot2_f32_bf16 v51, v39, v115, v51
    v_dot2_f32_bf16 v50, v40, v88, v50
    v_dot2_f32_bf16 v51, v40, v116, v51
    v_dot2_f32_bf16 v50, v41, v89, v50
    v_dot2_f32_bf16 v51, v41, v117, v51
    v_dot2_f32_bf16 v50, v42, v90, v50
    v_dot2_f32_bf16 v51, v42, v118, v51
    v_dot2_f32_bf16 v50, v43, v91, v50
    v_dot2_f32_bf16 v51, v43, v119, v51
    s_nop 3
    v_add_f32_dpp v48, v48, v48 row_ror:8 row_mask:0xf bank_mask:0xf
    v_add_f32_dpp v49, v49, v49 row_ror:8 row_mask:0xf bank_mask:0xf
    v_add_f32_dpp v50, v50, v50 row_ror:8 row_mask:0xf bank_mask:0xf
    v_add_f32_dpp v51, v51, v51 row_ror:8 row_mask:0xf bank_mask:0xf
    v_mov_b32 v5, v48
    s_nop 1
    v_permlane16_swap_b32 v48, v5
    v_add_f32 v48, v48, v5
    v_mov_b32 v5, v49
    s_nop 1
    v_permlane16_swap_b32 v49, v5
    v_add_f32 v49, v49, v5
    v_mov_b32 v5, v50
    s_nop 1
    v_permlane16_swap_b32 v50, v5
    v_add_f32 v50, v50, v5
    v_mov_b32 v5, v51
    s_nop 1
    v_permlane16_swap_b32 v51, v5
    v_add_f32 v51, v51, v5
    v_mov_b32 v5, v48
    s_nop 1
    v_permlane32_swap_b32 v48, v5
    v_add_f32 v48, v48, v5
    v_mov_b32 v5, v49
    s_nop 1
    v_permlane32_swap_b32 v49, v5
    v_add_f32 v49, v49, v5
    v_mov_b32 v5, v50
    s_nop 1
    v_permlane32_swap_b32 v50, v5
    v_add_f32 v50, v50, v5
    v_mov_b32 v5, v51
    s_nop 1
    v_permlane32_swap_b32 v51, v5
    v_add_f32 v51, v51, v5
    v_lshrrev_b32 v7, 6, v0
    v_lshlrev_b32 v7, 7, v7
    v_lshl_add_u32 v7, v3, 4, v7
    ds_write_b128 v7, v[48:51] offset:1024
    s_waitcnt lgkmcnt(0)
    s_barrier
    v_lshlrev_b32 v7, 4, v3
    v_lshl_add_u32 v7, v9, 3, v7
    ds_read_b64 v[16:17], v7 offset:1024
    ds_read_b64 v[18:19], v7 offset:1152
    ds_read_b64 v[20:21], v7 offset:1280
    ds_read_b64 v[22:23], v7 offset:1408
    v_mul_f32 v10, 0xbfb8aa3b, v11
    v_exp_f32 v10, v10
    s_nop 0
    v_add_f32 v10, 1.0, v10
    v_rcp_f32 v10, v10
    s_nop 0
    v_cvt_pk_bf16_f32 v5, v10, v10
    v_lshlrev_b32 v10, 16, v5
    s_waitcnt lgkmcnt(0)
    v_lshlrev_b32 v24, 16, v15
    v_and_b32 v25, 0xffff0000, v15
    v_lshlrev_b32 v26, 16, v14
    v_and_b32 v27, 0xffff0000, v14
    v_add_f32 v16, v16, v18
    v_add_f32 v20, v20, v22
    v_add_f32 v16, v16, v20
    v_cvt_pk_bf16_f32 v5, v16, v16
    v_lshlrev_b32 v16, 16, v5
    v_mul_f32 v16, v16, v10
    v_cvt_pk_bf16_f32 v5, v16, v16
    v_lshlrev_b32 v16, 16, v5
    v_add_f32 v16, v16, v24
    v_cvt_pk_bf16_f32 v5, v16, v16
    v_lshlrev_b32 v16, 16, v5
    v_add_f32 v16, v16, v26
    v_add_f32 v17, v17, v19
    v_add_f32 v21, v21, v23
    v_add_f32 v17, v17, v21
    v_cvt_pk_bf16_f32 v5, v17, v17
    v_lshlrev_b32 v17, 16, v5
    v_mul_f32 v17, v17, v10
    v_cvt_pk_bf16_f32 v5, v17, v17
    v_lshlrev_b32 v17, 16, v5
    v_add_f32 v17, v17, v25
    v_cvt_pk_bf16_f32 v5, v17, v17
    v_lshlrev_b32 v17, 16, v5
    v_add_f32 v17, v17, v27
    v_cvt_pk_bf16_f32 v13, v16, v17
L_M_next:
    s_add_u32 s24, s24, 1
    s_mov_b32 s25, 192
    s_cmp_eq_u32 s24, 1
    s_cbranch_scc1 L_M_round
    s_mov_b32 s25, 256
    s_cmp_eq_u32 s24, 2
    s_cbranch_scc1 L_M_round
    buffer_store_dword v13, v12, s[60:63], 0 offen sc1
L_end:
    s_endpgm
.section .rodata,"a"
.p2align 6
.amdhsa_kernel sequential_preLN__memory_aug_recurrent_mem_tr__moe_arch_mod__prompt_kernel
  .amdhsa_next_free_vgpr 512
  .amdhsa_next_free_sgpr 102
  .amdhsa_accum_offset 256
  .amdhsa_group_segment_fixed_size 0
  .amdhsa_kernarg_size 120
  .amdhsa_user_sgpr_count 2
  .amdhsa_user_sgpr_kernarg_segment_ptr 1
  .amdhsa_system_sgpr_workgroup_id_x 1
.end_amdhsa_kernel
```

```asm
; @launch grid=(256,1,1) block=(256,1,1) lds=163840
.amdgcn_target "amdgcn-amd-amdhsa--gfx950"
.text
.globl sequential_preLN__memory_aug_recurrent_mem_tr__moe_arch_mod__prompt_kernel
.p2align 8
.type sequential_preLN__memory_aug_recurrent_mem_tr__moe_arch_mod__prompt_kernel,@function
sequential_preLN__memory_aug_recurrent_mem_tr__moe_arch_mod__prompt_kernel:
    s_cmp_ge_u32 s2, 256
    s_cbranch_scc1 L_end
    s_load_dwordx8 s[44:51], s[0:1], 0
    s_load_dwordx4 s[52:55], s[0:1], 32
    s_load_dwordx4 s[56:59], s[0:1], 104
    s_load_dwordx2 s[80:81], s[0:1], 64
    s_load_dwordx2 s[82:83], s[0:1], 96
    s_load_dwordx4 s[84:87], s[0:1], 72
    s_load_dwordx2 s[88:89], s[0:1], 88
    v_lshrrev_b32 v1, 6, v0
    s_nop 0
    v_readfirstlane_b32 s21, v1
    s_waitcnt lgkmcnt(0)
    s_mov_b32 s8, s58
    s_and_b32 s9, s59, 0xffff
    s_mov_b32 s10, 0x10000000
    s_mov_b32 s11, 0x20000
    s_mov_b32 s16, s56
    s_and_b32 s17, s57, 0xffff
    s_mov_b32 s18, 0x100
    s_mov_b32 s19, 0x20000
    s_and_b32 s3, s2, 7
    s_cmp_lg_u32 s3, 0
    s_cbranch_scc1 L_worker
    s_lshr_b32 s20, s2, 3
    v_mov_b32 v1, 0x4444
    v_bfe_u32 v14, v0, 1, 1
    s_mov_b32 s38, 0xaaaa
    v_mad_u32_u24 v1, v14, s38, v1
    v_mov_b32 v3, 0x0
    v_bfe_u32 v14, v0, 0, 1
    s_mov_b32 s38, 0x10
    v_mad_u32_u24 v3, v14, s38, v3
    v_bfe_u32 v14, v0, 1, 1
    s_mov_b32 s38, 0x20
    v_mad_u32_u24 v3, v14, s38, v3
    v_bfe_u32 v14, v0, 2, 1
    s_mov_b32 s38, 0x40
    v_mad_u32_u24 v3, v14, s38, v3
    v_bfe_u32 v14, v0, 3, 1
    s_mov_b32 s38, 0x80
    v_mad_u32_u24 v3, v14, s38, v3
    v_bfe_u32 v14, v0, 4, 1
    s_mov_b32 s38, 0x100
    v_mad_u32_u24 v3, v14, s38, v3
    v_bfe_u32 v14, v0, 5, 1
    s_mov_b32 s38, 0x200
    v_mad_u32_u24 v3, v14, s38, v3
    v_mov_b32 v2, 0x0
    v_bfe_u32 v14, v0, 0, 1
    s_mov_b32 s38, 0x10
    v_mad_u32_u24 v2, v14, s38, v2
    v_bfe_u32 v14, v0, 1, 1
    s_mov_b32 s38, 0x20
    v_mad_u32_u24 v2, v14, s38, v2
    v_bfe_u32 v14, v0, 2, 1
    s_mov_b32 s38, 0x40
    v_mad_u32_u24 v2, v14, s38, v2
    v_bfe_u32 v14, v0, 3, 1
    s_mov_b32 s38, 0x80
    v_mad_u32_u24 v2, v14, s38, v2
    v_bfe_u32 v14, v0, 4, 1
    s_mov_b32 s38, 0x100
    v_mad_u32_u24 v2, v14, s38, v2
    v_bfe_u32 v14, v0, 5, 1
    s_mov_b32 s38, 0x200
    v_mad_u32_u24 v2, v14, s38, v2
    v_bfe_u32 v14, v0, 6, 1
    s_mov_b32 s38, 0x800
    v_mad_u32_u24 v2, v14, s38, v2
    v_bfe_u32 v14, v0, 7, 1
    s_mov_b32 s38, 0x1000
    v_mad_u32_u24 v2, v14, s38, v2
    v_mov_b32 v4, 0x8000
    v_bfe_u32 v14, v0, 0, 1
    s_mov_b32 s38, 0x10
    v_mad_u32_u24 v4, v14, s38, v4
    v_bfe_u32 v14, v0, 1, 1
    s_mov_b32 s38, 0x20
    v_mad_u32_u24 v4, v14, s38, v4
    v_bfe_u32 v14, v0, 2, 1
    s_mov_b32 s38, 0x40
    v_mad_u32_u24 v4, v14, s38, v4
    v_bfe_u32 v14, v0, 3, 1
    s_mov_b32 s38, 0x80
    v_mad_u32_u24 v4, v14, s38, v4
    v_bfe_u32 v14, v0, 4, 1
    s_mov_b32 s38, 0x100
    v_mad_u32_u24 v4, v14, s38, v4
    v_bfe_u32 v14, v0, 5, 1
    s_mov_b32 s38, 0x200
    v_mad_u32_u24 v4, v14, s38, v4
    v_bfe_u32 v14, v0, 6, 1
    s_mov_b32 s38, 0x8000
    v_mad_u32_u24 v4, v14, s38, v4
    v_bfe_u32 v14, v0, 7, 1
    s_mov_b32 s38, 0x10000
    v_mad_u32_u24 v4, v14, s38, v4
    v_mov_b32 v5, 0x4000
    v_bfe_u32 v14, v0, 0, 1
    s_mov_b32 s38, 0x4
    v_mad_u32_u24 v5, v14, s38, v5
    v_bfe_u32 v14, v0, 1, 1
    s_mov_b32 s38, 0x8
    v_mad_u32_u24 v5, v14, s38, v5
    v_bfe_u32 v14, v0, 2, 1
    s_mov_b32 s38, 0x10
    v_mad_u32_u24 v5, v14, s38, v5
    v_bfe_u32 v14, v0, 3, 1
    s_mov_b32 s38, 0x20
    v_mad_u32_u24 v5, v14, s38, v5
    v_bfe_u32 v14, v0, 4, 1
    s_mov_b32 s38, 0x240
    v_mad_u32_u24 v5, v14, s38, v5
    v_bfe_u32 v14, v0, 5, 1
    s_mov_b32 s38, 0x480
    v_mad_u32_u24 v5, v14, s38, v5
    v_bfe_u32 v14, v0, 6, 1
    s_mov_b32 s38, 0x40
    v_mad_u32_u24 v5, v14, s38, v5
    v_bfe_u32 v14, v0, 7, 1
    s_mov_b32 s38, 0x80
    v_mad_u32_u24 v5, v14, s38, v5
    v_mov_b32 v6, 0x4000
    v_bfe_u32 v14, v0, 0, 1
    s_mov_b32 s38, 0x120
    v_mad_u32_u24 v6, v14, s38, v6
    v_bfe_u32 v14, v0, 2, 1
    s_mov_b32 s38, 0x240
    v_mad_u32_u24 v6, v14, s38, v6
    v_bfe_u32 v14, v0, 3, 1
    s_mov_b32 s38, 0x480
    v_mad_u32_u24 v6, v14, s38, v6
    v_bfe_u32 v14, v0, 4, 1
    s_mov_b32 s38, 0x10
    v_mad_u32_u24 v6, v14, s38, v6
    v_bfe_u32 v14, v0, 5, 1
    s_mov_b32 s38, 0x20
    v_mad_u32_u24 v6, v14, s38, v6
    v_add_u32 v7, 2304, v5
    v_xor_b32 v8, 0x1000, v2
    v_mov_b32 v13, 0x0
    v_bfe_u32 v14, v0, 0, 1
    s_mov_b32 s38, 0x4
    v_mad_u32_u24 v13, v14, s38, v13
    v_bfe_u32 v14, v0, 1, 1
    s_mov_b32 s38, 0x8
    v_mad_u32_u24 v13, v14, s38, v13
    v_bfe_u32 v14, v0, 2, 1
    s_mov_b32 s38, 0x10
    v_mad_u32_u24 v13, v14, s38, v13
    v_bfe_u32 v14, v0, 3, 1
    s_mov_b32 s38, 0x20
    v_mad_u32_u24 v13, v14, s38, v13
    v_bfe_u32 v14, v0, 4, 1
    s_mov_b32 s38, 0x40
    v_mad_u32_u24 v13, v14, s38, v13
    v_mov_b32 v24, 0x0
    v_bfe_u32 v14, v0, 3, 1
    s_mov_b32 s38, 0x1
    v_mad_u32_u24 v24, v14, s38, v24
    v_bfe_u32 v14, v0, 4, 1
    s_mov_b32 s38, 0x2
    v_mad_u32_u24 v24, v14, s38, v24
    v_bfe_u32 v14, v0, 5, 1
    s_mov_b32 s38, 0x4
    v_mad_u32_u24 v24, v14, s38, v24
    v_bfe_u32 v14, v0, 6, 1
    s_mov_b32 s38, 0x8
    v_mad_u32_u24 v24, v14, s38, v24
    v_bfe_u32 v14, v0, 7, 1
    s_mov_b32 s38, 0x10
    v_mad_u32_u24 v24, v14, s38, v24
    v_add_u32 v24, s20, v24
    v_and_b32 v24, 31, v24
    v_lshlrev_b32 v24, 6, v24
    v_mov_b32 v9, 0x0
    v_bfe_u32 v14, v0, 0, 1
    s_mov_b32 s38, 0x8
    v_mad_u32_u24 v9, v14, s38, v9
    v_bfe_u32 v14, v0, 1, 1
    s_mov_b32 s38, 0x10
    v_mad_u32_u24 v9, v14, s38, v9
    v_bfe_u32 v14, v0, 2, 1
    s_mov_b32 s38, 0x20
    v_mad_u32_u24 v9, v14, s38, v9
    v_bfe_u32 v14, v0, 3, 1
    s_mov_b32 s38, 0x2000
    v_mad_u32_u24 v9, v14, s38, v9
    v_bfe_u32 v14, v0, 4, 1
    s_mov_b32 s38, 0x4000
    v_mad_u32_u24 v9, v14, s38, v9
    v_bfe_u32 v14, v0, 5, 1
    s_mov_b32 s38, 0x8000
    v_mad_u32_u24 v9, v14, s38, v9
    v_bfe_u32 v14, v0, 6, 1
    s_mov_b32 s38, 0x10000
    v_mad_u32_u24 v9, v14, s38, v9
    v_bfe_u32 v14, v0, 7, 1
    s_mov_b32 s38, 0x20000
    v_mad_u32_u24 v9, v14, s38, v9
    v_add_u32 v9, v9, v24
    v_mov_b32 v10, 0x80000
    v_bfe_u32 v14, v0, 0, 1
    s_mov_b32 s38, 0x8
    v_mad_u32_u24 v10, v14, s38, v10
    v_bfe_u32 v14, v0, 1, 1
    s_mov_b32 s38, 0x20
    v_mad_u32_u24 v10, v14, s38, v10
    v_bfe_u32 v14, v0, 4, 1
    s_mov_b32 s38, 0x10
    v_mad_u32_u24 v10, v14, s38, v10
    v_bfe_u32 v14, v0, 5, 1
    s_mov_b32 s38, 0x4
    v_mad_u32_u24 v10, v14, s38, v10
    v_bfe_u32 v14, v0, 6, 1
    s_mov_b32 s38, 0x800
    v_mad_u32_u24 v10, v14, s38, v10
    v_bfe_u32 v14, v0, 7, 1
    s_mov_b32 s38, 0x1000
    v_mad_u32_u24 v10, v14, s38, v10
    v_mov_b32 v25, s20
    v_mov_b32 v24, 0x0
    v_bfe_u32 v14, v25, 0, 1
    s_mov_b32 s38, 0x100
    v_mad_u32_u24 v24, v14, s38, v24
    v_bfe_u32 v14, v25, 1, 1
    s_mov_b32 s38, 0x40
    v_mad_u32_u24 v24, v14, s38, v24
    v_bfe_u32 v14, v25, 2, 1
    s_mov_b32 s38, 0x80
    v_mad_u32_u24 v24, v14, s38, v24
    v_bfe_u32 v14, v25, 3, 1
    s_mov_b32 s38, 0x200
    v_mad_u32_u24 v24, v14, s38, v24
    v_bfe_u32 v14, v25, 4, 1
    s_mov_b32 s38, 0x400
    v_mad_u32_u24 v24, v14, s38, v24
    v_add_u32 v10, v24, v10
    v_and_b32 v24, 12, v0
    v_cmp_ne_u32 vcc, 0, v24
    v_mov_b32 v24, 0x40000000
    s_nop 0
    v_cndmask_b32 v10, v10, v24, vcc
    s_lshl_b32 s6, s20, 13
    s_add_u32 s6, s6, 0x0
    s_mov_b32 s26, 4096
    v_and_b32 v24, 15, v0
    v_mov_b32 v16, 0
    v_mov_b32 v25, 0x3f80
    v_cmp_eq_u32 vcc, 0, v24
    s_nop 1
    v_cndmask_b32 v16, v16, v25, vcc
    v_mov_b32 v25, 0x3f800000
    v_cmp_eq_u32 vcc, 1, v24
    s_nop 1
    v_cndmask_b32 v16, v16, v25, vcc
    v_mov_b32 v17, 0
    v_mov_b32 v25, 0x3f80
    v_cmp_eq_u32 vcc, 4, v24
    s_nop 1
    v_cndmask_b32 v17, v17, v25, vcc
    v_mov_b32 v25, 0x3f800000
    v_cmp_eq_u32 vcc, 5, v24
    s_nop 1
    v_cndmask_b32 v17, v17, v25, vcc
    v_mov_b32 v18, 0
    v_mov_b32 v25, 0x3f80
    v_cmp_eq_u32 vcc, 8, v24
    s_nop 1
    v_cndmask_b32 v18, v18, v25, vcc
    v_mov_b32 v25, 0x3f800000
    v_cmp_eq_u32 vcc, 9, v24
    s_nop 1
    v_cndmask_b32 v18, v18, v25, vcc
    v_mov_b32 v19, 0
    v_mov_b32 v25, 0x3f80
    v_cmp_eq_u32 vcc, 12, v24
    s_nop 1
    v_cndmask_b32 v19, v19, v25, vcc
    v_mov_b32 v25, 0x3f800000
    v_cmp_eq_u32 vcc, 13, v24
    s_nop 1
    v_cndmask_b32 v19, v19, v25, vcc
    ds_write_b128 v3, v[16:19] offset:23040
    s_mov_b32 s34, 0x05040100
    s_mov_b32 s35, 0x07060302
    s_mov_b32 s33, 0x3e0293ee
    s_mov_b32 s40, 0x4e800000
    s_mov_b32 s32, 0
    s_mov_b32 s4, 0x3f803f80
    s_mov_b32 s5, 0x3f803f80
    s_lshl_b32 s36, s20, 14
    s_lshr_b32 s37, s21, 1
    s_lshl_b32 s37, s37, 12
    s_add_u32 s25, s36, s37
    s_lshl_b32 s37, s21, 11
    s_add_u32 s39, s36, s37
    s_add_u32 s39, s39, 8192
    v_mov_b32 v11, 0x0
    v_bfe_u32 v14, v0, 0, 1
    s_mov_b32 s38, 0x4
    v_mad_u32_u24 v11, v14, s38, v11
    v_bfe_u32 v14, v0, 1, 1
    s_mov_b32 s38, 0x8
    v_mad_u32_u24 v11, v14, s38, v11
    v_bfe_u32 v14, v0, 2, 1
    s_mov_b32 s38, 0x10
    v_mad_u32_u24 v11, v14, s38, v11
    v_bfe_u32 v14, v0, 3, 1
    s_mov_b32 s38, 0x20
    v_mad_u32_u24 v11, v14, s38, v11
    v_bfe_u32 v14, v0, 4, 1
    s_mov_b32 s38, 0x800
    v_mad_u32_u24 v11, v14, s38, v11
    v_bfe_u32 v14, v0, 5, 1
    s_mov_b32 s38, 0x1000
    v_mad_u32_u24 v11, v14, s38, v11
    v_bfe_u32 v14, v0, 6, 1
    s_mov_b32 s38, 0x100
    v_mad_u32_u24 v11, v14, s38, v11
    v_bfe_u32 v14, v0, 7, 1
    s_mov_b32 s38, 0x200
    v_mad_u32_u24 v11, v14, s38, v11
    s_mov_b32 s96, s48
    s_and_b32 s97, s49, 0xffff
    s_mov_b32 s98, 0x400000
    s_mov_b32 s99, 0x20000
    s_mov_b32 s88, s50
    s_and_b32 s89, s51, 0xffff
    s_mov_b32 s90, 0x400000
    s_mov_b32 s91, 0x20000
    s_mov_b32 s60, s52
    s_and_b32 s61, s53, 0xffff
    s_mov_b32 s62, 0x400000
    s_mov_b32 s63, 0x20000
    s_mov_b32 s92, s54
    s_and_b32 s93, s55, 0xffff
    s_mov_b32 s94, 0x400000
    s_mov_b32 s95, 0x20000
    s_lshl_b32 s29, s20, 17
    v_mov_b32 v16, 0x0
    v_bfe_u32 v14, v0, 0, 1
    s_mov_b32 s38, 0x10
    v_mad_u32_u24 v16, v14, s38, v16
    v_bfe_u32 v14, v0, 1, 1
    s_mov_b32 s38, 0x20
    v_mad_u32_u24 v16, v14, s38, v16
    v_bfe_u32 v14, v0, 2, 1
    s_mov_b32 s38, 0x40
    v_mad_u32_u24 v16, v14, s38, v16
    v_bfe_u32 v14, v0, 3, 1
    s_mov_b32 s38, 0x80
    v_mad_u32_u24 v16, v14, s38, v16
    v_bfe_u32 v14, v0, 4, 1
    s_mov_b32 s38, 0x2000
    v_mad_u32_u24 v16, v14, s38, v16
    v_bfe_u32 v14, v0, 5, 1
    s_mov_b32 s38, 0x4000
    v_mad_u32_u24 v16, v14, s38, v16
    v_bfe_u32 v14, v0, 6, 1
    s_mov_b32 s38, 0x40000
    v_mad_u32_u24 v16, v14, s38, v16
    v_bfe_u32 v14, v0, 7, 1
    s_mov_b32 s38, 0x80000
    v_mad_u32_u24 v16, v14, s38, v16
    v_mov_b32 v28, 0x0
    v_bfe_u32 v14, v0, 4, 1
    s_mov_b32 s38, 0x20
    v_mad_u32_u24 v28, v14, s38, v28
    v_xor_b32 v16, v16, v28
    v_xor_b32 v17, 64, v16
    v_xor_b32 v18, 128, v16
    v_xor_b32 v19, 192, v16
    v_mov_b32 v20, 0x0
    v_bfe_u32 v14, v0, 0, 1
    s_mov_b32 s38, 0x8
    v_mad_u32_u24 v20, v14, s38, v20
    v_bfe_u32 v14, v0, 1, 1
    s_mov_b32 s38, 0x10
    v_mad_u32_u24 v20, v14, s38, v20
    v_bfe_u32 v14, v0, 2, 1
    s_mov_b32 s38, 0x100
    v_mad_u32_u24 v20, v14, s38, v20
    v_bfe_u32 v14, v0, 3, 1
    s_mov_b32 s38, 0x800
    v_mad_u32_u24 v20, v14, s38, v20
    v_bfe_u32 v14, v0, 4, 1
    s_mov_b32 s38, 0x400
    v_mad_u32_u24 v20, v14, s38, v20
    v_bfe_u32 v14, v0, 5, 1
    s_mov_b32 s38, 0x1000
    v_mad_u32_u24 v20, v14, s38, v20
    v_mov_b32 v28, 0x0
    v_bfe_u32 v14, v0, 2, 1
    s_mov_b32 s38, 0x20
    v_mad_u32_u24 v28, v14, s38, v28
    v_bfe_u32 v14, v0, 3, 1
    s_mov_b32 s38, 0x80
    v_mad_u32_u24 v28, v14, s38, v28
    v_bfe_u32 v14, v0, 4, 1
    s_mov_b32 s38, 0x40
    v_mad_u32_u24 v28, v14, s38, v28
    v_mov_b32 v29, 0x0
    v_bfe_u32 v14, v0, 6, 1
    s_mov_b32 s38, 0x40
    v_mad_u32_u24 v29, v14, s38, v29
    v_bfe_u32 v14, v0, 7, 1
    s_mov_b32 s38, 0x80
    v_mad_u32_u24 v29, v14, s38, v29
    v_xor_b32 v28, v28, v29
    v_add_u32 v28, v28, v20
    s_xor_b32 s36, s21, 0
    s_add_u32 s36, s36, 1
    s_lshl_b32 s36, s36, 15
    v_add_u32 v20, s36, v28
    v_xor_b32 v21, 32, v20
    s_xor_b32 s36, s21, 1
    s_add_u32 s36, s36, 1
    s_lshl_b32 s36, s36, 15
    v_add_u32 v22, s36, v28
    v_xor_b32 v23, 32, v22
    s_xor_b32 s36, s21, 2
    s_add_u32 s36, s36, 1
    s_lshl_b32 s36, s36, 15
    v_add_u32 v24, s36, v28
    v_xor_b32 v25, 32, v24
    s_xor_b32 s36, s21, 3
    s_add_u32 s36, s36, 1
    s_lshl_b32 s36, s36, 15
    v_add_u32 v26, s36, v28
    v_xor_b32 v27, 32, v26
    s_add_u32 s28, s21, 1
    s_lshl_b32 s28, s28, 15
    s_lshl_b32 s3, s20, 8
    s_add_u32 m0, s28, 0
    s_add_u32 s37, s3, 0x0
    buffer_load_dwordx4 v16, s[60:63], s37 offen nt lds
    s_add_u32 m0, s28, 1024
    s_add_u32 s37, s3, 0x8000
    buffer_load_dwordx4 v17, s[60:63], s37 offen nt lds
    s_add_u32 m0, s28, 2048
    s_add_u32 s37, s3, 0x10000
    buffer_load_dwordx4 v18, s[60:63], s37 offen nt lds
    s_add_u32 m0, s28, 3072
    s_add_u32 s37, s3, 0x18000
    buffer_load_dwordx4 v19, s[60:63], s37 offen nt lds
    s_add_u32 m0, s28, 4096
    s_add_u32 s37, s3, 0x20000
    buffer_load_dwordx4 v16, s[60:63], s37 offen nt lds
    s_add_u32 m0, s28, 5120
    s_add_u32 s37, s3, 0x28000
    buffer_load_dwordx4 v17, s[60:63], s37 offen nt lds
    s_add_u32 m0, s28, 6144
    s_add_u32 s37, s3, 0x30000
    buffer_load_dwordx4 v18, s[60:63], s37 offen nt lds
    s_add_u32 m0, s28, 7168
    s_add_u32 s37, s3, 0x38000
    buffer_load_dwordx4 v19, s[60:63], s37 offen nt lds
    s_mov_b32 s12, s46
    s_and_b32 s13, s47, 0xffff
    s_mov_b32 s14, 0x2000
    s_mov_b32 s15, 0x20000
    v_mov_b32 v104, 0x0
    v_bfe_u32 v14, v0, 0, 1
    s_mov_b32 s38, 0x8
    v_mad_u32_u24 v104, v14, s38, v104
    v_bfe_u32 v14, v0, 1, 1
    s_mov_b32 s38, 0x10
    v_mad_u32_u24 v104, v14, s38, v104
    v_bfe_u32 v14, v0, 2, 1
    s_mov_b32 s38, 0x10000
    v_mad_u32_u24 v104, v14, s38, v104
    v_bfe_u32 v14, v0, 3, 1
    s_mov_b32 s38, 0x10000
    v_mad_u32_u24 v104, v14, s38, v104
    v_bfe_u32 v14, v0, 4, 1
    s_mov_b32 s38, 0x400
    v_mad_u32_u24 v104, v14, s38, v104
    v_bfe_u32 v14, v0, 5, 1
    s_mov_b32 s38, 0x4
    v_mad_u32_u24 v104, v14, s38, v104
    v_bfe_u32 v14, v0, 6, 1
    s_mov_b32 s38, 0x40
    v_mad_u32_u24 v104, v14, s38, v104
    v_bfe_u32 v14, v0, 7, 1
    s_mov_b32 s38, 0x80
    v_mad_u32_u24 v104, v14, s38, v104
    v_mov_b32 v106, s20
    v_mov_b32 v105, 0x0
    v_bfe_u32 v14, v106, 0, 1
    s_mov_b32 s38, 0x20
    v_mad_u32_u24 v105, v14, s38, v105
    v_bfe_u32 v14, v106, 1, 1
    s_mov_b32 s38, 0x800
    v_mad_u32_u24 v105, v14, s38, v105
    v_bfe_u32 v14, v106, 2, 1
    s_mov_b32 s38, 0x1000
    v_mad_u32_u24 v105, v14, s38, v105
    v_bfe_u32 v14, v106, 3, 1
    s_mov_b32 s38, 0x100
    v_mad_u32_u24 v105, v14, s38, v105
    v_bfe_u32 v14, v106, 4, 1
    s_mov_b32 s38, 0x200
    v_mad_u32_u24 v105, v14, s38, v105
    v_add_u32 v104, v104, v105
    buffer_load_dword v12, v104, s[12:15], 0 offen
    v_mov_b32 v100, -1
    v_mov_b32 v101, -1
    v_mov_b32 v102, -1
    v_mov_b32 v103, -1
    buffer_store_dwordx4 v[100:103], v2, s[8:11], s6 offen sc1
    buffer_store_dwordx4 v[100:103], v2, s[8:11], s6 offen offset:1024 sc1
    s_lshl_b32 s36, s20, 14
    s_add_u32 s36, s36, 0x100000
    s_add_u32 s37, s36, 0x2000
    buffer_store_dwordx4 v[100:103], v2, s[8:11], s36 offen sc1
    buffer_store_dwordx4 v[100:103], v2, s[8:11], s36 offen offset:1024 sc1
    buffer_store_dwordx4 v[100:103], v2, s[8:11], s37 offen sc1
    buffer_store_dwordx4 v[100:103], v2, s[8:11], s37 offen offset:1024 sc1
    s_mul_i32 s36, s20, 0x104000
    s_add_u32 s36, s36, 0x1102000
    s_add_u32 s37, s36, 0x82000
    buffer_store_dwordx4 v[100:103], v2, s[8:11], s36 offen sc1
    buffer_store_dwordx4 v[100:103], v2, s[8:11], s36 offen offset:1024 sc1
    buffer_store_dwordx4 v[100:103], v2, s[8:11], s37 offen sc1
    buffer_store_dwordx4 v[100:103], v2, s[8:11], s37 offen offset:1024 sc1
    v_lshlrev_b32 v104, 2, v0
    s_lshl_b32 s36, s20, 10
    s_add_u32 s37, s36, 0x194000
    buffer_store_dword v100, v104, s[8:11], s37 offen sc1
    s_add_u32 s37, s36, 0x1b0000
    buffer_store_dword v100, v104, s[8:11], s37 offen sc1
    s_add_u32 s37, s36, 0x1b8000
    buffer_store_dword v100, v104, s[8:11], s37 offen sc1
    v_mov_b32 v105, 0x40000000
    v_cmp_lt_u32 vcc, 63, v0
    s_nop 1
    v_cndmask_b32 v104, v104, v105, vcc
    v_mov_b32 v105, 0
    s_lshl_b32 s36, s20, 8
    s_add_u32 s36, s36, 0x190000
    s_add_u32 s37, s36, 0x2000
    s_lshl_b32 s38, s20, 2
    s_add_u32 s38, s38, 0x80000
    s_lshl_b32 s7, s21, 7
    s_add_u32 s38, s38, s7
    buffer_store_dword v105, off, s[8:11], s38 sc1
    buffer_store_dword v105, v104, s[8:11], s36 offen sc1
    buffer_store_dword v105, v104, s[8:11], s37 offen sc1
    s_add_u32 m0, s28, 8192
    s_add_u32 s37, s3, 0x100000
    buffer_load_dwordx4 v16, s[60:63], s37 offen nt lds
    s_add_u32 m0, s28, 9216
    s_add_u32 s37, s3, 0x108000
    buffer_load_dwordx4 v17, s[60:63], s37 offen nt lds
    s_add_u32 m0, s28, 10240
    s_add_u32 s37, s3, 0x110000
    buffer_load_dwordx4 v18, s[60:63], s37 offen nt lds
    s_add_u32 m0, s28, 11264
    s_add_u32 s37, s3, 0x118000
    buffer_load_dwordx4 v19, s[60:63], s37 offen nt lds
    s_add_u32 m0, s28, 12288
    s_add_u32 s37, s3, 0x120000
    buffer_load_dwordx4 v16, s[60:63], s37 offen nt lds
    s_add_u32 m0, s28, 13312
    s_add_u32 s37, s3, 0x128000
    buffer_load_dwordx4 v17, s[60:63], s37 offen nt lds
    s_add_u32 m0, s28, 14336
    s_add_u32 s37, s3, 0x130000
    buffer_load_dwordx4 v18, s[60:63], s37 offen nt lds
    s_add_u32 m0, s28, 15360
    s_add_u32 s37, s3, 0x138000
    buffer_load_dwordx4 v19, s[60:63], s37 offen nt lds
    s_add_u32 m0, s28, 16384
    s_add_u32 s37, s3, 0x200000
    buffer_load_dwordx4 v16, s[60:63], s37 offen nt lds
    s_add_u32 m0, s28, 17408
    s_add_u32 s37, s3, 0x208000
    buffer_load_dwordx4 v17, s[60:63], s37 offen nt lds
    s_add_u32 m0, s28, 18432
    s_add_u32 s37, s3, 0x210000
    buffer_load_dwordx4 v18, s[60:63], s37 offen nt lds
    s_add_u32 m0, s28, 19456
    s_add_u32 s37, s3, 0x218000
    buffer_load_dwordx4 v19, s[60:63], s37 offen nt lds
    s_add_u32 m0, s28, 20480
    s_add_u32 s37, s3, 0x220000
    buffer_load_dwordx4 v16, s[60:63], s37 offen nt lds
    s_add_u32 m0, s28, 21504
    s_add_u32 s37, s3, 0x228000
    buffer_load_dwordx4 v17, s[60:63], s37 offen nt lds
    s_add_u32 m0, s28, 22528
    s_add_u32 s37, s3, 0x230000
    buffer_load_dwordx4 v18, s[60:63], s37 offen nt lds
    s_add_u32 m0, s28, 23552
    s_add_u32 s37, s3, 0x238000
    buffer_load_dwordx4 v19, s[60:63], s37 offen nt lds
    s_xor_b32 s36, s21, 0
    s_lshl_b32 s36, s36, 15
    s_add_u32 s36, s36, s29
    s_add_u32 s37, s36, 0x0
    buffer_load_dword v32, v11, s[92:95], s37 offen
    s_add_u32 s37, s36, 0x4000
    buffer_load_dword v33, v11, s[92:95], s37 offen
    s_add_u32 s37, s36, 0x400
    buffer_load_dword v34, v11, s[92:95], s37 offen
    s_add_u32 s37, s36, 0x4400
    buffer_load_dword v35, v11, s[92:95], s37 offen
    s_add_u32 s37, s36, 0x2000
    buffer_load_dword v36, v11, s[92:95], s37 offen
    s_add_u32 s37, s36, 0x6000
    buffer_load_dword v37, v11, s[92:95], s37 offen
    s_add_u32 s37, s36, 0x2400
    buffer_load_dword v38, v11, s[92:95], s37 offen
    s_add_u32 s37, s36, 0x6400
    buffer_load_dword v39, v11, s[92:95], s37 offen
    s_add_u32 s37, s36, 0x40
    buffer_load_dword v40, v11, s[92:95], s37 offen
    s_add_u32 s37, s36, 0x4040
    buffer_load_dword v41, v11, s[92:95], s37 offen
    s_add_u32 s37, s36, 0x440
    buffer_load_dword v42, v11, s[92:95], s37 offen
    s_add_u32 s37, s36, 0x4440
    buffer_load_dword v43, v11, s[92:95], s37 offen
    s_add_u32 s37, s36, 0x2040
    buffer_load_dword v44, v11, s[92:95], s37 offen
    s_add_u32 s37, s36, 0x6040
    buffer_load_dword v45, v11, s[92:95], s37 offen
    s_add_u32 s37, s36, 0x2440
    buffer_load_dword v46, v11, s[92:95], s37 offen
    s_add_u32 s37, s36, 0x6440
    buffer_load_dword v47, v11, s[92:95], s37 offen
    s_waitcnt vmcnt(49)
    s_barrier
    ds_read_b64_tr_b16 a[160:161], v20 offset:0
    ds_read_b64_tr_b16 a[162:163], v20 offset:512
    ds_read_b64_tr_b16 a[168:169], v21 offset:0
    ds_read_b64_tr_b16 a[170:171], v21 offset:512
    ds_read_b64_tr_b16 a[192:193], v22 offset:0
    ds_read_b64_tr_b16 a[194:195], v22 offset:512
    ds_read_b64_tr_b16 a[200:201], v23 offset:0
    ds_read_b64_tr_b16 a[202:203], v23 offset:512
    ds_read_b64_tr_b16 a[224:225], v24 offset:0
    ds_read_b64_tr_b16 a[226:227], v24 offset:512
    ds_read_b64_tr_b16 a[232:233], v25 offset:0
    ds_read_b64_tr_b16 a[234:235], v25 offset:512
    s_waitcnt lgkmcnt(4)
    ds_read_b64_tr_b16 v[128:129], v26 offset:0
    ds_read_b64_tr_b16 v[130:131], v26 offset:512
    ds_read_b64_tr_b16 v[136:137], v27 offset:0
    ds_read_b64_tr_b16 v[138:139], v27 offset:512
    s_waitcnt lgkmcnt(0)
    s_barrier
    s_add_u32 m0, s28, 0
    s_add_u32 s37, s3, 0x300000
    buffer_load_dwordx4 v16, s[60:63], s37 offen nt lds
    s_add_u32 m0, s28, 1024
    s_add_u32 s37, s3, 0x308000
    buffer_load_dwordx4 v17, s[60:63], s37 offen nt lds
    s_add_u32 m0, s28, 2048
    s_add_u32 s37, s3, 0x310000
    buffer_load_dwordx4 v18, s[60:63], s37 offen nt lds
    s_add_u32 m0, s28, 3072
    s_add_u32 s37, s3, 0x318000
    buffer_load_dwordx4 v19, s[60:63], s37 offen nt lds
    s_add_u32 m0, s28, 4096
    s_add_u32 s37, s3, 0x320000
    buffer_load_dwordx4 v16, s[60:63], s37 offen nt lds
    s_add_u32 m0, s28, 5120
    s_add_u32 s37, s3, 0x328000
    buffer_load_dwordx4 v17, s[60:63], s37 offen nt lds
    s_add_u32 m0, s28, 6144
    s_add_u32 s37, s3, 0x330000
    buffer_load_dwordx4 v18, s[60:63], s37 offen nt lds
    s_add_u32 m0, s28, 7168
    s_add_u32 s37, s3, 0x338000
    buffer_load_dwordx4 v19, s[60:63], s37 offen nt lds
    s_waitcnt vmcnt(40)
    s_mov_b32 s36, 0x1000000
    buffer_store_dword v12, v10, s[8:11], s36 offen sc1
    s_xor_b32 s36, s21, 0
    s_lshl_b32 s36, s36, 15
    s_add_u32 s36, s36, s29
    s_add_u32 s37, s36, 0x80
    buffer_load_dword v48, v11, s[92:95], s37 offen
    s_add_u32 s37, s36, 0x4080
    buffer_load_dword v49, v11, s[92:95], s37 offen
    s_add_u32 s37, s36, 0x480
    buffer_load_dword v50, v11, s[92:95], s37 offen
    s_add_u32 s37, s36, 0x4480
    buffer_load_dword v51, v11, s[92:95], s37 offen
    s_add_u32 s37, s36, 0x2080
    buffer_load_dword v52, v11, s[92:95], s37 offen
    s_add_u32 s37, s36, 0x6080
    buffer_load_dword v53, v11, s[92:95], s37 offen
    s_add_u32 s37, s36, 0x2480
    buffer_load_dword v54, v11, s[92:95], s37 offen
    s_add_u32 s37, s36, 0x6480
    buffer_load_dword v55, v11, s[92:95], s37 offen
    s_add_u32 s37, s36, 0xc0
    buffer_load_dword v56, v11, s[92:95], s37 offen
    s_add_u32 s37, s36, 0x40c0
    buffer_load_dword v57, v11, s[92:95], s37 offen
    s_add_u32 s37, s36, 0x4c0
    buffer_load_dword v58, v11, s[92:95], s37 offen
    s_add_u32 s37, s36, 0x44c0
    buffer_load_dword v59, v11, s[92:95], s37 offen
    s_add_u32 s37, s36, 0x20c0
    buffer_load_dword v60, v11, s[92:95], s37 offen
    s_add_u32 s37, s36, 0x60c0
    buffer_load_dword v61, v11, s[92:95], s37 offen
    s_add_u32 s37, s36, 0x24c0
    buffer_load_dword v62, v11, s[92:95], s37 offen
    s_add_u32 s37, s36, 0x64c0
    buffer_load_dword v63, v11, s[92:95], s37 offen
    s_waitcnt vmcnt(49)
    s_barrier
    ds_read_b64_tr_b16 a[164:165], v20 offset:8192
    ds_read_b64_tr_b16 a[166:167], v20 offset:8704
    ds_read_b64_tr_b16 a[172:173], v21 offset:8192
    ds_read_b64_tr_b16 a[174:175], v21 offset:8704
    ds_read_b64_tr_b16 a[196:197], v22 offset:8192
    ds_read_b64_tr_b16 a[198:199], v22 offset:8704
    ds_read_b64_tr_b16 a[204:205], v23 offset:8192
    ds_read_b64_tr_b16 a[206:207], v23 offset:8704
    ds_read_b64_tr_b16 a[228:229], v24 offset:8192
    ds_read_b64_tr_b16 a[230:231], v24 offset:8704
    ds_read_b64_tr_b16 a[236:237], v25 offset:8192
    ds_read_b64_tr_b16 a[238:239], v25 offset:8704
    s_waitcnt lgkmcnt(4)
    ds_read_b64_tr_b16 v[132:133], v26 offset:8192
    ds_read_b64_tr_b16 v[134:135], v26 offset:8704
    ds_read_b64_tr_b16 v[140:141], v27 offset:8192
    ds_read_b64_tr_b16 v[142:143], v27 offset:8704
    s_waitcnt lgkmcnt(0)
    s_barrier
    s_add_u32 m0, s28, 8192
    s_add_u32 s37, s3, 0x0
    buffer_load_dwordx4 v16, s[88:91], s37 offen nt lds
    s_add_u32 m0, s28, 9216
    s_add_u32 s37, s3, 0x8000
    buffer_load_dwordx4 v17, s[88:91], s37 offen nt lds
    s_add_u32 m0, s28, 10240
    s_add_u32 s37, s3, 0x10000
    buffer_load_dwordx4 v18, s[88:91], s37 offen nt lds
    s_add_u32 m0, s28, 11264
    s_add_u32 s37, s3, 0x18000
    buffer_load_dwordx4 v19, s[88:91], s37 offen nt lds
    s_add_u32 m0, s28, 12288
    s_add_u32 s37, s3, 0x20000
    buffer_load_dwordx4 v16, s[88:91], s37 offen nt lds
    s_add_u32 m0, s28, 13312
    s_add_u32 s37, s3, 0x28000
    buffer_load_dwordx4 v17, s[88:91], s37 offen nt lds
    s_add_u32 m0, s28, 14336
    s_add_u32 s37, s3, 0x30000
    buffer_load_dwordx4 v18, s[88:91], s37 offen nt lds
    s_add_u32 m0, s28, 15360
    s_add_u32 s37, s3, 0x38000
    buffer_load_dwordx4 v19, s[88:91], s37 offen nt lds
    s_waitcnt vmcnt(33)
    v_perm_b32 v120, v33, v32, s34
    v_perm_b32 v121, v33, v32, s35
    v_perm_b32 v122, v35, v34, s34
    v_perm_b32 v123, v35, v34, s35
    v_perm_b32 v124, v37, v36, s34
    v_perm_b32 v125, v37, v36, s35
    v_perm_b32 v126, v39, v38, s34
    v_perm_b32 v127, v39, v38, s35
    ds_write_b128 v4, v[120:123] offset:24576
    ds_write_b128 v4, v[124:127] offset:25600
    s_waitcnt lgkmcnt(0)
    v_perm_b32 v120, v41, v40, s34
    v_perm_b32 v121, v41, v40, s35
    v_perm_b32 v122, v43, v42, s34
    v_perm_b32 v123, v43, v42, s35
    v_perm_b32 v124, v45, v44, s34
    v_perm_b32 v125, v45, v44, s35
    v_perm_b32 v126, v47, v46, s34
    v_perm_b32 v127, v47, v46, s35
    ds_write_b128 v4, v[120:123] offset:26624
    ds_write_b128 v4, v[124:127] offset:27648
    s_waitcnt lgkmcnt(0)
    s_xor_b32 s36, s21, 1
    s_lshl_b32 s36, s36, 15
    s_add_u32 s36, s36, s29
    s_add_u32 s37, s36, 0x0
    buffer_load_dword v80, v11, s[92:95], s37 offen
    s_add_u32 s37, s36, 0x4000
    buffer_load_dword v81, v11, s[92:95], s37 offen
    s_add_u32 s37, s36, 0x400
    buffer_load_dword v82, v11, s[92:95], s37 offen
    s_add_u32 s37, s36, 0x4400
    buffer_load_dword v83, v11, s[92:95], s37 offen
    s_add_u32 s37, s36, 0x2000
    buffer_load_dword v84, v11, s[92:95], s37 offen
    s_add_u32 s37, s36, 0x6000
    buffer_load_dword v85, v11, s[92:95], s37 offen
    s_add_u32 s37, s36, 0x2400
    buffer_load_dword v86, v11, s[92:95], s37 offen
    s_add_u32 s37, s36, 0x6400
    buffer_load_dword v87, v11, s[92:95], s37 offen
    s_add_u32 s37, s36, 0x40
    buffer_load_dword v88, v11, s[92:95], s37 offen
    s_add_u32 s37, s36, 0x4040
    buffer_load_dword v89, v11, s[92:95], s37 offen
    s_add_u32 s37, s36, 0x440
    buffer_load_dword v90, v11, s[92:95], s37 offen
    s_add_u32 s37, s36, 0x4440
    buffer_load_dword v91, v11, s[92:95], s37 offen
    s_add_u32 s37, s36, 0x2040
    buffer_load_dword v92, v11, s[92:95], s37 offen
    s_add_u32 s37, s36, 0x6040
    buffer_load_dword v93, v11, s[92:95], s37 offen
    s_add_u32 s37, s36, 0x2440
    buffer_load_dword v94, v11, s[92:95], s37 offen
    s_add_u32 s37, s36, 0x6440
    buffer_load_dword v95, v11, s[92:95], s37 offen
    s_barrier
    ds_read_b64_tr_b16 a[176:177], v20 offset:16384
    ds_read_b64_tr_b16 a[178:179], v20 offset:16896
    ds_read_b64_tr_b16 a[184:185], v21 offset:16384
    ds_read_b64_tr_b16 a[186:187], v21 offset:16896
    ds_read_b64_tr_b16 a[208:209], v22 offset:16384
    ds_read_b64_tr_b16 a[210:211], v22 offset:16896
    ds_read_b64_tr_b16 a[216:217], v23 offset:16384
    ds_read_b64_tr_b16 a[218:219], v23 offset:16896
    ds_read_b64_tr_b16 a[240:241], v24 offset:16384
    ds_read_b64_tr_b16 a[242:243], v24 offset:16896
    ds_read_b64_tr_b16 a[248:249], v25 offset:16384
    ds_read_b64_tr_b16 a[250:251], v25 offset:16896
    s_waitcnt lgkmcnt(4)
    ds_read_b64_tr_b16 v[144:145], v26 offset:16384
    ds_read_b64_tr_b16 v[146:147], v26 offset:16896
    ds_read_b64_tr_b16 v[152:153], v27 offset:16384
    ds_read_b64_tr_b16 v[154:155], v27 offset:16896
    s_waitcnt lgkmcnt(0)
    s_barrier
    s_add_u32 m0, s28, 16384
    s_add_u32 s37, s3, 0x100000
    buffer_load_dwordx4 v16, s[88:91], s37 offen nt lds
    s_add_u32 m0, s28, 17408
    s_add_u32 s37, s3, 0x108000
    buffer_load_dwordx4 v17, s[88:91], s37 offen nt lds
    s_add_u32 m0, s28, 18432
    s_add_u32 s37, s3, 0x110000
    buffer_load_dwordx4 v18, s[88:91], s37 offen nt lds
    s_add_u32 m0, s28, 19456
    s_add_u32 s37, s3, 0x118000
    buffer_load_dwordx4 v19, s[88:91], s37 offen nt lds
    s_add_u32 m0, s28, 20480
    s_add_u32 s37, s3, 0x120000
    buffer_load_dwordx4 v16, s[88:91], s37 offen nt lds
    s_add_u32 m0, s28, 21504
    s_add_u32 s37, s3, 0x128000
    buffer_load_dwordx4 v17, s[88:91], s37 offen nt lds
    s_add_u32 m0, s28, 22528
    s_add_u32 s37, s3, 0x130000
    buffer_load_dwordx4 v18, s[88:91], s37 offen nt lds
    s_add_u32 m0, s28, 23552
    s_add_u32 s37, s3, 0x138000
    buffer_load_dwordx4 v19, s[88:91], s37 offen nt lds
    s_waitcnt vmcnt(48)
    s_barrier
    s_getreg_b32 s36, hwreg(HW_REG_XCC_ID)
    s_and_b32 s36, s36, 15
    s_or_b32 s36, s36, 0x100
    v_mov_b32 v30, s36
    s_lshl_b32 s37, s20, 2
    v_lshlrev_b32 v31, 20, v0
    buffer_store_dword v30, v31, s[16:19], s37 offen offset:128 sc1
    s_waitcnt vmcnt(33)
    v_perm_b32 v120, v49, v48, s34
    v_perm_b32 v121, v49, v48, s35
    v_perm_b32 v122, v51, v50, s34
    v_perm_b32 v123, v51, v50, s35
    v_perm_b32 v124, v53, v52, s34
    v_perm_b32 v125, v53, v52, s35
    v_perm_b32 v126, v55, v54, s34
    v_perm_b32 v127, v55, v54, s35
    ds_write_b128 v4, v[120:123] offset:28672
    ds_write_b128 v4, v[124:127] offset:29696
    s_waitcnt lgkmcnt(0)
    v_perm_b32 v120, v57, v56, s34
    v_perm_b32 v121, v57, v56, s35
    v_perm_b32 v122, v59, v58, s34
    v_perm_b32 v123, v59, v58, s35
    v_perm_b32 v124, v61, v60, s34
    v_perm_b32 v125, v61, v60, s35
    v_perm_b32 v126, v63, v62, s34
    v_perm_b32 v127, v63, v62, s35
    ds_write_b128 v4, v[120:123] offset:30720
    ds_write_b128 v4, v[124:127] offset:31744
    s_waitcnt lgkmcnt(0)
    s_xor_b32 s36, s21, 1
    s_lshl_b32 s36, s36, 15
    s_add_u32 s36, s36, s29
    s_add_u32 s37, s36, 0x80
    buffer_load_dword v32, v11, s[92:95], s37 offen
    s_add_u32 s37, s36, 0x4080
    buffer_load_dword v33, v11, s[92:95], s37 offen
    s_add_u32 s37, s36, 0x480
    buffer_load_dword v34, v11, s[92:95], s37 offen
    s_add_u32 s37, s36, 0x4480
    buffer_load_dword v35, v11, s[92:95], s37 offen
    s_add_u32 s37, s36, 0x2080
    buffer_load_dword v36, v11, s[92:95], s37 offen
    s_add_u32 s37, s36, 0x6080
    buffer_load_dword v37, v11, s[92:95], s37 offen
    s_add_u32 s37, s36, 0x2480
    buffer_load_dword v38, v11, s[92:95], s37 offen
    s_add_u32 s37, s36, 0x6480
    buffer_load_dword v39, v11, s[92:95], s37 offen
    s_add_u32 s37, s36, 0xc0
    buffer_load_dword v40, v11, s[92:95], s37 offen
    s_add_u32 s37, s36, 0x40c0
    buffer_load_dword v41, v11, s[92:95], s37 offen
    s_add_u32 s37, s36, 0x4c0
    buffer_load_dword v42, v11, s[92:95], s37 offen
    s_add_u32 s37, s36, 0x44c0
    buffer_load_dword v43, v11, s[92:95], s37 offen
    s_add_u32 s37, s36, 0x20c0
    buffer_load_dword v44, v11, s[92:95], s37 offen
    s_add_u32 s37, s36, 0x60c0
    buffer_load_dword v45, v11, s[92:95], s37 offen
    s_add_u32 s37, s36, 0x24c0
    buffer_load_dword v46, v11, s[92:95], s37 offen
    s_add_u32 s37, s36, 0x64c0
    buffer_load_dword v47, v11, s[92:95], s37 offen
    s_barrier
    ds_read_b64_tr_b16 a[180:181], v20 offset:0
    ds_read_b64_tr_b16 a[182:183], v20 offset:512
    ds_read_b64_tr_b16 a[188:189], v21 offset:0
    ds_read_b64_tr_b16 a[190:191], v21 offset:512
    ds_read_b64_tr_b16 a[212:213], v22 offset:0
    ds_read_b64_tr_b16 a[214:215], v22 offset:512
    ds_read_b64_tr_b16 a[220:221], v23 offset:0
    ds_read_b64_tr_b16 a[222:223], v23 offset:512
    ds_read_b64_tr_b16 a[244:245], v24 offset:0
    ds_read_b64_tr_b16 a[246:247], v24 offset:512
    ds_read_b64_tr_b16 a[252:253], v25 offset:0
    ds_read_b64_tr_b16 a[254:255], v25 offset:512
    s_waitcnt lgkmcnt(4)
    ds_read_b64_tr_b16 v[148:149], v26 offset:0
    ds_read_b64_tr_b16 v[150:151], v26 offset:512
    ds_read_b64_tr_b16 v[156:157], v27 offset:0
    ds_read_b64_tr_b16 v[158:159], v27 offset:512
    s_waitcnt lgkmcnt(0)
    s_barrier
    s_add_u32 m0, s28, 0
    s_add_u32 s37, s3, 0x200000
    buffer_load_dwordx4 v16, s[88:91], s37 offen nt lds
    s_add_u32 m0, s28, 1024
    s_add_u32 s37, s3, 0x208000
    buffer_load_dwordx4 v17, s[88:91], s37 offen nt lds
    s_add_u32 m0, s28, 2048
    s_add_u32 s37, s3, 0x210000
    buffer_load_dwordx4 v18, s[88:91], s37 offen nt lds
    s_add_u32 m0, s28, 3072
    s_add_u32 s37, s3, 0x218000
    buffer_load_dwordx4 v19, s[88:91], s37 offen nt lds
    s_add_u32 m0, s28, 4096
    s_add_u32 s37, s3, 0x220000
    buffer_load_dwordx4 v16, s[88:91], s37 offen nt lds
    s_add_u32 m0, s28, 5120
    s_add_u32 s37, s3, 0x228000
    buffer_load_dwordx4 v17, s[88:91], s37 offen nt lds
    s_add_u32 m0, s28, 6144
    s_add_u32 s37, s3, 0x230000
    buffer_load_dwordx4 v18, s[88:91], s37 offen nt lds
    s_add_u32 m0, s28, 7168
    s_add_u32 s37, s3, 0x238000
    buffer_load_dwordx4 v19, s[88:91], s37 offen nt lds
    s_waitcnt vmcnt(33)
    v_perm_b32 v160, v81, v80, s34
    v_perm_b32 v161, v81, v80, s35
    v_perm_b32 v162, v83, v82, s34
    v_perm_b32 v163, v83, v82, s35
    v_perm_b32 v164, v85, v84, s34
    v_perm_b32 v165, v85, v84, s35
    v_perm_b32 v166, v87, v86, s34
    v_perm_b32 v167, v87, v86, s35
    v_perm_b32 v168, v89, v88, s34
    v_perm_b32 v169, v89, v88, s35
    v_perm_b32 v170, v91, v90, s34
    v_perm_b32 v171, v91, v90, s35
    v_perm_b32 v172, v93, v92, s34
    v_perm_b32 v173, v93, v92, s35
    v_perm_b32 v174, v95, v94, s34
    v_perm_b32 v175, v95, v94, s35
    s_xor_b32 s36, s21, 2
    s_lshl_b32 s36, s36, 15
    s_add_u32 s36, s36, s29
    s_add_u32 s37, s36, 0x0
    buffer_load_dword v48, v11, s[92:95], s37 offen
    s_add_u32 s37, s36, 0x4000
    buffer_load_dword v49, v11, s[92:95], s37 offen
    s_add_u32 s37, s36, 0x400
    buffer_load_dword v50, v11, s[92:95], s37 offen
    s_add_u32 s37, s36, 0x4400
    buffer_load_dword v51, v11, s[92:95], s37 offen
    s_add_u32 s37, s36, 0x2000
    buffer_load_dword v52, v11, s[92:95], s37 offen
    s_add_u32 s37, s36, 0x6000
    buffer_load_dword v53, v11, s[92:95], s37 offen
    s_add_u32 s37, s36, 0x2400
    buffer_load_dword v54, v11, s[92:95], s37 offen
    s_add_u32 s37, s36, 0x6400
    buffer_load_dword v55, v11, s[92:95], s37 offen
    s_add_u32 s37, s36, 0x40
    buffer_load_dword v56, v11, s[92:95], s37 offen
    s_add_u32 s37, s36, 0x4040
    buffer_load_dword v57, v11, s[92:95], s37 offen
    s_add_u32 s37, s36, 0x440
    buffer_load_dword v58, v11, s[92:95], s37 offen
    s_add_u32 s37, s36, 0x4440
    buffer_load_dword v59, v11, s[92:95], s37 offen
    s_add_u32 s37, s36, 0x2040
    buffer_load_dword v60, v11, s[92:95], s37 offen
    s_add_u32 s37, s36, 0x6040
    buffer_load_dword v61, v11, s[92:95], s37 offen
    s_add_u32 s37, s36, 0x2440
    buffer_load_dword v62, v11, s[92:95], s37 offen
    s_add_u32 s37, s36, 0x6440
    buffer_load_dword v63, v11, s[92:95], s37 offen
    s_barrier
    ds_read_b64_tr_b16 v[64:65], v20 offset:8192
    ds_read_b64_tr_b16 v[66:67], v20 offset:8704
    ds_read_b64_tr_b16 v[72:73], v21 offset:8192
    ds_read_b64_tr_b16 v[74:75], v21 offset:8704
    ds_read_b64_tr_b16 v[96:97], v22 offset:8192
    ds_read_b64_tr_b16 v[98:99], v22 offset:8704
    ds_read_b64_tr_b16 v[104:105], v23 offset:8192
    ds_read_b64_tr_b16 v[106:107], v23 offset:8704
    ds_read_b64_tr_b16 a[112:113], v24 offset:8192
    ds_read_b64_tr_b16 a[114:115], v24 offset:8704
    ds_read_b64_tr_b16 a[120:121], v25 offset:8192
    ds_read_b64_tr_b16 a[122:123], v25 offset:8704
    s_waitcnt lgkmcnt(4)
    ds_read_b64_tr_b16 a[144:145], v26 offset:8192
    ds_read_b64_tr_b16 a[146:147], v26 offset:8704
    ds_read_b64_tr_b16 a[152:153], v27 offset:8192
    ds_read_b64_tr_b16 a[154:155], v27 offset:8704
    s_waitcnt lgkmcnt(0)
    s_barrier
    s_add_u32 m0, s28, 8192
    s_add_u32 s37, s3, 0x300000
    buffer_load_dwordx4 v16, s[88:91], s37 offen nt lds
    s_add_u32 m0, s28, 9216
    s_add_u32 s37, s3, 0x308000
    buffer_load_dwordx4 v17, s[88:91], s37 offen nt lds
    s_add_u32 m0, s28, 10240
    s_add_u32 s37, s3, 0x310000
    buffer_load_dwordx4 v18, s[88:91], s37 offen nt lds
    s_add_u32 m0, s28, 11264
    s_add_u32 s37, s3, 0x318000
    buffer_load_dwordx4 v19, s[88:91], s37 offen nt lds
    s_add_u32 m0, s28, 12288
    s_add_u32 s37, s3, 0x320000
    buffer_load_dwordx4 v16, s[88:91], s37 offen nt lds
    s_add_u32 m0, s28, 13312
    s_add_u32 s37, s3, 0x328000
    buffer_load_dwordx4 v17, s[88:91], s37 offen nt lds
    s_add_u32 m0, s28, 14336
    s_add_u32 s37, s3, 0x330000
    buffer_load_dwordx4 v18, s[88:91], s37 offen nt lds
    s_add_u32 m0, s28, 15360
    s_add_u32 s37, s3, 0x338000
    buffer_load_dwordx4 v19, s[88:91], s37 offen nt lds
    s_waitcnt vmcnt(32)
    v_perm_b32 v176, v33, v32, s34
    v_perm_b32 v177, v33, v32, s35
    v_perm_b32 v178, v35, v34, s34
    v_perm_b32 v179, v35, v34, s35
    v_perm_b32 v180, v37, v36, s34
    v_perm_b32 v181, v37, v36, s35
    v_perm_b32 v182, v39, v38, s34
    v_perm_b32 v183, v39, v38, s35
    v_perm_b32 v184, v41, v40, s34
    v_perm_b32 v185, v41, v40, s35
    v_perm_b32 v186, v43, v42, s34
    v_perm_b32 v187, v43, v42, s35
    v_perm_b32 v188, v45, v44, s34
    v_perm_b32 v189, v45, v44, s35
    v_perm_b32 v190, v47, v46, s34
    v_perm_b32 v191, v47, v46, s35
    s_xor_b32 s36, s21, 2
    s_lshl_b32 s36, s36, 15
    s_add_u32 s36, s36, s29
    s_add_u32 s37, s36, 0x80
    buffer_load_dword v80, v11, s[92:95], s37 offen
    s_add_u32 s37, s36, 0x4080
    buffer_load_dword v81, v11, s[92:95], s37 offen
    s_add_u32 s37, s36, 0x480
    buffer_load_dword v82, v11, s[92:95], s37 offen
    s_add_u32 s37, s36, 0x4480
    buffer_load_dword v83, v11, s[92:95], s37 offen
    s_add_u32 s37, s36, 0x2080
    buffer_load_dword v84, v11, s[92:95], s37 offen
    s_add_u32 s37, s36, 0x6080
    buffer_load_dword v85, v11, s[92:95], s37 offen
    s_add_u32 s37, s36, 0x2480
    buffer_load_dword v86, v11, s[92:95], s37 offen
    s_add_u32 s37, s36, 0x6480
    buffer_load_dword v87, v11, s[92:95], s37 offen
    s_add_u32 s37, s36, 0xc0
    buffer_load_dword v88, v11, s[92:95], s37 offen
    s_add_u32 s37, s36, 0x40c0
    buffer_load_dword v89, v11, s[92:95], s37 offen
    s_add_u32 s37, s36, 0x4c0
    buffer_load_dword v90, v11, s[92:95], s37 offen
    s_add_u32 s37, s36, 0x44c0
    buffer_load_dword v91, v11, s[92:95], s37 offen
    s_add_u32 s37, s36, 0x20c0
    buffer_load_dword v92, v11, s[92:95], s37 offen
    s_add_u32 s37, s36, 0x60c0
    buffer_load_dword v93, v11, s[92:95], s37 offen
    s_add_u32 s37, s36, 0x24c0
    buffer_load_dword v94, v11, s[92:95], s37 offen
    s_add_u32 s37, s36, 0x64c0
    buffer_load_dword v95, v11, s[92:95], s37 offen
    s_barrier
    ds_read_b64_tr_b16 v[68:69], v20 offset:16384
    ds_read_b64_tr_b16 v[70:71], v20 offset:16896
    ds_read_b64_tr_b16 v[76:77], v21 offset:16384
    ds_read_b64_tr_b16 v[78:79], v21 offset:16896
    ds_read_b64_tr_b16 v[100:101], v22 offset:16384
    ds_read_b64_tr_b16 v[102:103], v22 offset:16896
    ds_read_b64_tr_b16 v[108:109], v23 offset:16384
    ds_read_b64_tr_b16 v[110:111], v23 offset:16896
    ds_read_b64_tr_b16 a[116:117], v24 offset:16384
    ds_read_b64_tr_b16 a[118:119], v24 offset:16896
    ds_read_b64_tr_b16 a[124:125], v25 offset:16384
    ds_read_b64_tr_b16 a[126:127], v25 offset:16896
    s_waitcnt lgkmcnt(4)
    ds_read_b64_tr_b16 a[148:149], v26 offset:16384
    ds_read_b64_tr_b16 a[150:151], v26 offset:16896
    ds_read_b64_tr_b16 a[156:157], v27 offset:16384
    ds_read_b64_tr_b16 a[158:159], v27 offset:16896
    s_waitcnt lgkmcnt(0)
    s_barrier
    s_add_u32 m0, s28, 16384
    s_add_u32 s37, s3, 0x0
    buffer_load_dwordx4 v16, s[96:99], s37 offen nt lds
    s_add_u32 m0, s28, 17408
    s_add_u32 s37, s3, 0x8000
    buffer_load_dwordx4 v17, s[96:99], s37 offen nt lds
    s_add_u32 m0, s28, 18432
    s_add_u32 s37, s3, 0x10000
    buffer_load_dwordx4 v18, s[96:99], s37 offen nt lds
    s_add_u32 m0, s28, 19456
    s_add_u32 s37, s3, 0x18000
    buffer_load_dwordx4 v19, s[96:99], s37 offen nt lds
    s_add_u32 m0, s28, 20480
    s_add_u32 s37, s3, 0x20000
    buffer_load_dwordx4 v16, s[96:99], s37 offen nt lds
    s_add_u32 m0, s28, 21504
    s_add_u32 s37, s3, 0x28000
    buffer_load_dwordx4 v17, s[96:99], s37 offen nt lds
    s_add_u32 m0, s28, 22528
    s_add_u32 s37, s3, 0x30000
    buffer_load_dwordx4 v18, s[96:99], s37 offen nt lds
    s_add_u32 m0, s28, 23552
    s_add_u32 s37, s3, 0x38000
    buffer_load_dwordx4 v19, s[96:99], s37 offen nt lds
    s_waitcnt vmcnt(32)
    v_perm_b32 v192, v49, v48, s34
    v_perm_b32 v193, v49, v48, s35
    v_perm_b32 v194, v51, v50, s34
    v_perm_b32 v195, v51, v50, s35
    v_perm_b32 v196, v53, v52, s34
    v_perm_b32 v197, v53, v52, s35
    v_perm_b32 v198, v55, v54, s34
    v_perm_b32 v199, v55, v54, s35
    v_perm_b32 v200, v57, v56, s34
    v_perm_b32 v201, v57, v56, s35
    v_perm_b32 v202, v59, v58, s34
    v_perm_b32 v203, v59, v58, s35
    v_perm_b32 v204, v61, v60, s34
    v_perm_b32 v205, v61, v60, s35
    v_perm_b32 v206, v63, v62, s34
    v_perm_b32 v207, v63, v62, s35
    s_xor_b32 s36, s21, 3
    s_lshl_b32 s36, s36, 15
    s_add_u32 s36, s36, s29
    s_add_u32 s37, s36, 0x0
    buffer_load_dword v32, v11, s[92:95], s37 offen
    s_add_u32 s37, s36, 0x4000
    buffer_load_dword v33, v11, s[92:95], s37 offen
    s_add_u32 s37, s36, 0x400
    buffer_load_dword v34, v11, s[92:95], s37 offen
    s_add_u32 s37, s36, 0x4400
    buffer_load_dword v35, v11, s[92:95], s37 offen
    s_add_u32 s37, s36, 0x2000
    buffer_load_dword v36, v11, s[92:95], s37 offen
    s_add_u32 s37, s36, 0x6000
    buffer_load_dword v37, v11, s[92:95], s37 offen
    s_add_u32 s37, s36, 0x2400
    buffer_load_dword v38, v11, s[92:95], s37 offen
    s_add_u32 s37, s36, 0x6400
    buffer_load_dword v39, v11, s[92:95], s37 offen
    s_add_u32 s37, s36, 0x40
    buffer_load_dword v40, v11, s[92:95], s37 offen
    s_add_u32 s37, s36, 0x4040
    buffer_load_dword v41, v11, s[92:95], s37 offen
    s_add_u32 s37, s36, 0x440
    buffer_load_dword v42, v11, s[92:95], s37 offen
    s_add_u32 s37, s36, 0x4440
    buffer_load_dword v43, v11, s[92:95], s37 offen
    s_add_u32 s37, s36, 0x2040
    buffer_load_dword v44, v11, s[92:95], s37 offen
    s_add_u32 s37, s36, 0x6040
    buffer_load_dword v45, v11, s[92:95], s37 offen
    s_add_u32 s37, s36, 0x2440
    buffer_load_dword v46, v11, s[92:95], s37 offen
    s_add_u32 s37, s36, 0x6440
    buffer_load_dword v47, v11, s[92:95], s37 offen
    s_barrier
    ds_read_b64_tr_b16 a[80:81], v20 offset:0
    ds_read_b64_tr_b16 a[82:83], v20 offset:512
    ds_read_b64_tr_b16 a[88:89], v21 offset:0
    ds_read_b64_tr_b16 a[90:91], v21 offset:512
    ds_read_b64_tr_b16 a[96:97], v22 offset:0
    ds_read_b64_tr_b16 a[98:99], v22 offset:512
    ds_read_b64_tr_b16 a[104:105], v23 offset:0
    ds_read_b64_tr_b16 a[106:107], v23 offset:512
    ds_read_b64_tr_b16 a[128:129], v24 offset:0
    ds_read_b64_tr_b16 a[130:131], v24 offset:512
    ds_read_b64_tr_b16 a[136:137], v25 offset:0
    ds_read_b64_tr_b16 a[138:139], v25 offset:512
    s_waitcnt lgkmcnt(4)
    ds_read_b64_tr_b16 v[112:113], v26 offset:0
    ds_read_b64_tr_b16 v[114:115], v26 offset:512
    ds_read_b64_tr_b16 v[120:121], v27 offset:0
    ds_read_b64_tr_b16 v[122:123], v27 offset:512
    s_waitcnt lgkmcnt(0)
    s_barrier
    s_add_u32 m0, s28, 0
    s_add_u32 s37, s3, 0x100000
    buffer_load_dwordx4 v16, s[96:99], s37 offen nt lds
    s_add_u32 m0, s28, 1024
    s_add_u32 s37, s3, 0x108000
    buffer_load_dwordx4 v17, s[96:99], s37 offen nt lds
    s_add_u32 m0, s28, 2048
    s_add_u32 s37, s3, 0x110000
    buffer_load_dwordx4 v18, s[96:99], s37 offen nt lds
    s_add_u32 m0, s28, 3072
    s_add_u32 s37, s3, 0x118000
    buffer_load_dwordx4 v19, s[96:99], s37 offen nt lds
    s_add_u32 m0, s28, 4096
    s_add_u32 s37, s3, 0x120000
    buffer_load_dwordx4 v16, s[96:99], s37 offen nt lds
    s_add_u32 m0, s28, 5120
    s_add_u32 s37, s3, 0x128000
    buffer_load_dwordx4 v17, s[96:99], s37 offen nt lds
    s_add_u32 m0, s28, 6144
    s_add_u32 s37, s3, 0x130000
    buffer_load_dwordx4 v18, s[96:99], s37 offen nt lds
    s_add_u32 m0, s28, 7168
    s_add_u32 s37, s3, 0x138000
    buffer_load_dwordx4 v19, s[96:99], s37 offen nt lds
    s_waitcnt vmcnt(32)
    v_perm_b32 v208, v81, v80, s34
    v_perm_b32 v209, v81, v80, s35
    v_perm_b32 v210, v83, v82, s34
    v_perm_b32 v211, v83, v82, s35
    v_perm_b32 v212, v85, v84, s34
    v_perm_b32 v213, v85, v84, s35
    v_perm_b32 v214, v87, v86, s34
    v_perm_b32 v215, v87, v86, s35
    v_perm_b32 v216, v89, v88, s34
    v_perm_b32 v217, v89, v88, s35
    v_perm_b32 v218, v91, v90, s34
    v_perm_b32 v219, v91, v90, s35
    v_perm_b32 v220, v93, v92, s34
    v_perm_b32 v221, v93, v92, s35
    v_perm_b32 v222, v95, v94, s34
    v_perm_b32 v223, v95, v94, s35
    s_xor_b32 s36, s21, 3
    s_lshl_b32 s36, s36, 15
    s_add_u32 s36, s36, s29
    s_add_u32 s37, s36, 0x80
    buffer_load_dword v48, v11, s[92:95], s37 offen
    s_add_u32 s37, s36, 0x4080
    buffer_load_dword v49, v11, s[92:95], s37 offen
    s_add_u32 s37, s36, 0x480
    buffer_load_dword v50, v11, s[92:95], s37 offen
    s_add_u32 s37, s36, 0x4480
    buffer_load_dword v51, v11, s[92:95], s37 offen
    s_add_u32 s37, s36, 0x2080
    buffer_load_dword v52, v11, s[92:95], s37 offen
    s_add_u32 s37, s36, 0x6080
    buffer_load_dword v53, v11, s[92:95], s37 offen
    s_add_u32 s37, s36, 0x2480
    buffer_load_dword v54, v11, s[92:95], s37 offen
    s_add_u32 s37, s36, 0x6480
    buffer_load_dword v55, v11, s[92:95], s37 offen
    s_add_u32 s37, s36, 0xc0
    buffer_load_dword v56, v11, s[92:95], s37 offen
    s_add_u32 s37, s36, 0x40c0
    buffer_load_dword v57, v11, s[92:95], s37 offen
    s_add_u32 s37, s36, 0x4c0
    buffer_load_dword v58, v11, s[92:95], s37 offen
    s_add_u32 s37, s36, 0x44c0
    buffer_load_dword v59, v11, s[92:95], s37 offen
    s_add_u32 s37, s36, 0x20c0
    buffer_load_dword v60, v11, s[92:95], s37 offen
    s_add_u32 s37, s36, 0x60c0
    buffer_load_dword v61, v11, s[92:95], s37 offen
    s_add_u32 s37, s36, 0x24c0
    buffer_load_dword v62, v11, s[92:95], s37 offen
    s_add_u32 s37, s36, 0x64c0
    buffer_load_dword v63, v11, s[92:95], s37 offen
    s_barrier
    ds_read_b64_tr_b16 a[84:85], v20 offset:8192
    ds_read_b64_tr_b16 a[86:87], v20 offset:8704
    ds_read_b64_tr_b16 a[92:93], v21 offset:8192
    ds_read_b64_tr_b16 a[94:95], v21 offset:8704
    ds_read_b64_tr_b16 a[100:101], v22 offset:8192
    ds_read_b64_tr_b16 a[102:103], v22 offset:8704
    ds_read_b64_tr_b16 a[108:109], v23 offset:8192
    ds_read_b64_tr_b16 a[110:111], v23 offset:8704
    ds_read_b64_tr_b16 a[132:133], v24 offset:8192
    ds_read_b64_tr_b16 a[134:135], v24 offset:8704
    ds_read_b64_tr_b16 a[140:141], v25 offset:8192
    ds_read_b64_tr_b16 a[142:143], v25 offset:8704
    s_waitcnt lgkmcnt(4)
    ds_read_b64_tr_b16 v[116:117], v26 offset:8192
    ds_read_b64_tr_b16 v[118:119], v26 offset:8704
    ds_read_b64_tr_b16 v[124:125], v27 offset:8192
    ds_read_b64_tr_b16 v[126:127], v27 offset:8704
    s_waitcnt lgkmcnt(0)
    s_barrier
    s_add_u32 m0, s28, 8192
    s_add_u32 s37, s3, 0x200000
    buffer_load_dwordx4 v16, s[96:99], s37 offen nt lds
    s_add_u32 m0, s28, 9216
    s_add_u32 s37, s3, 0x208000
    buffer_load_dwordx4 v17, s[96:99], s37 offen nt lds
    s_add_u32 m0, s28, 10240
    s_add_u32 s37, s3, 0x210000
    buffer_load_dwordx4 v18, s[96:99], s37 offen nt lds
    s_add_u32 m0, s28, 11264
    s_add_u32 s37, s3, 0x218000
    buffer_load_dwordx4 v19, s[96:99], s37 offen nt lds
    s_add_u32 m0, s28, 12288
    s_add_u32 s37, s3, 0x220000
    buffer_load_dwordx4 v16, s[96:99], s37 offen nt lds
    s_add_u32 m0, s28, 13312
    s_add_u32 s37, s3, 0x228000
    buffer_load_dwordx4 v17, s[96:99], s37 offen nt lds
    s_add_u32 m0, s28, 14336
    s_add_u32 s37, s3, 0x230000
    buffer_load_dwordx4 v18, s[96:99], s37 offen nt lds
    s_add_u32 m0, s28, 15360
    s_add_u32 s37, s3, 0x238000
    buffer_load_dwordx4 v19, s[96:99], s37 offen nt lds
    s_waitcnt vmcnt(32)
    v_perm_b32 v224, v33, v32, s34
    v_perm_b32 v225, v33, v32, s35
    v_perm_b32 v226, v35, v34, s34
    v_perm_b32 v227, v35, v34, s35
    v_perm_b32 v228, v37, v36, s34
    v_perm_b32 v229, v37, v36, s35
    v_perm_b32 v230, v39, v38, s34
    v_perm_b32 v231, v39, v38, s35
    v_perm_b32 v232, v41, v40, s34
    v_perm_b32 v233, v41, v40, s35
    v_perm_b32 v234, v43, v42, s34
    v_perm_b32 v235, v43, v42, s35
    v_perm_b32 v236, v45, v44, s34
    v_perm_b32 v237, v45, v44, s35
    v_perm_b32 v238, v47, v46, s34
    v_perm_b32 v239, v47, v46, s35
    s_barrier
    ds_read_b64_tr_b16 v[32:33], v20 offset:16384
    ds_read_b64_tr_b16 v[34:35], v20 offset:16896
    ds_read_b64_tr_b16 v[40:41], v21 offset:16384
    ds_read_b64_tr_b16 v[42:43], v21 offset:16896
    ds_read_b64_tr_b16 a[0:1], v22 offset:16384
    ds_read_b64_tr_b16 a[2:3], v22 offset:16896
    ds_read_b64_tr_b16 a[8:9], v23 offset:16384
    ds_read_b64_tr_b16 a[10:11], v23 offset:16896
    ds_read_b64_tr_b16 a[32:33], v24 offset:16384
    ds_read_b64_tr_b16 a[34:35], v24 offset:16896
    ds_read_b64_tr_b16 a[40:41], v25 offset:16384
    ds_read_b64_tr_b16 a[42:43], v25 offset:16896
    s_waitcnt lgkmcnt(4)
    ds_read_b64_tr_b16 a[64:65], v26 offset:16384
    ds_read_b64_tr_b16 a[66:67], v26 offset:16896
    ds_read_b64_tr_b16 a[72:73], v27 offset:16384
    ds_read_b64_tr_b16 a[74:75], v27 offset:16896
    s_waitcnt lgkmcnt(0)
    s_barrier
    s_add_u32 m0, s28, 16384
    s_add_u32 s37, s3, 0x300000
    buffer_load_dwordx4 v16, s[96:99], s37 offen nt lds
    s_add_u32 m0, s28, 17408
    s_add_u32 s37, s3, 0x308000
    buffer_load_dwordx4 v17, s[96:99], s37 offen nt lds
    s_add_u32 m0, s28, 18432
    s_add_u32 s37, s3, 0x310000
    buffer_load_dwordx4 v18, s[96:99], s37 offen nt lds
    s_add_u32 m0, s28, 19456
    s_add_u32 s37, s3, 0x318000
    buffer_load_dwordx4 v19, s[96:99], s37 offen nt lds
    s_add_u32 m0, s28, 20480
    s_add_u32 s37, s3, 0x320000
    buffer_load_dwordx4 v16, s[96:99], s37 offen nt lds
    s_add_u32 m0, s28, 21504
    s_add_u32 s37, s3, 0x328000
    buffer_load_dwordx4 v17, s[96:99], s37 offen nt lds
    s_add_u32 m0, s28, 22528
    s_add_u32 s37, s3, 0x330000
    buffer_load_dwordx4 v18, s[96:99], s37 offen nt lds
    s_add_u32 m0, s28, 23552
    s_add_u32 s37, s3, 0x338000
    buffer_load_dwordx4 v19, s[96:99], s37 offen nt lds
    s_waitcnt vmcnt(16)
    v_perm_b32 v240, v49, v48, s34
    v_perm_b32 v241, v49, v48, s35
    v_perm_b32 v242, v51, v50, s34
    v_perm_b32 v243, v51, v50, s35
    v_perm_b32 v244, v53, v52, s34
    v_perm_b32 v245, v53, v52, s35
    v_perm_b32 v246, v55, v54, s34
    v_perm_b32 v247, v55, v54, s35
    v_perm_b32 v248, v57, v56, s34
    v_perm_b32 v249, v57, v56, s35
    v_perm_b32 v250, v59, v58, s34
    v_perm_b32 v251, v59, v58, s35
    v_perm_b32 v252, v61, v60, s34
    v_perm_b32 v253, v61, v60, s35
    v_perm_b32 v254, v63, v62, s34
    v_perm_b32 v255, v63, v62, s35
    s_barrier
    ds_read_b64_tr_b16 v[36:37], v20 offset:0
    ds_read_b64_tr_b16 v[38:39], v20 offset:512
    ds_read_b64_tr_b16 v[44:45], v21 offset:0
    ds_read_b64_tr_b16 v[46:47], v21 offset:512
    ds_read_b64_tr_b16 a[4:5], v22 offset:0
    ds_read_b64_tr_b16 a[6:7], v22 offset:512
    ds_read_b64_tr_b16 a[12:13], v23 offset:0
    ds_read_b64_tr_b16 a[14:15], v23 offset:512
    ds_read_b64_tr_b16 a[36:37], v24 offset:0
    ds_read_b64_tr_b16 a[38:39], v24 offset:512
    ds_read_b64_tr_b16 a[44:45], v25 offset:0
    ds_read_b64_tr_b16 a[46:47], v25 offset:512
    s_waitcnt lgkmcnt(4)
    ds_read_b64_tr_b16 a[68:69], v26 offset:0
    ds_read_b64_tr_b16 a[70:71], v26 offset:512
    ds_read_b64_tr_b16 a[76:77], v27 offset:0
    ds_read_b64_tr_b16 a[78:79], v27 offset:512
    s_waitcnt lgkmcnt(0)
    s_barrier
    s_waitcnt vmcnt(8)
    s_barrier
    ds_read_b64_tr_b16 v[48:49], v20 offset:8192
    ds_read_b64_tr_b16 v[50:51], v20 offset:8704
    ds_read_b64_tr_b16 v[56:57], v21 offset:8192
    ds_read_b64_tr_b16 v[58:59], v21 offset:8704
    ds_read_b64_tr_b16 a[16:17], v22 offset:8192
    ds_read_b64_tr_b16 a[18:19], v22 offset:8704
    ds_read_b64_tr_b16 a[24:25], v23 offset:8192
    ds_read_b64_tr_b16 a[26:27], v23 offset:8704
    ds_read_b64_tr_b16 a[48:49], v24 offset:8192
    ds_read_b64_tr_b16 a[50:51], v24 offset:8704
    ds_read_b64_tr_b16 a[56:57], v25 offset:8192
    ds_read_b64_tr_b16 a[58:59], v25 offset:8704
    s_waitcnt lgkmcnt(4)
    ds_read_b64_tr_b16 v[80:81], v26 offset:8192
    ds_read_b64_tr_b16 v[82:83], v26 offset:8704
    ds_read_b64_tr_b16 v[88:89], v27 offset:8192
    ds_read_b64_tr_b16 v[90:91], v27 offset:8704
    s_waitcnt lgkmcnt(0)
    s_barrier
    s_waitcnt vmcnt(0)
    s_barrier
    ds_read_b64_tr_b16 v[52:53], v20 offset:16384
    ds_read_b64_tr_b16 v[54:55], v20 offset:16896
    ds_read_b64_tr_b16 v[60:61], v21 offset:16384
    ds_read_b64_tr_b16 v[62:63], v21 offset:16896
    ds_read_b64_tr_b16 a[20:21], v22 offset:16384
    ds_read_b64_tr_b16 a[22:23], v22 offset:16896
    ds_read_b64_tr_b16 a[28:29], v23 offset:16384
    ds_read_b64_tr_b16 a[30:31], v23 offset:16896
    ds_read_b64_tr_b16 a[52:53], v24 offset:16384
    ds_read_b64_tr_b16 a[54:55], v24 offset:16896
    ds_read_b64_tr_b16 a[60:61], v25 offset:16384
    ds_read_b64_tr_b16 a[62:63], v25 offset:16896
    s_waitcnt lgkmcnt(4)
    ds_read_b64_tr_b16 v[84:85], v26 offset:16384
    ds_read_b64_tr_b16 v[86:87], v26 offset:16896
    ds_read_b64_tr_b16 v[92:93], v27 offset:16384
    ds_read_b64_tr_b16 v[94:95], v27 offset:16896
    s_waitcnt lgkmcnt(0)
    s_barrier
    ds_write_b128 v4, v[32:35] offset:0
    ds_write_b128 v4, v[36:39] offset:1024
    ds_write_b128 v4, v[40:43] offset:2048
    ds_write_b128 v4, v[44:47] offset:3072
    ds_write_b128 v4, v[48:51] offset:4096
    ds_write_b128 v4, v[52:55] offset:5120
    ds_write_b128 v4, v[56:59] offset:6144
    ds_write_b128 v4, v[60:63] offset:7168
    s_waitcnt lgkmcnt(0)
    ds_write_b128 v4, v[64:67] offset:8192
    ds_write_b128 v4, v[68:71] offset:9216
    ds_write_b128 v4, v[72:75] offset:10240
    ds_write_b128 v4, v[76:79] offset:11264
    ds_write_b128 v4, v[80:83] offset:12288
    ds_write_b128 v4, v[84:87] offset:13312
    ds_write_b128 v4, v[88:91] offset:14336
    ds_write_b128 v4, v[92:95] offset:15360
    s_waitcnt lgkmcnt(0)
    ds_write_b128 v4, v[96:99] offset:16384
    ds_write_b128 v4, v[100:103] offset:17408
    ds_write_b128 v4, v[104:107] offset:18432
    ds_write_b128 v4, v[108:111] offset:19456
    ds_write_b128 v4, v[112:115] offset:20480
    ds_write_b128 v4, v[116:119] offset:21504
    ds_write_b128 v4, v[120:123] offset:22528
    ds_write_b128 v4, v[124:127] offset:23552
    s_waitcnt lgkmcnt(0)
    s_waitcnt lgkmcnt(0)
    v_mov_b32 v24, 0x0
    v_bfe_u32 v14, v0, 0, 1
    s_mov_b32 s38, 0x80
    v_mad_u32_u24 v24, v14, s38, v24
    v_bfe_u32 v14, v0, 1, 1
    s_mov_b32 s38, 0x100
    v_mad_u32_u24 v24, v14, s38, v24
    v_bfe_u32 v14, v0, 2, 1
    s_mov_b32 s38, 0x200
    v_mad_u32_u24 v24, v14, s38, v24
    v_bfe_u32 v14, v0, 3, 1
    s_mov_b32 s38, 0x400
    v_mad_u32_u24 v24, v14, s38, v24
    v_bfe_u32 v14, v0, 4, 1
    s_mov_b32 s38, 0x800
    v_mad_u32_u24 v24, v14, s38, v24
    v_bfe_u32 v14, v0, 6, 1
    s_mov_b32 s38, 0x1000
    v_mad_u32_u24 v24, v14, s38, v24
    v_bfe_u32 v14, v0, 7, 1
    s_mov_b32 s38, 0x2000
    v_mad_u32_u24 v24, v14, s38, v24
    s_lshl_b32 s36, s20, 14
    v_add_u32 v24, s36, v24
    s_lshl_b32 s36, s20, 8
    s_lshr_b32 s37, s21, 1
    s_lshl_b32 s37, s37, 7
    s_add_u32 s36, s36, s37
    s_add_u32 s36, s36, 0x102000
    v_and_b32 v14, 63, v0
    v_mov_b32 v25, 0x40000000
    v_cmp_lt_u32 vcc, 32, v14
    s_nop 1
    v_cndmask_b32 v24, v24, v25, vcc
    v_mov_b32 v25, s36
    v_cmp_eq_u32 vcc, 32, v14
    s_nop 1
    v_cndmask_b32 v0, v24, v25, vcc
    v_lshrrev_b32 v25, 2, v3
    v_and_b32 v25, 127, v25
L_HS:
    buffer_load_dword v24, v25, s[16:19], 0 offen offset:128 sc1
    s_add_u32 s32, s32, 1
    s_cmp_gt_u32 s32, 200000
    s_cbranch_scc1 L_slow_start
    s_waitcnt vmcnt(0)
    v_cmp_eq_u32 vcc, 0, v24
    s_cbranch_vccnz L_HS
    v_readfirstlane_b32 s36, v24
    s_nop 1
    v_cmp_ne_u32 vcc, s36, v24
    s_cbranch_vccnz L_slow_start
    s_branch L_fast_start
L_fast_start:
    s_mov_b32 s22, 0
    s_mov_b32 s23, 0x1000000
    s_mov_b32 s27, 0
    s_mov_b32 s31, 0x80000
    s_mov_b32 s61, 0x40000000
    s_mov_b32 s91, 0
    ds_read_b128 v[104:107], v4 offset:0
    ds_read_b128 v[108:111], v4 offset:1024
    ds_read_b128 v[112:115], v4 offset:2048
    ds_read_b128 v[116:119], v4 offset:3072
    ds_read_b128 v[88:91], v4 offset:4096
    ds_read_b128 v[92:95], v4 offset:5120
    ds_read_b128 v[96:99], v4 offset:6144
    ds_read_b128 v[100:103], v4 offset:7168
    ds_read_b128 v[72:75], v4 offset:8192
    ds_read_b128 v[76:79], v4 offset:9216
    ds_read_b128 v[80:83], v4 offset:10240
    ds_read_b128 v[84:87], v4 offset:11264
    v_mov_b64 v[48:49], 0
    v_mov_b64 v[50:51], 0
    v_mov_b64 v[52:53], 0
    v_mov_b64 v[54:55], 0
    v_mov_b64 v[56:57], 0
    v_mov_b64 v[58:59], 0
    v_mov_b64 v[60:61], 0
    v_mov_b64 v[62:63], 0
    v_mov_b64 v[64:65], 0
    v_mov_b64 v[66:67], 0
    v_mov_b64 v[68:69], 0
    v_mov_b64 v[70:71], 0
    s_mov_b64 s[62:63], 0
    s_add_u32 s7, s23, 0x80000
    buffer_load_dwordx4 v[16:19], v2, s[8:11], s7 offen sc1
    buffer_load_dwordx4 v[20:23], v2, s[8:11], s7 offen offset:1024 sc1
L_fast_step:
    s_lshr_b64 s[36:37], s[62:63], s22
    s_andn2_b32 s36, 3, s36
    s_cbranch_scc1 L_fast_refresh
    s_add_u32 s24, s23, 0x82000
    s_add_u32 s29, s23, s25
    s_add_u32 s30, s23, s39
    s_xor_b32 s28, s27, 1
    s_add_u32 s90, s22, 1
    v_xor_b32 v28, 0x800, v2
    v_xor_b32 v44, 0x1800, v2
    s_nop 13
    buffer_load_dwordx4 v[16:19], v2, s[8:11], s7 offen sc1
    buffer_load_dwordx4 v[20:23], v2, s[8:11], s7 offen offset:1024 sc1
L_fast_waitm:
    s_waitcnt vmcnt(3) lgkmcnt(0)
L_fast_gotm:
    v_max3_u32 v14, v16, v17, v18
    v_max_u32 v14, v14, v19
    v_smfmac_f32_16x16x64_bf16 v[48:51], v[16:19], v[104:111], v1
    s_waitcnt vmcnt(2)
    v_max3_u32 v14, v14, v20, v21
    v_smfmac_f32_16x16x64_bf16 v[52:55], v[16:19], v[112:119], v1
    v_max3_u32 v14, v14, v22, v23
    v_cmp_eq_u32 vcc, -1, v14
    v_smfmac_f32_16x16x64_bf16 v[48:51], v[20:23], v[88:95], v1
    ds_write_b128 v2, v[16:19] offset:0
    s_cbranch_vccnz L_fast_retrym
L_fast_okm:
    v_smfmac_f32_16x16x64_bf16 v[52:55], v[20:23], v[96:103], v1
    ds_write_b128 v2, v[20:23] offset:1024
    v_smfmac_f32_16x16x64_bf16 v[56:59], v[16:19], v[72:79], v1
    buffer_load_dwordx4 v[104:107], v3, s[8:11], s29 offen offset:0 sc1
    v_smfmac_f32_16x16x64_bf16 v[60:63], v[16:19], v[80:87], v1
    buffer_load_dwordx4 v[108:111], v3, s[8:11], s29 offen offset:1024 sc1
    v_smfmac_f32_16x16x64_bf16 v[56:59], v[20:23], a[80:87], v1
    buffer_load_dwordx4 v[112:115], v3, s[8:11], s29 offen offset:2048 sc1
    v_smfmac_f32_16x16x64_bf16 v[60:63], v[20:23], a[88:95], v1
    s_waitcnt lgkmcnt(0)
    s_barrier
    ds_read_b128 v[24:27], v28 offset:0
    v_smfmac_f32_16x16x64_bf16 v[64:67], v[16:19], a[160:167], v1
    ds_read_b128 v[28:31], v28 offset:1024
    v_smfmac_f32_16x16x64_bf16 v[68:71], v[16:19], a[168:175], v1
    buffer_load_dwordx4 v[116:119], v3, s[8:11], s29 offen offset:3072 sc1
    v_smfmac_f32_16x16x64_bf16 v[64:67], v[20:23], a[176:183], v1
    ds_read_b128 v[32:35], v8 offset:0
    v_smfmac_f32_16x16x64_bf16 v[68:71], v[20:23], a[184:191], v1
    ds_read_b128 v[36:39], v8 offset:1024
    s_waitcnt lgkmcnt(3)
    v_smfmac_f32_16x16x64_bf16 v[48:51], v[24:27], a[0:7], v1
    buffer_load_dwordx4 v[120:123], v3, s[8:11], s30 offen offset:0 sc1
    v_smfmac_f32_16x16x64_bf16 v[52:55], v[24:27], a[8:15], v1
    ds_read_b128 v[40:43], v44 offset:0
    s_waitcnt lgkmcnt(3)
    v_smfmac_f32_16x16x64_bf16 v[48:51], v[28:31], a[16:23], v1
    buffer_load_dwordx4 v[124:127], v3, s[8:11], s30 offen offset:1024 sc1
    v_smfmac_f32_16x16x64_bf16 v[52:55], v[28:31], a[24:31], v1
    ds_read_b128 v[44:47], v44 offset:1024
    s_waitcnt lgkmcnt(2)
    v_smfmac_f32_16x16x64_bf16 v[48:51], v[32:35], a[32:39], v1
    v_smfmac_f32_16x16x64_bf16 v[52:55], v[32:35], a[40:47], v1
    ds_read_b128 v[88:91], v4 offset:12288
    v_smfmac_f32_16x16x64_bf16 v[48:51], v[36:39], a[48:55], v1
    ds_read_b128 v[92:95], v4 offset:13312
    s_waitcnt lgkmcnt(2)
    v_smfmac_f32_16x16x64_bf16 v[52:55], v[36:39], a[56:63], v1
    ds_read_b128 v[96:99], v4 offset:14336
    v_smfmac_f32_16x16x64_bf16 v[48:51], v[40:43], a[64:71], v1
    ds_read_b128 v[100:103], v4 offset:15360
    v_smfmac_f32_16x16x64_bf16 v[52:55], v[40:43], a[72:79], v1
    buffer_load_dword v15, v0, s[8:11], s24 offen sc1
    v_smfmac_f32_16x16x64_bf16 v[56:59], v[28:31], a[96:103], v1
    ds_read_b128 v[72:75], v4 offset:16384
    v_smfmac_f32_16x16x64_bf16 v[60:63], v[28:31], a[104:111], v1
    ds_read_b128 v[76:79], v4 offset:17408
    s_waitcnt lgkmcnt(2)
    v_smfmac_f32_16x16x64_bf16 v[48:51], v[44:47], v[88:95], v1
    ds_read_b128 v[80:83], v4 offset:18432
    v_smfmac_f32_16x16x64_bf16 v[52:55], v[44:47], v[96:103], v1
    ds_read_b128 v[84:87], v4 offset:19456
    v_smfmac_f32_16x16x64_bf16 v[56:59], v[32:35], a[112:119], v1
    ds_read_b128 v[88:91], v4 offset:20480
    v_smfmac_f32_16x16x64_bf16 v[60:63], v[32:35], a[120:127], v1
    ds_read_b128 v[92:95], v4 offset:21504
    v_smfmac_f32_16x16x64_bf16 v[56:59], v[36:39], a[128:135], v1
    ds_read_b128 v[96:99], v4 offset:22528
    v_add_f32 v48, v48, v50
    v_add_f32 v49, v49, v51
    v_smfmac_f32_16x16x64_bf16 v[60:63], v[36:39], a[136:143], v1
    ds_read_b128 v[100:103], v4 offset:23552
    v_add_f32 v52, v52, v54
    v_add_f32 v53, v53, v55
    v_smfmac_f32_16x16x64_bf16 v[56:59], v[40:43], a[144:151], v1
    s_waitcnt lgkmcnt(4)
    v_cvt_pk_bf16_f32 v50, v48, v52
    v_cvt_pk_bf16_f32 v51, v49, v53
    v_smfmac_f32_16x16x64_bf16 v[60:63], v[40:43], a[152:159], v1
    ds_write2_b32 v5, v50, v51 offset0:0 offset1:72
    v_smfmac_f32_16x16x64_bf16 v[56:59], v[24:27], v[72:79], v1
    buffer_store_dword v12, v10, s[8:11], s31 offen sc1
    v_smfmac_f32_16x16x64_bf16 v[60:63], v[24:27], v[80:87], v1
    s_waitcnt lgkmcnt(1)
    v_smfmac_f32_16x16x64_bf16 v[56:59], v[44:47], v[88:95], v1
    v_smfmac_f32_16x16x64_bf16 v[60:63], v[44:47], v[96:103], v1
    s_waitcnt lgkmcnt(0)
    s_barrier
    v_smfmac_f32_16x16x64_bf16 v[64:67], v[24:27], a[192:199], v1
    ds_read_b128 v[72:75], v6 offset:0
    v_smfmac_f32_16x16x64_bf16 v[68:71], v[24:27], a[200:207], v1
    ds_read_b128 v[76:79], v6 offset:64
    s_nop 0
    v_add_f32 v56, v56, v58
    v_smfmac_f32_16x16x64_bf16 v[64:67], v[28:31], a[208:215], v1
    ds_read_b128 v[80:83], v6 offset:128
    v_add_f32 v57, v57, v59
    v_smfmac_f32_16x16x64_bf16 v[68:71], v[28:31], a[216:223], v1
    ds_read_b128 v[84:87], v6 offset:192
    v_add_f32 v60, v60, v62
    v_add_f32 v61, v61, v63
    s_waitcnt vmcnt(2) lgkmcnt(3)
    v_mfma_f32_16x16x32_bf16 v[48:51], v[104:107], v[72:75], 0
    s_waitcnt lgkmcnt(2)
    v_cvt_pk_bf16_f32 v58, v56, v60
    v_cvt_pk_bf16_f32 v59, v57, v61
    v_mfma_f32_16x16x32_bf16 v[48:51], v[108:111], v[76:79], v[48:51]
    ds_write2_b32 v7, v58, v59 offset0:0 offset1:72
    s_waitcnt lgkmcnt(2)
    v_mfma_f32_16x16x32_bf16 v[48:51], v[112:115], v[80:83], v[48:51]
    s_waitcnt lgkmcnt(1)
    v_mov_b64 v[104:105], s[4:5]
    v_mov_b64 v[106:107], s[4:5]
    v_mfma_f32_16x16x32_bf16 v[48:51], v[116:119], v[84:87], v[48:51]
    v_mov_b64 v[16:17], 0
    v_mov_b64 v[18:19], 0
    v_smfmac_f32_16x16x64_bf16 v[64:67], v[32:35], a[224:231], v1
    v_mov_b32 v113, 0
    v_smfmac_f32_16x16x64_bf16 v[68:71], v[32:35], a[232:239], v1
    s_waitcnt lgkmcnt(0)
    s_barrier
    v_mov_b32 v115, 0
    v_smfmac_f32_16x16x64_bf16 v[64:67], v[36:39], a[240:247], v1
    ds_read_b128 v[88:91], v6 offset:2304
    v_exp_f32 v48, v48
    v_smfmac_f32_16x16x64_bf16 v[68:71], v[36:39], a[248:255], v1
    ds_read_b128 v[92:95], v6 offset:2368
    v_exp_f32 v49, v49
    v_smfmac_f32_16x16x64_bf16 v[64:67], v[40:43], v[128:135], v1
    ds_read_b128 v[96:99], v6 offset:2432
    v_exp_f32 v50, v50
    v_smfmac_f32_16x16x64_bf16 v[68:71], v[40:43], v[136:143], v1
    ds_read_b128 v[100:103], v6 offset:2496
    v_exp_f32 v51, v51
    s_waitcnt lgkmcnt(3)
    v_mfma_f32_16x16x32_bf16 v[52:55], v[88:91], v[72:75], 0
    s_waitcnt lgkmcnt(2)
    v_cvt_pk_bf16_f32 v108, v48, v49
    v_cvt_pk_bf16_f32 v109, v50, v51
    v_mfma_f32_16x16x32_bf16 v[52:55], v[92:95], v[76:79], v[52:55]
    ds_write_b64 v2, v[108:109] offset:8192
    s_waitcnt lgkmcnt(2)
    v_mfma_f32_16x16x32_bf16 v[52:55], v[96:99], v[80:83], v[52:55]
    s_waitcnt lgkmcnt(1)
    v_mov_b32 v117, 0
    v_mov_b64 v[20:21], 0
    v_mfma_f32_16x16x32_bf16 v[52:55], v[100:103], v[84:87], v[52:55]
    v_mov_b64 v[22:23], 0
    v_mov_b64 v[24:25], 0
    v_smfmac_f32_16x16x64_bf16 v[64:67], v[44:47], v[144:151], v1
    ds_read_b128 v[88:91], v4 offset:24576
    v_smfmac_f32_16x16x64_bf16 v[68:71], v[44:47], v[152:159], v1
    s_waitcnt lgkmcnt(1)
    s_barrier
    ds_read_b64 v[110:111], v8 offset:8192
    ds_read_b128 v[92:95], v4 offset:25600
    v_mul_f32 v52, s33, v52
    v_mul_f32 v53, s33, v53
    v_exp_f32 v52, v52
    v_exp_f32 v53, v53
    s_nop 0
    v_cvt_pk_bf16_f32 v112, v52, v53
    v_add_f32 v64, v64, v66
    v_add_f32 v65, v65, v67
    s_waitcnt lgkmcnt(1)
    v_mfma_f32_16x16x32_bf16 v[48:51], v[104:107], v[108:111], 0
    v_cvt_pk_bf16_f32 v114, v64, v65
    v_add_f32 v68, v68, v70
    v_mfma_f32_16x16x32_bf16 v[56:59], v[120:123], v[108:111], 0
    v_add_f32 v69, v69, v71
    v_cvt_pk_bf16_f32 v116, v68, v69
    v_mfma_f32_16x16x32_bf16 v[60:63], v[124:127], v[108:111], 0
    ds_read_b128 v[96:99], v4 offset:26624
    v_mov_b64 v[26:27], 0
    v_mfma_f32_16x16x16_bf16 v[48:51], v[104:105], v[112:113], v[48:51]
    ds_read_b128 v[100:103], v4 offset:27648
    v_mov_b64 v[28:29], 0
    v_mfma_f32_16x16x16_bf16 v[56:59], v[114:115], v[112:113], v[56:59]
    v_mov_b64 v[30:31], 0
    v_mfma_f32_16x16x16_bf16 v[60:63], v[116:117], v[112:113], v[60:63]
    s_nop 2
    v_rcp_f32 v118, v48
    s_nop 0
    v_max_f32 v14, v118, v48
    v_cmp_nge_f32 vcc, s40, v14
    v_pk_mul_f32 v[56:57], v[56:57], v[118:119] op_sel_hi:[1,0]
    v_pk_mul_f32 v[58:59], v[58:59], v[118:119] op_sel_hi:[1,0]
    v_pk_mul_f32 v[60:61], v[60:61], v[118:119] op_sel_hi:[1,0]
    v_pk_mul_f32 v[62:63], v[62:63], v[118:119] op_sel_hi:[1,0]
    v_cvt_pk_bf16_f32 v52, v56, v60
    v_cvt_pk_bf16_f32 v53, v57, v61
    v_cvt_pk_bf16_f32 v54, v58, v62
    v_cvt_pk_bf16_f32 v55, v59, v63
L_fast_rejoin:
    ds_write_b128 v2, v[52:55] offset:9216
    s_waitcnt lgkmcnt(1)
    v_smfmac_f32_16x16x64_bf16 v[16:19], v[52:55], v[88:95], v1
    ds_read_b128 v[72:75], v4 offset:28672
    v_xor_b32 v32, 0x800, v2
    v_smfmac_f32_16x16x64_bf16 v[20:23], v[52:55], v[96:103], v1
    ds_read_b128 v[76:79], v4 offset:29696
    v_xor_b32 v40, 0x1800, v2
    s_waitcnt lgkmcnt(2)
    s_barrier
    ds_read_b128 v[32:35], v32 offset:9216
    ds_read_b128 v[36:39], v8 offset:9216
    ds_read_b128 v[40:43], v40 offset:9216
    ds_read_b128 v[80:83], v4 offset:30720
    ds_read_b128 v[84:87], v4 offset:31744
    s_waitcnt lgkmcnt(4)
    v_smfmac_f32_16x16x64_bf16 v[16:19], v[32:35], v[160:167], v1
    s_waitcnt lgkmcnt(3)
    v_smfmac_f32_16x16x64_bf16 v[16:19], v[36:39], v[192:199], v1
    s_waitcnt lgkmcnt(2)
    v_smfmac_f32_16x16x64_bf16 v[16:19], v[40:43], v[224:231], v1
    s_cmp_lg_u64 vcc, 0
    s_cselect_b32 s60, s28, s27
    v_smfmac_f32_16x16x64_bf16 v[20:23], v[32:35], v[168:175], v1
    ds_read_b128 v[64:67], v3 offset:23040
    s_waitcnt lgkmcnt(1)
    v_smfmac_f32_16x16x64_bf16 v[20:23], v[36:39], v[200:207], v1
    s_nop 1
    v_smfmac_f32_16x16x64_bf16 v[20:23], v[40:43], v[232:239], v1
    v_cvt_pk_bf16_f32 v56, v16, v18
    v_smfmac_f32_16x16x64_bf16 v[24:27], v[52:55], v[72:79], v1
    v_cvt_pk_bf16_f32 v57, v17, v19
    v_and_or_b32 v56, v56, -2, s60
    v_smfmac_f32_16x16x64_bf16 v[24:27], v[32:35], v[176:183], v1
    buffer_store_dwordx2 v[56:57], v9, s[8:11], 0 offen offset:0
    v_smfmac_f32_16x16x64_bf16 v[24:27], v[36:39], v[208:215], v1
    s_nop 0
    v_cvt_pk_bf16_f32 v58, v20, v22
    v_smfmac_f32_16x16x64_bf16 v[24:27], v[40:43], v[240:247], v1
    v_cvt_pk_bf16_f32 v59, v21, v23
    v_and_or_b32 v58, v58, -2, s60
    v_smfmac_f32_16x16x64_bf16 v[28:31], v[52:55], v[80:87], v1
    buffer_store_dwordx2 v[58:59], v9, s[8:11], 0 offen offset:2048
    v_smfmac_f32_16x16x64_bf16 v[28:31], v[32:35], v[184:191], v1
    s_nop 1
    v_smfmac_f32_16x16x64_bf16 v[28:31], v[36:39], v[216:223], v1
    v_cvt_pk_bf16_f32 v60, v24, v26
    v_smfmac_f32_16x16x64_bf16 v[28:31], v[40:43], v[248:255], v1
    v_cvt_pk_bf16_f32 v61, v25, v27
    v_and_or_b32 v60, v60, -2, s60
    buffer_store_dwordx2 v[60:61], v9, s[8:11], s26 offen offset:0
    s_nop 4
    v_cvt_pk_bf16_f32 v62, v28, v30
    v_cvt_pk_bf16_f32 v63, v29, v31
    v_and_or_b32 v62, v62, -2, s60
    buffer_store_dwordx2 v[62:63], v9, s[8:11], s26 offen offset:2048
L_fast_stored:
    s_cmp_lg_u32 s60, s27
    s_cbranch_scc1 L_fast_safe
    ds_read_b128 v[104:107], v4 offset:0
    ds_read_b128 v[108:111], v4 offset:1024
    ds_read_b128 v[112:115], v4 offset:2048
    ds_read_b128 v[116:119], v4 offset:3072
    ds_read_b128 v[88:91], v4 offset:4096
    ds_read_b128 v[92:95], v4 offset:5120
    ds_read_b128 v[96:99], v4 offset:6144
    ds_read_b128 v[100:103], v4 offset:7168
    ds_read_b128 v[72:75], v4 offset:8192
    ds_read_b128 v[76:79], v4 offset:9216
    ds_read_b128 v[80:83], v4 offset:10240
    ds_read_b128 v[84:87], v4 offset:11264
    s_cmp_lt_u32 s21, 1
    s_cbranch_scc1 L_fast_pollp
    s_nop 7
    s_cmp_lt_u32 s21, 2
    s_cbranch_scc1 L_fast_pollp
    s_nop 7
    s_cmp_lt_u32 s21, 3
    s_cbranch_scc1 L_fast_pollp
    s_nop 7
L_fast_pollp:
    buffer_load_dwordx4 v[120:123], v2, s[8:11], s6 offen sc1
    buffer_load_dwordx4 v[124:127], v2, s[8:11], s6 offen offset:1024 sc1
    v_mov_b64 v[48:49], 0
    v_mov_b64 v[50:51], 0
    v_mov_b64 v[52:53], 0
    v_mov_b64 v[54:55], 0
    v_mov_b64 v[56:57], 0
    v_mov_b64 v[58:59], 0
    v_mov_b64 v[60:61], 0
    v_mov_b64 v[62:63], 0
    s_nop 15
    s_nop 11
    buffer_load_dwordx4 v[32:35], v2, s[8:11], s6 offen sc1
    buffer_load_dwordx4 v[36:39], v2, s[8:11], s6 offen offset:1024 sc1
    s_add_u32 s7, s24, 0x80000
    s_waitcnt vmcnt(3) lgkmcnt(0)
    v_mfma_f32_16x16x32_bf16 v[68:71], v[64:67], v[120:123], 0
    v_bitop3_b32 v14, v120, v122, s27 bitop3:0x7e
    s_waitcnt vmcnt(2)
    v_mfma_f32_16x16x32_bf16 v[68:71], v[64:67], v[124:127], v[68:71]
    v_bitop3_b32 v11, v124, v126, s27 bitop3:0x7e
    v_bitop3_b32 v14, v14, v11, 1 bitop3:0xa8
    v_cmp_ne_u32 vcc, 0, v14
    s_nop 2
    s_cmp_eq_u64 vcc, 0
    s_cselect_b32 s36, s24, s61
    v_add_f32_dpp v68, v68, v68 row_ror:8 row_mask:0xf bank_mask:0xf
    v_add_f32_dpp v69, v69, v69 row_ror:8 row_mask:0xf bank_mask:0xf
    s_nop 0
    v_add_f32_dpp v68, v68, v68 row_ror:4 row_mask:0xf bank_mask:0xf
    v_add_f32_dpp v69, v69, v69 row_ror:4 row_mask:0xf bank_mask:0xf
    v_cvt_pk_bf16_f32 v12, v68, v69
    buffer_store_dword v12, v10, s[8:11], s36 offen
    s_cbranch_scc0 L_fast_retryp
L_fast_gotp:
    s_mov_b32 s23, s24
    s_add_u32 s31, s31, 0x2000
    s_mov_b32 s22, s90
    s_mov_b32 s27, s28
    v_mov_b64 v[64:65], 0
    v_mov_b64 v[66:67], 0
    v_mov_b64 v[68:69], 0
    v_mov_b64 v[70:71], 0
    s_nop 15
    s_nop 15
    s_nop 3
    buffer_load_dwordx4 v[16:19], v2, s[8:11], s7 offen sc1
    buffer_load_dwordx4 v[20:23], v2, s[8:11], s7 offen offset:1024 sc1
    s_cmp_lt_u32 s22, 63
    s_cbranch_scc1 L_fast_step
    buffer_store_dword v12, v10, s[8:11], s31 offen sc1
    s_branch L_fast_done
L_fast_retrym:
    s_add_u32 s32, s32, 1
    s_cmp_gt_u32 s32, 200000
    s_cbranch_scc1 L_fast_okm
    buffer_load_dwordx4 v[16:19], v2, s[8:11], s7 offen sc1
    buffer_load_dwordx4 v[20:23], v2, s[8:11], s7 offen offset:1024 sc1
    s_nop 1
    v_mov_b64 v[48:49], 0
    v_mov_b64 v[50:51], 0
    v_mov_b64 v[52:53], 0
    v_mov_b64 v[54:55], 0
    s_branch L_fast_waitm
L_fast_retryp:
    s_add_u32 s32, s32, 1
    buffer_load_dwordx4 v[120:123], v2, s[8:11], s6 offen sc1
    buffer_load_dwordx4 v[124:127], v2, s[8:11], s6 offen offset:1024 sc1
    s_waitcnt vmcnt(4) lgkmcnt(0)
    v_mfma_f32_16x16x32_bf16 v[68:71], v[64:67], v[32:35], 0
    v_bitop3_b32 v14, v32, v34, s27 bitop3:0x7e
    s_waitcnt vmcnt(3)
    v_mfma_f32_16x16x32_bf16 v[68:71], v[64:67], v[36:39], v[68:71]
    v_bitop3_b32 v11, v36, v38, s27 bitop3:0x7e
    v_bitop3_b32 v14, v14, v11, 1 bitop3:0xa8
    v_cmp_ne_u32 vcc, 0, v14
    s_nop 2
    s_cmp_eq_u64 vcc, 0
    s_cselect_b32 s36, s24, s61
    v_add_f32_dpp v68, v68, v68 row_ror:8 row_mask:0xf bank_mask:0xf
    v_add_f32_dpp v69, v69, v69 row_ror:8 row_mask:0xf bank_mask:0xf
    s_nop 0
    v_add_f32_dpp v68, v68, v68 row_ror:4 row_mask:0xf bank_mask:0xf
    v_add_f32_dpp v69, v69, v69 row_ror:4 row_mask:0xf bank_mask:0xf
    v_cvt_pk_bf16_f32 v12, v68, v69
    buffer_store_dword v12, v10, s[8:11], s36 offen
    s_cbranch_scc1 L_fast_gotp
    buffer_load_dwordx4 v[32:35], v2, s[8:11], s6 offen sc1
    buffer_load_dwordx4 v[36:39], v2, s[8:11], s6 offen offset:1024 sc1
    s_waitcnt vmcnt(4) lgkmcnt(0)
    v_mfma_f32_16x16x32_bf16 v[68:71], v[64:67], v[120:123], 0
    v_bitop3_b32 v14, v120, v122, s27 bitop3:0x7e
    s_waitcnt vmcnt(3)
    v_mfma_f32_16x16x32_bf16 v[68:71], v[64:67], v[124:127], v[68:71]
    v_bitop3_b32 v11, v124, v126, s27 bitop3:0x7e
    v_bitop3_b32 v14, v14, v11, 1 bitop3:0xa8
    v_cmp_ne_u32 vcc, 0, v14
    s_nop 2
    s_cmp_eq_u64 vcc, 0
    s_cselect_b32 s36, s24, s61
    v_add_f32_dpp v68, v68, v68 row_ror:8 row_mask:0xf bank_mask:0xf
    v_add_f32_dpp v69, v69, v69 row_ror:8 row_mask:0xf bank_mask:0xf
    s_nop 0
    v_add_f32_dpp v68, v68, v68 row_ror:4 row_mask:0xf bank_mask:0xf
    v_add_f32_dpp v69, v69, v69 row_ror:4 row_mask:0xf bank_mask:0xf
    v_cvt_pk_bf16_f32 v12, v68, v69
    buffer_store_dword v12, v10, s[8:11], s36 offen
    s_cbranch_scc1 L_fast_gotp
    s_cmp_le_u32 s32, 200000
    s_cbranch_scc1 L_fast_retryp
    s_mov_b32 s36, s24
    buffer_store_dword v12, v10, s[8:11], s36 offen
    s_branch L_fast_gotp
L_fast_refresh:
    v_lshrrev_b32 v14, 2, v3
    s_lshl_b32 s36, s20, 8
    s_add_u32 s36, s36, 0x190000
    buffer_load_dword v14, v14, s[8:11], s36 offen sc1
    s_add_u32 s32, s32, 1
    s_waitcnt vmcnt(0)
    v_cmp_ne_u32 s[62:63], 0, v14
    s_nop 3
    s_cmp_le_u32 s32, 200000
    s_cbranch_scc1 L_fast_step
    s_mov_b64 s[62:63], -1
    s_branch L_fast_step
L_fast_safe:
    s_nop 11
    s_waitcnt vmcnt(0) lgkmcnt(0)
    s_barrier
    ds_read_b128 v[72:75], v6 offset:0
    ds_read_b128 v[88:91], v6 offset:2304
    ds_read_b128 v[76:79], v6 offset:64
    ds_read_b128 v[92:95], v6 offset:2368
    ds_read_b128 v[80:83], v6 offset:128
    ds_read_b128 v[96:99], v6 offset:2432
    ds_read_b128 v[84:87], v6 offset:192
    ds_read_b128 v[100:103], v6 offset:2496
    s_xor_b32 s36, s25, 0x1000
    s_add_u32 s36, s36, s23
    buffer_load_dwordx4 v[16:19], v3, s[8:11], s29 offen offset:0 sc1
    buffer_load_dwordx4 v[32:35], v3, s[8:11], s36 offen offset:0 sc1
    buffer_load_dwordx4 v[20:23], v3, s[8:11], s29 offen offset:1024 sc1
    buffer_load_dwordx4 v[36:39], v3, s[8:11], s36 offen offset:1024 sc1
    buffer_load_dwordx4 v[24:27], v3, s[8:11], s29 offen offset:2048 sc1
    buffer_load_dwordx4 v[40:43], v3, s[8:11], s36 offen offset:2048 sc1
    buffer_load_dwordx4 v[28:31], v3, s[8:11], s29 offen offset:3072 sc1
    buffer_load_dwordx4 v[44:47], v3, s[8:11], s36 offen offset:3072 sc1
    s_waitcnt vmcnt(0) lgkmcnt(0)
    v_mfma_f32_16x16x32_bf16 v[48:51], v[16:19], v[72:75], 0
    v_mfma_f32_16x16x32_bf16 v[48:51], v[20:23], v[76:79], v[48:51]
    v_mfma_f32_16x16x32_bf16 v[48:51], v[24:27], v[80:83], v[48:51]
    v_mfma_f32_16x16x32_bf16 v[48:51], v[28:31], v[84:87], v[48:51]
    v_mfma_f32_16x16x32_bf16 v[52:55], v[32:35], v[72:75], 0
    v_mfma_f32_16x16x32_bf16 v[52:55], v[36:39], v[76:79], v[52:55]
    v_mfma_f32_16x16x32_bf16 v[52:55], v[40:43], v[80:83], v[52:55]
    v_mfma_f32_16x16x32_bf16 v[52:55], v[44:47], v[84:87], v[52:55]
    v_mfma_f32_16x16x32_bf16 v[56:59], v[88:91], v[72:75], 0
    v_mfma_f32_16x16x32_bf16 v[56:59], v[92:95], v[76:79], v[56:59]
    v_mfma_f32_16x16x32_bf16 v[56:59], v[96:99], v[80:83], v[56:59]
    v_mfma_f32_16x16x32_bf16 v[56:59], v[100:103], v[84:87], v[56:59]
    s_nop 7
    v_mul_f32 v56, s33, v56
    v_mul_f32 v57, s33, v57
    v_max3_f32 v16, v48, v49, v50
    v_max3_f32 v16, v16, v51, v52
    v_max3_f32 v16, v16, v53, v54
    v_max3_f32 v16, v16, v55, v56
    v_max_f32 v16, v16, v57
    v_mov_b32 v17, v16
    s_nop 1
    v_permlane16_swap_b32 v16, v17
    v_max_f32 v16, v16, v17
    v_mov_b32 v17, v16
    s_nop 1
    v_permlane32_swap_b32 v16, v17
    v_max_f32 v16, v16, v17
    v_sub_f32 v48, v48, v16
    v_exp_f32 v48, v48
    v_sub_f32 v49, v49, v16
    v_exp_f32 v49, v49
    v_sub_f32 v50, v50, v16
    v_exp_f32 v50, v50
    v_sub_f32 v51, v51, v16
    v_exp_f32 v51, v51
    v_sub_f32 v52, v52, v16
    v_exp_f32 v52, v52
    v_sub_f32 v53, v53, v16
    v_exp_f32 v53, v53
    v_sub_f32 v54, v54, v16
    v_exp_f32 v54, v54
    v_sub_f32 v55, v55, v16
    v_exp_f32 v55, v55
    v_sub_f32 v56, v56, v16
    v_exp_f32 v56, v56
    v_sub_f32 v57, v57, v16
    v_exp_f32 v57, v57
    v_cvt_pk_bf16_f32 v108, v48, v49
    v_cvt_pk_bf16_f32 v109, v50, v51
    v_cvt_pk_bf16_f32 v110, v52, v53
    v_cvt_pk_bf16_f32 v111, v54, v55
    v_cvt_pk_bf16_f32 v112, v56, v57
    s_nop 0
    v_mfma_f32_16x16x32_bf16 v[48:51], v[104:107], v[108:111], 0
    v_mfma_f32_16x16x32_bf16 v[56:59], v[120:123], v[108:111], 0
    v_mfma_f32_16x16x32_bf16 v[60:63], v[124:127], v[108:111], 0
    s_nop 3
    v_mfma_f32_16x16x16_bf16 v[48:51], v[104:105], v[112:113], v[48:51]
    v_mfma_f32_16x16x16_bf16 v[56:59], v[114:115], v[112:113], v[56:59]
    v_mfma_f32_16x16x16_bf16 v[60:63], v[116:117], v[112:113], v[60:63]
    s_nop 5
    v_rcp_f32 v118, v48
    s_nop 0
    v_mul_f32 v56, v56, v118
    v_mul_f32 v57, v57, v118
    v_mul_f32 v58, v58, v118
    v_mul_f32 v59, v59, v118
    v_mul_f32 v60, v60, v118
    v_mul_f32 v61, v61, v118
    v_mul_f32 v62, v62, v118
    v_mul_f32 v63, v63, v118
    v_cvt_pk_bf16_f32 v52, v56, v60
    v_cvt_pk_bf16_f32 v53, v57, v61
    v_cvt_pk_bf16_f32 v54, v58, v62
    v_cvt_pk_bf16_f32 v55, v59, v63
    ds_read_b128 v[88:91], v4 offset:24576
    ds_read_b128 v[92:95], v4 offset:25600
    ds_read_b128 v[96:99], v4 offset:26624
    ds_read_b128 v[100:103], v4 offset:27648
    v_mov_b32 v16, 0
    v_mov_b32 v17, 0
    v_mov_b32 v18, 0
    v_mov_b32 v19, 0
    v_mov_b32 v20, 0
    v_mov_b32 v21, 0
    v_mov_b32 v22, 0
    v_mov_b32 v23, 0
    v_mov_b32 v24, 0
    v_mov_b32 v25, 0
    v_mov_b32 v26, 0
    v_mov_b32 v27, 0
    v_mov_b32 v28, 0
    v_mov_b32 v29, 0
    v_mov_b32 v30, 0
    v_mov_b32 v31, 0
    s_mov_b64 vcc, 0
    s_branch L_fast_rejoin
L_fast_done:
    s_branch L_end
L_slow_start:
    s_mov_b32 s22, 0
    s_mov_b32 s23, 0x1000000
    s_mov_b32 s27, 0
    s_mov_b32 s31, 0x80000
    s_mov_b32 s61, 0x40000000
    s_mov_b32 s91, 0
    ds_read_b128 v[104:107], v4 offset:0
    ds_read_b128 v[108:111], v4 offset:1024
    ds_read_b128 v[112:115], v4 offset:2048
    ds_read_b128 v[116:119], v4 offset:3072
    ds_read_b128 v[88:91], v4 offset:4096
    ds_read_b128 v[92:95], v4 offset:5120
    ds_read_b128 v[96:99], v4 offset:6144
    ds_read_b128 v[100:103], v4 offset:7168
    ds_read_b128 v[72:75], v4 offset:8192
    ds_read_b128 v[76:79], v4 offset:9216
    ds_read_b128 v[80:83], v4 offset:10240
    ds_read_b128 v[84:87], v4 offset:11264
    v_mov_b64 v[48:49], 0
    v_mov_b64 v[50:51], 0
    v_mov_b64 v[52:53], 0
    v_mov_b64 v[54:55], 0
    v_mov_b64 v[56:57], 0
    v_mov_b64 v[58:59], 0
    v_mov_b64 v[60:61], 0
    v_mov_b64 v[62:63], 0
    v_mov_b64 v[64:65], 0
    v_mov_b64 v[66:67], 0
    v_mov_b64 v[68:69], 0
    v_mov_b64 v[70:71], 0
    s_mov_b64 s[62:63], 0
    s_add_u32 s7, s23, 0x80000
    buffer_load_dwordx4 v[16:19], v2, s[8:11], s7 offen sc1
    buffer_load_dwordx4 v[20:23], v2, s[8:11], s7 offen offset:1024 sc1
L_slow_step:
    s_lshr_b64 s[36:37], s[62:63], s22
    s_andn2_b32 s36, 3, s36
    s_cbranch_scc1 L_slow_refresh
    s_add_u32 s24, s23, 0x82000
    s_add_u32 s29, s23, s25
    s_add_u32 s30, s23, s39
    s_xor_b32 s28, s27, 1
    s_add_u32 s90, s22, 1
    v_xor_b32 v28, 0x800, v2
    v_xor_b32 v44, 0x1800, v2
    s_nop 13
    buffer_load_dwordx4 v[16:19], v2, s[8:11], s7 offen sc1
    buffer_load_dwordx4 v[20:23], v2, s[8:11], s7 offen offset:1024 sc1
L_slow_waitm:
    s_waitcnt vmcnt(3) lgkmcnt(0)
L_slow_gotm:
    v_max3_u32 v14, v16, v17, v18
    v_max_u32 v14, v14, v19
    v_smfmac_f32_16x16x64_bf16 v[48:51], v[16:19], v[104:111], v1
    s_waitcnt vmcnt(2)
    v_max3_u32 v14, v14, v20, v21
    v_smfmac_f32_16x16x64_bf16 v[52:55], v[16:19], v[112:119], v1
    v_max3_u32 v14, v14, v22, v23
    v_cmp_eq_u32 vcc, -1, v14
    v_smfmac_f32_16x16x64_bf16 v[48:51], v[20:23], v[88:95], v1
    ds_write_b128 v2, v[16:19] offset:0
    s_cbranch_vccnz L_slow_retrym
L_slow_okm:
    v_smfmac_f32_16x16x64_bf16 v[52:55], v[20:23], v[96:103], v1
    ds_write_b128 v2, v[20:23] offset:1024
    v_smfmac_f32_16x16x64_bf16 v[56:59], v[16:19], v[72:79], v1
    buffer_load_dwordx4 v[104:107], v3, s[8:11], s29 offen offset:0 sc1
    v_smfmac_f32_16x16x64_bf16 v[60:63], v[16:19], v[80:87], v1
    buffer_load_dwordx4 v[108:111], v3, s[8:11], s29 offen offset:1024 sc1
    v_smfmac_f32_16x16x64_bf16 v[56:59], v[20:23], a[80:87], v1
    buffer_load_dwordx4 v[112:115], v3, s[8:11], s29 offen offset:2048 sc1
    v_smfmac_f32_16x16x64_bf16 v[60:63], v[20:23], a[88:95], v1
    s_waitcnt lgkmcnt(0)
    s_barrier
    ds_read_b128 v[24:27], v28 offset:0
    v_smfmac_f32_16x16x64_bf16 v[64:67], v[16:19], a[160:167], v1
    ds_read_b128 v[28:31], v28 offset:1024
    v_smfmac_f32_16x16x64_bf16 v[68:71], v[16:19], a[168:175], v1
    buffer_load_dwordx4 v[116:119], v3, s[8:11], s29 offen offset:3072 sc1
    v_smfmac_f32_16x16x64_bf16 v[64:67], v[20:23], a[176:183], v1
    ds_read_b128 v[32:35], v8 offset:0
    v_smfmac_f32_16x16x64_bf16 v[68:71], v[20:23], a[184:191], v1
    ds_read_b128 v[36:39], v8 offset:1024
    s_waitcnt lgkmcnt(3)
    v_smfmac_f32_16x16x64_bf16 v[48:51], v[24:27], a[0:7], v1
    buffer_load_dwordx4 v[120:123], v3, s[8:11], s30 offen offset:0 sc1
    v_smfmac_f32_16x16x64_bf16 v[52:55], v[24:27], a[8:15], v1
    ds_read_b128 v[40:43], v44 offset:0
    s_waitcnt lgkmcnt(3)
    v_smfmac_f32_16x16x64_bf16 v[48:51], v[28:31], a[16:23], v1
    buffer_load_dwordx4 v[124:127], v3, s[8:11], s30 offen offset:1024 sc1
    v_smfmac_f32_16x16x64_bf16 v[52:55], v[28:31], a[24:31], v1
    ds_read_b128 v[44:47], v44 offset:1024
    s_waitcnt lgkmcnt(2)
    v_smfmac_f32_16x16x64_bf16 v[48:51], v[32:35], a[32:39], v1
    v_smfmac_f32_16x16x64_bf16 v[52:55], v[32:35], a[40:47], v1
    ds_read_b128 v[88:91], v4 offset:12288
    v_smfmac_f32_16x16x64_bf16 v[48:51], v[36:39], a[48:55], v1
    ds_read_b128 v[92:95], v4 offset:13312
    s_waitcnt lgkmcnt(2)
    v_smfmac_f32_16x16x64_bf16 v[52:55], v[36:39], a[56:63], v1
    ds_read_b128 v[96:99], v4 offset:14336
    v_smfmac_f32_16x16x64_bf16 v[48:51], v[40:43], a[64:71], v1
    ds_read_b128 v[100:103], v4 offset:15360
    v_smfmac_f32_16x16x64_bf16 v[52:55], v[40:43], a[72:79], v1
    buffer_load_dword v15, v0, s[8:11], s24 offen sc1
    v_smfmac_f32_16x16x64_bf16 v[56:59], v[28:31], a[96:103], v1
    ds_read_b128 v[72:75], v4 offset:16384
    v_smfmac_f32_16x16x64_bf16 v[60:63], v[28:31], a[104:111], v1
    ds_read_b128 v[76:79], v4 offset:17408
    s_waitcnt lgkmcnt(2)
    v_smfmac_f32_16x16x64_bf16 v[48:51], v[44:47], v[88:95], v1
    ds_read_b128 v[80:83], v4 offset:18432
    v_smfmac_f32_16x16x64_bf16 v[52:55], v[44:47], v[96:103], v1
    ds_read_b128 v[84:87], v4 offset:19456
    v_smfmac_f32_16x16x64_bf16 v[56:59], v[32:35], a[112:119], v1
    ds_read_b128 v[88:91], v4 offset:20480
    v_smfmac_f32_16x16x64_bf16 v[60:63], v[32:35], a[120:127], v1
    ds_read_b128 v[92:95], v4 offset:21504
    v_smfmac_f32_16x16x64_bf16 v[56:59], v[36:39], a[128:135], v1
    ds_read_b128 v[96:99], v4 offset:22528
    v_add_f32 v48, v48, v50
    v_add_f32 v49, v49, v51
    v_smfmac_f32_16x16x64_bf16 v[60:63], v[36:39], a[136:143], v1
    ds_read_b128 v[100:103], v4 offset:23552
    v_add_f32 v52, v52, v54
    v_add_f32 v53, v53, v55
    v_smfmac_f32_16x16x64_bf16 v[56:59], v[40:43], a[144:151], v1
    s_waitcnt lgkmcnt(4)
    v_cvt_pk_bf16_f32 v50, v48, v52
    v_cvt_pk_bf16_f32 v51, v49, v53
    v_smfmac_f32_16x16x64_bf16 v[60:63], v[40:43], a[152:159], v1
    ds_write2_b32 v5, v50, v51 offset0:0 offset1:72
    v_smfmac_f32_16x16x64_bf16 v[56:59], v[24:27], v[72:79], v1
    buffer_store_dword v12, v10, s[8:11], s31 offen sc1
    v_smfmac_f32_16x16x64_bf16 v[60:63], v[24:27], v[80:87], v1
    s_waitcnt lgkmcnt(1)
    v_smfmac_f32_16x16x64_bf16 v[56:59], v[44:47], v[88:95], v1
    v_smfmac_f32_16x16x64_bf16 v[60:63], v[44:47], v[96:103], v1
    s_waitcnt lgkmcnt(0)
    s_barrier
    v_smfmac_f32_16x16x64_bf16 v[64:67], v[24:27], a[192:199], v1
    ds_read_b128 v[72:75], v6 offset:0
    v_smfmac_f32_16x16x64_bf16 v[68:71], v[24:27], a[200:207], v1
    ds_read_b128 v[76:79], v6 offset:64
    s_nop 0
    v_add_f32 v56, v56, v58
    v_smfmac_f32_16x16x64_bf16 v[64:67], v[28:31], a[208:215], v1
    ds_read_b128 v[80:83], v6 offset:128
    v_add_f32 v57, v57, v59
    v_smfmac_f32_16x16x64_bf16 v[68:71], v[28:31], a[216:223], v1
    ds_read_b128 v[84:87], v6 offset:192
    v_add_f32 v60, v60, v62
    v_add_f32 v61, v61, v63
    s_waitcnt vmcnt(2) lgkmcnt(3)
    v_mfma_f32_16x16x32_bf16 v[48:51], v[104:107], v[72:75], 0
    s_waitcnt lgkmcnt(2)
    v_cvt_pk_bf16_f32 v58, v56, v60
    v_cvt_pk_bf16_f32 v59, v57, v61
    v_mfma_f32_16x16x32_bf16 v[48:51], v[108:111], v[76:79], v[48:51]
    ds_write2_b32 v7, v58, v59 offset0:0 offset1:72
    s_waitcnt lgkmcnt(2)
    v_mfma_f32_16x16x32_bf16 v[48:51], v[112:115], v[80:83], v[48:51]
    s_waitcnt lgkmcnt(1)
    v_mov_b64 v[104:105], s[4:5]
    v_mov_b64 v[106:107], s[4:5]
    v_mfma_f32_16x16x32_bf16 v[48:51], v[116:119], v[84:87], v[48:51]
    v_mov_b64 v[16:17], 0
    v_mov_b64 v[18:19], 0
    v_smfmac_f32_16x16x64_bf16 v[64:67], v[32:35], a[224:231], v1
    v_mov_b32 v113, 0
    v_smfmac_f32_16x16x64_bf16 v[68:71], v[32:35], a[232:239], v1
    s_waitcnt lgkmcnt(0)
    s_barrier
    v_mov_b32 v115, 0
    v_smfmac_f32_16x16x64_bf16 v[64:67], v[36:39], a[240:247], v1
    ds_read_b128 v[88:91], v6 offset:2304
    v_exp_f32 v48, v48
    v_smfmac_f32_16x16x64_bf16 v[68:71], v[36:39], a[248:255], v1
    ds_read_b128 v[92:95], v6 offset:2368
    v_exp_f32 v49, v49
    v_smfmac_f32_16x16x64_bf16 v[64:67], v[40:43], v[128:135], v1
    ds_read_b128 v[96:99], v6 offset:2432
    v_exp_f32 v50, v50
    v_smfmac_f32_16x16x64_bf16 v[68:71], v[40:43], v[136:143], v1
    ds_read_b128 v[100:103], v6 offset:2496
    v_exp_f32 v51, v51
    s_waitcnt lgkmcnt(3)
    v_mfma_f32_16x16x32_bf16 v[52:55], v[88:91], v[72:75], 0
    s_waitcnt lgkmcnt(2)
    v_cvt_pk_bf16_f32 v108, v48, v49
    v_cvt_pk_bf16_f32 v109, v50, v51
    v_mfma_f32_16x16x32_bf16 v[52:55], v[92:95], v[76:79], v[52:55]
    ds_write_b64 v2, v[108:109] offset:8192
    s_waitcnt lgkmcnt(2)
    v_mfma_f32_16x16x32_bf16 v[52:55], v[96:99], v[80:83], v[52:55]
    s_waitcnt lgkmcnt(1)
    v_mov_b32 v117, 0
    v_mov_b64 v[20:21], 0
    v_mfma_f32_16x16x32_bf16 v[52:55], v[100:103], v[84:87], v[52:55]
    v_mov_b64 v[22:23], 0
    v_mov_b64 v[24:25], 0
    v_smfmac_f32_16x16x64_bf16 v[64:67], v[44:47], v[144:151], v1
    ds_read_b128 v[88:91], v4 offset:24576
    v_smfmac_f32_16x16x64_bf16 v[68:71], v[44:47], v[152:159], v1
    s_waitcnt lgkmcnt(1)
    s_barrier
    ds_read_b64 v[110:111], v8 offset:8192
    ds_read_b128 v[92:95], v4 offset:25600
    v_mul_f32 v52, s33, v52
    v_mul_f32 v53, s33, v53
    v_exp_f32 v52, v52
    v_exp_f32 v53, v53
    s_nop 0
    v_cvt_pk_bf16_f32 v112, v52, v53
    v_add_f32 v64, v64, v66
    v_add_f32 v65, v65, v67
    s_waitcnt lgkmcnt(1)
    v_mfma_f32_16x16x32_bf16 v[48:51], v[104:107], v[108:111], 0
    v_cvt_pk_bf16_f32 v114, v64, v65
    v_add_f32 v68, v68, v70
    v_mfma_f32_16x16x32_bf16 v[56:59], v[120:123], v[108:111], 0
    v_add_f32 v69, v69, v71
    v_cvt_pk_bf16_f32 v116, v68, v69
    v_mfma_f32_16x16x32_bf16 v[60:63], v[124:127], v[108:111], 0
    ds_read_b128 v[96:99], v4 offset:26624
    v_mov_b64 v[26:27], 0
    v_mfma_f32_16x16x16_bf16 v[48:51], v[104:105], v[112:113], v[48:51]
    ds_read_b128 v[100:103], v4 offset:27648
    v_mov_b64 v[28:29], 0
    v_mfma_f32_16x16x16_bf16 v[56:59], v[114:115], v[112:113], v[56:59]
    v_mov_b64 v[30:31], 0
    v_mfma_f32_16x16x16_bf16 v[60:63], v[116:117], v[112:113], v[60:63]
    s_nop 2
    v_rcp_f32 v118, v48
    s_nop 0
    v_max_f32 v14, v118, v48
    v_cmp_nge_f32 vcc, s40, v14
    v_pk_mul_f32 v[56:57], v[56:57], v[118:119] op_sel_hi:[1,0]
    v_pk_mul_f32 v[58:59], v[58:59], v[118:119] op_sel_hi:[1,0]
    v_pk_mul_f32 v[60:61], v[60:61], v[118:119] op_sel_hi:[1,0]
    v_pk_mul_f32 v[62:63], v[62:63], v[118:119] op_sel_hi:[1,0]
    v_cvt_pk_bf16_f32 v52, v56, v60
    v_cvt_pk_bf16_f32 v53, v57, v61
    v_cvt_pk_bf16_f32 v54, v58, v62
    v_cvt_pk_bf16_f32 v55, v59, v63
L_slow_rejoin:
    ds_write_b128 v2, v[52:55] offset:9216
    s_waitcnt lgkmcnt(1)
    v_smfmac_f32_16x16x64_bf16 v[16:19], v[52:55], v[88:95], v1
    ds_read_b128 v[72:75], v4 offset:28672
    v_xor_b32 v32, 0x800, v2
    v_smfmac_f32_16x16x64_bf16 v[20:23], v[52:55], v[96:103], v1
    ds_read_b128 v[76:79], v4 offset:29696
    v_xor_b32 v40, 0x1800, v2
    s_waitcnt lgkmcnt(2)
    s_barrier
    ds_read_b128 v[32:35], v32 offset:9216
    ds_read_b128 v[36:39], v8 offset:9216
    ds_read_b128 v[40:43], v40 offset:9216
    ds_read_b128 v[80:83], v4 offset:30720
    ds_read_b128 v[84:87], v4 offset:31744
    s_waitcnt lgkmcnt(4)
    v_smfmac_f32_16x16x64_bf16 v[16:19], v[32:35], v[160:167], v1
    s_waitcnt lgkmcnt(3)
    v_smfmac_f32_16x16x64_bf16 v[16:19], v[36:39], v[192:199], v1
    s_waitcnt lgkmcnt(2)
    v_smfmac_f32_16x16x64_bf16 v[16:19], v[40:43], v[224:231], v1
    s_cmp_lg_u64 vcc, 0
    s_cselect_b32 s60, s28, s27
    v_smfmac_f32_16x16x64_bf16 v[20:23], v[32:35], v[168:175], v1
    ds_read_b128 v[64:67], v3 offset:23040
    s_waitcnt lgkmcnt(1)
    v_smfmac_f32_16x16x64_bf16 v[20:23], v[36:39], v[200:207], v1
    s_nop 1
    v_smfmac_f32_16x16x64_bf16 v[20:23], v[40:43], v[232:239], v1
    v_cvt_pk_bf16_f32 v56, v16, v18
    v_smfmac_f32_16x16x64_bf16 v[24:27], v[52:55], v[72:79], v1
    v_cvt_pk_bf16_f32 v57, v17, v19
    v_and_or_b32 v56, v56, -2, s60
    v_smfmac_f32_16x16x64_bf16 v[24:27], v[32:35], v[176:183], v1
    buffer_store_dwordx2 v[56:57], v9, s[8:11], 0 offen offset:0 sc1
    v_smfmac_f32_16x16x64_bf16 v[24:27], v[36:39], v[208:215], v1
    s_nop 0
    v_cvt_pk_bf16_f32 v58, v20, v22
    v_smfmac_f32_16x16x64_bf16 v[24:27], v[40:43], v[240:247], v1
    v_cvt_pk_bf16_f32 v59, v21, v23
    v_and_or_b32 v58, v58, -2, s60
    v_smfmac_f32_16x16x64_bf16 v[28:31], v[52:55], v[80:87], v1
    buffer_store_dwordx2 v[58:59], v9, s[8:11], 0 offen offset:2048 sc1
    v_smfmac_f32_16x16x64_bf16 v[28:31], v[32:35], v[184:191], v1
    s_nop 1
    v_smfmac_f32_16x16x64_bf16 v[28:31], v[36:39], v[216:223], v1
    v_cvt_pk_bf16_f32 v60, v24, v26
    v_smfmac_f32_16x16x64_bf16 v[28:31], v[40:43], v[248:255], v1
    v_cvt_pk_bf16_f32 v61, v25, v27
    v_and_or_b32 v60, v60, -2, s60
    buffer_store_dwordx2 v[60:61], v9, s[8:11], s26 offen offset:0 sc1
    s_nop 4
    v_cvt_pk_bf16_f32 v62, v28, v30
    v_cvt_pk_bf16_f32 v63, v29, v31
    v_and_or_b32 v62, v62, -2, s60
    buffer_store_dwordx2 v[62:63], v9, s[8:11], s26 offen offset:2048 sc1
L_slow_stored:
    s_cmp_lg_u32 s60, s27
    s_cbranch_scc1 L_slow_safe
    ds_read_b128 v[104:107], v4 offset:0
    ds_read_b128 v[108:111], v4 offset:1024
    ds_read_b128 v[112:115], v4 offset:2048
    ds_read_b128 v[116:119], v4 offset:3072
    ds_read_b128 v[88:91], v4 offset:4096
    ds_read_b128 v[92:95], v4 offset:5120
    ds_read_b128 v[96:99], v4 offset:6144
    ds_read_b128 v[100:103], v4 offset:7168
    ds_read_b128 v[72:75], v4 offset:8192
    ds_read_b128 v[76:79], v4 offset:9216
    ds_read_b128 v[80:83], v4 offset:10240
    ds_read_b128 v[84:87], v4 offset:11264
    s_cmp_lt_u32 s21, 1
    s_cbranch_scc1 L_slow_pollp
    s_nop 7
    s_cmp_lt_u32 s21, 2
    s_cbranch_scc1 L_slow_pollp
    s_nop 7
    s_cmp_lt_u32 s21, 3
    s_cbranch_scc1 L_slow_pollp
    s_nop 7
L_slow_pollp:
    buffer_load_dwordx4 v[120:123], v2, s[8:11], s6 offen sc1
    buffer_load_dwordx4 v[124:127], v2, s[8:11], s6 offen offset:1024 sc1
    v_mov_b64 v[48:49], 0
    v_mov_b64 v[50:51], 0
    v_mov_b64 v[52:53], 0
    v_mov_b64 v[54:55], 0
    v_mov_b64 v[56:57], 0
    v_mov_b64 v[58:59], 0
    v_mov_b64 v[60:61], 0
    v_mov_b64 v[62:63], 0
    s_nop 15
    s_nop 11
    buffer_load_dwordx4 v[32:35], v2, s[8:11], s6 offen sc1
    buffer_load_dwordx4 v[36:39], v2, s[8:11], s6 offen offset:1024 sc1
    s_add_u32 s7, s24, 0x80000
    s_waitcnt vmcnt(3) lgkmcnt(0)
    v_mfma_f32_16x16x32_bf16 v[68:71], v[64:67], v[120:123], 0
    v_bitop3_b32 v14, v120, v122, s27 bitop3:0x7e
    s_waitcnt vmcnt(2)
    v_mfma_f32_16x16x32_bf16 v[68:71], v[64:67], v[124:127], v[68:71]
    v_bitop3_b32 v11, v124, v126, s27 bitop3:0x7e
    v_bitop3_b32 v14, v14, v11, 1 bitop3:0xa8
    v_cmp_ne_u32 vcc, 0, v14
    s_nop 2
    s_cmp_eq_u64 vcc, 0
    s_cselect_b32 s36, s24, s61
    v_add_f32_dpp v68, v68, v68 row_ror:8 row_mask:0xf bank_mask:0xf
    v_add_f32_dpp v69, v69, v69 row_ror:8 row_mask:0xf bank_mask:0xf
    s_nop 0
    v_add_f32_dpp v68, v68, v68 row_ror:4 row_mask:0xf bank_mask:0xf
    v_add_f32_dpp v69, v69, v69 row_ror:4 row_mask:0xf bank_mask:0xf
    v_cvt_pk_bf16_f32 v12, v68, v69
    buffer_store_dword v12, v10, s[8:11], s36 offen sc1
    s_cbranch_scc0 L_slow_retryp
L_slow_gotp:
    s_mov_b32 s23, s24
    s_add_u32 s31, s31, 0x2000
    s_mov_b32 s22, s90
    s_mov_b32 s27, s28
    v_mov_b64 v[64:65], 0
    v_mov_b64 v[66:67], 0
    v_mov_b64 v[68:69], 0
    v_mov_b64 v[70:71], 0
    s_nop 15
    s_nop 15
    s_nop 3
    buffer_load_dwordx4 v[16:19], v2, s[8:11], s7 offen sc1
    buffer_load_dwordx4 v[20:23], v2, s[8:11], s7 offen offset:1024 sc1
    s_cmp_lt_u32 s22, 63
    s_cbranch_scc1 L_slow_step
    buffer_store_dword v12, v10, s[8:11], s31 offen sc1
    s_branch L_slow_done
L_slow_retrym:
    s_add_u32 s32, s32, 1
    s_cmp_gt_u32 s32, 200000
    s_cbranch_scc1 L_slow_okm
    buffer_load_dwordx4 v[16:19], v2, s[8:11], s7 offen sc1
    buffer_load_dwordx4 v[20:23], v2, s[8:11], s7 offen offset:1024 sc1
    s_nop 1
    v_mov_b64 v[48:49], 0
    v_mov_b64 v[50:51], 0
    v_mov_b64 v[52:53], 0
    v_mov_b64 v[54:55], 0
    s_branch L_slow_waitm
L_slow_retryp:
    s_add_u32 s32, s32, 1
    buffer_load_dwordx4 v[120:123], v2, s[8:11], s6 offen sc1
    buffer_load_dwordx4 v[124:127], v2, s[8:11], s6 offen offset:1024 sc1
    s_waitcnt vmcnt(4) lgkmcnt(0)
    v_mfma_f32_16x16x32_bf16 v[68:71], v[64:67], v[32:35], 0
    v_bitop3_b32 v14, v32, v34, s27 bitop3:0x7e
    s_waitcnt vmcnt(3)
    v_mfma_f32_16x16x32_bf16 v[68:71], v[64:67], v[36:39], v[68:71]
    v_bitop3_b32 v11, v36, v38, s27 bitop3:0x7e
    v_bitop3_b32 v14, v14, v11, 1 bitop3:0xa8
    v_cmp_ne_u32 vcc, 0, v14
    s_nop 2
    s_cmp_eq_u64 vcc, 0
    s_cselect_b32 s36, s24, s61
    v_add_f32_dpp v68, v68, v68 row_ror:8 row_mask:0xf bank_mask:0xf
    v_add_f32_dpp v69, v69, v69 row_ror:8 row_mask:0xf bank_mask:0xf
    s_nop 0
    v_add_f32_dpp v68, v68, v68 row_ror:4 row_mask:0xf bank_mask:0xf
    v_add_f32_dpp v69, v69, v69 row_ror:4 row_mask:0xf bank_mask:0xf
    v_cvt_pk_bf16_f32 v12, v68, v69
    buffer_store_dword v12, v10, s[8:11], s36 offen sc1
    s_cbranch_scc1 L_slow_gotp
    buffer_load_dwordx4 v[32:35], v2, s[8:11], s6 offen sc1
    buffer_load_dwordx4 v[36:39], v2, s[8:11], s6 offen offset:1024 sc1
    s_waitcnt vmcnt(4) lgkmcnt(0)
    v_mfma_f32_16x16x32_bf16 v[68:71], v[64:67], v[120:123], 0
    v_bitop3_b32 v14, v120, v122, s27 bitop3:0x7e
    s_waitcnt vmcnt(3)
    v_mfma_f32_16x16x32_bf16 v[68:71], v[64:67], v[124:127], v[68:71]
    v_bitop3_b32 v11, v124, v126, s27 bitop3:0x7e
    v_bitop3_b32 v14, v14, v11, 1 bitop3:0xa8
    v_cmp_ne_u32 vcc, 0, v14
    s_nop 2
    s_cmp_eq_u64 vcc, 0
    s_cselect_b32 s36, s24, s61
    v_add_f32_dpp v68, v68, v68 row_ror:8 row_mask:0xf bank_mask:0xf
    v_add_f32_dpp v69, v69, v69 row_ror:8 row_mask:0xf bank_mask:0xf
    s_nop 0
    v_add_f32_dpp v68, v68, v68 row_ror:4 row_mask:0xf bank_mask:0xf
    v_add_f32_dpp v69, v69, v69 row_ror:4 row_mask:0xf bank_mask:0xf
    v_cvt_pk_bf16_f32 v12, v68, v69
    buffer_store_dword v12, v10, s[8:11], s36 offen sc1
    s_cbranch_scc1 L_slow_gotp
    s_cmp_le_u32 s32, 200000
    s_cbranch_scc1 L_slow_retryp
    s_mov_b32 s36, s24
    buffer_store_dword v12, v10, s[8:11], s36 offen sc1
    s_branch L_slow_gotp
L_slow_refresh:
    v_lshrrev_b32 v14, 2, v3
    s_lshl_b32 s36, s20, 8
    s_add_u32 s36, s36, 0x190000
    buffer_load_dword v14, v14, s[8:11], s36 offen sc1
    s_add_u32 s32, s32, 1
    s_waitcnt vmcnt(0)
    v_cmp_ne_u32 s[62:63], 0, v14
    s_nop 3
    s_cmp_le_u32 s32, 200000
    s_cbranch_scc1 L_slow_step
    s_mov_b64 s[62:63], -1
    s_branch L_slow_step
L_slow_safe:
    s_nop 11
    s_waitcnt vmcnt(0) lgkmcnt(0)
    s_barrier
    ds_read_b128 v[72:75], v6 offset:0
    ds_read_b128 v[88:91], v6 offset:2304
    ds_read_b128 v[76:79], v6 offset:64
    ds_read_b128 v[92:95], v6 offset:2368
    ds_read_b128 v[80:83], v6 offset:128
    ds_read_b128 v[96:99], v6 offset:2432
    ds_read_b128 v[84:87], v6 offset:192
    ds_read_b128 v[100:103], v6 offset:2496
    s_xor_b32 s36, s25, 0x1000
    s_add_u32 s36, s36, s23
    buffer_load_dwordx4 v[16:19], v3, s[8:11], s29 offen offset:0 sc1
    buffer_load_dwordx4 v[32:35], v3, s[8:11], s36 offen offset:0 sc1
    buffer_load_dwordx4 v[20:23], v3, s[8:11], s29 offen offset:1024 sc1
    buffer_load_dwordx4 v[36:39], v3, s[8:11], s36 offen offset:1024 sc1
    buffer_load_dwordx4 v[24:27], v3, s[8:11], s29 offen offset:2048 sc1
    buffer_load_dwordx4 v[40:43], v3, s[8:11], s36 offen offset:2048 sc1
    buffer_load_dwordx4 v[28:31], v3, s[8:11], s29 offen offset:3072 sc1
    buffer_load_dwordx4 v[44:47], v3, s[8:11], s36 offen offset:3072 sc1
    s_waitcnt vmcnt(0) lgkmcnt(0)
    v_mfma_f32_16x16x32_bf16 v[48:51], v[16:19], v[72:75], 0
    v_mfma_f32_16x16x32_bf16 v[48:51], v[20:23], v[76:79], v[48:51]
    v_mfma_f32_16x16x32_bf16 v[48:51], v[24:27], v[80:83], v[48:51]
    v_mfma_f32_16x16x32_bf16 v[48:51], v[28:31], v[84:87], v[48:51]
    v_mfma_f32_16x16x32_bf16 v[52:55], v[32:35], v[72:75], 0
    v_mfma_f32_16x16x32_bf16 v[52:55], v[36:39], v[76:79], v[52:55]
    v_mfma_f32_16x16x32_bf16 v[52:55], v[40:43], v[80:83], v[52:55]
    v_mfma_f32_16x16x32_bf16 v[52:55], v[44:47], v[84:87], v[52:55]
    v_mfma_f32_16x16x32_bf16 v[56:59], v[88:91], v[72:75], 0
    v_mfma_f32_16x16x32_bf16 v[56:59], v[92:95], v[76:79], v[56:59]
    v_mfma_f32_16x16x32_bf16 v[56:59], v[96:99], v[80:83], v[56:59]
    v_mfma_f32_16x16x32_bf16 v[56:59], v[100:103], v[84:87], v[56:59]
    s_nop 7
    v_mul_f32 v56, s33, v56
    v_mul_f32 v57, s33, v57
    v_max3_f32 v16, v48, v49, v50
    v_max3_f32 v16, v16, v51, v52
    v_max3_f32 v16, v16, v53, v54
    v_max3_f32 v16, v16, v55, v56
    v_max_f32 v16, v16, v57
    v_mov_b32 v17, v16
    s_nop 1
    v_permlane16_swap_b32 v16, v17
    v_max_f32 v16, v16, v17
    v_mov_b32 v17, v16
    s_nop 1
    v_permlane32_swap_b32 v16, v17
    v_max_f32 v16, v16, v17
    v_sub_f32 v48, v48, v16
    v_exp_f32 v48, v48
    v_sub_f32 v49, v49, v16
    v_exp_f32 v49, v49
    v_sub_f32 v50, v50, v16
    v_exp_f32 v50, v50
    v_sub_f32 v51, v51, v16
    v_exp_f32 v51, v51
    v_sub_f32 v52, v52, v16
    v_exp_f32 v52, v52
    v_sub_f32 v53, v53, v16
    v_exp_f32 v53, v53
    v_sub_f32 v54, v54, v16
    v_exp_f32 v54, v54
    v_sub_f32 v55, v55, v16
    v_exp_f32 v55, v55
    v_sub_f32 v56, v56, v16
    v_exp_f32 v56, v56
    v_sub_f32 v57, v57, v16
    v_exp_f32 v57, v57
    v_cvt_pk_bf16_f32 v108, v48, v49
    v_cvt_pk_bf16_f32 v109, v50, v51
    v_cvt_pk_bf16_f32 v110, v52, v53
    v_cvt_pk_bf16_f32 v111, v54, v55
    v_cvt_pk_bf16_f32 v112, v56, v57
    s_nop 0
    v_mfma_f32_16x16x32_bf16 v[48:51], v[104:107], v[108:111], 0
    v_mfma_f32_16x16x32_bf16 v[56:59], v[120:123], v[108:111], 0
    v_mfma_f32_16x16x32_bf16 v[60:63], v[124:127], v[108:111], 0
    s_nop 3
    v_mfma_f32_16x16x16_bf16 v[48:51], v[104:105], v[112:113], v[48:51]
    v_mfma_f32_16x16x16_bf16 v[56:59], v[114:115], v[112:113], v[56:59]
    v_mfma_f32_16x16x16_bf16 v[60:63], v[116:117], v[112:113], v[60:63]
    s_nop 5
    v_rcp_f32 v118, v48
    s_nop 0
    v_mul_f32 v56, v56, v118
    v_mul_f32 v57, v57, v118
    v_mul_f32 v58, v58, v118
    v_mul_f32 v59, v59, v118
    v_mul_f32 v60, v60, v118
    v_mul_f32 v61, v61, v118
    v_mul_f32 v62, v62, v118
    v_mul_f32 v63, v63, v118
    v_cvt_pk_bf16_f32 v52, v56, v60
    v_cvt_pk_bf16_f32 v53, v57, v61
    v_cvt_pk_bf16_f32 v54, v58, v62
    v_cvt_pk_bf16_f32 v55, v59, v63
    ds_read_b128 v[88:91], v4 offset:24576
    ds_read_b128 v[92:95], v4 offset:25600
    ds_read_b128 v[96:99], v4 offset:26624
    ds_read_b128 v[100:103], v4 offset:27648
    v_mov_b32 v16, 0
    v_mov_b32 v17, 0
    v_mov_b32 v18, 0
    v_mov_b32 v19, 0
    v_mov_b32 v20, 0
    v_mov_b32 v21, 0
    v_mov_b32 v22, 0
    v_mov_b32 v23, 0
    v_mov_b32 v24, 0
    v_mov_b32 v25, 0
    v_mov_b32 v26, 0
    v_mov_b32 v27, 0
    v_mov_b32 v28, 0
    v_mov_b32 v29, 0
    v_mov_b32 v30, 0
    v_mov_b32 v31, 0
    s_mov_b64 vcc, 0
    s_branch L_slow_rejoin
L_slow_done:
    s_branch L_end
L_worker:
    s_mov_b32 s12, s44
    s_and_b32 s13, s45, 0xffff
    s_mov_b32 s14, 0x200000
    s_mov_b32 s15, 0x20000
    s_mov_b32 s60, s82
    s_and_b32 s61, s83, 0xffff
    s_mov_b32 s62, 0x200000
    s_mov_b32 s63, 0x20000
    s_cmp_eq_u32 s3, 7
    s_cbranch_scc1 L_mlp
    s_mov_b32 s92, s80
    s_and_b32 s93, s81, 0xffff
    s_mov_b32 s94, 0x400
    s_mov_b32 s95, 0x20000
    s_and_b32 s36, s2, 7
    s_sub_u32 s36, s36, 1
    s_lshl_b32 s36, s36, 5
    s_lshr_b32 s37, s2, 3
    s_add_u32 s36, s36, s37
    s_mul_i32 s20, s36, 10923
    s_lshr_b32 s20, s20, 16
    s_mul_i32 s37, s20, 6
    s_sub_u32 s22, s36, s37
    v_mov_b32 v1, 0x0
    v_bfe_u32 v14, v0, 0, 1
    s_mov_b32 s38, 0x10
    v_mad_u32_u24 v1, v14, s38, v1
    v_bfe_u32 v14, v0, 1, 1
    s_mov_b32 s38, 0x20
    v_mad_u32_u24 v1, v14, s38, v1
    v_bfe_u32 v14, v0, 2, 1
    s_mov_b32 s38, 0x40
    v_mad_u32_u24 v1, v14, s38, v1
    v_bfe_u32 v14, v0, 3, 1
    s_mov_b32 s38, 0x80
    v_mad_u32_u24 v1, v14, s38, v1
    v_bfe_u32 v14, v0, 4, 1
    s_mov_b32 s38, 0x100
    v_mad_u32_u24 v1, v14, s38, v1
    v_bfe_u32 v14, v0, 5, 1
    s_mov_b32 s38, 0x200
    v_mad_u32_u24 v1, v14, s38, v1
    v_mov_b32 v2, 0x0
    v_bfe_u32 v14, v0, 0, 1
    s_mov_b32 s38, 0x10
    v_mad_u32_u24 v2, v14, s38, v2
    v_bfe_u32 v14, v0, 1, 1
    s_mov_b32 s38, 0x20
    v_mad_u32_u24 v2, v14, s38, v2
    v_bfe_u32 v14, v0, 2, 1
    s_mov_b32 s38, 0x40
    v_mad_u32_u24 v2, v14, s38, v2
    v_bfe_u32 v14, v0, 3, 1
    s_mov_b32 s38, 0x80
    v_mad_u32_u24 v2, v14, s38, v2
    v_bfe_u32 v14, v0, 4, 1
    s_mov_b32 s38, 0x100
    v_mad_u32_u24 v2, v14, s38, v2
    v_bfe_u32 v14, v0, 5, 1
    s_mov_b32 s38, 0x200
    v_mad_u32_u24 v2, v14, s38, v2
    v_bfe_u32 v14, v0, 6, 1
    s_mov_b32 s38, 0x800
    v_mad_u32_u24 v2, v14, s38, v2
    v_bfe_u32 v14, v0, 7, 1
    s_mov_b32 s38, 0x1000
    v_mad_u32_u24 v2, v14, s38, v2
    v_mov_b32 v9, 0x0
    v_bfe_u32 v14, v0, 0, 1
    s_mov_b32 s38, 0x10
    v_mad_u32_u24 v9, v14, s38, v9
    v_bfe_u32 v14, v0, 1, 1
    s_mov_b32 s38, 0x20
    v_mad_u32_u24 v9, v14, s38, v9
    v_bfe_u32 v14, v0, 2, 1
    s_mov_b32 s38, 0x40
    v_mad_u32_u24 v9, v14, s38, v9
    v_bfe_u32 v14, v0, 3, 1
    s_mov_b32 s38, 0x80
    v_mad_u32_u24 v9, v14, s38, v9
    v_bfe_u32 v14, v0, 4, 1
    s_mov_b32 s38, 0x100
    v_mad_u32_u24 v9, v14, s38, v9
    v_bfe_u32 v14, v0, 5, 1
    s_mov_b32 s38, 0x200
    v_mad_u32_u24 v9, v14, s38, v9
    v_bfe_u32 v14, v0, 6, 1
    s_mov_b32 s38, 0x400
    v_mad_u32_u24 v9, v14, s38, v9
    v_bfe_u32 v14, v0, 7, 1
    s_mov_b32 s38, 0x800
    v_mad_u32_u24 v9, v14, s38, v9
    v_mov_b32 v7, 0x8000
    v_bfe_u32 v14, v0, 0, 1
    s_mov_b32 s38, 0x10
    v_mad_u32_u24 v7, v14, s38, v7
    v_bfe_u32 v14, v0, 1, 1
    s_mov_b32 s38, 0x20
    v_mad_u32_u24 v7, v14, s38, v7
    v_bfe_u32 v14, v0, 2, 1
    s_mov_b32 s38, 0x40
    v_mad_u32_u24 v7, v14, s38, v7
    v_bfe_u32 v14, v0, 3, 1
    s_mov_b32 s38, 0x80
    v_mad_u32_u24 v7, v14, s38, v7
    v_bfe_u32 v14, v0, 4, 1
    s_mov_b32 s38, 0x100
    v_mad_u32_u24 v7, v14, s38, v7
    v_bfe_u32 v14, v0, 5, 1
    s_mov_b32 s38, 0x200
    v_mad_u32_u24 v7, v14, s38, v7
    v_bfe_u32 v14, v0, 6, 1
    s_mov_b32 s38, 0x8000
    v_mad_u32_u24 v7, v14, s38, v7
    v_bfe_u32 v14, v0, 7, 1
    s_mov_b32 s38, 0x10000
    v_mad_u32_u24 v7, v14, s38, v7
    v_mov_b32 v3, 0x0
    v_bfe_u32 v14, v0, 0, 1
    s_mov_b32 s38, 0x10
    v_mad_u32_u24 v3, v14, s38, v3
    v_bfe_u32 v14, v0, 1, 1
    s_mov_b32 s38, 0x20
    v_mad_u32_u24 v3, v14, s38, v3
    v_bfe_u32 v14, v0, 2, 1
    s_mov_b32 s38, 0x40
    v_mad_u32_u24 v3, v14, s38, v3
    v_bfe_u32 v14, v0, 3, 1
    s_mov_b32 s38, 0x400
    v_mad_u32_u24 v3, v14, s38, v3
    v_bfe_u32 v14, v0, 4, 1
    s_mov_b32 s38, 0x800
    v_mad_u32_u24 v3, v14, s38, v3
    v_bfe_u32 v14, v0, 5, 1
    s_mov_b32 s38, 0x1000
    v_mad_u32_u24 v3, v14, s38, v3
    v_bfe_u32 v14, v0, 6, 1
    s_mov_b32 s38, 0x2000
    v_mad_u32_u24 v3, v14, s38, v3
    v_bfe_u32 v14, v0, 7, 1
    s_mov_b32 s38, 0x4000
    v_mad_u32_u24 v3, v14, s38, v3
    v_mov_b32 v4, 0x0
    v_bfe_u32 v14, v0, 0, 1
    s_mov_b32 s38, 0x100
    v_mad_u32_u24 v4, v14, s38, v4
    v_bfe_u32 v14, v0, 1, 1
    s_mov_b32 s38, 0x200
    v_mad_u32_u24 v4, v14, s38, v4
    v_bfe_u32 v14, v0, 2, 1
    s_mov_b32 s38, 0x400
    v_mad_u32_u24 v4, v14, s38, v4
    v_bfe_u32 v14, v0, 6, 1
    s_mov_b32 s38, 0x80
    v_mad_u32_u24 v4, v14, s38, v4
    v_bfe_u32 v14, v0, 7, 1
    s_mov_b32 s38, 0x4000
    v_mad_u32_u24 v4, v14, s38, v4
    v_lshrrev_b32 v15, 3, v0
    v_xor_b32 v15, v15, v0
    v_and_b32 v15, 7, v15
    v_lshl_add_u32 v4, v15, 4, v4
    v_bfe_u32 v15, v0, 4, 2
    v_lshlrev_b32 v15, 4, v15
    v_xor_b32 v5, v15, v1
    v_xor_b32 v6, 64, v5
    v_mov_b32 v8, 0x5000
    v_bfe_u32 v14, v0, 0, 1
    s_mov_b32 s38, 0x10
    v_mad_u32_u24 v8, v14, s38, v8
    v_bfe_u32 v14, v0, 1, 1
    s_mov_b32 s38, 0x40
    v_mad_u32_u24 v8, v14, s38, v8
    v_bfe_u32 v14, v0, 2, 1
    s_mov_b32 s38, 0x80
    v_mad_u32_u24 v8, v14, s38, v8
    v_bfe_u32 v14, v0, 4, 1
    s_mov_b32 s38, 0x20
    v_mad_u32_u24 v8, v14, s38, v8
    v_bfe_u32 v14, v0, 5, 1
    s_mov_b32 s38, 0x100
    v_mad_u32_u24 v8, v14, s38, v8
    v_mov_b32 v10, 0x0
    v_bfe_u32 v14, v0, 0, 1
    s_mov_b32 s38, 0x10
    v_mad_u32_u24 v10, v14, s38, v10
    v_bfe_u32 v14, v0, 1, 1
    s_mov_b32 s38, 0x20
    v_mad_u32_u24 v10, v14, s38, v10
    v_bfe_u32 v14, v0, 2, 1
    s_mov_b32 s38, 0x40
    v_mad_u32_u24 v10, v14, s38, v10
    v_bfe_u32 v14, v0, 3, 1
    s_mov_b32 s38, 0x80
    v_mad_u32_u24 v10, v14, s38, v10
    v_bfe_u32 v14, v0, 4, 1
    s_mov_b32 s38, 0x20000
    v_mad_u32_u24 v10, v14, s38, v10
    v_bfe_u32 v14, v0, 5, 1
    s_mov_b32 s38, 0x40000
    v_mad_u32_u24 v10, v14, s38, v10
    v_bfe_u32 v14, v0, 6, 1
    s_mov_b32 s38, 0x100
    v_mad_u32_u24 v10, v14, s38, v10
    v_bfe_u32 v14, v0, 7, 1
    s_mov_b32 s38, 0x200
    v_mad_u32_u24 v10, v14, s38, v10
    v_mov_b32 v11, 0x0
    v_bfe_u32 v14, v0, 0, 1
    s_mov_b32 s38, 0x10
    v_mad_u32_u24 v11, v14, s38, v11
    v_bfe_u32 v14, v0, 1, 1
    s_mov_b32 s38, 0x20
    v_mad_u32_u24 v11, v14, s38, v11
    v_bfe_u32 v14, v0, 2, 1
    s_mov_b32 s38, 0x40
    v_mad_u32_u24 v11, v14, s38, v11
    v_bfe_u32 v14, v0, 3, 1
    s_mov_b32 s38, 0x80
    v_mad_u32_u24 v11, v14, s38, v11
    v_bfe_u32 v14, v0, 4, 1
    s_mov_b32 s38, 0x400
    v_mad_u32_u24 v11, v14, s38, v11
    v_bfe_u32 v14, v0, 5, 1
    s_mov_b32 s38, 0x800
    v_mad_u32_u24 v11, v14, s38, v11
    v_bfe_u32 v14, v0, 6, 1
    s_mov_b32 s38, 0x100
    v_mad_u32_u24 v11, v14, s38, v11
    v_bfe_u32 v14, v0, 7, 1
    s_mov_b32 s38, 0x200
    v_mad_u32_u24 v11, v14, s38, v11
    v_mov_b32 v12, 0x0
    v_bfe_u32 v14, v0, 0, 1
    s_mov_b32 s38, 0x10
    v_mad_u32_u24 v12, v14, s38, v12
    v_bfe_u32 v14, v0, 1, 1
    s_mov_b32 s38, 0x20
    v_mad_u32_u24 v12, v14, s38, v12
    v_bfe_u32 v14, v0, 2, 1
    s_mov_b32 s38, 0x40
    v_mad_u32_u24 v12, v14, s38, v12
    v_bfe_u32 v14, v0, 3, 1
    s_mov_b32 s38, 0x80
    v_mad_u32_u24 v12, v14, s38, v12
    v_bfe_u32 v14, v0, 4, 1
    s_mov_b32 s38, 0x4
    v_mad_u32_u24 v12, v14, s38, v12
    v_bfe_u32 v14, v0, 5, 1
    s_mov_b32 s38, 0x8
    v_mad_u32_u24 v12, v14, s38, v12
    v_bfe_u32 v14, v0, 6, 1
    s_mov_b32 s38, 0x100
    v_mad_u32_u24 v12, v14, s38, v12
    v_bfe_u32 v14, v0, 7, 1
    s_mov_b32 s38, 0x200
    v_mad_u32_u24 v12, v14, s38, v12
    v_mov_b32 v13, 0xf149f2ca
    v_and_b32 v14, 15, v0
    v_bfe_u32 v15, v0, 4, 2
    v_cmp_gt_u32 s[72:73], 2, v15
    v_lshlrev_b32 v15, 2, v15
    v_cmp_le_u32 s[64:65], v15, v14
    v_add_u32 v15, 1, v15
    v_cmp_le_u32 s[66:67], v15, v14
    v_add_u32 v15, 1, v15
    v_cmp_le_u32 s[68:69], v15, v14
    v_add_u32 v15, 1, v15
    v_cmp_le_u32 s[70:71], v15, v14
    v_add_u32 v15, 1, v15
    s_mov_b32 s34, 0x05040100
    s_mov_b32 s35, 0x07060302
    s_mov_b32 s33, 0x3e0293ee
    s_mov_b32 s32, 0
    s_mov_b32 s4, 0x3f803f80
    s_mov_b32 s5, 0x3f803f80
    s_mov_b32 s23, s22
    s_mov_b32 s96, s54
    s_and_b32 s97, s55, 0xffff
    s_mov_b32 s98, 0x400000
    s_mov_b32 s99, 0x20000
    s_lshl_b32 s3, s20, 17
    s_and_b32 s28, s22, 3
    s_lshl_b32 s28, s28, 15
    s_add_u32 s3, s3, s28
    v_lshlrev_b32 v30, 7, v0
    buffer_load_dword v31, v30, s[96:99], s3 offen
    s_lshl_b32 s36, s23, 15
    buffer_load_dwordx4 v[96:99], v3, s[12:15], s36 offen offset:0
    buffer_load_dwordx4 v[100:103], v3, s[12:15], s36 offen offset:128
    buffer_load_dwordx4 v[104:107], v3, s[12:15], s36 offen offset:256
    buffer_load_dwordx4 v[108:111], v3, s[12:15], s36 offen offset:384
    buffer_load_dwordx4 v[112:115], v3, s[12:15], s36 offen offset:512
    buffer_load_dwordx4 v[116:119], v3, s[12:15], s36 offen offset:640
    buffer_load_dwordx4 v[120:123], v3, s[12:15], s36 offen offset:768
    buffer_load_dwordx4 v[124:127], v3, s[12:15], s36 offen offset:896
    s_mov_b32 s76, s52
    s_and_b32 s77, s53, 0xffff
    s_mov_b32 s78, 0x400000
    s_mov_b32 s79, 0x20000
    s_mov_b32 s40, s50
    s_and_b32 s41, s51, 0xffff
    s_mov_b32 s42, 0x400000
    s_mov_b32 s43, 0x20000
    s_mov_b32 s96, s48
    s_and_b32 s97, s49, 0xffff
    s_mov_b32 s98, 0x400000
    s_mov_b32 s99, 0x20000
    v_mov_b32 v16, 0x0
    v_bfe_u32 v14, v0, 0, 1
    s_mov_b32 s38, 0x10
    v_mad_u32_u24 v16, v14, s38, v16
    v_bfe_u32 v14, v0, 1, 1
    s_mov_b32 s38, 0x20
    v_mad_u32_u24 v16, v14, s38, v16
    v_bfe_u32 v14, v0, 2, 1
    s_mov_b32 s38, 0x40
    v_mad_u32_u24 v16, v14, s38, v16
    v_bfe_u32 v14, v0, 3, 1
    s_mov_b32 s38, 0x80
    v_mad_u32_u24 v16, v14, s38, v16
    v_bfe_u32 v14, v0, 4, 1
    s_mov_b32 s38, 0x2000
    v_mad_u32_u24 v16, v14, s38, v16
    v_bfe_u32 v14, v0, 5, 1
    s_mov_b32 s38, 0x4000
    v_mad_u32_u24 v16, v14, s38, v16
    v_bfe_u32 v14, v0, 6, 1
    s_mov_b32 s38, 0x40000
    v_mad_u32_u24 v16, v14, s38, v16
    v_bfe_u32 v14, v0, 7, 1
    s_mov_b32 s38, 0x80000
    v_mad_u32_u24 v16, v14, s38, v16
    v_mov_b32 v28, 0x0
    v_bfe_u32 v14, v0, 4, 1
    s_mov_b32 s38, 0x20
    v_mad_u32_u24 v28, v14, s38, v28
    v_bfe_u32 v14, v0, 5, 1
    s_mov_b32 s38, 0x40
    v_mad_u32_u24 v28, v14, s38, v28
    v_xor_b32 v16, v16, v28
    v_xor_b32 v17, 0, v16
    v_xor_b32 v18, 128, v16
    v_xor_b32 v19, 128, v16
    v_mov_b32 v20, 0x0
    v_bfe_u32 v14, v0, 0, 1
    s_mov_b32 s38, 0x8
    v_mad_u32_u24 v20, v14, s38, v20
    v_bfe_u32 v14, v0, 1, 1
    s_mov_b32 s38, 0x10
    v_mad_u32_u24 v20, v14, s38, v20
    v_bfe_u32 v14, v0, 2, 1
    s_mov_b32 s38, 0x100
    v_mad_u32_u24 v20, v14, s38, v20
    v_bfe_u32 v14, v0, 3, 1
    s_mov_b32 s38, 0x200
    v_mad_u32_u24 v20, v14, s38, v20
    v_bfe_u32 v14, v0, 4, 1
    s_mov_b32 s38, 0x800
    v_mad_u32_u24 v20, v14, s38, v20
    v_bfe_u32 v14, v0, 5, 1
    s_mov_b32 s38, 0x1000
    v_mad_u32_u24 v20, v14, s38, v20
    v_mov_b32 v28, 0x0
    v_bfe_u32 v14, v0, 2, 1
    s_mov_b32 s38, 0x20
    v_mad_u32_u24 v28, v14, s38, v28
    v_bfe_u32 v14, v0, 3, 1
    s_mov_b32 s38, 0x40
    v_mad_u32_u24 v28, v14, s38, v28
    v_bfe_u32 v14, v0, 4, 1
    s_mov_b32 s38, 0x80
    v_mad_u32_u24 v28, v14, s38, v28
    v_mov_b32 v29, 0x0
    v_bfe_u32 v14, v0, 6, 1
    s_mov_b32 s38, 0x40
    v_mad_u32_u24 v29, v14, s38, v29
    v_bfe_u32 v14, v0, 7, 1
    s_mov_b32 s38, 0x80
    v_mad_u32_u24 v29, v14, s38, v29
    v_xor_b32 v28, v28, v29
    v_add_u32 v28, v28, v20
    v_add_u32 v20, 0x8000, v28
    v_xor_b32 v21, 32, v20
    v_add_u32 v22, 0x10000, v28
    v_xor_b32 v23, 32, v22
    v_add_u32 v24, 0x18000, v28
    v_xor_b32 v25, 32, v24
    v_add_u32 v26, 0x20000, v28
    v_xor_b32 v27, 32, v26
    s_add_u32 s28, s21, 1
    s_lshl_b32 s28, s28, 15
    s_lshl_b32 s3, s20, 8
    s_add_u32 m0, s28, 0
    s_add_u32 s37, s3, 0x0
    buffer_load_dwordx4 v16, s[76:79], s37 offen lds
    s_add_u32 m0, s28, 1024
    s_add_u32 s37, s3, 0x8000
    buffer_load_dwordx4 v17, s[76:79], s37 offen lds
    s_add_u32 m0, s28, 2048
    s_add_u32 s37, s3, 0x10000
    buffer_load_dwordx4 v18, s[76:79], s37 offen lds
    s_add_u32 m0, s28, 3072
    s_add_u32 s37, s3, 0x18000
    buffer_load_dwordx4 v19, s[76:79], s37 offen lds
    s_add_u32 m0, s28, 4096
    s_add_u32 s37, s3, 0x20000
    buffer_load_dwordx4 v16, s[76:79], s37 offen lds
    s_add_u32 m0, s28, 5120
    s_add_u32 s37, s3, 0x28000
    buffer_load_dwordx4 v17, s[76:79], s37 offen lds
    s_add_u32 m0, s28, 6144
    s_add_u32 s37, s3, 0x30000
    buffer_load_dwordx4 v18, s[76:79], s37 offen lds
    s_add_u32 m0, s28, 7168
    s_add_u32 s37, s3, 0x38000
    buffer_load_dwordx4 v19, s[76:79], s37 offen lds
    s_add_u32 m0, s28, 8192
    s_add_u32 s37, s3, 0x100000
    buffer_load_dwordx4 v16, s[76:79], s37 offen lds
    s_add_u32 m0, s28, 9216
    s_add_u32 s37, s3, 0x108000
    buffer_load_dwordx4 v17, s[76:79], s37 offen lds
    s_add_u32 m0, s28, 10240
    s_add_u32 s37, s3, 0x110000
    buffer_load_dwordx4 v18, s[76:79], s37 offen lds
    s_add_u32 m0, s28, 11264
    s_add_u32 s37, s3, 0x118000
    buffer_load_dwordx4 v19, s[76:79], s37 offen lds
    s_add_u32 m0, s28, 12288
    s_add_u32 s37, s3, 0x120000
    buffer_load_dwordx4 v16, s[76:79], s37 offen lds
    s_add_u32 m0, s28, 13312
    s_add_u32 s37, s3, 0x128000
    buffer_load_dwordx4 v17, s[76:79], s37 offen lds
    s_add_u32 m0, s28, 14336
    s_add_u32 s37, s3, 0x130000
    buffer_load_dwordx4 v18, s[76:79], s37 offen lds
    s_add_u32 m0, s28, 15360
    s_add_u32 s37, s3, 0x138000
    buffer_load_dwordx4 v19, s[76:79], s37 offen lds
    s_add_u32 m0, s28, 16384
    s_add_u32 s37, s3, 0x200000
    buffer_load_dwordx4 v16, s[76:79], s37 offen lds
    s_add_u32 m0, s28, 17408
    s_add_u32 s37, s3, 0x208000
    buffer_load_dwordx4 v17, s[76:79], s37 offen lds
    s_add_u32 m0, s28, 18432
    s_add_u32 s37, s3, 0x210000
    buffer_load_dwordx4 v18, s[76:79], s37 offen lds
    s_add_u32 m0, s28, 19456
    s_add_u32 s37, s3, 0x218000
    buffer_load_dwordx4 v19, s[76:79], s37 offen lds
    s_add_u32 m0, s28, 20480
    s_add_u32 s37, s3, 0x220000
    buffer_load_dwordx4 v16, s[76:79], s37 offen lds
    s_add_u32 m0, s28, 21504
    s_add_u32 s37, s3, 0x228000
    buffer_load_dwordx4 v17, s[76:79], s37 offen lds
    s_add_u32 m0, s28, 22528
    s_add_u32 s37, s3, 0x230000
    buffer_load_dwordx4 v18, s[76:79], s37 offen lds
    s_add_u32 m0, s28, 23552
    s_add_u32 s37, s3, 0x238000
    buffer_load_dwordx4 v19, s[76:79], s37 offen lds
    s_waitcnt vmcnt(16)
    s_barrier
    ds_read_b64_tr_b16 v[128:129], v20 offset:0
    ds_read_b64_tr_b16 v[130:131], v20 offset:1024
    ds_read_b64_tr_b16 v[132:133], v21 offset:0
    ds_read_b64_tr_b16 v[134:135], v21 offset:1024
    ds_read_b64_tr_b16 v[136:137], v22 offset:0
    ds_read_b64_tr_b16 v[138:139], v22 offset:1024
    ds_read_b64_tr_b16 v[140:141], v23 offset:0
    ds_read_b64_tr_b16 v[142:143], v23 offset:1024
    ds_read_b64_tr_b16 v[144:145], v24 offset:0
    ds_read_b64_tr_b16 v[146:147], v24 offset:1024
    ds_read_b64_tr_b16 v[148:149], v25 offset:0
    ds_read_b64_tr_b16 v[150:151], v25 offset:1024
    s_waitcnt lgkmcnt(4)
    ds_read_b64_tr_b16 v[152:153], v26 offset:0
    ds_read_b64_tr_b16 v[154:155], v26 offset:1024
    ds_read_b64_tr_b16 v[156:157], v27 offset:0
    ds_read_b64_tr_b16 v[158:159], v27 offset:1024
    s_waitcnt lgkmcnt(0)
    s_barrier
    s_add_u32 m0, s28, 0
    s_add_u32 s37, s3, 0x300000
    buffer_load_dwordx4 v16, s[76:79], s37 offen lds
    s_add_u32 m0, s28, 1024
    s_add_u32 s37, s3, 0x308000
    buffer_load_dwordx4 v17, s[76:79], s37 offen lds
    s_add_u32 m0, s28, 2048
    s_add_u32 s37, s3, 0x310000
    buffer_load_dwordx4 v18, s[76:79], s37 offen lds
    s_add_u32 m0, s28, 3072
    s_add_u32 s37, s3, 0x318000
    buffer_load_dwordx4 v19, s[76:79], s37 offen lds
    s_add_u32 m0, s28, 4096
    s_add_u32 s37, s3, 0x320000
    buffer_load_dwordx4 v16, s[76:79], s37 offen lds
    s_add_u32 m0, s28, 5120
    s_add_u32 s37, s3, 0x328000
    buffer_load_dwordx4 v17, s[76:79], s37 offen lds
    s_add_u32 m0, s28, 6144
    s_add_u32 s37, s3, 0x330000
    buffer_load_dwordx4 v18, s[76:79], s37 offen lds
    s_add_u32 m0, s28, 7168
    s_add_u32 s37, s3, 0x338000
    buffer_load_dwordx4 v19, s[76:79], s37 offen lds
    s_waitcnt vmcnt(16)
    s_barrier
    ds_read_b64_tr_b16 v[160:161], v20 offset:8192
    ds_read_b64_tr_b16 v[162:163], v20 offset:9216
    ds_read_b64_tr_b16 v[164:165], v21 offset:8192
    ds_read_b64_tr_b16 v[166:167], v21 offset:9216
    ds_read_b64_tr_b16 v[168:169], v22 offset:8192
    ds_read_b64_tr_b16 v[170:171], v22 offset:9216
    ds_read_b64_tr_b16 v[172:173], v23 offset:8192
    ds_read_b64_tr_b16 v[174:175], v23 offset:9216
    ds_read_b64_tr_b16 v[176:177], v24 offset:8192
    ds_read_b64_tr_b16 v[178:179], v24 offset:9216
    ds_read_b64_tr_b16 v[180:181], v25 offset:8192
    ds_read_b64_tr_b16 v[182:183], v25 offset:9216
    s_waitcnt lgkmcnt(4)
    ds_read_b64_tr_b16 v[184:185], v26 offset:8192
    ds_read_b64_tr_b16 v[186:187], v26 offset:9216
    ds_read_b64_tr_b16 v[188:189], v27 offset:8192
    ds_read_b64_tr_b16 v[190:191], v27 offset:9216
    s_waitcnt lgkmcnt(0)
    s_barrier
    s_add_u32 m0, s28, 8192
    s_add_u32 s37, s3, 0x0
    buffer_load_dwordx4 v16, s[40:43], s37 offen lds
    s_add_u32 m0, s28, 9216
    s_add_u32 s37, s3, 0x8000
    buffer_load_dwordx4 v17, s[40:43], s37 offen lds
    s_add_u32 m0, s28, 10240
    s_add_u32 s37, s3, 0x10000
    buffer_load_dwordx4 v18, s[40:43], s37 offen lds
    s_add_u32 m0, s28, 11264
    s_add_u32 s37, s3, 0x18000
    buffer_load_dwordx4 v19, s[40:43], s37 offen lds
    s_add_u32 m0, s28, 12288
    s_add_u32 s37, s3, 0x20000
    buffer_load_dwordx4 v16, s[40:43], s37 offen lds
    s_add_u32 m0, s28, 13312
    s_add_u32 s37, s3, 0x28000
    buffer_load_dwordx4 v17, s[40:43], s37 offen lds
    s_add_u32 m0, s28, 14336
    s_add_u32 s37, s3, 0x30000
    buffer_load_dwordx4 v18, s[40:43], s37 offen lds
    s_add_u32 m0, s28, 15360
    s_add_u32 s37, s3, 0x38000
    buffer_load_dwordx4 v19, s[40:43], s37 offen lds
    s_waitcnt vmcnt(16)
    s_barrier
    ds_read_b64_tr_b16 v[192:193], v20 offset:16384
    ds_read_b64_tr_b16 v[194:195], v20 offset:17408
    ds_read_b64_tr_b16 v[196:197], v21 offset:16384
    ds_read_b64_tr_b16 v[198:199], v21 offset:17408
    ds_read_b64_tr_b16 v[200:201], v22 offset:16384
    ds_read_b64_tr_b16 v[202:203], v22 offset:17408
    ds_read_b64_tr_b16 v[204:205], v23 offset:16384
    ds_read_b64_tr_b16 v[206:207], v23 offset:17408
    ds_read_b64_tr_b16 v[208:209], v24 offset:16384
    ds_read_b64_tr_b16 v[210:211], v24 offset:17408
    ds_read_b64_tr_b16 v[212:213], v25 offset:16384
    ds_read_b64_tr_b16 v[214:215], v25 offset:17408
    s_waitcnt lgkmcnt(4)
    ds_read_b64_tr_b16 v[216:217], v26 offset:16384
    ds_read_b64_tr_b16 v[218:219], v26 offset:17408
    ds_read_b64_tr_b16 v[220:221], v27 offset:16384
    ds_read_b64_tr_b16 v[222:223], v27 offset:17408
    s_waitcnt lgkmcnt(0)
    s_barrier
    s_add_u32 m0, s28, 16384
    s_add_u32 s37, s3, 0x100000
    buffer_load_dwordx4 v16, s[40:43], s37 offen lds
    s_add_u32 m0, s28, 17408
    s_add_u32 s37, s3, 0x108000
    buffer_load_dwordx4 v17, s[40:43], s37 offen lds
    s_add_u32 m0, s28, 18432
    s_add_u32 s37, s3, 0x110000
    buffer_load_dwordx4 v18, s[40:43], s37 offen lds
    s_add_u32 m0, s28, 19456
    s_add_u32 s37, s3, 0x118000
    buffer_load_dwordx4 v19, s[40:43], s37 offen lds
    s_add_u32 m0, s28, 20480
    s_add_u32 s37, s3, 0x120000
    buffer_load_dwordx4 v16, s[40:43], s37 offen lds
    s_add_u32 m0, s28, 21504
    s_add_u32 s37, s3, 0x128000
    buffer_load_dwordx4 v17, s[40:43], s37 offen lds
    s_add_u32 m0, s28, 22528
    s_add_u32 s37, s3, 0x130000
    buffer_load_dwordx4 v18, s[40:43], s37 offen lds
    s_add_u32 m0, s28, 23552
    s_add_u32 s37, s3, 0x138000
    buffer_load_dwordx4 v19, s[40:43], s37 offen lds
    s_waitcnt vmcnt(16)
    s_barrier
    ds_read_b64_tr_b16 v[224:225], v20 offset:0
    ds_read_b64_tr_b16 v[226:227], v20 offset:1024
    ds_read_b64_tr_b16 v[228:229], v21 offset:0
    ds_read_b64_tr_b16 v[230:231], v21 offset:1024
    ds_read_b64_tr_b16 v[232:233], v22 offset:0
    ds_read_b64_tr_b16 v[234:235], v22 offset:1024
    ds_read_b64_tr_b16 v[236:237], v23 offset:0
    ds_read_b64_tr_b16 v[238:239], v23 offset:1024
    ds_read_b64_tr_b16 v[240:241], v24 offset:0
    ds_read_b64_tr_b16 v[242:243], v24 offset:1024
    ds_read_b64_tr_b16 v[244:245], v25 offset:0
    ds_read_b64_tr_b16 v[246:247], v25 offset:1024
    s_waitcnt lgkmcnt(4)
    ds_read_b64_tr_b16 v[248:249], v26 offset:0
    ds_read_b64_tr_b16 v[250:251], v26 offset:1024
    ds_read_b64_tr_b16 v[252:253], v27 offset:0
    ds_read_b64_tr_b16 v[254:255], v27 offset:1024
    s_waitcnt lgkmcnt(0)
    s_barrier
    s_add_u32 m0, s28, 0
    s_add_u32 s37, s3, 0x200000
    buffer_load_dwordx4 v16, s[40:43], s37 offen lds
    s_add_u32 m0, s28, 1024
    s_add_u32 s37, s3, 0x208000
    buffer_load_dwordx4 v17, s[40:43], s37 offen lds
    s_add_u32 m0, s28, 2048
    s_add_u32 s37, s3, 0x210000
    buffer_load_dwordx4 v18, s[40:43], s37 offen lds
    s_add_u32 m0, s28, 3072
    s_add_u32 s37, s3, 0x218000
    buffer_load_dwordx4 v19, s[40:43], s37 offen lds
    s_add_u32 m0, s28, 4096
    s_add_u32 s37, s3, 0x220000
    buffer_load_dwordx4 v16, s[40:43], s37 offen lds
    s_add_u32 m0, s28, 5120
    s_add_u32 s37, s3, 0x228000
    buffer_load_dwordx4 v17, s[40:43], s37 offen lds
    s_add_u32 m0, s28, 6144
    s_add_u32 s37, s3, 0x230000
    buffer_load_dwordx4 v18, s[40:43], s37 offen lds
    s_add_u32 m0, s28, 7168
    s_add_u32 s37, s3, 0x238000
    buffer_load_dwordx4 v19, s[40:43], s37 offen lds
    s_waitcnt vmcnt(16)
    s_barrier
    ds_read_b64_tr_b16 a[128:129], v20 offset:8192
    ds_read_b64_tr_b16 a[130:131], v20 offset:9216
    ds_read_b64_tr_b16 a[132:133], v21 offset:8192
    ds_read_b64_tr_b16 a[134:135], v21 offset:9216
    ds_read_b64_tr_b16 a[136:137], v22 offset:8192
    ds_read_b64_tr_b16 a[138:139], v22 offset:9216
    ds_read_b64_tr_b16 a[140:141], v23 offset:8192
    ds_read_b64_tr_b16 a[142:143], v23 offset:9216
    ds_read_b64_tr_b16 a[144:145], v24 offset:8192
    ds_read_b64_tr_b16 a[146:147], v24 offset:9216
    ds_read_b64_tr_b16 a[148:149], v25 offset:8192
    ds_read_b64_tr_b16 a[150:151], v25 offset:9216
    s_waitcnt lgkmcnt(4)
    ds_read_b64_tr_b16 a[152:153], v26 offset:8192
    ds_read_b64_tr_b16 a[154:155], v26 offset:9216
    ds_read_b64_tr_b16 a[156:157], v27 offset:8192
    ds_read_b64_tr_b16 a[158:159], v27 offset:9216
    s_waitcnt lgkmcnt(0)
    s_barrier
    s_add_u32 m0, s28, 8192
    s_add_u32 s37, s3, 0x300000
    buffer_load_dwordx4 v16, s[40:43], s37 offen lds
    s_add_u32 m0, s28, 9216
    s_add_u32 s37, s3, 0x308000
    buffer_load_dwordx4 v17, s[40:43], s37 offen lds
    s_add_u32 m0, s28, 10240
    s_add_u32 s37, s3, 0x310000
    buffer_load_dwordx4 v18, s[40:43], s37 offen lds
    s_add_u32 m0, s28, 11264
    s_add_u32 s37, s3, 0x318000
    buffer_load_dwordx4 v19, s[40:43], s37 offen lds
    s_add_u32 m0, s28, 12288
    s_add_u32 s37, s3, 0x320000
    buffer_load_dwordx4 v16, s[40:43], s37 offen lds
    s_add_u32 m0, s28, 13312
    s_add_u32 s37, s3, 0x328000
    buffer_load_dwordx4 v17, s[40:43], s37 offen lds
    s_add_u32 m0, s28, 14336
    s_add_u32 s37, s3, 0x330000
    buffer_load_dwordx4 v18, s[40:43], s37 offen lds
    s_add_u32 m0, s28, 15360
    s_add_u32 s37, s3, 0x338000
    buffer_load_dwordx4 v19, s[40:43], s37 offen lds
    s_waitcnt vmcnt(16)
    s_barrier
    ds_read_b64_tr_b16 a[160:161], v20 offset:16384
    ds_read_b64_tr_b16 a[162:163], v20 offset:17408
    ds_read_b64_tr_b16 a[164:165], v21 offset:16384
    ds_read_b64_tr_b16 a[166:167], v21 offset:17408
    ds_read_b64_tr_b16 a[168:169], v22 offset:16384
    ds_read_b64_tr_b16 a[170:171], v22 offset:17408
    ds_read_b64_tr_b16 a[172:173], v23 offset:16384
    ds_read_b64_tr_b16 a[174:175], v23 offset:17408
    ds_read_b64_tr_b16 a[176:177], v24 offset:16384
    ds_read_b64_tr_b16 a[178:179], v24 offset:17408
    ds_read_b64_tr_b16 a[180:181], v25 offset:16384
    ds_read_b64_tr_b16 a[182:183], v25 offset:17408
    s_waitcnt lgkmcnt(4)
    ds_read_b64_tr_b16 a[184:185], v26 offset:16384
    ds_read_b64_tr_b16 a[186:187], v26 offset:17408
    ds_read_b64_tr_b16 a[188:189], v27 offset:16384
    ds_read_b64_tr_b16 a[190:191], v27 offset:17408
    s_waitcnt lgkmcnt(0)
    s_barrier
    s_add_u32 m0, s28, 16384
    s_add_u32 s37, s3, 0x0
    buffer_load_dwordx4 v16, s[96:99], s37 offen lds
    s_add_u32 m0, s28, 17408
    s_add_u32 s37, s3, 0x8000
    buffer_load_dwordx4 v17, s[96:99], s37 offen lds
    s_add_u32 m0, s28, 18432
    s_add_u32 s37, s3, 0x10000
    buffer_load_dwordx4 v18, s[96:99], s37 offen lds
    s_add_u32 m0, s28, 19456
    s_add_u32 s37, s3, 0x18000
    buffer_load_dwordx4 v19, s[96:99], s37 offen lds
    s_add_u32 m0, s28, 20480
    s_add_u32 s37, s3, 0x20000
    buffer_load_dwordx4 v16, s[96:99], s37 offen lds
    s_add_u32 m0, s28, 21504
    s_add_u32 s37, s3, 0x28000
    buffer_load_dwordx4 v17, s[96:99], s37 offen lds
    s_add_u32 m0, s28, 22528
    s_add_u32 s37, s3, 0x30000
    buffer_load_dwordx4 v18, s[96:99], s37 offen lds
    s_add_u32 m0, s28, 23552
    s_add_u32 s37, s3, 0x38000
    buffer_load_dwordx4 v19, s[96:99], s37 offen lds
    s_waitcnt vmcnt(16)
    s_barrier
    ds_read_b64_tr_b16 a[192:193], v20 offset:0
    ds_read_b64_tr_b16 a[194:195], v20 offset:1024
    ds_read_b64_tr_b16 a[196:197], v21 offset:0
    ds_read_b64_tr_b16 a[198:199], v21 offset:1024
    ds_read_b64_tr_b16 a[200:201], v22 offset:0
    ds_read_b64_tr_b16 a[202:203], v22 offset:1024
    ds_read_b64_tr_b16 a[204:205], v23 offset:0
    ds_read_b64_tr_b16 a[206:207], v23 offset:1024
    ds_read_b64_tr_b16 a[208:209], v24 offset:0
    ds_read_b64_tr_b16 a[210:211], v24 offset:1024
    ds_read_b64_tr_b16 a[212:213], v25 offset:0
    ds_read_b64_tr_b16 a[214:215], v25 offset:1024
    s_waitcnt lgkmcnt(4)
    ds_read_b64_tr_b16 a[216:217], v26 offset:0
    ds_read_b64_tr_b16 a[218:219], v26 offset:1024
    ds_read_b64_tr_b16 a[220:221], v27 offset:0
    ds_read_b64_tr_b16 a[222:223], v27 offset:1024
    s_waitcnt lgkmcnt(0)
    s_barrier
    s_add_u32 m0, s28, 0
    s_add_u32 s37, s3, 0x100000
    buffer_load_dwordx4 v16, s[96:99], s37 offen lds
    s_add_u32 m0, s28, 1024
    s_add_u32 s37, s3, 0x108000
    buffer_load_dwordx4 v17, s[96:99], s37 offen lds
    s_add_u32 m0, s28, 2048
    s_add_u32 s37, s3, 0x110000
    buffer_load_dwordx4 v18, s[96:99], s37 offen lds
    s_add_u32 m0, s28, 3072
    s_add_u32 s37, s3, 0x118000
    buffer_load_dwordx4 v19, s[96:99], s37 offen lds
    s_add_u32 m0, s28, 4096
    s_add_u32 s37, s3, 0x120000
    buffer_load_dwordx4 v16, s[96:99], s37 offen lds
    s_add_u32 m0, s28, 5120
    s_add_u32 s37, s3, 0x128000
    buffer_load_dwordx4 v17, s[96:99], s37 offen lds
    s_add_u32 m0, s28, 6144
    s_add_u32 s37, s3, 0x130000
    buffer_load_dwordx4 v18, s[96:99], s37 offen lds
    s_add_u32 m0, s28, 7168
    s_add_u32 s37, s3, 0x138000
    buffer_load_dwordx4 v19, s[96:99], s37 offen lds
    s_waitcnt vmcnt(16)
    s_barrier
    ds_read_b64_tr_b16 a[224:225], v20 offset:8192
    ds_read_b64_tr_b16 a[226:227], v20 offset:9216
    ds_read_b64_tr_b16 a[228:229], v21 offset:8192
    ds_read_b64_tr_b16 a[230:231], v21 offset:9216
    ds_read_b64_tr_b16 a[232:233], v22 offset:8192
    ds_read_b64_tr_b16 a[234:235], v22 offset:9216
    ds_read_b64_tr_b16 a[236:237], v23 offset:8192
    ds_read_b64_tr_b16 a[238:239], v23 offset:9216
    ds_read_b64_tr_b16 a[240:241], v24 offset:8192
    ds_read_b64_tr_b16 a[242:243], v24 offset:9216
    ds_read_b64_tr_b16 a[244:245], v25 offset:8192
    ds_read_b64_tr_b16 a[246:247], v25 offset:9216
    s_waitcnt lgkmcnt(4)
    ds_read_b64_tr_b16 a[248:249], v26 offset:8192
    ds_read_b64_tr_b16 a[250:251], v26 offset:9216
    ds_read_b64_tr_b16 a[252:253], v27 offset:8192
    ds_read_b64_tr_b16 a[254:255], v27 offset:9216
    s_waitcnt lgkmcnt(0)
    s_barrier
    s_add_u32 m0, s28, 8192
    s_add_u32 s37, s3, 0x200000
    buffer_load_dwordx4 v16, s[96:99], s37 offen lds
    s_add_u32 m0, s28, 9216
    s_add_u32 s37, s3, 0x208000
    buffer_load_dwordx4 v17, s[96:99], s37 offen lds
    s_add_u32 m0, s28, 10240
    s_add_u32 s37, s3, 0x210000
    buffer_load_dwordx4 v18, s[96:99], s37 offen lds
    s_add_u32 m0, s28, 11264
    s_add_u32 s37, s3, 0x218000
    buffer_load_dwordx4 v19, s[96:99], s37 offen lds
    s_add_u32 m0, s28, 12288
    s_add_u32 s37, s3, 0x220000
    buffer_load_dwordx4 v16, s[96:99], s37 offen lds
    s_add_u32 m0, s28, 13312
    s_add_u32 s37, s3, 0x228000
    buffer_load_dwordx4 v17, s[96:99], s37 offen lds
    s_add_u32 m0, s28, 14336
    s_add_u32 s37, s3, 0x230000
    buffer_load_dwordx4 v18, s[96:99], s37 offen lds
    s_add_u32 m0, s28, 15360
    s_add_u32 s37, s3, 0x238000
    buffer_load_dwordx4 v19, s[96:99], s37 offen lds
    s_waitcnt vmcnt(16)
    s_barrier
    ds_read_b64_tr_b16 a[0:1], v20 offset:16384
    ds_read_b64_tr_b16 a[2:3], v20 offset:17408
    ds_read_b64_tr_b16 a[4:5], v21 offset:16384
    ds_read_b64_tr_b16 a[6:7], v21 offset:17408
    ds_read_b64_tr_b16 a[8:9], v22 offset:16384
    ds_read_b64_tr_b16 a[10:11], v22 offset:17408
    ds_read_b64_tr_b16 a[12:13], v23 offset:16384
    ds_read_b64_tr_b16 a[14:15], v23 offset:17408
    ds_read_b64_tr_b16 a[16:17], v24 offset:16384
    ds_read_b64_tr_b16 a[18:19], v24 offset:17408
    ds_read_b64_tr_b16 a[20:21], v25 offset:16384
    ds_read_b64_tr_b16 a[22:23], v25 offset:17408
    s_waitcnt lgkmcnt(4)
    ds_read_b64_tr_b16 a[24:25], v26 offset:16384
    ds_read_b64_tr_b16 a[26:27], v26 offset:17408
    ds_read_b64_tr_b16 a[28:29], v27 offset:16384
    ds_read_b64_tr_b16 a[30:31], v27 offset:17408
    s_waitcnt lgkmcnt(0)
    s_barrier
    s_add_u32 m0, s28, 16384
    s_add_u32 s37, s3, 0x300000
    buffer_load_dwordx4 v16, s[96:99], s37 offen lds
    s_add_u32 m0, s28, 17408
    s_add_u32 s37, s3, 0x308000
    buffer_load_dwordx4 v17, s[96:99], s37 offen lds
    s_add_u32 m0, s28, 18432
    s_add_u32 s37, s3, 0x310000
    buffer_load_dwordx4 v18, s[96:99], s37 offen lds
    s_add_u32 m0, s28, 19456
    s_add_u32 s37, s3, 0x318000
    buffer_load_dwordx4 v19, s[96:99], s37 offen lds
    s_add_u32 m0, s28, 20480
    s_add_u32 s37, s3, 0x320000
    buffer_load_dwordx4 v16, s[96:99], s37 offen lds
    s_add_u32 m0, s28, 21504
    s_add_u32 s37, s3, 0x328000
    buffer_load_dwordx4 v17, s[96:99], s37 offen lds
    s_add_u32 m0, s28, 22528
    s_add_u32 s37, s3, 0x330000
    buffer_load_dwordx4 v18, s[96:99], s37 offen lds
    s_add_u32 m0, s28, 23552
    s_add_u32 s37, s3, 0x338000
    buffer_load_dwordx4 v19, s[96:99], s37 offen lds
    s_waitcnt vmcnt(16)
    s_barrier
    ds_read_b64_tr_b16 a[32:33], v20 offset:0
    ds_read_b64_tr_b16 a[34:35], v20 offset:1024
    ds_read_b64_tr_b16 a[36:37], v21 offset:0
    ds_read_b64_tr_b16 a[38:39], v21 offset:1024
    ds_read_b64_tr_b16 a[40:41], v22 offset:0
    ds_read_b64_tr_b16 a[42:43], v22 offset:1024
    ds_read_b64_tr_b16 a[44:45], v23 offset:0
    ds_read_b64_tr_b16 a[46:47], v23 offset:1024
    ds_read_b64_tr_b16 a[48:49], v24 offset:0
    ds_read_b64_tr_b16 a[50:51], v24 offset:1024
    ds_read_b64_tr_b16 a[52:53], v25 offset:0
    ds_read_b64_tr_b16 a[54:55], v25 offset:1024
    s_waitcnt lgkmcnt(4)
    ds_read_b64_tr_b16 a[56:57], v26 offset:0
    ds_read_b64_tr_b16 a[58:59], v26 offset:1024
    ds_read_b64_tr_b16 a[60:61], v27 offset:0
    ds_read_b64_tr_b16 a[62:63], v27 offset:1024
    s_waitcnt lgkmcnt(0)
    s_barrier
    s_waitcnt vmcnt(8)
    s_barrier
    ds_read_b64_tr_b16 a[64:65], v20 offset:8192
    ds_read_b64_tr_b16 a[66:67], v20 offset:9216
    ds_read_b64_tr_b16 a[68:69], v21 offset:8192
    ds_read_b64_tr_b16 a[70:71], v21 offset:9216
    ds_read_b64_tr_b16 a[72:73], v22 offset:8192
    ds_read_b64_tr_b16 a[74:75], v22 offset:9216
    ds_read_b64_tr_b16 a[76:77], v23 offset:8192
    ds_read_b64_tr_b16 a[78:79], v23 offset:9216
    ds_read_b64_tr_b16 a[80:81], v24 offset:8192
    ds_read_b64_tr_b16 a[82:83], v24 offset:9216
    ds_read_b64_tr_b16 a[84:85], v25 offset:8192
    ds_read_b64_tr_b16 a[86:87], v25 offset:9216
    s_waitcnt lgkmcnt(4)
    ds_read_b64_tr_b16 a[88:89], v26 offset:8192
    ds_read_b64_tr_b16 a[90:91], v26 offset:9216
    ds_read_b64_tr_b16 a[92:93], v27 offset:8192
    ds_read_b64_tr_b16 a[94:95], v27 offset:9216
    s_waitcnt lgkmcnt(0)
    s_barrier
    s_waitcnt vmcnt(0)
    s_barrier
    ds_read_b64_tr_b16 a[96:97], v20 offset:16384
    ds_read_b64_tr_b16 a[98:99], v20 offset:17408
    ds_read_b64_tr_b16 a[100:101], v21 offset:16384
    ds_read_b64_tr_b16 a[102:103], v21 offset:17408
    ds_read_b64_tr_b16 a[104:105], v22 offset:16384
    ds_read_b64_tr_b16 a[106:107], v22 offset:17408
    ds_read_b64_tr_b16 a[108:109], v23 offset:16384
    ds_read_b64_tr_b16 a[110:111], v23 offset:17408
    ds_read_b64_tr_b16 a[112:113], v24 offset:16384
    ds_read_b64_tr_b16 a[114:115], v24 offset:17408
    ds_read_b64_tr_b16 a[116:117], v25 offset:16384
    ds_read_b64_tr_b16 a[118:119], v25 offset:17408
    s_waitcnt lgkmcnt(4)
    ds_read_b64_tr_b16 a[120:121], v26 offset:16384
    ds_read_b64_tr_b16 a[122:123], v26 offset:17408
    ds_read_b64_tr_b16 a[124:125], v27 offset:16384
    ds_read_b64_tr_b16 a[126:127], v27 offset:17408
    s_waitcnt lgkmcnt(0)
    s_barrier
    v_lshrrev_b32 v15, 2, v1
    v_and_b32 v15, 127, v15
L_WHS:
    buffer_load_dword v14, v15, s[16:19], 0 offen offset:128 sc1
    s_add_u32 s32, s32, 1
    s_cmp_gt_u32 s32, 200000
    s_cbranch_scc1 L_WHS_done
    s_waitcnt vmcnt(0)
    v_cmp_eq_u32 vcc, 0, v14
    s_cbranch_vccnz L_WHS
L_WHS_done:
    s_lshr_b32 s36, s21, 1
    s_lshl_b32 s36, s36, 14
    s_xor_b32 s37, s36, 16384
    v_add_u32 v80, s36, v5
    v_add_u32 v81, s37, v5
    v_add_u32 v82, s36, v6
    v_add_u32 v83, s37, v6
    s_mov_b32 s25, 0x40000000
L_P1:
    s_waitcnt vmcnt(6)
    v_mov_b32 v16, 0
    v_mov_b32 v17, 0
    v_dot2_f32_bf16 v16, v96, s4, v16
    v_dot2_f32_bf16 v17, v96, v96, v17
    v_dot2_f32_bf16 v16, v97, s4, v16
    v_dot2_f32_bf16 v17, v97, v97, v17
    v_dot2_f32_bf16 v16, v98, s4, v16
    v_dot2_f32_bf16 v17, v98, v98, v17
    v_dot2_f32_bf16 v16, v99, s4, v16
    v_dot2_f32_bf16 v17, v99, v99, v17
    v_dot2_f32_bf16 v16, v100, s4, v16
    v_dot2_f32_bf16 v17, v100, v100, v17
    v_dot2_f32_bf16 v16, v101, s4, v16
    v_dot2_f32_bf16 v17, v101, v101, v17
    v_dot2_f32_bf16 v16, v102, s4, v16
    v_dot2_f32_bf16 v17, v102, v102, v17
    v_dot2_f32_bf16 v16, v103, s4, v16
    v_dot2_f32_bf16 v17, v103, v103, v17
    v_dot2_f32_bf16 v16, v104, s4, v16
    v_dot2_f32_bf16 v17, v104, v104, v17
    v_dot2_f32_bf16 v16, v105, s4, v16
    v_dot2_f32_bf16 v17, v105, v105, v17
    v_dot2_f32_bf16 v16, v106, s4, v16
    v_dot2_f32_bf16 v17, v106, v106, v17
    v_dot2_f32_bf16 v16, v107, s4, v16
    v_dot2_f32_bf16 v17, v107, v107, v17
    v_dot2_f32_bf16 v16, v108, s4, v16
    v_dot2_f32_bf16 v17, v108, v108, v17
    v_dot2_f32_bf16 v16, v109, s4, v16
    v_dot2_f32_bf16 v17, v109, v109, v17
    v_dot2_f32_bf16 v16, v110, s4, v16
    v_dot2_f32_bf16 v17, v110, v110, v17
    v_dot2_f32_bf16 v16, v111, s4, v16
    v_dot2_f32_bf16 v17, v111, v111, v17
    v_dot2_f32_bf16 v16, v112, s4, v16
    v_dot2_f32_bf16 v17, v112, v112, v17
    v_dot2_f32_bf16 v16, v113, s4, v16
    v_dot2_f32_bf16 v17, v113, v113, v17
    v_dot2_f32_bf16 v16, v114, s4, v16
    v_dot2_f32_bf16 v17, v114, v114, v17
    v_dot2_f32_bf16 v16, v115, s4, v16
    v_dot2_f32_bf16 v17, v115, v115, v17
    v_dot2_f32_bf16 v16, v116, s4, v16
    v_dot2_f32_bf16 v17, v116, v116, v17
    v_dot2_f32_bf16 v16, v117, s4, v16
    v_dot2_f32_bf16 v17, v117, v117, v17
    v_dot2_f32_bf16 v16, v118, s4, v16
    v_dot2_f32_bf16 v17, v118, v118, v17
    v_dot2_f32_bf16 v16, v119, s4, v16
    v_dot2_f32_bf16 v17, v119, v119, v17
    v_dot2_f32_bf16 v16, v120, s4, v16
    v_dot2_f32_bf16 v17, v120, v120, v17
    v_dot2_f32_bf16 v16, v121, s4, v16
    v_dot2_f32_bf16 v17, v121, v121, v17
    v_dot2_f32_bf16 v16, v122, s4, v16
    v_dot2_f32_bf16 v17, v122, v122, v17
    v_dot2_f32_bf16 v16, v123, s4, v16
    v_dot2_f32_bf16 v17, v123, v123, v17
    v_dot2_f32_bf16 v16, v124, s4, v16
    v_dot2_f32_bf16 v17, v124, v124, v17
    v_dot2_f32_bf16 v16, v125, s4, v16
    v_dot2_f32_bf16 v17, v125, v125, v17
    v_dot2_f32_bf16 v16, v126, s4, v16
    v_dot2_f32_bf16 v17, v126, v126, v17
    v_dot2_f32_bf16 v16, v127, s4, v16
    v_dot2_f32_bf16 v17, v127, v127, v17
    s_nop 3
    v_add_f32_dpp v16, v16, v16 quad_perm:[1,0,3,2] row_mask:0xf bank_mask:0xf
    v_add_f32_dpp v17, v17, v17 quad_perm:[1,0,3,2] row_mask:0xf bank_mask:0xf
    s_nop 0
    v_add_f32_dpp v16, v16, v16 quad_perm:[2,3,0,1] row_mask:0xf bank_mask:0xf
    v_add_f32_dpp v17, v17, v17 quad_perm:[2,3,0,1] row_mask:0xf bank_mask:0xf
    s_nop 0
    v_add_f32_dpp v16, v16, v16 row_half_mirror row_mask:0xf bank_mask:0xf
    v_add_f32_dpp v17, v17, v17 row_half_mirror row_mask:0xf bank_mask:0xf
    v_mul_f32 v16, 0x3b000000, v16
    v_mul_f32 v17, 0x3b000000, v17
    v_fma_f32 v17, -v16, v16, v17
    v_max_f32 v17, 0, v17
    v_cvt_pk_bf16_f32 v14, v16, v17
    v_lshlrev_b32 v16, 16, v14
    v_and_b32 v17, 0xffff0000, v14
    v_add_f32 v17, 0x3727c5ac, v17
    v_cvt_pk_bf16_f32 v14, v17, v17
    v_lshlrev_b32 v17, 16, v14
    v_sqrt_f32 v17, v17
    s_nop 0
    v_cvt_pk_bf16_f32 v14, v17, v17
    v_lshlrev_b32 v17, 16, v14
    v_rcp_f32 v17, v17
    v_lshlrev_b32 v18, 16, v96
    v_and_b32 v19, 0xffff0000, v96
    v_sub_f32 v18, v18, v16
    v_sub_f32 v19, v19, v16
    v_cvt_pk_bf16_f32 v96, v18, v19
    v_lshlrev_b32 v18, 16, v96
    v_and_b32 v19, 0xffff0000, v96
    v_mul_f32 v18, v18, v17
    v_mul_f32 v19, v19, v17
    v_cvt_pk_bf16_f32 v96, v18, v19
    v_lshlrev_b32 v18, 16, v97
    v_and_b32 v19, 0xffff0000, v97
    v_sub_f32 v18, v18, v16
    v_sub_f32 v19, v19, v16
    v_cvt_pk_bf16_f32 v97, v18, v19
    v_lshlrev_b32 v18, 16, v97
    v_and_b32 v19, 0xffff0000, v97
    v_mul_f32 v18, v18, v17
    v_mul_f32 v19, v19, v17
    v_cvt_pk_bf16_f32 v97, v18, v19
    v_lshlrev_b32 v18, 16, v98
    v_and_b32 v19, 0xffff0000, v98
    v_sub_f32 v18, v18, v16
    v_sub_f32 v19, v19, v16
    v_cvt_pk_bf16_f32 v98, v18, v19
    v_lshlrev_b32 v18, 16, v98
    v_and_b32 v19, 0xffff0000, v98
    v_mul_f32 v18, v18, v17
    v_mul_f32 v19, v19, v17
    v_cvt_pk_bf16_f32 v98, v18, v19
    v_lshlrev_b32 v18, 16, v99
    v_and_b32 v19, 0xffff0000, v99
    v_sub_f32 v18, v18, v16
    v_sub_f32 v19, v19, v16
    v_cvt_pk_bf16_f32 v99, v18, v19
    v_lshlrev_b32 v18, 16, v99
    v_and_b32 v19, 0xffff0000, v99
    v_mul_f32 v18, v18, v17
    v_mul_f32 v19, v19, v17
    v_cvt_pk_bf16_f32 v99, v18, v19
    ds_write_b128 v4, v[96:99] offset:0
    v_lshlrev_b32 v18, 16, v100
    v_and_b32 v19, 0xffff0000, v100
    v_sub_f32 v18, v18, v16
    v_sub_f32 v19, v19, v16
    v_cvt_pk_bf16_f32 v100, v18, v19
    v_lshlrev_b32 v18, 16, v100
    v_and_b32 v19, 0xffff0000, v100
    v_mul_f32 v18, v18, v17
    v_mul_f32 v19, v19, v17
    v_cvt_pk_bf16_f32 v100, v18, v19
    v_lshlrev_b32 v18, 16, v101
    v_and_b32 v19, 0xffff0000, v101
    v_sub_f32 v18, v18, v16
    v_sub_f32 v19, v19, v16
    v_cvt_pk_bf16_f32 v101, v18, v19
    v_lshlrev_b32 v18, 16, v101
    v_and_b32 v19, 0xffff0000, v101
    v_mul_f32 v18, v18, v17
    v_mul_f32 v19, v19, v17
    v_cvt_pk_bf16_f32 v101, v18, v19
    v_lshlrev_b32 v18, 16, v102
    v_and_b32 v19, 0xffff0000, v102
    v_sub_f32 v18, v18, v16
    v_sub_f32 v19, v19, v16
    v_cvt_pk_bf16_f32 v102, v18, v19
    v_lshlrev_b32 v18, 16, v102
    v_and_b32 v19, 0xffff0000, v102
    v_mul_f32 v18, v18, v17
    v_mul_f32 v19, v19, v17
    v_cvt_pk_bf16_f32 v102, v18, v19
    v_lshlrev_b32 v18, 16, v103
    v_and_b32 v19, 0xffff0000, v103
    v_sub_f32 v18, v18, v16
    v_sub_f32 v19, v19, v16
    v_cvt_pk_bf16_f32 v103, v18, v19
    v_lshlrev_b32 v18, 16, v103
    v_and_b32 v19, 0xffff0000, v103
    v_mul_f32 v18, v18, v17
    v_mul_f32 v19, v19, v17
    v_cvt_pk_bf16_f32 v103, v18, v19
    ds_write_b128 v4, v[100:103] offset:2048
    v_lshlrev_b32 v18, 16, v104
    v_and_b32 v19, 0xffff0000, v104
    v_sub_f32 v18, v18, v16
    v_sub_f32 v19, v19, v16
    v_cvt_pk_bf16_f32 v104, v18, v19
    v_lshlrev_b32 v18, 16, v104
    v_and_b32 v19, 0xffff0000, v104
    v_mul_f32 v18, v18, v17
    v_mul_f32 v19, v19, v17
    v_cvt_pk_bf16_f32 v104, v18, v19
    v_lshlrev_b32 v18, 16, v105
    v_and_b32 v19, 0xffff0000, v105
    v_sub_f32 v18, v18, v16
    v_sub_f32 v19, v19, v16
    v_cvt_pk_bf16_f32 v105, v18, v19
    v_lshlrev_b32 v18, 16, v105
    v_and_b32 v19, 0xffff0000, v105
    v_mul_f32 v18, v18, v17
    v_mul_f32 v19, v19, v17
    v_cvt_pk_bf16_f32 v105, v18, v19
    v_lshlrev_b32 v18, 16, v106
    v_and_b32 v19, 0xffff0000, v106
    v_sub_f32 v18, v18, v16
    v_sub_f32 v19, v19, v16
    v_cvt_pk_bf16_f32 v106, v18, v19
    v_lshlrev_b32 v18, 16, v106
    v_and_b32 v19, 0xffff0000, v106
    v_mul_f32 v18, v18, v17
    v_mul_f32 v19, v19, v17
    v_cvt_pk_bf16_f32 v106, v18, v19
    v_lshlrev_b32 v18, 16, v107
    v_and_b32 v19, 0xffff0000, v107
    v_sub_f32 v18, v18, v16
    v_sub_f32 v19, v19, v16
    v_cvt_pk_bf16_f32 v107, v18, v19
    v_lshlrev_b32 v18, 16, v107
    v_and_b32 v19, 0xffff0000, v107
    v_mul_f32 v18, v18, v17
    v_mul_f32 v19, v19, v17
    v_cvt_pk_bf16_f32 v107, v18, v19
    ds_write_b128 v4, v[104:107] offset:4096
    v_lshlrev_b32 v18, 16, v108
    v_and_b32 v19, 0xffff0000, v108
    v_sub_f32 v18, v18, v16
    v_sub_f32 v19, v19, v16
    v_cvt_pk_bf16_f32 v108, v18, v19
    v_lshlrev_b32 v18, 16, v108
    v_and_b32 v19, 0xffff0000, v108
    v_mul_f32 v18, v18, v17
    v_mul_f32 v19, v19, v17
    v_cvt_pk_bf16_f32 v108, v18, v19
    v_lshlrev_b32 v18, 16, v109
    v_and_b32 v19, 0xffff0000, v109
    v_sub_f32 v18, v18, v16
    v_sub_f32 v19, v19, v16
    v_cvt_pk_bf16_f32 v109, v18, v19
    v_lshlrev_b32 v18, 16, v109
    v_and_b32 v19, 0xffff0000, v109
    v_mul_f32 v18, v18, v17
    v_mul_f32 v19, v19, v17
    v_cvt_pk_bf16_f32 v109, v18, v19
    v_lshlrev_b32 v18, 16, v110
    v_and_b32 v19, 0xffff0000, v110
    v_sub_f32 v18, v18, v16
    v_sub_f32 v19, v19, v16
    v_cvt_pk_bf16_f32 v110, v18, v19
    v_lshlrev_b32 v18, 16, v110
    v_and_b32 v19, 0xffff0000, v110
    v_mul_f32 v18, v18, v17
    v_mul_f32 v19, v19, v17
    v_cvt_pk_bf16_f32 v110, v18, v19
    v_lshlrev_b32 v18, 16, v111
    v_and_b32 v19, 0xffff0000, v111
    v_sub_f32 v18, v18, v16
    v_sub_f32 v19, v19, v16
    v_cvt_pk_bf16_f32 v111, v18, v19
    v_lshlrev_b32 v18, 16, v111
    v_and_b32 v19, 0xffff0000, v111
    v_mul_f32 v18, v18, v17
    v_mul_f32 v19, v19, v17
    v_cvt_pk_bf16_f32 v111, v18, v19
    ds_write_b128 v4, v[108:111] offset:6144
    v_lshlrev_b32 v18, 16, v112
    v_and_b32 v19, 0xffff0000, v112
    v_sub_f32 v18, v18, v16
    v_sub_f32 v19, v19, v16
    v_cvt_pk_bf16_f32 v112, v18, v19
    v_lshlrev_b32 v18, 16, v112
    v_and_b32 v19, 0xffff0000, v112
    v_mul_f32 v18, v18, v17
    v_mul_f32 v19, v19, v17
    v_cvt_pk_bf16_f32 v112, v18, v19
    v_lshlrev_b32 v18, 16, v113
    v_and_b32 v19, 0xffff0000, v113
    v_sub_f32 v18, v18, v16
    v_sub_f32 v19, v19, v16
    v_cvt_pk_bf16_f32 v113, v18, v19
    v_lshlrev_b32 v18, 16, v113
    v_and_b32 v19, 0xffff0000, v113
    v_mul_f32 v18, v18, v17
    v_mul_f32 v19, v19, v17
    v_cvt_pk_bf16_f32 v113, v18, v19
    v_lshlrev_b32 v18, 16, v114
    v_and_b32 v19, 0xffff0000, v114
    v_sub_f32 v18, v18, v16
    v_sub_f32 v19, v19, v16
    v_cvt_pk_bf16_f32 v114, v18, v19
    v_lshlrev_b32 v18, 16, v114
    v_and_b32 v19, 0xffff0000, v114
    v_mul_f32 v18, v18, v17
    v_mul_f32 v19, v19, v17
    v_cvt_pk_bf16_f32 v114, v18, v19
    v_lshlrev_b32 v18, 16, v115
    v_and_b32 v19, 0xffff0000, v115
    v_sub_f32 v18, v18, v16
    v_sub_f32 v19, v19, v16
    v_cvt_pk_bf16_f32 v115, v18, v19
    v_lshlrev_b32 v18, 16, v115
    v_and_b32 v19, 0xffff0000, v115
    v_mul_f32 v18, v18, v17
    v_mul_f32 v19, v19, v17
    v_cvt_pk_bf16_f32 v115, v18, v19
    ds_write_b128 v4, v[112:115] offset:8192
    v_lshlrev_b32 v18, 16, v116
    v_and_b32 v19, 0xffff0000, v116
    v_sub_f32 v18, v18, v16
    v_sub_f32 v19, v19, v16
    v_cvt_pk_bf16_f32 v116, v18, v19
    v_lshlrev_b32 v18, 16, v116
    v_and_b32 v19, 0xffff0000, v116
    v_mul_f32 v18, v18, v17
    v_mul_f32 v19, v19, v17
    v_cvt_pk_bf16_f32 v116, v18, v19
    v_lshlrev_b32 v18, 16, v117
    v_and_b32 v19, 0xffff0000, v117
    v_sub_f32 v18, v18, v16
    v_sub_f32 v19, v19, v16
    v_cvt_pk_bf16_f32 v117, v18, v19
    v_lshlrev_b32 v18, 16, v117
    v_and_b32 v19, 0xffff0000, v117
    v_mul_f32 v18, v18, v17
    v_mul_f32 v19, v19, v17
    v_cvt_pk_bf16_f32 v117, v18, v19
    v_lshlrev_b32 v18, 16, v118
    v_and_b32 v19, 0xffff0000, v118
    v_sub_f32 v18, v18, v16
    v_sub_f32 v19, v19, v16
    v_cvt_pk_bf16_f32 v118, v18, v19
    v_lshlrev_b32 v18, 16, v118
    v_and_b32 v19, 0xffff0000, v118
    v_mul_f32 v18, v18, v17
    v_mul_f32 v19, v19, v17
    v_cvt_pk_bf16_f32 v118, v18, v19
    v_lshlrev_b32 v18, 16, v119
    v_and_b32 v19, 0xffff0000, v119
    v_sub_f32 v18, v18, v16
    v_sub_f32 v19, v19, v16
    v_cvt_pk_bf16_f32 v119, v18, v19
    v_lshlrev_b32 v18, 16, v119
    v_and_b32 v19, 0xffff0000, v119
    v_mul_f32 v18, v18, v17
    v_mul_f32 v19, v19, v17
    v_cvt_pk_bf16_f32 v119, v18, v19
    ds_write_b128 v4, v[116:119] offset:10240
    v_lshlrev_b32 v18, 16, v120
    v_and_b32 v19, 0xffff0000, v120
    v_sub_f32 v18, v18, v16
    v_sub_f32 v19, v19, v16
    v_cvt_pk_bf16_f32 v120, v18, v19
    v_lshlrev_b32 v18, 16, v120
    v_and_b32 v19, 0xffff0000, v120
    v_mul_f32 v18, v18, v17
    v_mul_f32 v19, v19, v17
    v_cvt_pk_bf16_f32 v120, v18, v19
    v_lshlrev_b32 v18, 16, v121
    v_and_b32 v19, 0xffff0000, v121
    v_sub_f32 v18, v18, v16
    v_sub_f32 v19, v19, v16
    v_cvt_pk_bf16_f32 v121, v18, v19
    v_lshlrev_b32 v18, 16, v121
    v_and_b32 v19, 0xffff0000, v121
    v_mul_f32 v18, v18, v17
    v_mul_f32 v19, v19, v17
    v_cvt_pk_bf16_f32 v121, v18, v19
    v_lshlrev_b32 v18, 16, v122
    v_and_b32 v19, 0xffff0000, v122
    v_sub_f32 v18, v18, v16
    v_sub_f32 v19, v19, v16
    v_cvt_pk_bf16_f32 v122, v18, v19
    v_lshlrev_b32 v18, 16, v122
    v_and_b32 v19, 0xffff0000, v122
    v_mul_f32 v18, v18, v17
    v_mul_f32 v19, v19, v17
    v_cvt_pk_bf16_f32 v122, v18, v19
    v_lshlrev_b32 v18, 16, v123
    v_and_b32 v19, 0xffff0000, v123
    v_sub_f32 v18, v18, v16
    v_sub_f32 v19, v19, v16
    v_cvt_pk_bf16_f32 v123, v18, v19
    v_lshlrev_b32 v18, 16, v123
    v_and_b32 v19, 0xffff0000, v123
    v_mul_f32 v18, v18, v17
    v_mul_f32 v19, v19, v17
    v_cvt_pk_bf16_f32 v123, v18, v19
    ds_write_b128 v4, v[120:123] offset:12288
    v_lshlrev_b32 v18, 16, v124
    v_and_b32 v19, 0xffff0000, v124
    v_sub_f32 v18, v18, v16
    v_sub_f32 v19, v19, v16
    v_cvt_pk_bf16_f32 v124, v18, v19
    v_lshlrev_b32 v18, 16, v124
    v_and_b32 v19, 0xffff0000, v124
    v_mul_f32 v18, v18, v17
    v_mul_f32 v19, v19, v17
    v_cvt_pk_bf16_f32 v124, v18, v19
    v_lshlrev_b32 v18, 16, v125
    v_and_b32 v19, 0xffff0000, v125
    v_sub_f32 v18, v18, v16
    v_sub_f32 v19, v19, v16
    v_cvt_pk_bf16_f32 v125, v18, v19
    v_lshlrev_b32 v18, 16, v125
    v_and_b32 v19, 0xffff0000, v125
    v_mul_f32 v18, v18, v17
    v_mul_f32 v19, v19, v17
    v_cvt_pk_bf16_f32 v125, v18, v19
    v_lshlrev_b32 v18, 16, v126
    v_and_b32 v19, 0xffff0000, v126
    v_sub_f32 v18, v18, v16
    v_sub_f32 v19, v19, v16
    v_cvt_pk_bf16_f32 v126, v18, v19
    v_lshlrev_b32 v18, 16, v126
    v_and_b32 v19, 0xffff0000, v126
    v_mul_f32 v18, v18, v17
    v_mul_f32 v19, v19, v17
    v_cvt_pk_bf16_f32 v126, v18, v19
    v_lshlrev_b32 v18, 16, v127
    v_and_b32 v19, 0xffff0000, v127
    v_sub_f32 v18, v18, v16
    v_sub_f32 v19, v19, v16
    v_cvt_pk_bf16_f32 v127, v18, v19
    v_lshlrev_b32 v18, 16, v127
    v_and_b32 v19, 0xffff0000, v127
    v_mul_f32 v18, v18, v17
    v_mul_f32 v19, v19, v17
    v_cvt_pk_bf16_f32 v127, v18, v19
    ds_write_b128 v4, v[124:127] offset:14336
    s_waitcnt vmcnt(0) lgkmcnt(0)
    s_barrier
    v_cmp_ne_u32 vcc, 0, v0
    v_mov_b32 v15, 0x40000000
    v_mov_b32 v14, 1
    v_cndmask_b32 v15, v0, v15, vcc
    buffer_store_dword v14, v15, s[8:11], s25 offen sc1
    s_add_u32 s24, s23, 6
    s_min_u32 s24, s24, 63
    s_lshl_b32 s36, s24, 15
    buffer_load_dwordx4 v[96:99], v3, s[12:15], s36 offen offset:0
    buffer_load_dwordx4 v[100:103], v3, s[12:15], s36 offen offset:128
    buffer_load_dwordx4 v[104:107], v3, s[12:15], s36 offen offset:256
    buffer_load_dwordx4 v[108:111], v3, s[12:15], s36 offen offset:384
    buffer_load_dwordx4 v[112:115], v3, s[12:15], s36 offen offset:512
    buffer_load_dwordx4 v[116:119], v3, s[12:15], s36 offen offset:640
    buffer_load_dwordx4 v[120:123], v3, s[12:15], s36 offen offset:768
    buffer_load_dwordx4 v[124:127], v3, s[12:15], s36 offen offset:896
    ds_read_b128 v[64:67], v80 offset:0
    ds_read_b128 v[68:71], v81 offset:0
    ds_read_b128 v[72:75], v82 offset:1024
    ds_read_b128 v[76:79], v83 offset:1024
    s_waitcnt lgkmcnt(2)
    v_mfma_f32_16x16x32_bf16 v[32:35], a[128:131], v[64:67], 0
    v_mfma_f32_16x16x32_bf16 v[36:39], a[128:131], v[68:71], 0
    v_mfma_f32_16x16x32_bf16 v[40:43], a[132:135], v[64:67], 0
    v_mfma_f32_16x16x32_bf16 v[44:47], a[132:135], v[68:71], 0
    v_mfma_f32_16x16x32_bf16 v[48:51], v[64:67], v[128:131], 0
    v_mfma_f32_16x16x32_bf16 v[56:59], v[68:71], v[128:131], 0
    v_mfma_f32_16x16x32_bf16 v[52:55], v[64:67], v[132:135], 0
    v_mfma_f32_16x16x32_bf16 v[60:63], v[68:71], v[132:135], 0
    v_mfma_f32_16x16x32_bf16 v[16:19], a[0:3], v[64:67], 0
    v_mfma_f32_16x16x32_bf16 v[20:23], a[0:3], v[68:71], 0
    v_mfma_f32_16x16x32_bf16 v[24:27], a[4:7], v[64:67], 0
    v_mfma_f32_16x16x32_bf16 v[28:31], a[4:7], v[68:71], 0
    ds_read_b128 v[64:67], v80 offset:2048
    ds_read_b128 v[68:71], v81 offset:2048
    s_waitcnt lgkmcnt(2)
    v_mfma_f32_16x16x32_bf16 v[32:35], a[136:139], v[72:75], v[32:35]
    v_mfma_f32_16x16x32_bf16 v[36:39], a[136:139], v[76:79], v[36:39]
    v_mfma_f32_16x16x32_bf16 v[40:43], a[140:143], v[72:75], v[40:43]
    v_mfma_f32_16x16x32_bf16 v[44:47], a[140:143], v[76:79], v[44:47]
    v_mfma_f32_16x16x32_bf16 v[48:51], v[72:75], v[136:139], v[48:51]
    v_mfma_f32_16x16x32_bf16 v[56:59], v[76:79], v[136:139], v[56:59]
    v_mfma_f32_16x16x32_bf16 v[52:55], v[72:75], v[140:143], v[52:55]
    v_mfma_f32_16x16x32_bf16 v[60:63], v[76:79], v[140:143], v[60:63]
    v_mfma_f32_16x16x32_bf16 v[16:19], a[8:11], v[72:75], v[16:19]
    v_mfma_f32_16x16x32_bf16 v[20:23], a[8:11], v[76:79], v[20:23]
    v_mfma_f32_16x16x32_bf16 v[24:27], a[12:15], v[72:75], v[24:27]
    v_mfma_f32_16x16x32_bf16 v[28:31], a[12:15], v[76:79], v[28:31]
    ds_read_b128 v[72:75], v82 offset:3072
    ds_read_b128 v[76:79], v83 offset:3072
    s_waitcnt lgkmcnt(2)
    v_mfma_f32_16x16x32_bf16 v[32:35], a[144:147], v[64:67], v[32:35]
    v_mfma_f32_16x16x32_bf16 v[36:39], a[144:147], v[68:71], v[36:39]
    v_mfma_f32_16x16x32_bf16 v[40:43], a[148:151], v[64:67], v[40:43]
    v_mfma_f32_16x16x32_bf16 v[44:47], a[148:151], v[68:71], v[44:47]
    v_mfma_f32_16x16x32_bf16 v[48:51], v[64:67], v[144:147], v[48:51]
    v_mfma_f32_16x16x32_bf16 v[56:59], v[68:71], v[144:147], v[56:59]
    v_mfma_f32_16x16x32_bf16 v[52:55], v[64:67], v[148:151], v[52:55]
    v_mfma_f32_16x16x32_bf16 v[60:63], v[68:71], v[148:151], v[60:63]
    v_mfma_f32_16x16x32_bf16 v[16:19], a[16:19], v[64:67], v[16:19]
    v_mfma_f32_16x16x32_bf16 v[20:23], a[16:19], v[68:71], v[20:23]
    v_mfma_f32_16x16x32_bf16 v[24:27], a[20:23], v[64:67], v[24:27]
    v_mfma_f32_16x16x32_bf16 v[28:31], a[20:23], v[68:71], v[28:31]
    ds_read_b128 v[64:67], v80 offset:4096
    ds_read_b128 v[68:71], v81 offset:4096
    s_waitcnt lgkmcnt(2)
    v_mfma_f32_16x16x32_bf16 v[32:35], a[152:155], v[72:75], v[32:35]
    v_mfma_f32_16x16x32_bf16 v[36:39], a[152:155], v[76:79], v[36:39]
    v_mfma_f32_16x16x32_bf16 v[40:43], a[156:159], v[72:75], v[40:43]
    v_mfma_f32_16x16x32_bf16 v[44:47], a[156:159], v[76:79], v[44:47]
    v_mfma_f32_16x16x32_bf16 v[48:51], v[72:75], v[152:155], v[48:51]
    v_mfma_f32_16x16x32_bf16 v[56:59], v[76:79], v[152:155], v[56:59]
    v_mfma_f32_16x16x32_bf16 v[52:55], v[72:75], v[156:159], v[52:55]
    v_mfma_f32_16x16x32_bf16 v[60:63], v[76:79], v[156:159], v[60:63]
    v_mfma_f32_16x16x32_bf16 v[16:19], a[24:27], v[72:75], v[16:19]
    v_mfma_f32_16x16x32_bf16 v[20:23], a[24:27], v[76:79], v[20:23]
    v_mfma_f32_16x16x32_bf16 v[24:27], a[28:31], v[72:75], v[24:27]
    v_mfma_f32_16x16x32_bf16 v[28:31], a[28:31], v[76:79], v[28:31]
    ds_read_b128 v[72:75], v82 offset:5120
    ds_read_b128 v[76:79], v83 offset:5120
    s_waitcnt lgkmcnt(2)
    v_mfma_f32_16x16x32_bf16 v[32:35], a[160:163], v[64:67], v[32:35]
    v_mfma_f32_16x16x32_bf16 v[36:39], a[160:163], v[68:71], v[36:39]
    v_mfma_f32_16x16x32_bf16 v[40:43], a[164:167], v[64:67], v[40:43]
    v_mfma_f32_16x16x32_bf16 v[44:47], a[164:167], v[68:71], v[44:47]
    v_mfma_f32_16x16x32_bf16 v[48:51], v[64:67], v[160:163], v[48:51]
    v_mfma_f32_16x16x32_bf16 v[56:59], v[68:71], v[160:163], v[56:59]
    v_mfma_f32_16x16x32_bf16 v[52:55], v[64:67], v[164:167], v[52:55]
    v_mfma_f32_16x16x32_bf16 v[60:63], v[68:71], v[164:167], v[60:63]
    v_mfma_f32_16x16x32_bf16 v[16:19], a[32:35], v[64:67], v[16:19]
    v_mfma_f32_16x16x32_bf16 v[20:23], a[32:35], v[68:71], v[20:23]
    v_mfma_f32_16x16x32_bf16 v[24:27], a[36:39], v[64:67], v[24:27]
    v_mfma_f32_16x16x32_bf16 v[28:31], a[36:39], v[68:71], v[28:31]
    ds_read_b128 v[64:67], v80 offset:6144
    ds_read_b128 v[68:71], v81 offset:6144
    s_waitcnt lgkmcnt(2)
    v_mfma_f32_16x16x32_bf16 v[32:35], a[168:171], v[72:75], v[32:35]
    v_mfma_f32_16x16x32_bf16 v[36:39], a[168:171], v[76:79], v[36:39]
    v_mfma_f32_16x16x32_bf16 v[40:43], a[172:175], v[72:75], v[40:43]
    v_mfma_f32_16x16x32_bf16 v[44:47], a[172:175], v[76:79], v[44:47]
    v_mfma_f32_16x16x32_bf16 v[48:51], v[72:75], v[168:171], v[48:51]
    v_mfma_f32_16x16x32_bf16 v[56:59], v[76:79], v[168:171], v[56:59]
    v_mfma_f32_16x16x32_bf16 v[52:55], v[72:75], v[172:175], v[52:55]
    v_mfma_f32_16x16x32_bf16 v[60:63], v[76:79], v[172:175], v[60:63]
    v_mfma_f32_16x16x32_bf16 v[16:19], a[40:43], v[72:75], v[16:19]
    v_mfma_f32_16x16x32_bf16 v[20:23], a[40:43], v[76:79], v[20:23]
    v_mfma_f32_16x16x32_bf16 v[24:27], a[44:47], v[72:75], v[24:27]
    v_mfma_f32_16x16x32_bf16 v[28:31], a[44:47], v[76:79], v[28:31]
    ds_read_b128 v[72:75], v82 offset:7168
    ds_read_b128 v[76:79], v83 offset:7168
    s_waitcnt lgkmcnt(2)
    v_mfma_f32_16x16x32_bf16 v[32:35], a[176:179], v[64:67], v[32:35]
    v_mfma_f32_16x16x32_bf16 v[36:39], a[176:179], v[68:71], v[36:39]
    v_mfma_f32_16x16x32_bf16 v[40:43], a[180:183], v[64:67], v[40:43]
    v_mfma_f32_16x16x32_bf16 v[44:47], a[180:183], v[68:71], v[44:47]
    v_mfma_f32_16x16x32_bf16 v[48:51], v[64:67], v[176:179], v[48:51]
    v_mfma_f32_16x16x32_bf16 v[56:59], v[68:71], v[176:179], v[56:59]
    v_mfma_f32_16x16x32_bf16 v[52:55], v[64:67], v[180:183], v[52:55]
    v_mfma_f32_16x16x32_bf16 v[60:63], v[68:71], v[180:183], v[60:63]
    v_mfma_f32_16x16x32_bf16 v[16:19], a[48:51], v[64:67], v[16:19]
    v_mfma_f32_16x16x32_bf16 v[20:23], a[48:51], v[68:71], v[20:23]
    v_mfma_f32_16x16x32_bf16 v[24:27], a[52:55], v[64:67], v[24:27]
    v_mfma_f32_16x16x32_bf16 v[28:31], a[52:55], v[68:71], v[28:31]
    ds_read_b128 v[64:67], v80 offset:8192
    ds_read_b128 v[68:71], v81 offset:8192
    s_waitcnt lgkmcnt(2)
    v_mfma_f32_16x16x32_bf16 v[32:35], a[184:187], v[72:75], v[32:35]
    v_mfma_f32_16x16x32_bf16 v[36:39], a[184:187], v[76:79], v[36:39]
    v_mfma_f32_16x16x32_bf16 v[40:43], a[188:191], v[72:75], v[40:43]
    v_mfma_f32_16x16x32_bf16 v[44:47], a[188:191], v[76:79], v[44:47]
    v_mfma_f32_16x16x32_bf16 v[48:51], v[72:75], v[184:187], v[48:51]
    v_mfma_f32_16x16x32_bf16 v[56:59], v[76:79], v[184:187], v[56:59]
    v_mfma_f32_16x16x32_bf16 v[52:55], v[72:75], v[188:191], v[52:55]
    v_mfma_f32_16x16x32_bf16 v[60:63], v[76:79], v[188:191], v[60:63]
    v_mfma_f32_16x16x32_bf16 v[16:19], a[56:59], v[72:75], v[16:19]
    v_mfma_f32_16x16x32_bf16 v[20:23], a[56:59], v[76:79], v[20:23]
    v_mfma_f32_16x16x32_bf16 v[24:27], a[60:63], v[72:75], v[24:27]
    v_mfma_f32_16x16x32_bf16 v[28:31], a[60:63], v[76:79], v[28:31]
    ds_read_b128 v[72:75], v82 offset:9216
    ds_read_b128 v[76:79], v83 offset:9216
    s_waitcnt lgkmcnt(2)
    v_mfma_f32_16x16x32_bf16 v[32:35], a[192:195], v[64:67], v[32:35]
    v_mfma_f32_16x16x32_bf16 v[36:39], a[192:195], v[68:71], v[36:39]
    v_mfma_f32_16x16x32_bf16 v[40:43], a[196:199], v[64:67], v[40:43]
    v_mfma_f32_16x16x32_bf16 v[44:47], a[196:199], v[68:71], v[44:47]
    v_mfma_f32_16x16x32_bf16 v[48:51], v[64:67], v[192:195], v[48:51]
    v_mfma_f32_16x16x32_bf16 v[56:59], v[68:71], v[192:195], v[56:59]
    v_mfma_f32_16x16x32_bf16 v[52:55], v[64:67], v[196:199], v[52:55]
    v_mfma_f32_16x16x32_bf16 v[60:63], v[68:71], v[196:199], v[60:63]
    v_mfma_f32_16x16x32_bf16 v[16:19], a[64:67], v[64:67], v[16:19]
    v_mfma_f32_16x16x32_bf16 v[20:23], a[64:67], v[68:71], v[20:23]
    v_mfma_f32_16x16x32_bf16 v[24:27], a[68:71], v[64:67], v[24:27]
    v_mfma_f32_16x16x32_bf16 v[28:31], a[68:71], v[68:71], v[28:31]
    ds_read_b128 v[64:67], v80 offset:10240
    ds_read_b128 v[68:71], v81 offset:10240
    s_waitcnt lgkmcnt(2)
    v_mfma_f32_16x16x32_bf16 v[32:35], a[200:203], v[72:75], v[32:35]
    v_mfma_f32_16x16x32_bf16 v[36:39], a[200:203], v[76:79], v[36:39]
    v_mfma_f32_16x16x32_bf16 v[40:43], a[204:207], v[72:75], v[40:43]
    v_mfma_f32_16x16x32_bf16 v[44:47], a[204:207], v[76:79], v[44:47]
    v_mfma_f32_16x16x32_bf16 v[48:51], v[72:75], v[200:203], v[48:51]
    v_mfma_f32_16x16x32_bf16 v[56:59], v[76:79], v[200:203], v[56:59]
    v_mfma_f32_16x16x32_bf16 v[52:55], v[72:75], v[204:207], v[52:55]
    v_mfma_f32_16x16x32_bf16 v[60:63], v[76:79], v[204:207], v[60:63]
    v_mfma_f32_16x16x32_bf16 v[16:19], a[72:75], v[72:75], v[16:19]
    v_mfma_f32_16x16x32_bf16 v[20:23], a[72:75], v[76:79], v[20:23]
    v_mfma_f32_16x16x32_bf16 v[24:27], a[76:79], v[72:75], v[24:27]
    v_mfma_f32_16x16x32_bf16 v[28:31], a[76:79], v[76:79], v[28:31]
    ds_read_b128 v[72:75], v82 offset:11264
    ds_read_b128 v[76:79], v83 offset:11264
    s_waitcnt lgkmcnt(2)
    v_mfma_f32_16x16x32_bf16 v[32:35], a[208:211], v[64:67], v[32:35]
    v_mfma_f32_16x16x32_bf16 v[36:39], a[208:211], v[68:71], v[36:39]
    v_mfma_f32_16x16x32_bf16 v[40:43], a[212:215], v[64:67], v[40:43]
    v_mfma_f32_16x16x32_bf16 v[44:47], a[212:215], v[68:71], v[44:47]
    v_mfma_f32_16x16x32_bf16 v[48:51], v[64:67], v[208:211], v[48:51]
    v_mfma_f32_16x16x32_bf16 v[56:59], v[68:71], v[208:211], v[56:59]
    v_mfma_f32_16x16x32_bf16 v[52:55], v[64:67], v[212:215], v[52:55]
    v_mfma_f32_16x16x32_bf16 v[60:63], v[68:71], v[212:215], v[60:63]
    v_mfma_f32_16x16x32_bf16 v[16:19], a[80:83], v[64:67], v[16:19]
    v_mfma_f32_16x16x32_bf16 v[20:23], a[80:83], v[68:71], v[20:23]
    v_mfma_f32_16x16x32_bf16 v[24:27], a[84:87], v[64:67], v[24:27]
    v_mfma_f32_16x16x32_bf16 v[28:31], a[84:87], v[68:71], v[28:31]
    ds_read_b128 v[64:67], v80 offset:12288
    ds_read_b128 v[68:71], v81 offset:12288
    s_waitcnt lgkmcnt(2)
    v_mfma_f32_16x16x32_bf16 v[32:35], a[216:219], v[72:75], v[32:35]
    v_mfma_f32_16x16x32_bf16 v[36:39], a[216:219], v[76:79], v[36:39]
    v_mfma_f32_16x16x32_bf16 v[40:43], a[220:223], v[72:75], v[40:43]
    v_mfma_f32_16x16x32_bf16 v[44:47], a[220:223], v[76:79], v[44:47]
    v_mfma_f32_16x16x32_bf16 v[48:51], v[72:75], v[216:219], v[48:51]
    v_mfma_f32_16x16x32_bf16 v[56:59], v[76:79], v[216:219], v[56:59]
    v_mfma_f32_16x16x32_bf16 v[52:55], v[72:75], v[220:223], v[52:55]
    v_mfma_f32_16x16x32_bf16 v[60:63], v[76:79], v[220:223], v[60:63]
    v_mfma_f32_16x16x32_bf16 v[16:19], a[88:91], v[72:75], v[16:19]
    v_mfma_f32_16x16x32_bf16 v[20:23], a[88:91], v[76:79], v[20:23]
    v_mfma_f32_16x16x32_bf16 v[24:27], a[92:95], v[72:75], v[24:27]
    v_mfma_f32_16x16x32_bf16 v[28:31], a[92:95], v[76:79], v[28:31]
    ds_read_b128 v[72:75], v82 offset:13312
    ds_read_b128 v[76:79], v83 offset:13312
    s_waitcnt lgkmcnt(2)
    v_mfma_f32_16x16x32_bf16 v[32:35], a[224:227], v[64:67], v[32:35]
    v_mfma_f32_16x16x32_bf16 v[36:39], a[224:227], v[68:71], v[36:39]
    v_mfma_f32_16x16x32_bf16 v[40:43], a[228:231], v[64:67], v[40:43]
    v_mfma_f32_16x16x32_bf16 v[44:47], a[228:231], v[68:71], v[44:47]
    v_mfma_f32_16x16x32_bf16 v[48:51], v[64:67], v[224:227], v[48:51]
    v_mfma_f32_16x16x32_bf16 v[56:59], v[68:71], v[224:227], v[56:59]
    v_mfma_f32_16x16x32_bf16 v[52:55], v[64:67], v[228:231], v[52:55]
    v_mfma_f32_16x16x32_bf16 v[60:63], v[68:71], v[228:231], v[60:63]
    v_mfma_f32_16x16x32_bf16 v[16:19], a[96:99], v[64:67], v[16:19]
    v_mfma_f32_16x16x32_bf16 v[20:23], a[96:99], v[68:71], v[20:23]
    v_mfma_f32_16x16x32_bf16 v[24:27], a[100:103], v[64:67], v[24:27]
    v_mfma_f32_16x16x32_bf16 v[28:31], a[100:103], v[68:71], v[28:31]
    ds_read_b128 v[64:67], v80 offset:14336
    ds_read_b128 v[68:71], v81 offset:14336
    s_waitcnt lgkmcnt(2)
    v_mfma_f32_16x16x32_bf16 v[32:35], a[232:235], v[72:75], v[32:35]
    v_mfma_f32_16x16x32_bf16 v[36:39], a[232:235], v[76:79], v[36:39]
    v_mfma_f32_16x16x32_bf16 v[40:43], a[236:239], v[72:75], v[40:43]
    v_mfma_f32_16x16x32_bf16 v[44:47], a[236:239], v[76:79], v[44:47]
    v_mfma_f32_16x16x32_bf16 v[48:51], v[72:75], v[232:235], v[48:51]
    v_mfma_f32_16x16x32_bf16 v[56:59], v[76:79], v[232:235], v[56:59]
    v_mfma_f32_16x16x32_bf16 v[52:55], v[72:75], v[236:239], v[52:55]
    v_mfma_f32_16x16x32_bf16 v[60:63], v[76:79], v[236:239], v[60:63]
    v_mfma_f32_16x16x32_bf16 v[16:19], a[104:107], v[72:75], v[16:19]
    v_mfma_f32_16x16x32_bf16 v[20:23], a[104:107], v[76:79], v[20:23]
    v_mfma_f32_16x16x32_bf16 v[24:27], a[108:111], v[72:75], v[24:27]
    v_mfma_f32_16x16x32_bf16 v[28:31], a[108:111], v[76:79], v[28:31]
    ds_read_b128 v[72:75], v82 offset:15360
    ds_read_b128 v[76:79], v83 offset:15360
    s_waitcnt lgkmcnt(2)
    v_mfma_f32_16x16x32_bf16 v[32:35], a[240:243], v[64:67], v[32:35]
    v_mfma_f32_16x16x32_bf16 v[36:39], a[240:243], v[68:71], v[36:39]
    v_mfma_f32_16x16x32_bf16 v[40:43], a[244:247], v[64:67], v[40:43]
    v_mfma_f32_16x16x32_bf16 v[44:47], a[244:247], v[68:71], v[44:47]
    v_mfma_f32_16x16x32_bf16 v[48:51], v[64:67], v[240:243], v[48:51]
    v_mfma_f32_16x16x32_bf16 v[56:59], v[68:71], v[240:243], v[56:59]
    v_mfma_f32_16x16x32_bf16 v[52:55], v[64:67], v[244:247], v[52:55]
    v_mfma_f32_16x16x32_bf16 v[60:63], v[68:71], v[244:247], v[60:63]
    v_mfma_f32_16x16x32_bf16 v[16:19], a[112:115], v[64:67], v[16:19]
    v_mfma_f32_16x16x32_bf16 v[20:23], a[112:115], v[68:71], v[20:23]
    v_mfma_f32_16x16x32_bf16 v[24:27], a[116:119], v[64:67], v[24:27]
    v_mfma_f32_16x16x32_bf16 v[28:31], a[116:119], v[68:71], v[28:31]
    s_waitcnt lgkmcnt(0)
    v_mfma_f32_16x16x32_bf16 v[32:35], a[248:251], v[72:75], v[32:35]
    v_mfma_f32_16x16x32_bf16 v[36:39], a[248:251], v[76:79], v[36:39]
    v_mfma_f32_16x16x32_bf16 v[40:43], a[252:255], v[72:75], v[40:43]
    v_mfma_f32_16x16x32_bf16 v[44:47], a[252:255], v[76:79], v[44:47]
    v_mfma_f32_16x16x32_bf16 v[48:51], v[72:75], v[248:251], v[48:51]
    v_mfma_f32_16x16x32_bf16 v[56:59], v[76:79], v[248:251], v[56:59]
    v_mfma_f32_16x16x32_bf16 v[52:55], v[72:75], v[252:255], v[52:55]
    v_mfma_f32_16x16x32_bf16 v[60:63], v[76:79], v[252:255], v[60:63]
    v_mfma_f32_16x16x32_bf16 v[16:19], a[120:123], v[72:75], v[16:19]
    v_mfma_f32_16x16x32_bf16 v[20:23], a[120:123], v[76:79], v[20:23]
    v_mfma_f32_16x16x32_bf16 v[24:27], a[124:127], v[72:75], v[24:27]
    v_mfma_f32_16x16x32_bf16 v[28:31], a[124:127], v[76:79], v[28:31]
    s_barrier
    v_mul_f32 v32, s33, v32
    v_mul_f32 v33, s33, v33
    v_mul_f32 v34, s33, v34
    v_mul_f32 v35, s33, v35
    v_mul_f32 v36, s33, v36
    v_mul_f32 v37, s33, v37
    v_mul_f32 v38, s33, v38
    v_mul_f32 v39, s33, v39
    v_mul_f32 v40, s33, v40
    v_mul_f32 v41, s33, v41
    v_mul_f32 v42, s33, v42
    v_mul_f32 v43, s33, v43
    v_mul_f32 v44, s33, v44
    v_mul_f32 v45, s33, v45
    v_mul_f32 v46, s33, v46
    v_mul_f32 v47, s33, v47
    v_cvt_pk_bf16_f32 v64, v32, v40
    v_cvt_pk_bf16_f32 v65, v33, v41
    v_cvt_pk_bf16_f32 v66, v34, v42
    v_cvt_pk_bf16_f32 v67, v35, v43
    v_cvt_pk_bf16_f32 v68, v36, v44
    v_cvt_pk_bf16_f32 v69, v37, v45
    v_cvt_pk_bf16_f32 v70, v38, v46
    v_cvt_pk_bf16_f32 v71, v39, v47
    v_cvt_pk_bf16_f32 v72, v48, v49
    v_cvt_pk_bf16_f32 v73, v50, v51
    v_cvt_pk_bf16_f32 v74, v56, v57
    v_cvt_pk_bf16_f32 v75, v58, v59
    v_cvt_pk_bf16_f32 v76, v52, v53
    v_cvt_pk_bf16_f32 v77, v54, v55
    v_cvt_pk_bf16_f32 v78, v60, v61
    v_cvt_pk_bf16_f32 v79, v62, v63
    v_cvt_pk_bf16_f32 v84, v16, v24
    v_cvt_pk_bf16_f32 v85, v17, v25
    v_cvt_pk_bf16_f32 v86, v18, v26
    v_cvt_pk_bf16_f32 v87, v19, v27
    v_cvt_pk_bf16_f32 v88, v20, v28
    v_cvt_pk_bf16_f32 v89, v21, v29
    v_cvt_pk_bf16_f32 v90, v22, v30
    v_cvt_pk_bf16_f32 v91, v23, v31
    s_mul_i32 s24, s23, 0x82000
    s_lshl_b32 s36, s20, 14
    s_add_u32 s24, s24, s36
    s_add_u32 s24, s24, 0x1000000
    s_lshr_b32 s36, s21, 1
    s_lshl_b32 s36, s36, 12
    s_xor_b32 s37, s36, 4096
    s_add_u32 s36, s36, s24
    s_add_u32 s37, s37, s24
    buffer_store_dwordx4 v[64:67], v9, s[8:11], s36 offen sc1
    buffer_store_dwordx4 v[68:71], v9, s[8:11], s37 offen sc1
    s_add_u32 s24, s24, 8192
    buffer_store_dwordx4 v[72:75], v2, s[8:11], s24 offen sc1
    buffer_store_dwordx4 v[76:79], v2, s[8:11], s24 offen offset:1024 sc1
    s_add_u32 s36, s36, 0x7000000
    s_add_u32 s37, s37, 0x7000000
    buffer_store_dwordx4 v[84:87], v9, s[8:11], s36 offen sc1
    buffer_store_dwordx4 v[88:91], v9, s[8:11], s37 offen sc1
    s_lshl_b32 s25, s20, 8
    s_lshl_b32 s36, s23, 2
    s_add_u32 s25, s25, s36
    s_add_u32 s25, s25, 0x190000
    s_cmp_ge_u32 s23, 6
    s_cbranch_scc1 L_P1_defer
    s_waitcnt vmcnt(0)
    s_barrier
    v_cmp_ne_u32 vcc, 0, v0
    v_mov_b32 v15, 0x40000000
    v_mov_b32 v14, 1
    v_cndmask_b32 v15, v0, v15, vcc
    buffer_store_dword v14, v15, s[8:11], s25 offen sc1
L_P1_defer:
    s_add_u32 s23, s23, 6
    s_cmp_lt_u32 s23, 64
    s_cbranch_scc1 L_P1
    v_mov_b32 v20, -1
    v_mov_b32 v21, -1
    v_mov_b32 v22, -1
    v_mov_b32 v23, -1
    s_lshl_b32 s24, s22, 21
    s_lshl_b32 s36, s20, 15
    s_add_u32 s24, s24, s36
    s_add_u32 s36, s24, 0x4000000
    buffer_store_dwordx4 v[20:23], v11, s[8:11], s36 offen sc1
    s_add_u32 s36, s24, 0x4001000
    buffer_store_dwordx4 v[20:23], v11, s[8:11], s36 offen sc1
    s_add_u32 s36, s24, 0x4002000
    buffer_store_dwordx4 v[20:23], v11, s[8:11], s36 offen sc1
    s_add_u32 s36, s24, 0x4003000
    buffer_store_dwordx4 v[20:23], v11, s[8:11], s36 offen sc1
    s_add_u32 s36, s24, 0x4004000
    buffer_store_dwordx4 v[20:23], v11, s[8:11], s36 offen sc1
    s_add_u32 s36, s24, 0x4005000
    buffer_store_dwordx4 v[20:23], v11, s[8:11], s36 offen sc1
    s_add_u32 s36, s24, 0x4006000
    buffer_store_dwordx4 v[20:23], v11, s[8:11], s36 offen sc1
    s_add_u32 s36, s24, 0x4007000
    buffer_store_dwordx4 v[20:23], v11, s[8:11], s36 offen sc1
    s_add_u32 s36, s24, 0x4100000
    buffer_store_dwordx4 v[20:23], v11, s[8:11], s36 offen sc1
    s_add_u32 s36, s24, 0x4101000
    buffer_store_dwordx4 v[20:23], v11, s[8:11], s36 offen sc1
    s_add_u32 s36, s24, 0x4102000
    buffer_store_dwordx4 v[20:23], v11, s[8:11], s36 offen sc1
    s_add_u32 s36, s24, 0x4103000
    buffer_store_dwordx4 v[20:23], v11, s[8:11], s36 offen sc1
    s_add_u32 s36, s24, 0x4104000
    buffer_store_dwordx4 v[20:23], v11, s[8:11], s36 offen sc1
    s_add_u32 s36, s24, 0x4105000
    buffer_store_dwordx4 v[20:23], v11, s[8:11], s36 offen sc1
    s_add_u32 s36, s24, 0x4106000
    buffer_store_dwordx4 v[20:23], v11, s[8:11], s36 offen sc1
    s_add_u32 s36, s24, 0x4107000
    buffer_store_dwordx4 v[20:23], v11, s[8:11], s36 offen sc1
    s_waitcnt vmcnt(0)
    s_barrier
    v_cmp_ne_u32 vcc, 0, v0
    v_mov_b32 v15, 0x40000000
    v_mov_b32 v14, 1
    v_cndmask_b32 v15, v0, v15, vcc
    buffer_store_dword v14, v15, s[8:11], s25 offen sc1
    s_lshl_b32 s25, s22, 7
    s_lshl_b32 s36, s20, 2
    s_add_u32 s36, s36, s25
    s_add_u32 s36, s36, 0x192000
    v_cmp_ne_u32 vcc, 0, v0
    v_mov_b32 v15, 0x40000000
    v_mov_b32 v14, 1
    v_cndmask_b32 v15, v0, v15, vcc
    buffer_store_dword v14, v15, s[8:11], s36 offen sc1
    s_mov_b32 s96, s54
    s_and_b32 s97, s55, 0xffff
    s_mov_b32 s98, 0x400000
    s_mov_b32 s99, 0x20000
    v_mov_b32 v15, 0x0
    v_bfe_u32 v14, v0, 0, 1
    s_mov_b32 s38, 0x10
    v_mad_u32_u24 v15, v14, s38, v15
    v_bfe_u32 v14, v0, 1, 1
    s_mov_b32 s38, 0x20
    v_mad_u32_u24 v15, v14, s38, v15
    v_bfe_u32 v14, v0, 2, 1
    s_mov_b32 s38, 0x40
    v_mad_u32_u24 v15, v14, s38, v15
    v_bfe_u32 v14, v0, 3, 1
    s_mov_b32 s38, 0x80
    v_mad_u32_u24 v15, v14, s38, v15
    v_bfe_u32 v14, v0, 4, 1
    s_mov_b32 s38, 0x1000
    v_mad_u32_u24 v15, v14, s38, v15
    v_bfe_u32 v14, v0, 5, 1
    s_mov_b32 s38, 0x2000
    v_mad_u32_u24 v15, v14, s38, v15
    v_bfe_u32 v14, v0, 6, 1
    s_mov_b32 s38, 0x100
    v_mad_u32_u24 v15, v14, s38, v15
    v_bfe_u32 v14, v0, 7, 1
    s_mov_b32 s38, 0x200
    v_mad_u32_u24 v15, v14, s38, v15
    s_lshl_b32 s36, s20, 17
    s_add_u32 s37, s36, 0x0
    buffer_load_dwordx4 v[16:19], v15, s[96:99], s37 offen
    s_add_u32 s37, s36, 0x4000
    buffer_load_dwordx4 v[20:23], v15, s[96:99], s37 offen
    s_add_u32 s37, s36, 0x400
    buffer_load_dwordx4 v[24:27], v15, s[96:99], s37 offen
    s_add_u32 s37, s36, 0x4400
    buffer_load_dwordx4 v[28:31], v15, s[96:99], s37 offen
    s_add_u32 s37, s36, 0x800
    buffer_load_dwordx4 v[32:35], v15, s[96:99], s37 offen
    s_add_u32 s37, s36, 0x4800
    buffer_load_dwordx4 v[36:39], v15, s[96:99], s37 offen
    s_add_u32 s37, s36, 0xc00
    buffer_load_dwordx4 v[40:43], v15, s[96:99], s37 offen
    s_add_u32 s37, s36, 0x4c00
    buffer_load_dwordx4 v[44:47], v15, s[96:99], s37 offen
    s_add_u32 s37, s36, 0x8000
    buffer_load_dwordx4 v[48:51], v15, s[96:99], s37 offen
    s_add_u32 s37, s36, 0xc000
    buffer_load_dwordx4 v[52:55], v15, s[96:99], s37 offen
    s_add_u32 s37, s36, 0x8400
    buffer_load_dwordx4 v[56:59], v15, s[96:99], s37 offen
    s_add_u32 s37, s36, 0xc400
    buffer_load_dwordx4 v[60:63], v15, s[96:99], s37 offen
    s_add_u32 s37, s36, 0x8800
    buffer_load_dwordx4 v[64:67], v15, s[96:99], s37 offen
    s_add_u32 s37, s36, 0xc800
    buffer_load_dwordx4 v[68:71], v15, s[96:99], s37 offen
    s_add_u32 s37, s36, 0x8c00
    buffer_load_dwordx4 v[72:75], v15, s[96:99], s37 offen
    s_add_u32 s37, s36, 0xcc00
    buffer_load_dwordx4 v[76:79], v15, s[96:99], s37 offen
    s_add_u32 s37, s36, 0x10000
    buffer_load_dwordx4 v[80:83], v15, s[96:99], s37 offen
    s_add_u32 s37, s36, 0x14000
    buffer_load_dwordx4 v[84:87], v15, s[96:99], s37 offen
    s_add_u32 s37, s36, 0x10400
    buffer_load_dwordx4 v[88:91], v15, s[96:99], s37 offen
    s_add_u32 s37, s36, 0x14400
    buffer_load_dwordx4 v[92:95], v15, s[96:99], s37 offen
    s_add_u32 s37, s36, 0x10800
    buffer_load_dwordx4 v[96:99], v15, s[96:99], s37 offen
    s_add_u32 s37, s36, 0x14800
    buffer_load_dwordx4 v[100:103], v15, s[96:99], s37 offen
    s_add_u32 s37, s36, 0x10c00
    buffer_load_dwordx4 v[104:107], v15, s[96:99], s37 offen
    s_add_u32 s37, s36, 0x14c00
    buffer_load_dwordx4 v[108:111], v15, s[96:99], s37 offen
    s_waitcnt vmcnt(16)
    v_perm_b32 v112, v20, v16, s34
    v_perm_b32 v113, v28, v24, s34
    v_perm_b32 v114, v36, v32, s34
    v_perm_b32 v115, v44, v40, s34
    ds_write_b128 v7, v[112:115] offset:0
    v_perm_b32 v116, v20, v16, s35
    v_perm_b32 v117, v28, v24, s35
    v_perm_b32 v118, v36, v32, s35
    v_perm_b32 v119, v44, v40, s35
    ds_write_b128 v7, v[116:119] offset:1024
    v_perm_b32 v120, v21, v17, s34
    v_perm_b32 v121, v29, v25, s34
    v_perm_b32 v122, v37, v33, s34
    v_perm_b32 v123, v45, v41, s34
    ds_write_b128 v7, v[120:123] offset:2048
    v_perm_b32 v124, v21, v17, s35
    v_perm_b32 v125, v29, v25, s35
    v_perm_b32 v126, v37, v33, s35
    v_perm_b32 v127, v45, v41, s35
    ds_write_b128 v7, v[124:127] offset:3072
    s_waitcnt lgkmcnt(0)
    v_perm_b32 v112, v22, v18, s34
    v_perm_b32 v113, v30, v26, s34
    v_perm_b32 v114, v38, v34, s34
    v_perm_b32 v115, v46, v42, s34
    ds_write_b128 v7, v[112:115] offset:4096
    v_perm_b32 v116, v22, v18, s35
    v_perm_b32 v117, v30, v26, s35
    v_perm_b32 v118, v38, v34, s35
    v_perm_b32 v119, v46, v42, s35
    ds_write_b128 v7, v[116:119] offset:5120
    v_perm_b32 v120, v23, v19, s34
    v_perm_b32 v121, v31, v27, s34
    v_perm_b32 v122, v39, v35, s34
    v_perm_b32 v123, v47, v43, s34
    ds_write_b128 v7, v[120:123] offset:6144
    v_perm_b32 v124, v23, v19, s35
    v_perm_b32 v125, v31, v27, s35
    v_perm_b32 v126, v39, v35, s35
    v_perm_b32 v127, v47, v43, s35
    ds_write_b128 v7, v[124:127] offset:7168
    s_waitcnt lgkmcnt(0)
    s_add_u32 s37, s36, 0x18000
    buffer_load_dwordx4 v[16:19], v15, s[96:99], s37 offen
    s_add_u32 s37, s36, 0x1c000
    buffer_load_dwordx4 v[20:23], v15, s[96:99], s37 offen
    s_add_u32 s37, s36, 0x18400
    buffer_load_dwordx4 v[24:27], v15, s[96:99], s37 offen
    s_add_u32 s37, s36, 0x1c400
    buffer_load_dwordx4 v[28:31], v15, s[96:99], s37 offen
    s_add_u32 s37, s36, 0x18800
    buffer_load_dwordx4 v[32:35], v15, s[96:99], s37 offen
    s_add_u32 s37, s36, 0x1c800
    buffer_load_dwordx4 v[36:39], v15, s[96:99], s37 offen
    s_add_u32 s37, s36, 0x18c00
    buffer_load_dwordx4 v[40:43], v15, s[96:99], s37 offen
    s_add_u32 s37, s36, 0x1cc00
    buffer_load_dwordx4 v[44:47], v15, s[96:99], s37 offen
    s_waitcnt vmcnt(16)
    v_perm_b32 v112, v52, v48, s34
    v_perm_b32 v113, v60, v56, s34
    v_perm_b32 v114, v68, v64, s34
    v_perm_b32 v115, v76, v72, s34
    ds_write_b128 v7, v[112:115] offset:8192
    v_perm_b32 v116, v52, v48, s35
    v_perm_b32 v117, v60, v56, s35
    v_perm_b32 v118, v68, v64, s35
    v_perm_b32 v119, v76, v72, s35
    ds_write_b128 v7, v[116:119] offset:9216
    v_perm_b32 v120, v53, v49, s34
    v_perm_b32 v121, v61, v57, s34
    v_perm_b32 v122, v69, v65, s34
    v_perm_b32 v123, v77, v73, s34
    ds_write_b128 v7, v[120:123] offset:10240
    v_perm_b32 v124, v53, v49, s35
    v_perm_b32 v125, v61, v57, s35
    v_perm_b32 v126, v69, v65, s35
    v_perm_b32 v127, v77, v73, s35
    ds_write_b128 v7, v[124:127] offset:11264
    s_waitcnt lgkmcnt(0)
    v_perm_b32 v112, v54, v50, s34
    v_perm_b32 v113, v62, v58, s34
    v_perm_b32 v114, v70, v66, s34
    v_perm_b32 v115, v78, v74, s34
    ds_write_b128 v7, v[112:115] offset:12288
    v_perm_b32 v116, v54, v50, s35
    v_perm_b32 v117, v62, v58, s35
    v_perm_b32 v118, v70, v66, s35
    v_perm_b32 v119, v78, v74, s35
    ds_write_b128 v7, v[116:119] offset:13312
    v_perm_b32 v120, v55, v51, s34
    v_perm_b32 v121, v63, v59, s34
    v_perm_b32 v122, v71, v67, s34
    v_perm_b32 v123, v79, v75, s34
    ds_write_b128 v7, v[120:123] offset:14336
    v_perm_b32 v124, v55, v51, s35
    v_perm_b32 v125, v63, v59, s35
    v_perm_b32 v126, v71, v67, s35
    v_perm_b32 v127, v79, v75, s35
    ds_write_b128 v7, v[124:127] offset:15360
    s_waitcnt lgkmcnt(0)
    s_waitcnt vmcnt(8)
    v_perm_b32 v112, v84, v80, s34
    v_perm_b32 v113, v92, v88, s34
    v_perm_b32 v114, v100, v96, s34
    v_perm_b32 v115, v108, v104, s34
    ds_write_b128 v7, v[112:115] offset:16384
    v_perm_b32 v116, v84, v80, s35
    v_perm_b32 v117, v92, v88, s35
    v_perm_b32 v118, v100, v96, s35
    v_perm_b32 v119, v108, v104, s35
    ds_write_b128 v7, v[116:119] offset:17408
    v_perm_b32 v120, v85, v81, s34
    v_perm_b32 v121, v93, v89, s34
    v_perm_b32 v122, v101, v97, s34
    v_perm_b32 v123, v109, v105, s34
    ds_write_b128 v7, v[120:123] offset:18432
    v_perm_b32 v124, v85, v81, s35
    v_perm_b32 v125, v93, v89, s35
    v_perm_b32 v126, v101, v97, s35
    v_perm_b32 v127, v109, v105, s35
    ds_write_b128 v7, v[124:127] offset:19456
    s_waitcnt lgkmcnt(0)
    v_perm_b32 v112, v86, v82, s34
    v_perm_b32 v113, v94, v90, s34
    v_perm_b32 v114, v102, v98, s34
    v_perm_b32 v115, v110, v106, s34
    ds_write_b128 v7, v[112:115] offset:20480
    v_perm_b32 v116, v86, v82, s35
    v_perm_b32 v117, v94, v90, s35
    v_perm_b32 v118, v102, v98, s35
    v_perm_b32 v119, v110, v106, s35
    ds_write_b128 v7, v[116:119] offset:21504
    v_perm_b32 v120, v87, v83, s34
    v_perm_b32 v121, v95, v91, s34
    v_perm_b32 v122, v103, v99, s34
    v_perm_b32 v123, v111, v107, s34
    ds_write_b128 v7, v[120:123] offset:22528
    v_perm_b32 v124, v87, v83, s35
    v_perm_b32 v125, v95, v91, s35
    v_perm_b32 v126, v103, v99, s35
    v_perm_b32 v127, v111, v107, s35
    ds_write_b128 v7, v[124:127] offset:23552
    s_waitcnt lgkmcnt(0)
    s_waitcnt vmcnt(0)
    v_perm_b32 v112, v20, v16, s34
    v_perm_b32 v113, v28, v24, s34
    v_perm_b32 v114, v36, v32, s34
    v_perm_b32 v115, v44, v40, s34
    ds_write_b128 v7, v[112:115] offset:24576
    v_perm_b32 v116, v20, v16, s35
    v_perm_b32 v117, v28, v24, s35
    v_perm_b32 v118, v36, v32, s35
    v_perm_b32 v119, v44, v40, s35
    ds_write_b128 v7, v[116:119] offset:25600
    v_perm_b32 v120, v21, v17, s34
    v_perm_b32 v121, v29, v25, s34
    v_perm_b32 v122, v37, v33, s34
    v_perm_b32 v123, v45, v41, s34
    ds_write_b128 v7, v[120:123] offset:26624
    v_perm_b32 v124, v21, v17, s35
    v_perm_b32 v125, v29, v25, s35
    v_perm_b32 v126, v37, v33, s35
    v_perm_b32 v127, v45, v41, s35
    ds_write_b128 v7, v[124:127] offset:27648
    s_waitcnt lgkmcnt(0)
    v_perm_b32 v112, v22, v18, s34
    v_perm_b32 v113, v30, v26, s34
    v_perm_b32 v114, v38, v34, s34
    v_perm_b32 v115, v46, v42, s34
    ds_write_b128 v7, v[112:115] offset:28672
    v_perm_b32 v116, v22, v18, s35
    v_perm_b32 v117, v30, v26, s35
    v_perm_b32 v118, v38, v34, s35
    v_perm_b32 v119, v46, v42, s35
    ds_write_b128 v7, v[116:119] offset:29696
    v_perm_b32 v120, v23, v19, s34
    v_perm_b32 v121, v31, v27, s34
    v_perm_b32 v122, v39, v35, s34
    v_perm_b32 v123, v47, v43, s34
    ds_write_b128 v7, v[120:123] offset:30720
    v_perm_b32 v124, v23, v19, s35
    v_perm_b32 v125, v31, v27, s35
    v_perm_b32 v126, v39, v35, s35
    v_perm_b32 v127, v47, v43, s35
    ds_write_b128 v7, v[124:127] offset:31744
    s_waitcnt lgkmcnt(0)
    s_lshl_b32 s25, s22, 7
    s_add_u32 s25, s25, 0x192000
    v_lshrrev_b32 v15, 2, v1
    v_and_b32 v15, 127, v15
L_TPI:
    buffer_load_dword v14, v15, s[8:11], s25 offen sc1
    s_add_u32 s32, s32, 1
    s_cmp_gt_u32 s32, 200000
    s_waitcnt vmcnt(0)
    s_cbranch_scc1 L_TPI_ok
    v_cmp_eq_u32 vcc, 0, v14
    s_cbranch_vccz L_TPI_ok
    s_sleep 8
    s_branch L_TPI
L_TPI_ok:
    s_mov_b32 s23, s22
    s_mov_b32 s29, 0
L_P2:
    s_and_b32 s36, s29, 1
    s_lshl_b32 s36, s36, 20
    s_lshl_b32 s26, s22, 21
    s_add_u32 s26, s26, s36
    s_add_u32 s26, s26, 0x4000000
    s_bfe_u32 s27, s29, 0x10001
    s_mul_i32 s24, s23, 0x82000
    s_lshl_b32 s36, s20, 14
    s_add_u32 s24, s24, s36
    s_add_u32 s24, s24, 0x1000000
    s_add_u32 s36, s24, 0
    s_add_u32 s37, s36, 0x7000000
    buffer_load_dwordx4 v[48:51], v1, s[8:11], s36 offen offset:0 sc1
    buffer_load_dwordx4 v[16:19], v1, s[8:11], s37 offen offset:0 sc1
    buffer_load_dwordx4 v[52:55], v1, s[8:11], s36 offen offset:1024 sc1
    buffer_load_dwordx4 v[20:23], v1, s[8:11], s37 offen offset:1024 sc1
    buffer_load_dwordx4 v[56:59], v1, s[8:11], s36 offen offset:2048 sc1
    buffer_load_dwordx4 v[24:27], v1, s[8:11], s37 offen offset:2048 sc1
    buffer_load_dwordx4 v[60:63], v1, s[8:11], s36 offen offset:3072 sc1
    buffer_load_dwordx4 v[28:31], v1, s[8:11], s37 offen offset:3072 sc1
    s_add_u32 s36, s24, 4096
    s_add_u32 s37, s36, 0x7000000
    buffer_load_dwordx4 v[64:67], v1, s[8:11], s36 offen offset:0 sc1
    buffer_load_dwordx4 v[32:35], v1, s[8:11], s37 offen offset:0 sc1
    buffer_load_dwordx4 v[68:71], v1, s[8:11], s36 offen offset:1024 sc1
    buffer_load_dwordx4 v[36:39], v1, s[8:11], s37 offen offset:1024 sc1
    buffer_load_dwordx4 v[72:75], v1, s[8:11], s36 offen offset:2048 sc1
    buffer_load_dwordx4 v[40:43], v1, s[8:11], s37 offen offset:2048 sc1
    buffer_load_dwordx4 v[76:79], v1, s[8:11], s36 offen offset:3072 sc1
    buffer_load_dwordx4 v[44:47], v1, s[8:11], s37 offen offset:3072 sc1
    s_add_u32 s24, s24, 8192
    buffer_load_dwordx4 v[120:123], v2, s[8:11], s24 offen sc1
    buffer_load_dwordx4 v[124:127], v2, s[8:11], s24 offen offset:1024 sc1
    s_waitcnt vmcnt(0)
    s_cmp_lt_u32 s21, 2
    s_cbranch_scc1 L_P2_noswap
    v_swap_b32 v120, v122
    v_swap_b32 v121, v123
    v_swap_b32 v124, v126
    v_swap_b32 v125, v127
L_P2_noswap:
    s_nop 1
    v_mfma_f32_16x16x32_bf16 v[80:83], v[48:51], v[16:19], 0
    v_mfma_f32_16x16x32_bf16 v[80:83], v[52:55], v[20:23], v[80:83]
    v_mfma_f32_16x16x32_bf16 v[80:83], v[56:59], v[24:27], v[80:83]
    v_mfma_f32_16x16x32_bf16 v[80:83], v[60:63], v[28:31], v[80:83]
    v_mfma_f32_16x16x32_bf16 v[84:87], v[48:51], v[32:35], 0
    v_mfma_f32_16x16x32_bf16 v[84:87], v[52:55], v[36:39], v[84:87]
    v_mfma_f32_16x16x32_bf16 v[84:87], v[56:59], v[40:43], v[84:87]
    v_mfma_f32_16x16x32_bf16 v[84:87], v[60:63], v[44:47], v[84:87]
    v_mfma_f32_16x16x32_bf16 v[88:91], v[64:67], v[32:35], 0
    v_mfma_f32_16x16x32_bf16 v[88:91], v[68:71], v[36:39], v[88:91]
    v_mfma_f32_16x16x32_bf16 v[88:91], v[72:75], v[40:43], v[88:91]
    v_mfma_f32_16x16x32_bf16 v[88:91], v[76:79], v[44:47], v[88:91]
    s_lshl_b32 s24, s23, 13
    s_add_u32 s24, s24, 0x100000
    s_max_u32 s25, s23, 1
    s_lshl_b32 s25, s25, 13
    s_add_u32 s25, s25, 0xfe000
L_P2_far:
    buffer_load_dword v14, v2, s[8:11], s25 offen sc1
    s_add_u32 s32, s32, 1
    s_cmp_gt_u32 s32, 200000
    s_waitcnt vmcnt(0)
    s_cbranch_scc1 L_P2_poll
    v_cmp_eq_u32 vcc, -1, v14
    s_cbranch_vccz L_P2_poll
    s_sleep 12
    s_branch L_P2_far
L_P2_poll:
    buffer_load_dwordx4 v[48:51], v2, s[8:11], s24 offen sc1
    buffer_load_dwordx4 v[52:55], v2, s[8:11], s24 offen offset:1024 sc1
    s_add_u32 s32, s32, 1
    s_cmp_gt_u32 s32, 200000
    s_waitcnt vmcnt(0)
    v_max3_u32 v14, v48, v49, v50
    v_max3_u32 v15, v51, v52, v53
    v_max3_u32 v14, v14, v54, v55
    v_max_u32 v14, v14, v15
    s_cbranch_scc1 L_P2_got
    v_cmp_eq_u32 vcc, -1, v14
    s_cbranch_vccnz L_P2_poll
L_P2_got:
    ds_write_b128 v2, v[48:51] offset:20480
    ds_write_b128 v2, v[52:55] offset:21504
    s_waitcnt lgkmcnt(0)
    s_barrier
    ds_read_b128 v[48:51], v8 offset:0
    ds_read_b128 v[52:55], v8 offset:2048
    ds_read_b128 v[56:59], v8 offset:4096
    ds_read_b128 v[60:63], v8 offset:6144
    ds_read_b128 v[64:67], v8 offset:512
    s_waitcnt lgkmcnt(4)
    v_mfma_f32_16x16x32_bf16 v[100:103], a[128:131], v[48:51], 0
    v_mfma_f32_16x16x32_bf16 v[104:107], a[132:135], v[48:51], 0
    v_mfma_f32_16x16x32_bf16 v[108:111], v[48:51], v[128:131], 0
    v_mfma_f32_16x16x32_bf16 v[112:115], v[48:51], v[132:135], 0
    ds_read_b128 v[68:71], v8 offset:2560
    s_waitcnt lgkmcnt(4)
    v_mfma_f32_16x16x32_bf16 v[100:103], a[136:139], v[52:55], v[100:103]
    v_mfma_f32_16x16x32_bf16 v[104:107], a[140:143], v[52:55], v[104:107]
    v_mfma_f32_16x16x32_bf16 v[108:111], v[52:55], v[136:139], v[108:111]
    v_mfma_f32_16x16x32_bf16 v[112:115], v[52:55], v[140:143], v[112:115]
    ds_read_b128 v[72:75], v8 offset:4608
    s_waitcnt lgkmcnt(4)
    v_mfma_f32_16x16x32_bf16 v[100:103], a[144:147], v[56:59], v[100:103]
    v_mfma_f32_16x16x32_bf16 v[104:107], a[148:151], v[56:59], v[104:107]
    v_mfma_f32_16x16x32_bf16 v[108:111], v[56:59], v[144:147], v[108:111]
    v_mfma_f32_16x16x32_bf16 v[112:115], v[56:59], v[148:151], v[112:115]
    ds_read_b128 v[76:79], v8 offset:6656
    s_waitcnt lgkmcnt(4)
    v_mfma_f32_16x16x32_bf16 v[100:103], a[152:155], v[60:63], v[100:103]
    v_mfma_f32_16x16x32_bf16 v[104:107], a[156:159], v[60:63], v[104:107]
    v_mfma_f32_16x16x32_bf16 v[108:111], v[60:63], v[152:155], v[108:111]
    v_mfma_f32_16x16x32_bf16 v[112:115], v[60:63], v[156:159], v[112:115]
    ds_read_b128 v[48:51], v8 offset:1024
    s_waitcnt lgkmcnt(4)
    v_mfma_f32_16x16x32_bf16 v[100:103], a[160:163], v[64:67], v[100:103]
    v_mfma_f32_16x16x32_bf16 v[104:107], a[164:167], v[64:67], v[104:107]
    v_mfma_f32_16x16x32_bf16 v[108:111], v[64:67], v[160:163], v[108:111]
    v_mfma_f32_16x16x32_bf16 v[112:115], v[64:67], v[164:167], v[112:115]
    ds_read_b128 v[52:55], v8 offset:3072
    s_waitcnt lgkmcnt(4)
    v_mfma_f32_16x16x32_bf16 v[100:103], a[168:171], v[68:71], v[100:103]
    v_mfma_f32_16x16x32_bf16 v[104:107], a[172:175], v[68:71], v[104:107]
    v_mfma_f32_16x16x32_bf16 v[108:111], v[68:71], v[168:171], v[108:111]
    v_mfma_f32_16x16x32_bf16 v[112:115], v[68:71], v[172:175], v[112:115]
    ds_read_b128 v[56:59], v8 offset:5120
    s_waitcnt lgkmcnt(4)
    v_mfma_f32_16x16x32_bf16 v[100:103], a[176:179], v[72:75], v[100:103]
    v_mfma_f32_16x16x32_bf16 v[104:107], a[180:183], v[72:75], v[104:107]
    v_mfma_f32_16x16x32_bf16 v[108:111], v[72:75], v[176:179], v[108:111]
    v_mfma_f32_16x16x32_bf16 v[112:115], v[72:75], v[180:183], v[112:115]
    ds_read_b128 v[60:63], v8 offset:7168
    s_waitcnt lgkmcnt(4)
    v_mfma_f32_16x16x32_bf16 v[100:103], a[184:187], v[76:79], v[100:103]
    v_mfma_f32_16x16x32_bf16 v[104:107], a[188:191], v[76:79], v[104:107]
    v_mfma_f32_16x16x32_bf16 v[108:111], v[76:79], v[184:187], v[108:111]
    v_mfma_f32_16x16x32_bf16 v[112:115], v[76:79], v[188:191], v[112:115]
    ds_read_b128 v[64:67], v8 offset:1536
    s_waitcnt lgkmcnt(4)
    v_mfma_f32_16x16x32_bf16 v[100:103], a[192:195], v[48:51], v[100:103]
    v_mfma_f32_16x16x32_bf16 v[104:107], a[196:199], v[48:51], v[104:107]
    v_mfma_f32_16x16x32_bf16 v[108:111], v[48:51], v[192:195], v[108:111]
    v_mfma_f32_16x16x32_bf16 v[112:115], v[48:51], v[196:199], v[112:115]
    ds_read_b128 v[68:71], v8 offset:3584
    s_waitcnt lgkmcnt(4)
    v_mfma_f32_16x16x32_bf16 v[100:103], a[200:203], v[52:55], v[100:103]
    v_mfma_f32_16x16x32_bf16 v[104:107], a[204:207], v[52:55], v[104:107]
    v_mfma_f32_16x16x32_bf16 v[108:111], v[52:55], v[200:203], v[108:111]
    v_mfma_f32_16x16x32_bf16 v[112:115], v[52:55], v[204:207], v[112:115]
    ds_read_b128 v[72:75], v8 offset:5632
    s_waitcnt lgkmcnt(4)
    v_mfma_f32_16x16x32_bf16 v[100:103], a[208:211], v[56:59], v[100:103]
    v_mfma_f32_16x16x32_bf16 v[104:107], a[212:215], v[56:59], v[104:107]
    v_mfma_f32_16x16x32_bf16 v[108:111], v[56:59], v[208:211], v[108:111]
    v_mfma_f32_16x16x32_bf16 v[112:115], v[56:59], v[212:215], v[112:115]
    ds_read_b128 v[76:79], v8 offset:7680
    s_waitcnt lgkmcnt(4)
    v_mfma_f32_16x16x32_bf16 v[100:103], a[216:219], v[60:63], v[100:103]
    v_mfma_f32_16x16x32_bf16 v[104:107], a[220:223], v[60:63], v[104:107]
    v_mfma_f32_16x16x32_bf16 v[108:111], v[60:63], v[216:219], v[108:111]
    v_mfma_f32_16x16x32_bf16 v[112:115], v[60:63], v[220:223], v[112:115]
    s_waitcnt lgkmcnt(3)
    v_mfma_f32_16x16x32_bf16 v[100:103], a[224:227], v[64:67], v[100:103]
    v_mfma_f32_16x16x32_bf16 v[104:107], a[228:231], v[64:67], v[104:107]
    v_mfma_f32_16x16x32_bf16 v[108:111], v[64:67], v[224:227], v[108:111]
    v_mfma_f32_16x16x32_bf16 v[112:115], v[64:67], v[228:231], v[112:115]
    s_waitcnt lgkmcnt(2)
    v_mfma_f32_16x16x32_bf16 v[100:103], a[232:235], v[68:71], v[100:103]
    v_mfma_f32_16x16x32_bf16 v[104:107], a[236:239], v[68:71], v[104:107]
    v_mfma_f32_16x16x32_bf16 v[108:111], v[68:71], v[232:235], v[108:111]
    v_mfma_f32_16x16x32_bf16 v[112:115], v[68:71], v[236:239], v[112:115]
    s_waitcnt lgkmcnt(1)
    v_mfma_f32_16x16x32_bf16 v[100:103], a[240:243], v[72:75], v[100:103]
    v_mfma_f32_16x16x32_bf16 v[104:107], a[244:247], v[72:75], v[104:107]
    v_mfma_f32_16x16x32_bf16 v[108:111], v[72:75], v[240:243], v[108:111]
    v_mfma_f32_16x16x32_bf16 v[112:115], v[72:75], v[244:247], v[112:115]
    s_waitcnt lgkmcnt(0)
    v_mfma_f32_16x16x32_bf16 v[100:103], a[248:251], v[76:79], v[100:103]
    v_mfma_f32_16x16x32_bf16 v[104:107], a[252:255], v[76:79], v[104:107]
    v_mfma_f32_16x16x32_bf16 v[108:111], v[76:79], v[248:251], v[108:111]
    v_mfma_f32_16x16x32_bf16 v[112:115], v[76:79], v[252:255], v[112:115]
    s_nop 4
    v_mul_f32 v100, s33, v100
    v_mul_f32 v101, s33, v101
    v_mul_f32 v102, s33, v102
    v_mul_f32 v103, s33, v103
    v_mul_f32 v104, s33, v104
    v_mul_f32 v105, s33, v105
    v_mul_f32 v106, s33, v106
    v_mul_f32 v107, s33, v107
    v_cvt_pk_bf16_f32 v48, v100, v104
    v_cvt_pk_bf16_f32 v49, v101, v105
    v_cvt_pk_bf16_f32 v50, v102, v106
    v_cvt_pk_bf16_f32 v51, v103, v107
    ds_write_b128 v9, v[48:51] offset:16384
    v_cvt_pk_bf16_f32 v116, v108, v109
    v_cvt_pk_bf16_f32 v117, v110, v111
    v_cvt_pk_bf16_f32 v118, v112, v113
    v_cvt_pk_bf16_f32 v119, v114, v115
    s_waitcnt lgkmcnt(0)
    s_barrier
    ds_read_b128 v[64:67], v1 offset:16384
    ds_read_b128 v[68:71], v1 offset:17408
    ds_read_b128 v[72:75], v1 offset:18432
    ds_read_b128 v[76:79], v1 offset:19456
    v_cndmask_b32 v80, v13, v80, s[64:65]
    v_cndmask_b32 v81, v13, v81, s[66:67]
    v_cndmask_b32 v82, v13, v82, s[68:69]
    v_cndmask_b32 v83, v13, v83, s[70:71]
    v_cndmask_b32 v88, v13, v88, s[64:65]
    v_cndmask_b32 v89, v13, v89, s[66:67]
    v_cndmask_b32 v90, v13, v90, s[68:69]
    v_cndmask_b32 v91, v13, v91, s[70:71]
    s_waitcnt lgkmcnt(0)
    v_mfma_f32_16x16x32_bf16 v[92:95], v[64:67], v[16:19], 0
    v_mfma_f32_16x16x32_bf16 v[92:95], v[68:71], v[20:23], v[92:95]
    v_mfma_f32_16x16x32_bf16 v[92:95], v[72:75], v[24:27], v[92:95]
    v_mfma_f32_16x16x32_bf16 v[92:95], v[76:79], v[28:31], v[92:95]
    v_mfma_f32_16x16x32_bf16 v[96:99], v[64:67], v[32:35], 0
    v_mfma_f32_16x16x32_bf16 v[96:99], v[68:71], v[36:39], v[96:99]
    v_mfma_f32_16x16x32_bf16 v[96:99], v[72:75], v[40:43], v[96:99]
    v_mfma_f32_16x16x32_bf16 v[96:99], v[76:79], v[44:47], v[96:99]
    s_nop 3
    v_cndmask_b32 v92, v13, v92, s[72:73]
    v_cndmask_b32 v93, v13, v93, s[72:73]
    v_cndmask_b32 v94, v13, v94, s[72:73]
    v_cndmask_b32 v95, v13, v95, s[72:73]
    v_cndmask_b32 v96, v13, v96, s[72:73]
    v_cndmask_b32 v97, v13, v97, s[72:73]
    v_cndmask_b32 v98, v13, v98, s[72:73]
    v_cndmask_b32 v99, v13, v99, s[72:73]
    v_max_f32 v48, v80, v81
    v_max3_f32 v48, v48, v82, v83
    v_max3_f32 v48, v48, v92, v93
    v_max3_f32 v48, v48, v94, v95
    v_max_f32 v49, v84, v85
    v_max3_f32 v49, v49, v86, v87
    v_max3_f32 v49, v49, v88, v89
    v_max3_f32 v49, v49, v90, v91
    v_max3_f32 v49, v49, v96, v97
    v_max3_f32 v49, v49, v98, v99
    v_mov_b32 v14, v48
    s_nop 1
    v_permlane16_swap_b32 v48, v14
    v_max_f32 v48, v48, v14
    v_mov_b32 v14, v49
    s_nop 1
    v_permlane16_swap_b32 v49, v14
    v_max_f32 v49, v49, v14
    v_mov_b32 v14, v48
    s_nop 1
    v_permlane32_swap_b32 v48, v14
    v_max_f32 v48, v48, v14
    v_mov_b32 v14, v49
    s_nop 1
    v_permlane32_swap_b32 v49, v14
    v_max_f32 v49, v49, v14
    v_sub_f32 v80, v80, v48
    v_exp_f32 v80, v80
    v_sub_f32 v81, v81, v48
    v_exp_f32 v81, v81
    v_sub_f32 v82, v82, v48
    v_exp_f32 v82, v82
    v_sub_f32 v83, v83, v48
    v_exp_f32 v83, v83
    v_sub_f32 v92, v92, v48
    v_exp_f32 v92, v92
    v_sub_f32 v93, v93, v48
    v_exp_f32 v93, v93
    v_sub_f32 v94, v94, v48
    v_exp_f32 v94, v94
    v_sub_f32 v95, v95, v48
    v_exp_f32 v95, v95
    v_sub_f32 v84, v84, v49
    v_exp_f32 v84, v84
    v_sub_f32 v85, v85, v49
    v_exp_f32 v85, v85
    v_sub_f32 v86, v86, v49
    v_exp_f32 v86, v86
    v_sub_f32 v87, v87, v49
    v_exp_f32 v87, v87
    v_sub_f32 v88, v88, v49
    v_exp_f32 v88, v88
    v_sub_f32 v89, v89, v49
    v_exp_f32 v89, v89
    v_sub_f32 v90, v90, v49
    v_exp_f32 v90, v90
    v_sub_f32 v91, v91, v49
    v_exp_f32 v91, v91
    v_sub_f32 v96, v96, v49
    v_exp_f32 v96, v96
    v_sub_f32 v97, v97, v49
    v_exp_f32 v97, v97
    v_sub_f32 v98, v98, v49
    v_exp_f32 v98, v98
    v_sub_f32 v99, v99, v49
    v_exp_f32 v99, v99
    v_cvt_pk_bf16_f32 v16, v80, v81
    v_cvt_pk_bf16_f32 v17, v82, v83
    v_mov_b64 v[18:19], 0
    v_cvt_pk_bf16_f32 v20, v84, v85
    v_cvt_pk_bf16_f32 v21, v86, v87
    v_cvt_pk_bf16_f32 v22, v88, v89
    v_cvt_pk_bf16_f32 v23, v90, v91
    v_cvt_pk_bf16_f32 v24, v92, v93
    v_cvt_pk_bf16_f32 v25, v94, v95
    v_cvt_pk_bf16_f32 v26, v96, v97
    v_cvt_pk_bf16_f32 v27, v98, v99
    v_mov_b64 v[28:29], s[4:5]
    v_mov_b64 v[30:31], s[4:5]
    s_nop 1
    v_mfma_f32_16x16x32_bf16 v[32:35], v[28:31], v[16:19], 0
    v_mfma_f32_16x16x32_bf16 v[40:43], v[120:123], v[16:19], 0
    v_mfma_f32_16x16x32_bf16 v[44:47], v[124:127], v[16:19], 0
    v_mfma_f32_16x16x32_bf16 v[36:39], v[28:31], v[20:23], 0
    v_mfma_f32_16x16x32_bf16 v[48:51], v[120:123], v[20:23], 0
    v_mfma_f32_16x16x32_bf16 v[52:55], v[124:127], v[20:23], 0
    s_nop 0
    v_mfma_f32_16x16x16_bf16 v[32:35], v[28:29], v[24:25], v[32:35]
    v_mfma_f32_16x16x16_bf16 v[40:43], v[116:117], v[24:25], v[40:43]
    v_mfma_f32_16x16x16_bf16 v[44:47], v[118:119], v[24:25], v[44:47]
    v_mfma_f32_16x16x16_bf16 v[36:39], v[28:29], v[26:27], v[36:39]
    v_mfma_f32_16x16x16_bf16 v[48:51], v[116:117], v[26:27], v[48:51]
    v_mfma_f32_16x16x16_bf16 v[52:55], v[118:119], v[26:27], v[52:55]
    s_nop 2
    v_rcp_f32 v14, v32
    s_nop 0
    v_mul_f32 v40, v40, v14
    v_mul_f32 v41, v41, v14
    v_mul_f32 v42, v42, v14
    v_mul_f32 v43, v43, v14
    v_mul_f32 v44, v44, v14
    v_mul_f32 v45, v45, v14
    v_mul_f32 v46, v46, v14
    v_mul_f32 v47, v47, v14
    v_cvt_pk_bf16_f32 v56, v40, v44
    v_cvt_pk_bf16_f32 v57, v41, v45
    v_cvt_pk_bf16_f32 v58, v42, v46
    v_cvt_pk_bf16_f32 v59, v43, v47
    ds_write_b128 v9, v[56:59] offset:0
    v_rcp_f32 v14, v36
    s_nop 0
    v_mul_f32 v48, v48, v14
    v_mul_f32 v49, v49, v14
    v_mul_f32 v50, v50, v14
    v_mul_f32 v51, v51, v14
    v_mul_f32 v52, v52, v14
    v_mul_f32 v53, v53, v14
    v_mul_f32 v54, v54, v14
    v_mul_f32 v55, v55, v14
    v_cvt_pk_bf16_f32 v60, v48, v52
    v_cvt_pk_bf16_f32 v61, v49, v53
    v_cvt_pk_bf16_f32 v62, v50, v54
    v_cvt_pk_bf16_f32 v63, v51, v55
    ds_write_b128 v9, v[60:63] offset:4096
    s_waitcnt lgkmcnt(0)
    s_barrier
    ds_read_b128 v[16:19], v1 offset:0
    ds_read_b128 v[20:23], v1 offset:1024
    ds_read_b128 v[24:27], v1 offset:2048
    ds_read_b128 v[28:31], v1 offset:3072
    ds_read_b128 v[32:35], v1 offset:4096
    ds_read_b128 v[36:39], v1 offset:5120
    ds_read_b128 v[40:43], v1 offset:6144
    ds_read_b128 v[44:47], v1 offset:7168
    ds_read_b128 v[48:51], v7 offset:0
    ds_read_b128 v[52:55], v7 offset:1024
    ds_read_b128 v[56:59], v7 offset:2048
    ds_read_b128 v[60:63], v7 offset:3072
    s_waitcnt lgkmcnt(3)
    v_mfma_f32_16x16x32_bf16 v[64:67], v[16:19], v[48:51], 0
    v_mfma_f32_16x16x32_bf16 v[96:99], v[32:35], v[48:51], 0
    ds_read_b128 v[48:51], v7 offset:4096
    s_waitcnt lgkmcnt(3)
    v_mfma_f32_16x16x32_bf16 v[68:71], v[16:19], v[52:55], 0
    v_mfma_f32_16x16x32_bf16 v[100:103], v[32:35], v[52:55], 0
    ds_read_b128 v[52:55], v7 offset:5120
    s_waitcnt lgkmcnt(3)
    v_mfma_f32_16x16x32_bf16 v[72:75], v[16:19], v[56:59], 0
    v_mfma_f32_16x16x32_bf16 v[104:107], v[32:35], v[56:59], 0
    ds_read_b128 v[56:59], v7 offset:6144
    s_waitcnt lgkmcnt(3)
    v_mfma_f32_16x16x32_bf16 v[76:79], v[16:19], v[60:63], 0
    v_mfma_f32_16x16x32_bf16 v[108:111], v[32:35], v[60:63], 0
    ds_read_b128 v[60:63], v7 offset:7168
    s_waitcnt lgkmcnt(3)
    v_mfma_f32_16x16x32_bf16 v[80:83], v[16:19], v[48:51], 0
    v_mfma_f32_16x16x32_bf16 v[112:115], v[32:35], v[48:51], 0
    ds_read_b128 v[48:51], v7 offset:8192
    s_waitcnt lgkmcnt(3)
    v_mfma_f32_16x16x32_bf16 v[84:87], v[16:19], v[52:55], 0
    v_mfma_f32_16x16x32_bf16 v[116:119], v[32:35], v[52:55], 0
    ds_read_b128 v[52:55], v7 offset:9216
    s_waitcnt lgkmcnt(3)
    v_mfma_f32_16x16x32_bf16 v[88:91], v[16:19], v[56:59], 0
    v_mfma_f32_16x16x32_bf16 v[120:123], v[32:35], v[56:59], 0
    ds_read_b128 v[56:59], v7 offset:10240
    s_waitcnt lgkmcnt(3)
    v_mfma_f32_16x16x32_bf16 v[92:95], v[16:19], v[60:63], 0
    v_mfma_f32_16x16x32_bf16 v[124:127], v[32:35], v[60:63], 0
    ds_read_b128 v[60:63], v7 offset:11264
    s_waitcnt lgkmcnt(3)
    v_mfma_f32_16x16x32_bf16 v[64:67], v[20:23], v[48:51], v[64:67]
    v_mfma_f32_16x16x32_bf16 v[96:99], v[36:39], v[48:51], v[96:99]
    ds_read_b128 v[48:51], v7 offset:12288
    s_waitcnt lgkmcnt(3)
    v_mfma_f32_16x16x32_bf16 v[68:71], v[20:23], v[52:55], v[68:71]
    v_mfma_f32_16x16x32_bf16 v[100:103], v[36:39], v[52:55], v[100:103]
    ds_read_b128 v[52:55], v7 offset:13312
    s_waitcnt lgkmcnt(3)
    v_mfma_f32_16x16x32_bf16 v[72:75], v[20:23], v[56:59], v[72:75]
    v_mfma_f32_16x16x32_bf16 v[104:107], v[36:39], v[56:59], v[104:107]
    ds_read_b128 v[56:59], v7 offset:14336
    s_waitcnt lgkmcnt(3)
    v_mfma_f32_16x16x32_bf16 v[76:79], v[20:23], v[60:63], v[76:79]
    v_mfma_f32_16x16x32_bf16 v[108:111], v[36:39], v[60:63], v[108:111]
    ds_read_b128 v[60:63], v7 offset:15360
    s_waitcnt lgkmcnt(3)
    v_mfma_f32_16x16x32_bf16 v[80:83], v[20:23], v[48:51], v[80:83]
    v_mfma_f32_16x16x32_bf16 v[112:115], v[36:39], v[48:51], v[112:115]
    ds_read_b128 v[48:51], v7 offset:16384
    s_waitcnt lgkmcnt(3)
    v_mfma_f32_16x16x32_bf16 v[84:87], v[20:23], v[52:55], v[84:87]
    v_mfma_f32_16x16x32_bf16 v[116:119], v[36:39], v[52:55], v[116:119]
    ds_read_b128 v[52:55], v7 offset:17408
    s_waitcnt lgkmcnt(3)
    v_mfma_f32_16x16x32_bf16 v[88:91], v[20:23], v[56:59], v[88:91]
    v_mfma_f32_16x16x32_bf16 v[120:123], v[36:39], v[56:59], v[120:123]
    ds_read_b128 v[56:59], v7 offset:18432
    s_waitcnt lgkmcnt(3)
    v_mfma_f32_16x16x32_bf16 v[92:95], v[20:23], v[60:63], v[92:95]
    v_mfma_f32_16x16x32_bf16 v[124:127], v[36:39], v[60:63], v[124:127]
    ds_read_b128 v[60:63], v7 offset:19456
    s_waitcnt lgkmcnt(3)
    v_mfma_f32_16x16x32_bf16 v[64:67], v[24:27], v[48:51], v[64:67]
    v_mfma_f32_16x16x32_bf16 v[96:99], v[40:43], v[48:51], v[96:99]
    ds_read_b128 v[48:51], v7 offset:20480
    s_waitcnt lgkmcnt(3)
    v_mfma_f32_16x16x32_bf16 v[68:71], v[24:27], v[52:55], v[68:71]
    v_mfma_f32_16x16x32_bf16 v[100:103], v[40:43], v[52:55], v[100:103]
    ds_read_b128 v[52:55], v7 offset:21504
    s_waitcnt lgkmcnt(3)
    v_mfma_f32_16x16x32_bf16 v[72:75], v[24:27], v[56:59], v[72:75]
    v_mfma_f32_16x16x32_bf16 v[104:107], v[40:43], v[56:59], v[104:107]
    ds_read_b128 v[56:59], v7 offset:22528
    s_waitcnt lgkmcnt(3)
    v_mfma_f32_16x16x32_bf16 v[76:79], v[24:27], v[60:63], v[76:79]
    v_mfma_f32_16x16x32_bf16 v[108:111], v[40:43], v[60:63], v[108:111]
    ds_read_b128 v[60:63], v7 offset:23552
    s_waitcnt lgkmcnt(3)
    v_mfma_f32_16x16x32_bf16 v[80:83], v[24:27], v[48:51], v[80:83]
    v_mfma_f32_16x16x32_bf16 v[112:115], v[40:43], v[48:51], v[112:115]
    ds_read_b128 v[48:51], v7 offset:24576
    s_waitcnt lgkmcnt(3)
    v_mfma_f32_16x16x32_bf16 v[84:87], v[24:27], v[52:55], v[84:87]
    v_mfma_f32_16x16x32_bf16 v[116:119], v[40:43], v[52:55], v[116:119]
    ds_read_b128 v[52:55], v7 offset:25600
    s_waitcnt lgkmcnt(3)
    v_mfma_f32_16x16x32_bf16 v[88:91], v[24:27], v[56:59], v[88:91]
    v_mfma_f32_16x16x32_bf16 v[120:123], v[40:43], v[56:59], v[120:123]
    ds_read_b128 v[56:59], v7 offset:26624
    s_waitcnt lgkmcnt(3)
    v_mfma_f32_16x16x32_bf16 v[92:95], v[24:27], v[60:63], v[92:95]
    v_mfma_f32_16x16x32_bf16 v[124:127], v[40:43], v[60:63], v[124:127]
    ds_read_b128 v[60:63], v7 offset:27648
    s_waitcnt lgkmcnt(3)
    v_mfma_f32_16x16x32_bf16 v[64:67], v[28:31], v[48:51], v[64:67]
    v_mfma_f32_16x16x32_bf16 v[96:99], v[44:47], v[48:51], v[96:99]
    ds_read_b128 v[48:51], v7 offset:28672
    s_waitcnt lgkmcnt(3)
    v_mfma_f32_16x16x32_bf16 v[68:71], v[28:31], v[52:55], v[68:71]
    v_mfma_f32_16x16x32_bf16 v[100:103], v[44:47], v[52:55], v[100:103]
    ds_read_b128 v[52:55], v7 offset:29696
    s_waitcnt lgkmcnt(3)
    v_mfma_f32_16x16x32_bf16 v[72:75], v[28:31], v[56:59], v[72:75]
    v_mfma_f32_16x16x32_bf16 v[104:107], v[44:47], v[56:59], v[104:107]
    ds_read_b128 v[56:59], v7 offset:30720
    s_waitcnt lgkmcnt(3)
    v_mfma_f32_16x16x32_bf16 v[76:79], v[28:31], v[60:63], v[76:79]
    v_mfma_f32_16x16x32_bf16 v[108:111], v[44:47], v[60:63], v[108:111]
    ds_read_b128 v[60:63], v7 offset:31744
    s_waitcnt lgkmcnt(3)
    v_mfma_f32_16x16x32_bf16 v[80:83], v[28:31], v[48:51], v[80:83]
    v_mfma_f32_16x16x32_bf16 v[112:115], v[44:47], v[48:51], v[112:115]
    s_waitcnt lgkmcnt(2)
    v_mfma_f32_16x16x32_bf16 v[84:87], v[28:31], v[52:55], v[84:87]
    v_mfma_f32_16x16x32_bf16 v[116:119], v[44:47], v[52:55], v[116:119]
    s_waitcnt lgkmcnt(1)
    v_mfma_f32_16x16x32_bf16 v[88:91], v[28:31], v[56:59], v[88:91]
    v_mfma_f32_16x16x32_bf16 v[120:123], v[44:47], v[56:59], v[120:123]
    s_waitcnt lgkmcnt(0)
    v_mfma_f32_16x16x32_bf16 v[92:95], v[28:31], v[60:63], v[92:95]
    v_mfma_f32_16x16x32_bf16 v[124:127], v[44:47], v[60:63], v[124:127]
    s_lshl_b32 s36, s20, 10
    s_add_u32 s24, s26, s36
    v_cvt_pk_bf16_f32 v16, v64, v68
    v_cvt_pk_bf16_f32 v17, v72, v76
    v_cvt_pk_bf16_f32 v18, v80, v84
    s_nop 1
    v_cvt_pk_bf16_f32 v19, v88, v92
    v_and_or_b32 v16, v16, -2, s27
    s_add_u32 s36, s24, 0x0
    buffer_store_dwordx4 v[16:19], v10, s[8:11], s36 offen sc1
    v_cvt_pk_bf16_f32 v20, v65, v69
    v_cvt_pk_bf16_f32 v21, v73, v77
    v_cvt_pk_bf16_f32 v22, v81, v85
    v_cvt_pk_bf16_f32 v23, v89, v93
    v_and_or_b32 v20, v20, -2, s27
    s_add_u32 s36, s24, 0x8000
    buffer_store_dwordx4 v[20:23], v10, s[8:11], s36 offen sc1
    v_cvt_pk_bf16_f32 v24, v66, v70
    v_cvt_pk_bf16_f32 v25, v74, v78
    v_cvt_pk_bf16_f32 v26, v82, v86
    v_cvt_pk_bf16_f32 v27, v90, v94
    v_and_or_b32 v24, v24, -2, s27
    s_add_u32 s36, s24, 0x10000
    buffer_store_dwordx4 v[24:27], v10, s[8:11], s36 offen sc1
    v_cvt_pk_bf16_f32 v28, v67, v71
    v_cvt_pk_bf16_f32 v29, v75, v79
    v_cvt_pk_bf16_f32 v30, v83, v87
    v_cvt_pk_bf16_f32 v31, v91, v95
    v_and_or_b32 v28, v28, -2, s27
    s_add_u32 s36, s24, 0x18000
    buffer_store_dwordx4 v[28:31], v10, s[8:11], s36 offen sc1
    v_cvt_pk_bf16_f32 v32, v96, v100
    v_cvt_pk_bf16_f32 v33, v104, v108
    v_cvt_pk_bf16_f32 v34, v112, v116
    v_cvt_pk_bf16_f32 v35, v120, v124
    v_and_or_b32 v32, v32, -2, s27
    s_add_u32 s36, s24, 0x80000
    buffer_store_dwordx4 v[32:35], v10, s[8:11], s36 offen sc1
    v_cvt_pk_bf16_f32 v36, v97, v101
    v_cvt_pk_bf16_f32 v37, v105, v109
    v_cvt_pk_bf16_f32 v38, v113, v117
    v_cvt_pk_bf16_f32 v39, v121, v125
    v_and_or_b32 v36, v36, -2, s27
    s_add_u32 s36, s24, 0x88000
    buffer_store_dwordx4 v[36:39], v10, s[8:11], s36 offen sc1
    v_cvt_pk_bf16_f32 v40, v98, v102
    v_cvt_pk_bf16_f32 v41, v106, v110
    v_cvt_pk_bf16_f32 v42, v114, v118
    v_cvt_pk_bf16_f32 v43, v122, v126
    v_and_or_b32 v40, v40, -2, s27
    s_add_u32 s36, s24, 0x90000
    buffer_store_dwordx4 v[40:43], v10, s[8:11], s36 offen sc1
    v_cvt_pk_bf16_f32 v44, v99, v103
    v_cvt_pk_bf16_f32 v45, v107, v111
    v_cvt_pk_bf16_f32 v46, v115, v119
    v_cvt_pk_bf16_f32 v47, v123, v127
    v_and_or_b32 v44, v44, -2, s27
    s_add_u32 s36, s24, 0x98000
    buffer_store_dwordx4 v[44:47], v10, s[8:11], s36 offen sc1
    s_lshl_b32 s24, s23, 5
    s_add_u32 s24, s24, s20
    s_lshl_b32 s24, s24, 10
    buffer_load_dword v52, v12, s[12:15], s24 offen
    buffer_load_dword v53, v12, s[92:95], 0 offen
    v_and_b32 v15, 15, v0
    v_mov_b32 v48, 0
    v_mov_b32 v14, 0x3f80
    v_cmp_eq_u32 vcc, 0, v15
    s_nop 1
    v_cndmask_b32 v48, v48, v14, vcc
    v_mov_b32 v14, 0x3f800000
    v_cmp_eq_u32 vcc, 1, v15
    s_nop 1
    v_cndmask_b32 v48, v48, v14, vcc
    v_mov_b32 v49, 0
    v_mov_b32 v14, 0x3f80
    v_cmp_eq_u32 vcc, 4, v15
    s_nop 1
    v_cndmask_b32 v49, v49, v14, vcc
    v_mov_b32 v14, 0x3f800000
    v_cmp_eq_u32 vcc, 5, v15
    s_nop 1
    v_cndmask_b32 v49, v49, v14, vcc
    v_mov_b32 v50, 0
    v_mov_b32 v14, 0x3f80
    v_cmp_eq_u32 vcc, 8, v15
    s_nop 1
    v_cndmask_b32 v50, v50, v14, vcc
    v_mov_b32 v14, 0x3f800000
    v_cmp_eq_u32 vcc, 9, v15
    s_nop 1
    v_cndmask_b32 v50, v50, v14, vcc
    v_mov_b32 v51, 0
    v_mov_b32 v14, 0x3f80
    v_cmp_eq_u32 vcc, 12, v15
    s_nop 1
    v_cndmask_b32 v51, v51, v14, vcc
    v_mov_b32 v14, 0x3f800000
    v_cmp_eq_u32 vcc, 13, v15
    s_nop 1
    v_cndmask_b32 v51, v51, v14, vcc
    s_lshl_b32 s25, s20, 15
    s_add_u32 s25, s25, s26
L_P3_poll:
    s_add_u32 s36, s25, 0
    buffer_load_dwordx4 v[80:83], v11, s[8:11], s36 offen sc1
    s_add_u32 s36, s25, 4096
    buffer_load_dwordx4 v[84:87], v11, s[8:11], s36 offen sc1
    s_add_u32 s36, s25, 8192
    buffer_load_dwordx4 v[88:91], v11, s[8:11], s36 offen sc1
    s_add_u32 s36, s25, 12288
    buffer_load_dwordx4 v[92:95], v11, s[8:11], s36 offen sc1
    s_add_u32 s36, s25, 16384
    buffer_load_dwordx4 v[96:99], v11, s[8:11], s36 offen sc1
    s_add_u32 s36, s25, 20480
    buffer_load_dwordx4 v[100:103], v11, s[8:11], s36 offen sc1
    s_add_u32 s36, s25, 24576
    buffer_load_dwordx4 v[104:107], v11, s[8:11], s36 offen sc1
    s_add_u32 s36, s25, 28672
    buffer_load_dwordx4 v[108:111], v11, s[8:11], s36 offen sc1
    s_mov_b64 exec, -1
    s_add_u32 s32, s32, 1
    s_cmp_gt_u32 s32, 200000
    s_waitcnt vmcnt(7)
    v_mfma_f32_16x16x32_bf16 v[56:59], v[48:51], v[80:83], 0
    s_waitcnt vmcnt(6)
    v_mfma_f32_16x16x32_bf16 v[56:59], v[48:51], v[84:87], v[56:59]
    v_bitop3_b32 v60, v80, v84, s27 bitop3:0x7e
    s_waitcnt vmcnt(5)
    v_mfma_f32_16x16x32_bf16 v[56:59], v[48:51], v[88:91], v[56:59]
    s_waitcnt vmcnt(4)
    v_mfma_f32_16x16x32_bf16 v[56:59], v[48:51], v[92:95], v[56:59]
    v_bitop3_b32 v61, v88, v92, s27 bitop3:0x7e
    s_waitcnt vmcnt(3)
    v_mfma_f32_16x16x32_bf16 v[56:59], v[48:51], v[96:99], v[56:59]
    s_waitcnt vmcnt(2)
    v_mfma_f32_16x16x32_bf16 v[56:59], v[48:51], v[100:103], v[56:59]
    v_bitop3_b32 v62, v96, v100, s27 bitop3:0x7e
    s_waitcnt vmcnt(1)
    v_mfma_f32_16x16x32_bf16 v[56:59], v[48:51], v[104:107], v[56:59]
    s_waitcnt vmcnt(0)
    v_mfma_f32_16x16x32_bf16 v[56:59], v[48:51], v[108:111], v[56:59]
    v_bitop3_b32 v63, v104, v108, s27 bitop3:0x7e
    v_or3_b32 v14, v60, v61, v62
    v_bitop3_b32 v14, v14, v63, 1 bitop3:0xa8
    s_cbranch_scc1 L_P3_got
    v_cmp_ne_u32 vcc, 0, v14
    s_cbranch_vccz L_P3_got
    s_mov_b64 exec, vcc
    s_branch L_P3_poll
L_P3_got:
    s_nop 4
    v_cvt_pk_bf16_f32 v62, v56, v57
    v_lshlrev_b32 v65, 16, v62
    v_and_b32 v66, 0xffff0000, v62
    v_lshlrev_b32 v60, 16, v52
    v_and_b32 v61, 0xffff0000, v52
    v_add_f32 v60, v60, v65
    v_add_f32 v61, v61, v66
    v_cvt_pk_bf16_f32 v62, v60, v61
    v_lshlrev_b32 v60, 16, v62
    v_and_b32 v61, 0xffff0000, v62
    v_add_f32 v63, v60, v61
    v_mul_f32 v64, v60, v60
    v_fmac_f32 v64, v61, v61
    v_add_f32_dpp v63, v63, v63 quad_perm:[1,0,3,2] row_mask:0xf bank_mask:0xf
    s_nop 0
    v_add_f32_dpp v64, v64, v64 quad_perm:[1,0,3,2] row_mask:0xf bank_mask:0xf
    v_add_f32_dpp v63, v63, v63 quad_perm:[2,3,0,1] row_mask:0xf bank_mask:0xf
    s_nop 0
    v_add_f32_dpp v64, v64, v64 quad_perm:[2,3,0,1] row_mask:0xf bank_mask:0xf
    v_add_f32_dpp v63, v63, v63 row_half_mirror row_mask:0xf bank_mask:0xf
    s_nop 0
    v_add_f32_dpp v64, v64, v64 row_half_mirror row_mask:0xf bank_mask:0xf
    v_add_f32_dpp v63, v63, v63 row_mirror row_mask:0xf bank_mask:0xf
    s_nop 0
    v_add_f32_dpp v64, v64, v64 row_mirror row_mask:0xf bank_mask:0xf
    v_mov_b32 v14, v63
    s_nop 1
    v_permlane16_swap_b32 v63, v14
    v_add_f32 v63, v63, v14
    v_mov_b32 v14, v64
    s_nop 1
    v_permlane16_swap_b32 v64, v14
    v_add_f32 v64, v64, v14
    v_mov_b32 v14, v63
    s_nop 1
    v_permlane32_swap_b32 v63, v14
    v_add_f32 v63, v63, v14
    v_mov_b32 v14, v64
    s_nop 1
    v_permlane32_swap_b32 v64, v14
    v_add_f32 v64, v64, v14
    v_mov_b32 v15, s21
    v_lshlrev_b32 v15, 3, v15
    v_add_u32 v15, 28672, v15
    ds_write2_b32 v15, v63, v64 offset0:0 offset1:1
    s_add_u32 s36, s24, 0x400000
    buffer_store_dword v62, v12, s[8:11], s36 offen sc1
    s_waitcnt lgkmcnt(0)
    s_barrier
    v_mov_b32 v15, 28672
    ds_read_b128 v[68:71], v15
    ds_read_b128 v[72:75], v15 offset:16
    s_waitcnt lgkmcnt(0)
    v_add_f32 v63, v68, v70
    v_add_f32 v63, v63, v72
    v_add_f32 v63, v63, v74
    v_mul_f32 v63, 0x3b000000, v63
    v_add_f32 v64, v69, v71
    v_add_f32 v64, v64, v73
    v_add_f32 v64, v64, v75
    v_mul_f32 v64, 0x3b000000, v64
    v_fma_f32 v64, -v63, v63, v64
    v_max_f32 v64, 0, v64
    v_cvt_pk_bf16_f32 v14, v63, v64
    v_lshlrev_b32 v63, 16, v14
    v_and_b32 v64, 0xffff0000, v14
    v_add_f32 v64, 0x3727c5ac, v64
    v_cvt_pk_bf16_f32 v14, v64, v64
    v_lshlrev_b32 v64, 16, v14
    v_sqrt_f32 v64, v64
    s_nop 0
    v_cvt_pk_bf16_f32 v14, v64, v64
    v_lshlrev_b32 v64, 16, v14
    v_rcp_f32 v64, v64
    v_sub_f32 v65, v60, v63
    v_sub_f32 v66, v61, v63
    v_cvt_pk_bf16_f32 v14, v65, v66
    v_lshlrev_b32 v65, 16, v14
    v_and_b32 v66, 0xffff0000, v14
    v_mul_f32 v65, v65, v64
    v_mul_f32 v66, v66, v64
    v_cvt_pk_bf16_f32 v67, v65, v66
    v_lshlrev_b32 v65, 16, v67
    v_and_b32 v66, 0xffff0000, v67
    v_lshlrev_b32 v68, 16, v53
    v_and_b32 v69, 0xffff0000, v53
    v_mul_f32 v63, v65, v68
    v_fmac_f32 v63, v66, v69
    s_nop 1
    v_add_f32_dpp v63, v63, v63 quad_perm:[1,0,3,2] row_mask:0xf bank_mask:0xf
    s_nop 1
    v_add_f32_dpp v63, v63, v63 quad_perm:[2,3,0,1] row_mask:0xf bank_mask:0xf
    s_nop 1
    v_add_f32_dpp v63, v63, v63 row_half_mirror row_mask:0xf bank_mask:0xf
    s_nop 1
    v_add_f32_dpp v63, v63, v63 row_mirror row_mask:0xf bank_mask:0xf
    v_mov_b32 v14, v63
    s_nop 1
    v_permlane16_swap_b32 v63, v14
    v_add_f32 v63, v63, v14
    v_mov_b32 v14, v63
    s_nop 1
    v_permlane32_swap_b32 v63, v14
    v_add_f32 v63, v63, v14
    s_lshr_b32 s25, s24, 6
    s_lshl_b32 s37, s21, 2
    s_add_u32 s25, s25, s37
    s_add_u32 s36, s25, 0x194000
    v_cmp_ne_u32 vcc, 0, v1
    v_mov_b32 v15, 0x40000000
    s_nop 0
    v_cndmask_b32 v15, v1, v15, vcc
    buffer_store_dword v63, v15, s[8:11], s36 offen sc1
    v_add_f32 v60, v60, v65
    v_add_f32 v61, v61, v66
    v_cvt_pk_bf16_f32 v62, v60, v61
    buffer_store_dword v62, v12, s[60:63], s24 offen sc1
    s_add_u32 s36, s24, 0x600000
    buffer_store_dword v67, v12, s[8:11], s36 offen sc1
    v_mov_b32 v14, 0
    s_add_u32 s36, s25, 0x1b8000
    s_waitcnt vmcnt(0)
    buffer_store_dword v14, v15, s[8:11], s36 offen sc1
    s_add_u32 s29, s29, 1
    s_barrier
    s_add_u32 s23, s23, 6
    s_cmp_lt_u32 s23, 64
    s_cbranch_scc1 L_P2
    s_branch L_end
L_mlp:
    s_lshr_b32 s20, s2, 3
    s_mov_b32 s34, 0x05040100
    s_mov_b32 s35, 0x07060302
    s_mov_b32 s32, 0
    s_mov_b32 s64, s84
    s_and_b32 s65, s85, 0xffff
    s_mov_b32 s66, 0x1c0000
    s_mov_b32 s67, 0x20000
    s_mov_b32 s68, s86
    s_and_b32 s69, s87, 0xffff
    s_mov_b32 s70, 0x1c0000
    s_mov_b32 s71, 0x20000
    s_mov_b32 s76, s88
    s_and_b32 s77, s89, 0xffff
    s_mov_b32 s78, 0x1c0000
    s_mov_b32 s79, 0x20000
    v_and_b32 v3, 31, v0
    v_lshlrev_b32 v3, 2, v3
L_M_hs:
    buffer_load_dword v5, v3, s[16:19], 0 offen offset:128 sc1
    s_add_u32 s32, s32, 1
    s_cmp_gt_u32 s32, 200000
    s_waitcnt vmcnt(0)
    s_cbranch_scc1 L_M_hs_ok
    v_cmp_eq_u32 vcc, 0, v5
    s_cbranch_vccz L_M_hs_ok
    s_sleep 16
    s_branch L_M_hs
L_M_hs_ok:
    v_lshlrev_b32 v3, 4, v0
L_M00_rp:
    s_mov_b32 s36, 0x194000
    buffer_load_dwordx4 v[16:19], v3, s[8:11], s36 offen sc1
    s_add_u32 s32, s32, 1
    v_mov_b32 v5, 0
    s_waitcnt vmcnt(0)
    v_max3_u32 v5, v5, v16, v17
    v_max3_u32 v5, v5, v18, v19
    s_cmp_gt_u32 s32, 200000
    s_cbranch_scc1 L_M00_rp_ok
    v_cmp_eq_u32 vcc, -1, v5
    s_cbranch_vccz L_M00_rp_ok
    s_sleep 64
    s_branch L_M00_rp
L_M00_rp_ok:
    v_add_f32 v16, v16, v17
    v_add_f32 v18, v18, v19
    v_add_f32 v16, v16, v18
    v_cvt_pk_bf16_f32 v5, v16, v16
    v_lshlrev_b32 v16, 16, v5
    v_ashrrev_i32 v5, 31, v16
    v_or_b32 v5, 0x80000000, v5
    v_xor_b32 v5, v5, v16
    v_and_b32 v5, 0xffff0000, v5
    v_sub_u32 v6, 2047, v0
    v_or_b32 v120, v5, v6
    v_lshrrev_b32 v1, 5, v0
    v_and_b32 v2, 31, v0
    s_mov_b32 s36, 229376
    v_mul_lo_u32 v4, v1, s36
    v_lshl_add_u32 v4, v2, 2, v4
    v_mov_b32 v5, 0x40000000
    v_cmp_lt_u32 vcc, 27, v2
    s_nop 1
    v_cndmask_b32 v4, v4, v5, vcc
    s_mul_i32 s23, s20, 112
    s_add_u32 s36, s23, 0
    buffer_load_dword v16, v4, s[64:67], s36 offen
    s_add_u32 s36, s23, 3584
    buffer_load_dword v17, v4, s[64:67], s36 offen
    s_add_u32 s36, s23, 7168
    buffer_load_dword v18, v4, s[64:67], s36 offen
    s_add_u32 s36, s23, 10752
    buffer_load_dword v19, v4, s[64:67], s36 offen
    s_add_u32 s36, s23, 14336
    buffer_load_dword v20, v4, s[64:67], s36 offen
    s_add_u32 s36, s23, 17920
    buffer_load_dword v21, v4, s[64:67], s36 offen
    s_add_u32 s36, s23, 21504
    buffer_load_dword v22, v4, s[64:67], s36 offen
    s_add_u32 s36, s23, 25088
    buffer_load_dword v23, v4, s[64:67], s36 offen
    s_add_u32 s36, s23, 28672
    buffer_load_dword v24, v4, s[64:67], s36 offen
    s_add_u32 s36, s23, 32256
    buffer_load_dword v25, v4, s[64:67], s36 offen
    s_add_u32 s36, s23, 35840
    buffer_load_dword v26, v4, s[64:67], s36 offen
    s_add_u32 s36, s23, 39424
    buffer_load_dword v27, v4, s[64:67], s36 offen
    s_add_u32 s36, s23, 43008
    buffer_load_dword v28, v4, s[64:67], s36 offen
    s_add_u32 s36, s23, 46592
    buffer_load_dword v29, v4, s[64:67], s36 offen
    s_add_u32 s36, s23, 50176
    buffer_load_dword v30, v4, s[64:67], s36 offen
    s_add_u32 s36, s23, 53760
    buffer_load_dword v31, v4, s[64:67], s36 offen
    s_add_u32 s36, s23, 57344
    buffer_load_dword v32, v4, s[64:67], s36 offen
    s_add_u32 s36, s23, 60928
    buffer_load_dword v33, v4, s[64:67], s36 offen
    s_add_u32 s36, s23, 64512
    buffer_load_dword v34, v4, s[64:67], s36 offen
    s_add_u32 s36, s23, 68096
    buffer_load_dword v35, v4, s[64:67], s36 offen
    s_add_u32 s36, s23, 71680
    buffer_load_dword v36, v4, s[64:67], s36 offen
    s_add_u32 s36, s23, 75264
    buffer_load_dword v37, v4, s[64:67], s36 offen
    s_add_u32 s36, s23, 78848
    buffer_load_dword v38, v4, s[64:67], s36 offen
    s_add_u32 s36, s23, 82432
    buffer_load_dword v39, v4, s[64:67], s36 offen
    s_add_u32 s36, s23, 86016
    buffer_load_dword v40, v4, s[64:67], s36 offen
    s_add_u32 s36, s23, 89600
    buffer_load_dword v41, v4, s[64:67], s36 offen
    s_add_u32 s36, s23, 93184
    buffer_load_dword v42, v4, s[64:67], s36 offen
    s_add_u32 s36, s23, 96768
    buffer_load_dword v43, v4, s[64:67], s36 offen
    s_add_u32 s36, s23, 100352
    buffer_load_dword v44, v4, s[64:67], s36 offen
    s_add_u32 s36, s23, 103936
    buffer_load_dword v45, v4, s[64:67], s36 offen
    s_add_u32 s36, s23, 107520
    buffer_load_dword v46, v4, s[64:67], s36 offen
    s_add_u32 s36, s23, 111104
    buffer_load_dword v47, v4, s[64:67], s36 offen
    s_waitcnt vmcnt(0)
    v_perm_b32 v128, v17, v16, s34
    v_perm_b32 v129, v19, v18, s34
    v_perm_b32 v130, v21, v20, s34
    v_perm_b32 v131, v23, v22, s34
    v_perm_b32 v132, v25, v24, s34
    v_perm_b32 v133, v27, v26, s34
    v_perm_b32 v134, v29, v28, s34
    v_perm_b32 v135, v31, v30, s34
    v_perm_b32 v136, v33, v32, s34
    v_perm_b32 v137, v35, v34, s34
    v_perm_b32 v138, v37, v36, s34
    v_perm_b32 v139, v39, v38, s34
    v_perm_b32 v140, v41, v40, s34
    v_perm_b32 v141, v43, v42, s34
    v_perm_b32 v142, v45, v44, s34
    v_perm_b32 v143, v47, v46, s34
    v_perm_b32 v160, v17, v16, s35
    v_perm_b32 v161, v19, v18, s35
    v_perm_b32 v162, v21, v20, s35
    v_perm_b32 v163, v23, v22, s35
    v_perm_b32 v164, v25, v24, s35
    v_perm_b32 v165, v27, v26, s35
    v_perm_b32 v166, v29, v28, s35
    v_perm_b32 v167, v31, v30, s35
    v_perm_b32 v168, v33, v32, s35
    v_perm_b32 v169, v35, v34, s35
    v_perm_b32 v170, v37, v36, s35
    v_perm_b32 v171, v39, v38, s35
    v_perm_b32 v172, v41, v40, s35
    v_perm_b32 v173, v43, v42, s35
    v_perm_b32 v174, v45, v44, s35
    v_perm_b32 v175, v47, v46, s35
    s_add_u32 s36, s23, 114688
    buffer_load_dword v16, v4, s[64:67], s36 offen
    s_add_u32 s36, s23, 118272
    buffer_load_dword v17, v4, s[64:67], s36 offen
    s_add_u32 s36, s23, 121856
    buffer_load_dword v18, v4, s[64:67], s36 offen
    s_add_u32 s36, s23, 125440
    buffer_load_dword v19, v4, s[64:67], s36 offen
    s_add_u32 s36, s23, 129024
    buffer_load_dword v20, v4, s[64:67], s36 offen
    s_add_u32 s36, s23, 132608
    buffer_load_dword v21, v4, s[64:67], s36 offen
    s_add_u32 s36, s23, 136192
    buffer_load_dword v22, v4, s[64:67], s36 offen
    s_add_u32 s36, s23, 139776
    buffer_load_dword v23, v4, s[64:67], s36 offen
    s_add_u32 s36, s23, 143360
    buffer_load_dword v24, v4, s[64:67], s36 offen
    s_add_u32 s36, s23, 146944
    buffer_load_dword v25, v4, s[64:67], s36 offen
    s_add_u32 s36, s23, 150528
    buffer_load_dword v26, v4, s[64:67], s36 offen
    s_add_u32 s36, s23, 154112
    buffer_load_dword v27, v4, s[64:67], s36 offen
    s_add_u32 s36, s23, 157696
    buffer_load_dword v28, v4, s[64:67], s36 offen
    s_add_u32 s36, s23, 161280
    buffer_load_dword v29, v4, s[64:67], s36 offen
    s_add_u32 s36, s23, 164864
    buffer_load_dword v30, v4, s[64:67], s36 offen
    s_add_u32 s36, s23, 168448
    buffer_load_dword v31, v4, s[64:67], s36 offen
    s_add_u32 s36, s23, 172032
    buffer_load_dword v32, v4, s[64:67], s36 offen
    s_add_u32 s36, s23, 175616
    buffer_load_dword v33, v4, s[64:67], s36 offen
    s_add_u32 s36, s23, 179200
    buffer_load_dword v34, v4, s[64:67], s36 offen
    s_add_u32 s36, s23, 182784
    buffer_load_dword v35, v4, s[64:67], s36 offen
    s_add_u32 s36, s23, 186368
    buffer_load_dword v36, v4, s[64:67], s36 offen
    s_add_u32 s36, s23, 189952
    buffer_load_dword v37, v4, s[64:67], s36 offen
    s_add_u32 s36, s23, 193536
    buffer_load_dword v38, v4, s[64:67], s36 offen
    s_add_u32 s36, s23, 197120
    buffer_load_dword v39, v4, s[64:67], s36 offen
    s_add_u32 s36, s23, 200704
    buffer_load_dword v40, v4, s[64:67], s36 offen
    s_add_u32 s36, s23, 204288
    buffer_load_dword v41, v4, s[64:67], s36 offen
    s_add_u32 s36, s23, 207872
    buffer_load_dword v42, v4, s[64:67], s36 offen
    s_add_u32 s36, s23, 211456
    buffer_load_dword v43, v4, s[64:67], s36 offen
    s_add_u32 s36, s23, 215040
    buffer_load_dword v44, v4, s[64:67], s36 offen
    s_add_u32 s36, s23, 218624
    buffer_load_dword v45, v4, s[64:67], s36 offen
    s_add_u32 s36, s23, 222208
    buffer_load_dword v46, v4, s[64:67], s36 offen
    s_add_u32 s36, s23, 225792
    buffer_load_dword v47, v4, s[64:67], s36 offen
    s_waitcnt vmcnt(0)
    v_perm_b32 v144, v17, v16, s34
    v_perm_b32 v145, v19, v18, s34
    v_perm_b32 v146, v21, v20, s34
    v_perm_b32 v147, v23, v22, s34
    v_perm_b32 v148, v25, v24, s34
    v_perm_b32 v149, v27, v26, s34
    v_perm_b32 v150, v29, v28, s34
    v_perm_b32 v151, v31, v30, s34
    v_perm_b32 v152, v33, v32, s34
    v_perm_b32 v153, v35, v34, s34
    v_perm_b32 v154, v37, v36, s34
    v_perm_b32 v155, v39, v38, s34
    v_perm_b32 v156, v41, v40, s34
    v_perm_b32 v157, v43, v42, s34
    v_perm_b32 v158, v45, v44, s34
    v_perm_b32 v159, v47, v46, s34
    v_perm_b32 v176, v17, v16, s35
    v_perm_b32 v177, v19, v18, s35
    v_perm_b32 v178, v21, v20, s35
    v_perm_b32 v179, v23, v22, s35
    v_perm_b32 v180, v25, v24, s35
    v_perm_b32 v181, v27, v26, s35
    v_perm_b32 v182, v29, v28, s35
    v_perm_b32 v183, v31, v30, s35
    v_perm_b32 v184, v33, v32, s35
    v_perm_b32 v185, v35, v34, s35
    v_perm_b32 v186, v37, v36, s35
    v_perm_b32 v187, v39, v38, s35
    v_perm_b32 v188, v41, v40, s35
    v_perm_b32 v189, v43, v42, s35
    v_perm_b32 v190, v45, v44, s35
    v_perm_b32 v191, v47, v46, s35
    s_add_u32 s36, s23, 0
    buffer_load_dword v16, v4, s[68:71], s36 offen
    s_add_u32 s36, s23, 3584
    buffer_load_dword v17, v4, s[68:71], s36 offen
    s_add_u32 s36, s23, 7168
    buffer_load_dword v18, v4, s[68:71], s36 offen
    s_add_u32 s36, s23, 10752
    buffer_load_dword v19, v4, s[68:71], s36 offen
    s_add_u32 s36, s23, 14336
    buffer_load_dword v20, v4, s[68:71], s36 offen
    s_add_u32 s36, s23, 17920
    buffer_load_dword v21, v4, s[68:71], s36 offen
    s_add_u32 s36, s23, 21504
    buffer_load_dword v22, v4, s[68:71], s36 offen
    s_add_u32 s36, s23, 25088
    buffer_load_dword v23, v4, s[68:71], s36 offen
    s_add_u32 s36, s23, 28672
    buffer_load_dword v24, v4, s[68:71], s36 offen
    s_add_u32 s36, s23, 32256
    buffer_load_dword v25, v4, s[68:71], s36 offen
    s_add_u32 s36, s23, 35840
    buffer_load_dword v26, v4, s[68:71], s36 offen
    s_add_u32 s36, s23, 39424
    buffer_load_dword v27, v4, s[68:71], s36 offen
    s_add_u32 s36, s23, 43008
    buffer_load_dword v28, v4, s[68:71], s36 offen
    s_add_u32 s36, s23, 46592
    buffer_load_dword v29, v4, s[68:71], s36 offen
    s_add_u32 s36, s23, 50176
    buffer_load_dword v30, v4, s[68:71], s36 offen
    s_add_u32 s36, s23, 53760
    buffer_load_dword v31, v4, s[68:71], s36 offen
    s_add_u32 s36, s23, 57344
    buffer_load_dword v32, v4, s[68:71], s36 offen
    s_add_u32 s36, s23, 60928
    buffer_load_dword v33, v4, s[68:71], s36 offen
    s_add_u32 s36, s23, 64512
    buffer_load_dword v34, v4, s[68:71], s36 offen
    s_add_u32 s36, s23, 68096
    buffer_load_dword v35, v4, s[68:71], s36 offen
    s_add_u32 s36, s23, 71680
    buffer_load_dword v36, v4, s[68:71], s36 offen
    s_add_u32 s36, s23, 75264
    buffer_load_dword v37, v4, s[68:71], s36 offen
    s_add_u32 s36, s23, 78848
    buffer_load_dword v38, v4, s[68:71], s36 offen
    s_add_u32 s36, s23, 82432
    buffer_load_dword v39, v4, s[68:71], s36 offen
    s_add_u32 s36, s23, 86016
    buffer_load_dword v40, v4, s[68:71], s36 offen
    s_add_u32 s36, s23, 89600
    buffer_load_dword v41, v4, s[68:71], s36 offen
    s_add_u32 s36, s23, 93184
    buffer_load_dword v42, v4, s[68:71], s36 offen
    s_add_u32 s36, s23, 96768
    buffer_load_dword v43, v4, s[68:71], s36 offen
    s_add_u32 s36, s23, 100352
    buffer_load_dword v44, v4, s[68:71], s36 offen
    s_add_u32 s36, s23, 103936
    buffer_load_dword v45, v4, s[68:71], s36 offen
    s_add_u32 s36, s23, 107520
    buffer_load_dword v46, v4, s[68:71], s36 offen
    s_add_u32 s36, s23, 111104
    buffer_load_dword v47, v4, s[68:71], s36 offen
    s_waitcnt vmcnt(0)
    v_perm_b32 v192, v17, v16, s34
    v_perm_b32 v193, v19, v18, s34
    v_perm_b32 v194, v21, v20, s34
    v_perm_b32 v195, v23, v22, s34
    v_perm_b32 v196, v25, v24, s34
    v_perm_b32 v197, v27, v26, s34
    v_perm_b32 v198, v29, v28, s34
    v_perm_b32 v199, v31, v30, s34
    v_perm_b32 v200, v33, v32, s34
    v_perm_b32 v201, v35, v34, s34
    v_perm_b32 v202, v37, v36, s34
    v_perm_b32 v203, v39, v38, s34
    v_perm_b32 v204, v41, v40, s34
    v_perm_b32 v205, v43, v42, s34
    v_perm_b32 v206, v45, v44, s34
    v_perm_b32 v207, v47, v46, s34
    v_perm_b32 v224, v17, v16, s35
    v_perm_b32 v225, v19, v18, s35
    v_perm_b32 v226, v21, v20, s35
    v_perm_b32 v227, v23, v22, s35
    v_perm_b32 v228, v25, v24, s35
    v_perm_b32 v229, v27, v26, s35
    v_perm_b32 v230, v29, v28, s35
    v_perm_b32 v231, v31, v30, s35
    v_perm_b32 v232, v33, v32, s35
    v_perm_b32 v233, v35, v34, s35
    v_perm_b32 v234, v37, v36, s35
    v_perm_b32 v235, v39, v38, s35
    v_perm_b32 v236, v41, v40, s35
    v_perm_b32 v237, v43, v42, s35
    v_perm_b32 v238, v45, v44, s35
    v_perm_b32 v239, v47, v46, s35
    s_add_u32 s36, s23, 114688
    buffer_load_dword v16, v4, s[68:71], s36 offen
    s_add_u32 s36, s23, 118272
    buffer_load_dword v17, v4, s[68:71], s36 offen
    s_add_u32 s36, s23, 121856
    buffer_load_dword v18, v4, s[68:71], s36 offen
    s_add_u32 s36, s23, 125440
    buffer_load_dword v19, v4, s[68:71], s36 offen
    s_add_u32 s36, s23, 129024
    buffer_load_dword v20, v4, s[68:71], s36 offen
    s_add_u32 s36, s23, 132608
    buffer_load_dword v21, v4, s[68:71], s36 offen
    s_add_u32 s36, s23, 136192
    buffer_load_dword v22, v4, s[68:71], s36 offen
    s_add_u32 s36, s23, 139776
    buffer_load_dword v23, v4, s[68:71], s36 offen
    s_add_u32 s36, s23, 143360
    buffer_load_dword v24, v4, s[68:71], s36 offen
    s_add_u32 s36, s23, 146944
    buffer_load_dword v25, v4, s[68:71], s36 offen
    s_add_u32 s36, s23, 150528
    buffer_load_dword v26, v4, s[68:71], s36 offen
    s_add_u32 s36, s23, 154112
    buffer_load_dword v27, v4, s[68:71], s36 offen
    s_add_u32 s36, s23, 157696
    buffer_load_dword v28, v4, s[68:71], s36 offen
    s_add_u32 s36, s23, 161280
    buffer_load_dword v29, v4, s[68:71], s36 offen
    s_add_u32 s36, s23, 164864
    buffer_load_dword v30, v4, s[68:71], s36 offen
    s_add_u32 s36, s23, 168448
    buffer_load_dword v31, v4, s[68:71], s36 offen
    s_add_u32 s36, s23, 172032
    buffer_load_dword v32, v4, s[68:71], s36 offen
    s_add_u32 s36, s23, 175616
    buffer_load_dword v33, v4, s[68:71], s36 offen
    s_add_u32 s36, s23, 179200
    buffer_load_dword v34, v4, s[68:71], s36 offen
    s_add_u32 s36, s23, 182784
    buffer_load_dword v35, v4, s[68:71], s36 offen
    s_add_u32 s36, s23, 186368
    buffer_load_dword v36, v4, s[68:71], s36 offen
    s_add_u32 s36, s23, 189952
    buffer_load_dword v37, v4, s[68:71], s36 offen
    s_add_u32 s36, s23, 193536
    buffer_load_dword v38, v4, s[68:71], s36 offen
    s_add_u32 s36, s23, 197120
    buffer_load_dword v39, v4, s[68:71], s36 offen
    s_add_u32 s36, s23, 200704
    buffer_load_dword v40, v4, s[68:71], s36 offen
    s_add_u32 s36, s23, 204288
    buffer_load_dword v41, v4, s[68:71], s36 offen
    s_add_u32 s36, s23, 207872
    buffer_load_dword v42, v4, s[68:71], s36 offen
    s_add_u32 s36, s23, 211456
    buffer_load_dword v43, v4, s[68:71], s36 offen
    s_add_u32 s36, s23, 215040
    buffer_load_dword v44, v4, s[68:71], s36 offen
    s_add_u32 s36, s23, 218624
    buffer_load_dword v45, v4, s[68:71], s36 offen
    s_add_u32 s36, s23, 222208
    buffer_load_dword v46, v4, s[68:71], s36 offen
    s_add_u32 s36, s23, 225792
    buffer_load_dword v47, v4, s[68:71], s36 offen
    s_waitcnt vmcnt(0)
    v_perm_b32 v208, v17, v16, s34
    v_perm_b32 v209, v19, v18, s34
    v_perm_b32 v210, v21, v20, s34
    v_perm_b32 v211, v23, v22, s34
    v_perm_b32 v212, v25, v24, s34
    v_perm_b32 v213, v27, v26, s34
    v_perm_b32 v214, v29, v28, s34
    v_perm_b32 v215, v31, v30, s34
    v_perm_b32 v216, v33, v32, s34
    v_perm_b32 v217, v35, v34, s34
    v_perm_b32 v218, v37, v36, s34
    v_perm_b32 v219, v39, v38, s34
    v_perm_b32 v220, v41, v40, s34
    v_perm_b32 v221, v43, v42, s34
    v_perm_b32 v222, v45, v44, s34
    v_perm_b32 v223, v47, v46, s34
    v_perm_b32 v240, v17, v16, s35
    v_perm_b32 v241, v19, v18, s35
    v_perm_b32 v242, v21, v20, s35
    v_perm_b32 v243, v23, v22, s35
    v_perm_b32 v244, v25, v24, s35
    v_perm_b32 v245, v27, v26, s35
    v_perm_b32 v246, v29, v28, s35
    v_perm_b32 v247, v31, v30, s35
    v_perm_b32 v248, v33, v32, s35
    v_perm_b32 v249, v35, v34, s35
    v_perm_b32 v250, v37, v36, s35
    v_perm_b32 v251, v39, v38, s35
    v_perm_b32 v252, v41, v40, s35
    v_perm_b32 v253, v43, v42, s35
    v_perm_b32 v254, v45, v44, s35
    v_perm_b32 v255, v47, v46, s35
    v_lshrrev_b32 v3, 3, v0
    v_mul_u32_u24 v4, 57344, v3
    v_and_b32 v3, 7, v0
    v_lshl_add_u32 v4, v3, 2, v4
    s_lshl_b32 s37, s20, 5
    s_add_u32 s36, s37, 0
    buffer_load_dword v16, v4, s[76:79], s36 offen
    s_add_u32 s36, s37, 1024
    buffer_load_dword v17, v4, s[76:79], s36 offen
    s_add_u32 s36, s37, 2048
    buffer_load_dword v18, v4, s[76:79], s36 offen
    s_add_u32 s36, s37, 3072
    buffer_load_dword v19, v4, s[76:79], s36 offen
    s_add_u32 s36, s37, 4096
    buffer_load_dword v20, v4, s[76:79], s36 offen
    s_add_u32 s36, s37, 5120
    buffer_load_dword v21, v4, s[76:79], s36 offen
    s_add_u32 s36, s37, 6144
    buffer_load_dword v22, v4, s[76:79], s36 offen
    s_add_u32 s36, s37, 7168
    buffer_load_dword v23, v4, s[76:79], s36 offen
    s_add_u32 s36, s37, 8192
    buffer_load_dword v24, v4, s[76:79], s36 offen
    s_add_u32 s36, s37, 9216
    buffer_load_dword v25, v4, s[76:79], s36 offen
    s_add_u32 s36, s37, 10240
    buffer_load_dword v26, v4, s[76:79], s36 offen
    s_add_u32 s36, s37, 11264
    buffer_load_dword v27, v4, s[76:79], s36 offen
    s_add_u32 s36, s37, 12288
    buffer_load_dword v28, v4, s[76:79], s36 offen
    s_add_u32 s36, s37, 13312
    buffer_load_dword v29, v4, s[76:79], s36 offen
    s_add_u32 s36, s37, 14336
    buffer_load_dword v30, v4, s[76:79], s36 offen
    s_add_u32 s36, s37, 15360
    buffer_load_dword v31, v4, s[76:79], s36 offen
    s_add_u32 s36, s37, 16384
    buffer_load_dword v32, v4, s[76:79], s36 offen
    s_add_u32 s36, s37, 17408
    buffer_load_dword v33, v4, s[76:79], s36 offen
    s_add_u32 s36, s37, 18432
    buffer_load_dword v34, v4, s[76:79], s36 offen
    s_add_u32 s36, s37, 19456
    buffer_load_dword v35, v4, s[76:79], s36 offen
    s_add_u32 s36, s37, 20480
    buffer_load_dword v36, v4, s[76:79], s36 offen
    s_add_u32 s36, s37, 21504
    buffer_load_dword v37, v4, s[76:79], s36 offen
    s_add_u32 s36, s37, 22528
    buffer_load_dword v38, v4, s[76:79], s36 offen
    s_add_u32 s36, s37, 23552
    buffer_load_dword v39, v4, s[76:79], s36 offen
    s_add_u32 s36, s37, 24576
    buffer_load_dword v40, v4, s[76:79], s36 offen
    s_add_u32 s36, s37, 25600
    buffer_load_dword v41, v4, s[76:79], s36 offen
    s_add_u32 s36, s37, 26624
    buffer_load_dword v42, v4, s[76:79], s36 offen
    s_add_u32 s36, s37, 27648
    buffer_load_dword v43, v4, s[76:79], s36 offen
    s_waitcnt vmcnt(0)
    v_perm_b32 v64, v17, v16, s34
    v_perm_b32 v65, v19, v18, s34
    v_perm_b32 v66, v21, v20, s34
    v_perm_b32 v67, v23, v22, s34
    v_perm_b32 v68, v25, v24, s34
    v_perm_b32 v69, v27, v26, s34
    v_perm_b32 v70, v29, v28, s34
    v_perm_b32 v71, v31, v30, s34
    v_perm_b32 v72, v33, v32, s34
    v_perm_b32 v73, v35, v34, s34
    v_perm_b32 v74, v37, v36, s34
    v_perm_b32 v75, v39, v38, s34
    v_perm_b32 v76, v41, v40, s34
    v_perm_b32 v77, v43, v42, s34
    v_perm_b32 v92, v17, v16, s35
    v_perm_b32 v93, v19, v18, s35
    v_perm_b32 v94, v21, v20, s35
    v_perm_b32 v95, v23, v22, s35
    v_perm_b32 v96, v25, v24, s35
    v_perm_b32 v97, v27, v26, s35
    v_perm_b32 v98, v29, v28, s35
    v_perm_b32 v99, v31, v30, s35
    v_perm_b32 v100, v33, v32, s35
    v_perm_b32 v101, v35, v34, s35
    v_perm_b32 v102, v37, v36, s35
    v_perm_b32 v103, v39, v38, s35
    v_perm_b32 v104, v41, v40, s35
    v_perm_b32 v105, v43, v42, s35
    s_add_u32 s36, s37, 28672
    buffer_load_dword v16, v4, s[76:79], s36 offen
    s_add_u32 s36, s37, 29696
    buffer_load_dword v17, v4, s[76:79], s36 offen
    s_add_u32 s36, s37, 30720
    buffer_load_dword v18, v4, s[76:79], s36 offen
    s_add_u32 s36, s37, 31744
    buffer_load_dword v19, v4, s[76:79], s36 offen
    s_add_u32 s36, s37, 32768
    buffer_load_dword v20, v4, s[76:79], s36 offen
    s_add_u32 s36, s37, 33792
    buffer_load_dword v21, v4, s[76:79], s36 offen
    s_add_u32 s36, s37, 34816
    buffer_load_dword v22, v4, s[76:79], s36 offen
    s_add_u32 s36, s37, 35840
    buffer_load_dword v23, v4, s[76:79], s36 offen
    s_add_u32 s36, s37, 36864
    buffer_load_dword v24, v4, s[76:79], s36 offen
    s_add_u32 s36, s37, 37888
    buffer_load_dword v25, v4, s[76:79], s36 offen
    s_add_u32 s36, s37, 38912
    buffer_load_dword v26, v4, s[76:79], s36 offen
    s_add_u32 s36, s37, 39936
    buffer_load_dword v27, v4, s[76:79], s36 offen
    s_add_u32 s36, s37, 40960
    buffer_load_dword v28, v4, s[76:79], s36 offen
    s_add_u32 s36, s37, 41984
    buffer_load_dword v29, v4, s[76:79], s36 offen
    s_add_u32 s36, s37, 43008
    buffer_load_dword v30, v4, s[76:79], s36 offen
    s_add_u32 s36, s37, 44032
    buffer_load_dword v31, v4, s[76:79], s36 offen
    s_add_u32 s36, s37, 45056
    buffer_load_dword v32, v4, s[76:79], s36 offen
    s_add_u32 s36, s37, 46080
    buffer_load_dword v33, v4, s[76:79], s36 offen
    s_add_u32 s36, s37, 47104
    buffer_load_dword v34, v4, s[76:79], s36 offen
    s_add_u32 s36, s37, 48128
    buffer_load_dword v35, v4, s[76:79], s36 offen
    s_add_u32 s36, s37, 49152
    buffer_load_dword v36, v4, s[76:79], s36 offen
    s_add_u32 s36, s37, 50176
    buffer_load_dword v37, v4, s[76:79], s36 offen
    s_add_u32 s36, s37, 51200
    buffer_load_dword v38, v4, s[76:79], s36 offen
    s_add_u32 s36, s37, 52224
    buffer_load_dword v39, v4, s[76:79], s36 offen
    s_add_u32 s36, s37, 53248
    buffer_load_dword v40, v4, s[76:79], s36 offen
    s_add_u32 s36, s37, 54272
    buffer_load_dword v41, v4, s[76:79], s36 offen
    s_add_u32 s36, s37, 55296
    buffer_load_dword v42, v4, s[76:79], s36 offen
    s_add_u32 s36, s37, 56320
    buffer_load_dword v43, v4, s[76:79], s36 offen
    s_waitcnt vmcnt(0)
    v_perm_b32 v78, v17, v16, s34
    v_perm_b32 v79, v19, v18, s34
    v_perm_b32 v80, v21, v20, s34
    v_perm_b32 v81, v23, v22, s34
    v_perm_b32 v82, v25, v24, s34
    v_perm_b32 v83, v27, v26, s34
    v_perm_b32 v84, v29, v28, s34
    v_perm_b32 v85, v31, v30, s34
    v_perm_b32 v86, v33, v32, s34
    v_perm_b32 v87, v35, v34, s34
    v_perm_b32 v88, v37, v36, s34
    v_perm_b32 v89, v39, v38, s34
    v_perm_b32 v90, v41, v40, s34
    v_perm_b32 v91, v43, v42, s34
    v_perm_b32 v106, v17, v16, s35
    v_perm_b32 v107, v19, v18, s35
    v_perm_b32 v108, v21, v20, s35
    v_perm_b32 v109, v23, v22, s35
    v_perm_b32 v110, v25, v24, s35
    v_perm_b32 v111, v27, v26, s35
    v_perm_b32 v112, v29, v28, s35
    v_perm_b32 v113, v31, v30, s35
    v_perm_b32 v114, v33, v32, s35
    v_perm_b32 v115, v35, v34, s35
    v_perm_b32 v116, v37, v36, s35
    v_perm_b32 v117, v39, v38, s35
    v_perm_b32 v118, v41, v40, s35
    v_perm_b32 v119, v43, v42, s35
    s_mov_b32 s24, 0
    s_mov_b64 s[28:29], 0
    v_mov_b32 v12, 0x40000000
    v_mov_b32 v13, 0
    v_lshlrev_b32 v3, 4, v0
L_M06_rp:
    s_mov_b32 s36, 0x19a000
    buffer_load_dwordx4 v[40:43], v3, s[8:11], s36 offen sc1
    s_add_u32 s32, s32, 1
    v_mov_b32 v5, 0
    s_waitcnt vmcnt(0)
    v_max3_u32 v5, v5, v40, v41
    v_max3_u32 v5, v5, v42, v43
    s_cmp_gt_u32 s32, 200000
    s_cbranch_scc1 L_M06_rp_ok
    v_cmp_eq_u32 vcc, -1, v5
    s_cbranch_vccz L_M06_rp_ok
    s_sleep 32
    s_branch L_M06_rp
L_M06_rp_ok:
    v_add_f32 v40, v40, v41
    v_add_f32 v42, v42, v43
    v_add_f32 v40, v40, v42
    v_cvt_pk_bf16_f32 v5, v40, v40
    v_lshlrev_b32 v40, 16, v5
    v_ashrrev_i32 v5, 31, v40
    v_or_b32 v5, 0x80000000, v5
    v_xor_b32 v5, v5, v40
    v_and_b32 v5, 0xffff0000, v5
    v_sub_u32 v6, 511, v0
    v_or_b32 v126, v5, v6
    v_lshlrev_b32 v3, 4, v0
L_M01_rp:
    s_mov_b32 s36, 0x195000
    buffer_load_dwordx4 v[20:23], v3, s[8:11], s36 offen sc1
    s_mov_b32 s36, 0x196000
    buffer_load_dwordx4 v[24:27], v3, s[8:11], s36 offen sc1
    s_mov_b32 s36, 0x197000
    buffer_load_dwordx4 v[28:31], v3, s[8:11], s36 offen sc1
    s_mov_b32 s36, 0x198000
    buffer_load_dwordx4 v[32:35], v3, s[8:11], s36 offen sc1
    s_mov_b32 s36, 0x199000
    buffer_load_dwordx4 v[36:39], v3, s[8:11], s36 offen sc1
    s_add_u32 s32, s32, 1
    v_mov_b32 v5, 0
    s_waitcnt vmcnt(0)
    v_max3_u32 v5, v5, v20, v21
    v_max3_u32 v5, v5, v22, v23
    v_max3_u32 v5, v5, v24, v25
    v_max3_u32 v5, v5, v26, v27
    v_max3_u32 v5, v5, v28, v29
    v_max3_u32 v5, v5, v30, v31
    v_max3_u32 v5, v5, v32, v33
    v_max3_u32 v5, v5, v34, v35
    v_max3_u32 v5, v5, v36, v37
    v_max3_u32 v5, v5, v38, v39
    s_cmp_gt_u32 s32, 200000
    s_cbranch_scc1 L_M01_rp_ok
    v_cmp_eq_u32 vcc, -1, v5
    s_cbranch_vccz L_M01_rp_ok
    s_sleep 8
    s_branch L_M01_rp
L_M01_rp_ok:
    v_add_f32 v20, v20, v21
    v_add_f32 v22, v22, v23
    v_add_f32 v20, v20, v22
    v_cvt_pk_bf16_f32 v5, v20, v20
    v_lshlrev_b32 v20, 16, v5
    v_ashrrev_i32 v5, 31, v20
    v_or_b32 v5, 0x80000000, v5
    v_xor_b32 v5, v5, v20
    v_and_b32 v5, 0xffff0000, v5
    v_sub_u32 v6, 1791, v0
    v_or_b32 v121, v5, v6
    v_add_f32 v24, v24, v25
    v_add_f32 v26, v26, v27
    v_add_f32 v24, v24, v26
    v_cvt_pk_bf16_f32 v5, v24, v24
    v_lshlrev_b32 v24, 16, v5
    v_ashrrev_i32 v5, 31, v24
    v_or_b32 v5, 0x80000000, v5
    v_xor_b32 v5, v5, v24
    v_and_b32 v5, 0xffff0000, v5
    v_sub_u32 v6, 1535, v0
    v_or_b32 v122, v5, v6
    v_add_f32 v28, v28, v29
    v_add_f32 v30, v30, v31
    v_add_f32 v28, v28, v30
    v_cvt_pk_bf16_f32 v5, v28, v28
    v_lshlrev_b32 v28, 16, v5
    v_ashrrev_i32 v5, 31, v28
    v_or_b32 v5, 0x80000000, v5
    v_xor_b32 v5, v5, v28
    v_and_b32 v5, 0xffff0000, v5
    v_sub_u32 v6, 1279, v0
    v_or_b32 v123, v5, v6
    v_add_f32 v32, v32, v33
    v_add_f32 v34, v34, v35
    v_add_f32 v32, v32, v34
    v_cvt_pk_bf16_f32 v5, v32, v32
    v_lshlrev_b32 v32, 16, v5
    v_ashrrev_i32 v5, 31, v32
    v_or_b32 v5, 0x80000000, v5
    v_xor_b32 v5, v5, v32
    v_and_b32 v5, 0xffff0000, v5
    v_sub_u32 v6, 1023, v0
    v_or_b32 v124, v5, v6
    v_add_f32 v36, v36, v37
    v_add_f32 v38, v38, v39
    v_add_f32 v36, v36, v38
    v_cvt_pk_bf16_f32 v5, v36, v36
    v_lshlrev_b32 v36, 16, v5
    v_ashrrev_i32 v5, 31, v36
    v_or_b32 v5, 0x80000000, v5
    v_xor_b32 v5, v5, v36
    v_and_b32 v5, 0xffff0000, v5
    v_sub_u32 v6, 767, v0
    v_or_b32 v125, v5, v6
    v_max_u32 v5, v120, v121
    v_min_u32 v6, v120, v121
    v_med3_u32 v6, v5, v6, v122
    v_max_u32 v5, v5, v122
    v_med3_u32 v6, v5, v6, v123
    v_max_u32 v5, v5, v123
    v_med3_u32 v6, v5, v6, v124
    v_max_u32 v5, v5, v124
    v_med3_u32 v6, v5, v6, v125
    v_max_u32 v5, v5, v125
    v_med3_u32 v6, v5, v6, v126
    v_max_u32 v5, v5, v126
    v_mov_b32 v120, v5
    v_mov_b32 v121, v6
    s_mov_b32 s25, 32
L_M_round:
    v_lshlrev_b32 v3, 4, v0
    v_cmp_gt_u32 s[74:75], s25, v0
L_M7_rp:
    s_mov_b32 s36, 0x19b000
    buffer_load_dwordx4 v[44:47], v3, s[8:11], s36 offen sc1
    s_add_u32 s32, s32, 1
    v_mov_b32 v5, 0
    s_waitcnt vmcnt(0)
    v_max3_u32 v5, v5, v44, v45
    v_max3_u32 v5, v5, v46, v47
    v_cndmask_b32 v5, 0, v5, s[74:75]
    s_cmp_gt_u32 s32, 200000
    s_cbranch_scc1 L_M7_rp_ok
    v_cmp_eq_u32 vcc, -1, v5
    s_cbranch_vccnz L_M7_rp
L_M7_rp_ok:
    v_add_f32 v44, v44, v45
    v_add_f32 v46, v46, v47
    v_add_f32 v44, v44, v46
    v_cvt_pk_bf16_f32 v5, v44, v44
    v_lshlrev_b32 v44, 16, v5
    v_ashrrev_i32 v5, 31, v44
    v_or_b32 v5, 0x80000000, v5
    v_xor_b32 v5, v5, v44
    v_and_b32 v5, 0xffff0000, v5
    v_sub_u32 v6, 255, v0
    v_or_b32 v127, v5, v6
    v_cndmask_b32 v127, 0, v127, s[74:75]
    v_max_u32 v5, v120, v127
    v_med3_u32 v6, v120, v121, v127
    s_nop 0
    v_mov_b32_dpp v7, v5 quad_perm:[1,0,3,2] row_mask:0xf bank_mask:0xf
    v_mov_b32_dpp v8, v6 quad_perm:[1,0,3,2] row_mask:0xf bank_mask:0xf
    v_min_u32 v9, v5, v7
    v_max_u32 v5, v5, v7
    v_max3_u32 v6, v6, v8, v9
    s_nop 0
    v_mov_b32_dpp v7, v5 quad_perm:[2,3,0,1] row_mask:0xf bank_mask:0xf
    v_mov_b32_dpp v8, v6 quad_perm:[2,3,0,1] row_mask:0xf bank_mask:0xf
    v_min_u32 v9, v5, v7
    v_max_u32 v5, v5, v7
    v_max3_u32 v6, v6, v8, v9
    s_nop 0
    v_mov_b32_dpp v7, v5 row_half_mirror row_mask:0xf bank_mask:0xf
    v_mov_b32_dpp v8, v6 row_half_mirror row_mask:0xf bank_mask:0xf
    v_min_u32 v9, v5, v7
    v_max_u32 v5, v5, v7
    v_max3_u32 v6, v6, v8, v9
    s_nop 0
    v_mov_b32_dpp v7, v5 row_mirror row_mask:0xf bank_mask:0xf
    v_mov_b32_dpp v8, v6 row_mirror row_mask:0xf bank_mask:0xf
    v_min_u32 v9, v5, v7
    v_max_u32 v5, v5, v7
    v_max3_u32 v6, v6, v8, v9
    v_lshrrev_b32 v9, 4, v0
    v_lshlrev_b32 v9, 3, v9
    s_barrier
    ds_write2_b32 v9, v5, v6 offset0:0 offset1:1
    v_and_b32 v9, 15, v0
    v_lshlrev_b32 v9, 3, v9
    s_waitcnt lgkmcnt(0)
    s_barrier
    ds_read2_b32 v[10:11], v9 offset0:0 offset1:1
    s_waitcnt lgkmcnt(0)
    v_mov_b32 v5, v10
    v_mov_b32 v6, v11
    s_nop 0
    v_mov_b32_dpp v7, v5 quad_perm:[1,0,3,2] row_mask:0xf bank_mask:0xf
    v_mov_b32_dpp v8, v6 quad_perm:[1,0,3,2] row_mask:0xf bank_mask:0xf
    v_min_u32 v9, v5, v7
    v_max_u32 v5, v5, v7
    v_max3_u32 v6, v6, v8, v9
    s_nop 0
    v_mov_b32_dpp v7, v5 quad_perm:[2,3,0,1] row_mask:0xf bank_mask:0xf
    v_mov_b32_dpp v8, v6 quad_perm:[2,3,0,1] row_mask:0xf bank_mask:0xf
    v_min_u32 v9, v5, v7
    v_max_u32 v5, v5, v7
    v_max3_u32 v6, v6, v8, v9
    s_nop 0
    v_mov_b32_dpp v7, v5 row_half_mirror row_mask:0xf bank_mask:0xf
    v_mov_b32_dpp v8, v6 row_half_mirror row_mask:0xf bank_mask:0xf
    v_min_u32 v9, v5, v7
    v_max_u32 v5, v5, v7
    v_max3_u32 v6, v6, v8, v9
    s_nop 0
    v_mov_b32_dpp v7, v5 row_mirror row_mask:0xf bank_mask:0xf
    v_mov_b32_dpp v8, v6 row_mirror row_mask:0xf bank_mask:0xf
    v_min_u32 v9, v5, v7
    v_max_u32 v5, v5, v7
    v_max3_u32 v6, v6, v8, v9
    v_readfirstlane_b32 s26, v5
    v_readfirstlane_b32 s27, v6
    s_nop 3
    s_cmp_eq_u64 s[26:27], s[28:29]
    s_cbranch_scc1 L_M_next
    s_mov_b64 s[28:29], s[26:27]
    s_and_b32 s36, s26, 0x7ff
    s_sub_u32 s30, 2047, s36
    s_and_b32 s36, s26, 0xffff0000
    s_xor_b32 s37, s36, 0x80000000
    s_xor_b32 s40, s36, 0xffff0000
    s_bitcmp1_b32 s36, 31
    s_cselect_b32 s40, s37, s40
    s_and_b32 s36, s27, 0x7ff
    s_sub_u32 s31, 2047, s36
    s_and_b32 s36, s27, 0xffff0000
    s_xor_b32 s37, s36, 0x80000000
    s_xor_b32 s41, s36, 0xffff0000
    s_bitcmp1_b32 s36, 31
    s_cselect_b32 s41, s37, s41
    v_mov_b32 v8, 0
L_M_rows:
    s_lshl_b32 s36, s30, 4
    s_add_u32 s36, s36, 0x1b8000
    buffer_load_dwordx4 v[16:19], v8, s[8:11], s36 offen sc1
    s_lshl_b32 s36, s31, 4
    s_add_u32 s36, s36, 0x1b8000
    buffer_load_dwordx4 v[20:23], v8, s[8:11], s36 offen sc1
    s_add_u32 s32, s32, 1
    s_cmp_gt_u32 s32, 200000
    s_waitcnt vmcnt(0)
    v_or3_b32 v5, v16, v17, v18
    v_or3_b32 v5, v5, v19, v20
    v_or3_b32 v5, v5, v21, v22
    v_or_b32 v5, v5, v23
    s_cbranch_scc1 L_M_rows_ok
    v_cmp_ne_u32 vcc, 0, v5
    s_cbranch_vccnz L_M_rows
L_M_rows_ok:
    v_bfe_u32 v9, v0, 6, 1
    v_cmp_ne_u32 vcc, 0, v9
    v_mov_b32 v5, s30
    v_mov_b32 v6, s31
    v_cndmask_b32 v7, v5, v6, vcc
    v_lshlrev_b32 v7, 10, v7
    v_and_b32 v8, 63, v0
    v_lshl_add_u32 v7, v8, 4, v7
    s_mov_b32 s37, 0x600000
    buffer_load_dwordx4 v[16:19], v7, s[8:11], s37 offen sc1
    v_bfe_u32 v9, v0, 3, 1
    v_cmp_ne_u32 vcc, 0, v9
    s_nop 1
    v_cndmask_b32 v12, v5, v6, vcc
    v_mov_b32 v5, s40
    v_mov_b32 v6, s41
    v_cndmask_b32 v11, v5, v6, vcc
    v_lshlrev_b32 v12, 10, v12
    v_and_b32 v3, 7, v0
    v_lshl_add_u32 v12, v3, 2, v12
    s_lshl_b32 s36, s20, 5
    v_add_u32 v12, s36, v12
    v_mov_b32 v7, 0x40000000
    v_cmp_lt_u32 vcc, 15, v0
    s_nop 1
    v_cndmask_b32 v12, v12, v7, vcc
    s_mov_b32 s36, 0x400000
    buffer_load_dword v14, v12, s[8:11], s36 offen sc1
    buffer_load_dword v15, v12, s[8:11], s37 offen sc1
    v_and_b32 v8, 127, v0
    v_lshlrev_b32 v8, 4, v8
    s_waitcnt vmcnt(2)
    ds_write_b128 v8, v[16:19] offset:4096
    s_waitcnt lgkmcnt(0)
    s_barrier
    v_mov_b64 v[48:49], 0
    v_mov_b64 v[50:51], 0
    v_mov_b64 v[52:53], 0
    v_mov_b64 v[54:55], 0
    v_lshlrev_b32 v8, 7, v1
    ds_read_b128 v[16:19], v8 offset:4096
    ds_read_b128 v[20:23], v8 offset:4112
    ds_read_b128 v[24:27], v8 offset:4128
    ds_read_b128 v[28:31], v8 offset:4144
    ds_read_b128 v[32:35], v8 offset:5120
    ds_read_b128 v[36:39], v8 offset:5136
    ds_read_b128 v[40:43], v8 offset:5152
    ds_read_b128 v[44:47], v8 offset:5168
    s_waitcnt lgkmcnt(0)
    v_dot2_f32_bf16 v48, v16, v128, v48
    v_dot2_f32_bf16 v49, v16, v160, v49
    v_dot2_f32_bf16 v50, v32, v128, v50
    v_dot2_f32_bf16 v51, v32, v160, v51
    v_dot2_f32_bf16 v52, v16, v192, v52
    v_dot2_f32_bf16 v53, v16, v224, v53
    v_dot2_f32_bf16 v54, v32, v192, v54
    v_dot2_f32_bf16 v55, v32, v224, v55
    v_dot2_f32_bf16 v48, v17, v129, v48
    v_dot2_f32_bf16 v49, v17, v161, v49
    v_dot2_f32_bf16 v50, v33, v129, v50
    v_dot2_f32_bf16 v51, v33, v161, v51
    v_dot2_f32_bf16 v52, v17, v193, v52
    v_dot2_f32_bf16 v53, v17, v225, v53
    v_dot2_f32_bf16 v54, v33, v193, v54
    v_dot2_f32_bf16 v55, v33, v225, v55
    v_dot2_f32_bf16 v48, v18, v130, v48
    v_dot2_f32_bf16 v49, v18, v162, v49
    v_dot2_f32_bf16 v50, v34, v130, v50
    v_dot2_f32_bf16 v51, v34, v162, v51
    v_dot2_f32_bf16 v52, v18, v194, v52
    v_dot2_f32_bf16 v53, v18, v226, v53
    v_dot2_f32_bf16 v54, v34, v194, v54
    v_dot2_f32_bf16 v55, v34, v226, v55
    v_dot2_f32_bf16 v48, v19, v131, v48
    v_dot2_f32_bf16 v49, v19, v163, v49
    v_dot2_f32_bf16 v50, v35, v131, v50
    v_dot2_f32_bf16 v51, v35, v163, v51
    v_dot2_f32_bf16 v52, v19, v195, v52
    v_dot2_f32_bf16 v53, v19, v227, v53
    v_dot2_f32_bf16 v54, v35, v195, v54
    v_dot2_f32_bf16 v55, v35, v227, v55
    v_dot2_f32_bf16 v48, v20, v132, v48
    v_dot2_f32_bf16 v49, v20, v164, v49
    v_dot2_f32_bf16 v50, v36, v132, v50
    v_dot2_f32_bf16 v51, v36, v164, v51
    v_dot2_f32_bf16 v52, v20, v196, v52
    v_dot2_f32_bf16 v53, v20, v228, v53
    v_dot2_f32_bf16 v54, v36, v196, v54
    v_dot2_f32_bf16 v55, v36, v228, v55
    v_dot2_f32_bf16 v48, v21, v133, v48
    v_dot2_f32_bf16 v49, v21, v165, v49
    v_dot2_f32_bf16 v50, v37, v133, v50
    v_dot2_f32_bf16 v51, v37, v165, v51
    v_dot2_f32_bf16 v52, v21, v197, v52
    v_dot2_f32_bf16 v53, v21, v229, v53
    v_dot2_f32_bf16 v54, v37, v197, v54
    v_dot2_f32_bf16 v55, v37, v229, v55
    v_dot2_f32_bf16 v48, v22, v134, v48
    v_dot2_f32_bf16 v49, v22, v166, v49
    v_dot2_f32_bf16 v50, v38, v134, v50
    v_dot2_f32_bf16 v51, v38, v166, v51
    v_dot2_f32_bf16 v52, v22, v198, v52
    v_dot2_f32_bf16 v53, v22, v230, v53
    v_dot2_f32_bf16 v54, v38, v198, v54
    v_dot2_f32_bf16 v55, v38, v230, v55
    v_dot2_f32_bf16 v48, v23, v135, v48
    v_dot2_f32_bf16 v49, v23, v167, v49
    v_dot2_f32_bf16 v50, v39, v135, v50
    v_dot2_f32_bf16 v51, v39, v167, v51
    v_dot2_f32_bf16 v52, v23, v199, v52
    v_dot2_f32_bf16 v53, v23, v231, v53
    v_dot2_f32_bf16 v54, v39, v199, v54
    v_dot2_f32_bf16 v55, v39, v231, v55
    v_dot2_f32_bf16 v48, v24, v136, v48
    v_dot2_f32_bf16 v49, v24, v168, v49
    v_dot2_f32_bf16 v50, v40, v136, v50
    v_dot2_f32_bf16 v51, v40, v168, v51
    v_dot2_f32_bf16 v52, v24, v200, v52
    v_dot2_f32_bf16 v53, v24, v232, v53
    v_dot2_f32_bf16 v54, v40, v200, v54
    v_dot2_f32_bf16 v55, v40, v232, v55
    v_dot2_f32_bf16 v48, v25, v137, v48
    v_dot2_f32_bf16 v49, v25, v169, v49
    v_dot2_f32_bf16 v50, v41, v137, v50
    v_dot2_f32_bf16 v51, v41, v169, v51
    v_dot2_f32_bf16 v52, v25, v201, v52
    v_dot2_f32_bf16 v53, v25, v233, v53
    v_dot2_f32_bf16 v54, v41, v201, v54
    v_dot2_f32_bf16 v55, v41, v233, v55
    v_dot2_f32_bf16 v48, v26, v138, v48
    v_dot2_f32_bf16 v49, v26, v170, v49
    v_dot2_f32_bf16 v50, v42, v138, v50
    v_dot2_f32_bf16 v51, v42, v170, v51
    v_dot2_f32_bf16 v52, v26, v202, v52
    v_dot2_f32_bf16 v53, v26, v234, v53
    v_dot2_f32_bf16 v54, v42, v202, v54
    v_dot2_f32_bf16 v55, v42, v234, v55
    v_dot2_f32_bf16 v48, v27, v139, v48
    v_dot2_f32_bf16 v49, v27, v171, v49
    v_dot2_f32_bf16 v50, v43, v139, v50
    v_dot2_f32_bf16 v51, v43, v171, v51
    v_dot2_f32_bf16 v52, v27, v203, v52
    v_dot2_f32_bf16 v53, v27, v235, v53
    v_dot2_f32_bf16 v54, v43, v203, v54
    v_dot2_f32_bf16 v55, v43, v235, v55
    v_dot2_f32_bf16 v48, v28, v140, v48
    v_dot2_f32_bf16 v49, v28, v172, v49
    v_dot2_f32_bf16 v50, v44, v140, v50
    v_dot2_f32_bf16 v51, v44, v172, v51
    v_dot2_f32_bf16 v52, v28, v204, v52
    v_dot2_f32_bf16 v53, v28, v236, v53
    v_dot2_f32_bf16 v54, v44, v204, v54
    v_dot2_f32_bf16 v55, v44, v236, v55
    v_dot2_f32_bf16 v48, v29, v141, v48
    v_dot2_f32_bf16 v49, v29, v173, v49
    v_dot2_f32_bf16 v50, v45, v141, v50
    v_dot2_f32_bf16 v51, v45, v173, v51
    v_dot2_f32_bf16 v52, v29, v205, v52
    v_dot2_f32_bf16 v53, v29, v237, v53
    v_dot2_f32_bf16 v54, v45, v205, v54
    v_dot2_f32_bf16 v55, v45, v237, v55
    v_dot2_f32_bf16 v48, v30, v142, v48
    v_dot2_f32_bf16 v49, v30, v174, v49
    v_dot2_f32_bf16 v50, v46, v142, v50
    v_dot2_f32_bf16 v51, v46, v174, v51
    v_dot2_f32_bf16 v52, v30, v206, v52
    v_dot2_f32_bf16 v53, v30, v238, v53
    v_dot2_f32_bf16 v54, v46, v206, v54
    v_dot2_f32_bf16 v55, v46, v238, v55
    v_dot2_f32_bf16 v48, v31, v143, v48
    v_dot2_f32_bf16 v49, v31, v175, v49
    v_dot2_f32_bf16 v50, v47, v143, v50
    v_dot2_f32_bf16 v51, v47, v175, v51
    v_dot2_f32_bf16 v52, v31, v207, v52
    v_dot2_f32_bf16 v53, v31, v239, v53
    v_dot2_f32_bf16 v54, v47, v207, v54
    v_dot2_f32_bf16 v55, v47, v239, v55
    ds_read_b128 v[16:19], v8 offset:4160
    ds_read_b128 v[20:23], v8 offset:4176
    ds_read_b128 v[24:27], v8 offset:4192
    ds_read_b128 v[28:31], v8 offset:4208
    ds_read_b128 v[32:35], v8 offset:5184
    ds_read_b128 v[36:39], v8 offset:5200
    ds_read_b128 v[40:43], v8 offset:5216
    ds_read_b128 v[44:47], v8 offset:5232
    s_waitcnt lgkmcnt(0)
    v_dot2_f32_bf16 v48, v16, v144, v48
    v_dot2_f32_bf16 v49, v16, v176, v49
    v_dot2_f32_bf16 v50, v32, v144, v50
    v_dot2_f32_bf16 v51, v32, v176, v51
    v_dot2_f32_bf16 v52, v16, v208, v52
    v_dot2_f32_bf16 v53, v16, v240, v53
    v_dot2_f32_bf16 v54, v32, v208, v54
    v_dot2_f32_bf16 v55, v32, v240, v55
    v_dot2_f32_bf16 v48, v17, v145, v48
    v_dot2_f32_bf16 v49, v17, v177, v49
    v_dot2_f32_bf16 v50, v33, v145, v50
    v_dot2_f32_bf16 v51, v33, v177, v51
    v_dot2_f32_bf16 v52, v17, v209, v52
    v_dot2_f32_bf16 v53, v17, v241, v53
    v_dot2_f32_bf16 v54, v33, v209, v54
    v_dot2_f32_bf16 v55, v33, v241, v55
    v_dot2_f32_bf16 v48, v18, v146, v48
    v_dot2_f32_bf16 v49, v18, v178, v49
    v_dot2_f32_bf16 v50, v34, v146, v50
    v_dot2_f32_bf16 v51, v34, v178, v51
    v_dot2_f32_bf16 v52, v18, v210, v52
    v_dot2_f32_bf16 v53, v18, v242, v53
    v_dot2_f32_bf16 v54, v34, v210, v54
    v_dot2_f32_bf16 v55, v34, v242, v55
    v_dot2_f32_bf16 v48, v19, v147, v48
    v_dot2_f32_bf16 v49, v19, v179, v49
    v_dot2_f32_bf16 v50, v35, v147, v50
    v_dot2_f32_bf16 v51, v35, v179, v51
    v_dot2_f32_bf16 v52, v19, v211, v52
    v_dot2_f32_bf16 v53, v19, v243, v53
    v_dot2_f32_bf16 v54, v35, v211, v54
    v_dot2_f32_bf16 v55, v35, v243, v55
    v_dot2_f32_bf16 v48, v20, v148, v48
    v_dot2_f32_bf16 v49, v20, v180, v49
    v_dot2_f32_bf16 v50, v36, v148, v50
    v_dot2_f32_bf16 v51, v36, v180, v51
    v_dot2_f32_bf16 v52, v20, v212, v52
    v_dot2_f32_bf16 v53, v20, v244, v53
    v_dot2_f32_bf16 v54, v36, v212, v54
    v_dot2_f32_bf16 v55, v36, v244, v55
    v_dot2_f32_bf16 v48, v21, v149, v48
    v_dot2_f32_bf16 v49, v21, v181, v49
    v_dot2_f32_bf16 v50, v37, v149, v50
    v_dot2_f32_bf16 v51, v37, v181, v51
    v_dot2_f32_bf16 v52, v21, v213, v52
    v_dot2_f32_bf16 v53, v21, v245, v53
    v_dot2_f32_bf16 v54, v37, v213, v54
    v_dot2_f32_bf16 v55, v37, v245, v55
    v_dot2_f32_bf16 v48, v22, v150, v48
    v_dot2_f32_bf16 v49, v22, v182, v49
    v_dot2_f32_bf16 v50, v38, v150, v50
    v_dot2_f32_bf16 v51, v38, v182, v51
    v_dot2_f32_bf16 v52, v22, v214, v52
    v_dot2_f32_bf16 v53, v22, v246, v53
    v_dot2_f32_bf16 v54, v38, v214, v54
    v_dot2_f32_bf16 v55, v38, v246, v55
    v_dot2_f32_bf16 v48, v23, v151, v48
    v_dot2_f32_bf16 v49, v23, v183, v49
    v_dot2_f32_bf16 v50, v39, v151, v50
    v_dot2_f32_bf16 v51, v39, v183, v51
    v_dot2_f32_bf16 v52, v23, v215, v52
    v_dot2_f32_bf16 v53, v23, v247, v53
    v_dot2_f32_bf16 v54, v39, v215, v54
    v_dot2_f32_bf16 v55, v39, v247, v55
    v_dot2_f32_bf16 v48, v24, v152, v48
    v_dot2_f32_bf16 v49, v24, v184, v49
    v_dot2_f32_bf16 v50, v40, v152, v50
    v_dot2_f32_bf16 v51, v40, v184, v51
    v_dot2_f32_bf16 v52, v24, v216, v52
    v_dot2_f32_bf16 v53, v24, v248, v53
    v_dot2_f32_bf16 v54, v40, v216, v54
    v_dot2_f32_bf16 v55, v40, v248, v55
    v_dot2_f32_bf16 v48, v25, v153, v48
    v_dot2_f32_bf16 v49, v25, v185, v49
    v_dot2_f32_bf16 v50, v41, v153, v50
    v_dot2_f32_bf16 v51, v41, v185, v51
    v_dot2_f32_bf16 v52, v25, v217, v52
    v_dot2_f32_bf16 v53, v25, v249, v53
    v_dot2_f32_bf16 v54, v41, v217, v54
    v_dot2_f32_bf16 v55, v41, v249, v55
    v_dot2_f32_bf16 v48, v26, v154, v48
    v_dot2_f32_bf16 v49, v26, v186, v49
    v_dot2_f32_bf16 v50, v42, v154, v50
    v_dot2_f32_bf16 v51, v42, v186, v51
    v_dot2_f32_bf16 v52, v26, v218, v52
    v_dot2_f32_bf16 v53, v26, v250, v53
    v_dot2_f32_bf16 v54, v42, v218, v54
    v_dot2_f32_bf16 v55, v42, v250, v55
    v_dot2_f32_bf16 v48, v27, v155, v48
    v_dot2_f32_bf16 v49, v27, v187, v49
    v_dot2_f32_bf16 v50, v43, v155, v50
    v_dot2_f32_bf16 v51, v43, v187, v51
    v_dot2_f32_bf16 v52, v27, v219, v52
    v_dot2_f32_bf16 v53, v27, v251, v53
    v_dot2_f32_bf16 v54, v43, v219, v54
    v_dot2_f32_bf16 v55, v43, v251, v55
    v_dot2_f32_bf16 v48, v28, v156, v48
    v_dot2_f32_bf16 v49, v28, v188, v49
    v_dot2_f32_bf16 v50, v44, v156, v50
    v_dot2_f32_bf16 v51, v44, v188, v51
    v_dot2_f32_bf16 v52, v28, v220, v52
    v_dot2_f32_bf16 v53, v28, v252, v53
    v_dot2_f32_bf16 v54, v44, v220, v54
    v_dot2_f32_bf16 v55, v44, v252, v55
    v_dot2_f32_bf16 v48, v29, v157, v48
    v_dot2_f32_bf16 v49, v29, v189, v49
    v_dot2_f32_bf16 v50, v45, v157, v50
    v_dot2_f32_bf16 v51, v45, v189, v51
    v_dot2_f32_bf16 v52, v29, v221, v52
    v_dot2_f32_bf16 v53, v29, v253, v53
    v_dot2_f32_bf16 v54, v45, v221, v54
    v_dot2_f32_bf16 v55, v45, v253, v55
    v_dot2_f32_bf16 v48, v30, v158, v48
    v_dot2_f32_bf16 v49, v30, v190, v49
    v_dot2_f32_bf16 v50, v46, v158, v50
    v_dot2_f32_bf16 v51, v46, v190, v51
    v_dot2_f32_bf16 v52, v30, v222, v52
    v_dot2_f32_bf16 v53, v30, v254, v53
    v_dot2_f32_bf16 v54, v46, v222, v54
    v_dot2_f32_bf16 v55, v46, v254, v55
    v_dot2_f32_bf16 v48, v31, v159, v48
    v_dot2_f32_bf16 v49, v31, v191, v49
    v_dot2_f32_bf16 v50, v47, v159, v50
    v_dot2_f32_bf16 v51, v47, v191, v51
    v_dot2_f32_bf16 v52, v31, v223, v52
    v_dot2_f32_bf16 v53, v31, v255, v53
    v_dot2_f32_bf16 v54, v47, v223, v54
    v_dot2_f32_bf16 v55, v47, v255, v55
    s_nop 3
    v_lshlrev_b32 v7, 5, v0
    ds_write_b128 v7, v[48:51] offset:8192
    ds_write_b128 v7, v[52:55] offset:8208
    s_waitcnt lgkmcnt(0)
    s_barrier
    v_lshlrev_b32 v7, 5, v2
    v_bfe_u32 v8, v0, 5, 1
    v_lshl_add_u32 v7, v8, 3, v7
    ds_read_b64 v[16:17], v7 offset:8192
    ds_read_b64 v[18:19], v7 offset:8208
    ds_read_b64 v[20:21], v7 offset:9216
    ds_read_b64 v[22:23], v7 offset:9232
    ds_read_b64 v[24:25], v7 offset:10240
    ds_read_b64 v[26:27], v7 offset:10256
    ds_read_b64 v[28:29], v7 offset:11264
    ds_read_b64 v[30:31], v7 offset:11280
    s_waitcnt lgkmcnt(0)
    ds_read_b64 v[32:33], v7 offset:12288
    ds_read_b64 v[34:35], v7 offset:12304
    ds_read_b64 v[36:37], v7 offset:13312
    ds_read_b64 v[38:39], v7 offset:13328
    ds_read_b64 v[40:41], v7 offset:14336
    ds_read_b64 v[42:43], v7 offset:14352
    ds_read_b64 v[44:45], v7 offset:15360
    ds_read_b64 v[46:47], v7 offset:15376
    s_waitcnt lgkmcnt(0)
    v_add_f32 v16, v16, v20
    v_add_f32 v16, v16, v24
    v_add_f32 v16, v16, v28
    v_add_f32 v16, v16, v32
    v_add_f32 v16, v16, v36
    v_add_f32 v16, v16, v40
    v_add_f32 v16, v16, v44
    v_cvt_pk_bf16_f32 v5, v16, v16
    v_lshlrev_b32 v16, 16, v5
    v_add_f32 v17, v17, v21
    v_add_f32 v17, v17, v25
    v_add_f32 v17, v17, v29
    v_add_f32 v17, v17, v33
    v_add_f32 v17, v17, v37
    v_add_f32 v17, v17, v41
    v_add_f32 v17, v17, v45
    v_cvt_pk_bf16_f32 v5, v17, v17
    v_lshlrev_b32 v17, 16, v5
    v_add_f32 v18, v18, v22
    v_add_f32 v18, v18, v26
    v_add_f32 v18, v18, v30
    v_add_f32 v18, v18, v34
    v_add_f32 v18, v18, v38
    v_add_f32 v18, v18, v42
    v_add_f32 v18, v18, v46
    v_cvt_pk_bf16_f32 v5, v18, v18
    v_lshlrev_b32 v18, 16, v5
    v_add_f32 v19, v19, v23
    v_add_f32 v19, v19, v27
    v_add_f32 v19, v19, v31
    v_add_f32 v19, v19, v35
    v_add_f32 v19, v19, v39
    v_add_f32 v19, v19, v43
    v_add_f32 v19, v19, v47
    v_cvt_pk_bf16_f32 v5, v19, v19
    v_lshlrev_b32 v19, 16, v5
    v_mul_f32 v6, 0xbfb8aa3b, v16
    v_exp_f32 v6, v6
    s_nop 0
    v_add_f32 v6, 1.0, v6
    v_rcp_f32 v6, v6
    s_nop 0
    v_mul_f32 v16, v16, v6
    v_cvt_pk_bf16_f32 v5, v16, v16
    v_lshlrev_b32 v16, 16, v5
    v_mul_f32 v16, v16, v18
    v_mul_f32 v6, 0xbfb8aa3b, v17
    v_exp_f32 v6, v6
    s_nop 0
    v_add_f32 v6, 1.0, v6
    v_rcp_f32 v6, v6
    s_nop 0
    v_mul_f32 v17, v17, v6
    v_cvt_pk_bf16_f32 v5, v17, v17
    v_lshlrev_b32 v17, 16, v5
    v_mul_f32 v17, v17, v19
    v_cvt_pk_bf16_f32 v16, v16, v17
    v_mul_u32_u24 v8, 3584, v8
    v_lshl_add_u32 v7, v2, 2, v8
    v_mov_b32 v6, 0x40000000
    v_cmp_lt_u32 vcc, 27, v2
    s_nop 1
    v_cndmask_b32 v7, v7, v6, vcc
    v_cmp_lt_u32 vcc, 63, v0
    s_nop 1
    v_cndmask_b32 v7, v7, v6, vcc
    s_mul_i32 s37, s24, 8192
    s_add_u32 s37, s37, 0x1b0000
    s_add_u32 s36, s37, s23
    buffer_store_dword v16, v7, s[8:11], s36 offen sc1
    v_lshlrev_b32 v7, 4, v0
    v_add_u32 v8, 4096, v7
    v_cmp_lt_u32 vcc, 191, v0
    s_nop 1
    v_cndmask_b32 v8, v8, v6, vcc
L_M_act:
    buffer_load_dwordx4 v[20:23], v7, s[8:11], s37 offen sc1
    buffer_load_dwordx4 v[24:27], v8, s[8:11], s37 offen sc1
    s_add_u32 s32, s32, 1
    s_cmp_gt_u32 s32, 200000
    s_waitcnt vmcnt(0)
    v_max3_u32 v5, v20, v21, v22
    v_max3_u32 v5, v5, v23, v24
    v_max3_u32 v5, v5, v25, v26
    v_max_u32 v5, v5, v27
    s_cbranch_scc1 L_M_act_ok
    v_cmp_eq_u32 vcc, -1, v5
    s_cbranch_vccnz L_M_act
L_M_act_ok:
    ds_write_b128 v7, v[20:23] offset:16384
    ds_write_b128 v7, v[24:27] offset:20480
    s_waitcnt lgkmcnt(0)
    s_barrier
    v_lshrrev_b32 v7, 3, v0
    v_mul_u32_u24 v7, 112, v7
    v_mov_b64 v[48:49], 0
    v_mov_b64 v[50:51], 0
    ds_read_b128 v[16:19], v7 offset:16384
    ds_read_b128 v[20:23], v7 offset:16400
    ds_read_b128 v[24:27], v7 offset:16416
    ds_read_b128 v[28:31], v7 offset:16432
    ds_read_b128 v[32:35], v7 offset:16448
    ds_read_b128 v[36:39], v7 offset:16464
    ds_read_b128 v[40:43], v7 offset:16480
    s_waitcnt lgkmcnt(0)
    v_dot2_f32_bf16 v48, v16, v64, v48
    v_dot2_f32_bf16 v49, v16, v92, v49
    v_dot2_f32_bf16 v48, v17, v65, v48
    v_dot2_f32_bf16 v49, v17, v93, v49
    v_dot2_f32_bf16 v48, v18, v66, v48
    v_dot2_f32_bf16 v49, v18, v94, v49
    v_dot2_f32_bf16 v48, v19, v67, v48
    v_dot2_f32_bf16 v49, v19, v95, v49
    v_dot2_f32_bf16 v48, v20, v68, v48
    v_dot2_f32_bf16 v49, v20, v96, v49
    v_dot2_f32_bf16 v48, v21, v69, v48
    v_dot2_f32_bf16 v49, v21, v97, v49
    v_dot2_f32_bf16 v48, v22, v70, v48
    v_dot2_f32_bf16 v49, v22, v98, v49
    v_dot2_f32_bf16 v48, v23, v71, v48
    v_dot2_f32_bf16 v49, v23, v99, v49
    v_dot2_f32_bf16 v48, v24, v72, v48
    v_dot2_f32_bf16 v49, v24, v100, v49
    v_dot2_f32_bf16 v48, v25, v73, v48
    v_dot2_f32_bf16 v49, v25, v101, v49
    v_dot2_f32_bf16 v48, v26, v74, v48
    v_dot2_f32_bf16 v49, v26, v102, v49
    v_dot2_f32_bf16 v48, v27, v75, v48
    v_dot2_f32_bf16 v49, v27, v103, v49
    v_dot2_f32_bf16 v48, v28, v76, v48
    v_dot2_f32_bf16 v49, v28, v104, v49
    v_dot2_f32_bf16 v48, v29, v77, v48
    v_dot2_f32_bf16 v49, v29, v105, v49
    v_dot2_f32_bf16 v48, v30, v78, v48
    v_dot2_f32_bf16 v49, v30, v106, v49
    v_dot2_f32_bf16 v48, v31, v79, v48
    v_dot2_f32_bf16 v49, v31, v107, v49
    v_dot2_f32_bf16 v48, v32, v80, v48
    v_dot2_f32_bf16 v49, v32, v108, v49
    v_dot2_f32_bf16 v48, v33, v81, v48
    v_dot2_f32_bf16 v49, v33, v109, v49
    v_dot2_f32_bf16 v48, v34, v82, v48
    v_dot2_f32_bf16 v49, v34, v110, v49
    v_dot2_f32_bf16 v48, v35, v83, v48
    v_dot2_f32_bf16 v49, v35, v111, v49
    v_dot2_f32_bf16 v48, v36, v84, v48
    v_dot2_f32_bf16 v49, v36, v112, v49
    v_dot2_f32_bf16 v48, v37, v85, v48
    v_dot2_f32_bf16 v49, v37, v113, v49
    v_dot2_f32_bf16 v48, v38, v86, v48
    v_dot2_f32_bf16 v49, v38, v114, v49
    v_dot2_f32_bf16 v48, v39, v87, v48
    v_dot2_f32_bf16 v49, v39, v115, v49
    v_dot2_f32_bf16 v48, v40, v88, v48
    v_dot2_f32_bf16 v49, v40, v116, v49
    v_dot2_f32_bf16 v48, v41, v89, v48
    v_dot2_f32_bf16 v49, v41, v117, v49
    v_dot2_f32_bf16 v48, v42, v90, v48
    v_dot2_f32_bf16 v49, v42, v118, v49
    v_dot2_f32_bf16 v48, v43, v91, v48
    v_dot2_f32_bf16 v49, v43, v119, v49
    ds_read_b128 v[16:19], v7 offset:19968
    ds_read_b128 v[20:23], v7 offset:19984
    ds_read_b128 v[24:27], v7 offset:20000
    ds_read_b128 v[28:31], v7 offset:20016
    ds_read_b128 v[32:35], v7 offset:20032
    ds_read_b128 v[36:39], v7 offset:20048
    ds_read_b128 v[40:43], v7 offset:20064
    s_waitcnt lgkmcnt(0)
    v_dot2_f32_bf16 v50, v16, v64, v50
    v_dot2_f32_bf16 v51, v16, v92, v51
    v_dot2_f32_bf16 v50, v17, v65, v50
    v_dot2_f32_bf16 v51, v17, v93, v51
    v_dot2_f32_bf16 v50, v18, v66, v50
    v_dot2_f32_bf16 v51, v18, v94, v51
    v_dot2_f32_bf16 v50, v19, v67, v50
    v_dot2_f32_bf16 v51, v19, v95, v51
    v_dot2_f32_bf16 v50, v20, v68, v50
    v_dot2_f32_bf16 v51, v20, v96, v51
    v_dot2_f32_bf16 v50, v21, v69, v50
    v_dot2_f32_bf16 v51, v21, v97, v51
    v_dot2_f32_bf16 v50, v22, v70, v50
    v_dot2_f32_bf16 v51, v22, v98, v51
    v_dot2_f32_bf16 v50, v23, v71, v50
    v_dot2_f32_bf16 v51, v23, v99, v51
    v_dot2_f32_bf16 v50, v24, v72, v50
    v_dot2_f32_bf16 v51, v24, v100, v51
    v_dot2_f32_bf16 v50, v25, v73, v50
    v_dot2_f32_bf16 v51, v25, v101, v51
    v_dot2_f32_bf16 v50, v26, v74, v50
    v_dot2_f32_bf16 v51, v26, v102, v51
    v_dot2_f32_bf16 v50, v27, v75, v50
    v_dot2_f32_bf16 v51, v27, v103, v51
    v_dot2_f32_bf16 v50, v28, v76, v50
    v_dot2_f32_bf16 v51, v28, v104, v51
    v_dot2_f32_bf16 v50, v29, v77, v50
    v_dot2_f32_bf16 v51, v29, v105, v51
    v_dot2_f32_bf16 v50, v30, v78, v50
    v_dot2_f32_bf16 v51, v30, v106, v51
    v_dot2_f32_bf16 v50, v31, v79, v50
    v_dot2_f32_bf16 v51, v31, v107, v51
    v_dot2_f32_bf16 v50, v32, v80, v50
    v_dot2_f32_bf16 v51, v32, v108, v51
    v_dot2_f32_bf16 v50, v33, v81, v50
    v_dot2_f32_bf16 v51, v33, v109, v51
    v_dot2_f32_bf16 v50, v34, v82, v50
    v_dot2_f32_bf16 v51, v34, v110, v51
    v_dot2_f32_bf16 v50, v35, v83, v50
    v_dot2_f32_bf16 v51, v35, v111, v51
    v_dot2_f32_bf16 v50, v36, v84, v50
    v_dot2_f32_bf16 v51, v36, v112, v51
    v_dot2_f32_bf16 v50, v37, v85, v50
    v_dot2_f32_bf16 v51, v37, v113, v51
    v_dot2_f32_bf16 v50, v38, v86, v50
    v_dot2_f32_bf16 v51, v38, v114, v51
    v_dot2_f32_bf16 v50, v39, v87, v50
    v_dot2_f32_bf16 v51, v39, v115, v51
    v_dot2_f32_bf16 v50, v40, v88, v50
    v_dot2_f32_bf16 v51, v40, v116, v51
    v_dot2_f32_bf16 v50, v41, v89, v50
    v_dot2_f32_bf16 v51, v41, v117, v51
    v_dot2_f32_bf16 v50, v42, v90, v50
    v_dot2_f32_bf16 v51, v42, v118, v51
    v_dot2_f32_bf16 v50, v43, v91, v50
    v_dot2_f32_bf16 v51, v43, v119, v51
    s_nop 3
    v_add_f32_dpp v48, v48, v48 row_ror:8 row_mask:0xf bank_mask:0xf
    v_add_f32_dpp v49, v49, v49 row_ror:8 row_mask:0xf bank_mask:0xf
    v_add_f32_dpp v50, v50, v50 row_ror:8 row_mask:0xf bank_mask:0xf
    v_add_f32_dpp v51, v51, v51 row_ror:8 row_mask:0xf bank_mask:0xf
    v_mov_b32 v5, v48
    s_nop 1
    v_permlane16_swap_b32 v48, v5
    v_add_f32 v48, v48, v5
    v_mov_b32 v5, v49
    s_nop 1
    v_permlane16_swap_b32 v49, v5
    v_add_f32 v49, v49, v5
    v_mov_b32 v5, v50
    s_nop 1
    v_permlane16_swap_b32 v50, v5
    v_add_f32 v50, v50, v5
    v_mov_b32 v5, v51
    s_nop 1
    v_permlane16_swap_b32 v51, v5
    v_add_f32 v51, v51, v5
    v_mov_b32 v5, v48
    s_nop 1
    v_permlane32_swap_b32 v48, v5
    v_add_f32 v48, v48, v5
    v_mov_b32 v5, v49
    s_nop 1
    v_permlane32_swap_b32 v49, v5
    v_add_f32 v49, v49, v5
    v_mov_b32 v5, v50
    s_nop 1
    v_permlane32_swap_b32 v50, v5
    v_add_f32 v50, v50, v5
    v_mov_b32 v5, v51
    s_nop 1
    v_permlane32_swap_b32 v51, v5
    v_add_f32 v51, v51, v5
    v_lshrrev_b32 v7, 6, v0
    v_lshlrev_b32 v7, 7, v7
    v_lshl_add_u32 v7, v3, 4, v7
    ds_write_b128 v7, v[48:51] offset:1024
    s_waitcnt lgkmcnt(0)
    s_barrier
    v_lshlrev_b32 v7, 4, v3
    v_lshl_add_u32 v7, v9, 3, v7
    ds_read_b64 v[16:17], v7 offset:1024
    ds_read_b64 v[18:19], v7 offset:1152
    ds_read_b64 v[20:21], v7 offset:1280
    ds_read_b64 v[22:23], v7 offset:1408
    v_mul_f32 v10, 0xbfb8aa3b, v11
    v_exp_f32 v10, v10
    s_nop 0
    v_add_f32 v10, 1.0, v10
    v_rcp_f32 v10, v10
    s_nop 0
    v_cvt_pk_bf16_f32 v5, v10, v10
    v_lshlrev_b32 v10, 16, v5
    s_waitcnt lgkmcnt(0)
    v_lshlrev_b32 v24, 16, v15
    v_and_b32 v25, 0xffff0000, v15
    v_lshlrev_b32 v26, 16, v14
    v_and_b32 v27, 0xffff0000, v14
    v_add_f32 v16, v16, v18
    v_add_f32 v20, v20, v22
    v_add_f32 v16, v16, v20
    v_cvt_pk_bf16_f32 v5, v16, v16
    v_lshlrev_b32 v16, 16, v5
    v_mul_f32 v16, v16, v10
    v_cvt_pk_bf16_f32 v5, v16, v16
    v_lshlrev_b32 v16, 16, v5
    v_add_f32 v16, v16, v24
    v_cvt_pk_bf16_f32 v5, v16, v16
    v_lshlrev_b32 v16, 16, v5
    v_add_f32 v16, v16, v26
    v_add_f32 v17, v17, v19
    v_add_f32 v21, v21, v23
    v_add_f32 v17, v17, v21
    v_cvt_pk_bf16_f32 v5, v17, v17
    v_lshlrev_b32 v17, 16, v5
    v_mul_f32 v17, v17, v10
    v_cvt_pk_bf16_f32 v5, v17, v17
    v_lshlrev_b32 v17, 16, v5
    v_add_f32 v17, v17, v25
    v_cvt_pk_bf16_f32 v5, v17, v17
    v_lshlrev_b32 v17, 16, v5
    v_add_f32 v17, v17, v27
    v_cvt_pk_bf16_f32 v13, v16, v17
L_M_next:
    s_add_u32 s24, s24, 1
    s_mov_b32 s25, 192
    s_cmp_eq_u32 s24, 1
    s_cbranch_scc1 L_M_round
    s_mov_b32 s25, 256
    s_cmp_eq_u32 s24, 2
    s_cbranch_scc1 L_M_round
    buffer_store_dword v13, v12, s[60:63], 0 offen sc1
L_end:
    s_endpgm
.section .rodata,"a"
.p2align 6
.amdhsa_kernel sequential_preLN__memory_aug_recurrent_mem_tr__moe_arch_mod__prompt_kernel
  .amdhsa_next_free_vgpr 512
  .amdhsa_next_free_sgpr 102
  .amdhsa_accum_offset 256
  .amdhsa_group_segment_fixed_size 0
  .amdhsa_kernarg_size 120
  .amdhsa_user_sgpr_count 2
  .amdhsa_user_sgpr_kernarg_segment_ptr 1
  .amdhsa_system_sgpr_workgroup_id_x 1
.end_amdhsa_kernel
```

```asm
; @launch grid=(256,1,1) block=(256,1,1) lds=163840
.amdgcn_target "amdgcn-amd-amdhsa--gfx950"
.text
.globl sequential_preLN__memory_aug_recurrent_mem_tr__moe_arch_mod__prompt_kernel
.p2align 8
.type sequential_preLN__memory_aug_recurrent_mem_tr__moe_arch_mod__prompt_kernel,@function
sequential_preLN__memory_aug_recurrent_mem_tr__moe_arch_mod__prompt_kernel:
    s_cmp_ge_u32 s2, 256
    s_cbranch_scc1 L_end
    s_load_dwordx8 s[44:51], s[0:1], 0
    s_load_dwordx4 s[52:55], s[0:1], 32
    s_load_dwordx4 s[56:59], s[0:1], 104
    s_load_dwordx2 s[80:81], s[0:1], 64
    s_load_dwordx2 s[82:83], s[0:1], 96
    s_load_dwordx4 s[84:87], s[0:1], 72
    s_load_dwordx2 s[88:89], s[0:1], 88
    v_lshrrev_b32 v1, 6, v0
    s_nop 0
    v_readfirstlane_b32 s21, v1
    s_waitcnt lgkmcnt(0)
    s_mov_b32 s8, s58
    s_and_b32 s9, s59, 0xffff
    s_mov_b32 s10, 0x10000000
    s_mov_b32 s11, 0x20000
    s_mov_b32 s16, s56
    s_and_b32 s17, s57, 0xffff
    s_mov_b32 s18, 0x100
    s_mov_b32 s19, 0x20000
    s_and_b32 s3, s2, 7
    s_cmp_lg_u32 s3, 0
    s_cbranch_scc1 L_worker
    s_lshr_b32 s20, s2, 3
    v_mov_b32 v1, 0x4444
    v_bfe_u32 v14, v0, 1, 1
    s_mov_b32 s38, 0xaaaa
    v_mad_u32_u24 v1, v14, s38, v1
    v_mov_b32 v3, 0x0
    v_bfe_u32 v14, v0, 0, 1
    s_mov_b32 s38, 0x10
    v_mad_u32_u24 v3, v14, s38, v3
    v_bfe_u32 v14, v0, 1, 1
    s_mov_b32 s38, 0x20
    v_mad_u32_u24 v3, v14, s38, v3
    v_bfe_u32 v14, v0, 2, 1
    s_mov_b32 s38, 0x40
    v_mad_u32_u24 v3, v14, s38, v3
    v_bfe_u32 v14, v0, 3, 1
    s_mov_b32 s38, 0x80
    v_mad_u32_u24 v3, v14, s38, v3
    v_bfe_u32 v14, v0, 4, 1
    s_mov_b32 s38, 0x100
    v_mad_u32_u24 v3, v14, s38, v3
    v_bfe_u32 v14, v0, 5, 1
    s_mov_b32 s38, 0x200
    v_mad_u32_u24 v3, v14, s38, v3
    v_mov_b32 v2, 0x0
    v_bfe_u32 v14, v0, 0, 1
    s_mov_b32 s38, 0x10
    v_mad_u32_u24 v2, v14, s38, v2
    v_bfe_u32 v14, v0, 1, 1
    s_mov_b32 s38, 0x20
    v_mad_u32_u24 v2, v14, s38, v2
    v_bfe_u32 v14, v0, 2, 1
    s_mov_b32 s38, 0x40
    v_mad_u32_u24 v2, v14, s38, v2
    v_bfe_u32 v14, v0, 3, 1
    s_mov_b32 s38, 0x80
    v_mad_u32_u24 v2, v14, s38, v2
    v_bfe_u32 v14, v0, 4, 1
    s_mov_b32 s38, 0x100
    v_mad_u32_u24 v2, v14, s38, v2
    v_bfe_u32 v14, v0, 5, 1
    s_mov_b32 s38, 0x200
    v_mad_u32_u24 v2, v14, s38, v2
    v_bfe_u32 v14, v0, 6, 1
    s_mov_b32 s38, 0x800
    v_mad_u32_u24 v2, v14, s38, v2
    v_bfe_u32 v14, v0, 7, 1
    s_mov_b32 s38, 0x1000
    v_mad_u32_u24 v2, v14, s38, v2
    v_mov_b32 v4, 0x8000
    v_bfe_u32 v14, v0, 0, 1
    s_mov_b32 s38, 0x10
    v_mad_u32_u24 v4, v14, s38, v4
    v_bfe_u32 v14, v0, 1, 1
    s_mov_b32 s38, 0x20
    v_mad_u32_u24 v4, v14, s38, v4
    v_bfe_u32 v14, v0, 2, 1
    s_mov_b32 s38, 0x40
    v_mad_u32_u24 v4, v14, s38, v4
    v_bfe_u32 v14, v0, 3, 1
    s_mov_b32 s38, 0x80
    v_mad_u32_u24 v4, v14, s38, v4
    v_bfe_u32 v14, v0, 4, 1
    s_mov_b32 s38, 0x100
    v_mad_u32_u24 v4, v14, s38, v4
    v_bfe_u32 v14, v0, 5, 1
    s_mov_b32 s38, 0x200
    v_mad_u32_u24 v4, v14, s38, v4
    v_bfe_u32 v14, v0, 6, 1
    s_mov_b32 s38, 0x8000
    v_mad_u32_u24 v4, v14, s38, v4
    v_bfe_u32 v14, v0, 7, 1
    s_mov_b32 s38, 0x10000
    v_mad_u32_u24 v4, v14, s38, v4
    v_mov_b32 v5, 0x4000
    v_bfe_u32 v14, v0, 0, 1
    s_mov_b32 s38, 0x4
    v_mad_u32_u24 v5, v14, s38, v5
    v_bfe_u32 v14, v0, 1, 1
    s_mov_b32 s38, 0x8
    v_mad_u32_u24 v5, v14, s38, v5
    v_bfe_u32 v14, v0, 2, 1
    s_mov_b32 s38, 0x10
    v_mad_u32_u24 v5, v14, s38, v5
    v_bfe_u32 v14, v0, 3, 1
    s_mov_b32 s38, 0x20
    v_mad_u32_u24 v5, v14, s38, v5
    v_bfe_u32 v14, v0, 4, 1
    s_mov_b32 s38, 0x240
    v_mad_u32_u24 v5, v14, s38, v5
    v_bfe_u32 v14, v0, 5, 1
    s_mov_b32 s38, 0x480
    v_mad_u32_u24 v5, v14, s38, v5
    v_bfe_u32 v14, v0, 6, 1
    s_mov_b32 s38, 0x40
    v_mad_u32_u24 v5, v14, s38, v5
    v_bfe_u32 v14, v0, 7, 1
    s_mov_b32 s38, 0x80
    v_mad_u32_u24 v5, v14, s38, v5
    v_mov_b32 v6, 0x4000
    v_bfe_u32 v14, v0, 0, 1
    s_mov_b32 s38, 0x120
    v_mad_u32_u24 v6, v14, s38, v6
    v_bfe_u32 v14, v0, 2, 1
    s_mov_b32 s38, 0x240
    v_mad_u32_u24 v6, v14, s38, v6
    v_bfe_u32 v14, v0, 3, 1
    s_mov_b32 s38, 0x480
    v_mad_u32_u24 v6, v14, s38, v6
    v_bfe_u32 v14, v0, 4, 1
    s_mov_b32 s38, 0x10
    v_mad_u32_u24 v6, v14, s38, v6
    v_bfe_u32 v14, v0, 5, 1
    s_mov_b32 s38, 0x20
    v_mad_u32_u24 v6, v14, s38, v6
    v_add_u32 v7, 2304, v5
    v_xor_b32 v8, 0x1000, v2
    v_mov_b32 v13, 0x0
    v_bfe_u32 v14, v0, 0, 1
    s_mov_b32 s38, 0x4
    v_mad_u32_u24 v13, v14, s38, v13
    v_bfe_u32 v14, v0, 1, 1
    s_mov_b32 s38, 0x8
    v_mad_u32_u24 v13, v14, s38, v13
    v_bfe_u32 v14, v0, 2, 1
    s_mov_b32 s38, 0x10
    v_mad_u32_u24 v13, v14, s38, v13
    v_bfe_u32 v14, v0, 3, 1
    s_mov_b32 s38, 0x20
    v_mad_u32_u24 v13, v14, s38, v13
    v_bfe_u32 v14, v0, 4, 1
    s_mov_b32 s38, 0x40
    v_mad_u32_u24 v13, v14, s38, v13
    v_mov_b32 v24, 0x0
    v_bfe_u32 v14, v0, 3, 1
    s_mov_b32 s38, 0x1
    v_mad_u32_u24 v24, v14, s38, v24
    v_bfe_u32 v14, v0, 4, 1
    s_mov_b32 s38, 0x2
    v_mad_u32_u24 v24, v14, s38, v24
    v_bfe_u32 v14, v0, 5, 1
    s_mov_b32 s38, 0x4
    v_mad_u32_u24 v24, v14, s38, v24
    v_bfe_u32 v14, v0, 6, 1
    s_mov_b32 s38, 0x8
    v_mad_u32_u24 v24, v14, s38, v24
    v_bfe_u32 v14, v0, 7, 1
    s_mov_b32 s38, 0x10
    v_mad_u32_u24 v24, v14, s38, v24
    v_add_u32 v24, s20, v24
    v_and_b32 v24, 31, v24
    v_lshlrev_b32 v24, 6, v24
    v_mov_b32 v9, 0x0
    v_bfe_u32 v14, v0, 0, 1
    s_mov_b32 s38, 0x8
    v_mad_u32_u24 v9, v14, s38, v9
    v_bfe_u32 v14, v0, 1, 1
    s_mov_b32 s38, 0x10
    v_mad_u32_u24 v9, v14, s38, v9
    v_bfe_u32 v14, v0, 2, 1
    s_mov_b32 s38, 0x20
    v_mad_u32_u24 v9, v14, s38, v9
    v_bfe_u32 v14, v0, 3, 1
    s_mov_b32 s38, 0x2000
    v_mad_u32_u24 v9, v14, s38, v9
    v_bfe_u32 v14, v0, 4, 1
    s_mov_b32 s38, 0x4000
    v_mad_u32_u24 v9, v14, s38, v9
    v_bfe_u32 v14, v0, 5, 1
    s_mov_b32 s38, 0x8000
    v_mad_u32_u24 v9, v14, s38, v9
    v_bfe_u32 v14, v0, 6, 1
    s_mov_b32 s38, 0x10000
    v_mad_u32_u24 v9, v14, s38, v9
    v_bfe_u32 v14, v0, 7, 1
    s_mov_b32 s38, 0x20000
    v_mad_u32_u24 v9, v14, s38, v9
    v_add_u32 v9, v9, v24
    v_mov_b32 v10, 0x80000
    v_bfe_u32 v14, v0, 0, 1
    s_mov_b32 s38, 0x8
    v_mad_u32_u24 v10, v14, s38, v10
    v_bfe_u32 v14, v0, 1, 1
    s_mov_b32 s38, 0x20
    v_mad_u32_u24 v10, v14, s38, v10
    v_bfe_u32 v14, v0, 4, 1
    s_mov_b32 s38, 0x10
    v_mad_u32_u24 v10, v14, s38, v10
    v_bfe_u32 v14, v0, 5, 1
    s_mov_b32 s38, 0x4
    v_mad_u32_u24 v10, v14, s38, v10
    v_bfe_u32 v14, v0, 6, 1
    s_mov_b32 s38, 0x800
    v_mad_u32_u24 v10, v14, s38, v10
    v_bfe_u32 v14, v0, 7, 1
    s_mov_b32 s38, 0x1000
    v_mad_u32_u24 v10, v14, s38, v10
    v_mov_b32 v25, s20
    v_mov_b32 v24, 0x0
    v_bfe_u32 v14, v25, 0, 1
    s_mov_b32 s38, 0x100
    v_mad_u32_u24 v24, v14, s38, v24
    v_bfe_u32 v14, v25, 1, 1
    s_mov_b32 s38, 0x40
    v_mad_u32_u24 v24, v14, s38, v24
    v_bfe_u32 v14, v25, 2, 1
    s_mov_b32 s38, 0x80
    v_mad_u32_u24 v24, v14, s38, v24
    v_bfe_u32 v14, v25, 3, 1
    s_mov_b32 s38, 0x200
    v_mad_u32_u24 v24, v14, s38, v24
    v_bfe_u32 v14, v25, 4, 1
    s_mov_b32 s38, 0x400
    v_mad_u32_u24 v24, v14, s38, v24
    v_add_u32 v10, v24, v10
    v_and_b32 v24, 12, v0
    v_cmp_ne_u32 vcc, 0, v24
    v_mov_b32 v24, 0x40000000
    s_nop 0
    v_cndmask_b32 v10, v10, v24, vcc
    s_lshl_b32 s6, s20, 13
    s_add_u32 s6, s6, 0x0
    s_mov_b32 s26, 4096
    v_and_b32 v24, 15, v0
    v_mov_b32 v16, 0
    v_mov_b32 v25, 0x3f80
    v_cmp_eq_u32 vcc, 0, v24
    s_nop 1
    v_cndmask_b32 v16, v16, v25, vcc
    v_mov_b32 v25, 0x3f800000
    v_cmp_eq_u32 vcc, 1, v24
    s_nop 1
    v_cndmask_b32 v16, v16, v25, vcc
    v_mov_b32 v17, 0
    v_mov_b32 v25, 0x3f80
    v_cmp_eq_u32 vcc, 4, v24
    s_nop 1
    v_cndmask_b32 v17, v17, v25, vcc
    v_mov_b32 v25, 0x3f800000
    v_cmp_eq_u32 vcc, 5, v24
    s_nop 1
    v_cndmask_b32 v17, v17, v25, vcc
    v_mov_b32 v18, 0
    v_mov_b32 v25, 0x3f80
    v_cmp_eq_u32 vcc, 8, v24
    s_nop 1
    v_cndmask_b32 v18, v18, v25, vcc
    v_mov_b32 v25, 0x3f800000
    v_cmp_eq_u32 vcc, 9, v24
    s_nop 1
    v_cndmask_b32 v18, v18, v25, vcc
    v_mov_b32 v19, 0
    v_mov_b32 v25, 0x3f80
    v_cmp_eq_u32 vcc, 12, v24
    s_nop 1
    v_cndmask_b32 v19, v19, v25, vcc
    v_mov_b32 v25, 0x3f800000
    v_cmp_eq_u32 vcc, 13, v24
    s_nop 1
    v_cndmask_b32 v19, v19, v25, vcc
    ds_write_b128 v3, v[16:19] offset:23040
    s_mov_b32 s34, 0x05040100
    s_mov_b32 s35, 0x07060302
    s_mov_b32 s33, 0x3e0293ee
    s_mov_b32 s40, 0x4e800000
    s_mov_b32 s32, 0
    s_mov_b32 s4, 0x3f803f80
    s_mov_b32 s5, 0x3f803f80
    s_lshl_b32 s36, s20, 14
    s_lshr_b32 s37, s21, 1
    s_lshl_b32 s37, s37, 12
    s_add_u32 s25, s36, s37
    s_lshl_b32 s37, s21, 11
    s_add_u32 s39, s36, s37
    s_add_u32 s39, s39, 8192
    v_mov_b32 v11, 0x0
    v_bfe_u32 v14, v0, 0, 1
    s_mov_b32 s38, 0x4
    v_mad_u32_u24 v11, v14, s38, v11
    v_bfe_u32 v14, v0, 1, 1
    s_mov_b32 s38, 0x8
    v_mad_u32_u24 v11, v14, s38, v11
    v_bfe_u32 v14, v0, 2, 1
    s_mov_b32 s38, 0x10
    v_mad_u32_u24 v11, v14, s38, v11
    v_bfe_u32 v14, v0, 3, 1
    s_mov_b32 s38, 0x20
    v_mad_u32_u24 v11, v14, s38, v11
    v_bfe_u32 v14, v0, 4, 1
    s_mov_b32 s38, 0x800
    v_mad_u32_u24 v11, v14, s38, v11
    v_bfe_u32 v14, v0, 5, 1
    s_mov_b32 s38, 0x1000
    v_mad_u32_u24 v11, v14, s38, v11
    v_bfe_u32 v14, v0, 6, 1
    s_mov_b32 s38, 0x100
    v_mad_u32_u24 v11, v14, s38, v11
    v_bfe_u32 v14, v0, 7, 1
    s_mov_b32 s38, 0x200
    v_mad_u32_u24 v11, v14, s38, v11
    s_mov_b32 s96, s48
    s_and_b32 s97, s49, 0xffff
    s_mov_b32 s98, 0x400000
    s_mov_b32 s99, 0x20000
    s_mov_b32 s88, s50
    s_and_b32 s89, s51, 0xffff
    s_mov_b32 s90, 0x400000
    s_mov_b32 s91, 0x20000
    s_mov_b32 s60, s52
    s_and_b32 s61, s53, 0xffff
    s_mov_b32 s62, 0x400000
    s_mov_b32 s63, 0x20000
    s_mov_b32 s92, s54
    s_and_b32 s93, s55, 0xffff
    s_mov_b32 s94, 0x400000
    s_mov_b32 s95, 0x20000
    s_lshl_b32 s29, s20, 17
    v_mov_b32 v16, 0x0
    v_bfe_u32 v14, v0, 0, 1
    s_mov_b32 s38, 0x10
    v_mad_u32_u24 v16, v14, s38, v16
    v_bfe_u32 v14, v0, 1, 1
    s_mov_b32 s38, 0x20
    v_mad_u32_u24 v16, v14, s38, v16
    v_bfe_u32 v14, v0, 2, 1
    s_mov_b32 s38, 0x40
    v_mad_u32_u24 v16, v14, s38, v16
    v_bfe_u32 v14, v0, 3, 1
    s_mov_b32 s38, 0x80
    v_mad_u32_u24 v16, v14, s38, v16
    v_bfe_u32 v14, v0, 4, 1
    s_mov_b32 s38, 0x2000
    v_mad_u32_u24 v16, v14, s38, v16
    v_bfe_u32 v14, v0, 5, 1
    s_mov_b32 s38, 0x4000
    v_mad_u32_u24 v16, v14, s38, v16
    v_bfe_u32 v14, v0, 6, 1
    s_mov_b32 s38, 0x40000
    v_mad_u32_u24 v16, v14, s38, v16
    v_bfe_u32 v14, v0, 7, 1
    s_mov_b32 s38, 0x80000
    v_mad_u32_u24 v16, v14, s38, v16
    v_mov_b32 v28, 0x0
    v_bfe_u32 v14, v0, 4, 1
    s_mov_b32 s38, 0x20
    v_mad_u32_u24 v28, v14, s38, v28
    v_xor_b32 v16, v16, v28
    v_xor_b32 v17, 64, v16
    v_xor_b32 v18, 128, v16
    v_xor_b32 v19, 192, v16
    v_mov_b32 v20, 0x0
    v_bfe_u32 v14, v0, 0, 1
    s_mov_b32 s38, 0x8
    v_mad_u32_u24 v20, v14, s38, v20
    v_bfe_u32 v14, v0, 1, 1
    s_mov_b32 s38, 0x10
    v_mad_u32_u24 v20, v14, s38, v20
    v_bfe_u32 v14, v0, 2, 1
    s_mov_b32 s38, 0x100
    v_mad_u32_u24 v20, v14, s38, v20
    v_bfe_u32 v14, v0, 3, 1
    s_mov_b32 s38, 0x800
    v_mad_u32_u24 v20, v14, s38, v20
    v_bfe_u32 v14, v0, 4, 1
    s_mov_b32 s38, 0x400
    v_mad_u32_u24 v20, v14, s38, v20
    v_bfe_u32 v14, v0, 5, 1
    s_mov_b32 s38, 0x1000
    v_mad_u32_u24 v20, v14, s38, v20
    v_mov_b32 v28, 0x0
    v_bfe_u32 v14, v0, 2, 1
    s_mov_b32 s38, 0x20
    v_mad_u32_u24 v28, v14, s38, v28
    v_bfe_u32 v14, v0, 3, 1
    s_mov_b32 s38, 0x80
    v_mad_u32_u24 v28, v14, s38, v28
    v_bfe_u32 v14, v0, 4, 1
    s_mov_b32 s38, 0x40
    v_mad_u32_u24 v28, v14, s38, v28
    v_mov_b32 v29, 0x0
    v_bfe_u32 v14, v0, 6, 1
    s_mov_b32 s38, 0x40
    v_mad_u32_u24 v29, v14, s38, v29
    v_bfe_u32 v14, v0, 7, 1
    s_mov_b32 s38, 0x80
    v_mad_u32_u24 v29, v14, s38, v29
    v_xor_b32 v28, v28, v29
    v_add_u32 v28, v28, v20
    s_xor_b32 s36, s21, 0
    s_add_u32 s36, s36, 1
    s_lshl_b32 s36, s36, 15
    v_add_u32 v20, s36, v28
    v_xor_b32 v21, 32, v20
    s_xor_b32 s36, s21, 1
    s_add_u32 s36, s36, 1
    s_lshl_b32 s36, s36, 15
    v_add_u32 v22, s36, v28
    v_xor_b32 v23, 32, v22
    s_xor_b32 s36, s21, 2
    s_add_u32 s36, s36, 1
    s_lshl_b32 s36, s36, 15
    v_add_u32 v24, s36, v28
    v_xor_b32 v25, 32, v24
    s_xor_b32 s36, s21, 3
    s_add_u32 s36, s36, 1
    s_lshl_b32 s36, s36, 15
    v_add_u32 v26, s36, v28
    v_xor_b32 v27, 32, v26
    s_add_u32 s28, s21, 1
    s_lshl_b32 s28, s28, 15
    s_lshl_b32 s3, s20, 8
    s_add_u32 m0, s28, 0
    s_add_u32 s37, s3, 0x0
    buffer_load_dwordx4 v16, s[60:63], s37 offen nt lds
    s_add_u32 m0, s28, 1024
    s_add_u32 s37, s3, 0x8000
    buffer_load_dwordx4 v17, s[60:63], s37 offen nt lds
    s_add_u32 m0, s28, 2048
    s_add_u32 s37, s3, 0x10000
    buffer_load_dwordx4 v18, s[60:63], s37 offen nt lds
    s_add_u32 m0, s28, 3072
    s_add_u32 s37, s3, 0x18000
    buffer_load_dwordx4 v19, s[60:63], s37 offen nt lds
    s_add_u32 m0, s28, 4096
    s_add_u32 s37, s3, 0x20000
    buffer_load_dwordx4 v16, s[60:63], s37 offen nt lds
    s_add_u32 m0, s28, 5120
    s_add_u32 s37, s3, 0x28000
    buffer_load_dwordx4 v17, s[60:63], s37 offen nt lds
    s_add_u32 m0, s28, 6144
    s_add_u32 s37, s3, 0x30000
    buffer_load_dwordx4 v18, s[60:63], s37 offen nt lds
    s_add_u32 m0, s28, 7168
    s_add_u32 s37, s3, 0x38000
    buffer_load_dwordx4 v19, s[60:63], s37 offen nt lds
    s_mov_b32 s12, s46
    s_and_b32 s13, s47, 0xffff
    s_mov_b32 s14, 0x2000
    s_mov_b32 s15, 0x20000
    v_mov_b32 v104, 0x0
    v_bfe_u32 v14, v0, 0, 1
    s_mov_b32 s38, 0x8
    v_mad_u32_u24 v104, v14, s38, v104
    v_bfe_u32 v14, v0, 1, 1
    s_mov_b32 s38, 0x10
    v_mad_u32_u24 v104, v14, s38, v104
    v_bfe_u32 v14, v0, 2, 1
    s_mov_b32 s38, 0x10000
    v_mad_u32_u24 v104, v14, s38, v104
    v_bfe_u32 v14, v0, 3, 1
    s_mov_b32 s38, 0x10000
    v_mad_u32_u24 v104, v14, s38, v104
    v_bfe_u32 v14, v0, 4, 1
    s_mov_b32 s38, 0x400
    v_mad_u32_u24 v104, v14, s38, v104
    v_bfe_u32 v14, v0, 5, 1
    s_mov_b32 s38, 0x4
    v_mad_u32_u24 v104, v14, s38, v104
    v_bfe_u32 v14, v0, 6, 1
    s_mov_b32 s38, 0x40
    v_mad_u32_u24 v104, v14, s38, v104
    v_bfe_u32 v14, v0, 7, 1
    s_mov_b32 s38, 0x80
    v_mad_u32_u24 v104, v14, s38, v104
    v_mov_b32 v106, s20
    v_mov_b32 v105, 0x0
    v_bfe_u32 v14, v106, 0, 1
    s_mov_b32 s38, 0x20
    v_mad_u32_u24 v105, v14, s38, v105
    v_bfe_u32 v14, v106, 1, 1
    s_mov_b32 s38, 0x800
    v_mad_u32_u24 v105, v14, s38, v105
    v_bfe_u32 v14, v106, 2, 1
    s_mov_b32 s38, 0x1000
    v_mad_u32_u24 v105, v14, s38, v105
    v_bfe_u32 v14, v106, 3, 1
    s_mov_b32 s38, 0x100
    v_mad_u32_u24 v105, v14, s38, v105
    v_bfe_u32 v14, v106, 4, 1
    s_mov_b32 s38, 0x200
    v_mad_u32_u24 v105, v14, s38, v105
    v_add_u32 v104, v104, v105
    buffer_load_dword v12, v104, s[12:15], 0 offen
    v_mov_b32 v100, -1
    v_mov_b32 v101, -1
    v_mov_b32 v102, -1
    v_mov_b32 v103, -1
    buffer_store_dwordx4 v[100:103], v2, s[8:11], s6 offen sc1
    buffer_store_dwordx4 v[100:103], v2, s[8:11], s6 offen offset:1024 sc1
    s_lshl_b32 s36, s20, 14
    s_add_u32 s36, s36, 0x100000
    s_add_u32 s37, s36, 0x2000
    buffer_store_dwordx4 v[100:103], v2, s[8:11], s36 offen sc1
    buffer_store_dwordx4 v[100:103], v2, s[8:11], s36 offen offset:1024 sc1
    buffer_store_dwordx4 v[100:103], v2, s[8:11], s37 offen sc1
    buffer_store_dwordx4 v[100:103], v2, s[8:11], s37 offen offset:1024 sc1
    s_mul_i32 s36, s20, 0x104000
    s_add_u32 s36, s36, 0x1102000
    s_add_u32 s37, s36, 0x82000
    buffer_store_dwordx4 v[100:103], v2, s[8:11], s36 offen sc1
    buffer_store_dwordx4 v[100:103], v2, s[8:11], s36 offen offset:1024 sc1
    buffer_store_dwordx4 v[100:103], v2, s[8:11], s37 offen sc1
    buffer_store_dwordx4 v[100:103], v2, s[8:11], s37 offen offset:1024 sc1
    v_lshlrev_b32 v104, 2, v0
    s_lshl_b32 s36, s20, 10
    s_add_u32 s37, s36, 0x194000
    buffer_store_dword v100, v104, s[8:11], s37 offen sc1
    s_add_u32 s37, s36, 0x1b0000
    buffer_store_dword v100, v104, s[8:11], s37 offen sc1
    s_add_u32 s37, s36, 0x1b8000
    buffer_store_dword v100, v104, s[8:11], s37 offen sc1
    v_mov_b32 v105, 0x40000000
    v_cmp_lt_u32 vcc, 63, v0
    s_nop 1
    v_cndmask_b32 v104, v104, v105, vcc
    v_mov_b32 v105, 0
    s_lshl_b32 s36, s20, 8
    s_add_u32 s36, s36, 0x190000
    s_add_u32 s37, s36, 0x2000
    s_lshl_b32 s38, s20, 2
    s_add_u32 s38, s38, 0x80000
    s_lshl_b32 s7, s21, 7
    s_add_u32 s38, s38, s7
    buffer_store_dword v105, off, s[8:11], s38 sc1
    buffer_store_dword v105, v104, s[8:11], s36 offen sc1
    buffer_store_dword v105, v104, s[8:11], s37 offen sc1
    s_add_u32 m0, s28, 8192
    s_add_u32 s37, s3, 0x100000
    buffer_load_dwordx4 v16, s[60:63], s37 offen nt lds
    s_add_u32 m0, s28, 9216
    s_add_u32 s37, s3, 0x108000
    buffer_load_dwordx4 v17, s[60:63], s37 offen nt lds
    s_add_u32 m0, s28, 10240
    s_add_u32 s37, s3, 0x110000
    buffer_load_dwordx4 v18, s[60:63], s37 offen nt lds
    s_add_u32 m0, s28, 11264
    s_add_u32 s37, s3, 0x118000
    buffer_load_dwordx4 v19, s[60:63], s37 offen nt lds
    s_add_u32 m0, s28, 12288
    s_add_u32 s37, s3, 0x120000
    buffer_load_dwordx4 v16, s[60:63], s37 offen nt lds
    s_add_u32 m0, s28, 13312
    s_add_u32 s37, s3, 0x128000
    buffer_load_dwordx4 v17, s[60:63], s37 offen nt lds
    s_add_u32 m0, s28, 14336
    s_add_u32 s37, s3, 0x130000
    buffer_load_dwordx4 v18, s[60:63], s37 offen nt lds
    s_add_u32 m0, s28, 15360
    s_add_u32 s37, s3, 0x138000
    buffer_load_dwordx4 v19, s[60:63], s37 offen nt lds
    s_add_u32 m0, s28, 16384
    s_add_u32 s37, s3, 0x200000
    buffer_load_dwordx4 v16, s[60:63], s37 offen nt lds
    s_add_u32 m0, s28, 17408
    s_add_u32 s37, s3, 0x208000
    buffer_load_dwordx4 v17, s[60:63], s37 offen nt lds
    s_add_u32 m0, s28, 18432
    s_add_u32 s37, s3, 0x210000
    buffer_load_dwordx4 v18, s[60:63], s37 offen nt lds
    s_add_u32 m0, s28, 19456
    s_add_u32 s37, s3, 0x218000
    buffer_load_dwordx4 v19, s[60:63], s37 offen nt lds
    s_add_u32 m0, s28, 20480
    s_add_u32 s37, s3, 0x220000
    buffer_load_dwordx4 v16, s[60:63], s37 offen nt lds
    s_add_u32 m0, s28, 21504
    s_add_u32 s37, s3, 0x228000
    buffer_load_dwordx4 v17, s[60:63], s37 offen nt lds
    s_add_u32 m0, s28, 22528
    s_add_u32 s37, s3, 0x230000
    buffer_load_dwordx4 v18, s[60:63], s37 offen nt lds
    s_add_u32 m0, s28, 23552
    s_add_u32 s37, s3, 0x238000
    buffer_load_dwordx4 v19, s[60:63], s37 offen nt lds
    s_xor_b32 s36, s21, 0
    s_lshl_b32 s36, s36, 15
    s_add_u32 s36, s36, s29
    s_add_u32 s37, s36, 0x0
    buffer_load_dword v32, v11, s[92:95], s37 offen
    s_add_u32 s37, s36, 0x4000
    buffer_load_dword v33, v11, s[92:95], s37 offen
    s_add_u32 s37, s36, 0x400
    buffer_load_dword v34, v11, s[92:95], s37 offen
    s_add_u32 s37, s36, 0x4400
    buffer_load_dword v35, v11, s[92:95], s37 offen
    s_add_u32 s37, s36, 0x2000
    buffer_load_dword v36, v11, s[92:95], s37 offen
    s_add_u32 s37, s36, 0x6000
    buffer_load_dword v37, v11, s[92:95], s37 offen
    s_add_u32 s37, s36, 0x2400
    buffer_load_dword v38, v11, s[92:95], s37 offen
    s_add_u32 s37, s36, 0x6400
    buffer_load_dword v39, v11, s[92:95], s37 offen
    s_add_u32 s37, s36, 0x40
    buffer_load_dword v40, v11, s[92:95], s37 offen
    s_add_u32 s37, s36, 0x4040
    buffer_load_dword v41, v11, s[92:95], s37 offen
    s_add_u32 s37, s36, 0x440
    buffer_load_dword v42, v11, s[92:95], s37 offen
    s_add_u32 s37, s36, 0x4440
    buffer_load_dword v43, v11, s[92:95], s37 offen
    s_add_u32 s37, s36, 0x2040
    buffer_load_dword v44, v11, s[92:95], s37 offen
    s_add_u32 s37, s36, 0x6040
    buffer_load_dword v45, v11, s[92:95], s37 offen
    s_add_u32 s37, s36, 0x2440
    buffer_load_dword v46, v11, s[92:95], s37 offen
    s_add_u32 s37, s36, 0x6440
    buffer_load_dword v47, v11, s[92:95], s37 offen
    s_waitcnt vmcnt(49)
    s_barrier
    ds_read_b64_tr_b16 a[160:161], v20 offset:0
    ds_read_b64_tr_b16 a[162:163], v20 offset:512
    ds_read_b64_tr_b16 a[168:169], v21 offset:0
    ds_read_b64_tr_b16 a[170:171], v21 offset:512
    ds_read_b64_tr_b16 a[192:193], v22 offset:0
    ds_read_b64_tr_b16 a[194:195], v22 offset:512
    ds_read_b64_tr_b16 a[200:201], v23 offset:0
    ds_read_b64_tr_b16 a[202:203], v23 offset:512
    ds_read_b64_tr_b16 a[224:225], v24 offset:0
    ds_read_b64_tr_b16 a[226:227], v24 offset:512
    ds_read_b64_tr_b16 a[232:233], v25 offset:0
    ds_read_b64_tr_b16 a[234:235], v25 offset:512
    s_waitcnt lgkmcnt(4)
    ds_read_b64_tr_b16 v[128:129], v26 offset:0
    ds_read_b64_tr_b16 v[130:131], v26 offset:512
    ds_read_b64_tr_b16 v[136:137], v27 offset:0
    ds_read_b64_tr_b16 v[138:139], v27 offset:512
    s_waitcnt lgkmcnt(0)
    s_barrier
    s_add_u32 m0, s28, 0
    s_add_u32 s37, s3, 0x300000
    buffer_load_dwordx4 v16, s[60:63], s37 offen nt lds
    s_add_u32 m0, s28, 1024
    s_add_u32 s37, s3, 0x308000
    buffer_load_dwordx4 v17, s[60:63], s37 offen nt lds
    s_add_u32 m0, s28, 2048
    s_add_u32 s37, s3, 0x310000
    buffer_load_dwordx4 v18, s[60:63], s37 offen nt lds
    s_add_u32 m0, s28, 3072
    s_add_u32 s37, s3, 0x318000
    buffer_load_dwordx4 v19, s[60:63], s37 offen nt lds
    s_add_u32 m0, s28, 4096
    s_add_u32 s37, s3, 0x320000
    buffer_load_dwordx4 v16, s[60:63], s37 offen nt lds
    s_add_u32 m0, s28, 5120
    s_add_u32 s37, s3, 0x328000
    buffer_load_dwordx4 v17, s[60:63], s37 offen nt lds
    s_add_u32 m0, s28, 6144
    s_add_u32 s37, s3, 0x330000
    buffer_load_dwordx4 v18, s[60:63], s37 offen nt lds
    s_add_u32 m0, s28, 7168
    s_add_u32 s37, s3, 0x338000
    buffer_load_dwordx4 v19, s[60:63], s37 offen nt lds
    s_waitcnt vmcnt(40)
    s_mov_b32 s36, 0x1000000
    buffer_store_dword v12, v10, s[8:11], s36 offen sc1
    s_xor_b32 s36, s21, 0
    s_lshl_b32 s36, s36, 15
    s_add_u32 s36, s36, s29
    s_add_u32 s37, s36, 0x80
    buffer_load_dword v48, v11, s[92:95], s37 offen
    s_add_u32 s37, s36, 0x4080
    buffer_load_dword v49, v11, s[92:95], s37 offen
    s_add_u32 s37, s36, 0x480
    buffer_load_dword v50, v11, s[92:95], s37 offen
    s_add_u32 s37, s36, 0x4480
    buffer_load_dword v51, v11, s[92:95], s37 offen
    s_add_u32 s37, s36, 0x2080
    buffer_load_dword v52, v11, s[92:95], s37 offen
    s_add_u32 s37, s36, 0x6080
    buffer_load_dword v53, v11, s[92:95], s37 offen
    s_add_u32 s37, s36, 0x2480
    buffer_load_dword v54, v11, s[92:95], s37 offen
    s_add_u32 s37, s36, 0x6480
    buffer_load_dword v55, v11, s[92:95], s37 offen
    s_add_u32 s37, s36, 0xc0
    buffer_load_dword v56, v11, s[92:95], s37 offen
    s_add_u32 s37, s36, 0x40c0
    buffer_load_dword v57, v11, s[92:95], s37 offen
    s_add_u32 s37, s36, 0x4c0
    buffer_load_dword v58, v11, s[92:95], s37 offen
    s_add_u32 s37, s36, 0x44c0
    buffer_load_dword v59, v11, s[92:95], s37 offen
    s_add_u32 s37, s36, 0x20c0
    buffer_load_dword v60, v11, s[92:95], s37 offen
    s_add_u32 s37, s36, 0x60c0
    buffer_load_dword v61, v11, s[92:95], s37 offen
    s_add_u32 s37, s36, 0x24c0
    buffer_load_dword v62, v11, s[92:95], s37 offen
    s_add_u32 s37, s36, 0x64c0
    buffer_load_dword v63, v11, s[92:95], s37 offen
    s_waitcnt vmcnt(49)
    s_barrier
    ds_read_b64_tr_b16 a[164:165], v20 offset:8192
    ds_read_b64_tr_b16 a[166:167], v20 offset:8704
    ds_read_b64_tr_b16 a[172:173], v21 offset:8192
    ds_read_b64_tr_b16 a[174:175], v21 offset:8704
    ds_read_b64_tr_b16 a[196:197], v22 offset:8192
    ds_read_b64_tr_b16 a[198:199], v22 offset:8704
    ds_read_b64_tr_b16 a[204:205], v23 offset:8192
    ds_read_b64_tr_b16 a[206:207], v23 offset:8704
    ds_read_b64_tr_b16 a[228:229], v24 offset:8192
    ds_read_b64_tr_b16 a[230:231], v24 offset:8704
    ds_read_b64_tr_b16 a[236:237], v25 offset:8192
    ds_read_b64_tr_b16 a[238:239], v25 offset:8704
    s_waitcnt lgkmcnt(4)
    ds_read_b64_tr_b16 v[132:133], v26 offset:8192
    ds_read_b64_tr_b16 v[134:135], v26 offset:8704
    ds_read_b64_tr_b16 v[140:141], v27 offset:8192
    ds_read_b64_tr_b16 v[142:143], v27 offset:8704
    s_waitcnt lgkmcnt(0)
    s_barrier
    s_add_u32 m0, s28, 8192
    s_add_u32 s37, s3, 0x0
    buffer_load_dwordx4 v16, s[88:91], s37 offen nt lds
    s_add_u32 m0, s28, 9216
    s_add_u32 s37, s3, 0x8000
    buffer_load_dwordx4 v17, s[88:91], s37 offen nt lds
    s_add_u32 m0, s28, 10240
    s_add_u32 s37, s3, 0x10000
    buffer_load_dwordx4 v18, s[88:91], s37 offen nt lds
    s_add_u32 m0, s28, 11264
    s_add_u32 s37, s3, 0x18000
    buffer_load_dwordx4 v19, s[88:91], s37 offen nt lds
    s_add_u32 m0, s28, 12288
    s_add_u32 s37, s3, 0x20000
    buffer_load_dwordx4 v16, s[88:91], s37 offen nt lds
    s_add_u32 m0, s28, 13312
    s_add_u32 s37, s3, 0x28000
    buffer_load_dwordx4 v17, s[88:91], s37 offen nt lds
    s_add_u32 m0, s28, 14336
    s_add_u32 s37, s3, 0x30000
    buffer_load_dwordx4 v18, s[88:91], s37 offen nt lds
    s_add_u32 m0, s28, 15360
    s_add_u32 s37, s3, 0x38000
    buffer_load_dwordx4 v19, s[88:91], s37 offen nt lds
    s_waitcnt vmcnt(33)
    v_perm_b32 v120, v33, v32, s34
    v_perm_b32 v121, v33, v32, s35
    v_perm_b32 v122, v35, v34, s34
    v_perm_b32 v123, v35, v34, s35
    v_perm_b32 v124, v37, v36, s34
    v_perm_b32 v125, v37, v36, s35
    v_perm_b32 v126, v39, v38, s34
    v_perm_b32 v127, v39, v38, s35
    ds_write_b128 v4, v[120:123] offset:24576
    ds_write_b128 v4, v[124:127] offset:25600
    s_waitcnt lgkmcnt(0)
    v_perm_b32 v120, v41, v40, s34
    v_perm_b32 v121, v41, v40, s35
    v_perm_b32 v122, v43, v42, s34
    v_perm_b32 v123, v43, v42, s35
    v_perm_b32 v124, v45, v44, s34
    v_perm_b32 v125, v45, v44, s35
    v_perm_b32 v126, v47, v46, s34
    v_perm_b32 v127, v47, v46, s35
    ds_write_b128 v4, v[120:123] offset:26624
    ds_write_b128 v4, v[124:127] offset:27648
    s_waitcnt lgkmcnt(0)
    s_xor_b32 s36, s21, 1
    s_lshl_b32 s36, s36, 15
    s_add_u32 s36, s36, s29
    s_add_u32 s37, s36, 0x0
    buffer_load_dword v80, v11, s[92:95], s37 offen
    s_add_u32 s37, s36, 0x4000
    buffer_load_dword v81, v11, s[92:95], s37 offen
    s_add_u32 s37, s36, 0x400
    buffer_load_dword v82, v11, s[92:95], s37 offen
    s_add_u32 s37, s36, 0x4400
    buffer_load_dword v83, v11, s[92:95], s37 offen
    s_add_u32 s37, s36, 0x2000
    buffer_load_dword v84, v11, s[92:95], s37 offen
    s_add_u32 s37, s36, 0x6000
    buffer_load_dword v85, v11, s[92:95], s37 offen
    s_add_u32 s37, s36, 0x2400
    buffer_load_dword v86, v11, s[92:95], s37 offen
    s_add_u32 s37, s36, 0x6400
    buffer_load_dword v87, v11, s[92:95], s37 offen
    s_add_u32 s37, s36, 0x40
    buffer_load_dword v88, v11, s[92:95], s37 offen
    s_add_u32 s37, s36, 0x4040
    buffer_load_dword v89, v11, s[92:95], s37 offen
    s_add_u32 s37, s36, 0x440
    buffer_load_dword v90, v11, s[92:95], s37 offen
    s_add_u32 s37, s36, 0x4440
    buffer_load_dword v91, v11, s[92:95], s37 offen
    s_add_u32 s37, s36, 0x2040
    buffer_load_dword v92, v11, s[92:95], s37 offen
    s_add_u32 s37, s36, 0x6040
    buffer_load_dword v93, v11, s[92:95], s37 offen
    s_add_u32 s37, s36, 0x2440
    buffer_load_dword v94, v11, s[92:95], s37 offen
    s_add_u32 s37, s36, 0x6440
    buffer_load_dword v95, v11, s[92:95], s37 offen
    s_barrier
    ds_read_b64_tr_b16 a[176:177], v20 offset:16384
    ds_read_b64_tr_b16 a[178:179], v20 offset:16896
    ds_read_b64_tr_b16 a[184:185], v21 offset:16384
    ds_read_b64_tr_b16 a[186:187], v21 offset:16896
    ds_read_b64_tr_b16 a[208:209], v22 offset:16384
    ds_read_b64_tr_b16 a[210:211], v22 offset:16896
    ds_read_b64_tr_b16 a[216:217], v23 offset:16384
    ds_read_b64_tr_b16 a[218:219], v23 offset:16896
    ds_read_b64_tr_b16 a[240:241], v24 offset:16384
    ds_read_b64_tr_b16 a[242:243], v24 offset:16896
    ds_read_b64_tr_b16 a[248:249], v25 offset:16384
    ds_read_b64_tr_b16 a[250:251], v25 offset:16896
    s_waitcnt lgkmcnt(4)
    ds_read_b64_tr_b16 v[144:145], v26 offset:16384
    ds_read_b64_tr_b16 v[146:147], v26 offset:16896
    ds_read_b64_tr_b16 v[152:153], v27 offset:16384
    ds_read_b64_tr_b16 v[154:155], v27 offset:16896
    s_waitcnt lgkmcnt(0)
    s_barrier
    s_add_u32 m0, s28, 16384
    s_add_u32 s37, s3, 0x100000
    buffer_load_dwordx4 v16, s[88:91], s37 offen nt lds
    s_add_u32 m0, s28, 17408
    s_add_u32 s37, s3, 0x108000
    buffer_load_dwordx4 v17, s[88:91], s37 offen nt lds
    s_add_u32 m0, s28, 18432
    s_add_u32 s37, s3, 0x110000
    buffer_load_dwordx4 v18, s[88:91], s37 offen nt lds
    s_add_u32 m0, s28, 19456
    s_add_u32 s37, s3, 0x118000
    buffer_load_dwordx4 v19, s[88:91], s37 offen nt lds
    s_add_u32 m0, s28, 20480
    s_add_u32 s37, s3, 0x120000
    buffer_load_dwordx4 v16, s[88:91], s37 offen nt lds
    s_add_u32 m0, s28, 21504
    s_add_u32 s37, s3, 0x128000
    buffer_load_dwordx4 v17, s[88:91], s37 offen nt lds
    s_add_u32 m0, s28, 22528
    s_add_u32 s37, s3, 0x130000
    buffer_load_dwordx4 v18, s[88:91], s37 offen nt lds
    s_add_u32 m0, s28, 23552
    s_add_u32 s37, s3, 0x138000
    buffer_load_dwordx4 v19, s[88:91], s37 offen nt lds
    s_waitcnt vmcnt(48)
    s_barrier
    s_getreg_b32 s36, hwreg(HW_REG_XCC_ID)
    s_and_b32 s36, s36, 15
    s_or_b32 s36, s36, 0x100
    v_mov_b32 v30, s36
    s_lshl_b32 s37, s20, 2
    v_lshlrev_b32 v31, 20, v0
    buffer_store_dword v30, v31, s[16:19], s37 offen offset:128 sc1
    s_waitcnt vmcnt(33)
    v_perm_b32 v120, v49, v48, s34
    v_perm_b32 v121, v49, v48, s35
    v_perm_b32 v122, v51, v50, s34
    v_perm_b32 v123, v51, v50, s35
    v_perm_b32 v124, v53, v52, s34
    v_perm_b32 v125, v53, v52, s35
    v_perm_b32 v126, v55, v54, s34
    v_perm_b32 v127, v55, v54, s35
    ds_write_b128 v4, v[120:123] offset:28672
    ds_write_b128 v4, v[124:127] offset:29696
    s_waitcnt lgkmcnt(0)
    v_perm_b32 v120, v57, v56, s34
    v_perm_b32 v121, v57, v56, s35
    v_perm_b32 v122, v59, v58, s34
    v_perm_b32 v123, v59, v58, s35
    v_perm_b32 v124, v61, v60, s34
    v_perm_b32 v125, v61, v60, s35
    v_perm_b32 v126, v63, v62, s34
    v_perm_b32 v127, v63, v62, s35
    ds_write_b128 v4, v[120:123] offset:30720
    ds_write_b128 v4, v[124:127] offset:31744
    s_waitcnt lgkmcnt(0)
    s_xor_b32 s36, s21, 1
    s_lshl_b32 s36, s36, 15
    s_add_u32 s36, s36, s29
    s_add_u32 s37, s36, 0x80
    buffer_load_dword v32, v11, s[92:95], s37 offen
    s_add_u32 s37, s36, 0x4080
    buffer_load_dword v33, v11, s[92:95], s37 offen
    s_add_u32 s37, s36, 0x480
    buffer_load_dword v34, v11, s[92:95], s37 offen
    s_add_u32 s37, s36, 0x4480
    buffer_load_dword v35, v11, s[92:95], s37 offen
    s_add_u32 s37, s36, 0x2080
    buffer_load_dword v36, v11, s[92:95], s37 offen
    s_add_u32 s37, s36, 0x6080
    buffer_load_dword v37, v11, s[92:95], s37 offen
    s_add_u32 s37, s36, 0x2480
    buffer_load_dword v38, v11, s[92:95], s37 offen
    s_add_u32 s37, s36, 0x6480
    buffer_load_dword v39, v11, s[92:95], s37 offen
    s_add_u32 s37, s36, 0xc0
    buffer_load_dword v40, v11, s[92:95], s37 offen
    s_add_u32 s37, s36, 0x40c0
    buffer_load_dword v41, v11, s[92:95], s37 offen
    s_add_u32 s37, s36, 0x4c0
    buffer_load_dword v42, v11, s[92:95], s37 offen
    s_add_u32 s37, s36, 0x44c0
    buffer_load_dword v43, v11, s[92:95], s37 offen
    s_add_u32 s37, s36, 0x20c0
    buffer_load_dword v44, v11, s[92:95], s37 offen
    s_add_u32 s37, s36, 0x60c0
    buffer_load_dword v45, v11, s[92:95], s37 offen
    s_add_u32 s37, s36, 0x24c0
    buffer_load_dword v46, v11, s[92:95], s37 offen
    s_add_u32 s37, s36, 0x64c0
    buffer_load_dword v47, v11, s[92:95], s37 offen
    s_barrier
    ds_read_b64_tr_b16 a[180:181], v20 offset:0
    ds_read_b64_tr_b16 a[182:183], v20 offset:512
    ds_read_b64_tr_b16 a[188:189], v21 offset:0
    ds_read_b64_tr_b16 a[190:191], v21 offset:512
    ds_read_b64_tr_b16 a[212:213], v22 offset:0
    ds_read_b64_tr_b16 a[214:215], v22 offset:512
    ds_read_b64_tr_b16 a[220:221], v23 offset:0
    ds_read_b64_tr_b16 a[222:223], v23 offset:512
    ds_read_b64_tr_b16 a[244:245], v24 offset:0
    ds_read_b64_tr_b16 a[246:247], v24 offset:512
    ds_read_b64_tr_b16 a[252:253], v25 offset:0
    ds_read_b64_tr_b16 a[254:255], v25 offset:512
    s_waitcnt lgkmcnt(4)
    ds_read_b64_tr_b16 v[148:149], v26 offset:0
    ds_read_b64_tr_b16 v[150:151], v26 offset:512
    ds_read_b64_tr_b16 v[156:157], v27 offset:0
    ds_read_b64_tr_b16 v[158:159], v27 offset:512
    s_waitcnt lgkmcnt(0)
    s_barrier
    s_add_u32 m0, s28, 0
    s_add_u32 s37, s3, 0x200000
    buffer_load_dwordx4 v16, s[88:91], s37 offen nt lds
    s_add_u32 m0, s28, 1024
    s_add_u32 s37, s3, 0x208000
    buffer_load_dwordx4 v17, s[88:91], s37 offen nt lds
    s_add_u32 m0, s28, 2048
    s_add_u32 s37, s3, 0x210000
    buffer_load_dwordx4 v18, s[88:91], s37 offen nt lds
    s_add_u32 m0, s28, 3072
    s_add_u32 s37, s3, 0x218000
    buffer_load_dwordx4 v19, s[88:91], s37 offen nt lds
    s_add_u32 m0, s28, 4096
    s_add_u32 s37, s3, 0x220000
    buffer_load_dwordx4 v16, s[88:91], s37 offen nt lds
    s_add_u32 m0, s28, 5120
    s_add_u32 s37, s3, 0x228000
    buffer_load_dwordx4 v17, s[88:91], s37 offen nt lds
    s_add_u32 m0, s28, 6144
    s_add_u32 s37, s3, 0x230000
    buffer_load_dwordx4 v18, s[88:91], s37 offen nt lds
    s_add_u32 m0, s28, 7168
    s_add_u32 s37, s3, 0x238000
    buffer_load_dwordx4 v19, s[88:91], s37 offen nt lds
    s_waitcnt vmcnt(33)
    v_perm_b32 v160, v81, v80, s34
    v_perm_b32 v161, v81, v80, s35
    v_perm_b32 v162, v83, v82, s34
    v_perm_b32 v163, v83, v82, s35
    v_perm_b32 v164, v85, v84, s34
    v_perm_b32 v165, v85, v84, s35
    v_perm_b32 v166, v87, v86, s34
    v_perm_b32 v167, v87, v86, s35
    v_perm_b32 v168, v89, v88, s34
    v_perm_b32 v169, v89, v88, s35
    v_perm_b32 v170, v91, v90, s34
    v_perm_b32 v171, v91, v90, s35
    v_perm_b32 v172, v93, v92, s34
    v_perm_b32 v173, v93, v92, s35
    v_perm_b32 v174, v95, v94, s34
    v_perm_b32 v175, v95, v94, s35
    s_xor_b32 s36, s21, 2
    s_lshl_b32 s36, s36, 15
    s_add_u32 s36, s36, s29
    s_add_u32 s37, s36, 0x0
    buffer_load_dword v48, v11, s[92:95], s37 offen
    s_add_u32 s37, s36, 0x4000
    buffer_load_dword v49, v11, s[92:95], s37 offen
    s_add_u32 s37, s36, 0x400
    buffer_load_dword v50, v11, s[92:95], s37 offen
    s_add_u32 s37, s36, 0x4400
    buffer_load_dword v51, v11, s[92:95], s37 offen
    s_add_u32 s37, s36, 0x2000
    buffer_load_dword v52, v11, s[92:95], s37 offen
    s_add_u32 s37, s36, 0x6000
    buffer_load_dword v53, v11, s[92:95], s37 offen
    s_add_u32 s37, s36, 0x2400
    buffer_load_dword v54, v11, s[92:95], s37 offen
    s_add_u32 s37, s36, 0x6400
    buffer_load_dword v55, v11, s[92:95], s37 offen
    s_add_u32 s37, s36, 0x40
    buffer_load_dword v56, v11, s[92:95], s37 offen
    s_add_u32 s37, s36, 0x4040
    buffer_load_dword v57, v11, s[92:95], s37 offen
    s_add_u32 s37, s36, 0x440
    buffer_load_dword v58, v11, s[92:95], s37 offen
    s_add_u32 s37, s36, 0x4440
    buffer_load_dword v59, v11, s[92:95], s37 offen
    s_add_u32 s37, s36, 0x2040
    buffer_load_dword v60, v11, s[92:95], s37 offen
    s_add_u32 s37, s36, 0x6040
    buffer_load_dword v61, v11, s[92:95], s37 offen
    s_add_u32 s37, s36, 0x2440
    buffer_load_dword v62, v11, s[92:95], s37 offen
    s_add_u32 s37, s36, 0x6440
    buffer_load_dword v63, v11, s[92:95], s37 offen
    s_barrier
    ds_read_b64_tr_b16 v[64:65], v20 offset:8192
    ds_read_b64_tr_b16 v[66:67], v20 offset:8704
    ds_read_b64_tr_b16 v[72:73], v21 offset:8192
    ds_read_b64_tr_b16 v[74:75], v21 offset:8704
    ds_read_b64_tr_b16 v[96:97], v22 offset:8192
    ds_read_b64_tr_b16 v[98:99], v22 offset:8704
    ds_read_b64_tr_b16 v[104:105], v23 offset:8192
    ds_read_b64_tr_b16 v[106:107], v23 offset:8704
    ds_read_b64_tr_b16 a[112:113], v24 offset:8192
    ds_read_b64_tr_b16 a[114:115], v24 offset:8704
    ds_read_b64_tr_b16 a[120:121], v25 offset:8192
    ds_read_b64_tr_b16 a[122:123], v25 offset:8704
    s_waitcnt lgkmcnt(4)
    ds_read_b64_tr_b16 a[144:145], v26 offset:8192
    ds_read_b64_tr_b16 a[146:147], v26 offset:8704
    ds_read_b64_tr_b16 a[152:153], v27 offset:8192
    ds_read_b64_tr_b16 a[154:155], v27 offset:8704
    s_waitcnt lgkmcnt(0)
    s_barrier
    s_add_u32 m0, s28, 8192
    s_add_u32 s37, s3, 0x300000
    buffer_load_dwordx4 v16, s[88:91], s37 offen nt lds
    s_add_u32 m0, s28, 9216
    s_add_u32 s37, s3, 0x308000
    buffer_load_dwordx4 v17, s[88:91], s37 offen nt lds
    s_add_u32 m0, s28, 10240
    s_add_u32 s37, s3, 0x310000
    buffer_load_dwordx4 v18, s[88:91], s37 offen nt lds
    s_add_u32 m0, s28, 11264
    s_add_u32 s37, s3, 0x318000
    buffer_load_dwordx4 v19, s[88:91], s37 offen nt lds
    s_add_u32 m0, s28, 12288
    s_add_u32 s37, s3, 0x320000
    buffer_load_dwordx4 v16, s[88:91], s37 offen nt lds
    s_add_u32 m0, s28, 13312
    s_add_u32 s37, s3, 0x328000
    buffer_load_dwordx4 v17, s[88:91], s37 offen nt lds
    s_add_u32 m0, s28, 14336
    s_add_u32 s37, s3, 0x330000
    buffer_load_dwordx4 v18, s[88:91], s37 offen nt lds
    s_add_u32 m0, s28, 15360
    s_add_u32 s37, s3, 0x338000
    buffer_load_dwordx4 v19, s[88:91], s37 offen nt lds
    s_waitcnt vmcnt(32)
    v_perm_b32 v176, v33, v32, s34
    v_perm_b32 v177, v33, v32, s35
    v_perm_b32 v178, v35, v34, s34
    v_perm_b32 v179, v35, v34, s35
    v_perm_b32 v180, v37, v36, s34
    v_perm_b32 v181, v37, v36, s35
    v_perm_b32 v182, v39, v38, s34
    v_perm_b32 v183, v39, v38, s35
    v_perm_b32 v184, v41, v40, s34
    v_perm_b32 v185, v41, v40, s35
    v_perm_b32 v186, v43, v42, s34
    v_perm_b32 v187, v43, v42, s35
    v_perm_b32 v188, v45, v44, s34
    v_perm_b32 v189, v45, v44, s35
    v_perm_b32 v190, v47, v46, s34
    v_perm_b32 v191, v47, v46, s35
    s_xor_b32 s36, s21, 2
    s_lshl_b32 s36, s36, 15
    s_add_u32 s36, s36, s29
    s_add_u32 s37, s36, 0x80
    buffer_load_dword v80, v11, s[92:95], s37 offen
    s_add_u32 s37, s36, 0x4080
    buffer_load_dword v81, v11, s[92:95], s37 offen
    s_add_u32 s37, s36, 0x480
    buffer_load_dword v82, v11, s[92:95], s37 offen
    s_add_u32 s37, s36, 0x4480
    buffer_load_dword v83, v11, s[92:95], s37 offen
    s_add_u32 s37, s36, 0x2080
    buffer_load_dword v84, v11, s[92:95], s37 offen
    s_add_u32 s37, s36, 0x6080
    buffer_load_dword v85, v11, s[92:95], s37 offen
    s_add_u32 s37, s36, 0x2480
    buffer_load_dword v86, v11, s[92:95], s37 offen
    s_add_u32 s37, s36, 0x6480
    buffer_load_dword v87, v11, s[92:95], s37 offen
    s_add_u32 s37, s36, 0xc0
    buffer_load_dword v88, v11, s[92:95], s37 offen
    s_add_u32 s37, s36, 0x40c0
    buffer_load_dword v89, v11, s[92:95], s37 offen
    s_add_u32 s37, s36, 0x4c0
    buffer_load_dword v90, v11, s[92:95], s37 offen
    s_add_u32 s37, s36, 0x44c0
    buffer_load_dword v91, v11, s[92:95], s37 offen
    s_add_u32 s37, s36, 0x20c0
    buffer_load_dword v92, v11, s[92:95], s37 offen
    s_add_u32 s37, s36, 0x60c0
    buffer_load_dword v93, v11, s[92:95], s37 offen
    s_add_u32 s37, s36, 0x24c0
    buffer_load_dword v94, v11, s[92:95], s37 offen
    s_add_u32 s37, s36, 0x64c0
    buffer_load_dword v95, v11, s[92:95], s37 offen
    s_barrier
    ds_read_b64_tr_b16 v[68:69], v20 offset:16384
    ds_read_b64_tr_b16 v[70:71], v20 offset:16896
    ds_read_b64_tr_b16 v[76:77], v21 offset:16384
    ds_read_b64_tr_b16 v[78:79], v21 offset:16896
    ds_read_b64_tr_b16 v[100:101], v22 offset:16384
    ds_read_b64_tr_b16 v[102:103], v22 offset:16896
    ds_read_b64_tr_b16 v[108:109], v23 offset:16384
    ds_read_b64_tr_b16 v[110:111], v23 offset:16896
    ds_read_b64_tr_b16 a[116:117], v24 offset:16384
    ds_read_b64_tr_b16 a[118:119], v24 offset:16896
    ds_read_b64_tr_b16 a[124:125], v25 offset:16384
    ds_read_b64_tr_b16 a[126:127], v25 offset:16896
    s_waitcnt lgkmcnt(4)
    ds_read_b64_tr_b16 a[148:149], v26 offset:16384
    ds_read_b64_tr_b16 a[150:151], v26 offset:16896
    ds_read_b64_tr_b16 a[156:157], v27 offset:16384
    ds_read_b64_tr_b16 a[158:159], v27 offset:16896
    s_waitcnt lgkmcnt(0)
    s_barrier
    s_add_u32 m0, s28, 16384
    s_add_u32 s37, s3, 0x0
    buffer_load_dwordx4 v16, s[96:99], s37 offen nt lds
    s_add_u32 m0, s28, 17408
    s_add_u32 s37, s3, 0x8000
    buffer_load_dwordx4 v17, s[96:99], s37 offen nt lds
    s_add_u32 m0, s28, 18432
    s_add_u32 s37, s3, 0x10000
    buffer_load_dwordx4 v18, s[96:99], s37 offen nt lds
    s_add_u32 m0, s28, 19456
    s_add_u32 s37, s3, 0x18000
    buffer_load_dwordx4 v19, s[96:99], s37 offen nt lds
    s_add_u32 m0, s28, 20480
    s_add_u32 s37, s3, 0x20000
    buffer_load_dwordx4 v16, s[96:99], s37 offen nt lds
    s_add_u32 m0, s28, 21504
    s_add_u32 s37, s3, 0x28000
    buffer_load_dwordx4 v17, s[96:99], s37 offen nt lds
    s_add_u32 m0, s28, 22528
    s_add_u32 s37, s3, 0x30000
    buffer_load_dwordx4 v18, s[96:99], s37 offen nt lds
    s_add_u32 m0, s28, 23552
    s_add_u32 s37, s3, 0x38000
    buffer_load_dwordx4 v19, s[96:99], s37 offen nt lds
    s_waitcnt vmcnt(32)
    v_perm_b32 v192, v49, v48, s34
    v_perm_b32 v193, v49, v48, s35
    v_perm_b32 v194, v51, v50, s34
    v_perm_b32 v195, v51, v50, s35
    v_perm_b32 v196, v53, v52, s34
    v_perm_b32 v197, v53, v52, s35
    v_perm_b32 v198, v55, v54, s34
    v_perm_b32 v199, v55, v54, s35
    v_perm_b32 v200, v57, v56, s34
    v_perm_b32 v201, v57, v56, s35
    v_perm_b32 v202, v59, v58, s34
    v_perm_b32 v203, v59, v58, s35
    v_perm_b32 v204, v61, v60, s34
    v_perm_b32 v205, v61, v60, s35
    v_perm_b32 v206, v63, v62, s34
    v_perm_b32 v207, v63, v62, s35
    s_xor_b32 s36, s21, 3
    s_lshl_b32 s36, s36, 15
    s_add_u32 s36, s36, s29
    s_add_u32 s37, s36, 0x0
    buffer_load_dword v32, v11, s[92:95], s37 offen
    s_add_u32 s37, s36, 0x4000
    buffer_load_dword v33, v11, s[92:95], s37 offen
    s_add_u32 s37, s36, 0x400
    buffer_load_dword v34, v11, s[92:95], s37 offen
    s_add_u32 s37, s36, 0x4400
    buffer_load_dword v35, v11, s[92:95], s37 offen
    s_add_u32 s37, s36, 0x2000
    buffer_load_dword v36, v11, s[92:95], s37 offen
    s_add_u32 s37, s36, 0x6000
    buffer_load_dword v37, v11, s[92:95], s37 offen
    s_add_u32 s37, s36, 0x2400
    buffer_load_dword v38, v11, s[92:95], s37 offen
    s_add_u32 s37, s36, 0x6400
    buffer_load_dword v39, v11, s[92:95], s37 offen
    s_add_u32 s37, s36, 0x40
    buffer_load_dword v40, v11, s[92:95], s37 offen
    s_add_u32 s37, s36, 0x4040
    buffer_load_dword v41, v11, s[92:95], s37 offen
    s_add_u32 s37, s36, 0x440
    buffer_load_dword v42, v11, s[92:95], s37 offen
    s_add_u32 s37, s36, 0x4440
    buffer_load_dword v43, v11, s[92:95], s37 offen
    s_add_u32 s37, s36, 0x2040
    buffer_load_dword v44, v11, s[92:95], s37 offen
    s_add_u32 s37, s36, 0x6040
    buffer_load_dword v45, v11, s[92:95], s37 offen
    s_add_u32 s37, s36, 0x2440
    buffer_load_dword v46, v11, s[92:95], s37 offen
    s_add_u32 s37, s36, 0x6440
    buffer_load_dword v47, v11, s[92:95], s37 offen
    s_barrier
    ds_read_b64_tr_b16 a[80:81], v20 offset:0
    ds_read_b64_tr_b16 a[82:83], v20 offset:512
    ds_read_b64_tr_b16 a[88:89], v21 offset:0
    ds_read_b64_tr_b16 a[90:91], v21 offset:512
    ds_read_b64_tr_b16 a[96:97], v22 offset:0
    ds_read_b64_tr_b16 a[98:99], v22 offset:512
    ds_read_b64_tr_b16 a[104:105], v23 offset:0
    ds_read_b64_tr_b16 a[106:107], v23 offset:512
    ds_read_b64_tr_b16 a[128:129], v24 offset:0
    ds_read_b64_tr_b16 a[130:131], v24 offset:512
    ds_read_b64_tr_b16 a[136:137], v25 offset:0
    ds_read_b64_tr_b16 a[138:139], v25 offset:512
    s_waitcnt lgkmcnt(4)
    ds_read_b64_tr_b16 v[112:113], v26 offset:0
    ds_read_b64_tr_b16 v[114:115], v26 offset:512
    ds_read_b64_tr_b16 v[120:121], v27 offset:0
    ds_read_b64_tr_b16 v[122:123], v27 offset:512
    s_waitcnt lgkmcnt(0)
    s_barrier
    s_add_u32 m0, s28, 0
    s_add_u32 s37, s3, 0x100000
    buffer_load_dwordx4 v16, s[96:99], s37 offen nt lds
    s_add_u32 m0, s28, 1024
    s_add_u32 s37, s3, 0x108000
    buffer_load_dwordx4 v17, s[96:99], s37 offen nt lds
    s_add_u32 m0, s28, 2048
    s_add_u32 s37, s3, 0x110000
    buffer_load_dwordx4 v18, s[96:99], s37 offen nt lds
    s_add_u32 m0, s28, 3072
    s_add_u32 s37, s3, 0x118000
    buffer_load_dwordx4 v19, s[96:99], s37 offen nt lds
    s_add_u32 m0, s28, 4096
    s_add_u32 s37, s3, 0x120000
    buffer_load_dwordx4 v16, s[96:99], s37 offen nt lds
    s_add_u32 m0, s28, 5120
    s_add_u32 s37, s3, 0x128000
    buffer_load_dwordx4 v17, s[96:99], s37 offen nt lds
    s_add_u32 m0, s28, 6144
    s_add_u32 s37, s3, 0x130000
    buffer_load_dwordx4 v18, s[96:99], s37 offen nt lds
    s_add_u32 m0, s28, 7168
    s_add_u32 s37, s3, 0x138000
    buffer_load_dwordx4 v19, s[96:99], s37 offen nt lds
    s_waitcnt vmcnt(32)
    v_perm_b32 v208, v81, v80, s34
    v_perm_b32 v209, v81, v80, s35
    v_perm_b32 v210, v83, v82, s34
    v_perm_b32 v211, v83, v82, s35
    v_perm_b32 v212, v85, v84, s34
    v_perm_b32 v213, v85, v84, s35
    v_perm_b32 v214, v87, v86, s34
    v_perm_b32 v215, v87, v86, s35
    v_perm_b32 v216, v89, v88, s34
    v_perm_b32 v217, v89, v88, s35
    v_perm_b32 v218, v91, v90, s34
    v_perm_b32 v219, v91, v90, s35
    v_perm_b32 v220, v93, v92, s34
    v_perm_b32 v221, v93, v92, s35
    v_perm_b32 v222, v95, v94, s34
    v_perm_b32 v223, v95, v94, s35
    s_xor_b32 s36, s21, 3
    s_lshl_b32 s36, s36, 15
    s_add_u32 s36, s36, s29
    s_add_u32 s37, s36, 0x80
    buffer_load_dword v48, v11, s[92:95], s37 offen
    s_add_u32 s37, s36, 0x4080
    buffer_load_dword v49, v11, s[92:95], s37 offen
    s_add_u32 s37, s36, 0x480
    buffer_load_dword v50, v11, s[92:95], s37 offen
    s_add_u32 s37, s36, 0x4480
    buffer_load_dword v51, v11, s[92:95], s37 offen
    s_add_u32 s37, s36, 0x2080
    buffer_load_dword v52, v11, s[92:95], s37 offen
    s_add_u32 s37, s36, 0x6080
    buffer_load_dword v53, v11, s[92:95], s37 offen
    s_add_u32 s37, s36, 0x2480
    buffer_load_dword v54, v11, s[92:95], s37 offen
    s_add_u32 s37, s36, 0x6480
    buffer_load_dword v55, v11, s[92:95], s37 offen
    s_add_u32 s37, s36, 0xc0
    buffer_load_dword v56, v11, s[92:95], s37 offen
    s_add_u32 s37, s36, 0x40c0
    buffer_load_dword v57, v11, s[92:95], s37 offen
    s_add_u32 s37, s36, 0x4c0
    buffer_load_dword v58, v11, s[92:95], s37 offen
    s_add_u32 s37, s36, 0x44c0
    buffer_load_dword v59, v11, s[92:95], s37 offen
    s_add_u32 s37, s36, 0x20c0
    buffer_load_dword v60, v11, s[92:95], s37 offen
    s_add_u32 s37, s36, 0x60c0
    buffer_load_dword v61, v11, s[92:95], s37 offen
    s_add_u32 s37, s36, 0x24c0
    buffer_load_dword v62, v11, s[92:95], s37 offen
    s_add_u32 s37, s36, 0x64c0
    buffer_load_dword v63, v11, s[92:95], s37 offen
    s_barrier
    ds_read_b64_tr_b16 a[84:85], v20 offset:8192
    ds_read_b64_tr_b16 a[86:87], v20 offset:8704
    ds_read_b64_tr_b16 a[92:93], v21 offset:8192
    ds_read_b64_tr_b16 a[94:95], v21 offset:8704
    ds_read_b64_tr_b16 a[100:101], v22 offset:8192
    ds_read_b64_tr_b16 a[102:103], v22 offset:8704
    ds_read_b64_tr_b16 a[108:109], v23 offset:8192
    ds_read_b64_tr_b16 a[110:111], v23 offset:8704
    ds_read_b64_tr_b16 a[132:133], v24 offset:8192
    ds_read_b64_tr_b16 a[134:135], v24 offset:8704
    ds_read_b64_tr_b16 a[140:141], v25 offset:8192
    ds_read_b64_tr_b16 a[142:143], v25 offset:8704
    s_waitcnt lgkmcnt(4)
    ds_read_b64_tr_b16 v[116:117], v26 offset:8192
    ds_read_b64_tr_b16 v[118:119], v26 offset:8704
    ds_read_b64_tr_b16 v[124:125], v27 offset:8192
    ds_read_b64_tr_b16 v[126:127], v27 offset:8704
    s_waitcnt lgkmcnt(0)
    s_barrier
    s_add_u32 m0, s28, 8192
    s_add_u32 s37, s3, 0x200000
    buffer_load_dwordx4 v16, s[96:99], s37 offen nt lds
    s_add_u32 m0, s28, 9216
    s_add_u32 s37, s3, 0x208000
    buffer_load_dwordx4 v17, s[96:99], s37 offen nt lds
    s_add_u32 m0, s28, 10240
    s_add_u32 s37, s3, 0x210000
    buffer_load_dwordx4 v18, s[96:99], s37 offen nt lds
    s_add_u32 m0, s28, 11264
    s_add_u32 s37, s3, 0x218000
    buffer_load_dwordx4 v19, s[96:99], s37 offen nt lds
    s_add_u32 m0, s28, 12288
    s_add_u32 s37, s3, 0x220000
    buffer_load_dwordx4 v16, s[96:99], s37 offen nt lds
    s_add_u32 m0, s28, 13312
    s_add_u32 s37, s3, 0x228000
    buffer_load_dwordx4 v17, s[96:99], s37 offen nt lds
    s_add_u32 m0, s28, 14336
    s_add_u32 s37, s3, 0x230000
    buffer_load_dwordx4 v18, s[96:99], s37 offen nt lds
    s_add_u32 m0, s28, 15360
    s_add_u32 s37, s3, 0x238000
    buffer_load_dwordx4 v19, s[96:99], s37 offen nt lds
    s_waitcnt vmcnt(32)
    v_perm_b32 v224, v33, v32, s34
    v_perm_b32 v225, v33, v32, s35
    v_perm_b32 v226, v35, v34, s34
    v_perm_b32 v227, v35, v34, s35
    v_perm_b32 v228, v37, v36, s34
    v_perm_b32 v229, v37, v36, s35
    v_perm_b32 v230, v39, v38, s34
    v_perm_b32 v231, v39, v38, s35
    v_perm_b32 v232, v41, v40, s34
    v_perm_b32 v233, v41, v40, s35
    v_perm_b32 v234, v43, v42, s34
    v_perm_b32 v235, v43, v42, s35
    v_perm_b32 v236, v45, v44, s34
    v_perm_b32 v237, v45, v44, s35
    v_perm_b32 v238, v47, v46, s34
    v_perm_b32 v239, v47, v46, s35
    s_barrier
    ds_read_b64_tr_b16 v[32:33], v20 offset:16384
    ds_read_b64_tr_b16 v[34:35], v20 offset:16896
    ds_read_b64_tr_b16 v[40:41], v21 offset:16384
    ds_read_b64_tr_b16 v[42:43], v21 offset:16896
    ds_read_b64_tr_b16 a[0:1], v22 offset:16384
    ds_read_b64_tr_b16 a[2:3], v22 offset:16896
    ds_read_b64_tr_b16 a[8:9], v23 offset:16384
    ds_read_b64_tr_b16 a[10:11], v23 offset:16896
    ds_read_b64_tr_b16 a[32:33], v24 offset:16384
    ds_read_b64_tr_b16 a[34:35], v24 offset:16896
    ds_read_b64_tr_b16 a[40:41], v25 offset:16384
    ds_read_b64_tr_b16 a[42:43], v25 offset:16896
    s_waitcnt lgkmcnt(4)
    ds_read_b64_tr_b16 a[64:65], v26 offset:16384
    ds_read_b64_tr_b16 a[66:67], v26 offset:16896
    ds_read_b64_tr_b16 a[72:73], v27 offset:16384
    ds_read_b64_tr_b16 a[74:75], v27 offset:16896
    s_waitcnt lgkmcnt(0)
    s_barrier
    s_add_u32 m0, s28, 16384
    s_add_u32 s37, s3, 0x300000
    buffer_load_dwordx4 v16, s[96:99], s37 offen nt lds
    s_add_u32 m0, s28, 17408
    s_add_u32 s37, s3, 0x308000
    buffer_load_dwordx4 v17, s[96:99], s37 offen nt lds
    s_add_u32 m0, s28, 18432
    s_add_u32 s37, s3, 0x310000
    buffer_load_dwordx4 v18, s[96:99], s37 offen nt lds
    s_add_u32 m0, s28, 19456
    s_add_u32 s37, s3, 0x318000
    buffer_load_dwordx4 v19, s[96:99], s37 offen nt lds
    s_add_u32 m0, s28, 20480
    s_add_u32 s37, s3, 0x320000
    buffer_load_dwordx4 v16, s[96:99], s37 offen nt lds
    s_add_u32 m0, s28, 21504
    s_add_u32 s37, s3, 0x328000
    buffer_load_dwordx4 v17, s[96:99], s37 offen nt lds
    s_add_u32 m0, s28, 22528
    s_add_u32 s37, s3, 0x330000
    buffer_load_dwordx4 v18, s[96:99], s37 offen nt lds
    s_add_u32 m0, s28, 23552
    s_add_u32 s37, s3, 0x338000
    buffer_load_dwordx4 v19, s[96:99], s37 offen nt lds
    s_waitcnt vmcnt(16)
    v_perm_b32 v240, v49, v48, s34
    v_perm_b32 v241, v49, v48, s35
    v_perm_b32 v242, v51, v50, s34
    v_perm_b32 v243, v51, v50, s35
    v_perm_b32 v244, v53, v52, s34
    v_perm_b32 v245, v53, v52, s35
    v_perm_b32 v246, v55, v54, s34
    v_perm_b32 v247, v55, v54, s35
    v_perm_b32 v248, v57, v56, s34
    v_perm_b32 v249, v57, v56, s35
    v_perm_b32 v250, v59, v58, s34
    v_perm_b32 v251, v59, v58, s35
    v_perm_b32 v252, v61, v60, s34
    v_perm_b32 v253, v61, v60, s35
    v_perm_b32 v254, v63, v62, s34
    v_perm_b32 v255, v63, v62, s35
    s_barrier
    ds_read_b64_tr_b16 v[36:37], v20 offset:0
    ds_read_b64_tr_b16 v[38:39], v20 offset:512
    ds_read_b64_tr_b16 v[44:45], v21 offset:0
    ds_read_b64_tr_b16 v[46:47], v21 offset:512
    ds_read_b64_tr_b16 a[4:5], v22 offset:0
    ds_read_b64_tr_b16 a[6:7], v22 offset:512
    ds_read_b64_tr_b16 a[12:13], v23 offset:0
    ds_read_b64_tr_b16 a[14:15], v23 offset:512
    ds_read_b64_tr_b16 a[36:37], v24 offset:0
    ds_read_b64_tr_b16 a[38:39], v24 offset:512
    ds_read_b64_tr_b16 a[44:45], v25 offset:0
    ds_read_b64_tr_b16 a[46:47], v25 offset:512
    s_waitcnt lgkmcnt(4)
    ds_read_b64_tr_b16 a[68:69], v26 offset:0
    ds_read_b64_tr_b16 a[70:71], v26 offset:512
    ds_read_b64_tr_b16 a[76:77], v27 offset:0
    ds_read_b64_tr_b16 a[78:79], v27 offset:512
    s_waitcnt lgkmcnt(0)
    s_barrier
    s_waitcnt vmcnt(8)
    s_barrier
    ds_read_b64_tr_b16 v[48:49], v20 offset:8192
    ds_read_b64_tr_b16 v[50:51], v20 offset:8704
    ds_read_b64_tr_b16 v[56:57], v21 offset:8192
    ds_read_b64_tr_b16 v[58:59], v21 offset:8704
    ds_read_b64_tr_b16 a[16:17], v22 offset:8192
    ds_read_b64_tr_b16 a[18:19], v22 offset:8704
    ds_read_b64_tr_b16 a[24:25], v23 offset:8192
    ds_read_b64_tr_b16 a[26:27], v23 offset:8704
    ds_read_b64_tr_b16 a[48:49], v24 offset:8192
    ds_read_b64_tr_b16 a[50:51], v24 offset:8704
    ds_read_b64_tr_b16 a[56:57], v25 offset:8192
    ds_read_b64_tr_b16 a[58:59], v25 offset:8704
    s_waitcnt lgkmcnt(4)
    ds_read_b64_tr_b16 v[80:81], v26 offset:8192
    ds_read_b64_tr_b16 v[82:83], v26 offset:8704
    ds_read_b64_tr_b16 v[88:89], v27 offset:8192
    ds_read_b64_tr_b16 v[90:91], v27 offset:8704
    s_waitcnt lgkmcnt(0)
    s_barrier
    s_waitcnt vmcnt(0)
    s_barrier
    ds_read_b64_tr_b16 v[52:53], v20 offset:16384
    ds_read_b64_tr_b16 v[54:55], v20 offset:16896
    ds_read_b64_tr_b16 v[60:61], v21 offset:16384
    ds_read_b64_tr_b16 v[62:63], v21 offset:16896
    ds_read_b64_tr_b16 a[20:21], v22 offset:16384
    ds_read_b64_tr_b16 a[22:23], v22 offset:16896
    ds_read_b64_tr_b16 a[28:29], v23 offset:16384
    ds_read_b64_tr_b16 a[30:31], v23 offset:16896
    ds_read_b64_tr_b16 a[52:53], v24 offset:16384
    ds_read_b64_tr_b16 a[54:55], v24 offset:16896
    ds_read_b64_tr_b16 a[60:61], v25 offset:16384
    ds_read_b64_tr_b16 a[62:63], v25 offset:16896
    s_waitcnt lgkmcnt(4)
    ds_read_b64_tr_b16 v[84:85], v26 offset:16384
    ds_read_b64_tr_b16 v[86:87], v26 offset:16896
    ds_read_b64_tr_b16 v[92:93], v27 offset:16384
    ds_read_b64_tr_b16 v[94:95], v27 offset:16896
    s_waitcnt lgkmcnt(0)
    s_barrier
    ds_write_b128 v4, v[32:35] offset:0
    ds_write_b128 v4, v[36:39] offset:1024
    ds_write_b128 v4, v[40:43] offset:2048
    ds_write_b128 v4, v[44:47] offset:3072
    ds_write_b128 v4, v[48:51] offset:4096
    ds_write_b128 v4, v[52:55] offset:5120
    ds_write_b128 v4, v[56:59] offset:6144
    ds_write_b128 v4, v[60:63] offset:7168
    s_waitcnt lgkmcnt(0)
    ds_write_b128 v4, v[64:67] offset:8192
    ds_write_b128 v4, v[68:71] offset:9216
    ds_write_b128 v4, v[72:75] offset:10240
    ds_write_b128 v4, v[76:79] offset:11264
    ds_write_b128 v4, v[80:83] offset:12288
    ds_write_b128 v4, v[84:87] offset:13312
    ds_write_b128 v4, v[88:91] offset:14336
    ds_write_b128 v4, v[92:95] offset:15360
    s_waitcnt lgkmcnt(0)
    ds_write_b128 v4, v[96:99] offset:16384
    ds_write_b128 v4, v[100:103] offset:17408
    ds_write_b128 v4, v[104:107] offset:18432
    ds_write_b128 v4, v[108:111] offset:19456
    ds_write_b128 v4, v[112:115] offset:20480
    ds_write_b128 v4, v[116:119] offset:21504
    ds_write_b128 v4, v[120:123] offset:22528
    ds_write_b128 v4, v[124:127] offset:23552
    s_waitcnt lgkmcnt(0)
    s_waitcnt lgkmcnt(0)
    v_mov_b32 v24, 0x0
    v_bfe_u32 v14, v0, 0, 1
    s_mov_b32 s38, 0x80
    v_mad_u32_u24 v24, v14, s38, v24
    v_bfe_u32 v14, v0, 1, 1
    s_mov_b32 s38, 0x100
    v_mad_u32_u24 v24, v14, s38, v24
    v_bfe_u32 v14, v0, 2, 1
    s_mov_b32 s38, 0x200
    v_mad_u32_u24 v24, v14, s38, v24
    v_bfe_u32 v14, v0, 3, 1
    s_mov_b32 s38, 0x400
    v_mad_u32_u24 v24, v14, s38, v24
    v_bfe_u32 v14, v0, 4, 1
    s_mov_b32 s38, 0x800
    v_mad_u32_u24 v24, v14, s38, v24
    v_bfe_u32 v14, v0, 6, 1
    s_mov_b32 s38, 0x1000
    v_mad_u32_u24 v24, v14, s38, v24
    v_bfe_u32 v14, v0, 7, 1
    s_mov_b32 s38, 0x2000
    v_mad_u32_u24 v24, v14, s38, v24
    s_lshl_b32 s36, s20, 14
    v_add_u32 v24, s36, v24
    s_lshl_b32 s36, s20, 8
    s_lshr_b32 s37, s21, 1
    s_lshl_b32 s37, s37, 7
    s_add_u32 s36, s36, s37
    s_add_u32 s36, s36, 0x102000
    v_and_b32 v14, 63, v0
    v_mov_b32 v25, 0x40000000
    v_cmp_lt_u32 vcc, 32, v14
    s_nop 1
    v_cndmask_b32 v24, v24, v25, vcc
    v_mov_b32 v25, s36
    v_cmp_eq_u32 vcc, 32, v14
    s_nop 1
    v_cndmask_b32 v0, v24, v25, vcc
    v_lshrrev_b32 v25, 2, v3
    v_and_b32 v25, 127, v25
L_HS:
    buffer_load_dword v24, v25, s[16:19], 0 offen offset:128 sc1
    s_add_u32 s32, s32, 1
    s_cmp_gt_u32 s32, 200000
    s_cbranch_scc1 L_slow_start
    s_waitcnt vmcnt(0)
    v_cmp_eq_u32 vcc, 0, v24
    s_cbranch_vccnz L_HS
    v_readfirstlane_b32 s36, v24
    s_nop 1
    v_cmp_ne_u32 vcc, s36, v24
    s_cbranch_vccnz L_slow_start
    s_branch L_fast_start
L_fast_start:
    s_mov_b32 s22, 0
    s_mov_b32 s23, 0x1000000
    s_mov_b32 s27, 0
    s_mov_b32 s31, 0x80000
    s_mov_b32 s61, 0x40000000
    s_mov_b32 s91, 0
    ds_read_b128 v[104:107], v4 offset:0
    ds_read_b128 v[108:111], v4 offset:1024
    ds_read_b128 v[112:115], v4 offset:2048
    ds_read_b128 v[116:119], v4 offset:3072
    ds_read_b128 v[88:91], v4 offset:4096
    ds_read_b128 v[92:95], v4 offset:5120
    ds_read_b128 v[96:99], v4 offset:6144
    ds_read_b128 v[100:103], v4 offset:7168
    ds_read_b128 v[72:75], v4 offset:8192
    ds_read_b128 v[76:79], v4 offset:9216
    ds_read_b128 v[80:83], v4 offset:10240
    ds_read_b128 v[84:87], v4 offset:11264
    v_mov_b64 v[48:49], 0
    v_mov_b64 v[50:51], 0
    v_mov_b64 v[52:53], 0
    v_mov_b64 v[54:55], 0
    v_mov_b64 v[56:57], 0
    v_mov_b64 v[58:59], 0
    v_mov_b64 v[60:61], 0
    v_mov_b64 v[62:63], 0
    v_mov_b64 v[64:65], 0
    v_mov_b64 v[66:67], 0
    v_mov_b64 v[68:69], 0
    v_mov_b64 v[70:71], 0
    s_mov_b64 s[62:63], 0
    s_add_u32 s7, s23, 0x80000
    buffer_load_dwordx4 v[16:19], v2, s[8:11], s7 offen sc1
    buffer_load_dwordx4 v[20:23], v2, s[8:11], s7 offen offset:1024 sc1
L_fast_step:
    s_lshr_b64 s[36:37], s[62:63], s22
    s_andn2_b32 s36, 3, s36
    s_cbranch_scc1 L_fast_refresh
    s_add_u32 s24, s23, 0x82000
    s_add_u32 s29, s23, s25
    s_add_u32 s30, s23, s39
    s_xor_b32 s28, s27, 1
    s_add_u32 s90, s22, 1
    v_xor_b32 v28, 0x800, v2
    v_xor_b32 v44, 0x1800, v2
    s_nop 13
    buffer_load_dwordx4 v[16:19], v2, s[8:11], s7 offen sc1
    buffer_load_dwordx4 v[20:23], v2, s[8:11], s7 offen offset:1024 sc1
L_fast_waitm:
    s_waitcnt vmcnt(3) lgkmcnt(0)
L_fast_gotm:
    v_max3_u32 v14, v16, v17, v18
    v_max_u32 v14, v14, v19
    v_smfmac_f32_16x16x64_bf16 v[48:51], v[16:19], v[104:111], v1
    s_waitcnt vmcnt(2)
    v_max3_u32 v14, v14, v20, v21
    v_smfmac_f32_16x16x64_bf16 v[52:55], v[16:19], v[112:119], v1
    v_max3_u32 v14, v14, v22, v23
    v_cmp_eq_u32 vcc, -1, v14
    v_smfmac_f32_16x16x64_bf16 v[48:51], v[20:23], v[88:95], v1
    ds_write_b128 v2, v[16:19] offset:0
    s_cbranch_vccnz L_fast_retrym
L_fast_okm:
    v_smfmac_f32_16x16x64_bf16 v[52:55], v[20:23], v[96:103], v1
    ds_write_b128 v2, v[20:23] offset:1024
    v_smfmac_f32_16x16x64_bf16 v[56:59], v[16:19], v[72:79], v1
    buffer_load_dwordx4 v[104:107], v3, s[8:11], s29 offen offset:0 sc1
    v_smfmac_f32_16x16x64_bf16 v[60:63], v[16:19], v[80:87], v1
    buffer_load_dwordx4 v[108:111], v3, s[8:11], s29 offen offset:1024 sc1
    v_smfmac_f32_16x16x64_bf16 v[56:59], v[20:23], a[80:87], v1
    buffer_load_dwordx4 v[112:115], v3, s[8:11], s29 offen offset:2048 sc1
    v_smfmac_f32_16x16x64_bf16 v[60:63], v[20:23], a[88:95], v1
    s_waitcnt lgkmcnt(0)
    s_barrier
    ds_read_b128 v[24:27], v28 offset:0
    v_smfmac_f32_16x16x64_bf16 v[64:67], v[16:19], a[160:167], v1
    ds_read_b128 v[28:31], v28 offset:1024
    v_smfmac_f32_16x16x64_bf16 v[68:71], v[16:19], a[168:175], v1
    buffer_load_dwordx4 v[116:119], v3, s[8:11], s29 offen offset:3072 sc1
    v_smfmac_f32_16x16x64_bf16 v[64:67], v[20:23], a[176:183], v1
    ds_read_b128 v[32:35], v8 offset:0
    v_smfmac_f32_16x16x64_bf16 v[68:71], v[20:23], a[184:191], v1
    ds_read_b128 v[36:39], v8 offset:1024
    s_waitcnt lgkmcnt(3)
    v_smfmac_f32_16x16x64_bf16 v[48:51], v[24:27], a[0:7], v1
    buffer_load_dwordx4 v[120:123], v3, s[8:11], s30 offen offset:0 sc1
    v_smfmac_f32_16x16x64_bf16 v[52:55], v[24:27], a[8:15], v1
    ds_read_b128 v[40:43], v44 offset:0
    s_waitcnt lgkmcnt(3)
    v_smfmac_f32_16x16x64_bf16 v[48:51], v[28:31], a[16:23], v1
    buffer_load_dwordx4 v[124:127], v3, s[8:11], s30 offen offset:1024 sc1
    v_smfmac_f32_16x16x64_bf16 v[52:55], v[28:31], a[24:31], v1
    ds_read_b128 v[44:47], v44 offset:1024
    s_waitcnt lgkmcnt(2)
    v_smfmac_f32_16x16x64_bf16 v[48:51], v[32:35], a[32:39], v1
    v_smfmac_f32_16x16x64_bf16 v[52:55], v[32:35], a[40:47], v1
    ds_read_b128 v[88:91], v4 offset:12288
    v_smfmac_f32_16x16x64_bf16 v[48:51], v[36:39], a[48:55], v1
    ds_read_b128 v[92:95], v4 offset:13312
    s_waitcnt lgkmcnt(2)
    v_smfmac_f32_16x16x64_bf16 v[52:55], v[36:39], a[56:63], v1
    ds_read_b128 v[96:99], v4 offset:14336
    v_smfmac_f32_16x16x64_bf16 v[48:51], v[40:43], a[64:71], v1
    ds_read_b128 v[100:103], v4 offset:15360
    v_smfmac_f32_16x16x64_bf16 v[52:55], v[40:43], a[72:79], v1
    buffer_load_dword v15, v0, s[8:11], s24 offen sc1
    v_smfmac_f32_16x16x64_bf16 v[56:59], v[28:31], a[96:103], v1
    ds_read_b128 v[72:75], v4 offset:16384
    v_smfmac_f32_16x16x64_bf16 v[60:63], v[28:31], a[104:111], v1
    ds_read_b128 v[76:79], v4 offset:17408
    s_waitcnt lgkmcnt(2)
    v_smfmac_f32_16x16x64_bf16 v[48:51], v[44:47], v[88:95], v1
    ds_read_b128 v[80:83], v4 offset:18432
    v_smfmac_f32_16x16x64_bf16 v[52:55], v[44:47], v[96:103], v1
    ds_read_b128 v[84:87], v4 offset:19456
    v_smfmac_f32_16x16x64_bf16 v[56:59], v[32:35], a[112:119], v1
    ds_read_b128 v[88:91], v4 offset:20480
    v_smfmac_f32_16x16x64_bf16 v[60:63], v[32:35], a[120:127], v1
    ds_read_b128 v[92:95], v4 offset:21504
    v_smfmac_f32_16x16x64_bf16 v[56:59], v[36:39], a[128:135], v1
    ds_read_b128 v[96:99], v4 offset:22528
    v_add_f32 v48, v48, v50
    v_add_f32 v49, v49, v51
    v_smfmac_f32_16x16x64_bf16 v[60:63], v[36:39], a[136:143], v1
    ds_read_b128 v[100:103], v4 offset:23552
    v_add_f32 v52, v52, v54
    v_add_f32 v53, v53, v55
    v_smfmac_f32_16x16x64_bf16 v[56:59], v[40:43], a[144:151], v1
    s_waitcnt lgkmcnt(4)
    v_cvt_pk_bf16_f32 v50, v48, v52
    v_cvt_pk_bf16_f32 v51, v49, v53
    v_smfmac_f32_16x16x64_bf16 v[60:63], v[40:43], a[152:159], v1
    ds_write2_b32 v5, v50, v51 offset0:0 offset1:72
    v_smfmac_f32_16x16x64_bf16 v[56:59], v[24:27], v[72:79], v1
    buffer_store_dword v12, v10, s[8:11], s31 offen sc1
    v_smfmac_f32_16x16x64_bf16 v[60:63], v[24:27], v[80:87], v1
    s_waitcnt lgkmcnt(1)
    v_smfmac_f32_16x16x64_bf16 v[56:59], v[44:47], v[88:95], v1
    v_smfmac_f32_16x16x64_bf16 v[60:63], v[44:47], v[96:103], v1
    s_waitcnt lgkmcnt(0)
    s_barrier
    v_smfmac_f32_16x16x64_bf16 v[64:67], v[24:27], a[192:199], v1
    ds_read_b128 v[72:75], v6 offset:0
    v_smfmac_f32_16x16x64_bf16 v[68:71], v[24:27], a[200:207], v1
    ds_read_b128 v[76:79], v6 offset:64
    s_nop 0
    v_add_f32 v56, v56, v58
    v_smfmac_f32_16x16x64_bf16 v[64:67], v[28:31], a[208:215], v1
    ds_read_b128 v[80:83], v6 offset:128
    v_add_f32 v57, v57, v59
    v_smfmac_f32_16x16x64_bf16 v[68:71], v[28:31], a[216:223], v1
    ds_read_b128 v[84:87], v6 offset:192
    v_add_f32 v60, v60, v62
    v_add_f32 v61, v61, v63
    s_waitcnt vmcnt(2) lgkmcnt(3)
    v_mfma_f32_16x16x32_bf16 v[48:51], v[104:107], v[72:75], 0
    s_waitcnt lgkmcnt(2)
    v_cvt_pk_bf16_f32 v58, v56, v60
    v_cvt_pk_bf16_f32 v59, v57, v61
    v_mfma_f32_16x16x32_bf16 v[48:51], v[108:111], v[76:79], v[48:51]
    ds_write2_b32 v7, v58, v59 offset0:0 offset1:72
    s_waitcnt lgkmcnt(2)
    v_mfma_f32_16x16x32_bf16 v[48:51], v[112:115], v[80:83], v[48:51]
    s_waitcnt lgkmcnt(1)
    v_mov_b64 v[104:105], s[4:5]
    v_mov_b64 v[106:107], s[4:5]
    v_mfma_f32_16x16x32_bf16 v[48:51], v[116:119], v[84:87], v[48:51]
    v_mov_b64 v[16:17], 0
    v_mov_b64 v[18:19], 0
    v_smfmac_f32_16x16x64_bf16 v[64:67], v[32:35], a[224:231], v1
    v_mov_b32 v113, 0
    v_smfmac_f32_16x16x64_bf16 v[68:71], v[32:35], a[232:239], v1
    s_waitcnt lgkmcnt(0)
    s_barrier
    v_mov_b32 v115, 0
    v_smfmac_f32_16x16x64_bf16 v[64:67], v[36:39], a[240:247], v1
    ds_read_b128 v[88:91], v6 offset:2304
    v_exp_f32 v48, v48
    v_smfmac_f32_16x16x64_bf16 v[68:71], v[36:39], a[248:255], v1
    ds_read_b128 v[92:95], v6 offset:2368
    v_exp_f32 v49, v49
    v_smfmac_f32_16x16x64_bf16 v[64:67], v[40:43], v[128:135], v1
    ds_read_b128 v[96:99], v6 offset:2432
    v_exp_f32 v50, v50
    v_smfmac_f32_16x16x64_bf16 v[68:71], v[40:43], v[136:143], v1
    ds_read_b128 v[100:103], v6 offset:2496
    v_exp_f32 v51, v51
    s_waitcnt lgkmcnt(3)
    v_mfma_f32_16x16x32_bf16 v[52:55], v[88:91], v[72:75], 0
    s_waitcnt lgkmcnt(2)
    v_cvt_pk_bf16_f32 v108, v48, v49
    v_cvt_pk_bf16_f32 v109, v50, v51
    v_mfma_f32_16x16x32_bf16 v[52:55], v[92:95], v[76:79], v[52:55]
    ds_write_b64 v2, v[108:109] offset:8192
    s_waitcnt lgkmcnt(2)
    v_mfma_f32_16x16x32_bf16 v[52:55], v[96:99], v[80:83], v[52:55]
    s_waitcnt lgkmcnt(1)
    v_mov_b32 v117, 0
    v_mov_b64 v[20:21], 0
    v_mfma_f32_16x16x32_bf16 v[52:55], v[100:103], v[84:87], v[52:55]
    v_mov_b64 v[22:23], 0
    v_mov_b64 v[24:25], 0
    v_smfmac_f32_16x16x64_bf16 v[64:67], v[44:47], v[144:151], v1
    ds_read_b128 v[88:91], v4 offset:24576
    v_smfmac_f32_16x16x64_bf16 v[68:71], v[44:47], v[152:159], v1
    s_waitcnt lgkmcnt(1)
    s_barrier
    ds_read_b64 v[110:111], v8 offset:8192
    ds_read_b128 v[92:95], v4 offset:25600
    v_mul_f32 v52, s33, v52
    v_mul_f32 v53, s33, v53
    v_exp_f32 v52, v52
    v_exp_f32 v53, v53
    s_nop 0
    v_cvt_pk_bf16_f32 v112, v52, v53
    v_add_f32 v64, v64, v66
    v_add_f32 v65, v65, v67
    s_waitcnt lgkmcnt(1)
    v_mfma_f32_16x16x32_bf16 v[48:51], v[104:107], v[108:111], 0
    v_cvt_pk_bf16_f32 v114, v64, v65
    v_add_f32 v68, v68, v70
    v_mfma_f32_16x16x32_bf16 v[56:59], v[120:123], v[108:111], 0
    v_add_f32 v69, v69, v71
    v_cvt_pk_bf16_f32 v116, v68, v69
    v_mfma_f32_16x16x32_bf16 v[60:63], v[124:127], v[108:111], 0
    ds_read_b128 v[96:99], v4 offset:26624
    v_mov_b64 v[26:27], 0
    v_mfma_f32_16x16x16_bf16 v[48:51], v[104:105], v[112:113], v[48:51]
    ds_read_b128 v[100:103], v4 offset:27648
    v_mov_b64 v[28:29], 0
    v_mfma_f32_16x16x16_bf16 v[56:59], v[114:115], v[112:113], v[56:59]
    v_mov_b64 v[30:31], 0
    v_mfma_f32_16x16x16_bf16 v[60:63], v[116:117], v[112:113], v[60:63]
    s_nop 2
    v_rcp_f32 v118, v48
    s_nop 0
    v_max_f32 v14, v118, v48
    v_cmp_nge_f32 vcc, s40, v14
    v_pk_mul_f32 v[56:57], v[56:57], v[118:119] op_sel_hi:[1,0]
    v_pk_mul_f32 v[58:59], v[58:59], v[118:119] op_sel_hi:[1,0]
    v_pk_mul_f32 v[60:61], v[60:61], v[118:119] op_sel_hi:[1,0]
    v_pk_mul_f32 v[62:63], v[62:63], v[118:119] op_sel_hi:[1,0]
    v_cvt_pk_bf16_f32 v52, v56, v60
    v_cvt_pk_bf16_f32 v53, v57, v61
    v_cvt_pk_bf16_f32 v54, v58, v62
    v_cvt_pk_bf16_f32 v55, v59, v63
L_fast_rejoin:
    ds_write_b128 v2, v[52:55] offset:9216
    s_waitcnt lgkmcnt(1)
    v_smfmac_f32_16x16x64_bf16 v[16:19], v[52:55], v[88:95], v1
    ds_read_b128 v[72:75], v4 offset:28672
    v_xor_b32 v32, 0x800, v2
    v_smfmac_f32_16x16x64_bf16 v[20:23], v[52:55], v[96:103], v1
    ds_read_b128 v[76:79], v4 offset:29696
    v_xor_b32 v40, 0x1800, v2
    s_waitcnt lgkmcnt(2)
    s_barrier
    ds_read_b128 v[32:35], v32 offset:9216
    ds_read_b128 v[36:39], v8 offset:9216
    ds_read_b128 v[40:43], v40 offset:9216
    ds_read_b128 v[80:83], v4 offset:30720
    ds_read_b128 v[84:87], v4 offset:31744
    s_waitcnt lgkmcnt(4)
    v_smfmac_f32_16x16x64_bf16 v[16:19], v[32:35], v[160:167], v1
    s_waitcnt lgkmcnt(3)
    v_smfmac_f32_16x16x64_bf16 v[16:19], v[36:39], v[192:199], v1
    s_waitcnt lgkmcnt(2)
    v_smfmac_f32_16x16x64_bf16 v[16:19], v[40:43], v[224:231], v1
    s_cmp_lg_u64 vcc, 0
    s_cselect_b32 s60, s28, s27
    v_smfmac_f32_16x16x64_bf16 v[20:23], v[32:35], v[168:175], v1
    ds_read_b128 v[64:67], v3 offset:23040
    s_waitcnt lgkmcnt(1)
    v_smfmac_f32_16x16x64_bf16 v[20:23], v[36:39], v[200:207], v1
    s_nop 1
    v_smfmac_f32_16x16x64_bf16 v[20:23], v[40:43], v[232:239], v1
    v_cvt_pk_bf16_f32 v56, v16, v18
    v_smfmac_f32_16x16x64_bf16 v[24:27], v[52:55], v[72:79], v1
    v_cvt_pk_bf16_f32 v57, v17, v19
    v_and_or_b32 v56, v56, -2, s60
    v_smfmac_f32_16x16x64_bf16 v[24:27], v[32:35], v[176:183], v1
    buffer_store_dwordx2 v[56:57], v9, s[8:11], 0 offen offset:0
    v_smfmac_f32_16x16x64_bf16 v[24:27], v[36:39], v[208:215], v1
    s_nop 0
    v_cvt_pk_bf16_f32 v58, v20, v22
    v_smfmac_f32_16x16x64_bf16 v[24:27], v[40:43], v[240:247], v1
    v_cvt_pk_bf16_f32 v59, v21, v23
    v_and_or_b32 v58, v58, -2, s60
    v_smfmac_f32_16x16x64_bf16 v[28:31], v[52:55], v[80:87], v1
    buffer_store_dwordx2 v[58:59], v9, s[8:11], 0 offen offset:2048
    v_smfmac_f32_16x16x64_bf16 v[28:31], v[32:35], v[184:191], v1
    s_nop 1
    v_smfmac_f32_16x16x64_bf16 v[28:31], v[36:39], v[216:223], v1
    v_cvt_pk_bf16_f32 v60, v24, v26
    v_smfmac_f32_16x16x64_bf16 v[28:31], v[40:43], v[248:255], v1
    v_cvt_pk_bf16_f32 v61, v25, v27
    v_and_or_b32 v60, v60, -2, s60
    buffer_store_dwordx2 v[60:61], v9, s[8:11], s26 offen offset:0
    s_nop 4
    v_cvt_pk_bf16_f32 v62, v28, v30
    v_cvt_pk_bf16_f32 v63, v29, v31
    v_and_or_b32 v62, v62, -2, s60
    buffer_store_dwordx2 v[62:63], v9, s[8:11], s26 offen offset:2048
L_fast_stored:
    s_cmp_lg_u32 s60, s27
    s_cbranch_scc1 L_fast_safe
    ds_read_b128 v[104:107], v4 offset:0
    ds_read_b128 v[108:111], v4 offset:1024
    ds_read_b128 v[112:115], v4 offset:2048
    ds_read_b128 v[116:119], v4 offset:3072
    ds_read_b128 v[88:91], v4 offset:4096
    ds_read_b128 v[92:95], v4 offset:5120
    ds_read_b128 v[96:99], v4 offset:6144
    ds_read_b128 v[100:103], v4 offset:7168
    ds_read_b128 v[72:75], v4 offset:8192
    ds_read_b128 v[76:79], v4 offset:9216
    ds_read_b128 v[80:83], v4 offset:10240
    ds_read_b128 v[84:87], v4 offset:11264
    s_cmp_lt_u32 s21, 1
    s_cbranch_scc1 L_fast_pollp
    s_nop 7
    s_cmp_lt_u32 s21, 2
    s_cbranch_scc1 L_fast_pollp
    s_nop 7
    s_cmp_lt_u32 s21, 3
    s_cbranch_scc1 L_fast_pollp
    s_nop 7
L_fast_pollp:
    buffer_load_dwordx4 v[120:123], v2, s[8:11], s6 offen sc1
    buffer_load_dwordx4 v[124:127], v2, s[8:11], s6 offen offset:1024 sc1
    v_mov_b64 v[48:49], 0
    v_mov_b64 v[50:51], 0
    v_mov_b64 v[52:53], 0
    v_mov_b64 v[54:55], 0
    v_mov_b64 v[56:57], 0
    v_mov_b64 v[58:59], 0
    v_mov_b64 v[60:61], 0
    v_mov_b64 v[62:63], 0
    s_nop 15
    s_nop 11
    buffer_load_dwordx4 v[32:35], v2, s[8:11], s6 offen sc1
    buffer_load_dwordx4 v[36:39], v2, s[8:11], s6 offen offset:1024 sc1
    s_add_u32 s7, s24, 0x80000
    s_waitcnt vmcnt(3) lgkmcnt(0)
    v_mfma_f32_16x16x32_bf16 v[68:71], v[64:67], v[120:123], 0
    v_bitop3_b32 v14, v120, v122, s27 bitop3:0x7e
    s_waitcnt vmcnt(2)
    v_mfma_f32_16x16x32_bf16 v[68:71], v[64:67], v[124:127], v[68:71]
    v_bitop3_b32 v11, v124, v126, s27 bitop3:0x7e
    v_bitop3_b32 v14, v14, v11, 1 bitop3:0xa8
    v_cmp_ne_u32 vcc, 0, v14
    s_nop 2
    s_cmp_eq_u64 vcc, 0
    s_cselect_b32 s36, s24, s61
    v_add_f32_dpp v68, v68, v68 row_ror:8 row_mask:0xf bank_mask:0xf
    v_add_f32_dpp v69, v69, v69 row_ror:8 row_mask:0xf bank_mask:0xf
    s_nop 0
    v_add_f32_dpp v68, v68, v68 row_ror:4 row_mask:0xf bank_mask:0xf
    v_add_f32_dpp v69, v69, v69 row_ror:4 row_mask:0xf bank_mask:0xf
    v_cvt_pk_bf16_f32 v12, v68, v69
    buffer_store_dword v12, v10, s[8:11], s36 offen
    s_cbranch_scc0 L_fast_retryp
L_fast_gotp:
    s_mov_b32 s23, s24
    s_add_u32 s31, s31, 0x2000
    s_mov_b32 s22, s90
    s_mov_b32 s27, s28
    v_mov_b64 v[64:65], 0
    v_mov_b64 v[66:67], 0
    v_mov_b64 v[68:69], 0
    v_mov_b64 v[70:71], 0
    s_nop 15
    s_nop 15
    s_nop 3
    buffer_load_dwordx4 v[16:19], v2, s[8:11], s7 offen sc1
    buffer_load_dwordx4 v[20:23], v2, s[8:11], s7 offen offset:1024 sc1
    s_cmp_lt_u32 s22, 63
    s_cbranch_scc1 L_fast_step
    buffer_store_dword v12, v10, s[8:11], s31 offen sc1
    s_branch L_fast_done
L_fast_retrym:
    s_add_u32 s32, s32, 1
    s_cmp_gt_u32 s32, 200000
    s_cbranch_scc1 L_fast_okm
    buffer_load_dwordx4 v[16:19], v2, s[8:11], s7 offen sc1
    buffer_load_dwordx4 v[20:23], v2, s[8:11], s7 offen offset:1024 sc1
    s_nop 1
    v_mov_b64 v[48:49], 0
    v_mov_b64 v[50:51], 0
    v_mov_b64 v[52:53], 0
    v_mov_b64 v[54:55], 0
    s_branch L_fast_waitm
L_fast_retryp:
    s_add_u32 s32, s32, 1
    buffer_load_dwordx4 v[120:123], v2, s[8:11], s6 offen sc1
    buffer_load_dwordx4 v[124:127], v2, s[8:11], s6 offen offset:1024 sc1
    s_waitcnt vmcnt(4) lgkmcnt(0)
    v_mfma_f32_16x16x32_bf16 v[68:71], v[64:67], v[32:35], 0
    v_bitop3_b32 v14, v32, v34, s27 bitop3:0x7e
    s_waitcnt vmcnt(3)
    v_mfma_f32_16x16x32_bf16 v[68:71], v[64:67], v[36:39], v[68:71]
    v_bitop3_b32 v11, v36, v38, s27 bitop3:0x7e
    v_bitop3_b32 v14, v14, v11, 1 bitop3:0xa8
    v_cmp_ne_u32 vcc, 0, v14
    s_nop 2
    s_cmp_eq_u64 vcc, 0
    s_cselect_b32 s36, s24, s61
    v_add_f32_dpp v68, v68, v68 row_ror:8 row_mask:0xf bank_mask:0xf
    v_add_f32_dpp v69, v69, v69 row_ror:8 row_mask:0xf bank_mask:0xf
    s_nop 0
    v_add_f32_dpp v68, v68, v68 row_ror:4 row_mask:0xf bank_mask:0xf
    v_add_f32_dpp v69, v69, v69 row_ror:4 row_mask:0xf bank_mask:0xf
    v_cvt_pk_bf16_f32 v12, v68, v69
    buffer_store_dword v12, v10, s[8:11], s36 offen
    s_cbranch_scc1 L_fast_gotp
    buffer_load_dwordx4 v[32:35], v2, s[8:11], s6 offen sc1
    buffer_load_dwordx4 v[36:39], v2, s[8:11], s6 offen offset:1024 sc1
    s_waitcnt vmcnt(4) lgkmcnt(0)
    v_mfma_f32_16x16x32_bf16 v[68:71], v[64:67], v[120:123], 0
    v_bitop3_b32 v14, v120, v122, s27 bitop3:0x7e
    s_waitcnt vmcnt(3)
    v_mfma_f32_16x16x32_bf16 v[68:71], v[64:67], v[124:127], v[68:71]
    v_bitop3_b32 v11, v124, v126, s27 bitop3:0x7e
    v_bitop3_b32 v14, v14, v11, 1 bitop3:0xa8
    v_cmp_ne_u32 vcc, 0, v14
    s_nop 2
    s_cmp_eq_u64 vcc, 0
    s_cselect_b32 s36, s24, s61
    v_add_f32_dpp v68, v68, v68 row_ror:8 row_mask:0xf bank_mask:0xf
    v_add_f32_dpp v69, v69, v69 row_ror:8 row_mask:0xf bank_mask:0xf
    s_nop 0
    v_add_f32_dpp v68, v68, v68 row_ror:4 row_mask:0xf bank_mask:0xf
    v_add_f32_dpp v69, v69, v69 row_ror:4 row_mask:0xf bank_mask:0xf
    v_cvt_pk_bf16_f32 v12, v68, v69
    buffer_store_dword v12, v10, s[8:11], s36 offen
    s_cbranch_scc1 L_fast_gotp
    s_cmp_le_u32 s32, 200000
    s_cbranch_scc1 L_fast_retryp
    s_mov_b32 s36, s24
    buffer_store_dword v12, v10, s[8:11], s36 offen
    s_branch L_fast_gotp
L_fast_refresh:
    v_lshrrev_b32 v14, 2, v3
    s_lshl_b32 s36, s20, 8
    s_add_u32 s36, s36, 0x190000
    buffer_load_dword v14, v14, s[8:11], s36 offen sc1
    s_add_u32 s32, s32, 1
    s_waitcnt vmcnt(0)
    v_cmp_ne_u32 s[62:63], 0, v14
    s_nop 3
    s_cmp_le_u32 s32, 200000
    s_cbranch_scc1 L_fast_step
    s_mov_b64 s[62:63], -1
    s_branch L_fast_step
L_fast_safe:
    s_nop 11
    s_waitcnt vmcnt(0) lgkmcnt(0)
    s_barrier
    ds_read_b128 v[72:75], v6 offset:0
    ds_read_b128 v[88:91], v6 offset:2304
    ds_read_b128 v[76:79], v6 offset:64
    ds_read_b128 v[92:95], v6 offset:2368
    ds_read_b128 v[80:83], v6 offset:128
    ds_read_b128 v[96:99], v6 offset:2432
    ds_read_b128 v[84:87], v6 offset:192
    ds_read_b128 v[100:103], v6 offset:2496
    s_xor_b32 s36, s25, 0x1000
    s_add_u32 s36, s36, s23
    buffer_load_dwordx4 v[16:19], v3, s[8:11], s29 offen offset:0 sc1
    buffer_load_dwordx4 v[32:35], v3, s[8:11], s36 offen offset:0 sc1
    buffer_load_dwordx4 v[20:23], v3, s[8:11], s29 offen offset:1024 sc1
    buffer_load_dwordx4 v[36:39], v3, s[8:11], s36 offen offset:1024 sc1
    buffer_load_dwordx4 v[24:27], v3, s[8:11], s29 offen offset:2048 sc1
    buffer_load_dwordx4 v[40:43], v3, s[8:11], s36 offen offset:2048 sc1
    buffer_load_dwordx4 v[28:31], v3, s[8:11], s29 offen offset:3072 sc1
    buffer_load_dwordx4 v[44:47], v3, s[8:11], s36 offen offset:3072 sc1
    s_waitcnt vmcnt(0) lgkmcnt(0)
    v_mfma_f32_16x16x32_bf16 v[48:51], v[16:19], v[72:75], 0
    v_mfma_f32_16x16x32_bf16 v[48:51], v[20:23], v[76:79], v[48:51]
    v_mfma_f32_16x16x32_bf16 v[48:51], v[24:27], v[80:83], v[48:51]
    v_mfma_f32_16x16x32_bf16 v[48:51], v[28:31], v[84:87], v[48:51]
    v_mfma_f32_16x16x32_bf16 v[52:55], v[32:35], v[72:75], 0
    v_mfma_f32_16x16x32_bf16 v[52:55], v[36:39], v[76:79], v[52:55]
    v_mfma_f32_16x16x32_bf16 v[52:55], v[40:43], v[80:83], v[52:55]
    v_mfma_f32_16x16x32_bf16 v[52:55], v[44:47], v[84:87], v[52:55]
    v_mfma_f32_16x16x32_bf16 v[56:59], v[88:91], v[72:75], 0
    v_mfma_f32_16x16x32_bf16 v[56:59], v[92:95], v[76:79], v[56:59]
    v_mfma_f32_16x16x32_bf16 v[56:59], v[96:99], v[80:83], v[56:59]
    v_mfma_f32_16x16x32_bf16 v[56:59], v[100:103], v[84:87], v[56:59]
    s_nop 7
    v_mul_f32 v56, s33, v56
    v_mul_f32 v57, s33, v57
    v_max3_f32 v16, v48, v49, v50
    v_max3_f32 v16, v16, v51, v52
    v_max3_f32 v16, v16, v53, v54
    v_max3_f32 v16, v16, v55, v56
    v_max_f32 v16, v16, v57
    v_mov_b32 v17, v16
    s_nop 1
    v_permlane16_swap_b32 v16, v17
    v_max_f32 v16, v16, v17
    v_mov_b32 v17, v16
    s_nop 1
    v_permlane32_swap_b32 v16, v17
    v_max_f32 v16, v16, v17
    v_sub_f32 v48, v48, v16
    v_exp_f32 v48, v48
    v_sub_f32 v49, v49, v16
    v_exp_f32 v49, v49
    v_sub_f32 v50, v50, v16
    v_exp_f32 v50, v50
    v_sub_f32 v51, v51, v16
    v_exp_f32 v51, v51
    v_sub_f32 v52, v52, v16
    v_exp_f32 v52, v52
    v_sub_f32 v53, v53, v16
    v_exp_f32 v53, v53
    v_sub_f32 v54, v54, v16
    v_exp_f32 v54, v54
    v_sub_f32 v55, v55, v16
    v_exp_f32 v55, v55
    v_sub_f32 v56, v56, v16
    v_exp_f32 v56, v56
    v_sub_f32 v57, v57, v16
    v_exp_f32 v57, v57
    v_cvt_pk_bf16_f32 v108, v48, v49
    v_cvt_pk_bf16_f32 v109, v50, v51
    v_cvt_pk_bf16_f32 v110, v52, v53
    v_cvt_pk_bf16_f32 v111, v54, v55
    v_cvt_pk_bf16_f32 v112, v56, v57
    s_nop 0
    v_mfma_f32_16x16x32_bf16 v[48:51], v[104:107], v[108:111], 0
    v_mfma_f32_16x16x32_bf16 v[56:59], v[120:123], v[108:111], 0
    v_mfma_f32_16x16x32_bf16 v[60:63], v[124:127], v[108:111], 0
    s_nop 3
    v_mfma_f32_16x16x16_bf16 v[48:51], v[104:105], v[112:113], v[48:51]
    v_mfma_f32_16x16x16_bf16 v[56:59], v[114:115], v[112:113], v[56:59]
    v_mfma_f32_16x16x16_bf16 v[60:63], v[116:117], v[112:113], v[60:63]
    s_nop 5
    v_rcp_f32 v118, v48
    s_nop 0
    v_mul_f32 v56, v56, v118
    v_mul_f32 v57, v57, v118
    v_mul_f32 v58, v58, v118
    v_mul_f32 v59, v59, v118
    v_mul_f32 v60, v60, v118
    v_mul_f32 v61, v61, v118
    v_mul_f32 v62, v62, v118
    v_mul_f32 v63, v63, v118
    v_cvt_pk_bf16_f32 v52, v56, v60
    v_cvt_pk_bf16_f32 v53, v57, v61
    v_cvt_pk_bf16_f32 v54, v58, v62
    v_cvt_pk_bf16_f32 v55, v59, v63
    ds_read_b128 v[88:91], v4 offset:24576
    ds_read_b128 v[92:95], v4 offset:25600
    ds_read_b128 v[96:99], v4 offset:26624
    ds_read_b128 v[100:103], v4 offset:27648
    v_mov_b32 v16, 0
    v_mov_b32 v17, 0
    v_mov_b32 v18, 0
    v_mov_b32 v19, 0
    v_mov_b32 v20, 0
    v_mov_b32 v21, 0
    v_mov_b32 v22, 0
    v_mov_b32 v23, 0
    v_mov_b32 v24, 0
    v_mov_b32 v25, 0
    v_mov_b32 v26, 0
    v_mov_b32 v27, 0
    v_mov_b32 v28, 0
    v_mov_b32 v29, 0
    v_mov_b32 v30, 0
    v_mov_b32 v31, 0
    s_mov_b64 vcc, 0
    s_branch L_fast_rejoin
L_fast_done:
    s_branch L_end
L_slow_start:
    s_mov_b32 s22, 0
    s_mov_b32 s23, 0x1000000
    s_mov_b32 s27, 0
    s_mov_b32 s31, 0x80000
    s_mov_b32 s61, 0x40000000
    s_mov_b32 s91, 0
    ds_read_b128 v[104:107], v4 offset:0
    ds_read_b128 v[108:111], v4 offset:1024
    ds_read_b128 v[112:115], v4 offset:2048
    ds_read_b128 v[116:119], v4 offset:3072
    ds_read_b128 v[88:91], v4 offset:4096
    ds_read_b128 v[92:95], v4 offset:5120
    ds_read_b128 v[96:99], v4 offset:6144
    ds_read_b128 v[100:103], v4 offset:7168
    ds_read_b128 v[72:75], v4 offset:8192
    ds_read_b128 v[76:79], v4 offset:9216
    ds_read_b128 v[80:83], v4 offset:10240
    ds_read_b128 v[84:87], v4 offset:11264
    v_mov_b64 v[48:49], 0
    v_mov_b64 v[50:51], 0
    v_mov_b64 v[52:53], 0
    v_mov_b64 v[54:55], 0
    v_mov_b64 v[56:57], 0
    v_mov_b64 v[58:59], 0
    v_mov_b64 v[60:61], 0
    v_mov_b64 v[62:63], 0
    v_mov_b64 v[64:65], 0
    v_mov_b64 v[66:67], 0
    v_mov_b64 v[68:69], 0
    v_mov_b64 v[70:71], 0
    s_mov_b64 s[62:63], 0
    s_add_u32 s7, s23, 0x80000
    buffer_load_dwordx4 v[16:19], v2, s[8:11], s7 offen sc1
    buffer_load_dwordx4 v[20:23], v2, s[8:11], s7 offen offset:1024 sc1
L_slow_step:
    s_lshr_b64 s[36:37], s[62:63], s22
    s_andn2_b32 s36, 3, s36
    s_cbranch_scc1 L_slow_refresh
    s_add_u32 s24, s23, 0x82000
    s_add_u32 s29, s23, s25
    s_add_u32 s30, s23, s39
    s_xor_b32 s28, s27, 1
    s_add_u32 s90, s22, 1
    v_xor_b32 v28, 0x800, v2
    v_xor_b32 v44, 0x1800, v2
    s_nop 13
    buffer_load_dwordx4 v[16:19], v2, s[8:11], s7 offen sc1
    buffer_load_dwordx4 v[20:23], v2, s[8:11], s7 offen offset:1024 sc1
L_slow_waitm:
    s_waitcnt vmcnt(3) lgkmcnt(0)
L_slow_gotm:
    v_max3_u32 v14, v16, v17, v18
    v_max_u32 v14, v14, v19
    v_smfmac_f32_16x16x64_bf16 v[48:51], v[16:19], v[104:111], v1
    s_waitcnt vmcnt(2)
    v_max3_u32 v14, v14, v20, v21
    v_smfmac_f32_16x16x64_bf16 v[52:55], v[16:19], v[112:119], v1
    v_max3_u32 v14, v14, v22, v23
    v_cmp_eq_u32 vcc, -1, v14
    v_smfmac_f32_16x16x64_bf16 v[48:51], v[20:23], v[88:95], v1
    ds_write_b128 v2, v[16:19] offset:0
    s_cbranch_vccnz L_slow_retrym
L_slow_okm:
    v_smfmac_f32_16x16x64_bf16 v[52:55], v[20:23], v[96:103], v1
    ds_write_b128 v2, v[20:23] offset:1024
    v_smfmac_f32_16x16x64_bf16 v[56:59], v[16:19], v[72:79], v1
    buffer_load_dwordx4 v[104:107], v3, s[8:11], s29 offen offset:0 sc1
    v_smfmac_f32_16x16x64_bf16 v[60:63], v[16:19], v[80:87], v1
    buffer_load_dwordx4 v[108:111], v3, s[8:11], s29 offen offset:1024 sc1
    v_smfmac_f32_16x16x64_bf16 v[56:59], v[20:23], a[80:87], v1
    buffer_load_dwordx4 v[112:115], v3, s[8:11], s29 offen offset:2048 sc1
    v_smfmac_f32_16x16x64_bf16 v[60:63], v[20:23], a[88:95], v1
    s_waitcnt lgkmcnt(0)
    s_barrier
    ds_read_b128 v[24:27], v28 offset:0
    v_smfmac_f32_16x16x64_bf16 v[64:67], v[16:19], a[160:167], v1
    ds_read_b128 v[28:31], v28 offset:1024
    v_smfmac_f32_16x16x64_bf16 v[68:71], v[16:19], a[168:175], v1
    buffer_load_dwordx4 v[116:119], v3, s[8:11], s29 offen offset:3072 sc1
    v_smfmac_f32_16x16x64_bf16 v[64:67], v[20:23], a[176:183], v1
    ds_read_b128 v[32:35], v8 offset:0
    v_smfmac_f32_16x16x64_bf16 v[68:71], v[20:23], a[184:191], v1
    ds_read_b128 v[36:39], v8 offset:1024
    s_waitcnt lgkmcnt(3)
    v_smfmac_f32_16x16x64_bf16 v[48:51], v[24:27], a[0:7], v1
    buffer_load_dwordx4 v[120:123], v3, s[8:11], s30 offen offset:0 sc1
    v_smfmac_f32_16x16x64_bf16 v[52:55], v[24:27], a[8:15], v1
    ds_read_b128 v[40:43], v44 offset:0
    s_waitcnt lgkmcnt(3)
    v_smfmac_f32_16x16x64_bf16 v[48:51], v[28:31], a[16:23], v1
    buffer_load_dwordx4 v[124:127], v3, s[8:11], s30 offen offset:1024 sc1
    v_smfmac_f32_16x16x64_bf16 v[52:55], v[28:31], a[24:31], v1
    ds_read_b128 v[44:47], v44 offset:1024
    s_waitcnt lgkmcnt(2)
    v_smfmac_f32_16x16x64_bf16 v[48:51], v[32:35], a[32:39], v1
    v_smfmac_f32_16x16x64_bf16 v[52:55], v[32:35], a[40:47], v1
    ds_read_b128 v[88:91], v4 offset:12288
    v_smfmac_f32_16x16x64_bf16 v[48:51], v[36:39], a[48:55], v1
    ds_read_b128 v[92:95], v4 offset:13312
    s_waitcnt lgkmcnt(2)
    v_smfmac_f32_16x16x64_bf16 v[52:55], v[36:39], a[56:63], v1
    ds_read_b128 v[96:99], v4 offset:14336
    v_smfmac_f32_16x16x64_bf16 v[48:51], v[40:43], a[64:71], v1
    ds_read_b128 v[100:103], v4 offset:15360
    v_smfmac_f32_16x16x64_bf16 v[52:55], v[40:43], a[72:79], v1
    buffer_load_dword v15, v0, s[8:11], s24 offen sc1
    v_smfmac_f32_16x16x64_bf16 v[56:59], v[28:31], a[96:103], v1
    ds_read_b128 v[72:75], v4 offset:16384
    v_smfmac_f32_16x16x64_bf16 v[60:63], v[28:31], a[104:111], v1
    ds_read_b128 v[76:79], v4 offset:17408
    s_waitcnt lgkmcnt(2)
    v_smfmac_f32_16x16x64_bf16 v[48:51], v[44:47], v[88:95], v1
    ds_read_b128 v[80:83], v4 offset:18432
    v_smfmac_f32_16x16x64_bf16 v[52:55], v[44:47], v[96:103], v1
    ds_read_b128 v[84:87], v4 offset:19456
    v_smfmac_f32_16x16x64_bf16 v[56:59], v[32:35], a[112:119], v1
    ds_read_b128 v[88:91], v4 offset:20480
    v_smfmac_f32_16x16x64_bf16 v[60:63], v[32:35], a[120:127], v1
    ds_read_b128 v[92:95], v4 offset:21504
    v_smfmac_f32_16x16x64_bf16 v[56:59], v[36:39], a[128:135], v1
    ds_read_b128 v[96:99], v4 offset:22528
    v_add_f32 v48, v48, v50
    v_add_f32 v49, v49, v51
    v_smfmac_f32_16x16x64_bf16 v[60:63], v[36:39], a[136:143], v1
    ds_read_b128 v[100:103], v4 offset:23552
    v_add_f32 v52, v52, v54
    v_add_f32 v53, v53, v55
    v_smfmac_f32_16x16x64_bf16 v[56:59], v[40:43], a[144:151], v1
    s_waitcnt lgkmcnt(4)
    v_cvt_pk_bf16_f32 v50, v48, v52
    v_cvt_pk_bf16_f32 v51, v49, v53
    v_smfmac_f32_16x16x64_bf16 v[60:63], v[40:43], a[152:159], v1
    ds_write2_b32 v5, v50, v51 offset0:0 offset1:72
    v_smfmac_f32_16x16x64_bf16 v[56:59], v[24:27], v[72:79], v1
    buffer_store_dword v12, v10, s[8:11], s31 offen sc1
    v_smfmac_f32_16x16x64_bf16 v[60:63], v[24:27], v[80:87], v1
    s_waitcnt lgkmcnt(1)
    v_smfmac_f32_16x16x64_bf16 v[56:59], v[44:47], v[88:95], v1
    v_smfmac_f32_16x16x64_bf16 v[60:63], v[44:47], v[96:103], v1
    s_waitcnt lgkmcnt(0)
    s_barrier
    v_smfmac_f32_16x16x64_bf16 v[64:67], v[24:27], a[192:199], v1
    ds_read_b128 v[72:75], v6 offset:0
    v_smfmac_f32_16x16x64_bf16 v[68:71], v[24:27], a[200:207], v1
    ds_read_b128 v[76:79], v6 offset:64
    s_nop 0
    v_add_f32 v56, v56, v58
    v_smfmac_f32_16x16x64_bf16 v[64:67], v[28:31], a[208:215], v1
    ds_read_b128 v[80:83], v6 offset:128
    v_add_f32 v57, v57, v59
    v_smfmac_f32_16x16x64_bf16 v[68:71], v[28:31], a[216:223], v1
    ds_read_b128 v[84:87], v6 offset:192
    v_add_f32 v60, v60, v62
    v_add_f32 v61, v61, v63
    s_waitcnt vmcnt(2) lgkmcnt(3)
    v_mfma_f32_16x16x32_bf16 v[48:51], v[104:107], v[72:75], 0
    s_waitcnt lgkmcnt(2)
    v_cvt_pk_bf16_f32 v58, v56, v60
    v_cvt_pk_bf16_f32 v59, v57, v61
    v_mfma_f32_16x16x32_bf16 v[48:51], v[108:111], v[76:79], v[48:51]
    ds_write2_b32 v7, v58, v59 offset0:0 offset1:72
    s_waitcnt lgkmcnt(2)
    v_mfma_f32_16x16x32_bf16 v[48:51], v[112:115], v[80:83], v[48:51]
    s_waitcnt lgkmcnt(1)
    v_mov_b64 v[104:105], s[4:5]
    v_mov_b64 v[106:107], s[4:5]
    v_mfma_f32_16x16x32_bf16 v[48:51], v[116:119], v[84:87], v[48:51]
    v_mov_b64 v[16:17], 0
    v_mov_b64 v[18:19], 0
    v_smfmac_f32_16x16x64_bf16 v[64:67], v[32:35], a[224:231], v1
    v_mov_b32 v113, 0
    v_smfmac_f32_16x16x64_bf16 v[68:71], v[32:35], a[232:239], v1
    s_waitcnt lgkmcnt(0)
    s_barrier
    v_mov_b32 v115, 0
    v_smfmac_f32_16x16x64_bf16 v[64:67], v[36:39], a[240:247], v1
    ds_read_b128 v[88:91], v6 offset:2304
    v_exp_f32 v48, v48
    v_smfmac_f32_16x16x64_bf16 v[68:71], v[36:39], a[248:255], v1
    ds_read_b128 v[92:95], v6 offset:2368
    v_exp_f32 v49, v49
    v_smfmac_f32_16x16x64_bf16 v[64:67], v[40:43], v[128:135], v1
    ds_read_b128 v[96:99], v6 offset:2432
    v_exp_f32 v50, v50
    v_smfmac_f32_16x16x64_bf16 v[68:71], v[40:43], v[136:143], v1
    ds_read_b128 v[100:103], v6 offset:2496
    v_exp_f32 v51, v51
    s_waitcnt lgkmcnt(3)
    v_mfma_f32_16x16x32_bf16 v[52:55], v[88:91], v[72:75], 0
    s_waitcnt lgkmcnt(2)
    v_cvt_pk_bf16_f32 v108, v48, v49
    v_cvt_pk_bf16_f32 v109, v50, v51
    v_mfma_f32_16x16x32_bf16 v[52:55], v[92:95], v[76:79], v[52:55]
    ds_write_b64 v2, v[108:109] offset:8192
    s_waitcnt lgkmcnt(2)
    v_mfma_f32_16x16x32_bf16 v[52:55], v[96:99], v[80:83], v[52:55]
    s_waitcnt lgkmcnt(1)
    v_mov_b32 v117, 0
    v_mov_b64 v[20:21], 0
    v_mfma_f32_16x16x32_bf16 v[52:55], v[100:103], v[84:87], v[52:55]
    v_mov_b64 v[22:23], 0
    v_mov_b64 v[24:25], 0
    v_smfmac_f32_16x16x64_bf16 v[64:67], v[44:47], v[144:151], v1
    ds_read_b128 v[88:91], v4 offset:24576
    v_smfmac_f32_16x16x64_bf16 v[68:71], v[44:47], v[152:159], v1
    s_waitcnt lgkmcnt(1)
    s_barrier
    ds_read_b64 v[110:111], v8 offset:8192
    ds_read_b128 v[92:95], v4 offset:25600
    v_mul_f32 v52, s33, v52
    v_mul_f32 v53, s33, v53
    v_exp_f32 v52, v52
    v_exp_f32 v53, v53
    s_nop 0
    v_cvt_pk_bf16_f32 v112, v52, v53
    v_add_f32 v64, v64, v66
    v_add_f32 v65, v65, v67
    s_waitcnt lgkmcnt(1)
    v_mfma_f32_16x16x32_bf16 v[48:51], v[104:107], v[108:111], 0
    v_cvt_pk_bf16_f32 v114, v64, v65
    v_add_f32 v68, v68, v70
    v_mfma_f32_16x16x32_bf16 v[56:59], v[120:123], v[108:111], 0
    v_add_f32 v69, v69, v71
    v_cvt_pk_bf16_f32 v116, v68, v69
    v_mfma_f32_16x16x32_bf16 v[60:63], v[124:127], v[108:111], 0
    ds_read_b128 v[96:99], v4 offset:26624
    v_mov_b64 v[26:27], 0
    v_mfma_f32_16x16x16_bf16 v[48:51], v[104:105], v[112:113], v[48:51]
    ds_read_b128 v[100:103], v4 offset:27648
    v_mov_b64 v[28:29], 0
    v_mfma_f32_16x16x16_bf16 v[56:59], v[114:115], v[112:113], v[56:59]
    v_mov_b64 v[30:31], 0
    v_mfma_f32_16x16x16_bf16 v[60:63], v[116:117], v[112:113], v[60:63]
    s_nop 2
    v_rcp_f32 v118, v48
    s_nop 0
    v_max_f32 v14, v118, v48
    v_cmp_nge_f32 vcc, s40, v14
    v_pk_mul_f32 v[56:57], v[56:57], v[118:119] op_sel_hi:[1,0]
    v_pk_mul_f32 v[58:59], v[58:59], v[118:119] op_sel_hi:[1,0]
    v_pk_mul_f32 v[60:61], v[60:61], v[118:119] op_sel_hi:[1,0]
    v_pk_mul_f32 v[62:63], v[62:63], v[118:119] op_sel_hi:[1,0]
    v_cvt_pk_bf16_f32 v52, v56, v60
    v_cvt_pk_bf16_f32 v53, v57, v61
    v_cvt_pk_bf16_f32 v54, v58, v62
    v_cvt_pk_bf16_f32 v55, v59, v63
L_slow_rejoin:
    ds_write_b128 v2, v[52:55] offset:9216
    s_waitcnt lgkmcnt(1)
    v_smfmac_f32_16x16x64_bf16 v[16:19], v[52:55], v[88:95], v1
    ds_read_b128 v[72:75], v4 offset:28672
    v_xor_b32 v32, 0x800, v2
    v_smfmac_f32_16x16x64_bf16 v[20:23], v[52:55], v[96:103], v1
    ds_read_b128 v[76:79], v4 offset:29696
    v_xor_b32 v40, 0x1800, v2
    s_waitcnt lgkmcnt(2)
    s_barrier
    ds_read_b128 v[32:35], v32 offset:9216
    ds_read_b128 v[36:39], v8 offset:9216
    ds_read_b128 v[40:43], v40 offset:9216
    ds_read_b128 v[80:83], v4 offset:30720
    ds_read_b128 v[84:87], v4 offset:31744
    s_waitcnt lgkmcnt(4)
    v_smfmac_f32_16x16x64_bf16 v[16:19], v[32:35], v[160:167], v1
    s_waitcnt lgkmcnt(3)
    v_smfmac_f32_16x16x64_bf16 v[16:19], v[36:39], v[192:199], v1
    s_waitcnt lgkmcnt(2)
    v_smfmac_f32_16x16x64_bf16 v[16:19], v[40:43], v[224:231], v1
    s_cmp_lg_u64 vcc, 0
    s_cselect_b32 s60, s28, s27
    v_smfmac_f32_16x16x64_bf16 v[20:23], v[32:35], v[168:175], v1
    ds_read_b128 v[64:67], v3 offset:23040
    s_waitcnt lgkmcnt(1)
    v_smfmac_f32_16x16x64_bf16 v[20:23], v[36:39], v[200:207], v1
    s_nop 1
    v_smfmac_f32_16x16x64_bf16 v[20:23], v[40:43], v[232:239], v1
    v_cvt_pk_bf16_f32 v56, v16, v18
    v_smfmac_f32_16x16x64_bf16 v[24:27], v[52:55], v[72:79], v1
    v_cvt_pk_bf16_f32 v57, v17, v19
    v_and_or_b32 v56, v56, -2, s60
    v_smfmac_f32_16x16x64_bf16 v[24:27], v[32:35], v[176:183], v1
    buffer_store_dwordx2 v[56:57], v9, s[8:11], 0 offen offset:0 sc1
    v_smfmac_f32_16x16x64_bf16 v[24:27], v[36:39], v[208:215], v1
    s_nop 0
    v_cvt_pk_bf16_f32 v58, v20, v22
    v_smfmac_f32_16x16x64_bf16 v[24:27], v[40:43], v[240:247], v1
    v_cvt_pk_bf16_f32 v59, v21, v23
    v_and_or_b32 v58, v58, -2, s60
    v_smfmac_f32_16x16x64_bf16 v[28:31], v[52:55], v[80:87], v1
    buffer_store_dwordx2 v[58:59], v9, s[8:11], 0 offen offset:2048 sc1
    v_smfmac_f32_16x16x64_bf16 v[28:31], v[32:35], v[184:191], v1
    s_nop 1
    v_smfmac_f32_16x16x64_bf16 v[28:31], v[36:39], v[216:223], v1
    v_cvt_pk_bf16_f32 v60, v24, v26
    v_smfmac_f32_16x16x64_bf16 v[28:31], v[40:43], v[248:255], v1
    v_cvt_pk_bf16_f32 v61, v25, v27
    v_and_or_b32 v60, v60, -2, s60
    buffer_store_dwordx2 v[60:61], v9, s[8:11], s26 offen offset:0 sc1
    s_nop 4
    v_cvt_pk_bf16_f32 v62, v28, v30
    v_cvt_pk_bf16_f32 v63, v29, v31
    v_and_or_b32 v62, v62, -2, s60
    buffer_store_dwordx2 v[62:63], v9, s[8:11], s26 offen offset:2048 sc1
L_slow_stored:
    s_cmp_lg_u32 s60, s27
    s_cbranch_scc1 L_slow_safe
    ds_read_b128 v[104:107], v4 offset:0
    ds_read_b128 v[108:111], v4 offset:1024
    ds_read_b128 v[112:115], v4 offset:2048
    ds_read_b128 v[116:119], v4 offset:3072
    ds_read_b128 v[88:91], v4 offset:4096
    ds_read_b128 v[92:95], v4 offset:5120
    ds_read_b128 v[96:99], v4 offset:6144
    ds_read_b128 v[100:103], v4 offset:7168
    ds_read_b128 v[72:75], v4 offset:8192
    ds_read_b128 v[76:79], v4 offset:9216
    ds_read_b128 v[80:83], v4 offset:10240
    ds_read_b128 v[84:87], v4 offset:11264
    s_cmp_lt_u32 s21, 1
    s_cbranch_scc1 L_slow_pollp
    s_nop 7
    s_cmp_lt_u32 s21, 2
    s_cbranch_scc1 L_slow_pollp
    s_nop 7
    s_cmp_lt_u32 s21, 3
    s_cbranch_scc1 L_slow_pollp
    s_nop 7
L_slow_pollp:
    buffer_load_dwordx4 v[120:123], v2, s[8:11], s6 offen sc1
    buffer_load_dwordx4 v[124:127], v2, s[8:11], s6 offen offset:1024 sc1
    v_mov_b64 v[48:49], 0
    v_mov_b64 v[50:51], 0
    v_mov_b64 v[52:53], 0
    v_mov_b64 v[54:55], 0
    v_mov_b64 v[56:57], 0
    v_mov_b64 v[58:59], 0
    v_mov_b64 v[60:61], 0
    v_mov_b64 v[62:63], 0
    s_nop 15
    s_nop 11
    buffer_load_dwordx4 v[32:35], v2, s[8:11], s6 offen sc1
    buffer_load_dwordx4 v[36:39], v2, s[8:11], s6 offen offset:1024 sc1
    s_add_u32 s7, s24, 0x80000
    s_waitcnt vmcnt(3) lgkmcnt(0)
    v_mfma_f32_16x16x32_bf16 v[68:71], v[64:67], v[120:123], 0
    v_bitop3_b32 v14, v120, v122, s27 bitop3:0x7e
    s_waitcnt vmcnt(2)
    v_mfma_f32_16x16x32_bf16 v[68:71], v[64:67], v[124:127], v[68:71]
    v_bitop3_b32 v11, v124, v126, s27 bitop3:0x7e
    v_bitop3_b32 v14, v14, v11, 1 bitop3:0xa8
    v_cmp_ne_u32 vcc, 0, v14
    s_nop 2
    s_cmp_eq_u64 vcc, 0
    s_cselect_b32 s36, s24, s61
    v_add_f32_dpp v68, v68, v68 row_ror:8 row_mask:0xf bank_mask:0xf
    v_add_f32_dpp v69, v69, v69 row_ror:8 row_mask:0xf bank_mask:0xf
    s_nop 0
    v_add_f32_dpp v68, v68, v68 row_ror:4 row_mask:0xf bank_mask:0xf
    v_add_f32_dpp v69, v69, v69 row_ror:4 row_mask:0xf bank_mask:0xf
    v_cvt_pk_bf16_f32 v12, v68, v69
    buffer_store_dword v12, v10, s[8:11], s36 offen sc1
    s_cbranch_scc0 L_slow_retryp
L_slow_gotp:
    s_mov_b32 s23, s24
    s_add_u32 s31, s31, 0x2000
    s_mov_b32 s22, s90
    s_mov_b32 s27, s28
    v_mov_b64 v[64:65], 0
    v_mov_b64 v[66:67], 0
    v_mov_b64 v[68:69], 0
    v_mov_b64 v[70:71], 0
    s_nop 15
    s_nop 15
    s_nop 3
    buffer_load_dwordx4 v[16:19], v2, s[8:11], s7 offen sc1
    buffer_load_dwordx4 v[20:23], v2, s[8:11], s7 offen offset:1024 sc1
    s_cmp_lt_u32 s22, 63
    s_cbranch_scc1 L_slow_step
    buffer_store_dword v12, v10, s[8:11], s31 offen sc1
    s_branch L_slow_done
L_slow_retrym:
    s_add_u32 s32, s32, 1
    s_cmp_gt_u32 s32, 200000
    s_cbranch_scc1 L_slow_okm
    buffer_load_dwordx4 v[16:19], v2, s[8:11], s7 offen sc1
    buffer_load_dwordx4 v[20:23], v2, s[8:11], s7 offen offset:1024 sc1
    s_nop 1
    v_mov_b64 v[48:49], 0
    v_mov_b64 v[50:51], 0
    v_mov_b64 v[52:53], 0
    v_mov_b64 v[54:55], 0
    s_branch L_slow_waitm
L_slow_retryp:
    s_add_u32 s32, s32, 1
    buffer_load_dwordx4 v[120:123], v2, s[8:11], s6 offen sc1
    buffer_load_dwordx4 v[124:127], v2, s[8:11], s6 offen offset:1024 sc1
    s_waitcnt vmcnt(4) lgkmcnt(0)
    v_mfma_f32_16x16x32_bf16 v[68:71], v[64:67], v[32:35], 0
    v_bitop3_b32 v14, v32, v34, s27 bitop3:0x7e
    s_waitcnt vmcnt(3)
    v_mfma_f32_16x16x32_bf16 v[68:71], v[64:67], v[36:39], v[68:71]
    v_bitop3_b32 v11, v36, v38, s27 bitop3:0x7e
    v_bitop3_b32 v14, v14, v11, 1 bitop3:0xa8
    v_cmp_ne_u32 vcc, 0, v14
    s_nop 2
    s_cmp_eq_u64 vcc, 0
    s_cselect_b32 s36, s24, s61
    v_add_f32_dpp v68, v68, v68 row_ror:8 row_mask:0xf bank_mask:0xf
    v_add_f32_dpp v69, v69, v69 row_ror:8 row_mask:0xf bank_mask:0xf
    s_nop 0
    v_add_f32_dpp v68, v68, v68 row_ror:4 row_mask:0xf bank_mask:0xf
    v_add_f32_dpp v69, v69, v69 row_ror:4 row_mask:0xf bank_mask:0xf
    v_cvt_pk_bf16_f32 v12, v68, v69
    buffer_store_dword v12, v10, s[8:11], s36 offen sc1
    s_cbranch_scc1 L_slow_gotp
    buffer_load_dwordx4 v[32:35], v2, s[8:11], s6 offen sc1
    buffer_load_dwordx4 v[36:39], v2, s[8:11], s6 offen offset:1024 sc1
    s_waitcnt vmcnt(4) lgkmcnt(0)
    v_mfma_f32_16x16x32_bf16 v[68:71], v[64:67], v[120:123], 0
    v_bitop3_b32 v14, v120, v122, s27 bitop3:0x7e
    s_waitcnt vmcnt(3)
    v_mfma_f32_16x16x32_bf16 v[68:71], v[64:67], v[124:127], v[68:71]
    v_bitop3_b32 v11, v124, v126, s27 bitop3:0x7e
    v_bitop3_b32 v14, v14, v11, 1 bitop3:0xa8
    v_cmp_ne_u32 vcc, 0, v14
    s_nop 2
    s_cmp_eq_u64 vcc, 0
    s_cselect_b32 s36, s24, s61
    v_add_f32_dpp v68, v68, v68 row_ror:8 row_mask:0xf bank_mask:0xf
    v_add_f32_dpp v69, v69, v69 row_ror:8 row_mask:0xf bank_mask:0xf
    s_nop 0
    v_add_f32_dpp v68, v68, v68 row_ror:4 row_mask:0xf bank_mask:0xf
    v_add_f32_dpp v69, v69, v69 row_ror:4 row_mask:0xf bank_mask:0xf
    v_cvt_pk_bf16_f32 v12, v68, v69
    buffer_store_dword v12, v10, s[8:11], s36 offen sc1
    s_cbranch_scc1 L_slow_gotp
    s_cmp_le_u32 s32, 200000
    s_cbranch_scc1 L_slow_retryp
    s_mov_b32 s36, s24
    buffer_store_dword v12, v10, s[8:11], s36 offen sc1
    s_branch L_slow_gotp
L_slow_refresh:
    v_lshrrev_b32 v14, 2, v3
    s_lshl_b32 s36, s20, 8
    s_add_u32 s36, s36, 0x190000
    buffer_load_dword v14, v14, s[8:11], s36 offen sc1
    s_add_u32 s32, s32, 1
    s_waitcnt vmcnt(0)
    v_cmp_ne_u32 s[62:63], 0, v14
    s_nop 3
    s_cmp_le_u32 s32, 200000
    s_cbranch_scc1 L_slow_step
    s_mov_b64 s[62:63], -1
    s_branch L_slow_step
L_slow_safe:
    s_nop 11
    s_waitcnt vmcnt(0) lgkmcnt(0)
    s_barrier
    ds_read_b128 v[72:75], v6 offset:0
    ds_read_b128 v[88:91], v6 offset:2304
    ds_read_b128 v[76:79], v6 offset:64
    ds_read_b128 v[92:95], v6 offset:2368
    ds_read_b128 v[80:83], v6 offset:128
    ds_read_b128 v[96:99], v6 offset:2432
    ds_read_b128 v[84:87], v6 offset:192
    ds_read_b128 v[100:103], v6 offset:2496
    s_xor_b32 s36, s25, 0x1000
    s_add_u32 s36, s36, s23
    buffer_load_dwordx4 v[16:19], v3, s[8:11], s29 offen offset:0 sc1
    buffer_load_dwordx4 v[32:35], v3, s[8:11], s36 offen offset:0 sc1
    buffer_load_dwordx4 v[20:23], v3, s[8:11], s29 offen offset:1024 sc1
    buffer_load_dwordx4 v[36:39], v3, s[8:11], s36 offen offset:1024 sc1
    buffer_load_dwordx4 v[24:27], v3, s[8:11], s29 offen offset:2048 sc1
    buffer_load_dwordx4 v[40:43], v3, s[8:11], s36 offen offset:2048 sc1
    buffer_load_dwordx4 v[28:31], v3, s[8:11], s29 offen offset:3072 sc1
    buffer_load_dwordx4 v[44:47], v3, s[8:11], s36 offen offset:3072 sc1
    s_waitcnt vmcnt(0) lgkmcnt(0)
    v_mfma_f32_16x16x32_bf16 v[48:51], v[16:19], v[72:75], 0
    v_mfma_f32_16x16x32_bf16 v[48:51], v[20:23], v[76:79], v[48:51]
    v_mfma_f32_16x16x32_bf16 v[48:51], v[24:27], v[80:83], v[48:51]
    v_mfma_f32_16x16x32_bf16 v[48:51], v[28:31], v[84:87], v[48:51]
    v_mfma_f32_16x16x32_bf16 v[52:55], v[32:35], v[72:75], 0
    v_mfma_f32_16x16x32_bf16 v[52:55], v[36:39], v[76:79], v[52:55]
    v_mfma_f32_16x16x32_bf16 v[52:55], v[40:43], v[80:83], v[52:55]
    v_mfma_f32_16x16x32_bf16 v[52:55], v[44:47], v[84:87], v[52:55]
    v_mfma_f32_16x16x32_bf16 v[56:59], v[88:91], v[72:75], 0
    v_mfma_f32_16x16x32_bf16 v[56:59], v[92:95], v[76:79], v[56:59]
    v_mfma_f32_16x16x32_bf16 v[56:59], v[96:99], v[80:83], v[56:59]
    v_mfma_f32_16x16x32_bf16 v[56:59], v[100:103], v[84:87], v[56:59]
    s_nop 7
    v_mul_f32 v56, s33, v56
    v_mul_f32 v57, s33, v57
    v_max3_f32 v16, v48, v49, v50
    v_max3_f32 v16, v16, v51, v52
    v_max3_f32 v16, v16, v53, v54
    v_max3_f32 v16, v16, v55, v56
    v_max_f32 v16, v16, v57
    v_mov_b32 v17, v16
    s_nop 1
    v_permlane16_swap_b32 v16, v17
    v_max_f32 v16, v16, v17
    v_mov_b32 v17, v16
    s_nop 1
    v_permlane32_swap_b32 v16, v17
    v_max_f32 v16, v16, v17
    v_sub_f32 v48, v48, v16
    v_exp_f32 v48, v48
    v_sub_f32 v49, v49, v16
    v_exp_f32 v49, v49
    v_sub_f32 v50, v50, v16
    v_exp_f32 v50, v50
    v_sub_f32 v51, v51, v16
    v_exp_f32 v51, v51
    v_sub_f32 v52, v52, v16
    v_exp_f32 v52, v52
    v_sub_f32 v53, v53, v16
    v_exp_f32 v53, v53
    v_sub_f32 v54, v54, v16
    v_exp_f32 v54, v54
    v_sub_f32 v55, v55, v16
    v_exp_f32 v55, v55
    v_sub_f32 v56, v56, v16
    v_exp_f32 v56, v56
    v_sub_f32 v57, v57, v16
    v_exp_f32 v57, v57
    v_cvt_pk_bf16_f32 v108, v48, v49
    v_cvt_pk_bf16_f32 v109, v50, v51
    v_cvt_pk_bf16_f32 v110, v52, v53
    v_cvt_pk_bf16_f32 v111, v54, v55
    v_cvt_pk_bf16_f32 v112, v56, v57
    s_nop 0
    v_mfma_f32_16x16x32_bf16 v[48:51], v[104:107], v[108:111], 0
    v_mfma_f32_16x16x32_bf16 v[56:59], v[120:123], v[108:111], 0
    v_mfma_f32_16x16x32_bf16 v[60:63], v[124:127], v[108:111], 0
    s_nop 3
    v_mfma_f32_16x16x16_bf16 v[48:51], v[104:105], v[112:113], v[48:51]
    v_mfma_f32_16x16x16_bf16 v[56:59], v[114:115], v[112:113], v[56:59]
    v_mfma_f32_16x16x16_bf16 v[60:63], v[116:117], v[112:113], v[60:63]
    s_nop 5
    v_rcp_f32 v118, v48
    s_nop 0
    v_mul_f32 v56, v56, v118
    v_mul_f32 v57, v57, v118
    v_mul_f32 v58, v58, v118
    v_mul_f32 v59, v59, v118
    v_mul_f32 v60, v60, v118
    v_mul_f32 v61, v61, v118
    v_mul_f32 v62, v62, v118
    v_mul_f32 v63, v63, v118
    v_cvt_pk_bf16_f32 v52, v56, v60
    v_cvt_pk_bf16_f32 v53, v57, v61
    v_cvt_pk_bf16_f32 v54, v58, v62
    v_cvt_pk_bf16_f32 v55, v59, v63
    ds_read_b128 v[88:91], v4 offset:24576
    ds_read_b128 v[92:95], v4 offset:25600
    ds_read_b128 v[96:99], v4 offset:26624
    ds_read_b128 v[100:103], v4 offset:27648
    v_mov_b32 v16, 0
    v_mov_b32 v17, 0
    v_mov_b32 v18, 0
    v_mov_b32 v19, 0
    v_mov_b32 v20, 0
    v_mov_b32 v21, 0
    v_mov_b32 v22, 0
    v_mov_b32 v23, 0
    v_mov_b32 v24, 0
    v_mov_b32 v25, 0
    v_mov_b32 v26, 0
    v_mov_b32 v27, 0
    v_mov_b32 v28, 0
    v_mov_b32 v29, 0
    v_mov_b32 v30, 0
    v_mov_b32 v31, 0
    s_mov_b64 vcc, 0
    s_branch L_slow_rejoin
L_slow_done:
    s_branch L_end
L_worker:
    s_mov_b32 s12, s44
    s_and_b32 s13, s45, 0xffff
    s_mov_b32 s14, 0x200000
    s_mov_b32 s15, 0x20000
    s_mov_b32 s60, s82
    s_and_b32 s61, s83, 0xffff
    s_mov_b32 s62, 0x200000
    s_mov_b32 s63, 0x20000
    s_mov_b32 s92, s80
    s_and_b32 s93, s81, 0xffff
    s_mov_b32 s94, 0x400
    s_mov_b32 s95, 0x20000
    s_and_b32 s36, s2, 7
    s_sub_u32 s36, s36, 1
    s_lshl_b32 s36, s36, 5
    s_lshr_b32 s37, s2, 3
    s_add_u32 s36, s36, s37
    s_mul_i32 s20, s36, 10923
    s_lshr_b32 s20, s20, 16
    s_mul_i32 s37, s20, 6
    s_sub_u32 s22, s36, s37
    v_mov_b32 v1, 0x0
    v_bfe_u32 v14, v0, 0, 1
    s_mov_b32 s38, 0x10
    v_mad_u32_u24 v1, v14, s38, v1
    v_bfe_u32 v14, v0, 1, 1
    s_mov_b32 s38, 0x20
    v_mad_u32_u24 v1, v14, s38, v1
    v_bfe_u32 v14, v0, 2, 1
    s_mov_b32 s38, 0x40
    v_mad_u32_u24 v1, v14, s38, v1
    v_bfe_u32 v14, v0, 3, 1
    s_mov_b32 s38, 0x80
    v_mad_u32_u24 v1, v14, s38, v1
    v_bfe_u32 v14, v0, 4, 1
    s_mov_b32 s38, 0x100
    v_mad_u32_u24 v1, v14, s38, v1
    v_bfe_u32 v14, v0, 5, 1
    s_mov_b32 s38, 0x200
    v_mad_u32_u24 v1, v14, s38, v1
    v_mov_b32 v2, 0x0
    v_bfe_u32 v14, v0, 0, 1
    s_mov_b32 s38, 0x10
    v_mad_u32_u24 v2, v14, s38, v2
    v_bfe_u32 v14, v0, 1, 1
    s_mov_b32 s38, 0x20
    v_mad_u32_u24 v2, v14, s38, v2
    v_bfe_u32 v14, v0, 2, 1
    s_mov_b32 s38, 0x40
    v_mad_u32_u24 v2, v14, s38, v2
    v_bfe_u32 v14, v0, 3, 1
    s_mov_b32 s38, 0x80
    v_mad_u32_u24 v2, v14, s38, v2
    v_bfe_u32 v14, v0, 4, 1
    s_mov_b32 s38, 0x100
    v_mad_u32_u24 v2, v14, s38, v2
    v_bfe_u32 v14, v0, 5, 1
    s_mov_b32 s38, 0x200
    v_mad_u32_u24 v2, v14, s38, v2
    v_bfe_u32 v14, v0, 6, 1
    s_mov_b32 s38, 0x800
    v_mad_u32_u24 v2, v14, s38, v2
    v_bfe_u32 v14, v0, 7, 1
    s_mov_b32 s38, 0x1000
    v_mad_u32_u24 v2, v14, s38, v2
    v_mov_b32 v9, 0x0
    v_bfe_u32 v14, v0, 0, 1
    s_mov_b32 s38, 0x10
    v_mad_u32_u24 v9, v14, s38, v9
    v_bfe_u32 v14, v0, 1, 1
    s_mov_b32 s38, 0x20
    v_mad_u32_u24 v9, v14, s38, v9
    v_bfe_u32 v14, v0, 2, 1
    s_mov_b32 s38, 0x40
    v_mad_u32_u24 v9, v14, s38, v9
    v_bfe_u32 v14, v0, 3, 1
    s_mov_b32 s38, 0x80
    v_mad_u32_u24 v9, v14, s38, v9
    v_bfe_u32 v14, v0, 4, 1
    s_mov_b32 s38, 0x100
    v_mad_u32_u24 v9, v14, s38, v9
    v_bfe_u32 v14, v0, 5, 1
    s_mov_b32 s38, 0x200
    v_mad_u32_u24 v9, v14, s38, v9
    v_bfe_u32 v14, v0, 6, 1
    s_mov_b32 s38, 0x400
    v_mad_u32_u24 v9, v14, s38, v9
    v_bfe_u32 v14, v0, 7, 1
    s_mov_b32 s38, 0x800
    v_mad_u32_u24 v9, v14, s38, v9
    v_mov_b32 v7, 0x8000
    v_bfe_u32 v14, v0, 0, 1
    s_mov_b32 s38, 0x10
    v_mad_u32_u24 v7, v14, s38, v7
    v_bfe_u32 v14, v0, 1, 1
    s_mov_b32 s38, 0x20
    v_mad_u32_u24 v7, v14, s38, v7
    v_bfe_u32 v14, v0, 2, 1
    s_mov_b32 s38, 0x40
    v_mad_u32_u24 v7, v14, s38, v7
    v_bfe_u32 v14, v0, 3, 1
    s_mov_b32 s38, 0x80
    v_mad_u32_u24 v7, v14, s38, v7
    v_bfe_u32 v14, v0, 4, 1
    s_mov_b32 s38, 0x100
    v_mad_u32_u24 v7, v14, s38, v7
    v_bfe_u32 v14, v0, 5, 1
    s_mov_b32 s38, 0x200
    v_mad_u32_u24 v7, v14, s38, v7
    v_bfe_u32 v14, v0, 6, 1
    s_mov_b32 s38, 0x8000
    v_mad_u32_u24 v7, v14, s38, v7
    v_bfe_u32 v14, v0, 7, 1
    s_mov_b32 s38, 0x10000
    v_mad_u32_u24 v7, v14, s38, v7
    v_mov_b32 v3, 0x0
    v_bfe_u32 v14, v0, 0, 1
    s_mov_b32 s38, 0x10
    v_mad_u32_u24 v3, v14, s38, v3
    v_bfe_u32 v14, v0, 1, 1
    s_mov_b32 s38, 0x20
    v_mad_u32_u24 v3, v14, s38, v3
    v_bfe_u32 v14, v0, 2, 1
    s_mov_b32 s38, 0x40
    v_mad_u32_u24 v3, v14, s38, v3
    v_bfe_u32 v14, v0, 3, 1
    s_mov_b32 s38, 0x400
    v_mad_u32_u24 v3, v14, s38, v3
    v_bfe_u32 v14, v0, 4, 1
    s_mov_b32 s38, 0x800
    v_mad_u32_u24 v3, v14, s38, v3
    v_bfe_u32 v14, v0, 5, 1
    s_mov_b32 s38, 0x1000
    v_mad_u32_u24 v3, v14, s38, v3
    v_bfe_u32 v14, v0, 6, 1
    s_mov_b32 s38, 0x2000
    v_mad_u32_u24 v3, v14, s38, v3
    v_bfe_u32 v14, v0, 7, 1
    s_mov_b32 s38, 0x4000
    v_mad_u32_u24 v3, v14, s38, v3
    v_mov_b32 v4, 0x0
    v_bfe_u32 v14, v0, 0, 1
    s_mov_b32 s38, 0x100
    v_mad_u32_u24 v4, v14, s38, v4
    v_bfe_u32 v14, v0, 1, 1
    s_mov_b32 s38, 0x200
    v_mad_u32_u24 v4, v14, s38, v4
    v_bfe_u32 v14, v0, 2, 1
    s_mov_b32 s38, 0x400
    v_mad_u32_u24 v4, v14, s38, v4
    v_bfe_u32 v14, v0, 6, 1
    s_mov_b32 s38, 0x80
    v_mad_u32_u24 v4, v14, s38, v4
    v_bfe_u32 v14, v0, 7, 1
    s_mov_b32 s38, 0x4000
    v_mad_u32_u24 v4, v14, s38, v4
    v_lshrrev_b32 v15, 3, v0
    v_xor_b32 v15, v15, v0
    v_and_b32 v15, 7, v15
    v_lshl_add_u32 v4, v15, 4, v4
    v_bfe_u32 v15, v0, 4, 2
    v_lshlrev_b32 v15, 4, v15
    v_xor_b32 v5, v15, v1
    v_xor_b32 v6, 64, v5
    v_mov_b32 v8, 0x5000
    v_bfe_u32 v14, v0, 0, 1
    s_mov_b32 s38, 0x10
    v_mad_u32_u24 v8, v14, s38, v8
    v_bfe_u32 v14, v0, 1, 1
    s_mov_b32 s38, 0x40
    v_mad_u32_u24 v8, v14, s38, v8
    v_bfe_u32 v14, v0, 2, 1
    s_mov_b32 s38, 0x80
    v_mad_u32_u24 v8, v14, s38, v8
    v_bfe_u32 v14, v0, 4, 1
    s_mov_b32 s38, 0x20
    v_mad_u32_u24 v8, v14, s38, v8
    v_bfe_u32 v14, v0, 5, 1
    s_mov_b32 s38, 0x100
    v_mad_u32_u24 v8, v14, s38, v8
    v_mov_b32 v10, 0x0
    v_bfe_u32 v14, v0, 0, 1
    s_mov_b32 s38, 0x10
    v_mad_u32_u24 v10, v14, s38, v10
    v_bfe_u32 v14, v0, 1, 1
    s_mov_b32 s38, 0x20
    v_mad_u32_u24 v10, v14, s38, v10
    v_bfe_u32 v14, v0, 2, 1
    s_mov_b32 s38, 0x40
    v_mad_u32_u24 v10, v14, s38, v10
    v_bfe_u32 v14, v0, 3, 1
    s_mov_b32 s38, 0x80
    v_mad_u32_u24 v10, v14, s38, v10
    v_bfe_u32 v14, v0, 4, 1
    s_mov_b32 s38, 0x20000
    v_mad_u32_u24 v10, v14, s38, v10
    v_bfe_u32 v14, v0, 5, 1
    s_mov_b32 s38, 0x40000
    v_mad_u32_u24 v10, v14, s38, v10
    v_bfe_u32 v14, v0, 6, 1
    s_mov_b32 s38, 0x100
    v_mad_u32_u24 v10, v14, s38, v10
    v_bfe_u32 v14, v0, 7, 1
    s_mov_b32 s38, 0x200
    v_mad_u32_u24 v10, v14, s38, v10
    v_mov_b32 v11, 0x0
    v_bfe_u32 v14, v0, 0, 1
    s_mov_b32 s38, 0x10
    v_mad_u32_u24 v11, v14, s38, v11
    v_bfe_u32 v14, v0, 1, 1
    s_mov_b32 s38, 0x20
    v_mad_u32_u24 v11, v14, s38, v11
    v_bfe_u32 v14, v0, 2, 1
    s_mov_b32 s38, 0x40
    v_mad_u32_u24 v11, v14, s38, v11
    v_bfe_u32 v14, v0, 3, 1
    s_mov_b32 s38, 0x80
    v_mad_u32_u24 v11, v14, s38, v11
    v_bfe_u32 v14, v0, 4, 1
    s_mov_b32 s38, 0x400
    v_mad_u32_u24 v11, v14, s38, v11
    v_bfe_u32 v14, v0, 5, 1
    s_mov_b32 s38, 0x800
    v_mad_u32_u24 v11, v14, s38, v11
    v_bfe_u32 v14, v0, 6, 1
    s_mov_b32 s38, 0x100
    v_mad_u32_u24 v11, v14, s38, v11
    v_bfe_u32 v14, v0, 7, 1
    s_mov_b32 s38, 0x200
    v_mad_u32_u24 v11, v14, s38, v11
    v_mov_b32 v12, 0x0
    v_bfe_u32 v14, v0, 0, 1
    s_mov_b32 s38, 0x10
    v_mad_u32_u24 v12, v14, s38, v12
    v_bfe_u32 v14, v0, 1, 1
    s_mov_b32 s38, 0x20
    v_mad_u32_u24 v12, v14, s38, v12
    v_bfe_u32 v14, v0, 2, 1
    s_mov_b32 s38, 0x40
    v_mad_u32_u24 v12, v14, s38, v12
    v_bfe_u32 v14, v0, 3, 1
    s_mov_b32 s38, 0x80
    v_mad_u32_u24 v12, v14, s38, v12
    v_bfe_u32 v14, v0, 4, 1
    s_mov_b32 s38, 0x4
    v_mad_u32_u24 v12, v14, s38, v12
    v_bfe_u32 v14, v0, 5, 1
    s_mov_b32 s38, 0x8
    v_mad_u32_u24 v12, v14, s38, v12
    v_bfe_u32 v14, v0, 6, 1
    s_mov_b32 s38, 0x100
    v_mad_u32_u24 v12, v14, s38, v12
    v_bfe_u32 v14, v0, 7, 1
    s_mov_b32 s38, 0x200
    v_mad_u32_u24 v12, v14, s38, v12
    v_mov_b32 v13, 0xf149f2ca
    v_and_b32 v14, 15, v0
    v_bfe_u32 v15, v0, 4, 2
    v_cmp_gt_u32 s[72:73], 2, v15
    v_lshlrev_b32 v15, 2, v15
    v_cmp_le_u32 s[64:65], v15, v14
    v_add_u32 v15, 1, v15
    v_cmp_le_u32 s[66:67], v15, v14
    v_add_u32 v15, 1, v15
    v_cmp_le_u32 s[68:69], v15, v14
    v_add_u32 v15, 1, v15
    v_cmp_le_u32 s[70:71], v15, v14
    v_add_u32 v15, 1, v15
    s_mov_b32 s34, 0x05040100
    s_mov_b32 s35, 0x07060302
    s_mov_b32 s33, 0x3e0293ee
    s_mov_b32 s32, 0
    s_mov_b32 s4, 0x3f803f80
    s_mov_b32 s5, 0x3f803f80
    s_and_b32 s3, s2, 7
    s_cmp_eq_u32 s3, 7
    s_cbranch_scc1 L_mlp
    s_mov_b32 s96, s54
    s_and_b32 s97, s55, 0xffff
    s_mov_b32 s98, 0x400000
    s_mov_b32 s99, 0x20000
    s_lshl_b32 s3, s20, 17
    s_and_b32 s28, s22, 3
    s_lshl_b32 s28, s28, 15
    s_add_u32 s3, s3, s28
    v_lshlrev_b32 v30, 7, v0
    buffer_load_dword v31, v30, s[96:99], s3 offen
    s_mov_b32 s76, s52
    s_and_b32 s77, s53, 0xffff
    s_mov_b32 s78, 0x400000
    s_mov_b32 s79, 0x20000
    s_mov_b32 s40, s50
    s_and_b32 s41, s51, 0xffff
    s_mov_b32 s42, 0x400000
    s_mov_b32 s43, 0x20000
    s_mov_b32 s96, s48
    s_and_b32 s97, s49, 0xffff
    s_mov_b32 s98, 0x400000
    s_mov_b32 s99, 0x20000
    v_mov_b32 v16, 0x0
    v_bfe_u32 v14, v0, 0, 1
    s_mov_b32 s38, 0x10
    v_mad_u32_u24 v16, v14, s38, v16
    v_bfe_u32 v14, v0, 1, 1
    s_mov_b32 s38, 0x20
    v_mad_u32_u24 v16, v14, s38, v16
    v_bfe_u32 v14, v0, 2, 1
    s_mov_b32 s38, 0x40
    v_mad_u32_u24 v16, v14, s38, v16
    v_bfe_u32 v14, v0, 3, 1
    s_mov_b32 s38, 0x80
    v_mad_u32_u24 v16, v14, s38, v16
    v_bfe_u32 v14, v0, 4, 1
    s_mov_b32 s38, 0x2000
    v_mad_u32_u24 v16, v14, s38, v16
    v_bfe_u32 v14, v0, 5, 1
    s_mov_b32 s38, 0x4000
    v_mad_u32_u24 v16, v14, s38, v16
    v_bfe_u32 v14, v0, 6, 1
    s_mov_b32 s38, 0x40000
    v_mad_u32_u24 v16, v14, s38, v16
    v_bfe_u32 v14, v0, 7, 1
    s_mov_b32 s38, 0x80000
    v_mad_u32_u24 v16, v14, s38, v16
    v_mov_b32 v28, 0x0
    v_bfe_u32 v14, v0, 4, 1
    s_mov_b32 s38, 0x20
    v_mad_u32_u24 v28, v14, s38, v28
    v_bfe_u32 v14, v0, 5, 1
    s_mov_b32 s38, 0x40
    v_mad_u32_u24 v28, v14, s38, v28
    v_xor_b32 v16, v16, v28
    v_xor_b32 v17, 0, v16
    v_xor_b32 v18, 128, v16
    v_xor_b32 v19, 128, v16
    v_mov_b32 v20, 0x0
    v_bfe_u32 v14, v0, 0, 1
    s_mov_b32 s38, 0x8
    v_mad_u32_u24 v20, v14, s38, v20
    v_bfe_u32 v14, v0, 1, 1
    s_mov_b32 s38, 0x10
    v_mad_u32_u24 v20, v14, s38, v20
    v_bfe_u32 v14, v0, 2, 1
    s_mov_b32 s38, 0x100
    v_mad_u32_u24 v20, v14, s38, v20
    v_bfe_u32 v14, v0, 3, 1
    s_mov_b32 s38, 0x200
    v_mad_u32_u24 v20, v14, s38, v20
    v_bfe_u32 v14, v0, 4, 1
    s_mov_b32 s38, 0x800
    v_mad_u32_u24 v20, v14, s38, v20
    v_bfe_u32 v14, v0, 5, 1
    s_mov_b32 s38, 0x1000
    v_mad_u32_u24 v20, v14, s38, v20
    v_mov_b32 v28, 0x0
    v_bfe_u32 v14, v0, 2, 1
    s_mov_b32 s38, 0x20
    v_mad_u32_u24 v28, v14, s38, v28
    v_bfe_u32 v14, v0, 3, 1
    s_mov_b32 s38, 0x40
    v_mad_u32_u24 v28, v14, s38, v28
    v_bfe_u32 v14, v0, 4, 1
    s_mov_b32 s38, 0x80
    v_mad_u32_u24 v28, v14, s38, v28
    v_mov_b32 v29, 0x0
    v_bfe_u32 v14, v0, 6, 1
    s_mov_b32 s38, 0x40
    v_mad_u32_u24 v29, v14, s38, v29
    v_bfe_u32 v14, v0, 7, 1
    s_mov_b32 s38, 0x80
    v_mad_u32_u24 v29, v14, s38, v29
    v_xor_b32 v28, v28, v29
    v_add_u32 v28, v28, v20
    v_add_u32 v20, 0x8000, v28
    v_xor_b32 v21, 32, v20
    v_add_u32 v22, 0x10000, v28
    v_xor_b32 v23, 32, v22
    v_add_u32 v24, 0x18000, v28
    v_xor_b32 v25, 32, v24
    v_add_u32 v26, 0x20000, v28
    v_xor_b32 v27, 32, v26
    s_add_u32 s28, s21, 1
    s_lshl_b32 s28, s28, 15
    s_lshl_b32 s3, s20, 8
    s_add_u32 m0, s28, 0
    s_add_u32 s37, s3, 0x0
    buffer_load_dwordx4 v16, s[76:79], s37 offen lds
    s_add_u32 m0, s28, 1024
    s_add_u32 s37, s3, 0x8000
    buffer_load_dwordx4 v17, s[76:79], s37 offen lds
    s_add_u32 m0, s28, 2048
    s_add_u32 s37, s3, 0x10000
    buffer_load_dwordx4 v18, s[76:79], s37 offen lds
    s_add_u32 m0, s28, 3072
    s_add_u32 s37, s3, 0x18000
    buffer_load_dwordx4 v19, s[76:79], s37 offen lds
    s_add_u32 m0, s28, 4096
    s_add_u32 s37, s3, 0x20000
    buffer_load_dwordx4 v16, s[76:79], s37 offen lds
    s_add_u32 m0, s28, 5120
    s_add_u32 s37, s3, 0x28000
    buffer_load_dwordx4 v17, s[76:79], s37 offen lds
    s_add_u32 m0, s28, 6144
    s_add_u32 s37, s3, 0x30000
    buffer_load_dwordx4 v18, s[76:79], s37 offen lds
    s_add_u32 m0, s28, 7168
    s_add_u32 s37, s3, 0x38000
    buffer_load_dwordx4 v19, s[76:79], s37 offen lds
    s_add_u32 m0, s28, 8192
    s_add_u32 s37, s3, 0x100000
    buffer_load_dwordx4 v16, s[76:79], s37 offen lds
    s_add_u32 m0, s28, 9216
    s_add_u32 s37, s3, 0x108000
    buffer_load_dwordx4 v17, s[76:79], s37 offen lds
    s_add_u32 m0, s28, 10240
    s_add_u32 s37, s3, 0x110000
    buffer_load_dwordx4 v18, s[76:79], s37 offen lds
    s_add_u32 m0, s28, 11264
    s_add_u32 s37, s3, 0x118000
    buffer_load_dwordx4 v19, s[76:79], s37 offen lds
    s_add_u32 m0, s28, 12288
    s_add_u32 s37, s3, 0x120000
    buffer_load_dwordx4 v16, s[76:79], s37 offen lds
    s_add_u32 m0, s28, 13312
    s_add_u32 s37, s3, 0x128000
    buffer_load_dwordx4 v17, s[76:79], s37 offen lds
    s_add_u32 m0, s28, 14336
    s_add_u32 s37, s3, 0x130000
    buffer_load_dwordx4 v18, s[76:79], s37 offen lds
    s_add_u32 m0, s28, 15360
    s_add_u32 s37, s3, 0x138000
    buffer_load_dwordx4 v19, s[76:79], s37 offen lds
    s_add_u32 m0, s28, 16384
    s_add_u32 s37, s3, 0x200000
    buffer_load_dwordx4 v16, s[76:79], s37 offen lds
    s_add_u32 m0, s28, 17408
    s_add_u32 s37, s3, 0x208000
    buffer_load_dwordx4 v17, s[76:79], s37 offen lds
    s_add_u32 m0, s28, 18432
    s_add_u32 s37, s3, 0x210000
    buffer_load_dwordx4 v18, s[76:79], s37 offen lds
    s_add_u32 m0, s28, 19456
    s_add_u32 s37, s3, 0x218000
    buffer_load_dwordx4 v19, s[76:79], s37 offen lds
    s_add_u32 m0, s28, 20480
    s_add_u32 s37, s3, 0x220000
    buffer_load_dwordx4 v16, s[76:79], s37 offen lds
    s_add_u32 m0, s28, 21504
    s_add_u32 s37, s3, 0x228000
    buffer_load_dwordx4 v17, s[76:79], s37 offen lds
    s_add_u32 m0, s28, 22528
    s_add_u32 s37, s3, 0x230000
    buffer_load_dwordx4 v18, s[76:79], s37 offen lds
    s_add_u32 m0, s28, 23552
    s_add_u32 s37, s3, 0x238000
    buffer_load_dwordx4 v19, s[76:79], s37 offen lds
    s_waitcnt vmcnt(16)
    s_barrier
    ds_read_b64_tr_b16 v[128:129], v20 offset:0
    ds_read_b64_tr_b16 v[130:131], v20 offset:1024
    ds_read_b64_tr_b16 v[132:133], v21 offset:0
    ds_read_b64_tr_b16 v[134:135], v21 offset:1024
    ds_read_b64_tr_b16 v[136:137], v22 offset:0
    ds_read_b64_tr_b16 v[138:139], v22 offset:1024
    ds_read_b64_tr_b16 v[140:141], v23 offset:0
    ds_read_b64_tr_b16 v[142:143], v23 offset:1024
    ds_read_b64_tr_b16 v[144:145], v24 offset:0
    ds_read_b64_tr_b16 v[146:147], v24 offset:1024
    ds_read_b64_tr_b16 v[148:149], v25 offset:0
    ds_read_b64_tr_b16 v[150:151], v25 offset:1024
    s_waitcnt lgkmcnt(4)
    ds_read_b64_tr_b16 v[152:153], v26 offset:0
    ds_read_b64_tr_b16 v[154:155], v26 offset:1024
    ds_read_b64_tr_b16 v[156:157], v27 offset:0
    ds_read_b64_tr_b16 v[158:159], v27 offset:1024
    s_waitcnt lgkmcnt(0)
    s_barrier
    s_add_u32 m0, s28, 0
    s_add_u32 s37, s3, 0x300000
    buffer_load_dwordx4 v16, s[76:79], s37 offen lds
    s_add_u32 m0, s28, 1024
    s_add_u32 s37, s3, 0x308000
    buffer_load_dwordx4 v17, s[76:79], s37 offen lds
    s_add_u32 m0, s28, 2048
    s_add_u32 s37, s3, 0x310000
    buffer_load_dwordx4 v18, s[76:79], s37 offen lds
    s_add_u32 m0, s28, 3072
    s_add_u32 s37, s3, 0x318000
    buffer_load_dwordx4 v19, s[76:79], s37 offen lds
    s_add_u32 m0, s28, 4096
    s_add_u32 s37, s3, 0x320000
    buffer_load_dwordx4 v16, s[76:79], s37 offen lds
    s_add_u32 m0, s28, 5120
    s_add_u32 s37, s3, 0x328000
    buffer_load_dwordx4 v17, s[76:79], s37 offen lds
    s_add_u32 m0, s28, 6144
    s_add_u32 s37, s3, 0x330000
    buffer_load_dwordx4 v18, s[76:79], s37 offen lds
    s_add_u32 m0, s28, 7168
    s_add_u32 s37, s3, 0x338000
    buffer_load_dwordx4 v19, s[76:79], s37 offen lds
    s_waitcnt vmcnt(16)
    s_barrier
    ds_read_b64_tr_b16 v[160:161], v20 offset:8192
    ds_read_b64_tr_b16 v[162:163], v20 offset:9216
    ds_read_b64_tr_b16 v[164:165], v21 offset:8192
    ds_read_b64_tr_b16 v[166:167], v21 offset:9216
    ds_read_b64_tr_b16 v[168:169], v22 offset:8192
    ds_read_b64_tr_b16 v[170:171], v22 offset:9216
    ds_read_b64_tr_b16 v[172:173], v23 offset:8192
    ds_read_b64_tr_b16 v[174:175], v23 offset:9216
    ds_read_b64_tr_b16 v[176:177], v24 offset:8192
    ds_read_b64_tr_b16 v[178:179], v24 offset:9216
    ds_read_b64_tr_b16 v[180:181], v25 offset:8192
    ds_read_b64_tr_b16 v[182:183], v25 offset:9216
    s_waitcnt lgkmcnt(4)
    ds_read_b64_tr_b16 v[184:185], v26 offset:8192
    ds_read_b64_tr_b16 v[186:187], v26 offset:9216
    ds_read_b64_tr_b16 v[188:189], v27 offset:8192
    ds_read_b64_tr_b16 v[190:191], v27 offset:9216
    s_waitcnt lgkmcnt(0)
    s_barrier
    s_add_u32 m0, s28, 8192
    s_add_u32 s37, s3, 0x0
    buffer_load_dwordx4 v16, s[40:43], s37 offen lds
    s_add_u32 m0, s28, 9216
    s_add_u32 s37, s3, 0x8000
    buffer_load_dwordx4 v17, s[40:43], s37 offen lds
    s_add_u32 m0, s28, 10240
    s_add_u32 s37, s3, 0x10000
    buffer_load_dwordx4 v18, s[40:43], s37 offen lds
    s_add_u32 m0, s28, 11264
    s_add_u32 s37, s3, 0x18000
    buffer_load_dwordx4 v19, s[40:43], s37 offen lds
    s_add_u32 m0, s28, 12288
    s_add_u32 s37, s3, 0x20000
    buffer_load_dwordx4 v16, s[40:43], s37 offen lds
    s_add_u32 m0, s28, 13312
    s_add_u32 s37, s3, 0x28000
    buffer_load_dwordx4 v17, s[40:43], s37 offen lds
    s_add_u32 m0, s28, 14336
    s_add_u32 s37, s3, 0x30000
    buffer_load_dwordx4 v18, s[40:43], s37 offen lds
    s_add_u32 m0, s28, 15360
    s_add_u32 s37, s3, 0x38000
    buffer_load_dwordx4 v19, s[40:43], s37 offen lds
    s_waitcnt vmcnt(16)
    s_barrier
    ds_read_b64_tr_b16 v[192:193], v20 offset:16384
    ds_read_b64_tr_b16 v[194:195], v20 offset:17408
    ds_read_b64_tr_b16 v[196:197], v21 offset:16384
    ds_read_b64_tr_b16 v[198:199], v21 offset:17408
    ds_read_b64_tr_b16 v[200:201], v22 offset:16384
    ds_read_b64_tr_b16 v[202:203], v22 offset:17408
    ds_read_b64_tr_b16 v[204:205], v23 offset:16384
    ds_read_b64_tr_b16 v[206:207], v23 offset:17408
    ds_read_b64_tr_b16 v[208:209], v24 offset:16384
    ds_read_b64_tr_b16 v[210:211], v24 offset:17408
    ds_read_b64_tr_b16 v[212:213], v25 offset:16384
    ds_read_b64_tr_b16 v[214:215], v25 offset:17408
    s_waitcnt lgkmcnt(4)
    ds_read_b64_tr_b16 v[216:217], v26 offset:16384
    ds_read_b64_tr_b16 v[218:219], v26 offset:17408
    ds_read_b64_tr_b16 v[220:221], v27 offset:16384
    ds_read_b64_tr_b16 v[222:223], v27 offset:17408
    s_waitcnt lgkmcnt(0)
    s_barrier
    s_add_u32 m0, s28, 16384
    s_add_u32 s37, s3, 0x100000
    buffer_load_dwordx4 v16, s[40:43], s37 offen lds
    s_add_u32 m0, s28, 17408
    s_add_u32 s37, s3, 0x108000
    buffer_load_dwordx4 v17, s[40:43], s37 offen lds
    s_add_u32 m0, s28, 18432
    s_add_u32 s37, s3, 0x110000
    buffer_load_dwordx4 v18, s[40:43], s37 offen lds
    s_add_u32 m0, s28, 19456
    s_add_u32 s37, s3, 0x118000
    buffer_load_dwordx4 v19, s[40:43], s37 offen lds
    s_add_u32 m0, s28, 20480
    s_add_u32 s37, s3, 0x120000
    buffer_load_dwordx4 v16, s[40:43], s37 offen lds
    s_add_u32 m0, s28, 21504
    s_add_u32 s37, s3, 0x128000
    buffer_load_dwordx4 v17, s[40:43], s37 offen lds
    s_add_u32 m0, s28, 22528
    s_add_u32 s37, s3, 0x130000
    buffer_load_dwordx4 v18, s[40:43], s37 offen lds
    s_add_u32 m0, s28, 23552
    s_add_u32 s37, s3, 0x138000
    buffer_load_dwordx4 v19, s[40:43], s37 offen lds
    s_waitcnt vmcnt(16)
    s_barrier
    ds_read_b64_tr_b16 v[224:225], v20 offset:0
    ds_read_b64_tr_b16 v[226:227], v20 offset:1024
    ds_read_b64_tr_b16 v[228:229], v21 offset:0
    ds_read_b64_tr_b16 v[230:231], v21 offset:1024
    ds_read_b64_tr_b16 v[232:233], v22 offset:0
    ds_read_b64_tr_b16 v[234:235], v22 offset:1024
    ds_read_b64_tr_b16 v[236:237], v23 offset:0
    ds_read_b64_tr_b16 v[238:239], v23 offset:1024
    ds_read_b64_tr_b16 v[240:241], v24 offset:0
    ds_read_b64_tr_b16 v[242:243], v24 offset:1024
    ds_read_b64_tr_b16 v[244:245], v25 offset:0
    ds_read_b64_tr_b16 v[246:247], v25 offset:1024
    s_waitcnt lgkmcnt(4)
    ds_read_b64_tr_b16 v[248:249], v26 offset:0
    ds_read_b64_tr_b16 v[250:251], v26 offset:1024
    ds_read_b64_tr_b16 v[252:253], v27 offset:0
    ds_read_b64_tr_b16 v[254:255], v27 offset:1024
    s_waitcnt lgkmcnt(0)
    s_barrier
    s_add_u32 m0, s28, 0
    s_add_u32 s37, s3, 0x200000
    buffer_load_dwordx4 v16, s[40:43], s37 offen lds
    s_add_u32 m0, s28, 1024
    s_add_u32 s37, s3, 0x208000
    buffer_load_dwordx4 v17, s[40:43], s37 offen lds
    s_add_u32 m0, s28, 2048
    s_add_u32 s37, s3, 0x210000
    buffer_load_dwordx4 v18, s[40:43], s37 offen lds
    s_add_u32 m0, s28, 3072
    s_add_u32 s37, s3, 0x218000
    buffer_load_dwordx4 v19, s[40:43], s37 offen lds
    s_add_u32 m0, s28, 4096
    s_add_u32 s37, s3, 0x220000
    buffer_load_dwordx4 v16, s[40:43], s37 offen lds
    s_add_u32 m0, s28, 5120
    s_add_u32 s37, s3, 0x228000
    buffer_load_dwordx4 v17, s[40:43], s37 offen lds
    s_add_u32 m0, s28, 6144
    s_add_u32 s37, s3, 0x230000
    buffer_load_dwordx4 v18, s[40:43], s37 offen lds
    s_add_u32 m0, s28, 7168
    s_add_u32 s37, s3, 0x238000
    buffer_load_dwordx4 v19, s[40:43], s37 offen lds
    s_waitcnt vmcnt(16)
    s_barrier
    ds_read_b64_tr_b16 a[128:129], v20 offset:8192
    ds_read_b64_tr_b16 a[130:131], v20 offset:9216
    ds_read_b64_tr_b16 a[132:133], v21 offset:8192
    ds_read_b64_tr_b16 a[134:135], v21 offset:9216
    ds_read_b64_tr_b16 a[136:137], v22 offset:8192
    ds_read_b64_tr_b16 a[138:139], v22 offset:9216
    ds_read_b64_tr_b16 a[140:141], v23 offset:8192
    ds_read_b64_tr_b16 a[142:143], v23 offset:9216
    ds_read_b64_tr_b16 a[144:145], v24 offset:8192
    ds_read_b64_tr_b16 a[146:147], v24 offset:9216
    ds_read_b64_tr_b16 a[148:149], v25 offset:8192
    ds_read_b64_tr_b16 a[150:151], v25 offset:9216
    s_waitcnt lgkmcnt(4)
    ds_read_b64_tr_b16 a[152:153], v26 offset:8192
    ds_read_b64_tr_b16 a[154:155], v26 offset:9216
    ds_read_b64_tr_b16 a[156:157], v27 offset:8192
    ds_read_b64_tr_b16 a[158:159], v27 offset:9216
    s_waitcnt lgkmcnt(0)
    s_barrier
    s_add_u32 m0, s28, 8192
    s_add_u32 s37, s3, 0x300000
    buffer_load_dwordx4 v16, s[40:43], s37 offen lds
    s_add_u32 m0, s28, 9216
    s_add_u32 s37, s3, 0x308000
    buffer_load_dwordx4 v17, s[40:43], s37 offen lds
    s_add_u32 m0, s28, 10240
    s_add_u32 s37, s3, 0x310000
    buffer_load_dwordx4 v18, s[40:43], s37 offen lds
    s_add_u32 m0, s28, 11264
    s_add_u32 s37, s3, 0x318000
    buffer_load_dwordx4 v19, s[40:43], s37 offen lds
    s_add_u32 m0, s28, 12288
    s_add_u32 s37, s3, 0x320000
    buffer_load_dwordx4 v16, s[40:43], s37 offen lds
    s_add_u32 m0, s28, 13312
    s_add_u32 s37, s3, 0x328000
    buffer_load_dwordx4 v17, s[40:43], s37 offen lds
    s_add_u32 m0, s28, 14336
    s_add_u32 s37, s3, 0x330000
    buffer_load_dwordx4 v18, s[40:43], s37 offen lds
    s_add_u32 m0, s28, 15360
    s_add_u32 s37, s3, 0x338000
    buffer_load_dwordx4 v19, s[40:43], s37 offen lds
    s_waitcnt vmcnt(16)
    s_barrier
    ds_read_b64_tr_b16 a[160:161], v20 offset:16384
    ds_read_b64_tr_b16 a[162:163], v20 offset:17408
    ds_read_b64_tr_b16 a[164:165], v21 offset:16384
    ds_read_b64_tr_b16 a[166:167], v21 offset:17408
    ds_read_b64_tr_b16 a[168:169], v22 offset:16384
    ds_read_b64_tr_b16 a[170:171], v22 offset:17408
    ds_read_b64_tr_b16 a[172:173], v23 offset:16384
    ds_read_b64_tr_b16 a[174:175], v23 offset:17408
    ds_read_b64_tr_b16 a[176:177], v24 offset:16384
    ds_read_b64_tr_b16 a[178:179], v24 offset:17408
    ds_read_b64_tr_b16 a[180:181], v25 offset:16384
    ds_read_b64_tr_b16 a[182:183], v25 offset:17408
    s_waitcnt lgkmcnt(4)
    ds_read_b64_tr_b16 a[184:185], v26 offset:16384
    ds_read_b64_tr_b16 a[186:187], v26 offset:17408
    ds_read_b64_tr_b16 a[188:189], v27 offset:16384
    ds_read_b64_tr_b16 a[190:191], v27 offset:17408
    s_waitcnt lgkmcnt(0)
    s_barrier
    s_add_u32 m0, s28, 16384
    s_add_u32 s37, s3, 0x0
    buffer_load_dwordx4 v16, s[96:99], s37 offen lds
    s_add_u32 m0, s28, 17408
    s_add_u32 s37, s3, 0x8000
    buffer_load_dwordx4 v17, s[96:99], s37 offen lds
    s_add_u32 m0, s28, 18432
    s_add_u32 s37, s3, 0x10000
    buffer_load_dwordx4 v18, s[96:99], s37 offen lds
    s_add_u32 m0, s28, 19456
    s_add_u32 s37, s3, 0x18000
    buffer_load_dwordx4 v19, s[96:99], s37 offen lds
    s_add_u32 m0, s28, 20480
    s_add_u32 s37, s3, 0x20000
    buffer_load_dwordx4 v16, s[96:99], s37 offen lds
    s_add_u32 m0, s28, 21504
    s_add_u32 s37, s3, 0x28000
    buffer_load_dwordx4 v17, s[96:99], s37 offen lds
    s_add_u32 m0, s28, 22528
    s_add_u32 s37, s3, 0x30000
    buffer_load_dwordx4 v18, s[96:99], s37 offen lds
    s_add_u32 m0, s28, 23552
    s_add_u32 s37, s3, 0x38000
    buffer_load_dwordx4 v19, s[96:99], s37 offen lds
    s_waitcnt vmcnt(16)
    s_barrier
    ds_read_b64_tr_b16 a[192:193], v20 offset:0
    ds_read_b64_tr_b16 a[194:195], v20 offset:1024
    ds_read_b64_tr_b16 a[196:197], v21 offset:0
    ds_read_b64_tr_b16 a[198:199], v21 offset:1024
    ds_read_b64_tr_b16 a[200:201], v22 offset:0
    ds_read_b64_tr_b16 a[202:203], v22 offset:1024
    ds_read_b64_tr_b16 a[204:205], v23 offset:0
    ds_read_b64_tr_b16 a[206:207], v23 offset:1024
    ds_read_b64_tr_b16 a[208:209], v24 offset:0
    ds_read_b64_tr_b16 a[210:211], v24 offset:1024
    ds_read_b64_tr_b16 a[212:213], v25 offset:0
    ds_read_b64_tr_b16 a[214:215], v25 offset:1024
    s_waitcnt lgkmcnt(4)
    ds_read_b64_tr_b16 a[216:217], v26 offset:0
    ds_read_b64_tr_b16 a[218:219], v26 offset:1024
    ds_read_b64_tr_b16 a[220:221], v27 offset:0
    ds_read_b64_tr_b16 a[222:223], v27 offset:1024
    s_waitcnt lgkmcnt(0)
    s_barrier
    s_add_u32 m0, s28, 0
    s_add_u32 s37, s3, 0x100000
    buffer_load_dwordx4 v16, s[96:99], s37 offen lds
    s_add_u32 m0, s28, 1024
    s_add_u32 s37, s3, 0x108000
    buffer_load_dwordx4 v17, s[96:99], s37 offen lds
    s_add_u32 m0, s28, 2048
    s_add_u32 s37, s3, 0x110000
    buffer_load_dwordx4 v18, s[96:99], s37 offen lds
    s_add_u32 m0, s28, 3072
    s_add_u32 s37, s3, 0x118000
    buffer_load_dwordx4 v19, s[96:99], s37 offen lds
    s_add_u32 m0, s28, 4096
    s_add_u32 s37, s3, 0x120000
    buffer_load_dwordx4 v16, s[96:99], s37 offen lds
    s_add_u32 m0, s28, 5120
    s_add_u32 s37, s3, 0x128000
    buffer_load_dwordx4 v17, s[96:99], s37 offen lds
    s_add_u32 m0, s28, 6144
    s_add_u32 s37, s3, 0x130000
    buffer_load_dwordx4 v18, s[96:99], s37 offen lds
    s_add_u32 m0, s28, 7168
    s_add_u32 s37, s3, 0x138000
    buffer_load_dwordx4 v19, s[96:99], s37 offen lds
    s_waitcnt vmcnt(16)
    s_barrier
    ds_read_b64_tr_b16 a[224:225], v20 offset:8192
    ds_read_b64_tr_b16 a[226:227], v20 offset:9216
    ds_read_b64_tr_b16 a[228:229], v21 offset:8192
    ds_read_b64_tr_b16 a[230:231], v21 offset:9216
    ds_read_b64_tr_b16 a[232:233], v22 offset:8192
    ds_read_b64_tr_b16 a[234:235], v22 offset:9216
    ds_read_b64_tr_b16 a[236:237], v23 offset:8192
    ds_read_b64_tr_b16 a[238:239], v23 offset:9216
    ds_read_b64_tr_b16 a[240:241], v24 offset:8192
    ds_read_b64_tr_b16 a[242:243], v24 offset:9216
    ds_read_b64_tr_b16 a[244:245], v25 offset:8192
    ds_read_b64_tr_b16 a[246:247], v25 offset:9216
    s_waitcnt lgkmcnt(4)
    ds_read_b64_tr_b16 a[248:249], v26 offset:8192
    ds_read_b64_tr_b16 a[250:251], v26 offset:9216
    ds_read_b64_tr_b16 a[252:253], v27 offset:8192
    ds_read_b64_tr_b16 a[254:255], v27 offset:9216
    s_waitcnt lgkmcnt(0)
    s_barrier
    s_add_u32 m0, s28, 8192
    s_add_u32 s37, s3, 0x200000
    buffer_load_dwordx4 v16, s[96:99], s37 offen lds
    s_add_u32 m0, s28, 9216
    s_add_u32 s37, s3, 0x208000
    buffer_load_dwordx4 v17, s[96:99], s37 offen lds
    s_add_u32 m0, s28, 10240
    s_add_u32 s37, s3, 0x210000
    buffer_load_dwordx4 v18, s[96:99], s37 offen lds
    s_add_u32 m0, s28, 11264
    s_add_u32 s37, s3, 0x218000
    buffer_load_dwordx4 v19, s[96:99], s37 offen lds
    s_add_u32 m0, s28, 12288
    s_add_u32 s37, s3, 0x220000
    buffer_load_dwordx4 v16, s[96:99], s37 offen lds
    s_add_u32 m0, s28, 13312
    s_add_u32 s37, s3, 0x228000
    buffer_load_dwordx4 v17, s[96:99], s37 offen lds
    s_add_u32 m0, s28, 14336
    s_add_u32 s37, s3, 0x230000
    buffer_load_dwordx4 v18, s[96:99], s37 offen lds
    s_add_u32 m0, s28, 15360
    s_add_u32 s37, s3, 0x238000
    buffer_load_dwordx4 v19, s[96:99], s37 offen lds
    s_waitcnt vmcnt(16)
    s_barrier
    ds_read_b64_tr_b16 a[0:1], v20 offset:16384
    ds_read_b64_tr_b16 a[2:3], v20 offset:17408
    ds_read_b64_tr_b16 a[4:5], v21 offset:16384
    ds_read_b64_tr_b16 a[6:7], v21 offset:17408
    ds_read_b64_tr_b16 a[8:9], v22 offset:16384
    ds_read_b64_tr_b16 a[10:11], v22 offset:17408
    ds_read_b64_tr_b16 a[12:13], v23 offset:16384
    ds_read_b64_tr_b16 a[14:15], v23 offset:17408
    ds_read_b64_tr_b16 a[16:17], v24 offset:16384
    ds_read_b64_tr_b16 a[18:19], v24 offset:17408
    ds_read_b64_tr_b16 a[20:21], v25 offset:16384
    ds_read_b64_tr_b16 a[22:23], v25 offset:17408
    s_waitcnt lgkmcnt(4)
    ds_read_b64_tr_b16 a[24:25], v26 offset:16384
    ds_read_b64_tr_b16 a[26:27], v26 offset:17408
    ds_read_b64_tr_b16 a[28:29], v27 offset:16384
    ds_read_b64_tr_b16 a[30:31], v27 offset:17408
    s_waitcnt lgkmcnt(0)
    s_barrier
    s_add_u32 m0, s28, 16384
    s_add_u32 s37, s3, 0x300000
    buffer_load_dwordx4 v16, s[96:99], s37 offen lds
    s_add_u32 m0, s28, 17408
    s_add_u32 s37, s3, 0x308000
    buffer_load_dwordx4 v17, s[96:99], s37 offen lds
    s_add_u32 m0, s28, 18432
    s_add_u32 s37, s3, 0x310000
    buffer_load_dwordx4 v18, s[96:99], s37 offen lds
    s_add_u32 m0, s28, 19456
    s_add_u32 s37, s3, 0x318000
    buffer_load_dwordx4 v19, s[96:99], s37 offen lds
    s_add_u32 m0, s28, 20480
    s_add_u32 s37, s3, 0x320000
    buffer_load_dwordx4 v16, s[96:99], s37 offen lds
    s_add_u32 m0, s28, 21504
    s_add_u32 s37, s3, 0x328000
    buffer_load_dwordx4 v17, s[96:99], s37 offen lds
    s_add_u32 m0, s28, 22528
    s_add_u32 s37, s3, 0x330000
    buffer_load_dwordx4 v18, s[96:99], s37 offen lds
    s_add_u32 m0, s28, 23552
    s_add_u32 s37, s3, 0x338000
    buffer_load_dwordx4 v19, s[96:99], s37 offen lds
    s_waitcnt vmcnt(16)
    s_barrier
    ds_read_b64_tr_b16 a[32:33], v20 offset:0
    ds_read_b64_tr_b16 a[34:35], v20 offset:1024
    ds_read_b64_tr_b16 a[36:37], v21 offset:0
    ds_read_b64_tr_b16 a[38:39], v21 offset:1024
    ds_read_b64_tr_b16 a[40:41], v22 offset:0
    ds_read_b64_tr_b16 a[42:43], v22 offset:1024
    ds_read_b64_tr_b16 a[44:45], v23 offset:0
    ds_read_b64_tr_b16 a[46:47], v23 offset:1024
    ds_read_b64_tr_b16 a[48:49], v24 offset:0
    ds_read_b64_tr_b16 a[50:51], v24 offset:1024
    ds_read_b64_tr_b16 a[52:53], v25 offset:0
    ds_read_b64_tr_b16 a[54:55], v25 offset:1024
    s_waitcnt lgkmcnt(4)
    ds_read_b64_tr_b16 a[56:57], v26 offset:0
    ds_read_b64_tr_b16 a[58:59], v26 offset:1024
    ds_read_b64_tr_b16 a[60:61], v27 offset:0
    ds_read_b64_tr_b16 a[62:63], v27 offset:1024
    s_waitcnt lgkmcnt(0)
    s_barrier
    s_waitcnt vmcnt(8)
    s_barrier
    ds_read_b64_tr_b16 a[64:65], v20 offset:8192
    ds_read_b64_tr_b16 a[66:67], v20 offset:9216
    ds_read_b64_tr_b16 a[68:69], v21 offset:8192
    ds_read_b64_tr_b16 a[70:71], v21 offset:9216
    ds_read_b64_tr_b16 a[72:73], v22 offset:8192
    ds_read_b64_tr_b16 a[74:75], v22 offset:9216
    ds_read_b64_tr_b16 a[76:77], v23 offset:8192
    ds_read_b64_tr_b16 a[78:79], v23 offset:9216
    ds_read_b64_tr_b16 a[80:81], v24 offset:8192
    ds_read_b64_tr_b16 a[82:83], v24 offset:9216
    ds_read_b64_tr_b16 a[84:85], v25 offset:8192
    ds_read_b64_tr_b16 a[86:87], v25 offset:9216
    s_waitcnt lgkmcnt(4)
    ds_read_b64_tr_b16 a[88:89], v26 offset:8192
    ds_read_b64_tr_b16 a[90:91], v26 offset:9216
    ds_read_b64_tr_b16 a[92:93], v27 offset:8192
    ds_read_b64_tr_b16 a[94:95], v27 offset:9216
    s_waitcnt lgkmcnt(0)
    s_barrier
    s_waitcnt vmcnt(0)
    s_barrier
    ds_read_b64_tr_b16 a[96:97], v20 offset:16384
    ds_read_b64_tr_b16 a[98:99], v20 offset:17408
    ds_read_b64_tr_b16 a[100:101], v21 offset:16384
    ds_read_b64_tr_b16 a[102:103], v21 offset:17408
    ds_read_b64_tr_b16 a[104:105], v22 offset:16384
    ds_read_b64_tr_b16 a[106:107], v22 offset:17408
    ds_read_b64_tr_b16 a[108:109], v23 offset:16384
    ds_read_b64_tr_b16 a[110:111], v23 offset:17408
    ds_read_b64_tr_b16 a[112:113], v24 offset:16384
    ds_read_b64_tr_b16 a[114:115], v24 offset:17408
    ds_read_b64_tr_b16 a[116:117], v25 offset:16384
    ds_read_b64_tr_b16 a[118:119], v25 offset:17408
    s_waitcnt lgkmcnt(4)
    ds_read_b64_tr_b16 a[120:121], v26 offset:16384
    ds_read_b64_tr_b16 a[122:123], v26 offset:17408
    ds_read_b64_tr_b16 a[124:125], v27 offset:16384
    ds_read_b64_tr_b16 a[126:127], v27 offset:17408
    s_waitcnt lgkmcnt(0)
    s_barrier
    v_lshrrev_b32 v15, 2, v1
    v_and_b32 v15, 127, v15
L_WHS:
    buffer_load_dword v14, v15, s[16:19], 0 offen offset:128 sc1
    s_add_u32 s32, s32, 1
    s_cmp_gt_u32 s32, 200000
    s_cbranch_scc1 L_WHS_done
    s_waitcnt vmcnt(0)
    v_cmp_eq_u32 vcc, 0, v14
    s_cbranch_vccnz L_WHS
L_WHS_done:
    v_lshrrev_b32 v15, 2, v1
    s_mov_b32 s24, 0x192400
L_XNW:
    buffer_load_dword v14, v15, s[8:11], s24 offen sc1
    s_add_u32 s32, s32, 1
    s_cmp_gt_u32 s32, 200000
    s_waitcnt vmcnt(0)
    s_cbranch_scc1 L_XNW_ok
    v_cmp_eq_u32 vcc, 0, v14
    s_cbranch_vccnz L_XNW
L_XNW_ok:
    s_lshr_b32 s36, s21, 1
    s_lshl_b32 s36, s36, 14
    s_xor_b32 s37, s36, 16384
    v_add_u32 v80, s36, v5
    v_add_u32 v81, s37, v5
    v_add_u32 v82, s36, v6
    v_add_u32 v83, s37, v6
    s_mov_b32 s25, 0x40000000
    s_mov_b32 s28, 0
    s_mov_b32 s23, s22
    s_lshl_b32 s36, s23, 15
    s_add_u32 s36, s36, 0x800000
    s_lshl_b32 s37, s21, 10
    s_add_u32 s37, s37, s28
    s_add_u32 m0, s37, 0
    s_add_u32 s38, s36, 0
    buffer_load_dwordx4 v9, s[8:11], s38 offen sc1 lds
    s_add_u32 m0, s37, 4096
    s_add_u32 s38, s36, 4096
    buffer_load_dwordx4 v9, s[8:11], s38 offen sc1 lds
    s_add_u32 m0, s37, 8192
    s_add_u32 s38, s36, 8192
    buffer_load_dwordx4 v9, s[8:11], s38 offen sc1 lds
    s_add_u32 m0, s37, 12288
    s_add_u32 s38, s36, 12288
    buffer_load_dwordx4 v9, s[8:11], s38 offen sc1 lds
    s_add_u32 m0, s37, 16384
    s_add_u32 s38, s36, 16384
    buffer_load_dwordx4 v9, s[8:11], s38 offen sc1 lds
    s_add_u32 m0, s37, 20480
    s_add_u32 s38, s36, 20480
    buffer_load_dwordx4 v9, s[8:11], s38 offen sc1 lds
    s_add_u32 m0, s37, 24576
    s_add_u32 s38, s36, 24576
    buffer_load_dwordx4 v9, s[8:11], s38 offen sc1 lds
    s_add_u32 m0, s37, 28672
    s_add_u32 s38, s36, 28672
    buffer_load_dwordx4 v9, s[8:11], s38 offen sc1 lds
    s_waitcnt vmcnt(0)
L_P1:
    s_waitcnt vmcnt(6)
    s_barrier
    s_xor_b32 s28, s28, 32768
    s_add_u32 s24, s23, 6
    s_min_u32 s24, s24, 63
    s_lshl_b32 s36, s24, 15
    s_add_u32 s36, s36, 0x800000
    s_lshl_b32 s37, s21, 10
    s_add_u32 s37, s37, s28
    s_add_u32 m0, s37, 0
    s_add_u32 s38, s36, 0
    buffer_load_dwordx4 v9, s[8:11], s38 offen sc1 lds
    s_add_u32 m0, s37, 4096
    s_add_u32 s38, s36, 4096
    buffer_load_dwordx4 v9, s[8:11], s38 offen sc1 lds
    s_add_u32 m0, s37, 8192
    s_add_u32 s38, s36, 8192
    buffer_load_dwordx4 v9, s[8:11], s38 offen sc1 lds
    s_add_u32 m0, s37, 12288
    s_add_u32 s38, s36, 12288
    buffer_load_dwordx4 v9, s[8:11], s38 offen sc1 lds
    s_add_u32 m0, s37, 16384
    s_add_u32 s38, s36, 16384
    buffer_load_dwordx4 v9, s[8:11], s38 offen sc1 lds
    s_add_u32 m0, s37, 20480
    s_add_u32 s38, s36, 20480
    buffer_load_dwordx4 v9, s[8:11], s38 offen sc1 lds
    s_add_u32 m0, s37, 24576
    s_add_u32 s38, s36, 24576
    buffer_load_dwordx4 v9, s[8:11], s38 offen sc1 lds
    s_add_u32 m0, s37, 28672
    s_add_u32 s38, s36, 28672
    buffer_load_dwordx4 v9, s[8:11], s38 offen sc1 lds
    ds_read_b128 v[64:67], v80 offset:0
    ds_read_b128 v[68:71], v81 offset:0
    ds_read_b128 v[72:75], v82 offset:1024
    ds_read_b128 v[76:79], v83 offset:1024
    s_waitcnt lgkmcnt(2)
    v_mfma_f32_16x16x32_bf16 v[32:35], a[128:131], v[64:67], 0
    v_mfma_f32_16x16x32_bf16 v[36:39], a[128:131], v[68:71], 0
    v_mfma_f32_16x16x32_bf16 v[40:43], a[132:135], v[64:67], 0
    v_mfma_f32_16x16x32_bf16 v[44:47], a[132:135], v[68:71], 0
    v_mfma_f32_16x16x32_bf16 v[48:51], v[64:67], v[128:131], 0
    v_mfma_f32_16x16x32_bf16 v[56:59], v[68:71], v[128:131], 0
    v_mfma_f32_16x16x32_bf16 v[52:55], v[64:67], v[132:135], 0
    v_mfma_f32_16x16x32_bf16 v[60:63], v[68:71], v[132:135], 0
    v_mfma_f32_16x16x32_bf16 v[16:19], a[0:3], v[64:67], 0
    v_mfma_f32_16x16x32_bf16 v[20:23], a[0:3], v[68:71], 0
    v_mfma_f32_16x16x32_bf16 v[24:27], a[4:7], v[64:67], 0
    v_mfma_f32_16x16x32_bf16 v[28:31], a[4:7], v[68:71], 0
    ds_read_b128 v[64:67], v80 offset:2048
    ds_read_b128 v[68:71], v81 offset:2048
    s_waitcnt lgkmcnt(2)
    v_mfma_f32_16x16x32_bf16 v[32:35], a[136:139], v[72:75], v[32:35]
    v_mfma_f32_16x16x32_bf16 v[36:39], a[136:139], v[76:79], v[36:39]
    v_mfma_f32_16x16x32_bf16 v[40:43], a[140:143], v[72:75], v[40:43]
    v_mfma_f32_16x16x32_bf16 v[44:47], a[140:143], v[76:79], v[44:47]
    v_mfma_f32_16x16x32_bf16 v[48:51], v[72:75], v[136:139], v[48:51]
    v_mfma_f32_16x16x32_bf16 v[56:59], v[76:79], v[136:139], v[56:59]
    v_mfma_f32_16x16x32_bf16 v[52:55], v[72:75], v[140:143], v[52:55]
    v_mfma_f32_16x16x32_bf16 v[60:63], v[76:79], v[140:143], v[60:63]
    v_mfma_f32_16x16x32_bf16 v[16:19], a[8:11], v[72:75], v[16:19]
    v_mfma_f32_16x16x32_bf16 v[20:23], a[8:11], v[76:79], v[20:23]
    v_mfma_f32_16x16x32_bf16 v[24:27], a[12:15], v[72:75], v[24:27]
    v_mfma_f32_16x16x32_bf16 v[28:31], a[12:15], v[76:79], v[28:31]
    ds_read_b128 v[72:75], v82 offset:3072
    ds_read_b128 v[76:79], v83 offset:3072
    s_waitcnt lgkmcnt(2)
    v_mfma_f32_16x16x32_bf16 v[32:35], a[144:147], v[64:67], v[32:35]
    v_mfma_f32_16x16x32_bf16 v[36:39], a[144:147], v[68:71], v[36:39]
    v_mfma_f32_16x16x32_bf16 v[40:43], a[148:151], v[64:67], v[40:43]
    v_mfma_f32_16x16x32_bf16 v[44:47], a[148:151], v[68:71], v[44:47]
    v_mfma_f32_16x16x32_bf16 v[48:51], v[64:67], v[144:147], v[48:51]
    v_mfma_f32_16x16x32_bf16 v[56:59], v[68:71], v[144:147], v[56:59]
    v_mfma_f32_16x16x32_bf16 v[52:55], v[64:67], v[148:151], v[52:55]
    v_mfma_f32_16x16x32_bf16 v[60:63], v[68:71], v[148:151], v[60:63]
    v_mfma_f32_16x16x32_bf16 v[16:19], a[16:19], v[64:67], v[16:19]
    v_mfma_f32_16x16x32_bf16 v[20:23], a[16:19], v[68:71], v[20:23]
    v_mfma_f32_16x16x32_bf16 v[24:27], a[20:23], v[64:67], v[24:27]
    v_mfma_f32_16x16x32_bf16 v[28:31], a[20:23], v[68:71], v[28:31]
    ds_read_b128 v[64:67], v80 offset:4096
    ds_read_b128 v[68:71], v81 offset:4096
    s_waitcnt lgkmcnt(2)
    v_mfma_f32_16x16x32_bf16 v[32:35], a[152:155], v[72:75], v[32:35]
    v_mfma_f32_16x16x32_bf16 v[36:39], a[152:155], v[76:79], v[36:39]
    v_mfma_f32_16x16x32_bf16 v[40:43], a[156:159], v[72:75], v[40:43]
    v_mfma_f32_16x16x32_bf16 v[44:47], a[156:159], v[76:79], v[44:47]
    v_mfma_f32_16x16x32_bf16 v[48:51], v[72:75], v[152:155], v[48:51]
    v_mfma_f32_16x16x32_bf16 v[56:59], v[76:79], v[152:155], v[56:59]
    v_mfma_f32_16x16x32_bf16 v[52:55], v[72:75], v[156:159], v[52:55]
    v_mfma_f32_16x16x32_bf16 v[60:63], v[76:79], v[156:159], v[60:63]
    v_mfma_f32_16x16x32_bf16 v[16:19], a[24:27], v[72:75], v[16:19]
    v_mfma_f32_16x16x32_bf16 v[20:23], a[24:27], v[76:79], v[20:23]
    v_mfma_f32_16x16x32_bf16 v[24:27], a[28:31], v[72:75], v[24:27]
    v_mfma_f32_16x16x32_bf16 v[28:31], a[28:31], v[76:79], v[28:31]
    ds_read_b128 v[72:75], v82 offset:5120
    ds_read_b128 v[76:79], v83 offset:5120
    s_waitcnt lgkmcnt(2)
    v_mfma_f32_16x16x32_bf16 v[32:35], a[160:163], v[64:67], v[32:35]
    v_mfma_f32_16x16x32_bf16 v[36:39], a[160:163], v[68:71], v[36:39]
    v_mfma_f32_16x16x32_bf16 v[40:43], a[164:167], v[64:67], v[40:43]
    v_mfma_f32_16x16x32_bf16 v[44:47], a[164:167], v[68:71], v[44:47]
    v_mfma_f32_16x16x32_bf16 v[48:51], v[64:67], v[160:163], v[48:51]
    v_mfma_f32_16x16x32_bf16 v[56:59], v[68:71], v[160:163], v[56:59]
    v_mfma_f32_16x16x32_bf16 v[52:55], v[64:67], v[164:167], v[52:55]
    v_mfma_f32_16x16x32_bf16 v[60:63], v[68:71], v[164:167], v[60:63]
    v_mfma_f32_16x16x32_bf16 v[16:19], a[32:35], v[64:67], v[16:19]
    v_mfma_f32_16x16x32_bf16 v[20:23], a[32:35], v[68:71], v[20:23]
    v_mfma_f32_16x16x32_bf16 v[24:27], a[36:39], v[64:67], v[24:27]
    v_mfma_f32_16x16x32_bf16 v[28:31], a[36:39], v[68:71], v[28:31]
    ds_read_b128 v[64:67], v80 offset:6144
    ds_read_b128 v[68:71], v81 offset:6144
    s_waitcnt lgkmcnt(2)
    v_mfma_f32_16x16x32_bf16 v[32:35], a[168:171], v[72:75], v[32:35]
    v_mfma_f32_16x16x32_bf16 v[36:39], a[168:171], v[76:79], v[36:39]
    v_mfma_f32_16x16x32_bf16 v[40:43], a[172:175], v[72:75], v[40:43]
    v_mfma_f32_16x16x32_bf16 v[44:47], a[172:175], v[76:79], v[44:47]
    v_mfma_f32_16x16x32_bf16 v[48:51], v[72:75], v[168:171], v[48:51]
    v_mfma_f32_16x16x32_bf16 v[56:59], v[76:79], v[168:171], v[56:59]
    v_mfma_f32_16x16x32_bf16 v[52:55], v[72:75], v[172:175], v[52:55]
    v_mfma_f32_16x16x32_bf16 v[60:63], v[76:79], v[172:175], v[60:63]
    v_mfma_f32_16x16x32_bf16 v[16:19], a[40:43], v[72:75], v[16:19]
    v_mfma_f32_16x16x32_bf16 v[20:23], a[40:43], v[76:79], v[20:23]
    v_mfma_f32_16x16x32_bf16 v[24:27], a[44:47], v[72:75], v[24:27]
    v_mfma_f32_16x16x32_bf16 v[28:31], a[44:47], v[76:79], v[28:31]
    ds_read_b128 v[72:75], v82 offset:7168
    ds_read_b128 v[76:79], v83 offset:7168
    s_waitcnt lgkmcnt(2)
    v_mfma_f32_16x16x32_bf16 v[32:35], a[176:179], v[64:67], v[32:35]
    v_mfma_f32_16x16x32_bf16 v[36:39], a[176:179], v[68:71], v[36:39]
    v_mfma_f32_16x16x32_bf16 v[40:43], a[180:183], v[64:67], v[40:43]
    v_mfma_f32_16x16x32_bf16 v[44:47], a[180:183], v[68:71], v[44:47]
    v_mfma_f32_16x16x32_bf16 v[48:51], v[64:67], v[176:179], v[48:51]
    v_mfma_f32_16x16x32_bf16 v[56:59], v[68:71], v[176:179], v[56:59]
    v_mfma_f32_16x16x32_bf16 v[52:55], v[64:67], v[180:183], v[52:55]
    v_mfma_f32_16x16x32_bf16 v[60:63], v[68:71], v[180:183], v[60:63]
    v_mfma_f32_16x16x32_bf16 v[16:19], a[48:51], v[64:67], v[16:19]
    v_mfma_f32_16x16x32_bf16 v[20:23], a[48:51], v[68:71], v[20:23]
    v_mfma_f32_16x16x32_bf16 v[24:27], a[52:55], v[64:67], v[24:27]
    v_mfma_f32_16x16x32_bf16 v[28:31], a[52:55], v[68:71], v[28:31]
    ds_read_b128 v[64:67], v80 offset:8192
    ds_read_b128 v[68:71], v81 offset:8192
    s_waitcnt lgkmcnt(2)
    v_mfma_f32_16x16x32_bf16 v[32:35], a[184:187], v[72:75], v[32:35]
    v_mfma_f32_16x16x32_bf16 v[36:39], a[184:187], v[76:79], v[36:39]
    v_mfma_f32_16x16x32_bf16 v[40:43], a[188:191], v[72:75], v[40:43]
    v_mfma_f32_16x16x32_bf16 v[44:47], a[188:191], v[76:79], v[44:47]
    v_mfma_f32_16x16x32_bf16 v[48:51], v[72:75], v[184:187], v[48:51]
    v_mfma_f32_16x16x32_bf16 v[56:59], v[76:79], v[184:187], v[56:59]
    v_mfma_f32_16x16x32_bf16 v[52:55], v[72:75], v[188:191], v[52:55]
    v_mfma_f32_16x16x32_bf16 v[60:63], v[76:79], v[188:191], v[60:63]
    v_mfma_f32_16x16x32_bf16 v[16:19], a[56:59], v[72:75], v[16:19]
    v_mfma_f32_16x16x32_bf16 v[20:23], a[56:59], v[76:79], v[20:23]
    v_mfma_f32_16x16x32_bf16 v[24:27], a[60:63], v[72:75], v[24:27]
    v_mfma_f32_16x16x32_bf16 v[28:31], a[60:63], v[76:79], v[28:31]
    ds_read_b128 v[72:75], v82 offset:9216
    ds_read_b128 v[76:79], v83 offset:9216
    s_waitcnt lgkmcnt(2)
    s_waitcnt vmcnt(8)
    s_barrier
    v_cmp_ne_u32 vcc, 0, v0
    v_mov_b32 v15, 0x40000000
    v_mov_b32 v14, 1
    v_cndmask_b32 v15, v0, v15, vcc
    buffer_store_dword v14, v15, s[8:11], s25 offen sc1
    v_mfma_f32_16x16x32_bf16 v[32:35], a[192:195], v[64:67], v[32:35]
    v_mfma_f32_16x16x32_bf16 v[36:39], a[192:195], v[68:71], v[36:39]
    v_mfma_f32_16x16x32_bf16 v[40:43], a[196:199], v[64:67], v[40:43]
    v_mfma_f32_16x16x32_bf16 v[44:47], a[196:199], v[68:71], v[44:47]
    v_mfma_f32_16x16x32_bf16 v[48:51], v[64:67], v[192:195], v[48:51]
    v_mfma_f32_16x16x32_bf16 v[56:59], v[68:71], v[192:195], v[56:59]
    v_mfma_f32_16x16x32_bf16 v[52:55], v[64:67], v[196:199], v[52:55]
    v_mfma_f32_16x16x32_bf16 v[60:63], v[68:71], v[196:199], v[60:63]
    v_mfma_f32_16x16x32_bf16 v[16:19], a[64:67], v[64:67], v[16:19]
    v_mfma_f32_16x16x32_bf16 v[20:23], a[64:67], v[68:71], v[20:23]
    v_mfma_f32_16x16x32_bf16 v[24:27], a[68:71], v[64:67], v[24:27]
    v_mfma_f32_16x16x32_bf16 v[28:31], a[68:71], v[68:71], v[28:31]
    ds_read_b128 v[64:67], v80 offset:10240
    ds_read_b128 v[68:71], v81 offset:10240
    s_waitcnt lgkmcnt(2)
    v_mfma_f32_16x16x32_bf16 v[32:35], a[200:203], v[72:75], v[32:35]
    v_mfma_f32_16x16x32_bf16 v[36:39], a[200:203], v[76:79], v[36:39]
    v_mfma_f32_16x16x32_bf16 v[40:43], a[204:207], v[72:75], v[40:43]
    v_mfma_f32_16x16x32_bf16 v[44:47], a[204:207], v[76:79], v[44:47]
    v_mfma_f32_16x16x32_bf16 v[48:51], v[72:75], v[200:203], v[48:51]
    v_mfma_f32_16x16x32_bf16 v[56:59], v[76:79], v[200:203], v[56:59]
    v_mfma_f32_16x16x32_bf16 v[52:55], v[72:75], v[204:207], v[52:55]
    v_mfma_f32_16x16x32_bf16 v[60:63], v[76:79], v[204:207], v[60:63]
    v_mfma_f32_16x16x32_bf16 v[16:19], a[72:75], v[72:75], v[16:19]
    v_mfma_f32_16x16x32_bf16 v[20:23], a[72:75], v[76:79], v[20:23]
    v_mfma_f32_16x16x32_bf16 v[24:27], a[76:79], v[72:75], v[24:27]
    v_mfma_f32_16x16x32_bf16 v[28:31], a[76:79], v[76:79], v[28:31]
    ds_read_b128 v[72:75], v82 offset:11264
    ds_read_b128 v[76:79], v83 offset:11264
    s_waitcnt lgkmcnt(2)
    v_mfma_f32_16x16x32_bf16 v[32:35], a[208:211], v[64:67], v[32:35]
    v_mfma_f32_16x16x32_bf16 v[36:39], a[208:211], v[68:71], v[36:39]
    v_mfma_f32_16x16x32_bf16 v[40:43], a[212:215], v[64:67], v[40:43]
    v_mfma_f32_16x16x32_bf16 v[44:47], a[212:215], v[68:71], v[44:47]
    v_mfma_f32_16x16x32_bf16 v[48:51], v[64:67], v[208:211], v[48:51]
    v_mfma_f32_16x16x32_bf16 v[56:59], v[68:71], v[208:211], v[56:59]
    v_mfma_f32_16x16x32_bf16 v[52:55], v[64:67], v[212:215], v[52:55]
    v_mfma_f32_16x16x32_bf16 v[60:63], v[68:71], v[212:215], v[60:63]
    v_mfma_f32_16x16x32_bf16 v[16:19], a[80:83], v[64:67], v[16:19]
    v_mfma_f32_16x16x32_bf16 v[20:23], a[80:83], v[68:71], v[20:23]
    v_mfma_f32_16x16x32_bf16 v[24:27], a[84:87], v[64:67], v[24:27]
    v_mfma_f32_16x16x32_bf16 v[28:31], a[84:87], v[68:71], v[28:31]
    ds_read_b128 v[64:67], v80 offset:12288
    ds_read_b128 v[68:71], v81 offset:12288
    s_waitcnt lgkmcnt(2)
    v_mfma_f32_16x16x32_bf16 v[32:35], a[216:219], v[72:75], v[32:35]
    v_mfma_f32_16x16x32_bf16 v[36:39], a[216:219], v[76:79], v[36:39]
    v_mfma_f32_16x16x32_bf16 v[40:43], a[220:223], v[72:75], v[40:43]
    v_mfma_f32_16x16x32_bf16 v[44:47], a[220:223], v[76:79], v[44:47]
    v_mfma_f32_16x16x32_bf16 v[48:51], v[72:75], v[216:219], v[48:51]
    v_mfma_f32_16x16x32_bf16 v[56:59], v[76:79], v[216:219], v[56:59]
    v_mfma_f32_16x16x32_bf16 v[52:55], v[72:75], v[220:223], v[52:55]
    v_mfma_f32_16x16x32_bf16 v[60:63], v[76:79], v[220:223], v[60:63]
    v_mfma_f32_16x16x32_bf16 v[16:19], a[88:91], v[72:75], v[16:19]
    v_mfma_f32_16x16x32_bf16 v[20:23], a[88:91], v[76:79], v[20:23]
    v_mfma_f32_16x16x32_bf16 v[24:27], a[92:95], v[72:75], v[24:27]
    v_mfma_f32_16x16x32_bf16 v[28:31], a[92:95], v[76:79], v[28:31]
    ds_read_b128 v[72:75], v82 offset:13312
    ds_read_b128 v[76:79], v83 offset:13312
    s_waitcnt lgkmcnt(2)
    v_mfma_f32_16x16x32_bf16 v[32:35], a[224:227], v[64:67], v[32:35]
    v_mfma_f32_16x16x32_bf16 v[36:39], a[224:227], v[68:71], v[36:39]
    v_mfma_f32_16x16x32_bf16 v[40:43], a[228:231], v[64:67], v[40:43]
    v_mfma_f32_16x16x32_bf16 v[44:47], a[228:231], v[68:71], v[44:47]
    v_mfma_f32_16x16x32_bf16 v[48:51], v[64:67], v[224:227], v[48:51]
    v_mfma_f32_16x16x32_bf16 v[56:59], v[68:71], v[224:227], v[56:59]
    v_mfma_f32_16x16x32_bf16 v[52:55], v[64:67], v[228:231], v[52:55]
    v_mfma_f32_16x16x32_bf16 v[60:63], v[68:71], v[228:231], v[60:63]
    v_mfma_f32_16x16x32_bf16 v[16:19], a[96:99], v[64:67], v[16:19]
    v_mfma_f32_16x16x32_bf16 v[20:23], a[96:99], v[68:71], v[20:23]
    v_mfma_f32_16x16x32_bf16 v[24:27], a[100:103], v[64:67], v[24:27]
    v_mfma_f32_16x16x32_bf16 v[28:31], a[100:103], v[68:71], v[28:31]
    ds_read_b128 v[64:67], v80 offset:14336
    ds_read_b128 v[68:71], v81 offset:14336
    s_waitcnt lgkmcnt(2)
    v_mfma_f32_16x16x32_bf16 v[32:35], a[232:235], v[72:75], v[32:35]
    v_mfma_f32_16x16x32_bf16 v[36:39], a[232:235], v[76:79], v[36:39]
    v_mfma_f32_16x16x32_bf16 v[40:43], a[236:239], v[72:75], v[40:43]
    v_mfma_f32_16x16x32_bf16 v[44:47], a[236:239], v[76:79], v[44:47]
    v_mfma_f32_16x16x32_bf16 v[48:51], v[72:75], v[232:235], v[48:51]
    v_mfma_f32_16x16x32_bf16 v[56:59], v[76:79], v[232:235], v[56:59]
    v_mfma_f32_16x16x32_bf16 v[52:55], v[72:75], v[236:239], v[52:55]
    v_mfma_f32_16x16x32_bf16 v[60:63], v[76:79], v[236:239], v[60:63]
    v_mfma_f32_16x16x32_bf16 v[16:19], a[104:107], v[72:75], v[16:19]
    v_mfma_f32_16x16x32_bf16 v[20:23], a[104:107], v[76:79], v[20:23]
    v_mfma_f32_16x16x32_bf16 v[24:27], a[108:111], v[72:75], v[24:27]
    v_mfma_f32_16x16x32_bf16 v[28:31], a[108:111], v[76:79], v[28:31]
    ds_read_b128 v[72:75], v82 offset:15360
    ds_read_b128 v[76:79], v83 offset:15360
    s_waitcnt lgkmcnt(2)
    v_mfma_f32_16x16x32_bf16 v[32:35], a[240:243], v[64:67], v[32:35]
    v_mfma_f32_16x16x32_bf16 v[36:39], a[240:243], v[68:71], v[36:39]
    v_mfma_f32_16x16x32_bf16 v[40:43], a[244:247], v[64:67], v[40:43]
    v_mfma_f32_16x16x32_bf16 v[44:47], a[244:247], v[68:71], v[44:47]
    v_mfma_f32_16x16x32_bf16 v[48:51], v[64:67], v[240:243], v[48:51]
    v_mfma_f32_16x16x32_bf16 v[56:59], v[68:71], v[240:243], v[56:59]
    v_mfma_f32_16x16x32_bf16 v[52:55], v[64:67], v[244:247], v[52:55]
    v_mfma_f32_16x16x32_bf16 v[60:63], v[68:71], v[244:247], v[60:63]
    v_mfma_f32_16x16x32_bf16 v[16:19], a[112:115], v[64:67], v[16:19]
    v_mfma_f32_16x16x32_bf16 v[20:23], a[112:115], v[68:71], v[20:23]
    v_mfma_f32_16x16x32_bf16 v[24:27], a[116:119], v[64:67], v[24:27]
    v_mfma_f32_16x16x32_bf16 v[28:31], a[116:119], v[68:71], v[28:31]
    s_waitcnt lgkmcnt(0)
    v_mfma_f32_16x16x32_bf16 v[32:35], a[248:251], v[72:75], v[32:35]
    v_mfma_f32_16x16x32_bf16 v[36:39], a[248:251], v[76:79], v[36:39]
    v_mfma_f32_16x16x32_bf16 v[40:43], a[252:255], v[72:75], v[40:43]
    v_mfma_f32_16x16x32_bf16 v[44:47], a[252:255], v[76:79], v[44:47]
    v_mfma_f32_16x16x32_bf16 v[48:51], v[72:75], v[248:251], v[48:51]
    v_mfma_f32_16x16x32_bf16 v[56:59], v[76:79], v[248:251], v[56:59]
    v_mfma_f32_16x16x32_bf16 v[52:55], v[72:75], v[252:255], v[52:55]
    v_mfma_f32_16x16x32_bf16 v[60:63], v[76:79], v[252:255], v[60:63]
    v_mfma_f32_16x16x32_bf16 v[16:19], a[120:123], v[72:75], v[16:19]
    v_mfma_f32_16x16x32_bf16 v[20:23], a[120:123], v[76:79], v[20:23]
    v_mfma_f32_16x16x32_bf16 v[24:27], a[124:127], v[72:75], v[24:27]
    v_mfma_f32_16x16x32_bf16 v[28:31], a[124:127], v[76:79], v[28:31]
    v_xor_b32 v80, 0x8000, v80
    v_xor_b32 v81, 0x8000, v81
    v_xor_b32 v82, 0x8000, v82
    v_xor_b32 v83, 0x8000, v83
    v_mul_f32 v32, s33, v32
    v_mul_f32 v33, s33, v33
    v_mul_f32 v34, s33, v34
    v_mul_f32 v35, s33, v35
    v_mul_f32 v36, s33, v36
    v_mul_f32 v37, s33, v37
    v_mul_f32 v38, s33, v38
    v_mul_f32 v39, s33, v39
    v_mul_f32 v40, s33, v40
    v_mul_f32 v41, s33, v41
    v_mul_f32 v42, s33, v42
    v_mul_f32 v43, s33, v43
    v_mul_f32 v44, s33, v44
    v_mul_f32 v45, s33, v45
    v_mul_f32 v46, s33, v46
    v_mul_f32 v47, s33, v47
    v_cvt_pk_bf16_f32 v88, v32, v40
    v_cvt_pk_bf16_f32 v89, v33, v41
    v_cvt_pk_bf16_f32 v90, v34, v42
    v_cvt_pk_bf16_f32 v91, v35, v43
    v_cvt_pk_bf16_f32 v92, v36, v44
    v_cvt_pk_bf16_f32 v93, v37, v45
    v_cvt_pk_bf16_f32 v94, v38, v46
    v_cvt_pk_bf16_f32 v95, v39, v47
    v_cvt_pk_bf16_f32 v96, v48, v49
    v_cvt_pk_bf16_f32 v97, v50, v51
    v_cvt_pk_bf16_f32 v98, v56, v57
    v_cvt_pk_bf16_f32 v99, v58, v59
    v_cvt_pk_bf16_f32 v100, v52, v53
    v_cvt_pk_bf16_f32 v101, v54, v55
    v_cvt_pk_bf16_f32 v102, v60, v61
    v_cvt_pk_bf16_f32 v103, v62, v63
    v_cvt_pk_bf16_f32 v104, v16, v24
    v_cvt_pk_bf16_f32 v105, v17, v25
    v_cvt_pk_bf16_f32 v106, v18, v26
    v_cvt_pk_bf16_f32 v107, v19, v27
    v_cvt_pk_bf16_f32 v108, v20, v28
    v_cvt_pk_bf16_f32 v109, v21, v29
    v_cvt_pk_bf16_f32 v110, v22, v30
    v_cvt_pk_bf16_f32 v111, v23, v31
    s_mul_i32 s24, s23, 0x82000
    s_lshl_b32 s36, s20, 14
    s_add_u32 s24, s24, s36
    s_add_u32 s24, s24, 0x1000000
    s_lshr_b32 s36, s21, 1
    s_lshl_b32 s36, s36, 12
    s_xor_b32 s37, s36, 4096
    s_add_u32 s36, s36, s24
    s_add_u32 s37, s37, s24
    buffer_store_dwordx4 v[88:91], v9, s[8:11], s36 offen sc1
    buffer_store_dwordx4 v[92:95], v9, s[8:11], s37 offen sc1
    s_add_u32 s24, s24, 8192
    buffer_store_dwordx4 v[96:99], v2, s[8:11], s24 offen sc1
    buffer_store_dwordx4 v[100:103], v2, s[8:11], s24 offen offset:1024 sc1
    s_add_u32 s36, s36, 0x7000000
    s_add_u32 s37, s37, 0x7000000
    buffer_store_dwordx4 v[104:107], v9, s[8:11], s36 offen sc1
    buffer_store_dwordx4 v[108:111], v9, s[8:11], s37 offen sc1
    s_lshl_b32 s25, s20, 8
    s_lshl_b32 s36, s23, 2
    s_add_u32 s25, s25, s36
    s_add_u32 s25, s25, 0x190000
    s_add_u32 s23, s23, 6
    s_cmp_lt_u32 s23, 64
    s_cbranch_scc1 L_P1
    v_mov_b32 v20, -1
    v_mov_b32 v21, -1
    v_mov_b32 v22, -1
    v_mov_b32 v23, -1
    s_lshl_b32 s24, s22, 21
    s_lshl_b32 s36, s20, 15
    s_add_u32 s24, s24, s36
    s_add_u32 s36, s24, 0x4000000
    buffer_store_dwordx4 v[20:23], v11, s[8:11], s36 offen sc1
    s_add_u32 s36, s24, 0x4001000
    buffer_store_dwordx4 v[20:23], v11, s[8:11], s36 offen sc1
    s_add_u32 s36, s24, 0x4002000
    buffer_store_dwordx4 v[20:23], v11, s[8:11], s36 offen sc1
    s_add_u32 s36, s24, 0x4003000
    buffer_store_dwordx4 v[20:23], v11, s[8:11], s36 offen sc1
    s_add_u32 s36, s24, 0x4004000
    buffer_store_dwordx4 v[20:23], v11, s[8:11], s36 offen sc1
    s_add_u32 s36, s24, 0x4005000
    buffer_store_dwordx4 v[20:23], v11, s[8:11], s36 offen sc1
    s_add_u32 s36, s24, 0x4006000
    buffer_store_dwordx4 v[20:23], v11, s[8:11], s36 offen sc1
    s_add_u32 s36, s24, 0x4007000
    buffer_store_dwordx4 v[20:23], v11, s[8:11], s36 offen sc1
    s_add_u32 s36, s24, 0x4100000
    buffer_store_dwordx4 v[20:23], v11, s[8:11], s36 offen sc1
    s_add_u32 s36, s24, 0x4101000
    buffer_store_dwordx4 v[20:23], v11, s[8:11], s36 offen sc1
    s_add_u32 s36, s24, 0x4102000
    buffer_store_dwordx4 v[20:23], v11, s[8:11], s36 offen sc1
    s_add_u32 s36, s24, 0x4103000
    buffer_store_dwordx4 v[20:23], v11, s[8:11], s36 offen sc1
    s_add_u32 s36, s24, 0x4104000
    buffer_store_dwordx4 v[20:23], v11, s[8:11], s36 offen sc1
    s_add_u32 s36, s24, 0x4105000
    buffer_store_dwordx4 v[20:23], v11, s[8:11], s36 offen sc1
    s_add_u32 s36, s24, 0x4106000
    buffer_store_dwordx4 v[20:23], v11, s[8:11], s36 offen sc1
    s_add_u32 s36, s24, 0x4107000
    buffer_store_dwordx4 v[20:23], v11, s[8:11], s36 offen sc1
    s_waitcnt vmcnt(0)
    s_barrier
    v_cmp_ne_u32 vcc, 0, v0
    v_mov_b32 v15, 0x40000000
    v_mov_b32 v14, 1
    v_cndmask_b32 v15, v0, v15, vcc
    buffer_store_dword v14, v15, s[8:11], s25 offen sc1
    s_lshl_b32 s25, s22, 7
    s_lshl_b32 s36, s20, 2
    s_add_u32 s36, s36, s25
    s_add_u32 s36, s36, 0x192000
    v_cmp_ne_u32 vcc, 0, v0
    v_mov_b32 v15, 0x40000000
    v_mov_b32 v14, 1
    v_cndmask_b32 v15, v0, v15, vcc
    buffer_store_dword v14, v15, s[8:11], s36 offen sc1
    s_mov_b32 s96, s54
    s_and_b32 s97, s55, 0xffff
    s_mov_b32 s98, 0x400000
    s_mov_b32 s99, 0x20000
    v_mov_b32 v15, 0x0
    v_bfe_u32 v14, v0, 0, 1
    s_mov_b32 s38, 0x10
    v_mad_u32_u24 v15, v14, s38, v15
    v_bfe_u32 v14, v0, 1, 1
    s_mov_b32 s38, 0x20
    v_mad_u32_u24 v15, v14, s38, v15
    v_bfe_u32 v14, v0, 2, 1
    s_mov_b32 s38, 0x40
    v_mad_u32_u24 v15, v14, s38, v15
    v_bfe_u32 v14, v0, 3, 1
    s_mov_b32 s38, 0x80
    v_mad_u32_u24 v15, v14, s38, v15
    v_bfe_u32 v14, v0, 4, 1
    s_mov_b32 s38, 0x1000
    v_mad_u32_u24 v15, v14, s38, v15
    v_bfe_u32 v14, v0, 5, 1
    s_mov_b32 s38, 0x2000
    v_mad_u32_u24 v15, v14, s38, v15
    v_bfe_u32 v14, v0, 6, 1
    s_mov_b32 s38, 0x100
    v_mad_u32_u24 v15, v14, s38, v15
    v_bfe_u32 v14, v0, 7, 1
    s_mov_b32 s38, 0x200
    v_mad_u32_u24 v15, v14, s38, v15
    s_lshl_b32 s36, s20, 17
    s_add_u32 s37, s36, 0x0
    buffer_load_dwordx4 v[16:19], v15, s[96:99], s37 offen
    s_add_u32 s37, s36, 0x4000
    buffer_load_dwordx4 v[20:23], v15, s[96:99], s37 offen
    s_add_u32 s37, s36, 0x400
    buffer_load_dwordx4 v[24:27], v15, s[96:99], s37 offen
    s_add_u32 s37, s36, 0x4400
    buffer_load_dwordx4 v[28:31], v15, s[96:99], s37 offen
    s_add_u32 s37, s36, 0x800
    buffer_load_dwordx4 v[32:35], v15, s[96:99], s37 offen
    s_add_u32 s37, s36, 0x4800
    buffer_load_dwordx4 v[36:39], v15, s[96:99], s37 offen
    s_add_u32 s37, s36, 0xc00
    buffer_load_dwordx4 v[40:43], v15, s[96:99], s37 offen
    s_add_u32 s37, s36, 0x4c00
    buffer_load_dwordx4 v[44:47], v15, s[96:99], s37 offen
    s_add_u32 s37, s36, 0x8000
    buffer_load_dwordx4 v[48:51], v15, s[96:99], s37 offen
    s_add_u32 s37, s36, 0xc000
    buffer_load_dwordx4 v[52:55], v15, s[96:99], s37 offen
    s_add_u32 s37, s36, 0x8400
    buffer_load_dwordx4 v[56:59], v15, s[96:99], s37 offen
    s_add_u32 s37, s36, 0xc400
    buffer_load_dwordx4 v[60:63], v15, s[96:99], s37 offen
    s_add_u32 s37, s36, 0x8800
    buffer_load_dwordx4 v[64:67], v15, s[96:99], s37 offen
    s_add_u32 s37, s36, 0xc800
    buffer_load_dwordx4 v[68:71], v15, s[96:99], s37 offen
    s_add_u32 s37, s36, 0x8c00
    buffer_load_dwordx4 v[72:75], v15, s[96:99], s37 offen
    s_add_u32 s37, s36, 0xcc00
    buffer_load_dwordx4 v[76:79], v15, s[96:99], s37 offen
    s_add_u32 s37, s36, 0x10000
    buffer_load_dwordx4 v[80:83], v15, s[96:99], s37 offen
    s_add_u32 s37, s36, 0x14000
    buffer_load_dwordx4 v[84:87], v15, s[96:99], s37 offen
    s_add_u32 s37, s36, 0x10400
    buffer_load_dwordx4 v[88:91], v15, s[96:99], s37 offen
    s_add_u32 s37, s36, 0x14400
    buffer_load_dwordx4 v[92:95], v15, s[96:99], s37 offen
    s_add_u32 s37, s36, 0x10800
    buffer_load_dwordx4 v[96:99], v15, s[96:99], s37 offen
    s_add_u32 s37, s36, 0x14800
    buffer_load_dwordx4 v[100:103], v15, s[96:99], s37 offen
    s_add_u32 s37, s36, 0x10c00
    buffer_load_dwordx4 v[104:107], v15, s[96:99], s37 offen
    s_add_u32 s37, s36, 0x14c00
    buffer_load_dwordx4 v[108:111], v15, s[96:99], s37 offen
    s_waitcnt vmcnt(16)
    v_perm_b32 v112, v20, v16, s34
    v_perm_b32 v113, v28, v24, s34
    v_perm_b32 v114, v36, v32, s34
    v_perm_b32 v115, v44, v40, s34
    ds_write_b128 v7, v[112:115] offset:0
    v_perm_b32 v116, v20, v16, s35
    v_perm_b32 v117, v28, v24, s35
    v_perm_b32 v118, v36, v32, s35
    v_perm_b32 v119, v44, v40, s35
    ds_write_b128 v7, v[116:119] offset:1024
    v_perm_b32 v120, v21, v17, s34
    v_perm_b32 v121, v29, v25, s34
    v_perm_b32 v122, v37, v33, s34
    v_perm_b32 v123, v45, v41, s34
    ds_write_b128 v7, v[120:123] offset:2048
    v_perm_b32 v124, v21, v17, s35
    v_perm_b32 v125, v29, v25, s35
    v_perm_b32 v126, v37, v33, s35
    v_perm_b32 v127, v45, v41, s35
    ds_write_b128 v7, v[124:127] offset:3072
    s_waitcnt lgkmcnt(0)
    v_perm_b32 v112, v22, v18, s34
    v_perm_b32 v113, v30, v26, s34
    v_perm_b32 v114, v38, v34, s34
    v_perm_b32 v115, v46, v42, s34
    ds_write_b128 v7, v[112:115] offset:4096
    v_perm_b32 v116, v22, v18, s35
    v_perm_b32 v117, v30, v26, s35
    v_perm_b32 v118, v38, v34, s35
    v_perm_b32 v119, v46, v42, s35
    ds_write_b128 v7, v[116:119] offset:5120
    v_perm_b32 v120, v23, v19, s34
    v_perm_b32 v121, v31, v27, s34
    v_perm_b32 v122, v39, v35, s34
    v_perm_b32 v123, v47, v43, s34
    ds_write_b128 v7, v[120:123] offset:6144
    v_perm_b32 v124, v23, v19, s35
    v_perm_b32 v125, v31, v27, s35
    v_perm_b32 v126, v39, v35, s35
    v_perm_b32 v127, v47, v43, s35
    ds_write_b128 v7, v[124:127] offset:7168
    s_waitcnt lgkmcnt(0)
    s_add_u32 s37, s36, 0x18000
    buffer_load_dwordx4 v[16:19], v15, s[96:99], s37 offen
    s_add_u32 s37, s36, 0x1c000
    buffer_load_dwordx4 v[20:23], v15, s[96:99], s37 offen
    s_add_u32 s37, s36, 0x18400
    buffer_load_dwordx4 v[24:27], v15, s[96:99], s37 offen
    s_add_u32 s37, s36, 0x1c400
    buffer_load_dwordx4 v[28:31], v15, s[96:99], s37 offen
    s_add_u32 s37, s36, 0x18800
    buffer_load_dwordx4 v[32:35], v15, s[96:99], s37 offen
    s_add_u32 s37, s36, 0x1c800
    buffer_load_dwordx4 v[36:39], v15, s[96:99], s37 offen
    s_add_u32 s37, s36, 0x18c00
    buffer_load_dwordx4 v[40:43], v15, s[96:99], s37 offen
    s_add_u32 s37, s36, 0x1cc00
    buffer_load_dwordx4 v[44:47], v15, s[96:99], s37 offen
    s_waitcnt vmcnt(16)
    v_perm_b32 v112, v52, v48, s34
    v_perm_b32 v113, v60, v56, s34
    v_perm_b32 v114, v68, v64, s34
    v_perm_b32 v115, v76, v72, s34
    ds_write_b128 v7, v[112:115] offset:8192
    v_perm_b32 v116, v52, v48, s35
    v_perm_b32 v117, v60, v56, s35
    v_perm_b32 v118, v68, v64, s35
    v_perm_b32 v119, v76, v72, s35
    ds_write_b128 v7, v[116:119] offset:9216
    v_perm_b32 v120, v53, v49, s34
    v_perm_b32 v121, v61, v57, s34
    v_perm_b32 v122, v69, v65, s34
    v_perm_b32 v123, v77, v73, s34
    ds_write_b128 v7, v[120:123] offset:10240
    v_perm_b32 v124, v53, v49, s35
    v_perm_b32 v125, v61, v57, s35
    v_perm_b32 v126, v69, v65, s35
    v_perm_b32 v127, v77, v73, s35
    ds_write_b128 v7, v[124:127] offset:11264
    s_waitcnt lgkmcnt(0)
    v_perm_b32 v112, v54, v50, s34
    v_perm_b32 v113, v62, v58, s34
    v_perm_b32 v114, v70, v66, s34
    v_perm_b32 v115, v78, v74, s34
    ds_write_b128 v7, v[112:115] offset:12288
    v_perm_b32 v116, v54, v50, s35
    v_perm_b32 v117, v62, v58, s35
    v_perm_b32 v118, v70, v66, s35
    v_perm_b32 v119, v78, v74, s35
    ds_write_b128 v7, v[116:119] offset:13312
    v_perm_b32 v120, v55, v51, s34
    v_perm_b32 v121, v63, v59, s34
    v_perm_b32 v122, v71, v67, s34
    v_perm_b32 v123, v79, v75, s34
    ds_write_b128 v7, v[120:123] offset:14336
    v_perm_b32 v124, v55, v51, s35
    v_perm_b32 v125, v63, v59, s35
    v_perm_b32 v126, v71, v67, s35
    v_perm_b32 v127, v79, v75, s35
    ds_write_b128 v7, v[124:127] offset:15360
    s_waitcnt lgkmcnt(0)
    s_waitcnt vmcnt(8)
    v_perm_b32 v112, v84, v80, s34
    v_perm_b32 v113, v92, v88, s34
    v_perm_b32 v114, v100, v96, s34
    v_perm_b32 v115, v108, v104, s34
    ds_write_b128 v7, v[112:115] offset:16384
    v_perm_b32 v116, v84, v80, s35
    v_perm_b32 v117, v92, v88, s35
    v_perm_b32 v118, v100, v96, s35
    v_perm_b32 v119, v108, v104, s35
    ds_write_b128 v7, v[116:119] offset:17408
    v_perm_b32 v120, v85, v81, s34
    v_perm_b32 v121, v93, v89, s34
    v_perm_b32 v122, v101, v97, s34
    v_perm_b32 v123, v109, v105, s34
    ds_write_b128 v7, v[120:123] offset:18432
    v_perm_b32 v124, v85, v81, s35
    v_perm_b32 v125, v93, v89, s35
    v_perm_b32 v126, v101, v97, s35
    v_perm_b32 v127, v109, v105, s35
    ds_write_b128 v7, v[124:127] offset:19456
    s_waitcnt lgkmcnt(0)
    v_perm_b32 v112, v86, v82, s34
    v_perm_b32 v113, v94, v90, s34
    v_perm_b32 v114, v102, v98, s34
    v_perm_b32 v115, v110, v106, s34
    ds_write_b128 v7, v[112:115] offset:20480
    v_perm_b32 v116, v86, v82, s35
    v_perm_b32 v117, v94, v90, s35
    v_perm_b32 v118, v102, v98, s35
    v_perm_b32 v119, v110, v106, s35
    ds_write_b128 v7, v[116:119] offset:21504
    v_perm_b32 v120, v87, v83, s34
    v_perm_b32 v121, v95, v91, s34
    v_perm_b32 v122, v103, v99, s34
    v_perm_b32 v123, v111, v107, s34
    ds_write_b128 v7, v[120:123] offset:22528
    v_perm_b32 v124, v87, v83, s35
    v_perm_b32 v125, v95, v91, s35
    v_perm_b32 v126, v103, v99, s35
    v_perm_b32 v127, v111, v107, s35
    ds_write_b128 v7, v[124:127] offset:23552
    s_waitcnt lgkmcnt(0)
    s_waitcnt vmcnt(0)
    v_perm_b32 v112, v20, v16, s34
    v_perm_b32 v113, v28, v24, s34
    v_perm_b32 v114, v36, v32, s34
    v_perm_b32 v115, v44, v40, s34
    ds_write_b128 v7, v[112:115] offset:24576
    v_perm_b32 v116, v20, v16, s35
    v_perm_b32 v117, v28, v24, s35
    v_perm_b32 v118, v36, v32, s35
    v_perm_b32 v119, v44, v40, s35
    ds_write_b128 v7, v[116:119] offset:25600
    v_perm_b32 v120, v21, v17, s34
    v_perm_b32 v121, v29, v25, s34
    v_perm_b32 v122, v37, v33, s34
    v_perm_b32 v123, v45, v41, s34
    ds_write_b128 v7, v[120:123] offset:26624
    v_perm_b32 v124, v21, v17, s35
    v_perm_b32 v125, v29, v25, s35
    v_perm_b32 v126, v37, v33, s35
    v_perm_b32 v127, v45, v41, s35
    ds_write_b128 v7, v[124:127] offset:27648
    s_waitcnt lgkmcnt(0)
    v_perm_b32 v112, v22, v18, s34
    v_perm_b32 v113, v30, v26, s34
    v_perm_b32 v114, v38, v34, s34
    v_perm_b32 v115, v46, v42, s34
    ds_write_b128 v7, v[112:115] offset:28672
    v_perm_b32 v116, v22, v18, s35
    v_perm_b32 v117, v30, v26, s35
    v_perm_b32 v118, v38, v34, s35
    v_perm_b32 v119, v46, v42, s35
    ds_write_b128 v7, v[116:119] offset:29696
    v_perm_b32 v120, v23, v19, s34
    v_perm_b32 v121, v31, v27, s34
    v_perm_b32 v122, v39, v35, s34
    v_perm_b32 v123, v47, v43, s34
    ds_write_b128 v7, v[120:123] offset:30720
    v_perm_b32 v124, v23, v19, s35
    v_perm_b32 v125, v31, v27, s35
    v_perm_b32 v126, v39, v35, s35
    v_perm_b32 v127, v47, v43, s35
    ds_write_b128 v7, v[124:127] offset:31744
    s_waitcnt lgkmcnt(0)
    s_lshl_b32 s25, s22, 7
    s_add_u32 s25, s25, 0x192000
    v_lshrrev_b32 v15, 2, v1
    v_and_b32 v15, 127, v15
L_TPI:
    buffer_load_dword v14, v15, s[8:11], s25 offen sc1
    s_add_u32 s32, s32, 1
    s_cmp_gt_u32 s32, 200000
    s_waitcnt vmcnt(0)
    s_cbranch_scc1 L_TPI_ok
    v_cmp_eq_u32 vcc, 0, v14
    s_cbranch_vccz L_TPI_ok
    s_sleep 8
    s_branch L_TPI
L_TPI_ok:
    s_mov_b32 s23, s22
    s_mov_b32 s29, 0
    s_mov_b32 s30, 0x40000000
    s_mul_i32 s24, s23, 0x82000
    s_lshl_b32 s36, s20, 14
    s_add_u32 s24, s24, s36
    s_add_u32 s24, s24, 0x1000000
    s_add_u32 s36, s24, 0
    s_add_u32 s37, s36, 0x7000000
    buffer_load_dwordx4 a[32:35], v1, s[8:11], s36 offen offset:0 sc1
    buffer_load_dwordx4 a[0:3], v1, s[8:11], s37 offen offset:0 sc1
    buffer_load_dwordx4 a[36:39], v1, s[8:11], s36 offen offset:1024 sc1
    buffer_load_dwordx4 a[4:7], v1, s[8:11], s37 offen offset:1024 sc1
    buffer_load_dwordx4 a[40:43], v1, s[8:11], s36 offen offset:2048 sc1
    buffer_load_dwordx4 a[8:11], v1, s[8:11], s37 offen offset:2048 sc1
    buffer_load_dwordx4 a[44:47], v1, s[8:11], s36 offen offset:3072 sc1
    buffer_load_dwordx4 a[12:15], v1, s[8:11], s37 offen offset:3072 sc1
    s_add_u32 s36, s24, 4096
    s_add_u32 s37, s36, 0x7000000
    buffer_load_dwordx4 a[48:51], v1, s[8:11], s36 offen offset:0 sc1
    buffer_load_dwordx4 a[16:19], v1, s[8:11], s37 offen offset:0 sc1
    buffer_load_dwordx4 a[52:55], v1, s[8:11], s36 offen offset:1024 sc1
    buffer_load_dwordx4 a[20:23], v1, s[8:11], s37 offen offset:1024 sc1
    buffer_load_dwordx4 a[56:59], v1, s[8:11], s36 offen offset:2048 sc1
    buffer_load_dwordx4 a[24:27], v1, s[8:11], s37 offen offset:2048 sc1
    buffer_load_dwordx4 a[60:63], v1, s[8:11], s36 offen offset:3072 sc1
    buffer_load_dwordx4 a[28:31], v1, s[8:11], s37 offen offset:3072 sc1
    s_lshr_b32 s36, s21, 1
    s_lshl_b32 s36, s36, 3
    s_xor_b32 s37, s36, 8
    s_add_u32 s24, s24, 8192
    s_add_u32 s36, s36, s24
    s_add_u32 s37, s37, s24
    buffer_load_dwordx2 a[64:65], v2, s[8:11], s36 offen offset:0 sc1
    buffer_load_dwordx2 a[66:67], v2, s[8:11], s37 offen offset:0 sc1
    buffer_load_dwordx2 a[68:69], v2, s[8:11], s36 offen offset:1024 sc1
    buffer_load_dwordx2 a[70:71], v2, s[8:11], s37 offen offset:1024 sc1
L_P2:
    s_and_b32 s36, s29, 1
    s_lshl_b32 s36, s36, 20
    s_lshl_b32 s26, s22, 21
    s_add_u32 s26, s26, s36
    s_add_u32 s26, s26, 0x4000000
    s_bfe_u32 s27, s29, 0x10001
    s_lshl_b32 s24, s23, 13
    s_add_u32 s24, s24, 0x100000
    s_max_u32 s25, s23, 1
    s_lshl_b32 s25, s25, 13
    s_add_u32 s25, s25, 0xfe000
    buffer_load_dwordx4 v[48:51], v2, s[8:11], s24 offen sc1
    buffer_load_dwordx4 v[52:55], v2, s[8:11], s24 offen offset:1024 sc1
    s_lshl_b32 s36, s23, 5
    s_add_u32 s36, s36, s20
    s_lshl_b32 s36, s36, 10
    buffer_load_dword a72, v12, s[12:15], s36 offen
    buffer_load_dword a73, v12, s[92:95], 0 offen
    s_waitcnt vmcnt(4)
    v_cmp_ne_u32 vcc, 0, v1
    v_mov_b32 v15, 0x40000000
    v_mov_b32 v14, 0
    v_cndmask_b32 v15, v1, v15, vcc
    buffer_store_dword v14, v15, s[8:11], s30 offen sc1
    v_mfma_f32_16x16x32_bf16 v[80:83], a[32:35], a[0:3], 0
    v_mfma_f32_16x16x32_bf16 v[80:83], a[36:39], a[4:7], v[80:83]
    v_mfma_f32_16x16x32_bf16 v[80:83], a[40:43], a[8:11], v[80:83]
    v_mfma_f32_16x16x32_bf16 v[80:83], a[44:47], a[12:15], v[80:83]
    v_mfma_f32_16x16x32_bf16 v[88:91], a[48:51], a[16:19], 0
    v_mfma_f32_16x16x32_bf16 v[88:91], a[52:55], a[20:23], v[88:91]
    v_mfma_f32_16x16x32_bf16 v[88:91], a[56:59], a[24:27], v[88:91]
    v_mfma_f32_16x16x32_bf16 v[88:91], a[60:63], a[28:31], v[88:91]
    v_mfma_f32_16x16x32_bf16 v[84:87], a[32:35], a[16:19], 0
    v_mfma_f32_16x16x32_bf16 v[84:87], a[36:39], a[20:23], v[84:87]
    v_mfma_f32_16x16x32_bf16 v[84:87], a[40:43], a[24:27], v[84:87]
    v_mfma_f32_16x16x32_bf16 v[84:87], a[44:47], a[28:31], v[84:87]
    v_cndmask_b32 v80, v13, v80, s[64:65]
    v_cndmask_b32 v81, v13, v81, s[66:67]
    v_cndmask_b32 v82, v13, v82, s[68:69]
    v_cndmask_b32 v83, v13, v83, s[70:71]
    v_cndmask_b32 v88, v13, v88, s[64:65]
    v_cndmask_b32 v89, v13, v89, s[66:67]
    v_cndmask_b32 v90, v13, v90, s[68:69]
    v_cndmask_b32 v91, v13, v91, s[70:71]
    v_max_f32 v116, v80, v81
    v_max3_f32 v116, v116, v82, v83
    v_max_f32 v117, v84, v85
    v_max3_f32 v117, v117, v86, v87
    v_max3_f32 v117, v117, v88, v89
    v_max3_f32 v117, v117, v90, v91
    v_mov_b32 v14, v116
    s_nop 1
    v_permlane16_swap_b32 v116, v14
    v_max_f32 v116, v116, v14
    v_mov_b32 v14, v117
    s_nop 1
    v_permlane16_swap_b32 v117, v14
    v_max_f32 v117, v117, v14
    v_mov_b32 v14, v116
    s_nop 1
    v_permlane32_swap_b32 v116, v14
    v_max_f32 v116, v116, v14
    v_mov_b32 v14, v117
    s_nop 1
    v_permlane32_swap_b32 v117, v14
    v_max_f32 v117, v117, v14
    v_sub_f32 v80, v80, v116
    v_exp_f32 v80, v80
    v_sub_f32 v81, v81, v116
    v_exp_f32 v81, v81
    v_sub_f32 v82, v82, v116
    v_exp_f32 v82, v82
    v_sub_f32 v83, v83, v116
    v_exp_f32 v83, v83
    v_sub_f32 v84, v84, v117
    v_exp_f32 v84, v84
    v_sub_f32 v85, v85, v117
    v_exp_f32 v85, v85
    v_sub_f32 v86, v86, v117
    v_exp_f32 v86, v86
    v_sub_f32 v87, v87, v117
    v_exp_f32 v87, v87
    v_sub_f32 v88, v88, v117
    v_exp_f32 v88, v88
    v_sub_f32 v89, v89, v117
    v_exp_f32 v89, v89
    v_sub_f32 v90, v90, v117
    v_exp_f32 v90, v90
    v_sub_f32 v91, v91, v117
    v_exp_f32 v91, v91
    v_cvt_pk_bf16_f32 v100, v80, v81
    v_cvt_pk_bf16_f32 v101, v82, v83
    v_mov_b64 v[102:103], 0
    v_cvt_pk_bf16_f32 v104, v84, v85
    v_cvt_pk_bf16_f32 v105, v86, v87
    v_cvt_pk_bf16_f32 v106, v88, v89
    v_cvt_pk_bf16_f32 v107, v90, v91
    v_mov_b64 v[108:109], s[4:5]
    v_mov_b64 v[110:111], s[4:5]
    v_cndmask_b32 v112, 0, v108, s[72:73]
    v_cndmask_b32 v113, 0, v108, s[72:73]
    v_mfma_f32_16x16x32_bf16 v[16:19], v[108:111], v[100:103], 0
    v_mfma_f32_16x16x32_bf16 v[24:27], a[64:67], v[100:103], 0
    v_mfma_f32_16x16x32_bf16 v[28:31], a[68:71], v[100:103], 0
    v_mfma_f32_16x16x32_bf16 v[20:23], v[108:111], v[104:107], 0
    v_mfma_f32_16x16x32_bf16 v[32:35], a[64:67], v[104:107], 0
    v_mfma_f32_16x16x32_bf16 v[36:39], a[68:71], v[104:107], 0
    s_branch L_P2_chk
L_P2_far:
    buffer_load_dword v14, v2, s[8:11], s25 offen sc1
    s_add_u32 s32, s32, 1
    s_cmp_gt_u32 s32, 200000
    s_waitcnt vmcnt(0)
    s_cbranch_scc1 L_P2_poll
    v_cmp_eq_u32 vcc, -1, v14
    s_cbranch_vccz L_P2_near
    s_sleep 12
    s_branch L_P2_far
L_P2_near:
    s_mov_b32 s25, 0x40000000
L_P2_poll:
    buffer_load_dwordx4 v[48:51], v2, s[8:11], s24 offen sc1
    buffer_load_dwordx4 v[52:55], v2, s[8:11], s24 offen offset:1024 sc1
L_P2_chk:
    s_add_u32 s32, s32, 1
    s_waitcnt vmcnt(0)
    ds_write_b128 v2, v[48:51] offset:20480
    ds_write_b128 v2, v[52:55] offset:21504
    v_max3_u32 v14, v48, v49, v50
    v_max3_u32 v15, v51, v52, v53
    v_max3_u32 v14, v14, v54, v55
    v_max_u32 v14, v14, v15
    v_cmp_eq_u32 vcc, -1, v14
    s_cbranch_vccz L_P2_got
    s_cmp_gt_u32 s32, 200000
    s_cbranch_scc1 L_P2_got
    s_cmp_eq_u32 s25, 0x40000000
    s_cbranch_scc1 L_P2_poll
    s_branch L_P2_far
L_P2_got:
    s_waitcnt lgkmcnt(0)
    s_barrier
    ds_read_b128 v[48:51], v8 offset:0
    ds_read_b128 v[52:55], v8 offset:2048
    ds_read_b128 v[56:59], v8 offset:4096
    ds_read_b128 v[60:63], v8 offset:6144
    s_waitcnt lgkmcnt(3)
    v_mfma_f32_16x16x32_bf16 v[80:83], a[128:131], v[48:51], 0
    v_mfma_f32_16x16x32_bf16 v[84:87], a[132:135], v[48:51], 0
    ds_read_b128 v[48:51], v8 offset:512
    s_waitcnt lgkmcnt(3)
    v_mfma_f32_16x16x32_bf16 v[80:83], a[136:139], v[52:55], v[80:83]
    v_mfma_f32_16x16x32_bf16 v[84:87], a[140:143], v[52:55], v[84:87]
    ds_read_b128 v[52:55], v8 offset:2560
    s_waitcnt lgkmcnt(3)
    v_mfma_f32_16x16x32_bf16 v[80:83], a[144:147], v[56:59], v[80:83]
    v_mfma_f32_16x16x32_bf16 v[84:87], a[148:151], v[56:59], v[84:87]
    ds_read_b128 v[56:59], v8 offset:4608
    s_waitcnt lgkmcnt(3)
    v_mfma_f32_16x16x32_bf16 v[80:83], a[152:155], v[60:63], v[80:83]
    v_mfma_f32_16x16x32_bf16 v[84:87], a[156:159], v[60:63], v[84:87]
    ds_read_b128 v[60:63], v8 offset:6656
    s_waitcnt lgkmcnt(3)
    v_mfma_f32_16x16x32_bf16 v[80:83], a[160:163], v[48:51], v[80:83]
    v_mfma_f32_16x16x32_bf16 v[84:87], a[164:167], v[48:51], v[84:87]
    ds_read_b128 v[48:51], v8 offset:1024
    s_waitcnt lgkmcnt(3)
    v_mfma_f32_16x16x32_bf16 v[80:83], a[168:171], v[52:55], v[80:83]
    v_mfma_f32_16x16x32_bf16 v[84:87], a[172:175], v[52:55], v[84:87]
    ds_read_b128 v[52:55], v8 offset:3072
    s_waitcnt lgkmcnt(3)
    v_mfma_f32_16x16x32_bf16 v[80:83], a[176:179], v[56:59], v[80:83]
    v_mfma_f32_16x16x32_bf16 v[84:87], a[180:183], v[56:59], v[84:87]
    ds_read_b128 v[56:59], v8 offset:5120
    s_waitcnt lgkmcnt(3)
    v_mfma_f32_16x16x32_bf16 v[80:83], a[184:187], v[60:63], v[80:83]
    v_mfma_f32_16x16x32_bf16 v[84:87], a[188:191], v[60:63], v[84:87]
    ds_read_b128 v[60:63], v8 offset:7168
    s_waitcnt lgkmcnt(3)
    v_mfma_f32_16x16x32_bf16 v[80:83], a[192:195], v[48:51], v[80:83]
    v_mfma_f32_16x16x32_bf16 v[84:87], a[196:199], v[48:51], v[84:87]
    ds_read_b128 v[48:51], v8 offset:1536
    s_waitcnt lgkmcnt(3)
    v_mfma_f32_16x16x32_bf16 v[80:83], a[200:203], v[52:55], v[80:83]
    v_mfma_f32_16x16x32_bf16 v[84:87], a[204:207], v[52:55], v[84:87]
    ds_read_b128 v[52:55], v8 offset:3584
    s_waitcnt lgkmcnt(3)
    v_mfma_f32_16x16x32_bf16 v[80:83], a[208:211], v[56:59], v[80:83]
    v_mfma_f32_16x16x32_bf16 v[84:87], a[212:215], v[56:59], v[84:87]
    ds_read_b128 v[56:59], v8 offset:5632
    s_waitcnt lgkmcnt(3)
    v_mfma_f32_16x16x32_bf16 v[80:83], a[216:219], v[60:63], v[80:83]
    v_mfma_f32_16x16x32_bf16 v[84:87], a[220:223], v[60:63], v[84:87]
    ds_read_b128 v[60:63], v8 offset:7680
    s_waitcnt lgkmcnt(3)
    v_mfma_f32_16x16x32_bf16 v[80:83], a[224:227], v[48:51], v[80:83]
    v_mfma_f32_16x16x32_bf16 v[84:87], a[228:231], v[48:51], v[84:87]
    ds_read_b128 v[48:51], v8 offset:0
    s_waitcnt lgkmcnt(3)
    v_mfma_f32_16x16x32_bf16 v[80:83], a[232:235], v[52:55], v[80:83]
    v_mfma_f32_16x16x32_bf16 v[84:87], a[236:239], v[52:55], v[84:87]
    ds_read_b128 v[52:55], v8 offset:2048
    s_waitcnt lgkmcnt(3)
    v_mfma_f32_16x16x32_bf16 v[80:83], a[240:243], v[56:59], v[80:83]
    v_mfma_f32_16x16x32_bf16 v[84:87], a[244:247], v[56:59], v[84:87]
    ds_read_b128 v[56:59], v8 offset:4096
    s_waitcnt lgkmcnt(3)
    v_mfma_f32_16x16x32_bf16 v[80:83], a[248:251], v[60:63], v[80:83]
    v_mfma_f32_16x16x32_bf16 v[84:87], a[252:255], v[60:63], v[84:87]
    ds_read_b128 v[60:63], v8 offset:6144
    s_waitcnt lgkmcnt(3)
    v_mfma_f32_16x16x32_bf16 v[40:43], v[48:51], v[128:131], 0
    v_mfma_f32_16x16x32_bf16 v[44:47], v[48:51], v[132:135], 0
    ds_read_b128 v[48:51], v8 offset:512
    s_waitcnt lgkmcnt(3)
    v_mfma_f32_16x16x32_bf16 v[40:43], v[52:55], v[136:139], v[40:43]
    v_mfma_f32_16x16x32_bf16 v[44:47], v[52:55], v[140:143], v[44:47]
    ds_read_b128 v[52:55], v8 offset:2560
    s_waitcnt lgkmcnt(3)
    v_mfma_f32_16x16x32_bf16 v[40:43], v[56:59], v[144:147], v[40:43]
    v_mfma_f32_16x16x32_bf16 v[44:47], v[56:59], v[148:151], v[44:47]
    v_mul_f32 v80, s33, v80
    v_mul_f32 v81, s33, v81
    v_mul_f32 v82, s33, v82
    v_mul_f32 v83, s33, v83
    ds_read_b128 v[56:59], v8 offset:4608
    s_waitcnt lgkmcnt(3)
    v_mfma_f32_16x16x32_bf16 v[40:43], v[60:63], v[152:155], v[40:43]
    v_mfma_f32_16x16x32_bf16 v[44:47], v[60:63], v[156:159], v[44:47]
    v_mul_f32 v84, s33, v84
    v_mul_f32 v85, s33, v85
    v_mul_f32 v86, s33, v86
    v_mul_f32 v87, s33, v87
    ds_read_b128 v[60:63], v8 offset:6656
    s_waitcnt lgkmcnt(3)
    v_mfma_f32_16x16x32_bf16 v[40:43], v[48:51], v[160:163], v[40:43]
    v_mfma_f32_16x16x32_bf16 v[44:47], v[48:51], v[164:167], v[44:47]
    v_cvt_pk_bf16_f32 v88, v80, v84
    v_cvt_pk_bf16_f32 v89, v81, v85
    v_cvt_pk_bf16_f32 v90, v82, v86
    v_cvt_pk_bf16_f32 v91, v83, v87
    ds_write_b128 v9, v[88:91] offset:16384
    ds_read_b128 v[48:51], v8 offset:1024
    s_waitcnt lgkmcnt(4)
    v_mfma_f32_16x16x32_bf16 v[40:43], v[52:55], v[168:171], v[40:43]
    v_mfma_f32_16x16x32_bf16 v[44:47], v[52:55], v[172:175], v[44:47]
    ds_read_b128 v[52:55], v8 offset:3072
    s_waitcnt lgkmcnt(4)
    v_mfma_f32_16x16x32_bf16 v[40:43], v[56:59], v[176:179], v[40:43]
    v_mfma_f32_16x16x32_bf16 v[44:47], v[56:59], v[180:183], v[44:47]
    ds_read_b128 v[56:59], v8 offset:5120
    s_waitcnt lgkmcnt(4)
    v_mfma_f32_16x16x32_bf16 v[40:43], v[60:63], v[184:187], v[40:43]
    v_mfma_f32_16x16x32_bf16 v[44:47], v[60:63], v[188:191], v[44:47]
    s_waitcnt lgkmcnt(3)
    s_barrier
    ds_read_b128 v[64:67], v1 offset:16384
    ds_read_b128 v[68:71], v1 offset:17408
    ds_read_b128 v[72:75], v1 offset:18432
    ds_read_b128 v[76:79], v1 offset:19456
    ds_read_b128 v[60:63], v8 offset:7168
    s_waitcnt lgkmcnt(7)
    v_mfma_f32_16x16x32_bf16 v[40:43], v[48:51], v[192:195], v[40:43]
    v_mfma_f32_16x16x32_bf16 v[44:47], v[48:51], v[196:199], v[44:47]
    ds_read_b128 v[48:51], v8 offset:1536
    s_waitcnt lgkmcnt(7)
    v_mfma_f32_16x16x32_bf16 v[40:43], v[52:55], v[200:203], v[40:43]
    v_mfma_f32_16x16x32_bf16 v[44:47], v[52:55], v[204:207], v[44:47]
    s_waitcnt lgkmcnt(2)
    v_mfma_f32_16x16x32_bf16 v[92:95], v[64:67], a[0:3], 0
    v_mfma_f32_16x16x32_bf16 v[96:99], v[64:67], a[16:19], 0
    v_mfma_f32_16x16x32_bf16 v[92:95], v[68:71], a[4:7], v[92:95]
    v_mfma_f32_16x16x32_bf16 v[96:99], v[68:71], a[20:23], v[96:99]
    v_mfma_f32_16x16x32_bf16 v[92:95], v[72:75], a[8:11], v[92:95]
    v_mfma_f32_16x16x32_bf16 v[96:99], v[72:75], a[24:27], v[96:99]
    v_mfma_f32_16x16x32_bf16 v[92:95], v[76:79], a[12:15], v[92:95]
    v_mfma_f32_16x16x32_bf16 v[96:99], v[76:79], a[28:31], v[96:99]
    ds_read_b128 v[52:55], v8 offset:3584
    s_waitcnt lgkmcnt(3)
    v_mfma_f32_16x16x32_bf16 v[40:43], v[56:59], v[208:211], v[40:43]
    v_mfma_f32_16x16x32_bf16 v[44:47], v[56:59], v[212:215], v[44:47]
    ds_read_b128 v[56:59], v8 offset:5632
    s_waitcnt lgkmcnt(3)
    v_mfma_f32_16x16x32_bf16 v[40:43], v[60:63], v[216:219], v[40:43]
    v_mfma_f32_16x16x32_bf16 v[44:47], v[60:63], v[220:223], v[44:47]
    v_max3_f32 v118, v92, v93, v94
    v_max3_f32 v118, v118, v95, v116
    v_max3_f32 v119, v96, v97, v98
    v_max3_f32 v119, v119, v99, v117
    v_mov_b32 v14, v118
    v_mov_b32 v15, v119
    ds_read_b128 v[60:63], v8 offset:7680
    s_waitcnt lgkmcnt(3)
    v_mfma_f32_16x16x32_bf16 v[40:43], v[48:51], v[224:227], v[40:43]
    v_mfma_f32_16x16x32_bf16 v[44:47], v[48:51], v[228:231], v[44:47]
    v_permlane16_swap_b32 v118, v14
    v_permlane16_swap_b32 v119, v15
    v_max_f32 v118, v118, v14
    v_max_f32 v119, v119, v15
    v_sub_f32 v92, v92, v118
    v_exp_f32 v92, v92
    s_waitcnt lgkmcnt(2)
    v_mfma_f32_16x16x32_bf16 v[40:43], v[52:55], v[232:235], v[40:43]
    v_mfma_f32_16x16x32_bf16 v[44:47], v[52:55], v[236:239], v[44:47]
    v_sub_f32 v93, v93, v118
    v_exp_f32 v93, v93
    v_sub_f32 v94, v94, v118
    v_exp_f32 v94, v94
    v_sub_f32 v95, v95, v118
    v_exp_f32 v95, v95
    s_waitcnt lgkmcnt(1)
    v_mfma_f32_16x16x32_bf16 v[40:43], v[56:59], v[240:243], v[40:43]
    v_mfma_f32_16x16x32_bf16 v[44:47], v[56:59], v[244:247], v[44:47]
    v_sub_f32 v104, v116, v118
    v_exp_f32 v104, v104
    v_cvt_pk_bf16_f32 v100, v92, v93
    v_cvt_pk_bf16_f32 v101, v94, v95
    v_sub_f32 v96, v96, v119
    v_exp_f32 v96, v96
    s_waitcnt lgkmcnt(0)
    v_mfma_f32_16x16x32_bf16 v[40:43], v[60:63], v[248:251], v[40:43]
    v_mfma_f32_16x16x32_bf16 v[44:47], v[60:63], v[252:255], v[44:47]
    v_sub_f32 v97, v97, v119
    v_exp_f32 v97, v97
    v_sub_f32 v98, v98, v119
    v_exp_f32 v98, v98
    v_sub_f32 v99, v99, v119
    v_exp_f32 v99, v99
    v_sub_f32 v105, v117, v119
    v_exp_f32 v105, v105
    v_cvt_pk_bf16_f32 v102, v96, v97
    v_cvt_pk_bf16_f32 v103, v98, v99
    v_mfma_f32_16x16x16_bf16 v[48:51], v[112:113], v[100:101], 0
    s_nop 0
    v_mfma_f32_16x16x16_bf16 v[52:55], v[112:113], v[102:103], 0
    v_cvt_pk_bf16_f32 v80, v40, v41
    v_cndmask_b32 v80, 0, v80, s[72:73]
    v_cvt_pk_bf16_f32 v81, v42, v43
    v_cndmask_b32 v81, 0, v81, s[72:73]
    v_cvt_pk_bf16_f32 v82, v44, v45
    v_cndmask_b32 v82, 0, v82, s[72:73]
    v_cvt_pk_bf16_f32 v83, v46, v47
    v_cndmask_b32 v83, 0, v83, s[72:73]
    v_mfma_f32_16x16x16_bf16 v[56:59], v[80:81], v[100:101], 0
    s_nop 0
    v_mfma_f32_16x16x16_bf16 v[60:63], v[82:83], v[100:101], 0
    v_mfma_f32_16x16x16_bf16 v[64:67], v[80:81], v[102:103], 0
    v_mfma_f32_16x16x16_bf16 v[68:71], v[82:83], v[102:103], 0
    v_fma_f32 v48, v16, v104, v48
    v_rcp_f32 v48, v48
    v_fma_f32 v52, v20, v105, v52
    v_rcp_f32 v52, v52
    v_fma_f32 v56, v24, v104, v56
    v_fma_f32 v57, v25, v104, v57
    v_fma_f32 v58, v26, v104, v58
    v_fma_f32 v59, v27, v104, v59
    v_fma_f32 v60, v28, v104, v60
    v_fma_f32 v61, v29, v104, v61
    v_fma_f32 v62, v30, v104, v62
    v_fma_f32 v63, v31, v104, v63
    v_pk_mul_f32 v[56:57], v[56:57], v[48:49] op_sel_hi:[1,0]
    v_pk_mul_f32 v[58:59], v[58:59], v[48:49] op_sel_hi:[1,0]
    v_pk_mul_f32 v[60:61], v[60:61], v[48:49] op_sel_hi:[1,0]
    v_pk_mul_f32 v[62:63], v[62:63], v[48:49] op_sel_hi:[1,0]
    v_cvt_pk_bf16_f32 v72, v56, v60
    v_cvt_pk_bf16_f32 v73, v57, v61
    v_cvt_pk_bf16_f32 v74, v58, v62
    v_cvt_pk_bf16_f32 v75, v59, v63
    ds_write_b128 v9, v[72:75] offset:0
    v_fma_f32 v64, v32, v105, v64
    v_fma_f32 v65, v33, v105, v65
    v_fma_f32 v66, v34, v105, v66
    v_fma_f32 v67, v35, v105, v67
    v_fma_f32 v68, v36, v105, v68
    v_fma_f32 v69, v37, v105, v69
    v_fma_f32 v70, v38, v105, v70
    v_fma_f32 v71, v39, v105, v71
    v_pk_mul_f32 v[64:65], v[64:65], v[52:53] op_sel_hi:[1,0]
    v_pk_mul_f32 v[66:67], v[66:67], v[52:53] op_sel_hi:[1,0]
    v_pk_mul_f32 v[68:69], v[68:69], v[52:53] op_sel_hi:[1,0]
    v_pk_mul_f32 v[70:71], v[70:71], v[52:53] op_sel_hi:[1,0]
    v_cvt_pk_bf16_f32 v76, v64, v68
    v_cvt_pk_bf16_f32 v77, v65, v69
    v_cvt_pk_bf16_f32 v78, v66, v70
    v_cvt_pk_bf16_f32 v79, v67, v71
    ds_write_b128 v9, v[76:79] offset:4096
    s_waitcnt lgkmcnt(0)
    s_barrier
    ds_read_b128 v[16:19], v1 offset:0
    ds_read_b128 v[20:23], v1 offset:1024
    ds_read_b128 v[24:27], v1 offset:2048
    ds_read_b128 v[28:31], v1 offset:3072
    ds_read_b128 v[32:35], v1 offset:4096
    ds_read_b128 v[36:39], v1 offset:5120
    ds_read_b128 v[40:43], v1 offset:6144
    ds_read_b128 v[44:47], v1 offset:7168
    ds_read_b128 v[48:51], v7 offset:0
    ds_read_b128 v[52:55], v7 offset:1024
    ds_read_b128 v[56:59], v7 offset:2048
    s_lshl_b32 s36, s20, 10
    s_add_u32 s25, s26, s36
    s_waitcnt lgkmcnt(2)
    v_mfma_f32_16x16x32_bf16 v[64:67], v[16:19], v[48:51], 0
    ds_read_b128 v[60:63], v7 offset:3072
    s_waitcnt lgkmcnt(2)
    v_mfma_f32_16x16x32_bf16 v[68:71], v[16:19], v[52:55], 0
    ds_read_b128 v[48:51], v7 offset:4096
    s_waitcnt lgkmcnt(2)
    v_mfma_f32_16x16x32_bf16 v[72:75], v[16:19], v[56:59], 0
    ds_read_b128 v[52:55], v7 offset:5120
    s_waitcnt lgkmcnt(2)
    v_mfma_f32_16x16x32_bf16 v[76:79], v[16:19], v[60:63], 0
    ds_read_b128 v[56:59], v7 offset:6144
    s_waitcnt lgkmcnt(2)
    v_mfma_f32_16x16x32_bf16 v[80:83], v[16:19], v[48:51], 0
    ds_read_b128 v[60:63], v7 offset:7168
    s_waitcnt lgkmcnt(2)
    v_mfma_f32_16x16x32_bf16 v[84:87], v[16:19], v[52:55], 0
    ds_read_b128 v[48:51], v7 offset:8192
    s_waitcnt lgkmcnt(2)
    v_mfma_f32_16x16x32_bf16 v[88:91], v[16:19], v[56:59], 0
    ds_read_b128 v[52:55], v7 offset:9216
    s_waitcnt lgkmcnt(2)
    v_mfma_f32_16x16x32_bf16 v[92:95], v[16:19], v[60:63], 0
    ds_read_b128 v[56:59], v7 offset:10240
    s_waitcnt lgkmcnt(2)
    v_mfma_f32_16x16x32_bf16 v[64:67], v[20:23], v[48:51], v[64:67]
    ds_read_b128 v[60:63], v7 offset:11264
    s_waitcnt lgkmcnt(2)
    v_mfma_f32_16x16x32_bf16 v[68:71], v[20:23], v[52:55], v[68:71]
    ds_read_b128 v[48:51], v7 offset:12288
    s_waitcnt lgkmcnt(2)
    v_mfma_f32_16x16x32_bf16 v[72:75], v[20:23], v[56:59], v[72:75]
    ds_read_b128 v[52:55], v7 offset:13312
    s_waitcnt lgkmcnt(2)
    v_mfma_f32_16x16x32_bf16 v[76:79], v[20:23], v[60:63], v[76:79]
    ds_read_b128 v[56:59], v7 offset:14336
    s_waitcnt lgkmcnt(2)
    v_mfma_f32_16x16x32_bf16 v[80:83], v[20:23], v[48:51], v[80:83]
    ds_read_b128 v[60:63], v7 offset:15360
    s_waitcnt lgkmcnt(2)
    v_mfma_f32_16x16x32_bf16 v[84:87], v[20:23], v[52:55], v[84:87]
    ds_read_b128 v[48:51], v7 offset:16384
    s_waitcnt lgkmcnt(2)
    v_mfma_f32_16x16x32_bf16 v[88:91], v[20:23], v[56:59], v[88:91]
    ds_read_b128 v[52:55], v7 offset:17408
    s_waitcnt lgkmcnt(2)
    v_mfma_f32_16x16x32_bf16 v[92:95], v[20:23], v[60:63], v[92:95]
    ds_read_b128 v[56:59], v7 offset:18432
    s_waitcnt lgkmcnt(2)
    v_mfma_f32_16x16x32_bf16 v[64:67], v[24:27], v[48:51], v[64:67]
    ds_read_b128 v[60:63], v7 offset:19456
    s_waitcnt lgkmcnt(2)
    v_mfma_f32_16x16x32_bf16 v[68:71], v[24:27], v[52:55], v[68:71]
    ds_read_b128 v[48:51], v7 offset:20480
    s_waitcnt lgkmcnt(2)
    v_mfma_f32_16x16x32_bf16 v[72:75], v[24:27], v[56:59], v[72:75]
    ds_read_b128 v[52:55], v7 offset:21504
    s_waitcnt lgkmcnt(2)
    v_mfma_f32_16x16x32_bf16 v[76:79], v[24:27], v[60:63], v[76:79]
    ds_read_b128 v[56:59], v7 offset:22528
    s_waitcnt lgkmcnt(2)
    v_mfma_f32_16x16x32_bf16 v[80:83], v[24:27], v[48:51], v[80:83]
    ds_read_b128 v[60:63], v7 offset:23552
    s_waitcnt lgkmcnt(2)
    v_mfma_f32_16x16x32_bf16 v[84:87], v[24:27], v[52:55], v[84:87]
    ds_read_b128 v[48:51], v7 offset:24576
    s_waitcnt lgkmcnt(2)
    v_mfma_f32_16x16x32_bf16 v[88:91], v[24:27], v[56:59], v[88:91]
    ds_read_b128 v[52:55], v7 offset:25600
    s_waitcnt lgkmcnt(2)
    v_mfma_f32_16x16x32_bf16 v[92:95], v[24:27], v[60:63], v[92:95]
    ds_read_b128 v[56:59], v7 offset:26624
    s_waitcnt lgkmcnt(2)
    v_mfma_f32_16x16x32_bf16 v[64:67], v[28:31], v[48:51], v[64:67]
    ds_read_b128 v[60:63], v7 offset:27648
    s_waitcnt lgkmcnt(2)
    v_mfma_f32_16x16x32_bf16 v[68:71], v[28:31], v[52:55], v[68:71]
    ds_read_b128 v[48:51], v7 offset:28672
    s_waitcnt lgkmcnt(2)
    v_mfma_f32_16x16x32_bf16 v[72:75], v[28:31], v[56:59], v[72:75]
    ds_read_b128 v[52:55], v7 offset:29696
    s_waitcnt lgkmcnt(2)
    v_mfma_f32_16x16x32_bf16 v[76:79], v[28:31], v[60:63], v[76:79]
    ds_read_b128 v[56:59], v7 offset:30720
    s_waitcnt lgkmcnt(2)
    v_mfma_f32_16x16x32_bf16 v[80:83], v[28:31], v[48:51], v[80:83]
    ds_read_b128 v[60:63], v7 offset:31744
    s_waitcnt lgkmcnt(2)
    v_mfma_f32_16x16x32_bf16 v[84:87], v[28:31], v[52:55], v[84:87]
    ds_read_b128 v[48:51], v7 offset:0
    s_waitcnt lgkmcnt(2)
    v_mfma_f32_16x16x32_bf16 v[88:91], v[28:31], v[56:59], v[88:91]
    ds_read_b128 v[52:55], v7 offset:1024
    s_waitcnt lgkmcnt(2)
    v_mfma_f32_16x16x32_bf16 v[92:95], v[28:31], v[60:63], v[92:95]
    ds_read_b128 v[56:59], v7 offset:2048
    s_waitcnt lgkmcnt(2)
    v_mfma_f32_16x16x32_bf16 v[96:99], v[32:35], v[48:51], 0
    ds_read_b128 v[60:63], v7 offset:3072
    s_waitcnt lgkmcnt(2)
    v_mfma_f32_16x16x32_bf16 v[100:103], v[32:35], v[52:55], 0
    ds_read_b128 v[48:51], v7 offset:4096
    s_waitcnt lgkmcnt(2)
    v_mfma_f32_16x16x32_bf16 v[104:107], v[32:35], v[56:59], 0
    ds_read_b128 v[52:55], v7 offset:5120
    s_waitcnt lgkmcnt(2)
    v_mfma_f32_16x16x32_bf16 v[108:111], v[32:35], v[60:63], 0
    ds_read_b128 v[56:59], v7 offset:6144
    v_cvt_pk_bf16_f32 v16, v64, v68
    s_waitcnt lgkmcnt(2)
    v_mfma_f32_16x16x32_bf16 v[112:115], v[32:35], v[48:51], 0
    ds_read_b128 v[60:63], v7 offset:7168
    v_cvt_pk_bf16_f32 v17, v72, v76
    s_waitcnt lgkmcnt(2)
    v_mfma_f32_16x16x32_bf16 v[116:119], v[32:35], v[52:55], 0
    ds_read_b128 v[48:51], v7 offset:8192
    v_cvt_pk_bf16_f32 v18, v80, v84
    s_waitcnt lgkmcnt(2)
    v_mfma_f32_16x16x32_bf16 v[120:123], v[32:35], v[56:59], 0
    ds_read_b128 v[52:55], v7 offset:9216
    v_cvt_pk_bf16_f32 v19, v88, v92
    s_waitcnt lgkmcnt(2)
    v_mfma_f32_16x16x32_bf16 v[124:127], v[32:35], v[60:63], 0
    ds_read_b128 v[56:59], v7 offset:10240
    v_and_or_b32 v16, v16, -2, s27
    s_waitcnt lgkmcnt(2)
    v_mfma_f32_16x16x32_bf16 v[96:99], v[36:39], v[48:51], v[96:99]
    ds_read_b128 v[60:63], v7 offset:11264
    s_add_u32 s36, s25, 0x0
    s_waitcnt lgkmcnt(2)
    v_mfma_f32_16x16x32_bf16 v[100:103], v[36:39], v[52:55], v[100:103]
    ds_read_b128 v[48:51], v7 offset:12288
    buffer_store_dwordx4 v[16:19], v10, s[8:11], s36 offen sc1
    s_waitcnt lgkmcnt(2)
    v_mfma_f32_16x16x32_bf16 v[104:107], v[36:39], v[56:59], v[104:107]
    ds_read_b128 v[52:55], v7 offset:13312
    v_cvt_pk_bf16_f32 v20, v65, v69
    s_waitcnt lgkmcnt(2)
    v_mfma_f32_16x16x32_bf16 v[108:111], v[36:39], v[60:63], v[108:111]
    ds_read_b128 v[56:59], v7 offset:14336
    v_cvt_pk_bf16_f32 v21, v73, v77
    s_waitcnt lgkmcnt(2)
    v_mfma_f32_16x16x32_bf16 v[112:115], v[36:39], v[48:51], v[112:115]
    ds_read_b128 v[60:63], v7 offset:15360
    v_cvt_pk_bf16_f32 v22, v81, v85
    s_waitcnt lgkmcnt(2)
    v_mfma_f32_16x16x32_bf16 v[116:119], v[36:39], v[52:55], v[116:119]
    ds_read_b128 v[48:51], v7 offset:16384
    v_cvt_pk_bf16_f32 v23, v89, v93
    s_waitcnt lgkmcnt(2)
    v_mfma_f32_16x16x32_bf16 v[120:123], v[36:39], v[56:59], v[120:123]
    ds_read_b128 v[52:55], v7 offset:17408
    v_and_or_b32 v20, v20, -2, s27
    s_waitcnt lgkmcnt(2)
    v_mfma_f32_16x16x32_bf16 v[124:127], v[36:39], v[60:63], v[124:127]
    ds_read_b128 v[56:59], v7 offset:18432
    s_add_u32 s36, s25, 0x8000
    s_waitcnt lgkmcnt(2)
    v_mfma_f32_16x16x32_bf16 v[96:99], v[40:43], v[48:51], v[96:99]
    ds_read_b128 v[60:63], v7 offset:19456
    buffer_store_dwordx4 v[20:23], v10, s[8:11], s36 offen sc1
    s_waitcnt lgkmcnt(2)
    v_mfma_f32_16x16x32_bf16 v[100:103], v[40:43], v[52:55], v[100:103]
    ds_read_b128 v[48:51], v7 offset:20480
    v_cvt_pk_bf16_f32 v24, v66, v70
    s_waitcnt lgkmcnt(2)
    v_mfma_f32_16x16x32_bf16 v[104:107], v[40:43], v[56:59], v[104:107]
    ds_read_b128 v[52:55], v7 offset:21504
    v_cvt_pk_bf16_f32 v25, v74, v78
    s_waitcnt lgkmcnt(2)
    v_mfma_f32_16x16x32_bf16 v[108:111], v[40:43], v[60:63], v[108:111]
    ds_read_b128 v[56:59], v7 offset:22528
    v_cvt_pk_bf16_f32 v26, v82, v86
    s_waitcnt lgkmcnt(2)
    v_mfma_f32_16x16x32_bf16 v[112:115], v[40:43], v[48:51], v[112:115]
    ds_read_b128 v[60:63], v7 offset:23552
    v_cvt_pk_bf16_f32 v27, v90, v94
    s_waitcnt lgkmcnt(2)
    v_mfma_f32_16x16x32_bf16 v[116:119], v[40:43], v[52:55], v[116:119]
    ds_read_b128 v[48:51], v7 offset:24576
    v_and_or_b32 v24, v24, -2, s27
    s_waitcnt lgkmcnt(2)
    v_mfma_f32_16x16x32_bf16 v[120:123], v[40:43], v[56:59], v[120:123]
    ds_read_b128 v[52:55], v7 offset:25600
    s_add_u32 s36, s25, 0x10000
    s_waitcnt lgkmcnt(2)
    v_mfma_f32_16x16x32_bf16 v[124:127], v[40:43], v[60:63], v[124:127]
    ds_read_b128 v[56:59], v7 offset:26624
    buffer_store_dwordx4 v[24:27], v10, s[8:11], s36 offen sc1
    s_waitcnt lgkmcnt(2)
    v_mfma_f32_16x16x32_bf16 v[96:99], v[44:47], v[48:51], v[96:99]
    ds_read_b128 v[60:63], v7 offset:27648
    v_cvt_pk_bf16_f32 v28, v67, v71
    s_waitcnt lgkmcnt(2)
    v_mfma_f32_16x16x32_bf16 v[100:103], v[44:47], v[52:55], v[100:103]
    ds_read_b128 v[48:51], v7 offset:28672
    v_cvt_pk_bf16_f32 v29, v75, v79
    s_waitcnt lgkmcnt(2)
    v_mfma_f32_16x16x32_bf16 v[104:107], v[44:47], v[56:59], v[104:107]
    ds_read_b128 v[52:55], v7 offset:29696
    v_cvt_pk_bf16_f32 v30, v83, v87
    s_waitcnt lgkmcnt(2)
    v_mfma_f32_16x16x32_bf16 v[108:111], v[44:47], v[60:63], v[108:111]
    ds_read_b128 v[56:59], v7 offset:30720
    v_cvt_pk_bf16_f32 v31, v91, v95
    s_waitcnt lgkmcnt(2)
    v_mfma_f32_16x16x32_bf16 v[112:115], v[44:47], v[48:51], v[112:115]
    ds_read_b128 v[60:63], v7 offset:31744
    v_and_or_b32 v28, v28, -2, s27
    s_waitcnt lgkmcnt(2)
    v_mfma_f32_16x16x32_bf16 v[116:119], v[44:47], v[52:55], v[116:119]
    s_add_u32 s36, s25, 0x18000
    s_waitcnt lgkmcnt(1)
    v_mfma_f32_16x16x32_bf16 v[120:123], v[44:47], v[56:59], v[120:123]
    buffer_store_dwordx4 v[28:31], v10, s[8:11], s36 offen sc1
    s_waitcnt lgkmcnt(0)
    v_mfma_f32_16x16x32_bf16 v[124:127], v[44:47], v[60:63], v[124:127]
    v_cvt_pk_bf16_f32 v32, v96, v100
    v_cvt_pk_bf16_f32 v33, v104, v108
    v_cvt_pk_bf16_f32 v34, v112, v116
    s_nop 4
    v_cvt_pk_bf16_f32 v35, v120, v124
    v_and_or_b32 v32, v32, -2, s27
    s_add_u32 s36, s25, 0x80000
    buffer_store_dwordx4 v[32:35], v10, s[8:11], s36 offen sc1
    v_cvt_pk_bf16_f32 v36, v97, v101
    v_cvt_pk_bf16_f32 v37, v105, v109
    v_cvt_pk_bf16_f32 v38, v113, v117
    v_cvt_pk_bf16_f32 v39, v121, v125
    v_and_or_b32 v36, v36, -2, s27
    s_add_u32 s36, s25, 0x88000
    buffer_store_dwordx4 v[36:39], v10, s[8:11], s36 offen sc1
    v_cvt_pk_bf16_f32 v40, v98, v102
    v_cvt_pk_bf16_f32 v41, v106, v110
    v_cvt_pk_bf16_f32 v42, v114, v118
    v_cvt_pk_bf16_f32 v43, v122, v126
    v_and_or_b32 v40, v40, -2, s27
    s_add_u32 s36, s25, 0x90000
    buffer_store_dwordx4 v[40:43], v10, s[8:11], s36 offen sc1
    v_cvt_pk_bf16_f32 v44, v99, v103
    v_cvt_pk_bf16_f32 v45, v107, v111
    v_cvt_pk_bf16_f32 v46, v115, v119
    v_cvt_pk_bf16_f32 v47, v123, v127
    v_and_or_b32 v44, v44, -2, s27
    s_add_u32 s36, s25, 0x98000
    buffer_store_dwordx4 v[44:47], v10, s[8:11], s36 offen sc1
    s_add_u32 s38, s23, 6
    s_cmp_ge_u32 s38, 64
    s_cbranch_scc1 L_P2_last
    s_mul_i32 s24, s38, 0x82000
    s_lshl_b32 s36, s20, 14
    s_add_u32 s24, s24, s36
    s_add_u32 s24, s24, 0x1000000
    s_add_u32 s36, s24, 0
    s_add_u32 s37, s36, 0x7000000
    buffer_load_dwordx4 a[32:35], v1, s[8:11], s36 offen offset:0 sc1
    buffer_load_dwordx4 a[0:3], v1, s[8:11], s37 offen offset:0 sc1
    buffer_load_dwordx4 a[36:39], v1, s[8:11], s36 offen offset:1024 sc1
    buffer_load_dwordx4 a[4:7], v1, s[8:11], s37 offen offset:1024 sc1
    buffer_load_dwordx4 a[40:43], v1, s[8:11], s36 offen offset:2048 sc1
    buffer_load_dwordx4 a[8:11], v1, s[8:11], s37 offen offset:2048 sc1
    buffer_load_dwordx4 a[44:47], v1, s[8:11], s36 offen offset:3072 sc1
    buffer_load_dwordx4 a[12:15], v1, s[8:11], s37 offen offset:3072 sc1
    s_add_u32 s36, s24, 4096
    s_add_u32 s37, s36, 0x7000000
    buffer_load_dwordx4 a[48:51], v1, s[8:11], s36 offen offset:0 sc1
    buffer_load_dwordx4 a[16:19], v1, s[8:11], s37 offen offset:0 sc1
    buffer_load_dwordx4 a[52:55], v1, s[8:11], s36 offen offset:1024 sc1
    buffer_load_dwordx4 a[20:23], v1, s[8:11], s37 offen offset:1024 sc1
    buffer_load_dwordx4 a[56:59], v1, s[8:11], s36 offen offset:2048 sc1
    buffer_load_dwordx4 a[24:27], v1, s[8:11], s37 offen offset:2048 sc1
    buffer_load_dwordx4 a[60:63], v1, s[8:11], s36 offen offset:3072 sc1
    buffer_load_dwordx4 a[28:31], v1, s[8:11], s37 offen offset:3072 sc1
    s_lshr_b32 s36, s21, 1
    s_lshl_b32 s36, s36, 3
    s_xor_b32 s37, s36, 8
    s_add_u32 s24, s24, 8192
    s_add_u32 s36, s36, s24
    s_add_u32 s37, s37, s24
    buffer_load_dwordx2 a[64:65], v2, s[8:11], s36 offen offset:0 sc1
    buffer_load_dwordx2 a[66:67], v2, s[8:11], s37 offen offset:0 sc1
    buffer_load_dwordx2 a[68:69], v2, s[8:11], s36 offen offset:1024 sc1
    buffer_load_dwordx2 a[70:71], v2, s[8:11], s37 offen offset:1024 sc1
L_P2_last:
    s_lshl_b32 s24, s23, 5
    s_add_u32 s24, s24, s20
    s_lshl_b32 s24, s24, 10
    v_accvgpr_read_b32 v52, a72
    v_accvgpr_read_b32 v53, a73
    v_and_b32 v15, 15, v0
    v_mov_b32 v48, 0
    v_mov_b32 v14, 0x3f80
    v_cmp_eq_u32 vcc, 0, v15
    s_nop 1
    v_cndmask_b32 v48, v48, v14, vcc
    v_mov_b32 v14, 0x3f800000
    v_cmp_eq_u32 vcc, 1, v15
    s_nop 1
    v_cndmask_b32 v48, v48, v14, vcc
    v_mov_b32 v49, 0
    v_mov_b32 v14, 0x3f80
    v_cmp_eq_u32 vcc, 4, v15
    s_nop 1
    v_cndmask_b32 v49, v49, v14, vcc
    v_mov_b32 v14, 0x3f800000
    v_cmp_eq_u32 vcc, 5, v15
    s_nop 1
    v_cndmask_b32 v49, v49, v14, vcc
    v_mov_b32 v50, 0
    v_mov_b32 v14, 0x3f80
    v_cmp_eq_u32 vcc, 8, v15
    s_nop 1
    v_cndmask_b32 v50, v50, v14, vcc
    v_mov_b32 v14, 0x3f800000
    v_cmp_eq_u32 vcc, 9, v15
    s_nop 1
    v_cndmask_b32 v50, v50, v14, vcc
    v_mov_b32 v51, 0
    v_mov_b32 v14, 0x3f80
    v_cmp_eq_u32 vcc, 12, v15
    s_nop 1
    v_cndmask_b32 v51, v51, v14, vcc
    v_mov_b32 v14, 0x3f800000
    v_cmp_eq_u32 vcc, 13, v15
    s_nop 1
    v_cndmask_b32 v51, v51, v14, vcc
    s_lshl_b32 s25, s20, 15
    s_add_u32 s25, s25, s26
L_P3_poll:
    s_add_u32 s36, s25, 0
    buffer_load_dwordx4 v[80:83], v11, s[8:11], s36 offen sc1
    s_add_u32 s36, s25, 4096
    buffer_load_dwordx4 v[84:87], v11, s[8:11], s36 offen sc1
    s_add_u32 s36, s25, 8192
    buffer_load_dwordx4 v[88:91], v11, s[8:11], s36 offen sc1
    s_add_u32 s36, s25, 12288
    buffer_load_dwordx4 v[92:95], v11, s[8:11], s36 offen sc1
    s_add_u32 s36, s25, 16384
    buffer_load_dwordx4 v[96:99], v11, s[8:11], s36 offen sc1
    s_add_u32 s36, s25, 20480
    buffer_load_dwordx4 v[100:103], v11, s[8:11], s36 offen sc1
    s_add_u32 s36, s25, 24576
    buffer_load_dwordx4 v[104:107], v11, s[8:11], s36 offen sc1
    s_add_u32 s36, s25, 28672
    buffer_load_dwordx4 v[108:111], v11, s[8:11], s36 offen sc1
    s_mov_b64 exec, -1
    s_add_u32 s32, s32, 1
    s_cmp_gt_u32 s32, 200000
    s_waitcnt vmcnt(7)
    v_mfma_f32_16x16x32_bf16 v[56:59], v[48:51], v[80:83], 0
    s_waitcnt vmcnt(6)
    v_mfma_f32_16x16x32_bf16 v[56:59], v[48:51], v[84:87], v[56:59]
    v_bitop3_b32 v60, v80, v84, s27 bitop3:0x7e
    s_waitcnt vmcnt(5)
    v_mfma_f32_16x16x32_bf16 v[56:59], v[48:51], v[88:91], v[56:59]
    s_waitcnt vmcnt(4)
    v_mfma_f32_16x16x32_bf16 v[56:59], v[48:51], v[92:95], v[56:59]
    v_bitop3_b32 v61, v88, v92, s27 bitop3:0x7e
    s_waitcnt vmcnt(3)
    v_mfma_f32_16x16x32_bf16 v[56:59], v[48:51], v[96:99], v[56:59]
    s_waitcnt vmcnt(2)
    v_mfma_f32_16x16x32_bf16 v[56:59], v[48:51], v[100:103], v[56:59]
    v_bitop3_b32 v62, v96, v100, s27 bitop3:0x7e
    s_waitcnt vmcnt(1)
    v_mfma_f32_16x16x32_bf16 v[56:59], v[48:51], v[104:107], v[56:59]
    s_waitcnt vmcnt(0)
    v_mfma_f32_16x16x32_bf16 v[56:59], v[48:51], v[108:111], v[56:59]
    v_bitop3_b32 v63, v104, v108, s27 bitop3:0x7e
    v_or3_b32 v14, v60, v61, v62
    v_bitop3_b32 v14, v14, v63, 1 bitop3:0xa8
    s_cbranch_scc1 L_P3_got
    v_cmp_ne_u32 vcc, 0, v14
    s_cbranch_vccz L_P3_got
    s_mov_b64 exec, vcc
    s_branch L_P3_poll
L_P3_got:
    s_nop 4
    v_cvt_pk_bf16_f32 v62, v56, v57
    v_lshlrev_b32 v65, 16, v62
    v_and_b32 v66, 0xffff0000, v62
    v_lshlrev_b32 v60, 16, v52
    v_and_b32 v61, 0xffff0000, v52
    v_add_f32 v60, v60, v65
    v_add_f32 v61, v61, v66
    v_cvt_pk_bf16_f32 v62, v60, v61
    v_lshlrev_b32 v60, 16, v62
    v_and_b32 v61, 0xffff0000, v62
    v_add_f32 v63, v60, v61
    v_mul_f32 v64, v60, v60
    v_fmac_f32 v64, v61, v61
    v_add_f32_dpp v63, v63, v63 quad_perm:[1,0,3,2] row_mask:0xf bank_mask:0xf
    s_nop 0
    v_add_f32_dpp v64, v64, v64 quad_perm:[1,0,3,2] row_mask:0xf bank_mask:0xf
    v_add_f32_dpp v63, v63, v63 quad_perm:[2,3,0,1] row_mask:0xf bank_mask:0xf
    s_nop 0
    v_add_f32_dpp v64, v64, v64 quad_perm:[2,3,0,1] row_mask:0xf bank_mask:0xf
    v_add_f32_dpp v63, v63, v63 row_half_mirror row_mask:0xf bank_mask:0xf
    s_nop 0
    v_add_f32_dpp v64, v64, v64 row_half_mirror row_mask:0xf bank_mask:0xf
    v_add_f32_dpp v63, v63, v63 row_mirror row_mask:0xf bank_mask:0xf
    s_nop 0
    v_add_f32_dpp v64, v64, v64 row_mirror row_mask:0xf bank_mask:0xf
    v_mov_b32 v14, v63
    s_nop 1
    v_permlane16_swap_b32 v63, v14
    v_add_f32 v63, v63, v14
    v_mov_b32 v14, v64
    s_nop 1
    v_permlane16_swap_b32 v64, v14
    v_add_f32 v64, v64, v14
    v_mov_b32 v14, v63
    s_nop 1
    v_permlane32_swap_b32 v63, v14
    v_add_f32 v63, v63, v14
    v_mov_b32 v14, v64
    s_nop 1
    v_permlane32_swap_b32 v64, v14
    v_add_f32 v64, v64, v14
    v_mov_b32 v15, s21
    v_lshlrev_b32 v15, 3, v15
    v_add_u32 v15, 28672, v15
    ds_write2_b32 v15, v63, v64 offset0:0 offset1:1
    s_add_u32 s36, s24, 0x400000
    buffer_store_dword v62, v12, s[8:11], s36 offen sc1
    s_waitcnt lgkmcnt(0)
    s_barrier
    v_mov_b32 v15, 28672
    ds_read_b128 v[68:71], v15
    ds_read_b128 v[72:75], v15 offset:16
    s_waitcnt lgkmcnt(0)
    v_add_f32 v63, v68, v70
    v_add_f32 v63, v63, v72
    v_add_f32 v63, v63, v74
    v_mul_f32 v63, 0x3b000000, v63
    v_add_f32 v64, v69, v71
    v_add_f32 v64, v64, v73
    v_add_f32 v64, v64, v75
    v_mul_f32 v64, 0x3b000000, v64
    v_fma_f32 v64, -v63, v63, v64
    v_max_f32 v64, 0, v64
    v_cvt_pk_bf16_f32 v14, v63, v64
    v_lshlrev_b32 v63, 16, v14
    v_and_b32 v64, 0xffff0000, v14
    v_add_f32 v64, 0x3727c5ac, v64
    v_cvt_pk_bf16_f32 v14, v64, v64
    v_lshlrev_b32 v64, 16, v14
    v_sqrt_f32 v64, v64
    s_nop 0
    v_cvt_pk_bf16_f32 v14, v64, v64
    v_lshlrev_b32 v64, 16, v14
    v_rcp_f32 v64, v64
    v_sub_f32 v65, v60, v63
    v_sub_f32 v66, v61, v63
    v_cvt_pk_bf16_f32 v14, v65, v66
    v_lshlrev_b32 v65, 16, v14
    v_and_b32 v66, 0xffff0000, v14
    v_mul_f32 v65, v65, v64
    v_mul_f32 v66, v66, v64
    v_cvt_pk_bf16_f32 v67, v65, v66
    v_lshlrev_b32 v65, 16, v67
    v_and_b32 v66, 0xffff0000, v67
    v_lshlrev_b32 v68, 16, v53
    v_and_b32 v69, 0xffff0000, v53
    v_mul_f32 v63, v65, v68
    v_fmac_f32 v63, v66, v69
    s_nop 1
    v_add_f32_dpp v63, v63, v63 quad_perm:[1,0,3,2] row_mask:0xf bank_mask:0xf
    s_nop 1
    v_add_f32_dpp v63, v63, v63 quad_perm:[2,3,0,1] row_mask:0xf bank_mask:0xf
    s_nop 1
    v_add_f32_dpp v63, v63, v63 row_half_mirror row_mask:0xf bank_mask:0xf
    s_nop 1
    v_add_f32_dpp v63, v63, v63 row_mirror row_mask:0xf bank_mask:0xf
    v_mov_b32 v14, v63
    s_nop 1
    v_permlane16_swap_b32 v63, v14
    v_add_f32 v63, v63, v14
    v_mov_b32 v14, v63
    s_nop 1
    v_permlane32_swap_b32 v63, v14
    v_add_f32 v63, v63, v14
    s_lshr_b32 s25, s24, 6
    s_lshl_b32 s37, s21, 2
    s_add_u32 s25, s25, s37
    s_add_u32 s36, s25, 0x194000
    v_cmp_ne_u32 vcc, 0, v1
    v_mov_b32 v15, 0x40000000
    s_nop 0
    v_cndmask_b32 v15, v1, v15, vcc
    buffer_store_dword v63, v15, s[8:11], s36 offen sc1
    v_add_f32 v60, v60, v65
    v_add_f32 v61, v61, v66
    v_cvt_pk_bf16_f32 v62, v60, v61
    buffer_store_dword v62, v12, s[60:63], s24 offen sc1
    s_add_u32 s36, s24, 0x600000
    buffer_store_dword v67, v12, s[8:11], s36 offen sc1
    s_add_u32 s30, s25, 0x1b8000
    s_add_u32 s29, s29, 1
    s_barrier
    s_add_u32 s23, s23, 6
    s_cmp_lt_u32 s23, 64
    s_cbranch_scc1 L_P2
    s_waitcnt vmcnt(0)
    v_cmp_ne_u32 vcc, 0, v1
    v_mov_b32 v15, 0x40000000
    v_mov_b32 v14, 0
    v_cndmask_b32 v15, v1, v15, vcc
    buffer_store_dword v14, v15, s[8:11], s30 offen sc1
    s_branch L_end
L_mlp:
    s_lshr_b32 s23, s2, 3
    s_lshl_b32 s23, s23, 1
    s_lshl_b32 s36, s23, 15
    buffer_load_dwordx4 v[96:99], v3, s[12:15], s36 offen offset:0
    buffer_load_dwordx4 v[100:103], v3, s[12:15], s36 offen offset:128
    buffer_load_dwordx4 v[104:107], v3, s[12:15], s36 offen offset:256
    buffer_load_dwordx4 v[108:111], v3, s[12:15], s36 offen offset:384
    buffer_load_dwordx4 v[112:115], v3, s[12:15], s36 offen offset:512
    buffer_load_dwordx4 v[116:119], v3, s[12:15], s36 offen offset:640
    buffer_load_dwordx4 v[120:123], v3, s[12:15], s36 offen offset:768
    buffer_load_dwordx4 v[124:127], v3, s[12:15], s36 offen offset:896
    s_waitcnt vmcnt(0)
    v_mov_b32 v16, 0
    v_mov_b32 v17, 0
    v_dot2_f32_bf16 v16, v96, s4, v16
    v_dot2_f32_bf16 v17, v96, v96, v17
    v_dot2_f32_bf16 v16, v97, s4, v16
    v_dot2_f32_bf16 v17, v97, v97, v17
    v_dot2_f32_bf16 v16, v98, s4, v16
    v_dot2_f32_bf16 v17, v98, v98, v17
    v_dot2_f32_bf16 v16, v99, s4, v16
    v_dot2_f32_bf16 v17, v99, v99, v17
    v_dot2_f32_bf16 v16, v100, s4, v16
    v_dot2_f32_bf16 v17, v100, v100, v17
    v_dot2_f32_bf16 v16, v101, s4, v16
    v_dot2_f32_bf16 v17, v101, v101, v17
    v_dot2_f32_bf16 v16, v102, s4, v16
    v_dot2_f32_bf16 v17, v102, v102, v17
    v_dot2_f32_bf16 v16, v103, s4, v16
    v_dot2_f32_bf16 v17, v103, v103, v17
    v_dot2_f32_bf16 v16, v104, s4, v16
    v_dot2_f32_bf16 v17, v104, v104, v17
    v_dot2_f32_bf16 v16, v105, s4, v16
    v_dot2_f32_bf16 v17, v105, v105, v17
    v_dot2_f32_bf16 v16, v106, s4, v16
    v_dot2_f32_bf16 v17, v106, v106, v17
    v_dot2_f32_bf16 v16, v107, s4, v16
    v_dot2_f32_bf16 v17, v107, v107, v17
    v_dot2_f32_bf16 v16, v108, s4, v16
    v_dot2_f32_bf16 v17, v108, v108, v17
    v_dot2_f32_bf16 v16, v109, s4, v16
    v_dot2_f32_bf16 v17, v109, v109, v17
    v_dot2_f32_bf16 v16, v110, s4, v16
    v_dot2_f32_bf16 v17, v110, v110, v17
    v_dot2_f32_bf16 v16, v111, s4, v16
    v_dot2_f32_bf16 v17, v111, v111, v17
    v_dot2_f32_bf16 v16, v112, s4, v16
    v_dot2_f32_bf16 v17, v112, v112, v17
    v_dot2_f32_bf16 v16, v113, s4, v16
    v_dot2_f32_bf16 v17, v113, v113, v17
    v_dot2_f32_bf16 v16, v114, s4, v16
    v_dot2_f32_bf16 v17, v114, v114, v17
    v_dot2_f32_bf16 v16, v115, s4, v16
    v_dot2_f32_bf16 v17, v115, v115, v17
    v_dot2_f32_bf16 v16, v116, s4, v16
    v_dot2_f32_bf16 v17, v116, v116, v17
    v_dot2_f32_bf16 v16, v117, s4, v16
    v_dot2_f32_bf16 v17, v117, v117, v17
    v_dot2_f32_bf16 v16, v118, s4, v16
    v_dot2_f32_bf16 v17, v118, v118, v17
    v_dot2_f32_bf16 v16, v119, s4, v16
    v_dot2_f32_bf16 v17, v119, v119, v17
    v_dot2_f32_bf16 v16, v120, s4, v16
    v_dot2_f32_bf16 v17, v120, v120, v17
    v_dot2_f32_bf16 v16, v121, s4, v16
    v_dot2_f32_bf16 v17, v121, v121, v17
    v_dot2_f32_bf16 v16, v122, s4, v16
    v_dot2_f32_bf16 v17, v122, v122, v17
    v_dot2_f32_bf16 v16, v123, s4, v16
    v_dot2_f32_bf16 v17, v123, v123, v17
    v_dot2_f32_bf16 v16, v124, s4, v16
    v_dot2_f32_bf16 v17, v124, v124, v17
    v_dot2_f32_bf16 v16, v125, s4, v16
    v_dot2_f32_bf16 v17, v125, v125, v17
    v_dot2_f32_bf16 v16, v126, s4, v16
    v_dot2_f32_bf16 v17, v126, v126, v17
    v_dot2_f32_bf16 v16, v127, s4, v16
    v_dot2_f32_bf16 v17, v127, v127, v17
    s_nop 3
    v_add_f32_dpp v16, v16, v16 quad_perm:[1,0,3,2] row_mask:0xf bank_mask:0xf
    v_add_f32_dpp v17, v17, v17 quad_perm:[1,0,3,2] row_mask:0xf bank_mask:0xf
    s_nop 0
    v_add_f32_dpp v16, v16, v16 quad_perm:[2,3,0,1] row_mask:0xf bank_mask:0xf
    v_add_f32_dpp v17, v17, v17 quad_perm:[2,3,0,1] row_mask:0xf bank_mask:0xf
    s_nop 0
    v_add_f32_dpp v16, v16, v16 row_half_mirror row_mask:0xf bank_mask:0xf
    v_add_f32_dpp v17, v17, v17 row_half_mirror row_mask:0xf bank_mask:0xf
    v_mul_f32 v16, 0x3b000000, v16
    v_mul_f32 v17, 0x3b000000, v17
    v_fma_f32 v17, -v16, v16, v17
    v_max_f32 v17, 0, v17
    v_cvt_pk_bf16_f32 v14, v16, v17
    v_lshlrev_b32 v16, 16, v14
    v_and_b32 v17, 0xffff0000, v14
    v_add_f32 v17, 0x3727c5ac, v17
    v_cvt_pk_bf16_f32 v14, v17, v17
    v_lshlrev_b32 v17, 16, v14
    v_sqrt_f32 v17, v17
    s_nop 0
    v_cvt_pk_bf16_f32 v14, v17, v17
    v_lshlrev_b32 v17, 16, v14
    v_rcp_f32 v17, v17
    v_lshlrev_b32 v18, 16, v96
    v_and_b32 v19, 0xffff0000, v96
    v_sub_f32 v18, v18, v16
    v_sub_f32 v19, v19, v16
    v_cvt_pk_bf16_f32 v96, v18, v19
    v_lshlrev_b32 v18, 16, v96
    v_and_b32 v19, 0xffff0000, v96
    v_mul_f32 v18, v18, v17
    v_mul_f32 v19, v19, v17
    v_cvt_pk_bf16_f32 v96, v18, v19
    v_lshlrev_b32 v18, 16, v97
    v_and_b32 v19, 0xffff0000, v97
    v_sub_f32 v18, v18, v16
    v_sub_f32 v19, v19, v16
    v_cvt_pk_bf16_f32 v97, v18, v19
    v_lshlrev_b32 v18, 16, v97
    v_and_b32 v19, 0xffff0000, v97
    v_mul_f32 v18, v18, v17
    v_mul_f32 v19, v19, v17
    v_cvt_pk_bf16_f32 v97, v18, v19
    v_lshlrev_b32 v18, 16, v98
    v_and_b32 v19, 0xffff0000, v98
    v_sub_f32 v18, v18, v16
    v_sub_f32 v19, v19, v16
    v_cvt_pk_bf16_f32 v98, v18, v19
    v_lshlrev_b32 v18, 16, v98
    v_and_b32 v19, 0xffff0000, v98
    v_mul_f32 v18, v18, v17
    v_mul_f32 v19, v19, v17
    v_cvt_pk_bf16_f32 v98, v18, v19
    v_lshlrev_b32 v18, 16, v99
    v_and_b32 v19, 0xffff0000, v99
    v_sub_f32 v18, v18, v16
    v_sub_f32 v19, v19, v16
    v_cvt_pk_bf16_f32 v99, v18, v19
    v_lshlrev_b32 v18, 16, v99
    v_and_b32 v19, 0xffff0000, v99
    v_mul_f32 v18, v18, v17
    v_mul_f32 v19, v19, v17
    v_cvt_pk_bf16_f32 v99, v18, v19
    ds_write_b128 v4, v[96:99] offset:0
    v_lshlrev_b32 v18, 16, v100
    v_and_b32 v19, 0xffff0000, v100
    v_sub_f32 v18, v18, v16
    v_sub_f32 v19, v19, v16
    v_cvt_pk_bf16_f32 v100, v18, v19
    v_lshlrev_b32 v18, 16, v100
    v_and_b32 v19, 0xffff0000, v100
    v_mul_f32 v18, v18, v17
    v_mul_f32 v19, v19, v17
    v_cvt_pk_bf16_f32 v100, v18, v19
    v_lshlrev_b32 v18, 16, v101
    v_and_b32 v19, 0xffff0000, v101
    v_sub_f32 v18, v18, v16
    v_sub_f32 v19, v19, v16
    v_cvt_pk_bf16_f32 v101, v18, v19
    v_lshlrev_b32 v18, 16, v101
    v_and_b32 v19, 0xffff0000, v101
    v_mul_f32 v18, v18, v17
    v_mul_f32 v19, v19, v17
    v_cvt_pk_bf16_f32 v101, v18, v19
    v_lshlrev_b32 v18, 16, v102
    v_and_b32 v19, 0xffff0000, v102
    v_sub_f32 v18, v18, v16
    v_sub_f32 v19, v19, v16
    v_cvt_pk_bf16_f32 v102, v18, v19
    v_lshlrev_b32 v18, 16, v102
    v_and_b32 v19, 0xffff0000, v102
    v_mul_f32 v18, v18, v17
    v_mul_f32 v19, v19, v17
    v_cvt_pk_bf16_f32 v102, v18, v19
    v_lshlrev_b32 v18, 16, v103
    v_and_b32 v19, 0xffff0000, v103
    v_sub_f32 v18, v18, v16
    v_sub_f32 v19, v19, v16
    v_cvt_pk_bf16_f32 v103, v18, v19
    v_lshlrev_b32 v18, 16, v103
    v_and_b32 v19, 0xffff0000, v103
    v_mul_f32 v18, v18, v17
    v_mul_f32 v19, v19, v17
    v_cvt_pk_bf16_f32 v103, v18, v19
    ds_write_b128 v4, v[100:103] offset:2048
    v_lshlrev_b32 v18, 16, v104
    v_and_b32 v19, 0xffff0000, v104
    v_sub_f32 v18, v18, v16
    v_sub_f32 v19, v19, v16
    v_cvt_pk_bf16_f32 v104, v18, v19
    v_lshlrev_b32 v18, 16, v104
    v_and_b32 v19, 0xffff0000, v104
    v_mul_f32 v18, v18, v17
    v_mul_f32 v19, v19, v17
    v_cvt_pk_bf16_f32 v104, v18, v19
    v_lshlrev_b32 v18, 16, v105
    v_and_b32 v19, 0xffff0000, v105
    v_sub_f32 v18, v18, v16
    v_sub_f32 v19, v19, v16
    v_cvt_pk_bf16_f32 v105, v18, v19
    v_lshlrev_b32 v18, 16, v105
    v_and_b32 v19, 0xffff0000, v105
    v_mul_f32 v18, v18, v17
    v_mul_f32 v19, v19, v17
    v_cvt_pk_bf16_f32 v105, v18, v19
    v_lshlrev_b32 v18, 16, v106
    v_and_b32 v19, 0xffff0000, v106
    v_sub_f32 v18, v18, v16
    v_sub_f32 v19, v19, v16
    v_cvt_pk_bf16_f32 v106, v18, v19
    v_lshlrev_b32 v18, 16, v106
    v_and_b32 v19, 0xffff0000, v106
    v_mul_f32 v18, v18, v17
    v_mul_f32 v19, v19, v17
    v_cvt_pk_bf16_f32 v106, v18, v19
    v_lshlrev_b32 v18, 16, v107
    v_and_b32 v19, 0xffff0000, v107
    v_sub_f32 v18, v18, v16
    v_sub_f32 v19, v19, v16
    v_cvt_pk_bf16_f32 v107, v18, v19
    v_lshlrev_b32 v18, 16, v107
    v_and_b32 v19, 0xffff0000, v107
    v_mul_f32 v18, v18, v17
    v_mul_f32 v19, v19, v17
    v_cvt_pk_bf16_f32 v107, v18, v19
    ds_write_b128 v4, v[104:107] offset:4096
    v_lshlrev_b32 v18, 16, v108
    v_and_b32 v19, 0xffff0000, v108
    v_sub_f32 v18, v18, v16
    v_sub_f32 v19, v19, v16
    v_cvt_pk_bf16_f32 v108, v18, v19
    v_lshlrev_b32 v18, 16, v108
    v_and_b32 v19, 0xffff0000, v108
    v_mul_f32 v18, v18, v17
    v_mul_f32 v19, v19, v17
    v_cvt_pk_bf16_f32 v108, v18, v19
    v_lshlrev_b32 v18, 16, v109
    v_and_b32 v19, 0xffff0000, v109
    v_sub_f32 v18, v18, v16
    v_sub_f32 v19, v19, v16
    v_cvt_pk_bf16_f32 v109, v18, v19
    v_lshlrev_b32 v18, 16, v109
    v_and_b32 v19, 0xffff0000, v109
    v_mul_f32 v18, v18, v17
    v_mul_f32 v19, v19, v17
    v_cvt_pk_bf16_f32 v109, v18, v19
    v_lshlrev_b32 v18, 16, v110
    v_and_b32 v19, 0xffff0000, v110
    v_sub_f32 v18, v18, v16
    v_sub_f32 v19, v19, v16
    v_cvt_pk_bf16_f32 v110, v18, v19
    v_lshlrev_b32 v18, 16, v110
    v_and_b32 v19, 0xffff0000, v110
    v_mul_f32 v18, v18, v17
    v_mul_f32 v19, v19, v17
    v_cvt_pk_bf16_f32 v110, v18, v19
    v_lshlrev_b32 v18, 16, v111
    v_and_b32 v19, 0xffff0000, v111
    v_sub_f32 v18, v18, v16
    v_sub_f32 v19, v19, v16
    v_cvt_pk_bf16_f32 v111, v18, v19
    v_lshlrev_b32 v18, 16, v111
    v_and_b32 v19, 0xffff0000, v111
    v_mul_f32 v18, v18, v17
    v_mul_f32 v19, v19, v17
    v_cvt_pk_bf16_f32 v111, v18, v19
    ds_write_b128 v4, v[108:111] offset:6144
    v_lshlrev_b32 v18, 16, v112
    v_and_b32 v19, 0xffff0000, v112
    v_sub_f32 v18, v18, v16
    v_sub_f32 v19, v19, v16
    v_cvt_pk_bf16_f32 v112, v18, v19
    v_lshlrev_b32 v18, 16, v112
    v_and_b32 v19, 0xffff0000, v112
    v_mul_f32 v18, v18, v17
    v_mul_f32 v19, v19, v17
    v_cvt_pk_bf16_f32 v112, v18, v19
    v_lshlrev_b32 v18, 16, v113
    v_and_b32 v19, 0xffff0000, v113
    v_sub_f32 v18, v18, v16
    v_sub_f32 v19, v19, v16
    v_cvt_pk_bf16_f32 v113, v18, v19
    v_lshlrev_b32 v18, 16, v113
    v_and_b32 v19, 0xffff0000, v113
    v_mul_f32 v18, v18, v17
    v_mul_f32 v19, v19, v17
    v_cvt_pk_bf16_f32 v113, v18, v19
    v_lshlrev_b32 v18, 16, v114
    v_and_b32 v19, 0xffff0000, v114
    v_sub_f32 v18, v18, v16
    v_sub_f32 v19, v19, v16
    v_cvt_pk_bf16_f32 v114, v18, v19
    v_lshlrev_b32 v18, 16, v114
    v_and_b32 v19, 0xffff0000, v114
    v_mul_f32 v18, v18, v17
    v_mul_f32 v19, v19, v17
    v_cvt_pk_bf16_f32 v114, v18, v19
    v_lshlrev_b32 v18, 16, v115
    v_and_b32 v19, 0xffff0000, v115
    v_sub_f32 v18, v18, v16
    v_sub_f32 v19, v19, v16
    v_cvt_pk_bf16_f32 v115, v18, v19
    v_lshlrev_b32 v18, 16, v115
    v_and_b32 v19, 0xffff0000, v115
    v_mul_f32 v18, v18, v17
    v_mul_f32 v19, v19, v17
    v_cvt_pk_bf16_f32 v115, v18, v19
    ds_write_b128 v4, v[112:115] offset:8192
    v_lshlrev_b32 v18, 16, v116
    v_and_b32 v19, 0xffff0000, v116
    v_sub_f32 v18, v18, v16
    v_sub_f32 v19, v19, v16
    v_cvt_pk_bf16_f32 v116, v18, v19
    v_lshlrev_b32 v18, 16, v116
    v_and_b32 v19, 0xffff0000, v116
    v_mul_f32 v18, v18, v17
    v_mul_f32 v19, v19, v17
    v_cvt_pk_bf16_f32 v116, v18, v19
    v_lshlrev_b32 v18, 16, v117
    v_and_b32 v19, 0xffff0000, v117
    v_sub_f32 v18, v18, v16
    v_sub_f32 v19, v19, v16
    v_cvt_pk_bf16_f32 v117, v18, v19
    v_lshlrev_b32 v18, 16, v117
    v_and_b32 v19, 0xffff0000, v117
    v_mul_f32 v18, v18, v17
    v_mul_f32 v19, v19, v17
    v_cvt_pk_bf16_f32 v117, v18, v19
    v_lshlrev_b32 v18, 16, v118
    v_and_b32 v19, 0xffff0000, v118
    v_sub_f32 v18, v18, v16
    v_sub_f32 v19, v19, v16
    v_cvt_pk_bf16_f32 v118, v18, v19
    v_lshlrev_b32 v18, 16, v118
    v_and_b32 v19, 0xffff0000, v118
    v_mul_f32 v18, v18, v17
    v_mul_f32 v19, v19, v17
    v_cvt_pk_bf16_f32 v118, v18, v19
    v_lshlrev_b32 v18, 16, v119
    v_and_b32 v19, 0xffff0000, v119
    v_sub_f32 v18, v18, v16
    v_sub_f32 v19, v19, v16
    v_cvt_pk_bf16_f32 v119, v18, v19
    v_lshlrev_b32 v18, 16, v119
    v_and_b32 v19, 0xffff0000, v119
    v_mul_f32 v18, v18, v17
    v_mul_f32 v19, v19, v17
    v_cvt_pk_bf16_f32 v119, v18, v19
    ds_write_b128 v4, v[116:119] offset:10240
    v_lshlrev_b32 v18, 16, v120
    v_and_b32 v19, 0xffff0000, v120
    v_sub_f32 v18, v18, v16
    v_sub_f32 v19, v19, v16
    v_cvt_pk_bf16_f32 v120, v18, v19
    v_lshlrev_b32 v18, 16, v120
    v_and_b32 v19, 0xffff0000, v120
    v_mul_f32 v18, v18, v17
    v_mul_f32 v19, v19, v17
    v_cvt_pk_bf16_f32 v120, v18, v19
    v_lshlrev_b32 v18, 16, v121
    v_and_b32 v19, 0xffff0000, v121
    v_sub_f32 v18, v18, v16
    v_sub_f32 v19, v19, v16
    v_cvt_pk_bf16_f32 v121, v18, v19
    v_lshlrev_b32 v18, 16, v121
    v_and_b32 v19, 0xffff0000, v121
    v_mul_f32 v18, v18, v17
    v_mul_f32 v19, v19, v17
    v_cvt_pk_bf16_f32 v121, v18, v19
    v_lshlrev_b32 v18, 16, v122
    v_and_b32 v19, 0xffff0000, v122
    v_sub_f32 v18, v18, v16
    v_sub_f32 v19, v19, v16
    v_cvt_pk_bf16_f32 v122, v18, v19
    v_lshlrev_b32 v18, 16, v122
    v_and_b32 v19, 0xffff0000, v122
    v_mul_f32 v18, v18, v17
    v_mul_f32 v19, v19, v17
    v_cvt_pk_bf16_f32 v122, v18, v19
    v_lshlrev_b32 v18, 16, v123
    v_and_b32 v19, 0xffff0000, v123
    v_sub_f32 v18, v18, v16
    v_sub_f32 v19, v19, v16
    v_cvt_pk_bf16_f32 v123, v18, v19
    v_lshlrev_b32 v18, 16, v123
    v_and_b32 v19, 0xffff0000, v123
    v_mul_f32 v18, v18, v17
    v_mul_f32 v19, v19, v17
    v_cvt_pk_bf16_f32 v123, v18, v19
    ds_write_b128 v4, v[120:123] offset:12288
    v_lshlrev_b32 v18, 16, v124
    v_and_b32 v19, 0xffff0000, v124
    v_sub_f32 v18, v18, v16
    v_sub_f32 v19, v19, v16
    v_cvt_pk_bf16_f32 v124, v18, v19
    v_lshlrev_b32 v18, 16, v124
    v_and_b32 v19, 0xffff0000, v124
    v_mul_f32 v18, v18, v17
    v_mul_f32 v19, v19, v17
    v_cvt_pk_bf16_f32 v124, v18, v19
    v_lshlrev_b32 v18, 16, v125
    v_and_b32 v19, 0xffff0000, v125
    v_sub_f32 v18, v18, v16
    v_sub_f32 v19, v19, v16
    v_cvt_pk_bf16_f32 v125, v18, v19
    v_lshlrev_b32 v18, 16, v125
    v_and_b32 v19, 0xffff0000, v125
    v_mul_f32 v18, v18, v17
    v_mul_f32 v19, v19, v17
    v_cvt_pk_bf16_f32 v125, v18, v19
    v_lshlrev_b32 v18, 16, v126
    v_and_b32 v19, 0xffff0000, v126
    v_sub_f32 v18, v18, v16
    v_sub_f32 v19, v19, v16
    v_cvt_pk_bf16_f32 v126, v18, v19
    v_lshlrev_b32 v18, 16, v126
    v_and_b32 v19, 0xffff0000, v126
    v_mul_f32 v18, v18, v17
    v_mul_f32 v19, v19, v17
    v_cvt_pk_bf16_f32 v126, v18, v19
    v_lshlrev_b32 v18, 16, v127
    v_and_b32 v19, 0xffff0000, v127
    v_sub_f32 v18, v18, v16
    v_sub_f32 v19, v19, v16
    v_cvt_pk_bf16_f32 v127, v18, v19
    v_lshlrev_b32 v18, 16, v127
    v_and_b32 v19, 0xffff0000, v127
    v_mul_f32 v18, v18, v17
    v_mul_f32 v19, v19, v17
    v_cvt_pk_bf16_f32 v127, v18, v19
    ds_write_b128 v4, v[124:127] offset:14336
    s_waitcnt lgkmcnt(0)
    s_barrier
    s_lshl_b32 s24, s23, 15
    s_add_u32 s24, s24, 0x800000
    ds_read_b128 v[24:27], v9 offset:0
    ds_read_b128 v[28:31], v9 offset:4096
    ds_read_b128 v[32:35], v9 offset:8192
    ds_read_b128 v[36:39], v9 offset:12288
    ds_read_b128 v[40:43], v9 offset:16384
    ds_read_b128 v[44:47], v9 offset:20480
    ds_read_b128 v[48:51], v9 offset:24576
    ds_read_b128 v[52:55], v9 offset:28672
    s_waitcnt lgkmcnt(7)
    s_add_u32 s36, s24, 0
    buffer_store_dwordx4 v[24:27], v9, s[8:11], s36 offen sc1
    s_waitcnt lgkmcnt(6)
    s_add_u32 s36, s24, 4096
    buffer_store_dwordx4 v[28:31], v9, s[8:11], s36 offen sc1
    s_waitcnt lgkmcnt(5)
    s_add_u32 s36, s24, 8192
    buffer_store_dwordx4 v[32:35], v9, s[8:11], s36 offen sc1
    s_waitcnt lgkmcnt(4)
    s_add_u32 s36, s24, 12288
    buffer_store_dwordx4 v[36:39], v9, s[8:11], s36 offen sc1
    s_waitcnt lgkmcnt(3)
    s_add_u32 s36, s24, 16384
    buffer_store_dwordx4 v[40:43], v9, s[8:11], s36 offen sc1
    s_waitcnt lgkmcnt(2)
    s_add_u32 s36, s24, 20480
    buffer_store_dwordx4 v[44:47], v9, s[8:11], s36 offen sc1
    s_waitcnt lgkmcnt(1)
    s_add_u32 s36, s24, 24576
    buffer_store_dwordx4 v[48:51], v9, s[8:11], s36 offen sc1
    s_waitcnt lgkmcnt(0)
    s_add_u32 s36, s24, 28672
    buffer_store_dwordx4 v[52:55], v9, s[8:11], s36 offen sc1
    s_barrier
    s_add_u32 s23, s23, 1
    s_lshl_b32 s36, s23, 15
    buffer_load_dwordx4 v[96:99], v3, s[12:15], s36 offen offset:0
    buffer_load_dwordx4 v[100:103], v3, s[12:15], s36 offen offset:128
    buffer_load_dwordx4 v[104:107], v3, s[12:15], s36 offen offset:256
    buffer_load_dwordx4 v[108:111], v3, s[12:15], s36 offen offset:384
    buffer_load_dwordx4 v[112:115], v3, s[12:15], s36 offen offset:512
    buffer_load_dwordx4 v[116:119], v3, s[12:15], s36 offen offset:640
    buffer_load_dwordx4 v[120:123], v3, s[12:15], s36 offen offset:768
    buffer_load_dwordx4 v[124:127], v3, s[12:15], s36 offen offset:896
    s_waitcnt vmcnt(0)
    v_mov_b32 v16, 0
    v_mov_b32 v17, 0
    v_dot2_f32_bf16 v16, v96, s4, v16
    v_dot2_f32_bf16 v17, v96, v96, v17
    v_dot2_f32_bf16 v16, v97, s4, v16
    v_dot2_f32_bf16 v17, v97, v97, v17
    v_dot2_f32_bf16 v16, v98, s4, v16
    v_dot2_f32_bf16 v17, v98, v98, v17
    v_dot2_f32_bf16 v16, v99, s4, v16
    v_dot2_f32_bf16 v17, v99, v99, v17
    v_dot2_f32_bf16 v16, v100, s4, v16
    v_dot2_f32_bf16 v17, v100, v100, v17
    v_dot2_f32_bf16 v16, v101, s4, v16
    v_dot2_f32_bf16 v17, v101, v101, v17
    v_dot2_f32_bf16 v16, v102, s4, v16
    v_dot2_f32_bf16 v17, v102, v102, v17
    v_dot2_f32_bf16 v16, v103, s4, v16
    v_dot2_f32_bf16 v17, v103, v103, v17
    v_dot2_f32_bf16 v16, v104, s4, v16
    v_dot2_f32_bf16 v17, v104, v104, v17
    v_dot2_f32_bf16 v16, v105, s4, v16
    v_dot2_f32_bf16 v17, v105, v105, v17
    v_dot2_f32_bf16 v16, v106, s4, v16
    v_dot2_f32_bf16 v17, v106, v106, v17
    v_dot2_f32_bf16 v16, v107, s4, v16
    v_dot2_f32_bf16 v17, v107, v107, v17
    v_dot2_f32_bf16 v16, v108, s4, v16
    v_dot2_f32_bf16 v17, v108, v108, v17
    v_dot2_f32_bf16 v16, v109, s4, v16
    v_dot2_f32_bf16 v17, v109, v109, v17
    v_dot2_f32_bf16 v16, v110, s4, v16
    v_dot2_f32_bf16 v17, v110, v110, v17
    v_dot2_f32_bf16 v16, v111, s4, v16
    v_dot2_f32_bf16 v17, v111, v111, v17
    v_dot2_f32_bf16 v16, v112, s4, v16
    v_dot2_f32_bf16 v17, v112, v112, v17
    v_dot2_f32_bf16 v16, v113, s4, v16
    v_dot2_f32_bf16 v17, v113, v113, v17
    v_dot2_f32_bf16 v16, v114, s4, v16
    v_dot2_f32_bf16 v17, v114, v114, v17
    v_dot2_f32_bf16 v16, v115, s4, v16
    v_dot2_f32_bf16 v17, v115, v115, v17
    v_dot2_f32_bf16 v16, v116, s4, v16
    v_dot2_f32_bf16 v17, v116, v116, v17
    v_dot2_f32_bf16 v16, v117, s4, v16
    v_dot2_f32_bf16 v17, v117, v117, v17
    v_dot2_f32_bf16 v16, v118, s4, v16
    v_dot2_f32_bf16 v17, v118, v118, v17
    v_dot2_f32_bf16 v16, v119, s4, v16
    v_dot2_f32_bf16 v17, v119, v119, v17
    v_dot2_f32_bf16 v16, v120, s4, v16
    v_dot2_f32_bf16 v17, v120, v120, v17
    v_dot2_f32_bf16 v16, v121, s4, v16
    v_dot2_f32_bf16 v17, v121, v121, v17
    v_dot2_f32_bf16 v16, v122, s4, v16
    v_dot2_f32_bf16 v17, v122, v122, v17
    v_dot2_f32_bf16 v16, v123, s4, v16
    v_dot2_f32_bf16 v17, v123, v123, v17
    v_dot2_f32_bf16 v16, v124, s4, v16
    v_dot2_f32_bf16 v17, v124, v124, v17
    v_dot2_f32_bf16 v16, v125, s4, v16
    v_dot2_f32_bf16 v17, v125, v125, v17
    v_dot2_f32_bf16 v16, v126, s4, v16
    v_dot2_f32_bf16 v17, v126, v126, v17
    v_dot2_f32_bf16 v16, v127, s4, v16
    v_dot2_f32_bf16 v17, v127, v127, v17
    s_nop 3
    v_add_f32_dpp v16, v16, v16 quad_perm:[1,0,3,2] row_mask:0xf bank_mask:0xf
    v_add_f32_dpp v17, v17, v17 quad_perm:[1,0,3,2] row_mask:0xf bank_mask:0xf
    s_nop 0
    v_add_f32_dpp v16, v16, v16 quad_perm:[2,3,0,1] row_mask:0xf bank_mask:0xf
    v_add_f32_dpp v17, v17, v17 quad_perm:[2,3,0,1] row_mask:0xf bank_mask:0xf
    s_nop 0
    v_add_f32_dpp v16, v16, v16 row_half_mirror row_mask:0xf bank_mask:0xf
    v_add_f32_dpp v17, v17, v17 row_half_mirror row_mask:0xf bank_mask:0xf
    v_mul_f32 v16, 0x3b000000, v16
    v_mul_f32 v17, 0x3b000000, v17
    v_fma_f32 v17, -v16, v16, v17
    v_max_f32 v17, 0, v17
    v_cvt_pk_bf16_f32 v14, v16, v17
    v_lshlrev_b32 v16, 16, v14
    v_and_b32 v17, 0xffff0000, v14
    v_add_f32 v17, 0x3727c5ac, v17
    v_cvt_pk_bf16_f32 v14, v17, v17
    v_lshlrev_b32 v17, 16, v14
    v_sqrt_f32 v17, v17
    s_nop 0
    v_cvt_pk_bf16_f32 v14, v17, v17
    v_lshlrev_b32 v17, 16, v14
    v_rcp_f32 v17, v17
    v_lshlrev_b32 v18, 16, v96
    v_and_b32 v19, 0xffff0000, v96
    v_sub_f32 v18, v18, v16
    v_sub_f32 v19, v19, v16
    v_cvt_pk_bf16_f32 v96, v18, v19
    v_lshlrev_b32 v18, 16, v96
    v_and_b32 v19, 0xffff0000, v96
    v_mul_f32 v18, v18, v17
    v_mul_f32 v19, v19, v17
    v_cvt_pk_bf16_f32 v96, v18, v19
    v_lshlrev_b32 v18, 16, v97
    v_and_b32 v19, 0xffff0000, v97
    v_sub_f32 v18, v18, v16
    v_sub_f32 v19, v19, v16
    v_cvt_pk_bf16_f32 v97, v18, v19
    v_lshlrev_b32 v18, 16, v97
    v_and_b32 v19, 0xffff0000, v97
    v_mul_f32 v18, v18, v17
    v_mul_f32 v19, v19, v17
    v_cvt_pk_bf16_f32 v97, v18, v19
    v_lshlrev_b32 v18, 16, v98
    v_and_b32 v19, 0xffff0000, v98
    v_sub_f32 v18, v18, v16
    v_sub_f32 v19, v19, v16
    v_cvt_pk_bf16_f32 v98, v18, v19
    v_lshlrev_b32 v18, 16, v98
    v_and_b32 v19, 0xffff0000, v98
    v_mul_f32 v18, v18, v17
    v_mul_f32 v19, v19, v17
    v_cvt_pk_bf16_f32 v98, v18, v19
    v_lshlrev_b32 v18, 16, v99
    v_and_b32 v19, 0xffff0000, v99
    v_sub_f32 v18, v18, v16
    v_sub_f32 v19, v19, v16
    v_cvt_pk_bf16_f32 v99, v18, v19
    v_lshlrev_b32 v18, 16, v99
    v_and_b32 v19, 0xffff0000, v99
    v_mul_f32 v18, v18, v17
    v_mul_f32 v19, v19, v17
    v_cvt_pk_bf16_f32 v99, v18, v19
    ds_write_b128 v4, v[96:99] offset:0
    v_lshlrev_b32 v18, 16, v100
    v_and_b32 v19, 0xffff0000, v100
    v_sub_f32 v18, v18, v16
    v_sub_f32 v19, v19, v16
    v_cvt_pk_bf16_f32 v100, v18, v19
    v_lshlrev_b32 v18, 16, v100
    v_and_b32 v19, 0xffff0000, v100
    v_mul_f32 v18, v18, v17
    v_mul_f32 v19, v19, v17
    v_cvt_pk_bf16_f32 v100, v18, v19
    v_lshlrev_b32 v18, 16, v101
    v_and_b32 v19, 0xffff0000, v101
    v_sub_f32 v18, v18, v16
    v_sub_f32 v19, v19, v16
    v_cvt_pk_bf16_f32 v101, v18, v19
    v_lshlrev_b32 v18, 16, v101
    v_and_b32 v19, 0xffff0000, v101
    v_mul_f32 v18, v18, v17
    v_mul_f32 v19, v19, v17
    v_cvt_pk_bf16_f32 v101, v18, v19
    v_lshlrev_b32 v18, 16, v102
    v_and_b32 v19, 0xffff0000, v102
    v_sub_f32 v18, v18, v16
    v_sub_f32 v19, v19, v16
    v_cvt_pk_bf16_f32 v102, v18, v19
    v_lshlrev_b32 v18, 16, v102
    v_and_b32 v19, 0xffff0000, v102
    v_mul_f32 v18, v18, v17
    v_mul_f32 v19, v19, v17
    v_cvt_pk_bf16_f32 v102, v18, v19
    v_lshlrev_b32 v18, 16, v103
    v_and_b32 v19, 0xffff0000, v103
    v_sub_f32 v18, v18, v16
    v_sub_f32 v19, v19, v16
    v_cvt_pk_bf16_f32 v103, v18, v19
    v_lshlrev_b32 v18, 16, v103
    v_and_b32 v19, 0xffff0000, v103
    v_mul_f32 v18, v18, v17
    v_mul_f32 v19, v19, v17
    v_cvt_pk_bf16_f32 v103, v18, v19
    ds_write_b128 v4, v[100:103] offset:2048
    v_lshlrev_b32 v18, 16, v104
    v_and_b32 v19, 0xffff0000, v104
    v_sub_f32 v18, v18, v16
    v_sub_f32 v19, v19, v16
    v_cvt_pk_bf16_f32 v104, v18, v19
    v_lshlrev_b32 v18, 16, v104
    v_and_b32 v19, 0xffff0000, v104
    v_mul_f32 v18, v18, v17
    v_mul_f32 v19, v19, v17
    v_cvt_pk_bf16_f32 v104, v18, v19
    v_lshlrev_b32 v18, 16, v105
    v_and_b32 v19, 0xffff0000, v105
    v_sub_f32 v18, v18, v16
    v_sub_f32 v19, v19, v16
    v_cvt_pk_bf16_f32 v105, v18, v19
    v_lshlrev_b32 v18, 16, v105
    v_and_b32 v19, 0xffff0000, v105
    v_mul_f32 v18, v18, v17
    v_mul_f32 v19, v19, v17
    v_cvt_pk_bf16_f32 v105, v18, v19
    v_lshlrev_b32 v18, 16, v106
    v_and_b32 v19, 0xffff0000, v106
    v_sub_f32 v18, v18, v16
    v_sub_f32 v19, v19, v16
    v_cvt_pk_bf16_f32 v106, v18, v19
    v_lshlrev_b32 v18, 16, v106
    v_and_b32 v19, 0xffff0000, v106
    v_mul_f32 v18, v18, v17
    v_mul_f32 v19, v19, v17
    v_cvt_pk_bf16_f32 v106, v18, v19
    v_lshlrev_b32 v18, 16, v107
    v_and_b32 v19, 0xffff0000, v107
    v_sub_f32 v18, v18, v16
    v_sub_f32 v19, v19, v16
    v_cvt_pk_bf16_f32 v107, v18, v19
    v_lshlrev_b32 v18, 16, v107
    v_and_b32 v19, 0xffff0000, v107
    v_mul_f32 v18, v18, v17
    v_mul_f32 v19, v19, v17
    v_cvt_pk_bf16_f32 v107, v18, v19
    ds_write_b128 v4, v[104:107] offset:4096
    v_lshlrev_b32 v18, 16, v108
    v_and_b32 v19, 0xffff0000, v108
    v_sub_f32 v18, v18, v16
    v_sub_f32 v19, v19, v16
    v_cvt_pk_bf16_f32 v108, v18, v19
    v_lshlrev_b32 v18, 16, v108
    v_and_b32 v19, 0xffff0000, v108
    v_mul_f32 v18, v18, v17
    v_mul_f32 v19, v19, v17
    v_cvt_pk_bf16_f32 v108, v18, v19
    v_lshlrev_b32 v18, 16, v109
    v_and_b32 v19, 0xffff0000, v109
    v_sub_f32 v18, v18, v16
    v_sub_f32 v19, v19, v16
    v_cvt_pk_bf16_f32 v109, v18, v19
    v_lshlrev_b32 v18, 16, v109
    v_and_b32 v19, 0xffff0000, v109
    v_mul_f32 v18, v18, v17
    v_mul_f32 v19, v19, v17
    v_cvt_pk_bf16_f32 v109, v18, v19
    v_lshlrev_b32 v18, 16, v110
    v_and_b32 v19, 0xffff0000, v110
    v_sub_f32 v18, v18, v16
    v_sub_f32 v19, v19, v16
    v_cvt_pk_bf16_f32 v110, v18, v19
    v_lshlrev_b32 v18, 16, v110
    v_and_b32 v19, 0xffff0000, v110
    v_mul_f32 v18, v18, v17
    v_mul_f32 v19, v19, v17
    v_cvt_pk_bf16_f32 v110, v18, v19
    v_lshlrev_b32 v18, 16, v111
    v_and_b32 v19, 0xffff0000, v111
    v_sub_f32 v18, v18, v16
    v_sub_f32 v19, v19, v16
    v_cvt_pk_bf16_f32 v111, v18, v19
    v_lshlrev_b32 v18, 16, v111
    v_and_b32 v19, 0xffff0000, v111
    v_mul_f32 v18, v18, v17
    v_mul_f32 v19, v19, v17
    v_cvt_pk_bf16_f32 v111, v18, v19
    ds_write_b128 v4, v[108:111] offset:6144
    v_lshlrev_b32 v18, 16, v112
    v_and_b32 v19, 0xffff0000, v112
    v_sub_f32 v18, v18, v16
    v_sub_f32 v19, v19, v16
    v_cvt_pk_bf16_f32 v112, v18, v19
    v_lshlrev_b32 v18, 16, v112
    v_and_b32 v19, 0xffff0000, v112
    v_mul_f32 v18, v18, v17
    v_mul_f32 v19, v19, v17
    v_cvt_pk_bf16_f32 v112, v18, v19
    v_lshlrev_b32 v18, 16, v113
    v_and_b32 v19, 0xffff0000, v113
    v_sub_f32 v18, v18, v16
    v_sub_f32 v19, v19, v16
    v_cvt_pk_bf16_f32 v113, v18, v19
    v_lshlrev_b32 v18, 16, v113
    v_and_b32 v19, 0xffff0000, v113
    v_mul_f32 v18, v18, v17
    v_mul_f32 v19, v19, v17
    v_cvt_pk_bf16_f32 v113, v18, v19
    v_lshlrev_b32 v18, 16, v114
    v_and_b32 v19, 0xffff0000, v114
    v_sub_f32 v18, v18, v16
    v_sub_f32 v19, v19, v16
    v_cvt_pk_bf16_f32 v114, v18, v19
    v_lshlrev_b32 v18, 16, v114
    v_and_b32 v19, 0xffff0000, v114
    v_mul_f32 v18, v18, v17
    v_mul_f32 v19, v19, v17
    v_cvt_pk_bf16_f32 v114, v18, v19
    v_lshlrev_b32 v18, 16, v115
    v_and_b32 v19, 0xffff0000, v115
    v_sub_f32 v18, v18, v16
    v_sub_f32 v19, v19, v16
    v_cvt_pk_bf16_f32 v115, v18, v19
    v_lshlrev_b32 v18, 16, v115
    v_and_b32 v19, 0xffff0000, v115
    v_mul_f32 v18, v18, v17
    v_mul_f32 v19, v19, v17
    v_cvt_pk_bf16_f32 v115, v18, v19
    ds_write_b128 v4, v[112:115] offset:8192
    v_lshlrev_b32 v18, 16, v116
    v_and_b32 v19, 0xffff0000, v116
    v_sub_f32 v18, v18, v16
    v_sub_f32 v19, v19, v16
    v_cvt_pk_bf16_f32 v116, v18, v19
    v_lshlrev_b32 v18, 16, v116
    v_and_b32 v19, 0xffff0000, v116
    v_mul_f32 v18, v18, v17
    v_mul_f32 v19, v19, v17
    v_cvt_pk_bf16_f32 v116, v18, v19
    v_lshlrev_b32 v18, 16, v117
    v_and_b32 v19, 0xffff0000, v117
    v_sub_f32 v18, v18, v16
    v_sub_f32 v19, v19, v16
    v_cvt_pk_bf16_f32 v117, v18, v19
    v_lshlrev_b32 v18, 16, v117
    v_and_b32 v19, 0xffff0000, v117
    v_mul_f32 v18, v18, v17
    v_mul_f32 v19, v19, v17
    v_cvt_pk_bf16_f32 v117, v18, v19
    v_lshlrev_b32 v18, 16, v118
    v_and_b32 v19, 0xffff0000, v118
    v_sub_f32 v18, v18, v16
    v_sub_f32 v19, v19, v16
    v_cvt_pk_bf16_f32 v118, v18, v19
    v_lshlrev_b32 v18, 16, v118
    v_and_b32 v19, 0xffff0000, v118
    v_mul_f32 v18, v18, v17
    v_mul_f32 v19, v19, v17
    v_cvt_pk_bf16_f32 v118, v18, v19
    v_lshlrev_b32 v18, 16, v119
    v_and_b32 v19, 0xffff0000, v119
    v_sub_f32 v18, v18, v16
    v_sub_f32 v19, v19, v16
    v_cvt_pk_bf16_f32 v119, v18, v19
    v_lshlrev_b32 v18, 16, v119
    v_and_b32 v19, 0xffff0000, v119
    v_mul_f32 v18, v18, v17
    v_mul_f32 v19, v19, v17
    v_cvt_pk_bf16_f32 v119, v18, v19
    ds_write_b128 v4, v[116:119] offset:10240
    v_lshlrev_b32 v18, 16, v120
    v_and_b32 v19, 0xffff0000, v120
    v_sub_f32 v18, v18, v16
    v_sub_f32 v19, v19, v16
    v_cvt_pk_bf16_f32 v120, v18, v19
    v_lshlrev_b32 v18, 16, v120
    v_and_b32 v19, 0xffff0000, v120
    v_mul_f32 v18, v18, v17
    v_mul_f32 v19, v19, v17
    v_cvt_pk_bf16_f32 v120, v18, v19
    v_lshlrev_b32 v18, 16, v121
    v_and_b32 v19, 0xffff0000, v121
    v_sub_f32 v18, v18, v16
    v_sub_f32 v19, v19, v16
    v_cvt_pk_bf16_f32 v121, v18, v19
    v_lshlrev_b32 v18, 16, v121
    v_and_b32 v19, 0xffff0000, v121
    v_mul_f32 v18, v18, v17
    v_mul_f32 v19, v19, v17
    v_cvt_pk_bf16_f32 v121, v18, v19
    v_lshlrev_b32 v18, 16, v122
    v_and_b32 v19, 0xffff0000, v122
    v_sub_f32 v18, v18, v16
    v_sub_f32 v19, v19, v16
    v_cvt_pk_bf16_f32 v122, v18, v19
    v_lshlrev_b32 v18, 16, v122
    v_and_b32 v19, 0xffff0000, v122
    v_mul_f32 v18, v18, v17
    v_mul_f32 v19, v19, v17
    v_cvt_pk_bf16_f32 v122, v18, v19
    v_lshlrev_b32 v18, 16, v123
    v_and_b32 v19, 0xffff0000, v123
    v_sub_f32 v18, v18, v16
    v_sub_f32 v19, v19, v16
    v_cvt_pk_bf16_f32 v123, v18, v19
    v_lshlrev_b32 v18, 16, v123
    v_and_b32 v19, 0xffff0000, v123
    v_mul_f32 v18, v18, v17
    v_mul_f32 v19, v19, v17
    v_cvt_pk_bf16_f32 v123, v18, v19
    ds_write_b128 v4, v[120:123] offset:12288
    v_lshlrev_b32 v18, 16, v124
    v_and_b32 v19, 0xffff0000, v124
    v_sub_f32 v18, v18, v16
    v_sub_f32 v19, v19, v16
    v_cvt_pk_bf16_f32 v124, v18, v19
    v_lshlrev_b32 v18, 16, v124
    v_and_b32 v19, 0xffff0000, v124
    v_mul_f32 v18, v18, v17
    v_mul_f32 v19, v19, v17
    v_cvt_pk_bf16_f32 v124, v18, v19
    v_lshlrev_b32 v18, 16, v125
    v_and_b32 v19, 0xffff0000, v125
    v_sub_f32 v18, v18, v16
    v_sub_f32 v19, v19, v16
    v_cvt_pk_bf16_f32 v125, v18, v19
    v_lshlrev_b32 v18, 16, v125
    v_and_b32 v19, 0xffff0000, v125
    v_mul_f32 v18, v18, v17
    v_mul_f32 v19, v19, v17
    v_cvt_pk_bf16_f32 v125, v18, v19
    v_lshlrev_b32 v18, 16, v126
    v_and_b32 v19, 0xffff0000, v126
    v_sub_f32 v18, v18, v16
    v_sub_f32 v19, v19, v16
    v_cvt_pk_bf16_f32 v126, v18, v19
    v_lshlrev_b32 v18, 16, v126
    v_and_b32 v19, 0xffff0000, v126
    v_mul_f32 v18, v18, v17
    v_mul_f32 v19, v19, v17
    v_cvt_pk_bf16_f32 v126, v18, v19
    v_lshlrev_b32 v18, 16, v127
    v_and_b32 v19, 0xffff0000, v127
    v_sub_f32 v18, v18, v16
    v_sub_f32 v19, v19, v16
    v_cvt_pk_bf16_f32 v127, v18, v19
    v_lshlrev_b32 v18, 16, v127
    v_and_b32 v19, 0xffff0000, v127
    v_mul_f32 v18, v18, v17
    v_mul_f32 v19, v19, v17
    v_cvt_pk_bf16_f32 v127, v18, v19
    ds_write_b128 v4, v[124:127] offset:14336
    s_waitcnt lgkmcnt(0)
    s_barrier
    s_lshl_b32 s24, s23, 15
    s_add_u32 s24, s24, 0x800000
    ds_read_b128 v[24:27], v9 offset:0
    ds_read_b128 v[28:31], v9 offset:4096
    ds_read_b128 v[32:35], v9 offset:8192
    ds_read_b128 v[36:39], v9 offset:12288
    ds_read_b128 v[40:43], v9 offset:16384
    ds_read_b128 v[44:47], v9 offset:20480
    ds_read_b128 v[48:51], v9 offset:24576
    ds_read_b128 v[52:55], v9 offset:28672
    s_waitcnt lgkmcnt(7)
    s_add_u32 s36, s24, 0
    buffer_store_dwordx4 v[24:27], v9, s[8:11], s36 offen sc1
    s_waitcnt lgkmcnt(6)
    s_add_u32 s36, s24, 4096
    buffer_store_dwordx4 v[28:31], v9, s[8:11], s36 offen sc1
    s_waitcnt lgkmcnt(5)
    s_add_u32 s36, s24, 8192
    buffer_store_dwordx4 v[32:35], v9, s[8:11], s36 offen sc1
    s_waitcnt lgkmcnt(4)
    s_add_u32 s36, s24, 12288
    buffer_store_dwordx4 v[36:39], v9, s[8:11], s36 offen sc1
    s_waitcnt lgkmcnt(3)
    s_add_u32 s36, s24, 16384
    buffer_store_dwordx4 v[40:43], v9, s[8:11], s36 offen sc1
    s_waitcnt lgkmcnt(2)
    s_add_u32 s36, s24, 20480
    buffer_store_dwordx4 v[44:47], v9, s[8:11], s36 offen sc1
    s_waitcnt lgkmcnt(1)
    s_add_u32 s36, s24, 24576
    buffer_store_dwordx4 v[48:51], v9, s[8:11], s36 offen sc1
    s_waitcnt lgkmcnt(0)
    s_add_u32 s36, s24, 28672
    buffer_store_dwordx4 v[52:55], v9, s[8:11], s36 offen sc1
    s_barrier
    s_add_u32 s23, s23, 1
    v_lshrrev_b32 v15, 2, v1
    v_and_b32 v15, 127, v15
L_XHS:
    buffer_load_dword v14, v15, s[16:19], 0 offen offset:128 sc1
    s_add_u32 s32, s32, 1
    s_cmp_gt_u32 s32, 200000
    s_cbranch_scc1 L_XHS_done
    s_waitcnt vmcnt(0)
    v_cmp_eq_u32 vcc, 0, v14
    s_cbranch_vccnz L_XHS
L_XHS_done:
    s_lshl_b32 s24, s23, 2
    s_add_u32 s24, s24, 0x1923f8
    s_waitcnt vmcnt(0)
    s_barrier
    v_cmp_ne_u32 vcc, 0, v0
    v_mov_b32 v15, 0x40000000
    v_mov_b32 v14, 1
    v_cndmask_b32 v15, v0, v15, vcc
    buffer_store_dword v14, v15, s[8:11], s24 offen sc1
    s_add_u32 s24, s24, 4
    v_cmp_ne_u32 vcc, 0, v0
    v_mov_b32 v15, 0x40000000
    v_mov_b32 v14, 1
    v_cndmask_b32 v15, v0, v15, vcc
    buffer_store_dword v14, v15, s[8:11], s24 offen sc1
    s_lshr_b32 s20, s2, 3
    s_mov_b32 s34, 0x05040100
    s_mov_b32 s35, 0x07060302
    s_mov_b32 s32, 0
    s_mov_b32 s64, s84
    s_and_b32 s65, s85, 0xffff
    s_mov_b32 s66, 0x1c0000
    s_mov_b32 s67, 0x20000
    s_mov_b32 s68, s86
    s_and_b32 s69, s87, 0xffff
    s_mov_b32 s70, 0x1c0000
    s_mov_b32 s71, 0x20000
    s_mov_b32 s76, s88
    s_and_b32 s77, s89, 0xffff
    s_mov_b32 s78, 0x1c0000
    s_mov_b32 s79, 0x20000
    v_and_b32 v3, 31, v0
    v_lshlrev_b32 v3, 2, v3
L_M_hs:
    buffer_load_dword v5, v3, s[16:19], 0 offen offset:128 sc1
    s_add_u32 s32, s32, 1
    s_cmp_gt_u32 s32, 200000
    s_waitcnt vmcnt(0)
    s_cbranch_scc1 L_M_hs_ok
    v_cmp_eq_u32 vcc, 0, v5
    s_cbranch_vccz L_M_hs_ok
    s_sleep 16
    s_branch L_M_hs
L_M_hs_ok:
    v_lshlrev_b32 v3, 4, v0
L_M00_rp:
    s_mov_b32 s36, 0x194000
    buffer_load_dwordx4 v[16:19], v3, s[8:11], s36 offen sc1
    s_add_u32 s32, s32, 1
    v_mov_b32 v5, 0
    s_waitcnt vmcnt(0)
    v_max3_u32 v5, v5, v16, v17
    v_max3_u32 v5, v5, v18, v19
    s_cmp_gt_u32 s32, 200000
    s_cbranch_scc1 L_M00_rp_ok
    v_cmp_eq_u32 vcc, -1, v5
    s_cbranch_vccz L_M00_rp_ok
    s_sleep 64
    s_branch L_M00_rp
L_M00_rp_ok:
    v_add_f32 v16, v16, v17
    v_add_f32 v18, v18, v19
    v_add_f32 v16, v16, v18
    v_cvt_pk_bf16_f32 v5, v16, v16
    v_lshlrev_b32 v16, 16, v5
    v_ashrrev_i32 v5, 31, v16
    v_or_b32 v5, 0x80000000, v5
    v_xor_b32 v5, v5, v16
    v_and_b32 v5, 0xffff0000, v5
    v_sub_u32 v6, 2047, v0
    v_or_b32 v120, v5, v6
    v_lshrrev_b32 v1, 5, v0
    v_and_b32 v2, 31, v0
    s_mov_b32 s36, 229376
    v_mul_lo_u32 v4, v1, s36
    v_lshl_add_u32 v4, v2, 2, v4
    v_mov_b32 v5, 0x40000000
    v_cmp_lt_u32 vcc, 27, v2
    s_nop 1
    v_cndmask_b32 v4, v4, v5, vcc
    s_mul_i32 s23, s20, 112
    s_add_u32 s36, s23, 0
    buffer_load_dword v16, v4, s[64:67], s36 offen
    s_add_u32 s36, s23, 3584
    buffer_load_dword v17, v4, s[64:67], s36 offen
    s_add_u32 s36, s23, 7168
    buffer_load_dword v18, v4, s[64:67], s36 offen
    s_add_u32 s36, s23, 10752
    buffer_load_dword v19, v4, s[64:67], s36 offen
    s_add_u32 s36, s23, 14336
    buffer_load_dword v20, v4, s[64:67], s36 offen
    s_add_u32 s36, s23, 17920
    buffer_load_dword v21, v4, s[64:67], s36 offen
    s_add_u32 s36, s23, 21504
    buffer_load_dword v22, v4, s[64:67], s36 offen
    s_add_u32 s36, s23, 25088
    buffer_load_dword v23, v4, s[64:67], s36 offen
    s_add_u32 s36, s23, 28672
    buffer_load_dword v24, v4, s[64:67], s36 offen
    s_add_u32 s36, s23, 32256
    buffer_load_dword v25, v4, s[64:67], s36 offen
    s_add_u32 s36, s23, 35840
    buffer_load_dword v26, v4, s[64:67], s36 offen
    s_add_u32 s36, s23, 39424
    buffer_load_dword v27, v4, s[64:67], s36 offen
    s_add_u32 s36, s23, 43008
    buffer_load_dword v28, v4, s[64:67], s36 offen
    s_add_u32 s36, s23, 46592
    buffer_load_dword v29, v4, s[64:67], s36 offen
    s_add_u32 s36, s23, 50176
    buffer_load_dword v30, v4, s[64:67], s36 offen
    s_add_u32 s36, s23, 53760
    buffer_load_dword v31, v4, s[64:67], s36 offen
    s_add_u32 s36, s23, 57344
    buffer_load_dword v32, v4, s[64:67], s36 offen
    s_add_u32 s36, s23, 60928
    buffer_load_dword v33, v4, s[64:67], s36 offen
    s_add_u32 s36, s23, 64512
    buffer_load_dword v34, v4, s[64:67], s36 offen
    s_add_u32 s36, s23, 68096
    buffer_load_dword v35, v4, s[64:67], s36 offen
    s_add_u32 s36, s23, 71680
    buffer_load_dword v36, v4, s[64:67], s36 offen
    s_add_u32 s36, s23, 75264
    buffer_load_dword v37, v4, s[64:67], s36 offen
    s_add_u32 s36, s23, 78848
    buffer_load_dword v38, v4, s[64:67], s36 offen
    s_add_u32 s36, s23, 82432
    buffer_load_dword v39, v4, s[64:67], s36 offen
    s_add_u32 s36, s23, 86016
    buffer_load_dword v40, v4, s[64:67], s36 offen
    s_add_u32 s36, s23, 89600
    buffer_load_dword v41, v4, s[64:67], s36 offen
    s_add_u32 s36, s23, 93184
    buffer_load_dword v42, v4, s[64:67], s36 offen
    s_add_u32 s36, s23, 96768
    buffer_load_dword v43, v4, s[64:67], s36 offen
    s_add_u32 s36, s23, 100352
    buffer_load_dword v44, v4, s[64:67], s36 offen
    s_add_u32 s36, s23, 103936
    buffer_load_dword v45, v4, s[64:67], s36 offen
    s_add_u32 s36, s23, 107520
    buffer_load_dword v46, v4, s[64:67], s36 offen
    s_add_u32 s36, s23, 111104
    buffer_load_dword v47, v4, s[64:67], s36 offen
    s_waitcnt vmcnt(0)
    v_perm_b32 v128, v17, v16, s34
    v_perm_b32 v129, v19, v18, s34
    v_perm_b32 v130, v21, v20, s34
    v_perm_b32 v131, v23, v22, s34
    v_perm_b32 v132, v25, v24, s34
    v_perm_b32 v133, v27, v26, s34
    v_perm_b32 v134, v29, v28, s34
    v_perm_b32 v135, v31, v30, s34
    v_perm_b32 v136, v33, v32, s34
    v_perm_b32 v137, v35, v34, s34
    v_perm_b32 v138, v37, v36, s34
    v_perm_b32 v139, v39, v38, s34
    v_perm_b32 v140, v41, v40, s34
    v_perm_b32 v141, v43, v42, s34
    v_perm_b32 v142, v45, v44, s34
    v_perm_b32 v143, v47, v46, s34
    v_perm_b32 v160, v17, v16, s35
    v_perm_b32 v161, v19, v18, s35
    v_perm_b32 v162, v21, v20, s35
    v_perm_b32 v163, v23, v22, s35
    v_perm_b32 v164, v25, v24, s35
    v_perm_b32 v165, v27, v26, s35
    v_perm_b32 v166, v29, v28, s35
    v_perm_b32 v167, v31, v30, s35
    v_perm_b32 v168, v33, v32, s35
    v_perm_b32 v169, v35, v34, s35
    v_perm_b32 v170, v37, v36, s35
    v_perm_b32 v171, v39, v38, s35
    v_perm_b32 v172, v41, v40, s35
    v_perm_b32 v173, v43, v42, s35
    v_perm_b32 v174, v45, v44, s35
    v_perm_b32 v175, v47, v46, s35
    s_add_u32 s36, s23, 114688
    buffer_load_dword v16, v4, s[64:67], s36 offen
    s_add_u32 s36, s23, 118272
    buffer_load_dword v17, v4, s[64:67], s36 offen
    s_add_u32 s36, s23, 121856
    buffer_load_dword v18, v4, s[64:67], s36 offen
    s_add_u32 s36, s23, 125440
    buffer_load_dword v19, v4, s[64:67], s36 offen
    s_add_u32 s36, s23, 129024
    buffer_load_dword v20, v4, s[64:67], s36 offen
    s_add_u32 s36, s23, 132608
    buffer_load_dword v21, v4, s[64:67], s36 offen
    s_add_u32 s36, s23, 136192
    buffer_load_dword v22, v4, s[64:67], s36 offen
    s_add_u32 s36, s23, 139776
    buffer_load_dword v23, v4, s[64:67], s36 offen
    s_add_u32 s36, s23, 143360
    buffer_load_dword v24, v4, s[64:67], s36 offen
    s_add_u32 s36, s23, 146944
    buffer_load_dword v25, v4, s[64:67], s36 offen
    s_add_u32 s36, s23, 150528
    buffer_load_dword v26, v4, s[64:67], s36 offen
    s_add_u32 s36, s23, 154112
    buffer_load_dword v27, v4, s[64:67], s36 offen
    s_add_u32 s36, s23, 157696
    buffer_load_dword v28, v4, s[64:67], s36 offen
    s_add_u32 s36, s23, 161280
    buffer_load_dword v29, v4, s[64:67], s36 offen
    s_add_u32 s36, s23, 164864
    buffer_load_dword v30, v4, s[64:67], s36 offen
    s_add_u32 s36, s23, 168448
    buffer_load_dword v31, v4, s[64:67], s36 offen
    s_add_u32 s36, s23, 172032
    buffer_load_dword v32, v4, s[64:67], s36 offen
    s_add_u32 s36, s23, 175616
    buffer_load_dword v33, v4, s[64:67], s36 offen
    s_add_u32 s36, s23, 179200
    buffer_load_dword v34, v4, s[64:67], s36 offen
    s_add_u32 s36, s23, 182784
    buffer_load_dword v35, v4, s[64:67], s36 offen
    s_add_u32 s36, s23, 186368
    buffer_load_dword v36, v4, s[64:67], s36 offen
    s_add_u32 s36, s23, 189952
    buffer_load_dword v37, v4, s[64:67], s36 offen
    s_add_u32 s36, s23, 193536
    buffer_load_dword v38, v4, s[64:67], s36 offen
    s_add_u32 s36, s23, 197120
    buffer_load_dword v39, v4, s[64:67], s36 offen
    s_add_u32 s36, s23, 200704
    buffer_load_dword v40, v4, s[64:67], s36 offen
    s_add_u32 s36, s23, 204288
    buffer_load_dword v41, v4, s[64:67], s36 offen
    s_add_u32 s36, s23, 207872
    buffer_load_dword v42, v4, s[64:67], s36 offen
    s_add_u32 s36, s23, 211456
    buffer_load_dword v43, v4, s[64:67], s36 offen
    s_add_u32 s36, s23, 215040
    buffer_load_dword v44, v4, s[64:67], s36 offen
    s_add_u32 s36, s23, 218624
    buffer_load_dword v45, v4, s[64:67], s36 offen
    s_add_u32 s36, s23, 222208
    buffer_load_dword v46, v4, s[64:67], s36 offen
    s_add_u32 s36, s23, 225792
    buffer_load_dword v47, v4, s[64:67], s36 offen
    s_waitcnt vmcnt(0)
    v_perm_b32 v144, v17, v16, s34
    v_perm_b32 v145, v19, v18, s34
    v_perm_b32 v146, v21, v20, s34
    v_perm_b32 v147, v23, v22, s34
    v_perm_b32 v148, v25, v24, s34
    v_perm_b32 v149, v27, v26, s34
    v_perm_b32 v150, v29, v28, s34
    v_perm_b32 v151, v31, v30, s34
    v_perm_b32 v152, v33, v32, s34
    v_perm_b32 v153, v35, v34, s34
    v_perm_b32 v154, v37, v36, s34
    v_perm_b32 v155, v39, v38, s34
    v_perm_b32 v156, v41, v40, s34
    v_perm_b32 v157, v43, v42, s34
    v_perm_b32 v158, v45, v44, s34
    v_perm_b32 v159, v47, v46, s34
    v_perm_b32 v176, v17, v16, s35
    v_perm_b32 v177, v19, v18, s35
    v_perm_b32 v178, v21, v20, s35
    v_perm_b32 v179, v23, v22, s35
    v_perm_b32 v180, v25, v24, s35
    v_perm_b32 v181, v27, v26, s35
    v_perm_b32 v182, v29, v28, s35
    v_perm_b32 v183, v31, v30, s35
    v_perm_b32 v184, v33, v32, s35
    v_perm_b32 v185, v35, v34, s35
    v_perm_b32 v186, v37, v36, s35
    v_perm_b32 v187, v39, v38, s35
    v_perm_b32 v188, v41, v40, s35
    v_perm_b32 v189, v43, v42, s35
    v_perm_b32 v190, v45, v44, s35
    v_perm_b32 v191, v47, v46, s35
    s_add_u32 s36, s23, 0
    buffer_load_dword v16, v4, s[68:71], s36 offen
    s_add_u32 s36, s23, 3584
    buffer_load_dword v17, v4, s[68:71], s36 offen
    s_add_u32 s36, s23, 7168
    buffer_load_dword v18, v4, s[68:71], s36 offen
    s_add_u32 s36, s23, 10752
    buffer_load_dword v19, v4, s[68:71], s36 offen
    s_add_u32 s36, s23, 14336
    buffer_load_dword v20, v4, s[68:71], s36 offen
    s_add_u32 s36, s23, 17920
    buffer_load_dword v21, v4, s[68:71], s36 offen
    s_add_u32 s36, s23, 21504
    buffer_load_dword v22, v4, s[68:71], s36 offen
    s_add_u32 s36, s23, 25088
    buffer_load_dword v23, v4, s[68:71], s36 offen
    s_add_u32 s36, s23, 28672
    buffer_load_dword v24, v4, s[68:71], s36 offen
    s_add_u32 s36, s23, 32256
    buffer_load_dword v25, v4, s[68:71], s36 offen
    s_add_u32 s36, s23, 35840
    buffer_load_dword v26, v4, s[68:71], s36 offen
    s_add_u32 s36, s23, 39424
    buffer_load_dword v27, v4, s[68:71], s36 offen
    s_add_u32 s36, s23, 43008
    buffer_load_dword v28, v4, s[68:71], s36 offen
    s_add_u32 s36, s23, 46592
    buffer_load_dword v29, v4, s[68:71], s36 offen
    s_add_u32 s36, s23, 50176
    buffer_load_dword v30, v4, s[68:71], s36 offen
    s_add_u32 s36, s23, 53760
    buffer_load_dword v31, v4, s[68:71], s36 offen
    s_add_u32 s36, s23, 57344
    buffer_load_dword v32, v4, s[68:71], s36 offen
    s_add_u32 s36, s23, 60928
    buffer_load_dword v33, v4, s[68:71], s36 offen
    s_add_u32 s36, s23, 64512
    buffer_load_dword v34, v4, s[68:71], s36 offen
    s_add_u32 s36, s23, 68096
    buffer_load_dword v35, v4, s[68:71], s36 offen
    s_add_u32 s36, s23, 71680
    buffer_load_dword v36, v4, s[68:71], s36 offen
    s_add_u32 s36, s23, 75264
    buffer_load_dword v37, v4, s[68:71], s36 offen
    s_add_u32 s36, s23, 78848
    buffer_load_dword v38, v4, s[68:71], s36 offen
    s_add_u32 s36, s23, 82432
    buffer_load_dword v39, v4, s[68:71], s36 offen
    s_add_u32 s36, s23, 86016
    buffer_load_dword v40, v4, s[68:71], s36 offen
    s_add_u32 s36, s23, 89600
    buffer_load_dword v41, v4, s[68:71], s36 offen
    s_add_u32 s36, s23, 93184
    buffer_load_dword v42, v4, s[68:71], s36 offen
    s_add_u32 s36, s23, 96768
    buffer_load_dword v43, v4, s[68:71], s36 offen
    s_add_u32 s36, s23, 100352
    buffer_load_dword v44, v4, s[68:71], s36 offen
    s_add_u32 s36, s23, 103936
    buffer_load_dword v45, v4, s[68:71], s36 offen
    s_add_u32 s36, s23, 107520
    buffer_load_dword v46, v4, s[68:71], s36 offen
    s_add_u32 s36, s23, 111104
    buffer_load_dword v47, v4, s[68:71], s36 offen
    s_waitcnt vmcnt(0)
    v_perm_b32 v192, v17, v16, s34
    v_perm_b32 v193, v19, v18, s34
    v_perm_b32 v194, v21, v20, s34
    v_perm_b32 v195, v23, v22, s34
    v_perm_b32 v196, v25, v24, s34
    v_perm_b32 v197, v27, v26, s34
    v_perm_b32 v198, v29, v28, s34
    v_perm_b32 v199, v31, v30, s34
    v_perm_b32 v200, v33, v32, s34
    v_perm_b32 v201, v35, v34, s34
    v_perm_b32 v202, v37, v36, s34
    v_perm_b32 v203, v39, v38, s34
    v_perm_b32 v204, v41, v40, s34
    v_perm_b32 v205, v43, v42, s34
    v_perm_b32 v206, v45, v44, s34
    v_perm_b32 v207, v47, v46, s34
    v_perm_b32 v224, v17, v16, s35
    v_perm_b32 v225, v19, v18, s35
    v_perm_b32 v226, v21, v20, s35
    v_perm_b32 v227, v23, v22, s35
    v_perm_b32 v228, v25, v24, s35
    v_perm_b32 v229, v27, v26, s35
    v_perm_b32 v230, v29, v28, s35
    v_perm_b32 v231, v31, v30, s35
    v_perm_b32 v232, v33, v32, s35
    v_perm_b32 v233, v35, v34, s35
    v_perm_b32 v234, v37, v36, s35
    v_perm_b32 v235, v39, v38, s35
    v_perm_b32 v236, v41, v40, s35
    v_perm_b32 v237, v43, v42, s35
    v_perm_b32 v238, v45, v44, s35
    v_perm_b32 v239, v47, v46, s35
    s_add_u32 s36, s23, 114688
    buffer_load_dword v16, v4, s[68:71], s36 offen
    s_add_u32 s36, s23, 118272
    buffer_load_dword v17, v4, s[68:71], s36 offen
    s_add_u32 s36, s23, 121856
    buffer_load_dword v18, v4, s[68:71], s36 offen
    s_add_u32 s36, s23, 125440
    buffer_load_dword v19, v4, s[68:71], s36 offen
    s_add_u32 s36, s23, 129024
    buffer_load_dword v20, v4, s[68:71], s36 offen
    s_add_u32 s36, s23, 132608
    buffer_load_dword v21, v4, s[68:71], s36 offen
    s_add_u32 s36, s23, 136192
    buffer_load_dword v22, v4, s[68:71], s36 offen
    s_add_u32 s36, s23, 139776
    buffer_load_dword v23, v4, s[68:71], s36 offen
    s_add_u32 s36, s23, 143360
    buffer_load_dword v24, v4, s[68:71], s36 offen
    s_add_u32 s36, s23, 146944
    buffer_load_dword v25, v4, s[68:71], s36 offen
    s_add_u32 s36, s23, 150528
    buffer_load_dword v26, v4, s[68:71], s36 offen
    s_add_u32 s36, s23, 154112
    buffer_load_dword v27, v4, s[68:71], s36 offen
    s_add_u32 s36, s23, 157696
    buffer_load_dword v28, v4, s[68:71], s36 offen
    s_add_u32 s36, s23, 161280
    buffer_load_dword v29, v4, s[68:71], s36 offen
    s_add_u32 s36, s23, 164864
    buffer_load_dword v30, v4, s[68:71], s36 offen
    s_add_u32 s36, s23, 168448
    buffer_load_dword v31, v4, s[68:71], s36 offen
    s_add_u32 s36, s23, 172032
    buffer_load_dword v32, v4, s[68:71], s36 offen
    s_add_u32 s36, s23, 175616
    buffer_load_dword v33, v4, s[68:71], s36 offen
    s_add_u32 s36, s23, 179200
    buffer_load_dword v34, v4, s[68:71], s36 offen
    s_add_u32 s36, s23, 182784
    buffer_load_dword v35, v4, s[68:71], s36 offen
    s_add_u32 s36, s23, 186368
    buffer_load_dword v36, v4, s[68:71], s36 offen
    s_add_u32 s36, s23, 189952
    buffer_load_dword v37, v4, s[68:71], s36 offen
    s_add_u32 s36, s23, 193536
    buffer_load_dword v38, v4, s[68:71], s36 offen
    s_add_u32 s36, s23, 197120
    buffer_load_dword v39, v4, s[68:71], s36 offen
    s_add_u32 s36, s23, 200704
    buffer_load_dword v40, v4, s[68:71], s36 offen
    s_add_u32 s36, s23, 204288
    buffer_load_dword v41, v4, s[68:71], s36 offen
    s_add_u32 s36, s23, 207872
    buffer_load_dword v42, v4, s[68:71], s36 offen
    s_add_u32 s36, s23, 211456
    buffer_load_dword v43, v4, s[68:71], s36 offen
    s_add_u32 s36, s23, 215040
    buffer_load_dword v44, v4, s[68:71], s36 offen
    s_add_u32 s36, s23, 218624
    buffer_load_dword v45, v4, s[68:71], s36 offen
    s_add_u32 s36, s23, 222208
    buffer_load_dword v46, v4, s[68:71], s36 offen
    s_add_u32 s36, s23, 225792
    buffer_load_dword v47, v4, s[68:71], s36 offen
    s_waitcnt vmcnt(0)
    v_perm_b32 v208, v17, v16, s34
    v_perm_b32 v209, v19, v18, s34
    v_perm_b32 v210, v21, v20, s34
    v_perm_b32 v211, v23, v22, s34
    v_perm_b32 v212, v25, v24, s34
    v_perm_b32 v213, v27, v26, s34
    v_perm_b32 v214, v29, v28, s34
    v_perm_b32 v215, v31, v30, s34
    v_perm_b32 v216, v33, v32, s34
    v_perm_b32 v217, v35, v34, s34
    v_perm_b32 v218, v37, v36, s34
    v_perm_b32 v219, v39, v38, s34
    v_perm_b32 v220, v41, v40, s34
    v_perm_b32 v221, v43, v42, s34
    v_perm_b32 v222, v45, v44, s34
    v_perm_b32 v223, v47, v46, s34
    v_perm_b32 v240, v17, v16, s35
    v_perm_b32 v241, v19, v18, s35
    v_perm_b32 v242, v21, v20, s35
    v_perm_b32 v243, v23, v22, s35
    v_perm_b32 v244, v25, v24, s35
    v_perm_b32 v245, v27, v26, s35
    v_perm_b32 v246, v29, v28, s35
    v_perm_b32 v247, v31, v30, s35
    v_perm_b32 v248, v33, v32, s35
    v_perm_b32 v249, v35, v34, s35
    v_perm_b32 v250, v37, v36, s35
    v_perm_b32 v251, v39, v38, s35
    v_perm_b32 v252, v41, v40, s35
    v_perm_b32 v253, v43, v42, s35
    v_perm_b32 v254, v45, v44, s35
    v_perm_b32 v255, v47, v46, s35
    v_lshrrev_b32 v3, 3, v0
    v_mul_u32_u24 v4, 57344, v3
    v_and_b32 v3, 7, v0
    v_lshl_add_u32 v4, v3, 2, v4
    s_lshl_b32 s37, s20, 5
    s_add_u32 s36, s37, 0
    buffer_load_dword v16, v4, s[76:79], s36 offen
    s_add_u32 s36, s37, 1024
    buffer_load_dword v17, v4, s[76:79], s36 offen
    s_add_u32 s36, s37, 2048
    buffer_load_dword v18, v4, s[76:79], s36 offen
    s_add_u32 s36, s37, 3072
    buffer_load_dword v19, v4, s[76:79], s36 offen
    s_add_u32 s36, s37, 4096
    buffer_load_dword v20, v4, s[76:79], s36 offen
    s_add_u32 s36, s37, 5120
    buffer_load_dword v21, v4, s[76:79], s36 offen
    s_add_u32 s36, s37, 6144
    buffer_load_dword v22, v4, s[76:79], s36 offen
    s_add_u32 s36, s37, 7168
    buffer_load_dword v23, v4, s[76:79], s36 offen
    s_add_u32 s36, s37, 8192
    buffer_load_dword v24, v4, s[76:79], s36 offen
    s_add_u32 s36, s37, 9216
    buffer_load_dword v25, v4, s[76:79], s36 offen
    s_add_u32 s36, s37, 10240
    buffer_load_dword v26, v4, s[76:79], s36 offen
    s_add_u32 s36, s37, 11264
    buffer_load_dword v27, v4, s[76:79], s36 offen
    s_add_u32 s36, s37, 12288
    buffer_load_dword v28, v4, s[76:79], s36 offen
    s_add_u32 s36, s37, 13312
    buffer_load_dword v29, v4, s[76:79], s36 offen
    s_add_u32 s36, s37, 14336
    buffer_load_dword v30, v4, s[76:79], s36 offen
    s_add_u32 s36, s37, 15360
    buffer_load_dword v31, v4, s[76:79], s36 offen
    s_add_u32 s36, s37, 16384
    buffer_load_dword v32, v4, s[76:79], s36 offen
    s_add_u32 s36, s37, 17408
    buffer_load_dword v33, v4, s[76:79], s36 offen
    s_add_u32 s36, s37, 18432
    buffer_load_dword v34, v4, s[76:79], s36 offen
    s_add_u32 s36, s37, 19456
    buffer_load_dword v35, v4, s[76:79], s36 offen
    s_add_u32 s36, s37, 20480
    buffer_load_dword v36, v4, s[76:79], s36 offen
    s_add_u32 s36, s37, 21504
    buffer_load_dword v37, v4, s[76:79], s36 offen
    s_add_u32 s36, s37, 22528
    buffer_load_dword v38, v4, s[76:79], s36 offen
    s_add_u32 s36, s37, 23552
    buffer_load_dword v39, v4, s[76:79], s36 offen
    s_add_u32 s36, s37, 24576
    buffer_load_dword v40, v4, s[76:79], s36 offen
    s_add_u32 s36, s37, 25600
    buffer_load_dword v41, v4, s[76:79], s36 offen
    s_add_u32 s36, s37, 26624
    buffer_load_dword v42, v4, s[76:79], s36 offen
    s_add_u32 s36, s37, 27648
    buffer_load_dword v43, v4, s[76:79], s36 offen
    s_waitcnt vmcnt(0)
    v_perm_b32 v64, v17, v16, s34
    v_perm_b32 v65, v19, v18, s34
    v_perm_b32 v66, v21, v20, s34
    v_perm_b32 v67, v23, v22, s34
    v_perm_b32 v68, v25, v24, s34
    v_perm_b32 v69, v27, v26, s34
    v_perm_b32 v70, v29, v28, s34
    v_perm_b32 v71, v31, v30, s34
    v_perm_b32 v72, v33, v32, s34
    v_perm_b32 v73, v35, v34, s34
    v_perm_b32 v74, v37, v36, s34
    v_perm_b32 v75, v39, v38, s34
    v_perm_b32 v76, v41, v40, s34
    v_perm_b32 v77, v43, v42, s34
    v_perm_b32 v92, v17, v16, s35
    v_perm_b32 v93, v19, v18, s35
    v_perm_b32 v94, v21, v20, s35
    v_perm_b32 v95, v23, v22, s35
    v_perm_b32 v96, v25, v24, s35
    v_perm_b32 v97, v27, v26, s35
    v_perm_b32 v98, v29, v28, s35
    v_perm_b32 v99, v31, v30, s35
    v_perm_b32 v100, v33, v32, s35
    v_perm_b32 v101, v35, v34, s35
    v_perm_b32 v102, v37, v36, s35
    v_perm_b32 v103, v39, v38, s35
    v_perm_b32 v104, v41, v40, s35
    v_perm_b32 v105, v43, v42, s35
    s_add_u32 s36, s37, 28672
    buffer_load_dword v16, v4, s[76:79], s36 offen
    s_add_u32 s36, s37, 29696
    buffer_load_dword v17, v4, s[76:79], s36 offen
    s_add_u32 s36, s37, 30720
    buffer_load_dword v18, v4, s[76:79], s36 offen
    s_add_u32 s36, s37, 31744
    buffer_load_dword v19, v4, s[76:79], s36 offen
    s_add_u32 s36, s37, 32768
    buffer_load_dword v20, v4, s[76:79], s36 offen
    s_add_u32 s36, s37, 33792
    buffer_load_dword v21, v4, s[76:79], s36 offen
    s_add_u32 s36, s37, 34816
    buffer_load_dword v22, v4, s[76:79], s36 offen
    s_add_u32 s36, s37, 35840
    buffer_load_dword v23, v4, s[76:79], s36 offen
    s_add_u32 s36, s37, 36864
    buffer_load_dword v24, v4, s[76:79], s36 offen
    s_add_u32 s36, s37, 37888
    buffer_load_dword v25, v4, s[76:79], s36 offen
    s_add_u32 s36, s37, 38912
    buffer_load_dword v26, v4, s[76:79], s36 offen
    s_add_u32 s36, s37, 39936
    buffer_load_dword v27, v4, s[76:79], s36 offen
    s_add_u32 s36, s37, 40960
    buffer_load_dword v28, v4, s[76:79], s36 offen
    s_add_u32 s36, s37, 41984
    buffer_load_dword v29, v4, s[76:79], s36 offen
    s_add_u32 s36, s37, 43008
    buffer_load_dword v30, v4, s[76:79], s36 offen
    s_add_u32 s36, s37, 44032
    buffer_load_dword v31, v4, s[76:79], s36 offen
    s_add_u32 s36, s37, 45056
    buffer_load_dword v32, v4, s[76:79], s36 offen
    s_add_u32 s36, s37, 46080
    buffer_load_dword v33, v4, s[76:79], s36 offen
    s_add_u32 s36, s37, 47104
    buffer_load_dword v34, v4, s[76:79], s36 offen
    s_add_u32 s36, s37, 48128
    buffer_load_dword v35, v4, s[76:79], s36 offen
    s_add_u32 s36, s37, 49152
    buffer_load_dword v36, v4, s[76:79], s36 offen
    s_add_u32 s36, s37, 50176
    buffer_load_dword v37, v4, s[76:79], s36 offen
    s_add_u32 s36, s37, 51200
    buffer_load_dword v38, v4, s[76:79], s36 offen
    s_add_u32 s36, s37, 52224
    buffer_load_dword v39, v4, s[76:79], s36 offen
    s_add_u32 s36, s37, 53248
    buffer_load_dword v40, v4, s[76:79], s36 offen
    s_add_u32 s36, s37, 54272
    buffer_load_dword v41, v4, s[76:79], s36 offen
    s_add_u32 s36, s37, 55296
    buffer_load_dword v42, v4, s[76:79], s36 offen
    s_add_u32 s36, s37, 56320
    buffer_load_dword v43, v4, s[76:79], s36 offen
    s_waitcnt vmcnt(0)
    v_perm_b32 v78, v17, v16, s34
    v_perm_b32 v79, v19, v18, s34
    v_perm_b32 v80, v21, v20, s34
    v_perm_b32 v81, v23, v22, s34
    v_perm_b32 v82, v25, v24, s34
    v_perm_b32 v83, v27, v26, s34
    v_perm_b32 v84, v29, v28, s34
    v_perm_b32 v85, v31, v30, s34
    v_perm_b32 v86, v33, v32, s34
    v_perm_b32 v87, v35, v34, s34
    v_perm_b32 v88, v37, v36, s34
    v_perm_b32 v89, v39, v38, s34
    v_perm_b32 v90, v41, v40, s34
    v_perm_b32 v91, v43, v42, s34
    v_perm_b32 v106, v17, v16, s35
    v_perm_b32 v107, v19, v18, s35
    v_perm_b32 v108, v21, v20, s35
    v_perm_b32 v109, v23, v22, s35
    v_perm_b32 v110, v25, v24, s35
    v_perm_b32 v111, v27, v26, s35
    v_perm_b32 v112, v29, v28, s35
    v_perm_b32 v113, v31, v30, s35
    v_perm_b32 v114, v33, v32, s35
    v_perm_b32 v115, v35, v34, s35
    v_perm_b32 v116, v37, v36, s35
    v_perm_b32 v117, v39, v38, s35
    v_perm_b32 v118, v41, v40, s35
    v_perm_b32 v119, v43, v42, s35
    s_mov_b32 s24, 0
    s_mov_b64 s[28:29], 0
    v_mov_b32 v12, 0x40000000
    v_mov_b32 v13, 0
    v_lshlrev_b32 v3, 4, v0
L_M06_rp:
    s_mov_b32 s36, 0x19a000
    buffer_load_dwordx4 v[40:43], v3, s[8:11], s36 offen sc1
    s_add_u32 s32, s32, 1
    v_mov_b32 v5, 0
    s_waitcnt vmcnt(0)
    v_max3_u32 v5, v5, v40, v41
    v_max3_u32 v5, v5, v42, v43
    s_cmp_gt_u32 s32, 200000
    s_cbranch_scc1 L_M06_rp_ok
    v_cmp_eq_u32 vcc, -1, v5
    s_cbranch_vccz L_M06_rp_ok
    s_sleep 32
    s_branch L_M06_rp
L_M06_rp_ok:
    v_add_f32 v40, v40, v41
    v_add_f32 v42, v42, v43
    v_add_f32 v40, v40, v42
    v_cvt_pk_bf16_f32 v5, v40, v40
    v_lshlrev_b32 v40, 16, v5
    v_ashrrev_i32 v5, 31, v40
    v_or_b32 v5, 0x80000000, v5
    v_xor_b32 v5, v5, v40
    v_and_b32 v5, 0xffff0000, v5
    v_sub_u32 v6, 511, v0
    v_or_b32 v126, v5, v6
    v_lshlrev_b32 v3, 4, v0
L_M01_rp:
    s_mov_b32 s36, 0x195000
    buffer_load_dwordx4 v[20:23], v3, s[8:11], s36 offen sc1
    s_mov_b32 s36, 0x196000
    buffer_load_dwordx4 v[24:27], v3, s[8:11], s36 offen sc1
    s_mov_b32 s36, 0x197000
    buffer_load_dwordx4 v[28:31], v3, s[8:11], s36 offen sc1
    s_mov_b32 s36, 0x198000
    buffer_load_dwordx4 v[32:35], v3, s[8:11], s36 offen sc1
    s_mov_b32 s36, 0x199000
    buffer_load_dwordx4 v[36:39], v3, s[8:11], s36 offen sc1
    s_add_u32 s32, s32, 1
    v_mov_b32 v5, 0
    s_waitcnt vmcnt(0)
    v_max3_u32 v5, v5, v20, v21
    v_max3_u32 v5, v5, v22, v23
    v_max3_u32 v5, v5, v24, v25
    v_max3_u32 v5, v5, v26, v27
    v_max3_u32 v5, v5, v28, v29
    v_max3_u32 v5, v5, v30, v31
    v_max3_u32 v5, v5, v32, v33
    v_max3_u32 v5, v5, v34, v35
    v_max3_u32 v5, v5, v36, v37
    v_max3_u32 v5, v5, v38, v39
    s_cmp_gt_u32 s32, 200000
    s_cbranch_scc1 L_M01_rp_ok
    v_cmp_eq_u32 vcc, -1, v5
    s_cbranch_vccz L_M01_rp_ok
    s_sleep 8
    s_branch L_M01_rp
L_M01_rp_ok:
    v_add_f32 v20, v20, v21
    v_add_f32 v22, v22, v23
    v_add_f32 v20, v20, v22
    v_cvt_pk_bf16_f32 v5, v20, v20
    v_lshlrev_b32 v20, 16, v5
    v_ashrrev_i32 v5, 31, v20
    v_or_b32 v5, 0x80000000, v5
    v_xor_b32 v5, v5, v20
    v_and_b32 v5, 0xffff0000, v5
    v_sub_u32 v6, 1791, v0
    v_or_b32 v121, v5, v6
    v_add_f32 v24, v24, v25
    v_add_f32 v26, v26, v27
    v_add_f32 v24, v24, v26
    v_cvt_pk_bf16_f32 v5, v24, v24
    v_lshlrev_b32 v24, 16, v5
    v_ashrrev_i32 v5, 31, v24
    v_or_b32 v5, 0x80000000, v5
    v_xor_b32 v5, v5, v24
    v_and_b32 v5, 0xffff0000, v5
    v_sub_u32 v6, 1535, v0
    v_or_b32 v122, v5, v6
    v_add_f32 v28, v28, v29
    v_add_f32 v30, v30, v31
    v_add_f32 v28, v28, v30
    v_cvt_pk_bf16_f32 v5, v28, v28
    v_lshlrev_b32 v28, 16, v5
    v_ashrrev_i32 v5, 31, v28
    v_or_b32 v5, 0x80000000, v5
    v_xor_b32 v5, v5, v28
    v_and_b32 v5, 0xffff0000, v5
    v_sub_u32 v6, 1279, v0
    v_or_b32 v123, v5, v6
    v_add_f32 v32, v32, v33
    v_add_f32 v34, v34, v35
    v_add_f32 v32, v32, v34
    v_cvt_pk_bf16_f32 v5, v32, v32
    v_lshlrev_b32 v32, 16, v5
    v_ashrrev_i32 v5, 31, v32
    v_or_b32 v5, 0x80000000, v5
    v_xor_b32 v5, v5, v32
    v_and_b32 v5, 0xffff0000, v5
    v_sub_u32 v6, 1023, v0
    v_or_b32 v124, v5, v6
    v_add_f32 v36, v36, v37
    v_add_f32 v38, v38, v39
    v_add_f32 v36, v36, v38
    v_cvt_pk_bf16_f32 v5, v36, v36
    v_lshlrev_b32 v36, 16, v5
    v_ashrrev_i32 v5, 31, v36
    v_or_b32 v5, 0x80000000, v5
    v_xor_b32 v5, v5, v36
    v_and_b32 v5, 0xffff0000, v5
    v_sub_u32 v6, 767, v0
    v_or_b32 v125, v5, v6
    v_max_u32 v5, v120, v121
    v_min_u32 v6, v120, v121
    v_med3_u32 v6, v5, v6, v122
    v_max_u32 v5, v5, v122
    v_med3_u32 v6, v5, v6, v123
    v_max_u32 v5, v5, v123
    v_med3_u32 v6, v5, v6, v124
    v_max_u32 v5, v5, v124
    v_med3_u32 v6, v5, v6, v125
    v_max_u32 v5, v5, v125
    v_med3_u32 v6, v5, v6, v126
    v_max_u32 v5, v5, v126
    v_mov_b32 v120, v5
    v_mov_b32 v121, v6
    s_mov_b32 s25, 32
L_M_round:
    v_lshlrev_b32 v3, 4, v0
    v_cmp_gt_u32 s[74:75], s25, v0
L_M7_rp:
    s_mov_b32 s36, 0x19b000
    buffer_load_dwordx4 v[44:47], v3, s[8:11], s36 offen sc1
    s_add_u32 s32, s32, 1
    v_mov_b32 v5, 0
    s_waitcnt vmcnt(0)
    v_max3_u32 v5, v5, v44, v45
    v_max3_u32 v5, v5, v46, v47
    v_cndmask_b32 v5, 0, v5, s[74:75]
    s_cmp_gt_u32 s32, 200000
    s_cbranch_scc1 L_M7_rp_ok
    v_cmp_eq_u32 vcc, -1, v5
    s_cbranch_vccnz L_M7_rp
L_M7_rp_ok:
    v_add_f32 v44, v44, v45
    v_add_f32 v46, v46, v47
    v_add_f32 v44, v44, v46
    v_cvt_pk_bf16_f32 v5, v44, v44
    v_lshlrev_b32 v44, 16, v5
    v_ashrrev_i32 v5, 31, v44
    v_or_b32 v5, 0x80000000, v5
    v_xor_b32 v5, v5, v44
    v_and_b32 v5, 0xffff0000, v5
    v_sub_u32 v6, 255, v0
    v_or_b32 v127, v5, v6
    v_cndmask_b32 v127, 0, v127, s[74:75]
    v_max_u32 v5, v120, v127
    v_med3_u32 v6, v120, v121, v127
    s_nop 0
    v_mov_b32_dpp v7, v5 quad_perm:[1,0,3,2] row_mask:0xf bank_mask:0xf
    v_mov_b32_dpp v8, v6 quad_perm:[1,0,3,2] row_mask:0xf bank_mask:0xf
    v_min_u32 v9, v5, v7
    v_max_u32 v5, v5, v7
    v_max3_u32 v6, v6, v8, v9
    s_nop 0
    v_mov_b32_dpp v7, v5 quad_perm:[2,3,0,1] row_mask:0xf bank_mask:0xf
    v_mov_b32_dpp v8, v6 quad_perm:[2,3,0,1] row_mask:0xf bank_mask:0xf
    v_min_u32 v9, v5, v7
    v_max_u32 v5, v5, v7
    v_max3_u32 v6, v6, v8, v9
    s_nop 0
    v_mov_b32_dpp v7, v5 row_half_mirror row_mask:0xf bank_mask:0xf
    v_mov_b32_dpp v8, v6 row_half_mirror row_mask:0xf bank_mask:0xf
    v_min_u32 v9, v5, v7
    v_max_u32 v5, v5, v7
    v_max3_u32 v6, v6, v8, v9
    s_nop 0
    v_mov_b32_dpp v7, v5 row_mirror row_mask:0xf bank_mask:0xf
    v_mov_b32_dpp v8, v6 row_mirror row_mask:0xf bank_mask:0xf
    v_min_u32 v9, v5, v7
    v_max_u32 v5, v5, v7
    v_max3_u32 v6, v6, v8, v9
    v_lshrrev_b32 v9, 4, v0
    v_lshlrev_b32 v9, 3, v9
    s_barrier
    ds_write2_b32 v9, v5, v6 offset0:0 offset1:1
    v_and_b32 v9, 15, v0
    v_lshlrev_b32 v9, 3, v9
    s_waitcnt lgkmcnt(0)
    s_barrier
    ds_read2_b32 v[10:11], v9 offset0:0 offset1:1
    s_waitcnt lgkmcnt(0)
    v_mov_b32 v5, v10
    v_mov_b32 v6, v11
    s_nop 0
    v_mov_b32_dpp v7, v5 quad_perm:[1,0,3,2] row_mask:0xf bank_mask:0xf
    v_mov_b32_dpp v8, v6 quad_perm:[1,0,3,2] row_mask:0xf bank_mask:0xf
    v_min_u32 v9, v5, v7
    v_max_u32 v5, v5, v7
    v_max3_u32 v6, v6, v8, v9
    s_nop 0
    v_mov_b32_dpp v7, v5 quad_perm:[2,3,0,1] row_mask:0xf bank_mask:0xf
    v_mov_b32_dpp v8, v6 quad_perm:[2,3,0,1] row_mask:0xf bank_mask:0xf
    v_min_u32 v9, v5, v7
    v_max_u32 v5, v5, v7
    v_max3_u32 v6, v6, v8, v9
    s_nop 0
    v_mov_b32_dpp v7, v5 row_half_mirror row_mask:0xf bank_mask:0xf
    v_mov_b32_dpp v8, v6 row_half_mirror row_mask:0xf bank_mask:0xf
    v_min_u32 v9, v5, v7
    v_max_u32 v5, v5, v7
    v_max3_u32 v6, v6, v8, v9
    s_nop 0
    v_mov_b32_dpp v7, v5 row_mirror row_mask:0xf bank_mask:0xf
    v_mov_b32_dpp v8, v6 row_mirror row_mask:0xf bank_mask:0xf
    v_min_u32 v9, v5, v7
    v_max_u32 v5, v5, v7
    v_max3_u32 v6, v6, v8, v9
    v_readfirstlane_b32 s26, v5
    v_readfirstlane_b32 s27, v6
    s_nop 3
    s_cmp_eq_u64 s[26:27], s[28:29]
    s_cbranch_scc1 L_M_next
    s_mov_b64 s[28:29], s[26:27]
    s_and_b32 s36, s26, 0x7ff
    s_sub_u32 s30, 2047, s36
    s_and_b32 s36, s26, 0xffff0000
    s_xor_b32 s37, s36, 0x80000000
    s_xor_b32 s40, s36, 0xffff0000
    s_bitcmp1_b32 s36, 31
    s_cselect_b32 s40, s37, s40
    s_and_b32 s36, s27, 0x7ff
    s_sub_u32 s31, 2047, s36
    s_and_b32 s36, s27, 0xffff0000
    s_xor_b32 s37, s36, 0x80000000
    s_xor_b32 s41, s36, 0xffff0000
    s_bitcmp1_b32 s36, 31
    s_cselect_b32 s41, s37, s41
    v_mov_b32 v8, 0
L_M_rows:
    s_lshl_b32 s36, s30, 4
    s_add_u32 s36, s36, 0x1b8000
    buffer_load_dwordx4 v[16:19], v8, s[8:11], s36 offen sc1
    s_lshl_b32 s36, s31, 4
    s_add_u32 s36, s36, 0x1b8000
    buffer_load_dwordx4 v[20:23], v8, s[8:11], s36 offen sc1
    s_add_u32 s32, s32, 1
    s_cmp_gt_u32 s32, 200000
    s_waitcnt vmcnt(0)
    v_or3_b32 v5, v16, v17, v18
    v_or3_b32 v5, v5, v19, v20
    v_or3_b32 v5, v5, v21, v22
    v_or_b32 v5, v5, v23
    s_cbranch_scc1 L_M_rows_ok
    v_cmp_ne_u32 vcc, 0, v5
    s_cbranch_vccnz L_M_rows
L_M_rows_ok:
    v_bfe_u32 v9, v0, 6, 1
    v_cmp_ne_u32 vcc, 0, v9
    v_mov_b32 v5, s30
    v_mov_b32 v6, s31
    v_cndmask_b32 v7, v5, v6, vcc
    v_lshlrev_b32 v7, 10, v7
    v_and_b32 v8, 63, v0
    v_lshl_add_u32 v7, v8, 4, v7
    s_mov_b32 s37, 0x600000
    buffer_load_dwordx4 v[16:19], v7, s[8:11], s37 offen sc1
    v_bfe_u32 v9, v0, 3, 1
    v_cmp_ne_u32 vcc, 0, v9
    s_nop 1
    v_cndmask_b32 v12, v5, v6, vcc
    v_mov_b32 v5, s40
    v_mov_b32 v6, s41
    v_cndmask_b32 v11, v5, v6, vcc
    v_lshlrev_b32 v12, 10, v12
    v_and_b32 v3, 7, v0
    v_lshl_add_u32 v12, v3, 2, v12
    s_lshl_b32 s36, s20, 5
    v_add_u32 v12, s36, v12
    v_mov_b32 v7, 0x40000000
    v_cmp_lt_u32 vcc, 15, v0
    s_nop 1
    v_cndmask_b32 v12, v12, v7, vcc
    s_mov_b32 s36, 0x400000
    buffer_load_dword v14, v12, s[8:11], s36 offen sc1
    buffer_load_dword v15, v12, s[8:11], s37 offen sc1
    v_and_b32 v8, 127, v0
    v_lshlrev_b32 v8, 4, v8
    s_waitcnt vmcnt(2)
    ds_write_b128 v8, v[16:19] offset:4096
    s_waitcnt lgkmcnt(0)
    s_barrier
    v_mov_b64 v[48:49], 0
    v_mov_b64 v[50:51], 0
    v_mov_b64 v[52:53], 0
    v_mov_b64 v[54:55], 0
    v_lshlrev_b32 v8, 7, v1
    ds_read_b128 v[16:19], v8 offset:4096
    ds_read_b128 v[20:23], v8 offset:4112
    ds_read_b128 v[24:27], v8 offset:4128
    ds_read_b128 v[28:31], v8 offset:4144
    ds_read_b128 v[32:35], v8 offset:5120
    ds_read_b128 v[36:39], v8 offset:5136
    ds_read_b128 v[40:43], v8 offset:5152
    ds_read_b128 v[44:47], v8 offset:5168
    s_waitcnt lgkmcnt(0)
    v_dot2_f32_bf16 v48, v16, v128, v48
    v_dot2_f32_bf16 v49, v16, v160, v49
    v_dot2_f32_bf16 v50, v32, v128, v50
    v_dot2_f32_bf16 v51, v32, v160, v51
    v_dot2_f32_bf16 v52, v16, v192, v52
    v_dot2_f32_bf16 v53, v16, v224, v53
    v_dot2_f32_bf16 v54, v32, v192, v54
    v_dot2_f32_bf16 v55, v32, v224, v55
    v_dot2_f32_bf16 v48, v17, v129, v48
    v_dot2_f32_bf16 v49, v17, v161, v49
    v_dot2_f32_bf16 v50, v33, v129, v50
    v_dot2_f32_bf16 v51, v33, v161, v51
    v_dot2_f32_bf16 v52, v17, v193, v52
    v_dot2_f32_bf16 v53, v17, v225, v53
    v_dot2_f32_bf16 v54, v33, v193, v54
    v_dot2_f32_bf16 v55, v33, v225, v55
    v_dot2_f32_bf16 v48, v18, v130, v48
    v_dot2_f32_bf16 v49, v18, v162, v49
    v_dot2_f32_bf16 v50, v34, v130, v50
    v_dot2_f32_bf16 v51, v34, v162, v51
    v_dot2_f32_bf16 v52, v18, v194, v52
    v_dot2_f32_bf16 v53, v18, v226, v53
    v_dot2_f32_bf16 v54, v34, v194, v54
    v_dot2_f32_bf16 v55, v34, v226, v55
    v_dot2_f32_bf16 v48, v19, v131, v48
    v_dot2_f32_bf16 v49, v19, v163, v49
    v_dot2_f32_bf16 v50, v35, v131, v50
    v_dot2_f32_bf16 v51, v35, v163, v51
    v_dot2_f32_bf16 v52, v19, v195, v52
    v_dot2_f32_bf16 v53, v19, v227, v53
    v_dot2_f32_bf16 v54, v35, v195, v54
    v_dot2_f32_bf16 v55, v35, v227, v55
    v_dot2_f32_bf16 v48, v20, v132, v48
    v_dot2_f32_bf16 v49, v20, v164, v49
    v_dot2_f32_bf16 v50, v36, v132, v50
    v_dot2_f32_bf16 v51, v36, v164, v51
    v_dot2_f32_bf16 v52, v20, v196, v52
    v_dot2_f32_bf16 v53, v20, v228, v53
    v_dot2_f32_bf16 v54, v36, v196, v54
    v_dot2_f32_bf16 v55, v36, v228, v55
    v_dot2_f32_bf16 v48, v21, v133, v48
    v_dot2_f32_bf16 v49, v21, v165, v49
    v_dot2_f32_bf16 v50, v37, v133, v50
    v_dot2_f32_bf16 v51, v37, v165, v51
    v_dot2_f32_bf16 v52, v21, v197, v52
    v_dot2_f32_bf16 v53, v21, v229, v53
    v_dot2_f32_bf16 v54, v37, v197, v54
    v_dot2_f32_bf16 v55, v37, v229, v55
    v_dot2_f32_bf16 v48, v22, v134, v48
    v_dot2_f32_bf16 v49, v22, v166, v49
    v_dot2_f32_bf16 v50, v38, v134, v50
    v_dot2_f32_bf16 v51, v38, v166, v51
    v_dot2_f32_bf16 v52, v22, v198, v52
    v_dot2_f32_bf16 v53, v22, v230, v53
    v_dot2_f32_bf16 v54, v38, v198, v54
    v_dot2_f32_bf16 v55, v38, v230, v55
    v_dot2_f32_bf16 v48, v23, v135, v48
    v_dot2_f32_bf16 v49, v23, v167, v49
    v_dot2_f32_bf16 v50, v39, v135, v50
    v_dot2_f32_bf16 v51, v39, v167, v51
    v_dot2_f32_bf16 v52, v23, v199, v52
    v_dot2_f32_bf16 v53, v23, v231, v53
    v_dot2_f32_bf16 v54, v39, v199, v54
    v_dot2_f32_bf16 v55, v39, v231, v55
    v_dot2_f32_bf16 v48, v24, v136, v48
    v_dot2_f32_bf16 v49, v24, v168, v49
    v_dot2_f32_bf16 v50, v40, v136, v50
    v_dot2_f32_bf16 v51, v40, v168, v51
    v_dot2_f32_bf16 v52, v24, v200, v52
    v_dot2_f32_bf16 v53, v24, v232, v53
    v_dot2_f32_bf16 v54, v40, v200, v54
    v_dot2_f32_bf16 v55, v40, v232, v55
    v_dot2_f32_bf16 v48, v25, v137, v48
    v_dot2_f32_bf16 v49, v25, v169, v49
    v_dot2_f32_bf16 v50, v41, v137, v50
    v_dot2_f32_bf16 v51, v41, v169, v51
    v_dot2_f32_bf16 v52, v25, v201, v52
    v_dot2_f32_bf16 v53, v25, v233, v53
    v_dot2_f32_bf16 v54, v41, v201, v54
    v_dot2_f32_bf16 v55, v41, v233, v55
    v_dot2_f32_bf16 v48, v26, v138, v48
    v_dot2_f32_bf16 v49, v26, v170, v49
    v_dot2_f32_bf16 v50, v42, v138, v50
    v_dot2_f32_bf16 v51, v42, v170, v51
    v_dot2_f32_bf16 v52, v26, v202, v52
    v_dot2_f32_bf16 v53, v26, v234, v53
    v_dot2_f32_bf16 v54, v42, v202, v54
    v_dot2_f32_bf16 v55, v42, v234, v55
    v_dot2_f32_bf16 v48, v27, v139, v48
    v_dot2_f32_bf16 v49, v27, v171, v49
    v_dot2_f32_bf16 v50, v43, v139, v50
    v_dot2_f32_bf16 v51, v43, v171, v51
    v_dot2_f32_bf16 v52, v27, v203, v52
    v_dot2_f32_bf16 v53, v27, v235, v53
    v_dot2_f32_bf16 v54, v43, v203, v54
    v_dot2_f32_bf16 v55, v43, v235, v55
    v_dot2_f32_bf16 v48, v28, v140, v48
    v_dot2_f32_bf16 v49, v28, v172, v49
    v_dot2_f32_bf16 v50, v44, v140, v50
    v_dot2_f32_bf16 v51, v44, v172, v51
    v_dot2_f32_bf16 v52, v28, v204, v52
    v_dot2_f32_bf16 v53, v28, v236, v53
    v_dot2_f32_bf16 v54, v44, v204, v54
    v_dot2_f32_bf16 v55, v44, v236, v55
    v_dot2_f32_bf16 v48, v29, v141, v48
    v_dot2_f32_bf16 v49, v29, v173, v49
    v_dot2_f32_bf16 v50, v45, v141, v50
    v_dot2_f32_bf16 v51, v45, v173, v51
    v_dot2_f32_bf16 v52, v29, v205, v52
    v_dot2_f32_bf16 v53, v29, v237, v53
    v_dot2_f32_bf16 v54, v45, v205, v54
    v_dot2_f32_bf16 v55, v45, v237, v55
    v_dot2_f32_bf16 v48, v30, v142, v48
    v_dot2_f32_bf16 v49, v30, v174, v49
    v_dot2_f32_bf16 v50, v46, v142, v50
    v_dot2_f32_bf16 v51, v46, v174, v51
    v_dot2_f32_bf16 v52, v30, v206, v52
    v_dot2_f32_bf16 v53, v30, v238, v53
    v_dot2_f32_bf16 v54, v46, v206, v54
    v_dot2_f32_bf16 v55, v46, v238, v55
    v_dot2_f32_bf16 v48, v31, v143, v48
    v_dot2_f32_bf16 v49, v31, v175, v49
    v_dot2_f32_bf16 v50, v47, v143, v50
    v_dot2_f32_bf16 v51, v47, v175, v51
    v_dot2_f32_bf16 v52, v31, v207, v52
    v_dot2_f32_bf16 v53, v31, v239, v53
    v_dot2_f32_bf16 v54, v47, v207, v54
    v_dot2_f32_bf16 v55, v47, v239, v55
    ds_read_b128 v[16:19], v8 offset:4160
    ds_read_b128 v[20:23], v8 offset:4176
    ds_read_b128 v[24:27], v8 offset:4192
    ds_read_b128 v[28:31], v8 offset:4208
    ds_read_b128 v[32:35], v8 offset:5184
    ds_read_b128 v[36:39], v8 offset:5200
    ds_read_b128 v[40:43], v8 offset:5216
    ds_read_b128 v[44:47], v8 offset:5232
    s_waitcnt lgkmcnt(0)
    v_dot2_f32_bf16 v48, v16, v144, v48
    v_dot2_f32_bf16 v49, v16, v176, v49
    v_dot2_f32_bf16 v50, v32, v144, v50
    v_dot2_f32_bf16 v51, v32, v176, v51
    v_dot2_f32_bf16 v52, v16, v208, v52
    v_dot2_f32_bf16 v53, v16, v240, v53
    v_dot2_f32_bf16 v54, v32, v208, v54
    v_dot2_f32_bf16 v55, v32, v240, v55
    v_dot2_f32_bf16 v48, v17, v145, v48
    v_dot2_f32_bf16 v49, v17, v177, v49
    v_dot2_f32_bf16 v50, v33, v145, v50
    v_dot2_f32_bf16 v51, v33, v177, v51
    v_dot2_f32_bf16 v52, v17, v209, v52
    v_dot2_f32_bf16 v53, v17, v241, v53
    v_dot2_f32_bf16 v54, v33, v209, v54
    v_dot2_f32_bf16 v55, v33, v241, v55
    v_dot2_f32_bf16 v48, v18, v146, v48
    v_dot2_f32_bf16 v49, v18, v178, v49
    v_dot2_f32_bf16 v50, v34, v146, v50
    v_dot2_f32_bf16 v51, v34, v178, v51
    v_dot2_f32_bf16 v52, v18, v210, v52
    v_dot2_f32_bf16 v53, v18, v242, v53
    v_dot2_f32_bf16 v54, v34, v210, v54
    v_dot2_f32_bf16 v55, v34, v242, v55
    v_dot2_f32_bf16 v48, v19, v147, v48
    v_dot2_f32_bf16 v49, v19, v179, v49
    v_dot2_f32_bf16 v50, v35, v147, v50
    v_dot2_f32_bf16 v51, v35, v179, v51
    v_dot2_f32_bf16 v52, v19, v211, v52
    v_dot2_f32_bf16 v53, v19, v243, v53
    v_dot2_f32_bf16 v54, v35, v211, v54
    v_dot2_f32_bf16 v55, v35, v243, v55
    v_dot2_f32_bf16 v48, v20, v148, v48
    v_dot2_f32_bf16 v49, v20, v180, v49
    v_dot2_f32_bf16 v50, v36, v148, v50
    v_dot2_f32_bf16 v51, v36, v180, v51
    v_dot2_f32_bf16 v52, v20, v212, v52
    v_dot2_f32_bf16 v53, v20, v244, v53
    v_dot2_f32_bf16 v54, v36, v212, v54
    v_dot2_f32_bf16 v55, v36, v244, v55
    v_dot2_f32_bf16 v48, v21, v149, v48
    v_dot2_f32_bf16 v49, v21, v181, v49
    v_dot2_f32_bf16 v50, v37, v149, v50
    v_dot2_f32_bf16 v51, v37, v181, v51
    v_dot2_f32_bf16 v52, v21, v213, v52
    v_dot2_f32_bf16 v53, v21, v245, v53
    v_dot2_f32_bf16 v54, v37, v213, v54
    v_dot2_f32_bf16 v55, v37, v245, v55
    v_dot2_f32_bf16 v48, v22, v150, v48
    v_dot2_f32_bf16 v49, v22, v182, v49
    v_dot2_f32_bf16 v50, v38, v150, v50
    v_dot2_f32_bf16 v51, v38, v182, v51
    v_dot2_f32_bf16 v52, v22, v214, v52
    v_dot2_f32_bf16 v53, v22, v246, v53
    v_dot2_f32_bf16 v54, v38, v214, v54
    v_dot2_f32_bf16 v55, v38, v246, v55
    v_dot2_f32_bf16 v48, v23, v151, v48
    v_dot2_f32_bf16 v49, v23, v183, v49
    v_dot2_f32_bf16 v50, v39, v151, v50
    v_dot2_f32_bf16 v51, v39, v183, v51
    v_dot2_f32_bf16 v52, v23, v215, v52
    v_dot2_f32_bf16 v53, v23, v247, v53
    v_dot2_f32_bf16 v54, v39, v215, v54
    v_dot2_f32_bf16 v55, v39, v247, v55
    v_dot2_f32_bf16 v48, v24, v152, v48
    v_dot2_f32_bf16 v49, v24, v184, v49
    v_dot2_f32_bf16 v50, v40, v152, v50
    v_dot2_f32_bf16 v51, v40, v184, v51
    v_dot2_f32_bf16 v52, v24, v216, v52
    v_dot2_f32_bf16 v53, v24, v248, v53
    v_dot2_f32_bf16 v54, v40, v216, v54
    v_dot2_f32_bf16 v55, v40, v248, v55
    v_dot2_f32_bf16 v48, v25, v153, v48
    v_dot2_f32_bf16 v49, v25, v185, v49
    v_dot2_f32_bf16 v50, v41, v153, v50
    v_dot2_f32_bf16 v51, v41, v185, v51
    v_dot2_f32_bf16 v52, v25, v217, v52
    v_dot2_f32_bf16 v53, v25, v249, v53
    v_dot2_f32_bf16 v54, v41, v217, v54
    v_dot2_f32_bf16 v55, v41, v249, v55
    v_dot2_f32_bf16 v48, v26, v154, v48
    v_dot2_f32_bf16 v49, v26, v186, v49
    v_dot2_f32_bf16 v50, v42, v154, v50
    v_dot2_f32_bf16 v51, v42, v186, v51
    v_dot2_f32_bf16 v52, v26, v218, v52
    v_dot2_f32_bf16 v53, v26, v250, v53
    v_dot2_f32_bf16 v54, v42, v218, v54
    v_dot2_f32_bf16 v55, v42, v250, v55
    v_dot2_f32_bf16 v48, v27, v155, v48
    v_dot2_f32_bf16 v49, v27, v187, v49
    v_dot2_f32_bf16 v50, v43, v155, v50
    v_dot2_f32_bf16 v51, v43, v187, v51
    v_dot2_f32_bf16 v52, v27, v219, v52
    v_dot2_f32_bf16 v53, v27, v251, v53
    v_dot2_f32_bf16 v54, v43, v219, v54
    v_dot2_f32_bf16 v55, v43, v251, v55
    v_dot2_f32_bf16 v48, v28, v156, v48
    v_dot2_f32_bf16 v49, v28, v188, v49
    v_dot2_f32_bf16 v50, v44, v156, v50
    v_dot2_f32_bf16 v51, v44, v188, v51
    v_dot2_f32_bf16 v52, v28, v220, v52
    v_dot2_f32_bf16 v53, v28, v252, v53
    v_dot2_f32_bf16 v54, v44, v220, v54
    v_dot2_f32_bf16 v55, v44, v252, v55
    v_dot2_f32_bf16 v48, v29, v157, v48
    v_dot2_f32_bf16 v49, v29, v189, v49
    v_dot2_f32_bf16 v50, v45, v157, v50
    v_dot2_f32_bf16 v51, v45, v189, v51
    v_dot2_f32_bf16 v52, v29, v221, v52
    v_dot2_f32_bf16 v53, v29, v253, v53
    v_dot2_f32_bf16 v54, v45, v221, v54
    v_dot2_f32_bf16 v55, v45, v253, v55
    v_dot2_f32_bf16 v48, v30, v158, v48
    v_dot2_f32_bf16 v49, v30, v190, v49
    v_dot2_f32_bf16 v50, v46, v158, v50
    v_dot2_f32_bf16 v51, v46, v190, v51
    v_dot2_f32_bf16 v52, v30, v222, v52
    v_dot2_f32_bf16 v53, v30, v254, v53
    v_dot2_f32_bf16 v54, v46, v222, v54
    v_dot2_f32_bf16 v55, v46, v254, v55
    v_dot2_f32_bf16 v48, v31, v159, v48
    v_dot2_f32_bf16 v49, v31, v191, v49
    v_dot2_f32_bf16 v50, v47, v159, v50
    v_dot2_f32_bf16 v51, v47, v191, v51
    v_dot2_f32_bf16 v52, v31, v223, v52
    v_dot2_f32_bf16 v53, v31, v255, v53
    v_dot2_f32_bf16 v54, v47, v223, v54
    v_dot2_f32_bf16 v55, v47, v255, v55
    s_nop 3
    v_lshlrev_b32 v7, 5, v0
    ds_write_b128 v7, v[48:51] offset:8192
    ds_write_b128 v7, v[52:55] offset:8208
    s_waitcnt lgkmcnt(0)
    s_barrier
    v_lshlrev_b32 v7, 5, v2
    v_bfe_u32 v8, v0, 5, 1
    v_lshl_add_u32 v7, v8, 3, v7
    ds_read_b64 v[16:17], v7 offset:8192
    ds_read_b64 v[18:19], v7 offset:8208
    ds_read_b64 v[20:21], v7 offset:9216
    ds_read_b64 v[22:23], v7 offset:9232
    ds_read_b64 v[24:25], v7 offset:10240
    ds_read_b64 v[26:27], v7 offset:10256
    ds_read_b64 v[28:29], v7 offset:11264
    ds_read_b64 v[30:31], v7 offset:11280
    s_waitcnt lgkmcnt(0)
    ds_read_b64 v[32:33], v7 offset:12288
    ds_read_b64 v[34:35], v7 offset:12304
    ds_read_b64 v[36:37], v7 offset:13312
    ds_read_b64 v[38:39], v7 offset:13328
    ds_read_b64 v[40:41], v7 offset:14336
    ds_read_b64 v[42:43], v7 offset:14352
    ds_read_b64 v[44:45], v7 offset:15360
    ds_read_b64 v[46:47], v7 offset:15376
    s_waitcnt lgkmcnt(0)
    v_add_f32 v16, v16, v20
    v_add_f32 v16, v16, v24
    v_add_f32 v16, v16, v28
    v_add_f32 v16, v16, v32
    v_add_f32 v16, v16, v36
    v_add_f32 v16, v16, v40
    v_add_f32 v16, v16, v44
    v_cvt_pk_bf16_f32 v5, v16, v16
    v_lshlrev_b32 v16, 16, v5
    v_add_f32 v17, v17, v21
    v_add_f32 v17, v17, v25
    v_add_f32 v17, v17, v29
    v_add_f32 v17, v17, v33
    v_add_f32 v17, v17, v37
    v_add_f32 v17, v17, v41
    v_add_f32 v17, v17, v45
    v_cvt_pk_bf16_f32 v5, v17, v17
    v_lshlrev_b32 v17, 16, v5
    v_add_f32 v18, v18, v22
    v_add_f32 v18, v18, v26
    v_add_f32 v18, v18, v30
    v_add_f32 v18, v18, v34
    v_add_f32 v18, v18, v38
    v_add_f32 v18, v18, v42
    v_add_f32 v18, v18, v46
    v_cvt_pk_bf16_f32 v5, v18, v18
    v_lshlrev_b32 v18, 16, v5
    v_add_f32 v19, v19, v23
    v_add_f32 v19, v19, v27
    v_add_f32 v19, v19, v31
    v_add_f32 v19, v19, v35
    v_add_f32 v19, v19, v39
    v_add_f32 v19, v19, v43
    v_add_f32 v19, v19, v47
    v_cvt_pk_bf16_f32 v5, v19, v19
    v_lshlrev_b32 v19, 16, v5
    v_mul_f32 v6, 0xbfb8aa3b, v16
    v_exp_f32 v6, v6
    s_nop 0
    v_add_f32 v6, 1.0, v6
    v_rcp_f32 v6, v6
    s_nop 0
    v_mul_f32 v16, v16, v6
    v_cvt_pk_bf16_f32 v5, v16, v16
    v_lshlrev_b32 v16, 16, v5
    v_mul_f32 v16, v16, v18
    v_mul_f32 v6, 0xbfb8aa3b, v17
    v_exp_f32 v6, v6
    s_nop 0
    v_add_f32 v6, 1.0, v6
    v_rcp_f32 v6, v6
    s_nop 0
    v_mul_f32 v17, v17, v6
    v_cvt_pk_bf16_f32 v5, v17, v17
    v_lshlrev_b32 v17, 16, v5
    v_mul_f32 v17, v17, v19
    v_cvt_pk_bf16_f32 v16, v16, v17
    v_mul_u32_u24 v8, 3584, v8
    v_lshl_add_u32 v7, v2, 2, v8
    v_mov_b32 v6, 0x40000000
    v_cmp_lt_u32 vcc, 27, v2
    s_nop 1
    v_cndmask_b32 v7, v7, v6, vcc
    v_cmp_lt_u32 vcc, 63, v0
    s_nop 1
    v_cndmask_b32 v7, v7, v6, vcc
    s_mul_i32 s37, s24, 8192
    s_add_u32 s37, s37, 0x1b0000
    s_add_u32 s36, s37, s23
    buffer_store_dword v16, v7, s[8:11], s36 offen sc1
    v_lshlrev_b32 v7, 4, v0
    v_add_u32 v8, 4096, v7
    v_cmp_lt_u32 vcc, 191, v0
    s_nop 1
    v_cndmask_b32 v8, v8, v6, vcc
L_M_act:
    buffer_load_dwordx4 v[20:23], v7, s[8:11], s37 offen sc1
    buffer_load_dwordx4 v[24:27], v8, s[8:11], s37 offen sc1
    s_add_u32 s32, s32, 1
    s_cmp_gt_u32 s32, 200000
    s_waitcnt vmcnt(0)
    v_max3_u32 v5, v20, v21, v22
    v_max3_u32 v5, v5, v23, v24
    v_max3_u32 v5, v5, v25, v26
    v_max_u32 v5, v5, v27
    s_cbranch_scc1 L_M_act_ok
    v_cmp_eq_u32 vcc, -1, v5
    s_cbranch_vccnz L_M_act
L_M_act_ok:
    ds_write_b128 v7, v[20:23] offset:16384
    ds_write_b128 v7, v[24:27] offset:20480
    s_waitcnt lgkmcnt(0)
    s_barrier
    v_lshrrev_b32 v7, 3, v0
    v_mul_u32_u24 v7, 112, v7
    v_mov_b64 v[48:49], 0
    v_mov_b64 v[50:51], 0
    ds_read_b128 v[16:19], v7 offset:16384
    ds_read_b128 v[20:23], v7 offset:16400
    ds_read_b128 v[24:27], v7 offset:16416
    ds_read_b128 v[28:31], v7 offset:16432
    ds_read_b128 v[32:35], v7 offset:16448
    ds_read_b128 v[36:39], v7 offset:16464
    ds_read_b128 v[40:43], v7 offset:16480
    s_waitcnt lgkmcnt(0)
    v_dot2_f32_bf16 v48, v16, v64, v48
    v_dot2_f32_bf16 v49, v16, v92, v49
    v_dot2_f32_bf16 v48, v17, v65, v48
    v_dot2_f32_bf16 v49, v17, v93, v49
    v_dot2_f32_bf16 v48, v18, v66, v48
    v_dot2_f32_bf16 v49, v18, v94, v49
    v_dot2_f32_bf16 v48, v19, v67, v48
    v_dot2_f32_bf16 v49, v19, v95, v49
    v_dot2_f32_bf16 v48, v20, v68, v48
    v_dot2_f32_bf16 v49, v20, v96, v49
    v_dot2_f32_bf16 v48, v21, v69, v48
    v_dot2_f32_bf16 v49, v21, v97, v49
    v_dot2_f32_bf16 v48, v22, v70, v48
    v_dot2_f32_bf16 v49, v22, v98, v49
    v_dot2_f32_bf16 v48, v23, v71, v48
    v_dot2_f32_bf16 v49, v23, v99, v49
    v_dot2_f32_bf16 v48, v24, v72, v48
    v_dot2_f32_bf16 v49, v24, v100, v49
    v_dot2_f32_bf16 v48, v25, v73, v48
    v_dot2_f32_bf16 v49, v25, v101, v49
    v_dot2_f32_bf16 v48, v26, v74, v48
    v_dot2_f32_bf16 v49, v26, v102, v49
    v_dot2_f32_bf16 v48, v27, v75, v48
    v_dot2_f32_bf16 v49, v27, v103, v49
    v_dot2_f32_bf16 v48, v28, v76, v48
    v_dot2_f32_bf16 v49, v28, v104, v49
    v_dot2_f32_bf16 v48, v29, v77, v48
    v_dot2_f32_bf16 v49, v29, v105, v49
    v_dot2_f32_bf16 v48, v30, v78, v48
    v_dot2_f32_bf16 v49, v30, v106, v49
    v_dot2_f32_bf16 v48, v31, v79, v48
    v_dot2_f32_bf16 v49, v31, v107, v49
    v_dot2_f32_bf16 v48, v32, v80, v48
    v_dot2_f32_bf16 v49, v32, v108, v49
    v_dot2_f32_bf16 v48, v33, v81, v48
    v_dot2_f32_bf16 v49, v33, v109, v49
    v_dot2_f32_bf16 v48, v34, v82, v48
    v_dot2_f32_bf16 v49, v34, v110, v49
    v_dot2_f32_bf16 v48, v35, v83, v48
    v_dot2_f32_bf16 v49, v35, v111, v49
    v_dot2_f32_bf16 v48, v36, v84, v48
    v_dot2_f32_bf16 v49, v36, v112, v49
    v_dot2_f32_bf16 v48, v37, v85, v48
    v_dot2_f32_bf16 v49, v37, v113, v49
    v_dot2_f32_bf16 v48, v38, v86, v48
    v_dot2_f32_bf16 v49, v38, v114, v49
    v_dot2_f32_bf16 v48, v39, v87, v48
    v_dot2_f32_bf16 v49, v39, v115, v49
    v_dot2_f32_bf16 v48, v40, v88, v48
    v_dot2_f32_bf16 v49, v40, v116, v49
    v_dot2_f32_bf16 v48, v41, v89, v48
    v_dot2_f32_bf16 v49, v41, v117, v49
    v_dot2_f32_bf16 v48, v42, v90, v48
    v_dot2_f32_bf16 v49, v42, v118, v49
    v_dot2_f32_bf16 v48, v43, v91, v48
    v_dot2_f32_bf16 v49, v43, v119, v49
    ds_read_b128 v[16:19], v7 offset:19968
    ds_read_b128 v[20:23], v7 offset:19984
    ds_read_b128 v[24:27], v7 offset:20000
    ds_read_b128 v[28:31], v7 offset:20016
    ds_read_b128 v[32:35], v7 offset:20032
    ds_read_b128 v[36:39], v7 offset:20048
    ds_read_b128 v[40:43], v7 offset:20064
    s_waitcnt lgkmcnt(0)
    v_dot2_f32_bf16 v50, v16, v64, v50
    v_dot2_f32_bf16 v51, v16, v92, v51
    v_dot2_f32_bf16 v50, v17, v65, v50
    v_dot2_f32_bf16 v51, v17, v93, v51
    v_dot2_f32_bf16 v50, v18, v66, v50
    v_dot2_f32_bf16 v51, v18, v94, v51
    v_dot2_f32_bf16 v50, v19, v67, v50
    v_dot2_f32_bf16 v51, v19, v95, v51
    v_dot2_f32_bf16 v50, v20, v68, v50
    v_dot2_f32_bf16 v51, v20, v96, v51
    v_dot2_f32_bf16 v50, v21, v69, v50
    v_dot2_f32_bf16 v51, v21, v97, v51
    v_dot2_f32_bf16 v50, v22, v70, v50
    v_dot2_f32_bf16 v51, v22, v98, v51
    v_dot2_f32_bf16 v50, v23, v71, v50
    v_dot2_f32_bf16 v51, v23, v99, v51
    v_dot2_f32_bf16 v50, v24, v72, v50
    v_dot2_f32_bf16 v51, v24, v100, v51
    v_dot2_f32_bf16 v50, v25, v73, v50
    v_dot2_f32_bf16 v51, v25, v101, v51
    v_dot2_f32_bf16 v50, v26, v74, v50
    v_dot2_f32_bf16 v51, v26, v102, v51
    v_dot2_f32_bf16 v50, v27, v75, v50
    v_dot2_f32_bf16 v51, v27, v103, v51
    v_dot2_f32_bf16 v50, v28, v76, v50
    v_dot2_f32_bf16 v51, v28, v104, v51
    v_dot2_f32_bf16 v50, v29, v77, v50
    v_dot2_f32_bf16 v51, v29, v105, v51
    v_dot2_f32_bf16 v50, v30, v78, v50
    v_dot2_f32_bf16 v51, v30, v106, v51
    v_dot2_f32_bf16 v50, v31, v79, v50
    v_dot2_f32_bf16 v51, v31, v107, v51
    v_dot2_f32_bf16 v50, v32, v80, v50
    v_dot2_f32_bf16 v51, v32, v108, v51
    v_dot2_f32_bf16 v50, v33, v81, v50
    v_dot2_f32_bf16 v51, v33, v109, v51
    v_dot2_f32_bf16 v50, v34, v82, v50
    v_dot2_f32_bf16 v51, v34, v110, v51
    v_dot2_f32_bf16 v50, v35, v83, v50
    v_dot2_f32_bf16 v51, v35, v111, v51
    v_dot2_f32_bf16 v50, v36, v84, v50
    v_dot2_f32_bf16 v51, v36, v112, v51
    v_dot2_f32_bf16 v50, v37, v85, v50
    v_dot2_f32_bf16 v51, v37, v113, v51
    v_dot2_f32_bf16 v50, v38, v86, v50
    v_dot2_f32_bf16 v51, v38, v114, v51
    v_dot2_f32_bf16 v50, v39, v87, v50
    v_dot2_f32_bf16 v51, v39, v115, v51
    v_dot2_f32_bf16 v50, v40, v88, v50
    v_dot2_f32_bf16 v51, v40, v116, v51
    v_dot2_f32_bf16 v50, v41, v89, v50
    v_dot2_f32_bf16 v51, v41, v117, v51
    v_dot2_f32_bf16 v50, v42, v90, v50
    v_dot2_f32_bf16 v51, v42, v118, v51
    v_dot2_f32_bf16 v50, v43, v91, v50
    v_dot2_f32_bf16 v51, v43, v119, v51
    s_nop 3
    v_add_f32_dpp v48, v48, v48 row_ror:8 row_mask:0xf bank_mask:0xf
    v_add_f32_dpp v49, v49, v49 row_ror:8 row_mask:0xf bank_mask:0xf
    v_add_f32_dpp v50, v50, v50 row_ror:8 row_mask:0xf bank_mask:0xf
    v_add_f32_dpp v51, v51, v51 row_ror:8 row_mask:0xf bank_mask:0xf
    v_mov_b32 v5, v48
    s_nop 1
    v_permlane16_swap_b32 v48, v5
    v_add_f32 v48, v48, v5
    v_mov_b32 v5, v49
    s_nop 1
    v_permlane16_swap_b32 v49, v5
    v_add_f32 v49, v49, v5
    v_mov_b32 v5, v50
    s_nop 1
    v_permlane16_swap_b32 v50, v5
    v_add_f32 v50, v50, v5
    v_mov_b32 v5, v51
    s_nop 1
    v_permlane16_swap_b32 v51, v5
    v_add_f32 v51, v51, v5
    v_mov_b32 v5, v48
    s_nop 1
    v_permlane32_swap_b32 v48, v5
    v_add_f32 v48, v48, v5
    v_mov_b32 v5, v49
    s_nop 1
    v_permlane32_swap_b32 v49, v5
    v_add_f32 v49, v49, v5
    v_mov_b32 v5, v50
    s_nop 1
    v_permlane32_swap_b32 v50, v5
    v_add_f32 v50, v50, v5
    v_mov_b32 v5, v51
    s_nop 1
    v_permlane32_swap_b32 v51, v5
    v_add_f32 v51, v51, v5
    v_lshrrev_b32 v7, 6, v0
    v_lshlrev_b32 v7, 7, v7
    v_lshl_add_u32 v7, v3, 4, v7
    ds_write_b128 v7, v[48:51] offset:1024
    s_waitcnt lgkmcnt(0)
    s_barrier
    v_lshlrev_b32 v7, 4, v3
    v_lshl_add_u32 v7, v9, 3, v7
    ds_read_b64 v[16:17], v7 offset:1024
    ds_read_b64 v[18:19], v7 offset:1152
    ds_read_b64 v[20:21], v7 offset:1280
    ds_read_b64 v[22:23], v7 offset:1408
    v_mul_f32 v10, 0xbfb8aa3b, v11
    v_exp_f32 v10, v10
    s_nop 0
    v_add_f32 v10, 1.0, v10
    v_rcp_f32 v10, v10
    s_nop 0
    v_cvt_pk_bf16_f32 v5, v10, v10
    v_lshlrev_b32 v10, 16, v5
    s_waitcnt lgkmcnt(0)
    v_lshlrev_b32 v24, 16, v15
    v_and_b32 v25, 0xffff0000, v15
    v_lshlrev_b32 v26, 16, v14
    v_and_b32 v27, 0xffff0000, v14
    v_add_f32 v16, v16, v18
    v_add_f32 v20, v20, v22
    v_add_f32 v16, v16, v20
    v_cvt_pk_bf16_f32 v5, v16, v16
    v_lshlrev_b32 v16, 16, v5
    v_mul_f32 v16, v16, v10
    v_cvt_pk_bf16_f32 v5, v16, v16
    v_lshlrev_b32 v16, 16, v5
    v_add_f32 v16, v16, v24
    v_cvt_pk_bf16_f32 v5, v16, v16
    v_lshlrev_b32 v16, 16, v5
    v_add_f32 v16, v16, v26
    v_add_f32 v17, v17, v19
    v_add_f32 v21, v21, v23
    v_add_f32 v17, v17, v21
    v_cvt_pk_bf16_f32 v5, v17, v17
    v_lshlrev_b32 v17, 16, v5
    v_mul_f32 v17, v17, v10
    v_cvt_pk_bf16_f32 v5, v17, v17
    v_lshlrev_b32 v17, 16, v5
    v_add_f32 v17, v17, v25
    v_cvt_pk_bf16_f32 v5, v17, v17
    v_lshlrev_b32 v17, 16, v5
    v_add_f32 v17, v17, v27
    v_cvt_pk_bf16_f32 v13, v16, v17
L_M_next:
    s_add_u32 s24, s24, 1
    s_mov_b32 s25, 192
    s_cmp_eq_u32 s24, 1
    s_cbranch_scc1 L_M_round
    s_mov_b32 s25, 256
    s_cmp_eq_u32 s24, 2
    s_cbranch_scc1 L_M_round
    buffer_store_dword v13, v12, s[60:63], 0 offen sc1
L_end:
    s_endpgm
.section .rodata,"a"
.p2align 6
.amdhsa_kernel sequential_preLN__memory_aug_recurrent_mem_tr__moe_arch_mod__prompt_kernel
  .amdhsa_next_free_vgpr 512
  .amdhsa_next_free_sgpr 102
  .amdhsa_accum_offset 256
  .amdhsa_group_segment_fixed_size 0
  .amdhsa_kernarg_size 120
  .amdhsa_user_sgpr_count 2
  .amdhsa_user_sgpr_kernarg_segment_ptr 1
  .amdhsa_system_sgpr_workgroup_id_x 1
.end_amdhsa_kernel
```

```asm
; @launch grid=(256,1,1) block=(256,1,1) lds=163840
.amdgcn_target "amdgcn-amd-amdhsa--gfx950"
.text
.globl sequential_preLN__memory_aug_recurrent_mem_tr__moe_arch_mod__prompt_kernel
.p2align 8
.type sequential_preLN__memory_aug_recurrent_mem_tr__moe_arch_mod__prompt_kernel,@function
sequential_preLN__memory_aug_recurrent_mem_tr__moe_arch_mod__prompt_kernel:
    s_cmp_ge_u32 s2, 256
    s_cbranch_scc1 L_end
    s_load_dwordx8 s[44:51], s[0:1], 0
    s_load_dwordx4 s[52:55], s[0:1], 32
    s_load_dwordx4 s[56:59], s[0:1], 104
    s_load_dwordx2 s[80:81], s[0:1], 64
    s_load_dwordx2 s[82:83], s[0:1], 96
    s_load_dwordx4 s[84:87], s[0:1], 72
    s_load_dwordx2 s[88:89], s[0:1], 88
    v_lshrrev_b32 v1, 6, v0
    s_nop 0
    v_readfirstlane_b32 s21, v1
    s_waitcnt lgkmcnt(0)
    s_mov_b32 s8, s58
    s_and_b32 s9, s59, 0xffff
    s_mov_b32 s10, 0x10000000
    s_mov_b32 s11, 0x20000
    s_mov_b32 s16, s56
    s_and_b32 s17, s57, 0xffff
    s_mov_b32 s18, 0x100
    s_mov_b32 s19, 0x20000
    s_and_b32 s3, s2, 7
    s_cmp_lg_u32 s3, 0
    s_cbranch_scc1 L_worker
    s_lshr_b32 s20, s2, 3
    v_mov_b32 v1, 0x4444
    v_bfe_u32 v14, v0, 1, 1
    s_mov_b32 s38, 0xaaaa
    v_mad_u32_u24 v1, v14, s38, v1
    v_mov_b32 v3, 0x0
    v_bfe_u32 v14, v0, 0, 1
    s_mov_b32 s38, 0x10
    v_mad_u32_u24 v3, v14, s38, v3
    v_bfe_u32 v14, v0, 1, 1
    s_mov_b32 s38, 0x20
    v_mad_u32_u24 v3, v14, s38, v3
    v_bfe_u32 v14, v0, 2, 1
    s_mov_b32 s38, 0x40
    v_mad_u32_u24 v3, v14, s38, v3
    v_bfe_u32 v14, v0, 3, 1
    s_mov_b32 s38, 0x80
    v_mad_u32_u24 v3, v14, s38, v3
    v_bfe_u32 v14, v0, 4, 1
    s_mov_b32 s38, 0x100
    v_mad_u32_u24 v3, v14, s38, v3
    v_bfe_u32 v14, v0, 5, 1
    s_mov_b32 s38, 0x200
    v_mad_u32_u24 v3, v14, s38, v3
    v_mov_b32 v2, 0x0
    v_bfe_u32 v14, v0, 0, 1
    s_mov_b32 s38, 0x10
    v_mad_u32_u24 v2, v14, s38, v2
    v_bfe_u32 v14, v0, 1, 1
    s_mov_b32 s38, 0x20
    v_mad_u32_u24 v2, v14, s38, v2
    v_bfe_u32 v14, v0, 2, 1
    s_mov_b32 s38, 0x40
    v_mad_u32_u24 v2, v14, s38, v2
    v_bfe_u32 v14, v0, 3, 1
    s_mov_b32 s38, 0x80
    v_mad_u32_u24 v2, v14, s38, v2
    v_bfe_u32 v14, v0, 4, 1
    s_mov_b32 s38, 0x100
    v_mad_u32_u24 v2, v14, s38, v2
    v_bfe_u32 v14, v0, 5, 1
    s_mov_b32 s38, 0x200
    v_mad_u32_u24 v2, v14, s38, v2
    v_bfe_u32 v14, v0, 6, 1
    s_mov_b32 s38, 0x800
    v_mad_u32_u24 v2, v14, s38, v2
    v_bfe_u32 v14, v0, 7, 1
    s_mov_b32 s38, 0x1000
    v_mad_u32_u24 v2, v14, s38, v2
    v_mov_b32 v4, 0x8000
    v_bfe_u32 v14, v0, 0, 1
    s_mov_b32 s38, 0x10
    v_mad_u32_u24 v4, v14, s38, v4
    v_bfe_u32 v14, v0, 1, 1
    s_mov_b32 s38, 0x20
    v_mad_u32_u24 v4, v14, s38, v4
    v_bfe_u32 v14, v0, 2, 1
    s_mov_b32 s38, 0x40
    v_mad_u32_u24 v4, v14, s38, v4
    v_bfe_u32 v14, v0, 3, 1
    s_mov_b32 s38, 0x80
    v_mad_u32_u24 v4, v14, s38, v4
    v_bfe_u32 v14, v0, 4, 1
    s_mov_b32 s38, 0x100
    v_mad_u32_u24 v4, v14, s38, v4
    v_bfe_u32 v14, v0, 5, 1
    s_mov_b32 s38, 0x200
    v_mad_u32_u24 v4, v14, s38, v4
    v_bfe_u32 v14, v0, 6, 1
    s_mov_b32 s38, 0x8000
    v_mad_u32_u24 v4, v14, s38, v4
    v_bfe_u32 v14, v0, 7, 1
    s_mov_b32 s38, 0x10000
    v_mad_u32_u24 v4, v14, s38, v4
    v_mov_b32 v5, 0x4000
    v_bfe_u32 v14, v0, 0, 1
    s_mov_b32 s38, 0x4
    v_mad_u32_u24 v5, v14, s38, v5
    v_bfe_u32 v14, v0, 1, 1
    s_mov_b32 s38, 0x8
    v_mad_u32_u24 v5, v14, s38, v5
    v_bfe_u32 v14, v0, 2, 1
    s_mov_b32 s38, 0x10
    v_mad_u32_u24 v5, v14, s38, v5
    v_bfe_u32 v14, v0, 3, 1
    s_mov_b32 s38, 0x20
    v_mad_u32_u24 v5, v14, s38, v5
    v_bfe_u32 v14, v0, 4, 1
    s_mov_b32 s38, 0x240
    v_mad_u32_u24 v5, v14, s38, v5
    v_bfe_u32 v14, v0, 5, 1
    s_mov_b32 s38, 0x480
    v_mad_u32_u24 v5, v14, s38, v5
    v_bfe_u32 v14, v0, 6, 1
    s_mov_b32 s38, 0x40
    v_mad_u32_u24 v5, v14, s38, v5
    v_bfe_u32 v14, v0, 7, 1
    s_mov_b32 s38, 0x80
    v_mad_u32_u24 v5, v14, s38, v5
    v_mov_b32 v6, 0x4000
    v_bfe_u32 v14, v0, 0, 1
    s_mov_b32 s38, 0x120
    v_mad_u32_u24 v6, v14, s38, v6
    v_bfe_u32 v14, v0, 2, 1
    s_mov_b32 s38, 0x240
    v_mad_u32_u24 v6, v14, s38, v6
    v_bfe_u32 v14, v0, 3, 1
    s_mov_b32 s38, 0x480
    v_mad_u32_u24 v6, v14, s38, v6
    v_bfe_u32 v14, v0, 4, 1
    s_mov_b32 s38, 0x10
    v_mad_u32_u24 v6, v14, s38, v6
    v_bfe_u32 v14, v0, 5, 1
    s_mov_b32 s38, 0x20
    v_mad_u32_u24 v6, v14, s38, v6
    v_add_u32 v7, 2304, v5
    v_xor_b32 v8, 0x1000, v2
    v_mov_b32 v13, 0x0
    v_bfe_u32 v14, v0, 0, 1
    s_mov_b32 s38, 0x4
    v_mad_u32_u24 v13, v14, s38, v13
    v_bfe_u32 v14, v0, 1, 1
    s_mov_b32 s38, 0x8
    v_mad_u32_u24 v13, v14, s38, v13
    v_bfe_u32 v14, v0, 2, 1
    s_mov_b32 s38, 0x10
    v_mad_u32_u24 v13, v14, s38, v13
    v_bfe_u32 v14, v0, 3, 1
    s_mov_b32 s38, 0x20
    v_mad_u32_u24 v13, v14, s38, v13
    v_bfe_u32 v14, v0, 4, 1
    s_mov_b32 s38, 0x40
    v_mad_u32_u24 v13, v14, s38, v13
    v_mov_b32 v24, 0x0
    v_bfe_u32 v14, v0, 3, 1
    s_mov_b32 s38, 0x1
    v_mad_u32_u24 v24, v14, s38, v24
    v_bfe_u32 v14, v0, 4, 1
    s_mov_b32 s38, 0x2
    v_mad_u32_u24 v24, v14, s38, v24
    v_bfe_u32 v14, v0, 5, 1
    s_mov_b32 s38, 0x4
    v_mad_u32_u24 v24, v14, s38, v24
    v_bfe_u32 v14, v0, 6, 1
    s_mov_b32 s38, 0x8
    v_mad_u32_u24 v24, v14, s38, v24
    v_bfe_u32 v14, v0, 7, 1
    s_mov_b32 s38, 0x10
    v_mad_u32_u24 v24, v14, s38, v24
    v_add_u32 v24, s20, v24
    v_and_b32 v24, 31, v24
    v_lshlrev_b32 v24, 6, v24
    v_mov_b32 v9, 0x0
    v_bfe_u32 v14, v0, 0, 1
    s_mov_b32 s38, 0x8
    v_mad_u32_u24 v9, v14, s38, v9
    v_bfe_u32 v14, v0, 1, 1
    s_mov_b32 s38, 0x10
    v_mad_u32_u24 v9, v14, s38, v9
    v_bfe_u32 v14, v0, 2, 1
    s_mov_b32 s38, 0x20
    v_mad_u32_u24 v9, v14, s38, v9
    v_bfe_u32 v14, v0, 3, 1
    s_mov_b32 s38, 0x2000
    v_mad_u32_u24 v9, v14, s38, v9
    v_bfe_u32 v14, v0, 4, 1
    s_mov_b32 s38, 0x4000
    v_mad_u32_u24 v9, v14, s38, v9
    v_bfe_u32 v14, v0, 5, 1
    s_mov_b32 s38, 0x8000
    v_mad_u32_u24 v9, v14, s38, v9
    v_bfe_u32 v14, v0, 6, 1
    s_mov_b32 s38, 0x10000
    v_mad_u32_u24 v9, v14, s38, v9
    v_bfe_u32 v14, v0, 7, 1
    s_mov_b32 s38, 0x20000
    v_mad_u32_u24 v9, v14, s38, v9
    v_add_u32 v9, v9, v24
    v_mov_b32 v10, 0x80000
    v_bfe_u32 v14, v0, 0, 1
    s_mov_b32 s38, 0x8
    v_mad_u32_u24 v10, v14, s38, v10
    v_bfe_u32 v14, v0, 1, 1
    s_mov_b32 s38, 0x20
    v_mad_u32_u24 v10, v14, s38, v10
    v_bfe_u32 v14, v0, 4, 1
    s_mov_b32 s38, 0x10
    v_mad_u32_u24 v10, v14, s38, v10
    v_bfe_u32 v14, v0, 5, 1
    s_mov_b32 s38, 0x4
    v_mad_u32_u24 v10, v14, s38, v10
    v_bfe_u32 v14, v0, 6, 1
    s_mov_b32 s38, 0x800
    v_mad_u32_u24 v10, v14, s38, v10
    v_bfe_u32 v14, v0, 7, 1
    s_mov_b32 s38, 0x1000
    v_mad_u32_u24 v10, v14, s38, v10
    v_mov_b32 v25, s20
    v_mov_b32 v24, 0x0
    v_bfe_u32 v14, v25, 0, 1
    s_mov_b32 s38, 0x100
    v_mad_u32_u24 v24, v14, s38, v24
    v_bfe_u32 v14, v25, 1, 1
    s_mov_b32 s38, 0x40
    v_mad_u32_u24 v24, v14, s38, v24
    v_bfe_u32 v14, v25, 2, 1
    s_mov_b32 s38, 0x80
    v_mad_u32_u24 v24, v14, s38, v24
    v_bfe_u32 v14, v25, 3, 1
    s_mov_b32 s38, 0x200
    v_mad_u32_u24 v24, v14, s38, v24
    v_bfe_u32 v14, v25, 4, 1
    s_mov_b32 s38, 0x400
    v_mad_u32_u24 v24, v14, s38, v24
    v_add_u32 v10, v24, v10
    v_and_b32 v24, 12, v0
    v_cmp_ne_u32 vcc, 0, v24
    v_mov_b32 v24, 0x40000000
    s_nop 0
    v_cndmask_b32 v10, v10, v24, vcc
    s_lshl_b32 s6, s20, 13
    s_add_u32 s6, s6, 0x0
    s_mov_b32 s26, 4096
    v_and_b32 v24, 15, v0
    v_mov_b32 v16, 0
    v_mov_b32 v25, 0x3f80
    v_cmp_eq_u32 vcc, 0, v24
    s_nop 1
    v_cndmask_b32 v16, v16, v25, vcc
    v_mov_b32 v25, 0x3f800000
    v_cmp_eq_u32 vcc, 1, v24
    s_nop 1
    v_cndmask_b32 v16, v16, v25, vcc
    v_mov_b32 v17, 0
    v_mov_b32 v25, 0x3f80
    v_cmp_eq_u32 vcc, 4, v24
    s_nop 1
    v_cndmask_b32 v17, v17, v25, vcc
    v_mov_b32 v25, 0x3f800000
    v_cmp_eq_u32 vcc, 5, v24
    s_nop 1
    v_cndmask_b32 v17, v17, v25, vcc
    v_mov_b32 v18, 0
    v_mov_b32 v25, 0x3f80
    v_cmp_eq_u32 vcc, 8, v24
    s_nop 1
    v_cndmask_b32 v18, v18, v25, vcc
    v_mov_b32 v25, 0x3f800000
    v_cmp_eq_u32 vcc, 9, v24
    s_nop 1
    v_cndmask_b32 v18, v18, v25, vcc
    v_mov_b32 v19, 0
    v_mov_b32 v25, 0x3f80
    v_cmp_eq_u32 vcc, 12, v24
    s_nop 1
    v_cndmask_b32 v19, v19, v25, vcc
    v_mov_b32 v25, 0x3f800000
    v_cmp_eq_u32 vcc, 13, v24
    s_nop 1
    v_cndmask_b32 v19, v19, v25, vcc
    ds_write_b128 v3, v[16:19] offset:23040
    s_mov_b32 s34, 0x05040100
    s_mov_b32 s35, 0x07060302
    s_mov_b32 s33, 0x3e0293ee
    s_mov_b32 s40, 0x4e800000
    s_mov_b32 s32, 0
    s_mov_b32 s4, 0x3f803f80
    s_mov_b32 s5, 0x3f803f80
    s_lshl_b32 s36, s20, 14
    s_lshr_b32 s37, s21, 1
    s_lshl_b32 s37, s37, 12
    s_add_u32 s25, s36, s37
    s_lshl_b32 s37, s21, 11
    s_add_u32 s39, s36, s37
    s_add_u32 s39, s39, 8192
    v_mov_b32 v11, 0x0
    v_bfe_u32 v14, v0, 0, 1
    s_mov_b32 s38, 0x4
    v_mad_u32_u24 v11, v14, s38, v11
    v_bfe_u32 v14, v0, 1, 1
    s_mov_b32 s38, 0x8
    v_mad_u32_u24 v11, v14, s38, v11
    v_bfe_u32 v14, v0, 2, 1
    s_mov_b32 s38, 0x10
    v_mad_u32_u24 v11, v14, s38, v11
    v_bfe_u32 v14, v0, 3, 1
    s_mov_b32 s38, 0x20
    v_mad_u32_u24 v11, v14, s38, v11
    v_bfe_u32 v14, v0, 4, 1
    s_mov_b32 s38, 0x800
    v_mad_u32_u24 v11, v14, s38, v11
    v_bfe_u32 v14, v0, 5, 1
    s_mov_b32 s38, 0x1000
    v_mad_u32_u24 v11, v14, s38, v11
    v_bfe_u32 v14, v0, 6, 1
    s_mov_b32 s38, 0x100
    v_mad_u32_u24 v11, v14, s38, v11
    v_bfe_u32 v14, v0, 7, 1
    s_mov_b32 s38, 0x200
    v_mad_u32_u24 v11, v14, s38, v11
    s_mov_b32 s96, s48
    s_and_b32 s97, s49, 0xffff
    s_mov_b32 s98, 0x400000
    s_mov_b32 s99, 0x20000
    s_mov_b32 s88, s50
    s_and_b32 s89, s51, 0xffff
    s_mov_b32 s90, 0x400000
    s_mov_b32 s91, 0x20000
    s_mov_b32 s60, s52
    s_and_b32 s61, s53, 0xffff
    s_mov_b32 s62, 0x400000
    s_mov_b32 s63, 0x20000
    s_mov_b32 s92, s54
    s_and_b32 s93, s55, 0xffff
    s_mov_b32 s94, 0x400000
    s_mov_b32 s95, 0x20000
    s_lshl_b32 s29, s20, 17
    v_mov_b32 v16, 0x0
    v_bfe_u32 v14, v0, 0, 1
    s_mov_b32 s38, 0x10
    v_mad_u32_u24 v16, v14, s38, v16
    v_bfe_u32 v14, v0, 1, 1
    s_mov_b32 s38, 0x20
    v_mad_u32_u24 v16, v14, s38, v16
    v_bfe_u32 v14, v0, 2, 1
    s_mov_b32 s38, 0x40
    v_mad_u32_u24 v16, v14, s38, v16
    v_bfe_u32 v14, v0, 3, 1
    s_mov_b32 s38, 0x80
    v_mad_u32_u24 v16, v14, s38, v16
    v_bfe_u32 v14, v0, 4, 1
    s_mov_b32 s38, 0x2000
    v_mad_u32_u24 v16, v14, s38, v16
    v_bfe_u32 v14, v0, 5, 1
    s_mov_b32 s38, 0x4000
    v_mad_u32_u24 v16, v14, s38, v16
    v_bfe_u32 v14, v0, 6, 1
    s_mov_b32 s38, 0x40000
    v_mad_u32_u24 v16, v14, s38, v16
    v_bfe_u32 v14, v0, 7, 1
    s_mov_b32 s38, 0x80000
    v_mad_u32_u24 v16, v14, s38, v16
    v_mov_b32 v28, 0x0
    v_bfe_u32 v14, v0, 4, 1
    s_mov_b32 s38, 0x20
    v_mad_u32_u24 v28, v14, s38, v28
    v_xor_b32 v16, v16, v28
    v_xor_b32 v17, 64, v16
    v_xor_b32 v18, 128, v16
    v_xor_b32 v19, 192, v16
    v_mov_b32 v20, 0x0
    v_bfe_u32 v14, v0, 0, 1
    s_mov_b32 s38, 0x8
    v_mad_u32_u24 v20, v14, s38, v20
    v_bfe_u32 v14, v0, 1, 1
    s_mov_b32 s38, 0x10
    v_mad_u32_u24 v20, v14, s38, v20
    v_bfe_u32 v14, v0, 2, 1
    s_mov_b32 s38, 0x100
    v_mad_u32_u24 v20, v14, s38, v20
    v_bfe_u32 v14, v0, 3, 1
    s_mov_b32 s38, 0x800
    v_mad_u32_u24 v20, v14, s38, v20
    v_bfe_u32 v14, v0, 4, 1
    s_mov_b32 s38, 0x400
    v_mad_u32_u24 v20, v14, s38, v20
    v_bfe_u32 v14, v0, 5, 1
    s_mov_b32 s38, 0x1000
    v_mad_u32_u24 v20, v14, s38, v20
    v_mov_b32 v28, 0x0
    v_bfe_u32 v14, v0, 2, 1
    s_mov_b32 s38, 0x20
    v_mad_u32_u24 v28, v14, s38, v28
    v_bfe_u32 v14, v0, 3, 1
    s_mov_b32 s38, 0x80
    v_mad_u32_u24 v28, v14, s38, v28
    v_bfe_u32 v14, v0, 4, 1
    s_mov_b32 s38, 0x40
    v_mad_u32_u24 v28, v14, s38, v28
    v_mov_b32 v29, 0x0
    v_bfe_u32 v14, v0, 6, 1
    s_mov_b32 s38, 0x40
    v_mad_u32_u24 v29, v14, s38, v29
    v_bfe_u32 v14, v0, 7, 1
    s_mov_b32 s38, 0x80
    v_mad_u32_u24 v29, v14, s38, v29
    v_xor_b32 v28, v28, v29
    v_add_u32 v28, v28, v20
    s_xor_b32 s36, s21, 0
    s_add_u32 s36, s36, 1
    s_lshl_b32 s36, s36, 15
    v_add_u32 v20, s36, v28
    v_xor_b32 v21, 32, v20
    s_xor_b32 s36, s21, 1
    s_add_u32 s36, s36, 1
    s_lshl_b32 s36, s36, 15
    v_add_u32 v22, s36, v28
    v_xor_b32 v23, 32, v22
    s_xor_b32 s36, s21, 2
    s_add_u32 s36, s36, 1
    s_lshl_b32 s36, s36, 15
    v_add_u32 v24, s36, v28
    v_xor_b32 v25, 32, v24
    s_xor_b32 s36, s21, 3
    s_add_u32 s36, s36, 1
    s_lshl_b32 s36, s36, 15
    v_add_u32 v26, s36, v28
    v_xor_b32 v27, 32, v26
    s_add_u32 s28, s21, 1
    s_lshl_b32 s28, s28, 15
    s_lshl_b32 s3, s20, 8
    s_add_u32 m0, s28, 0
    s_add_u32 s37, s3, 0x0
    buffer_load_dwordx4 v16, s[60:63], s37 offen nt lds
    s_add_u32 m0, s28, 1024
    s_add_u32 s37, s3, 0x8000
    buffer_load_dwordx4 v17, s[60:63], s37 offen nt lds
    s_add_u32 m0, s28, 2048
    s_add_u32 s37, s3, 0x10000
    buffer_load_dwordx4 v18, s[60:63], s37 offen nt lds
    s_add_u32 m0, s28, 3072
    s_add_u32 s37, s3, 0x18000
    buffer_load_dwordx4 v19, s[60:63], s37 offen nt lds
    s_add_u32 m0, s28, 4096
    s_add_u32 s37, s3, 0x20000
    buffer_load_dwordx4 v16, s[60:63], s37 offen nt lds
    s_add_u32 m0, s28, 5120
    s_add_u32 s37, s3, 0x28000
    buffer_load_dwordx4 v17, s[60:63], s37 offen nt lds
    s_add_u32 m0, s28, 6144
    s_add_u32 s37, s3, 0x30000
    buffer_load_dwordx4 v18, s[60:63], s37 offen nt lds
    s_add_u32 m0, s28, 7168
    s_add_u32 s37, s3, 0x38000
    buffer_load_dwordx4 v19, s[60:63], s37 offen nt lds
    s_mov_b32 s12, s46
    s_and_b32 s13, s47, 0xffff
    s_mov_b32 s14, 0x2000
    s_mov_b32 s15, 0x20000
    v_mov_b32 v104, 0x0
    v_bfe_u32 v14, v0, 0, 1
    s_mov_b32 s38, 0x8
    v_mad_u32_u24 v104, v14, s38, v104
    v_bfe_u32 v14, v0, 1, 1
    s_mov_b32 s38, 0x10
    v_mad_u32_u24 v104, v14, s38, v104
    v_bfe_u32 v14, v0, 2, 1
    s_mov_b32 s38, 0x10000
    v_mad_u32_u24 v104, v14, s38, v104
    v_bfe_u32 v14, v0, 3, 1
    s_mov_b32 s38, 0x10000
    v_mad_u32_u24 v104, v14, s38, v104
    v_bfe_u32 v14, v0, 4, 1
    s_mov_b32 s38, 0x400
    v_mad_u32_u24 v104, v14, s38, v104
    v_bfe_u32 v14, v0, 5, 1
    s_mov_b32 s38, 0x4
    v_mad_u32_u24 v104, v14, s38, v104
    v_bfe_u32 v14, v0, 6, 1
    s_mov_b32 s38, 0x40
    v_mad_u32_u24 v104, v14, s38, v104
    v_bfe_u32 v14, v0, 7, 1
    s_mov_b32 s38, 0x80
    v_mad_u32_u24 v104, v14, s38, v104
    v_mov_b32 v106, s20
    v_mov_b32 v105, 0x0
    v_bfe_u32 v14, v106, 0, 1
    s_mov_b32 s38, 0x20
    v_mad_u32_u24 v105, v14, s38, v105
    v_bfe_u32 v14, v106, 1, 1
    s_mov_b32 s38, 0x800
    v_mad_u32_u24 v105, v14, s38, v105
    v_bfe_u32 v14, v106, 2, 1
    s_mov_b32 s38, 0x1000
    v_mad_u32_u24 v105, v14, s38, v105
    v_bfe_u32 v14, v106, 3, 1
    s_mov_b32 s38, 0x100
    v_mad_u32_u24 v105, v14, s38, v105
    v_bfe_u32 v14, v106, 4, 1
    s_mov_b32 s38, 0x200
    v_mad_u32_u24 v105, v14, s38, v105
    v_add_u32 v104, v104, v105
    buffer_load_dword v12, v104, s[12:15], 0 offen
    v_mov_b32 v100, -1
    v_mov_b32 v101, -1
    v_mov_b32 v102, -1
    v_mov_b32 v103, -1
    buffer_store_dwordx4 v[100:103], v2, s[8:11], s6 offen sc1
    buffer_store_dwordx4 v[100:103], v2, s[8:11], s6 offen offset:1024 sc1
    s_lshl_b32 s36, s20, 14
    s_add_u32 s36, s36, 0x100000
    s_add_u32 s37, s36, 0x2000
    buffer_store_dwordx4 v[100:103], v2, s[8:11], s36 offen sc1
    buffer_store_dwordx4 v[100:103], v2, s[8:11], s36 offen offset:1024 sc1
    buffer_store_dwordx4 v[100:103], v2, s[8:11], s37 offen sc1
    buffer_store_dwordx4 v[100:103], v2, s[8:11], s37 offen offset:1024 sc1
    s_mul_i32 s36, s20, 0x104000
    s_add_u32 s36, s36, 0x1102000
    s_add_u32 s37, s36, 0x82000
    buffer_store_dwordx4 v[100:103], v2, s[8:11], s36 offen sc1
    buffer_store_dwordx4 v[100:103], v2, s[8:11], s36 offen offset:1024 sc1
    buffer_store_dwordx4 v[100:103], v2, s[8:11], s37 offen sc1
    buffer_store_dwordx4 v[100:103], v2, s[8:11], s37 offen offset:1024 sc1
    v_lshlrev_b32 v104, 2, v0
    s_lshl_b32 s36, s20, 10
    s_add_u32 s37, s36, 0x194000
    buffer_store_dword v100, v104, s[8:11], s37 offen sc1
    s_add_u32 s37, s36, 0x1b0000
    buffer_store_dword v100, v104, s[8:11], s37 offen sc1
    s_add_u32 s37, s36, 0x1b8000
    buffer_store_dword v100, v104, s[8:11], s37 offen sc1
    v_mov_b32 v105, 0x40000000
    v_cmp_lt_u32 vcc, 63, v0
    s_nop 1
    v_cndmask_b32 v104, v104, v105, vcc
    v_mov_b32 v105, 0
    s_lshl_b32 s36, s20, 8
    s_add_u32 s36, s36, 0x190000
    s_add_u32 s37, s36, 0x2000
    s_lshl_b32 s38, s20, 2
    s_add_u32 s38, s38, 0x80000
    s_lshl_b32 s7, s21, 7
    s_add_u32 s38, s38, s7
    buffer_store_dword v105, off, s[8:11], s38 sc1
    buffer_store_dword v105, v104, s[8:11], s36 offen sc1
    buffer_store_dword v105, v104, s[8:11], s37 offen sc1
    s_add_u32 m0, s28, 8192
    s_add_u32 s37, s3, 0x100000
    buffer_load_dwordx4 v16, s[60:63], s37 offen nt lds
    s_add_u32 m0, s28, 9216
    s_add_u32 s37, s3, 0x108000
    buffer_load_dwordx4 v17, s[60:63], s37 offen nt lds
    s_add_u32 m0, s28, 10240
    s_add_u32 s37, s3, 0x110000
    buffer_load_dwordx4 v18, s[60:63], s37 offen nt lds
    s_add_u32 m0, s28, 11264
    s_add_u32 s37, s3, 0x118000
    buffer_load_dwordx4 v19, s[60:63], s37 offen nt lds
    s_add_u32 m0, s28, 12288
    s_add_u32 s37, s3, 0x120000
    buffer_load_dwordx4 v16, s[60:63], s37 offen nt lds
    s_add_u32 m0, s28, 13312
    s_add_u32 s37, s3, 0x128000
    buffer_load_dwordx4 v17, s[60:63], s37 offen nt lds
    s_add_u32 m0, s28, 14336
    s_add_u32 s37, s3, 0x130000
    buffer_load_dwordx4 v18, s[60:63], s37 offen nt lds
    s_add_u32 m0, s28, 15360
    s_add_u32 s37, s3, 0x138000
    buffer_load_dwordx4 v19, s[60:63], s37 offen nt lds
    s_add_u32 m0, s28, 16384
    s_add_u32 s37, s3, 0x200000
    buffer_load_dwordx4 v16, s[60:63], s37 offen nt lds
    s_add_u32 m0, s28, 17408
    s_add_u32 s37, s3, 0x208000
    buffer_load_dwordx4 v17, s[60:63], s37 offen nt lds
    s_add_u32 m0, s28, 18432
    s_add_u32 s37, s3, 0x210000
    buffer_load_dwordx4 v18, s[60:63], s37 offen nt lds
    s_add_u32 m0, s28, 19456
    s_add_u32 s37, s3, 0x218000
    buffer_load_dwordx4 v19, s[60:63], s37 offen nt lds
    s_add_u32 m0, s28, 20480
    s_add_u32 s37, s3, 0x220000
    buffer_load_dwordx4 v16, s[60:63], s37 offen nt lds
    s_add_u32 m0, s28, 21504
    s_add_u32 s37, s3, 0x228000
    buffer_load_dwordx4 v17, s[60:63], s37 offen nt lds
    s_add_u32 m0, s28, 22528
    s_add_u32 s37, s3, 0x230000
    buffer_load_dwordx4 v18, s[60:63], s37 offen nt lds
    s_add_u32 m0, s28, 23552
    s_add_u32 s37, s3, 0x238000
    buffer_load_dwordx4 v19, s[60:63], s37 offen nt lds
    s_xor_b32 s36, s21, 3
    s_lshl_b32 s36, s36, 15
    s_add_u32 s36, s36, s29
    s_add_u32 s37, s36, 0x80
    buffer_load_dword v32, v11, s[92:95], s37 offen
    s_add_u32 s37, s36, 0x4080
    buffer_load_dword v33, v11, s[92:95], s37 offen
    s_add_u32 s37, s36, 0x480
    buffer_load_dword v34, v11, s[92:95], s37 offen
    s_add_u32 s37, s36, 0x4480
    buffer_load_dword v35, v11, s[92:95], s37 offen
    s_add_u32 s37, s36, 0x2080
    buffer_load_dword v36, v11, s[92:95], s37 offen
    s_add_u32 s37, s36, 0x6080
    buffer_load_dword v37, v11, s[92:95], s37 offen
    s_add_u32 s37, s36, 0x2480
    buffer_load_dword v38, v11, s[92:95], s37 offen
    s_add_u32 s37, s36, 0x6480
    buffer_load_dword v39, v11, s[92:95], s37 offen
    s_add_u32 s37, s36, 0xc0
    buffer_load_dword v40, v11, s[92:95], s37 offen
    s_add_u32 s37, s36, 0x40c0
    buffer_load_dword v41, v11, s[92:95], s37 offen
    s_add_u32 s37, s36, 0x4c0
    buffer_load_dword v42, v11, s[92:95], s37 offen
    s_add_u32 s37, s36, 0x44c0
    buffer_load_dword v43, v11, s[92:95], s37 offen
    s_add_u32 s37, s36, 0x20c0
    buffer_load_dword v44, v11, s[92:95], s37 offen
    s_add_u32 s37, s36, 0x60c0
    buffer_load_dword v45, v11, s[92:95], s37 offen
    s_add_u32 s37, s36, 0x24c0
    buffer_load_dword v46, v11, s[92:95], s37 offen
    s_add_u32 s37, s36, 0x64c0
    buffer_load_dword v47, v11, s[92:95], s37 offen
    s_waitcnt vmcnt(49)
    s_barrier
    ds_read_b64_tr_b16 a[160:161], v20 offset:0
    ds_read_b64_tr_b16 a[162:163], v20 offset:512
    ds_read_b64_tr_b16 a[168:169], v21 offset:0
    ds_read_b64_tr_b16 a[170:171], v21 offset:512
    ds_read_b64_tr_b16 a[192:193], v22 offset:0
    ds_read_b64_tr_b16 a[194:195], v22 offset:512
    ds_read_b64_tr_b16 a[200:201], v23 offset:0
    ds_read_b64_tr_b16 a[202:203], v23 offset:512
    ds_read_b64_tr_b16 a[224:225], v24 offset:0
    ds_read_b64_tr_b16 a[226:227], v24 offset:512
    ds_read_b64_tr_b16 a[232:233], v25 offset:0
    ds_read_b64_tr_b16 a[234:235], v25 offset:512
    s_waitcnt lgkmcnt(4)
    ds_read_b64_tr_b16 v[128:129], v26 offset:0
    ds_read_b64_tr_b16 v[130:131], v26 offset:512
    ds_read_b64_tr_b16 v[136:137], v27 offset:0
    ds_read_b64_tr_b16 v[138:139], v27 offset:512
    s_waitcnt lgkmcnt(0)
    s_barrier
    s_add_u32 m0, s28, 0
    s_add_u32 s37, s3, 0x300000
    buffer_load_dwordx4 v16, s[60:63], s37 offen nt lds
    s_add_u32 m0, s28, 1024
    s_add_u32 s37, s3, 0x308000
    buffer_load_dwordx4 v17, s[60:63], s37 offen nt lds
    s_add_u32 m0, s28, 2048
    s_add_u32 s37, s3, 0x310000
    buffer_load_dwordx4 v18, s[60:63], s37 offen nt lds
    s_add_u32 m0, s28, 3072
    s_add_u32 s37, s3, 0x318000
    buffer_load_dwordx4 v19, s[60:63], s37 offen nt lds
    s_add_u32 m0, s28, 4096
    s_add_u32 s37, s3, 0x320000
    buffer_load_dwordx4 v16, s[60:63], s37 offen nt lds
    s_add_u32 m0, s28, 5120
    s_add_u32 s37, s3, 0x328000
    buffer_load_dwordx4 v17, s[60:63], s37 offen nt lds
    s_add_u32 m0, s28, 6144
    s_add_u32 s37, s3, 0x330000
    buffer_load_dwordx4 v18, s[60:63], s37 offen nt lds
    s_add_u32 m0, s28, 7168
    s_add_u32 s37, s3, 0x338000
    buffer_load_dwordx4 v19, s[60:63], s37 offen nt lds
    s_waitcnt vmcnt(40)
    s_mov_b32 s36, 0x1000000
    buffer_store_dword v12, v10, s[8:11], s36 offen sc1
    s_xor_b32 s36, s21, 2
    s_lshl_b32 s36, s36, 15
    s_add_u32 s36, s36, s29
    s_add_u32 s37, s36, 0x80
    buffer_load_dword v48, v11, s[92:95], s37 offen
    s_add_u32 s37, s36, 0x4080
    buffer_load_dword v49, v11, s[92:95], s37 offen
    s_add_u32 s37, s36, 0x480
    buffer_load_dword v50, v11, s[92:95], s37 offen
    s_add_u32 s37, s36, 0x4480
    buffer_load_dword v51, v11, s[92:95], s37 offen
    s_add_u32 s37, s36, 0x2080
    buffer_load_dword v52, v11, s[92:95], s37 offen
    s_add_u32 s37, s36, 0x6080
    buffer_load_dword v53, v11, s[92:95], s37 offen
    s_add_u32 s37, s36, 0x2480
    buffer_load_dword v54, v11, s[92:95], s37 offen
    s_add_u32 s37, s36, 0x6480
    buffer_load_dword v55, v11, s[92:95], s37 offen
    s_add_u32 s37, s36, 0xc0
    buffer_load_dword v56, v11, s[92:95], s37 offen
    s_add_u32 s37, s36, 0x40c0
    buffer_load_dword v57, v11, s[92:95], s37 offen
    s_add_u32 s37, s36, 0x4c0
    buffer_load_dword v58, v11, s[92:95], s37 offen
    s_add_u32 s37, s36, 0x44c0
    buffer_load_dword v59, v11, s[92:95], s37 offen
    s_add_u32 s37, s36, 0x20c0
    buffer_load_dword v60, v11, s[92:95], s37 offen
    s_add_u32 s37, s36, 0x60c0
    buffer_load_dword v61, v11, s[92:95], s37 offen
    s_add_u32 s37, s36, 0x24c0
    buffer_load_dword v62, v11, s[92:95], s37 offen
    s_add_u32 s37, s36, 0x64c0
    buffer_load_dword v63, v11, s[92:95], s37 offen
    s_waitcnt vmcnt(49)
    s_barrier
    ds_read_b64_tr_b16 a[164:165], v20 offset:8192
    ds_read_b64_tr_b16 a[166:167], v20 offset:8704
    ds_read_b64_tr_b16 a[172:173], v21 offset:8192
    ds_read_b64_tr_b16 a[174:175], v21 offset:8704
    ds_read_b64_tr_b16 a[196:197], v22 offset:8192
    ds_read_b64_tr_b16 a[198:199], v22 offset:8704
    ds_read_b64_tr_b16 a[204:205], v23 offset:8192
    ds_read_b64_tr_b16 a[206:207], v23 offset:8704
    ds_read_b64_tr_b16 a[228:229], v24 offset:8192
    ds_read_b64_tr_b16 a[230:231], v24 offset:8704
    ds_read_b64_tr_b16 a[236:237], v25 offset:8192
    ds_read_b64_tr_b16 a[238:239], v25 offset:8704
    s_waitcnt lgkmcnt(4)
    ds_read_b64_tr_b16 v[132:133], v26 offset:8192
    ds_read_b64_tr_b16 v[134:135], v26 offset:8704
    ds_read_b64_tr_b16 v[140:141], v27 offset:8192
    ds_read_b64_tr_b16 v[142:143], v27 offset:8704
    s_waitcnt lgkmcnt(0)
    s_barrier
    s_add_u32 m0, s28, 8192
    s_add_u32 s37, s3, 0x0
    buffer_load_dwordx4 v16, s[88:91], s37 offen nt lds
    s_add_u32 m0, s28, 9216
    s_add_u32 s37, s3, 0x8000
    buffer_load_dwordx4 v17, s[88:91], s37 offen nt lds
    s_add_u32 m0, s28, 10240
    s_add_u32 s37, s3, 0x10000
    buffer_load_dwordx4 v18, s[88:91], s37 offen nt lds
    s_add_u32 m0, s28, 11264
    s_add_u32 s37, s3, 0x18000
    buffer_load_dwordx4 v19, s[88:91], s37 offen nt lds
    s_add_u32 m0, s28, 12288
    s_add_u32 s37, s3, 0x20000
    buffer_load_dwordx4 v16, s[88:91], s37 offen nt lds
    s_add_u32 m0, s28, 13312
    s_add_u32 s37, s3, 0x28000
    buffer_load_dwordx4 v17, s[88:91], s37 offen nt lds
    s_add_u32 m0, s28, 14336
    s_add_u32 s37, s3, 0x30000
    buffer_load_dwordx4 v18, s[88:91], s37 offen nt lds
    s_add_u32 m0, s28, 15360
    s_add_u32 s37, s3, 0x38000
    buffer_load_dwordx4 v19, s[88:91], s37 offen nt lds
    s_waitcnt vmcnt(33)
    v_perm_b32 v120, v33, v32, s34
    v_perm_b32 v121, v33, v32, s35
    v_perm_b32 v122, v35, v34, s34
    v_perm_b32 v123, v35, v34, s35
    v_perm_b32 v124, v37, v36, s34
    v_perm_b32 v125, v37, v36, s35
    v_perm_b32 v126, v39, v38, s34
    v_perm_b32 v127, v39, v38, s35
    ds_write_b128 v4, v[120:123] offset:24576
    ds_write_b128 v4, v[124:127] offset:25600
    s_waitcnt lgkmcnt(0)
    v_perm_b32 v120, v41, v40, s34
    v_perm_b32 v121, v41, v40, s35
    v_perm_b32 v122, v43, v42, s34
    v_perm_b32 v123, v43, v42, s35
    v_perm_b32 v124, v45, v44, s34
    v_perm_b32 v125, v45, v44, s35
    v_perm_b32 v126, v47, v46, s34
    v_perm_b32 v127, v47, v46, s35
    ds_write_b128 v4, v[120:123] offset:30720
    ds_write_b128 v4, v[124:127] offset:31744
    s_waitcnt lgkmcnt(0)
    s_xor_b32 s36, s21, 1
    s_lshl_b32 s36, s36, 15
    s_add_u32 s36, s36, s29
    s_add_u32 s37, s36, 0x80
    buffer_load_dword v80, v11, s[92:95], s37 offen
    s_add_u32 s37, s36, 0x4080
    buffer_load_dword v81, v11, s[92:95], s37 offen
    s_add_u32 s37, s36, 0x480
    buffer_load_dword v82, v11, s[92:95], s37 offen
    s_add_u32 s37, s36, 0x4480
    buffer_load_dword v83, v11, s[92:95], s37 offen
    s_add_u32 s37, s36, 0x2080
    buffer_load_dword v84, v11, s[92:95], s37 offen
    s_add_u32 s37, s36, 0x6080
    buffer_load_dword v85, v11, s[92:95], s37 offen
    s_add_u32 s37, s36, 0x2480
    buffer_load_dword v86, v11, s[92:95], s37 offen
    s_add_u32 s37, s36, 0x6480
    buffer_load_dword v87, v11, s[92:95], s37 offen
    s_add_u32 s37, s36, 0xc0
    buffer_load_dword v88, v11, s[92:95], s37 offen
    s_add_u32 s37, s36, 0x40c0
    buffer_load_dword v89, v11, s[92:95], s37 offen
    s_add_u32 s37, s36, 0x4c0
    buffer_load_dword v90, v11, s[92:95], s37 offen
    s_add_u32 s37, s36, 0x44c0
    buffer_load_dword v91, v11, s[92:95], s37 offen
    s_add_u32 s37, s36, 0x20c0
    buffer_load_dword v92, v11, s[92:95], s37 offen
    s_add_u32 s37, s36, 0x60c0
    buffer_load_dword v93, v11, s[92:95], s37 offen
    s_add_u32 s37, s36, 0x24c0
    buffer_load_dword v94, v11, s[92:95], s37 offen
    s_add_u32 s37, s36, 0x64c0
    buffer_load_dword v95, v11, s[92:95], s37 offen
    s_barrier
    ds_read_b64_tr_b16 a[176:177], v20 offset:16384
    ds_read_b64_tr_b16 a[178:179], v20 offset:16896
    ds_read_b64_tr_b16 a[184:185], v21 offset:16384
    ds_read_b64_tr_b16 a[186:187], v21 offset:16896
    ds_read_b64_tr_b16 a[208:209], v22 offset:16384
    ds_read_b64_tr_b16 a[210:211], v22 offset:16896
    ds_read_b64_tr_b16 a[216:217], v23 offset:16384
    ds_read_b64_tr_b16 a[218:219], v23 offset:16896
    ds_read_b64_tr_b16 a[240:241], v24 offset:16384
    ds_read_b64_tr_b16 a[242:243], v24 offset:16896
    ds_read_b64_tr_b16 a[248:249], v25 offset:16384
    ds_read_b64_tr_b16 a[250:251], v25 offset:16896
    s_waitcnt lgkmcnt(4)
    ds_read_b64_tr_b16 v[144:145], v26 offset:16384
    ds_read_b64_tr_b16 v[146:147], v26 offset:16896
    ds_read_b64_tr_b16 v[152:153], v27 offset:16384
    ds_read_b64_tr_b16 v[154:155], v27 offset:16896
    s_waitcnt lgkmcnt(0)
    s_barrier
    s_add_u32 m0, s28, 16384
    s_add_u32 s37, s3, 0x100000
    buffer_load_dwordx4 v16, s[88:91], s37 offen nt lds
    s_add_u32 m0, s28, 17408
    s_add_u32 s37, s3, 0x108000
    buffer_load_dwordx4 v17, s[88:91], s37 offen nt lds
    s_add_u32 m0, s28, 18432
    s_add_u32 s37, s3, 0x110000
    buffer_load_dwordx4 v18, s[88:91], s37 offen nt lds
    s_add_u32 m0, s28, 19456
    s_add_u32 s37, s3, 0x118000
    buffer_load_dwordx4 v19, s[88:91], s37 offen nt lds
    s_add_u32 m0, s28, 20480
    s_add_u32 s37, s3, 0x120000
    buffer_load_dwordx4 v16, s[88:91], s37 offen nt lds
    s_add_u32 m0, s28, 21504
    s_add_u32 s37, s3, 0x128000
    buffer_load_dwordx4 v17, s[88:91], s37 offen nt lds
    s_add_u32 m0, s28, 22528
    s_add_u32 s37, s3, 0x130000
    buffer_load_dwordx4 v18, s[88:91], s37 offen nt lds
    s_add_u32 m0, s28, 23552
    s_add_u32 s37, s3, 0x138000
    buffer_load_dwordx4 v19, s[88:91], s37 offen nt lds
    s_waitcnt vmcnt(48)
    s_barrier
    s_getreg_b32 s36, hwreg(HW_REG_XCC_ID)
    s_and_b32 s36, s36, 15
    s_or_b32 s36, s36, 0x100
    v_mov_b32 v30, s36
    s_lshl_b32 s37, s20, 2
    v_lshlrev_b32 v31, 20, v0
    buffer_store_dword v30, v31, s[16:19], s37 offen offset:128 sc1
    s_waitcnt vmcnt(33)
    v_perm_b32 v232, v49, v48, s34
    v_perm_b32 v233, v49, v48, s35
    v_perm_b32 v234, v51, v50, s34
    v_perm_b32 v235, v51, v50, s35
    v_perm_b32 v236, v53, v52, s34
    v_perm_b32 v237, v53, v52, s35
    v_perm_b32 v238, v55, v54, s34
    v_perm_b32 v239, v55, v54, s35
    v_perm_b32 v120, v57, v56, s34
    v_perm_b32 v121, v57, v56, s35
    v_perm_b32 v122, v59, v58, s34
    v_perm_b32 v123, v59, v58, s35
    v_perm_b32 v124, v61, v60, s34
    v_perm_b32 v125, v61, v60, s35
    v_perm_b32 v126, v63, v62, s34
    v_perm_b32 v127, v63, v62, s35
    ds_write_b128 v4, v[120:123] offset:28672
    ds_write_b128 v4, v[124:127] offset:29696
    s_waitcnt lgkmcnt(0)
    s_xor_b32 s36, s21, 3
    s_lshl_b32 s36, s36, 15
    s_add_u32 s36, s36, s29
    s_add_u32 s37, s36, 0x0
    buffer_load_dword v32, v11, s[92:95], s37 offen
    s_add_u32 s37, s36, 0x4000
    buffer_load_dword v33, v11, s[92:95], s37 offen
    s_add_u32 s37, s36, 0x400
    buffer_load_dword v34, v11, s[92:95], s37 offen
    s_add_u32 s37, s36, 0x4400
    buffer_load_dword v35, v11, s[92:95], s37 offen
    s_add_u32 s37, s36, 0x2000
    buffer_load_dword v36, v11, s[92:95], s37 offen
    s_add_u32 s37, s36, 0x6000
    buffer_load_dword v37, v11, s[92:95], s37 offen
    s_add_u32 s37, s36, 0x2400
    buffer_load_dword v38, v11, s[92:95], s37 offen
    s_add_u32 s37, s36, 0x6400
    buffer_load_dword v39, v11, s[92:95], s37 offen
    s_add_u32 s37, s36, 0x40
    buffer_load_dword v40, v11, s[92:95], s37 offen
    s_add_u32 s37, s36, 0x4040
    buffer_load_dword v41, v11, s[92:95], s37 offen
    s_add_u32 s37, s36, 0x440
    buffer_load_dword v42, v11, s[92:95], s37 offen
    s_add_u32 s37, s36, 0x4440
    buffer_load_dword v43, v11, s[92:95], s37 offen
    s_add_u32 s37, s36, 0x2040
    buffer_load_dword v44, v11, s[92:95], s37 offen
    s_add_u32 s37, s36, 0x6040
    buffer_load_dword v45, v11, s[92:95], s37 offen
    s_add_u32 s37, s36, 0x2440
    buffer_load_dword v46, v11, s[92:95], s37 offen
    s_add_u32 s37, s36, 0x6440
    buffer_load_dword v47, v11, s[92:95], s37 offen
    s_barrier
    ds_read_b64_tr_b16 a[180:181], v20 offset:0
    ds_read_b64_tr_b16 a[182:183], v20 offset:512
    ds_read_b64_tr_b16 a[188:189], v21 offset:0
    ds_read_b64_tr_b16 a[190:191], v21 offset:512
    ds_read_b64_tr_b16 a[212:213], v22 offset:0
    ds_read_b64_tr_b16 a[214:215], v22 offset:512
    ds_read_b64_tr_b16 a[220:221], v23 offset:0
    ds_read_b64_tr_b16 a[222:223], v23 offset:512
    ds_read_b64_tr_b16 a[244:245], v24 offset:0
    ds_read_b64_tr_b16 a[246:247], v24 offset:512
    ds_read_b64_tr_b16 a[252:253], v25 offset:0
    ds_read_b64_tr_b16 a[254:255], v25 offset:512
    s_waitcnt lgkmcnt(4)
    ds_read_b64_tr_b16 v[148:149], v26 offset:0
    ds_read_b64_tr_b16 v[150:151], v26 offset:512
    ds_read_b64_tr_b16 v[156:157], v27 offset:0
    ds_read_b64_tr_b16 v[158:159], v27 offset:512
    s_waitcnt lgkmcnt(0)
    s_barrier
    s_add_u32 m0, s28, 0
    s_add_u32 s37, s3, 0x200000
    buffer_load_dwordx4 v16, s[88:91], s37 offen nt lds
    s_add_u32 m0, s28, 1024
    s_add_u32 s37, s3, 0x208000
    buffer_load_dwordx4 v17, s[88:91], s37 offen nt lds
    s_add_u32 m0, s28, 2048
    s_add_u32 s37, s3, 0x210000
    buffer_load_dwordx4 v18, s[88:91], s37 offen nt lds
    s_add_u32 m0, s28, 3072
    s_add_u32 s37, s3, 0x218000
    buffer_load_dwordx4 v19, s[88:91], s37 offen nt lds
    s_add_u32 m0, s28, 4096
    s_add_u32 s37, s3, 0x220000
    buffer_load_dwordx4 v16, s[88:91], s37 offen nt lds
    s_add_u32 m0, s28, 5120
    s_add_u32 s37, s3, 0x228000
    buffer_load_dwordx4 v17, s[88:91], s37 offen nt lds
    s_add_u32 m0, s28, 6144
    s_add_u32 s37, s3, 0x230000
    buffer_load_dwordx4 v18, s[88:91], s37 offen nt lds
    s_add_u32 m0, s28, 7168
    s_add_u32 s37, s3, 0x238000
    buffer_load_dwordx4 v19, s[88:91], s37 offen nt lds
    s_waitcnt vmcnt(33)
    v_perm_b32 v208, v81, v80, s34
    v_perm_b32 v209, v81, v80, s35
    v_perm_b32 v210, v83, v82, s34
    v_perm_b32 v211, v83, v82, s35
    v_perm_b32 v212, v85, v84, s34
    v_perm_b32 v213, v85, v84, s35
    v_perm_b32 v214, v87, v86, s34
    v_perm_b32 v215, v87, v86, s35
    v_perm_b32 v120, v89, v88, s34
    v_perm_b32 v121, v89, v88, s35
    v_perm_b32 v122, v91, v90, s34
    v_perm_b32 v123, v91, v90, s35
    v_perm_b32 v124, v93, v92, s34
    v_perm_b32 v125, v93, v92, s35
    v_perm_b32 v126, v95, v94, s34
    v_perm_b32 v127, v95, v94, s35
    ds_write_b128 v4, v[120:123] offset:26624
    ds_write_b128 v4, v[124:127] offset:27648
    s_waitcnt lgkmcnt(0)
    s_xor_b32 s36, s21, 2
    s_lshl_b32 s36, s36, 15
    s_add_u32 s36, s36, s29
    s_add_u32 s37, s36, 0x0
    buffer_load_dword v48, v11, s[92:95], s37 offen
    s_add_u32 s37, s36, 0x4000
    buffer_load_dword v49, v11, s[92:95], s37 offen
    s_add_u32 s37, s36, 0x400
    buffer_load_dword v50, v11, s[92:95], s37 offen
    s_add_u32 s37, s36, 0x4400
    buffer_load_dword v51, v11, s[92:95], s37 offen
    s_add_u32 s37, s36, 0x2000
    buffer_load_dword v52, v11, s[92:95], s37 offen
    s_add_u32 s37, s36, 0x6000
    buffer_load_dword v53, v11, s[92:95], s37 offen
    s_add_u32 s37, s36, 0x2400
    buffer_load_dword v54, v11, s[92:95], s37 offen
    s_add_u32 s37, s36, 0x6400
    buffer_load_dword v55, v11, s[92:95], s37 offen
    s_add_u32 s37, s36, 0x40
    buffer_load_dword v56, v11, s[92:95], s37 offen
    s_add_u32 s37, s36, 0x4040
    buffer_load_dword v57, v11, s[92:95], s37 offen
    s_add_u32 s37, s36, 0x440
    buffer_load_dword v58, v11, s[92:95], s37 offen
    s_add_u32 s37, s36, 0x4440
    buffer_load_dword v59, v11, s[92:95], s37 offen
    s_add_u32 s37, s36, 0x2040
    buffer_load_dword v60, v11, s[92:95], s37 offen
    s_add_u32 s37, s36, 0x6040
    buffer_load_dword v61, v11, s[92:95], s37 offen
    s_add_u32 s37, s36, 0x2440
    buffer_load_dword v62, v11, s[92:95], s37 offen
    s_add_u32 s37, s36, 0x6440
    buffer_load_dword v63, v11, s[92:95], s37 offen
    s_barrier
    ds_read_b64_tr_b16 v[64:65], v20 offset:8192
    ds_read_b64_tr_b16 v[66:67], v20 offset:8704
    ds_read_b64_tr_b16 v[72:73], v21 offset:8192
    ds_read_b64_tr_b16 v[74:75], v21 offset:8704
    ds_read_b64_tr_b16 v[96:97], v22 offset:8192
    ds_read_b64_tr_b16 v[98:99], v22 offset:8704
    ds_read_b64_tr_b16 v[104:105], v23 offset:8192
    ds_read_b64_tr_b16 v[106:107], v23 offset:8704
    ds_read_b64_tr_b16 a[112:113], v24 offset:8192
    ds_read_b64_tr_b16 a[114:115], v24 offset:8704
    ds_read_b64_tr_b16 a[120:121], v25 offset:8192
    ds_read_b64_tr_b16 a[122:123], v25 offset:8704
    s_waitcnt lgkmcnt(4)
    ds_read_b64_tr_b16 a[144:145], v26 offset:8192
    ds_read_b64_tr_b16 a[146:147], v26 offset:8704
    ds_read_b64_tr_b16 a[152:153], v27 offset:8192
    ds_read_b64_tr_b16 a[154:155], v27 offset:8704
    s_waitcnt lgkmcnt(0)
    s_barrier
    s_add_u32 m0, s28, 8192
    s_add_u32 s37, s3, 0x300000
    buffer_load_dwordx4 v16, s[88:91], s37 offen nt lds
    s_add_u32 m0, s28, 9216
    s_add_u32 s37, s3, 0x308000
    buffer_load_dwordx4 v17, s[88:91], s37 offen nt lds
    s_add_u32 m0, s28, 10240
    s_add_u32 s37, s3, 0x310000
    buffer_load_dwordx4 v18, s[88:91], s37 offen nt lds
    s_add_u32 m0, s28, 11264
    s_add_u32 s37, s3, 0x318000
    buffer_load_dwordx4 v19, s[88:91], s37 offen nt lds
    s_add_u32 m0, s28, 12288
    s_add_u32 s37, s3, 0x320000
    buffer_load_dwordx4 v16, s[88:91], s37 offen nt lds
    s_add_u32 m0, s28, 13312
    s_add_u32 s37, s3, 0x328000
    buffer_load_dwordx4 v17, s[88:91], s37 offen nt lds
    s_add_u32 m0, s28, 14336
    s_add_u32 s37, s3, 0x330000
    buffer_load_dwordx4 v18, s[88:91], s37 offen nt lds
    s_add_u32 m0, s28, 15360
    s_add_u32 s37, s3, 0x338000
    buffer_load_dwordx4 v19, s[88:91], s37 offen nt lds
    s_waitcnt vmcnt(32)
    v_perm_b32 v240, v33, v32, s34
    v_perm_b32 v241, v33, v32, s35
    v_perm_b32 v242, v35, v34, s34
    v_perm_b32 v243, v35, v34, s35
    v_perm_b32 v244, v37, v36, s34
    v_perm_b32 v245, v37, v36, s35
    v_perm_b32 v246, v39, v38, s34
    v_perm_b32 v247, v39, v38, s35
    v_perm_b32 v248, v41, v40, s34
    v_perm_b32 v249, v41, v40, s35
    v_perm_b32 v250, v43, v42, s34
    v_perm_b32 v251, v43, v42, s35
    v_perm_b32 v252, v45, v44, s34
    v_perm_b32 v253, v45, v44, s35
    v_perm_b32 v254, v47, v46, s34
    v_perm_b32 v255, v47, v46, s35
    s_xor_b32 s36, s21, 1
    s_lshl_b32 s36, s36, 15
    s_add_u32 s36, s36, s29
    s_add_u32 s37, s36, 0x0
    buffer_load_dword v80, v11, s[92:95], s37 offen
    s_add_u32 s37, s36, 0x4000
    buffer_load_dword v81, v11, s[92:95], s37 offen
    s_add_u32 s37, s36, 0x400
    buffer_load_dword v82, v11, s[92:95], s37 offen
    s_add_u32 s37, s36, 0x4400
    buffer_load_dword v83, v11, s[92:95], s37 offen
    s_add_u32 s37, s36, 0x2000
    buffer_load_dword v84, v11, s[92:95], s37 offen
    s_add_u32 s37, s36, 0x6000
    buffer_load_dword v85, v11, s[92:95], s37 offen
    s_add_u32 s37, s36, 0x2400
    buffer_load_dword v86, v11, s[92:95], s37 offen
    s_add_u32 s37, s36, 0x6400
    buffer_load_dword v87, v11, s[92:95], s37 offen
    s_add_u32 s37, s36, 0x40
    buffer_load_dword v88, v11, s[92:95], s37 offen
    s_add_u32 s37, s36, 0x4040
    buffer_load_dword v89, v11, s[92:95], s37 offen
    s_add_u32 s37, s36, 0x440
    buffer_load_dword v90, v11, s[92:95], s37 offen
    s_add_u32 s37, s36, 0x4440
    buffer_load_dword v91, v11, s[92:95], s37 offen
    s_add_u32 s37, s36, 0x2040
    buffer_load_dword v92, v11, s[92:95], s37 offen
    s_add_u32 s37, s36, 0x6040
    buffer_load_dword v93, v11, s[92:95], s37 offen
    s_add_u32 s37, s36, 0x2440
    buffer_load_dword v94, v11, s[92:95], s37 offen
    s_add_u32 s37, s36, 0x6440
    buffer_load_dword v95, v11, s[92:95], s37 offen
    s_barrier
    ds_read_b64_tr_b16 v[68:69], v20 offset:16384
    ds_read_b64_tr_b16 v[70:71], v20 offset:16896
    ds_read_b64_tr_b16 v[76:77], v21 offset:16384
    ds_read_b64_tr_b16 v[78:79], v21 offset:16896
    ds_read_b64_tr_b16 v[100:101], v22 offset:16384
    ds_read_b64_tr_b16 v[102:103], v22 offset:16896
    ds_read_b64_tr_b16 v[108:109], v23 offset:16384
    ds_read_b64_tr_b16 v[110:111], v23 offset:16896
    ds_read_b64_tr_b16 a[116:117], v24 offset:16384
    ds_read_b64_tr_b16 a[118:119], v24 offset:16896
    ds_read_b64_tr_b16 a[124:125], v25 offset:16384
    ds_read_b64_tr_b16 a[126:127], v25 offset:16896
    s_waitcnt lgkmcnt(4)
    ds_read_b64_tr_b16 a[148:149], v26 offset:16384
    ds_read_b64_tr_b16 a[150:151], v26 offset:16896
    ds_read_b64_tr_b16 a[156:157], v27 offset:16384
    ds_read_b64_tr_b16 a[158:159], v27 offset:16896
    s_waitcnt lgkmcnt(0)
    s_barrier
    s_add_u32 m0, s28, 16384
    s_add_u32 s37, s3, 0x0
    buffer_load_dwordx4 v16, s[96:99], s37 offen nt lds
    s_add_u32 m0, s28, 17408
    s_add_u32 s37, s3, 0x8000
    buffer_load_dwordx4 v17, s[96:99], s37 offen nt lds
    s_add_u32 m0, s28, 18432
    s_add_u32 s37, s3, 0x10000
    buffer_load_dwordx4 v18, s[96:99], s37 offen nt lds
    s_add_u32 m0, s28, 19456
    s_add_u32 s37, s3, 0x18000
    buffer_load_dwordx4 v19, s[96:99], s37 offen nt lds
    s_add_u32 m0, s28, 20480
    s_add_u32 s37, s3, 0x20000
    buffer_load_dwordx4 v16, s[96:99], s37 offen nt lds
    s_add_u32 m0, s28, 21504
    s_add_u32 s37, s3, 0x28000
    buffer_load_dwordx4 v17, s[96:99], s37 offen nt lds
    s_add_u32 m0, s28, 22528
    s_add_u32 s37, s3, 0x30000
    buffer_load_dwordx4 v18, s[96:99], s37 offen nt lds
    s_add_u32 m0, s28, 23552
    s_add_u32 s37, s3, 0x38000
    buffer_load_dwordx4 v19, s[96:99], s37 offen nt lds
    s_waitcnt vmcnt(32)
    v_perm_b32 v216, v49, v48, s34
    v_perm_b32 v217, v49, v48, s35
    v_perm_b32 v218, v51, v50, s34
    v_perm_b32 v219, v51, v50, s35
    v_perm_b32 v220, v53, v52, s34
    v_perm_b32 v221, v53, v52, s35
    v_perm_b32 v222, v55, v54, s34
    v_perm_b32 v223, v55, v54, s35
    v_perm_b32 v224, v57, v56, s34
    v_perm_b32 v225, v57, v56, s35
    v_perm_b32 v226, v59, v58, s34
    v_perm_b32 v227, v59, v58, s35
    v_perm_b32 v228, v61, v60, s34
    v_perm_b32 v229, v61, v60, s35
    v_perm_b32 v230, v63, v62, s34
    v_perm_b32 v231, v63, v62, s35
    s_xor_b32 s36, s21, 0
    s_lshl_b32 s36, s36, 15
    s_add_u32 s36, s36, s29
    s_add_u32 s37, s36, 0x80
    buffer_load_dword v32, v11, s[92:95], s37 offen
    s_add_u32 s37, s36, 0x4080
    buffer_load_dword v33, v11, s[92:95], s37 offen
    s_add_u32 s37, s36, 0x480
    buffer_load_dword v34, v11, s[92:95], s37 offen
    s_add_u32 s37, s36, 0x4480
    buffer_load_dword v35, v11, s[92:95], s37 offen
    s_add_u32 s37, s36, 0x2080
    buffer_load_dword v36, v11, s[92:95], s37 offen
    s_add_u32 s37, s36, 0x6080
    buffer_load_dword v37, v11, s[92:95], s37 offen
    s_add_u32 s37, s36, 0x2480
    buffer_load_dword v38, v11, s[92:95], s37 offen
    s_add_u32 s37, s36, 0x6480
    buffer_load_dword v39, v11, s[92:95], s37 offen
    s_add_u32 s37, s36, 0xc0
    buffer_load_dword v40, v11, s[92:95], s37 offen
    s_add_u32 s37, s36, 0x40c0
    buffer_load_dword v41, v11, s[92:95], s37 offen
    s_add_u32 s37, s36, 0x4c0
    buffer_load_dword v42, v11, s[92:95], s37 offen
    s_add_u32 s37, s36, 0x44c0
    buffer_load_dword v43, v11, s[92:95], s37 offen
    s_add_u32 s37, s36, 0x20c0
    buffer_load_dword v44, v11, s[92:95], s37 offen
    s_add_u32 s37, s36, 0x60c0
    buffer_load_dword v45, v11, s[92:95], s37 offen
    s_add_u32 s37, s36, 0x24c0
    buffer_load_dword v46, v11, s[92:95], s37 offen
    s_add_u32 s37, s36, 0x64c0
    buffer_load_dword v47, v11, s[92:95], s37 offen
    s_barrier
    ds_read_b64_tr_b16 a[80:81], v20 offset:0
    ds_read_b64_tr_b16 a[82:83], v20 offset:512
    ds_read_b64_tr_b16 a[88:89], v21 offset:0
    ds_read_b64_tr_b16 a[90:91], v21 offset:512
    ds_read_b64_tr_b16 a[96:97], v22 offset:0
    ds_read_b64_tr_b16 a[98:99], v22 offset:512
    ds_read_b64_tr_b16 a[104:105], v23 offset:0
    ds_read_b64_tr_b16 a[106:107], v23 offset:512
    ds_read_b64_tr_b16 a[128:129], v24 offset:0
    ds_read_b64_tr_b16 a[130:131], v24 offset:512
    ds_read_b64_tr_b16 a[136:137], v25 offset:0
    ds_read_b64_tr_b16 a[138:139], v25 offset:512
    s_waitcnt lgkmcnt(4)
    ds_read_b64_tr_b16 v[112:113], v26 offset:0
    ds_read_b64_tr_b16 v[114:115], v26 offset:512
    ds_read_b64_tr_b16 v[120:121], v27 offset:0
    ds_read_b64_tr_b16 v[122:123], v27 offset:512
    s_waitcnt lgkmcnt(0)
    s_barrier
    s_add_u32 m0, s28, 0
    s_add_u32 s37, s3, 0x100000
    buffer_load_dwordx4 v16, s[96:99], s37 offen nt lds
    s_add_u32 m0, s28, 1024
    s_add_u32 s37, s3, 0x108000
    buffer_load_dwordx4 v17, s[96:99], s37 offen nt lds
    s_add_u32 m0, s28, 2048
    s_add_u32 s37, s3, 0x110000
    buffer_load_dwordx4 v18, s[96:99], s37 offen nt lds
    s_add_u32 m0, s28, 3072
    s_add_u32 s37, s3, 0x118000
    buffer_load_dwordx4 v19, s[96:99], s37 offen nt lds
    s_add_u32 m0, s28, 4096
    s_add_u32 s37, s3, 0x120000
    buffer_load_dwordx4 v16, s[96:99], s37 offen nt lds
    s_add_u32 m0, s28, 5120
    s_add_u32 s37, s3, 0x128000
    buffer_load_dwordx4 v17, s[96:99], s37 offen nt lds
    s_add_u32 m0, s28, 6144
    s_add_u32 s37, s3, 0x130000
    buffer_load_dwordx4 v18, s[96:99], s37 offen nt lds
    s_add_u32 m0, s28, 7168
    s_add_u32 s37, s3, 0x138000
    buffer_load_dwordx4 v19, s[96:99], s37 offen nt lds
    s_waitcnt vmcnt(32)
    v_perm_b32 v192, v81, v80, s34
    v_perm_b32 v193, v81, v80, s35
    v_perm_b32 v194, v83, v82, s34
    v_perm_b32 v195, v83, v82, s35
    v_perm_b32 v196, v85, v84, s34
    v_perm_b32 v197, v85, v84, s35
    v_perm_b32 v198, v87, v86, s34
    v_perm_b32 v199, v87, v86, s35
    v_perm_b32 v200, v89, v88, s34
    v_perm_b32 v201, v89, v88, s35
    v_perm_b32 v202, v91, v90, s34
    v_perm_b32 v203, v91, v90, s35
    v_perm_b32 v204, v93, v92, s34
    v_perm_b32 v205, v93, v92, s35
    v_perm_b32 v206, v95, v94, s34
    v_perm_b32 v207, v95, v94, s35
    s_xor_b32 s36, s21, 0
    s_lshl_b32 s36, s36, 15
    s_add_u32 s36, s36, s29
    s_add_u32 s37, s36, 0x0
    buffer_load_dword v48, v11, s[92:95], s37 offen
    s_add_u32 s37, s36, 0x4000
    buffer_load_dword v49, v11, s[92:95], s37 offen
    s_add_u32 s37, s36, 0x400
    buffer_load_dword v50, v11, s[92:95], s37 offen
    s_add_u32 s37, s36, 0x4400
    buffer_load_dword v51, v11, s[92:95], s37 offen
    s_add_u32 s37, s36, 0x2000
    buffer_load_dword v52, v11, s[92:95], s37 offen
    s_add_u32 s37, s36, 0x6000
    buffer_load_dword v53, v11, s[92:95], s37 offen
    s_add_u32 s37, s36, 0x2400
    buffer_load_dword v54, v11, s[92:95], s37 offen
    s_add_u32 s37, s36, 0x6400
    buffer_load_dword v55, v11, s[92:95], s37 offen
    s_add_u32 s37, s36, 0x40
    buffer_load_dword v56, v11, s[92:95], s37 offen
    s_add_u32 s37, s36, 0x4040
    buffer_load_dword v57, v11, s[92:95], s37 offen
    s_add_u32 s37, s36, 0x440
    buffer_load_dword v58, v11, s[92:95], s37 offen
    s_add_u32 s37, s36, 0x4440
    buffer_load_dword v59, v11, s[92:95], s37 offen
    s_add_u32 s37, s36, 0x2040
    buffer_load_dword v60, v11, s[92:95], s37 offen
    s_add_u32 s37, s36, 0x6040
    buffer_load_dword v61, v11, s[92:95], s37 offen
    s_add_u32 s37, s36, 0x2440
    buffer_load_dword v62, v11, s[92:95], s37 offen
    s_add_u32 s37, s36, 0x6440
    buffer_load_dword v63, v11, s[92:95], s37 offen
    s_barrier
    ds_read_b64_tr_b16 a[84:85], v20 offset:8192
    ds_read_b64_tr_b16 a[86:87], v20 offset:8704
    ds_read_b64_tr_b16 a[92:93], v21 offset:8192
    ds_read_b64_tr_b16 a[94:95], v21 offset:8704
    ds_read_b64_tr_b16 a[100:101], v22 offset:8192
    ds_read_b64_tr_b16 a[102:103], v22 offset:8704
    ds_read_b64_tr_b16 a[108:109], v23 offset:8192
    ds_read_b64_tr_b16 a[110:111], v23 offset:8704
    ds_read_b64_tr_b16 a[132:133], v24 offset:8192
    ds_read_b64_tr_b16 a[134:135], v24 offset:8704
    ds_read_b64_tr_b16 a[140:141], v25 offset:8192
    ds_read_b64_tr_b16 a[142:143], v25 offset:8704
    s_waitcnt lgkmcnt(4)
    ds_read_b64_tr_b16 v[116:117], v26 offset:8192
    ds_read_b64_tr_b16 v[118:119], v26 offset:8704
    ds_read_b64_tr_b16 v[124:125], v27 offset:8192
    ds_read_b64_tr_b16 v[126:127], v27 offset:8704
    s_waitcnt lgkmcnt(0)
    s_barrier
    s_add_u32 m0, s28, 8192
    s_add_u32 s37, s3, 0x200000
    buffer_load_dwordx4 v16, s[96:99], s37 offen nt lds
    s_add_u32 m0, s28, 9216
    s_add_u32 s37, s3, 0x208000
    buffer_load_dwordx4 v17, s[96:99], s37 offen nt lds
    s_add_u32 m0, s28, 10240
    s_add_u32 s37, s3, 0x210000
    buffer_load_dwordx4 v18, s[96:99], s37 offen nt lds
    s_add_u32 m0, s28, 11264
    s_add_u32 s37, s3, 0x218000
    buffer_load_dwordx4 v19, s[96:99], s37 offen nt lds
    s_add_u32 m0, s28, 12288
    s_add_u32 s37, s3, 0x220000
    buffer_load_dwordx4 v16, s[96:99], s37 offen nt lds
    s_add_u32 m0, s28, 13312
    s_add_u32 s37, s3, 0x228000
    buffer_load_dwordx4 v17, s[96:99], s37 offen nt lds
    s_add_u32 m0, s28, 14336
    s_add_u32 s37, s3, 0x230000
    buffer_load_dwordx4 v18, s[96:99], s37 offen nt lds
    s_add_u32 m0, s28, 15360
    s_add_u32 s37, s3, 0x238000
    buffer_load_dwordx4 v19, s[96:99], s37 offen nt lds
    s_waitcnt vmcnt(32)
    v_perm_b32 v176, v33, v32, s34
    v_perm_b32 v177, v33, v32, s35
    v_perm_b32 v178, v35, v34, s34
    v_perm_b32 v179, v35, v34, s35
    v_perm_b32 v180, v37, v36, s34
    v_perm_b32 v181, v37, v36, s35
    v_perm_b32 v182, v39, v38, s34
    v_perm_b32 v183, v39, v38, s35
    v_perm_b32 v184, v41, v40, s34
    v_perm_b32 v185, v41, v40, s35
    v_perm_b32 v186, v43, v42, s34
    v_perm_b32 v187, v43, v42, s35
    v_perm_b32 v188, v45, v44, s34
    v_perm_b32 v189, v45, v44, s35
    v_perm_b32 v190, v47, v46, s34
    v_perm_b32 v191, v47, v46, s35
    s_barrier
    ds_read_b64_tr_b16 v[32:33], v20 offset:16384
    ds_read_b64_tr_b16 v[34:35], v20 offset:16896
    ds_read_b64_tr_b16 v[40:41], v21 offset:16384
    ds_read_b64_tr_b16 v[42:43], v21 offset:16896
    ds_read_b64_tr_b16 a[0:1], v22 offset:16384
    ds_read_b64_tr_b16 a[2:3], v22 offset:16896
    ds_read_b64_tr_b16 a[8:9], v23 offset:16384
    ds_read_b64_tr_b16 a[10:11], v23 offset:16896
    ds_read_b64_tr_b16 a[32:33], v24 offset:16384
    ds_read_b64_tr_b16 a[34:35], v24 offset:16896
    ds_read_b64_tr_b16 a[40:41], v25 offset:16384
    ds_read_b64_tr_b16 a[42:43], v25 offset:16896
    s_waitcnt lgkmcnt(4)
    ds_read_b64_tr_b16 a[64:65], v26 offset:16384
    ds_read_b64_tr_b16 a[66:67], v26 offset:16896
    ds_read_b64_tr_b16 a[72:73], v27 offset:16384
    ds_read_b64_tr_b16 a[74:75], v27 offset:16896
    s_waitcnt lgkmcnt(0)
    s_barrier
    s_add_u32 m0, s28, 16384
    s_add_u32 s37, s3, 0x300000
    buffer_load_dwordx4 v16, s[96:99], s37 offen nt lds
    s_add_u32 m0, s28, 17408
    s_add_u32 s37, s3, 0x308000
    buffer_load_dwordx4 v17, s[96:99], s37 offen nt lds
    s_add_u32 m0, s28, 18432
    s_add_u32 s37, s3, 0x310000
    buffer_load_dwordx4 v18, s[96:99], s37 offen nt lds
    s_add_u32 m0, s28, 19456
    s_add_u32 s37, s3, 0x318000
    buffer_load_dwordx4 v19, s[96:99], s37 offen nt lds
    s_add_u32 m0, s28, 20480
    s_add_u32 s37, s3, 0x320000
    buffer_load_dwordx4 v16, s[96:99], s37 offen nt lds
    s_add_u32 m0, s28, 21504
    s_add_u32 s37, s3, 0x328000
    buffer_load_dwordx4 v17, s[96:99], s37 offen nt lds
    s_add_u32 m0, s28, 22528
    s_add_u32 s37, s3, 0x330000
    buffer_load_dwordx4 v18, s[96:99], s37 offen nt lds
    s_add_u32 m0, s28, 23552
    s_add_u32 s37, s3, 0x338000
    buffer_load_dwordx4 v19, s[96:99], s37 offen nt lds
    s_waitcnt vmcnt(16)
    v_perm_b32 v160, v49, v48, s34
    v_perm_b32 v161, v49, v48, s35
    v_perm_b32 v162, v51, v50, s34
    v_perm_b32 v163, v51, v50, s35
    v_perm_b32 v164, v53, v52, s34
    v_perm_b32 v165, v53, v52, s35
    v_perm_b32 v166, v55, v54, s34
    v_perm_b32 v167, v55, v54, s35
    v_perm_b32 v168, v57, v56, s34
    v_perm_b32 v169, v57, v56, s35
    v_perm_b32 v170, v59, v58, s34
    v_perm_b32 v171, v59, v58, s35
    v_perm_b32 v172, v61, v60, s34
    v_perm_b32 v173, v61, v60, s35
    v_perm_b32 v174, v63, v62, s34
    v_perm_b32 v175, v63, v62, s35
    s_barrier
    ds_read_b64_tr_b16 v[36:37], v20 offset:0
    ds_read_b64_tr_b16 v[38:39], v20 offset:512
    ds_read_b64_tr_b16 v[44:45], v21 offset:0
    ds_read_b64_tr_b16 v[46:47], v21 offset:512
    ds_read_b64_tr_b16 a[4:5], v22 offset:0
    ds_read_b64_tr_b16 a[6:7], v22 offset:512
    ds_read_b64_tr_b16 a[12:13], v23 offset:0
    ds_read_b64_tr_b16 a[14:15], v23 offset:512
    ds_read_b64_tr_b16 a[36:37], v24 offset:0
    ds_read_b64_tr_b16 a[38:39], v24 offset:512
    ds_read_b64_tr_b16 a[44:45], v25 offset:0
    ds_read_b64_tr_b16 a[46:47], v25 offset:512
    s_waitcnt lgkmcnt(4)
    ds_read_b64_tr_b16 a[68:69], v26 offset:0
    ds_read_b64_tr_b16 a[70:71], v26 offset:512
    ds_read_b64_tr_b16 a[76:77], v27 offset:0
    ds_read_b64_tr_b16 a[78:79], v27 offset:512
    s_waitcnt lgkmcnt(0)
    s_barrier
    s_waitcnt vmcnt(8)
    s_barrier
    ds_read_b64_tr_b16 v[48:49], v20 offset:8192
    ds_read_b64_tr_b16 v[50:51], v20 offset:8704
    ds_read_b64_tr_b16 v[56:57], v21 offset:8192
    ds_read_b64_tr_b16 v[58:59], v21 offset:8704
    ds_read_b64_tr_b16 a[16:17], v22 offset:8192
    ds_read_b64_tr_b16 a[18:19], v22 offset:8704
    ds_read_b64_tr_b16 a[24:25], v23 offset:8192
    ds_read_b64_tr_b16 a[26:27], v23 offset:8704
    ds_read_b64_tr_b16 a[48:49], v24 offset:8192
    ds_read_b64_tr_b16 a[50:51], v24 offset:8704
    ds_read_b64_tr_b16 a[56:57], v25 offset:8192
    ds_read_b64_tr_b16 a[58:59], v25 offset:8704
    s_waitcnt lgkmcnt(4)
    ds_read_b64_tr_b16 v[80:81], v26 offset:8192
    ds_read_b64_tr_b16 v[82:83], v26 offset:8704
    ds_read_b64_tr_b16 v[88:89], v27 offset:8192
    ds_read_b64_tr_b16 v[90:91], v27 offset:8704
    s_waitcnt lgkmcnt(0)
    s_barrier
    s_waitcnt vmcnt(0)
    s_barrier
    ds_read_b64_tr_b16 v[52:53], v20 offset:16384
    ds_read_b64_tr_b16 v[54:55], v20 offset:16896
    ds_read_b64_tr_b16 v[60:61], v21 offset:16384
    ds_read_b64_tr_b16 v[62:63], v21 offset:16896
    ds_read_b64_tr_b16 a[20:21], v22 offset:16384
    ds_read_b64_tr_b16 a[22:23], v22 offset:16896
    ds_read_b64_tr_b16 a[28:29], v23 offset:16384
    ds_read_b64_tr_b16 a[30:31], v23 offset:16896
    ds_read_b64_tr_b16 a[52:53], v24 offset:16384
    ds_read_b64_tr_b16 a[54:55], v24 offset:16896
    ds_read_b64_tr_b16 a[60:61], v25 offset:16384
    ds_read_b64_tr_b16 a[62:63], v25 offset:16896
    s_waitcnt lgkmcnt(4)
    ds_read_b64_tr_b16 v[84:85], v26 offset:16384
    ds_read_b64_tr_b16 v[86:87], v26 offset:16896
    ds_read_b64_tr_b16 v[92:93], v27 offset:16384
    ds_read_b64_tr_b16 v[94:95], v27 offset:16896
    s_waitcnt lgkmcnt(0)
    s_barrier
    ds_write_b128 v4, v[32:35] offset:0
    ds_write_b128 v4, v[36:39] offset:1024
    ds_write_b128 v4, v[40:43] offset:2048
    ds_write_b128 v4, v[44:47] offset:3072
    ds_write_b128 v4, v[48:51] offset:4096
    ds_write_b128 v4, v[52:55] offset:5120
    ds_write_b128 v4, v[56:59] offset:6144
    ds_write_b128 v4, v[60:63] offset:7168
    s_waitcnt lgkmcnt(0)
    ds_write_b128 v4, v[64:67] offset:8192
    ds_write_b128 v4, v[68:71] offset:9216
    ds_write_b128 v4, v[72:75] offset:10240
    ds_write_b128 v4, v[76:79] offset:11264
    ds_write_b128 v4, v[80:83] offset:12288
    ds_write_b128 v4, v[84:87] offset:13312
    ds_write_b128 v4, v[88:91] offset:14336
    ds_write_b128 v4, v[92:95] offset:15360
    s_waitcnt lgkmcnt(0)
    ds_write_b128 v4, v[96:99] offset:16384
    ds_write_b128 v4, v[100:103] offset:17408
    ds_write_b128 v4, v[104:107] offset:18432
    ds_write_b128 v4, v[108:111] offset:19456
    ds_write_b128 v4, v[112:115] offset:20480
    ds_write_b128 v4, v[116:119] offset:21504
    ds_write_b128 v4, v[120:123] offset:22528
    ds_write_b128 v4, v[124:127] offset:23552
    s_waitcnt lgkmcnt(0)
    s_waitcnt lgkmcnt(0)
    v_mov_b32 v24, 0x0
    v_bfe_u32 v14, v0, 0, 1
    s_mov_b32 s38, 0x80
    v_mad_u32_u24 v24, v14, s38, v24
    v_bfe_u32 v14, v0, 1, 1
    s_mov_b32 s38, 0x100
    v_mad_u32_u24 v24, v14, s38, v24
    v_bfe_u32 v14, v0, 2, 1
    s_mov_b32 s38, 0x200
    v_mad_u32_u24 v24, v14, s38, v24
    v_bfe_u32 v14, v0, 3, 1
    s_mov_b32 s38, 0x400
    v_mad_u32_u24 v24, v14, s38, v24
    v_bfe_u32 v14, v0, 4, 1
    s_mov_b32 s38, 0x800
    v_mad_u32_u24 v24, v14, s38, v24
    v_bfe_u32 v14, v0, 6, 1
    s_mov_b32 s38, 0x1000
    v_mad_u32_u24 v24, v14, s38, v24
    v_bfe_u32 v14, v0, 7, 1
    s_mov_b32 s38, 0x2000
    v_mad_u32_u24 v24, v14, s38, v24
    s_lshl_b32 s36, s20, 14
    v_add_u32 v24, s36, v24
    s_lshl_b32 s36, s20, 8
    s_lshr_b32 s37, s21, 1
    s_lshl_b32 s37, s37, 7
    s_add_u32 s36, s36, s37
    s_add_u32 s36, s36, 0x102000
    v_and_b32 v14, 63, v0
    v_mov_b32 v25, 0x40000000
    v_cmp_lt_u32 vcc, 32, v14
    s_nop 1
    v_cndmask_b32 v24, v24, v25, vcc
    v_mov_b32 v25, s36
    v_cmp_eq_u32 vcc, 32, v14
    s_nop 1
    v_cndmask_b32 v0, v24, v25, vcc
    v_lshrrev_b32 v25, 2, v3
    v_and_b32 v25, 127, v25
L_HS:
    buffer_load_dword v24, v25, s[16:19], 0 offen offset:128 sc1
    s_add_u32 s32, s32, 1
    s_cmp_gt_u32 s32, 200000
    s_cbranch_scc1 L_slow_start
    s_waitcnt vmcnt(0)
    v_cmp_eq_u32 vcc, 0, v24
    s_cbranch_vccnz L_HS
    v_readfirstlane_b32 s36, v24
    s_nop 1
    v_cmp_ne_u32 vcc, s36, v24
    s_cbranch_vccnz L_slow_start
    s_branch L_fast_start
L_fast_start:
    s_mov_b32 s22, 0
    s_mov_b32 s23, 0x1000000
    s_mov_b32 s27, 0
    s_mov_b32 s31, 0x80000
    s_mov_b32 s61, 0x40000000
    s_mov_b32 s91, 0
    ds_read_b128 v[104:107], v4 offset:0
    ds_read_b128 v[108:111], v4 offset:1024
    ds_read_b128 v[112:115], v4 offset:2048
    ds_read_b128 v[116:119], v4 offset:3072
    ds_read_b128 v[88:91], v4 offset:4096
    ds_read_b128 v[92:95], v4 offset:5120
    ds_read_b128 v[96:99], v4 offset:6144
    ds_read_b128 v[100:103], v4 offset:7168
    ds_read_b128 v[72:75], v4 offset:8192
    ds_read_b128 v[76:79], v4 offset:9216
    ds_read_b128 v[80:83], v4 offset:10240
    ds_read_b128 v[84:87], v4 offset:11264
    v_mov_b64 v[48:49], 0
    v_mov_b64 v[50:51], 0
    v_mov_b64 v[52:53], 0
    v_mov_b64 v[54:55], 0
    v_mov_b64 v[56:57], 0
    v_mov_b64 v[58:59], 0
    v_mov_b64 v[60:61], 0
    v_mov_b64 v[62:63], 0
    v_mov_b64 v[64:65], 0
    v_mov_b64 v[66:67], 0
    v_mov_b64 v[68:69], 0
    v_mov_b64 v[70:71], 0
    s_mov_b64 s[62:63], 0
    s_add_u32 s7, s23, 0x80000
    buffer_load_dwordx4 v[16:19], v2, s[8:11], s7 offen sc1
    buffer_load_dwordx4 v[20:23], v2, s[8:11], s7 offen offset:1024 sc1
L_fast_step:
    s_lshr_b64 s[36:37], s[62:63], s22
    s_andn2_b32 s36, 3, s36
    s_cbranch_scc1 L_fast_refresh
    s_add_u32 s24, s23, 0x82000
    s_add_u32 s29, s23, s25
    s_add_u32 s30, s23, s39
    s_xor_b32 s28, s27, 1
    s_add_u32 s90, s22, 1
    s_nop 15
L_fast_retrym:
    buffer_load_dwordx4 v[16:19], v2, s[8:11], s7 offen sc1
    buffer_load_dwordx4 v[20:23], v2, s[8:11], s7 offen offset:1024 sc1
    s_add_u32 s32, s32, 1
    s_cmp_gt_u32 s32, 200000
    s_cselect_b32 s94, -1, -2
    v_xor_b32 v28, 0x800, v2
    v_xor_b32 v44, 0x1800, v2
    v_mov_b64 v[48:49], 0
    v_mov_b64 v[50:51], 0
    v_mov_b64 v[52:53], 0
    v_mov_b64 v[54:55], 0
L_fast_waitm:
    s_waitcnt vmcnt(3) lgkmcnt(0)
L_fast_gotm:
    v_max3_u32 v14, v16, v17, v18
    v_max_u32 v14, v14, v19
    v_smfmac_f32_16x16x64_bf16 v[48:51], v[16:19], v[104:111], v1
    s_waitcnt vmcnt(2)
    v_max3_u32 v14, v14, v20, v21
    v_smfmac_f32_16x16x64_bf16 v[52:55], v[16:19], v[112:119], v1
    v_max3_u32 v14, v14, v22, v23
    v_cmp_lt_u32 vcc, s94, v14
    v_smfmac_f32_16x16x64_bf16 v[48:51], v[20:23], v[88:95], v1
    ds_write_b128 v2, v[16:19] offset:0
    s_cbranch_vccnz L_fast_retrym
    v_smfmac_f32_16x16x64_bf16 v[52:55], v[20:23], v[96:103], v1
    ds_write_b128 v2, v[20:23] offset:1024
    v_smfmac_f32_16x16x64_bf16 v[56:59], v[16:19], v[72:79], v1
    buffer_load_dwordx4 v[104:107], v3, s[8:11], s29 offen offset:0 sc1
    v_smfmac_f32_16x16x64_bf16 v[60:63], v[16:19], v[80:87], v1
    buffer_load_dwordx4 v[108:111], v3, s[8:11], s29 offen offset:1024 sc1
    v_smfmac_f32_16x16x64_bf16 v[56:59], v[20:23], a[80:87], v1
    buffer_load_dwordx4 v[112:115], v3, s[8:11], s29 offen offset:2048 sc1
    v_smfmac_f32_16x16x64_bf16 v[60:63], v[20:23], a[88:95], v1
    s_waitcnt lgkmcnt(0)
    s_barrier
    ds_read_b128 v[24:27], v28 offset:0
    v_smfmac_f32_16x16x64_bf16 v[64:67], v[16:19], a[160:167], v1
    ds_read_b128 v[28:31], v28 offset:1024
    v_smfmac_f32_16x16x64_bf16 v[68:71], v[16:19], a[168:175], v1
    buffer_load_dwordx4 v[116:119], v3, s[8:11], s29 offen offset:3072 sc1
    v_smfmac_f32_16x16x64_bf16 v[64:67], v[20:23], a[176:183], v1
    ds_read_b128 v[32:35], v8 offset:0
    v_smfmac_f32_16x16x64_bf16 v[68:71], v[20:23], a[184:191], v1
    ds_read_b128 v[36:39], v8 offset:1024
    s_waitcnt lgkmcnt(3)
    v_smfmac_f32_16x16x64_bf16 v[48:51], v[24:27], a[0:7], v1
    ds_read_b128 v[40:43], v44 offset:0
    v_smfmac_f32_16x16x64_bf16 v[52:55], v[24:27], a[8:15], v1
    ds_read_b128 v[44:47], v44 offset:1024
    s_waitcnt lgkmcnt(4)
    v_smfmac_f32_16x16x64_bf16 v[48:51], v[28:31], a[16:23], v1
    ds_read_b128 v[88:91], v4 offset:12288
    v_smfmac_f32_16x16x64_bf16 v[52:55], v[28:31], a[24:31], v1
    ds_read_b128 v[92:95], v4 offset:13312
    s_waitcnt lgkmcnt(4)
    v_smfmac_f32_16x16x64_bf16 v[48:51], v[32:35], a[32:39], v1
    ds_read_b128 v[96:99], v4 offset:14336
    v_smfmac_f32_16x16x64_bf16 v[52:55], v[32:35], a[40:47], v1
    ds_read_b128 v[100:103], v4 offset:15360
    s_waitcnt lgkmcnt(4)
    v_smfmac_f32_16x16x64_bf16 v[48:51], v[36:39], a[48:55], v1
    buffer_load_dwordx4 v[120:123], v3, s[8:11], s30 offen offset:0 sc1
    v_smfmac_f32_16x16x64_bf16 v[52:55], v[36:39], a[56:63], v1
    ds_read_b128 v[72:75], v4 offset:16384
    v_smfmac_f32_16x16x64_bf16 v[48:51], v[40:43], a[64:71], v1
    buffer_load_dwordx4 v[124:127], v3, s[8:11], s30 offen offset:1024 sc1
    v_smfmac_f32_16x16x64_bf16 v[52:55], v[40:43], a[72:79], v1
    ds_read_b128 v[76:79], v4 offset:17408
    s_waitcnt lgkmcnt(2)
    v_smfmac_f32_16x16x64_bf16 v[48:51], v[44:47], v[88:95], v1
    ds_read_b128 v[80:83], v4 offset:18432
    v_smfmac_f32_16x16x64_bf16 v[52:55], v[44:47], v[96:103], v1
    ds_read_b128 v[84:87], v4 offset:19456
    v_smfmac_f32_16x16x64_bf16 v[56:59], v[28:31], a[96:103], v1
    ds_read_b128 v[88:91], v4 offset:20480
    v_smfmac_f32_16x16x64_bf16 v[60:63], v[28:31], a[104:111], v1
    ds_read_b128 v[92:95], v4 offset:21504
    v_smfmac_f32_16x16x64_bf16 v[56:59], v[32:35], a[112:119], v1
    ds_read_b128 v[96:99], v4 offset:22528
    v_add_f32 v48, v48, v50
    v_add_f32 v49, v49, v51
    v_smfmac_f32_16x16x64_bf16 v[60:63], v[32:35], a[120:127], v1
    ds_read_b128 v[100:103], v4 offset:23552
    v_add_f32 v52, v52, v54
    v_add_f32 v53, v53, v55
    v_smfmac_f32_16x16x64_bf16 v[56:59], v[36:39], a[128:135], v1
    s_waitcnt lgkmcnt(4)
    v_cvt_pk_bf16_f32 v50, v48, v52
    v_cvt_pk_bf16_f32 v51, v49, v53
    v_smfmac_f32_16x16x64_bf16 v[56:59], v[24:27], v[72:79], v1
    ds_write2_b32 v5, v50, v51 offset0:0 offset1:72
    v_smfmac_f32_16x16x64_bf16 v[60:63], v[24:27], v[80:87], v1
    buffer_load_dword v15, v0, s[8:11], s24 offen sc1
    v_smfmac_f32_16x16x64_bf16 v[60:63], v[36:39], a[136:143], v1
    v_smfmac_f32_16x16x64_bf16 v[56:59], v[40:43], a[144:151], v1
    buffer_store_dword v12, v10, s[8:11], s31 offen sc1
    v_smfmac_f32_16x16x64_bf16 v[60:63], v[40:43], a[152:159], v1
    s_waitcnt lgkmcnt(0)
    s_barrier
    v_smfmac_f32_16x16x64_bf16 v[56:59], v[44:47], v[88:95], v1
    ds_read_b128 v[72:75], v6 offset:0
    v_smfmac_f32_16x16x64_bf16 v[60:63], v[44:47], v[96:103], v1
    ds_read_b128 v[76:79], v6 offset:64
    v_smfmac_f32_16x16x64_bf16 v[64:67], v[24:27], a[192:199], v1
    ds_read_b128 v[80:83], v6 offset:128
    v_smfmac_f32_16x16x64_bf16 v[68:71], v[24:27], a[200:207], v1
    ds_read_b128 v[84:87], v6 offset:192
    s_waitcnt vmcnt(2) lgkmcnt(3)
    v_mfma_f32_16x16x32_bf16 v[48:51], v[104:107], v[72:75], 0
    s_waitcnt lgkmcnt(2)
    v_add_f32 v56, v56, v58
    v_add_f32 v57, v57, v59
    v_mfma_f32_16x16x32_bf16 v[48:51], v[108:111], v[76:79], v[48:51]
    s_waitcnt lgkmcnt(1)
    v_add_f32 v60, v60, v62
    v_add_f32 v61, v61, v63
    v_mfma_f32_16x16x32_bf16 v[48:51], v[112:115], v[80:83], v[48:51]
    s_waitcnt lgkmcnt(0)
    v_cvt_pk_bf16_f32 v58, v56, v60
    v_cvt_pk_bf16_f32 v59, v57, v61
    v_mfma_f32_16x16x32_bf16 v[48:51], v[116:119], v[84:87], v[48:51]
    ds_write2_b32 v7, v58, v59 offset0:0 offset1:72
    v_smfmac_f32_16x16x64_bf16 v[64:67], v[28:31], a[208:215], v1
    v_mov_b64 v[104:105], s[4:5]
    v_smfmac_f32_16x16x64_bf16 v[68:71], v[28:31], a[216:223], v1
    s_nop 1
    v_mov_b64 v[106:107], s[4:5]
    v_smfmac_f32_16x16x64_bf16 v[64:67], v[32:35], a[224:231], v1
    v_exp_f32 v48, v48
    v_smfmac_f32_16x16x64_bf16 v[68:71], v[32:35], a[232:239], v1
    s_waitcnt lgkmcnt(0)
    s_barrier
    v_exp_f32 v49, v49
    v_smfmac_f32_16x16x64_bf16 v[64:67], v[36:39], a[240:247], v1
    ds_read_b128 v[88:91], v6 offset:2304
    v_exp_f32 v50, v50
    v_smfmac_f32_16x16x64_bf16 v[68:71], v[36:39], a[248:255], v1
    ds_read_b128 v[92:95], v6 offset:2368
    v_exp_f32 v51, v51
    v_smfmac_f32_16x16x64_bf16 v[64:67], v[40:43], v[128:135], v1
    ds_read_b128 v[96:99], v6 offset:2432
    v_cvt_pk_bf16_f32 v108, v48, v49
    v_cvt_pk_bf16_f32 v109, v50, v51
    v_smfmac_f32_16x16x64_bf16 v[68:71], v[40:43], v[136:143], v1
    ds_read_b128 v[100:103], v6 offset:2496
    ds_write_b64 v2, v[108:109] offset:8192
    s_waitcnt lgkmcnt(4)
    v_mfma_f32_16x16x32_bf16 v[52:55], v[88:91], v[72:75], 0
    s_waitcnt lgkmcnt(3)
    v_mov_b32 v113, 0
    v_mov_b32 v115, 0
    v_mfma_f32_16x16x32_bf16 v[52:55], v[92:95], v[76:79], v[52:55]
    s_waitcnt lgkmcnt(2)
    v_mov_b32 v117, 0
    v_mov_b64 v[16:17], 0
    v_mfma_f32_16x16x32_bf16 v[52:55], v[96:99], v[80:83], v[52:55]
    s_waitcnt lgkmcnt(1)
    v_mov_b64 v[18:19], 0
    v_mov_b64 v[20:21], 0
    v_mfma_f32_16x16x32_bf16 v[52:55], v[100:103], v[84:87], v[52:55]
    s_waitcnt lgkmcnt(0)
    s_barrier
    v_smfmac_f32_16x16x64_bf16 v[64:67], v[44:47], v[144:151], v1
    ds_read_b64 v[110:111], v8 offset:8192
    v_mov_b64 v[22:23], 0
    v_smfmac_f32_16x16x64_bf16 v[68:71], v[44:47], v[152:159], v1
    v_mov_b64 v[24:25], 0
    v_mov_b64 v[26:27], 0
    v_mul_f32 v52, s33, v52
    v_mul_f32 v53, s33, v53
    v_exp_f32 v52, v52
    s_waitcnt lgkmcnt(0)
    v_mfma_f32_16x16x32_bf16 v[48:51], v[104:107], v[108:111], 0
    v_exp_f32 v53, v53
    v_add_f32 v64, v64, v66
    v_mfma_f32_16x16x32_bf16 v[56:59], v[120:123], v[108:111], 0
    v_cvt_pk_bf16_f32 v112, v52, v53
    v_add_f32 v65, v65, v67
    v_mfma_f32_16x16x32_bf16 v[60:63], v[124:127], v[108:111], 0
    v_cvt_pk_bf16_f32 v114, v64, v65
    v_add_f32 v68, v68, v70
    v_mfma_f32_16x16x16_bf16 v[48:51], v[104:105], v[112:113], v[48:51]
    v_add_f32 v69, v69, v71
    v_cvt_pk_bf16_f32 v116, v68, v69
    v_mfma_f32_16x16x16_bf16 v[56:59], v[114:115], v[112:113], v[56:59]
    v_mov_b64 v[28:29], 0
    v_mov_b64 v[30:31], 0
    v_mfma_f32_16x16x16_bf16 v[60:63], v[116:117], v[112:113], v[60:63]
    v_xor_b32 v32, 0x800, v2
    v_xor_b32 v40, 0x1800, v2
    v_rcp_f32 v118, v48
    s_nop 0
    v_max_f32 v14, v118, v48
    v_cmp_nge_f32 vcc, s40, v14
    v_pk_mul_f32 v[56:57], v[56:57], v[118:119] op_sel_hi:[1,0]
    v_pk_mul_f32 v[58:59], v[58:59], v[118:119] op_sel_hi:[1,0]
    v_pk_mul_f32 v[60:61], v[60:61], v[118:119] op_sel_hi:[1,0]
    v_pk_mul_f32 v[62:63], v[62:63], v[118:119] op_sel_hi:[1,0]
    v_cvt_pk_bf16_f32 v52, v56, v60
    v_cvt_pk_bf16_f32 v53, v57, v61
    v_cvt_pk_bf16_f32 v54, v58, v62
    v_cvt_pk_bf16_f32 v55, v59, v63
L_fast_rejoin:
    ds_write_b128 v2, v[52:55] offset:9216
    s_nop 0
    v_smfmac_f32_16x16x64_bf16 v[16:19], v[52:55], v[160:167], v1
    v_smfmac_f32_16x16x64_bf16 v[20:23], v[52:55], v[168:175], v1
    v_smfmac_f32_16x16x64_bf16 v[24:27], v[52:55], v[176:183], v1
    s_waitcnt lgkmcnt(0)
    s_barrier
    ds_read_b128 v[32:35], v32 offset:9216
    ds_read_b128 v[36:39], v8 offset:9216
    v_smfmac_f32_16x16x64_bf16 v[28:31], v[52:55], v[184:191], v1
    ds_read_b128 v[40:43], v40 offset:9216
    ds_read_b128 v[88:91], v4 offset:24576
    ds_read_b128 v[92:95], v4 offset:25600
    s_waitcnt lgkmcnt(4)
    v_smfmac_f32_16x16x64_bf16 v[16:19], v[32:35], v[192:199], v1
    ds_read_b128 v[96:99], v4 offset:26624
    s_waitcnt lgkmcnt(4)
    v_smfmac_f32_16x16x64_bf16 v[16:19], v[36:39], v[216:223], v1
    ds_read_b128 v[100:103], v4 offset:27648
    s_waitcnt lgkmcnt(4)
    v_smfmac_f32_16x16x64_bf16 v[16:19], v[40:43], v[240:247], v1
    ds_read_b128 v[72:75], v4 offset:28672
    s_cmp_lg_u64 vcc, 0
    v_smfmac_f32_16x16x64_bf16 v[20:23], v[32:35], v[200:207], v1
    ds_read_b128 v[76:79], v4 offset:29696
    s_cselect_b32 s60, s28, s27
    v_smfmac_f32_16x16x64_bf16 v[20:23], v[36:39], v[224:231], v1
    ds_read_b128 v[80:83], v4 offset:30720
    s_nop 0
    v_cvt_pk_bf16_f32 v56, v16, v18
    v_smfmac_f32_16x16x64_bf16 v[20:23], v[40:43], v[248:255], v1
    ds_read_b128 v[84:87], v4 offset:31744
    v_cvt_pk_bf16_f32 v57, v17, v19
    v_and_or_b32 v56, v56, -2, s60
    v_smfmac_f32_16x16x64_bf16 v[24:27], v[32:35], v[208:215], v1
    buffer_store_dwordx2 v[56:57], v9, s[8:11], 0 offen offset:0
    v_smfmac_f32_16x16x64_bf16 v[24:27], v[36:39], v[232:239], v1
    s_waitcnt lgkmcnt(4)
    s_nop 0
    v_cvt_pk_bf16_f32 v58, v20, v22
    v_smfmac_f32_16x16x64_bf16 v[24:27], v[40:43], v[88:95], v1
    ds_read_b128 v[64:67], v3 offset:23040
    v_cvt_pk_bf16_f32 v59, v21, v23
    v_and_or_b32 v58, v58, -2, s60
    v_smfmac_f32_16x16x64_bf16 v[28:31], v[32:35], v[96:103], v1
    buffer_store_dwordx2 v[58:59], v9, s[8:11], 0 offen offset:2048
    s_waitcnt lgkmcnt(1)
    v_smfmac_f32_16x16x64_bf16 v[28:31], v[36:39], v[72:79], v1
    s_nop 1
    v_cvt_pk_bf16_f32 v60, v24, v26
    v_smfmac_f32_16x16x64_bf16 v[28:31], v[40:43], v[80:87], v1
    v_cvt_pk_bf16_f32 v61, v25, v27
    v_and_or_b32 v60, v60, -2, s60
    buffer_store_dwordx2 v[60:61], v9, s[8:11], s26 offen offset:0
    s_nop 4
    v_cvt_pk_bf16_f32 v62, v28, v30
    v_cvt_pk_bf16_f32 v63, v29, v31
    v_and_or_b32 v62, v62, -2, s60
    buffer_store_dwordx2 v[62:63], v9, s[8:11], s26 offen offset:2048
L_fast_stored:
    s_cmp_lg_u32 s60, s27
    s_cbranch_scc1 L_fast_safe
    ds_read_b128 v[104:107], v4 offset:0
    ds_read_b128 v[108:111], v4 offset:1024
    ds_read_b128 v[112:115], v4 offset:2048
    ds_read_b128 v[116:119], v4 offset:3072
    ds_read_b128 v[88:91], v4 offset:4096
    ds_read_b128 v[92:95], v4 offset:5120
    ds_read_b128 v[96:99], v4 offset:6144
    ds_read_b128 v[100:103], v4 offset:7168
    ds_read_b128 v[72:75], v4 offset:8192
    ds_read_b128 v[76:79], v4 offset:9216
    ds_read_b128 v[80:83], v4 offset:10240
    ds_read_b128 v[84:87], v4 offset:11264
    s_cmp_lt_u32 s21, 1
    s_cbranch_scc1 L_fast_pollp
    s_nop 13
    s_cmp_lt_u32 s21, 2
    s_cbranch_scc1 L_fast_pollp
    s_nop 13
    s_cmp_lt_u32 s21, 3
    s_cbranch_scc1 L_fast_pollp
    s_nop 13
L_fast_pollp:
    buffer_load_dwordx4 v[120:123], v2, s[8:11], s6 offen sc1
    buffer_load_dwordx4 v[124:127], v2, s[8:11], s6 offen offset:1024 sc1
    v_mov_b64 v[56:57], 0
    v_mov_b64 v[58:59], 0
    v_mov_b64 v[60:61], 0
    v_mov_b64 v[62:63], 0
    s_nop 15
    s_nop 15
    buffer_load_dwordx4 v[32:35], v2, s[8:11], s6 offen sc1
    buffer_load_dwordx4 v[36:39], v2, s[8:11], s6 offen offset:1024 sc1
    s_add_u32 s7, s24, 0x80000
    s_waitcnt vmcnt(3) lgkmcnt(0)
    v_mfma_f32_16x16x32_bf16 v[68:71], v[64:67], v[120:123], 0
    v_bitop3_b32 v14, v120, v122, s27 bitop3:0x7e
    s_waitcnt vmcnt(2)
    v_mfma_f32_16x16x32_bf16 v[68:71], v[64:67], v[124:127], v[68:71]
    v_bitop3_b32 v11, v124, v126, s27 bitop3:0x7e
    v_bitop3_b32 v14, v14, v11, 1 bitop3:0xa8
    v_cmp_ne_u32 vcc, 0, v14
    s_nop 2
    s_cmp_eq_u64 vcc, 0
    s_cselect_b32 s36, s24, s61
    v_add_f32_dpp v68, v68, v68 row_ror:8 row_mask:0xf bank_mask:0xf
    v_add_f32_dpp v69, v69, v69 row_ror:8 row_mask:0xf bank_mask:0xf
    s_nop 0
    v_add_f32_dpp v68, v68, v68 row_ror:4 row_mask:0xf bank_mask:0xf
    v_add_f32_dpp v69, v69, v69 row_ror:4 row_mask:0xf bank_mask:0xf
    v_cvt_pk_bf16_f32 v12, v68, v69
    buffer_store_dword v12, v10, s[8:11], s36 offen
    s_cbranch_scc1 L_fast_gotp
L_fast_retryp:
    buffer_load_dwordx4 v[120:123], v2, s[8:11], s6 offen sc1
    buffer_load_dwordx4 v[124:127], v2, s[8:11], s6 offen offset:1024 sc1
    s_waitcnt vmcnt(4) lgkmcnt(0)
    v_mfma_f32_16x16x32_bf16 v[68:71], v[64:67], v[32:35], 0
    v_bitop3_b32 v14, v32, v34, s27 bitop3:0x7e
    s_waitcnt vmcnt(3)
    v_mfma_f32_16x16x32_bf16 v[68:71], v[64:67], v[36:39], v[68:71]
    v_bitop3_b32 v11, v36, v38, s27 bitop3:0x7e
    v_bitop3_b32 v14, v14, v11, 1 bitop3:0xa8
    v_cmp_ne_u32 vcc, 0, v14
    s_nop 2
    s_cmp_eq_u64 vcc, 0
    s_cselect_b32 s36, s24, s61
    v_add_f32_dpp v68, v68, v68 row_ror:8 row_mask:0xf bank_mask:0xf
    v_add_f32_dpp v69, v69, v69 row_ror:8 row_mask:0xf bank_mask:0xf
    s_nop 0
    v_add_f32_dpp v68, v68, v68 row_ror:4 row_mask:0xf bank_mask:0xf
    v_add_f32_dpp v69, v69, v69 row_ror:4 row_mask:0xf bank_mask:0xf
    v_cvt_pk_bf16_f32 v12, v68, v69
    buffer_store_dword v12, v10, s[8:11], s36 offen
    s_cbranch_scc1 L_fast_gotp
    buffer_load_dwordx4 v[32:35], v2, s[8:11], s6 offen sc1
    buffer_load_dwordx4 v[36:39], v2, s[8:11], s6 offen offset:1024 sc1
    s_waitcnt vmcnt(4) lgkmcnt(0)
    v_mfma_f32_16x16x32_bf16 v[68:71], v[64:67], v[120:123], 0
    v_bitop3_b32 v14, v120, v122, s27 bitop3:0x7e
    s_waitcnt vmcnt(3)
    v_mfma_f32_16x16x32_bf16 v[68:71], v[64:67], v[124:127], v[68:71]
    v_bitop3_b32 v11, v124, v126, s27 bitop3:0x7e
    v_bitop3_b32 v14, v14, v11, 1 bitop3:0xa8
    v_cmp_ne_u32 vcc, 0, v14
    s_nop 2
    s_cmp_eq_u64 vcc, 0
    s_cselect_b32 s36, s24, s61
    v_add_f32_dpp v68, v68, v68 row_ror:8 row_mask:0xf bank_mask:0xf
    v_add_f32_dpp v69, v69, v69 row_ror:8 row_mask:0xf bank_mask:0xf
    s_nop 0
    v_add_f32_dpp v68, v68, v68 row_ror:4 row_mask:0xf bank_mask:0xf
    v_add_f32_dpp v69, v69, v69 row_ror:4 row_mask:0xf bank_mask:0xf
    v_cvt_pk_bf16_f32 v12, v68, v69
    buffer_store_dword v12, v10, s[8:11], s36 offen
    s_cbranch_scc1 L_fast_gotp
    s_add_u32 s32, s32, 1
    s_cmp_le_u32 s32, 200000
    s_cbranch_scc1 L_fast_retryp
    s_mov_b32 s36, s24
    buffer_store_dword v12, v10, s[8:11], s36 offen
L_fast_gotp:
    s_mov_b32 s23, s24
    s_add_u32 s31, s31, 0x2000
    s_mov_b32 s22, s90
    s_mov_b32 s27, s28
    v_mov_b64 v[64:65], 0
    v_mov_b64 v[66:67], 0
    v_mov_b64 v[68:69], 0
    v_mov_b64 v[70:71], 0
    s_nop 15
    s_nop 15
    buffer_load_dwordx4 v[16:19], v2, s[8:11], s7 offen sc1
    buffer_load_dwordx4 v[20:23], v2, s[8:11], s7 offen offset:1024 sc1
    s_cmp_lt_u32 s22, 63
    s_cbranch_scc1 L_fast_step
    buffer_store_dword v12, v10, s[8:11], s31 offen sc1
    s_branch L_fast_done
L_fast_refresh:
    v_lshrrev_b32 v14, 2, v3
    s_lshl_b32 s36, s20, 8
    s_add_u32 s36, s36, 0x190000
    buffer_load_dword v14, v14, s[8:11], s36 offen sc1
    s_add_u32 s32, s32, 1
    s_waitcnt vmcnt(0)
    v_cmp_ne_u32 s[62:63], 0, v14
    s_nop 3
    s_cmp_le_u32 s32, 200000
    s_cbranch_scc1 L_fast_step
    s_mov_b64 s[62:63], -1
    s_branch L_fast_step
L_fast_safe:
    s_nop 11
    s_waitcnt vmcnt(0) lgkmcnt(0)
    s_barrier
    ds_read_b128 v[72:75], v6 offset:0
    ds_read_b128 v[88:91], v6 offset:2304
    ds_read_b128 v[76:79], v6 offset:64
    ds_read_b128 v[92:95], v6 offset:2368
    ds_read_b128 v[80:83], v6 offset:128
    ds_read_b128 v[96:99], v6 offset:2432
    ds_read_b128 v[84:87], v6 offset:192
    ds_read_b128 v[100:103], v6 offset:2496
    s_xor_b32 s36, s25, 0x1000
    s_add_u32 s36, s36, s23
    buffer_load_dwordx4 v[16:19], v3, s[8:11], s29 offen offset:0 sc1
    buffer_load_dwordx4 v[32:35], v3, s[8:11], s36 offen offset:0 sc1
    buffer_load_dwordx4 v[20:23], v3, s[8:11], s29 offen offset:1024 sc1
    buffer_load_dwordx4 v[36:39], v3, s[8:11], s36 offen offset:1024 sc1
    buffer_load_dwordx4 v[24:27], v3, s[8:11], s29 offen offset:2048 sc1
    buffer_load_dwordx4 v[40:43], v3, s[8:11], s36 offen offset:2048 sc1
    buffer_load_dwordx4 v[28:31], v3, s[8:11], s29 offen offset:3072 sc1
    buffer_load_dwordx4 v[44:47], v3, s[8:11], s36 offen offset:3072 sc1
    s_waitcnt vmcnt(0) lgkmcnt(0)
    v_mfma_f32_16x16x32_bf16 v[48:51], v[16:19], v[72:75], 0
    v_mfma_f32_16x16x32_bf16 v[48:51], v[20:23], v[76:79], v[48:51]
    v_mfma_f32_16x16x32_bf16 v[48:51], v[24:27], v[80:83], v[48:51]
    v_mfma_f32_16x16x32_bf16 v[48:51], v[28:31], v[84:87], v[48:51]
    v_mfma_f32_16x16x32_bf16 v[52:55], v[32:35], v[72:75], 0
    v_mfma_f32_16x16x32_bf16 v[52:55], v[36:39], v[76:79], v[52:55]
    v_mfma_f32_16x16x32_bf16 v[52:55], v[40:43], v[80:83], v[52:55]
    v_mfma_f32_16x16x32_bf16 v[52:55], v[44:47], v[84:87], v[52:55]
    v_mfma_f32_16x16x32_bf16 v[56:59], v[88:91], v[72:75], 0
    v_mfma_f32_16x16x32_bf16 v[56:59], v[92:95], v[76:79], v[56:59]
    v_mfma_f32_16x16x32_bf16 v[56:59], v[96:99], v[80:83], v[56:59]
    v_mfma_f32_16x16x32_bf16 v[56:59], v[100:103], v[84:87], v[56:59]
    s_nop 7
    v_mul_f32 v56, s33, v56
    v_mul_f32 v57, s33, v57
    v_max3_f32 v16, v48, v49, v50
    v_max3_f32 v16, v16, v51, v52
    v_max3_f32 v16, v16, v53, v54
    v_max3_f32 v16, v16, v55, v56
    v_max_f32 v16, v16, v57
    v_mov_b32 v17, v16
    s_nop 1
    v_permlane16_swap_b32 v16, v17
    v_max_f32 v16, v16, v17
    v_mov_b32 v17, v16
    s_nop 1
    v_permlane32_swap_b32 v16, v17
    v_max_f32 v16, v16, v17
    v_sub_f32 v48, v48, v16
    v_exp_f32 v48, v48
    v_sub_f32 v49, v49, v16
    v_exp_f32 v49, v49
    v_sub_f32 v50, v50, v16
    v_exp_f32 v50, v50
    v_sub_f32 v51, v51, v16
    v_exp_f32 v51, v51
    v_sub_f32 v52, v52, v16
    v_exp_f32 v52, v52
    v_sub_f32 v53, v53, v16
    v_exp_f32 v53, v53
    v_sub_f32 v54, v54, v16
    v_exp_f32 v54, v54
    v_sub_f32 v55, v55, v16
    v_exp_f32 v55, v55
    v_sub_f32 v56, v56, v16
    v_exp_f32 v56, v56
    v_sub_f32 v57, v57, v16
    v_exp_f32 v57, v57
    v_cvt_pk_bf16_f32 v108, v48, v49
    v_cvt_pk_bf16_f32 v109, v50, v51
    v_cvt_pk_bf16_f32 v110, v52, v53
    v_cvt_pk_bf16_f32 v111, v54, v55
    v_cvt_pk_bf16_f32 v112, v56, v57
    s_nop 0
    v_mfma_f32_16x16x32_bf16 v[48:51], v[104:107], v[108:111], 0
    v_mfma_f32_16x16x32_bf16 v[56:59], v[120:123], v[108:111], 0
    v_mfma_f32_16x16x32_bf16 v[60:63], v[124:127], v[108:111], 0
    s_nop 3
    v_mfma_f32_16x16x16_bf16 v[48:51], v[104:105], v[112:113], v[48:51]
    v_mfma_f32_16x16x16_bf16 v[56:59], v[114:115], v[112:113], v[56:59]
    v_mfma_f32_16x16x16_bf16 v[60:63], v[116:117], v[112:113], v[60:63]
    s_nop 5
    v_rcp_f32 v118, v48
    s_nop 0
    v_mul_f32 v56, v56, v118
    v_mul_f32 v57, v57, v118
    v_mul_f32 v58, v58, v118
    v_mul_f32 v59, v59, v118
    v_mul_f32 v60, v60, v118
    v_mul_f32 v61, v61, v118
    v_mul_f32 v62, v62, v118
    v_mul_f32 v63, v63, v118
    v_cvt_pk_bf16_f32 v52, v56, v60
    v_cvt_pk_bf16_f32 v53, v57, v61
    v_cvt_pk_bf16_f32 v54, v58, v62
    v_cvt_pk_bf16_f32 v55, v59, v63
    v_mov_b32 v16, 0
    v_mov_b32 v17, 0
    v_mov_b32 v18, 0
    v_mov_b32 v19, 0
    v_mov_b32 v20, 0
    v_mov_b32 v21, 0
    v_mov_b32 v22, 0
    v_mov_b32 v23, 0
    v_mov_b32 v24, 0
    v_mov_b32 v25, 0
    v_mov_b32 v26, 0
    v_mov_b32 v27, 0
    v_mov_b32 v28, 0
    v_mov_b32 v29, 0
    v_mov_b32 v30, 0
    v_mov_b32 v31, 0
    v_xor_b32 v32, 0x800, v2
    v_xor_b32 v40, 0x1800, v2
    s_mov_b64 vcc, 0
    s_branch L_fast_rejoin
L_fast_done:
    s_branch L_end
L_slow_start:
    s_mov_b32 s22, 0
    s_mov_b32 s23, 0x1000000
    s_mov_b32 s27, 0
    s_mov_b32 s31, 0x80000
    s_mov_b32 s61, 0x40000000
    s_mov_b32 s91, 0
    ds_read_b128 v[104:107], v4 offset:0
    ds_read_b128 v[108:111], v4 offset:1024
    ds_read_b128 v[112:115], v4 offset:2048
    ds_read_b128 v[116:119], v4 offset:3072
    ds_read_b128 v[88:91], v4 offset:4096
    ds_read_b128 v[92:95], v4 offset:5120
    ds_read_b128 v[96:99], v4 offset:6144
    ds_read_b128 v[100:103], v4 offset:7168
    ds_read_b128 v[72:75], v4 offset:8192
    ds_read_b128 v[76:79], v4 offset:9216
    ds_read_b128 v[80:83], v4 offset:10240
    ds_read_b128 v[84:87], v4 offset:11264
    v_mov_b64 v[48:49], 0
    v_mov_b64 v[50:51], 0
    v_mov_b64 v[52:53], 0
    v_mov_b64 v[54:55], 0
    v_mov_b64 v[56:57], 0
    v_mov_b64 v[58:59], 0
    v_mov_b64 v[60:61], 0
    v_mov_b64 v[62:63], 0
    v_mov_b64 v[64:65], 0
    v_mov_b64 v[66:67], 0
    v_mov_b64 v[68:69], 0
    v_mov_b64 v[70:71], 0
    s_mov_b64 s[62:63], 0
    s_add_u32 s7, s23, 0x80000
    buffer_load_dwordx4 v[16:19], v2, s[8:11], s7 offen sc1
    buffer_load_dwordx4 v[20:23], v2, s[8:11], s7 offen offset:1024 sc1
L_slow_step:
    s_lshr_b64 s[36:37], s[62:63], s22
    s_andn2_b32 s36, 3, s36
    s_cbranch_scc1 L_slow_refresh
    s_add_u32 s24, s23, 0x82000
    s_add_u32 s29, s23, s25
    s_add_u32 s30, s23, s39
    s_xor_b32 s28, s27, 1
    s_add_u32 s90, s22, 1
    s_nop 15
L_slow_retrym:
    buffer_load_dwordx4 v[16:19], v2, s[8:11], s7 offen sc1
    buffer_load_dwordx4 v[20:23], v2, s[8:11], s7 offen offset:1024 sc1
    s_add_u32 s32, s32, 1
    s_cmp_gt_u32 s32, 200000
    s_cselect_b32 s94, -1, -2
    v_xor_b32 v28, 0x800, v2
    v_xor_b32 v44, 0x1800, v2
    v_mov_b64 v[48:49], 0
    v_mov_b64 v[50:51], 0
    v_mov_b64 v[52:53], 0
    v_mov_b64 v[54:55], 0
L_slow_waitm:
    s_waitcnt vmcnt(3) lgkmcnt(0)
L_slow_gotm:
    v_max3_u32 v14, v16, v17, v18
    v_max_u32 v14, v14, v19
    v_smfmac_f32_16x16x64_bf16 v[48:51], v[16:19], v[104:111], v1
    s_waitcnt vmcnt(2)
    v_max3_u32 v14, v14, v20, v21
    v_smfmac_f32_16x16x64_bf16 v[52:55], v[16:19], v[112:119], v1
    v_max3_u32 v14, v14, v22, v23
    v_cmp_lt_u32 vcc, s94, v14
    v_smfmac_f32_16x16x64_bf16 v[48:51], v[20:23], v[88:95], v1
    ds_write_b128 v2, v[16:19] offset:0
    s_cbranch_vccnz L_slow_retrym
    v_smfmac_f32_16x16x64_bf16 v[52:55], v[20:23], v[96:103], v1
    ds_write_b128 v2, v[20:23] offset:1024
    v_smfmac_f32_16x16x64_bf16 v[56:59], v[16:19], v[72:79], v1
    buffer_load_dwordx4 v[104:107], v3, s[8:11], s29 offen offset:0 sc1
    v_smfmac_f32_16x16x64_bf16 v[60:63], v[16:19], v[80:87], v1
    buffer_load_dwordx4 v[108:111], v3, s[8:11], s29 offen offset:1024 sc1
    v_smfmac_f32_16x16x64_bf16 v[56:59], v[20:23], a[80:87], v1
    buffer_load_dwordx4 v[112:115], v3, s[8:11], s29 offen offset:2048 sc1
    v_smfmac_f32_16x16x64_bf16 v[60:63], v[20:23], a[88:95], v1
    s_waitcnt lgkmcnt(0)
    s_barrier
    ds_read_b128 v[24:27], v28 offset:0
    v_smfmac_f32_16x16x64_bf16 v[64:67], v[16:19], a[160:167], v1
    ds_read_b128 v[28:31], v28 offset:1024
    v_smfmac_f32_16x16x64_bf16 v[68:71], v[16:19], a[168:175], v1
    buffer_load_dwordx4 v[116:119], v3, s[8:11], s29 offen offset:3072 sc1
    v_smfmac_f32_16x16x64_bf16 v[64:67], v[20:23], a[176:183], v1
    ds_read_b128 v[32:35], v8 offset:0
    v_smfmac_f32_16x16x64_bf16 v[68:71], v[20:23], a[184:191], v1
    ds_read_b128 v[36:39], v8 offset:1024
    s_waitcnt lgkmcnt(3)
    v_smfmac_f32_16x16x64_bf16 v[48:51], v[24:27], a[0:7], v1
    ds_read_b128 v[40:43], v44 offset:0
    v_smfmac_f32_16x16x64_bf16 v[52:55], v[24:27], a[8:15], v1
    ds_read_b128 v[44:47], v44 offset:1024
    s_waitcnt lgkmcnt(4)
    v_smfmac_f32_16x16x64_bf16 v[48:51], v[28:31], a[16:23], v1
    ds_read_b128 v[88:91], v4 offset:12288
    v_smfmac_f32_16x16x64_bf16 v[52:55], v[28:31], a[24:31], v1
    ds_read_b128 v[92:95], v4 offset:13312
    s_waitcnt lgkmcnt(4)
    v_smfmac_f32_16x16x64_bf16 v[48:51], v[32:35], a[32:39], v1
    ds_read_b128 v[96:99], v4 offset:14336
    v_smfmac_f32_16x16x64_bf16 v[52:55], v[32:35], a[40:47], v1
    ds_read_b128 v[100:103], v4 offset:15360
    s_waitcnt lgkmcnt(4)
    v_smfmac_f32_16x16x64_bf16 v[48:51], v[36:39], a[48:55], v1
    buffer_load_dwordx4 v[120:123], v3, s[8:11], s30 offen offset:0 sc1
    v_smfmac_f32_16x16x64_bf16 v[52:55], v[36:39], a[56:63], v1
    ds_read_b128 v[72:75], v4 offset:16384
    v_smfmac_f32_16x16x64_bf16 v[48:51], v[40:43], a[64:71], v1
    buffer_load_dwordx4 v[124:127], v3, s[8:11], s30 offen offset:1024 sc1
    v_smfmac_f32_16x16x64_bf16 v[52:55], v[40:43], a[72:79], v1
    ds_read_b128 v[76:79], v4 offset:17408
    s_waitcnt lgkmcnt(2)
    v_smfmac_f32_16x16x64_bf16 v[48:51], v[44:47], v[88:95], v1
    ds_read_b128 v[80:83], v4 offset:18432
    v_smfmac_f32_16x16x64_bf16 v[52:55], v[44:47], v[96:103], v1
    ds_read_b128 v[84:87], v4 offset:19456
    v_smfmac_f32_16x16x64_bf16 v[56:59], v[28:31], a[96:103], v1
    ds_read_b128 v[88:91], v4 offset:20480
    v_smfmac_f32_16x16x64_bf16 v[60:63], v[28:31], a[104:111], v1
    ds_read_b128 v[92:95], v4 offset:21504
    v_smfmac_f32_16x16x64_bf16 v[56:59], v[32:35], a[112:119], v1
    ds_read_b128 v[96:99], v4 offset:22528
    v_add_f32 v48, v48, v50
    v_add_f32 v49, v49, v51
    v_smfmac_f32_16x16x64_bf16 v[60:63], v[32:35], a[120:127], v1
    ds_read_b128 v[100:103], v4 offset:23552
    v_add_f32 v52, v52, v54
    v_add_f32 v53, v53, v55
    v_smfmac_f32_16x16x64_bf16 v[56:59], v[36:39], a[128:135], v1
    s_waitcnt lgkmcnt(4)
    v_cvt_pk_bf16_f32 v50, v48, v52
    v_cvt_pk_bf16_f32 v51, v49, v53
    v_smfmac_f32_16x16x64_bf16 v[56:59], v[24:27], v[72:79], v1
    ds_write2_b32 v5, v50, v51 offset0:0 offset1:72
    v_smfmac_f32_16x16x64_bf16 v[60:63], v[24:27], v[80:87], v1
    buffer_load_dword v15, v0, s[8:11], s24 offen sc1
    v_smfmac_f32_16x16x64_bf16 v[60:63], v[36:39], a[136:143], v1
    v_smfmac_f32_16x16x64_bf16 v[56:59], v[40:43], a[144:151], v1
    buffer_store_dword v12, v10, s[8:11], s31 offen sc1
    v_smfmac_f32_16x16x64_bf16 v[60:63], v[40:43], a[152:159], v1
    s_waitcnt lgkmcnt(0)
    s_barrier
    v_smfmac_f32_16x16x64_bf16 v[56:59], v[44:47], v[88:95], v1
    ds_read_b128 v[72:75], v6 offset:0
    v_smfmac_f32_16x16x64_bf16 v[60:63], v[44:47], v[96:103], v1
    ds_read_b128 v[76:79], v6 offset:64
    v_smfmac_f32_16x16x64_bf16 v[64:67], v[24:27], a[192:199], v1
    ds_read_b128 v[80:83], v6 offset:128
    v_smfmac_f32_16x16x64_bf16 v[68:71], v[24:27], a[200:207], v1
    ds_read_b128 v[84:87], v6 offset:192
    s_waitcnt vmcnt(2) lgkmcnt(3)
    v_mfma_f32_16x16x32_bf16 v[48:51], v[104:107], v[72:75], 0
    s_waitcnt lgkmcnt(2)
    v_add_f32 v56, v56, v58
    v_add_f32 v57, v57, v59
    v_mfma_f32_16x16x32_bf16 v[48:51], v[108:111], v[76:79], v[48:51]
    s_waitcnt lgkmcnt(1)
    v_add_f32 v60, v60, v62
    v_add_f32 v61, v61, v63
    v_mfma_f32_16x16x32_bf16 v[48:51], v[112:115], v[80:83], v[48:51]
    s_waitcnt lgkmcnt(0)
    v_cvt_pk_bf16_f32 v58, v56, v60
    v_cvt_pk_bf16_f32 v59, v57, v61
    v_mfma_f32_16x16x32_bf16 v[48:51], v[116:119], v[84:87], v[48:51]
    ds_write2_b32 v7, v58, v59 offset0:0 offset1:72
    v_smfmac_f32_16x16x64_bf16 v[64:67], v[28:31], a[208:215], v1
    v_mov_b64 v[104:105], s[4:5]
    v_smfmac_f32_16x16x64_bf16 v[68:71], v[28:31], a[216:223], v1
    s_nop 1
    v_mov_b64 v[106:107], s[4:5]
    v_smfmac_f32_16x16x64_bf16 v[64:67], v[32:35], a[224:231], v1
    v_exp_f32 v48, v48
    v_smfmac_f32_16x16x64_bf16 v[68:71], v[32:35], a[232:239], v1
    s_waitcnt lgkmcnt(0)
    s_barrier
    v_exp_f32 v49, v49
    v_smfmac_f32_16x16x64_bf16 v[64:67], v[36:39], a[240:247], v1
    ds_read_b128 v[88:91], v6 offset:2304
    v_exp_f32 v50, v50
    v_smfmac_f32_16x16x64_bf16 v[68:71], v[36:39], a[248:255], v1
    ds_read_b128 v[92:95], v6 offset:2368
    v_exp_f32 v51, v51
    v_smfmac_f32_16x16x64_bf16 v[64:67], v[40:43], v[128:135], v1
    ds_read_b128 v[96:99], v6 offset:2432
    v_cvt_pk_bf16_f32 v108, v48, v49
    v_cvt_pk_bf16_f32 v109, v50, v51
    v_smfmac_f32_16x16x64_bf16 v[68:71], v[40:43], v[136:143], v1
    ds_read_b128 v[100:103], v6 offset:2496
    ds_write_b64 v2, v[108:109] offset:8192
    s_waitcnt lgkmcnt(4)
    v_mfma_f32_16x16x32_bf16 v[52:55], v[88:91], v[72:75], 0
    s_waitcnt lgkmcnt(3)
    v_mov_b32 v113, 0
    v_mov_b32 v115, 0
    v_mfma_f32_16x16x32_bf16 v[52:55], v[92:95], v[76:79], v[52:55]
    s_waitcnt lgkmcnt(2)
    v_mov_b32 v117, 0
    v_mov_b64 v[16:17], 0
    v_mfma_f32_16x16x32_bf16 v[52:55], v[96:99], v[80:83], v[52:55]
    s_waitcnt lgkmcnt(1)
    v_mov_b64 v[18:19], 0
    v_mov_b64 v[20:21], 0
    v_mfma_f32_16x16x32_bf16 v[52:55], v[100:103], v[84:87], v[52:55]
    s_waitcnt lgkmcnt(0)
    s_barrier
    v_smfmac_f32_16x16x64_bf16 v[64:67], v[44:47], v[144:151], v1
    ds_read_b64 v[110:111], v8 offset:8192
    v_mov_b64 v[22:23], 0
    v_smfmac_f32_16x16x64_bf16 v[68:71], v[44:47], v[152:159], v1
    v_mov_b64 v[24:25], 0
    v_mov_b64 v[26:27], 0
    v_mul_f32 v52, s33, v52
    v_mul_f32 v53, s33, v53
    v_exp_f32 v52, v52
    s_waitcnt lgkmcnt(0)
    v_mfma_f32_16x16x32_bf16 v[48:51], v[104:107], v[108:111], 0
    v_exp_f32 v53, v53
    v_add_f32 v64, v64, v66
    v_mfma_f32_16x16x32_bf16 v[56:59], v[120:123], v[108:111], 0
    v_cvt_pk_bf16_f32 v112, v52, v53
    v_add_f32 v65, v65, v67
    v_mfma_f32_16x16x32_bf16 v[60:63], v[124:127], v[108:111], 0
    v_cvt_pk_bf16_f32 v114, v64, v65
    v_add_f32 v68, v68, v70
    v_mfma_f32_16x16x16_bf16 v[48:51], v[104:105], v[112:113], v[48:51]
    v_add_f32 v69, v69, v71
    v_cvt_pk_bf16_f32 v116, v68, v69
    v_mfma_f32_16x16x16_bf16 v[56:59], v[114:115], v[112:113], v[56:59]
    v_mov_b64 v[28:29], 0
    v_mov_b64 v[30:31], 0
    v_mfma_f32_16x16x16_bf16 v[60:63], v[116:117], v[112:113], v[60:63]
    v_xor_b32 v32, 0x800, v2
    v_xor_b32 v40, 0x1800, v2
    v_rcp_f32 v118, v48
    s_nop 0
    v_max_f32 v14, v118, v48
    v_cmp_nge_f32 vcc, s40, v14
    v_pk_mul_f32 v[56:57], v[56:57], v[118:119] op_sel_hi:[1,0]
    v_pk_mul_f32 v[58:59], v[58:59], v[118:119] op_sel_hi:[1,0]
    v_pk_mul_f32 v[60:61], v[60:61], v[118:119] op_sel_hi:[1,0]
    v_pk_mul_f32 v[62:63], v[62:63], v[118:119] op_sel_hi:[1,0]
    v_cvt_pk_bf16_f32 v52, v56, v60
    v_cvt_pk_bf16_f32 v53, v57, v61
    v_cvt_pk_bf16_f32 v54, v58, v62
    v_cvt_pk_bf16_f32 v55, v59, v63
L_slow_rejoin:
    ds_write_b128 v2, v[52:55] offset:9216
    s_nop 0
    v_smfmac_f32_16x16x64_bf16 v[16:19], v[52:55], v[160:167], v1
    v_smfmac_f32_16x16x64_bf16 v[20:23], v[52:55], v[168:175], v1
    v_smfmac_f32_16x16x64_bf16 v[24:27], v[52:55], v[176:183], v1
    s_waitcnt lgkmcnt(0)
    s_barrier
    ds_read_b128 v[32:35], v32 offset:9216
    ds_read_b128 v[36:39], v8 offset:9216
    v_smfmac_f32_16x16x64_bf16 v[28:31], v[52:55], v[184:191], v1
    ds_read_b128 v[40:43], v40 offset:9216
    ds_read_b128 v[88:91], v4 offset:24576
    ds_read_b128 v[92:95], v4 offset:25600
    s_waitcnt lgkmcnt(4)
    v_smfmac_f32_16x16x64_bf16 v[16:19], v[32:35], v[192:199], v1
    ds_read_b128 v[96:99], v4 offset:26624
    s_waitcnt lgkmcnt(4)
    v_smfmac_f32_16x16x64_bf16 v[16:19], v[36:39], v[216:223], v1
    ds_read_b128 v[100:103], v4 offset:27648
    s_waitcnt lgkmcnt(4)
    v_smfmac_f32_16x16x64_bf16 v[16:19], v[40:43], v[240:247], v1
    ds_read_b128 v[72:75], v4 offset:28672
    s_cmp_lg_u64 vcc, 0
    v_smfmac_f32_16x16x64_bf16 v[20:23], v[32:35], v[200:207], v1
    ds_read_b128 v[76:79], v4 offset:29696
    s_cselect_b32 s60, s28, s27
    v_smfmac_f32_16x16x64_bf16 v[20:23], v[36:39], v[224:231], v1
    ds_read_b128 v[80:83], v4 offset:30720
    s_nop 0
    v_cvt_pk_bf16_f32 v56, v16, v18
    v_smfmac_f32_16x16x64_bf16 v[20:23], v[40:43], v[248:255], v1
    ds_read_b128 v[84:87], v4 offset:31744
    v_cvt_pk_bf16_f32 v57, v17, v19
    v_and_or_b32 v56, v56, -2, s60
    v_smfmac_f32_16x16x64_bf16 v[24:27], v[32:35], v[208:215], v1
    buffer_store_dwordx2 v[56:57], v9, s[8:11], 0 offen offset:0 sc1
    v_smfmac_f32_16x16x64_bf16 v[24:27], v[36:39], v[232:239], v1
    s_waitcnt lgkmcnt(4)
    s_nop 0
    v_cvt_pk_bf16_f32 v58, v20, v22
    v_smfmac_f32_16x16x64_bf16 v[24:27], v[40:43], v[88:95], v1
    ds_read_b128 v[64:67], v3 offset:23040
    v_cvt_pk_bf16_f32 v59, v21, v23
    v_and_or_b32 v58, v58, -2, s60
    v_smfmac_f32_16x16x64_bf16 v[28:31], v[32:35], v[96:103], v1
    buffer_store_dwordx2 v[58:59], v9, s[8:11], 0 offen offset:2048 sc1
    s_waitcnt lgkmcnt(1)
    v_smfmac_f32_16x16x64_bf16 v[28:31], v[36:39], v[72:79], v1
    s_nop 1
    v_cvt_pk_bf16_f32 v60, v24, v26
    v_smfmac_f32_16x16x64_bf16 v[28:31], v[40:43], v[80:87], v1
    v_cvt_pk_bf16_f32 v61, v25, v27
    v_and_or_b32 v60, v60, -2, s60
    buffer_store_dwordx2 v[60:61], v9, s[8:11], s26 offen offset:0 sc1
    s_nop 4
    v_cvt_pk_bf16_f32 v62, v28, v30
    v_cvt_pk_bf16_f32 v63, v29, v31
    v_and_or_b32 v62, v62, -2, s60
    buffer_store_dwordx2 v[62:63], v9, s[8:11], s26 offen offset:2048 sc1
L_slow_stored:
    s_cmp_lg_u32 s60, s27
    s_cbranch_scc1 L_slow_safe
    ds_read_b128 v[104:107], v4 offset:0
    ds_read_b128 v[108:111], v4 offset:1024
    ds_read_b128 v[112:115], v4 offset:2048
    ds_read_b128 v[116:119], v4 offset:3072
    ds_read_b128 v[88:91], v4 offset:4096
    ds_read_b128 v[92:95], v4 offset:5120
    ds_read_b128 v[96:99], v4 offset:6144
    ds_read_b128 v[100:103], v4 offset:7168
    ds_read_b128 v[72:75], v4 offset:8192
    ds_read_b128 v[76:79], v4 offset:9216
    ds_read_b128 v[80:83], v4 offset:10240
    ds_read_b128 v[84:87], v4 offset:11264
    s_cmp_lt_u32 s21, 1
    s_cbranch_scc1 L_slow_pollp
    s_nop 13
    s_cmp_lt_u32 s21, 2
    s_cbranch_scc1 L_slow_pollp
    s_nop 13
    s_cmp_lt_u32 s21, 3
    s_cbranch_scc1 L_slow_pollp
    s_nop 13
L_slow_pollp:
    buffer_load_dwordx4 v[120:123], v2, s[8:11], s6 offen sc1
    buffer_load_dwordx4 v[124:127], v2, s[8:11], s6 offen offset:1024 sc1
    v_mov_b64 v[56:57], 0
    v_mov_b64 v[58:59], 0
    v_mov_b64 v[60:61], 0
    v_mov_b64 v[62:63], 0
    s_nop 15
    s_nop 15
    buffer_load_dwordx4 v[32:35], v2, s[8:11], s6 offen sc1
    buffer_load_dwordx4 v[36:39], v2, s[8:11], s6 offen offset:1024 sc1
    s_add_u32 s7, s24, 0x80000
    s_waitcnt vmcnt(3) lgkmcnt(0)
    v_mfma_f32_16x16x32_bf16 v[68:71], v[64:67], v[120:123], 0
    v_bitop3_b32 v14, v120, v122, s27 bitop3:0x7e
    s_waitcnt vmcnt(2)
    v_mfma_f32_16x16x32_bf16 v[68:71], v[64:67], v[124:127], v[68:71]
    v_bitop3_b32 v11, v124, v126, s27 bitop3:0x7e
    v_bitop3_b32 v14, v14, v11, 1 bitop3:0xa8
    v_cmp_ne_u32 vcc, 0, v14
    s_nop 2
    s_cmp_eq_u64 vcc, 0
    s_cselect_b32 s36, s24, s61
    v_add_f32_dpp v68, v68, v68 row_ror:8 row_mask:0xf bank_mask:0xf
    v_add_f32_dpp v69, v69, v69 row_ror:8 row_mask:0xf bank_mask:0xf
    s_nop 0
    v_add_f32_dpp v68, v68, v68 row_ror:4 row_mask:0xf bank_mask:0xf
    v_add_f32_dpp v69, v69, v69 row_ror:4 row_mask:0xf bank_mask:0xf
    v_cvt_pk_bf16_f32 v12, v68, v69
    buffer_store_dword v12, v10, s[8:11], s36 offen sc1
    s_cbranch_scc1 L_slow_gotp
L_slow_retryp:
    buffer_load_dwordx4 v[120:123], v2, s[8:11], s6 offen sc1
    buffer_load_dwordx4 v[124:127], v2, s[8:11], s6 offen offset:1024 sc1
    s_waitcnt vmcnt(4) lgkmcnt(0)
    v_mfma_f32_16x16x32_bf16 v[68:71], v[64:67], v[32:35], 0
    v_bitop3_b32 v14, v32, v34, s27 bitop3:0x7e
    s_waitcnt vmcnt(3)
    v_mfma_f32_16x16x32_bf16 v[68:71], v[64:67], v[36:39], v[68:71]
    v_bitop3_b32 v11, v36, v38, s27 bitop3:0x7e
    v_bitop3_b32 v14, v14, v11, 1 bitop3:0xa8
    v_cmp_ne_u32 vcc, 0, v14
    s_nop 2
    s_cmp_eq_u64 vcc, 0
    s_cselect_b32 s36, s24, s61
    v_add_f32_dpp v68, v68, v68 row_ror:8 row_mask:0xf bank_mask:0xf
    v_add_f32_dpp v69, v69, v69 row_ror:8 row_mask:0xf bank_mask:0xf
    s_nop 0
    v_add_f32_dpp v68, v68, v68 row_ror:4 row_mask:0xf bank_mask:0xf
    v_add_f32_dpp v69, v69, v69 row_ror:4 row_mask:0xf bank_mask:0xf
    v_cvt_pk_bf16_f32 v12, v68, v69
    buffer_store_dword v12, v10, s[8:11], s36 offen sc1
    s_cbranch_scc1 L_slow_gotp
    buffer_load_dwordx4 v[32:35], v2, s[8:11], s6 offen sc1
    buffer_load_dwordx4 v[36:39], v2, s[8:11], s6 offen offset:1024 sc1
    s_waitcnt vmcnt(4) lgkmcnt(0)
    v_mfma_f32_16x16x32_bf16 v[68:71], v[64:67], v[120:123], 0
    v_bitop3_b32 v14, v120, v122, s27 bitop3:0x7e
    s_waitcnt vmcnt(3)
    v_mfma_f32_16x16x32_bf16 v[68:71], v[64:67], v[124:127], v[68:71]
    v_bitop3_b32 v11, v124, v126, s27 bitop3:0x7e
    v_bitop3_b32 v14, v14, v11, 1 bitop3:0xa8
    v_cmp_ne_u32 vcc, 0, v14
    s_nop 2
    s_cmp_eq_u64 vcc, 0
    s_cselect_b32 s36, s24, s61
    v_add_f32_dpp v68, v68, v68 row_ror:8 row_mask:0xf bank_mask:0xf
    v_add_f32_dpp v69, v69, v69 row_ror:8 row_mask:0xf bank_mask:0xf
    s_nop 0
    v_add_f32_dpp v68, v68, v68 row_ror:4 row_mask:0xf bank_mask:0xf
    v_add_f32_dpp v69, v69, v69 row_ror:4 row_mask:0xf bank_mask:0xf
    v_cvt_pk_bf16_f32 v12, v68, v69
    buffer_store_dword v12, v10, s[8:11], s36 offen sc1
    s_cbranch_scc1 L_slow_gotp
    s_add_u32 s32, s32, 1
    s_cmp_le_u32 s32, 200000
    s_cbranch_scc1 L_slow_retryp
    s_mov_b32 s36, s24
    buffer_store_dword v12, v10, s[8:11], s36 offen sc1
L_slow_gotp:
    s_mov_b32 s23, s24
    s_add_u32 s31, s31, 0x2000
    s_mov_b32 s22, s90
    s_mov_b32 s27, s28
    v_mov_b64 v[64:65], 0
    v_mov_b64 v[66:67], 0
    v_mov_b64 v[68:69], 0
    v_mov_b64 v[70:71], 0
    s_nop 15
    s_nop 15
    buffer_load_dwordx4 v[16:19], v2, s[8:11], s7 offen sc1
    buffer_load_dwordx4 v[20:23], v2, s[8:11], s7 offen offset:1024 sc1
    s_cmp_lt_u32 s22, 63
    s_cbranch_scc1 L_slow_step
    buffer_store_dword v12, v10, s[8:11], s31 offen sc1
    s_branch L_slow_done
L_slow_refresh:
    v_lshrrev_b32 v14, 2, v3
    s_lshl_b32 s36, s20, 8
    s_add_u32 s36, s36, 0x190000
    buffer_load_dword v14, v14, s[8:11], s36 offen sc1
    s_add_u32 s32, s32, 1
    s_waitcnt vmcnt(0)
    v_cmp_ne_u32 s[62:63], 0, v14
    s_nop 3
    s_cmp_le_u32 s32, 200000
    s_cbranch_scc1 L_slow_step
    s_mov_b64 s[62:63], -1
    s_branch L_slow_step
L_slow_safe:
    s_nop 11
    s_waitcnt vmcnt(0) lgkmcnt(0)
    s_barrier
    ds_read_b128 v[72:75], v6 offset:0
    ds_read_b128 v[88:91], v6 offset:2304
    ds_read_b128 v[76:79], v6 offset:64
    ds_read_b128 v[92:95], v6 offset:2368
    ds_read_b128 v[80:83], v6 offset:128
    ds_read_b128 v[96:99], v6 offset:2432
    ds_read_b128 v[84:87], v6 offset:192
    ds_read_b128 v[100:103], v6 offset:2496
    s_xor_b32 s36, s25, 0x1000
    s_add_u32 s36, s36, s23
    buffer_load_dwordx4 v[16:19], v3, s[8:11], s29 offen offset:0 sc1
    buffer_load_dwordx4 v[32:35], v3, s[8:11], s36 offen offset:0 sc1
    buffer_load_dwordx4 v[20:23], v3, s[8:11], s29 offen offset:1024 sc1
    buffer_load_dwordx4 v[36:39], v3, s[8:11], s36 offen offset:1024 sc1
    buffer_load_dwordx4 v[24:27], v3, s[8:11], s29 offen offset:2048 sc1
    buffer_load_dwordx4 v[40:43], v3, s[8:11], s36 offen offset:2048 sc1
    buffer_load_dwordx4 v[28:31], v3, s[8:11], s29 offen offset:3072 sc1
    buffer_load_dwordx4 v[44:47], v3, s[8:11], s36 offen offset:3072 sc1
    s_waitcnt vmcnt(0) lgkmcnt(0)
    v_mfma_f32_16x16x32_bf16 v[48:51], v[16:19], v[72:75], 0
    v_mfma_f32_16x16x32_bf16 v[48:51], v[20:23], v[76:79], v[48:51]
    v_mfma_f32_16x16x32_bf16 v[48:51], v[24:27], v[80:83], v[48:51]
    v_mfma_f32_16x16x32_bf16 v[48:51], v[28:31], v[84:87], v[48:51]
    v_mfma_f32_16x16x32_bf16 v[52:55], v[32:35], v[72:75], 0
    v_mfma_f32_16x16x32_bf16 v[52:55], v[36:39], v[76:79], v[52:55]
    v_mfma_f32_16x16x32_bf16 v[52:55], v[40:43], v[80:83], v[52:55]
    v_mfma_f32_16x16x32_bf16 v[52:55], v[44:47], v[84:87], v[52:55]
    v_mfma_f32_16x16x32_bf16 v[56:59], v[88:91], v[72:75], 0
    v_mfma_f32_16x16x32_bf16 v[56:59], v[92:95], v[76:79], v[56:59]
    v_mfma_f32_16x16x32_bf16 v[56:59], v[96:99], v[80:83], v[56:59]
    v_mfma_f32_16x16x32_bf16 v[56:59], v[100:103], v[84:87], v[56:59]
    s_nop 7
    v_mul_f32 v56, s33, v56
    v_mul_f32 v57, s33, v57
    v_max3_f32 v16, v48, v49, v50
    v_max3_f32 v16, v16, v51, v52
    v_max3_f32 v16, v16, v53, v54
    v_max3_f32 v16, v16, v55, v56
    v_max_f32 v16, v16, v57
    v_mov_b32 v17, v16
    s_nop 1
    v_permlane16_swap_b32 v16, v17
    v_max_f32 v16, v16, v17
    v_mov_b32 v17, v16
    s_nop 1
    v_permlane32_swap_b32 v16, v17
    v_max_f32 v16, v16, v17
    v_sub_f32 v48, v48, v16
    v_exp_f32 v48, v48
    v_sub_f32 v49, v49, v16
    v_exp_f32 v49, v49
    v_sub_f32 v50, v50, v16
    v_exp_f32 v50, v50
    v_sub_f32 v51, v51, v16
    v_exp_f32 v51, v51
    v_sub_f32 v52, v52, v16
    v_exp_f32 v52, v52
    v_sub_f32 v53, v53, v16
    v_exp_f32 v53, v53
    v_sub_f32 v54, v54, v16
    v_exp_f32 v54, v54
    v_sub_f32 v55, v55, v16
    v_exp_f32 v55, v55
    v_sub_f32 v56, v56, v16
    v_exp_f32 v56, v56
    v_sub_f32 v57, v57, v16
    v_exp_f32 v57, v57
    v_cvt_pk_bf16_f32 v108, v48, v49
    v_cvt_pk_bf16_f32 v109, v50, v51
    v_cvt_pk_bf16_f32 v110, v52, v53
    v_cvt_pk_bf16_f32 v111, v54, v55
    v_cvt_pk_bf16_f32 v112, v56, v57
    s_nop 0
    v_mfma_f32_16x16x32_bf16 v[48:51], v[104:107], v[108:111], 0
    v_mfma_f32_16x16x32_bf16 v[56:59], v[120:123], v[108:111], 0
    v_mfma_f32_16x16x32_bf16 v[60:63], v[124:127], v[108:111], 0
    s_nop 3
    v_mfma_f32_16x16x16_bf16 v[48:51], v[104:105], v[112:113], v[48:51]
    v_mfma_f32_16x16x16_bf16 v[56:59], v[114:115], v[112:113], v[56:59]
    v_mfma_f32_16x16x16_bf16 v[60:63], v[116:117], v[112:113], v[60:63]
    s_nop 5
    v_rcp_f32 v118, v48
    s_nop 0
    v_mul_f32 v56, v56, v118
    v_mul_f32 v57, v57, v118
    v_mul_f32 v58, v58, v118
    v_mul_f32 v59, v59, v118
    v_mul_f32 v60, v60, v118
    v_mul_f32 v61, v61, v118
    v_mul_f32 v62, v62, v118
    v_mul_f32 v63, v63, v118
    v_cvt_pk_bf16_f32 v52, v56, v60
    v_cvt_pk_bf16_f32 v53, v57, v61
    v_cvt_pk_bf16_f32 v54, v58, v62
    v_cvt_pk_bf16_f32 v55, v59, v63
    v_mov_b32 v16, 0
    v_mov_b32 v17, 0
    v_mov_b32 v18, 0
    v_mov_b32 v19, 0
    v_mov_b32 v20, 0
    v_mov_b32 v21, 0
    v_mov_b32 v22, 0
    v_mov_b32 v23, 0
    v_mov_b32 v24, 0
    v_mov_b32 v25, 0
    v_mov_b32 v26, 0
    v_mov_b32 v27, 0
    v_mov_b32 v28, 0
    v_mov_b32 v29, 0
    v_mov_b32 v30, 0
    v_mov_b32 v31, 0
    v_xor_b32 v32, 0x800, v2
    v_xor_b32 v40, 0x1800, v2
    s_mov_b64 vcc, 0
    s_branch L_slow_rejoin
L_slow_done:
    s_branch L_end
L_worker:
    s_mov_b32 s12, s44
    s_and_b32 s13, s45, 0xffff
    s_mov_b32 s14, 0x200000
    s_mov_b32 s15, 0x20000
    s_mov_b32 s60, s82
    s_and_b32 s61, s83, 0xffff
    s_mov_b32 s62, 0x200000
    s_mov_b32 s63, 0x20000
    s_mov_b32 s92, s80
    s_and_b32 s93, s81, 0xffff
    s_mov_b32 s94, 0x400
    s_mov_b32 s95, 0x20000
    s_and_b32 s36, s2, 7
    s_sub_u32 s36, s36, 1
    s_lshl_b32 s36, s36, 5
    s_lshr_b32 s37, s2, 3
    s_add_u32 s36, s36, s37
    s_mul_i32 s20, s36, 10923
    s_lshr_b32 s20, s20, 16
    s_mul_i32 s37, s20, 6
    s_sub_u32 s22, s36, s37
    v_mov_b32 v1, 0x0
    v_bfe_u32 v14, v0, 0, 1
    s_mov_b32 s38, 0x10
    v_mad_u32_u24 v1, v14, s38, v1
    v_bfe_u32 v14, v0, 1, 1
    s_mov_b32 s38, 0x20
    v_mad_u32_u24 v1, v14, s38, v1
    v_bfe_u32 v14, v0, 2, 1
    s_mov_b32 s38, 0x40
    v_mad_u32_u24 v1, v14, s38, v1
    v_bfe_u32 v14, v0, 3, 1
    s_mov_b32 s38, 0x80
    v_mad_u32_u24 v1, v14, s38, v1
    v_bfe_u32 v14, v0, 4, 1
    s_mov_b32 s38, 0x100
    v_mad_u32_u24 v1, v14, s38, v1
    v_bfe_u32 v14, v0, 5, 1
    s_mov_b32 s38, 0x200
    v_mad_u32_u24 v1, v14, s38, v1
    v_mov_b32 v2, 0x0
    v_bfe_u32 v14, v0, 0, 1
    s_mov_b32 s38, 0x10
    v_mad_u32_u24 v2, v14, s38, v2
    v_bfe_u32 v14, v0, 1, 1
    s_mov_b32 s38, 0x20
    v_mad_u32_u24 v2, v14, s38, v2
    v_bfe_u32 v14, v0, 2, 1
    s_mov_b32 s38, 0x40
    v_mad_u32_u24 v2, v14, s38, v2
    v_bfe_u32 v14, v0, 3, 1
    s_mov_b32 s38, 0x80
    v_mad_u32_u24 v2, v14, s38, v2
    v_bfe_u32 v14, v0, 4, 1
    s_mov_b32 s38, 0x100
    v_mad_u32_u24 v2, v14, s38, v2
    v_bfe_u32 v14, v0, 5, 1
    s_mov_b32 s38, 0x200
    v_mad_u32_u24 v2, v14, s38, v2
    v_bfe_u32 v14, v0, 6, 1
    s_mov_b32 s38, 0x800
    v_mad_u32_u24 v2, v14, s38, v2
    v_bfe_u32 v14, v0, 7, 1
    s_mov_b32 s38, 0x1000
    v_mad_u32_u24 v2, v14, s38, v2
    v_mov_b32 v9, 0x0
    v_bfe_u32 v14, v0, 0, 1
    s_mov_b32 s38, 0x10
    v_mad_u32_u24 v9, v14, s38, v9
    v_bfe_u32 v14, v0, 1, 1
    s_mov_b32 s38, 0x20
    v_mad_u32_u24 v9, v14, s38, v9
    v_bfe_u32 v14, v0, 2, 1
    s_mov_b32 s38, 0x40
    v_mad_u32_u24 v9, v14, s38, v9
    v_bfe_u32 v14, v0, 3, 1
    s_mov_b32 s38, 0x80
    v_mad_u32_u24 v9, v14, s38, v9
    v_bfe_u32 v14, v0, 4, 1
    s_mov_b32 s38, 0x100
    v_mad_u32_u24 v9, v14, s38, v9
    v_bfe_u32 v14, v0, 5, 1
    s_mov_b32 s38, 0x200
    v_mad_u32_u24 v9, v14, s38, v9
    v_bfe_u32 v14, v0, 6, 1
    s_mov_b32 s38, 0x400
    v_mad_u32_u24 v9, v14, s38, v9
    v_bfe_u32 v14, v0, 7, 1
    s_mov_b32 s38, 0x800
    v_mad_u32_u24 v9, v14, s38, v9
    v_mov_b32 v7, 0x8000
    v_bfe_u32 v14, v0, 0, 1
    s_mov_b32 s38, 0x10
    v_mad_u32_u24 v7, v14, s38, v7
    v_bfe_u32 v14, v0, 1, 1
    s_mov_b32 s38, 0x20
    v_mad_u32_u24 v7, v14, s38, v7
    v_bfe_u32 v14, v0, 2, 1
    s_mov_b32 s38, 0x40
    v_mad_u32_u24 v7, v14, s38, v7
    v_bfe_u32 v14, v0, 3, 1
    s_mov_b32 s38, 0x80
    v_mad_u32_u24 v7, v14, s38, v7
    v_bfe_u32 v14, v0, 4, 1
    s_mov_b32 s38, 0x100
    v_mad_u32_u24 v7, v14, s38, v7
    v_bfe_u32 v14, v0, 5, 1
    s_mov_b32 s38, 0x200
    v_mad_u32_u24 v7, v14, s38, v7
    v_bfe_u32 v14, v0, 6, 1
    s_mov_b32 s38, 0x8000
    v_mad_u32_u24 v7, v14, s38, v7
    v_bfe_u32 v14, v0, 7, 1
    s_mov_b32 s38, 0x10000
    v_mad_u32_u24 v7, v14, s38, v7
    v_mov_b32 v3, 0x0
    v_bfe_u32 v14, v0, 0, 1
    s_mov_b32 s38, 0x10
    v_mad_u32_u24 v3, v14, s38, v3
    v_bfe_u32 v14, v0, 1, 1
    s_mov_b32 s38, 0x20
    v_mad_u32_u24 v3, v14, s38, v3
    v_bfe_u32 v14, v0, 2, 1
    s_mov_b32 s38, 0x40
    v_mad_u32_u24 v3, v14, s38, v3
    v_bfe_u32 v14, v0, 3, 1
    s_mov_b32 s38, 0x400
    v_mad_u32_u24 v3, v14, s38, v3
    v_bfe_u32 v14, v0, 4, 1
    s_mov_b32 s38, 0x800
    v_mad_u32_u24 v3, v14, s38, v3
    v_bfe_u32 v14, v0, 5, 1
    s_mov_b32 s38, 0x1000
    v_mad_u32_u24 v3, v14, s38, v3
    v_bfe_u32 v14, v0, 6, 1
    s_mov_b32 s38, 0x2000
    v_mad_u32_u24 v3, v14, s38, v3
    v_bfe_u32 v14, v0, 7, 1
    s_mov_b32 s38, 0x4000
    v_mad_u32_u24 v3, v14, s38, v3
    v_mov_b32 v4, 0x0
    v_bfe_u32 v14, v0, 0, 1
    s_mov_b32 s38, 0x100
    v_mad_u32_u24 v4, v14, s38, v4
    v_bfe_u32 v14, v0, 1, 1
    s_mov_b32 s38, 0x200
    v_mad_u32_u24 v4, v14, s38, v4
    v_bfe_u32 v14, v0, 2, 1
    s_mov_b32 s38, 0x400
    v_mad_u32_u24 v4, v14, s38, v4
    v_bfe_u32 v14, v0, 6, 1
    s_mov_b32 s38, 0x80
    v_mad_u32_u24 v4, v14, s38, v4
    v_bfe_u32 v14, v0, 7, 1
    s_mov_b32 s38, 0x4000
    v_mad_u32_u24 v4, v14, s38, v4
    v_lshrrev_b32 v15, 3, v0
    v_xor_b32 v15, v15, v0
    v_and_b32 v15, 7, v15
    v_lshl_add_u32 v4, v15, 4, v4
    v_bfe_u32 v15, v0, 4, 2
    v_lshlrev_b32 v15, 4, v15
    v_xor_b32 v5, v15, v1
    v_xor_b32 v6, 64, v5
    v_mov_b32 v8, 0x5000
    v_bfe_u32 v14, v0, 0, 1
    s_mov_b32 s38, 0x10
    v_mad_u32_u24 v8, v14, s38, v8
    v_bfe_u32 v14, v0, 1, 1
    s_mov_b32 s38, 0x40
    v_mad_u32_u24 v8, v14, s38, v8
    v_bfe_u32 v14, v0, 2, 1
    s_mov_b32 s38, 0x80
    v_mad_u32_u24 v8, v14, s38, v8
    v_bfe_u32 v14, v0, 4, 1
    s_mov_b32 s38, 0x20
    v_mad_u32_u24 v8, v14, s38, v8
    v_bfe_u32 v14, v0, 5, 1
    s_mov_b32 s38, 0x100
    v_mad_u32_u24 v8, v14, s38, v8
    v_mov_b32 v10, 0x0
    v_bfe_u32 v14, v0, 0, 1
    s_mov_b32 s38, 0x10
    v_mad_u32_u24 v10, v14, s38, v10
    v_bfe_u32 v14, v0, 1, 1
    s_mov_b32 s38, 0x20
    v_mad_u32_u24 v10, v14, s38, v10
    v_bfe_u32 v14, v0, 2, 1
    s_mov_b32 s38, 0x40
    v_mad_u32_u24 v10, v14, s38, v10
    v_bfe_u32 v14, v0, 3, 1
    s_mov_b32 s38, 0x80
    v_mad_u32_u24 v10, v14, s38, v10
    v_bfe_u32 v14, v0, 4, 1
    s_mov_b32 s38, 0x20000
    v_mad_u32_u24 v10, v14, s38, v10
    v_bfe_u32 v14, v0, 5, 1
    s_mov_b32 s38, 0x40000
    v_mad_u32_u24 v10, v14, s38, v10
    v_bfe_u32 v14, v0, 6, 1
    s_mov_b32 s38, 0x100
    v_mad_u32_u24 v10, v14, s38, v10
    v_bfe_u32 v14, v0, 7, 1
    s_mov_b32 s38, 0x200
    v_mad_u32_u24 v10, v14, s38, v10
    v_mov_b32 v11, 0x0
    v_bfe_u32 v14, v0, 0, 1
    s_mov_b32 s38, 0x10
    v_mad_u32_u24 v11, v14, s38, v11
    v_bfe_u32 v14, v0, 1, 1
    s_mov_b32 s38, 0x20
    v_mad_u32_u24 v11, v14, s38, v11
    v_bfe_u32 v14, v0, 2, 1
    s_mov_b32 s38, 0x40
    v_mad_u32_u24 v11, v14, s38, v11
    v_bfe_u32 v14, v0, 3, 1
    s_mov_b32 s38, 0x80
    v_mad_u32_u24 v11, v14, s38, v11
    v_bfe_u32 v14, v0, 4, 1
    s_mov_b32 s38, 0x400
    v_mad_u32_u24 v11, v14, s38, v11
    v_bfe_u32 v14, v0, 5, 1
    s_mov_b32 s38, 0x800
    v_mad_u32_u24 v11, v14, s38, v11
    v_bfe_u32 v14, v0, 6, 1
    s_mov_b32 s38, 0x100
    v_mad_u32_u24 v11, v14, s38, v11
    v_bfe_u32 v14, v0, 7, 1
    s_mov_b32 s38, 0x200
    v_mad_u32_u24 v11, v14, s38, v11
    v_mov_b32 v12, 0x0
    v_bfe_u32 v14, v0, 0, 1
    s_mov_b32 s38, 0x10
    v_mad_u32_u24 v12, v14, s38, v12
    v_bfe_u32 v14, v0, 1, 1
    s_mov_b32 s38, 0x20
    v_mad_u32_u24 v12, v14, s38, v12
    v_bfe_u32 v14, v0, 2, 1
    s_mov_b32 s38, 0x40
    v_mad_u32_u24 v12, v14, s38, v12
    v_bfe_u32 v14, v0, 3, 1
    s_mov_b32 s38, 0x80
    v_mad_u32_u24 v12, v14, s38, v12
    v_bfe_u32 v14, v0, 4, 1
    s_mov_b32 s38, 0x4
    v_mad_u32_u24 v12, v14, s38, v12
    v_bfe_u32 v14, v0, 5, 1
    s_mov_b32 s38, 0x8
    v_mad_u32_u24 v12, v14, s38, v12
    v_bfe_u32 v14, v0, 6, 1
    s_mov_b32 s38, 0x100
    v_mad_u32_u24 v12, v14, s38, v12
    v_bfe_u32 v14, v0, 7, 1
    s_mov_b32 s38, 0x200
    v_mad_u32_u24 v12, v14, s38, v12
    v_mov_b32 v13, 0xf149f2ca
    v_and_b32 v14, 15, v0
    v_bfe_u32 v15, v0, 4, 2
    v_cmp_gt_u32 s[72:73], 2, v15
    v_lshlrev_b32 v15, 2, v15
    v_cmp_le_u32 s[64:65], v15, v14
    v_add_u32 v15, 1, v15
    v_cmp_le_u32 s[66:67], v15, v14
    v_add_u32 v15, 1, v15
    v_cmp_le_u32 s[68:69], v15, v14
    v_add_u32 v15, 1, v15
    v_cmp_le_u32 s[70:71], v15, v14
    v_add_u32 v15, 1, v15
    s_mov_b32 s34, 0x05040100
    s_mov_b32 s35, 0x07060302
    s_mov_b32 s33, 0x3e0293ee
    s_mov_b32 s32, 0
    s_mov_b32 s4, 0x3f803f80
    s_mov_b32 s5, 0x3f803f80
    s_and_b32 s3, s2, 7
    s_cmp_eq_u32 s3, 7
    s_cbranch_scc1 L_mlp
    s_mov_b32 s96, s54
    s_and_b32 s97, s55, 0xffff
    s_mov_b32 s98, 0x400000
    s_mov_b32 s99, 0x20000
    s_lshl_b32 s3, s20, 17
    s_and_b32 s28, s22, 3
    s_lshl_b32 s28, s28, 15
    s_add_u32 s3, s3, s28
    v_lshlrev_b32 v30, 7, v0
    buffer_load_dword v31, v30, s[96:99], s3 offen
    s_mov_b32 s76, s52
    s_and_b32 s77, s53, 0xffff
    s_mov_b32 s78, 0x400000
    s_mov_b32 s79, 0x20000
    s_mov_b32 s40, s50
    s_and_b32 s41, s51, 0xffff
    s_mov_b32 s42, 0x400000
    s_mov_b32 s43, 0x20000
    s_mov_b32 s96, s48
    s_and_b32 s97, s49, 0xffff
    s_mov_b32 s98, 0x400000
    s_mov_b32 s99, 0x20000
    v_mov_b32 v16, 0x0
    v_bfe_u32 v14, v0, 0, 1
    s_mov_b32 s38, 0x10
    v_mad_u32_u24 v16, v14, s38, v16
    v_bfe_u32 v14, v0, 1, 1
    s_mov_b32 s38, 0x20
    v_mad_u32_u24 v16, v14, s38, v16
    v_bfe_u32 v14, v0, 2, 1
    s_mov_b32 s38, 0x40
    v_mad_u32_u24 v16, v14, s38, v16
    v_bfe_u32 v14, v0, 3, 1
    s_mov_b32 s38, 0x80
    v_mad_u32_u24 v16, v14, s38, v16
    v_bfe_u32 v14, v0, 4, 1
    s_mov_b32 s38, 0x2000
    v_mad_u32_u24 v16, v14, s38, v16
    v_bfe_u32 v14, v0, 5, 1
    s_mov_b32 s38, 0x4000
    v_mad_u32_u24 v16, v14, s38, v16
    v_bfe_u32 v14, v0, 6, 1
    s_mov_b32 s38, 0x40000
    v_mad_u32_u24 v16, v14, s38, v16
    v_bfe_u32 v14, v0, 7, 1
    s_mov_b32 s38, 0x80000
    v_mad_u32_u24 v16, v14, s38, v16
    v_mov_b32 v28, 0x0
    v_bfe_u32 v14, v0, 4, 1
    s_mov_b32 s38, 0x20
    v_mad_u32_u24 v28, v14, s38, v28
    v_bfe_u32 v14, v0, 5, 1
    s_mov_b32 s38, 0x40
    v_mad_u32_u24 v28, v14, s38, v28
    v_xor_b32 v16, v16, v28
    v_xor_b32 v17, 0, v16
    v_xor_b32 v18, 128, v16
    v_xor_b32 v19, 128, v16
    v_mov_b32 v20, 0x0
    v_bfe_u32 v14, v0, 0, 1
    s_mov_b32 s38, 0x8
    v_mad_u32_u24 v20, v14, s38, v20
    v_bfe_u32 v14, v0, 1, 1
    s_mov_b32 s38, 0x10
    v_mad_u32_u24 v20, v14, s38, v20
    v_bfe_u32 v14, v0, 2, 1
    s_mov_b32 s38, 0x100
    v_mad_u32_u24 v20, v14, s38, v20
    v_bfe_u32 v14, v0, 3, 1
    s_mov_b32 s38, 0x200
    v_mad_u32_u24 v20, v14, s38, v20
    v_bfe_u32 v14, v0, 4, 1
    s_mov_b32 s38, 0x800
    v_mad_u32_u24 v20, v14, s38, v20
    v_bfe_u32 v14, v0, 5, 1
    s_mov_b32 s38, 0x1000
    v_mad_u32_u24 v20, v14, s38, v20
    v_mov_b32 v28, 0x0
    v_bfe_u32 v14, v0, 2, 1
    s_mov_b32 s38, 0x20
    v_mad_u32_u24 v28, v14, s38, v28
    v_bfe_u32 v14, v0, 3, 1
    s_mov_b32 s38, 0x40
    v_mad_u32_u24 v28, v14, s38, v28
    v_bfe_u32 v14, v0, 4, 1
    s_mov_b32 s38, 0x80
    v_mad_u32_u24 v28, v14, s38, v28
    v_mov_b32 v29, 0x0
    v_bfe_u32 v14, v0, 6, 1
    s_mov_b32 s38, 0x40
    v_mad_u32_u24 v29, v14, s38, v29
    v_bfe_u32 v14, v0, 7, 1
    s_mov_b32 s38, 0x80
    v_mad_u32_u24 v29, v14, s38, v29
    v_xor_b32 v28, v28, v29
    v_add_u32 v28, v28, v20
    v_add_u32 v20, 0x8000, v28
    v_xor_b32 v21, 32, v20
    v_add_u32 v22, 0x10000, v28
    v_xor_b32 v23, 32, v22
    v_add_u32 v24, 0x18000, v28
    v_xor_b32 v25, 32, v24
    v_add_u32 v26, 0x20000, v28
    v_xor_b32 v27, 32, v26
    s_add_u32 s28, s21, 1
    s_lshl_b32 s28, s28, 15
    s_lshl_b32 s3, s20, 8
    s_add_u32 m0, s28, 0
    s_add_u32 s37, s3, 0x0
    buffer_load_dwordx4 v16, s[76:79], s37 offen lds
    s_add_u32 m0, s28, 1024
    s_add_u32 s37, s3, 0x8000
    buffer_load_dwordx4 v17, s[76:79], s37 offen lds
    s_add_u32 m0, s28, 2048
    s_add_u32 s37, s3, 0x10000
    buffer_load_dwordx4 v18, s[76:79], s37 offen lds
    s_add_u32 m0, s28, 3072
    s_add_u32 s37, s3, 0x18000
    buffer_load_dwordx4 v19, s[76:79], s37 offen lds
    s_add_u32 m0, s28, 4096
    s_add_u32 s37, s3, 0x20000
    buffer_load_dwordx4 v16, s[76:79], s37 offen lds
    s_add_u32 m0, s28, 5120
    s_add_u32 s37, s3, 0x28000
    buffer_load_dwordx4 v17, s[76:79], s37 offen lds
    s_add_u32 m0, s28, 6144
    s_add_u32 s37, s3, 0x30000
    buffer_load_dwordx4 v18, s[76:79], s37 offen lds
    s_add_u32 m0, s28, 7168
    s_add_u32 s37, s3, 0x38000
    buffer_load_dwordx4 v19, s[76:79], s37 offen lds
    s_add_u32 m0, s28, 8192
    s_add_u32 s37, s3, 0x100000
    buffer_load_dwordx4 v16, s[76:79], s37 offen lds
    s_add_u32 m0, s28, 9216
    s_add_u32 s37, s3, 0x108000
    buffer_load_dwordx4 v17, s[76:79], s37 offen lds
    s_add_u32 m0, s28, 10240
    s_add_u32 s37, s3, 0x110000
    buffer_load_dwordx4 v18, s[76:79], s37 offen lds
    s_add_u32 m0, s28, 11264
    s_add_u32 s37, s3, 0x118000
    buffer_load_dwordx4 v19, s[76:79], s37 offen lds
    s_add_u32 m0, s28, 12288
    s_add_u32 s37, s3, 0x120000
    buffer_load_dwordx4 v16, s[76:79], s37 offen lds
    s_add_u32 m0, s28, 13312
    s_add_u32 s37, s3, 0x128000
    buffer_load_dwordx4 v17, s[76:79], s37 offen lds
    s_add_u32 m0, s28, 14336
    s_add_u32 s37, s3, 0x130000
    buffer_load_dwordx4 v18, s[76:79], s37 offen lds
    s_add_u32 m0, s28, 15360
    s_add_u32 s37, s3, 0x138000
    buffer_load_dwordx4 v19, s[76:79], s37 offen lds
    s_add_u32 m0, s28, 16384
    s_add_u32 s37, s3, 0x200000
    buffer_load_dwordx4 v16, s[76:79], s37 offen lds
    s_add_u32 m0, s28, 17408
    s_add_u32 s37, s3, 0x208000
    buffer_load_dwordx4 v17, s[76:79], s37 offen lds
    s_add_u32 m0, s28, 18432
    s_add_u32 s37, s3, 0x210000
    buffer_load_dwordx4 v18, s[76:79], s37 offen lds
    s_add_u32 m0, s28, 19456
    s_add_u32 s37, s3, 0x218000
    buffer_load_dwordx4 v19, s[76:79], s37 offen lds
    s_add_u32 m0, s28, 20480
    s_add_u32 s37, s3, 0x220000
    buffer_load_dwordx4 v16, s[76:79], s37 offen lds
    s_add_u32 m0, s28, 21504
    s_add_u32 s37, s3, 0x228000
    buffer_load_dwordx4 v17, s[76:79], s37 offen lds
    s_add_u32 m0, s28, 22528
    s_add_u32 s37, s3, 0x230000
    buffer_load_dwordx4 v18, s[76:79], s37 offen lds
    s_add_u32 m0, s28, 23552
    s_add_u32 s37, s3, 0x238000
    buffer_load_dwordx4 v19, s[76:79], s37 offen lds
    s_waitcnt vmcnt(16)
    s_barrier
    ds_read_b64_tr_b16 v[128:129], v20 offset:0
    ds_read_b64_tr_b16 v[130:131], v20 offset:1024
    ds_read_b64_tr_b16 v[132:133], v21 offset:0
    ds_read_b64_tr_b16 v[134:135], v21 offset:1024
    ds_read_b64_tr_b16 v[136:137], v22 offset:0
    ds_read_b64_tr_b16 v[138:139], v22 offset:1024
    ds_read_b64_tr_b16 v[140:141], v23 offset:0
    ds_read_b64_tr_b16 v[142:143], v23 offset:1024
    ds_read_b64_tr_b16 v[144:145], v24 offset:0
    ds_read_b64_tr_b16 v[146:147], v24 offset:1024
    ds_read_b64_tr_b16 v[148:149], v25 offset:0
    ds_read_b64_tr_b16 v[150:151], v25 offset:1024
    s_waitcnt lgkmcnt(4)
    ds_read_b64_tr_b16 v[152:153], v26 offset:0
    ds_read_b64_tr_b16 v[154:155], v26 offset:1024
    ds_read_b64_tr_b16 v[156:157], v27 offset:0
    ds_read_b64_tr_b16 v[158:159], v27 offset:1024
    s_waitcnt lgkmcnt(0)
    s_barrier
    s_add_u32 m0, s28, 0
    s_add_u32 s37, s3, 0x300000
    buffer_load_dwordx4 v16, s[76:79], s37 offen lds
    s_add_u32 m0, s28, 1024
    s_add_u32 s37, s3, 0x308000
    buffer_load_dwordx4 v17, s[76:79], s37 offen lds
    s_add_u32 m0, s28, 2048
    s_add_u32 s37, s3, 0x310000
    buffer_load_dwordx4 v18, s[76:79], s37 offen lds
    s_add_u32 m0, s28, 3072
    s_add_u32 s37, s3, 0x318000
    buffer_load_dwordx4 v19, s[76:79], s37 offen lds
    s_add_u32 m0, s28, 4096
    s_add_u32 s37, s3, 0x320000
    buffer_load_dwordx4 v16, s[76:79], s37 offen lds
    s_add_u32 m0, s28, 5120
    s_add_u32 s37, s3, 0x328000
    buffer_load_dwordx4 v17, s[76:79], s37 offen lds
    s_add_u32 m0, s28, 6144
    s_add_u32 s37, s3, 0x330000
    buffer_load_dwordx4 v18, s[76:79], s37 offen lds
    s_add_u32 m0, s28, 7168
    s_add_u32 s37, s3, 0x338000
    buffer_load_dwordx4 v19, s[76:79], s37 offen lds
    s_waitcnt vmcnt(16)
    s_barrier
    ds_read_b64_tr_b16 v[160:161], v20 offset:8192
    ds_read_b64_tr_b16 v[162:163], v20 offset:9216
    ds_read_b64_tr_b16 v[164:165], v21 offset:8192
    ds_read_b64_tr_b16 v[166:167], v21 offset:9216
    ds_read_b64_tr_b16 v[168:169], v22 offset:8192
    ds_read_b64_tr_b16 v[170:171], v22 offset:9216
    ds_read_b64_tr_b16 v[172:173], v23 offset:8192
    ds_read_b64_tr_b16 v[174:175], v23 offset:9216
    ds_read_b64_tr_b16 v[176:177], v24 offset:8192
    ds_read_b64_tr_b16 v[178:179], v24 offset:9216
    ds_read_b64_tr_b16 v[180:181], v25 offset:8192
    ds_read_b64_tr_b16 v[182:183], v25 offset:9216
    s_waitcnt lgkmcnt(4)
    ds_read_b64_tr_b16 v[184:185], v26 offset:8192
    ds_read_b64_tr_b16 v[186:187], v26 offset:9216
    ds_read_b64_tr_b16 v[188:189], v27 offset:8192
    ds_read_b64_tr_b16 v[190:191], v27 offset:9216
    s_waitcnt lgkmcnt(0)
    s_barrier
    s_add_u32 m0, s28, 8192
    s_add_u32 s37, s3, 0x0
    buffer_load_dwordx4 v16, s[40:43], s37 offen lds
    s_add_u32 m0, s28, 9216
    s_add_u32 s37, s3, 0x8000
    buffer_load_dwordx4 v17, s[40:43], s37 offen lds
    s_add_u32 m0, s28, 10240
    s_add_u32 s37, s3, 0x10000
    buffer_load_dwordx4 v18, s[40:43], s37 offen lds
    s_add_u32 m0, s28, 11264
    s_add_u32 s37, s3, 0x18000
    buffer_load_dwordx4 v19, s[40:43], s37 offen lds
    s_add_u32 m0, s28, 12288
    s_add_u32 s37, s3, 0x20000
    buffer_load_dwordx4 v16, s[40:43], s37 offen lds
    s_add_u32 m0, s28, 13312
    s_add_u32 s37, s3, 0x28000
    buffer_load_dwordx4 v17, s[40:43], s37 offen lds
    s_add_u32 m0, s28, 14336
    s_add_u32 s37, s3, 0x30000
    buffer_load_dwordx4 v18, s[40:43], s37 offen lds
    s_add_u32 m0, s28, 15360
    s_add_u32 s37, s3, 0x38000
    buffer_load_dwordx4 v19, s[40:43], s37 offen lds
    s_waitcnt vmcnt(16)
    s_barrier
    ds_read_b64_tr_b16 v[192:193], v20 offset:16384
    ds_read_b64_tr_b16 v[194:195], v20 offset:17408
    ds_read_b64_tr_b16 v[196:197], v21 offset:16384
    ds_read_b64_tr_b16 v[198:199], v21 offset:17408
    ds_read_b64_tr_b16 v[200:201], v22 offset:16384
    ds_read_b64_tr_b16 v[202:203], v22 offset:17408
    ds_read_b64_tr_b16 v[204:205], v23 offset:16384
    ds_read_b64_tr_b16 v[206:207], v23 offset:17408
    ds_read_b64_tr_b16 v[208:209], v24 offset:16384
    ds_read_b64_tr_b16 v[210:211], v24 offset:17408
    ds_read_b64_tr_b16 v[212:213], v25 offset:16384
    ds_read_b64_tr_b16 v[214:215], v25 offset:17408
    s_waitcnt lgkmcnt(4)
    ds_read_b64_tr_b16 v[216:217], v26 offset:16384
    ds_read_b64_tr_b16 v[218:219], v26 offset:17408
    ds_read_b64_tr_b16 v[220:221], v27 offset:16384
    ds_read_b64_tr_b16 v[222:223], v27 offset:17408
    s_waitcnt lgkmcnt(0)
    s_barrier
    s_add_u32 m0, s28, 16384
    s_add_u32 s37, s3, 0x100000
    buffer_load_dwordx4 v16, s[40:43], s37 offen lds
    s_add_u32 m0, s28, 17408
    s_add_u32 s37, s3, 0x108000
    buffer_load_dwordx4 v17, s[40:43], s37 offen lds
    s_add_u32 m0, s28, 18432
    s_add_u32 s37, s3, 0x110000
    buffer_load_dwordx4 v18, s[40:43], s37 offen lds
    s_add_u32 m0, s28, 19456
    s_add_u32 s37, s3, 0x118000
    buffer_load_dwordx4 v19, s[40:43], s37 offen lds
    s_add_u32 m0, s28, 20480
    s_add_u32 s37, s3, 0x120000
    buffer_load_dwordx4 v16, s[40:43], s37 offen lds
    s_add_u32 m0, s28, 21504
    s_add_u32 s37, s3, 0x128000
    buffer_load_dwordx4 v17, s[40:43], s37 offen lds
    s_add_u32 m0, s28, 22528
    s_add_u32 s37, s3, 0x130000
    buffer_load_dwordx4 v18, s[40:43], s37 offen lds
    s_add_u32 m0, s28, 23552
    s_add_u32 s37, s3, 0x138000
    buffer_load_dwordx4 v19, s[40:43], s37 offen lds
    s_waitcnt vmcnt(16)
    s_barrier
    ds_read_b64_tr_b16 v[224:225], v20 offset:0
    ds_read_b64_tr_b16 v[226:227], v20 offset:1024
    ds_read_b64_tr_b16 v[228:229], v21 offset:0
    ds_read_b64_tr_b16 v[230:231], v21 offset:1024
    ds_read_b64_tr_b16 v[232:233], v22 offset:0
    ds_read_b64_tr_b16 v[234:235], v22 offset:1024
    ds_read_b64_tr_b16 v[236:237], v23 offset:0
    ds_read_b64_tr_b16 v[238:239], v23 offset:1024
    ds_read_b64_tr_b16 v[240:241], v24 offset:0
    ds_read_b64_tr_b16 v[242:243], v24 offset:1024
    ds_read_b64_tr_b16 v[244:245], v25 offset:0
    ds_read_b64_tr_b16 v[246:247], v25 offset:1024
    s_waitcnt lgkmcnt(4)
    ds_read_b64_tr_b16 v[248:249], v26 offset:0
    ds_read_b64_tr_b16 v[250:251], v26 offset:1024
    ds_read_b64_tr_b16 v[252:253], v27 offset:0
    ds_read_b64_tr_b16 v[254:255], v27 offset:1024
    s_waitcnt lgkmcnt(0)
    s_barrier
    s_add_u32 m0, s28, 0
    s_add_u32 s37, s3, 0x200000
    buffer_load_dwordx4 v16, s[40:43], s37 offen lds
    s_add_u32 m0, s28, 1024
    s_add_u32 s37, s3, 0x208000
    buffer_load_dwordx4 v17, s[40:43], s37 offen lds
    s_add_u32 m0, s28, 2048
    s_add_u32 s37, s3, 0x210000
    buffer_load_dwordx4 v18, s[40:43], s37 offen lds
    s_add_u32 m0, s28, 3072
    s_add_u32 s37, s3, 0x218000
    buffer_load_dwordx4 v19, s[40:43], s37 offen lds
    s_add_u32 m0, s28, 4096
    s_add_u32 s37, s3, 0x220000
    buffer_load_dwordx4 v16, s[40:43], s37 offen lds
    s_add_u32 m0, s28, 5120
    s_add_u32 s37, s3, 0x228000
    buffer_load_dwordx4 v17, s[40:43], s37 offen lds
    s_add_u32 m0, s28, 6144
    s_add_u32 s37, s3, 0x230000
    buffer_load_dwordx4 v18, s[40:43], s37 offen lds
    s_add_u32 m0, s28, 7168
    s_add_u32 s37, s3, 0x238000
    buffer_load_dwordx4 v19, s[40:43], s37 offen lds
    s_waitcnt vmcnt(16)
    s_barrier
    ds_read_b64_tr_b16 a[128:129], v20 offset:8192
    ds_read_b64_tr_b16 a[130:131], v20 offset:9216
    ds_read_b64_tr_b16 a[132:133], v21 offset:8192
    ds_read_b64_tr_b16 a[134:135], v21 offset:9216
    ds_read_b64_tr_b16 a[136:137], v22 offset:8192
    ds_read_b64_tr_b16 a[138:139], v22 offset:9216
    ds_read_b64_tr_b16 a[140:141], v23 offset:8192
    ds_read_b64_tr_b16 a[142:143], v23 offset:9216
    ds_read_b64_tr_b16 a[144:145], v24 offset:8192
    ds_read_b64_tr_b16 a[146:147], v24 offset:9216
    ds_read_b64_tr_b16 a[148:149], v25 offset:8192
    ds_read_b64_tr_b16 a[150:151], v25 offset:9216
    s_waitcnt lgkmcnt(4)
    ds_read_b64_tr_b16 a[152:153], v26 offset:8192
    ds_read_b64_tr_b16 a[154:155], v26 offset:9216
    ds_read_b64_tr_b16 a[156:157], v27 offset:8192
    ds_read_b64_tr_b16 a[158:159], v27 offset:9216
    s_waitcnt lgkmcnt(0)
    s_barrier
    s_add_u32 m0, s28, 8192
    s_add_u32 s37, s3, 0x300000
    buffer_load_dwordx4 v16, s[40:43], s37 offen lds
    s_add_u32 m0, s28, 9216
    s_add_u32 s37, s3, 0x308000
    buffer_load_dwordx4 v17, s[40:43], s37 offen lds
    s_add_u32 m0, s28, 10240
    s_add_u32 s37, s3, 0x310000
    buffer_load_dwordx4 v18, s[40:43], s37 offen lds
    s_add_u32 m0, s28, 11264
    s_add_u32 s37, s3, 0x318000
    buffer_load_dwordx4 v19, s[40:43], s37 offen lds
    s_add_u32 m0, s28, 12288
    s_add_u32 s37, s3, 0x320000
    buffer_load_dwordx4 v16, s[40:43], s37 offen lds
    s_add_u32 m0, s28, 13312
    s_add_u32 s37, s3, 0x328000
    buffer_load_dwordx4 v17, s[40:43], s37 offen lds
    s_add_u32 m0, s28, 14336
    s_add_u32 s37, s3, 0x330000
    buffer_load_dwordx4 v18, s[40:43], s37 offen lds
    s_add_u32 m0, s28, 15360
    s_add_u32 s37, s3, 0x338000
    buffer_load_dwordx4 v19, s[40:43], s37 offen lds
    s_waitcnt vmcnt(16)
    s_barrier
    ds_read_b64_tr_b16 a[160:161], v20 offset:16384
    ds_read_b64_tr_b16 a[162:163], v20 offset:17408
    ds_read_b64_tr_b16 a[164:165], v21 offset:16384
    ds_read_b64_tr_b16 a[166:167], v21 offset:17408
    ds_read_b64_tr_b16 a[168:169], v22 offset:16384
    ds_read_b64_tr_b16 a[170:171], v22 offset:17408
    ds_read_b64_tr_b16 a[172:173], v23 offset:16384
    ds_read_b64_tr_b16 a[174:175], v23 offset:17408
    ds_read_b64_tr_b16 a[176:177], v24 offset:16384
    ds_read_b64_tr_b16 a[178:179], v24 offset:17408
    ds_read_b64_tr_b16 a[180:181], v25 offset:16384
    ds_read_b64_tr_b16 a[182:183], v25 offset:17408
    s_waitcnt lgkmcnt(4)
    ds_read_b64_tr_b16 a[184:185], v26 offset:16384
    ds_read_b64_tr_b16 a[186:187], v26 offset:17408
    ds_read_b64_tr_b16 a[188:189], v27 offset:16384
    ds_read_b64_tr_b16 a[190:191], v27 offset:17408
    s_waitcnt lgkmcnt(0)
    s_barrier
    s_add_u32 m0, s28, 16384
    s_add_u32 s37, s3, 0x0
    buffer_load_dwordx4 v16, s[96:99], s37 offen lds
    s_add_u32 m0, s28, 17408
    s_add_u32 s37, s3, 0x8000
    buffer_load_dwordx4 v17, s[96:99], s37 offen lds
    s_add_u32 m0, s28, 18432
    s_add_u32 s37, s3, 0x10000
    buffer_load_dwordx4 v18, s[96:99], s37 offen lds
    s_add_u32 m0, s28, 19456
    s_add_u32 s37, s3, 0x18000
    buffer_load_dwordx4 v19, s[96:99], s37 offen lds
    s_add_u32 m0, s28, 20480
    s_add_u32 s37, s3, 0x20000
    buffer_load_dwordx4 v16, s[96:99], s37 offen lds
    s_add_u32 m0, s28, 21504
    s_add_u32 s37, s3, 0x28000
    buffer_load_dwordx4 v17, s[96:99], s37 offen lds
    s_add_u32 m0, s28, 22528
    s_add_u32 s37, s3, 0x30000
    buffer_load_dwordx4 v18, s[96:99], s37 offen lds
    s_add_u32 m0, s28, 23552
    s_add_u32 s37, s3, 0x38000
    buffer_load_dwordx4 v19, s[96:99], s37 offen lds
    s_waitcnt vmcnt(16)
    s_barrier
    ds_read_b64_tr_b16 a[192:193], v20 offset:0
    ds_read_b64_tr_b16 a[194:195], v20 offset:1024
    ds_read_b64_tr_b16 a[196:197], v21 offset:0
    ds_read_b64_tr_b16 a[198:199], v21 offset:1024
    ds_read_b64_tr_b16 a[200:201], v22 offset:0
    ds_read_b64_tr_b16 a[202:203], v22 offset:1024
    ds_read_b64_tr_b16 a[204:205], v23 offset:0
    ds_read_b64_tr_b16 a[206:207], v23 offset:1024
    ds_read_b64_tr_b16 a[208:209], v24 offset:0
    ds_read_b64_tr_b16 a[210:211], v24 offset:1024
    ds_read_b64_tr_b16 a[212:213], v25 offset:0
    ds_read_b64_tr_b16 a[214:215], v25 offset:1024
    s_waitcnt lgkmcnt(4)
    ds_read_b64_tr_b16 a[216:217], v26 offset:0
    ds_read_b64_tr_b16 a[218:219], v26 offset:1024
    ds_read_b64_tr_b16 a[220:221], v27 offset:0
    ds_read_b64_tr_b16 a[222:223], v27 offset:1024
    s_waitcnt lgkmcnt(0)
    s_barrier
    s_add_u32 m0, s28, 0
    s_add_u32 s37, s3, 0x100000
    buffer_load_dwordx4 v16, s[96:99], s37 offen lds
    s_add_u32 m0, s28, 1024
    s_add_u32 s37, s3, 0x108000
    buffer_load_dwordx4 v17, s[96:99], s37 offen lds
    s_add_u32 m0, s28, 2048
    s_add_u32 s37, s3, 0x110000
    buffer_load_dwordx4 v18, s[96:99], s37 offen lds
    s_add_u32 m0, s28, 3072
    s_add_u32 s37, s3, 0x118000
    buffer_load_dwordx4 v19, s[96:99], s37 offen lds
    s_add_u32 m0, s28, 4096
    s_add_u32 s37, s3, 0x120000
    buffer_load_dwordx4 v16, s[96:99], s37 offen lds
    s_add_u32 m0, s28, 5120
    s_add_u32 s37, s3, 0x128000
    buffer_load_dwordx4 v17, s[96:99], s37 offen lds
    s_add_u32 m0, s28, 6144
    s_add_u32 s37, s3, 0x130000
    buffer_load_dwordx4 v18, s[96:99], s37 offen lds
    s_add_u32 m0, s28, 7168
    s_add_u32 s37, s3, 0x138000
    buffer_load_dwordx4 v19, s[96:99], s37 offen lds
    s_waitcnt vmcnt(16)
    s_barrier
    ds_read_b64_tr_b16 a[224:225], v20 offset:8192
    ds_read_b64_tr_b16 a[226:227], v20 offset:9216
    ds_read_b64_tr_b16 a[228:229], v21 offset:8192
    ds_read_b64_tr_b16 a[230:231], v21 offset:9216
    ds_read_b64_tr_b16 a[232:233], v22 offset:8192
    ds_read_b64_tr_b16 a[234:235], v22 offset:9216
    ds_read_b64_tr_b16 a[236:237], v23 offset:8192
    ds_read_b64_tr_b16 a[238:239], v23 offset:9216
    ds_read_b64_tr_b16 a[240:241], v24 offset:8192
    ds_read_b64_tr_b16 a[242:243], v24 offset:9216
    ds_read_b64_tr_b16 a[244:245], v25 offset:8192
    ds_read_b64_tr_b16 a[246:247], v25 offset:9216
    s_waitcnt lgkmcnt(4)
    ds_read_b64_tr_b16 a[248:249], v26 offset:8192
    ds_read_b64_tr_b16 a[250:251], v26 offset:9216
    ds_read_b64_tr_b16 a[252:253], v27 offset:8192
    ds_read_b64_tr_b16 a[254:255], v27 offset:9216
    s_waitcnt lgkmcnt(0)
    s_barrier
    s_add_u32 m0, s28, 8192
    s_add_u32 s37, s3, 0x200000
    buffer_load_dwordx4 v16, s[96:99], s37 offen lds
    s_add_u32 m0, s28, 9216
    s_add_u32 s37, s3, 0x208000
    buffer_load_dwordx4 v17, s[96:99], s37 offen lds
    s_add_u32 m0, s28, 10240
    s_add_u32 s37, s3, 0x210000
    buffer_load_dwordx4 v18, s[96:99], s37 offen lds
    s_add_u32 m0, s28, 11264
    s_add_u32 s37, s3, 0x218000
    buffer_load_dwordx4 v19, s[96:99], s37 offen lds
    s_add_u32 m0, s28, 12288
    s_add_u32 s37, s3, 0x220000
    buffer_load_dwordx4 v16, s[96:99], s37 offen lds
    s_add_u32 m0, s28, 13312
    s_add_u32 s37, s3, 0x228000
    buffer_load_dwordx4 v17, s[96:99], s37 offen lds
    s_add_u32 m0, s28, 14336
    s_add_u32 s37, s3, 0x230000
    buffer_load_dwordx4 v18, s[96:99], s37 offen lds
    s_add_u32 m0, s28, 15360
    s_add_u32 s37, s3, 0x238000
    buffer_load_dwordx4 v19, s[96:99], s37 offen lds
    s_waitcnt vmcnt(16)
    s_barrier
    ds_read_b64_tr_b16 a[0:1], v20 offset:16384
    ds_read_b64_tr_b16 a[2:3], v20 offset:17408
    ds_read_b64_tr_b16 a[4:5], v21 offset:16384
    ds_read_b64_tr_b16 a[6:7], v21 offset:17408
    ds_read_b64_tr_b16 a[8:9], v22 offset:16384
    ds_read_b64_tr_b16 a[10:11], v22 offset:17408
    ds_read_b64_tr_b16 a[12:13], v23 offset:16384
    ds_read_b64_tr_b16 a[14:15], v23 offset:17408
    ds_read_b64_tr_b16 a[16:17], v24 offset:16384
    ds_read_b64_tr_b16 a[18:19], v24 offset:17408
    ds_read_b64_tr_b16 a[20:21], v25 offset:16384
    ds_read_b64_tr_b16 a[22:23], v25 offset:17408
    s_waitcnt lgkmcnt(4)
    ds_read_b64_tr_b16 a[24:25], v26 offset:16384
    ds_read_b64_tr_b16 a[26:27], v26 offset:17408
    ds_read_b64_tr_b16 a[28:29], v27 offset:16384
    ds_read_b64_tr_b16 a[30:31], v27 offset:17408
    s_waitcnt lgkmcnt(0)
    s_barrier
    s_add_u32 m0, s28, 16384
    s_add_u32 s37, s3, 0x300000
    buffer_load_dwordx4 v16, s[96:99], s37 offen lds
    s_add_u32 m0, s28, 17408
    s_add_u32 s37, s3, 0x308000
    buffer_load_dwordx4 v17, s[96:99], s37 offen lds
    s_add_u32 m0, s28, 18432
    s_add_u32 s37, s3, 0x310000
    buffer_load_dwordx4 v18, s[96:99], s37 offen lds
    s_add_u32 m0, s28, 19456
    s_add_u32 s37, s3, 0x318000
    buffer_load_dwordx4 v19, s[96:99], s37 offen lds
    s_add_u32 m0, s28, 20480
    s_add_u32 s37, s3, 0x320000
    buffer_load_dwordx4 v16, s[96:99], s37 offen lds
    s_add_u32 m0, s28, 21504
    s_add_u32 s37, s3, 0x328000
    buffer_load_dwordx4 v17, s[96:99], s37 offen lds
    s_add_u32 m0, s28, 22528
    s_add_u32 s37, s3, 0x330000
    buffer_load_dwordx4 v18, s[96:99], s37 offen lds
    s_add_u32 m0, s28, 23552
    s_add_u32 s37, s3, 0x338000
    buffer_load_dwordx4 v19, s[96:99], s37 offen lds
    s_waitcnt vmcnt(16)
    s_barrier
    ds_read_b64_tr_b16 a[32:33], v20 offset:0
    ds_read_b64_tr_b16 a[34:35], v20 offset:1024
    ds_read_b64_tr_b16 a[36:37], v21 offset:0
    ds_read_b64_tr_b16 a[38:39], v21 offset:1024
    ds_read_b64_tr_b16 a[40:41], v22 offset:0
    ds_read_b64_tr_b16 a[42:43], v22 offset:1024
    ds_read_b64_tr_b16 a[44:45], v23 offset:0
    ds_read_b64_tr_b16 a[46:47], v23 offset:1024
    ds_read_b64_tr_b16 a[48:49], v24 offset:0
    ds_read_b64_tr_b16 a[50:51], v24 offset:1024
    ds_read_b64_tr_b16 a[52:53], v25 offset:0
    ds_read_b64_tr_b16 a[54:55], v25 offset:1024
    s_waitcnt lgkmcnt(4)
    ds_read_b64_tr_b16 a[56:57], v26 offset:0
    ds_read_b64_tr_b16 a[58:59], v26 offset:1024
    ds_read_b64_tr_b16 a[60:61], v27 offset:0
    ds_read_b64_tr_b16 a[62:63], v27 offset:1024
    s_waitcnt lgkmcnt(0)
    s_barrier
    s_waitcnt vmcnt(8)
    s_barrier
    ds_read_b64_tr_b16 a[64:65], v20 offset:8192
    ds_read_b64_tr_b16 a[66:67], v20 offset:9216
    ds_read_b64_tr_b16 a[68:69], v21 offset:8192
    ds_read_b64_tr_b16 a[70:71], v21 offset:9216
    ds_read_b64_tr_b16 a[72:73], v22 offset:8192
    ds_read_b64_tr_b16 a[74:75], v22 offset:9216
    ds_read_b64_tr_b16 a[76:77], v23 offset:8192
    ds_read_b64_tr_b16 a[78:79], v23 offset:9216
    ds_read_b64_tr_b16 a[80:81], v24 offset:8192
    ds_read_b64_tr_b16 a[82:83], v24 offset:9216
    ds_read_b64_tr_b16 a[84:85], v25 offset:8192
    ds_read_b64_tr_b16 a[86:87], v25 offset:9216
    s_waitcnt lgkmcnt(4)
    ds_read_b64_tr_b16 a[88:89], v26 offset:8192
    ds_read_b64_tr_b16 a[90:91], v26 offset:9216
    ds_read_b64_tr_b16 a[92:93], v27 offset:8192
    ds_read_b64_tr_b16 a[94:95], v27 offset:9216
    s_waitcnt lgkmcnt(0)
    s_barrier
    s_waitcnt vmcnt(0)
    s_barrier
    ds_read_b64_tr_b16 a[96:97], v20 offset:16384
    ds_read_b64_tr_b16 a[98:99], v20 offset:17408
    ds_read_b64_tr_b16 a[100:101], v21 offset:16384
    ds_read_b64_tr_b16 a[102:103], v21 offset:17408
    ds_read_b64_tr_b16 a[104:105], v22 offset:16384
    ds_read_b64_tr_b16 a[106:107], v22 offset:17408
    ds_read_b64_tr_b16 a[108:109], v23 offset:16384
    ds_read_b64_tr_b16 a[110:111], v23 offset:17408
    ds_read_b64_tr_b16 a[112:113], v24 offset:16384
    ds_read_b64_tr_b16 a[114:115], v24 offset:17408
    ds_read_b64_tr_b16 a[116:117], v25 offset:16384
    ds_read_b64_tr_b16 a[118:119], v25 offset:17408
    s_waitcnt lgkmcnt(4)
    ds_read_b64_tr_b16 a[120:121], v26 offset:16384
    ds_read_b64_tr_b16 a[122:123], v26 offset:17408
    ds_read_b64_tr_b16 a[124:125], v27 offset:16384
    ds_read_b64_tr_b16 a[126:127], v27 offset:17408
    s_waitcnt lgkmcnt(0)
    s_barrier
    v_lshrrev_b32 v15, 2, v1
    v_and_b32 v15, 127, v15
L_WHS:
    buffer_load_dword v14, v15, s[16:19], 0 offen offset:128 sc1
    s_add_u32 s32, s32, 1
    s_cmp_gt_u32 s32, 200000
    s_cbranch_scc1 L_WHS_done
    s_waitcnt vmcnt(0)
    v_cmp_eq_u32 vcc, 0, v14
    s_cbranch_vccnz L_WHS
L_WHS_done:
    v_lshrrev_b32 v15, 2, v1
    s_mov_b32 s24, 0x192400
L_XNW:
    buffer_load_dword v14, v15, s[8:11], s24 offen sc1
    s_add_u32 s32, s32, 1
    s_cmp_gt_u32 s32, 200000
    s_waitcnt vmcnt(0)
    s_cbranch_scc1 L_XNW_ok
    v_cmp_eq_u32 vcc, 0, v14
    s_cbranch_vccnz L_XNW
L_XNW_ok:
    s_lshr_b32 s36, s21, 1
    s_lshl_b32 s36, s36, 14
    s_xor_b32 s37, s36, 16384
    v_add_u32 v80, s36, v5
    v_add_u32 v81, s37, v5
    v_add_u32 v82, s36, v6
    v_add_u32 v83, s37, v6
    s_mov_b32 s25, 0x40000000
    s_mov_b32 s28, 0
    s_mov_b32 s23, s22
    s_lshl_b32 s36, s23, 15
    s_add_u32 s36, s36, 0x800000
    s_lshl_b32 s37, s21, 10
    s_add_u32 s37, s37, s28
    s_add_u32 m0, s37, 0
    s_add_u32 s38, s36, 0
    buffer_load_dwordx4 v9, s[8:11], s38 offen sc1 lds
    s_add_u32 m0, s37, 4096
    s_add_u32 s38, s36, 4096
    buffer_load_dwordx4 v9, s[8:11], s38 offen sc1 lds
    s_add_u32 m0, s37, 8192
    s_add_u32 s38, s36, 8192
    buffer_load_dwordx4 v9, s[8:11], s38 offen sc1 lds
    s_add_u32 m0, s37, 12288
    s_add_u32 s38, s36, 12288
    buffer_load_dwordx4 v9, s[8:11], s38 offen sc1 lds
    s_add_u32 m0, s37, 16384
    s_add_u32 s38, s36, 16384
    buffer_load_dwordx4 v9, s[8:11], s38 offen sc1 lds
    s_add_u32 m0, s37, 20480
    s_add_u32 s38, s36, 20480
    buffer_load_dwordx4 v9, s[8:11], s38 offen sc1 lds
    s_add_u32 m0, s37, 24576
    s_add_u32 s38, s36, 24576
    buffer_load_dwordx4 v9, s[8:11], s38 offen sc1 lds
    s_add_u32 m0, s37, 28672
    s_add_u32 s38, s36, 28672
    buffer_load_dwordx4 v9, s[8:11], s38 offen sc1 lds
    s_waitcnt vmcnt(0)
L_P1:
    s_waitcnt vmcnt(6)
    s_barrier
    s_xor_b32 s28, s28, 32768
    s_add_u32 s24, s23, 6
    s_min_u32 s24, s24, 63
    s_lshl_b32 s36, s24, 15
    s_add_u32 s36, s36, 0x800000
    s_lshl_b32 s37, s21, 10
    s_add_u32 s37, s37, s28
    s_add_u32 m0, s37, 0
    s_add_u32 s38, s36, 0
    buffer_load_dwordx4 v9, s[8:11], s38 offen sc1 lds
    s_add_u32 m0, s37, 4096
    s_add_u32 s38, s36, 4096
    buffer_load_dwordx4 v9, s[8:11], s38 offen sc1 lds
    s_add_u32 m0, s37, 8192
    s_add_u32 s38, s36, 8192
    buffer_load_dwordx4 v9, s[8:11], s38 offen sc1 lds
    s_add_u32 m0, s37, 12288
    s_add_u32 s38, s36, 12288
    buffer_load_dwordx4 v9, s[8:11], s38 offen sc1 lds
    s_add_u32 m0, s37, 16384
    s_add_u32 s38, s36, 16384
    buffer_load_dwordx4 v9, s[8:11], s38 offen sc1 lds
    s_add_u32 m0, s37, 20480
    s_add_u32 s38, s36, 20480
    buffer_load_dwordx4 v9, s[8:11], s38 offen sc1 lds
    s_add_u32 m0, s37, 24576
    s_add_u32 s38, s36, 24576
    buffer_load_dwordx4 v9, s[8:11], s38 offen sc1 lds
    s_add_u32 m0, s37, 28672
    s_add_u32 s38, s36, 28672
    buffer_load_dwordx4 v9, s[8:11], s38 offen sc1 lds
    ds_read_b128 v[64:67], v80 offset:0
    ds_read_b128 v[68:71], v81 offset:0
    ds_read_b128 v[72:75], v82 offset:1024
    ds_read_b128 v[76:79], v83 offset:1024
    s_waitcnt lgkmcnt(2)
    v_mfma_f32_16x16x32_bf16 v[32:35], a[128:131], v[64:67], 0
    v_mfma_f32_16x16x32_bf16 v[36:39], a[128:131], v[68:71], 0
    v_mfma_f32_16x16x32_bf16 v[40:43], a[132:135], v[64:67], 0
    v_mfma_f32_16x16x32_bf16 v[44:47], a[132:135], v[68:71], 0
    v_mfma_f32_16x16x32_bf16 v[48:51], v[64:67], v[128:131], 0
    v_mfma_f32_16x16x32_bf16 v[56:59], v[68:71], v[128:131], 0
    v_mfma_f32_16x16x32_bf16 v[52:55], v[64:67], v[132:135], 0
    v_mfma_f32_16x16x32_bf16 v[60:63], v[68:71], v[132:135], 0
    v_mfma_f32_16x16x32_bf16 v[16:19], a[0:3], v[64:67], 0
    v_mfma_f32_16x16x32_bf16 v[20:23], a[0:3], v[68:71], 0
    v_mfma_f32_16x16x32_bf16 v[24:27], a[4:7], v[64:67], 0
    v_mfma_f32_16x16x32_bf16 v[28:31], a[4:7], v[68:71], 0
    ds_read_b128 v[64:67], v80 offset:2048
    ds_read_b128 v[68:71], v81 offset:2048
    s_waitcnt lgkmcnt(2)
    v_mfma_f32_16x16x32_bf16 v[32:35], a[136:139], v[72:75], v[32:35]
    v_mfma_f32_16x16x32_bf16 v[36:39], a[136:139], v[76:79], v[36:39]
    v_mfma_f32_16x16x32_bf16 v[40:43], a[140:143], v[72:75], v[40:43]
    v_mfma_f32_16x16x32_bf16 v[44:47], a[140:143], v[76:79], v[44:47]
    v_mfma_f32_16x16x32_bf16 v[48:51], v[72:75], v[136:139], v[48:51]
    v_mfma_f32_16x16x32_bf16 v[56:59], v[76:79], v[136:139], v[56:59]
    v_mfma_f32_16x16x32_bf16 v[52:55], v[72:75], v[140:143], v[52:55]
    v_mfma_f32_16x16x32_bf16 v[60:63], v[76:79], v[140:143], v[60:63]
    v_mfma_f32_16x16x32_bf16 v[16:19], a[8:11], v[72:75], v[16:19]
    v_mfma_f32_16x16x32_bf16 v[20:23], a[8:11], v[76:79], v[20:23]
    v_mfma_f32_16x16x32_bf16 v[24:27], a[12:15], v[72:75], v[24:27]
    v_mfma_f32_16x16x32_bf16 v[28:31], a[12:15], v[76:79], v[28:31]
    ds_read_b128 v[72:75], v82 offset:3072
    ds_read_b128 v[76:79], v83 offset:3072
    s_waitcnt lgkmcnt(2)
    v_mfma_f32_16x16x32_bf16 v[32:35], a[144:147], v[64:67], v[32:35]
    v_mfma_f32_16x16x32_bf16 v[36:39], a[144:147], v[68:71], v[36:39]
    v_mfma_f32_16x16x32_bf16 v[40:43], a[148:151], v[64:67], v[40:43]
    v_mfma_f32_16x16x32_bf16 v[44:47], a[148:151], v[68:71], v[44:47]
    v_mfma_f32_16x16x32_bf16 v[48:51], v[64:67], v[144:147], v[48:51]
    v_mfma_f32_16x16x32_bf16 v[56:59], v[68:71], v[144:147], v[56:59]
    v_mfma_f32_16x16x32_bf16 v[52:55], v[64:67], v[148:151], v[52:55]
    v_mfma_f32_16x16x32_bf16 v[60:63], v[68:71], v[148:151], v[60:63]
    v_mfma_f32_16x16x32_bf16 v[16:19], a[16:19], v[64:67], v[16:19]
    v_mfma_f32_16x16x32_bf16 v[20:23], a[16:19], v[68:71], v[20:23]
    v_mfma_f32_16x16x32_bf16 v[24:27], a[20:23], v[64:67], v[24:27]
    v_mfma_f32_16x16x32_bf16 v[28:31], a[20:23], v[68:71], v[28:31]
    ds_read_b128 v[64:67], v80 offset:4096
    ds_read_b128 v[68:71], v81 offset:4096
    s_waitcnt lgkmcnt(2)
    v_mfma_f32_16x16x32_bf16 v[32:35], a[152:155], v[72:75], v[32:35]
    v_mfma_f32_16x16x32_bf16 v[36:39], a[152:155], v[76:79], v[36:39]
    v_mfma_f32_16x16x32_bf16 v[40:43], a[156:159], v[72:75], v[40:43]
    v_mfma_f32_16x16x32_bf16 v[44:47], a[156:159], v[76:79], v[44:47]
    v_mfma_f32_16x16x32_bf16 v[48:51], v[72:75], v[152:155], v[48:51]
    v_mfma_f32_16x16x32_bf16 v[56:59], v[76:79], v[152:155], v[56:59]
    v_mfma_f32_16x16x32_bf16 v[52:55], v[72:75], v[156:159], v[52:55]
    v_mfma_f32_16x16x32_bf16 v[60:63], v[76:79], v[156:159], v[60:63]
    v_mfma_f32_16x16x32_bf16 v[16:19], a[24:27], v[72:75], v[16:19]
    v_mfma_f32_16x16x32_bf16 v[20:23], a[24:27], v[76:79], v[20:23]
    v_mfma_f32_16x16x32_bf16 v[24:27], a[28:31], v[72:75], v[24:27]
    v_mfma_f32_16x16x32_bf16 v[28:31], a[28:31], v[76:79], v[28:31]
    ds_read_b128 v[72:75], v82 offset:5120
    ds_read_b128 v[76:79], v83 offset:5120
    s_waitcnt lgkmcnt(2)
    v_mfma_f32_16x16x32_bf16 v[32:35], a[160:163], v[64:67], v[32:35]
    v_mfma_f32_16x16x32_bf16 v[36:39], a[160:163], v[68:71], v[36:39]
    v_mfma_f32_16x16x32_bf16 v[40:43], a[164:167], v[64:67], v[40:43]
    v_mfma_f32_16x16x32_bf16 v[44:47], a[164:167], v[68:71], v[44:47]
    v_mfma_f32_16x16x32_bf16 v[48:51], v[64:67], v[160:163], v[48:51]
    v_mfma_f32_16x16x32_bf16 v[56:59], v[68:71], v[160:163], v[56:59]
    v_mfma_f32_16x16x32_bf16 v[52:55], v[64:67], v[164:167], v[52:55]
    v_mfma_f32_16x16x32_bf16 v[60:63], v[68:71], v[164:167], v[60:63]
    v_mfma_f32_16x16x32_bf16 v[16:19], a[32:35], v[64:67], v[16:19]
    v_mfma_f32_16x16x32_bf16 v[20:23], a[32:35], v[68:71], v[20:23]
    v_mfma_f32_16x16x32_bf16 v[24:27], a[36:39], v[64:67], v[24:27]
    v_mfma_f32_16x16x32_bf16 v[28:31], a[36:39], v[68:71], v[28:31]
    ds_read_b128 v[64:67], v80 offset:6144
    ds_read_b128 v[68:71], v81 offset:6144
    s_waitcnt lgkmcnt(2)
    v_mfma_f32_16x16x32_bf16 v[32:35], a[168:171], v[72:75], v[32:35]
    v_mfma_f32_16x16x32_bf16 v[36:39], a[168:171], v[76:79], v[36:39]
    v_mfma_f32_16x16x32_bf16 v[40:43], a[172:175], v[72:75], v[40:43]
    v_mfma_f32_16x16x32_bf16 v[44:47], a[172:175], v[76:79], v[44:47]
    v_mfma_f32_16x16x32_bf16 v[48:51], v[72:75], v[168:171], v[48:51]
    v_mfma_f32_16x16x32_bf16 v[56:59], v[76:79], v[168:171], v[56:59]
    v_mfma_f32_16x16x32_bf16 v[52:55], v[72:75], v[172:175], v[52:55]
    v_mfma_f32_16x16x32_bf16 v[60:63], v[76:79], v[172:175], v[60:63]
    v_mfma_f32_16x16x32_bf16 v[16:19], a[40:43], v[72:75], v[16:19]
    v_mfma_f32_16x16x32_bf16 v[20:23], a[40:43], v[76:79], v[20:23]
    v_mfma_f32_16x16x32_bf16 v[24:27], a[44:47], v[72:75], v[24:27]
    v_mfma_f32_16x16x32_bf16 v[28:31], a[44:47], v[76:79], v[28:31]
    ds_read_b128 v[72:75], v82 offset:7168
    ds_read_b128 v[76:79], v83 offset:7168
    s_waitcnt lgkmcnt(2)
    v_mfma_f32_16x16x32_bf16 v[32:35], a[176:179], v[64:67], v[32:35]
    v_mfma_f32_16x16x32_bf16 v[36:39], a[176:179], v[68:71], v[36:39]
    v_mfma_f32_16x16x32_bf16 v[40:43], a[180:183], v[64:67], v[40:43]
    v_mfma_f32_16x16x32_bf16 v[44:47], a[180:183], v[68:71], v[44:47]
    v_mfma_f32_16x16x32_bf16 v[48:51], v[64:67], v[176:179], v[48:51]
    v_mfma_f32_16x16x32_bf16 v[56:59], v[68:71], v[176:179], v[56:59]
    v_mfma_f32_16x16x32_bf16 v[52:55], v[64:67], v[180:183], v[52:55]
    v_mfma_f32_16x16x32_bf16 v[60:63], v[68:71], v[180:183], v[60:63]
    v_mfma_f32_16x16x32_bf16 v[16:19], a[48:51], v[64:67], v[16:19]
    v_mfma_f32_16x16x32_bf16 v[20:23], a[48:51], v[68:71], v[20:23]
    v_mfma_f32_16x16x32_bf16 v[24:27], a[52:55], v[64:67], v[24:27]
    v_mfma_f32_16x16x32_bf16 v[28:31], a[52:55], v[68:71], v[28:31]
    ds_read_b128 v[64:67], v80 offset:8192
    ds_read_b128 v[68:71], v81 offset:8192
    s_waitcnt lgkmcnt(2)
    v_mfma_f32_16x16x32_bf16 v[32:35], a[184:187], v[72:75], v[32:35]
    v_mfma_f32_16x16x32_bf16 v[36:39], a[184:187], v[76:79], v[36:39]
    v_mfma_f32_16x16x32_bf16 v[40:43], a[188:191], v[72:75], v[40:43]
    v_mfma_f32_16x16x32_bf16 v[44:47], a[188:191], v[76:79], v[44:47]
    v_mfma_f32_16x16x32_bf16 v[48:51], v[72:75], v[184:187], v[48:51]
    v_mfma_f32_16x16x32_bf16 v[56:59], v[76:79], v[184:187], v[56:59]
    v_mfma_f32_16x16x32_bf16 v[52:55], v[72:75], v[188:191], v[52:55]
    v_mfma_f32_16x16x32_bf16 v[60:63], v[76:79], v[188:191], v[60:63]
    v_mfma_f32_16x16x32_bf16 v[16:19], a[56:59], v[72:75], v[16:19]
    v_mfma_f32_16x16x32_bf16 v[20:23], a[56:59], v[76:79], v[20:23]
    v_mfma_f32_16x16x32_bf16 v[24:27], a[60:63], v[72:75], v[24:27]
    v_mfma_f32_16x16x32_bf16 v[28:31], a[60:63], v[76:79], v[28:31]
    ds_read_b128 v[72:75], v82 offset:9216
    ds_read_b128 v[76:79], v83 offset:9216
    s_waitcnt lgkmcnt(2)
    s_waitcnt vmcnt(8)
    s_barrier
    v_cmp_ne_u32 vcc, 0, v0
    v_mov_b32 v15, 0x40000000
    v_mov_b32 v14, 1
    v_cndmask_b32 v15, v0, v15, vcc
    buffer_store_dword v14, v15, s[8:11], s25 offen sc1
    v_mfma_f32_16x16x32_bf16 v[32:35], a[192:195], v[64:67], v[32:35]
    v_mfma_f32_16x16x32_bf16 v[36:39], a[192:195], v[68:71], v[36:39]
    v_mfma_f32_16x16x32_bf16 v[40:43], a[196:199], v[64:67], v[40:43]
    v_mfma_f32_16x16x32_bf16 v[44:47], a[196:199], v[68:71], v[44:47]
    v_mfma_f32_16x16x32_bf16 v[48:51], v[64:67], v[192:195], v[48:51]
    v_mfma_f32_16x16x32_bf16 v[56:59], v[68:71], v[192:195], v[56:59]
    v_mfma_f32_16x16x32_bf16 v[52:55], v[64:67], v[196:199], v[52:55]
    v_mfma_f32_16x16x32_bf16 v[60:63], v[68:71], v[196:199], v[60:63]
    v_mfma_f32_16x16x32_bf16 v[16:19], a[64:67], v[64:67], v[16:19]
    v_mfma_f32_16x16x32_bf16 v[20:23], a[64:67], v[68:71], v[20:23]
    v_mfma_f32_16x16x32_bf16 v[24:27], a[68:71], v[64:67], v[24:27]
    v_mfma_f32_16x16x32_bf16 v[28:31], a[68:71], v[68:71], v[28:31]
    ds_read_b128 v[64:67], v80 offset:10240
    ds_read_b128 v[68:71], v81 offset:10240
    s_waitcnt lgkmcnt(2)
    v_mfma_f32_16x16x32_bf16 v[32:35], a[200:203], v[72:75], v[32:35]
    v_mfma_f32_16x16x32_bf16 v[36:39], a[200:203], v[76:79], v[36:39]
    v_mfma_f32_16x16x32_bf16 v[40:43], a[204:207], v[72:75], v[40:43]
    v_mfma_f32_16x16x32_bf16 v[44:47], a[204:207], v[76:79], v[44:47]
    v_mfma_f32_16x16x32_bf16 v[48:51], v[72:75], v[200:203], v[48:51]
    v_mfma_f32_16x16x32_bf16 v[56:59], v[76:79], v[200:203], v[56:59]
    v_mfma_f32_16x16x32_bf16 v[52:55], v[72:75], v[204:207], v[52:55]
    v_mfma_f32_16x16x32_bf16 v[60:63], v[76:79], v[204:207], v[60:63]
    v_mfma_f32_16x16x32_bf16 v[16:19], a[72:75], v[72:75], v[16:19]
    v_mfma_f32_16x16x32_bf16 v[20:23], a[72:75], v[76:79], v[20:23]
    v_mfma_f32_16x16x32_bf16 v[24:27], a[76:79], v[72:75], v[24:27]
    v_mfma_f32_16x16x32_bf16 v[28:31], a[76:79], v[76:79], v[28:31]
    ds_read_b128 v[72:75], v82 offset:11264
    ds_read_b128 v[76:79], v83 offset:11264
    s_waitcnt lgkmcnt(2)
    v_mfma_f32_16x16x32_bf16 v[32:35], a[208:211], v[64:67], v[32:35]
    v_mfma_f32_16x16x32_bf16 v[36:39], a[208:211], v[68:71], v[36:39]
    v_mfma_f32_16x16x32_bf16 v[40:43], a[212:215], v[64:67], v[40:43]
    v_mfma_f32_16x16x32_bf16 v[44:47], a[212:215], v[68:71], v[44:47]
    v_mfma_f32_16x16x32_bf16 v[48:51], v[64:67], v[208:211], v[48:51]
    v_mfma_f32_16x16x32_bf16 v[56:59], v[68:71], v[208:211], v[56:59]
    v_mfma_f32_16x16x32_bf16 v[52:55], v[64:67], v[212:215], v[52:55]
    v_mfma_f32_16x16x32_bf16 v[60:63], v[68:71], v[212:215], v[60:63]
    v_mfma_f32_16x16x32_bf16 v[16:19], a[80:83], v[64:67], v[16:19]
    v_mfma_f32_16x16x32_bf16 v[20:23], a[80:83], v[68:71], v[20:23]
    v_mfma_f32_16x16x32_bf16 v[24:27], a[84:87], v[64:67], v[24:27]
    v_mfma_f32_16x16x32_bf16 v[28:31], a[84:87], v[68:71], v[28:31]
    ds_read_b128 v[64:67], v80 offset:12288
    ds_read_b128 v[68:71], v81 offset:12288
    s_waitcnt lgkmcnt(2)
    v_mfma_f32_16x16x32_bf16 v[32:35], a[216:219], v[72:75], v[32:35]
    v_mfma_f32_16x16x32_bf16 v[36:39], a[216:219], v[76:79], v[36:39]
    v_mfma_f32_16x16x32_bf16 v[40:43], a[220:223], v[72:75], v[40:43]
    v_mfma_f32_16x16x32_bf16 v[44:47], a[220:223], v[76:79], v[44:47]
    v_mfma_f32_16x16x32_bf16 v[48:51], v[72:75], v[216:219], v[48:51]
    v_mfma_f32_16x16x32_bf16 v[56:59], v[76:79], v[216:219], v[56:59]
    v_mfma_f32_16x16x32_bf16 v[52:55], v[72:75], v[220:223], v[52:55]
    v_mfma_f32_16x16x32_bf16 v[60:63], v[76:79], v[220:223], v[60:63]
    v_mfma_f32_16x16x32_bf16 v[16:19], a[88:91], v[72:75], v[16:19]
    v_mfma_f32_16x16x32_bf16 v[20:23], a[88:91], v[76:79], v[20:23]
    v_mfma_f32_16x16x32_bf16 v[24:27], a[92:95], v[72:75], v[24:27]
    v_mfma_f32_16x16x32_bf16 v[28:31], a[92:95], v[76:79], v[28:31]
    ds_read_b128 v[72:75], v82 offset:13312
    ds_read_b128 v[76:79], v83 offset:13312
    s_waitcnt lgkmcnt(2)
    v_mfma_f32_16x16x32_bf16 v[32:35], a[224:227], v[64:67], v[32:35]
    v_mfma_f32_16x16x32_bf16 v[36:39], a[224:227], v[68:71], v[36:39]
    v_mfma_f32_16x16x32_bf16 v[40:43], a[228:231], v[64:67], v[40:43]
    v_mfma_f32_16x16x32_bf16 v[44:47], a[228:231], v[68:71], v[44:47]
    v_mfma_f32_16x16x32_bf16 v[48:51], v[64:67], v[224:227], v[48:51]
    v_mfma_f32_16x16x32_bf16 v[56:59], v[68:71], v[224:227], v[56:59]
    v_mfma_f32_16x16x32_bf16 v[52:55], v[64:67], v[228:231], v[52:55]
    v_mfma_f32_16x16x32_bf16 v[60:63], v[68:71], v[228:231], v[60:63]
    v_mfma_f32_16x16x32_bf16 v[16:19], a[96:99], v[64:67], v[16:19]
    v_mfma_f32_16x16x32_bf16 v[20:23], a[96:99], v[68:71], v[20:23]
    v_mfma_f32_16x16x32_bf16 v[24:27], a[100:103], v[64:67], v[24:27]
    v_mfma_f32_16x16x32_bf16 v[28:31], a[100:103], v[68:71], v[28:31]
    ds_read_b128 v[64:67], v80 offset:14336
    ds_read_b128 v[68:71], v81 offset:14336
    s_waitcnt lgkmcnt(2)
    v_mfma_f32_16x16x32_bf16 v[32:35], a[232:235], v[72:75], v[32:35]
    v_mfma_f32_16x16x32_bf16 v[36:39], a[232:235], v[76:79], v[36:39]
    v_mfma_f32_16x16x32_bf16 v[40:43], a[236:239], v[72:75], v[40:43]
    v_mfma_f32_16x16x32_bf16 v[44:47], a[236:239], v[76:79], v[44:47]
    v_mfma_f32_16x16x32_bf16 v[48:51], v[72:75], v[232:235], v[48:51]
    v_mfma_f32_16x16x32_bf16 v[56:59], v[76:79], v[232:235], v[56:59]
    v_mfma_f32_16x16x32_bf16 v[52:55], v[72:75], v[236:239], v[52:55]
    v_mfma_f32_16x16x32_bf16 v[60:63], v[76:79], v[236:239], v[60:63]
    v_mfma_f32_16x16x32_bf16 v[16:19], a[104:107], v[72:75], v[16:19]
    v_mfma_f32_16x16x32_bf16 v[20:23], a[104:107], v[76:79], v[20:23]
    v_mfma_f32_16x16x32_bf16 v[24:27], a[108:111], v[72:75], v[24:27]
    v_mfma_f32_16x16x32_bf16 v[28:31], a[108:111], v[76:79], v[28:31]
    ds_read_b128 v[72:75], v82 offset:15360
    ds_read_b128 v[76:79], v83 offset:15360
    s_waitcnt lgkmcnt(2)
    v_mfma_f32_16x16x32_bf16 v[32:35], a[240:243], v[64:67], v[32:35]
    v_mfma_f32_16x16x32_bf16 v[36:39], a[240:243], v[68:71], v[36:39]
    v_mfma_f32_16x16x32_bf16 v[40:43], a[244:247], v[64:67], v[40:43]
    v_mfma_f32_16x16x32_bf16 v[44:47], a[244:247], v[68:71], v[44:47]
    v_mfma_f32_16x16x32_bf16 v[48:51], v[64:67], v[240:243], v[48:51]
    v_mfma_f32_16x16x32_bf16 v[56:59], v[68:71], v[240:243], v[56:59]
    v_mfma_f32_16x16x32_bf16 v[52:55], v[64:67], v[244:247], v[52:55]
    v_mfma_f32_16x16x32_bf16 v[60:63], v[68:71], v[244:247], v[60:63]
    v_mfma_f32_16x16x32_bf16 v[16:19], a[112:115], v[64:67], v[16:19]
    v_mfma_f32_16x16x32_bf16 v[20:23], a[112:115], v[68:71], v[20:23]
    v_mfma_f32_16x16x32_bf16 v[24:27], a[116:119], v[64:67], v[24:27]
    v_mfma_f32_16x16x32_bf16 v[28:31], a[116:119], v[68:71], v[28:31]
    s_waitcnt lgkmcnt(0)
    v_mfma_f32_16x16x32_bf16 v[32:35], a[248:251], v[72:75], v[32:35]
    v_mfma_f32_16x16x32_bf16 v[36:39], a[248:251], v[76:79], v[36:39]
    v_mfma_f32_16x16x32_bf16 v[40:43], a[252:255], v[72:75], v[40:43]
    v_mfma_f32_16x16x32_bf16 v[44:47], a[252:255], v[76:79], v[44:47]
    v_mfma_f32_16x16x32_bf16 v[48:51], v[72:75], v[248:251], v[48:51]
    v_mfma_f32_16x16x32_bf16 v[56:59], v[76:79], v[248:251], v[56:59]
    v_mfma_f32_16x16x32_bf16 v[52:55], v[72:75], v[252:255], v[52:55]
    v_mfma_f32_16x16x32_bf16 v[60:63], v[76:79], v[252:255], v[60:63]
    v_mfma_f32_16x16x32_bf16 v[16:19], a[120:123], v[72:75], v[16:19]
    v_mfma_f32_16x16x32_bf16 v[20:23], a[120:123], v[76:79], v[20:23]
    v_mfma_f32_16x16x32_bf16 v[24:27], a[124:127], v[72:75], v[24:27]
    v_mfma_f32_16x16x32_bf16 v[28:31], a[124:127], v[76:79], v[28:31]
    v_xor_b32 v80, 0x8000, v80
    v_xor_b32 v81, 0x8000, v81
    v_xor_b32 v82, 0x8000, v82
    v_xor_b32 v83, 0x8000, v83
    v_mul_f32 v32, s33, v32
    v_mul_f32 v33, s33, v33
    v_mul_f32 v34, s33, v34
    v_mul_f32 v35, s33, v35
    v_mul_f32 v36, s33, v36
    v_mul_f32 v37, s33, v37
    v_mul_f32 v38, s33, v38
    v_mul_f32 v39, s33, v39
    v_mul_f32 v40, s33, v40
    v_mul_f32 v41, s33, v41
    v_mul_f32 v42, s33, v42
    v_mul_f32 v43, s33, v43
    v_mul_f32 v44, s33, v44
    v_mul_f32 v45, s33, v45
    v_mul_f32 v46, s33, v46
    v_mul_f32 v47, s33, v47
    v_cvt_pk_bf16_f32 v88, v32, v40
    v_cvt_pk_bf16_f32 v89, v33, v41
    v_cvt_pk_bf16_f32 v90, v34, v42
    v_cvt_pk_bf16_f32 v91, v35, v43
    v_cvt_pk_bf16_f32 v92, v36, v44
    v_cvt_pk_bf16_f32 v93, v37, v45
    v_cvt_pk_bf16_f32 v94, v38, v46
    v_cvt_pk_bf16_f32 v95, v39, v47
    v_cvt_pk_bf16_f32 v96, v48, v49
    v_cvt_pk_bf16_f32 v97, v50, v51
    v_cvt_pk_bf16_f32 v98, v56, v57
    v_cvt_pk_bf16_f32 v99, v58, v59
    v_cvt_pk_bf16_f32 v100, v52, v53
    v_cvt_pk_bf16_f32 v101, v54, v55
    v_cvt_pk_bf16_f32 v102, v60, v61
    v_cvt_pk_bf16_f32 v103, v62, v63
    v_cvt_pk_bf16_f32 v104, v16, v24
    v_cvt_pk_bf16_f32 v105, v17, v25
    v_cvt_pk_bf16_f32 v106, v18, v26
    v_cvt_pk_bf16_f32 v107, v19, v27
    v_cvt_pk_bf16_f32 v108, v20, v28
    v_cvt_pk_bf16_f32 v109, v21, v29
    v_cvt_pk_bf16_f32 v110, v22, v30
    v_cvt_pk_bf16_f32 v111, v23, v31
    s_mul_i32 s24, s23, 0x82000
    s_lshl_b32 s36, s20, 14
    s_add_u32 s24, s24, s36
    s_add_u32 s24, s24, 0x1000000
    s_lshr_b32 s36, s21, 1
    s_lshl_b32 s36, s36, 12
    s_xor_b32 s37, s36, 4096
    s_add_u32 s36, s36, s24
    s_add_u32 s37, s37, s24
    buffer_store_dwordx4 v[88:91], v9, s[8:11], s36 offen sc1
    buffer_store_dwordx4 v[92:95], v9, s[8:11], s37 offen sc1
    s_add_u32 s24, s24, 8192
    buffer_store_dwordx4 v[96:99], v2, s[8:11], s24 offen sc1
    buffer_store_dwordx4 v[100:103], v2, s[8:11], s24 offen offset:1024 sc1
    s_add_u32 s36, s36, 0x7000000
    s_add_u32 s37, s37, 0x7000000
    buffer_store_dwordx4 v[104:107], v9, s[8:11], s36 offen sc1
    buffer_store_dwordx4 v[108:111], v9, s[8:11], s37 offen sc1
    s_lshl_b32 s25, s20, 8
    s_lshl_b32 s36, s23, 2
    s_add_u32 s25, s25, s36
    s_add_u32 s25, s25, 0x190000
    s_add_u32 s23, s23, 6
    s_cmp_lt_u32 s23, 64
    s_cbranch_scc1 L_P1
    v_mov_b32 v20, -1
    v_mov_b32 v21, -1
    v_mov_b32 v22, -1
    v_mov_b32 v23, -1
    s_lshl_b32 s24, s22, 21
    s_lshl_b32 s36, s20, 15
    s_add_u32 s24, s24, s36
    s_add_u32 s36, s24, 0x4000000
    buffer_store_dwordx4 v[20:23], v11, s[8:11], s36 offen sc1
    s_add_u32 s36, s24, 0x4001000
    buffer_store_dwordx4 v[20:23], v11, s[8:11], s36 offen sc1
    s_add_u32 s36, s24, 0x4002000
    buffer_store_dwordx4 v[20:23], v11, s[8:11], s36 offen sc1
    s_add_u32 s36, s24, 0x4003000
    buffer_store_dwordx4 v[20:23], v11, s[8:11], s36 offen sc1
    s_add_u32 s36, s24, 0x4004000
    buffer_store_dwordx4 v[20:23], v11, s[8:11], s36 offen sc1
    s_add_u32 s36, s24, 0x4005000
    buffer_store_dwordx4 v[20:23], v11, s[8:11], s36 offen sc1
    s_add_u32 s36, s24, 0x4006000
    buffer_store_dwordx4 v[20:23], v11, s[8:11], s36 offen sc1
    s_add_u32 s36, s24, 0x4007000
    buffer_store_dwordx4 v[20:23], v11, s[8:11], s36 offen sc1
    s_add_u32 s36, s24, 0x4100000
    buffer_store_dwordx4 v[20:23], v11, s[8:11], s36 offen sc1
    s_add_u32 s36, s24, 0x4101000
    buffer_store_dwordx4 v[20:23], v11, s[8:11], s36 offen sc1
    s_add_u32 s36, s24, 0x4102000
    buffer_store_dwordx4 v[20:23], v11, s[8:11], s36 offen sc1
    s_add_u32 s36, s24, 0x4103000
    buffer_store_dwordx4 v[20:23], v11, s[8:11], s36 offen sc1
    s_add_u32 s36, s24, 0x4104000
    buffer_store_dwordx4 v[20:23], v11, s[8:11], s36 offen sc1
    s_add_u32 s36, s24, 0x4105000
    buffer_store_dwordx4 v[20:23], v11, s[8:11], s36 offen sc1
    s_add_u32 s36, s24, 0x4106000
    buffer_store_dwordx4 v[20:23], v11, s[8:11], s36 offen sc1
    s_add_u32 s36, s24, 0x4107000
    buffer_store_dwordx4 v[20:23], v11, s[8:11], s36 offen sc1
    s_waitcnt vmcnt(0)
    s_barrier
    v_cmp_ne_u32 vcc, 0, v0
    v_mov_b32 v15, 0x40000000
    v_mov_b32 v14, 1
    v_cndmask_b32 v15, v0, v15, vcc
    buffer_store_dword v14, v15, s[8:11], s25 offen sc1
    s_lshl_b32 s25, s22, 7
    s_lshl_b32 s36, s20, 2
    s_add_u32 s36, s36, s25
    s_add_u32 s36, s36, 0x192000
    v_cmp_ne_u32 vcc, 0, v0
    v_mov_b32 v15, 0x40000000
    v_mov_b32 v14, 1
    v_cndmask_b32 v15, v0, v15, vcc
    buffer_store_dword v14, v15, s[8:11], s36 offen sc1
    s_mov_b32 s96, s54
    s_and_b32 s97, s55, 0xffff
    s_mov_b32 s98, 0x400000
    s_mov_b32 s99, 0x20000
    v_mov_b32 v15, 0x0
    v_bfe_u32 v14, v0, 0, 1
    s_mov_b32 s38, 0x10
    v_mad_u32_u24 v15, v14, s38, v15
    v_bfe_u32 v14, v0, 1, 1
    s_mov_b32 s38, 0x20
    v_mad_u32_u24 v15, v14, s38, v15
    v_bfe_u32 v14, v0, 2, 1
    s_mov_b32 s38, 0x40
    v_mad_u32_u24 v15, v14, s38, v15
    v_bfe_u32 v14, v0, 3, 1
    s_mov_b32 s38, 0x80
    v_mad_u32_u24 v15, v14, s38, v15
    v_bfe_u32 v14, v0, 4, 1
    s_mov_b32 s38, 0x1000
    v_mad_u32_u24 v15, v14, s38, v15
    v_bfe_u32 v14, v0, 5, 1
    s_mov_b32 s38, 0x2000
    v_mad_u32_u24 v15, v14, s38, v15
    v_bfe_u32 v14, v0, 6, 1
    s_mov_b32 s38, 0x100
    v_mad_u32_u24 v15, v14, s38, v15
    v_bfe_u32 v14, v0, 7, 1
    s_mov_b32 s38, 0x200
    v_mad_u32_u24 v15, v14, s38, v15
    s_lshl_b32 s36, s20, 17
    s_add_u32 s37, s36, 0x0
    buffer_load_dwordx4 v[16:19], v15, s[96:99], s37 offen
    s_add_u32 s37, s36, 0x4000
    buffer_load_dwordx4 v[20:23], v15, s[96:99], s37 offen
    s_add_u32 s37, s36, 0x400
    buffer_load_dwordx4 v[24:27], v15, s[96:99], s37 offen
    s_add_u32 s37, s36, 0x4400
    buffer_load_dwordx4 v[28:31], v15, s[96:99], s37 offen
    s_add_u32 s37, s36, 0x800
    buffer_load_dwordx4 v[32:35], v15, s[96:99], s37 offen
    s_add_u32 s37, s36, 0x4800
    buffer_load_dwordx4 v[36:39], v15, s[96:99], s37 offen
    s_add_u32 s37, s36, 0xc00
    buffer_load_dwordx4 v[40:43], v15, s[96:99], s37 offen
    s_add_u32 s37, s36, 0x4c00
    buffer_load_dwordx4 v[44:47], v15, s[96:99], s37 offen
    s_add_u32 s37, s36, 0x8000
    buffer_load_dwordx4 v[48:51], v15, s[96:99], s37 offen
    s_add_u32 s37, s36, 0xc000
    buffer_load_dwordx4 v[52:55], v15, s[96:99], s37 offen
    s_add_u32 s37, s36, 0x8400
    buffer_load_dwordx4 v[56:59], v15, s[96:99], s37 offen
    s_add_u32 s37, s36, 0xc400
    buffer_load_dwordx4 v[60:63], v15, s[96:99], s37 offen
    s_add_u32 s37, s36, 0x8800
    buffer_load_dwordx4 v[64:67], v15, s[96:99], s37 offen
    s_add_u32 s37, s36, 0xc800
    buffer_load_dwordx4 v[68:71], v15, s[96:99], s37 offen
    s_add_u32 s37, s36, 0x8c00
    buffer_load_dwordx4 v[72:75], v15, s[96:99], s37 offen
    s_add_u32 s37, s36, 0xcc00
    buffer_load_dwordx4 v[76:79], v15, s[96:99], s37 offen
    s_add_u32 s37, s36, 0x10000
    buffer_load_dwordx4 v[80:83], v15, s[96:99], s37 offen
    s_add_u32 s37, s36, 0x14000
    buffer_load_dwordx4 v[84:87], v15, s[96:99], s37 offen
    s_add_u32 s37, s36, 0x10400
    buffer_load_dwordx4 v[88:91], v15, s[96:99], s37 offen
    s_add_u32 s37, s36, 0x14400
    buffer_load_dwordx4 v[92:95], v15, s[96:99], s37 offen
    s_add_u32 s37, s36, 0x10800
    buffer_load_dwordx4 v[96:99], v15, s[96:99], s37 offen
    s_add_u32 s37, s36, 0x14800
    buffer_load_dwordx4 v[100:103], v15, s[96:99], s37 offen
    s_add_u32 s37, s36, 0x10c00
    buffer_load_dwordx4 v[104:107], v15, s[96:99], s37 offen
    s_add_u32 s37, s36, 0x14c00
    buffer_load_dwordx4 v[108:111], v15, s[96:99], s37 offen
    s_waitcnt vmcnt(16)
    v_perm_b32 v112, v20, v16, s34
    v_perm_b32 v113, v28, v24, s34
    v_perm_b32 v114, v36, v32, s34
    v_perm_b32 v115, v44, v40, s34
    ds_write_b128 v7, v[112:115] offset:0
    v_perm_b32 v116, v20, v16, s35
    v_perm_b32 v117, v28, v24, s35
    v_perm_b32 v118, v36, v32, s35
    v_perm_b32 v119, v44, v40, s35
    ds_write_b128 v7, v[116:119] offset:1024
    v_perm_b32 v120, v21, v17, s34
    v_perm_b32 v121, v29, v25, s34
    v_perm_b32 v122, v37, v33, s34
    v_perm_b32 v123, v45, v41, s34
    ds_write_b128 v7, v[120:123] offset:2048
    v_perm_b32 v124, v21, v17, s35
    v_perm_b32 v125, v29, v25, s35
    v_perm_b32 v126, v37, v33, s35
    v_perm_b32 v127, v45, v41, s35
    ds_write_b128 v7, v[124:127] offset:3072
    s_waitcnt lgkmcnt(0)
    v_perm_b32 v112, v22, v18, s34
    v_perm_b32 v113, v30, v26, s34
    v_perm_b32 v114, v38, v34, s34
    v_perm_b32 v115, v46, v42, s34
    ds_write_b128 v7, v[112:115] offset:4096
    v_perm_b32 v116, v22, v18, s35
    v_perm_b32 v117, v30, v26, s35
    v_perm_b32 v118, v38, v34, s35
    v_perm_b32 v119, v46, v42, s35
    ds_write_b128 v7, v[116:119] offset:5120
    v_perm_b32 v120, v23, v19, s34
    v_perm_b32 v121, v31, v27, s34
    v_perm_b32 v122, v39, v35, s34
    v_perm_b32 v123, v47, v43, s34
    ds_write_b128 v7, v[120:123] offset:6144
    v_perm_b32 v124, v23, v19, s35
    v_perm_b32 v125, v31, v27, s35
    v_perm_b32 v126, v39, v35, s35
    v_perm_b32 v127, v47, v43, s35
    ds_write_b128 v7, v[124:127] offset:7168
    s_waitcnt lgkmcnt(0)
    s_add_u32 s37, s36, 0x18000
    buffer_load_dwordx4 v[16:19], v15, s[96:99], s37 offen
    s_add_u32 s37, s36, 0x1c000
    buffer_load_dwordx4 v[20:23], v15, s[96:99], s37 offen
    s_add_u32 s37, s36, 0x18400
    buffer_load_dwordx4 v[24:27], v15, s[96:99], s37 offen
    s_add_u32 s37, s36, 0x1c400
    buffer_load_dwordx4 v[28:31], v15, s[96:99], s37 offen
    s_add_u32 s37, s36, 0x18800
    buffer_load_dwordx4 v[32:35], v15, s[96:99], s37 offen
    s_add_u32 s37, s36, 0x1c800
    buffer_load_dwordx4 v[36:39], v15, s[96:99], s37 offen
    s_add_u32 s37, s36, 0x18c00
    buffer_load_dwordx4 v[40:43], v15, s[96:99], s37 offen
    s_add_u32 s37, s36, 0x1cc00
    buffer_load_dwordx4 v[44:47], v15, s[96:99], s37 offen
    s_waitcnt vmcnt(16)
    v_perm_b32 v112, v52, v48, s34
    v_perm_b32 v113, v60, v56, s34
    v_perm_b32 v114, v68, v64, s34
    v_perm_b32 v115, v76, v72, s34
    ds_write_b128 v7, v[112:115] offset:8192
    v_perm_b32 v116, v52, v48, s35
    v_perm_b32 v117, v60, v56, s35
    v_perm_b32 v118, v68, v64, s35
    v_perm_b32 v119, v76, v72, s35
    ds_write_b128 v7, v[116:119] offset:9216
    v_perm_b32 v120, v53, v49, s34
    v_perm_b32 v121, v61, v57, s34
    v_perm_b32 v122, v69, v65, s34
    v_perm_b32 v123, v77, v73, s34
    ds_write_b128 v7, v[120:123] offset:10240
    v_perm_b32 v124, v53, v49, s35
    v_perm_b32 v125, v61, v57, s35
    v_perm_b32 v126, v69, v65, s35
    v_perm_b32 v127, v77, v73, s35
    ds_write_b128 v7, v[124:127] offset:11264
    s_waitcnt lgkmcnt(0)
    v_perm_b32 v112, v54, v50, s34
    v_perm_b32 v113, v62, v58, s34
    v_perm_b32 v114, v70, v66, s34
    v_perm_b32 v115, v78, v74, s34
    ds_write_b128 v7, v[112:115] offset:12288
    v_perm_b32 v116, v54, v50, s35
    v_perm_b32 v117, v62, v58, s35
    v_perm_b32 v118, v70, v66, s35
    v_perm_b32 v119, v78, v74, s35
    ds_write_b128 v7, v[116:119] offset:13312
    v_perm_b32 v120, v55, v51, s34
    v_perm_b32 v121, v63, v59, s34
    v_perm_b32 v122, v71, v67, s34
    v_perm_b32 v123, v79, v75, s34
    ds_write_b128 v7, v[120:123] offset:14336
    v_perm_b32 v124, v55, v51, s35
    v_perm_b32 v125, v63, v59, s35
    v_perm_b32 v126, v71, v67, s35
    v_perm_b32 v127, v79, v75, s35
    ds_write_b128 v7, v[124:127] offset:15360
    s_waitcnt lgkmcnt(0)
    s_waitcnt vmcnt(8)
    v_perm_b32 v112, v84, v80, s34
    v_perm_b32 v113, v92, v88, s34
    v_perm_b32 v114, v100, v96, s34
    v_perm_b32 v115, v108, v104, s34
    ds_write_b128 v7, v[112:115] offset:16384
    v_perm_b32 v116, v84, v80, s35
    v_perm_b32 v117, v92, v88, s35
    v_perm_b32 v118, v100, v96, s35
    v_perm_b32 v119, v108, v104, s35
    ds_write_b128 v7, v[116:119] offset:17408
    v_perm_b32 v120, v85, v81, s34
    v_perm_b32 v121, v93, v89, s34
    v_perm_b32 v122, v101, v97, s34
    v_perm_b32 v123, v109, v105, s34
    ds_write_b128 v7, v[120:123] offset:18432
    v_perm_b32 v124, v85, v81, s35
    v_perm_b32 v125, v93, v89, s35
    v_perm_b32 v126, v101, v97, s35
    v_perm_b32 v127, v109, v105, s35
    ds_write_b128 v7, v[124:127] offset:19456
    s_waitcnt lgkmcnt(0)
    v_perm_b32 v112, v86, v82, s34
    v_perm_b32 v113, v94, v90, s34
    v_perm_b32 v114, v102, v98, s34
    v_perm_b32 v115, v110, v106, s34
    ds_write_b128 v7, v[112:115] offset:20480
    v_perm_b32 v116, v86, v82, s35
    v_perm_b32 v117, v94, v90, s35
    v_perm_b32 v118, v102, v98, s35
    v_perm_b32 v119, v110, v106, s35
    ds_write_b128 v7, v[116:119] offset:21504
    v_perm_b32 v120, v87, v83, s34
    v_perm_b32 v121, v95, v91, s34
    v_perm_b32 v122, v103, v99, s34
    v_perm_b32 v123, v111, v107, s34
    ds_write_b128 v7, v[120:123] offset:22528
    v_perm_b32 v124, v87, v83, s35
    v_perm_b32 v125, v95, v91, s35
    v_perm_b32 v126, v103, v99, s35
    v_perm_b32 v127, v111, v107, s35
    ds_write_b128 v7, v[124:127] offset:23552
    s_waitcnt lgkmcnt(0)
    s_waitcnt vmcnt(0)
    v_perm_b32 v112, v20, v16, s34
    v_perm_b32 v113, v28, v24, s34
    v_perm_b32 v114, v36, v32, s34
    v_perm_b32 v115, v44, v40, s34
    ds_write_b128 v7, v[112:115] offset:24576
    v_perm_b32 v116, v20, v16, s35
    v_perm_b32 v117, v28, v24, s35
    v_perm_b32 v118, v36, v32, s35
    v_perm_b32 v119, v44, v40, s35
    ds_write_b128 v7, v[116:119] offset:25600
    v_perm_b32 v120, v21, v17, s34
    v_perm_b32 v121, v29, v25, s34
    v_perm_b32 v122, v37, v33, s34
    v_perm_b32 v123, v45, v41, s34
    ds_write_b128 v7, v[120:123] offset:26624
    v_perm_b32 v124, v21, v17, s35
    v_perm_b32 v125, v29, v25, s35
    v_perm_b32 v126, v37, v33, s35
    v_perm_b32 v127, v45, v41, s35
    ds_write_b128 v7, v[124:127] offset:27648
    s_waitcnt lgkmcnt(0)
    v_perm_b32 v112, v22, v18, s34
    v_perm_b32 v113, v30, v26, s34
    v_perm_b32 v114, v38, v34, s34
    v_perm_b32 v115, v46, v42, s34
    ds_write_b128 v7, v[112:115] offset:28672
    v_perm_b32 v116, v22, v18, s35
    v_perm_b32 v117, v30, v26, s35
    v_perm_b32 v118, v38, v34, s35
    v_perm_b32 v119, v46, v42, s35
    ds_write_b128 v7, v[116:119] offset:29696
    v_perm_b32 v120, v23, v19, s34
    v_perm_b32 v121, v31, v27, s34
    v_perm_b32 v122, v39, v35, s34
    v_perm_b32 v123, v47, v43, s34
    ds_write_b128 v7, v[120:123] offset:30720
    v_perm_b32 v124, v23, v19, s35
    v_perm_b32 v125, v31, v27, s35
    v_perm_b32 v126, v39, v35, s35
    v_perm_b32 v127, v47, v43, s35
    ds_write_b128 v7, v[124:127] offset:31744
    s_waitcnt lgkmcnt(0)
    s_lshl_b32 s25, s22, 7
    s_add_u32 s25, s25, 0x192000
    v_lshrrev_b32 v15, 2, v1
    v_and_b32 v15, 127, v15
L_TPI:
    buffer_load_dword v14, v15, s[8:11], s25 offen sc1
    s_add_u32 s32, s32, 1
    s_cmp_gt_u32 s32, 200000
    s_waitcnt vmcnt(0)
    s_cbranch_scc1 L_TPI_ok
    v_cmp_eq_u32 vcc, 0, v14
    s_cbranch_vccz L_TPI_ok
    s_sleep 8
    s_branch L_TPI
L_TPI_ok:
    s_mov_b32 s23, s22
    s_mov_b32 s29, 0
    s_mov_b32 s30, 0x40000000
    s_mul_i32 s24, s23, 0x82000
    s_lshl_b32 s36, s20, 14
    s_add_u32 s24, s24, s36
    s_add_u32 s24, s24, 0x1000000
    s_add_u32 s36, s24, 0
    s_add_u32 s37, s36, 0x7000000
    buffer_load_dwordx4 a[32:35], v1, s[8:11], s36 offen offset:0 sc1
    buffer_load_dwordx4 a[0:3], v1, s[8:11], s37 offen offset:0 sc1
    buffer_load_dwordx4 a[36:39], v1, s[8:11], s36 offen offset:1024 sc1
    buffer_load_dwordx4 a[4:7], v1, s[8:11], s37 offen offset:1024 sc1
    buffer_load_dwordx4 a[40:43], v1, s[8:11], s36 offen offset:2048 sc1
    buffer_load_dwordx4 a[8:11], v1, s[8:11], s37 offen offset:2048 sc1
    buffer_load_dwordx4 a[44:47], v1, s[8:11], s36 offen offset:3072 sc1
    buffer_load_dwordx4 a[12:15], v1, s[8:11], s37 offen offset:3072 sc1
    s_add_u32 s36, s24, 4096
    s_add_u32 s37, s36, 0x7000000
    buffer_load_dwordx4 a[48:51], v1, s[8:11], s36 offen offset:0 sc1
    buffer_load_dwordx4 a[16:19], v1, s[8:11], s37 offen offset:0 sc1
    buffer_load_dwordx4 a[52:55], v1, s[8:11], s36 offen offset:1024 sc1
    buffer_load_dwordx4 a[20:23], v1, s[8:11], s37 offen offset:1024 sc1
    buffer_load_dwordx4 a[56:59], v1, s[8:11], s36 offen offset:2048 sc1
    buffer_load_dwordx4 a[24:27], v1, s[8:11], s37 offen offset:2048 sc1
    buffer_load_dwordx4 a[60:63], v1, s[8:11], s36 offen offset:3072 sc1
    buffer_load_dwordx4 a[28:31], v1, s[8:11], s37 offen offset:3072 sc1
    s_lshr_b32 s36, s21, 1
    s_lshl_b32 s36, s36, 3
    s_xor_b32 s37, s36, 8
    s_add_u32 s24, s24, 8192
    s_add_u32 s36, s36, s24
    s_add_u32 s37, s37, s24
    buffer_load_dwordx2 a[64:65], v2, s[8:11], s36 offen offset:0 sc1
    buffer_load_dwordx2 a[66:67], v2, s[8:11], s37 offen offset:0 sc1
    buffer_load_dwordx2 a[68:69], v2, s[8:11], s36 offen offset:1024 sc1
    buffer_load_dwordx2 a[70:71], v2, s[8:11], s37 offen offset:1024 sc1
L_P2:
    s_and_b32 s36, s29, 1
    s_lshl_b32 s36, s36, 20
    s_lshl_b32 s26, s22, 21
    s_add_u32 s26, s26, s36
    s_add_u32 s26, s26, 0x4000000
    s_bfe_u32 s27, s29, 0x10001
    s_lshl_b32 s24, s23, 13
    s_add_u32 s24, s24, 0x100000
    s_max_u32 s25, s23, 1
    s_lshl_b32 s25, s25, 13
    s_add_u32 s25, s25, 0xfe000
    buffer_load_dwordx4 v[48:51], v2, s[8:11], s24 offen sc1
    buffer_load_dwordx4 v[52:55], v2, s[8:11], s24 offen offset:1024 sc1
    s_lshl_b32 s36, s23, 5
    s_add_u32 s36, s36, s20
    s_lshl_b32 s36, s36, 10
    buffer_load_dword a72, v12, s[12:15], s36 offen
    buffer_load_dword a73, v12, s[92:95], 0 offen
    s_waitcnt vmcnt(4)
    v_cmp_ne_u32 vcc, 0, v1
    v_mov_b32 v15, 0x40000000
    v_mov_b32 v14, 0
    v_cndmask_b32 v15, v1, v15, vcc
    buffer_store_dword v14, v15, s[8:11], s30 offen sc1
    v_mfma_f32_16x16x32_bf16 v[80:83], a[32:35], a[0:3], 0
    v_mfma_f32_16x16x32_bf16 v[80:83], a[36:39], a[4:7], v[80:83]
    v_mfma_f32_16x16x32_bf16 v[80:83], a[40:43], a[8:11], v[80:83]
    v_mfma_f32_16x16x32_bf16 v[80:83], a[44:47], a[12:15], v[80:83]
    v_mfma_f32_16x16x32_bf16 v[88:91], a[48:51], a[16:19], 0
    v_mfma_f32_16x16x32_bf16 v[88:91], a[52:55], a[20:23], v[88:91]
    v_mfma_f32_16x16x32_bf16 v[88:91], a[56:59], a[24:27], v[88:91]
    v_mfma_f32_16x16x32_bf16 v[88:91], a[60:63], a[28:31], v[88:91]
    v_mfma_f32_16x16x32_bf16 v[84:87], a[32:35], a[16:19], 0
    v_mfma_f32_16x16x32_bf16 v[84:87], a[36:39], a[20:23], v[84:87]
    v_mfma_f32_16x16x32_bf16 v[84:87], a[40:43], a[24:27], v[84:87]
    v_mfma_f32_16x16x32_bf16 v[84:87], a[44:47], a[28:31], v[84:87]
    v_cndmask_b32 v80, v13, v80, s[64:65]
    v_cndmask_b32 v81, v13, v81, s[66:67]
    v_cndmask_b32 v82, v13, v82, s[68:69]
    v_cndmask_b32 v83, v13, v83, s[70:71]
    v_cndmask_b32 v88, v13, v88, s[64:65]
    v_cndmask_b32 v89, v13, v89, s[66:67]
    v_cndmask_b32 v90, v13, v90, s[68:69]
    v_cndmask_b32 v91, v13, v91, s[70:71]
    v_max_f32 v116, v80, v81
    v_max3_f32 v116, v116, v82, v83
    v_max_f32 v117, v84, v85
    v_max3_f32 v117, v117, v86, v87
    v_max3_f32 v117, v117, v88, v89
    v_max3_f32 v117, v117, v90, v91
    v_mov_b32 v14, v116
    s_nop 1
    v_permlane16_swap_b32 v116, v14
    v_max_f32 v116, v116, v14
    v_mov_b32 v14, v117
    s_nop 1
    v_permlane16_swap_b32 v117, v14
    v_max_f32 v117, v117, v14
    v_mov_b32 v14, v116
    s_nop 1
    v_permlane32_swap_b32 v116, v14
    v_max_f32 v116, v116, v14
    v_mov_b32 v14, v117
    s_nop 1
    v_permlane32_swap_b32 v117, v14
    v_max_f32 v117, v117, v14
    v_sub_f32 v80, v80, v116
    v_exp_f32 v80, v80
    v_sub_f32 v81, v81, v116
    v_exp_f32 v81, v81
    v_sub_f32 v82, v82, v116
    v_exp_f32 v82, v82
    v_sub_f32 v83, v83, v116
    v_exp_f32 v83, v83
    v_sub_f32 v84, v84, v117
    v_exp_f32 v84, v84
    v_sub_f32 v85, v85, v117
    v_exp_f32 v85, v85
    v_sub_f32 v86, v86, v117
    v_exp_f32 v86, v86
    v_sub_f32 v87, v87, v117
    v_exp_f32 v87, v87
    v_sub_f32 v88, v88, v117
    v_exp_f32 v88, v88
    v_sub_f32 v89, v89, v117
    v_exp_f32 v89, v89
    v_sub_f32 v90, v90, v117
    v_exp_f32 v90, v90
    v_sub_f32 v91, v91, v117
    v_exp_f32 v91, v91
    v_cvt_pk_bf16_f32 v100, v80, v81
    v_cvt_pk_bf16_f32 v101, v82, v83
    v_mov_b64 v[102:103], 0
    v_cvt_pk_bf16_f32 v104, v84, v85
    v_cvt_pk_bf16_f32 v105, v86, v87
    v_cvt_pk_bf16_f32 v106, v88, v89
    v_cvt_pk_bf16_f32 v107, v90, v91
    v_mov_b64 v[108:109], s[4:5]
    v_mov_b64 v[110:111], s[4:5]
    v_cndmask_b32 v112, 0, v108, s[72:73]
    v_cndmask_b32 v113, 0, v108, s[72:73]
    v_mfma_f32_16x16x32_bf16 v[16:19], v[108:111], v[100:103], 0
    v_mfma_f32_16x16x32_bf16 v[24:27], a[64:67], v[100:103], 0
    v_mfma_f32_16x16x32_bf16 v[28:31], a[68:71], v[100:103], 0
    v_mfma_f32_16x16x32_bf16 v[20:23], v[108:111], v[104:107], 0
    v_mfma_f32_16x16x32_bf16 v[32:35], a[64:67], v[104:107], 0
    v_mfma_f32_16x16x32_bf16 v[36:39], a[68:71], v[104:107], 0
    s_branch L_P2_chk
L_P2_far:
    buffer_load_dword v14, v2, s[8:11], s25 offen sc1
    s_add_u32 s32, s32, 1
    s_cmp_gt_u32 s32, 200000
    s_waitcnt vmcnt(0)
    s_cbranch_scc1 L_P2_poll
    v_cmp_eq_u32 vcc, -1, v14
    s_cbranch_vccz L_P2_near
    s_sleep 12
    s_branch L_P2_far
L_P2_near:
    s_mov_b32 s25, 0x40000000
L_P2_poll:
    buffer_load_dwordx4 v[48:51], v2, s[8:11], s24 offen sc1
    buffer_load_dwordx4 v[52:55], v2, s[8:11], s24 offen offset:1024 sc1
L_P2_chk:
    s_add_u32 s32, s32, 1
    s_waitcnt vmcnt(0)
    ds_write_b128 v2, v[48:51] offset:20480
    ds_write_b128 v2, v[52:55] offset:21504
    v_max3_u32 v14, v48, v49, v50
    v_max3_u32 v15, v51, v52, v53
    v_max3_u32 v14, v14, v54, v55
    v_max_u32 v14, v14, v15
    v_cmp_eq_u32 vcc, -1, v14
    s_cbranch_vccz L_P2_got
    s_cmp_gt_u32 s32, 200000
    s_cbranch_scc1 L_P2_got
    s_cmp_eq_u32 s25, 0x40000000
    s_cbranch_scc1 L_P2_poll
    s_branch L_P2_far
L_P2_got:
    s_waitcnt lgkmcnt(0)
    s_barrier
    ds_read_b128 v[48:51], v8 offset:0
    ds_read_b128 v[52:55], v8 offset:2048
    ds_read_b128 v[56:59], v8 offset:4096
    ds_read_b128 v[60:63], v8 offset:6144
    s_waitcnt lgkmcnt(3)
    v_mfma_f32_16x16x32_bf16 v[80:83], a[128:131], v[48:51], 0
    v_mfma_f32_16x16x32_bf16 v[84:87], a[132:135], v[48:51], 0
    ds_read_b128 v[48:51], v8 offset:512
    s_waitcnt lgkmcnt(3)
    v_mfma_f32_16x16x32_bf16 v[80:83], a[136:139], v[52:55], v[80:83]
    v_mfma_f32_16x16x32_bf16 v[84:87], a[140:143], v[52:55], v[84:87]
    ds_read_b128 v[52:55], v8 offset:2560
    s_waitcnt lgkmcnt(3)
    v_mfma_f32_16x16x32_bf16 v[80:83], a[144:147], v[56:59], v[80:83]
    v_mfma_f32_16x16x32_bf16 v[84:87], a[148:151], v[56:59], v[84:87]
    ds_read_b128 v[56:59], v8 offset:4608
    s_waitcnt lgkmcnt(3)
    v_mfma_f32_16x16x32_bf16 v[80:83], a[152:155], v[60:63], v[80:83]
    v_mfma_f32_16x16x32_bf16 v[84:87], a[156:159], v[60:63], v[84:87]
    ds_read_b128 v[60:63], v8 offset:6656
    s_waitcnt lgkmcnt(3)
    v_mfma_f32_16x16x32_bf16 v[80:83], a[160:163], v[48:51], v[80:83]
    v_mfma_f32_16x16x32_bf16 v[84:87], a[164:167], v[48:51], v[84:87]
    ds_read_b128 v[48:51], v8 offset:1024
    s_waitcnt lgkmcnt(3)
    v_mfma_f32_16x16x32_bf16 v[80:83], a[168:171], v[52:55], v[80:83]
    v_mfma_f32_16x16x32_bf16 v[84:87], a[172:175], v[52:55], v[84:87]
    ds_read_b128 v[52:55], v8 offset:3072
    s_waitcnt lgkmcnt(3)
    v_mfma_f32_16x16x32_bf16 v[80:83], a[176:179], v[56:59], v[80:83]
    v_mfma_f32_16x16x32_bf16 v[84:87], a[180:183], v[56:59], v[84:87]
    ds_read_b128 v[56:59], v8 offset:5120
    s_waitcnt lgkmcnt(3)
    v_mfma_f32_16x16x32_bf16 v[80:83], a[184:187], v[60:63], v[80:83]
    v_mfma_f32_16x16x32_bf16 v[84:87], a[188:191], v[60:63], v[84:87]
    ds_read_b128 v[60:63], v8 offset:7168
    s_waitcnt lgkmcnt(3)
    v_mfma_f32_16x16x32_bf16 v[80:83], a[192:195], v[48:51], v[80:83]
    v_mfma_f32_16x16x32_bf16 v[84:87], a[196:199], v[48:51], v[84:87]
    ds_read_b128 v[48:51], v8 offset:1536
    s_waitcnt lgkmcnt(3)
    v_mfma_f32_16x16x32_bf16 v[80:83], a[200:203], v[52:55], v[80:83]
    v_mfma_f32_16x16x32_bf16 v[84:87], a[204:207], v[52:55], v[84:87]
    ds_read_b128 v[52:55], v8 offset:3584
    s_waitcnt lgkmcnt(3)
    v_mfma_f32_16x16x32_bf16 v[80:83], a[208:211], v[56:59], v[80:83]
    v_mfma_f32_16x16x32_bf16 v[84:87], a[212:215], v[56:59], v[84:87]
    ds_read_b128 v[56:59], v8 offset:5632
    s_waitcnt lgkmcnt(3)
    v_mfma_f32_16x16x32_bf16 v[80:83], a[216:219], v[60:63], v[80:83]
    v_mfma_f32_16x16x32_bf16 v[84:87], a[220:223], v[60:63], v[84:87]
    ds_read_b128 v[60:63], v8 offset:7680
    s_waitcnt lgkmcnt(3)
    v_mfma_f32_16x16x32_bf16 v[80:83], a[224:227], v[48:51], v[80:83]
    v_mfma_f32_16x16x32_bf16 v[84:87], a[228:231], v[48:51], v[84:87]
    ds_read_b128 v[48:51], v8 offset:0
    s_waitcnt lgkmcnt(3)
    v_mfma_f32_16x16x32_bf16 v[80:83], a[232:235], v[52:55], v[80:83]
    v_mfma_f32_16x16x32_bf16 v[84:87], a[236:239], v[52:55], v[84:87]
    ds_read_b128 v[52:55], v8 offset:2048
    s_waitcnt lgkmcnt(3)
    v_mfma_f32_16x16x32_bf16 v[80:83], a[240:243], v[56:59], v[80:83]
    v_mfma_f32_16x16x32_bf16 v[84:87], a[244:247], v[56:59], v[84:87]
    ds_read_b128 v[56:59], v8 offset:4096
    s_waitcnt lgkmcnt(3)
    v_mfma_f32_16x16x32_bf16 v[80:83], a[248:251], v[60:63], v[80:83]
    v_mfma_f32_16x16x32_bf16 v[84:87], a[252:255], v[60:63], v[84:87]
    ds_read_b128 v[60:63], v8 offset:6144
    s_waitcnt lgkmcnt(3)
    v_mfma_f32_16x16x32_bf16 v[40:43], v[48:51], v[128:131], 0
    v_mfma_f32_16x16x32_bf16 v[44:47], v[48:51], v[132:135], 0
    ds_read_b128 v[48:51], v8 offset:512
    s_waitcnt lgkmcnt(3)
    v_mfma_f32_16x16x32_bf16 v[40:43], v[52:55], v[136:139], v[40:43]
    v_mfma_f32_16x16x32_bf16 v[44:47], v[52:55], v[140:143], v[44:47]
    ds_read_b128 v[52:55], v8 offset:2560
    s_waitcnt lgkmcnt(3)
    v_mfma_f32_16x16x32_bf16 v[40:43], v[56:59], v[144:147], v[40:43]
    v_mfma_f32_16x16x32_bf16 v[44:47], v[56:59], v[148:151], v[44:47]
    v_mul_f32 v80, s33, v80
    v_mul_f32 v81, s33, v81
    v_mul_f32 v82, s33, v82
    v_mul_f32 v83, s33, v83
    ds_read_b128 v[56:59], v8 offset:4608
    s_waitcnt lgkmcnt(3)
    v_mfma_f32_16x16x32_bf16 v[40:43], v[60:63], v[152:155], v[40:43]
    v_mfma_f32_16x16x32_bf16 v[44:47], v[60:63], v[156:159], v[44:47]
    v_mul_f32 v84, s33, v84
    v_mul_f32 v85, s33, v85
    v_mul_f32 v86, s33, v86
    v_mul_f32 v87, s33, v87
    ds_read_b128 v[60:63], v8 offset:6656
    s_waitcnt lgkmcnt(3)
    v_mfma_f32_16x16x32_bf16 v[40:43], v[48:51], v[160:163], v[40:43]
    v_mfma_f32_16x16x32_bf16 v[44:47], v[48:51], v[164:167], v[44:47]
    v_cvt_pk_bf16_f32 v88, v80, v84
    v_cvt_pk_bf16_f32 v89, v81, v85
    v_cvt_pk_bf16_f32 v90, v82, v86
    v_cvt_pk_bf16_f32 v91, v83, v87
    ds_write_b128 v9, v[88:91] offset:16384
    ds_read_b128 v[48:51], v8 offset:1024
    s_waitcnt lgkmcnt(4)
    v_mfma_f32_16x16x32_bf16 v[40:43], v[52:55], v[168:171], v[40:43]
    v_mfma_f32_16x16x32_bf16 v[44:47], v[52:55], v[172:175], v[44:47]
    ds_read_b128 v[52:55], v8 offset:3072
    s_waitcnt lgkmcnt(4)
    v_mfma_f32_16x16x32_bf16 v[40:43], v[56:59], v[176:179], v[40:43]
    v_mfma_f32_16x16x32_bf16 v[44:47], v[56:59], v[180:183], v[44:47]
    ds_read_b128 v[56:59], v8 offset:5120
    s_waitcnt lgkmcnt(4)
    v_mfma_f32_16x16x32_bf16 v[40:43], v[60:63], v[184:187], v[40:43]
    v_mfma_f32_16x16x32_bf16 v[44:47], v[60:63], v[188:191], v[44:47]
    s_waitcnt lgkmcnt(3)
    s_barrier
    ds_read_b128 v[64:67], v1 offset:16384
    ds_read_b128 v[68:71], v1 offset:17408
    ds_read_b128 v[72:75], v1 offset:18432
    ds_read_b128 v[76:79], v1 offset:19456
    ds_read_b128 v[60:63], v8 offset:7168
    s_waitcnt lgkmcnt(7)
    v_mfma_f32_16x16x32_bf16 v[40:43], v[48:51], v[192:195], v[40:43]
    v_mfma_f32_16x16x32_bf16 v[44:47], v[48:51], v[196:199], v[44:47]
    ds_read_b128 v[48:51], v8 offset:1536
    s_waitcnt lgkmcnt(7)
    v_mfma_f32_16x16x32_bf16 v[40:43], v[52:55], v[200:203], v[40:43]
    v_mfma_f32_16x16x32_bf16 v[44:47], v[52:55], v[204:207], v[44:47]
    s_waitcnt lgkmcnt(2)
    v_mfma_f32_16x16x32_bf16 v[92:95], v[64:67], a[0:3], 0
    v_mfma_f32_16x16x32_bf16 v[96:99], v[64:67], a[16:19], 0
    v_mfma_f32_16x16x32_bf16 v[92:95], v[68:71], a[4:7], v[92:95]
    v_mfma_f32_16x16x32_bf16 v[96:99], v[68:71], a[20:23], v[96:99]
    v_mfma_f32_16x16x32_bf16 v[92:95], v[72:75], a[8:11], v[92:95]
    v_mfma_f32_16x16x32_bf16 v[96:99], v[72:75], a[24:27], v[96:99]
    v_mfma_f32_16x16x32_bf16 v[92:95], v[76:79], a[12:15], v[92:95]
    v_mfma_f32_16x16x32_bf16 v[96:99], v[76:79], a[28:31], v[96:99]
    ds_read_b128 v[52:55], v8 offset:3584
    s_waitcnt lgkmcnt(3)
    v_mfma_f32_16x16x32_bf16 v[40:43], v[56:59], v[208:211], v[40:43]
    v_mfma_f32_16x16x32_bf16 v[44:47], v[56:59], v[212:215], v[44:47]
    ds_read_b128 v[56:59], v8 offset:5632
    s_waitcnt lgkmcnt(3)
    v_mfma_f32_16x16x32_bf16 v[40:43], v[60:63], v[216:219], v[40:43]
    v_mfma_f32_16x16x32_bf16 v[44:47], v[60:63], v[220:223], v[44:47]
    v_max3_f32 v118, v92, v93, v94
    v_max3_f32 v118, v118, v95, v116
    v_max3_f32 v119, v96, v97, v98
    v_max3_f32 v119, v119, v99, v117
    v_mov_b32 v14, v118
    v_mov_b32 v15, v119
    ds_read_b128 v[60:63], v8 offset:7680
    s_waitcnt lgkmcnt(3)
    v_mfma_f32_16x16x32_bf16 v[40:43], v[48:51], v[224:227], v[40:43]
    v_mfma_f32_16x16x32_bf16 v[44:47], v[48:51], v[228:231], v[44:47]
    v_permlane16_swap_b32 v118, v14
    v_permlane16_swap_b32 v119, v15
    v_max_f32 v118, v118, v14
    v_max_f32 v119, v119, v15
    v_sub_f32 v92, v92, v118
    v_exp_f32 v92, v92
    s_waitcnt lgkmcnt(2)
    v_mfma_f32_16x16x32_bf16 v[40:43], v[52:55], v[232:235], v[40:43]
    v_mfma_f32_16x16x32_bf16 v[44:47], v[52:55], v[236:239], v[44:47]
    v_sub_f32 v93, v93, v118
    v_exp_f32 v93, v93
    v_sub_f32 v94, v94, v118
    v_exp_f32 v94, v94
    v_sub_f32 v95, v95, v118
    v_exp_f32 v95, v95
    s_waitcnt lgkmcnt(1)
    v_mfma_f32_16x16x32_bf16 v[40:43], v[56:59], v[240:243], v[40:43]
    v_mfma_f32_16x16x32_bf16 v[44:47], v[56:59], v[244:247], v[44:47]
    v_sub_f32 v104, v116, v118
    v_exp_f32 v104, v104
    v_cvt_pk_bf16_f32 v100, v92, v93
    v_cvt_pk_bf16_f32 v101, v94, v95
    v_sub_f32 v96, v96, v119
    v_exp_f32 v96, v96
    s_waitcnt lgkmcnt(0)
    v_mfma_f32_16x16x32_bf16 v[40:43], v[60:63], v[248:251], v[40:43]
    v_mfma_f32_16x16x32_bf16 v[44:47], v[60:63], v[252:255], v[44:47]
    v_sub_f32 v97, v97, v119
    v_exp_f32 v97, v97
    v_sub_f32 v98, v98, v119
    v_exp_f32 v98, v98
    v_sub_f32 v99, v99, v119
    v_exp_f32 v99, v99
    v_sub_f32 v105, v117, v119
    v_exp_f32 v105, v105
    v_cvt_pk_bf16_f32 v102, v96, v97
    v_cvt_pk_bf16_f32 v103, v98, v99
    v_mfma_f32_16x16x16_bf16 v[48:51], v[112:113], v[100:101], 0
    s_nop 0
    v_mfma_f32_16x16x16_bf16 v[52:55], v[112:113], v[102:103], 0
    v_cvt_pk_bf16_f32 v80, v40, v41
    v_cndmask_b32 v80, 0, v80, s[72:73]
    v_cvt_pk_bf16_f32 v81, v42, v43
    v_cndmask_b32 v81, 0, v81, s[72:73]
    v_cvt_pk_bf16_f32 v82, v44, v45
    v_cndmask_b32 v82, 0, v82, s[72:73]
    v_cvt_pk_bf16_f32 v83, v46, v47
    v_cndmask_b32 v83, 0, v83, s[72:73]
    v_mfma_f32_16x16x16_bf16 v[56:59], v[80:81], v[100:101], 0
    s_nop 0
    v_mfma_f32_16x16x16_bf16 v[60:63], v[82:83], v[100:101], 0
    v_mfma_f32_16x16x16_bf16 v[64:67], v[80:81], v[102:103], 0
    v_mfma_f32_16x16x16_bf16 v[68:71], v[82:83], v[102:103], 0
    v_fma_f32 v48, v16, v104, v48
    v_rcp_f32 v48, v48
    v_fma_f32 v52, v20, v105, v52
    v_rcp_f32 v52, v52
    v_fma_f32 v56, v24, v104, v56
    v_fma_f32 v57, v25, v104, v57
    v_fma_f32 v58, v26, v104, v58
    v_fma_f32 v59, v27, v104, v59
    v_fma_f32 v60, v28, v104, v60
    v_fma_f32 v61, v29, v104, v61
    v_fma_f32 v62, v30, v104, v62
    v_fma_f32 v63, v31, v104, v63
    v_pk_mul_f32 v[56:57], v[56:57], v[48:49] op_sel_hi:[1,0]
    v_pk_mul_f32 v[58:59], v[58:59], v[48:49] op_sel_hi:[1,0]
    v_pk_mul_f32 v[60:61], v[60:61], v[48:49] op_sel_hi:[1,0]
    v_pk_mul_f32 v[62:63], v[62:63], v[48:49] op_sel_hi:[1,0]
    v_cvt_pk_bf16_f32 v72, v56, v60
    v_cvt_pk_bf16_f32 v73, v57, v61
    v_cvt_pk_bf16_f32 v74, v58, v62
    v_cvt_pk_bf16_f32 v75, v59, v63
    ds_write_b128 v9, v[72:75] offset:0
    v_fma_f32 v64, v32, v105, v64
    v_fma_f32 v65, v33, v105, v65
    v_fma_f32 v66, v34, v105, v66
    v_fma_f32 v67, v35, v105, v67
    v_fma_f32 v68, v36, v105, v68
    v_fma_f32 v69, v37, v105, v69
    v_fma_f32 v70, v38, v105, v70
    v_fma_f32 v71, v39, v105, v71
    v_pk_mul_f32 v[64:65], v[64:65], v[52:53] op_sel_hi:[1,0]
    v_pk_mul_f32 v[66:67], v[66:67], v[52:53] op_sel_hi:[1,0]
    v_pk_mul_f32 v[68:69], v[68:69], v[52:53] op_sel_hi:[1,0]
    v_pk_mul_f32 v[70:71], v[70:71], v[52:53] op_sel_hi:[1,0]
    v_cvt_pk_bf16_f32 v76, v64, v68
    v_cvt_pk_bf16_f32 v77, v65, v69
    v_cvt_pk_bf16_f32 v78, v66, v70
    v_cvt_pk_bf16_f32 v79, v67, v71
    ds_write_b128 v9, v[76:79] offset:4096
    s_waitcnt lgkmcnt(0)
    s_barrier
    ds_read_b128 v[16:19], v1 offset:0
    ds_read_b128 v[20:23], v1 offset:1024
    ds_read_b128 v[24:27], v1 offset:2048
    ds_read_b128 v[28:31], v1 offset:3072
    ds_read_b128 v[32:35], v1 offset:4096
    ds_read_b128 v[36:39], v1 offset:5120
    ds_read_b128 v[40:43], v1 offset:6144
    ds_read_b128 v[44:47], v1 offset:7168
    ds_read_b128 v[48:51], v7 offset:0
    ds_read_b128 v[52:55], v7 offset:1024
    ds_read_b128 v[56:59], v7 offset:2048
    s_lshl_b32 s36, s20, 10
    s_add_u32 s25, s26, s36
    s_waitcnt lgkmcnt(2)
    v_mfma_f32_16x16x32_bf16 v[64:67], v[16:19], v[48:51], 0
    ds_read_b128 v[60:63], v7 offset:3072
    s_waitcnt lgkmcnt(2)
    v_mfma_f32_16x16x32_bf16 v[68:71], v[16:19], v[52:55], 0
    ds_read_b128 v[48:51], v7 offset:4096
    s_waitcnt lgkmcnt(2)
    v_mfma_f32_16x16x32_bf16 v[72:75], v[16:19], v[56:59], 0
    ds_read_b128 v[52:55], v7 offset:5120
    s_waitcnt lgkmcnt(2)
    v_mfma_f32_16x16x32_bf16 v[76:79], v[16:19], v[60:63], 0
    ds_read_b128 v[56:59], v7 offset:6144
    s_waitcnt lgkmcnt(2)
    v_mfma_f32_16x16x32_bf16 v[80:83], v[16:19], v[48:51], 0
    ds_read_b128 v[60:63], v7 offset:7168
    s_waitcnt lgkmcnt(2)
    v_mfma_f32_16x16x32_bf16 v[84:87], v[16:19], v[52:55], 0
    ds_read_b128 v[48:51], v7 offset:8192
    s_waitcnt lgkmcnt(2)
    v_mfma_f32_16x16x32_bf16 v[88:91], v[16:19], v[56:59], 0
    ds_read_b128 v[52:55], v7 offset:9216
    s_waitcnt lgkmcnt(2)
    v_mfma_f32_16x16x32_bf16 v[92:95], v[16:19], v[60:63], 0
    ds_read_b128 v[56:59], v7 offset:10240
    s_waitcnt lgkmcnt(2)
    v_mfma_f32_16x16x32_bf16 v[64:67], v[20:23], v[48:51], v[64:67]
    ds_read_b128 v[60:63], v7 offset:11264
    s_waitcnt lgkmcnt(2)
    v_mfma_f32_16x16x32_bf16 v[68:71], v[20:23], v[52:55], v[68:71]
    ds_read_b128 v[48:51], v7 offset:12288
    s_waitcnt lgkmcnt(2)
    v_mfma_f32_16x16x32_bf16 v[72:75], v[20:23], v[56:59], v[72:75]
    ds_read_b128 v[52:55], v7 offset:13312
    s_waitcnt lgkmcnt(2)
    v_mfma_f32_16x16x32_bf16 v[76:79], v[20:23], v[60:63], v[76:79]
    ds_read_b128 v[56:59], v7 offset:14336
    s_waitcnt lgkmcnt(2)
    v_mfma_f32_16x16x32_bf16 v[80:83], v[20:23], v[48:51], v[80:83]
    ds_read_b128 v[60:63], v7 offset:15360
    s_waitcnt lgkmcnt(2)
    v_mfma_f32_16x16x32_bf16 v[84:87], v[20:23], v[52:55], v[84:87]
    ds_read_b128 v[48:51], v7 offset:16384
    s_waitcnt lgkmcnt(2)
    v_mfma_f32_16x16x32_bf16 v[88:91], v[20:23], v[56:59], v[88:91]
    ds_read_b128 v[52:55], v7 offset:17408
    s_waitcnt lgkmcnt(2)
    v_mfma_f32_16x16x32_bf16 v[92:95], v[20:23], v[60:63], v[92:95]
    ds_read_b128 v[56:59], v7 offset:18432
    s_waitcnt lgkmcnt(2)
    v_mfma_f32_16x16x32_bf16 v[64:67], v[24:27], v[48:51], v[64:67]
    ds_read_b128 v[60:63], v7 offset:19456
    s_waitcnt lgkmcnt(2)
    v_mfma_f32_16x16x32_bf16 v[68:71], v[24:27], v[52:55], v[68:71]
    ds_read_b128 v[48:51], v7 offset:20480
    s_waitcnt lgkmcnt(2)
    v_mfma_f32_16x16x32_bf16 v[72:75], v[24:27], v[56:59], v[72:75]
    ds_read_b128 v[52:55], v7 offset:21504
    s_waitcnt lgkmcnt(2)
    v_mfma_f32_16x16x32_bf16 v[76:79], v[24:27], v[60:63], v[76:79]
    ds_read_b128 v[56:59], v7 offset:22528
    s_waitcnt lgkmcnt(2)
    v_mfma_f32_16x16x32_bf16 v[80:83], v[24:27], v[48:51], v[80:83]
    ds_read_b128 v[60:63], v7 offset:23552
    s_waitcnt lgkmcnt(2)
    v_mfma_f32_16x16x32_bf16 v[84:87], v[24:27], v[52:55], v[84:87]
    ds_read_b128 v[48:51], v7 offset:24576
    s_waitcnt lgkmcnt(2)
    v_mfma_f32_16x16x32_bf16 v[88:91], v[24:27], v[56:59], v[88:91]
    ds_read_b128 v[52:55], v7 offset:25600
    s_waitcnt lgkmcnt(2)
    v_mfma_f32_16x16x32_bf16 v[92:95], v[24:27], v[60:63], v[92:95]
    ds_read_b128 v[56:59], v7 offset:26624
    s_waitcnt lgkmcnt(2)
    v_mfma_f32_16x16x32_bf16 v[64:67], v[28:31], v[48:51], v[64:67]
    ds_read_b128 v[60:63], v7 offset:27648
    s_waitcnt lgkmcnt(2)
    v_mfma_f32_16x16x32_bf16 v[68:71], v[28:31], v[52:55], v[68:71]
    ds_read_b128 v[48:51], v7 offset:28672
    s_waitcnt lgkmcnt(2)
    v_mfma_f32_16x16x32_bf16 v[72:75], v[28:31], v[56:59], v[72:75]
    ds_read_b128 v[52:55], v7 offset:29696
    s_waitcnt lgkmcnt(2)
    v_mfma_f32_16x16x32_bf16 v[76:79], v[28:31], v[60:63], v[76:79]
    ds_read_b128 v[56:59], v7 offset:30720
    s_waitcnt lgkmcnt(2)
    v_mfma_f32_16x16x32_bf16 v[80:83], v[28:31], v[48:51], v[80:83]
    ds_read_b128 v[60:63], v7 offset:31744
    s_waitcnt lgkmcnt(2)
    v_mfma_f32_16x16x32_bf16 v[84:87], v[28:31], v[52:55], v[84:87]
    ds_read_b128 v[48:51], v7 offset:0
    s_waitcnt lgkmcnt(2)
    v_mfma_f32_16x16x32_bf16 v[88:91], v[28:31], v[56:59], v[88:91]
    ds_read_b128 v[52:55], v7 offset:1024
    s_waitcnt lgkmcnt(2)
    v_mfma_f32_16x16x32_bf16 v[92:95], v[28:31], v[60:63], v[92:95]
    ds_read_b128 v[56:59], v7 offset:2048
    s_waitcnt lgkmcnt(2)
    v_mfma_f32_16x16x32_bf16 v[96:99], v[32:35], v[48:51], 0
    ds_read_b128 v[60:63], v7 offset:3072
    s_waitcnt lgkmcnt(2)
    v_mfma_f32_16x16x32_bf16 v[100:103], v[32:35], v[52:55], 0
    ds_read_b128 v[48:51], v7 offset:4096
    s_waitcnt lgkmcnt(2)
    v_mfma_f32_16x16x32_bf16 v[104:107], v[32:35], v[56:59], 0
    ds_read_b128 v[52:55], v7 offset:5120
    s_waitcnt lgkmcnt(2)
    v_mfma_f32_16x16x32_bf16 v[108:111], v[32:35], v[60:63], 0
    ds_read_b128 v[56:59], v7 offset:6144
    v_cvt_pk_bf16_f32 v16, v64, v68
    s_waitcnt lgkmcnt(2)
    v_mfma_f32_16x16x32_bf16 v[112:115], v[32:35], v[48:51], 0
    ds_read_b128 v[60:63], v7 offset:7168
    v_cvt_pk_bf16_f32 v17, v72, v76
    s_waitcnt lgkmcnt(2)
    v_mfma_f32_16x16x32_bf16 v[116:119], v[32:35], v[52:55], 0
    ds_read_b128 v[48:51], v7 offset:8192
    v_cvt_pk_bf16_f32 v18, v80, v84
    s_waitcnt lgkmcnt(2)
    v_mfma_f32_16x16x32_bf16 v[120:123], v[32:35], v[56:59], 0
    ds_read_b128 v[52:55], v7 offset:9216
    v_cvt_pk_bf16_f32 v19, v88, v92
    s_waitcnt lgkmcnt(2)
    v_mfma_f32_16x16x32_bf16 v[124:127], v[32:35], v[60:63], 0
    ds_read_b128 v[56:59], v7 offset:10240
    v_and_or_b32 v16, v16, -2, s27
    s_waitcnt lgkmcnt(2)
    v_mfma_f32_16x16x32_bf16 v[96:99], v[36:39], v[48:51], v[96:99]
    ds_read_b128 v[60:63], v7 offset:11264
    s_add_u32 s36, s25, 0x0
    s_waitcnt lgkmcnt(2)
    v_mfma_f32_16x16x32_bf16 v[100:103], v[36:39], v[52:55], v[100:103]
    ds_read_b128 v[48:51], v7 offset:12288
    buffer_store_dwordx4 v[16:19], v10, s[8:11], s36 offen sc1
    s_waitcnt lgkmcnt(2)
    v_mfma_f32_16x16x32_bf16 v[104:107], v[36:39], v[56:59], v[104:107]
    ds_read_b128 v[52:55], v7 offset:13312
    v_cvt_pk_bf16_f32 v20, v65, v69
    s_waitcnt lgkmcnt(2)
    v_mfma_f32_16x16x32_bf16 v[108:111], v[36:39], v[60:63], v[108:111]
    ds_read_b128 v[56:59], v7 offset:14336
    v_cvt_pk_bf16_f32 v21, v73, v77
    s_waitcnt lgkmcnt(2)
    v_mfma_f32_16x16x32_bf16 v[112:115], v[36:39], v[48:51], v[112:115]
    ds_read_b128 v[60:63], v7 offset:15360
    v_cvt_pk_bf16_f32 v22, v81, v85
    s_waitcnt lgkmcnt(2)
    v_mfma_f32_16x16x32_bf16 v[116:119], v[36:39], v[52:55], v[116:119]
    ds_read_b128 v[48:51], v7 offset:16384
    v_cvt_pk_bf16_f32 v23, v89, v93
    s_waitcnt lgkmcnt(2)
    v_mfma_f32_16x16x32_bf16 v[120:123], v[36:39], v[56:59], v[120:123]
    ds_read_b128 v[52:55], v7 offset:17408
    v_and_or_b32 v20, v20, -2, s27
    s_waitcnt lgkmcnt(2)
    v_mfma_f32_16x16x32_bf16 v[124:127], v[36:39], v[60:63], v[124:127]
    ds_read_b128 v[56:59], v7 offset:18432
    s_add_u32 s36, s25, 0x8000
    s_waitcnt lgkmcnt(2)
    v_mfma_f32_16x16x32_bf16 v[96:99], v[40:43], v[48:51], v[96:99]
    ds_read_b128 v[60:63], v7 offset:19456
    buffer_store_dwordx4 v[20:23], v10, s[8:11], s36 offen sc1
    s_waitcnt lgkmcnt(2)
    v_mfma_f32_16x16x32_bf16 v[100:103], v[40:43], v[52:55], v[100:103]
    ds_read_b128 v[48:51], v7 offset:20480
    v_cvt_pk_bf16_f32 v24, v66, v70
    s_waitcnt lgkmcnt(2)
    v_mfma_f32_16x16x32_bf16 v[104:107], v[40:43], v[56:59], v[104:107]
    ds_read_b128 v[52:55], v7 offset:21504
    v_cvt_pk_bf16_f32 v25, v74, v78
    s_waitcnt lgkmcnt(2)
    v_mfma_f32_16x16x32_bf16 v[108:111], v[40:43], v[60:63], v[108:111]
    ds_read_b128 v[56:59], v7 offset:22528
    v_cvt_pk_bf16_f32 v26, v82, v86
    s_waitcnt lgkmcnt(2)
    v_mfma_f32_16x16x32_bf16 v[112:115], v[40:43], v[48:51], v[112:115]
    ds_read_b128 v[60:63], v7 offset:23552
    v_cvt_pk_bf16_f32 v27, v90, v94
    s_waitcnt lgkmcnt(2)
    v_mfma_f32_16x16x32_bf16 v[116:119], v[40:43], v[52:55], v[116:119]
    ds_read_b128 v[48:51], v7 offset:24576
    v_and_or_b32 v24, v24, -2, s27
    s_waitcnt lgkmcnt(2)
    v_mfma_f32_16x16x32_bf16 v[120:123], v[40:43], v[56:59], v[120:123]
    ds_read_b128 v[52:55], v7 offset:25600
    s_add_u32 s36, s25, 0x10000
    s_waitcnt lgkmcnt(2)
    v_mfma_f32_16x16x32_bf16 v[124:127], v[40:43], v[60:63], v[124:127]
    ds_read_b128 v[56:59], v7 offset:26624
    buffer_store_dwordx4 v[24:27], v10, s[8:11], s36 offen sc1
    s_waitcnt lgkmcnt(2)
    v_mfma_f32_16x16x32_bf16 v[96:99], v[44:47], v[48:51], v[96:99]
    ds_read_b128 v[60:63], v7 offset:27648
    v_cvt_pk_bf16_f32 v28, v67, v71
    s_waitcnt lgkmcnt(2)
    v_mfma_f32_16x16x32_bf16 v[100:103], v[44:47], v[52:55], v[100:103]
    ds_read_b128 v[48:51], v7 offset:28672
    v_cvt_pk_bf16_f32 v29, v75, v79
    s_waitcnt lgkmcnt(2)
    v_mfma_f32_16x16x32_bf16 v[104:107], v[44:47], v[56:59], v[104:107]
    ds_read_b128 v[52:55], v7 offset:29696
    v_cvt_pk_bf16_f32 v30, v83, v87
    s_waitcnt lgkmcnt(2)
    v_mfma_f32_16x16x32_bf16 v[108:111], v[44:47], v[60:63], v[108:111]
    ds_read_b128 v[56:59], v7 offset:30720
    v_cvt_pk_bf16_f32 v31, v91, v95
    s_waitcnt lgkmcnt(2)
    v_mfma_f32_16x16x32_bf16 v[112:115], v[44:47], v[48:51], v[112:115]
    ds_read_b128 v[60:63], v7 offset:31744
    v_and_or_b32 v28, v28, -2, s27
    s_waitcnt lgkmcnt(2)
    v_mfma_f32_16x16x32_bf16 v[116:119], v[44:47], v[52:55], v[116:119]
    s_add_u32 s36, s25, 0x18000
    s_waitcnt lgkmcnt(1)
    v_mfma_f32_16x16x32_bf16 v[120:123], v[44:47], v[56:59], v[120:123]
    buffer_store_dwordx4 v[28:31], v10, s[8:11], s36 offen sc1
    s_waitcnt lgkmcnt(0)
    v_mfma_f32_16x16x32_bf16 v[124:127], v[44:47], v[60:63], v[124:127]
    v_cvt_pk_bf16_f32 v32, v96, v100
    v_cvt_pk_bf16_f32 v33, v104, v108
    v_cvt_pk_bf16_f32 v34, v112, v116
    s_nop 4
    v_cvt_pk_bf16_f32 v35, v120, v124
    v_and_or_b32 v32, v32, -2, s27
    s_add_u32 s36, s25, 0x80000
    buffer_store_dwordx4 v[32:35], v10, s[8:11], s36 offen sc1
    v_cvt_pk_bf16_f32 v36, v97, v101
    v_cvt_pk_bf16_f32 v37, v105, v109
    v_cvt_pk_bf16_f32 v38, v113, v117
    v_cvt_pk_bf16_f32 v39, v121, v125
    v_and_or_b32 v36, v36, -2, s27
    s_add_u32 s36, s25, 0x88000
    buffer_store_dwordx4 v[36:39], v10, s[8:11], s36 offen sc1
    v_cvt_pk_bf16_f32 v40, v98, v102
    v_cvt_pk_bf16_f32 v41, v106, v110
    v_cvt_pk_bf16_f32 v42, v114, v118
    v_cvt_pk_bf16_f32 v43, v122, v126
    v_and_or_b32 v40, v40, -2, s27
    s_add_u32 s36, s25, 0x90000
    buffer_store_dwordx4 v[40:43], v10, s[8:11], s36 offen sc1
    v_cvt_pk_bf16_f32 v44, v99, v103
    v_cvt_pk_bf16_f32 v45, v107, v111
    v_cvt_pk_bf16_f32 v46, v115, v119
    v_cvt_pk_bf16_f32 v47, v123, v127
    v_and_or_b32 v44, v44, -2, s27
    s_add_u32 s36, s25, 0x98000
    buffer_store_dwordx4 v[44:47], v10, s[8:11], s36 offen sc1
    s_add_u32 s38, s23, 6
    s_cmp_ge_u32 s38, 64
    s_cbranch_scc1 L_P2_last
    s_mul_i32 s24, s38, 0x82000
    s_lshl_b32 s36, s20, 14
    s_add_u32 s24, s24, s36
    s_add_u32 s24, s24, 0x1000000
    s_add_u32 s36, s24, 0
    s_add_u32 s37, s36, 0x7000000
    buffer_load_dwordx4 a[32:35], v1, s[8:11], s36 offen offset:0 sc1
    buffer_load_dwordx4 a[0:3], v1, s[8:11], s37 offen offset:0 sc1
    buffer_load_dwordx4 a[36:39], v1, s[8:11], s36 offen offset:1024 sc1
    buffer_load_dwordx4 a[4:7], v1, s[8:11], s37 offen offset:1024 sc1
    buffer_load_dwordx4 a[40:43], v1, s[8:11], s36 offen offset:2048 sc1
    buffer_load_dwordx4 a[8:11], v1, s[8:11], s37 offen offset:2048 sc1
    buffer_load_dwordx4 a[44:47], v1, s[8:11], s36 offen offset:3072 sc1
    buffer_load_dwordx4 a[12:15], v1, s[8:11], s37 offen offset:3072 sc1
    s_add_u32 s36, s24, 4096
    s_add_u32 s37, s36, 0x7000000
    buffer_load_dwordx4 a[48:51], v1, s[8:11], s36 offen offset:0 sc1
    buffer_load_dwordx4 a[16:19], v1, s[8:11], s37 offen offset:0 sc1
    buffer_load_dwordx4 a[52:55], v1, s[8:11], s36 offen offset:1024 sc1
    buffer_load_dwordx4 a[20:23], v1, s[8:11], s37 offen offset:1024 sc1
    buffer_load_dwordx4 a[56:59], v1, s[8:11], s36 offen offset:2048 sc1
    buffer_load_dwordx4 a[24:27], v1, s[8:11], s37 offen offset:2048 sc1
    buffer_load_dwordx4 a[60:63], v1, s[8:11], s36 offen offset:3072 sc1
    buffer_load_dwordx4 a[28:31], v1, s[8:11], s37 offen offset:3072 sc1
    s_lshr_b32 s36, s21, 1
    s_lshl_b32 s36, s36, 3
    s_xor_b32 s37, s36, 8
    s_add_u32 s24, s24, 8192
    s_add_u32 s36, s36, s24
    s_add_u32 s37, s37, s24
    buffer_load_dwordx2 a[64:65], v2, s[8:11], s36 offen offset:0 sc1
    buffer_load_dwordx2 a[66:67], v2, s[8:11], s37 offen offset:0 sc1
    buffer_load_dwordx2 a[68:69], v2, s[8:11], s36 offen offset:1024 sc1
    buffer_load_dwordx2 a[70:71], v2, s[8:11], s37 offen offset:1024 sc1
L_P2_last:
    s_lshl_b32 s24, s23, 5
    s_add_u32 s24, s24, s20
    s_lshl_b32 s24, s24, 10
    v_accvgpr_read_b32 v52, a72
    v_accvgpr_read_b32 v53, a73
    v_and_b32 v15, 15, v0
    v_mov_b32 v48, 0
    v_mov_b32 v14, 0x3f80
    v_cmp_eq_u32 vcc, 0, v15
    s_nop 1
    v_cndmask_b32 v48, v48, v14, vcc
    v_mov_b32 v14, 0x3f800000
    v_cmp_eq_u32 vcc, 1, v15
    s_nop 1
    v_cndmask_b32 v48, v48, v14, vcc
    v_mov_b32 v49, 0
    v_mov_b32 v14, 0x3f80
    v_cmp_eq_u32 vcc, 4, v15
    s_nop 1
    v_cndmask_b32 v49, v49, v14, vcc
    v_mov_b32 v14, 0x3f800000
    v_cmp_eq_u32 vcc, 5, v15
    s_nop 1
    v_cndmask_b32 v49, v49, v14, vcc
    v_mov_b32 v50, 0
    v_mov_b32 v14, 0x3f80
    v_cmp_eq_u32 vcc, 8, v15
    s_nop 1
    v_cndmask_b32 v50, v50, v14, vcc
    v_mov_b32 v14, 0x3f800000
    v_cmp_eq_u32 vcc, 9, v15
    s_nop 1
    v_cndmask_b32 v50, v50, v14, vcc
    v_mov_b32 v51, 0
    v_mov_b32 v14, 0x3f80
    v_cmp_eq_u32 vcc, 12, v15
    s_nop 1
    v_cndmask_b32 v51, v51, v14, vcc
    v_mov_b32 v14, 0x3f800000
    v_cmp_eq_u32 vcc, 13, v15
    s_nop 1
    v_cndmask_b32 v51, v51, v14, vcc
    s_lshl_b32 s25, s20, 15
    s_add_u32 s25, s25, s26
L_P3_poll:
    s_add_u32 s36, s25, 0
    buffer_load_dwordx4 v[80:83], v11, s[8:11], s36 offen sc1
    s_add_u32 s36, s25, 4096
    buffer_load_dwordx4 v[84:87], v11, s[8:11], s36 offen sc1
    s_add_u32 s36, s25, 8192
    buffer_load_dwordx4 v[88:91], v11, s[8:11], s36 offen sc1
    s_add_u32 s36, s25, 12288
    buffer_load_dwordx4 v[92:95], v11, s[8:11], s36 offen sc1
    s_add_u32 s36, s25, 16384
    buffer_load_dwordx4 v[96:99], v11, s[8:11], s36 offen sc1
    s_add_u32 s36, s25, 20480
    buffer_load_dwordx4 v[100:103], v11, s[8:11], s36 offen sc1
    s_add_u32 s36, s25, 24576
    buffer_load_dwordx4 v[104:107], v11, s[8:11], s36 offen sc1
    s_add_u32 s36, s25, 28672
    buffer_load_dwordx4 v[108:111], v11, s[8:11], s36 offen sc1
    s_mov_b64 exec, -1
    s_add_u32 s32, s32, 1
    s_cmp_gt_u32 s32, 200000
    s_waitcnt vmcnt(7)
    v_mfma_f32_16x16x32_bf16 v[56:59], v[48:51], v[80:83], 0
    s_waitcnt vmcnt(6)
    v_mfma_f32_16x16x32_bf16 v[56:59], v[48:51], v[84:87], v[56:59]
    v_bitop3_b32 v60, v80, v84, s27 bitop3:0x7e
    s_waitcnt vmcnt(5)
    v_mfma_f32_16x16x32_bf16 v[56:59], v[48:51], v[88:91], v[56:59]
    s_waitcnt vmcnt(4)
    v_mfma_f32_16x16x32_bf16 v[56:59], v[48:51], v[92:95], v[56:59]
    v_bitop3_b32 v61, v88, v92, s27 bitop3:0x7e
    s_waitcnt vmcnt(3)
    v_mfma_f32_16x16x32_bf16 v[56:59], v[48:51], v[96:99], v[56:59]
    s_waitcnt vmcnt(2)
    v_mfma_f32_16x16x32_bf16 v[56:59], v[48:51], v[100:103], v[56:59]
    v_bitop3_b32 v62, v96, v100, s27 bitop3:0x7e
    s_waitcnt vmcnt(1)
    v_mfma_f32_16x16x32_bf16 v[56:59], v[48:51], v[104:107], v[56:59]
    s_waitcnt vmcnt(0)
    v_mfma_f32_16x16x32_bf16 v[56:59], v[48:51], v[108:111], v[56:59]
    v_bitop3_b32 v63, v104, v108, s27 bitop3:0x7e
    v_or3_b32 v14, v60, v61, v62
    v_bitop3_b32 v14, v14, v63, 1 bitop3:0xa8
    s_cbranch_scc1 L_P3_got
    v_cmp_ne_u32 vcc, 0, v14
    s_cbranch_vccz L_P3_got
    s_mov_b64 exec, vcc
    s_branch L_P3_poll
L_P3_got:
    s_nop 4
    v_cvt_pk_bf16_f32 v62, v56, v57
    v_lshlrev_b32 v65, 16, v62
    v_and_b32 v66, 0xffff0000, v62
    v_lshlrev_b32 v60, 16, v52
    v_and_b32 v61, 0xffff0000, v52
    v_add_f32 v60, v60, v65
    v_add_f32 v61, v61, v66
    v_cvt_pk_bf16_f32 v62, v60, v61
    v_lshlrev_b32 v60, 16, v62
    v_and_b32 v61, 0xffff0000, v62
    v_add_f32 v63, v60, v61
    v_mul_f32 v64, v60, v60
    v_fmac_f32 v64, v61, v61
    v_add_f32_dpp v63, v63, v63 quad_perm:[1,0,3,2] row_mask:0xf bank_mask:0xf
    s_nop 0
    v_add_f32_dpp v64, v64, v64 quad_perm:[1,0,3,2] row_mask:0xf bank_mask:0xf
    v_add_f32_dpp v63, v63, v63 quad_perm:[2,3,0,1] row_mask:0xf bank_mask:0xf
    s_nop 0
    v_add_f32_dpp v64, v64, v64 quad_perm:[2,3,0,1] row_mask:0xf bank_mask:0xf
    v_add_f32_dpp v63, v63, v63 row_half_mirror row_mask:0xf bank_mask:0xf
    s_nop 0
    v_add_f32_dpp v64, v64, v64 row_half_mirror row_mask:0xf bank_mask:0xf
    v_add_f32_dpp v63, v63, v63 row_mirror row_mask:0xf bank_mask:0xf
    s_nop 0
    v_add_f32_dpp v64, v64, v64 row_mirror row_mask:0xf bank_mask:0xf
    v_mov_b32 v14, v63
    s_nop 1
    v_permlane16_swap_b32 v63, v14
    v_add_f32 v63, v63, v14
    v_mov_b32 v14, v64
    s_nop 1
    v_permlane16_swap_b32 v64, v14
    v_add_f32 v64, v64, v14
    v_mov_b32 v14, v63
    s_nop 1
    v_permlane32_swap_b32 v63, v14
    v_add_f32 v63, v63, v14
    v_mov_b32 v14, v64
    s_nop 1
    v_permlane32_swap_b32 v64, v14
    v_add_f32 v64, v64, v14
    v_mov_b32 v15, s21
    v_lshlrev_b32 v15, 3, v15
    v_add_u32 v15, 28672, v15
    ds_write2_b32 v15, v63, v64 offset0:0 offset1:1
    s_add_u32 s36, s24, 0x400000
    buffer_store_dword v62, v12, s[8:11], s36 offen sc1
    s_waitcnt lgkmcnt(0)
    s_barrier
    v_mov_b32 v15, 28672
    ds_read_b128 v[68:71], v15
    ds_read_b128 v[72:75], v15 offset:16
    s_waitcnt lgkmcnt(0)
    v_add_f32 v63, v68, v70
    v_add_f32 v63, v63, v72
    v_add_f32 v63, v63, v74
    v_mul_f32 v63, 0x3b000000, v63
    v_add_f32 v64, v69, v71
    v_add_f32 v64, v64, v73
    v_add_f32 v64, v64, v75
    v_mul_f32 v64, 0x3b000000, v64
    v_fma_f32 v64, -v63, v63, v64
    v_max_f32 v64, 0, v64
    v_cvt_pk_bf16_f32 v14, v63, v64
    v_lshlrev_b32 v63, 16, v14
    v_and_b32 v64, 0xffff0000, v14
    v_add_f32 v64, 0x3727c5ac, v64
    v_cvt_pk_bf16_f32 v14, v64, v64
    v_lshlrev_b32 v64, 16, v14
    v_sqrt_f32 v64, v64
    s_nop 0
    v_cvt_pk_bf16_f32 v14, v64, v64
    v_lshlrev_b32 v64, 16, v14
    v_rcp_f32 v64, v64
    v_sub_f32 v65, v60, v63
    v_sub_f32 v66, v61, v63
    v_cvt_pk_bf16_f32 v14, v65, v66
    v_lshlrev_b32 v65, 16, v14
    v_and_b32 v66, 0xffff0000, v14
    v_mul_f32 v65, v65, v64
    v_mul_f32 v66, v66, v64
    v_cvt_pk_bf16_f32 v67, v65, v66
    v_lshlrev_b32 v65, 16, v67
    v_and_b32 v66, 0xffff0000, v67
    v_lshlrev_b32 v68, 16, v53
    v_and_b32 v69, 0xffff0000, v53
    v_mul_f32 v63, v65, v68
    v_fmac_f32 v63, v66, v69
    s_nop 1
    v_add_f32_dpp v63, v63, v63 quad_perm:[1,0,3,2] row_mask:0xf bank_mask:0xf
    s_nop 1
    v_add_f32_dpp v63, v63, v63 quad_perm:[2,3,0,1] row_mask:0xf bank_mask:0xf
    s_nop 1
    v_add_f32_dpp v63, v63, v63 row_half_mirror row_mask:0xf bank_mask:0xf
    s_nop 1
    v_add_f32_dpp v63, v63, v63 row_mirror row_mask:0xf bank_mask:0xf
    v_mov_b32 v14, v63
    s_nop 1
    v_permlane16_swap_b32 v63, v14
    v_add_f32 v63, v63, v14
    v_mov_b32 v14, v63
    s_nop 1
    v_permlane32_swap_b32 v63, v14
    v_add_f32 v63, v63, v14
    s_lshr_b32 s25, s24, 6
    s_lshl_b32 s37, s21, 2
    s_add_u32 s25, s25, s37
    s_add_u32 s36, s25, 0x194000
    v_cmp_ne_u32 vcc, 0, v1
    v_mov_b32 v15, 0x40000000
    s_nop 0
    v_cndmask_b32 v15, v1, v15, vcc
    buffer_store_dword v63, v15, s[8:11], s36 offen sc1
    v_add_f32 v60, v60, v65
    v_add_f32 v61, v61, v66
    v_cvt_pk_bf16_f32 v62, v60, v61
    buffer_store_dword v62, v12, s[60:63], s24 offen sc1
    s_add_u32 s36, s24, 0x600000
    buffer_store_dword v67, v12, s[8:11], s36 offen sc1
    s_add_u32 s30, s25, 0x1b8000
    s_add_u32 s29, s29, 1
    s_barrier
    s_add_u32 s23, s23, 6
    s_cmp_lt_u32 s23, 64
    s_cbranch_scc1 L_P2
    s_waitcnt vmcnt(0)
    v_cmp_ne_u32 vcc, 0, v1
    v_mov_b32 v15, 0x40000000
    v_mov_b32 v14, 0
    v_cndmask_b32 v15, v1, v15, vcc
    buffer_store_dword v14, v15, s[8:11], s30 offen sc1
    s_branch L_end
L_mlp:
    s_lshr_b32 s23, s2, 3
    s_lshl_b32 s23, s23, 1
    s_lshl_b32 s36, s23, 15
    buffer_load_dwordx4 v[96:99], v3, s[12:15], s36 offen offset:0
    buffer_load_dwordx4 v[100:103], v3, s[12:15], s36 offen offset:128
    buffer_load_dwordx4 v[104:107], v3, s[12:15], s36 offen offset:256
    buffer_load_dwordx4 v[108:111], v3, s[12:15], s36 offen offset:384
    buffer_load_dwordx4 v[112:115], v3, s[12:15], s36 offen offset:512
    buffer_load_dwordx4 v[116:119], v3, s[12:15], s36 offen offset:640
    buffer_load_dwordx4 v[120:123], v3, s[12:15], s36 offen offset:768
    buffer_load_dwordx4 v[124:127], v3, s[12:15], s36 offen offset:896
    s_waitcnt vmcnt(0)
    v_mov_b32 v16, 0
    v_mov_b32 v17, 0
    v_dot2_f32_bf16 v16, v96, s4, v16
    v_dot2_f32_bf16 v17, v96, v96, v17
    v_dot2_f32_bf16 v16, v97, s4, v16
    v_dot2_f32_bf16 v17, v97, v97, v17
    v_dot2_f32_bf16 v16, v98, s4, v16
    v_dot2_f32_bf16 v17, v98, v98, v17
    v_dot2_f32_bf16 v16, v99, s4, v16
    v_dot2_f32_bf16 v17, v99, v99, v17
    v_dot2_f32_bf16 v16, v100, s4, v16
    v_dot2_f32_bf16 v17, v100, v100, v17
    v_dot2_f32_bf16 v16, v101, s4, v16
    v_dot2_f32_bf16 v17, v101, v101, v17
    v_dot2_f32_bf16 v16, v102, s4, v16
    v_dot2_f32_bf16 v17, v102, v102, v17
    v_dot2_f32_bf16 v16, v103, s4, v16
    v_dot2_f32_bf16 v17, v103, v103, v17
    v_dot2_f32_bf16 v16, v104, s4, v16
    v_dot2_f32_bf16 v17, v104, v104, v17
    v_dot2_f32_bf16 v16, v105, s4, v16
    v_dot2_f32_bf16 v17, v105, v105, v17
    v_dot2_f32_bf16 v16, v106, s4, v16
    v_dot2_f32_bf16 v17, v106, v106, v17
    v_dot2_f32_bf16 v16, v107, s4, v16
    v_dot2_f32_bf16 v17, v107, v107, v17
    v_dot2_f32_bf16 v16, v108, s4, v16
    v_dot2_f32_bf16 v17, v108, v108, v17
    v_dot2_f32_bf16 v16, v109, s4, v16
    v_dot2_f32_bf16 v17, v109, v109, v17
    v_dot2_f32_bf16 v16, v110, s4, v16
    v_dot2_f32_bf16 v17, v110, v110, v17
    v_dot2_f32_bf16 v16, v111, s4, v16
    v_dot2_f32_bf16 v17, v111, v111, v17
    v_dot2_f32_bf16 v16, v112, s4, v16
    v_dot2_f32_bf16 v17, v112, v112, v17
    v_dot2_f32_bf16 v16, v113, s4, v16
    v_dot2_f32_bf16 v17, v113, v113, v17
    v_dot2_f32_bf16 v16, v114, s4, v16
    v_dot2_f32_bf16 v17, v114, v114, v17
    v_dot2_f32_bf16 v16, v115, s4, v16
    v_dot2_f32_bf16 v17, v115, v115, v17
    v_dot2_f32_bf16 v16, v116, s4, v16
    v_dot2_f32_bf16 v17, v116, v116, v17
    v_dot2_f32_bf16 v16, v117, s4, v16
    v_dot2_f32_bf16 v17, v117, v117, v17
    v_dot2_f32_bf16 v16, v118, s4, v16
    v_dot2_f32_bf16 v17, v118, v118, v17
    v_dot2_f32_bf16 v16, v119, s4, v16
    v_dot2_f32_bf16 v17, v119, v119, v17
    v_dot2_f32_bf16 v16, v120, s4, v16
    v_dot2_f32_bf16 v17, v120, v120, v17
    v_dot2_f32_bf16 v16, v121, s4, v16
    v_dot2_f32_bf16 v17, v121, v121, v17
    v_dot2_f32_bf16 v16, v122, s4, v16
    v_dot2_f32_bf16 v17, v122, v122, v17
    v_dot2_f32_bf16 v16, v123, s4, v16
    v_dot2_f32_bf16 v17, v123, v123, v17
    v_dot2_f32_bf16 v16, v124, s4, v16
    v_dot2_f32_bf16 v17, v124, v124, v17
    v_dot2_f32_bf16 v16, v125, s4, v16
    v_dot2_f32_bf16 v17, v125, v125, v17
    v_dot2_f32_bf16 v16, v126, s4, v16
    v_dot2_f32_bf16 v17, v126, v126, v17
    v_dot2_f32_bf16 v16, v127, s4, v16
    v_dot2_f32_bf16 v17, v127, v127, v17
    s_nop 3
    v_add_f32_dpp v16, v16, v16 quad_perm:[1,0,3,2] row_mask:0xf bank_mask:0xf
    v_add_f32_dpp v17, v17, v17 quad_perm:[1,0,3,2] row_mask:0xf bank_mask:0xf
    s_nop 0
    v_add_f32_dpp v16, v16, v16 quad_perm:[2,3,0,1] row_mask:0xf bank_mask:0xf
    v_add_f32_dpp v17, v17, v17 quad_perm:[2,3,0,1] row_mask:0xf bank_mask:0xf
    s_nop 0
    v_add_f32_dpp v16, v16, v16 row_half_mirror row_mask:0xf bank_mask:0xf
    v_add_f32_dpp v17, v17, v17 row_half_mirror row_mask:0xf bank_mask:0xf
    v_mul_f32 v16, 0x3b000000, v16
    v_mul_f32 v17, 0x3b000000, v17
    v_fma_f32 v17, -v16, v16, v17
    v_max_f32 v17, 0, v17
    v_cvt_pk_bf16_f32 v14, v16, v17
    v_lshlrev_b32 v16, 16, v14
    v_and_b32 v17, 0xffff0000, v14
    v_add_f32 v17, 0x3727c5ac, v17
    v_cvt_pk_bf16_f32 v14, v17, v17
    v_lshlrev_b32 v17, 16, v14
    v_sqrt_f32 v17, v17
    s_nop 0
    v_cvt_pk_bf16_f32 v14, v17, v17
    v_lshlrev_b32 v17, 16, v14
    v_rcp_f32 v17, v17
    v_lshlrev_b32 v18, 16, v96
    v_and_b32 v19, 0xffff0000, v96
    v_sub_f32 v18, v18, v16
    v_sub_f32 v19, v19, v16
    v_cvt_pk_bf16_f32 v96, v18, v19
    v_lshlrev_b32 v18, 16, v96
    v_and_b32 v19, 0xffff0000, v96
    v_mul_f32 v18, v18, v17
    v_mul_f32 v19, v19, v17
    v_cvt_pk_bf16_f32 v96, v18, v19
    v_lshlrev_b32 v18, 16, v97
    v_and_b32 v19, 0xffff0000, v97
    v_sub_f32 v18, v18, v16
    v_sub_f32 v19, v19, v16
    v_cvt_pk_bf16_f32 v97, v18, v19
    v_lshlrev_b32 v18, 16, v97
    v_and_b32 v19, 0xffff0000, v97
    v_mul_f32 v18, v18, v17
    v_mul_f32 v19, v19, v17
    v_cvt_pk_bf16_f32 v97, v18, v19
    v_lshlrev_b32 v18, 16, v98
    v_and_b32 v19, 0xffff0000, v98
    v_sub_f32 v18, v18, v16
    v_sub_f32 v19, v19, v16
    v_cvt_pk_bf16_f32 v98, v18, v19
    v_lshlrev_b32 v18, 16, v98
    v_and_b32 v19, 0xffff0000, v98
    v_mul_f32 v18, v18, v17
    v_mul_f32 v19, v19, v17
    v_cvt_pk_bf16_f32 v98, v18, v19
    v_lshlrev_b32 v18, 16, v99
    v_and_b32 v19, 0xffff0000, v99
    v_sub_f32 v18, v18, v16
    v_sub_f32 v19, v19, v16
    v_cvt_pk_bf16_f32 v99, v18, v19
    v_lshlrev_b32 v18, 16, v99
    v_and_b32 v19, 0xffff0000, v99
    v_mul_f32 v18, v18, v17
    v_mul_f32 v19, v19, v17
    v_cvt_pk_bf16_f32 v99, v18, v19
    ds_write_b128 v4, v[96:99] offset:0
    v_lshlrev_b32 v18, 16, v100
    v_and_b32 v19, 0xffff0000, v100
    v_sub_f32 v18, v18, v16
    v_sub_f32 v19, v19, v16
    v_cvt_pk_bf16_f32 v100, v18, v19
    v_lshlrev_b32 v18, 16, v100
    v_and_b32 v19, 0xffff0000, v100
    v_mul_f32 v18, v18, v17
    v_mul_f32 v19, v19, v17
    v_cvt_pk_bf16_f32 v100, v18, v19
    v_lshlrev_b32 v18, 16, v101
    v_and_b32 v19, 0xffff0000, v101
    v_sub_f32 v18, v18, v16
    v_sub_f32 v19, v19, v16
    v_cvt_pk_bf16_f32 v101, v18, v19
    v_lshlrev_b32 v18, 16, v101
    v_and_b32 v19, 0xffff0000, v101
    v_mul_f32 v18, v18, v17
    v_mul_f32 v19, v19, v17
    v_cvt_pk_bf16_f32 v101, v18, v19
    v_lshlrev_b32 v18, 16, v102
    v_and_b32 v19, 0xffff0000, v102
    v_sub_f32 v18, v18, v16
    v_sub_f32 v19, v19, v16
    v_cvt_pk_bf16_f32 v102, v18, v19
    v_lshlrev_b32 v18, 16, v102
    v_and_b32 v19, 0xffff0000, v102
    v_mul_f32 v18, v18, v17
    v_mul_f32 v19, v19, v17
    v_cvt_pk_bf16_f32 v102, v18, v19
    v_lshlrev_b32 v18, 16, v103
    v_and_b32 v19, 0xffff0000, v103
    v_sub_f32 v18, v18, v16
    v_sub_f32 v19, v19, v16
    v_cvt_pk_bf16_f32 v103, v18, v19
    v_lshlrev_b32 v18, 16, v103
    v_and_b32 v19, 0xffff0000, v103
    v_mul_f32 v18, v18, v17
    v_mul_f32 v19, v19, v17
    v_cvt_pk_bf16_f32 v103, v18, v19
    ds_write_b128 v4, v[100:103] offset:2048
    v_lshlrev_b32 v18, 16, v104
    v_and_b32 v19, 0xffff0000, v104
    v_sub_f32 v18, v18, v16
    v_sub_f32 v19, v19, v16
    v_cvt_pk_bf16_f32 v104, v18, v19
    v_lshlrev_b32 v18, 16, v104
    v_and_b32 v19, 0xffff0000, v104
    v_mul_f32 v18, v18, v17
    v_mul_f32 v19, v19, v17
    v_cvt_pk_bf16_f32 v104, v18, v19
    v_lshlrev_b32 v18, 16, v105
    v_and_b32 v19, 0xffff0000, v105
    v_sub_f32 v18, v18, v16
    v_sub_f32 v19, v19, v16
    v_cvt_pk_bf16_f32 v105, v18, v19
    v_lshlrev_b32 v18, 16, v105
    v_and_b32 v19, 0xffff0000, v105
    v_mul_f32 v18, v18, v17
    v_mul_f32 v19, v19, v17
    v_cvt_pk_bf16_f32 v105, v18, v19
    v_lshlrev_b32 v18, 16, v106
    v_and_b32 v19, 0xffff0000, v106
    v_sub_f32 v18, v18, v16
    v_sub_f32 v19, v19, v16
    v_cvt_pk_bf16_f32 v106, v18, v19
    v_lshlrev_b32 v18, 16, v106
    v_and_b32 v19, 0xffff0000, v106
    v_mul_f32 v18, v18, v17
    v_mul_f32 v19, v19, v17
    v_cvt_pk_bf16_f32 v106, v18, v19
    v_lshlrev_b32 v18, 16, v107
    v_and_b32 v19, 0xffff0000, v107
    v_sub_f32 v18, v18, v16
    v_sub_f32 v19, v19, v16
    v_cvt_pk_bf16_f32 v107, v18, v19
    v_lshlrev_b32 v18, 16, v107
    v_and_b32 v19, 0xffff0000, v107
    v_mul_f32 v18, v18, v17
    v_mul_f32 v19, v19, v17
    v_cvt_pk_bf16_f32 v107, v18, v19
    ds_write_b128 v4, v[104:107] offset:4096
    v_lshlrev_b32 v18, 16, v108
    v_and_b32 v19, 0xffff0000, v108
    v_sub_f32 v18, v18, v16
    v_sub_f32 v19, v19, v16
    v_cvt_pk_bf16_f32 v108, v18, v19
    v_lshlrev_b32 v18, 16, v108
    v_and_b32 v19, 0xffff0000, v108
    v_mul_f32 v18, v18, v17
    v_mul_f32 v19, v19, v17
    v_cvt_pk_bf16_f32 v108, v18, v19
    v_lshlrev_b32 v18, 16, v109
    v_and_b32 v19, 0xffff0000, v109
    v_sub_f32 v18, v18, v16
    v_sub_f32 v19, v19, v16
    v_cvt_pk_bf16_f32 v109, v18, v19
    v_lshlrev_b32 v18, 16, v109
    v_and_b32 v19, 0xffff0000, v109
    v_mul_f32 v18, v18, v17
    v_mul_f32 v19, v19, v17
    v_cvt_pk_bf16_f32 v109, v18, v19
    v_lshlrev_b32 v18, 16, v110
    v_and_b32 v19, 0xffff0000, v110
    v_sub_f32 v18, v18, v16
    v_sub_f32 v19, v19, v16
    v_cvt_pk_bf16_f32 v110, v18, v19
    v_lshlrev_b32 v18, 16, v110
    v_and_b32 v19, 0xffff0000, v110
    v_mul_f32 v18, v18, v17
    v_mul_f32 v19, v19, v17
    v_cvt_pk_bf16_f32 v110, v18, v19
    v_lshlrev_b32 v18, 16, v111
    v_and_b32 v19, 0xffff0000, v111
    v_sub_f32 v18, v18, v16
    v_sub_f32 v19, v19, v16
    v_cvt_pk_bf16_f32 v111, v18, v19
    v_lshlrev_b32 v18, 16, v111
    v_and_b32 v19, 0xffff0000, v111
    v_mul_f32 v18, v18, v17
    v_mul_f32 v19, v19, v17
    v_cvt_pk_bf16_f32 v111, v18, v19
    ds_write_b128 v4, v[108:111] offset:6144
    v_lshlrev_b32 v18, 16, v112
    v_and_b32 v19, 0xffff0000, v112
    v_sub_f32 v18, v18, v16
    v_sub_f32 v19, v19, v16
    v_cvt_pk_bf16_f32 v112, v18, v19
    v_lshlrev_b32 v18, 16, v112
    v_and_b32 v19, 0xffff0000, v112
    v_mul_f32 v18, v18, v17
    v_mul_f32 v19, v19, v17
    v_cvt_pk_bf16_f32 v112, v18, v19
    v_lshlrev_b32 v18, 16, v113
    v_and_b32 v19, 0xffff0000, v113
    v_sub_f32 v18, v18, v16
    v_sub_f32 v19, v19, v16
    v_cvt_pk_bf16_f32 v113, v18, v19
    v_lshlrev_b32 v18, 16, v113
    v_and_b32 v19, 0xffff0000, v113
    v_mul_f32 v18, v18, v17
    v_mul_f32 v19, v19, v17
    v_cvt_pk_bf16_f32 v113, v18, v19
    v_lshlrev_b32 v18, 16, v114
    v_and_b32 v19, 0xffff0000, v114
    v_sub_f32 v18, v18, v16
    v_sub_f32 v19, v19, v16
    v_cvt_pk_bf16_f32 v114, v18, v19
    v_lshlrev_b32 v18, 16, v114
    v_and_b32 v19, 0xffff0000, v114
    v_mul_f32 v18, v18, v17
    v_mul_f32 v19, v19, v17
    v_cvt_pk_bf16_f32 v114, v18, v19
    v_lshlrev_b32 v18, 16, v115
    v_and_b32 v19, 0xffff0000, v115
    v_sub_f32 v18, v18, v16
    v_sub_f32 v19, v19, v16
    v_cvt_pk_bf16_f32 v115, v18, v19
    v_lshlrev_b32 v18, 16, v115
    v_and_b32 v19, 0xffff0000, v115
    v_mul_f32 v18, v18, v17
    v_mul_f32 v19, v19, v17
    v_cvt_pk_bf16_f32 v115, v18, v19
    ds_write_b128 v4, v[112:115] offset:8192
    v_lshlrev_b32 v18, 16, v116
    v_and_b32 v19, 0xffff0000, v116
    v_sub_f32 v18, v18, v16
    v_sub_f32 v19, v19, v16
    v_cvt_pk_bf16_f32 v116, v18, v19
    v_lshlrev_b32 v18, 16, v116
    v_and_b32 v19, 0xffff0000, v116
    v_mul_f32 v18, v18, v17
    v_mul_f32 v19, v19, v17
    v_cvt_pk_bf16_f32 v116, v18, v19
    v_lshlrev_b32 v18, 16, v117
    v_and_b32 v19, 0xffff0000, v117
    v_sub_f32 v18, v18, v16
    v_sub_f32 v19, v19, v16
    v_cvt_pk_bf16_f32 v117, v18, v19
    v_lshlrev_b32 v18, 16, v117
    v_and_b32 v19, 0xffff0000, v117
    v_mul_f32 v18, v18, v17
    v_mul_f32 v19, v19, v17
    v_cvt_pk_bf16_f32 v117, v18, v19
    v_lshlrev_b32 v18, 16, v118
    v_and_b32 v19, 0xffff0000, v118
    v_sub_f32 v18, v18, v16
    v_sub_f32 v19, v19, v16
    v_cvt_pk_bf16_f32 v118, v18, v19
    v_lshlrev_b32 v18, 16, v118
    v_and_b32 v19, 0xffff0000, v118
    v_mul_f32 v18, v18, v17
    v_mul_f32 v19, v19, v17
    v_cvt_pk_bf16_f32 v118, v18, v19
    v_lshlrev_b32 v18, 16, v119
    v_and_b32 v19, 0xffff0000, v119
    v_sub_f32 v18, v18, v16
    v_sub_f32 v19, v19, v16
    v_cvt_pk_bf16_f32 v119, v18, v19
    v_lshlrev_b32 v18, 16, v119
    v_and_b32 v19, 0xffff0000, v119
    v_mul_f32 v18, v18, v17
    v_mul_f32 v19, v19, v17
    v_cvt_pk_bf16_f32 v119, v18, v19
    ds_write_b128 v4, v[116:119] offset:10240
    v_lshlrev_b32 v18, 16, v120
    v_and_b32 v19, 0xffff0000, v120
    v_sub_f32 v18, v18, v16
    v_sub_f32 v19, v19, v16
    v_cvt_pk_bf16_f32 v120, v18, v19
    v_lshlrev_b32 v18, 16, v120
    v_and_b32 v19, 0xffff0000, v120
    v_mul_f32 v18, v18, v17
    v_mul_f32 v19, v19, v17
    v_cvt_pk_bf16_f32 v120, v18, v19
    v_lshlrev_b32 v18, 16, v121
    v_and_b32 v19, 0xffff0000, v121
    v_sub_f32 v18, v18, v16
    v_sub_f32 v19, v19, v16
    v_cvt_pk_bf16_f32 v121, v18, v19
    v_lshlrev_b32 v18, 16, v121
    v_and_b32 v19, 0xffff0000, v121
    v_mul_f32 v18, v18, v17
    v_mul_f32 v19, v19, v17
    v_cvt_pk_bf16_f32 v121, v18, v19
    v_lshlrev_b32 v18, 16, v122
    v_and_b32 v19, 0xffff0000, v122
    v_sub_f32 v18, v18, v16
    v_sub_f32 v19, v19, v16
    v_cvt_pk_bf16_f32 v122, v18, v19
    v_lshlrev_b32 v18, 16, v122
    v_and_b32 v19, 0xffff0000, v122
    v_mul_f32 v18, v18, v17
    v_mul_f32 v19, v19, v17
    v_cvt_pk_bf16_f32 v122, v18, v19
    v_lshlrev_b32 v18, 16, v123
    v_and_b32 v19, 0xffff0000, v123
    v_sub_f32 v18, v18, v16
    v_sub_f32 v19, v19, v16
    v_cvt_pk_bf16_f32 v123, v18, v19
    v_lshlrev_b32 v18, 16, v123
    v_and_b32 v19, 0xffff0000, v123
    v_mul_f32 v18, v18, v17
    v_mul_f32 v19, v19, v17
    v_cvt_pk_bf16_f32 v123, v18, v19
    ds_write_b128 v4, v[120:123] offset:12288
    v_lshlrev_b32 v18, 16, v124
    v_and_b32 v19, 0xffff0000, v124
    v_sub_f32 v18, v18, v16
    v_sub_f32 v19, v19, v16
    v_cvt_pk_bf16_f32 v124, v18, v19
    v_lshlrev_b32 v18, 16, v124
    v_and_b32 v19, 0xffff0000, v124
    v_mul_f32 v18, v18, v17
    v_mul_f32 v19, v19, v17
    v_cvt_pk_bf16_f32 v124, v18, v19
    v_lshlrev_b32 v18, 16, v125
    v_and_b32 v19, 0xffff0000, v125
    v_sub_f32 v18, v18, v16
    v_sub_f32 v19, v19, v16
    v_cvt_pk_bf16_f32 v125, v18, v19
    v_lshlrev_b32 v18, 16, v125
    v_and_b32 v19, 0xffff0000, v125
    v_mul_f32 v18, v18, v17
    v_mul_f32 v19, v19, v17
    v_cvt_pk_bf16_f32 v125, v18, v19
    v_lshlrev_b32 v18, 16, v126
    v_and_b32 v19, 0xffff0000, v126
    v_sub_f32 v18, v18, v16
    v_sub_f32 v19, v19, v16
    v_cvt_pk_bf16_f32 v126, v18, v19
    v_lshlrev_b32 v18, 16, v126
    v_and_b32 v19, 0xffff0000, v126
    v_mul_f32 v18, v18, v17
    v_mul_f32 v19, v19, v17
    v_cvt_pk_bf16_f32 v126, v18, v19
    v_lshlrev_b32 v18, 16, v127
    v_and_b32 v19, 0xffff0000, v127
    v_sub_f32 v18, v18, v16
    v_sub_f32 v19, v19, v16
    v_cvt_pk_bf16_f32 v127, v18, v19
    v_lshlrev_b32 v18, 16, v127
    v_and_b32 v19, 0xffff0000, v127
    v_mul_f32 v18, v18, v17
    v_mul_f32 v19, v19, v17
    v_cvt_pk_bf16_f32 v127, v18, v19
    ds_write_b128 v4, v[124:127] offset:14336
    s_waitcnt lgkmcnt(0)
    s_barrier
    s_lshl_b32 s24, s23, 15
    s_add_u32 s24, s24, 0x800000
    ds_read_b128 v[24:27], v9 offset:0
    ds_read_b128 v[28:31], v9 offset:4096
    ds_read_b128 v[32:35], v9 offset:8192
    ds_read_b128 v[36:39], v9 offset:12288
    ds_read_b128 v[40:43], v9 offset:16384
    ds_read_b128 v[44:47], v9 offset:20480
    ds_read_b128 v[48:51], v9 offset:24576
    ds_read_b128 v[52:55], v9 offset:28672
    s_waitcnt lgkmcnt(7)
    s_add_u32 s36, s24, 0
    buffer_store_dwordx4 v[24:27], v9, s[8:11], s36 offen sc1
    s_waitcnt lgkmcnt(6)
    s_add_u32 s36, s24, 4096
    buffer_store_dwordx4 v[28:31], v9, s[8:11], s36 offen sc1
    s_waitcnt lgkmcnt(5)
    s_add_u32 s36, s24, 8192
    buffer_store_dwordx4 v[32:35], v9, s[8:11], s36 offen sc1
    s_waitcnt lgkmcnt(4)
    s_add_u32 s36, s24, 12288
    buffer_store_dwordx4 v[36:39], v9, s[8:11], s36 offen sc1
    s_waitcnt lgkmcnt(3)
    s_add_u32 s36, s24, 16384
    buffer_store_dwordx4 v[40:43], v9, s[8:11], s36 offen sc1
    s_waitcnt lgkmcnt(2)
    s_add_u32 s36, s24, 20480
    buffer_store_dwordx4 v[44:47], v9, s[8:11], s36 offen sc1
    s_waitcnt lgkmcnt(1)
    s_add_u32 s36, s24, 24576
    buffer_store_dwordx4 v[48:51], v9, s[8:11], s36 offen sc1
    s_waitcnt lgkmcnt(0)
    s_add_u32 s36, s24, 28672
    buffer_store_dwordx4 v[52:55], v9, s[8:11], s36 offen sc1
    s_barrier
    s_add_u32 s23, s23, 1
    s_lshl_b32 s36, s23, 15
    buffer_load_dwordx4 v[96:99], v3, s[12:15], s36 offen offset:0
    buffer_load_dwordx4 v[100:103], v3, s[12:15], s36 offen offset:128
    buffer_load_dwordx4 v[104:107], v3, s[12:15], s36 offen offset:256
    buffer_load_dwordx4 v[108:111], v3, s[12:15], s36 offen offset:384
    buffer_load_dwordx4 v[112:115], v3, s[12:15], s36 offen offset:512
    buffer_load_dwordx4 v[116:119], v3, s[12:15], s36 offen offset:640
    buffer_load_dwordx4 v[120:123], v3, s[12:15], s36 offen offset:768
    buffer_load_dwordx4 v[124:127], v3, s[12:15], s36 offen offset:896
    s_waitcnt vmcnt(0)
    v_mov_b32 v16, 0
    v_mov_b32 v17, 0
    v_dot2_f32_bf16 v16, v96, s4, v16
    v_dot2_f32_bf16 v17, v96, v96, v17
    v_dot2_f32_bf16 v16, v97, s4, v16
    v_dot2_f32_bf16 v17, v97, v97, v17
    v_dot2_f32_bf16 v16, v98, s4, v16
    v_dot2_f32_bf16 v17, v98, v98, v17
    v_dot2_f32_bf16 v16, v99, s4, v16
    v_dot2_f32_bf16 v17, v99, v99, v17
    v_dot2_f32_bf16 v16, v100, s4, v16
    v_dot2_f32_bf16 v17, v100, v100, v17
    v_dot2_f32_bf16 v16, v101, s4, v16
    v_dot2_f32_bf16 v17, v101, v101, v17
    v_dot2_f32_bf16 v16, v102, s4, v16
    v_dot2_f32_bf16 v17, v102, v102, v17
    v_dot2_f32_bf16 v16, v103, s4, v16
    v_dot2_f32_bf16 v17, v103, v103, v17
    v_dot2_f32_bf16 v16, v104, s4, v16
    v_dot2_f32_bf16 v17, v104, v104, v17
    v_dot2_f32_bf16 v16, v105, s4, v16
    v_dot2_f32_bf16 v17, v105, v105, v17
    v_dot2_f32_bf16 v16, v106, s4, v16
    v_dot2_f32_bf16 v17, v106, v106, v17
    v_dot2_f32_bf16 v16, v107, s4, v16
    v_dot2_f32_bf16 v17, v107, v107, v17
    v_dot2_f32_bf16 v16, v108, s4, v16
    v_dot2_f32_bf16 v17, v108, v108, v17
    v_dot2_f32_bf16 v16, v109, s4, v16
    v_dot2_f32_bf16 v17, v109, v109, v17
    v_dot2_f32_bf16 v16, v110, s4, v16
    v_dot2_f32_bf16 v17, v110, v110, v17
    v_dot2_f32_bf16 v16, v111, s4, v16
    v_dot2_f32_bf16 v17, v111, v111, v17
    v_dot2_f32_bf16 v16, v112, s4, v16
    v_dot2_f32_bf16 v17, v112, v112, v17
    v_dot2_f32_bf16 v16, v113, s4, v16
    v_dot2_f32_bf16 v17, v113, v113, v17
    v_dot2_f32_bf16 v16, v114, s4, v16
    v_dot2_f32_bf16 v17, v114, v114, v17
    v_dot2_f32_bf16 v16, v115, s4, v16
    v_dot2_f32_bf16 v17, v115, v115, v17
    v_dot2_f32_bf16 v16, v116, s4, v16
    v_dot2_f32_bf16 v17, v116, v116, v17
    v_dot2_f32_bf16 v16, v117, s4, v16
    v_dot2_f32_bf16 v17, v117, v117, v17
    v_dot2_f32_bf16 v16, v118, s4, v16
    v_dot2_f32_bf16 v17, v118, v118, v17
    v_dot2_f32_bf16 v16, v119, s4, v16
    v_dot2_f32_bf16 v17, v119, v119, v17
    v_dot2_f32_bf16 v16, v120, s4, v16
    v_dot2_f32_bf16 v17, v120, v120, v17
    v_dot2_f32_bf16 v16, v121, s4, v16
    v_dot2_f32_bf16 v17, v121, v121, v17
    v_dot2_f32_bf16 v16, v122, s4, v16
    v_dot2_f32_bf16 v17, v122, v122, v17
    v_dot2_f32_bf16 v16, v123, s4, v16
    v_dot2_f32_bf16 v17, v123, v123, v17
    v_dot2_f32_bf16 v16, v124, s4, v16
    v_dot2_f32_bf16 v17, v124, v124, v17
    v_dot2_f32_bf16 v16, v125, s4, v16
    v_dot2_f32_bf16 v17, v125, v125, v17
    v_dot2_f32_bf16 v16, v126, s4, v16
    v_dot2_f32_bf16 v17, v126, v126, v17
    v_dot2_f32_bf16 v16, v127, s4, v16
    v_dot2_f32_bf16 v17, v127, v127, v17
    s_nop 3
    v_add_f32_dpp v16, v16, v16 quad_perm:[1,0,3,2] row_mask:0xf bank_mask:0xf
    v_add_f32_dpp v17, v17, v17 quad_perm:[1,0,3,2] row_mask:0xf bank_mask:0xf
    s_nop 0
    v_add_f32_dpp v16, v16, v16 quad_perm:[2,3,0,1] row_mask:0xf bank_mask:0xf
    v_add_f32_dpp v17, v17, v17 quad_perm:[2,3,0,1] row_mask:0xf bank_mask:0xf
    s_nop 0
    v_add_f32_dpp v16, v16, v16 row_half_mirror row_mask:0xf bank_mask:0xf
    v_add_f32_dpp v17, v17, v17 row_half_mirror row_mask:0xf bank_mask:0xf
    v_mul_f32 v16, 0x3b000000, v16
    v_mul_f32 v17, 0x3b000000, v17
    v_fma_f32 v17, -v16, v16, v17
    v_max_f32 v17, 0, v17
    v_cvt_pk_bf16_f32 v14, v16, v17
    v_lshlrev_b32 v16, 16, v14
    v_and_b32 v17, 0xffff0000, v14
    v_add_f32 v17, 0x3727c5ac, v17
    v_cvt_pk_bf16_f32 v14, v17, v17
    v_lshlrev_b32 v17, 16, v14
    v_sqrt_f32 v17, v17
    s_nop 0
    v_cvt_pk_bf16_f32 v14, v17, v17
    v_lshlrev_b32 v17, 16, v14
    v_rcp_f32 v17, v17
    v_lshlrev_b32 v18, 16, v96
    v_and_b32 v19, 0xffff0000, v96
    v_sub_f32 v18, v18, v16
    v_sub_f32 v19, v19, v16
    v_cvt_pk_bf16_f32 v96, v18, v19
    v_lshlrev_b32 v18, 16, v96
    v_and_b32 v19, 0xffff0000, v96
    v_mul_f32 v18, v18, v17
    v_mul_f32 v19, v19, v17
    v_cvt_pk_bf16_f32 v96, v18, v19
    v_lshlrev_b32 v18, 16, v97
    v_and_b32 v19, 0xffff0000, v97
    v_sub_f32 v18, v18, v16
    v_sub_f32 v19, v19, v16
    v_cvt_pk_bf16_f32 v97, v18, v19
    v_lshlrev_b32 v18, 16, v97
    v_and_b32 v19, 0xffff0000, v97
    v_mul_f32 v18, v18, v17
    v_mul_f32 v19, v19, v17
    v_cvt_pk_bf16_f32 v97, v18, v19
    v_lshlrev_b32 v18, 16, v98
    v_and_b32 v19, 0xffff0000, v98
    v_sub_f32 v18, v18, v16
    v_sub_f32 v19, v19, v16
    v_cvt_pk_bf16_f32 v98, v18, v19
    v_lshlrev_b32 v18, 16, v98
    v_and_b32 v19, 0xffff0000, v98
    v_mul_f32 v18, v18, v17
    v_mul_f32 v19, v19, v17
    v_cvt_pk_bf16_f32 v98, v18, v19
    v_lshlrev_b32 v18, 16, v99
    v_and_b32 v19, 0xffff0000, v99
    v_sub_f32 v18, v18, v16
    v_sub_f32 v19, v19, v16
    v_cvt_pk_bf16_f32 v99, v18, v19
    v_lshlrev_b32 v18, 16, v99
    v_and_b32 v19, 0xffff0000, v99
    v_mul_f32 v18, v18, v17
    v_mul_f32 v19, v19, v17
    v_cvt_pk_bf16_f32 v99, v18, v19
    ds_write_b128 v4, v[96:99] offset:0
    v_lshlrev_b32 v18, 16, v100
    v_and_b32 v19, 0xffff0000, v100
    v_sub_f32 v18, v18, v16
    v_sub_f32 v19, v19, v16
    v_cvt_pk_bf16_f32 v100, v18, v19
    v_lshlrev_b32 v18, 16, v100
    v_and_b32 v19, 0xffff0000, v100
    v_mul_f32 v18, v18, v17
    v_mul_f32 v19, v19, v17
    v_cvt_pk_bf16_f32 v100, v18, v19
    v_lshlrev_b32 v18, 16, v101
    v_and_b32 v19, 0xffff0000, v101
    v_sub_f32 v18, v18, v16
    v_sub_f32 v19, v19, v16
    v_cvt_pk_bf16_f32 v101, v18, v19
    v_lshlrev_b32 v18, 16, v101
    v_and_b32 v19, 0xffff0000, v101
    v_mul_f32 v18, v18, v17
    v_mul_f32 v19, v19, v17
    v_cvt_pk_bf16_f32 v101, v18, v19
    v_lshlrev_b32 v18, 16, v102
    v_and_b32 v19, 0xffff0000, v102
    v_sub_f32 v18, v18, v16
    v_sub_f32 v19, v19, v16
    v_cvt_pk_bf16_f32 v102, v18, v19
    v_lshlrev_b32 v18, 16, v102
    v_and_b32 v19, 0xffff0000, v102
    v_mul_f32 v18, v18, v17
    v_mul_f32 v19, v19, v17
    v_cvt_pk_bf16_f32 v102, v18, v19
    v_lshlrev_b32 v18, 16, v103
    v_and_b32 v19, 0xffff0000, v103
    v_sub_f32 v18, v18, v16
    v_sub_f32 v19, v19, v16
    v_cvt_pk_bf16_f32 v103, v18, v19
    v_lshlrev_b32 v18, 16, v103
    v_and_b32 v19, 0xffff0000, v103
    v_mul_f32 v18, v18, v17
    v_mul_f32 v19, v19, v17
    v_cvt_pk_bf16_f32 v103, v18, v19
    ds_write_b128 v4, v[100:103] offset:2048
    v_lshlrev_b32 v18, 16, v104
    v_and_b32 v19, 0xffff0000, v104
    v_sub_f32 v18, v18, v16
    v_sub_f32 v19, v19, v16
    v_cvt_pk_bf16_f32 v104, v18, v19
    v_lshlrev_b32 v18, 16, v104
    v_and_b32 v19, 0xffff0000, v104
    v_mul_f32 v18, v18, v17
    v_mul_f32 v19, v19, v17
    v_cvt_pk_bf16_f32 v104, v18, v19
    v_lshlrev_b32 v18, 16, v105
    v_and_b32 v19, 0xffff0000, v105
    v_sub_f32 v18, v18, v16
    v_sub_f32 v19, v19, v16
    v_cvt_pk_bf16_f32 v105, v18, v19
    v_lshlrev_b32 v18, 16, v105
    v_and_b32 v19, 0xffff0000, v105
    v_mul_f32 v18, v18, v17
    v_mul_f32 v19, v19, v17
    v_cvt_pk_bf16_f32 v105, v18, v19
    v_lshlrev_b32 v18, 16, v106
    v_and_b32 v19, 0xffff0000, v106
    v_sub_f32 v18, v18, v16
    v_sub_f32 v19, v19, v16
    v_cvt_pk_bf16_f32 v106, v18, v19
    v_lshlrev_b32 v18, 16, v106
    v_and_b32 v19, 0xffff0000, v106
    v_mul_f32 v18, v18, v17
    v_mul_f32 v19, v19, v17
    v_cvt_pk_bf16_f32 v106, v18, v19
    v_lshlrev_b32 v18, 16, v107
    v_and_b32 v19, 0xffff0000, v107
    v_sub_f32 v18, v18, v16
    v_sub_f32 v19, v19, v16
    v_cvt_pk_bf16_f32 v107, v18, v19
    v_lshlrev_b32 v18, 16, v107
    v_and_b32 v19, 0xffff0000, v107
    v_mul_f32 v18, v18, v17
    v_mul_f32 v19, v19, v17
    v_cvt_pk_bf16_f32 v107, v18, v19
    ds_write_b128 v4, v[104:107] offset:4096
    v_lshlrev_b32 v18, 16, v108
    v_and_b32 v19, 0xffff0000, v108
    v_sub_f32 v18, v18, v16
    v_sub_f32 v19, v19, v16
    v_cvt_pk_bf16_f32 v108, v18, v19
    v_lshlrev_b32 v18, 16, v108
    v_and_b32 v19, 0xffff0000, v108
    v_mul_f32 v18, v18, v17
    v_mul_f32 v19, v19, v17
    v_cvt_pk_bf16_f32 v108, v18, v19
    v_lshlrev_b32 v18, 16, v109
    v_and_b32 v19, 0xffff0000, v109
    v_sub_f32 v18, v18, v16
    v_sub_f32 v19, v19, v16
    v_cvt_pk_bf16_f32 v109, v18, v19
    v_lshlrev_b32 v18, 16, v109
    v_and_b32 v19, 0xffff0000, v109
    v_mul_f32 v18, v18, v17
    v_mul_f32 v19, v19, v17
    v_cvt_pk_bf16_f32 v109, v18, v19
    v_lshlrev_b32 v18, 16, v110
    v_and_b32 v19, 0xffff0000, v110
    v_sub_f32 v18, v18, v16
    v_sub_f32 v19, v19, v16
    v_cvt_pk_bf16_f32 v110, v18, v19
    v_lshlrev_b32 v18, 16, v110
    v_and_b32 v19, 0xffff0000, v110
    v_mul_f32 v18, v18, v17
    v_mul_f32 v19, v19, v17
    v_cvt_pk_bf16_f32 v110, v18, v19
    v_lshlrev_b32 v18, 16, v111
    v_and_b32 v19, 0xffff0000, v111
    v_sub_f32 v18, v18, v16
    v_sub_f32 v19, v19, v16
    v_cvt_pk_bf16_f32 v111, v18, v19
    v_lshlrev_b32 v18, 16, v111
    v_and_b32 v19, 0xffff0000, v111
    v_mul_f32 v18, v18, v17
    v_mul_f32 v19, v19, v17
    v_cvt_pk_bf16_f32 v111, v18, v19
    ds_write_b128 v4, v[108:111] offset:6144
    v_lshlrev_b32 v18, 16, v112
    v_and_b32 v19, 0xffff0000, v112
    v_sub_f32 v18, v18, v16
    v_sub_f32 v19, v19, v16
    v_cvt_pk_bf16_f32 v112, v18, v19
    v_lshlrev_b32 v18, 16, v112
    v_and_b32 v19, 0xffff0000, v112
    v_mul_f32 v18, v18, v17
    v_mul_f32 v19, v19, v17
    v_cvt_pk_bf16_f32 v112, v18, v19
    v_lshlrev_b32 v18, 16, v113
    v_and_b32 v19, 0xffff0000, v113
    v_sub_f32 v18, v18, v16
    v_sub_f32 v19, v19, v16
    v_cvt_pk_bf16_f32 v113, v18, v19
    v_lshlrev_b32 v18, 16, v113
    v_and_b32 v19, 0xffff0000, v113
    v_mul_f32 v18, v18, v17
    v_mul_f32 v19, v19, v17
    v_cvt_pk_bf16_f32 v113, v18, v19
    v_lshlrev_b32 v18, 16, v114
    v_and_b32 v19, 0xffff0000, v114
    v_sub_f32 v18, v18, v16
    v_sub_f32 v19, v19, v16
    v_cvt_pk_bf16_f32 v114, v18, v19
    v_lshlrev_b32 v18, 16, v114
    v_and_b32 v19, 0xffff0000, v114
    v_mul_f32 v18, v18, v17
    v_mul_f32 v19, v19, v17
    v_cvt_pk_bf16_f32 v114, v18, v19
    v_lshlrev_b32 v18, 16, v115
    v_and_b32 v19, 0xffff0000, v115
    v_sub_f32 v18, v18, v16
    v_sub_f32 v19, v19, v16
    v_cvt_pk_bf16_f32 v115, v18, v19
    v_lshlrev_b32 v18, 16, v115
    v_and_b32 v19, 0xffff0000, v115
    v_mul_f32 v18, v18, v17
    v_mul_f32 v19, v19, v17
    v_cvt_pk_bf16_f32 v115, v18, v19
    ds_write_b128 v4, v[112:115] offset:8192
    v_lshlrev_b32 v18, 16, v116
    v_and_b32 v19, 0xffff0000, v116
    v_sub_f32 v18, v18, v16
    v_sub_f32 v19, v19, v16
    v_cvt_pk_bf16_f32 v116, v18, v19
    v_lshlrev_b32 v18, 16, v116
    v_and_b32 v19, 0xffff0000, v116
    v_mul_f32 v18, v18, v17
    v_mul_f32 v19, v19, v17
    v_cvt_pk_bf16_f32 v116, v18, v19
    v_lshlrev_b32 v18, 16, v117
    v_and_b32 v19, 0xffff0000, v117
    v_sub_f32 v18, v18, v16
    v_sub_f32 v19, v19, v16
    v_cvt_pk_bf16_f32 v117, v18, v19
    v_lshlrev_b32 v18, 16, v117
    v_and_b32 v19, 0xffff0000, v117
    v_mul_f32 v18, v18, v17
    v_mul_f32 v19, v19, v17
    v_cvt_pk_bf16_f32 v117, v18, v19
    v_lshlrev_b32 v18, 16, v118
    v_and_b32 v19, 0xffff0000, v118
    v_sub_f32 v18, v18, v16
    v_sub_f32 v19, v19, v16
    v_cvt_pk_bf16_f32 v118, v18, v19
    v_lshlrev_b32 v18, 16, v118
    v_and_b32 v19, 0xffff0000, v118
    v_mul_f32 v18, v18, v17
    v_mul_f32 v19, v19, v17
    v_cvt_pk_bf16_f32 v118, v18, v19
    v_lshlrev_b32 v18, 16, v119
    v_and_b32 v19, 0xffff0000, v119
    v_sub_f32 v18, v18, v16
    v_sub_f32 v19, v19, v16
    v_cvt_pk_bf16_f32 v119, v18, v19
    v_lshlrev_b32 v18, 16, v119
    v_and_b32 v19, 0xffff0000, v119
    v_mul_f32 v18, v18, v17
    v_mul_f32 v19, v19, v17
    v_cvt_pk_bf16_f32 v119, v18, v19
    ds_write_b128 v4, v[116:119] offset:10240
    v_lshlrev_b32 v18, 16, v120
    v_and_b32 v19, 0xffff0000, v120
    v_sub_f32 v18, v18, v16
    v_sub_f32 v19, v19, v16
    v_cvt_pk_bf16_f32 v120, v18, v19
    v_lshlrev_b32 v18, 16, v120
    v_and_b32 v19, 0xffff0000, v120
    v_mul_f32 v18, v18, v17
    v_mul_f32 v19, v19, v17
    v_cvt_pk_bf16_f32 v120, v18, v19
    v_lshlrev_b32 v18, 16, v121
    v_and_b32 v19, 0xffff0000, v121
    v_sub_f32 v18, v18, v16
    v_sub_f32 v19, v19, v16
    v_cvt_pk_bf16_f32 v121, v18, v19
    v_lshlrev_b32 v18, 16, v121
    v_and_b32 v19, 0xffff0000, v121
    v_mul_f32 v18, v18, v17
    v_mul_f32 v19, v19, v17
    v_cvt_pk_bf16_f32 v121, v18, v19
    v_lshlrev_b32 v18, 16, v122
    v_and_b32 v19, 0xffff0000, v122
    v_sub_f32 v18, v18, v16
    v_sub_f32 v19, v19, v16
    v_cvt_pk_bf16_f32 v122, v18, v19
    v_lshlrev_b32 v18, 16, v122
    v_and_b32 v19, 0xffff0000, v122
    v_mul_f32 v18, v18, v17
    v_mul_f32 v19, v19, v17
    v_cvt_pk_bf16_f32 v122, v18, v19
    v_lshlrev_b32 v18, 16, v123
    v_and_b32 v19, 0xffff0000, v123
    v_sub_f32 v18, v18, v16
    v_sub_f32 v19, v19, v16
    v_cvt_pk_bf16_f32 v123, v18, v19
    v_lshlrev_b32 v18, 16, v123
    v_and_b32 v19, 0xffff0000, v123
    v_mul_f32 v18, v18, v17
    v_mul_f32 v19, v19, v17
    v_cvt_pk_bf16_f32 v123, v18, v19
    ds_write_b128 v4, v[120:123] offset:12288
    v_lshlrev_b32 v18, 16, v124
    v_and_b32 v19, 0xffff0000, v124
    v_sub_f32 v18, v18, v16
    v_sub_f32 v19, v19, v16
    v_cvt_pk_bf16_f32 v124, v18, v19
    v_lshlrev_b32 v18, 16, v124
    v_and_b32 v19, 0xffff0000, v124
    v_mul_f32 v18, v18, v17
    v_mul_f32 v19, v19, v17
    v_cvt_pk_bf16_f32 v124, v18, v19
    v_lshlrev_b32 v18, 16, v125
    v_and_b32 v19, 0xffff0000, v125
    v_sub_f32 v18, v18, v16
    v_sub_f32 v19, v19, v16
    v_cvt_pk_bf16_f32 v125, v18, v19
    v_lshlrev_b32 v18, 16, v125
    v_and_b32 v19, 0xffff0000, v125
    v_mul_f32 v18, v18, v17
    v_mul_f32 v19, v19, v17
    v_cvt_pk_bf16_f32 v125, v18, v19
    v_lshlrev_b32 v18, 16, v126
    v_and_b32 v19, 0xffff0000, v126
    v_sub_f32 v18, v18, v16
    v_sub_f32 v19, v19, v16
    v_cvt_pk_bf16_f32 v126, v18, v19
    v_lshlrev_b32 v18, 16, v126
    v_and_b32 v19, 0xffff0000, v126
    v_mul_f32 v18, v18, v17
    v_mul_f32 v19, v19, v17
    v_cvt_pk_bf16_f32 v126, v18, v19
    v_lshlrev_b32 v18, 16, v127
    v_and_b32 v19, 0xffff0000, v127
    v_sub_f32 v18, v18, v16
    v_sub_f32 v19, v19, v16
    v_cvt_pk_bf16_f32 v127, v18, v19
    v_lshlrev_b32 v18, 16, v127
    v_and_b32 v19, 0xffff0000, v127
    v_mul_f32 v18, v18, v17
    v_mul_f32 v19, v19, v17
    v_cvt_pk_bf16_f32 v127, v18, v19
    ds_write_b128 v4, v[124:127] offset:14336
    s_waitcnt lgkmcnt(0)
    s_barrier
    s_lshl_b32 s24, s23, 15
    s_add_u32 s24, s24, 0x800000
    ds_read_b128 v[24:27], v9 offset:0
    ds_read_b128 v[28:31], v9 offset:4096
    ds_read_b128 v[32:35], v9 offset:8192
    ds_read_b128 v[36:39], v9 offset:12288
    ds_read_b128 v[40:43], v9 offset:16384
    ds_read_b128 v[44:47], v9 offset:20480
    ds_read_b128 v[48:51], v9 offset:24576
    ds_read_b128 v[52:55], v9 offset:28672
    s_waitcnt lgkmcnt(7)
    s_add_u32 s36, s24, 0
    buffer_store_dwordx4 v[24:27], v9, s[8:11], s36 offen sc1
    s_waitcnt lgkmcnt(6)
    s_add_u32 s36, s24, 4096
    buffer_store_dwordx4 v[28:31], v9, s[8:11], s36 offen sc1
    s_waitcnt lgkmcnt(5)
    s_add_u32 s36, s24, 8192
    buffer_store_dwordx4 v[32:35], v9, s[8:11], s36 offen sc1
    s_waitcnt lgkmcnt(4)
    s_add_u32 s36, s24, 12288
    buffer_store_dwordx4 v[36:39], v9, s[8:11], s36 offen sc1
    s_waitcnt lgkmcnt(3)
    s_add_u32 s36, s24, 16384
    buffer_store_dwordx4 v[40:43], v9, s[8:11], s36 offen sc1
    s_waitcnt lgkmcnt(2)
    s_add_u32 s36, s24, 20480
    buffer_store_dwordx4 v[44:47], v9, s[8:11], s36 offen sc1
    s_waitcnt lgkmcnt(1)
    s_add_u32 s36, s24, 24576
    buffer_store_dwordx4 v[48:51], v9, s[8:11], s36 offen sc1
    s_waitcnt lgkmcnt(0)
    s_add_u32 s36, s24, 28672
    buffer_store_dwordx4 v[52:55], v9, s[8:11], s36 offen sc1
    s_barrier
    s_add_u32 s23, s23, 1
    v_lshrrev_b32 v15, 2, v1
    v_and_b32 v15, 127, v15
L_XHS:
    buffer_load_dword v14, v15, s[16:19], 0 offen offset:128 sc1
    s_add_u32 s32, s32, 1
    s_cmp_gt_u32 s32, 200000
    s_cbranch_scc1 L_XHS_done
    s_waitcnt vmcnt(0)
    v_cmp_eq_u32 vcc, 0, v14
    s_cbranch_vccnz L_XHS
L_XHS_done:
    s_lshl_b32 s24, s23, 2
    s_add_u32 s24, s24, 0x1923f8
    s_waitcnt vmcnt(0)
    s_barrier
    v_cmp_ne_u32 vcc, 0, v0
    v_mov_b32 v15, 0x40000000
    v_mov_b32 v14, 1
    v_cndmask_b32 v15, v0, v15, vcc
    buffer_store_dword v14, v15, s[8:11], s24 offen sc1
    s_add_u32 s24, s24, 4
    v_cmp_ne_u32 vcc, 0, v0
    v_mov_b32 v15, 0x40000000
    v_mov_b32 v14, 1
    v_cndmask_b32 v15, v0, v15, vcc
    buffer_store_dword v14, v15, s[8:11], s24 offen sc1
    s_lshr_b32 s20, s2, 3
    s_mov_b32 s34, 0x05040100
    s_mov_b32 s35, 0x07060302
    s_mov_b32 s32, 0
    s_mov_b32 s64, s84
    s_and_b32 s65, s85, 0xffff
    s_mov_b32 s66, 0x1c0000
    s_mov_b32 s67, 0x20000
    s_mov_b32 s68, s86
    s_and_b32 s69, s87, 0xffff
    s_mov_b32 s70, 0x1c0000
    s_mov_b32 s71, 0x20000
    s_mov_b32 s76, s88
    s_and_b32 s77, s89, 0xffff
    s_mov_b32 s78, 0x1c0000
    s_mov_b32 s79, 0x20000
    v_and_b32 v3, 31, v0
    v_lshlrev_b32 v3, 2, v3
L_M_hs:
    buffer_load_dword v5, v3, s[16:19], 0 offen offset:128 sc1
    s_add_u32 s32, s32, 1
    s_cmp_gt_u32 s32, 200000
    s_waitcnt vmcnt(0)
    s_cbranch_scc1 L_M_hs_ok
    v_cmp_eq_u32 vcc, 0, v5
    s_cbranch_vccz L_M_hs_ok
    s_sleep 16
    s_branch L_M_hs
L_M_hs_ok:
    v_lshlrev_b32 v3, 4, v0
L_M00_rp:
    s_mov_b32 s36, 0x194000
    buffer_load_dwordx4 v[16:19], v3, s[8:11], s36 offen sc1
    s_add_u32 s32, s32, 1
    v_mov_b32 v5, 0
    s_waitcnt vmcnt(0)
    v_max3_u32 v5, v5, v16, v17
    v_max3_u32 v5, v5, v18, v19
    s_cmp_gt_u32 s32, 200000
    s_cbranch_scc1 L_M00_rp_ok
    v_cmp_eq_u32 vcc, -1, v5
    s_cbranch_vccz L_M00_rp_ok
    s_sleep 64
    s_branch L_M00_rp
L_M00_rp_ok:
    v_add_f32 v16, v16, v17
    v_add_f32 v18, v18, v19
    v_add_f32 v16, v16, v18
    v_cvt_pk_bf16_f32 v5, v16, v16
    v_lshlrev_b32 v16, 16, v5
    v_ashrrev_i32 v5, 31, v16
    v_or_b32 v5, 0x80000000, v5
    v_xor_b32 v5, v5, v16
    v_and_b32 v5, 0xffff0000, v5
    v_sub_u32 v6, 2047, v0
    v_or_b32 v120, v5, v6
    v_lshrrev_b32 v1, 5, v0
    v_and_b32 v2, 31, v0
    s_mov_b32 s36, 229376
    v_mul_lo_u32 v4, v1, s36
    v_lshl_add_u32 v4, v2, 2, v4
    v_mov_b32 v5, 0x40000000
    v_cmp_lt_u32 vcc, 27, v2
    s_nop 1
    v_cndmask_b32 v4, v4, v5, vcc
    s_mul_i32 s23, s20, 112
    s_add_u32 s36, s23, 0
    buffer_load_dword v16, v4, s[64:67], s36 offen
    s_add_u32 s36, s23, 3584
    buffer_load_dword v17, v4, s[64:67], s36 offen
    s_add_u32 s36, s23, 7168
    buffer_load_dword v18, v4, s[64:67], s36 offen
    s_add_u32 s36, s23, 10752
    buffer_load_dword v19, v4, s[64:67], s36 offen
    s_add_u32 s36, s23, 14336
    buffer_load_dword v20, v4, s[64:67], s36 offen
    s_add_u32 s36, s23, 17920
    buffer_load_dword v21, v4, s[64:67], s36 offen
    s_add_u32 s36, s23, 21504
    buffer_load_dword v22, v4, s[64:67], s36 offen
    s_add_u32 s36, s23, 25088
    buffer_load_dword v23, v4, s[64:67], s36 offen
    s_add_u32 s36, s23, 28672
    buffer_load_dword v24, v4, s[64:67], s36 offen
    s_add_u32 s36, s23, 32256
    buffer_load_dword v25, v4, s[64:67], s36 offen
    s_add_u32 s36, s23, 35840
    buffer_load_dword v26, v4, s[64:67], s36 offen
    s_add_u32 s36, s23, 39424
    buffer_load_dword v27, v4, s[64:67], s36 offen
    s_add_u32 s36, s23, 43008
    buffer_load_dword v28, v4, s[64:67], s36 offen
    s_add_u32 s36, s23, 46592
    buffer_load_dword v29, v4, s[64:67], s36 offen
    s_add_u32 s36, s23, 50176
    buffer_load_dword v30, v4, s[64:67], s36 offen
    s_add_u32 s36, s23, 53760
    buffer_load_dword v31, v4, s[64:67], s36 offen
    s_add_u32 s36, s23, 57344
    buffer_load_dword v32, v4, s[64:67], s36 offen
    s_add_u32 s36, s23, 60928
    buffer_load_dword v33, v4, s[64:67], s36 offen
    s_add_u32 s36, s23, 64512
    buffer_load_dword v34, v4, s[64:67], s36 offen
    s_add_u32 s36, s23, 68096
    buffer_load_dword v35, v4, s[64:67], s36 offen
    s_add_u32 s36, s23, 71680
    buffer_load_dword v36, v4, s[64:67], s36 offen
    s_add_u32 s36, s23, 75264
    buffer_load_dword v37, v4, s[64:67], s36 offen
    s_add_u32 s36, s23, 78848
    buffer_load_dword v38, v4, s[64:67], s36 offen
    s_add_u32 s36, s23, 82432
    buffer_load_dword v39, v4, s[64:67], s36 offen
    s_add_u32 s36, s23, 86016
    buffer_load_dword v40, v4, s[64:67], s36 offen
    s_add_u32 s36, s23, 89600
    buffer_load_dword v41, v4, s[64:67], s36 offen
    s_add_u32 s36, s23, 93184
    buffer_load_dword v42, v4, s[64:67], s36 offen
    s_add_u32 s36, s23, 96768
    buffer_load_dword v43, v4, s[64:67], s36 offen
    s_add_u32 s36, s23, 100352
    buffer_load_dword v44, v4, s[64:67], s36 offen
    s_add_u32 s36, s23, 103936
    buffer_load_dword v45, v4, s[64:67], s36 offen
    s_add_u32 s36, s23, 107520
    buffer_load_dword v46, v4, s[64:67], s36 offen
    s_add_u32 s36, s23, 111104
    buffer_load_dword v47, v4, s[64:67], s36 offen
    s_waitcnt vmcnt(0)
    v_perm_b32 v128, v17, v16, s34
    v_perm_b32 v129, v19, v18, s34
    v_perm_b32 v130, v21, v20, s34
    v_perm_b32 v131, v23, v22, s34
    v_perm_b32 v132, v25, v24, s34
    v_perm_b32 v133, v27, v26, s34
    v_perm_b32 v134, v29, v28, s34
    v_perm_b32 v135, v31, v30, s34
    v_perm_b32 v136, v33, v32, s34
    v_perm_b32 v137, v35, v34, s34
    v_perm_b32 v138, v37, v36, s34
    v_perm_b32 v139, v39, v38, s34
    v_perm_b32 v140, v41, v40, s34
    v_perm_b32 v141, v43, v42, s34
    v_perm_b32 v142, v45, v44, s34
    v_perm_b32 v143, v47, v46, s34
    v_perm_b32 v160, v17, v16, s35
    v_perm_b32 v161, v19, v18, s35
    v_perm_b32 v162, v21, v20, s35
    v_perm_b32 v163, v23, v22, s35
    v_perm_b32 v164, v25, v24, s35
    v_perm_b32 v165, v27, v26, s35
    v_perm_b32 v166, v29, v28, s35
    v_perm_b32 v167, v31, v30, s35
    v_perm_b32 v168, v33, v32, s35
    v_perm_b32 v169, v35, v34, s35
    v_perm_b32 v170, v37, v36, s35
    v_perm_b32 v171, v39, v38, s35
    v_perm_b32 v172, v41, v40, s35
    v_perm_b32 v173, v43, v42, s35
    v_perm_b32 v174, v45, v44, s35
    v_perm_b32 v175, v47, v46, s35
    s_add_u32 s36, s23, 114688
    buffer_load_dword v16, v4, s[64:67], s36 offen
    s_add_u32 s36, s23, 118272
    buffer_load_dword v17, v4, s[64:67], s36 offen
    s_add_u32 s36, s23, 121856
    buffer_load_dword v18, v4, s[64:67], s36 offen
    s_add_u32 s36, s23, 125440
    buffer_load_dword v19, v4, s[64:67], s36 offen
    s_add_u32 s36, s23, 129024
    buffer_load_dword v20, v4, s[64:67], s36 offen
    s_add_u32 s36, s23, 132608
    buffer_load_dword v21, v4, s[64:67], s36 offen
    s_add_u32 s36, s23, 136192
    buffer_load_dword v22, v4, s[64:67], s36 offen
    s_add_u32 s36, s23, 139776
    buffer_load_dword v23, v4, s[64:67], s36 offen
    s_add_u32 s36, s23, 143360
    buffer_load_dword v24, v4, s[64:67], s36 offen
    s_add_u32 s36, s23, 146944
    buffer_load_dword v25, v4, s[64:67], s36 offen
    s_add_u32 s36, s23, 150528
    buffer_load_dword v26, v4, s[64:67], s36 offen
    s_add_u32 s36, s23, 154112
    buffer_load_dword v27, v4, s[64:67], s36 offen
    s_add_u32 s36, s23, 157696
    buffer_load_dword v28, v4, s[64:67], s36 offen
    s_add_u32 s36, s23, 161280
    buffer_load_dword v29, v4, s[64:67], s36 offen
    s_add_u32 s36, s23, 164864
    buffer_load_dword v30, v4, s[64:67], s36 offen
    s_add_u32 s36, s23, 168448
    buffer_load_dword v31, v4, s[64:67], s36 offen
    s_add_u32 s36, s23, 172032
    buffer_load_dword v32, v4, s[64:67], s36 offen
    s_add_u32 s36, s23, 175616
    buffer_load_dword v33, v4, s[64:67], s36 offen
    s_add_u32 s36, s23, 179200
    buffer_load_dword v34, v4, s[64:67], s36 offen
    s_add_u32 s36, s23, 182784
    buffer_load_dword v35, v4, s[64:67], s36 offen
    s_add_u32 s36, s23, 186368
    buffer_load_dword v36, v4, s[64:67], s36 offen
    s_add_u32 s36, s23, 189952
    buffer_load_dword v37, v4, s[64:67], s36 offen
    s_add_u32 s36, s23, 193536
    buffer_load_dword v38, v4, s[64:67], s36 offen
    s_add_u32 s36, s23, 197120
    buffer_load_dword v39, v4, s[64:67], s36 offen
    s_add_u32 s36, s23, 200704
    buffer_load_dword v40, v4, s[64:67], s36 offen
    s_add_u32 s36, s23, 204288
    buffer_load_dword v41, v4, s[64:67], s36 offen
    s_add_u32 s36, s23, 207872
    buffer_load_dword v42, v4, s[64:67], s36 offen
    s_add_u32 s36, s23, 211456
    buffer_load_dword v43, v4, s[64:67], s36 offen
    s_add_u32 s36, s23, 215040
    buffer_load_dword v44, v4, s[64:67], s36 offen
    s_add_u32 s36, s23, 218624
    buffer_load_dword v45, v4, s[64:67], s36 offen
    s_add_u32 s36, s23, 222208
    buffer_load_dword v46, v4, s[64:67], s36 offen
    s_add_u32 s36, s23, 225792
    buffer_load_dword v47, v4, s[64:67], s36 offen
    s_waitcnt vmcnt(0)
    v_perm_b32 v144, v17, v16, s34
    v_perm_b32 v145, v19, v18, s34
    v_perm_b32 v146, v21, v20, s34
    v_perm_b32 v147, v23, v22, s34
    v_perm_b32 v148, v25, v24, s34
    v_perm_b32 v149, v27, v26, s34
    v_perm_b32 v150, v29, v28, s34
    v_perm_b32 v151, v31, v30, s34
    v_perm_b32 v152, v33, v32, s34
    v_perm_b32 v153, v35, v34, s34
    v_perm_b32 v154, v37, v36, s34
    v_perm_b32 v155, v39, v38, s34
    v_perm_b32 v156, v41, v40, s34
    v_perm_b32 v157, v43, v42, s34
    v_perm_b32 v158, v45, v44, s34
    v_perm_b32 v159, v47, v46, s34
    v_perm_b32 v176, v17, v16, s35
    v_perm_b32 v177, v19, v18, s35
    v_perm_b32 v178, v21, v20, s35
    v_perm_b32 v179, v23, v22, s35
    v_perm_b32 v180, v25, v24, s35
    v_perm_b32 v181, v27, v26, s35
    v_perm_b32 v182, v29, v28, s35
    v_perm_b32 v183, v31, v30, s35
    v_perm_b32 v184, v33, v32, s35
    v_perm_b32 v185, v35, v34, s35
    v_perm_b32 v186, v37, v36, s35
    v_perm_b32 v187, v39, v38, s35
    v_perm_b32 v188, v41, v40, s35
    v_perm_b32 v189, v43, v42, s35
    v_perm_b32 v190, v45, v44, s35
    v_perm_b32 v191, v47, v46, s35
    s_add_u32 s36, s23, 0
    buffer_load_dword v16, v4, s[68:71], s36 offen
    s_add_u32 s36, s23, 3584
    buffer_load_dword v17, v4, s[68:71], s36 offen
    s_add_u32 s36, s23, 7168
    buffer_load_dword v18, v4, s[68:71], s36 offen
    s_add_u32 s36, s23, 10752
    buffer_load_dword v19, v4, s[68:71], s36 offen
    s_add_u32 s36, s23, 14336
    buffer_load_dword v20, v4, s[68:71], s36 offen
    s_add_u32 s36, s23, 17920
    buffer_load_dword v21, v4, s[68:71], s36 offen
    s_add_u32 s36, s23, 21504
    buffer_load_dword v22, v4, s[68:71], s36 offen
    s_add_u32 s36, s23, 25088
    buffer_load_dword v23, v4, s[68:71], s36 offen
    s_add_u32 s36, s23, 28672
    buffer_load_dword v24, v4, s[68:71], s36 offen
    s_add_u32 s36, s23, 32256
    buffer_load_dword v25, v4, s[68:71], s36 offen
    s_add_u32 s36, s23, 35840
    buffer_load_dword v26, v4, s[68:71], s36 offen
    s_add_u32 s36, s23, 39424
    buffer_load_dword v27, v4, s[68:71], s36 offen
    s_add_u32 s36, s23, 43008
    buffer_load_dword v28, v4, s[68:71], s36 offen
    s_add_u32 s36, s23, 46592
    buffer_load_dword v29, v4, s[68:71], s36 offen
    s_add_u32 s36, s23, 50176
    buffer_load_dword v30, v4, s[68:71], s36 offen
    s_add_u32 s36, s23, 53760
    buffer_load_dword v31, v4, s[68:71], s36 offen
    s_add_u32 s36, s23, 57344
    buffer_load_dword v32, v4, s[68:71], s36 offen
    s_add_u32 s36, s23, 60928
    buffer_load_dword v33, v4, s[68:71], s36 offen
    s_add_u32 s36, s23, 64512
    buffer_load_dword v34, v4, s[68:71], s36 offen
    s_add_u32 s36, s23, 68096
    buffer_load_dword v35, v4, s[68:71], s36 offen
    s_add_u32 s36, s23, 71680
    buffer_load_dword v36, v4, s[68:71], s36 offen
    s_add_u32 s36, s23, 75264
    buffer_load_dword v37, v4, s[68:71], s36 offen
    s_add_u32 s36, s23, 78848
    buffer_load_dword v38, v4, s[68:71], s36 offen
    s_add_u32 s36, s23, 82432
    buffer_load_dword v39, v4, s[68:71], s36 offen
    s_add_u32 s36, s23, 86016
    buffer_load_dword v40, v4, s[68:71], s36 offen
    s_add_u32 s36, s23, 89600
    buffer_load_dword v41, v4, s[68:71], s36 offen
    s_add_u32 s36, s23, 93184
    buffer_load_dword v42, v4, s[68:71], s36 offen
    s_add_u32 s36, s23, 96768
    buffer_load_dword v43, v4, s[68:71], s36 offen
    s_add_u32 s36, s23, 100352
    buffer_load_dword v44, v4, s[68:71], s36 offen
    s_add_u32 s36, s23, 103936
    buffer_load_dword v45, v4, s[68:71], s36 offen
    s_add_u32 s36, s23, 107520
    buffer_load_dword v46, v4, s[68:71], s36 offen
    s_add_u32 s36, s23, 111104
    buffer_load_dword v47, v4, s[68:71], s36 offen
    s_waitcnt vmcnt(0)
    v_perm_b32 v192, v17, v16, s34
    v_perm_b32 v193, v19, v18, s34
    v_perm_b32 v194, v21, v20, s34
    v_perm_b32 v195, v23, v22, s34
    v_perm_b32 v196, v25, v24, s34
    v_perm_b32 v197, v27, v26, s34
    v_perm_b32 v198, v29, v28, s34
    v_perm_b32 v199, v31, v30, s34
    v_perm_b32 v200, v33, v32, s34
    v_perm_b32 v201, v35, v34, s34
    v_perm_b32 v202, v37, v36, s34
    v_perm_b32 v203, v39, v38, s34
    v_perm_b32 v204, v41, v40, s34
    v_perm_b32 v205, v43, v42, s34
    v_perm_b32 v206, v45, v44, s34
    v_perm_b32 v207, v47, v46, s34
    v_perm_b32 v224, v17, v16, s35
    v_perm_b32 v225, v19, v18, s35
    v_perm_b32 v226, v21, v20, s35
    v_perm_b32 v227, v23, v22, s35
    v_perm_b32 v228, v25, v24, s35
    v_perm_b32 v229, v27, v26, s35
    v_perm_b32 v230, v29, v28, s35
    v_perm_b32 v231, v31, v30, s35
    v_perm_b32 v232, v33, v32, s35
    v_perm_b32 v233, v35, v34, s35
    v_perm_b32 v234, v37, v36, s35
    v_perm_b32 v235, v39, v38, s35
    v_perm_b32 v236, v41, v40, s35
    v_perm_b32 v237, v43, v42, s35
    v_perm_b32 v238, v45, v44, s35
    v_perm_b32 v239, v47, v46, s35
    s_add_u32 s36, s23, 114688
    buffer_load_dword v16, v4, s[68:71], s36 offen
    s_add_u32 s36, s23, 118272
    buffer_load_dword v17, v4, s[68:71], s36 offen
    s_add_u32 s36, s23, 121856
    buffer_load_dword v18, v4, s[68:71], s36 offen
    s_add_u32 s36, s23, 125440
    buffer_load_dword v19, v4, s[68:71], s36 offen
    s_add_u32 s36, s23, 129024
    buffer_load_dword v20, v4, s[68:71], s36 offen
    s_add_u32 s36, s23, 132608
    buffer_load_dword v21, v4, s[68:71], s36 offen
    s_add_u32 s36, s23, 136192
    buffer_load_dword v22, v4, s[68:71], s36 offen
    s_add_u32 s36, s23, 139776
    buffer_load_dword v23, v4, s[68:71], s36 offen
    s_add_u32 s36, s23, 143360
    buffer_load_dword v24, v4, s[68:71], s36 offen
    s_add_u32 s36, s23, 146944
    buffer_load_dword v25, v4, s[68:71], s36 offen
    s_add_u32 s36, s23, 150528
    buffer_load_dword v26, v4, s[68:71], s36 offen
    s_add_u32 s36, s23, 154112
    buffer_load_dword v27, v4, s[68:71], s36 offen
    s_add_u32 s36, s23, 157696
    buffer_load_dword v28, v4, s[68:71], s36 offen
    s_add_u32 s36, s23, 161280
    buffer_load_dword v29, v4, s[68:71], s36 offen
    s_add_u32 s36, s23, 164864
    buffer_load_dword v30, v4, s[68:71], s36 offen
    s_add_u32 s36, s23, 168448
    buffer_load_dword v31, v4, s[68:71], s36 offen
    s_add_u32 s36, s23, 172032
    buffer_load_dword v32, v4, s[68:71], s36 offen
    s_add_u32 s36, s23, 175616
    buffer_load_dword v33, v4, s[68:71], s36 offen
    s_add_u32 s36, s23, 179200
    buffer_load_dword v34, v4, s[68:71], s36 offen
    s_add_u32 s36, s23, 182784
    buffer_load_dword v35, v4, s[68:71], s36 offen
    s_add_u32 s36, s23, 186368
    buffer_load_dword v36, v4, s[68:71], s36 offen
    s_add_u32 s36, s23, 189952
    buffer_load_dword v37, v4, s[68:71], s36 offen
    s_add_u32 s36, s23, 193536
    buffer_load_dword v38, v4, s[68:71], s36 offen
    s_add_u32 s36, s23, 197120
    buffer_load_dword v39, v4, s[68:71], s36 offen
    s_add_u32 s36, s23, 200704
    buffer_load_dword v40, v4, s[68:71], s36 offen
    s_add_u32 s36, s23, 204288
    buffer_load_dword v41, v4, s[68:71], s36 offen
    s_add_u32 s36, s23, 207872
    buffer_load_dword v42, v4, s[68:71], s36 offen
    s_add_u32 s36, s23, 211456
    buffer_load_dword v43, v4, s[68:71], s36 offen
    s_add_u32 s36, s23, 215040
    buffer_load_dword v44, v4, s[68:71], s36 offen
    s_add_u32 s36, s23, 218624
    buffer_load_dword v45, v4, s[68:71], s36 offen
    s_add_u32 s36, s23, 222208
    buffer_load_dword v46, v4, s[68:71], s36 offen
    s_add_u32 s36, s23, 225792
    buffer_load_dword v47, v4, s[68:71], s36 offen
    s_waitcnt vmcnt(0)
    v_perm_b32 v208, v17, v16, s34
    v_perm_b32 v209, v19, v18, s34
    v_perm_b32 v210, v21, v20, s34
    v_perm_b32 v211, v23, v22, s34
    v_perm_b32 v212, v25, v24, s34
    v_perm_b32 v213, v27, v26, s34
    v_perm_b32 v214, v29, v28, s34
    v_perm_b32 v215, v31, v30, s34
    v_perm_b32 v216, v33, v32, s34
    v_perm_b32 v217, v35, v34, s34
    v_perm_b32 v218, v37, v36, s34
    v_perm_b32 v219, v39, v38, s34
    v_perm_b32 v220, v41, v40, s34
    v_perm_b32 v221, v43, v42, s34
    v_perm_b32 v222, v45, v44, s34
    v_perm_b32 v223, v47, v46, s34
    v_perm_b32 v240, v17, v16, s35
    v_perm_b32 v241, v19, v18, s35
    v_perm_b32 v242, v21, v20, s35
    v_perm_b32 v243, v23, v22, s35
    v_perm_b32 v244, v25, v24, s35
    v_perm_b32 v245, v27, v26, s35
    v_perm_b32 v246, v29, v28, s35
    v_perm_b32 v247, v31, v30, s35
    v_perm_b32 v248, v33, v32, s35
    v_perm_b32 v249, v35, v34, s35
    v_perm_b32 v250, v37, v36, s35
    v_perm_b32 v251, v39, v38, s35
    v_perm_b32 v252, v41, v40, s35
    v_perm_b32 v253, v43, v42, s35
    v_perm_b32 v254, v45, v44, s35
    v_perm_b32 v255, v47, v46, s35
    v_lshrrev_b32 v3, 3, v0
    v_mul_u32_u24 v4, 57344, v3
    v_and_b32 v3, 7, v0
    v_lshl_add_u32 v4, v3, 2, v4
    s_lshl_b32 s37, s20, 5
    s_add_u32 s36, s37, 0
    buffer_load_dword v16, v4, s[76:79], s36 offen
    s_add_u32 s36, s37, 1024
    buffer_load_dword v17, v4, s[76:79], s36 offen
    s_add_u32 s36, s37, 2048
    buffer_load_dword v18, v4, s[76:79], s36 offen
    s_add_u32 s36, s37, 3072
    buffer_load_dword v19, v4, s[76:79], s36 offen
    s_add_u32 s36, s37, 4096
    buffer_load_dword v20, v4, s[76:79], s36 offen
    s_add_u32 s36, s37, 5120
    buffer_load_dword v21, v4, s[76:79], s36 offen
    s_add_u32 s36, s37, 6144
    buffer_load_dword v22, v4, s[76:79], s36 offen
    s_add_u32 s36, s37, 7168
    buffer_load_dword v23, v4, s[76:79], s36 offen
    s_add_u32 s36, s37, 8192
    buffer_load_dword v24, v4, s[76:79], s36 offen
    s_add_u32 s36, s37, 9216
    buffer_load_dword v25, v4, s[76:79], s36 offen
    s_add_u32 s36, s37, 10240
    buffer_load_dword v26, v4, s[76:79], s36 offen
    s_add_u32 s36, s37, 11264
    buffer_load_dword v27, v4, s[76:79], s36 offen
    s_add_u32 s36, s37, 12288
    buffer_load_dword v28, v4, s[76:79], s36 offen
    s_add_u32 s36, s37, 13312
    buffer_load_dword v29, v4, s[76:79], s36 offen
    s_add_u32 s36, s37, 14336
    buffer_load_dword v30, v4, s[76:79], s36 offen
    s_add_u32 s36, s37, 15360
    buffer_load_dword v31, v4, s[76:79], s36 offen
    s_add_u32 s36, s37, 16384
    buffer_load_dword v32, v4, s[76:79], s36 offen
    s_add_u32 s36, s37, 17408
    buffer_load_dword v33, v4, s[76:79], s36 offen
    s_add_u32 s36, s37, 18432
    buffer_load_dword v34, v4, s[76:79], s36 offen
    s_add_u32 s36, s37, 19456
    buffer_load_dword v35, v4, s[76:79], s36 offen
    s_add_u32 s36, s37, 20480
    buffer_load_dword v36, v4, s[76:79], s36 offen
    s_add_u32 s36, s37, 21504
    buffer_load_dword v37, v4, s[76:79], s36 offen
    s_add_u32 s36, s37, 22528
    buffer_load_dword v38, v4, s[76:79], s36 offen
    s_add_u32 s36, s37, 23552
    buffer_load_dword v39, v4, s[76:79], s36 offen
    s_add_u32 s36, s37, 24576
    buffer_load_dword v40, v4, s[76:79], s36 offen
    s_add_u32 s36, s37, 25600
    buffer_load_dword v41, v4, s[76:79], s36 offen
    s_add_u32 s36, s37, 26624
    buffer_load_dword v42, v4, s[76:79], s36 offen
    s_add_u32 s36, s37, 27648
    buffer_load_dword v43, v4, s[76:79], s36 offen
    s_waitcnt vmcnt(0)
    v_perm_b32 v64, v17, v16, s34
    v_perm_b32 v65, v19, v18, s34
    v_perm_b32 v66, v21, v20, s34
    v_perm_b32 v67, v23, v22, s34
    v_perm_b32 v68, v25, v24, s34
    v_perm_b32 v69, v27, v26, s34
    v_perm_b32 v70, v29, v28, s34
    v_perm_b32 v71, v31, v30, s34
    v_perm_b32 v72, v33, v32, s34
    v_perm_b32 v73, v35, v34, s34
    v_perm_b32 v74, v37, v36, s34
    v_perm_b32 v75, v39, v38, s34
    v_perm_b32 v76, v41, v40, s34
    v_perm_b32 v77, v43, v42, s34
    v_perm_b32 v92, v17, v16, s35
    v_perm_b32 v93, v19, v18, s35
    v_perm_b32 v94, v21, v20, s35
    v_perm_b32 v95, v23, v22, s35
    v_perm_b32 v96, v25, v24, s35
    v_perm_b32 v97, v27, v26, s35
    v_perm_b32 v98, v29, v28, s35
    v_perm_b32 v99, v31, v30, s35
    v_perm_b32 v100, v33, v32, s35
    v_perm_b32 v101, v35, v34, s35
    v_perm_b32 v102, v37, v36, s35
    v_perm_b32 v103, v39, v38, s35
    v_perm_b32 v104, v41, v40, s35
    v_perm_b32 v105, v43, v42, s35
    s_add_u32 s36, s37, 28672
    buffer_load_dword v16, v4, s[76:79], s36 offen
    s_add_u32 s36, s37, 29696
    buffer_load_dword v17, v4, s[76:79], s36 offen
    s_add_u32 s36, s37, 30720
    buffer_load_dword v18, v4, s[76:79], s36 offen
    s_add_u32 s36, s37, 31744
    buffer_load_dword v19, v4, s[76:79], s36 offen
    s_add_u32 s36, s37, 32768
    buffer_load_dword v20, v4, s[76:79], s36 offen
    s_add_u32 s36, s37, 33792
    buffer_load_dword v21, v4, s[76:79], s36 offen
    s_add_u32 s36, s37, 34816
    buffer_load_dword v22, v4, s[76:79], s36 offen
    s_add_u32 s36, s37, 35840
    buffer_load_dword v23, v4, s[76:79], s36 offen
    s_add_u32 s36, s37, 36864
    buffer_load_dword v24, v4, s[76:79], s36 offen
    s_add_u32 s36, s37, 37888
    buffer_load_dword v25, v4, s[76:79], s36 offen
    s_add_u32 s36, s37, 38912
    buffer_load_dword v26, v4, s[76:79], s36 offen
    s_add_u32 s36, s37, 39936
    buffer_load_dword v27, v4, s[76:79], s36 offen
    s_add_u32 s36, s37, 40960
    buffer_load_dword v28, v4, s[76:79], s36 offen
    s_add_u32 s36, s37, 41984
    buffer_load_dword v29, v4, s[76:79], s36 offen
    s_add_u32 s36, s37, 43008
    buffer_load_dword v30, v4, s[76:79], s36 offen
    s_add_u32 s36, s37, 44032
    buffer_load_dword v31, v4, s[76:79], s36 offen
    s_add_u32 s36, s37, 45056
    buffer_load_dword v32, v4, s[76:79], s36 offen
    s_add_u32 s36, s37, 46080
    buffer_load_dword v33, v4, s[76:79], s36 offen
    s_add_u32 s36, s37, 47104
    buffer_load_dword v34, v4, s[76:79], s36 offen
    s_add_u32 s36, s37, 48128
    buffer_load_dword v35, v4, s[76:79], s36 offen
    s_add_u32 s36, s37, 49152
    buffer_load_dword v36, v4, s[76:79], s36 offen
    s_add_u32 s36, s37, 50176
    buffer_load_dword v37, v4, s[76:79], s36 offen
    s_add_u32 s36, s37, 51200
    buffer_load_dword v38, v4, s[76:79], s36 offen
    s_add_u32 s36, s37, 52224
    buffer_load_dword v39, v4, s[76:79], s36 offen
    s_add_u32 s36, s37, 53248
    buffer_load_dword v40, v4, s[76:79], s36 offen
    s_add_u32 s36, s37, 54272
    buffer_load_dword v41, v4, s[76:79], s36 offen
    s_add_u32 s36, s37, 55296
    buffer_load_dword v42, v4, s[76:79], s36 offen
    s_add_u32 s36, s37, 56320
    buffer_load_dword v43, v4, s[76:79], s36 offen
    s_waitcnt vmcnt(0)
    v_perm_b32 v78, v17, v16, s34
    v_perm_b32 v79, v19, v18, s34
    v_perm_b32 v80, v21, v20, s34
    v_perm_b32 v81, v23, v22, s34
    v_perm_b32 v82, v25, v24, s34
    v_perm_b32 v83, v27, v26, s34
    v_perm_b32 v84, v29, v28, s34
    v_perm_b32 v85, v31, v30, s34
    v_perm_b32 v86, v33, v32, s34
    v_perm_b32 v87, v35, v34, s34
    v_perm_b32 v88, v37, v36, s34
    v_perm_b32 v89, v39, v38, s34
    v_perm_b32 v90, v41, v40, s34
    v_perm_b32 v91, v43, v42, s34
    v_perm_b32 v106, v17, v16, s35
    v_perm_b32 v107, v19, v18, s35
    v_perm_b32 v108, v21, v20, s35
    v_perm_b32 v109, v23, v22, s35
    v_perm_b32 v110, v25, v24, s35
    v_perm_b32 v111, v27, v26, s35
    v_perm_b32 v112, v29, v28, s35
    v_perm_b32 v113, v31, v30, s35
    v_perm_b32 v114, v33, v32, s35
    v_perm_b32 v115, v35, v34, s35
    v_perm_b32 v116, v37, v36, s35
    v_perm_b32 v117, v39, v38, s35
    v_perm_b32 v118, v41, v40, s35
    v_perm_b32 v119, v43, v42, s35
    s_mov_b32 s24, 0
    s_mov_b64 s[28:29], 0
    v_mov_b32 v12, 0x40000000
    v_mov_b32 v13, 0
    v_lshlrev_b32 v3, 4, v0
L_M06_rp:
    s_mov_b32 s36, 0x19a000
    buffer_load_dwordx4 v[40:43], v3, s[8:11], s36 offen sc1
    s_add_u32 s32, s32, 1
    v_mov_b32 v5, 0
    s_waitcnt vmcnt(0)
    v_max3_u32 v5, v5, v40, v41
    v_max3_u32 v5, v5, v42, v43
    s_cmp_gt_u32 s32, 200000
    s_cbranch_scc1 L_M06_rp_ok
    v_cmp_eq_u32 vcc, -1, v5
    s_cbranch_vccz L_M06_rp_ok
    s_sleep 32
    s_branch L_M06_rp
L_M06_rp_ok:
    v_add_f32 v40, v40, v41
    v_add_f32 v42, v42, v43
    v_add_f32 v40, v40, v42
    v_cvt_pk_bf16_f32 v5, v40, v40
    v_lshlrev_b32 v40, 16, v5
    v_ashrrev_i32 v5, 31, v40
    v_or_b32 v5, 0x80000000, v5
    v_xor_b32 v5, v5, v40
    v_and_b32 v5, 0xffff0000, v5
    v_sub_u32 v6, 511, v0
    v_or_b32 v126, v5, v6
    v_lshlrev_b32 v3, 4, v0
L_M01_rp:
    s_mov_b32 s36, 0x195000
    buffer_load_dwordx4 v[20:23], v3, s[8:11], s36 offen sc1
    s_mov_b32 s36, 0x196000
    buffer_load_dwordx4 v[24:27], v3, s[8:11], s36 offen sc1
    s_mov_b32 s36, 0x197000
    buffer_load_dwordx4 v[28:31], v3, s[8:11], s36 offen sc1
    s_mov_b32 s36, 0x198000
    buffer_load_dwordx4 v[32:35], v3, s[8:11], s36 offen sc1
    s_mov_b32 s36, 0x199000
    buffer_load_dwordx4 v[36:39], v3, s[8:11], s36 offen sc1
    s_add_u32 s32, s32, 1
    v_mov_b32 v5, 0
    s_waitcnt vmcnt(0)
    v_max3_u32 v5, v5, v20, v21
    v_max3_u32 v5, v5, v22, v23
    v_max3_u32 v5, v5, v24, v25
    v_max3_u32 v5, v5, v26, v27
    v_max3_u32 v5, v5, v28, v29
    v_max3_u32 v5, v5, v30, v31
    v_max3_u32 v5, v5, v32, v33
    v_max3_u32 v5, v5, v34, v35
    v_max3_u32 v5, v5, v36, v37
    v_max3_u32 v5, v5, v38, v39
    s_cmp_gt_u32 s32, 200000
    s_cbranch_scc1 L_M01_rp_ok
    v_cmp_eq_u32 vcc, -1, v5
    s_cbranch_vccz L_M01_rp_ok
    s_sleep 8
    s_branch L_M01_rp
L_M01_rp_ok:
    v_add_f32 v20, v20, v21
    v_add_f32 v22, v22, v23
    v_add_f32 v20, v20, v22
    v_cvt_pk_bf16_f32 v5, v20, v20
    v_lshlrev_b32 v20, 16, v5
    v_ashrrev_i32 v5, 31, v20
    v_or_b32 v5, 0x80000000, v5
    v_xor_b32 v5, v5, v20
    v_and_b32 v5, 0xffff0000, v5
    v_sub_u32 v6, 1791, v0
    v_or_b32 v121, v5, v6
    v_add_f32 v24, v24, v25
    v_add_f32 v26, v26, v27
    v_add_f32 v24, v24, v26
    v_cvt_pk_bf16_f32 v5, v24, v24
    v_lshlrev_b32 v24, 16, v5
    v_ashrrev_i32 v5, 31, v24
    v_or_b32 v5, 0x80000000, v5
    v_xor_b32 v5, v5, v24
    v_and_b32 v5, 0xffff0000, v5
    v_sub_u32 v6, 1535, v0
    v_or_b32 v122, v5, v6
    v_add_f32 v28, v28, v29
    v_add_f32 v30, v30, v31
    v_add_f32 v28, v28, v30
    v_cvt_pk_bf16_f32 v5, v28, v28
    v_lshlrev_b32 v28, 16, v5
    v_ashrrev_i32 v5, 31, v28
    v_or_b32 v5, 0x80000000, v5
    v_xor_b32 v5, v5, v28
    v_and_b32 v5, 0xffff0000, v5
    v_sub_u32 v6, 1279, v0
    v_or_b32 v123, v5, v6
    v_add_f32 v32, v32, v33
    v_add_f32 v34, v34, v35
    v_add_f32 v32, v32, v34
    v_cvt_pk_bf16_f32 v5, v32, v32
    v_lshlrev_b32 v32, 16, v5
    v_ashrrev_i32 v5, 31, v32
    v_or_b32 v5, 0x80000000, v5
    v_xor_b32 v5, v5, v32
    v_and_b32 v5, 0xffff0000, v5
    v_sub_u32 v6, 1023, v0
    v_or_b32 v124, v5, v6
    v_add_f32 v36, v36, v37
    v_add_f32 v38, v38, v39
    v_add_f32 v36, v36, v38
    v_cvt_pk_bf16_f32 v5, v36, v36
    v_lshlrev_b32 v36, 16, v5
    v_ashrrev_i32 v5, 31, v36
    v_or_b32 v5, 0x80000000, v5
    v_xor_b32 v5, v5, v36
    v_and_b32 v5, 0xffff0000, v5
    v_sub_u32 v6, 767, v0
    v_or_b32 v125, v5, v6
    v_max_u32 v5, v120, v121
    v_min_u32 v6, v120, v121
    v_med3_u32 v6, v5, v6, v122
    v_max_u32 v5, v5, v122
    v_med3_u32 v6, v5, v6, v123
    v_max_u32 v5, v5, v123
    v_med3_u32 v6, v5, v6, v124
    v_max_u32 v5, v5, v124
    v_med3_u32 v6, v5, v6, v125
    v_max_u32 v5, v5, v125
    v_med3_u32 v6, v5, v6, v126
    v_max_u32 v5, v5, v126
    v_mov_b32 v120, v5
    v_mov_b32 v121, v6
    s_mov_b32 s25, 32
L_M_round:
    v_lshlrev_b32 v3, 4, v0
    v_cmp_gt_u32 s[74:75], s25, v0
L_M7_rp:
    s_mov_b32 s36, 0x19b000
    buffer_load_dwordx4 v[44:47], v3, s[8:11], s36 offen sc1
    s_add_u32 s32, s32, 1
    v_mov_b32 v5, 0
    s_waitcnt vmcnt(0)
    v_max3_u32 v5, v5, v44, v45
    v_max3_u32 v5, v5, v46, v47
    v_cndmask_b32 v5, 0, v5, s[74:75]
    s_cmp_gt_u32 s32, 200000
    s_cbranch_scc1 L_M7_rp_ok
    v_cmp_eq_u32 vcc, -1, v5
    s_cbranch_vccnz L_M7_rp
L_M7_rp_ok:
    v_add_f32 v44, v44, v45
    v_add_f32 v46, v46, v47
    v_add_f32 v44, v44, v46
    v_cvt_pk_bf16_f32 v5, v44, v44
    v_lshlrev_b32 v44, 16, v5
    v_ashrrev_i32 v5, 31, v44
    v_or_b32 v5, 0x80000000, v5
    v_xor_b32 v5, v5, v44
    v_and_b32 v5, 0xffff0000, v5
    v_sub_u32 v6, 255, v0
    v_or_b32 v127, v5, v6
    v_cndmask_b32 v127, 0, v127, s[74:75]
    v_max_u32 v5, v120, v127
    v_med3_u32 v6, v120, v121, v127
    s_nop 0
    v_mov_b32_dpp v7, v5 quad_perm:[1,0,3,2] row_mask:0xf bank_mask:0xf
    v_mov_b32_dpp v8, v6 quad_perm:[1,0,3,2] row_mask:0xf bank_mask:0xf
    v_min_u32 v9, v5, v7
    v_max_u32 v5, v5, v7
    v_max3_u32 v6, v6, v8, v9
    s_nop 0
    v_mov_b32_dpp v7, v5 quad_perm:[2,3,0,1] row_mask:0xf bank_mask:0xf
    v_mov_b32_dpp v8, v6 quad_perm:[2,3,0,1] row_mask:0xf bank_mask:0xf
    v_min_u32 v9, v5, v7
    v_max_u32 v5, v5, v7
    v_max3_u32 v6, v6, v8, v9
    s_nop 0
    v_mov_b32_dpp v7, v5 row_half_mirror row_mask:0xf bank_mask:0xf
    v_mov_b32_dpp v8, v6 row_half_mirror row_mask:0xf bank_mask:0xf
    v_min_u32 v9, v5, v7
    v_max_u32 v5, v5, v7
    v_max3_u32 v6, v6, v8, v9
    s_nop 0
    v_mov_b32_dpp v7, v5 row_mirror row_mask:0xf bank_mask:0xf
    v_mov_b32_dpp v8, v6 row_mirror row_mask:0xf bank_mask:0xf
    v_min_u32 v9, v5, v7
    v_max_u32 v5, v5, v7
    v_max3_u32 v6, v6, v8, v9
    v_lshrrev_b32 v9, 4, v0
    v_lshlrev_b32 v9, 3, v9
    s_barrier
    ds_write2_b32 v9, v5, v6 offset0:0 offset1:1
    v_and_b32 v9, 15, v0
    v_lshlrev_b32 v9, 3, v9
    s_waitcnt lgkmcnt(0)
    s_barrier
    ds_read2_b32 v[10:11], v9 offset0:0 offset1:1
    s_waitcnt lgkmcnt(0)
    v_mov_b32 v5, v10
    v_mov_b32 v6, v11
    s_nop 0
    v_mov_b32_dpp v7, v5 quad_perm:[1,0,3,2] row_mask:0xf bank_mask:0xf
    v_mov_b32_dpp v8, v6 quad_perm:[1,0,3,2] row_mask:0xf bank_mask:0xf
    v_min_u32 v9, v5, v7
    v_max_u32 v5, v5, v7
    v_max3_u32 v6, v6, v8, v9
    s_nop 0
    v_mov_b32_dpp v7, v5 quad_perm:[2,3,0,1] row_mask:0xf bank_mask:0xf
    v_mov_b32_dpp v8, v6 quad_perm:[2,3,0,1] row_mask:0xf bank_mask:0xf
    v_min_u32 v9, v5, v7
    v_max_u32 v5, v5, v7
    v_max3_u32 v6, v6, v8, v9
    s_nop 0
    v_mov_b32_dpp v7, v5 row_half_mirror row_mask:0xf bank_mask:0xf
    v_mov_b32_dpp v8, v6 row_half_mirror row_mask:0xf bank_mask:0xf
    v_min_u32 v9, v5, v7
    v_max_u32 v5, v5, v7
    v_max3_u32 v6, v6, v8, v9
    s_nop 0
    v_mov_b32_dpp v7, v5 row_mirror row_mask:0xf bank_mask:0xf
    v_mov_b32_dpp v8, v6 row_mirror row_mask:0xf bank_mask:0xf
    v_min_u32 v9, v5, v7
    v_max_u32 v5, v5, v7
    v_max3_u32 v6, v6, v8, v9
    v_readfirstlane_b32 s26, v5
    v_readfirstlane_b32 s27, v6
    s_nop 3
    s_cmp_eq_u64 s[26:27], s[28:29]
    s_cbranch_scc1 L_M_next
    s_mov_b64 s[28:29], s[26:27]
    s_and_b32 s36, s26, 0x7ff
    s_sub_u32 s30, 2047, s36
    s_and_b32 s36, s26, 0xffff0000
    s_xor_b32 s37, s36, 0x80000000
    s_xor_b32 s40, s36, 0xffff0000
    s_bitcmp1_b32 s36, 31
    s_cselect_b32 s40, s37, s40
    s_and_b32 s36, s27, 0x7ff
    s_sub_u32 s31, 2047, s36
    s_and_b32 s36, s27, 0xffff0000
    s_xor_b32 s37, s36, 0x80000000
    s_xor_b32 s41, s36, 0xffff0000
    s_bitcmp1_b32 s36, 31
    s_cselect_b32 s41, s37, s41
    v_mov_b32 v8, 0
L_M_rows:
    s_lshl_b32 s36, s30, 4
    s_add_u32 s36, s36, 0x1b8000
    buffer_load_dwordx4 v[16:19], v8, s[8:11], s36 offen sc1
    s_lshl_b32 s36, s31, 4
    s_add_u32 s36, s36, 0x1b8000
    buffer_load_dwordx4 v[20:23], v8, s[8:11], s36 offen sc1
    s_add_u32 s32, s32, 1
    s_cmp_gt_u32 s32, 200000
    s_waitcnt vmcnt(0)
    v_or3_b32 v5, v16, v17, v18
    v_or3_b32 v5, v5, v19, v20
    v_or3_b32 v5, v5, v21, v22
    v_or_b32 v5, v5, v23
    s_cbranch_scc1 L_M_rows_ok
    v_cmp_ne_u32 vcc, 0, v5
    s_cbranch_vccnz L_M_rows
L_M_rows_ok:
    v_bfe_u32 v9, v0, 6, 1
    v_cmp_ne_u32 vcc, 0, v9
    v_mov_b32 v5, s30
    v_mov_b32 v6, s31
    v_cndmask_b32 v7, v5, v6, vcc
    v_lshlrev_b32 v7, 10, v7
    v_and_b32 v8, 63, v0
    v_lshl_add_u32 v7, v8, 4, v7
    s_mov_b32 s37, 0x600000
    buffer_load_dwordx4 v[16:19], v7, s[8:11], s37 offen sc1
    v_bfe_u32 v9, v0, 3, 1
    v_cmp_ne_u32 vcc, 0, v9
    s_nop 1
    v_cndmask_b32 v12, v5, v6, vcc
    v_mov_b32 v5, s40
    v_mov_b32 v6, s41
    v_cndmask_b32 v11, v5, v6, vcc
    v_lshlrev_b32 v12, 10, v12
    v_and_b32 v3, 7, v0
    v_lshl_add_u32 v12, v3, 2, v12
    s_lshl_b32 s36, s20, 5
    v_add_u32 v12, s36, v12
    v_mov_b32 v7, 0x40000000
    v_cmp_lt_u32 vcc, 15, v0
    s_nop 1
    v_cndmask_b32 v12, v12, v7, vcc
    s_mov_b32 s36, 0x400000
    buffer_load_dword v14, v12, s[8:11], s36 offen sc1
    buffer_load_dword v15, v12, s[8:11], s37 offen sc1
    v_and_b32 v8, 127, v0
    v_lshlrev_b32 v8, 4, v8
    s_waitcnt vmcnt(2)
    ds_write_b128 v8, v[16:19] offset:4096
    s_waitcnt lgkmcnt(0)
    s_barrier
    v_mov_b64 v[48:49], 0
    v_mov_b64 v[50:51], 0
    v_mov_b64 v[52:53], 0
    v_mov_b64 v[54:55], 0
    v_lshlrev_b32 v8, 7, v1
    ds_read_b128 v[16:19], v8 offset:4096
    ds_read_b128 v[20:23], v8 offset:4112
    ds_read_b128 v[24:27], v8 offset:4128
    ds_read_b128 v[28:31], v8 offset:4144
    ds_read_b128 v[32:35], v8 offset:5120
    ds_read_b128 v[36:39], v8 offset:5136
    ds_read_b128 v[40:43], v8 offset:5152
    ds_read_b128 v[44:47], v8 offset:5168
    s_waitcnt lgkmcnt(0)
    v_dot2_f32_bf16 v48, v16, v128, v48
    v_dot2_f32_bf16 v49, v16, v160, v49
    v_dot2_f32_bf16 v50, v32, v128, v50
    v_dot2_f32_bf16 v51, v32, v160, v51
    v_dot2_f32_bf16 v52, v16, v192, v52
    v_dot2_f32_bf16 v53, v16, v224, v53
    v_dot2_f32_bf16 v54, v32, v192, v54
    v_dot2_f32_bf16 v55, v32, v224, v55
    v_dot2_f32_bf16 v48, v17, v129, v48
    v_dot2_f32_bf16 v49, v17, v161, v49
    v_dot2_f32_bf16 v50, v33, v129, v50
    v_dot2_f32_bf16 v51, v33, v161, v51
    v_dot2_f32_bf16 v52, v17, v193, v52
    v_dot2_f32_bf16 v53, v17, v225, v53
    v_dot2_f32_bf16 v54, v33, v193, v54
    v_dot2_f32_bf16 v55, v33, v225, v55
    v_dot2_f32_bf16 v48, v18, v130, v48
    v_dot2_f32_bf16 v49, v18, v162, v49
    v_dot2_f32_bf16 v50, v34, v130, v50
    v_dot2_f32_bf16 v51, v34, v162, v51
    v_dot2_f32_bf16 v52, v18, v194, v52
    v_dot2_f32_bf16 v53, v18, v226, v53
    v_dot2_f32_bf16 v54, v34, v194, v54
    v_dot2_f32_bf16 v55, v34, v226, v55
    v_dot2_f32_bf16 v48, v19, v131, v48
    v_dot2_f32_bf16 v49, v19, v163, v49
    v_dot2_f32_bf16 v50, v35, v131, v50
    v_dot2_f32_bf16 v51, v35, v163, v51
    v_dot2_f32_bf16 v52, v19, v195, v52
    v_dot2_f32_bf16 v53, v19, v227, v53
    v_dot2_f32_bf16 v54, v35, v195, v54
    v_dot2_f32_bf16 v55, v35, v227, v55
    v_dot2_f32_bf16 v48, v20, v132, v48
    v_dot2_f32_bf16 v49, v20, v164, v49
    v_dot2_f32_bf16 v50, v36, v132, v50
    v_dot2_f32_bf16 v51, v36, v164, v51
    v_dot2_f32_bf16 v52, v20, v196, v52
    v_dot2_f32_bf16 v53, v20, v228, v53
    v_dot2_f32_bf16 v54, v36, v196, v54
    v_dot2_f32_bf16 v55, v36, v228, v55
    v_dot2_f32_bf16 v48, v21, v133, v48
    v_dot2_f32_bf16 v49, v21, v165, v49
    v_dot2_f32_bf16 v50, v37, v133, v50
    v_dot2_f32_bf16 v51, v37, v165, v51
    v_dot2_f32_bf16 v52, v21, v197, v52
    v_dot2_f32_bf16 v53, v21, v229, v53
    v_dot2_f32_bf16 v54, v37, v197, v54
    v_dot2_f32_bf16 v55, v37, v229, v55
    v_dot2_f32_bf16 v48, v22, v134, v48
    v_dot2_f32_bf16 v49, v22, v166, v49
    v_dot2_f32_bf16 v50, v38, v134, v50
    v_dot2_f32_bf16 v51, v38, v166, v51
    v_dot2_f32_bf16 v52, v22, v198, v52
    v_dot2_f32_bf16 v53, v22, v230, v53
    v_dot2_f32_bf16 v54, v38, v198, v54
    v_dot2_f32_bf16 v55, v38, v230, v55
    v_dot2_f32_bf16 v48, v23, v135, v48
    v_dot2_f32_bf16 v49, v23, v167, v49
    v_dot2_f32_bf16 v50, v39, v135, v50
    v_dot2_f32_bf16 v51, v39, v167, v51
    v_dot2_f32_bf16 v52, v23, v199, v52
    v_dot2_f32_bf16 v53, v23, v231, v53
    v_dot2_f32_bf16 v54, v39, v199, v54
    v_dot2_f32_bf16 v55, v39, v231, v55
    v_dot2_f32_bf16 v48, v24, v136, v48
    v_dot2_f32_bf16 v49, v24, v168, v49
    v_dot2_f32_bf16 v50, v40, v136, v50
    v_dot2_f32_bf16 v51, v40, v168, v51
    v_dot2_f32_bf16 v52, v24, v200, v52
    v_dot2_f32_bf16 v53, v24, v232, v53
    v_dot2_f32_bf16 v54, v40, v200, v54
    v_dot2_f32_bf16 v55, v40, v232, v55
    v_dot2_f32_bf16 v48, v25, v137, v48
    v_dot2_f32_bf16 v49, v25, v169, v49
    v_dot2_f32_bf16 v50, v41, v137, v50
    v_dot2_f32_bf16 v51, v41, v169, v51
    v_dot2_f32_bf16 v52, v25, v201, v52
    v_dot2_f32_bf16 v53, v25, v233, v53
    v_dot2_f32_bf16 v54, v41, v201, v54
    v_dot2_f32_bf16 v55, v41, v233, v55
    v_dot2_f32_bf16 v48, v26, v138, v48
    v_dot2_f32_bf16 v49, v26, v170, v49
    v_dot2_f32_bf16 v50, v42, v138, v50
    v_dot2_f32_bf16 v51, v42, v170, v51
    v_dot2_f32_bf16 v52, v26, v202, v52
    v_dot2_f32_bf16 v53, v26, v234, v53
    v_dot2_f32_bf16 v54, v42, v202, v54
    v_dot2_f32_bf16 v55, v42, v234, v55
    v_dot2_f32_bf16 v48, v27, v139, v48
    v_dot2_f32_bf16 v49, v27, v171, v49
    v_dot2_f32_bf16 v50, v43, v139, v50
    v_dot2_f32_bf16 v51, v43, v171, v51
    v_dot2_f32_bf16 v52, v27, v203, v52
    v_dot2_f32_bf16 v53, v27, v235, v53
    v_dot2_f32_bf16 v54, v43, v203, v54
    v_dot2_f32_bf16 v55, v43, v235, v55
    v_dot2_f32_bf16 v48, v28, v140, v48
    v_dot2_f32_bf16 v49, v28, v172, v49
    v_dot2_f32_bf16 v50, v44, v140, v50
    v_dot2_f32_bf16 v51, v44, v172, v51
    v_dot2_f32_bf16 v52, v28, v204, v52
    v_dot2_f32_bf16 v53, v28, v236, v53
    v_dot2_f32_bf16 v54, v44, v204, v54
    v_dot2_f32_bf16 v55, v44, v236, v55
    v_dot2_f32_bf16 v48, v29, v141, v48
    v_dot2_f32_bf16 v49, v29, v173, v49
    v_dot2_f32_bf16 v50, v45, v141, v50
    v_dot2_f32_bf16 v51, v45, v173, v51
    v_dot2_f32_bf16 v52, v29, v205, v52
    v_dot2_f32_bf16 v53, v29, v237, v53
    v_dot2_f32_bf16 v54, v45, v205, v54
    v_dot2_f32_bf16 v55, v45, v237, v55
    v_dot2_f32_bf16 v48, v30, v142, v48
    v_dot2_f32_bf16 v49, v30, v174, v49
    v_dot2_f32_bf16 v50, v46, v142, v50
    v_dot2_f32_bf16 v51, v46, v174, v51
    v_dot2_f32_bf16 v52, v30, v206, v52
    v_dot2_f32_bf16 v53, v30, v238, v53
    v_dot2_f32_bf16 v54, v46, v206, v54
    v_dot2_f32_bf16 v55, v46, v238, v55
    v_dot2_f32_bf16 v48, v31, v143, v48
    v_dot2_f32_bf16 v49, v31, v175, v49
    v_dot2_f32_bf16 v50, v47, v143, v50
    v_dot2_f32_bf16 v51, v47, v175, v51
    v_dot2_f32_bf16 v52, v31, v207, v52
    v_dot2_f32_bf16 v53, v31, v239, v53
    v_dot2_f32_bf16 v54, v47, v207, v54
    v_dot2_f32_bf16 v55, v47, v239, v55
    ds_read_b128 v[16:19], v8 offset:4160
    ds_read_b128 v[20:23], v8 offset:4176
    ds_read_b128 v[24:27], v8 offset:4192
    ds_read_b128 v[28:31], v8 offset:4208
    ds_read_b128 v[32:35], v8 offset:5184
    ds_read_b128 v[36:39], v8 offset:5200
    ds_read_b128 v[40:43], v8 offset:5216
    ds_read_b128 v[44:47], v8 offset:5232
    s_waitcnt lgkmcnt(0)
    v_dot2_f32_bf16 v48, v16, v144, v48
    v_dot2_f32_bf16 v49, v16, v176, v49
    v_dot2_f32_bf16 v50, v32, v144, v50
    v_dot2_f32_bf16 v51, v32, v176, v51
    v_dot2_f32_bf16 v52, v16, v208, v52
    v_dot2_f32_bf16 v53, v16, v240, v53
    v_dot2_f32_bf16 v54, v32, v208, v54
    v_dot2_f32_bf16 v55, v32, v240, v55
    v_dot2_f32_bf16 v48, v17, v145, v48
    v_dot2_f32_bf16 v49, v17, v177, v49
    v_dot2_f32_bf16 v50, v33, v145, v50
    v_dot2_f32_bf16 v51, v33, v177, v51
    v_dot2_f32_bf16 v52, v17, v209, v52
    v_dot2_f32_bf16 v53, v17, v241, v53
    v_dot2_f32_bf16 v54, v33, v209, v54
    v_dot2_f32_bf16 v55, v33, v241, v55
    v_dot2_f32_bf16 v48, v18, v146, v48
    v_dot2_f32_bf16 v49, v18, v178, v49
    v_dot2_f32_bf16 v50, v34, v146, v50
    v_dot2_f32_bf16 v51, v34, v178, v51
    v_dot2_f32_bf16 v52, v18, v210, v52
    v_dot2_f32_bf16 v53, v18, v242, v53
    v_dot2_f32_bf16 v54, v34, v210, v54
    v_dot2_f32_bf16 v55, v34, v242, v55
    v_dot2_f32_bf16 v48, v19, v147, v48
    v_dot2_f32_bf16 v49, v19, v179, v49
    v_dot2_f32_bf16 v50, v35, v147, v50
    v_dot2_f32_bf16 v51, v35, v179, v51
    v_dot2_f32_bf16 v52, v19, v211, v52
    v_dot2_f32_bf16 v53, v19, v243, v53
    v_dot2_f32_bf16 v54, v35, v211, v54
    v_dot2_f32_bf16 v55, v35, v243, v55
    v_dot2_f32_bf16 v48, v20, v148, v48
    v_dot2_f32_bf16 v49, v20, v180, v49
    v_dot2_f32_bf16 v50, v36, v148, v50
    v_dot2_f32_bf16 v51, v36, v180, v51
    v_dot2_f32_bf16 v52, v20, v212, v52
    v_dot2_f32_bf16 v53, v20, v244, v53
    v_dot2_f32_bf16 v54, v36, v212, v54
    v_dot2_f32_bf16 v55, v36, v244, v55
    v_dot2_f32_bf16 v48, v21, v149, v48
    v_dot2_f32_bf16 v49, v21, v181, v49
    v_dot2_f32_bf16 v50, v37, v149, v50
    v_dot2_f32_bf16 v51, v37, v181, v51
    v_dot2_f32_bf16 v52, v21, v213, v52
    v_dot2_f32_bf16 v53, v21, v245, v53
    v_dot2_f32_bf16 v54, v37, v213, v54
    v_dot2_f32_bf16 v55, v37, v245, v55
    v_dot2_f32_bf16 v48, v22, v150, v48
    v_dot2_f32_bf16 v49, v22, v182, v49
    v_dot2_f32_bf16 v50, v38, v150, v50
    v_dot2_f32_bf16 v51, v38, v182, v51
    v_dot2_f32_bf16 v52, v22, v214, v52
    v_dot2_f32_bf16 v53, v22, v246, v53
    v_dot2_f32_bf16 v54, v38, v214, v54
    v_dot2_f32_bf16 v55, v38, v246, v55
    v_dot2_f32_bf16 v48, v23, v151, v48
    v_dot2_f32_bf16 v49, v23, v183, v49
    v_dot2_f32_bf16 v50, v39, v151, v50
    v_dot2_f32_bf16 v51, v39, v183, v51
    v_dot2_f32_bf16 v52, v23, v215, v52
    v_dot2_f32_bf16 v53, v23, v247, v53
    v_dot2_f32_bf16 v54, v39, v215, v54
    v_dot2_f32_bf16 v55, v39, v247, v55
    v_dot2_f32_bf16 v48, v24, v152, v48
    v_dot2_f32_bf16 v49, v24, v184, v49
    v_dot2_f32_bf16 v50, v40, v152, v50
    v_dot2_f32_bf16 v51, v40, v184, v51
    v_dot2_f32_bf16 v52, v24, v216, v52
    v_dot2_f32_bf16 v53, v24, v248, v53
    v_dot2_f32_bf16 v54, v40, v216, v54
    v_dot2_f32_bf16 v55, v40, v248, v55
    v_dot2_f32_bf16 v48, v25, v153, v48
    v_dot2_f32_bf16 v49, v25, v185, v49
    v_dot2_f32_bf16 v50, v41, v153, v50
    v_dot2_f32_bf16 v51, v41, v185, v51
    v_dot2_f32_bf16 v52, v25, v217, v52
    v_dot2_f32_bf16 v53, v25, v249, v53
    v_dot2_f32_bf16 v54, v41, v217, v54
    v_dot2_f32_bf16 v55, v41, v249, v55
    v_dot2_f32_bf16 v48, v26, v154, v48
    v_dot2_f32_bf16 v49, v26, v186, v49
    v_dot2_f32_bf16 v50, v42, v154, v50
    v_dot2_f32_bf16 v51, v42, v186, v51
    v_dot2_f32_bf16 v52, v26, v218, v52
    v_dot2_f32_bf16 v53, v26, v250, v53
    v_dot2_f32_bf16 v54, v42, v218, v54
    v_dot2_f32_bf16 v55, v42, v250, v55
    v_dot2_f32_bf16 v48, v27, v155, v48
    v_dot2_f32_bf16 v49, v27, v187, v49
    v_dot2_f32_bf16 v50, v43, v155, v50
    v_dot2_f32_bf16 v51, v43, v187, v51
    v_dot2_f32_bf16 v52, v27, v219, v52
    v_dot2_f32_bf16 v53, v27, v251, v53
    v_dot2_f32_bf16 v54, v43, v219, v54
    v_dot2_f32_bf16 v55, v43, v251, v55
    v_dot2_f32_bf16 v48, v28, v156, v48
    v_dot2_f32_bf16 v49, v28, v188, v49
    v_dot2_f32_bf16 v50, v44, v156, v50
    v_dot2_f32_bf16 v51, v44, v188, v51
    v_dot2_f32_bf16 v52, v28, v220, v52
    v_dot2_f32_bf16 v53, v28, v252, v53
    v_dot2_f32_bf16 v54, v44, v220, v54
    v_dot2_f32_bf16 v55, v44, v252, v55
    v_dot2_f32_bf16 v48, v29, v157, v48
    v_dot2_f32_bf16 v49, v29, v189, v49
    v_dot2_f32_bf16 v50, v45, v157, v50
    v_dot2_f32_bf16 v51, v45, v189, v51
    v_dot2_f32_bf16 v52, v29, v221, v52
    v_dot2_f32_bf16 v53, v29, v253, v53
    v_dot2_f32_bf16 v54, v45, v221, v54
    v_dot2_f32_bf16 v55, v45, v253, v55
    v_dot2_f32_bf16 v48, v30, v158, v48
    v_dot2_f32_bf16 v49, v30, v190, v49
    v_dot2_f32_bf16 v50, v46, v158, v50
    v_dot2_f32_bf16 v51, v46, v190, v51
    v_dot2_f32_bf16 v52, v30, v222, v52
    v_dot2_f32_bf16 v53, v30, v254, v53
    v_dot2_f32_bf16 v54, v46, v222, v54
    v_dot2_f32_bf16 v55, v46, v254, v55
    v_dot2_f32_bf16 v48, v31, v159, v48
    v_dot2_f32_bf16 v49, v31, v191, v49
    v_dot2_f32_bf16 v50, v47, v159, v50
    v_dot2_f32_bf16 v51, v47, v191, v51
    v_dot2_f32_bf16 v52, v31, v223, v52
    v_dot2_f32_bf16 v53, v31, v255, v53
    v_dot2_f32_bf16 v54, v47, v223, v54
    v_dot2_f32_bf16 v55, v47, v255, v55
    s_nop 3
    v_lshlrev_b32 v7, 5, v0
    ds_write_b128 v7, v[48:51] offset:8192
    ds_write_b128 v7, v[52:55] offset:8208
    s_waitcnt lgkmcnt(0)
    s_barrier
    v_lshlrev_b32 v7, 5, v2
    v_bfe_u32 v8, v0, 5, 1
    v_lshl_add_u32 v7, v8, 3, v7
    ds_read_b64 v[16:17], v7 offset:8192
    ds_read_b64 v[18:19], v7 offset:8208
    ds_read_b64 v[20:21], v7 offset:9216
    ds_read_b64 v[22:23], v7 offset:9232
    ds_read_b64 v[24:25], v7 offset:10240
    ds_read_b64 v[26:27], v7 offset:10256
    ds_read_b64 v[28:29], v7 offset:11264
    ds_read_b64 v[30:31], v7 offset:11280
    s_waitcnt lgkmcnt(0)
    ds_read_b64 v[32:33], v7 offset:12288
    ds_read_b64 v[34:35], v7 offset:12304
    ds_read_b64 v[36:37], v7 offset:13312
    ds_read_b64 v[38:39], v7 offset:13328
    ds_read_b64 v[40:41], v7 offset:14336
    ds_read_b64 v[42:43], v7 offset:14352
    ds_read_b64 v[44:45], v7 offset:15360
    ds_read_b64 v[46:47], v7 offset:15376
    s_waitcnt lgkmcnt(0)
    v_add_f32 v16, v16, v20
    v_add_f32 v16, v16, v24
    v_add_f32 v16, v16, v28
    v_add_f32 v16, v16, v32
    v_add_f32 v16, v16, v36
    v_add_f32 v16, v16, v40
    v_add_f32 v16, v16, v44
    v_cvt_pk_bf16_f32 v5, v16, v16
    v_lshlrev_b32 v16, 16, v5
    v_add_f32 v17, v17, v21
    v_add_f32 v17, v17, v25
    v_add_f32 v17, v17, v29
    v_add_f32 v17, v17, v33
    v_add_f32 v17, v17, v37
    v_add_f32 v17, v17, v41
    v_add_f32 v17, v17, v45
    v_cvt_pk_bf16_f32 v5, v17, v17
    v_lshlrev_b32 v17, 16, v5
    v_add_f32 v18, v18, v22
    v_add_f32 v18, v18, v26
    v_add_f32 v18, v18, v30
    v_add_f32 v18, v18, v34
    v_add_f32 v18, v18, v38
    v_add_f32 v18, v18, v42
    v_add_f32 v18, v18, v46
    v_cvt_pk_bf16_f32 v5, v18, v18
    v_lshlrev_b32 v18, 16, v5
    v_add_f32 v19, v19, v23
    v_add_f32 v19, v19, v27
    v_add_f32 v19, v19, v31
    v_add_f32 v19, v19, v35
    v_add_f32 v19, v19, v39
    v_add_f32 v19, v19, v43
    v_add_f32 v19, v19, v47
    v_cvt_pk_bf16_f32 v5, v19, v19
    v_lshlrev_b32 v19, 16, v5
    v_mul_f32 v6, 0xbfb8aa3b, v16
    v_exp_f32 v6, v6
    s_nop 0
    v_add_f32 v6, 1.0, v6
    v_rcp_f32 v6, v6
    s_nop 0
    v_mul_f32 v16, v16, v6
    v_cvt_pk_bf16_f32 v5, v16, v16
    v_lshlrev_b32 v16, 16, v5
    v_mul_f32 v16, v16, v18
    v_mul_f32 v6, 0xbfb8aa3b, v17
    v_exp_f32 v6, v6
    s_nop 0
    v_add_f32 v6, 1.0, v6
    v_rcp_f32 v6, v6
    s_nop 0
    v_mul_f32 v17, v17, v6
    v_cvt_pk_bf16_f32 v5, v17, v17
    v_lshlrev_b32 v17, 16, v5
    v_mul_f32 v17, v17, v19
    v_cvt_pk_bf16_f32 v16, v16, v17
    v_mul_u32_u24 v8, 3584, v8
    v_lshl_add_u32 v7, v2, 2, v8
    v_mov_b32 v6, 0x40000000
    v_cmp_lt_u32 vcc, 27, v2
    s_nop 1
    v_cndmask_b32 v7, v7, v6, vcc
    v_cmp_lt_u32 vcc, 63, v0
    s_nop 1
    v_cndmask_b32 v7, v7, v6, vcc
    s_mul_i32 s37, s24, 8192
    s_add_u32 s37, s37, 0x1b0000
    s_add_u32 s36, s37, s23
    buffer_store_dword v16, v7, s[8:11], s36 offen sc1
    v_lshlrev_b32 v7, 4, v0
    v_add_u32 v8, 4096, v7
    v_cmp_lt_u32 vcc, 191, v0
    s_nop 1
    v_cndmask_b32 v8, v8, v6, vcc
L_M_act:
    buffer_load_dwordx4 v[20:23], v7, s[8:11], s37 offen sc1
    buffer_load_dwordx4 v[24:27], v8, s[8:11], s37 offen sc1
    s_add_u32 s32, s32, 1
    s_cmp_gt_u32 s32, 200000
    s_waitcnt vmcnt(0)
    v_max3_u32 v5, v20, v21, v22
    v_max3_u32 v5, v5, v23, v24
    v_max3_u32 v5, v5, v25, v26
    v_max_u32 v5, v5, v27
    s_cbranch_scc1 L_M_act_ok
    v_cmp_eq_u32 vcc, -1, v5
    s_cbranch_vccnz L_M_act
L_M_act_ok:
    ds_write_b128 v7, v[20:23] offset:16384
    ds_write_b128 v7, v[24:27] offset:20480
    s_waitcnt lgkmcnt(0)
    s_barrier
    v_lshrrev_b32 v7, 3, v0
    v_mul_u32_u24 v7, 112, v7
    v_mov_b64 v[48:49], 0
    v_mov_b64 v[50:51], 0
    ds_read_b128 v[16:19], v7 offset:16384
    ds_read_b128 v[20:23], v7 offset:16400
    ds_read_b128 v[24:27], v7 offset:16416
    ds_read_b128 v[28:31], v7 offset:16432
    ds_read_b128 v[32:35], v7 offset:16448
    ds_read_b128 v[36:39], v7 offset:16464
    ds_read_b128 v[40:43], v7 offset:16480
    s_waitcnt lgkmcnt(0)
    v_dot2_f32_bf16 v48, v16, v64, v48
    v_dot2_f32_bf16 v49, v16, v92, v49
    v_dot2_f32_bf16 v48, v17, v65, v48
    v_dot2_f32_bf16 v49, v17, v93, v49
    v_dot2_f32_bf16 v48, v18, v66, v48
    v_dot2_f32_bf16 v49, v18, v94, v49
    v_dot2_f32_bf16 v48, v19, v67, v48
    v_dot2_f32_bf16 v49, v19, v95, v49
    v_dot2_f32_bf16 v48, v20, v68, v48
    v_dot2_f32_bf16 v49, v20, v96, v49
    v_dot2_f32_bf16 v48, v21, v69, v48
    v_dot2_f32_bf16 v49, v21, v97, v49
    v_dot2_f32_bf16 v48, v22, v70, v48
    v_dot2_f32_bf16 v49, v22, v98, v49
    v_dot2_f32_bf16 v48, v23, v71, v48
    v_dot2_f32_bf16 v49, v23, v99, v49
    v_dot2_f32_bf16 v48, v24, v72, v48
    v_dot2_f32_bf16 v49, v24, v100, v49
    v_dot2_f32_bf16 v48, v25, v73, v48
    v_dot2_f32_bf16 v49, v25, v101, v49
    v_dot2_f32_bf16 v48, v26, v74, v48
    v_dot2_f32_bf16 v49, v26, v102, v49
    v_dot2_f32_bf16 v48, v27, v75, v48
    v_dot2_f32_bf16 v49, v27, v103, v49
    v_dot2_f32_bf16 v48, v28, v76, v48
    v_dot2_f32_bf16 v49, v28, v104, v49
    v_dot2_f32_bf16 v48, v29, v77, v48
    v_dot2_f32_bf16 v49, v29, v105, v49
    v_dot2_f32_bf16 v48, v30, v78, v48
    v_dot2_f32_bf16 v49, v30, v106, v49
    v_dot2_f32_bf16 v48, v31, v79, v48
    v_dot2_f32_bf16 v49, v31, v107, v49
    v_dot2_f32_bf16 v48, v32, v80, v48
    v_dot2_f32_bf16 v49, v32, v108, v49
    v_dot2_f32_bf16 v48, v33, v81, v48
    v_dot2_f32_bf16 v49, v33, v109, v49
    v_dot2_f32_bf16 v48, v34, v82, v48
    v_dot2_f32_bf16 v49, v34, v110, v49
    v_dot2_f32_bf16 v48, v35, v83, v48
    v_dot2_f32_bf16 v49, v35, v111, v49
    v_dot2_f32_bf16 v48, v36, v84, v48
    v_dot2_f32_bf16 v49, v36, v112, v49
    v_dot2_f32_bf16 v48, v37, v85, v48
    v_dot2_f32_bf16 v49, v37, v113, v49
    v_dot2_f32_bf16 v48, v38, v86, v48
    v_dot2_f32_bf16 v49, v38, v114, v49
    v_dot2_f32_bf16 v48, v39, v87, v48
    v_dot2_f32_bf16 v49, v39, v115, v49
    v_dot2_f32_bf16 v48, v40, v88, v48
    v_dot2_f32_bf16 v49, v40, v116, v49
    v_dot2_f32_bf16 v48, v41, v89, v48
    v_dot2_f32_bf16 v49, v41, v117, v49
    v_dot2_f32_bf16 v48, v42, v90, v48
    v_dot2_f32_bf16 v49, v42, v118, v49
    v_dot2_f32_bf16 v48, v43, v91, v48
    v_dot2_f32_bf16 v49, v43, v119, v49
    ds_read_b128 v[16:19], v7 offset:19968
    ds_read_b128 v[20:23], v7 offset:19984
    ds_read_b128 v[24:27], v7 offset:20000
    ds_read_b128 v[28:31], v7 offset:20016
    ds_read_b128 v[32:35], v7 offset:20032
    ds_read_b128 v[36:39], v7 offset:20048
    ds_read_b128 v[40:43], v7 offset:20064
    s_waitcnt lgkmcnt(0)
    v_dot2_f32_bf16 v50, v16, v64, v50
    v_dot2_f32_bf16 v51, v16, v92, v51
    v_dot2_f32_bf16 v50, v17, v65, v50
    v_dot2_f32_bf16 v51, v17, v93, v51
    v_dot2_f32_bf16 v50, v18, v66, v50
    v_dot2_f32_bf16 v51, v18, v94, v51
    v_dot2_f32_bf16 v50, v19, v67, v50
    v_dot2_f32_bf16 v51, v19, v95, v51
    v_dot2_f32_bf16 v50, v20, v68, v50
    v_dot2_f32_bf16 v51, v20, v96, v51
    v_dot2_f32_bf16 v50, v21, v69, v50
    v_dot2_f32_bf16 v51, v21, v97, v51
    v_dot2_f32_bf16 v50, v22, v70, v50
    v_dot2_f32_bf16 v51, v22, v98, v51
    v_dot2_f32_bf16 v50, v23, v71, v50
    v_dot2_f32_bf16 v51, v23, v99, v51
    v_dot2_f32_bf16 v50, v24, v72, v50
    v_dot2_f32_bf16 v51, v24, v100, v51
    v_dot2_f32_bf16 v50, v25, v73, v50
    v_dot2_f32_bf16 v51, v25, v101, v51
    v_dot2_f32_bf16 v50, v26, v74, v50
    v_dot2_f32_bf16 v51, v26, v102, v51
    v_dot2_f32_bf16 v50, v27, v75, v50
    v_dot2_f32_bf16 v51, v27, v103, v51
    v_dot2_f32_bf16 v50, v28, v76, v50
    v_dot2_f32_bf16 v51, v28, v104, v51
    v_dot2_f32_bf16 v50, v29, v77, v50
    v_dot2_f32_bf16 v51, v29, v105, v51
    v_dot2_f32_bf16 v50, v30, v78, v50
    v_dot2_f32_bf16 v51, v30, v106, v51
    v_dot2_f32_bf16 v50, v31, v79, v50
    v_dot2_f32_bf16 v51, v31, v107, v51
    v_dot2_f32_bf16 v50, v32, v80, v50
    v_dot2_f32_bf16 v51, v32, v108, v51
    v_dot2_f32_bf16 v50, v33, v81, v50
    v_dot2_f32_bf16 v51, v33, v109, v51
    v_dot2_f32_bf16 v50, v34, v82, v50
    v_dot2_f32_bf16 v51, v34, v110, v51
    v_dot2_f32_bf16 v50, v35, v83, v50
    v_dot2_f32_bf16 v51, v35, v111, v51
    v_dot2_f32_bf16 v50, v36, v84, v50
    v_dot2_f32_bf16 v51, v36, v112, v51
    v_dot2_f32_bf16 v50, v37, v85, v50
    v_dot2_f32_bf16 v51, v37, v113, v51
    v_dot2_f32_bf16 v50, v38, v86, v50
    v_dot2_f32_bf16 v51, v38, v114, v51
    v_dot2_f32_bf16 v50, v39, v87, v50
    v_dot2_f32_bf16 v51, v39, v115, v51
    v_dot2_f32_bf16 v50, v40, v88, v50
    v_dot2_f32_bf16 v51, v40, v116, v51
    v_dot2_f32_bf16 v50, v41, v89, v50
    v_dot2_f32_bf16 v51, v41, v117, v51
    v_dot2_f32_bf16 v50, v42, v90, v50
    v_dot2_f32_bf16 v51, v42, v118, v51
    v_dot2_f32_bf16 v50, v43, v91, v50
    v_dot2_f32_bf16 v51, v43, v119, v51
    s_nop 3
    v_add_f32_dpp v48, v48, v48 row_ror:8 row_mask:0xf bank_mask:0xf
    v_add_f32_dpp v49, v49, v49 row_ror:8 row_mask:0xf bank_mask:0xf
    v_add_f32_dpp v50, v50, v50 row_ror:8 row_mask:0xf bank_mask:0xf
    v_add_f32_dpp v51, v51, v51 row_ror:8 row_mask:0xf bank_mask:0xf
    v_mov_b32 v5, v48
    s_nop 1
    v_permlane16_swap_b32 v48, v5
    v_add_f32 v48, v48, v5
    v_mov_b32 v5, v49
    s_nop 1
    v_permlane16_swap_b32 v49, v5
    v_add_f32 v49, v49, v5
    v_mov_b32 v5, v50
    s_nop 1
    v_permlane16_swap_b32 v50, v5
    v_add_f32 v50, v50, v5
    v_mov_b32 v5, v51
    s_nop 1
    v_permlane16_swap_b32 v51, v5
    v_add_f32 v51, v51, v5
    v_mov_b32 v5, v48
    s_nop 1
    v_permlane32_swap_b32 v48, v5
    v_add_f32 v48, v48, v5
    v_mov_b32 v5, v49
    s_nop 1
    v_permlane32_swap_b32 v49, v5
    v_add_f32 v49, v49, v5
    v_mov_b32 v5, v50
    s_nop 1
    v_permlane32_swap_b32 v50, v5
    v_add_f32 v50, v50, v5
    v_mov_b32 v5, v51
    s_nop 1
    v_permlane32_swap_b32 v51, v5
    v_add_f32 v51, v51, v5
    v_lshrrev_b32 v7, 6, v0
    v_lshlrev_b32 v7, 7, v7
    v_lshl_add_u32 v7, v3, 4, v7
    ds_write_b128 v7, v[48:51] offset:1024
    s_waitcnt lgkmcnt(0)
    s_barrier
    v_lshlrev_b32 v7, 4, v3
    v_lshl_add_u32 v7, v9, 3, v7
    ds_read_b64 v[16:17], v7 offset:1024
    ds_read_b64 v[18:19], v7 offset:1152
    ds_read_b64 v[20:21], v7 offset:1280
    ds_read_b64 v[22:23], v7 offset:1408
    v_mul_f32 v10, 0xbfb8aa3b, v11
    v_exp_f32 v10, v10
    s_nop 0
    v_add_f32 v10, 1.0, v10
    v_rcp_f32 v10, v10
    s_nop 0
    v_cvt_pk_bf16_f32 v5, v10, v10
    v_lshlrev_b32 v10, 16, v5
    s_waitcnt lgkmcnt(0)
    v_lshlrev_b32 v24, 16, v15
    v_and_b32 v25, 0xffff0000, v15
    v_lshlrev_b32 v26, 16, v14
    v_and_b32 v27, 0xffff0000, v14
    v_add_f32 v16, v16, v18
    v_add_f32 v20, v20, v22
    v_add_f32 v16, v16, v20
    v_cvt_pk_bf16_f32 v5, v16, v16
    v_lshlrev_b32 v16, 16, v5
    v_mul_f32 v16, v16, v10
    v_cvt_pk_bf16_f32 v5, v16, v16
    v_lshlrev_b32 v16, 16, v5
    v_add_f32 v16, v16, v24
    v_cvt_pk_bf16_f32 v5, v16, v16
    v_lshlrev_b32 v16, 16, v5
    v_add_f32 v16, v16, v26
    v_add_f32 v17, v17, v19
    v_add_f32 v21, v21, v23
    v_add_f32 v17, v17, v21
    v_cvt_pk_bf16_f32 v5, v17, v17
    v_lshlrev_b32 v17, 16, v5
    v_mul_f32 v17, v17, v10
    v_cvt_pk_bf16_f32 v5, v17, v17
    v_lshlrev_b32 v17, 16, v5
    v_add_f32 v17, v17, v25
    v_cvt_pk_bf16_f32 v5, v17, v17
    v_lshlrev_b32 v17, 16, v5
    v_add_f32 v17, v17, v27
    v_cvt_pk_bf16_f32 v13, v16, v17
L_M_next:
    s_add_u32 s24, s24, 1
    s_mov_b32 s25, 192
    s_cmp_eq_u32 s24, 1
    s_cbranch_scc1 L_M_round
    s_mov_b32 s25, 256
    s_cmp_eq_u32 s24, 2
    s_cbranch_scc1 L_M_round
    buffer_store_dword v13, v12, s[60:63], 0 offen sc1
L_end:
    s_endpgm
.section .rodata,"a"
.p2align 6
.amdhsa_kernel sequential_preLN__memory_aug_recurrent_mem_tr__moe_arch_mod__prompt_kernel
  .amdhsa_next_free_vgpr 512
  .amdhsa_next_free_sgpr 102
  .amdhsa_accum_offset 256
  .amdhsa_group_segment_fixed_size 0
  .amdhsa_kernarg_size 120
  .amdhsa_user_sgpr_count 2
  .amdhsa_user_sgpr_kernarg_segment_ptr 1
  .amdhsa_system_sgpr_workgroup_id_x 1
.end_amdhsa_kernel
```

```asm
; @launch grid=(256,1,1) block=(256,1,1) lds=163840
.amdgcn_target "amdgcn-amd-amdhsa--gfx950"
.text
.globl sequential_preLN__memory_aug_recurrent_mem_tr__moe_arch_mod__prompt_kernel
.p2align 8
.type sequential_preLN__memory_aug_recurrent_mem_tr__moe_arch_mod__prompt_kernel,@function
sequential_preLN__memory_aug_recurrent_mem_tr__moe_arch_mod__prompt_kernel:
    s_cmp_ge_u32 s2, 256
    s_cbranch_scc1 L_end
    s_load_dwordx8 s[44:51], s[0:1], 0
    s_load_dwordx4 s[52:55], s[0:1], 32
    s_load_dwordx4 s[56:59], s[0:1], 104
    s_load_dwordx2 s[80:81], s[0:1], 64
    s_load_dwordx2 s[82:83], s[0:1], 96
    s_load_dwordx4 s[84:87], s[0:1], 72
    s_load_dwordx2 s[88:89], s[0:1], 88
    v_lshrrev_b32 v1, 6, v0
    s_nop 0
    v_readfirstlane_b32 s21, v1
    s_waitcnt lgkmcnt(0)
    s_mov_b32 s8, s58
    s_and_b32 s9, s59, 0xffff
    s_mov_b32 s10, 0x10000000
    s_mov_b32 s11, 0x20000
    s_mov_b32 s16, s56
    s_and_b32 s17, s57, 0xffff
    s_mov_b32 s18, 0x100
    s_mov_b32 s19, 0x20000
    s_and_b32 s3, s2, 7
    s_cmp_lg_u32 s3, 0
    s_cbranch_scc1 L_worker
    s_lshr_b32 s20, s2, 3
    v_lshrrev_b32 v28, 6, v0
    v_bfe_u32 v29, v0, 4, 2
    v_lshl_add_u32 v28, v28, 5, v29
    v_and_b32 v16, 15, v0
    v_lshlrev_b32 v16, 4, v16
    v_lshl_add_u32 v16, v28, 13, v16
    v_bfe_u32 v29, v0, 4, 1
    v_lshlrev_b32 v29, 5, v29
    v_xor_b32 v16, v16, v29
    v_xor_b32 v17, 64, v16
    v_xor_b32 v18, 128, v16
    v_xor_b32 v19, 192, v16
    s_add_u32 s28, s21, 1
    s_lshl_b32 s28, s28, 15
    s_lshl_b32 s3, s20, 8
    s_mov_b32 s60, s52
    s_and_b32 s61, s53, 0xffff
    s_mov_b32 s62, 0x400000
    s_mov_b32 s63, 0x20000
    s_add_u32 m0, s28, 0
    s_add_u32 s37, s3, 0x0
    buffer_load_dwordx4 v16, s[60:63], s37 offen nt lds
    s_add_u32 m0, s28, 1024
    s_add_u32 s37, s3, 0x8000
    buffer_load_dwordx4 v17, s[60:63], s37 offen nt lds
    s_add_u32 m0, s28, 2048
    s_add_u32 s37, s3, 0x10000
    buffer_load_dwordx4 v18, s[60:63], s37 offen nt lds
    s_add_u32 m0, s28, 3072
    s_add_u32 s37, s3, 0x18000
    buffer_load_dwordx4 v19, s[60:63], s37 offen nt lds
    s_add_u32 m0, s28, 4096
    s_add_u32 s37, s3, 0x20000
    buffer_load_dwordx4 v16, s[60:63], s37 offen nt lds
    s_add_u32 m0, s28, 5120
    s_add_u32 s37, s3, 0x28000
    buffer_load_dwordx4 v17, s[60:63], s37 offen nt lds
    s_add_u32 m0, s28, 6144
    s_add_u32 s37, s3, 0x30000
    buffer_load_dwordx4 v18, s[60:63], s37 offen nt lds
    s_add_u32 m0, s28, 7168
    s_add_u32 s37, s3, 0x38000
    buffer_load_dwordx4 v19, s[60:63], s37 offen nt lds
    s_add_u32 m0, s28, 8192
    s_add_u32 s37, s3, 0x100000
    buffer_load_dwordx4 v16, s[60:63], s37 offen nt lds
    s_add_u32 m0, s28, 9216
    s_add_u32 s37, s3, 0x108000
    buffer_load_dwordx4 v17, s[60:63], s37 offen nt lds
    s_add_u32 m0, s28, 10240
    s_add_u32 s37, s3, 0x110000
    buffer_load_dwordx4 v18, s[60:63], s37 offen nt lds
    s_add_u32 m0, s28, 11264
    s_add_u32 s37, s3, 0x118000
    buffer_load_dwordx4 v19, s[60:63], s37 offen nt lds
    s_add_u32 m0, s28, 12288
    s_add_u32 s37, s3, 0x120000
    buffer_load_dwordx4 v16, s[60:63], s37 offen nt lds
    s_add_u32 m0, s28, 13312
    s_add_u32 s37, s3, 0x128000
    buffer_load_dwordx4 v17, s[60:63], s37 offen nt lds
    s_add_u32 m0, s28, 14336
    s_add_u32 s37, s3, 0x130000
    buffer_load_dwordx4 v18, s[60:63], s37 offen nt lds
    s_add_u32 m0, s28, 15360
    s_add_u32 s37, s3, 0x138000
    buffer_load_dwordx4 v19, s[60:63], s37 offen nt lds
    s_add_u32 m0, s28, 16384
    s_add_u32 s37, s3, 0x200000
    buffer_load_dwordx4 v16, s[60:63], s37 offen nt lds
    s_add_u32 m0, s28, 17408
    s_add_u32 s37, s3, 0x208000
    buffer_load_dwordx4 v17, s[60:63], s37 offen nt lds
    s_add_u32 m0, s28, 18432
    s_add_u32 s37, s3, 0x210000
    buffer_load_dwordx4 v18, s[60:63], s37 offen nt lds
    s_add_u32 m0, s28, 19456
    s_add_u32 s37, s3, 0x218000
    buffer_load_dwordx4 v19, s[60:63], s37 offen nt lds
    s_add_u32 m0, s28, 20480
    s_add_u32 s37, s3, 0x220000
    buffer_load_dwordx4 v16, s[60:63], s37 offen nt lds
    s_add_u32 m0, s28, 21504
    s_add_u32 s37, s3, 0x228000
    buffer_load_dwordx4 v17, s[60:63], s37 offen nt lds
    s_add_u32 m0, s28, 22528
    s_add_u32 s37, s3, 0x230000
    buffer_load_dwordx4 v18, s[60:63], s37 offen nt lds
    s_add_u32 m0, s28, 23552
    s_add_u32 s37, s3, 0x238000
    buffer_load_dwordx4 v19, s[60:63], s37 offen nt lds
    v_mov_b32 v20, 0x0
    v_bfe_u32 v14, v0, 0, 1
    s_mov_b32 s38, 0x8
    v_mad_u32_u24 v20, v14, s38, v20
    v_bfe_u32 v14, v0, 1, 1
    s_mov_b32 s38, 0x10
    v_mad_u32_u24 v20, v14, s38, v20
    v_bfe_u32 v14, v0, 2, 1
    s_mov_b32 s38, 0x100
    v_mad_u32_u24 v20, v14, s38, v20
    v_bfe_u32 v14, v0, 3, 1
    s_mov_b32 s38, 0x800
    v_mad_u32_u24 v20, v14, s38, v20
    v_bfe_u32 v14, v0, 4, 1
    s_mov_b32 s38, 0x400
    v_mad_u32_u24 v20, v14, s38, v20
    v_bfe_u32 v14, v0, 5, 1
    s_mov_b32 s38, 0x1000
    v_mad_u32_u24 v20, v14, s38, v20
    v_mov_b32 v28, 0x0
    v_bfe_u32 v14, v0, 2, 1
    s_mov_b32 s38, 0x20
    v_mad_u32_u24 v28, v14, s38, v28
    v_bfe_u32 v14, v0, 3, 1
    s_mov_b32 s38, 0x80
    v_mad_u32_u24 v28, v14, s38, v28
    v_bfe_u32 v14, v0, 4, 1
    s_mov_b32 s38, 0x40
    v_mad_u32_u24 v28, v14, s38, v28
    v_mov_b32 v29, 0x0
    v_bfe_u32 v14, v0, 6, 1
    s_mov_b32 s38, 0x40
    v_mad_u32_u24 v29, v14, s38, v29
    v_bfe_u32 v14, v0, 7, 1
    s_mov_b32 s38, 0x80
    v_mad_u32_u24 v29, v14, s38, v29
    v_xor_b32 v28, v28, v29
    v_add_u32 v28, v28, v20
    s_xor_b32 s36, s21, 0
    s_add_u32 s36, s36, 1
    s_lshl_b32 s36, s36, 15
    v_add_u32 v20, s36, v28
    v_xor_b32 v21, 32, v20
    s_xor_b32 s36, s21, 1
    s_add_u32 s36, s36, 1
    s_lshl_b32 s36, s36, 15
    v_add_u32 v22, s36, v28
    v_xor_b32 v23, 32, v22
    s_xor_b32 s36, s21, 2
    s_add_u32 s36, s36, 1
    s_lshl_b32 s36, s36, 15
    v_add_u32 v24, s36, v28
    v_xor_b32 v25, 32, v24
    s_xor_b32 s36, s21, 3
    s_add_u32 s36, s36, 1
    s_lshl_b32 s36, s36, 15
    v_add_u32 v26, s36, v28
    v_xor_b32 v27, 32, v26
    v_mov_b32 v11, 0x0
    v_bfe_u32 v14, v0, 0, 1
    s_mov_b32 s38, 0x4
    v_mad_u32_u24 v11, v14, s38, v11
    v_bfe_u32 v14, v0, 1, 1
    s_mov_b32 s38, 0x8
    v_mad_u32_u24 v11, v14, s38, v11
    v_bfe_u32 v14, v0, 2, 1
    s_mov_b32 s38, 0x10
    v_mad_u32_u24 v11, v14, s38, v11
    v_bfe_u32 v14, v0, 3, 1
    s_mov_b32 s38, 0x20
    v_mad_u32_u24 v11, v14, s38, v11
    v_bfe_u32 v14, v0, 4, 1
    s_mov_b32 s38, 0x800
    v_mad_u32_u24 v11, v14, s38, v11
    v_bfe_u32 v14, v0, 5, 1
    s_mov_b32 s38, 0x1000
    v_mad_u32_u24 v11, v14, s38, v11
    v_bfe_u32 v14, v0, 6, 1
    s_mov_b32 s38, 0x100
    v_mad_u32_u24 v11, v14, s38, v11
    v_bfe_u32 v14, v0, 7, 1
    s_mov_b32 s38, 0x200
    v_mad_u32_u24 v11, v14, s38, v11
    s_mov_b32 s92, s54
    s_and_b32 s93, s55, 0xffff
    s_mov_b32 s94, 0x400000
    s_mov_b32 s95, 0x20000
    s_lshl_b32 s29, s20, 17
    s_xor_b32 s36, s21, 3
    s_lshl_b32 s36, s36, 15
    s_add_u32 s36, s36, s29
    s_add_u32 s37, s36, 0x80
    buffer_load_dword v32, v11, s[92:95], s37 offen
    s_add_u32 s37, s36, 0x4080
    buffer_load_dword v33, v11, s[92:95], s37 offen
    s_add_u32 s37, s36, 0x480
    buffer_load_dword v34, v11, s[92:95], s37 offen
    s_add_u32 s37, s36, 0x4480
    buffer_load_dword v35, v11, s[92:95], s37 offen
    s_add_u32 s37, s36, 0x2080
    buffer_load_dword v36, v11, s[92:95], s37 offen
    s_add_u32 s37, s36, 0x6080
    buffer_load_dword v37, v11, s[92:95], s37 offen
    s_add_u32 s37, s36, 0x2480
    buffer_load_dword v38, v11, s[92:95], s37 offen
    s_add_u32 s37, s36, 0x6480
    buffer_load_dword v39, v11, s[92:95], s37 offen
    s_add_u32 s37, s36, 0xc0
    buffer_load_dword v40, v11, s[92:95], s37 offen
    s_add_u32 s37, s36, 0x40c0
    buffer_load_dword v41, v11, s[92:95], s37 offen
    s_add_u32 s37, s36, 0x4c0
    buffer_load_dword v42, v11, s[92:95], s37 offen
    s_add_u32 s37, s36, 0x44c0
    buffer_load_dword v43, v11, s[92:95], s37 offen
    s_add_u32 s37, s36, 0x20c0
    buffer_load_dword v44, v11, s[92:95], s37 offen
    s_add_u32 s37, s36, 0x60c0
    buffer_load_dword v45, v11, s[92:95], s37 offen
    s_add_u32 s37, s36, 0x24c0
    buffer_load_dword v46, v11, s[92:95], s37 offen
    s_add_u32 s37, s36, 0x64c0
    buffer_load_dword v47, v11, s[92:95], s37 offen
    s_getreg_b32 s36, hwreg(HW_REG_XCC_ID)
    s_and_b32 s36, s36, 15
    s_or_b32 s36, s36, 0x100
    v_mov_b32 v30, s36
    s_lshl_b32 s37, s20, 2
    v_lshlrev_b32 v31, 20, v0
    buffer_store_dword v30, v31, s[16:19], s37 offen offset:128 sc1
    s_mov_b32 s12, s46
    s_and_b32 s13, s47, 0xffff
    s_mov_b32 s14, 0x2000
    s_mov_b32 s15, 0x20000
    v_mov_b32 v104, 0x0
    v_bfe_u32 v14, v0, 0, 1
    s_mov_b32 s38, 0x8
    v_mad_u32_u24 v104, v14, s38, v104
    v_bfe_u32 v14, v0, 1, 1
    s_mov_b32 s38, 0x10
    v_mad_u32_u24 v104, v14, s38, v104
    v_bfe_u32 v14, v0, 2, 1
    s_mov_b32 s38, 0x10000
    v_mad_u32_u24 v104, v14, s38, v104
    v_bfe_u32 v14, v0, 3, 1
    s_mov_b32 s38, 0x10000
    v_mad_u32_u24 v104, v14, s38, v104
    v_bfe_u32 v14, v0, 4, 1
    s_mov_b32 s38, 0x400
    v_mad_u32_u24 v104, v14, s38, v104
    v_bfe_u32 v14, v0, 5, 1
    s_mov_b32 s38, 0x4
    v_mad_u32_u24 v104, v14, s38, v104
    v_bfe_u32 v14, v0, 6, 1
    s_mov_b32 s38, 0x40
    v_mad_u32_u24 v104, v14, s38, v104
    v_bfe_u32 v14, v0, 7, 1
    s_mov_b32 s38, 0x80
    v_mad_u32_u24 v104, v14, s38, v104
    v_mov_b32 v106, s20
    v_mov_b32 v105, 0x0
    v_bfe_u32 v14, v106, 0, 1
    s_mov_b32 s38, 0x20
    v_mad_u32_u24 v105, v14, s38, v105
    v_bfe_u32 v14, v106, 1, 1
    s_mov_b32 s38, 0x800
    v_mad_u32_u24 v105, v14, s38, v105
    v_bfe_u32 v14, v106, 2, 1
    s_mov_b32 s38, 0x1000
    v_mad_u32_u24 v105, v14, s38, v105
    v_bfe_u32 v14, v106, 3, 1
    s_mov_b32 s38, 0x100
    v_mad_u32_u24 v105, v14, s38, v105
    v_bfe_u32 v14, v106, 4, 1
    s_mov_b32 s38, 0x200
    v_mad_u32_u24 v105, v14, s38, v105
    v_add_u32 v104, v104, v105
    buffer_load_dword v12, v104, s[12:15], 0 offen
    v_mov_b32 v1, 0x4444
    v_bfe_u32 v14, v0, 1, 1
    s_mov_b32 s38, 0xaaaa
    v_mad_u32_u24 v1, v14, s38, v1
    v_mov_b32 v3, 0x0
    v_bfe_u32 v14, v0, 0, 1
    s_mov_b32 s38, 0x10
    v_mad_u32_u24 v3, v14, s38, v3
    v_bfe_u32 v14, v0, 1, 1
    s_mov_b32 s38, 0x20
    v_mad_u32_u24 v3, v14, s38, v3
    v_bfe_u32 v14, v0, 2, 1
    s_mov_b32 s38, 0x40
    v_mad_u32_u24 v3, v14, s38, v3
    v_bfe_u32 v14, v0, 3, 1
    s_mov_b32 s38, 0x80
    v_mad_u32_u24 v3, v14, s38, v3
    v_bfe_u32 v14, v0, 4, 1
    s_mov_b32 s38, 0x100
    v_mad_u32_u24 v3, v14, s38, v3
    v_bfe_u32 v14, v0, 5, 1
    s_mov_b32 s38, 0x200
    v_mad_u32_u24 v3, v14, s38, v3
    v_mov_b32 v2, 0x0
    v_bfe_u32 v14, v0, 0, 1
    s_mov_b32 s38, 0x10
    v_mad_u32_u24 v2, v14, s38, v2
    v_bfe_u32 v14, v0, 1, 1
    s_mov_b32 s38, 0x20
    v_mad_u32_u24 v2, v14, s38, v2
    v_bfe_u32 v14, v0, 2, 1
    s_mov_b32 s38, 0x40
    v_mad_u32_u24 v2, v14, s38, v2
    v_bfe_u32 v14, v0, 3, 1
    s_mov_b32 s38, 0x80
    v_mad_u32_u24 v2, v14, s38, v2
    v_bfe_u32 v14, v0, 4, 1
    s_mov_b32 s38, 0x100
    v_mad_u32_u24 v2, v14, s38, v2
    v_bfe_u32 v14, v0, 5, 1
    s_mov_b32 s38, 0x200
    v_mad_u32_u24 v2, v14, s38, v2
    v_bfe_u32 v14, v0, 6, 1
    s_mov_b32 s38, 0x800
    v_mad_u32_u24 v2, v14, s38, v2
    v_bfe_u32 v14, v0, 7, 1
    s_mov_b32 s38, 0x1000
    v_mad_u32_u24 v2, v14, s38, v2
    v_mov_b32 v4, 0x8000
    v_bfe_u32 v14, v0, 0, 1
    s_mov_b32 s38, 0x10
    v_mad_u32_u24 v4, v14, s38, v4
    v_bfe_u32 v14, v0, 1, 1
    s_mov_b32 s38, 0x20
    v_mad_u32_u24 v4, v14, s38, v4
    v_bfe_u32 v14, v0, 2, 1
    s_mov_b32 s38, 0x40
    v_mad_u32_u24 v4, v14, s38, v4
    v_bfe_u32 v14, v0, 3, 1
    s_mov_b32 s38, 0x80
    v_mad_u32_u24 v4, v14, s38, v4
    v_bfe_u32 v14, v0, 4, 1
    s_mov_b32 s38, 0x100
    v_mad_u32_u24 v4, v14, s38, v4
    v_bfe_u32 v14, v0, 5, 1
    s_mov_b32 s38, 0x200
    v_mad_u32_u24 v4, v14, s38, v4
    v_bfe_u32 v14, v0, 6, 1
    s_mov_b32 s38, 0x8000
    v_mad_u32_u24 v4, v14, s38, v4
    v_bfe_u32 v14, v0, 7, 1
    s_mov_b32 s38, 0x10000
    v_mad_u32_u24 v4, v14, s38, v4
    v_mov_b32 v5, 0x4000
    v_bfe_u32 v14, v0, 0, 1
    s_mov_b32 s38, 0x4
    v_mad_u32_u24 v5, v14, s38, v5
    v_bfe_u32 v14, v0, 1, 1
    s_mov_b32 s38, 0x8
    v_mad_u32_u24 v5, v14, s38, v5
    v_bfe_u32 v14, v0, 2, 1
    s_mov_b32 s38, 0x10
    v_mad_u32_u24 v5, v14, s38, v5
    v_bfe_u32 v14, v0, 3, 1
    s_mov_b32 s38, 0x20
    v_mad_u32_u24 v5, v14, s38, v5
    v_bfe_u32 v14, v0, 4, 1
    s_mov_b32 s38, 0x240
    v_mad_u32_u24 v5, v14, s38, v5
    v_bfe_u32 v14, v0, 5, 1
    s_mov_b32 s38, 0x480
    v_mad_u32_u24 v5, v14, s38, v5
    v_bfe_u32 v14, v0, 6, 1
    s_mov_b32 s38, 0x40
    v_mad_u32_u24 v5, v14, s38, v5
    v_bfe_u32 v14, v0, 7, 1
    s_mov_b32 s38, 0x80
    v_mad_u32_u24 v5, v14, s38, v5
    v_mov_b32 v6, 0x4000
    v_bfe_u32 v14, v0, 0, 1
    s_mov_b32 s38, 0x120
    v_mad_u32_u24 v6, v14, s38, v6
    v_bfe_u32 v14, v0, 2, 1
    s_mov_b32 s38, 0x240
    v_mad_u32_u24 v6, v14, s38, v6
    v_bfe_u32 v14, v0, 3, 1
    s_mov_b32 s38, 0x480
    v_mad_u32_u24 v6, v14, s38, v6
    v_bfe_u32 v14, v0, 4, 1
    s_mov_b32 s38, 0x10
    v_mad_u32_u24 v6, v14, s38, v6
    v_bfe_u32 v14, v0, 5, 1
    s_mov_b32 s38, 0x20
    v_mad_u32_u24 v6, v14, s38, v6
    v_add_u32 v7, 2304, v5
    v_xor_b32 v8, 0x1000, v2
    v_mov_b32 v104, 0x0
    v_bfe_u32 v14, v0, 3, 1
    s_mov_b32 s38, 0x1
    v_mad_u32_u24 v104, v14, s38, v104
    v_bfe_u32 v14, v0, 4, 1
    s_mov_b32 s38, 0x2
    v_mad_u32_u24 v104, v14, s38, v104
    v_bfe_u32 v14, v0, 5, 1
    s_mov_b32 s38, 0x4
    v_mad_u32_u24 v104, v14, s38, v104
    v_bfe_u32 v14, v0, 6, 1
    s_mov_b32 s38, 0x8
    v_mad_u32_u24 v104, v14, s38, v104
    v_bfe_u32 v14, v0, 7, 1
    s_mov_b32 s38, 0x10
    v_mad_u32_u24 v104, v14, s38, v104
    v_add_u32 v104, s20, v104
    v_and_b32 v104, 31, v104
    v_lshlrev_b32 v104, 6, v104
    v_mov_b32 v9, 0x0
    v_bfe_u32 v14, v0, 0, 1
    s_mov_b32 s38, 0x8
    v_mad_u32_u24 v9, v14, s38, v9
    v_bfe_u32 v14, v0, 1, 1
    s_mov_b32 s38, 0x10
    v_mad_u32_u24 v9, v14, s38, v9
    v_bfe_u32 v14, v0, 2, 1
    s_mov_b32 s38, 0x20
    v_mad_u32_u24 v9, v14, s38, v9
    v_bfe_u32 v14, v0, 3, 1
    s_mov_b32 s38, 0x2000
    v_mad_u32_u24 v9, v14, s38, v9
    v_bfe_u32 v14, v0, 4, 1
    s_mov_b32 s38, 0x4000
    v_mad_u32_u24 v9, v14, s38, v9
    v_bfe_u32 v14, v0, 5, 1
    s_mov_b32 s38, 0x8000
    v_mad_u32_u24 v9, v14, s38, v9
    v_bfe_u32 v14, v0, 6, 1
    s_mov_b32 s38, 0x10000
    v_mad_u32_u24 v9, v14, s38, v9
    v_bfe_u32 v14, v0, 7, 1
    s_mov_b32 s38, 0x20000
    v_mad_u32_u24 v9, v14, s38, v9
    v_add_u32 v9, v9, v104
    v_mov_b32 v10, 0x80000
    v_bfe_u32 v14, v0, 0, 1
    s_mov_b32 s38, 0x8
    v_mad_u32_u24 v10, v14, s38, v10
    v_bfe_u32 v14, v0, 1, 1
    s_mov_b32 s38, 0x20
    v_mad_u32_u24 v10, v14, s38, v10
    v_bfe_u32 v14, v0, 4, 1
    s_mov_b32 s38, 0x10
    v_mad_u32_u24 v10, v14, s38, v10
    v_bfe_u32 v14, v0, 5, 1
    s_mov_b32 s38, 0x4
    v_mad_u32_u24 v10, v14, s38, v10
    v_bfe_u32 v14, v0, 6, 1
    s_mov_b32 s38, 0x800
    v_mad_u32_u24 v10, v14, s38, v10
    v_bfe_u32 v14, v0, 7, 1
    s_mov_b32 s38, 0x1000
    v_mad_u32_u24 v10, v14, s38, v10
    v_mov_b32 v105, s20
    v_mov_b32 v104, 0x0
    v_bfe_u32 v14, v105, 0, 1
    s_mov_b32 s38, 0x100
    v_mad_u32_u24 v104, v14, s38, v104
    v_bfe_u32 v14, v105, 1, 1
    s_mov_b32 s38, 0x40
    v_mad_u32_u24 v104, v14, s38, v104
    v_bfe_u32 v14, v105, 2, 1
    s_mov_b32 s38, 0x80
    v_mad_u32_u24 v104, v14, s38, v104
    v_bfe_u32 v14, v105, 3, 1
    s_mov_b32 s38, 0x200
    v_mad_u32_u24 v104, v14, s38, v104
    v_bfe_u32 v14, v105, 4, 1
    s_mov_b32 s38, 0x400
    v_mad_u32_u24 v104, v14, s38, v104
    v_add_u32 v10, v104, v10
    v_and_b32 v104, 12, v0
    v_cmp_ne_u32 vcc, 0, v104
    v_mov_b32 v104, 0x40000000
    s_nop 0
    v_cndmask_b32 v10, v10, v104, vcc
    s_lshl_b32 s6, s20, 13
    s_add_u32 s6, s6, 0x0
    s_mov_b32 s26, 4096
    v_and_b32 v104, 15, v0
    v_mov_b32 v100, 0
    v_mov_b32 v105, 0x3f80
    v_cmp_eq_u32 vcc, 0, v104
    s_nop 1
    v_cndmask_b32 v100, v100, v105, vcc
    v_mov_b32 v105, 0x3f800000
    v_cmp_eq_u32 vcc, 1, v104
    s_nop 1
    v_cndmask_b32 v100, v100, v105, vcc
    v_mov_b32 v101, 0
    v_mov_b32 v105, 0x3f80
    v_cmp_eq_u32 vcc, 4, v104
    s_nop 1
    v_cndmask_b32 v101, v101, v105, vcc
    v_mov_b32 v105, 0x3f800000
    v_cmp_eq_u32 vcc, 5, v104
    s_nop 1
    v_cndmask_b32 v101, v101, v105, vcc
    v_mov_b32 v102, 0
    v_mov_b32 v105, 0x3f80
    v_cmp_eq_u32 vcc, 8, v104
    s_nop 1
    v_cndmask_b32 v102, v102, v105, vcc
    v_mov_b32 v105, 0x3f800000
    v_cmp_eq_u32 vcc, 9, v104
    s_nop 1
    v_cndmask_b32 v102, v102, v105, vcc
    v_mov_b32 v103, 0
    v_mov_b32 v105, 0x3f80
    v_cmp_eq_u32 vcc, 12, v104
    s_nop 1
    v_cndmask_b32 v103, v103, v105, vcc
    v_mov_b32 v105, 0x3f800000
    v_cmp_eq_u32 vcc, 13, v104
    s_nop 1
    v_cndmask_b32 v103, v103, v105, vcc
    ds_write_b128 v3, v[100:103] offset:23040
    s_mov_b32 s34, 0x05040100
    s_mov_b32 s35, 0x07060302
    s_mov_b32 s33, 0x3e0293ee
    s_mov_b32 s40, 0x4e800000
    s_mov_b32 s32, 0
    s_mov_b32 s4, 0x3f803f80
    s_mov_b32 s5, 0x3f803f80
    s_lshl_b32 s36, s20, 14
    s_lshr_b32 s37, s21, 1
    s_lshl_b32 s37, s37, 12
    s_add_u32 s25, s36, s37
    s_lshl_b32 s37, s21, 11
    s_add_u32 s39, s36, s37
    s_add_u32 s39, s39, 8192
    s_waitcnt vmcnt(34)
    s_barrier
    ds_read_b64_tr_b16 a[160:161], v20 offset:0
    ds_read_b64_tr_b16 a[162:163], v20 offset:512
    ds_read_b64_tr_b16 a[168:169], v21 offset:0
    ds_read_b64_tr_b16 a[170:171], v21 offset:512
    ds_read_b64_tr_b16 a[192:193], v22 offset:0
    ds_read_b64_tr_b16 a[194:195], v22 offset:512
    ds_read_b64_tr_b16 a[200:201], v23 offset:0
    ds_read_b64_tr_b16 a[202:203], v23 offset:512
    ds_read_b64_tr_b16 a[224:225], v24 offset:0
    ds_read_b64_tr_b16 a[226:227], v24 offset:512
    ds_read_b64_tr_b16 a[232:233], v25 offset:0
    ds_read_b64_tr_b16 a[234:235], v25 offset:512
    s_waitcnt lgkmcnt(4)
    ds_read_b64_tr_b16 v[128:129], v26 offset:0
    ds_read_b64_tr_b16 v[130:131], v26 offset:512
    ds_read_b64_tr_b16 v[136:137], v27 offset:0
    ds_read_b64_tr_b16 v[138:139], v27 offset:512
    s_waitcnt lgkmcnt(0)
    s_barrier
    s_add_u32 m0, s28, 0
    s_add_u32 s37, s3, 0x300000
    buffer_load_dwordx4 v16, s[60:63], s37 offen nt lds
    s_add_u32 m0, s28, 1024
    s_add_u32 s37, s3, 0x308000
    buffer_load_dwordx4 v17, s[60:63], s37 offen nt lds
    s_add_u32 m0, s28, 2048
    s_add_u32 s37, s3, 0x310000
    buffer_load_dwordx4 v18, s[60:63], s37 offen nt lds
    s_add_u32 m0, s28, 3072
    s_add_u32 s37, s3, 0x318000
    buffer_load_dwordx4 v19, s[60:63], s37 offen nt lds
    s_add_u32 m0, s28, 4096
    s_add_u32 s37, s3, 0x320000
    buffer_load_dwordx4 v16, s[60:63], s37 offen nt lds
    s_add_u32 m0, s28, 5120
    s_add_u32 s37, s3, 0x328000
    buffer_load_dwordx4 v17, s[60:63], s37 offen nt lds
    s_add_u32 m0, s28, 6144
    s_add_u32 s37, s3, 0x330000
    buffer_load_dwordx4 v18, s[60:63], s37 offen nt lds
    s_add_u32 m0, s28, 7168
    s_add_u32 s37, s3, 0x338000
    buffer_load_dwordx4 v19, s[60:63], s37 offen nt lds
    s_xor_b32 s36, s21, 2
    s_lshl_b32 s36, s36, 15
    s_add_u32 s36, s36, s29
    s_add_u32 s37, s36, 0x80
    buffer_load_dword v48, v11, s[92:95], s37 offen
    s_add_u32 s37, s36, 0x4080
    buffer_load_dword v49, v11, s[92:95], s37 offen
    s_add_u32 s37, s36, 0x480
    buffer_load_dword v50, v11, s[92:95], s37 offen
    s_add_u32 s37, s36, 0x4480
    buffer_load_dword v51, v11, s[92:95], s37 offen
    s_add_u32 s37, s36, 0x2080
    buffer_load_dword v52, v11, s[92:95], s37 offen
    s_add_u32 s37, s36, 0x6080
    buffer_load_dword v53, v11, s[92:95], s37 offen
    s_add_u32 s37, s36, 0x2480
    buffer_load_dword v54, v11, s[92:95], s37 offen
    s_add_u32 s37, s36, 0x6480
    buffer_load_dword v55, v11, s[92:95], s37 offen
    s_add_u32 s37, s36, 0xc0
    buffer_load_dword v56, v11, s[92:95], s37 offen
    s_add_u32 s37, s36, 0x40c0
    buffer_load_dword v57, v11, s[92:95], s37 offen
    s_add_u32 s37, s36, 0x4c0
    buffer_load_dword v58, v11, s[92:95], s37 offen
    s_add_u32 s37, s36, 0x44c0
    buffer_load_dword v59, v11, s[92:95], s37 offen
    s_add_u32 s37, s36, 0x20c0
    buffer_load_dword v60, v11, s[92:95], s37 offen
    s_add_u32 s37, s36, 0x60c0
    buffer_load_dword v61, v11, s[92:95], s37 offen
    s_add_u32 s37, s36, 0x24c0
    buffer_load_dword v62, v11, s[92:95], s37 offen
    s_add_u32 s37, s36, 0x64c0
    buffer_load_dword v63, v11, s[92:95], s37 offen
    s_waitcnt vmcnt(50)
    s_barrier
    ds_read_b64_tr_b16 a[164:165], v20 offset:8192
    ds_read_b64_tr_b16 a[166:167], v20 offset:8704
    ds_read_b64_tr_b16 a[172:173], v21 offset:8192
    ds_read_b64_tr_b16 a[174:175], v21 offset:8704
    ds_read_b64_tr_b16 a[196:197], v22 offset:8192
    ds_read_b64_tr_b16 a[198:199], v22 offset:8704
    ds_read_b64_tr_b16 a[204:205], v23 offset:8192
    ds_read_b64_tr_b16 a[206:207], v23 offset:8704
    ds_read_b64_tr_b16 a[228:229], v24 offset:8192
    ds_read_b64_tr_b16 a[230:231], v24 offset:8704
    ds_read_b64_tr_b16 a[236:237], v25 offset:8192
    ds_read_b64_tr_b16 a[238:239], v25 offset:8704
    s_waitcnt lgkmcnt(4)
    ds_read_b64_tr_b16 v[132:133], v26 offset:8192
    ds_read_b64_tr_b16 v[134:135], v26 offset:8704
    ds_read_b64_tr_b16 v[140:141], v27 offset:8192
    ds_read_b64_tr_b16 v[142:143], v27 offset:8704
    s_waitcnt lgkmcnt(0)
    s_barrier
    s_mov_b32 s88, s50
    s_and_b32 s89, s51, 0xffff
    s_mov_b32 s90, 0x400000
    s_mov_b32 s91, 0x20000
    s_add_u32 m0, s28, 8192
    s_add_u32 s37, s3, 0x0
    buffer_load_dwordx4 v16, s[88:91], s37 offen nt lds
    s_add_u32 m0, s28, 9216
    s_add_u32 s37, s3, 0x8000
    buffer_load_dwordx4 v17, s[88:91], s37 offen nt lds
    s_add_u32 m0, s28, 10240
    s_add_u32 s37, s3, 0x10000
    buffer_load_dwordx4 v18, s[88:91], s37 offen nt lds
    s_add_u32 m0, s28, 11264
    s_add_u32 s37, s3, 0x18000
    buffer_load_dwordx4 v19, s[88:91], s37 offen nt lds
    s_add_u32 m0, s28, 12288
    s_add_u32 s37, s3, 0x20000
    buffer_load_dwordx4 v16, s[88:91], s37 offen nt lds
    s_add_u32 m0, s28, 13312
    s_add_u32 s37, s3, 0x28000
    buffer_load_dwordx4 v17, s[88:91], s37 offen nt lds
    s_add_u32 m0, s28, 14336
    s_add_u32 s37, s3, 0x30000
    buffer_load_dwordx4 v18, s[88:91], s37 offen nt lds
    s_add_u32 m0, s28, 15360
    s_add_u32 s37, s3, 0x38000
    buffer_load_dwordx4 v19, s[88:91], s37 offen nt lds
    s_waitcnt vmcnt(34)
    v_perm_b32 v120, v33, v32, s34
    v_perm_b32 v121, v33, v32, s35
    v_perm_b32 v122, v35, v34, s34
    v_perm_b32 v123, v35, v34, s35
    v_perm_b32 v124, v37, v36, s34
    v_perm_b32 v125, v37, v36, s35
    v_perm_b32 v126, v39, v38, s34
    v_perm_b32 v127, v39, v38, s35
    ds_write_b128 v4, v[120:123] offset:24576
    ds_write_b128 v4, v[124:127] offset:25600
    s_waitcnt lgkmcnt(0)
    v_perm_b32 v120, v41, v40, s34
    v_perm_b32 v121, v41, v40, s35
    v_perm_b32 v122, v43, v42, s34
    v_perm_b32 v123, v43, v42, s35
    v_perm_b32 v124, v45, v44, s34
    v_perm_b32 v125, v45, v44, s35
    v_perm_b32 v126, v47, v46, s34
    v_perm_b32 v127, v47, v46, s35
    ds_write_b128 v4, v[120:123] offset:30720
    ds_write_b128 v4, v[124:127] offset:31744
    s_waitcnt lgkmcnt(0)
    s_xor_b32 s36, s21, 1
    s_lshl_b32 s36, s36, 15
    s_add_u32 s36, s36, s29
    s_add_u32 s37, s36, 0x80
    buffer_load_dword v80, v11, s[92:95], s37 offen
    s_add_u32 s37, s36, 0x4080
    buffer_load_dword v81, v11, s[92:95], s37 offen
    s_add_u32 s37, s36, 0x480
    buffer_load_dword v82, v11, s[92:95], s37 offen
    s_add_u32 s37, s36, 0x4480
    buffer_load_dword v83, v11, s[92:95], s37 offen
    s_add_u32 s37, s36, 0x2080
    buffer_load_dword v84, v11, s[92:95], s37 offen
    s_add_u32 s37, s36, 0x6080
    buffer_load_dword v85, v11, s[92:95], s37 offen
    s_add_u32 s37, s36, 0x2480
    buffer_load_dword v86, v11, s[92:95], s37 offen
    s_add_u32 s37, s36, 0x6480
    buffer_load_dword v87, v11, s[92:95], s37 offen
    s_add_u32 s37, s36, 0xc0
    buffer_load_dword v88, v11, s[92:95], s37 offen
    s_add_u32 s37, s36, 0x40c0
    buffer_load_dword v89, v11, s[92:95], s37 offen
    s_add_u32 s37, s36, 0x4c0
    buffer_load_dword v90, v11, s[92:95], s37 offen
    s_add_u32 s37, s36, 0x44c0
    buffer_load_dword v91, v11, s[92:95], s37 offen
    s_add_u32 s37, s36, 0x20c0
    buffer_load_dword v92, v11, s[92:95], s37 offen
    s_add_u32 s37, s36, 0x60c0
    buffer_load_dword v93, v11, s[92:95], s37 offen
    s_add_u32 s37, s36, 0x24c0
    buffer_load_dword v94, v11, s[92:95], s37 offen
    s_add_u32 s37, s36, 0x64c0
    buffer_load_dword v95, v11, s[92:95], s37 offen
    s_barrier
    ds_read_b64_tr_b16 a[176:177], v20 offset:16384
    ds_read_b64_tr_b16 a[178:179], v20 offset:16896
    ds_read_b64_tr_b16 a[184:185], v21 offset:16384
    ds_read_b64_tr_b16 a[186:187], v21 offset:16896
    ds_read_b64_tr_b16 a[208:209], v22 offset:16384
    ds_read_b64_tr_b16 a[210:211], v22 offset:16896
    ds_read_b64_tr_b16 a[216:217], v23 offset:16384
    ds_read_b64_tr_b16 a[218:219], v23 offset:16896
    ds_read_b64_tr_b16 a[240:241], v24 offset:16384
    ds_read_b64_tr_b16 a[242:243], v24 offset:16896
    ds_read_b64_tr_b16 a[248:249], v25 offset:16384
    ds_read_b64_tr_b16 a[250:251], v25 offset:16896
    s_waitcnt lgkmcnt(4)
    ds_read_b64_tr_b16 v[144:145], v26 offset:16384
    ds_read_b64_tr_b16 v[146:147], v26 offset:16896
    ds_read_b64_tr_b16 v[152:153], v27 offset:16384
    ds_read_b64_tr_b16 v[154:155], v27 offset:16896
    s_waitcnt lgkmcnt(0)
    s_barrier
    s_add_u32 m0, s28, 16384
    s_add_u32 s37, s3, 0x100000
    buffer_load_dwordx4 v16, s[88:91], s37 offen nt lds
    s_add_u32 m0, s28, 17408
    s_add_u32 s37, s3, 0x108000
    buffer_load_dwordx4 v17, s[88:91], s37 offen nt lds
    s_add_u32 m0, s28, 18432
    s_add_u32 s37, s3, 0x110000
    buffer_load_dwordx4 v18, s[88:91], s37 offen nt lds
    s_add_u32 m0, s28, 19456
    s_add_u32 s37, s3, 0x118000
    buffer_load_dwordx4 v19, s[88:91], s37 offen nt lds
    s_add_u32 m0, s28, 20480
    s_add_u32 s37, s3, 0x120000
    buffer_load_dwordx4 v16, s[88:91], s37 offen nt lds
    s_add_u32 m0, s28, 21504
    s_add_u32 s37, s3, 0x128000
    buffer_load_dwordx4 v17, s[88:91], s37 offen nt lds
    s_add_u32 m0, s28, 22528
    s_add_u32 s37, s3, 0x130000
    buffer_load_dwordx4 v18, s[88:91], s37 offen nt lds
    s_add_u32 m0, s28, 23552
    s_add_u32 s37, s3, 0x138000
    buffer_load_dwordx4 v19, s[88:91], s37 offen nt lds
    s_waitcnt vmcnt(32)
    v_perm_b32 v232, v49, v48, s34
    v_perm_b32 v233, v49, v48, s35
    v_perm_b32 v234, v51, v50, s34
    v_perm_b32 v235, v51, v50, s35
    v_perm_b32 v236, v53, v52, s34
    v_perm_b32 v237, v53, v52, s35
    v_perm_b32 v238, v55, v54, s34
    v_perm_b32 v239, v55, v54, s35
    v_perm_b32 v120, v57, v56, s34
    v_perm_b32 v121, v57, v56, s35
    v_perm_b32 v122, v59, v58, s34
    v_perm_b32 v123, v59, v58, s35
    v_perm_b32 v124, v61, v60, s34
    v_perm_b32 v125, v61, v60, s35
    v_perm_b32 v126, v63, v62, s34
    v_perm_b32 v127, v63, v62, s35
    ds_write_b128 v4, v[120:123] offset:28672
    ds_write_b128 v4, v[124:127] offset:29696
    s_waitcnt lgkmcnt(0)
    s_xor_b32 s36, s21, 3
    s_lshl_b32 s36, s36, 15
    s_add_u32 s36, s36, s29
    s_add_u32 s37, s36, 0x0
    buffer_load_dword v32, v11, s[92:95], s37 offen
    s_add_u32 s37, s36, 0x4000
    buffer_load_dword v33, v11, s[92:95], s37 offen
    s_add_u32 s37, s36, 0x400
    buffer_load_dword v34, v11, s[92:95], s37 offen
    s_add_u32 s37, s36, 0x4400
    buffer_load_dword v35, v11, s[92:95], s37 offen
    s_add_u32 s37, s36, 0x2000
    buffer_load_dword v36, v11, s[92:95], s37 offen
    s_add_u32 s37, s36, 0x6000
    buffer_load_dword v37, v11, s[92:95], s37 offen
    s_add_u32 s37, s36, 0x2400
    buffer_load_dword v38, v11, s[92:95], s37 offen
    s_add_u32 s37, s36, 0x6400
    buffer_load_dword v39, v11, s[92:95], s37 offen
    s_add_u32 s37, s36, 0x40
    buffer_load_dword v40, v11, s[92:95], s37 offen
    s_add_u32 s37, s36, 0x4040
    buffer_load_dword v41, v11, s[92:95], s37 offen
    s_add_u32 s37, s36, 0x440
    buffer_load_dword v42, v11, s[92:95], s37 offen
    s_add_u32 s37, s36, 0x4440
    buffer_load_dword v43, v11, s[92:95], s37 offen
    s_add_u32 s37, s36, 0x2040
    buffer_load_dword v44, v11, s[92:95], s37 offen
    s_add_u32 s37, s36, 0x6040
    buffer_load_dword v45, v11, s[92:95], s37 offen
    s_add_u32 s37, s36, 0x2440
    buffer_load_dword v46, v11, s[92:95], s37 offen
    s_add_u32 s37, s36, 0x6440
    buffer_load_dword v47, v11, s[92:95], s37 offen
    s_barrier
    ds_read_b64_tr_b16 a[180:181], v20 offset:0
    ds_read_b64_tr_b16 a[182:183], v20 offset:512
    ds_read_b64_tr_b16 a[188:189], v21 offset:0
    ds_read_b64_tr_b16 a[190:191], v21 offset:512
    ds_read_b64_tr_b16 a[212:213], v22 offset:0
    ds_read_b64_tr_b16 a[214:215], v22 offset:512
    ds_read_b64_tr_b16 a[220:221], v23 offset:0
    ds_read_b64_tr_b16 a[222:223], v23 offset:512
    ds_read_b64_tr_b16 a[244:245], v24 offset:0
    ds_read_b64_tr_b16 a[246:247], v24 offset:512
    ds_read_b64_tr_b16 a[252:253], v25 offset:0
    ds_read_b64_tr_b16 a[254:255], v25 offset:512
    s_waitcnt lgkmcnt(4)
    ds_read_b64_tr_b16 v[148:149], v26 offset:0
    ds_read_b64_tr_b16 v[150:151], v26 offset:512
    ds_read_b64_tr_b16 v[156:157], v27 offset:0
    ds_read_b64_tr_b16 v[158:159], v27 offset:512
    s_waitcnt lgkmcnt(0)
    s_barrier
    s_add_u32 m0, s28, 0
    s_add_u32 s37, s3, 0x200000
    buffer_load_dwordx4 v16, s[88:91], s37 offen nt lds
    s_add_u32 m0, s28, 1024
    s_add_u32 s37, s3, 0x208000
    buffer_load_dwordx4 v17, s[88:91], s37 offen nt lds
    s_add_u32 m0, s28, 2048
    s_add_u32 s37, s3, 0x210000
    buffer_load_dwordx4 v18, s[88:91], s37 offen nt lds
    s_add_u32 m0, s28, 3072
    s_add_u32 s37, s3, 0x218000
    buffer_load_dwordx4 v19, s[88:91], s37 offen nt lds
    s_add_u32 m0, s28, 4096
    s_add_u32 s37, s3, 0x220000
    buffer_load_dwordx4 v16, s[88:91], s37 offen nt lds
    s_add_u32 m0, s28, 5120
    s_add_u32 s37, s3, 0x228000
    buffer_load_dwordx4 v17, s[88:91], s37 offen nt lds
    s_add_u32 m0, s28, 6144
    s_add_u32 s37, s3, 0x230000
    buffer_load_dwordx4 v18, s[88:91], s37 offen nt lds
    s_add_u32 m0, s28, 7168
    s_add_u32 s37, s3, 0x238000
    buffer_load_dwordx4 v19, s[88:91], s37 offen nt lds
    s_waitcnt vmcnt(32)
    v_perm_b32 v208, v81, v80, s34
    v_perm_b32 v209, v81, v80, s35
    v_perm_b32 v210, v83, v82, s34
    v_perm_b32 v211, v83, v82, s35
    v_perm_b32 v212, v85, v84, s34
    v_perm_b32 v213, v85, v84, s35
    v_perm_b32 v214, v87, v86, s34
    v_perm_b32 v215, v87, v86, s35
    v_perm_b32 v120, v89, v88, s34
    v_perm_b32 v121, v89, v88, s35
    v_perm_b32 v122, v91, v90, s34
    v_perm_b32 v123, v91, v90, s35
    v_perm_b32 v124, v93, v92, s34
    v_perm_b32 v125, v93, v92, s35
    v_perm_b32 v126, v95, v94, s34
    v_perm_b32 v127, v95, v94, s35
    ds_write_b128 v4, v[120:123] offset:26624
    ds_write_b128 v4, v[124:127] offset:27648
    s_waitcnt lgkmcnt(0)
    s_xor_b32 s36, s21, 2
    s_lshl_b32 s36, s36, 15
    s_add_u32 s36, s36, s29
    s_add_u32 s37, s36, 0x0
    buffer_load_dword v48, v11, s[92:95], s37 offen
    s_add_u32 s37, s36, 0x4000
    buffer_load_dword v49, v11, s[92:95], s37 offen
    s_add_u32 s37, s36, 0x400
    buffer_load_dword v50, v11, s[92:95], s37 offen
    s_add_u32 s37, s36, 0x4400
    buffer_load_dword v51, v11, s[92:95], s37 offen
    s_add_u32 s37, s36, 0x2000
    buffer_load_dword v52, v11, s[92:95], s37 offen
    s_add_u32 s37, s36, 0x6000
    buffer_load_dword v53, v11, s[92:95], s37 offen
    s_add_u32 s37, s36, 0x2400
    buffer_load_dword v54, v11, s[92:95], s37 offen
    s_add_u32 s37, s36, 0x6400
    buffer_load_dword v55, v11, s[92:95], s37 offen
    s_add_u32 s37, s36, 0x40
    buffer_load_dword v56, v11, s[92:95], s37 offen
    s_add_u32 s37, s36, 0x4040
    buffer_load_dword v57, v11, s[92:95], s37 offen
    s_add_u32 s37, s36, 0x440
    buffer_load_dword v58, v11, s[92:95], s37 offen
    s_add_u32 s37, s36, 0x4440
    buffer_load_dword v59, v11, s[92:95], s37 offen
    s_add_u32 s37, s36, 0x2040
    buffer_load_dword v60, v11, s[92:95], s37 offen
    s_add_u32 s37, s36, 0x6040
    buffer_load_dword v61, v11, s[92:95], s37 offen
    s_add_u32 s37, s36, 0x2440
    buffer_load_dword v62, v11, s[92:95], s37 offen
    s_add_u32 s37, s36, 0x6440
    buffer_load_dword v63, v11, s[92:95], s37 offen
    s_barrier
    ds_read_b64_tr_b16 v[64:65], v20 offset:8192
    ds_read_b64_tr_b16 v[66:67], v20 offset:8704
    ds_read_b64_tr_b16 v[72:73], v21 offset:8192
    ds_read_b64_tr_b16 v[74:75], v21 offset:8704
    ds_read_b64_tr_b16 v[96:97], v22 offset:8192
    ds_read_b64_tr_b16 v[98:99], v22 offset:8704
    ds_read_b64_tr_b16 v[104:105], v23 offset:8192
    ds_read_b64_tr_b16 v[106:107], v23 offset:8704
    ds_read_b64_tr_b16 a[112:113], v24 offset:8192
    ds_read_b64_tr_b16 a[114:115], v24 offset:8704
    ds_read_b64_tr_b16 a[120:121], v25 offset:8192
    ds_read_b64_tr_b16 a[122:123], v25 offset:8704
    s_waitcnt lgkmcnt(4)
    ds_read_b64_tr_b16 a[144:145], v26 offset:8192
    ds_read_b64_tr_b16 a[146:147], v26 offset:8704
    ds_read_b64_tr_b16 a[152:153], v27 offset:8192
    ds_read_b64_tr_b16 a[154:155], v27 offset:8704
    s_waitcnt lgkmcnt(0)
    s_barrier
    s_add_u32 m0, s28, 8192
    s_add_u32 s37, s3, 0x300000
    buffer_load_dwordx4 v16, s[88:91], s37 offen nt lds
    s_add_u32 m0, s28, 9216
    s_add_u32 s37, s3, 0x308000
    buffer_load_dwordx4 v17, s[88:91], s37 offen nt lds
    s_add_u32 m0, s28, 10240
    s_add_u32 s37, s3, 0x310000
    buffer_load_dwordx4 v18, s[88:91], s37 offen nt lds
    s_add_u32 m0, s28, 11264
    s_add_u32 s37, s3, 0x318000
    buffer_load_dwordx4 v19, s[88:91], s37 offen nt lds
    s_add_u32 m0, s28, 12288
    s_add_u32 s37, s3, 0x320000
    buffer_load_dwordx4 v16, s[88:91], s37 offen nt lds
    s_add_u32 m0, s28, 13312
    s_add_u32 s37, s3, 0x328000
    buffer_load_dwordx4 v17, s[88:91], s37 offen nt lds
    s_add_u32 m0, s28, 14336
    s_add_u32 s37, s3, 0x330000
    buffer_load_dwordx4 v18, s[88:91], s37 offen nt lds
    s_add_u32 m0, s28, 15360
    s_add_u32 s37, s3, 0x338000
    buffer_load_dwordx4 v19, s[88:91], s37 offen nt lds
    s_waitcnt vmcnt(32)
    v_perm_b32 v240, v33, v32, s34
    v_perm_b32 v241, v33, v32, s35
    v_perm_b32 v242, v35, v34, s34
    v_perm_b32 v243, v35, v34, s35
    v_perm_b32 v244, v37, v36, s34
    v_perm_b32 v245, v37, v36, s35
    v_perm_b32 v246, v39, v38, s34
    v_perm_b32 v247, v39, v38, s35
    v_perm_b32 v248, v41, v40, s34
    v_perm_b32 v249, v41, v40, s35
    v_perm_b32 v250, v43, v42, s34
    v_perm_b32 v251, v43, v42, s35
    v_perm_b32 v252, v45, v44, s34
    v_perm_b32 v253, v45, v44, s35
    v_perm_b32 v254, v47, v46, s34
    v_perm_b32 v255, v47, v46, s35
    s_xor_b32 s36, s21, 1
    s_lshl_b32 s36, s36, 15
    s_add_u32 s36, s36, s29
    s_add_u32 s37, s36, 0x0
    buffer_load_dword v80, v11, s[92:95], s37 offen
    s_add_u32 s37, s36, 0x4000
    buffer_load_dword v81, v11, s[92:95], s37 offen
    s_add_u32 s37, s36, 0x400
    buffer_load_dword v82, v11, s[92:95], s37 offen
    s_add_u32 s37, s36, 0x4400
    buffer_load_dword v83, v11, s[92:95], s37 offen
    s_add_u32 s37, s36, 0x2000
    buffer_load_dword v84, v11, s[92:95], s37 offen
    s_add_u32 s37, s36, 0x6000
    buffer_load_dword v85, v11, s[92:95], s37 offen
    s_add_u32 s37, s36, 0x2400
    buffer_load_dword v86, v11, s[92:95], s37 offen
    s_add_u32 s37, s36, 0x6400
    buffer_load_dword v87, v11, s[92:95], s37 offen
    s_add_u32 s37, s36, 0x40
    buffer_load_dword v88, v11, s[92:95], s37 offen
    s_add_u32 s37, s36, 0x4040
    buffer_load_dword v89, v11, s[92:95], s37 offen
    s_add_u32 s37, s36, 0x440
    buffer_load_dword v90, v11, s[92:95], s37 offen
    s_add_u32 s37, s36, 0x4440
    buffer_load_dword v91, v11, s[92:95], s37 offen
    s_add_u32 s37, s36, 0x2040
    buffer_load_dword v92, v11, s[92:95], s37 offen
    s_add_u32 s37, s36, 0x6040
    buffer_load_dword v93, v11, s[92:95], s37 offen
    s_add_u32 s37, s36, 0x2440
    buffer_load_dword v94, v11, s[92:95], s37 offen
    s_add_u32 s37, s36, 0x6440
    buffer_load_dword v95, v11, s[92:95], s37 offen
    s_barrier
    ds_read_b64_tr_b16 v[68:69], v20 offset:16384
    ds_read_b64_tr_b16 v[70:71], v20 offset:16896
    ds_read_b64_tr_b16 v[76:77], v21 offset:16384
    ds_read_b64_tr_b16 v[78:79], v21 offset:16896
    ds_read_b64_tr_b16 v[100:101], v22 offset:16384
    ds_read_b64_tr_b16 v[102:103], v22 offset:16896
    ds_read_b64_tr_b16 v[108:109], v23 offset:16384
    ds_read_b64_tr_b16 v[110:111], v23 offset:16896
    ds_read_b64_tr_b16 a[116:117], v24 offset:16384
    ds_read_b64_tr_b16 a[118:119], v24 offset:16896
    ds_read_b64_tr_b16 a[124:125], v25 offset:16384
    ds_read_b64_tr_b16 a[126:127], v25 offset:16896
    s_waitcnt lgkmcnt(4)
    ds_read_b64_tr_b16 a[148:149], v26 offset:16384
    ds_read_b64_tr_b16 a[150:151], v26 offset:16896
    ds_read_b64_tr_b16 a[156:157], v27 offset:16384
    ds_read_b64_tr_b16 a[158:159], v27 offset:16896
    s_waitcnt lgkmcnt(0)
    s_barrier
    s_mov_b32 s96, s48
    s_and_b32 s97, s49, 0xffff
    s_mov_b32 s98, 0x400000
    s_mov_b32 s99, 0x20000
    s_add_u32 m0, s28, 16384
    s_add_u32 s37, s3, 0x0
    buffer_load_dwordx4 v16, s[96:99], s37 offen nt lds
    s_add_u32 m0, s28, 17408
    s_add_u32 s37, s3, 0x8000
    buffer_load_dwordx4 v17, s[96:99], s37 offen nt lds
    s_add_u32 m0, s28, 18432
    s_add_u32 s37, s3, 0x10000
    buffer_load_dwordx4 v18, s[96:99], s37 offen nt lds
    s_add_u32 m0, s28, 19456
    s_add_u32 s37, s3, 0x18000
    buffer_load_dwordx4 v19, s[96:99], s37 offen nt lds
    s_add_u32 m0, s28, 20480
    s_add_u32 s37, s3, 0x20000
    buffer_load_dwordx4 v16, s[96:99], s37 offen nt lds
    s_add_u32 m0, s28, 21504
    s_add_u32 s37, s3, 0x28000
    buffer_load_dwordx4 v17, s[96:99], s37 offen nt lds
    s_add_u32 m0, s28, 22528
    s_add_u32 s37, s3, 0x30000
    buffer_load_dwordx4 v18, s[96:99], s37 offen nt lds
    s_add_u32 m0, s28, 23552
    s_add_u32 s37, s3, 0x38000
    buffer_load_dwordx4 v19, s[96:99], s37 offen nt lds
    s_waitcnt vmcnt(32)
    v_perm_b32 v216, v49, v48, s34
    v_perm_b32 v217, v49, v48, s35
    v_perm_b32 v218, v51, v50, s34
    v_perm_b32 v219, v51, v50, s35
    v_perm_b32 v220, v53, v52, s34
    v_perm_b32 v221, v53, v52, s35
    v_perm_b32 v222, v55, v54, s34
    v_perm_b32 v223, v55, v54, s35
    v_perm_b32 v224, v57, v56, s34
    v_perm_b32 v225, v57, v56, s35
    v_perm_b32 v226, v59, v58, s34
    v_perm_b32 v227, v59, v58, s35
    v_perm_b32 v228, v61, v60, s34
    v_perm_b32 v229, v61, v60, s35
    v_perm_b32 v230, v63, v62, s34
    v_perm_b32 v231, v63, v62, s35
    s_xor_b32 s36, s21, 0
    s_lshl_b32 s36, s36, 15
    s_add_u32 s36, s36, s29
    s_add_u32 s37, s36, 0x80
    buffer_load_dword v32, v11, s[92:95], s37 offen
    s_add_u32 s37, s36, 0x4080
    buffer_load_dword v33, v11, s[92:95], s37 offen
    s_add_u32 s37, s36, 0x480
    buffer_load_dword v34, v11, s[92:95], s37 offen
    s_add_u32 s37, s36, 0x4480
    buffer_load_dword v35, v11, s[92:95], s37 offen
    s_add_u32 s37, s36, 0x2080
    buffer_load_dword v36, v11, s[92:95], s37 offen
    s_add_u32 s37, s36, 0x6080
    buffer_load_dword v37, v11, s[92:95], s37 offen
    s_add_u32 s37, s36, 0x2480
    buffer_load_dword v38, v11, s[92:95], s37 offen
    s_add_u32 s37, s36, 0x6480
    buffer_load_dword v39, v11, s[92:95], s37 offen
    s_add_u32 s37, s36, 0xc0
    buffer_load_dword v40, v11, s[92:95], s37 offen
    s_add_u32 s37, s36, 0x40c0
    buffer_load_dword v41, v11, s[92:95], s37 offen
    s_add_u32 s37, s36, 0x4c0
    buffer_load_dword v42, v11, s[92:95], s37 offen
    s_add_u32 s37, s36, 0x44c0
    buffer_load_dword v43, v11, s[92:95], s37 offen
    s_add_u32 s37, s36, 0x20c0
    buffer_load_dword v44, v11, s[92:95], s37 offen
    s_add_u32 s37, s36, 0x60c0
    buffer_load_dword v45, v11, s[92:95], s37 offen
    s_add_u32 s37, s36, 0x24c0
    buffer_load_dword v46, v11, s[92:95], s37 offen
    s_add_u32 s37, s36, 0x64c0
    buffer_load_dword v47, v11, s[92:95], s37 offen
    s_barrier
    ds_read_b64_tr_b16 a[80:81], v20 offset:0
    ds_read_b64_tr_b16 a[82:83], v20 offset:512
    ds_read_b64_tr_b16 a[88:89], v21 offset:0
    ds_read_b64_tr_b16 a[90:91], v21 offset:512
    ds_read_b64_tr_b16 a[96:97], v22 offset:0
    ds_read_b64_tr_b16 a[98:99], v22 offset:512
    ds_read_b64_tr_b16 a[104:105], v23 offset:0
    ds_read_b64_tr_b16 a[106:107], v23 offset:512
    ds_read_b64_tr_b16 a[128:129], v24 offset:0
    ds_read_b64_tr_b16 a[130:131], v24 offset:512
    ds_read_b64_tr_b16 a[136:137], v25 offset:0
    ds_read_b64_tr_b16 a[138:139], v25 offset:512
    s_waitcnt lgkmcnt(4)
    ds_read_b64_tr_b16 v[112:113], v26 offset:0
    ds_read_b64_tr_b16 v[114:115], v26 offset:512
    ds_read_b64_tr_b16 v[120:121], v27 offset:0
    ds_read_b64_tr_b16 v[122:123], v27 offset:512
    s_waitcnt lgkmcnt(0)
    s_barrier
    s_add_u32 m0, s28, 0
    s_add_u32 s37, s3, 0x100000
    buffer_load_dwordx4 v16, s[96:99], s37 offen nt lds
    s_add_u32 m0, s28, 1024
    s_add_u32 s37, s3, 0x108000
    buffer_load_dwordx4 v17, s[96:99], s37 offen nt lds
    s_add_u32 m0, s28, 2048
    s_add_u32 s37, s3, 0x110000
    buffer_load_dwordx4 v18, s[96:99], s37 offen nt lds
    s_add_u32 m0, s28, 3072
    s_add_u32 s37, s3, 0x118000
    buffer_load_dwordx4 v19, s[96:99], s37 offen nt lds
    s_add_u32 m0, s28, 4096
    s_add_u32 s37, s3, 0x120000
    buffer_load_dwordx4 v16, s[96:99], s37 offen nt lds
    s_add_u32 m0, s28, 5120
    s_add_u32 s37, s3, 0x128000
    buffer_load_dwordx4 v17, s[96:99], s37 offen nt lds
    s_add_u32 m0, s28, 6144
    s_add_u32 s37, s3, 0x130000
    buffer_load_dwordx4 v18, s[96:99], s37 offen nt lds
    s_add_u32 m0, s28, 7168
    s_add_u32 s37, s3, 0x138000
    buffer_load_dwordx4 v19, s[96:99], s37 offen nt lds
    s_waitcnt vmcnt(32)
    v_perm_b32 v192, v81, v80, s34
    v_perm_b32 v193, v81, v80, s35
    v_perm_b32 v194, v83, v82, s34
    v_perm_b32 v195, v83, v82, s35
    v_perm_b32 v196, v85, v84, s34
    v_perm_b32 v197, v85, v84, s35
    v_perm_b32 v198, v87, v86, s34
    v_perm_b32 v199, v87, v86, s35
    v_perm_b32 v200, v89, v88, s34
    v_perm_b32 v201, v89, v88, s35
    v_perm_b32 v202, v91, v90, s34
    v_perm_b32 v203, v91, v90, s35
    v_perm_b32 v204, v93, v92, s34
    v_perm_b32 v205, v93, v92, s35
    v_perm_b32 v206, v95, v94, s34
    v_perm_b32 v207, v95, v94, s35
    s_xor_b32 s36, s21, 0
    s_lshl_b32 s36, s36, 15
    s_add_u32 s36, s36, s29
    s_add_u32 s37, s36, 0x0
    buffer_load_dword v48, v11, s[92:95], s37 offen
    s_add_u32 s37, s36, 0x4000
    buffer_load_dword v49, v11, s[92:95], s37 offen
    s_add_u32 s37, s36, 0x400
    buffer_load_dword v50, v11, s[92:95], s37 offen
    s_add_u32 s37, s36, 0x4400
    buffer_load_dword v51, v11, s[92:95], s37 offen
    s_add_u32 s37, s36, 0x2000
    buffer_load_dword v52, v11, s[92:95], s37 offen
    s_add_u32 s37, s36, 0x6000
    buffer_load_dword v53, v11, s[92:95], s37 offen
    s_add_u32 s37, s36, 0x2400
    buffer_load_dword v54, v11, s[92:95], s37 offen
    s_add_u32 s37, s36, 0x6400
    buffer_load_dword v55, v11, s[92:95], s37 offen
    s_add_u32 s37, s36, 0x40
    buffer_load_dword v56, v11, s[92:95], s37 offen
    s_add_u32 s37, s36, 0x4040
    buffer_load_dword v57, v11, s[92:95], s37 offen
    s_add_u32 s37, s36, 0x440
    buffer_load_dword v58, v11, s[92:95], s37 offen
    s_add_u32 s37, s36, 0x4440
    buffer_load_dword v59, v11, s[92:95], s37 offen
    s_add_u32 s37, s36, 0x2040
    buffer_load_dword v60, v11, s[92:95], s37 offen
    s_add_u32 s37, s36, 0x6040
    buffer_load_dword v61, v11, s[92:95], s37 offen
    s_add_u32 s37, s36, 0x2440
    buffer_load_dword v62, v11, s[92:95], s37 offen
    s_add_u32 s37, s36, 0x6440
    buffer_load_dword v63, v11, s[92:95], s37 offen
    s_barrier
    ds_read_b64_tr_b16 a[84:85], v20 offset:8192
    ds_read_b64_tr_b16 a[86:87], v20 offset:8704
    ds_read_b64_tr_b16 a[92:93], v21 offset:8192
    ds_read_b64_tr_b16 a[94:95], v21 offset:8704
    ds_read_b64_tr_b16 a[100:101], v22 offset:8192
    ds_read_b64_tr_b16 a[102:103], v22 offset:8704
    ds_read_b64_tr_b16 a[108:109], v23 offset:8192
    ds_read_b64_tr_b16 a[110:111], v23 offset:8704
    ds_read_b64_tr_b16 a[132:133], v24 offset:8192
    ds_read_b64_tr_b16 a[134:135], v24 offset:8704
    ds_read_b64_tr_b16 a[140:141], v25 offset:8192
    ds_read_b64_tr_b16 a[142:143], v25 offset:8704
    s_waitcnt lgkmcnt(4)
    ds_read_b64_tr_b16 v[116:117], v26 offset:8192
    ds_read_b64_tr_b16 v[118:119], v26 offset:8704
    ds_read_b64_tr_b16 v[124:125], v27 offset:8192
    ds_read_b64_tr_b16 v[126:127], v27 offset:8704
    s_waitcnt lgkmcnt(0)
    s_barrier
    s_add_u32 m0, s28, 8192
    s_add_u32 s37, s3, 0x200000
    buffer_load_dwordx4 v16, s[96:99], s37 offen nt lds
    s_add_u32 m0, s28, 9216
    s_add_u32 s37, s3, 0x208000
    buffer_load_dwordx4 v17, s[96:99], s37 offen nt lds
    s_add_u32 m0, s28, 10240
    s_add_u32 s37, s3, 0x210000
    buffer_load_dwordx4 v18, s[96:99], s37 offen nt lds
    s_add_u32 m0, s28, 11264
    s_add_u32 s37, s3, 0x218000
    buffer_load_dwordx4 v19, s[96:99], s37 offen nt lds
    s_add_u32 m0, s28, 12288
    s_add_u32 s37, s3, 0x220000
    buffer_load_dwordx4 v16, s[96:99], s37 offen nt lds
    s_add_u32 m0, s28, 13312
    s_add_u32 s37, s3, 0x228000
    buffer_load_dwordx4 v17, s[96:99], s37 offen nt lds
    s_add_u32 m0, s28, 14336
    s_add_u32 s37, s3, 0x230000
    buffer_load_dwordx4 v18, s[96:99], s37 offen nt lds
    s_add_u32 m0, s28, 15360
    s_add_u32 s37, s3, 0x238000
    buffer_load_dwordx4 v19, s[96:99], s37 offen nt lds
    s_waitcnt vmcnt(32)
    v_perm_b32 v176, v33, v32, s34
    v_perm_b32 v177, v33, v32, s35
    v_perm_b32 v178, v35, v34, s34
    v_perm_b32 v179, v35, v34, s35
    v_perm_b32 v180, v37, v36, s34
    v_perm_b32 v181, v37, v36, s35
    v_perm_b32 v182, v39, v38, s34
    v_perm_b32 v183, v39, v38, s35
    v_perm_b32 v184, v41, v40, s34
    v_perm_b32 v185, v41, v40, s35
    v_perm_b32 v186, v43, v42, s34
    v_perm_b32 v187, v43, v42, s35
    v_perm_b32 v188, v45, v44, s34
    v_perm_b32 v189, v45, v44, s35
    v_perm_b32 v190, v47, v46, s34
    v_perm_b32 v191, v47, v46, s35
    s_barrier
    ds_read_b64_tr_b16 v[32:33], v20 offset:16384
    ds_read_b64_tr_b16 v[34:35], v20 offset:16896
    ds_read_b64_tr_b16 v[40:41], v21 offset:16384
    ds_read_b64_tr_b16 v[42:43], v21 offset:16896
    ds_read_b64_tr_b16 a[0:1], v22 offset:16384
    ds_read_b64_tr_b16 a[2:3], v22 offset:16896
    ds_read_b64_tr_b16 a[8:9], v23 offset:16384
    ds_read_b64_tr_b16 a[10:11], v23 offset:16896
    ds_read_b64_tr_b16 a[32:33], v24 offset:16384
    ds_read_b64_tr_b16 a[34:35], v24 offset:16896
    ds_read_b64_tr_b16 a[40:41], v25 offset:16384
    ds_read_b64_tr_b16 a[42:43], v25 offset:16896
    s_waitcnt lgkmcnt(4)
    ds_read_b64_tr_b16 a[64:65], v26 offset:16384
    ds_read_b64_tr_b16 a[66:67], v26 offset:16896
    ds_read_b64_tr_b16 a[72:73], v27 offset:16384
    ds_read_b64_tr_b16 a[74:75], v27 offset:16896
    s_waitcnt lgkmcnt(0)
    s_barrier
    s_add_u32 m0, s28, 16384
    s_add_u32 s37, s3, 0x300000
    buffer_load_dwordx4 v16, s[96:99], s37 offen nt lds
    s_add_u32 m0, s28, 17408
    s_add_u32 s37, s3, 0x308000
    buffer_load_dwordx4 v17, s[96:99], s37 offen nt lds
    s_add_u32 m0, s28, 18432
    s_add_u32 s37, s3, 0x310000
    buffer_load_dwordx4 v18, s[96:99], s37 offen nt lds
    s_add_u32 m0, s28, 19456
    s_add_u32 s37, s3, 0x318000
    buffer_load_dwordx4 v19, s[96:99], s37 offen nt lds
    s_add_u32 m0, s28, 20480
    s_add_u32 s37, s3, 0x320000
    buffer_load_dwordx4 v16, s[96:99], s37 offen nt lds
    s_add_u32 m0, s28, 21504
    s_add_u32 s37, s3, 0x328000
    buffer_load_dwordx4 v17, s[96:99], s37 offen nt lds
    s_add_u32 m0, s28, 22528
    s_add_u32 s37, s3, 0x330000
    buffer_load_dwordx4 v18, s[96:99], s37 offen nt lds
    s_add_u32 m0, s28, 23552
    s_add_u32 s37, s3, 0x338000
    buffer_load_dwordx4 v19, s[96:99], s37 offen nt lds
    s_waitcnt vmcnt(16)
    v_perm_b32 v160, v49, v48, s34
    v_perm_b32 v161, v49, v48, s35
    v_perm_b32 v162, v51, v50, s34
    v_perm_b32 v163, v51, v50, s35
    v_perm_b32 v164, v53, v52, s34
    v_perm_b32 v165, v53, v52, s35
    v_perm_b32 v166, v55, v54, s34
    v_perm_b32 v167, v55, v54, s35
    v_perm_b32 v168, v57, v56, s34
    v_perm_b32 v169, v57, v56, s35
    v_perm_b32 v170, v59, v58, s34
    v_perm_b32 v171, v59, v58, s35
    v_perm_b32 v172, v61, v60, s34
    v_perm_b32 v173, v61, v60, s35
    v_perm_b32 v174, v63, v62, s34
    v_perm_b32 v175, v63, v62, s35
    s_barrier
    ds_read_b64_tr_b16 v[36:37], v20 offset:0
    ds_read_b64_tr_b16 v[38:39], v20 offset:512
    ds_read_b64_tr_b16 v[44:45], v21 offset:0
    ds_read_b64_tr_b16 v[46:47], v21 offset:512
    ds_read_b64_tr_b16 a[4:5], v22 offset:0
    ds_read_b64_tr_b16 a[6:7], v22 offset:512
    ds_read_b64_tr_b16 a[12:13], v23 offset:0
    ds_read_b64_tr_b16 a[14:15], v23 offset:512
    ds_read_b64_tr_b16 a[36:37], v24 offset:0
    ds_read_b64_tr_b16 a[38:39], v24 offset:512
    ds_read_b64_tr_b16 a[44:45], v25 offset:0
    ds_read_b64_tr_b16 a[46:47], v25 offset:512
    s_waitcnt lgkmcnt(4)
    ds_read_b64_tr_b16 a[68:69], v26 offset:0
    ds_read_b64_tr_b16 a[70:71], v26 offset:512
    ds_read_b64_tr_b16 a[76:77], v27 offset:0
    ds_read_b64_tr_b16 a[78:79], v27 offset:512
    s_waitcnt lgkmcnt(0)
    s_barrier
    s_waitcnt vmcnt(8)
    s_barrier
    ds_read_b64_tr_b16 v[48:49], v20 offset:8192
    ds_read_b64_tr_b16 v[50:51], v20 offset:8704
    ds_read_b64_tr_b16 v[56:57], v21 offset:8192
    ds_read_b64_tr_b16 v[58:59], v21 offset:8704
    ds_read_b64_tr_b16 a[16:17], v22 offset:8192
    ds_read_b64_tr_b16 a[18:19], v22 offset:8704
    ds_read_b64_tr_b16 a[24:25], v23 offset:8192
    ds_read_b64_tr_b16 a[26:27], v23 offset:8704
    ds_read_b64_tr_b16 a[48:49], v24 offset:8192
    ds_read_b64_tr_b16 a[50:51], v24 offset:8704
    ds_read_b64_tr_b16 a[56:57], v25 offset:8192
    ds_read_b64_tr_b16 a[58:59], v25 offset:8704
    s_waitcnt lgkmcnt(4)
    ds_read_b64_tr_b16 v[80:81], v26 offset:8192
    ds_read_b64_tr_b16 v[82:83], v26 offset:8704
    ds_read_b64_tr_b16 v[88:89], v27 offset:8192
    ds_read_b64_tr_b16 v[90:91], v27 offset:8704
    s_waitcnt lgkmcnt(0)
    s_barrier
    s_waitcnt vmcnt(0)
    s_barrier
    ds_read_b64_tr_b16 v[52:53], v20 offset:16384
    ds_read_b64_tr_b16 v[54:55], v20 offset:16896
    ds_read_b64_tr_b16 v[60:61], v21 offset:16384
    ds_read_b64_tr_b16 v[62:63], v21 offset:16896
    ds_read_b64_tr_b16 a[20:21], v22 offset:16384
    ds_read_b64_tr_b16 a[22:23], v22 offset:16896
    ds_read_b64_tr_b16 a[28:29], v23 offset:16384
    ds_read_b64_tr_b16 a[30:31], v23 offset:16896
    ds_read_b64_tr_b16 a[52:53], v24 offset:16384
    ds_read_b64_tr_b16 a[54:55], v24 offset:16896
    ds_read_b64_tr_b16 a[60:61], v25 offset:16384
    ds_read_b64_tr_b16 a[62:63], v25 offset:16896
    s_waitcnt lgkmcnt(4)
    ds_read_b64_tr_b16 v[84:85], v26 offset:16384
    ds_read_b64_tr_b16 v[86:87], v26 offset:16896
    ds_read_b64_tr_b16 v[92:93], v27 offset:16384
    ds_read_b64_tr_b16 v[94:95], v27 offset:16896
    s_waitcnt lgkmcnt(0)
    s_barrier
    ds_write_b128 v4, v[32:35] offset:0
    ds_write_b128 v4, v[36:39] offset:1024
    ds_write_b128 v4, v[40:43] offset:2048
    ds_write_b128 v4, v[44:47] offset:3072
    ds_write_b128 v4, v[48:51] offset:4096
    ds_write_b128 v4, v[52:55] offset:5120
    ds_write_b128 v4, v[56:59] offset:6144
    ds_write_b128 v4, v[60:63] offset:7168
    s_waitcnt lgkmcnt(0)
    ds_write_b128 v4, v[64:67] offset:8192
    ds_write_b128 v4, v[68:71] offset:9216
    ds_write_b128 v4, v[72:75] offset:10240
    ds_write_b128 v4, v[76:79] offset:11264
    ds_write_b128 v4, v[80:83] offset:12288
    ds_write_b128 v4, v[84:87] offset:13312
    ds_write_b128 v4, v[88:91] offset:14336
    ds_write_b128 v4, v[92:95] offset:15360
    s_waitcnt lgkmcnt(0)
    ds_write_b128 v4, v[96:99] offset:16384
    ds_write_b128 v4, v[100:103] offset:17408
    ds_write_b128 v4, v[104:107] offset:18432
    ds_write_b128 v4, v[108:111] offset:19456
    ds_write_b128 v4, v[112:115] offset:20480
    ds_write_b128 v4, v[116:119] offset:21504
    ds_write_b128 v4, v[120:123] offset:22528
    ds_write_b128 v4, v[124:127] offset:23552
    s_waitcnt lgkmcnt(0)
    s_waitcnt lgkmcnt(0)
    v_mov_b32 v24, 0x0
    v_bfe_u32 v14, v0, 0, 1
    s_mov_b32 s38, 0x80
    v_mad_u32_u24 v24, v14, s38, v24
    v_bfe_u32 v14, v0, 1, 1
    s_mov_b32 s38, 0x100
    v_mad_u32_u24 v24, v14, s38, v24
    v_bfe_u32 v14, v0, 2, 1
    s_mov_b32 s38, 0x200
    v_mad_u32_u24 v24, v14, s38, v24
    v_bfe_u32 v14, v0, 3, 1
    s_mov_b32 s38, 0x400
    v_mad_u32_u24 v24, v14, s38, v24
    v_bfe_u32 v14, v0, 4, 1
    s_mov_b32 s38, 0x800
    v_mad_u32_u24 v24, v14, s38, v24
    v_bfe_u32 v14, v0, 6, 1
    s_mov_b32 s38, 0x1000
    v_mad_u32_u24 v24, v14, s38, v24
    v_bfe_u32 v14, v0, 7, 1
    s_mov_b32 s38, 0x2000
    v_mad_u32_u24 v24, v14, s38, v24
    s_lshl_b32 s36, s20, 14
    v_add_u32 v24, s36, v24
    s_lshl_b32 s36, s20, 8
    s_lshr_b32 s37, s21, 1
    s_lshl_b32 s37, s37, 7
    s_add_u32 s36, s36, s37
    s_add_u32 s36, s36, 0x102000
    v_and_b32 v14, 63, v0
    v_mov_b32 v25, 0x40000000
    v_cmp_lt_u32 vcc, 32, v14
    s_nop 1
    v_cndmask_b32 v24, v24, v25, vcc
    v_mov_b32 v25, s36
    v_cmp_eq_u32 vcc, 32, v14
    s_nop 1
    v_cndmask_b32 v0, v24, v25, vcc
    v_lshrrev_b32 v25, 2, v3
L_HS:
    buffer_load_dword v24, v25, s[16:19], 0 offen sc1
    s_add_u32 s32, s32, 1
    s_cmp_gt_u32 s32, 200000
    s_cbranch_scc1 L_slow_start
    s_waitcnt vmcnt(0)
    v_cmp_eq_u32 vcc, 0, v24
    s_cbranch_vccnz L_HS
    v_readlane_b32 s36, v24, 63
    s_nop 1
    v_cmp_ne_u32 vcc, s36, v24
    s_nop 1
    s_cmp_lg_u32 vcc_hi, 0
    s_cbranch_scc1 L_slow_start
    s_branch L_fast_start
L_fast_start:
    s_mov_b32 s22, 0
    s_mov_b32 s23, 0x1000000
    s_mov_b32 s27, 0
    s_mov_b32 s31, 0x80000
    s_mov_b32 s61, 0x40000000
    s_mov_b32 s91, 0
    ds_read_b128 v[104:107], v4 offset:0
    ds_read_b128 v[108:111], v4 offset:1024
    ds_read_b128 v[112:115], v4 offset:2048
    ds_read_b128 v[116:119], v4 offset:3072
    ds_read_b128 v[88:91], v4 offset:4096
    ds_read_b128 v[92:95], v4 offset:5120
    ds_read_b128 v[96:99], v4 offset:6144
    ds_read_b128 v[100:103], v4 offset:7168
    ds_read_b128 v[72:75], v4 offset:8192
    ds_read_b128 v[76:79], v4 offset:9216
    ds_read_b128 v[80:83], v4 offset:10240
    ds_read_b128 v[84:87], v4 offset:11264
    v_mov_b64 v[48:49], 0
    v_mov_b64 v[50:51], 0
    v_mov_b64 v[52:53], 0
    v_mov_b64 v[54:55], 0
    v_mov_b64 v[56:57], 0
    v_mov_b64 v[58:59], 0
    v_mov_b64 v[60:61], 0
    v_mov_b64 v[62:63], 0
    v_mov_b64 v[64:65], 0
    v_mov_b64 v[66:67], 0
    v_mov_b64 v[68:69], 0
    v_mov_b64 v[70:71], 0
    s_mov_b64 s[62:63], 0
    s_add_u32 s7, s23, 0x80000
    buffer_load_dwordx4 v[16:19], v2, s[8:11], s7 offen sc1
    buffer_load_dwordx4 v[20:23], v2, s[8:11], s7 offen offset:1024 sc1
L_fast_step:
    s_lshr_b64 s[36:37], s[62:63], s22
    s_andn2_b32 s36, 3, s36
    s_cbranch_scc1 L_fast_refresh
    s_add_u32 s24, s23, 0x82000
    s_add_u32 s29, s23, s25
    s_add_u32 s30, s23, s39
    s_xor_b32 s28, s27, 1
    s_add_u32 s90, s22, 1
    s_nop 15
L_fast_retrym:
    buffer_load_dwordx4 v[16:19], v2, s[8:11], s7 offen sc1
    buffer_load_dwordx4 v[20:23], v2, s[8:11], s7 offen offset:1024 sc1
    s_add_u32 s32, s32, 1
    s_cmp_gt_u32 s32, 200000
    s_cselect_b32 s94, -1, -2
    v_xor_b32 v28, 0x800, v2
    v_xor_b32 v44, 0x1800, v2
    v_mov_b64 v[48:49], 0
    v_mov_b64 v[50:51], 0
    v_mov_b64 v[52:53], 0
    v_mov_b64 v[54:55], 0
L_fast_waitm:
    s_waitcnt vmcnt(3) lgkmcnt(0)
L_fast_gotm:
    v_max3_u32 v14, v16, v17, v18
    v_max_u32 v14, v14, v19
    v_smfmac_f32_16x16x64_bf16 v[48:51], v[16:19], v[104:111], v1
    s_waitcnt vmcnt(2)
    v_max3_u32 v14, v14, v20, v21
    v_smfmac_f32_16x16x64_bf16 v[52:55], v[16:19], v[112:119], v1
    v_max3_u32 v14, v14, v22, v23
    v_cmp_lt_u32 vcc, s94, v14
    v_smfmac_f32_16x16x64_bf16 v[48:51], v[20:23], v[88:95], v1
    ds_write_b128 v2, v[16:19] offset:0
    s_cbranch_vccnz L_fast_retrym
    v_smfmac_f32_16x16x64_bf16 v[52:55], v[20:23], v[96:103], v1
    ds_write_b128 v2, v[20:23] offset:1024
    v_smfmac_f32_16x16x64_bf16 v[56:59], v[16:19], v[72:79], v1
    buffer_load_dwordx4 v[104:107], v3, s[8:11], s29 offen offset:0 sc1
    buffer_load_dwordx4 v[120:123], v3, s[8:11], s30 offen offset:0 sc1
    v_smfmac_f32_16x16x64_bf16 v[60:63], v[16:19], v[80:87], v1
    buffer_load_dwordx4 v[108:111], v3, s[8:11], s29 offen offset:1024 sc1
    buffer_load_dwordx4 v[124:127], v3, s[8:11], s30 offen offset:1024 sc1
    v_smfmac_f32_16x16x64_bf16 v[56:59], v[20:23], a[80:87], v1
    buffer_load_dwordx4 v[112:115], v3, s[8:11], s29 offen offset:2048 sc1
    buffer_load_dwordx4 v[116:119], v3, s[8:11], s29 offen offset:3072 sc1
    v_smfmac_f32_16x16x64_bf16 v[60:63], v[20:23], a[88:95], v1
    s_waitcnt lgkmcnt(0)
    s_barrier
    ds_read_b128 v[24:27], v28 offset:0
    v_smfmac_f32_16x16x64_bf16 v[64:67], v[16:19], a[160:167], v1
    ds_read_b128 v[28:31], v28 offset:1024
    v_smfmac_f32_16x16x64_bf16 v[68:71], v[16:19], a[168:175], v1
    buffer_load_dword v15, v0, s[8:11], s24 offen sc1
    v_smfmac_f32_16x16x64_bf16 v[64:67], v[20:23], a[176:183], v1
    ds_read_b128 v[32:35], v8 offset:0
    v_smfmac_f32_16x16x64_bf16 v[68:71], v[20:23], a[184:191], v1
    ds_read_b128 v[36:39], v8 offset:1024
    s_waitcnt lgkmcnt(3)
    v_smfmac_f32_16x16x64_bf16 v[48:51], v[24:27], a[0:7], v1
    ds_read_b128 v[40:43], v44 offset:0
    v_smfmac_f32_16x16x64_bf16 v[52:55], v[24:27], a[8:15], v1
    ds_read_b128 v[44:47], v44 offset:1024
    s_waitcnt lgkmcnt(4)
    v_smfmac_f32_16x16x64_bf16 v[48:51], v[28:31], a[16:23], v1
    ds_read_b128 v[88:91], v4 offset:12288
    v_smfmac_f32_16x16x64_bf16 v[52:55], v[28:31], a[24:31], v1
    ds_read_b128 v[92:95], v4 offset:13312
    s_waitcnt lgkmcnt(4)
    v_smfmac_f32_16x16x64_bf16 v[48:51], v[32:35], a[32:39], v1
    ds_read_b128 v[96:99], v4 offset:14336
    v_smfmac_f32_16x16x64_bf16 v[52:55], v[32:35], a[40:47], v1
    ds_read_b128 v[100:103], v4 offset:15360
    s_waitcnt lgkmcnt(4)
    v_smfmac_f32_16x16x64_bf16 v[48:51], v[36:39], a[48:55], v1
    v_smfmac_f32_16x16x64_bf16 v[52:55], v[36:39], a[56:63], v1
    ds_read_b128 v[72:75], v4 offset:16384
    v_smfmac_f32_16x16x64_bf16 v[48:51], v[40:43], a[64:71], v1
    v_smfmac_f32_16x16x64_bf16 v[52:55], v[40:43], a[72:79], v1
    ds_read_b128 v[76:79], v4 offset:17408
    s_waitcnt lgkmcnt(2)
    v_smfmac_f32_16x16x64_bf16 v[48:51], v[44:47], v[88:95], v1
    ds_read_b128 v[80:83], v4 offset:18432
    v_smfmac_f32_16x16x64_bf16 v[52:55], v[44:47], v[96:103], v1
    ds_read_b128 v[84:87], v4 offset:19456
    v_smfmac_f32_16x16x64_bf16 v[56:59], v[28:31], a[96:103], v1
    ds_read_b128 v[88:91], v4 offset:20480
    v_smfmac_f32_16x16x64_bf16 v[60:63], v[28:31], a[104:111], v1
    ds_read_b128 v[92:95], v4 offset:21504
    v_smfmac_f32_16x16x64_bf16 v[56:59], v[32:35], a[112:119], v1
    ds_read_b128 v[96:99], v4 offset:22528
    v_add_f32 v48, v48, v50
    v_add_f32 v49, v49, v51
    v_smfmac_f32_16x16x64_bf16 v[60:63], v[32:35], a[120:127], v1
    ds_read_b128 v[100:103], v4 offset:23552
    v_add_f32 v52, v52, v54
    v_add_f32 v53, v53, v55
    v_smfmac_f32_16x16x64_bf16 v[56:59], v[36:39], a[128:135], v1
    s_waitcnt lgkmcnt(4)
    v_cvt_pk_bf16_f32 v50, v48, v52
    v_cvt_pk_bf16_f32 v51, v49, v53
    v_smfmac_f32_16x16x64_bf16 v[56:59], v[24:27], v[72:79], v1
    ds_write2_b32 v5, v50, v51 offset0:0 offset1:72
    v_smfmac_f32_16x16x64_bf16 v[60:63], v[24:27], v[80:87], v1
    v_smfmac_f32_16x16x64_bf16 v[60:63], v[36:39], a[136:143], v1
    v_smfmac_f32_16x16x64_bf16 v[56:59], v[40:43], a[144:151], v1
    buffer_store_dword v12, v10, s[8:11], s31 offen sc1
    v_smfmac_f32_16x16x64_bf16 v[60:63], v[40:43], a[152:159], v1
    s_waitcnt lgkmcnt(0)
    s_barrier
    v_smfmac_f32_16x16x64_bf16 v[56:59], v[44:47], v[88:95], v1
    ds_read_b128 v[72:75], v6 offset:0
    v_smfmac_f32_16x16x64_bf16 v[60:63], v[44:47], v[96:103], v1
    ds_read_b128 v[76:79], v6 offset:64
    v_smfmac_f32_16x16x64_bf16 v[64:67], v[24:27], a[192:199], v1
    ds_read_b128 v[80:83], v6 offset:128
    v_smfmac_f32_16x16x64_bf16 v[68:71], v[24:27], a[200:207], v1
    ds_read_b128 v[84:87], v6 offset:192
    s_waitcnt vmcnt(2) lgkmcnt(3)
    v_mfma_f32_16x16x32_bf16 v[48:51], v[104:107], v[72:75], 0
    s_waitcnt lgkmcnt(2)
    v_add_f32 v56, v56, v58
    v_add_f32 v57, v57, v59
    v_mfma_f32_16x16x32_bf16 v[48:51], v[108:111], v[76:79], v[48:51]
    s_waitcnt lgkmcnt(1)
    v_add_f32 v60, v60, v62
    v_add_f32 v61, v61, v63
    v_mfma_f32_16x16x32_bf16 v[48:51], v[112:115], v[80:83], v[48:51]
    s_waitcnt lgkmcnt(0)
    v_cvt_pk_bf16_f32 v58, v56, v60
    v_cvt_pk_bf16_f32 v59, v57, v61
    v_mfma_f32_16x16x32_bf16 v[48:51], v[116:119], v[84:87], v[48:51]
    ds_write2_b32 v7, v58, v59 offset0:0 offset1:72
    v_smfmac_f32_16x16x64_bf16 v[64:67], v[28:31], a[208:215], v1
    v_mov_b64 v[104:105], s[4:5]
    v_smfmac_f32_16x16x64_bf16 v[68:71], v[28:31], a[216:223], v1
    s_nop 1
    v_mov_b64 v[106:107], s[4:5]
    v_smfmac_f32_16x16x64_bf16 v[64:67], v[32:35], a[224:231], v1
    v_exp_f32 v48, v48
    v_smfmac_f32_16x16x64_bf16 v[68:71], v[32:35], a[232:239], v1
    s_waitcnt lgkmcnt(0)
    s_barrier
    v_exp_f32 v49, v49
    v_smfmac_f32_16x16x64_bf16 v[64:67], v[36:39], a[240:247], v1
    ds_read_b128 v[88:91], v6 offset:2304
    v_exp_f32 v50, v50
    v_smfmac_f32_16x16x64_bf16 v[68:71], v[36:39], a[248:255], v1
    ds_read_b128 v[92:95], v6 offset:2368
    v_exp_f32 v51, v51
    v_smfmac_f32_16x16x64_bf16 v[64:67], v[40:43], v[128:135], v1
    ds_read_b128 v[96:99], v6 offset:2432
    v_cvt_pk_bf16_f32 v108, v48, v49
    v_cvt_pk_bf16_f32 v109, v50, v51
    v_smfmac_f32_16x16x64_bf16 v[68:71], v[40:43], v[136:143], v1
    ds_read_b128 v[100:103], v6 offset:2496
    ds_write_b64 v2, v[108:109] offset:8192
    s_waitcnt lgkmcnt(4)
    v_mfma_f32_16x16x32_bf16 v[52:55], v[88:91], v[72:75], 0
    s_waitcnt lgkmcnt(3)
    v_mov_b32 v113, 0
    v_mov_b32 v115, 0
    v_mfma_f32_16x16x32_bf16 v[52:55], v[92:95], v[76:79], v[52:55]
    s_waitcnt lgkmcnt(2)
    v_mov_b32 v117, 0
    v_mov_b64 v[16:17], 0
    v_mfma_f32_16x16x32_bf16 v[52:55], v[96:99], v[80:83], v[52:55]
    s_waitcnt lgkmcnt(1)
    v_mov_b64 v[18:19], 0
    v_mov_b64 v[20:21], 0
    v_mfma_f32_16x16x32_bf16 v[52:55], v[100:103], v[84:87], v[52:55]
    s_waitcnt lgkmcnt(0)
    s_barrier
    v_smfmac_f32_16x16x64_bf16 v[64:67], v[44:47], v[144:151], v1
    ds_read_b64 v[110:111], v8 offset:8192
    v_mov_b64 v[22:23], 0
    v_smfmac_f32_16x16x64_bf16 v[68:71], v[44:47], v[152:159], v1
    v_mov_b64 v[24:25], 0
    v_mov_b64 v[26:27], 0
    v_mul_f32 v52, s33, v52
    v_mul_f32 v53, s33, v53
    v_exp_f32 v52, v52
    s_waitcnt lgkmcnt(0)
    v_mfma_f32_16x16x32_bf16 v[48:51], v[104:107], v[108:111], 0
    v_exp_f32 v53, v53
    v_add_f32 v64, v64, v66
    v_mfma_f32_16x16x32_bf16 v[56:59], v[120:123], v[108:111], 0
    v_cvt_pk_bf16_f32 v112, v52, v53
    v_add_f32 v65, v65, v67
    v_mfma_f32_16x16x32_bf16 v[60:63], v[124:127], v[108:111], 0
    v_cvt_pk_bf16_f32 v114, v64, v65
    v_add_f32 v68, v68, v70
    v_mfma_f32_16x16x16_bf16 v[48:51], v[104:105], v[112:113], v[48:51]
    v_add_f32 v69, v69, v71
    v_cvt_pk_bf16_f32 v116, v68, v69
    v_mfma_f32_16x16x16_bf16 v[56:59], v[114:115], v[112:113], v[56:59]
    v_mov_b64 v[28:29], 0
    v_mov_b64 v[30:31], 0
    v_mfma_f32_16x16x16_bf16 v[60:63], v[116:117], v[112:113], v[60:63]
    v_xor_b32 v32, 0x800, v2
    v_xor_b32 v40, 0x1800, v2
    v_rcp_f32 v118, v48
    s_nop 0
    v_max_f32 v14, v118, v48
    v_cmp_nge_f32 vcc, s40, v14
    v_pk_mul_f32 v[56:57], v[56:57], v[118:119] op_sel_hi:[1,0]
    v_pk_mul_f32 v[58:59], v[58:59], v[118:119] op_sel_hi:[1,0]
    v_pk_mul_f32 v[60:61], v[60:61], v[118:119] op_sel_hi:[1,0]
    v_pk_mul_f32 v[62:63], v[62:63], v[118:119] op_sel_hi:[1,0]
    v_cvt_pk_bf16_f32 v52, v56, v60
    v_cvt_pk_bf16_f32 v53, v57, v61
    v_cvt_pk_bf16_f32 v54, v58, v62
    v_cvt_pk_bf16_f32 v55, v59, v63
L_fast_rejoin:
    ds_write_b128 v2, v[52:55] offset:9216
    s_nop 0
    v_smfmac_f32_16x16x64_bf16 v[16:19], v[52:55], v[160:167], v1
    v_smfmac_f32_16x16x64_bf16 v[20:23], v[52:55], v[168:175], v1
    v_smfmac_f32_16x16x64_bf16 v[24:27], v[52:55], v[176:183], v1
    s_waitcnt lgkmcnt(0)
    s_barrier
    ds_read_b128 v[32:35], v32 offset:9216
    ds_read_b128 v[36:39], v8 offset:9216
    v_smfmac_f32_16x16x64_bf16 v[28:31], v[52:55], v[184:191], v1
    ds_read_b128 v[40:43], v40 offset:9216
    ds_read_b128 v[88:91], v4 offset:24576
    ds_read_b128 v[92:95], v4 offset:25600
    s_waitcnt lgkmcnt(4)
    v_smfmac_f32_16x16x64_bf16 v[16:19], v[32:35], v[192:199], v1
    ds_read_b128 v[96:99], v4 offset:26624
    s_waitcnt lgkmcnt(4)
    v_smfmac_f32_16x16x64_bf16 v[16:19], v[36:39], v[216:223], v1
    ds_read_b128 v[100:103], v4 offset:27648
    s_waitcnt lgkmcnt(4)
    v_smfmac_f32_16x16x64_bf16 v[16:19], v[40:43], v[240:247], v1
    ds_read_b128 v[72:75], v4 offset:28672
    s_cmp_lg_u64 vcc, 0
    v_smfmac_f32_16x16x64_bf16 v[20:23], v[32:35], v[200:207], v1
    ds_read_b128 v[76:79], v4 offset:29696
    s_cselect_b32 s60, s28, s27
    v_smfmac_f32_16x16x64_bf16 v[20:23], v[36:39], v[224:231], v1
    ds_read_b128 v[80:83], v4 offset:30720
    s_nop 0
    v_cvt_pk_bf16_f32 v56, v16, v18
    v_smfmac_f32_16x16x64_bf16 v[20:23], v[40:43], v[248:255], v1
    ds_read_b128 v[84:87], v4 offset:31744
    v_cvt_pk_bf16_f32 v57, v17, v19
    v_and_or_b32 v56, v56, -2, s60
    v_smfmac_f32_16x16x64_bf16 v[24:27], v[32:35], v[208:215], v1
    buffer_store_dwordx2 v[56:57], v9, s[8:11], 0 offen offset:0
    v_smfmac_f32_16x16x64_bf16 v[24:27], v[36:39], v[232:239], v1
    s_waitcnt lgkmcnt(4)
    s_nop 0
    v_cvt_pk_bf16_f32 v58, v20, v22
    v_smfmac_f32_16x16x64_bf16 v[24:27], v[40:43], v[88:95], v1
    ds_read_b128 v[64:67], v3 offset:23040
    v_cvt_pk_bf16_f32 v59, v21, v23
    v_and_or_b32 v58, v58, -2, s60
    v_smfmac_f32_16x16x64_bf16 v[28:31], v[32:35], v[96:103], v1
    buffer_store_dwordx2 v[58:59], v9, s[8:11], 0 offen offset:2048
    s_waitcnt lgkmcnt(1)
    v_smfmac_f32_16x16x64_bf16 v[28:31], v[36:39], v[72:79], v1
    s_nop 1
    v_cvt_pk_bf16_f32 v60, v24, v26
    v_smfmac_f32_16x16x64_bf16 v[28:31], v[40:43], v[80:87], v1
    v_cvt_pk_bf16_f32 v61, v25, v27
    v_and_or_b32 v60, v60, -2, s60
    buffer_store_dwordx2 v[60:61], v9, s[8:11], s26 offen offset:0
    s_nop 4
    v_cvt_pk_bf16_f32 v62, v28, v30
    v_cvt_pk_bf16_f32 v63, v29, v31
    v_and_or_b32 v62, v62, -2, s60
    buffer_store_dwordx2 v[62:63], v9, s[8:11], s26 offen offset:2048
L_fast_stored:
    s_cmp_lg_u32 s60, s27
    s_cbranch_scc1 L_fast_safe
    ds_read_b128 v[104:107], v4 offset:0
    ds_read_b128 v[108:111], v4 offset:1024
    ds_read_b128 v[112:115], v4 offset:2048
    ds_read_b128 v[116:119], v4 offset:3072
    ds_read_b128 v[88:91], v4 offset:4096
    ds_read_b128 v[92:95], v4 offset:5120
    ds_read_b128 v[96:99], v4 offset:6144
    ds_read_b128 v[100:103], v4 offset:7168
    ds_read_b128 v[72:75], v4 offset:8192
    ds_read_b128 v[76:79], v4 offset:9216
    ds_read_b128 v[80:83], v4 offset:10240
    ds_read_b128 v[84:87], v4 offset:11264
    s_cmp_lt_u32 s21, 1
    s_cbranch_scc1 L_fast_pollp
    s_nop 13
    s_cmp_lt_u32 s21, 2
    s_cbranch_scc1 L_fast_pollp
    s_nop 13
    s_cmp_lt_u32 s21, 3
    s_cbranch_scc1 L_fast_pollp
    s_nop 13
L_fast_pollp:
    buffer_load_dwordx4 v[120:123], v2, s[8:11], s6 offen sc1
    buffer_load_dwordx4 v[124:127], v2, s[8:11], s6 offen offset:1024 sc1
    v_mov_b64 v[56:57], 0
    v_mov_b64 v[58:59], 0
    v_mov_b64 v[60:61], 0
    v_mov_b64 v[62:63], 0
    s_nop 15
    s_nop 15
    buffer_load_dwordx4 v[32:35], v2, s[8:11], s6 offen sc1
    buffer_load_dwordx4 v[36:39], v2, s[8:11], s6 offen offset:1024 sc1
    s_add_u32 s7, s24, 0x80000
    s_waitcnt vmcnt(3) lgkmcnt(0)
    v_mfma_f32_16x16x32_bf16 v[68:71], v[64:67], v[120:123], 0
    v_bitop3_b32 v14, v120, v122, s27 bitop3:0x7e
    s_waitcnt vmcnt(2)
    v_mfma_f32_16x16x32_bf16 v[68:71], v[64:67], v[124:127], v[68:71]
    v_bitop3_b32 v11, v124, v126, s27 bitop3:0x7e
    v_bitop3_b32 v14, v14, v11, 1 bitop3:0xa8
    v_cmp_ne_u32 vcc, 0, v14
    s_nop 2
    s_cmp_eq_u64 vcc, 0
    s_cselect_b32 s36, s24, s61
    v_add_f32_dpp v68, v68, v68 row_ror:8 row_mask:0xf bank_mask:0xf
    v_add_f32_dpp v69, v69, v69 row_ror:8 row_mask:0xf bank_mask:0xf
    s_nop 0
    v_add_f32_dpp v68, v68, v68 row_ror:4 row_mask:0xf bank_mask:0xf
    v_add_f32_dpp v69, v69, v69 row_ror:4 row_mask:0xf bank_mask:0xf
    v_cvt_pk_bf16_f32 v12, v68, v69
    buffer_store_dword v12, v10, s[8:11], s36 offen
    s_cbranch_scc1 L_fast_gotp
L_fast_retryp:
    buffer_load_dwordx4 v[120:123], v2, s[8:11], s6 offen sc1
    buffer_load_dwordx4 v[124:127], v2, s[8:11], s6 offen offset:1024 sc1
    s_waitcnt vmcnt(4) lgkmcnt(0)
    v_mfma_f32_16x16x32_bf16 v[68:71], v[64:67], v[32:35], 0
    v_bitop3_b32 v14, v32, v34, s27 bitop3:0x7e
    s_waitcnt vmcnt(3)
    v_mfma_f32_16x16x32_bf16 v[68:71], v[64:67], v[36:39], v[68:71]
    v_bitop3_b32 v11, v36, v38, s27 bitop3:0x7e
    v_bitop3_b32 v14, v14, v11, 1 bitop3:0xa8
    v_cmp_ne_u32 vcc, 0, v14
    s_nop 2
    s_cmp_eq_u64 vcc, 0
    s_cselect_b32 s36, s24, s61
    v_add_f32_dpp v68, v68, v68 row_ror:8 row_mask:0xf bank_mask:0xf
    v_add_f32_dpp v69, v69, v69 row_ror:8 row_mask:0xf bank_mask:0xf
    s_nop 0
    v_add_f32_dpp v68, v68, v68 row_ror:4 row_mask:0xf bank_mask:0xf
    v_add_f32_dpp v69, v69, v69 row_ror:4 row_mask:0xf bank_mask:0xf
    v_cvt_pk_bf16_f32 v12, v68, v69
    buffer_store_dword v12, v10, s[8:11], s36 offen
    s_cbranch_scc1 L_fast_gotp
    buffer_load_dwordx4 v[32:35], v2, s[8:11], s6 offen sc1
    buffer_load_dwordx4 v[36:39], v2, s[8:11], s6 offen offset:1024 sc1
    s_waitcnt vmcnt(4) lgkmcnt(0)
    v_mfma_f32_16x16x32_bf16 v[68:71], v[64:67], v[120:123], 0
    v_bitop3_b32 v14, v120, v122, s27 bitop3:0x7e
    s_waitcnt vmcnt(3)
    v_mfma_f32_16x16x32_bf16 v[68:71], v[64:67], v[124:127], v[68:71]
    v_bitop3_b32 v11, v124, v126, s27 bitop3:0x7e
    v_bitop3_b32 v14, v14, v11, 1 bitop3:0xa8
    v_cmp_ne_u32 vcc, 0, v14
    s_nop 2
    s_cmp_eq_u64 vcc, 0
    s_cselect_b32 s36, s24, s61
    v_add_f32_dpp v68, v68, v68 row_ror:8 row_mask:0xf bank_mask:0xf
    v_add_f32_dpp v69, v69, v69 row_ror:8 row_mask:0xf bank_mask:0xf
    s_nop 0
    v_add_f32_dpp v68, v68, v68 row_ror:4 row_mask:0xf bank_mask:0xf
    v_add_f32_dpp v69, v69, v69 row_ror:4 row_mask:0xf bank_mask:0xf
    v_cvt_pk_bf16_f32 v12, v68, v69
    buffer_store_dword v12, v10, s[8:11], s36 offen
    s_cbranch_scc1 L_fast_gotp
    s_add_u32 s32, s32, 1
    s_cmp_le_u32 s32, 200000
    s_cbranch_scc1 L_fast_retryp
    s_mov_b32 s36, s24
    buffer_store_dword v12, v10, s[8:11], s36 offen
L_fast_gotp:
    s_mov_b32 s23, s24
    s_add_u32 s31, s31, 0x2000
    s_mov_b32 s22, s90
    s_mov_b32 s27, s28
    v_mov_b64 v[64:65], 0
    v_mov_b64 v[66:67], 0
    v_mov_b64 v[68:69], 0
    v_mov_b64 v[70:71], 0
    s_nop 15
    s_nop 15
    buffer_load_dwordx4 v[16:19], v2, s[8:11], s7 offen sc1
    buffer_load_dwordx4 v[20:23], v2, s[8:11], s7 offen offset:1024 sc1
    s_cmp_lt_u32 s22, 63
    s_cbranch_scc1 L_fast_step
    buffer_store_dword v12, v10, s[8:11], s31 offen sc1
    s_branch L_fast_done
L_fast_refresh:
    v_lshrrev_b32 v14, 2, v3
    s_lshl_b32 s36, s20, 8
    s_add_u32 s36, s36, 0x190000
    buffer_load_dword v14, v14, s[8:11], s36 offen sc1
    s_add_u32 s32, s32, 1
    s_waitcnt vmcnt(0)
    v_cmp_ne_u32 s[62:63], 0, v14
    s_nop 3
    s_cmp_le_u32 s32, 200000
    s_cbranch_scc1 L_fast_step
    s_mov_b64 s[62:63], -1
    s_branch L_fast_step
L_fast_safe:
    s_nop 11
    s_waitcnt vmcnt(0) lgkmcnt(0)
    s_barrier
    ds_read_b128 v[72:75], v6 offset:0
    ds_read_b128 v[88:91], v6 offset:2304
    ds_read_b128 v[76:79], v6 offset:64
    ds_read_b128 v[92:95], v6 offset:2368
    ds_read_b128 v[80:83], v6 offset:128
    ds_read_b128 v[96:99], v6 offset:2432
    ds_read_b128 v[84:87], v6 offset:192
    ds_read_b128 v[100:103], v6 offset:2496
    s_xor_b32 s36, s25, 0x1000
    s_add_u32 s36, s36, s23
    buffer_load_dwordx4 v[16:19], v3, s[8:11], s29 offen offset:0 sc1
    buffer_load_dwordx4 v[32:35], v3, s[8:11], s36 offen offset:0 sc1
    buffer_load_dwordx4 v[20:23], v3, s[8:11], s29 offen offset:1024 sc1
    buffer_load_dwordx4 v[36:39], v3, s[8:11], s36 offen offset:1024 sc1
    buffer_load_dwordx4 v[24:27], v3, s[8:11], s29 offen offset:2048 sc1
    buffer_load_dwordx4 v[40:43], v3, s[8:11], s36 offen offset:2048 sc1
    buffer_load_dwordx4 v[28:31], v3, s[8:11], s29 offen offset:3072 sc1
    buffer_load_dwordx4 v[44:47], v3, s[8:11], s36 offen offset:3072 sc1
    s_waitcnt vmcnt(0) lgkmcnt(0)
    v_mfma_f32_16x16x32_bf16 v[48:51], v[16:19], v[72:75], 0
    v_mfma_f32_16x16x32_bf16 v[48:51], v[20:23], v[76:79], v[48:51]
    v_mfma_f32_16x16x32_bf16 v[48:51], v[24:27], v[80:83], v[48:51]
    v_mfma_f32_16x16x32_bf16 v[48:51], v[28:31], v[84:87], v[48:51]
    v_mfma_f32_16x16x32_bf16 v[52:55], v[32:35], v[72:75], 0
    v_mfma_f32_16x16x32_bf16 v[52:55], v[36:39], v[76:79], v[52:55]
    v_mfma_f32_16x16x32_bf16 v[52:55], v[40:43], v[80:83], v[52:55]
    v_mfma_f32_16x16x32_bf16 v[52:55], v[44:47], v[84:87], v[52:55]
    v_mfma_f32_16x16x32_bf16 v[56:59], v[88:91], v[72:75], 0
    v_mfma_f32_16x16x32_bf16 v[56:59], v[92:95], v[76:79], v[56:59]
    v_mfma_f32_16x16x32_bf16 v[56:59], v[96:99], v[80:83], v[56:59]
    v_mfma_f32_16x16x32_bf16 v[56:59], v[100:103], v[84:87], v[56:59]
    s_nop 7
    v_mul_f32 v56, s33, v56
    v_mul_f32 v57, s33, v57
    v_max3_f32 v16, v48, v49, v50
    v_max3_f32 v16, v16, v51, v52
    v_max3_f32 v16, v16, v53, v54
    v_max3_f32 v16, v16, v55, v56
    v_max_f32 v16, v16, v57
    v_mov_b32 v17, v16
    s_nop 1
    v_permlane16_swap_b32 v16, v17
    v_max_f32 v16, v16, v17
    v_mov_b32 v17, v16
    s_nop 1
    v_permlane32_swap_b32 v16, v17
    v_max_f32 v16, v16, v17
    v_sub_f32 v48, v48, v16
    v_exp_f32 v48, v48
    v_sub_f32 v49, v49, v16
    v_exp_f32 v49, v49
    v_sub_f32 v50, v50, v16
    v_exp_f32 v50, v50
    v_sub_f32 v51, v51, v16
    v_exp_f32 v51, v51
    v_sub_f32 v52, v52, v16
    v_exp_f32 v52, v52
    v_sub_f32 v53, v53, v16
    v_exp_f32 v53, v53
    v_sub_f32 v54, v54, v16
    v_exp_f32 v54, v54
    v_sub_f32 v55, v55, v16
    v_exp_f32 v55, v55
    v_sub_f32 v56, v56, v16
    v_exp_f32 v56, v56
    v_sub_f32 v57, v57, v16
    v_exp_f32 v57, v57
    v_cvt_pk_bf16_f32 v108, v48, v49
    v_cvt_pk_bf16_f32 v109, v50, v51
    v_cvt_pk_bf16_f32 v110, v52, v53
    v_cvt_pk_bf16_f32 v111, v54, v55
    v_cvt_pk_bf16_f32 v112, v56, v57
    s_nop 0
    v_mfma_f32_16x16x32_bf16 v[48:51], v[104:107], v[108:111], 0
    v_mfma_f32_16x16x32_bf16 v[56:59], v[120:123], v[108:111], 0
    v_mfma_f32_16x16x32_bf16 v[60:63], v[124:127], v[108:111], 0
    s_nop 3
    v_mfma_f32_16x16x16_bf16 v[48:51], v[104:105], v[112:113], v[48:51]
    v_mfma_f32_16x16x16_bf16 v[56:59], v[114:115], v[112:113], v[56:59]
    v_mfma_f32_16x16x16_bf16 v[60:63], v[116:117], v[112:113], v[60:63]
    s_nop 5
    v_rcp_f32 v118, v48
    s_nop 0
    v_mul_f32 v56, v56, v118
    v_mul_f32 v57, v57, v118
    v_mul_f32 v58, v58, v118
    v_mul_f32 v59, v59, v118
    v_mul_f32 v60, v60, v118
    v_mul_f32 v61, v61, v118
    v_mul_f32 v62, v62, v118
    v_mul_f32 v63, v63, v118
    v_cvt_pk_bf16_f32 v52, v56, v60
    v_cvt_pk_bf16_f32 v53, v57, v61
    v_cvt_pk_bf16_f32 v54, v58, v62
    v_cvt_pk_bf16_f32 v55, v59, v63
    v_mov_b32 v16, 0
    v_mov_b32 v17, 0
    v_mov_b32 v18, 0
    v_mov_b32 v19, 0
    v_mov_b32 v20, 0
    v_mov_b32 v21, 0
    v_mov_b32 v22, 0
    v_mov_b32 v23, 0
    v_mov_b32 v24, 0
    v_mov_b32 v25, 0
    v_mov_b32 v26, 0
    v_mov_b32 v27, 0
    v_mov_b32 v28, 0
    v_mov_b32 v29, 0
    v_mov_b32 v30, 0
    v_mov_b32 v31, 0
    v_xor_b32 v32, 0x800, v2
    v_xor_b32 v40, 0x1800, v2
    s_mov_b64 vcc, 0
    s_branch L_fast_rejoin
L_fast_done:
    s_branch L_end
L_slow_start:
    s_mov_b32 s22, 0
    s_mov_b32 s23, 0x1000000
    s_mov_b32 s27, 0
    s_mov_b32 s31, 0x80000
    s_mov_b32 s61, 0x40000000
    s_mov_b32 s91, 0
    ds_read_b128 v[104:107], v4 offset:0
    ds_read_b128 v[108:111], v4 offset:1024
    ds_read_b128 v[112:115], v4 offset:2048
    ds_read_b128 v[116:119], v4 offset:3072
    ds_read_b128 v[88:91], v4 offset:4096
    ds_read_b128 v[92:95], v4 offset:5120
    ds_read_b128 v[96:99], v4 offset:6144
    ds_read_b128 v[100:103], v4 offset:7168
    ds_read_b128 v[72:75], v4 offset:8192
    ds_read_b128 v[76:79], v4 offset:9216
    ds_read_b128 v[80:83], v4 offset:10240
    ds_read_b128 v[84:87], v4 offset:11264
    v_mov_b64 v[48:49], 0
    v_mov_b64 v[50:51], 0
    v_mov_b64 v[52:53], 0
    v_mov_b64 v[54:55], 0
    v_mov_b64 v[56:57], 0
    v_mov_b64 v[58:59], 0
    v_mov_b64 v[60:61], 0
    v_mov_b64 v[62:63], 0
    v_mov_b64 v[64:65], 0
    v_mov_b64 v[66:67], 0
    v_mov_b64 v[68:69], 0
    v_mov_b64 v[70:71], 0
    s_mov_b64 s[62:63], 0
    s_add_u32 s7, s23, 0x80000
    buffer_load_dwordx4 v[16:19], v2, s[8:11], s7 offen sc1
    buffer_load_dwordx4 v[20:23], v2, s[8:11], s7 offen offset:1024 sc1
L_slow_step:
    s_lshr_b64 s[36:37], s[62:63], s22
    s_andn2_b32 s36, 3, s36
    s_cbranch_scc1 L_slow_refresh
    s_add_u32 s24, s23, 0x82000
    s_add_u32 s29, s23, s25
    s_add_u32 s30, s23, s39
    s_xor_b32 s28, s27, 1
    s_add_u32 s90, s22, 1
    s_nop 15
L_slow_retrym:
    buffer_load_dwordx4 v[16:19], v2, s[8:11], s7 offen sc1
    buffer_load_dwordx4 v[20:23], v2, s[8:11], s7 offen offset:1024 sc1
    s_add_u32 s32, s32, 1
    s_cmp_gt_u32 s32, 200000
    s_cselect_b32 s94, -1, -2
    v_xor_b32 v28, 0x800, v2
    v_xor_b32 v44, 0x1800, v2
    v_mov_b64 v[48:49], 0
    v_mov_b64 v[50:51], 0
    v_mov_b64 v[52:53], 0
    v_mov_b64 v[54:55], 0
L_slow_waitm:
    s_waitcnt vmcnt(3) lgkmcnt(0)
L_slow_gotm:
    v_max3_u32 v14, v16, v17, v18
    v_max_u32 v14, v14, v19
    v_smfmac_f32_16x16x64_bf16 v[48:51], v[16:19], v[104:111], v1
    s_waitcnt vmcnt(2)
    v_max3_u32 v14, v14, v20, v21
    v_smfmac_f32_16x16x64_bf16 v[52:55], v[16:19], v[112:119], v1
    v_max3_u32 v14, v14, v22, v23
    v_cmp_lt_u32 vcc, s94, v14
    v_smfmac_f32_16x16x64_bf16 v[48:51], v[20:23], v[88:95], v1
    ds_write_b128 v2, v[16:19] offset:0
    s_cbranch_vccnz L_slow_retrym
    v_smfmac_f32_16x16x64_bf16 v[52:55], v[20:23], v[96:103], v1
    ds_write_b128 v2, v[20:23] offset:1024
    v_smfmac_f32_16x16x64_bf16 v[56:59], v[16:19], v[72:79], v1
    buffer_load_dwordx4 v[104:107], v3, s[8:11], s29 offen offset:0 sc1
    buffer_load_dwordx4 v[120:123], v3, s[8:11], s30 offen offset:0 sc1
    v_smfmac_f32_16x16x64_bf16 v[60:63], v[16:19], v[80:87], v1
    buffer_load_dwordx4 v[108:111], v3, s[8:11], s29 offen offset:1024 sc1
    buffer_load_dwordx4 v[124:127], v3, s[8:11], s30 offen offset:1024 sc1
    v_smfmac_f32_16x16x64_bf16 v[56:59], v[20:23], a[80:87], v1
    buffer_load_dwordx4 v[112:115], v3, s[8:11], s29 offen offset:2048 sc1
    buffer_load_dwordx4 v[116:119], v3, s[8:11], s29 offen offset:3072 sc1
    v_smfmac_f32_16x16x64_bf16 v[60:63], v[20:23], a[88:95], v1
    s_waitcnt lgkmcnt(0)
    s_barrier
    ds_read_b128 v[24:27], v28 offset:0
    v_smfmac_f32_16x16x64_bf16 v[64:67], v[16:19], a[160:167], v1
    ds_read_b128 v[28:31], v28 offset:1024
    v_smfmac_f32_16x16x64_bf16 v[68:71], v[16:19], a[168:175], v1
    buffer_load_dword v15, v0, s[8:11], s24 offen sc1
    v_smfmac_f32_16x16x64_bf16 v[64:67], v[20:23], a[176:183], v1
    ds_read_b128 v[32:35], v8 offset:0
    v_smfmac_f32_16x16x64_bf16 v[68:71], v[20:23], a[184:191], v1
    ds_read_b128 v[36:39], v8 offset:1024
    s_waitcnt lgkmcnt(3)
    v_smfmac_f32_16x16x64_bf16 v[48:51], v[24:27], a[0:7], v1
    ds_read_b128 v[40:43], v44 offset:0
    v_smfmac_f32_16x16x64_bf16 v[52:55], v[24:27], a[8:15], v1
    ds_read_b128 v[44:47], v44 offset:1024
    s_waitcnt lgkmcnt(4)
    v_smfmac_f32_16x16x64_bf16 v[48:51], v[28:31], a[16:23], v1
    ds_read_b128 v[88:91], v4 offset:12288
    v_smfmac_f32_16x16x64_bf16 v[52:55], v[28:31], a[24:31], v1
    ds_read_b128 v[92:95], v4 offset:13312
    s_waitcnt lgkmcnt(4)
    v_smfmac_f32_16x16x64_bf16 v[48:51], v[32:35], a[32:39], v1
    ds_read_b128 v[96:99], v4 offset:14336
    v_smfmac_f32_16x16x64_bf16 v[52:55], v[32:35], a[40:47], v1
    ds_read_b128 v[100:103], v4 offset:15360
    s_waitcnt lgkmcnt(4)
    v_smfmac_f32_16x16x64_bf16 v[48:51], v[36:39], a[48:55], v1
    v_smfmac_f32_16x16x64_bf16 v[52:55], v[36:39], a[56:63], v1
    ds_read_b128 v[72:75], v4 offset:16384
    v_smfmac_f32_16x16x64_bf16 v[48:51], v[40:43], a[64:71], v1
    v_smfmac_f32_16x16x64_bf16 v[52:55], v[40:43], a[72:79], v1
    ds_read_b128 v[76:79], v4 offset:17408
    s_waitcnt lgkmcnt(2)
    v_smfmac_f32_16x16x64_bf16 v[48:51], v[44:47], v[88:95], v1
    ds_read_b128 v[80:83], v4 offset:18432
    v_smfmac_f32_16x16x64_bf16 v[52:55], v[44:47], v[96:103], v1
    ds_read_b128 v[84:87], v4 offset:19456
    v_smfmac_f32_16x16x64_bf16 v[56:59], v[28:31], a[96:103], v1
    ds_read_b128 v[88:91], v4 offset:20480
    v_smfmac_f32_16x16x64_bf16 v[60:63], v[28:31], a[104:111], v1
    ds_read_b128 v[92:95], v4 offset:21504
    v_smfmac_f32_16x16x64_bf16 v[56:59], v[32:35], a[112:119], v1
    ds_read_b128 v[96:99], v4 offset:22528
    v_add_f32 v48, v48, v50
    v_add_f32 v49, v49, v51
    v_smfmac_f32_16x16x64_bf16 v[60:63], v[32:35], a[120:127], v1
    ds_read_b128 v[100:103], v4 offset:23552
    v_add_f32 v52, v52, v54
    v_add_f32 v53, v53, v55
    v_smfmac_f32_16x16x64_bf16 v[56:59], v[36:39], a[128:135], v1
    s_waitcnt lgkmcnt(4)
    v_cvt_pk_bf16_f32 v50, v48, v52
    v_cvt_pk_bf16_f32 v51, v49, v53
    v_smfmac_f32_16x16x64_bf16 v[56:59], v[24:27], v[72:79], v1
    ds_write2_b32 v5, v50, v51 offset0:0 offset1:72
    v_smfmac_f32_16x16x64_bf16 v[60:63], v[24:27], v[80:87], v1
    v_smfmac_f32_16x16x64_bf16 v[60:63], v[36:39], a[136:143], v1
    v_smfmac_f32_16x16x64_bf16 v[56:59], v[40:43], a[144:151], v1
    buffer_store_dword v12, v10, s[8:11], s31 offen sc1
    v_smfmac_f32_16x16x64_bf16 v[60:63], v[40:43], a[152:159], v1
    s_waitcnt lgkmcnt(0)
    s_barrier
    v_smfmac_f32_16x16x64_bf16 v[56:59], v[44:47], v[88:95], v1
    ds_read_b128 v[72:75], v6 offset:0
    v_smfmac_f32_16x16x64_bf16 v[60:63], v[44:47], v[96:103], v1
    ds_read_b128 v[76:79], v6 offset:64
    v_smfmac_f32_16x16x64_bf16 v[64:67], v[24:27], a[192:199], v1
    ds_read_b128 v[80:83], v6 offset:128
    v_smfmac_f32_16x16x64_bf16 v[68:71], v[24:27], a[200:207], v1
    ds_read_b128 v[84:87], v6 offset:192
    s_waitcnt vmcnt(2) lgkmcnt(3)
    v_mfma_f32_16x16x32_bf16 v[48:51], v[104:107], v[72:75], 0
    s_waitcnt lgkmcnt(2)
    v_add_f32 v56, v56, v58
    v_add_f32 v57, v57, v59
    v_mfma_f32_16x16x32_bf16 v[48:51], v[108:111], v[76:79], v[48:51]
    s_waitcnt lgkmcnt(1)
    v_add_f32 v60, v60, v62
    v_add_f32 v61, v61, v63
    v_mfma_f32_16x16x32_bf16 v[48:51], v[112:115], v[80:83], v[48:51]
    s_waitcnt lgkmcnt(0)
    v_cvt_pk_bf16_f32 v58, v56, v60
    v_cvt_pk_bf16_f32 v59, v57, v61
    v_mfma_f32_16x16x32_bf16 v[48:51], v[116:119], v[84:87], v[48:51]
    ds_write2_b32 v7, v58, v59 offset0:0 offset1:72
    v_smfmac_f32_16x16x64_bf16 v[64:67], v[28:31], a[208:215], v1
    v_mov_b64 v[104:105], s[4:5]
    v_smfmac_f32_16x16x64_bf16 v[68:71], v[28:31], a[216:223], v1
    s_nop 1
    v_mov_b64 v[106:107], s[4:5]
    v_smfmac_f32_16x16x64_bf16 v[64:67], v[32:35], a[224:231], v1
    v_exp_f32 v48, v48
    v_smfmac_f32_16x16x64_bf16 v[68:71], v[32:35], a[232:239], v1
    s_waitcnt lgkmcnt(0)
    s_barrier
    v_exp_f32 v49, v49
    v_smfmac_f32_16x16x64_bf16 v[64:67], v[36:39], a[240:247], v1
    ds_read_b128 v[88:91], v6 offset:2304
    v_exp_f32 v50, v50
    v_smfmac_f32_16x16x64_bf16 v[68:71], v[36:39], a[248:255], v1
    ds_read_b128 v[92:95], v6 offset:2368
    v_exp_f32 v51, v51
    v_smfmac_f32_16x16x64_bf16 v[64:67], v[40:43], v[128:135], v1
    ds_read_b128 v[96:99], v6 offset:2432
    v_cvt_pk_bf16_f32 v108, v48, v49
    v_cvt_pk_bf16_f32 v109, v50, v51
    v_smfmac_f32_16x16x64_bf16 v[68:71], v[40:43], v[136:143], v1
    ds_read_b128 v[100:103], v6 offset:2496
    ds_write_b64 v2, v[108:109] offset:8192
    s_waitcnt lgkmcnt(4)
    v_mfma_f32_16x16x32_bf16 v[52:55], v[88:91], v[72:75], 0
    s_waitcnt lgkmcnt(3)
    v_mov_b32 v113, 0
    v_mov_b32 v115, 0
    v_mfma_f32_16x16x32_bf16 v[52:55], v[92:95], v[76:79], v[52:55]
    s_waitcnt lgkmcnt(2)
    v_mov_b32 v117, 0
    v_mov_b64 v[16:17], 0
    v_mfma_f32_16x16x32_bf16 v[52:55], v[96:99], v[80:83], v[52:55]
    s_waitcnt lgkmcnt(1)
    v_mov_b64 v[18:19], 0
    v_mov_b64 v[20:21], 0
    v_mfma_f32_16x16x32_bf16 v[52:55], v[100:103], v[84:87], v[52:55]
    s_waitcnt lgkmcnt(0)
    s_barrier
    v_smfmac_f32_16x16x64_bf16 v[64:67], v[44:47], v[144:151], v1
    ds_read_b64 v[110:111], v8 offset:8192
    v_mov_b64 v[22:23], 0
    v_smfmac_f32_16x16x64_bf16 v[68:71], v[44:47], v[152:159], v1
    v_mov_b64 v[24:25], 0
    v_mov_b64 v[26:27], 0
    v_mul_f32 v52, s33, v52
    v_mul_f32 v53, s33, v53
    v_exp_f32 v52, v52
    s_waitcnt lgkmcnt(0)
    v_mfma_f32_16x16x32_bf16 v[48:51], v[104:107], v[108:111], 0
    v_exp_f32 v53, v53
    v_add_f32 v64, v64, v66
    v_mfma_f32_16x16x32_bf16 v[56:59], v[120:123], v[108:111], 0
    v_cvt_pk_bf16_f32 v112, v52, v53
    v_add_f32 v65, v65, v67
    v_mfma_f32_16x16x32_bf16 v[60:63], v[124:127], v[108:111], 0
    v_cvt_pk_bf16_f32 v114, v64, v65
    v_add_f32 v68, v68, v70
    v_mfma_f32_16x16x16_bf16 v[48:51], v[104:105], v[112:113], v[48:51]
    v_add_f32 v69, v69, v71
    v_cvt_pk_bf16_f32 v116, v68, v69
    v_mfma_f32_16x16x16_bf16 v[56:59], v[114:115], v[112:113], v[56:59]
    v_mov_b64 v[28:29], 0
    v_mov_b64 v[30:31], 0
    v_mfma_f32_16x16x16_bf16 v[60:63], v[116:117], v[112:113], v[60:63]
    v_xor_b32 v32, 0x800, v2
    v_xor_b32 v40, 0x1800, v2
    v_rcp_f32 v118, v48
    s_nop 0
    v_max_f32 v14, v118, v48
    v_cmp_nge_f32 vcc, s40, v14
    v_pk_mul_f32 v[56:57], v[56:57], v[118:119] op_sel_hi:[1,0]
    v_pk_mul_f32 v[58:59], v[58:59], v[118:119] op_sel_hi:[1,0]
    v_pk_mul_f32 v[60:61], v[60:61], v[118:119] op_sel_hi:[1,0]
    v_pk_mul_f32 v[62:63], v[62:63], v[118:119] op_sel_hi:[1,0]
    v_cvt_pk_bf16_f32 v52, v56, v60
    v_cvt_pk_bf16_f32 v53, v57, v61
    v_cvt_pk_bf16_f32 v54, v58, v62
    v_cvt_pk_bf16_f32 v55, v59, v63
L_slow_rejoin:
    ds_write_b128 v2, v[52:55] offset:9216
    s_nop 0
    v_smfmac_f32_16x16x64_bf16 v[16:19], v[52:55], v[160:167], v1
    v_smfmac_f32_16x16x64_bf16 v[20:23], v[52:55], v[168:175], v1
    v_smfmac_f32_16x16x64_bf16 v[24:27], v[52:55], v[176:183], v1
    s_waitcnt lgkmcnt(0)
    s_barrier
    ds_read_b128 v[32:35], v32 offset:9216
    ds_read_b128 v[36:39], v8 offset:9216
    v_smfmac_f32_16x16x64_bf16 v[28:31], v[52:55], v[184:191], v1
    ds_read_b128 v[40:43], v40 offset:9216
    ds_read_b128 v[88:91], v4 offset:24576
    ds_read_b128 v[92:95], v4 offset:25600
    s_waitcnt lgkmcnt(4)
    v_smfmac_f32_16x16x64_bf16 v[16:19], v[32:35], v[192:199], v1
    ds_read_b128 v[96:99], v4 offset:26624
    s_waitcnt lgkmcnt(4)
    v_smfmac_f32_16x16x64_bf16 v[16:19], v[36:39], v[216:223], v1
    ds_read_b128 v[100:103], v4 offset:27648
    s_waitcnt lgkmcnt(4)
    v_smfmac_f32_16x16x64_bf16 v[16:19], v[40:43], v[240:247], v1
    ds_read_b128 v[72:75], v4 offset:28672
    s_cmp_lg_u64 vcc, 0
    v_smfmac_f32_16x16x64_bf16 v[20:23], v[32:35], v[200:207], v1
    ds_read_b128 v[76:79], v4 offset:29696
    s_cselect_b32 s60, s28, s27
    v_smfmac_f32_16x16x64_bf16 v[20:23], v[36:39], v[224:231], v1
    ds_read_b128 v[80:83], v4 offset:30720
    s_nop 0
    v_cvt_pk_bf16_f32 v56, v16, v18
    v_smfmac_f32_16x16x64_bf16 v[20:23], v[40:43], v[248:255], v1
    ds_read_b128 v[84:87], v4 offset:31744
    v_cvt_pk_bf16_f32 v57, v17, v19
    v_and_or_b32 v56, v56, -2, s60
    v_smfmac_f32_16x16x64_bf16 v[24:27], v[32:35], v[208:215], v1
    buffer_store_dwordx2 v[56:57], v9, s[8:11], 0 offen offset:0 sc1
    v_smfmac_f32_16x16x64_bf16 v[24:27], v[36:39], v[232:239], v1
    s_waitcnt lgkmcnt(4)
    s_nop 0
    v_cvt_pk_bf16_f32 v58, v20, v22
    v_smfmac_f32_16x16x64_bf16 v[24:27], v[40:43], v[88:95], v1
    ds_read_b128 v[64:67], v3 offset:23040
    v_cvt_pk_bf16_f32 v59, v21, v23
    v_and_or_b32 v58, v58, -2, s60
    v_smfmac_f32_16x16x64_bf16 v[28:31], v[32:35], v[96:103], v1
    buffer_store_dwordx2 v[58:59], v9, s[8:11], 0 offen offset:2048 sc1
    s_waitcnt lgkmcnt(1)
    v_smfmac_f32_16x16x64_bf16 v[28:31], v[36:39], v[72:79], v1
    s_nop 1
    v_cvt_pk_bf16_f32 v60, v24, v26
    v_smfmac_f32_16x16x64_bf16 v[28:31], v[40:43], v[80:87], v1
    v_cvt_pk_bf16_f32 v61, v25, v27
    v_and_or_b32 v60, v60, -2, s60
    buffer_store_dwordx2 v[60:61], v9, s[8:11], s26 offen offset:0 sc1
    s_nop 4
    v_cvt_pk_bf16_f32 v62, v28, v30
    v_cvt_pk_bf16_f32 v63, v29, v31
    v_and_or_b32 v62, v62, -2, s60
    buffer_store_dwordx2 v[62:63], v9, s[8:11], s26 offen offset:2048 sc1
L_slow_stored:
    s_cmp_lg_u32 s60, s27
    s_cbranch_scc1 L_slow_safe
    ds_read_b128 v[104:107], v4 offset:0
    ds_read_b128 v[108:111], v4 offset:1024
    ds_read_b128 v[112:115], v4 offset:2048
    ds_read_b128 v[116:119], v4 offset:3072
    ds_read_b128 v[88:91], v4 offset:4096
    ds_read_b128 v[92:95], v4 offset:5120
    ds_read_b128 v[96:99], v4 offset:6144
    ds_read_b128 v[100:103], v4 offset:7168
    ds_read_b128 v[72:75], v4 offset:8192
    ds_read_b128 v[76:79], v4 offset:9216
    ds_read_b128 v[80:83], v4 offset:10240
    ds_read_b128 v[84:87], v4 offset:11264
    s_cmp_lt_u32 s21, 1
    s_cbranch_scc1 L_slow_pollp
    s_nop 13
    s_cmp_lt_u32 s21, 2
    s_cbranch_scc1 L_slow_pollp
    s_nop 13
    s_cmp_lt_u32 s21, 3
    s_cbranch_scc1 L_slow_pollp
    s_nop 13
L_slow_pollp:
    buffer_load_dwordx4 v[120:123], v2, s[8:11], s6 offen sc1
    buffer_load_dwordx4 v[124:127], v2, s[8:11], s6 offen offset:1024 sc1
    v_mov_b64 v[56:57], 0
    v_mov_b64 v[58:59], 0
    v_mov_b64 v[60:61], 0
    v_mov_b64 v[62:63], 0
    s_nop 15
    s_nop 15
    buffer_load_dwordx4 v[32:35], v2, s[8:11], s6 offen sc1
    buffer_load_dwordx4 v[36:39], v2, s[8:11], s6 offen offset:1024 sc1
    s_add_u32 s7, s24, 0x80000
    s_waitcnt vmcnt(3) lgkmcnt(0)
    v_mfma_f32_16x16x32_bf16 v[68:71], v[64:67], v[120:123], 0
    v_bitop3_b32 v14, v120, v122, s27 bitop3:0x7e
    s_waitcnt vmcnt(2)
    v_mfma_f32_16x16x32_bf16 v[68:71], v[64:67], v[124:127], v[68:71]
    v_bitop3_b32 v11, v124, v126, s27 bitop3:0x7e
    v_bitop3_b32 v14, v14, v11, 1 bitop3:0xa8
    v_cmp_ne_u32 vcc, 0, v14
    s_nop 2
    s_cmp_eq_u64 vcc, 0
    s_cselect_b32 s36, s24, s61
    v_add_f32_dpp v68, v68, v68 row_ror:8 row_mask:0xf bank_mask:0xf
    v_add_f32_dpp v69, v69, v69 row_ror:8 row_mask:0xf bank_mask:0xf
    s_nop 0
    v_add_f32_dpp v68, v68, v68 row_ror:4 row_mask:0xf bank_mask:0xf
    v_add_f32_dpp v69, v69, v69 row_ror:4 row_mask:0xf bank_mask:0xf
    v_cvt_pk_bf16_f32 v12, v68, v69
    buffer_store_dword v12, v10, s[8:11], s36 offen sc1
    s_cbranch_scc1 L_slow_gotp
L_slow_retryp:
    buffer_load_dwordx4 v[120:123], v2, s[8:11], s6 offen sc1
    buffer_load_dwordx4 v[124:127], v2, s[8:11], s6 offen offset:1024 sc1
    s_waitcnt vmcnt(4) lgkmcnt(0)
    v_mfma_f32_16x16x32_bf16 v[68:71], v[64:67], v[32:35], 0
    v_bitop3_b32 v14, v32, v34, s27 bitop3:0x7e
    s_waitcnt vmcnt(3)
    v_mfma_f32_16x16x32_bf16 v[68:71], v[64:67], v[36:39], v[68:71]
    v_bitop3_b32 v11, v36, v38, s27 bitop3:0x7e
    v_bitop3_b32 v14, v14, v11, 1 bitop3:0xa8
    v_cmp_ne_u32 vcc, 0, v14
    s_nop 2
    s_cmp_eq_u64 vcc, 0
    s_cselect_b32 s36, s24, s61
    v_add_f32_dpp v68, v68, v68 row_ror:8 row_mask:0xf bank_mask:0xf
    v_add_f32_dpp v69, v69, v69 row_ror:8 row_mask:0xf bank_mask:0xf
    s_nop 0
    v_add_f32_dpp v68, v68, v68 row_ror:4 row_mask:0xf bank_mask:0xf
    v_add_f32_dpp v69, v69, v69 row_ror:4 row_mask:0xf bank_mask:0xf
    v_cvt_pk_bf16_f32 v12, v68, v69
    buffer_store_dword v12, v10, s[8:11], s36 offen sc1
    s_cbranch_scc1 L_slow_gotp
    buffer_load_dwordx4 v[32:35], v2, s[8:11], s6 offen sc1
    buffer_load_dwordx4 v[36:39], v2, s[8:11], s6 offen offset:1024 sc1
    s_waitcnt vmcnt(4) lgkmcnt(0)
    v_mfma_f32_16x16x32_bf16 v[68:71], v[64:67], v[120:123], 0
    v_bitop3_b32 v14, v120, v122, s27 bitop3:0x7e
    s_waitcnt vmcnt(3)
    v_mfma_f32_16x16x32_bf16 v[68:71], v[64:67], v[124:127], v[68:71]
    v_bitop3_b32 v11, v124, v126, s27 bitop3:0x7e
    v_bitop3_b32 v14, v14, v11, 1 bitop3:0xa8
    v_cmp_ne_u32 vcc, 0, v14
    s_nop 2
    s_cmp_eq_u64 vcc, 0
    s_cselect_b32 s36, s24, s61
    v_add_f32_dpp v68, v68, v68 row_ror:8 row_mask:0xf bank_mask:0xf
    v_add_f32_dpp v69, v69, v69 row_ror:8 row_mask:0xf bank_mask:0xf
    s_nop 0
    v_add_f32_dpp v68, v68, v68 row_ror:4 row_mask:0xf bank_mask:0xf
    v_add_f32_dpp v69, v69, v69 row_ror:4 row_mask:0xf bank_mask:0xf
    v_cvt_pk_bf16_f32 v12, v68, v69
    buffer_store_dword v12, v10, s[8:11], s36 offen sc1
    s_cbranch_scc1 L_slow_gotp
    s_add_u32 s32, s32, 1
    s_cmp_le_u32 s32, 200000
    s_cbranch_scc1 L_slow_retryp
    s_mov_b32 s36, s24
    buffer_store_dword v12, v10, s[8:11], s36 offen sc1
L_slow_gotp:
    s_mov_b32 s23, s24
    s_add_u32 s31, s31, 0x2000
    s_mov_b32 s22, s90
    s_mov_b32 s27, s28
    v_mov_b64 v[64:65], 0
    v_mov_b64 v[66:67], 0
    v_mov_b64 v[68:69], 0
    v_mov_b64 v[70:71], 0
    s_nop 15
    s_nop 15
    buffer_load_dwordx4 v[16:19], v2, s[8:11], s7 offen sc1
    buffer_load_dwordx4 v[20:23], v2, s[8:11], s7 offen offset:1024 sc1
    s_cmp_lt_u32 s22, 63
    s_cbranch_scc1 L_slow_step
    buffer_store_dword v12, v10, s[8:11], s31 offen sc1
    s_branch L_slow_done
L_slow_refresh:
    v_lshrrev_b32 v14, 2, v3
    s_lshl_b32 s36, s20, 8
    s_add_u32 s36, s36, 0x190000
    buffer_load_dword v14, v14, s[8:11], s36 offen sc1
    s_add_u32 s32, s32, 1
    s_waitcnt vmcnt(0)
    v_cmp_ne_u32 s[62:63], 0, v14
    s_nop 3
    s_cmp_le_u32 s32, 200000
    s_cbranch_scc1 L_slow_step
    s_mov_b64 s[62:63], -1
    s_branch L_slow_step
L_slow_safe:
    s_nop 11
    s_waitcnt vmcnt(0) lgkmcnt(0)
    s_barrier
    ds_read_b128 v[72:75], v6 offset:0
    ds_read_b128 v[88:91], v6 offset:2304
    ds_read_b128 v[76:79], v6 offset:64
    ds_read_b128 v[92:95], v6 offset:2368
    ds_read_b128 v[80:83], v6 offset:128
    ds_read_b128 v[96:99], v6 offset:2432
    ds_read_b128 v[84:87], v6 offset:192
    ds_read_b128 v[100:103], v6 offset:2496
    s_xor_b32 s36, s25, 0x1000
    s_add_u32 s36, s36, s23
    buffer_load_dwordx4 v[16:19], v3, s[8:11], s29 offen offset:0 sc1
    buffer_load_dwordx4 v[32:35], v3, s[8:11], s36 offen offset:0 sc1
    buffer_load_dwordx4 v[20:23], v3, s[8:11], s29 offen offset:1024 sc1
    buffer_load_dwordx4 v[36:39], v3, s[8:11], s36 offen offset:1024 sc1
    buffer_load_dwordx4 v[24:27], v3, s[8:11], s29 offen offset:2048 sc1
    buffer_load_dwordx4 v[40:43], v3, s[8:11], s36 offen offset:2048 sc1
    buffer_load_dwordx4 v[28:31], v3, s[8:11], s29 offen offset:3072 sc1
    buffer_load_dwordx4 v[44:47], v3, s[8:11], s36 offen offset:3072 sc1
    s_waitcnt vmcnt(0) lgkmcnt(0)
    v_mfma_f32_16x16x32_bf16 v[48:51], v[16:19], v[72:75], 0
    v_mfma_f32_16x16x32_bf16 v[48:51], v[20:23], v[76:79], v[48:51]
    v_mfma_f32_16x16x32_bf16 v[48:51], v[24:27], v[80:83], v[48:51]
    v_mfma_f32_16x16x32_bf16 v[48:51], v[28:31], v[84:87], v[48:51]
    v_mfma_f32_16x16x32_bf16 v[52:55], v[32:35], v[72:75], 0
    v_mfma_f32_16x16x32_bf16 v[52:55], v[36:39], v[76:79], v[52:55]
    v_mfma_f32_16x16x32_bf16 v[52:55], v[40:43], v[80:83], v[52:55]
    v_mfma_f32_16x16x32_bf16 v[52:55], v[44:47], v[84:87], v[52:55]
    v_mfma_f32_16x16x32_bf16 v[56:59], v[88:91], v[72:75], 0
    v_mfma_f32_16x16x32_bf16 v[56:59], v[92:95], v[76:79], v[56:59]
    v_mfma_f32_16x16x32_bf16 v[56:59], v[96:99], v[80:83], v[56:59]
    v_mfma_f32_16x16x32_bf16 v[56:59], v[100:103], v[84:87], v[56:59]
    s_nop 7
    v_mul_f32 v56, s33, v56
    v_mul_f32 v57, s33, v57
    v_max3_f32 v16, v48, v49, v50
    v_max3_f32 v16, v16, v51, v52
    v_max3_f32 v16, v16, v53, v54
    v_max3_f32 v16, v16, v55, v56
    v_max_f32 v16, v16, v57
    v_mov_b32 v17, v16
    s_nop 1
    v_permlane16_swap_b32 v16, v17
    v_max_f32 v16, v16, v17
    v_mov_b32 v17, v16
    s_nop 1
    v_permlane32_swap_b32 v16, v17
    v_max_f32 v16, v16, v17
    v_sub_f32 v48, v48, v16
    v_exp_f32 v48, v48
    v_sub_f32 v49, v49, v16
    v_exp_f32 v49, v49
    v_sub_f32 v50, v50, v16
    v_exp_f32 v50, v50
    v_sub_f32 v51, v51, v16
    v_exp_f32 v51, v51
    v_sub_f32 v52, v52, v16
    v_exp_f32 v52, v52
    v_sub_f32 v53, v53, v16
    v_exp_f32 v53, v53
    v_sub_f32 v54, v54, v16
    v_exp_f32 v54, v54
    v_sub_f32 v55, v55, v16
    v_exp_f32 v55, v55
    v_sub_f32 v56, v56, v16
    v_exp_f32 v56, v56
    v_sub_f32 v57, v57, v16
    v_exp_f32 v57, v57
    v_cvt_pk_bf16_f32 v108, v48, v49
    v_cvt_pk_bf16_f32 v109, v50, v51
    v_cvt_pk_bf16_f32 v110, v52, v53
    v_cvt_pk_bf16_f32 v111, v54, v55
    v_cvt_pk_bf16_f32 v112, v56, v57
    s_nop 0
    v_mfma_f32_16x16x32_bf16 v[48:51], v[104:107], v[108:111], 0
    v_mfma_f32_16x16x32_bf16 v[56:59], v[120:123], v[108:111], 0
    v_mfma_f32_16x16x32_bf16 v[60:63], v[124:127], v[108:111], 0
    s_nop 3
    v_mfma_f32_16x16x16_bf16 v[48:51], v[104:105], v[112:113], v[48:51]
    v_mfma_f32_16x16x16_bf16 v[56:59], v[114:115], v[112:113], v[56:59]
    v_mfma_f32_16x16x16_bf16 v[60:63], v[116:117], v[112:113], v[60:63]
    s_nop 5
    v_rcp_f32 v118, v48
    s_nop 0
    v_mul_f32 v56, v56, v118
    v_mul_f32 v57, v57, v118
    v_mul_f32 v58, v58, v118
    v_mul_f32 v59, v59, v118
    v_mul_f32 v60, v60, v118
    v_mul_f32 v61, v61, v118
    v_mul_f32 v62, v62, v118
    v_mul_f32 v63, v63, v118
    v_cvt_pk_bf16_f32 v52, v56, v60
    v_cvt_pk_bf16_f32 v53, v57, v61
    v_cvt_pk_bf16_f32 v54, v58, v62
    v_cvt_pk_bf16_f32 v55, v59, v63
    v_mov_b32 v16, 0
    v_mov_b32 v17, 0
    v_mov_b32 v18, 0
    v_mov_b32 v19, 0
    v_mov_b32 v20, 0
    v_mov_b32 v21, 0
    v_mov_b32 v22, 0
    v_mov_b32 v23, 0
    v_mov_b32 v24, 0
    v_mov_b32 v25, 0
    v_mov_b32 v26, 0
    v_mov_b32 v27, 0
    v_mov_b32 v28, 0
    v_mov_b32 v29, 0
    v_mov_b32 v30, 0
    v_mov_b32 v31, 0
    v_xor_b32 v32, 0x800, v2
    v_xor_b32 v40, 0x1800, v2
    s_mov_b64 vcc, 0
    s_branch L_slow_rejoin
L_slow_done:
    s_branch L_end
L_worker:
    s_cmp_eq_u32 s3, 7
    s_cbranch_scc1 L_mlp
    s_and_b32 s36, s2, 7
    s_sub_u32 s36, s36, 1
    s_lshl_b32 s36, s36, 5
    s_lshr_b32 s37, s2, 3
    s_add_u32 s36, s36, s37
    s_mul_i32 s20, s36, 10923
    s_lshr_b32 s20, s20, 16
    s_mul_i32 s37, s20, 6
    s_sub_u32 s22, s36, s37
    v_lshrrev_b32 v28, 6, v0
    v_bfe_u32 v29, v0, 4, 2
    v_lshl_add_u32 v28, v28, 5, v29
    v_and_b32 v16, 15, v0
    v_lshlrev_b32 v16, 4, v16
    v_lshl_add_u32 v16, v28, 13, v16
    v_bfe_u32 v29, v0, 4, 2
    v_lshlrev_b32 v29, 5, v29
    v_xor_b32 v16, v16, v29
    v_xor_b32 v17, 0, v16
    v_xor_b32 v18, 128, v16
    v_xor_b32 v19, 128, v16
    s_add_u32 s28, s21, 1
    s_lshl_b32 s28, s28, 15
    s_lshl_b32 s3, s20, 8
    s_mov_b32 s76, s52
    s_and_b32 s77, s53, 0xffff
    s_mov_b32 s78, 0x400000
    s_mov_b32 s79, 0x20000
    s_add_u32 m0, s28, 0
    s_add_u32 s37, s3, 0x0
    buffer_load_dwordx4 v16, s[76:79], s37 offen lds
    s_add_u32 m0, s28, 1024
    s_add_u32 s37, s3, 0x8000
    buffer_load_dwordx4 v17, s[76:79], s37 offen lds
    s_add_u32 m0, s28, 2048
    s_add_u32 s37, s3, 0x10000
    buffer_load_dwordx4 v18, s[76:79], s37 offen lds
    s_add_u32 m0, s28, 3072
    s_add_u32 s37, s3, 0x18000
    buffer_load_dwordx4 v19, s[76:79], s37 offen lds
    s_add_u32 m0, s28, 4096
    s_add_u32 s37, s3, 0x20000
    buffer_load_dwordx4 v16, s[76:79], s37 offen lds
    s_add_u32 m0, s28, 5120
    s_add_u32 s37, s3, 0x28000
    buffer_load_dwordx4 v17, s[76:79], s37 offen lds
    s_add_u32 m0, s28, 6144
    s_add_u32 s37, s3, 0x30000
    buffer_load_dwordx4 v18, s[76:79], s37 offen lds
    s_add_u32 m0, s28, 7168
    s_add_u32 s37, s3, 0x38000
    buffer_load_dwordx4 v19, s[76:79], s37 offen lds
    s_add_u32 m0, s28, 8192
    s_add_u32 s37, s3, 0x100000
    buffer_load_dwordx4 v16, s[76:79], s37 offen lds
    s_add_u32 m0, s28, 9216
    s_add_u32 s37, s3, 0x108000
    buffer_load_dwordx4 v17, s[76:79], s37 offen lds
    s_add_u32 m0, s28, 10240
    s_add_u32 s37, s3, 0x110000
    buffer_load_dwordx4 v18, s[76:79], s37 offen lds
    s_add_u32 m0, s28, 11264
    s_add_u32 s37, s3, 0x118000
    buffer_load_dwordx4 v19, s[76:79], s37 offen lds
    s_add_u32 m0, s28, 12288
    s_add_u32 s37, s3, 0x120000
    buffer_load_dwordx4 v16, s[76:79], s37 offen lds
    s_add_u32 m0, s28, 13312
    s_add_u32 s37, s3, 0x128000
    buffer_load_dwordx4 v17, s[76:79], s37 offen lds
    s_add_u32 m0, s28, 14336
    s_add_u32 s37, s3, 0x130000
    buffer_load_dwordx4 v18, s[76:79], s37 offen lds
    s_add_u32 m0, s28, 15360
    s_add_u32 s37, s3, 0x138000
    buffer_load_dwordx4 v19, s[76:79], s37 offen lds
    s_add_u32 m0, s28, 16384
    s_add_u32 s37, s3, 0x200000
    buffer_load_dwordx4 v16, s[76:79], s37 offen lds
    s_add_u32 m0, s28, 17408
    s_add_u32 s37, s3, 0x208000
    buffer_load_dwordx4 v17, s[76:79], s37 offen lds
    s_add_u32 m0, s28, 18432
    s_add_u32 s37, s3, 0x210000
    buffer_load_dwordx4 v18, s[76:79], s37 offen lds
    s_add_u32 m0, s28, 19456
    s_add_u32 s37, s3, 0x218000
    buffer_load_dwordx4 v19, s[76:79], s37 offen lds
    s_add_u32 m0, s28, 20480
    s_add_u32 s37, s3, 0x220000
    buffer_load_dwordx4 v16, s[76:79], s37 offen lds
    s_add_u32 m0, s28, 21504
    s_add_u32 s37, s3, 0x228000
    buffer_load_dwordx4 v17, s[76:79], s37 offen lds
    s_add_u32 m0, s28, 22528
    s_add_u32 s37, s3, 0x230000
    buffer_load_dwordx4 v18, s[76:79], s37 offen lds
    s_add_u32 m0, s28, 23552
    s_add_u32 s37, s3, 0x238000
    buffer_load_dwordx4 v19, s[76:79], s37 offen lds
    s_add_u32 m0, s28, 24576
    s_add_u32 s37, s3, 0x300000
    buffer_load_dwordx4 v16, s[76:79], s37 offen lds
    s_add_u32 m0, s28, 25600
    s_add_u32 s37, s3, 0x308000
    buffer_load_dwordx4 v17, s[76:79], s37 offen lds
    s_add_u32 m0, s28, 26624
    s_add_u32 s37, s3, 0x310000
    buffer_load_dwordx4 v18, s[76:79], s37 offen lds
    s_add_u32 m0, s28, 27648
    s_add_u32 s37, s3, 0x318000
    buffer_load_dwordx4 v19, s[76:79], s37 offen lds
    s_add_u32 m0, s28, 28672
    s_add_u32 s37, s3, 0x320000
    buffer_load_dwordx4 v16, s[76:79], s37 offen lds
    s_add_u32 m0, s28, 29696
    s_add_u32 s37, s3, 0x328000
    buffer_load_dwordx4 v17, s[76:79], s37 offen lds
    s_add_u32 m0, s28, 30720
    s_add_u32 s37, s3, 0x330000
    buffer_load_dwordx4 v18, s[76:79], s37 offen lds
    s_add_u32 m0, s28, 31744
    s_add_u32 s37, s3, 0x338000
    buffer_load_dwordx4 v19, s[76:79], s37 offen lds
    v_mov_b32 v20, 0x0
    v_bfe_u32 v14, v0, 0, 1
    s_mov_b32 s38, 0x8
    v_mad_u32_u24 v20, v14, s38, v20
    v_bfe_u32 v14, v0, 1, 1
    s_mov_b32 s38, 0x10
    v_mad_u32_u24 v20, v14, s38, v20
    v_bfe_u32 v14, v0, 2, 1
    s_mov_b32 s38, 0x100
    v_mad_u32_u24 v20, v14, s38, v20
    v_bfe_u32 v14, v0, 3, 1
    s_mov_b32 s38, 0x200
    v_mad_u32_u24 v20, v14, s38, v20
    v_bfe_u32 v14, v0, 4, 1
    s_mov_b32 s38, 0x800
    v_mad_u32_u24 v20, v14, s38, v20
    v_bfe_u32 v14, v0, 5, 1
    s_mov_b32 s38, 0x1000
    v_mad_u32_u24 v20, v14, s38, v20
    v_mov_b32 v28, 0x0
    v_bfe_u32 v14, v0, 2, 1
    s_mov_b32 s38, 0x20
    v_mad_u32_u24 v28, v14, s38, v28
    v_bfe_u32 v14, v0, 3, 1
    s_mov_b32 s38, 0x40
    v_mad_u32_u24 v28, v14, s38, v28
    v_bfe_u32 v14, v0, 4, 1
    s_mov_b32 s38, 0x80
    v_mad_u32_u24 v28, v14, s38, v28
    v_mov_b32 v29, 0x0
    v_bfe_u32 v14, v0, 6, 1
    s_mov_b32 s38, 0x40
    v_mad_u32_u24 v29, v14, s38, v29
    v_bfe_u32 v14, v0, 7, 1
    s_mov_b32 s38, 0x80
    v_mad_u32_u24 v29, v14, s38, v29
    v_xor_b32 v28, v28, v29
    v_add_u32 v28, v28, v20
    v_add_u32 v20, 0x8000, v28
    v_xor_b32 v21, 32, v20
    v_add_u32 v22, 0x10000, v28
    v_xor_b32 v23, 32, v22
    v_add_u32 v24, 0x18000, v28
    v_xor_b32 v25, 32, v24
    v_add_u32 v26, 0x20000, v28
    v_xor_b32 v27, 32, v26
    s_mov_b32 s12, s54
    s_and_b32 s13, s55, 0xffff
    s_mov_b32 s14, 0x400000
    s_mov_b32 s15, 0x20000
    s_lshl_b32 s24, s20, 17
    s_and_b32 s25, s22, 3
    s_lshl_b32 s25, s25, 15
    s_add_u32 s24, s24, s25
    v_lshlrev_b32 v30, 7, v0
    buffer_load_dword v31, v30, s[12:15], s24 offen
    s_mov_b32 s12, s44
    s_and_b32 s13, s45, 0xffff
    s_mov_b32 s14, 0x200000
    s_mov_b32 s15, 0x20000
    s_mov_b32 s60, s82
    s_and_b32 s61, s83, 0xffff
    s_mov_b32 s62, 0x200000
    s_mov_b32 s63, 0x20000
    s_mov_b32 s92, s80
    s_and_b32 s93, s81, 0xffff
    s_mov_b32 s94, 0x400
    s_mov_b32 s95, 0x20000
    v_mov_b32 v1, 0x0
    v_bfe_u32 v14, v0, 0, 1
    s_mov_b32 s38, 0x10
    v_mad_u32_u24 v1, v14, s38, v1
    v_bfe_u32 v14, v0, 1, 1
    s_mov_b32 s38, 0x20
    v_mad_u32_u24 v1, v14, s38, v1
    v_bfe_u32 v14, v0, 2, 1
    s_mov_b32 s38, 0x40
    v_mad_u32_u24 v1, v14, s38, v1
    v_bfe_u32 v14, v0, 3, 1
    s_mov_b32 s38, 0x80
    v_mad_u32_u24 v1, v14, s38, v1
    v_bfe_u32 v14, v0, 4, 1
    s_mov_b32 s38, 0x100
    v_mad_u32_u24 v1, v14, s38, v1
    v_bfe_u32 v14, v0, 5, 1
    s_mov_b32 s38, 0x200
    v_mad_u32_u24 v1, v14, s38, v1
    v_mov_b32 v2, 0x0
    v_bfe_u32 v14, v0, 0, 1
    s_mov_b32 s38, 0x10
    v_mad_u32_u24 v2, v14, s38, v2
    v_bfe_u32 v14, v0, 1, 1
    s_mov_b32 s38, 0x20
    v_mad_u32_u24 v2, v14, s38, v2
    v_bfe_u32 v14, v0, 2, 1
    s_mov_b32 s38, 0x40
    v_mad_u32_u24 v2, v14, s38, v2
    v_bfe_u32 v14, v0, 3, 1
    s_mov_b32 s38, 0x80
    v_mad_u32_u24 v2, v14, s38, v2
    v_bfe_u32 v14, v0, 4, 1
    s_mov_b32 s38, 0x100
    v_mad_u32_u24 v2, v14, s38, v2
    v_bfe_u32 v14, v0, 5, 1
    s_mov_b32 s38, 0x200
    v_mad_u32_u24 v2, v14, s38, v2
    v_bfe_u32 v14, v0, 6, 1
    s_mov_b32 s38, 0x800
    v_mad_u32_u24 v2, v14, s38, v2
    v_bfe_u32 v14, v0, 7, 1
    s_mov_b32 s38, 0x1000
    v_mad_u32_u24 v2, v14, s38, v2
    v_mov_b32 v9, 0x0
    v_bfe_u32 v14, v0, 0, 1
    s_mov_b32 s38, 0x10
    v_mad_u32_u24 v9, v14, s38, v9
    v_bfe_u32 v14, v0, 1, 1
    s_mov_b32 s38, 0x20
    v_mad_u32_u24 v9, v14, s38, v9
    v_bfe_u32 v14, v0, 2, 1
    s_mov_b32 s38, 0x40
    v_mad_u32_u24 v9, v14, s38, v9
    v_bfe_u32 v14, v0, 3, 1
    s_mov_b32 s38, 0x80
    v_mad_u32_u24 v9, v14, s38, v9
    v_bfe_u32 v14, v0, 4, 1
    s_mov_b32 s38, 0x100
    v_mad_u32_u24 v9, v14, s38, v9
    v_bfe_u32 v14, v0, 5, 1
    s_mov_b32 s38, 0x200
    v_mad_u32_u24 v9, v14, s38, v9
    v_bfe_u32 v14, v0, 6, 1
    s_mov_b32 s38, 0x400
    v_mad_u32_u24 v9, v14, s38, v9
    v_bfe_u32 v14, v0, 7, 1
    s_mov_b32 s38, 0x800
    v_mad_u32_u24 v9, v14, s38, v9
    v_mov_b32 v7, 0x8000
    v_bfe_u32 v14, v0, 0, 1
    s_mov_b32 s38, 0x10
    v_mad_u32_u24 v7, v14, s38, v7
    v_bfe_u32 v14, v0, 1, 1
    s_mov_b32 s38, 0x20
    v_mad_u32_u24 v7, v14, s38, v7
    v_bfe_u32 v14, v0, 2, 1
    s_mov_b32 s38, 0x40
    v_mad_u32_u24 v7, v14, s38, v7
    v_bfe_u32 v14, v0, 3, 1
    s_mov_b32 s38, 0x80
    v_mad_u32_u24 v7, v14, s38, v7
    v_bfe_u32 v14, v0, 4, 1
    s_mov_b32 s38, 0x100
    v_mad_u32_u24 v7, v14, s38, v7
    v_bfe_u32 v14, v0, 5, 1
    s_mov_b32 s38, 0x200
    v_mad_u32_u24 v7, v14, s38, v7
    v_bfe_u32 v14, v0, 6, 1
    s_mov_b32 s38, 0x8000
    v_mad_u32_u24 v7, v14, s38, v7
    v_bfe_u32 v14, v0, 7, 1
    s_mov_b32 s38, 0x10000
    v_mad_u32_u24 v7, v14, s38, v7
    v_mov_b32 v3, 0x0
    v_bfe_u32 v14, v0, 0, 1
    s_mov_b32 s38, 0x10
    v_mad_u32_u24 v3, v14, s38, v3
    v_bfe_u32 v14, v0, 1, 1
    s_mov_b32 s38, 0x20
    v_mad_u32_u24 v3, v14, s38, v3
    v_bfe_u32 v14, v0, 2, 1
    s_mov_b32 s38, 0x40
    v_mad_u32_u24 v3, v14, s38, v3
    v_bfe_u32 v14, v0, 3, 1
    s_mov_b32 s38, 0x400
    v_mad_u32_u24 v3, v14, s38, v3
    v_bfe_u32 v14, v0, 4, 1
    s_mov_b32 s38, 0x800
    v_mad_u32_u24 v3, v14, s38, v3
    v_bfe_u32 v14, v0, 5, 1
    s_mov_b32 s38, 0x1000
    v_mad_u32_u24 v3, v14, s38, v3
    v_bfe_u32 v14, v0, 6, 1
    s_mov_b32 s38, 0x2000
    v_mad_u32_u24 v3, v14, s38, v3
    v_bfe_u32 v14, v0, 7, 1
    s_mov_b32 s38, 0x4000
    v_mad_u32_u24 v3, v14, s38, v3
    v_mov_b32 v4, 0x0
    v_bfe_u32 v14, v0, 0, 1
    s_mov_b32 s38, 0x100
    v_mad_u32_u24 v4, v14, s38, v4
    v_bfe_u32 v14, v0, 1, 1
    s_mov_b32 s38, 0x200
    v_mad_u32_u24 v4, v14, s38, v4
    v_bfe_u32 v14, v0, 2, 1
    s_mov_b32 s38, 0x400
    v_mad_u32_u24 v4, v14, s38, v4
    v_bfe_u32 v14, v0, 6, 1
    s_mov_b32 s38, 0x80
    v_mad_u32_u24 v4, v14, s38, v4
    v_bfe_u32 v14, v0, 7, 1
    s_mov_b32 s38, 0x4000
    v_mad_u32_u24 v4, v14, s38, v4
    v_lshrrev_b32 v15, 3, v0
    v_xor_b32 v15, v15, v0
    v_and_b32 v15, 7, v15
    v_lshl_add_u32 v4, v15, 4, v4
    v_bfe_u32 v15, v0, 4, 2
    v_lshlrev_b32 v15, 4, v15
    v_xor_b32 v5, v15, v1
    v_xor_b32 v6, 64, v5
    v_mov_b32 v8, 0x5000
    v_bfe_u32 v14, v0, 0, 1
    s_mov_b32 s38, 0x10
    v_mad_u32_u24 v8, v14, s38, v8
    v_bfe_u32 v14, v0, 1, 1
    s_mov_b32 s38, 0x40
    v_mad_u32_u24 v8, v14, s38, v8
    v_bfe_u32 v14, v0, 2, 1
    s_mov_b32 s38, 0x80
    v_mad_u32_u24 v8, v14, s38, v8
    v_bfe_u32 v14, v0, 4, 1
    s_mov_b32 s38, 0x20
    v_mad_u32_u24 v8, v14, s38, v8
    v_bfe_u32 v14, v0, 5, 1
    s_mov_b32 s38, 0x100
    v_mad_u32_u24 v8, v14, s38, v8
    v_mov_b32 v10, 0x0
    v_bfe_u32 v14, v0, 0, 1
    s_mov_b32 s38, 0x10
    v_mad_u32_u24 v10, v14, s38, v10
    v_bfe_u32 v14, v0, 1, 1
    s_mov_b32 s38, 0x20
    v_mad_u32_u24 v10, v14, s38, v10
    v_bfe_u32 v14, v0, 2, 1
    s_mov_b32 s38, 0x40
    v_mad_u32_u24 v10, v14, s38, v10
    v_bfe_u32 v14, v0, 3, 1
    s_mov_b32 s38, 0x80
    v_mad_u32_u24 v10, v14, s38, v10
    v_bfe_u32 v14, v0, 4, 1
    s_mov_b32 s38, 0x20000
    v_mad_u32_u24 v10, v14, s38, v10
    v_bfe_u32 v14, v0, 5, 1
    s_mov_b32 s38, 0x40000
    v_mad_u32_u24 v10, v14, s38, v10
    v_bfe_u32 v14, v0, 6, 1
    s_mov_b32 s38, 0x100
    v_mad_u32_u24 v10, v14, s38, v10
    v_bfe_u32 v14, v0, 7, 1
    s_mov_b32 s38, 0x200
    v_mad_u32_u24 v10, v14, s38, v10
    v_mov_b32 v11, 0x0
    v_bfe_u32 v14, v0, 0, 1
    s_mov_b32 s38, 0x10
    v_mad_u32_u24 v11, v14, s38, v11
    v_bfe_u32 v14, v0, 1, 1
    s_mov_b32 s38, 0x20
    v_mad_u32_u24 v11, v14, s38, v11
    v_bfe_u32 v14, v0, 2, 1
    s_mov_b32 s38, 0x40
    v_mad_u32_u24 v11, v14, s38, v11
    v_bfe_u32 v14, v0, 3, 1
    s_mov_b32 s38, 0x80
    v_mad_u32_u24 v11, v14, s38, v11
    v_bfe_u32 v14, v0, 4, 1
    s_mov_b32 s38, 0x400
    v_mad_u32_u24 v11, v14, s38, v11
    v_bfe_u32 v14, v0, 5, 1
    s_mov_b32 s38, 0x800
    v_mad_u32_u24 v11, v14, s38, v11
    v_bfe_u32 v14, v0, 6, 1
    s_mov_b32 s38, 0x100
    v_mad_u32_u24 v11, v14, s38, v11
    v_bfe_u32 v14, v0, 7, 1
    s_mov_b32 s38, 0x200
    v_mad_u32_u24 v11, v14, s38, v11
    v_mov_b32 v12, 0x0
    v_bfe_u32 v14, v0, 0, 1
    s_mov_b32 s38, 0x10
    v_mad_u32_u24 v12, v14, s38, v12
    v_bfe_u32 v14, v0, 1, 1
    s_mov_b32 s38, 0x20
    v_mad_u32_u24 v12, v14, s38, v12
    v_bfe_u32 v14, v0, 2, 1
    s_mov_b32 s38, 0x40
    v_mad_u32_u24 v12, v14, s38, v12
    v_bfe_u32 v14, v0, 3, 1
    s_mov_b32 s38, 0x80
    v_mad_u32_u24 v12, v14, s38, v12
    v_bfe_u32 v14, v0, 4, 1
    s_mov_b32 s38, 0x4
    v_mad_u32_u24 v12, v14, s38, v12
    v_bfe_u32 v14, v0, 5, 1
    s_mov_b32 s38, 0x8
    v_mad_u32_u24 v12, v14, s38, v12
    v_bfe_u32 v14, v0, 6, 1
    s_mov_b32 s38, 0x100
    v_mad_u32_u24 v12, v14, s38, v12
    v_bfe_u32 v14, v0, 7, 1
    s_mov_b32 s38, 0x200
    v_mad_u32_u24 v12, v14, s38, v12
    v_mov_b32 v13, 0xf149f2ca
    v_and_b32 v14, 15, v0
    v_bfe_u32 v15, v0, 4, 2
    v_cmp_gt_u32 s[72:73], 2, v15
    v_lshlrev_b32 v15, 2, v15
    v_cmp_le_u32 s[64:65], v15, v14
    v_add_u32 v15, 1, v15
    v_cmp_le_u32 s[66:67], v15, v14
    v_add_u32 v15, 1, v15
    v_cmp_le_u32 s[68:69], v15, v14
    v_add_u32 v15, 1, v15
    v_cmp_le_u32 s[70:71], v15, v14
    v_add_u32 v15, 1, v15
    s_mov_b32 s34, 0x05040100
    s_mov_b32 s35, 0x07060302
    s_mov_b32 s33, 0x3e0293ee
    s_mov_b32 s32, 0
    s_mov_b32 s4, 0x3f803f80
    s_mov_b32 s5, 0x3f803f80
    s_mov_b32 s23, s22
    s_lshl_b32 s36, s23, 15
    buffer_load_dwordx4 v[96:99], v3, s[12:15], s36 offen offset:0
    buffer_load_dwordx4 v[100:103], v3, s[12:15], s36 offen offset:128
    buffer_load_dwordx4 v[104:107], v3, s[12:15], s36 offen offset:256
    buffer_load_dwordx4 v[108:111], v3, s[12:15], s36 offen offset:384
    buffer_load_dwordx4 v[112:115], v3, s[12:15], s36 offen offset:512
    buffer_load_dwordx4 v[116:119], v3, s[12:15], s36 offen offset:640
    buffer_load_dwordx4 v[120:123], v3, s[12:15], s36 offen offset:768
    buffer_load_dwordx4 v[124:127], v3, s[12:15], s36 offen offset:896
    s_waitcnt vmcnt(33)
    s_barrier
    ds_read_b64_tr_b16 v[128:129], v20 offset:0
    ds_read_b64_tr_b16 v[130:131], v20 offset:1024
    ds_read_b64_tr_b16 v[132:133], v21 offset:0
    ds_read_b64_tr_b16 v[134:135], v21 offset:1024
    ds_read_b64_tr_b16 v[136:137], v22 offset:0
    ds_read_b64_tr_b16 v[138:139], v22 offset:1024
    ds_read_b64_tr_b16 v[140:141], v23 offset:0
    ds_read_b64_tr_b16 v[142:143], v23 offset:1024
    ds_read_b64_tr_b16 v[144:145], v24 offset:0
    ds_read_b64_tr_b16 v[146:147], v24 offset:1024
    ds_read_b64_tr_b16 v[148:149], v25 offset:0
    ds_read_b64_tr_b16 v[150:151], v25 offset:1024
    s_waitcnt lgkmcnt(4)
    ds_read_b64_tr_b16 v[152:153], v26 offset:0
    ds_read_b64_tr_b16 v[154:155], v26 offset:1024
    ds_read_b64_tr_b16 v[156:157], v27 offset:0
    ds_read_b64_tr_b16 v[158:159], v27 offset:1024
    s_waitcnt lgkmcnt(0)
    s_barrier
    s_mov_b32 s40, s50
    s_and_b32 s41, s51, 0xffff
    s_mov_b32 s42, 0x400000
    s_mov_b32 s43, 0x20000
    s_add_u32 m0, s28, 0
    s_add_u32 s37, s3, 0x0
    buffer_load_dwordx4 v16, s[40:43], s37 offen lds
    s_add_u32 m0, s28, 1024
    s_add_u32 s37, s3, 0x8000
    buffer_load_dwordx4 v17, s[40:43], s37 offen lds
    s_add_u32 m0, s28, 2048
    s_add_u32 s37, s3, 0x10000
    buffer_load_dwordx4 v18, s[40:43], s37 offen lds
    s_add_u32 m0, s28, 3072
    s_add_u32 s37, s3, 0x18000
    buffer_load_dwordx4 v19, s[40:43], s37 offen lds
    s_add_u32 m0, s28, 4096
    s_add_u32 s37, s3, 0x20000
    buffer_load_dwordx4 v16, s[40:43], s37 offen lds
    s_add_u32 m0, s28, 5120
    s_add_u32 s37, s3, 0x28000
    buffer_load_dwordx4 v17, s[40:43], s37 offen lds
    s_add_u32 m0, s28, 6144
    s_add_u32 s37, s3, 0x30000
    buffer_load_dwordx4 v18, s[40:43], s37 offen lds
    s_add_u32 m0, s28, 7168
    s_add_u32 s37, s3, 0x38000
    buffer_load_dwordx4 v19, s[40:43], s37 offen lds
    s_waitcnt vmcnt(33)
    s_barrier
    ds_read_b64_tr_b16 v[160:161], v20 offset:8192
    ds_read_b64_tr_b16 v[162:163], v20 offset:9216
    ds_read_b64_tr_b16 v[164:165], v21 offset:8192
    ds_read_b64_tr_b16 v[166:167], v21 offset:9216
    ds_read_b64_tr_b16 v[168:169], v22 offset:8192
    ds_read_b64_tr_b16 v[170:171], v22 offset:9216
    ds_read_b64_tr_b16 v[172:173], v23 offset:8192
    ds_read_b64_tr_b16 v[174:175], v23 offset:9216
    ds_read_b64_tr_b16 v[176:177], v24 offset:8192
    ds_read_b64_tr_b16 v[178:179], v24 offset:9216
    ds_read_b64_tr_b16 v[180:181], v25 offset:8192
    ds_read_b64_tr_b16 v[182:183], v25 offset:9216
    s_waitcnt lgkmcnt(4)
    ds_read_b64_tr_b16 v[184:185], v26 offset:8192
    ds_read_b64_tr_b16 v[186:187], v26 offset:9216
    ds_read_b64_tr_b16 v[188:189], v27 offset:8192
    ds_read_b64_tr_b16 v[190:191], v27 offset:9216
    s_waitcnt lgkmcnt(0)
    s_barrier
    s_add_u32 m0, s28, 8192
    s_add_u32 s37, s3, 0x100000
    buffer_load_dwordx4 v16, s[40:43], s37 offen lds
    s_add_u32 m0, s28, 9216
    s_add_u32 s37, s3, 0x108000
    buffer_load_dwordx4 v17, s[40:43], s37 offen lds
    s_add_u32 m0, s28, 10240
    s_add_u32 s37, s3, 0x110000
    buffer_load_dwordx4 v18, s[40:43], s37 offen lds
    s_add_u32 m0, s28, 11264
    s_add_u32 s37, s3, 0x118000
    buffer_load_dwordx4 v19, s[40:43], s37 offen lds
    s_add_u32 m0, s28, 12288
    s_add_u32 s37, s3, 0x120000
    buffer_load_dwordx4 v16, s[40:43], s37 offen lds
    s_add_u32 m0, s28, 13312
    s_add_u32 s37, s3, 0x128000
    buffer_load_dwordx4 v17, s[40:43], s37 offen lds
    s_add_u32 m0, s28, 14336
    s_add_u32 s37, s3, 0x130000
    buffer_load_dwordx4 v18, s[40:43], s37 offen lds
    s_add_u32 m0, s28, 15360
    s_add_u32 s37, s3, 0x138000
    buffer_load_dwordx4 v19, s[40:43], s37 offen lds
    s_waitcnt vmcnt(33)
    s_barrier
    ds_read_b64_tr_b16 v[192:193], v20 offset:16384
    ds_read_b64_tr_b16 v[194:195], v20 offset:17408
    ds_read_b64_tr_b16 v[196:197], v21 offset:16384
    ds_read_b64_tr_b16 v[198:199], v21 offset:17408
    ds_read_b64_tr_b16 v[200:201], v22 offset:16384
    ds_read_b64_tr_b16 v[202:203], v22 offset:17408
    ds_read_b64_tr_b16 v[204:205], v23 offset:16384
    ds_read_b64_tr_b16 v[206:207], v23 offset:17408
    ds_read_b64_tr_b16 v[208:209], v24 offset:16384
    ds_read_b64_tr_b16 v[210:211], v24 offset:17408
    ds_read_b64_tr_b16 v[212:213], v25 offset:16384
    ds_read_b64_tr_b16 v[214:215], v25 offset:17408
    s_waitcnt lgkmcnt(4)
    ds_read_b64_tr_b16 v[216:217], v26 offset:16384
    ds_read_b64_tr_b16 v[218:219], v26 offset:17408
    ds_read_b64_tr_b16 v[220:221], v27 offset:16384
    ds_read_b64_tr_b16 v[222:223], v27 offset:17408
    s_waitcnt lgkmcnt(0)
    s_barrier
    s_add_u32 m0, s28, 16384
    s_add_u32 s37, s3, 0x200000
    buffer_load_dwordx4 v16, s[40:43], s37 offen lds
    s_add_u32 m0, s28, 17408
    s_add_u32 s37, s3, 0x208000
    buffer_load_dwordx4 v17, s[40:43], s37 offen lds
    s_add_u32 m0, s28, 18432
    s_add_u32 s37, s3, 0x210000
    buffer_load_dwordx4 v18, s[40:43], s37 offen lds
    s_add_u32 m0, s28, 19456
    s_add_u32 s37, s3, 0x218000
    buffer_load_dwordx4 v19, s[40:43], s37 offen lds
    s_add_u32 m0, s28, 20480
    s_add_u32 s37, s3, 0x220000
    buffer_load_dwordx4 v16, s[40:43], s37 offen lds
    s_add_u32 m0, s28, 21504
    s_add_u32 s37, s3, 0x228000
    buffer_load_dwordx4 v17, s[40:43], s37 offen lds
    s_add_u32 m0, s28, 22528
    s_add_u32 s37, s3, 0x230000
    buffer_load_dwordx4 v18, s[40:43], s37 offen lds
    s_add_u32 m0, s28, 23552
    s_add_u32 s37, s3, 0x238000
    buffer_load_dwordx4 v19, s[40:43], s37 offen lds
    s_waitcnt vmcnt(33)
    s_barrier
    ds_read_b64_tr_b16 v[224:225], v20 offset:24576
    ds_read_b64_tr_b16 v[226:227], v20 offset:25600
    ds_read_b64_tr_b16 v[228:229], v21 offset:24576
    ds_read_b64_tr_b16 v[230:231], v21 offset:25600
    ds_read_b64_tr_b16 v[232:233], v22 offset:24576
    ds_read_b64_tr_b16 v[234:235], v22 offset:25600
    ds_read_b64_tr_b16 v[236:237], v23 offset:24576
    ds_read_b64_tr_b16 v[238:239], v23 offset:25600
    ds_read_b64_tr_b16 v[240:241], v24 offset:24576
    ds_read_b64_tr_b16 v[242:243], v24 offset:25600
    ds_read_b64_tr_b16 v[244:245], v25 offset:24576
    ds_read_b64_tr_b16 v[246:247], v25 offset:25600
    s_waitcnt lgkmcnt(4)
    ds_read_b64_tr_b16 v[248:249], v26 offset:24576
    ds_read_b64_tr_b16 v[250:251], v26 offset:25600
    ds_read_b64_tr_b16 v[252:253], v27 offset:24576
    ds_read_b64_tr_b16 v[254:255], v27 offset:25600
    s_waitcnt lgkmcnt(0)
    s_barrier
    s_add_u32 m0, s28, 24576
    s_add_u32 s37, s3, 0x300000
    buffer_load_dwordx4 v16, s[40:43], s37 offen lds
    s_add_u32 m0, s28, 25600
    s_add_u32 s37, s3, 0x308000
    buffer_load_dwordx4 v17, s[40:43], s37 offen lds
    s_add_u32 m0, s28, 26624
    s_add_u32 s37, s3, 0x310000
    buffer_load_dwordx4 v18, s[40:43], s37 offen lds
    s_add_u32 m0, s28, 27648
    s_add_u32 s37, s3, 0x318000
    buffer_load_dwordx4 v19, s[40:43], s37 offen lds
    s_add_u32 m0, s28, 28672
    s_add_u32 s37, s3, 0x320000
    buffer_load_dwordx4 v16, s[40:43], s37 offen lds
    s_add_u32 m0, s28, 29696
    s_add_u32 s37, s3, 0x328000
    buffer_load_dwordx4 v17, s[40:43], s37 offen lds
    s_add_u32 m0, s28, 30720
    s_add_u32 s37, s3, 0x330000
    buffer_load_dwordx4 v18, s[40:43], s37 offen lds
    s_add_u32 m0, s28, 31744
    s_add_u32 s37, s3, 0x338000
    buffer_load_dwordx4 v19, s[40:43], s37 offen lds
    s_waitcnt vmcnt(32)
    v_mov_b32 v88, 0
    v_mov_b32 v89, 0
    v_dot2_f32_bf16 v88, v96, s4, v88
    v_dot2_f32_bf16 v89, v96, v96, v89
    v_dot2_f32_bf16 v88, v97, s4, v88
    v_dot2_f32_bf16 v89, v97, v97, v89
    v_dot2_f32_bf16 v88, v98, s4, v88
    v_dot2_f32_bf16 v89, v98, v98, v89
    v_dot2_f32_bf16 v88, v99, s4, v88
    v_dot2_f32_bf16 v89, v99, v99, v89
    v_dot2_f32_bf16 v88, v100, s4, v88
    v_dot2_f32_bf16 v89, v100, v100, v89
    v_dot2_f32_bf16 v88, v101, s4, v88
    v_dot2_f32_bf16 v89, v101, v101, v89
    v_dot2_f32_bf16 v88, v102, s4, v88
    v_dot2_f32_bf16 v89, v102, v102, v89
    v_dot2_f32_bf16 v88, v103, s4, v88
    v_dot2_f32_bf16 v89, v103, v103, v89
    v_dot2_f32_bf16 v88, v104, s4, v88
    v_dot2_f32_bf16 v89, v104, v104, v89
    v_dot2_f32_bf16 v88, v105, s4, v88
    v_dot2_f32_bf16 v89, v105, v105, v89
    v_dot2_f32_bf16 v88, v106, s4, v88
    v_dot2_f32_bf16 v89, v106, v106, v89
    v_dot2_f32_bf16 v88, v107, s4, v88
    v_dot2_f32_bf16 v89, v107, v107, v89
    v_dot2_f32_bf16 v88, v108, s4, v88
    v_dot2_f32_bf16 v89, v108, v108, v89
    v_dot2_f32_bf16 v88, v109, s4, v88
    v_dot2_f32_bf16 v89, v109, v109, v89
    v_dot2_f32_bf16 v88, v110, s4, v88
    v_dot2_f32_bf16 v89, v110, v110, v89
    v_dot2_f32_bf16 v88, v111, s4, v88
    v_dot2_f32_bf16 v89, v111, v111, v89
    v_dot2_f32_bf16 v88, v112, s4, v88
    v_dot2_f32_bf16 v89, v112, v112, v89
    v_dot2_f32_bf16 v88, v113, s4, v88
    v_dot2_f32_bf16 v89, v113, v113, v89
    v_dot2_f32_bf16 v88, v114, s4, v88
    v_dot2_f32_bf16 v89, v114, v114, v89
    v_dot2_f32_bf16 v88, v115, s4, v88
    v_dot2_f32_bf16 v89, v115, v115, v89
    v_dot2_f32_bf16 v88, v116, s4, v88
    v_dot2_f32_bf16 v89, v116, v116, v89
    v_dot2_f32_bf16 v88, v117, s4, v88
    v_dot2_f32_bf16 v89, v117, v117, v89
    v_dot2_f32_bf16 v88, v118, s4, v88
    v_dot2_f32_bf16 v89, v118, v118, v89
    v_dot2_f32_bf16 v88, v119, s4, v88
    v_dot2_f32_bf16 v89, v119, v119, v89
    v_dot2_f32_bf16 v88, v120, s4, v88
    v_dot2_f32_bf16 v89, v120, v120, v89
    v_dot2_f32_bf16 v88, v121, s4, v88
    v_dot2_f32_bf16 v89, v121, v121, v89
    v_dot2_f32_bf16 v88, v122, s4, v88
    v_dot2_f32_bf16 v89, v122, v122, v89
    v_dot2_f32_bf16 v88, v123, s4, v88
    v_dot2_f32_bf16 v89, v123, v123, v89
    v_dot2_f32_bf16 v88, v124, s4, v88
    v_dot2_f32_bf16 v89, v124, v124, v89
    v_dot2_f32_bf16 v88, v125, s4, v88
    v_dot2_f32_bf16 v89, v125, v125, v89
    v_dot2_f32_bf16 v88, v126, s4, v88
    v_dot2_f32_bf16 v89, v126, v126, v89
    v_dot2_f32_bf16 v88, v127, s4, v88
    v_dot2_f32_bf16 v89, v127, v127, v89
    s_nop 3
    v_add_f32_dpp v88, v88, v88 quad_perm:[1,0,3,2] row_mask:0xf bank_mask:0xf
    v_add_f32_dpp v89, v89, v89 quad_perm:[1,0,3,2] row_mask:0xf bank_mask:0xf
    s_nop 0
    v_add_f32_dpp v88, v88, v88 quad_perm:[2,3,0,1] row_mask:0xf bank_mask:0xf
    v_add_f32_dpp v89, v89, v89 quad_perm:[2,3,0,1] row_mask:0xf bank_mask:0xf
    s_nop 0
    v_add_f32_dpp v88, v88, v88 row_half_mirror row_mask:0xf bank_mask:0xf
    v_add_f32_dpp v89, v89, v89 row_half_mirror row_mask:0xf bank_mask:0xf
    v_mul_f32 v88, 0x3b000000, v88
    v_mul_f32 v89, 0x3b000000, v89
    v_fma_f32 v89, -v88, v88, v89
    v_max_f32 v89, 0, v89
    v_cvt_pk_bf16_f32 v14, v88, v89
    v_lshlrev_b32 v88, 16, v14
    v_and_b32 v89, 0xffff0000, v14
    v_add_f32 v89, 0x3727c5ac, v89
    v_cvt_pk_bf16_f32 v14, v89, v89
    v_lshlrev_b32 v89, 16, v14
    v_sqrt_f32 v89, v89
    s_nop 0
    v_cvt_pk_bf16_f32 v14, v89, v89
    v_lshlrev_b32 v89, 16, v14
    v_rcp_f32 v89, v89
    v_lshlrev_b32 v90, 16, v96
    v_and_b32 v91, 0xffff0000, v96
    v_sub_f32 v90, v90, v88
    v_sub_f32 v91, v91, v88
    v_cvt_pk_bf16_f32 v96, v90, v91
    v_lshlrev_b32 v90, 16, v96
    v_and_b32 v91, 0xffff0000, v96
    v_mul_f32 v90, v90, v89
    v_mul_f32 v91, v91, v89
    v_cvt_pk_bf16_f32 v96, v90, v91
    v_lshlrev_b32 v90, 16, v97
    v_and_b32 v91, 0xffff0000, v97
    v_sub_f32 v90, v90, v88
    v_sub_f32 v91, v91, v88
    v_cvt_pk_bf16_f32 v97, v90, v91
    v_lshlrev_b32 v90, 16, v97
    v_and_b32 v91, 0xffff0000, v97
    v_mul_f32 v90, v90, v89
    v_mul_f32 v91, v91, v89
    v_cvt_pk_bf16_f32 v97, v90, v91
    v_lshlrev_b32 v90, 16, v98
    v_and_b32 v91, 0xffff0000, v98
    v_sub_f32 v90, v90, v88
    v_sub_f32 v91, v91, v88
    v_cvt_pk_bf16_f32 v98, v90, v91
    v_lshlrev_b32 v90, 16, v98
    v_and_b32 v91, 0xffff0000, v98
    v_mul_f32 v90, v90, v89
    v_mul_f32 v91, v91, v89
    v_cvt_pk_bf16_f32 v98, v90, v91
    v_lshlrev_b32 v90, 16, v99
    v_and_b32 v91, 0xffff0000, v99
    v_sub_f32 v90, v90, v88
    v_sub_f32 v91, v91, v88
    v_cvt_pk_bf16_f32 v99, v90, v91
    v_lshlrev_b32 v90, 16, v99
    v_and_b32 v91, 0xffff0000, v99
    v_mul_f32 v90, v90, v89
    v_mul_f32 v91, v91, v89
    v_cvt_pk_bf16_f32 v99, v90, v91
    ds_write_b128 v4, v[96:99] offset:0
    v_lshlrev_b32 v90, 16, v100
    v_and_b32 v91, 0xffff0000, v100
    v_sub_f32 v90, v90, v88
    v_sub_f32 v91, v91, v88
    v_cvt_pk_bf16_f32 v100, v90, v91
    v_lshlrev_b32 v90, 16, v100
    v_and_b32 v91, 0xffff0000, v100
    v_mul_f32 v90, v90, v89
    v_mul_f32 v91, v91, v89
    v_cvt_pk_bf16_f32 v100, v90, v91
    v_lshlrev_b32 v90, 16, v101
    v_and_b32 v91, 0xffff0000, v101
    v_sub_f32 v90, v90, v88
    v_sub_f32 v91, v91, v88
    v_cvt_pk_bf16_f32 v101, v90, v91
    v_lshlrev_b32 v90, 16, v101
    v_and_b32 v91, 0xffff0000, v101
    v_mul_f32 v90, v90, v89
    v_mul_f32 v91, v91, v89
    v_cvt_pk_bf16_f32 v101, v90, v91
    v_lshlrev_b32 v90, 16, v102
    v_and_b32 v91, 0xffff0000, v102
    v_sub_f32 v90, v90, v88
    v_sub_f32 v91, v91, v88
    v_cvt_pk_bf16_f32 v102, v90, v91
    v_lshlrev_b32 v90, 16, v102
    v_and_b32 v91, 0xffff0000, v102
    v_mul_f32 v90, v90, v89
    v_mul_f32 v91, v91, v89
    v_cvt_pk_bf16_f32 v102, v90, v91
    v_lshlrev_b32 v90, 16, v103
    v_and_b32 v91, 0xffff0000, v103
    v_sub_f32 v90, v90, v88
    v_sub_f32 v91, v91, v88
    v_cvt_pk_bf16_f32 v103, v90, v91
    v_lshlrev_b32 v90, 16, v103
    v_and_b32 v91, 0xffff0000, v103
    v_mul_f32 v90, v90, v89
    v_mul_f32 v91, v91, v89
    v_cvt_pk_bf16_f32 v103, v90, v91
    ds_write_b128 v4, v[100:103] offset:2048
    v_lshlrev_b32 v90, 16, v104
    v_and_b32 v91, 0xffff0000, v104
    v_sub_f32 v90, v90, v88
    v_sub_f32 v91, v91, v88
    v_cvt_pk_bf16_f32 v104, v90, v91
    v_lshlrev_b32 v90, 16, v104
    v_and_b32 v91, 0xffff0000, v104
    v_mul_f32 v90, v90, v89
    v_mul_f32 v91, v91, v89
    v_cvt_pk_bf16_f32 v104, v90, v91
    v_lshlrev_b32 v90, 16, v105
    v_and_b32 v91, 0xffff0000, v105
    v_sub_f32 v90, v90, v88
    v_sub_f32 v91, v91, v88
    v_cvt_pk_bf16_f32 v105, v90, v91
    v_lshlrev_b32 v90, 16, v105
    v_and_b32 v91, 0xffff0000, v105
    v_mul_f32 v90, v90, v89
    v_mul_f32 v91, v91, v89
    v_cvt_pk_bf16_f32 v105, v90, v91
    v_lshlrev_b32 v90, 16, v106
    v_and_b32 v91, 0xffff0000, v106
    v_sub_f32 v90, v90, v88
    v_sub_f32 v91, v91, v88
    v_cvt_pk_bf16_f32 v106, v90, v91
    v_lshlrev_b32 v90, 16, v106
    v_and_b32 v91, 0xffff0000, v106
    v_mul_f32 v90, v90, v89
    v_mul_f32 v91, v91, v89
    v_cvt_pk_bf16_f32 v106, v90, v91
    v_lshlrev_b32 v90, 16, v107
    v_and_b32 v91, 0xffff0000, v107
    v_sub_f32 v90, v90, v88
    v_sub_f32 v91, v91, v88
    v_cvt_pk_bf16_f32 v107, v90, v91
    v_lshlrev_b32 v90, 16, v107
    v_and_b32 v91, 0xffff0000, v107
    v_mul_f32 v90, v90, v89
    v_mul_f32 v91, v91, v89
    v_cvt_pk_bf16_f32 v107, v90, v91
    ds_write_b128 v4, v[104:107] offset:4096
    v_lshlrev_b32 v90, 16, v108
    v_and_b32 v91, 0xffff0000, v108
    v_sub_f32 v90, v90, v88
    v_sub_f32 v91, v91, v88
    v_cvt_pk_bf16_f32 v108, v90, v91
    v_lshlrev_b32 v90, 16, v108
    v_and_b32 v91, 0xffff0000, v108
    v_mul_f32 v90, v90, v89
    v_mul_f32 v91, v91, v89
    v_cvt_pk_bf16_f32 v108, v90, v91
    v_lshlrev_b32 v90, 16, v109
    v_and_b32 v91, 0xffff0000, v109
    v_sub_f32 v90, v90, v88
    v_sub_f32 v91, v91, v88
    v_cvt_pk_bf16_f32 v109, v90, v91
    v_lshlrev_b32 v90, 16, v109
    v_and_b32 v91, 0xffff0000, v109
    v_mul_f32 v90, v90, v89
    v_mul_f32 v91, v91, v89
    v_cvt_pk_bf16_f32 v109, v90, v91
    v_lshlrev_b32 v90, 16, v110
    v_and_b32 v91, 0xffff0000, v110
    v_sub_f32 v90, v90, v88
    v_sub_f32 v91, v91, v88
    v_cvt_pk_bf16_f32 v110, v90, v91
    v_lshlrev_b32 v90, 16, v110
    v_and_b32 v91, 0xffff0000, v110
    v_mul_f32 v90, v90, v89
    v_mul_f32 v91, v91, v89
    v_cvt_pk_bf16_f32 v110, v90, v91
    v_lshlrev_b32 v90, 16, v111
    v_and_b32 v91, 0xffff0000, v111
    v_sub_f32 v90, v90, v88
    v_sub_f32 v91, v91, v88
    v_cvt_pk_bf16_f32 v111, v90, v91
    v_lshlrev_b32 v90, 16, v111
    v_and_b32 v91, 0xffff0000, v111
    v_mul_f32 v90, v90, v89
    v_mul_f32 v91, v91, v89
    v_cvt_pk_bf16_f32 v111, v90, v91
    ds_write_b128 v4, v[108:111] offset:6144
    v_lshlrev_b32 v90, 16, v112
    v_and_b32 v91, 0xffff0000, v112
    v_sub_f32 v90, v90, v88
    v_sub_f32 v91, v91, v88
    v_cvt_pk_bf16_f32 v112, v90, v91
    v_lshlrev_b32 v90, 16, v112
    v_and_b32 v91, 0xffff0000, v112
    v_mul_f32 v90, v90, v89
    v_mul_f32 v91, v91, v89
    v_cvt_pk_bf16_f32 v112, v90, v91
    v_lshlrev_b32 v90, 16, v113
    v_and_b32 v91, 0xffff0000, v113
    v_sub_f32 v90, v90, v88
    v_sub_f32 v91, v91, v88
    v_cvt_pk_bf16_f32 v113, v90, v91
    v_lshlrev_b32 v90, 16, v113
    v_and_b32 v91, 0xffff0000, v113
    v_mul_f32 v90, v90, v89
    v_mul_f32 v91, v91, v89
    v_cvt_pk_bf16_f32 v113, v90, v91
    v_lshlrev_b32 v90, 16, v114
    v_and_b32 v91, 0xffff0000, v114
    v_sub_f32 v90, v90, v88
    v_sub_f32 v91, v91, v88
    v_cvt_pk_bf16_f32 v114, v90, v91
    v_lshlrev_b32 v90, 16, v114
    v_and_b32 v91, 0xffff0000, v114
    v_mul_f32 v90, v90, v89
    v_mul_f32 v91, v91, v89
    v_cvt_pk_bf16_f32 v114, v90, v91
    v_lshlrev_b32 v90, 16, v115
    v_and_b32 v91, 0xffff0000, v115
    v_sub_f32 v90, v90, v88
    v_sub_f32 v91, v91, v88
    v_cvt_pk_bf16_f32 v115, v90, v91
    v_lshlrev_b32 v90, 16, v115
    v_and_b32 v91, 0xffff0000, v115
    v_mul_f32 v90, v90, v89
    v_mul_f32 v91, v91, v89
    v_cvt_pk_bf16_f32 v115, v90, v91
    ds_write_b128 v4, v[112:115] offset:8192
    v_lshlrev_b32 v90, 16, v116
    v_and_b32 v91, 0xffff0000, v116
    v_sub_f32 v90, v90, v88
    v_sub_f32 v91, v91, v88
    v_cvt_pk_bf16_f32 v116, v90, v91
    v_lshlrev_b32 v90, 16, v116
    v_and_b32 v91, 0xffff0000, v116
    v_mul_f32 v90, v90, v89
    v_mul_f32 v91, v91, v89
    v_cvt_pk_bf16_f32 v116, v90, v91
    v_lshlrev_b32 v90, 16, v117
    v_and_b32 v91, 0xffff0000, v117
    v_sub_f32 v90, v90, v88
    v_sub_f32 v91, v91, v88
    v_cvt_pk_bf16_f32 v117, v90, v91
    v_lshlrev_b32 v90, 16, v117
    v_and_b32 v91, 0xffff0000, v117
    v_mul_f32 v90, v90, v89
    v_mul_f32 v91, v91, v89
    v_cvt_pk_bf16_f32 v117, v90, v91
    v_lshlrev_b32 v90, 16, v118
    v_and_b32 v91, 0xffff0000, v118
    v_sub_f32 v90, v90, v88
    v_sub_f32 v91, v91, v88
    v_cvt_pk_bf16_f32 v118, v90, v91
    v_lshlrev_b32 v90, 16, v118
    v_and_b32 v91, 0xffff0000, v118
    v_mul_f32 v90, v90, v89
    v_mul_f32 v91, v91, v89
    v_cvt_pk_bf16_f32 v118, v90, v91
    v_lshlrev_b32 v90, 16, v119
    v_and_b32 v91, 0xffff0000, v119
    v_sub_f32 v90, v90, v88
    v_sub_f32 v91, v91, v88
    v_cvt_pk_bf16_f32 v119, v90, v91
    v_lshlrev_b32 v90, 16, v119
    v_and_b32 v91, 0xffff0000, v119
    v_mul_f32 v90, v90, v89
    v_mul_f32 v91, v91, v89
    v_cvt_pk_bf16_f32 v119, v90, v91
    ds_write_b128 v4, v[116:119] offset:10240
    v_lshlrev_b32 v90, 16, v120
    v_and_b32 v91, 0xffff0000, v120
    v_sub_f32 v90, v90, v88
    v_sub_f32 v91, v91, v88
    v_cvt_pk_bf16_f32 v120, v90, v91
    v_lshlrev_b32 v90, 16, v120
    v_and_b32 v91, 0xffff0000, v120
    v_mul_f32 v90, v90, v89
    v_mul_f32 v91, v91, v89
    v_cvt_pk_bf16_f32 v120, v90, v91
    v_lshlrev_b32 v90, 16, v121
    v_and_b32 v91, 0xffff0000, v121
    v_sub_f32 v90, v90, v88
    v_sub_f32 v91, v91, v88
    v_cvt_pk_bf16_f32 v121, v90, v91
    v_lshlrev_b32 v90, 16, v121
    v_and_b32 v91, 0xffff0000, v121
    v_mul_f32 v90, v90, v89
    v_mul_f32 v91, v91, v89
    v_cvt_pk_bf16_f32 v121, v90, v91
    v_lshlrev_b32 v90, 16, v122
    v_and_b32 v91, 0xffff0000, v122
    v_sub_f32 v90, v90, v88
    v_sub_f32 v91, v91, v88
    v_cvt_pk_bf16_f32 v122, v90, v91
    v_lshlrev_b32 v90, 16, v122
    v_and_b32 v91, 0xffff0000, v122
    v_mul_f32 v90, v90, v89
    v_mul_f32 v91, v91, v89
    v_cvt_pk_bf16_f32 v122, v90, v91
    v_lshlrev_b32 v90, 16, v123
    v_and_b32 v91, 0xffff0000, v123
    v_sub_f32 v90, v90, v88
    v_sub_f32 v91, v91, v88
    v_cvt_pk_bf16_f32 v123, v90, v91
    v_lshlrev_b32 v90, 16, v123
    v_and_b32 v91, 0xffff0000, v123
    v_mul_f32 v90, v90, v89
    v_mul_f32 v91, v91, v89
    v_cvt_pk_bf16_f32 v123, v90, v91
    ds_write_b128 v4, v[120:123] offset:12288
    v_lshlrev_b32 v90, 16, v124
    v_and_b32 v91, 0xffff0000, v124
    v_sub_f32 v90, v90, v88
    v_sub_f32 v91, v91, v88
    v_cvt_pk_bf16_f32 v124, v90, v91
    v_lshlrev_b32 v90, 16, v124
    v_and_b32 v91, 0xffff0000, v124
    v_mul_f32 v90, v90, v89
    v_mul_f32 v91, v91, v89
    v_cvt_pk_bf16_f32 v124, v90, v91
    v_lshlrev_b32 v90, 16, v125
    v_and_b32 v91, 0xffff0000, v125
    v_sub_f32 v90, v90, v88
    v_sub_f32 v91, v91, v88
    v_cvt_pk_bf16_f32 v125, v90, v91
    v_lshlrev_b32 v90, 16, v125
    v_and_b32 v91, 0xffff0000, v125
    v_mul_f32 v90, v90, v89
    v_mul_f32 v91, v91, v89
    v_cvt_pk_bf16_f32 v125, v90, v91
    v_lshlrev_b32 v90, 16, v126
    v_and_b32 v91, 0xffff0000, v126
    v_sub_f32 v90, v90, v88
    v_sub_f32 v91, v91, v88
    v_cvt_pk_bf16_f32 v126, v90, v91
    v_lshlrev_b32 v90, 16, v126
    v_and_b32 v91, 0xffff0000, v126
    v_mul_f32 v90, v90, v89
    v_mul_f32 v91, v91, v89
    v_cvt_pk_bf16_f32 v126, v90, v91
    v_lshlrev_b32 v90, 16, v127
    v_and_b32 v91, 0xffff0000, v127
    v_sub_f32 v90, v90, v88
    v_sub_f32 v91, v91, v88
    v_cvt_pk_bf16_f32 v127, v90, v91
    v_lshlrev_b32 v90, 16, v127
    v_and_b32 v91, 0xffff0000, v127
    v_mul_f32 v90, v90, v89
    v_mul_f32 v91, v91, v89
    v_cvt_pk_bf16_f32 v127, v90, v91
    ds_write_b128 v4, v[124:127] offset:14336
    s_lshr_b32 s36, s21, 1
    s_lshl_b32 s36, s36, 14
    s_xor_b32 s37, s36, 16384
    v_add_u32 v80, s36, v5
    v_add_u32 v81, s37, v5
    v_add_u32 v82, s36, v6
    v_add_u32 v83, s37, v6
    s_mov_b32 s31, 0
    s_waitcnt vmcnt(24)
    s_barrier
    ds_read_b64_tr_b16 a[128:129], v20 offset:0
    ds_read_b64_tr_b16 a[130:131], v20 offset:1024
    ds_read_b64_tr_b16 a[132:133], v21 offset:0
    ds_read_b64_tr_b16 a[134:135], v21 offset:1024
    ds_read_b64_tr_b16 a[136:137], v22 offset:0
    ds_read_b64_tr_b16 a[138:139], v22 offset:1024
    ds_read_b64_tr_b16 a[140:141], v23 offset:0
    ds_read_b64_tr_b16 a[142:143], v23 offset:1024
    ds_read_b64_tr_b16 a[144:145], v24 offset:0
    ds_read_b64_tr_b16 a[146:147], v24 offset:1024
    ds_read_b64_tr_b16 a[148:149], v25 offset:0
    ds_read_b64_tr_b16 a[150:151], v25 offset:1024
    s_waitcnt lgkmcnt(4)
    ds_read_b64_tr_b16 a[152:153], v26 offset:0
    ds_read_b64_tr_b16 a[154:155], v26 offset:1024
    ds_read_b64_tr_b16 a[156:157], v27 offset:0
    ds_read_b64_tr_b16 a[158:159], v27 offset:1024
    s_waitcnt lgkmcnt(0)
    s_barrier
    s_mov_b32 s96, s48
    s_and_b32 s97, s49, 0xffff
    s_mov_b32 s98, 0x400000
    s_mov_b32 s99, 0x20000
    s_add_u32 m0, s28, 0
    s_add_u32 s37, s3, 0x0
    buffer_load_dwordx4 v16, s[96:99], s37 offen lds
    s_add_u32 m0, s28, 1024
    s_add_u32 s37, s3, 0x8000
    buffer_load_dwordx4 v17, s[96:99], s37 offen lds
    s_add_u32 m0, s28, 2048
    s_add_u32 s37, s3, 0x10000
    buffer_load_dwordx4 v18, s[96:99], s37 offen lds
    s_add_u32 m0, s28, 3072
    s_add_u32 s37, s3, 0x18000
    buffer_load_dwordx4 v19, s[96:99], s37 offen lds
    s_add_u32 m0, s28, 4096
    s_add_u32 s37, s3, 0x20000
    buffer_load_dwordx4 v16, s[96:99], s37 offen lds
    s_add_u32 m0, s28, 5120
    s_add_u32 s37, s3, 0x28000
    buffer_load_dwordx4 v17, s[96:99], s37 offen lds
    s_add_u32 m0, s28, 6144
    s_add_u32 s37, s3, 0x30000
    buffer_load_dwordx4 v18, s[96:99], s37 offen lds
    s_add_u32 m0, s28, 7168
    s_add_u32 s37, s3, 0x38000
    buffer_load_dwordx4 v19, s[96:99], s37 offen lds
    s_waitcnt vmcnt(24)
    s_barrier
    ds_read_b64_tr_b16 a[160:161], v20 offset:8192
    ds_read_b64_tr_b16 a[162:163], v20 offset:9216
    ds_read_b64_tr_b16 a[164:165], v21 offset:8192
    ds_read_b64_tr_b16 a[166:167], v21 offset:9216
    ds_read_b64_tr_b16 a[168:169], v22 offset:8192
    ds_read_b64_tr_b16 a[170:171], v22 offset:9216
    ds_read_b64_tr_b16 a[172:173], v23 offset:8192
    ds_read_b64_tr_b16 a[174:175], v23 offset:9216
    ds_read_b64_tr_b16 a[176:177], v24 offset:8192
    ds_read_b64_tr_b16 a[178:179], v24 offset:9216
    ds_read_b64_tr_b16 a[180:181], v25 offset:8192
    ds_read_b64_tr_b16 a[182:183], v25 offset:9216
    s_waitcnt lgkmcnt(4)
    ds_read_b64_tr_b16 a[184:185], v26 offset:8192
    ds_read_b64_tr_b16 a[186:187], v26 offset:9216
    ds_read_b64_tr_b16 a[188:189], v27 offset:8192
    ds_read_b64_tr_b16 a[190:191], v27 offset:9216
    s_waitcnt lgkmcnt(0)
    s_barrier
    s_add_u32 m0, s28, 8192
    s_add_u32 s37, s3, 0x100000
    buffer_load_dwordx4 v16, s[96:99], s37 offen lds
    s_add_u32 m0, s28, 9216
    s_add_u32 s37, s3, 0x108000
    buffer_load_dwordx4 v17, s[96:99], s37 offen lds
    s_add_u32 m0, s28, 10240
    s_add_u32 s37, s3, 0x110000
    buffer_load_dwordx4 v18, s[96:99], s37 offen lds
    s_add_u32 m0, s28, 11264
    s_add_u32 s37, s3, 0x118000
    buffer_load_dwordx4 v19, s[96:99], s37 offen lds
    s_add_u32 m0, s28, 12288
    s_add_u32 s37, s3, 0x120000
    buffer_load_dwordx4 v16, s[96:99], s37 offen lds
    s_add_u32 m0, s28, 13312
    s_add_u32 s37, s3, 0x128000
    buffer_load_dwordx4 v17, s[96:99], s37 offen lds
    s_add_u32 m0, s28, 14336
    s_add_u32 s37, s3, 0x130000
    buffer_load_dwordx4 v18, s[96:99], s37 offen lds
    s_add_u32 m0, s28, 15360
    s_add_u32 s37, s3, 0x138000
    buffer_load_dwordx4 v19, s[96:99], s37 offen lds
    s_waitcnt vmcnt(24)
    s_barrier
    ds_read_b64_tr_b16 a[192:193], v20 offset:16384
    ds_read_b64_tr_b16 a[194:195], v20 offset:17408
    ds_read_b64_tr_b16 a[196:197], v21 offset:16384
    ds_read_b64_tr_b16 a[198:199], v21 offset:17408
    ds_read_b64_tr_b16 a[200:201], v22 offset:16384
    ds_read_b64_tr_b16 a[202:203], v22 offset:17408
    ds_read_b64_tr_b16 a[204:205], v23 offset:16384
    ds_read_b64_tr_b16 a[206:207], v23 offset:17408
    ds_read_b64_tr_b16 a[208:209], v24 offset:16384
    ds_read_b64_tr_b16 a[210:211], v24 offset:17408
    ds_read_b64_tr_b16 a[212:213], v25 offset:16384
    ds_read_b64_tr_b16 a[214:215], v25 offset:17408
    s_waitcnt lgkmcnt(4)
    ds_read_b64_tr_b16 a[216:217], v26 offset:16384
    ds_read_b64_tr_b16 a[218:219], v26 offset:17408
    ds_read_b64_tr_b16 a[220:221], v27 offset:16384
    ds_read_b64_tr_b16 a[222:223], v27 offset:17408
    s_waitcnt lgkmcnt(0)
    s_barrier
    s_add_u32 m0, s28, 16384
    s_add_u32 s37, s3, 0x200000
    buffer_load_dwordx4 v16, s[96:99], s37 offen lds
    s_add_u32 m0, s28, 17408
    s_add_u32 s37, s3, 0x208000
    buffer_load_dwordx4 v17, s[96:99], s37 offen lds
    s_add_u32 m0, s28, 18432
    s_add_u32 s37, s3, 0x210000
    buffer_load_dwordx4 v18, s[96:99], s37 offen lds
    s_add_u32 m0, s28, 19456
    s_add_u32 s37, s3, 0x218000
    buffer_load_dwordx4 v19, s[96:99], s37 offen lds
    s_add_u32 m0, s28, 20480
    s_add_u32 s37, s3, 0x220000
    buffer_load_dwordx4 v16, s[96:99], s37 offen lds
    s_add_u32 m0, s28, 21504
    s_add_u32 s37, s3, 0x228000
    buffer_load_dwordx4 v17, s[96:99], s37 offen lds
    s_add_u32 m0, s28, 22528
    s_add_u32 s37, s3, 0x230000
    buffer_load_dwordx4 v18, s[96:99], s37 offen lds
    s_add_u32 m0, s28, 23552
    s_add_u32 s37, s3, 0x238000
    buffer_load_dwordx4 v19, s[96:99], s37 offen lds
    s_waitcnt vmcnt(24)
    s_barrier
    ds_read_b64_tr_b16 a[224:225], v20 offset:24576
    ds_read_b64_tr_b16 a[226:227], v20 offset:25600
    ds_read_b64_tr_b16 a[228:229], v21 offset:24576
    ds_read_b64_tr_b16 a[230:231], v21 offset:25600
    ds_read_b64_tr_b16 a[232:233], v22 offset:24576
    ds_read_b64_tr_b16 a[234:235], v22 offset:25600
    ds_read_b64_tr_b16 a[236:237], v23 offset:24576
    ds_read_b64_tr_b16 a[238:239], v23 offset:25600
    ds_read_b64_tr_b16 a[240:241], v24 offset:24576
    ds_read_b64_tr_b16 a[242:243], v24 offset:25600
    ds_read_b64_tr_b16 a[244:245], v25 offset:24576
    ds_read_b64_tr_b16 a[246:247], v25 offset:25600
    s_waitcnt lgkmcnt(4)
    ds_read_b64_tr_b16 a[248:249], v26 offset:24576
    ds_read_b64_tr_b16 a[250:251], v26 offset:25600
    ds_read_b64_tr_b16 a[252:253], v27 offset:24576
    ds_read_b64_tr_b16 a[254:255], v27 offset:25600
    s_waitcnt lgkmcnt(0)
    s_barrier
    s_add_u32 m0, s28, 24576
    s_add_u32 s37, s3, 0x300000
    buffer_load_dwordx4 v16, s[96:99], s37 offen lds
    s_add_u32 m0, s28, 25600
    s_add_u32 s37, s3, 0x308000
    buffer_load_dwordx4 v17, s[96:99], s37 offen lds
    s_add_u32 m0, s28, 26624
    s_add_u32 s37, s3, 0x310000
    buffer_load_dwordx4 v18, s[96:99], s37 offen lds
    s_add_u32 m0, s28, 27648
    s_add_u32 s37, s3, 0x318000
    buffer_load_dwordx4 v19, s[96:99], s37 offen lds
    s_add_u32 m0, s28, 28672
    s_add_u32 s37, s3, 0x320000
    buffer_load_dwordx4 v16, s[96:99], s37 offen lds
    s_add_u32 m0, s28, 29696
    s_add_u32 s37, s3, 0x328000
    buffer_load_dwordx4 v17, s[96:99], s37 offen lds
    s_add_u32 m0, s28, 30720
    s_add_u32 s37, s3, 0x330000
    buffer_load_dwordx4 v18, s[96:99], s37 offen lds
    s_add_u32 m0, s28, 31744
    s_add_u32 s37, s3, 0x338000
    buffer_load_dwordx4 v19, s[96:99], s37 offen lds
    ds_read_b128 v[64:67], v80 offset:0
    ds_read_b128 v[68:71], v81 offset:0
    ds_read_b128 v[72:75], v82 offset:1024
    ds_read_b128 v[76:79], v83 offset:1024
    s_waitcnt lgkmcnt(2)
    v_mfma_f32_16x16x32_bf16 v[32:35], a[128:131], v[64:67], 0
    v_mfma_f32_16x16x32_bf16 v[36:39], a[128:131], v[68:71], 0
    v_mfma_f32_16x16x32_bf16 v[40:43], a[132:135], v[64:67], 0
    v_mfma_f32_16x16x32_bf16 v[44:47], a[132:135], v[68:71], 0
    v_mfma_f32_16x16x32_bf16 v[48:51], v[64:67], v[128:131], 0
    v_mfma_f32_16x16x32_bf16 v[56:59], v[68:71], v[128:131], 0
    v_mfma_f32_16x16x32_bf16 v[52:55], v[64:67], v[132:135], 0
    v_mfma_f32_16x16x32_bf16 v[60:63], v[68:71], v[132:135], 0
    ds_read_b128 v[64:67], v80 offset:2048
    ds_read_b128 v[68:71], v81 offset:2048
    s_waitcnt lgkmcnt(2)
    v_mfma_f32_16x16x32_bf16 v[32:35], a[136:139], v[72:75], v[32:35]
    v_mfma_f32_16x16x32_bf16 v[36:39], a[136:139], v[76:79], v[36:39]
    v_mfma_f32_16x16x32_bf16 v[40:43], a[140:143], v[72:75], v[40:43]
    v_mfma_f32_16x16x32_bf16 v[44:47], a[140:143], v[76:79], v[44:47]
    v_mfma_f32_16x16x32_bf16 v[48:51], v[72:75], v[136:139], v[48:51]
    v_mfma_f32_16x16x32_bf16 v[56:59], v[76:79], v[136:139], v[56:59]
    v_mfma_f32_16x16x32_bf16 v[52:55], v[72:75], v[140:143], v[52:55]
    v_mfma_f32_16x16x32_bf16 v[60:63], v[76:79], v[140:143], v[60:63]
    ds_read_b128 v[72:75], v82 offset:3072
    ds_read_b128 v[76:79], v83 offset:3072
    s_waitcnt lgkmcnt(2)
    v_mfma_f32_16x16x32_bf16 v[32:35], a[144:147], v[64:67], v[32:35]
    v_mfma_f32_16x16x32_bf16 v[36:39], a[144:147], v[68:71], v[36:39]
    v_mfma_f32_16x16x32_bf16 v[40:43], a[148:151], v[64:67], v[40:43]
    v_mfma_f32_16x16x32_bf16 v[44:47], a[148:151], v[68:71], v[44:47]
    v_mfma_f32_16x16x32_bf16 v[48:51], v[64:67], v[144:147], v[48:51]
    v_mfma_f32_16x16x32_bf16 v[56:59], v[68:71], v[144:147], v[56:59]
    v_mfma_f32_16x16x32_bf16 v[52:55], v[64:67], v[148:151], v[52:55]
    v_mfma_f32_16x16x32_bf16 v[60:63], v[68:71], v[148:151], v[60:63]
    ds_read_b128 v[64:67], v80 offset:4096
    ds_read_b128 v[68:71], v81 offset:4096
    s_waitcnt lgkmcnt(2)
    v_mfma_f32_16x16x32_bf16 v[32:35], a[152:155], v[72:75], v[32:35]
    v_mfma_f32_16x16x32_bf16 v[36:39], a[152:155], v[76:79], v[36:39]
    v_mfma_f32_16x16x32_bf16 v[40:43], a[156:159], v[72:75], v[40:43]
    v_mfma_f32_16x16x32_bf16 v[44:47], a[156:159], v[76:79], v[44:47]
    v_mfma_f32_16x16x32_bf16 v[48:51], v[72:75], v[152:155], v[48:51]
    v_mfma_f32_16x16x32_bf16 v[56:59], v[76:79], v[152:155], v[56:59]
    v_mfma_f32_16x16x32_bf16 v[52:55], v[72:75], v[156:159], v[52:55]
    v_mfma_f32_16x16x32_bf16 v[60:63], v[76:79], v[156:159], v[60:63]
    ds_read_b128 v[72:75], v82 offset:5120
    ds_read_b128 v[76:79], v83 offset:5120
    s_waitcnt lgkmcnt(2)
    v_mfma_f32_16x16x32_bf16 v[32:35], a[160:163], v[64:67], v[32:35]
    v_mfma_f32_16x16x32_bf16 v[36:39], a[160:163], v[68:71], v[36:39]
    v_mfma_f32_16x16x32_bf16 v[40:43], a[164:167], v[64:67], v[40:43]
    v_mfma_f32_16x16x32_bf16 v[44:47], a[164:167], v[68:71], v[44:47]
    v_mfma_f32_16x16x32_bf16 v[48:51], v[64:67], v[160:163], v[48:51]
    v_mfma_f32_16x16x32_bf16 v[56:59], v[68:71], v[160:163], v[56:59]
    v_mfma_f32_16x16x32_bf16 v[52:55], v[64:67], v[164:167], v[52:55]
    v_mfma_f32_16x16x32_bf16 v[60:63], v[68:71], v[164:167], v[60:63]
    ds_read_b128 v[64:67], v80 offset:6144
    ds_read_b128 v[68:71], v81 offset:6144
    s_waitcnt lgkmcnt(2)
    v_mfma_f32_16x16x32_bf16 v[32:35], a[168:171], v[72:75], v[32:35]
    v_mfma_f32_16x16x32_bf16 v[36:39], a[168:171], v[76:79], v[36:39]
    v_mfma_f32_16x16x32_bf16 v[40:43], a[172:175], v[72:75], v[40:43]
    v_mfma_f32_16x16x32_bf16 v[44:47], a[172:175], v[76:79], v[44:47]
    v_mfma_f32_16x16x32_bf16 v[48:51], v[72:75], v[168:171], v[48:51]
    v_mfma_f32_16x16x32_bf16 v[56:59], v[76:79], v[168:171], v[56:59]
    v_mfma_f32_16x16x32_bf16 v[52:55], v[72:75], v[172:175], v[52:55]
    v_mfma_f32_16x16x32_bf16 v[60:63], v[76:79], v[172:175], v[60:63]
    ds_read_b128 v[72:75], v82 offset:7168
    ds_read_b128 v[76:79], v83 offset:7168
    s_waitcnt lgkmcnt(2)
    v_mfma_f32_16x16x32_bf16 v[32:35], a[176:179], v[64:67], v[32:35]
    v_mfma_f32_16x16x32_bf16 v[36:39], a[176:179], v[68:71], v[36:39]
    v_mfma_f32_16x16x32_bf16 v[40:43], a[180:183], v[64:67], v[40:43]
    v_mfma_f32_16x16x32_bf16 v[44:47], a[180:183], v[68:71], v[44:47]
    v_mfma_f32_16x16x32_bf16 v[48:51], v[64:67], v[176:179], v[48:51]
    v_mfma_f32_16x16x32_bf16 v[56:59], v[68:71], v[176:179], v[56:59]
    v_mfma_f32_16x16x32_bf16 v[52:55], v[64:67], v[180:183], v[52:55]
    v_mfma_f32_16x16x32_bf16 v[60:63], v[68:71], v[180:183], v[60:63]
    ds_read_b128 v[64:67], v80 offset:8192
    ds_read_b128 v[68:71], v81 offset:8192
    s_waitcnt lgkmcnt(2)
    v_mfma_f32_16x16x32_bf16 v[32:35], a[184:187], v[72:75], v[32:35]
    v_mfma_f32_16x16x32_bf16 v[36:39], a[184:187], v[76:79], v[36:39]
    v_mfma_f32_16x16x32_bf16 v[40:43], a[188:191], v[72:75], v[40:43]
    v_mfma_f32_16x16x32_bf16 v[44:47], a[188:191], v[76:79], v[44:47]
    v_mfma_f32_16x16x32_bf16 v[48:51], v[72:75], v[184:187], v[48:51]
    v_mfma_f32_16x16x32_bf16 v[56:59], v[76:79], v[184:187], v[56:59]
    v_mfma_f32_16x16x32_bf16 v[52:55], v[72:75], v[188:191], v[52:55]
    v_mfma_f32_16x16x32_bf16 v[60:63], v[76:79], v[188:191], v[60:63]
    ds_read_b128 v[72:75], v82 offset:9216
    ds_read_b128 v[76:79], v83 offset:9216
    s_waitcnt lgkmcnt(2)
    v_mfma_f32_16x16x32_bf16 v[32:35], a[192:195], v[64:67], v[32:35]
    v_mfma_f32_16x16x32_bf16 v[36:39], a[192:195], v[68:71], v[36:39]
    v_mfma_f32_16x16x32_bf16 v[40:43], a[196:199], v[64:67], v[40:43]
    v_mfma_f32_16x16x32_bf16 v[44:47], a[196:199], v[68:71], v[44:47]
    v_mfma_f32_16x16x32_bf16 v[48:51], v[64:67], v[192:195], v[48:51]
    v_mfma_f32_16x16x32_bf16 v[56:59], v[68:71], v[192:195], v[56:59]
    v_mfma_f32_16x16x32_bf16 v[52:55], v[64:67], v[196:199], v[52:55]
    v_mfma_f32_16x16x32_bf16 v[60:63], v[68:71], v[196:199], v[60:63]
    ds_read_b128 v[64:67], v80 offset:10240
    ds_read_b128 v[68:71], v81 offset:10240
    s_waitcnt lgkmcnt(2)
    v_mfma_f32_16x16x32_bf16 v[32:35], a[200:203], v[72:75], v[32:35]
    v_mfma_f32_16x16x32_bf16 v[36:39], a[200:203], v[76:79], v[36:39]
    v_mfma_f32_16x16x32_bf16 v[40:43], a[204:207], v[72:75], v[40:43]
    v_mfma_f32_16x16x32_bf16 v[44:47], a[204:207], v[76:79], v[44:47]
    v_mfma_f32_16x16x32_bf16 v[48:51], v[72:75], v[200:203], v[48:51]
    v_mfma_f32_16x16x32_bf16 v[56:59], v[76:79], v[200:203], v[56:59]
    v_mfma_f32_16x16x32_bf16 v[52:55], v[72:75], v[204:207], v[52:55]
    v_mfma_f32_16x16x32_bf16 v[60:63], v[76:79], v[204:207], v[60:63]
    ds_read_b128 v[72:75], v82 offset:11264
    ds_read_b128 v[76:79], v83 offset:11264
    s_waitcnt lgkmcnt(2)
    v_mfma_f32_16x16x32_bf16 v[32:35], a[208:211], v[64:67], v[32:35]
    v_mfma_f32_16x16x32_bf16 v[36:39], a[208:211], v[68:71], v[36:39]
    v_mfma_f32_16x16x32_bf16 v[40:43], a[212:215], v[64:67], v[40:43]
    v_mfma_f32_16x16x32_bf16 v[44:47], a[212:215], v[68:71], v[44:47]
    v_mfma_f32_16x16x32_bf16 v[48:51], v[64:67], v[208:211], v[48:51]
    v_mfma_f32_16x16x32_bf16 v[56:59], v[68:71], v[208:211], v[56:59]
    v_mfma_f32_16x16x32_bf16 v[52:55], v[64:67], v[212:215], v[52:55]
    v_mfma_f32_16x16x32_bf16 v[60:63], v[68:71], v[212:215], v[60:63]
    ds_read_b128 v[64:67], v80 offset:12288
    ds_read_b128 v[68:71], v81 offset:12288
    s_waitcnt lgkmcnt(2)
    v_mfma_f32_16x16x32_bf16 v[32:35], a[216:219], v[72:75], v[32:35]
    v_mfma_f32_16x16x32_bf16 v[36:39], a[216:219], v[76:79], v[36:39]
    v_mfma_f32_16x16x32_bf16 v[40:43], a[220:223], v[72:75], v[40:43]
    v_mfma_f32_16x16x32_bf16 v[44:47], a[220:223], v[76:79], v[44:47]
    v_mfma_f32_16x16x32_bf16 v[48:51], v[72:75], v[216:219], v[48:51]
    v_mfma_f32_16x16x32_bf16 v[56:59], v[76:79], v[216:219], v[56:59]
    v_mfma_f32_16x16x32_bf16 v[52:55], v[72:75], v[220:223], v[52:55]
    v_mfma_f32_16x16x32_bf16 v[60:63], v[76:79], v[220:223], v[60:63]
    ds_read_b128 v[72:75], v82 offset:13312
    ds_read_b128 v[76:79], v83 offset:13312
    s_waitcnt lgkmcnt(2)
    v_mfma_f32_16x16x32_bf16 v[32:35], a[224:227], v[64:67], v[32:35]
    v_mfma_f32_16x16x32_bf16 v[36:39], a[224:227], v[68:71], v[36:39]
    v_mfma_f32_16x16x32_bf16 v[40:43], a[228:231], v[64:67], v[40:43]
    v_mfma_f32_16x16x32_bf16 v[44:47], a[228:231], v[68:71], v[44:47]
    v_mfma_f32_16x16x32_bf16 v[48:51], v[64:67], v[224:227], v[48:51]
    v_mfma_f32_16x16x32_bf16 v[56:59], v[68:71], v[224:227], v[56:59]
    v_mfma_f32_16x16x32_bf16 v[52:55], v[64:67], v[228:231], v[52:55]
    v_mfma_f32_16x16x32_bf16 v[60:63], v[68:71], v[228:231], v[60:63]
    ds_read_b128 v[64:67], v80 offset:14336
    ds_read_b128 v[68:71], v81 offset:14336
    s_waitcnt lgkmcnt(2)
    v_mfma_f32_16x16x32_bf16 v[32:35], a[232:235], v[72:75], v[32:35]
    v_mfma_f32_16x16x32_bf16 v[36:39], a[232:235], v[76:79], v[36:39]
    v_mfma_f32_16x16x32_bf16 v[40:43], a[236:239], v[72:75], v[40:43]
    v_mfma_f32_16x16x32_bf16 v[44:47], a[236:239], v[76:79], v[44:47]
    v_mfma_f32_16x16x32_bf16 v[48:51], v[72:75], v[232:235], v[48:51]
    v_mfma_f32_16x16x32_bf16 v[56:59], v[76:79], v[232:235], v[56:59]
    v_mfma_f32_16x16x32_bf16 v[52:55], v[72:75], v[236:239], v[52:55]
    v_mfma_f32_16x16x32_bf16 v[60:63], v[76:79], v[236:239], v[60:63]
    ds_read_b128 v[72:75], v82 offset:15360
    ds_read_b128 v[76:79], v83 offset:15360
    s_waitcnt lgkmcnt(2)
    v_mfma_f32_16x16x32_bf16 v[32:35], a[240:243], v[64:67], v[32:35]
    v_mfma_f32_16x16x32_bf16 v[36:39], a[240:243], v[68:71], v[36:39]
    v_mfma_f32_16x16x32_bf16 v[40:43], a[244:247], v[64:67], v[40:43]
    v_mfma_f32_16x16x32_bf16 v[44:47], a[244:247], v[68:71], v[44:47]
    v_mfma_f32_16x16x32_bf16 v[48:51], v[64:67], v[240:243], v[48:51]
    v_mfma_f32_16x16x32_bf16 v[56:59], v[68:71], v[240:243], v[56:59]
    v_mfma_f32_16x16x32_bf16 v[52:55], v[64:67], v[244:247], v[52:55]
    v_mfma_f32_16x16x32_bf16 v[60:63], v[68:71], v[244:247], v[60:63]
    s_waitcnt lgkmcnt(0)
    v_mfma_f32_16x16x32_bf16 v[32:35], a[248:251], v[72:75], v[32:35]
    v_mfma_f32_16x16x32_bf16 v[36:39], a[248:251], v[76:79], v[36:39]
    v_mfma_f32_16x16x32_bf16 v[40:43], a[252:255], v[72:75], v[40:43]
    v_mfma_f32_16x16x32_bf16 v[44:47], a[252:255], v[76:79], v[44:47]
    v_mfma_f32_16x16x32_bf16 v[48:51], v[72:75], v[248:251], v[48:51]
    v_mfma_f32_16x16x32_bf16 v[56:59], v[76:79], v[248:251], v[56:59]
    v_mfma_f32_16x16x32_bf16 v[52:55], v[72:75], v[252:255], v[52:55]
    v_mfma_f32_16x16x32_bf16 v[60:63], v[76:79], v[252:255], v[60:63]
    s_nop 0
    v_mul_f32 v32, s33, v32
    v_mul_f32 v33, s33, v33
    v_mul_f32 v34, s33, v34
    v_mul_f32 v35, s33, v35
    v_mul_f32 v36, s33, v36
    v_mul_f32 v37, s33, v37
    v_mul_f32 v38, s33, v38
    v_mul_f32 v39, s33, v39
    v_mul_f32 v40, s33, v40
    v_mul_f32 v41, s33, v41
    v_mul_f32 v42, s33, v42
    v_mul_f32 v43, s33, v43
    v_mul_f32 v44, s33, v44
    v_mul_f32 v45, s33, v45
    v_mul_f32 v46, s33, v46
    v_mul_f32 v47, s33, v47
    v_cvt_pk_bf16_f32 v88, v32, v40
    v_cvt_pk_bf16_f32 v89, v33, v41
    v_cvt_pk_bf16_f32 v90, v34, v42
    v_cvt_pk_bf16_f32 v91, v35, v43
    v_cvt_pk_bf16_f32 v92, v36, v44
    v_cvt_pk_bf16_f32 v93, v37, v45
    v_cvt_pk_bf16_f32 v94, v38, v46
    v_cvt_pk_bf16_f32 v95, v39, v47
    v_cvt_pk_bf16_f32 v96, v48, v49
    v_cvt_pk_bf16_f32 v97, v50, v51
    v_cvt_pk_bf16_f32 v98, v56, v57
    v_cvt_pk_bf16_f32 v99, v58, v59
    v_cvt_pk_bf16_f32 v100, v52, v53
    v_cvt_pk_bf16_f32 v101, v54, v55
    v_cvt_pk_bf16_f32 v102, v60, v61
    v_cvt_pk_bf16_f32 v103, v62, v63
    s_mul_i32 s24, s23, 0x82000
    s_lshl_b32 s36, s20, 14
    s_add_u32 s24, s24, s36
    s_add_u32 s24, s24, 0x1000000
    s_lshr_b32 s36, s21, 1
    s_lshl_b32 s36, s36, 12
    s_xor_b32 s37, s36, 4096
    s_add_u32 s36, s36, s24
    s_add_u32 s37, s37, s24
    buffer_store_dwordx4 v[88:91], v9, s[8:11], s36 offen sc1
    buffer_store_dwordx4 v[92:95], v9, s[8:11], s37 offen sc1
    s_add_u32 s24, s24, 8192
    buffer_store_dwordx4 v[96:99], v2, s[8:11], s24 offen sc1
    buffer_store_dwordx4 v[100:103], v2, s[8:11], s24 offen offset:1024 sc1
    s_lshl_b32 s25, s20, 8
    s_lshl_b32 s36, s23, 2
    s_add_u32 s25, s25, s36
    s_add_u32 s25, s25, 0x190000
    v_lshrrev_b32 v15, 2, v1
    v_and_b32 v15, 127, v15
L_WHS:
    buffer_load_dword v14, v15, s[16:19], 0 offen sc1
    s_add_u32 s32, s32, 1
    s_cmp_gt_u32 s32, 200000
    s_cbranch_scc1 L_WHS_done
    s_waitcnt vmcnt(0)
    v_cmp_eq_u32 vcc, 0, v14
    s_cbranch_vccnz L_WHS
L_WHS_done:
    s_waitcnt vmcnt(0)
    s_barrier
    v_cmp_ne_u32 vcc, 0, v0
    v_mov_b32 v15, 0x40000000
    v_mov_b32 v14, 1
    v_cndmask_b32 v15, v0, v15, vcc
    buffer_store_dword v14, v15, s[8:11], s25 offen sc1
    s_barrier
    ds_read_b64_tr_b16 a[0:1], v20 offset:0
    ds_read_b64_tr_b16 a[2:3], v20 offset:1024
    ds_read_b64_tr_b16 a[4:5], v21 offset:0
    ds_read_b64_tr_b16 a[6:7], v21 offset:1024
    ds_read_b64_tr_b16 a[8:9], v22 offset:0
    ds_read_b64_tr_b16 a[10:11], v22 offset:1024
    ds_read_b64_tr_b16 a[12:13], v23 offset:0
    ds_read_b64_tr_b16 a[14:15], v23 offset:1024
    ds_read_b64_tr_b16 a[16:17], v24 offset:0
    ds_read_b64_tr_b16 a[18:19], v24 offset:1024
    ds_read_b64_tr_b16 a[20:21], v25 offset:0
    ds_read_b64_tr_b16 a[22:23], v25 offset:1024
    s_waitcnt lgkmcnt(4)
    ds_read_b64_tr_b16 a[24:25], v26 offset:0
    ds_read_b64_tr_b16 a[26:27], v26 offset:1024
    ds_read_b64_tr_b16 a[28:29], v27 offset:0
    ds_read_b64_tr_b16 a[30:31], v27 offset:1024
    s_waitcnt lgkmcnt(0)
    s_barrier
    s_barrier
    ds_read_b64_tr_b16 a[32:33], v20 offset:8192
    ds_read_b64_tr_b16 a[34:35], v20 offset:9216
    ds_read_b64_tr_b16 a[36:37], v21 offset:8192
    ds_read_b64_tr_b16 a[38:39], v21 offset:9216
    ds_read_b64_tr_b16 a[40:41], v22 offset:8192
    ds_read_b64_tr_b16 a[42:43], v22 offset:9216
    ds_read_b64_tr_b16 a[44:45], v23 offset:8192
    ds_read_b64_tr_b16 a[46:47], v23 offset:9216
    ds_read_b64_tr_b16 a[48:49], v24 offset:8192
    ds_read_b64_tr_b16 a[50:51], v24 offset:9216
    ds_read_b64_tr_b16 a[52:53], v25 offset:8192
    ds_read_b64_tr_b16 a[54:55], v25 offset:9216
    s_waitcnt lgkmcnt(4)
    ds_read_b64_tr_b16 a[56:57], v26 offset:8192
    ds_read_b64_tr_b16 a[58:59], v26 offset:9216
    ds_read_b64_tr_b16 a[60:61], v27 offset:8192
    ds_read_b64_tr_b16 a[62:63], v27 offset:9216
    s_waitcnt lgkmcnt(0)
    s_barrier
    s_barrier
    ds_read_b64_tr_b16 a[64:65], v20 offset:16384
    ds_read_b64_tr_b16 a[66:67], v20 offset:17408
    ds_read_b64_tr_b16 a[68:69], v21 offset:16384
    ds_read_b64_tr_b16 a[70:71], v21 offset:17408
    ds_read_b64_tr_b16 a[72:73], v22 offset:16384
    ds_read_b64_tr_b16 a[74:75], v22 offset:17408
    ds_read_b64_tr_b16 a[76:77], v23 offset:16384
    ds_read_b64_tr_b16 a[78:79], v23 offset:17408
    ds_read_b64_tr_b16 a[80:81], v24 offset:16384
    ds_read_b64_tr_b16 a[82:83], v24 offset:17408
    ds_read_b64_tr_b16 a[84:85], v25 offset:16384
    ds_read_b64_tr_b16 a[86:87], v25 offset:17408
    s_waitcnt lgkmcnt(4)
    ds_read_b64_tr_b16 a[88:89], v26 offset:16384
    ds_read_b64_tr_b16 a[90:91], v26 offset:17408
    ds_read_b64_tr_b16 a[92:93], v27 offset:16384
    ds_read_b64_tr_b16 a[94:95], v27 offset:17408
    s_waitcnt lgkmcnt(0)
    s_barrier
    s_barrier
    ds_read_b64_tr_b16 a[96:97], v20 offset:24576
    ds_read_b64_tr_b16 a[98:99], v20 offset:25600
    ds_read_b64_tr_b16 a[100:101], v21 offset:24576
    ds_read_b64_tr_b16 a[102:103], v21 offset:25600
    ds_read_b64_tr_b16 a[104:105], v22 offset:24576
    ds_read_b64_tr_b16 a[106:107], v22 offset:25600
    ds_read_b64_tr_b16 a[108:109], v23 offset:24576
    ds_read_b64_tr_b16 a[110:111], v23 offset:25600
    ds_read_b64_tr_b16 a[112:113], v24 offset:24576
    ds_read_b64_tr_b16 a[114:115], v24 offset:25600
    ds_read_b64_tr_b16 a[116:117], v25 offset:24576
    ds_read_b64_tr_b16 a[118:119], v25 offset:25600
    s_waitcnt lgkmcnt(4)
    ds_read_b64_tr_b16 a[120:121], v26 offset:24576
    ds_read_b64_tr_b16 a[122:123], v26 offset:25600
    ds_read_b64_tr_b16 a[124:125], v27 offset:24576
    ds_read_b64_tr_b16 a[126:127], v27 offset:25600
    s_waitcnt lgkmcnt(0)
    s_barrier
L_P1:
    s_waitcnt vmcnt(6)
    s_barrier
    s_xor_b32 s31, s31, 32768
    s_add_u32 s24, s23, 6
    s_min_u32 s24, s24, 63
    s_lshl_b32 s36, s24, 15
    s_add_u32 s36, s36, 0x800000
    s_lshl_b32 s37, s21, 10
    s_add_u32 s37, s37, s31
    s_add_u32 m0, s37, 0
    s_add_u32 s38, s36, 0
    buffer_load_dwordx4 v9, s[8:11], s38 offen sc1 lds
    s_add_u32 m0, s37, 4096
    s_add_u32 s38, s36, 4096
    buffer_load_dwordx4 v9, s[8:11], s38 offen sc1 lds
    s_add_u32 m0, s37, 8192
    s_add_u32 s38, s36, 8192
    buffer_load_dwordx4 v9, s[8:11], s38 offen sc1 lds
    s_add_u32 m0, s37, 12288
    s_add_u32 s38, s36, 12288
    buffer_load_dwordx4 v9, s[8:11], s38 offen sc1 lds
    s_add_u32 m0, s37, 16384
    s_add_u32 s38, s36, 16384
    buffer_load_dwordx4 v9, s[8:11], s38 offen sc1 lds
    s_add_u32 m0, s37, 20480
    s_add_u32 s38, s36, 20480
    buffer_load_dwordx4 v9, s[8:11], s38 offen sc1 lds
    s_add_u32 m0, s37, 24576
    s_add_u32 s38, s36, 24576
    buffer_load_dwordx4 v9, s[8:11], s38 offen sc1 lds
    s_add_u32 m0, s37, 28672
    s_add_u32 s38, s36, 28672
    buffer_load_dwordx4 v9, s[8:11], s38 offen sc1 lds
    ds_read_b128 v[64:67], v80 offset:0
    ds_read_b128 v[68:71], v81 offset:0
    ds_read_b128 v[72:75], v82 offset:1024
    ds_read_b128 v[76:79], v83 offset:1024
    s_waitcnt lgkmcnt(2)
    v_mfma_f32_16x16x32_bf16 v[32:35], a[128:131], v[64:67], 0
    v_mfma_f32_16x16x32_bf16 v[36:39], a[128:131], v[68:71], 0
    v_mfma_f32_16x16x32_bf16 v[40:43], a[132:135], v[64:67], 0
    v_mfma_f32_16x16x32_bf16 v[44:47], a[132:135], v[68:71], 0
    v_mfma_f32_16x16x32_bf16 v[48:51], v[64:67], v[128:131], 0
    v_mfma_f32_16x16x32_bf16 v[56:59], v[68:71], v[128:131], 0
    v_mfma_f32_16x16x32_bf16 v[52:55], v[64:67], v[132:135], 0
    v_mfma_f32_16x16x32_bf16 v[60:63], v[68:71], v[132:135], 0
    v_mfma_f32_16x16x32_bf16 v[16:19], a[0:3], v[64:67], 0
    v_mfma_f32_16x16x32_bf16 v[20:23], a[0:3], v[68:71], 0
    v_mfma_f32_16x16x32_bf16 v[24:27], a[4:7], v[64:67], 0
    v_mfma_f32_16x16x32_bf16 v[28:31], a[4:7], v[68:71], 0
    ds_read_b128 v[64:67], v80 offset:2048
    ds_read_b128 v[68:71], v81 offset:2048
    s_waitcnt lgkmcnt(2)
    v_mfma_f32_16x16x32_bf16 v[32:35], a[136:139], v[72:75], v[32:35]
    v_mfma_f32_16x16x32_bf16 v[36:39], a[136:139], v[76:79], v[36:39]
    v_mfma_f32_16x16x32_bf16 v[40:43], a[140:143], v[72:75], v[40:43]
    v_mfma_f32_16x16x32_bf16 v[44:47], a[140:143], v[76:79], v[44:47]
    v_mfma_f32_16x16x32_bf16 v[48:51], v[72:75], v[136:139], v[48:51]
    v_mfma_f32_16x16x32_bf16 v[56:59], v[76:79], v[136:139], v[56:59]
    v_mfma_f32_16x16x32_bf16 v[52:55], v[72:75], v[140:143], v[52:55]
    v_mfma_f32_16x16x32_bf16 v[60:63], v[76:79], v[140:143], v[60:63]
    v_mfma_f32_16x16x32_bf16 v[16:19], a[8:11], v[72:75], v[16:19]
    v_mfma_f32_16x16x32_bf16 v[20:23], a[8:11], v[76:79], v[20:23]
    v_mfma_f32_16x16x32_bf16 v[24:27], a[12:15], v[72:75], v[24:27]
    v_mfma_f32_16x16x32_bf16 v[28:31], a[12:15], v[76:79], v[28:31]
    ds_read_b128 v[72:75], v82 offset:3072
    ds_read_b128 v[76:79], v83 offset:3072
    s_waitcnt lgkmcnt(2)
    v_mfma_f32_16x16x32_bf16 v[32:35], a[144:147], v[64:67], v[32:35]
    v_mfma_f32_16x16x32_bf16 v[36:39], a[144:147], v[68:71], v[36:39]
    v_mfma_f32_16x16x32_bf16 v[40:43], a[148:151], v[64:67], v[40:43]
    v_mfma_f32_16x16x32_bf16 v[44:47], a[148:151], v[68:71], v[44:47]
    v_mfma_f32_16x16x32_bf16 v[48:51], v[64:67], v[144:147], v[48:51]
    v_mfma_f32_16x16x32_bf16 v[56:59], v[68:71], v[144:147], v[56:59]
    v_mfma_f32_16x16x32_bf16 v[52:55], v[64:67], v[148:151], v[52:55]
    v_mfma_f32_16x16x32_bf16 v[60:63], v[68:71], v[148:151], v[60:63]
    v_mfma_f32_16x16x32_bf16 v[16:19], a[16:19], v[64:67], v[16:19]
    v_mfma_f32_16x16x32_bf16 v[20:23], a[16:19], v[68:71], v[20:23]
    v_mfma_f32_16x16x32_bf16 v[24:27], a[20:23], v[64:67], v[24:27]
    v_mfma_f32_16x16x32_bf16 v[28:31], a[20:23], v[68:71], v[28:31]
    ds_read_b128 v[64:67], v80 offset:4096
    ds_read_b128 v[68:71], v81 offset:4096
    s_waitcnt lgkmcnt(2)
    v_mfma_f32_16x16x32_bf16 v[32:35], a[152:155], v[72:75], v[32:35]
    v_mfma_f32_16x16x32_bf16 v[36:39], a[152:155], v[76:79], v[36:39]
    v_mfma_f32_16x16x32_bf16 v[40:43], a[156:159], v[72:75], v[40:43]
    v_mfma_f32_16x16x32_bf16 v[44:47], a[156:159], v[76:79], v[44:47]
    v_mfma_f32_16x16x32_bf16 v[48:51], v[72:75], v[152:155], v[48:51]
    v_mfma_f32_16x16x32_bf16 v[56:59], v[76:79], v[152:155], v[56:59]
    v_mfma_f32_16x16x32_bf16 v[52:55], v[72:75], v[156:159], v[52:55]
    v_mfma_f32_16x16x32_bf16 v[60:63], v[76:79], v[156:159], v[60:63]
    v_mfma_f32_16x16x32_bf16 v[16:19], a[24:27], v[72:75], v[16:19]
    v_mfma_f32_16x16x32_bf16 v[20:23], a[24:27], v[76:79], v[20:23]
    v_mfma_f32_16x16x32_bf16 v[24:27], a[28:31], v[72:75], v[24:27]
    v_mfma_f32_16x16x32_bf16 v[28:31], a[28:31], v[76:79], v[28:31]
    ds_read_b128 v[72:75], v82 offset:5120
    ds_read_b128 v[76:79], v83 offset:5120
    s_waitcnt lgkmcnt(2)
    v_mfma_f32_16x16x32_bf16 v[32:35], a[160:163], v[64:67], v[32:35]
    v_mfma_f32_16x16x32_bf16 v[36:39], a[160:163], v[68:71], v[36:39]
    v_mfma_f32_16x16x32_bf16 v[40:43], a[164:167], v[64:67], v[40:43]
    v_mfma_f32_16x16x32_bf16 v[44:47], a[164:167], v[68:71], v[44:47]
    v_mfma_f32_16x16x32_bf16 v[48:51], v[64:67], v[160:163], v[48:51]
    v_mfma_f32_16x16x32_bf16 v[56:59], v[68:71], v[160:163], v[56:59]
    v_mfma_f32_16x16x32_bf16 v[52:55], v[64:67], v[164:167], v[52:55]
    v_mfma_f32_16x16x32_bf16 v[60:63], v[68:71], v[164:167], v[60:63]
    v_mfma_f32_16x16x32_bf16 v[16:19], a[32:35], v[64:67], v[16:19]
    v_mfma_f32_16x16x32_bf16 v[20:23], a[32:35], v[68:71], v[20:23]
    v_mfma_f32_16x16x32_bf16 v[24:27], a[36:39], v[64:67], v[24:27]
    v_mfma_f32_16x16x32_bf16 v[28:31], a[36:39], v[68:71], v[28:31]
    ds_read_b128 v[64:67], v80 offset:6144
    ds_read_b128 v[68:71], v81 offset:6144
    s_waitcnt lgkmcnt(2)
    v_mfma_f32_16x16x32_bf16 v[32:35], a[168:171], v[72:75], v[32:35]
    v_mfma_f32_16x16x32_bf16 v[36:39], a[168:171], v[76:79], v[36:39]
    v_mfma_f32_16x16x32_bf16 v[40:43], a[172:175], v[72:75], v[40:43]
    v_mfma_f32_16x16x32_bf16 v[44:47], a[172:175], v[76:79], v[44:47]
    v_mfma_f32_16x16x32_bf16 v[48:51], v[72:75], v[168:171], v[48:51]
    v_mfma_f32_16x16x32_bf16 v[56:59], v[76:79], v[168:171], v[56:59]
    v_mfma_f32_16x16x32_bf16 v[52:55], v[72:75], v[172:175], v[52:55]
    v_mfma_f32_16x16x32_bf16 v[60:63], v[76:79], v[172:175], v[60:63]
    v_mfma_f32_16x16x32_bf16 v[16:19], a[40:43], v[72:75], v[16:19]
    v_mfma_f32_16x16x32_bf16 v[20:23], a[40:43], v[76:79], v[20:23]
    v_mfma_f32_16x16x32_bf16 v[24:27], a[44:47], v[72:75], v[24:27]
    v_mfma_f32_16x16x32_bf16 v[28:31], a[44:47], v[76:79], v[28:31]
    ds_read_b128 v[72:75], v82 offset:7168
    ds_read_b128 v[76:79], v83 offset:7168
    s_waitcnt lgkmcnt(2)
    s_waitcnt vmcnt(8)
    s_barrier
    v_cmp_ne_u32 vcc, 0, v0
    v_mov_b32 v15, 0x40000000
    v_mov_b32 v14, 1
    v_cndmask_b32 v15, v0, v15, vcc
    buffer_store_dword v14, v15, s[8:11], s25 offen sc1
    v_mfma_f32_16x16x32_bf16 v[32:35], a[176:179], v[64:67], v[32:35]
    v_mfma_f32_16x16x32_bf16 v[36:39], a[176:179], v[68:71], v[36:39]
    v_mfma_f32_16x16x32_bf16 v[40:43], a[180:183], v[64:67], v[40:43]
    v_mfma_f32_16x16x32_bf16 v[44:47], a[180:183], v[68:71], v[44:47]
    v_mfma_f32_16x16x32_bf16 v[48:51], v[64:67], v[176:179], v[48:51]
    v_mfma_f32_16x16x32_bf16 v[56:59], v[68:71], v[176:179], v[56:59]
    v_mfma_f32_16x16x32_bf16 v[52:55], v[64:67], v[180:183], v[52:55]
    v_mfma_f32_16x16x32_bf16 v[60:63], v[68:71], v[180:183], v[60:63]
    v_mfma_f32_16x16x32_bf16 v[16:19], a[48:51], v[64:67], v[16:19]
    v_mfma_f32_16x16x32_bf16 v[20:23], a[48:51], v[68:71], v[20:23]
    v_mfma_f32_16x16x32_bf16 v[24:27], a[52:55], v[64:67], v[24:27]
    v_mfma_f32_16x16x32_bf16 v[28:31], a[52:55], v[68:71], v[28:31]
    ds_read_b128 v[64:67], v80 offset:8192
    ds_read_b128 v[68:71], v81 offset:8192
    s_waitcnt lgkmcnt(2)
    v_mfma_f32_16x16x32_bf16 v[32:35], a[184:187], v[72:75], v[32:35]
    v_mfma_f32_16x16x32_bf16 v[36:39], a[184:187], v[76:79], v[36:39]
    v_mfma_f32_16x16x32_bf16 v[40:43], a[188:191], v[72:75], v[40:43]
    v_mfma_f32_16x16x32_bf16 v[44:47], a[188:191], v[76:79], v[44:47]
    v_mfma_f32_16x16x32_bf16 v[48:51], v[72:75], v[184:187], v[48:51]
    v_mfma_f32_16x16x32_bf16 v[56:59], v[76:79], v[184:187], v[56:59]
    v_mfma_f32_16x16x32_bf16 v[52:55], v[72:75], v[188:191], v[52:55]
    v_mfma_f32_16x16x32_bf16 v[60:63], v[76:79], v[188:191], v[60:63]
    v_mfma_f32_16x16x32_bf16 v[16:19], a[56:59], v[72:75], v[16:19]
    v_mfma_f32_16x16x32_bf16 v[20:23], a[56:59], v[76:79], v[20:23]
    v_mfma_f32_16x16x32_bf16 v[24:27], a[60:63], v[72:75], v[24:27]
    v_mfma_f32_16x16x32_bf16 v[28:31], a[60:63], v[76:79], v[28:31]
    ds_read_b128 v[72:75], v82 offset:9216
    ds_read_b128 v[76:79], v83 offset:9216
    s_waitcnt lgkmcnt(2)
    v_mfma_f32_16x16x32_bf16 v[32:35], a[192:195], v[64:67], v[32:35]
    v_mfma_f32_16x16x32_bf16 v[36:39], a[192:195], v[68:71], v[36:39]
    v_mfma_f32_16x16x32_bf16 v[40:43], a[196:199], v[64:67], v[40:43]
    v_mfma_f32_16x16x32_bf16 v[44:47], a[196:199], v[68:71], v[44:47]
    v_mfma_f32_16x16x32_bf16 v[48:51], v[64:67], v[192:195], v[48:51]
    v_mfma_f32_16x16x32_bf16 v[56:59], v[68:71], v[192:195], v[56:59]
    v_mfma_f32_16x16x32_bf16 v[52:55], v[64:67], v[196:199], v[52:55]
    v_mfma_f32_16x16x32_bf16 v[60:63], v[68:71], v[196:199], v[60:63]
    v_mfma_f32_16x16x32_bf16 v[16:19], a[64:67], v[64:67], v[16:19]
    v_mfma_f32_16x16x32_bf16 v[20:23], a[64:67], v[68:71], v[20:23]
    v_mfma_f32_16x16x32_bf16 v[24:27], a[68:71], v[64:67], v[24:27]
    v_mfma_f32_16x16x32_bf16 v[28:31], a[68:71], v[68:71], v[28:31]
    ds_read_b128 v[64:67], v80 offset:10240
    ds_read_b128 v[68:71], v81 offset:10240
    s_waitcnt lgkmcnt(2)
    v_mfma_f32_16x16x32_bf16 v[32:35], a[200:203], v[72:75], v[32:35]
    v_mfma_f32_16x16x32_bf16 v[36:39], a[200:203], v[76:79], v[36:39]
    v_mfma_f32_16x16x32_bf16 v[40:43], a[204:207], v[72:75], v[40:43]
    v_mfma_f32_16x16x32_bf16 v[44:47], a[204:207], v[76:79], v[44:47]
    v_mfma_f32_16x16x32_bf16 v[48:51], v[72:75], v[200:203], v[48:51]
    v_mfma_f32_16x16x32_bf16 v[56:59], v[76:79], v[200:203], v[56:59]
    v_mfma_f32_16x16x32_bf16 v[52:55], v[72:75], v[204:207], v[52:55]
    v_mfma_f32_16x16x32_bf16 v[60:63], v[76:79], v[204:207], v[60:63]
    v_mfma_f32_16x16x32_bf16 v[16:19], a[72:75], v[72:75], v[16:19]
    v_mfma_f32_16x16x32_bf16 v[20:23], a[72:75], v[76:79], v[20:23]
    v_mfma_f32_16x16x32_bf16 v[24:27], a[76:79], v[72:75], v[24:27]
    v_mfma_f32_16x16x32_bf16 v[28:31], a[76:79], v[76:79], v[28:31]
    ds_read_b128 v[72:75], v82 offset:11264
    ds_read_b128 v[76:79], v83 offset:11264
    s_waitcnt lgkmcnt(2)
    v_mfma_f32_16x16x32_bf16 v[32:35], a[208:211], v[64:67], v[32:35]
    v_mfma_f32_16x16x32_bf16 v[36:39], a[208:211], v[68:71], v[36:39]
    v_mfma_f32_16x16x32_bf16 v[40:43], a[212:215], v[64:67], v[40:43]
    v_mfma_f32_16x16x32_bf16 v[44:47], a[212:215], v[68:71], v[44:47]
    v_mfma_f32_16x16x32_bf16 v[48:51], v[64:67], v[208:211], v[48:51]
    v_mfma_f32_16x16x32_bf16 v[56:59], v[68:71], v[208:211], v[56:59]
    v_mfma_f32_16x16x32_bf16 v[52:55], v[64:67], v[212:215], v[52:55]
    v_mfma_f32_16x16x32_bf16 v[60:63], v[68:71], v[212:215], v[60:63]
    v_mfma_f32_16x16x32_bf16 v[16:19], a[80:83], v[64:67], v[16:19]
    v_mfma_f32_16x16x32_bf16 v[20:23], a[80:83], v[68:71], v[20:23]
    v_mfma_f32_16x16x32_bf16 v[24:27], a[84:87], v[64:67], v[24:27]
    v_mfma_f32_16x16x32_bf16 v[28:31], a[84:87], v[68:71], v[28:31]
    ds_read_b128 v[64:67], v80 offset:12288
    ds_read_b128 v[68:71], v81 offset:12288
    s_waitcnt lgkmcnt(2)
    v_mfma_f32_16x16x32_bf16 v[32:35], a[216:219], v[72:75], v[32:35]
    v_mfma_f32_16x16x32_bf16 v[36:39], a[216:219], v[76:79], v[36:39]
    v_mfma_f32_16x16x32_bf16 v[40:43], a[220:223], v[72:75], v[40:43]
    v_mfma_f32_16x16x32_bf16 v[44:47], a[220:223], v[76:79], v[44:47]
    v_mfma_f32_16x16x32_bf16 v[48:51], v[72:75], v[216:219], v[48:51]
    v_mfma_f32_16x16x32_bf16 v[56:59], v[76:79], v[216:219], v[56:59]
    v_mfma_f32_16x16x32_bf16 v[52:55], v[72:75], v[220:223], v[52:55]
    v_mfma_f32_16x16x32_bf16 v[60:63], v[76:79], v[220:223], v[60:63]
    v_mfma_f32_16x16x32_bf16 v[16:19], a[88:91], v[72:75], v[16:19]
    v_mfma_f32_16x16x32_bf16 v[20:23], a[88:91], v[76:79], v[20:23]
    v_mfma_f32_16x16x32_bf16 v[24:27], a[92:95], v[72:75], v[24:27]
    v_mfma_f32_16x16x32_bf16 v[28:31], a[92:95], v[76:79], v[28:31]
    ds_read_b128 v[72:75], v82 offset:13312
    ds_read_b128 v[76:79], v83 offset:13312
    s_waitcnt lgkmcnt(2)
    v_mfma_f32_16x16x32_bf16 v[32:35], a[224:227], v[64:67], v[32:35]
    v_mfma_f32_16x16x32_bf16 v[36:39], a[224:227], v[68:71], v[36:39]
    v_mfma_f32_16x16x32_bf16 v[40:43], a[228:231], v[64:67], v[40:43]
    v_mfma_f32_16x16x32_bf16 v[44:47], a[228:231], v[68:71], v[44:47]
    v_mfma_f32_16x16x32_bf16 v[48:51], v[64:67], v[224:227], v[48:51]
    v_mfma_f32_16x16x32_bf16 v[56:59], v[68:71], v[224:227], v[56:59]
    v_mfma_f32_16x16x32_bf16 v[52:55], v[64:67], v[228:231], v[52:55]
    v_mfma_f32_16x16x32_bf16 v[60:63], v[68:71], v[228:231], v[60:63]
    v_mfma_f32_16x16x32_bf16 v[16:19], a[96:99], v[64:67], v[16:19]
    v_mfma_f32_16x16x32_bf16 v[20:23], a[96:99], v[68:71], v[20:23]
    v_mfma_f32_16x16x32_bf16 v[24:27], a[100:103], v[64:67], v[24:27]
    v_mfma_f32_16x16x32_bf16 v[28:31], a[100:103], v[68:71], v[28:31]
    ds_read_b128 v[64:67], v80 offset:14336
    ds_read_b128 v[68:71], v81 offset:14336
    s_waitcnt lgkmcnt(2)
    v_mfma_f32_16x16x32_bf16 v[32:35], a[232:235], v[72:75], v[32:35]
    v_mfma_f32_16x16x32_bf16 v[36:39], a[232:235], v[76:79], v[36:39]
    v_mfma_f32_16x16x32_bf16 v[40:43], a[236:239], v[72:75], v[40:43]
    v_mfma_f32_16x16x32_bf16 v[44:47], a[236:239], v[76:79], v[44:47]
    v_mfma_f32_16x16x32_bf16 v[48:51], v[72:75], v[232:235], v[48:51]
    v_mfma_f32_16x16x32_bf16 v[56:59], v[76:79], v[232:235], v[56:59]
    v_mfma_f32_16x16x32_bf16 v[52:55], v[72:75], v[236:239], v[52:55]
    v_mfma_f32_16x16x32_bf16 v[60:63], v[76:79], v[236:239], v[60:63]
    v_mfma_f32_16x16x32_bf16 v[16:19], a[104:107], v[72:75], v[16:19]
    v_mfma_f32_16x16x32_bf16 v[20:23], a[104:107], v[76:79], v[20:23]
    v_mfma_f32_16x16x32_bf16 v[24:27], a[108:111], v[72:75], v[24:27]
    v_mfma_f32_16x16x32_bf16 v[28:31], a[108:111], v[76:79], v[28:31]
    ds_read_b128 v[72:75], v82 offset:15360
    ds_read_b128 v[76:79], v83 offset:15360
    s_waitcnt lgkmcnt(2)
    v_mfma_f32_16x16x32_bf16 v[32:35], a[240:243], v[64:67], v[32:35]
    v_mfma_f32_16x16x32_bf16 v[36:39], a[240:243], v[68:71], v[36:39]
    v_mfma_f32_16x16x32_bf16 v[40:43], a[244:247], v[64:67], v[40:43]
    v_mfma_f32_16x16x32_bf16 v[44:47], a[244:247], v[68:71], v[44:47]
    v_mfma_f32_16x16x32_bf16 v[48:51], v[64:67], v[240:243], v[48:51]
    v_mfma_f32_16x16x32_bf16 v[56:59], v[68:71], v[240:243], v[56:59]
    v_mfma_f32_16x16x32_bf16 v[52:55], v[64:67], v[244:247], v[52:55]
    v_mfma_f32_16x16x32_bf16 v[60:63], v[68:71], v[244:247], v[60:63]
    v_mfma_f32_16x16x32_bf16 v[16:19], a[112:115], v[64:67], v[16:19]
    v_mfma_f32_16x16x32_bf16 v[20:23], a[112:115], v[68:71], v[20:23]
    v_mfma_f32_16x16x32_bf16 v[24:27], a[116:119], v[64:67], v[24:27]
    v_mfma_f32_16x16x32_bf16 v[28:31], a[116:119], v[68:71], v[28:31]
    s_waitcnt lgkmcnt(0)
    v_mfma_f32_16x16x32_bf16 v[32:35], a[248:251], v[72:75], v[32:35]
    v_mfma_f32_16x16x32_bf16 v[36:39], a[248:251], v[76:79], v[36:39]
    v_mfma_f32_16x16x32_bf16 v[40:43], a[252:255], v[72:75], v[40:43]
    v_mfma_f32_16x16x32_bf16 v[44:47], a[252:255], v[76:79], v[44:47]
    v_mfma_f32_16x16x32_bf16 v[48:51], v[72:75], v[248:251], v[48:51]
    v_mfma_f32_16x16x32_bf16 v[56:59], v[76:79], v[248:251], v[56:59]
    v_mfma_f32_16x16x32_bf16 v[52:55], v[72:75], v[252:255], v[52:55]
    v_mfma_f32_16x16x32_bf16 v[60:63], v[76:79], v[252:255], v[60:63]
    v_mfma_f32_16x16x32_bf16 v[16:19], a[120:123], v[72:75], v[16:19]
    v_mfma_f32_16x16x32_bf16 v[20:23], a[120:123], v[76:79], v[20:23]
    v_mfma_f32_16x16x32_bf16 v[24:27], a[124:127], v[72:75], v[24:27]
    v_mfma_f32_16x16x32_bf16 v[28:31], a[124:127], v[76:79], v[28:31]
    v_xor_b32 v80, 0x8000, v80
    v_xor_b32 v81, 0x8000, v81
    v_xor_b32 v82, 0x8000, v82
    v_xor_b32 v83, 0x8000, v83
    v_mul_f32 v32, s33, v32
    v_mul_f32 v33, s33, v33
    v_mul_f32 v34, s33, v34
    v_mul_f32 v35, s33, v35
    v_mul_f32 v36, s33, v36
    v_mul_f32 v37, s33, v37
    v_mul_f32 v38, s33, v38
    v_mul_f32 v39, s33, v39
    v_mul_f32 v40, s33, v40
    v_mul_f32 v41, s33, v41
    v_mul_f32 v42, s33, v42
    v_mul_f32 v43, s33, v43
    v_mul_f32 v44, s33, v44
    v_mul_f32 v45, s33, v45
    v_mul_f32 v46, s33, v46
    v_mul_f32 v47, s33, v47
    v_cvt_pk_bf16_f32 v88, v32, v40
    v_cvt_pk_bf16_f32 v89, v33, v41
    v_cvt_pk_bf16_f32 v90, v34, v42
    v_cvt_pk_bf16_f32 v91, v35, v43
    v_cvt_pk_bf16_f32 v92, v36, v44
    v_cvt_pk_bf16_f32 v93, v37, v45
    v_cvt_pk_bf16_f32 v94, v38, v46
    v_cvt_pk_bf16_f32 v95, v39, v47
    v_cvt_pk_bf16_f32 v96, v48, v49
    v_cvt_pk_bf16_f32 v97, v50, v51
    v_cvt_pk_bf16_f32 v98, v56, v57
    v_cvt_pk_bf16_f32 v99, v58, v59
    v_cvt_pk_bf16_f32 v100, v52, v53
    v_cvt_pk_bf16_f32 v101, v54, v55
    v_cvt_pk_bf16_f32 v102, v60, v61
    v_cvt_pk_bf16_f32 v103, v62, v63
    v_cvt_pk_bf16_f32 v104, v16, v24
    v_cvt_pk_bf16_f32 v105, v17, v25
    v_cvt_pk_bf16_f32 v106, v18, v26
    v_cvt_pk_bf16_f32 v107, v19, v27
    v_cvt_pk_bf16_f32 v108, v20, v28
    v_cvt_pk_bf16_f32 v109, v21, v29
    v_cvt_pk_bf16_f32 v110, v22, v30
    v_cvt_pk_bf16_f32 v111, v23, v31
    s_mul_i32 s24, s23, 0x82000
    s_lshl_b32 s36, s20, 14
    s_add_u32 s24, s24, s36
    s_add_u32 s24, s24, 0x1000000
    s_lshr_b32 s36, s21, 1
    s_lshl_b32 s36, s36, 12
    s_xor_b32 s37, s36, 4096
    s_add_u32 s36, s36, s24
    s_add_u32 s37, s37, s24
    buffer_store_dwordx4 v[88:91], v9, s[8:11], s36 offen sc1
    buffer_store_dwordx4 v[92:95], v9, s[8:11], s37 offen sc1
    s_add_u32 s24, s24, 8192
    buffer_store_dwordx4 v[96:99], v2, s[8:11], s24 offen sc1
    buffer_store_dwordx4 v[100:103], v2, s[8:11], s24 offen offset:1024 sc1
    s_add_u32 s36, s36, 0x7000000
    s_add_u32 s37, s37, 0x7000000
    buffer_store_dwordx4 v[104:107], v9, s[8:11], s36 offen sc1
    buffer_store_dwordx4 v[108:111], v9, s[8:11], s37 offen sc1
    s_lshl_b32 s25, s20, 8
    s_lshl_b32 s36, s23, 2
    s_add_u32 s25, s25, s36
    s_add_u32 s25, s25, 0x190000
    s_add_u32 s23, s23, 6
    s_cmp_lt_u32 s23, 64
    s_cbranch_scc1 L_P1
    v_mov_b32 v20, -1
    v_mov_b32 v21, -1
    v_mov_b32 v22, -1
    v_mov_b32 v23, -1
    s_lshl_b32 s24, s22, 21
    s_lshl_b32 s36, s20, 15
    s_add_u32 s24, s24, s36
    s_add_u32 s36, s24, 0x4000000
    buffer_store_dwordx4 v[20:23], v11, s[8:11], s36 offen sc1
    s_add_u32 s36, s24, 0x4001000
    buffer_store_dwordx4 v[20:23], v11, s[8:11], s36 offen sc1
    s_add_u32 s36, s24, 0x4002000
    buffer_store_dwordx4 v[20:23], v11, s[8:11], s36 offen sc1
    s_add_u32 s36, s24, 0x4003000
    buffer_store_dwordx4 v[20:23], v11, s[8:11], s36 offen sc1
    s_add_u32 s36, s24, 0x4004000
    buffer_store_dwordx4 v[20:23], v11, s[8:11], s36 offen sc1
    s_add_u32 s36, s24, 0x4005000
    buffer_store_dwordx4 v[20:23], v11, s[8:11], s36 offen sc1
    s_add_u32 s36, s24, 0x4006000
    buffer_store_dwordx4 v[20:23], v11, s[8:11], s36 offen sc1
    s_add_u32 s36, s24, 0x4007000
    buffer_store_dwordx4 v[20:23], v11, s[8:11], s36 offen sc1
    s_add_u32 s36, s24, 0x4100000
    buffer_store_dwordx4 v[20:23], v11, s[8:11], s36 offen sc1
    s_add_u32 s36, s24, 0x4101000
    buffer_store_dwordx4 v[20:23], v11, s[8:11], s36 offen sc1
    s_add_u32 s36, s24, 0x4102000
    buffer_store_dwordx4 v[20:23], v11, s[8:11], s36 offen sc1
    s_add_u32 s36, s24, 0x4103000
    buffer_store_dwordx4 v[20:23], v11, s[8:11], s36 offen sc1
    s_add_u32 s36, s24, 0x4104000
    buffer_store_dwordx4 v[20:23], v11, s[8:11], s36 offen sc1
    s_add_u32 s36, s24, 0x4105000
    buffer_store_dwordx4 v[20:23], v11, s[8:11], s36 offen sc1
    s_add_u32 s36, s24, 0x4106000
    buffer_store_dwordx4 v[20:23], v11, s[8:11], s36 offen sc1
    s_add_u32 s36, s24, 0x4107000
    buffer_store_dwordx4 v[20:23], v11, s[8:11], s36 offen sc1
    s_waitcnt vmcnt(0)
    s_barrier
    v_cmp_ne_u32 vcc, 0, v0
    v_mov_b32 v15, 0x40000000
    v_mov_b32 v14, 1
    v_cndmask_b32 v15, v0, v15, vcc
    buffer_store_dword v14, v15, s[8:11], s25 offen sc1
    s_lshl_b32 s25, s22, 7
    s_lshl_b32 s36, s20, 2
    s_add_u32 s36, s36, s25
    s_add_u32 s36, s36, 0x192000
    v_cmp_ne_u32 vcc, 0, v0
    v_mov_b32 v15, 0x40000000
    v_mov_b32 v14, 1
    v_cndmask_b32 v15, v0, v15, vcc
    buffer_store_dword v14, v15, s[8:11], s36 offen sc1
    s_mov_b32 s96, s54
    s_and_b32 s97, s55, 0xffff
    s_mov_b32 s98, 0x400000
    s_mov_b32 s99, 0x20000
    v_mov_b32 v15, 0x0
    v_bfe_u32 v14, v0, 0, 1
    s_mov_b32 s38, 0x10
    v_mad_u32_u24 v15, v14, s38, v15
    v_bfe_u32 v14, v0, 1, 1
    s_mov_b32 s38, 0x20
    v_mad_u32_u24 v15, v14, s38, v15
    v_bfe_u32 v14, v0, 2, 1
    s_mov_b32 s38, 0x40
    v_mad_u32_u24 v15, v14, s38, v15
    v_bfe_u32 v14, v0, 3, 1
    s_mov_b32 s38, 0x80
    v_mad_u32_u24 v15, v14, s38, v15
    v_bfe_u32 v14, v0, 4, 1
    s_mov_b32 s38, 0x1000
    v_mad_u32_u24 v15, v14, s38, v15
    v_bfe_u32 v14, v0, 5, 1
    s_mov_b32 s38, 0x2000
    v_mad_u32_u24 v15, v14, s38, v15
    v_bfe_u32 v14, v0, 6, 1
    s_mov_b32 s38, 0x100
    v_mad_u32_u24 v15, v14, s38, v15
    v_bfe_u32 v14, v0, 7, 1
    s_mov_b32 s38, 0x200
    v_mad_u32_u24 v15, v14, s38, v15
    s_lshl_b32 s36, s20, 17
    s_add_u32 s37, s36, 0x0
    buffer_load_dwordx4 v[16:19], v15, s[96:99], s37 offen
    s_add_u32 s37, s36, 0x4000
    buffer_load_dwordx4 v[20:23], v15, s[96:99], s37 offen
    s_add_u32 s37, s36, 0x400
    buffer_load_dwordx4 v[24:27], v15, s[96:99], s37 offen
    s_add_u32 s37, s36, 0x4400
    buffer_load_dwordx4 v[28:31], v15, s[96:99], s37 offen
    s_add_u32 s37, s36, 0x800
    buffer_load_dwordx4 v[32:35], v15, s[96:99], s37 offen
    s_add_u32 s37, s36, 0x4800
    buffer_load_dwordx4 v[36:39], v15, s[96:99], s37 offen
    s_add_u32 s37, s36, 0xc00
    buffer_load_dwordx4 v[40:43], v15, s[96:99], s37 offen
    s_add_u32 s37, s36, 0x4c00
    buffer_load_dwordx4 v[44:47], v15, s[96:99], s37 offen
    s_add_u32 s37, s36, 0x8000
    buffer_load_dwordx4 v[48:51], v15, s[96:99], s37 offen
    s_add_u32 s37, s36, 0xc000
    buffer_load_dwordx4 v[52:55], v15, s[96:99], s37 offen
    s_add_u32 s37, s36, 0x8400
    buffer_load_dwordx4 v[56:59], v15, s[96:99], s37 offen
    s_add_u32 s37, s36, 0xc400
    buffer_load_dwordx4 v[60:63], v15, s[96:99], s37 offen
    s_add_u32 s37, s36, 0x8800
    buffer_load_dwordx4 v[64:67], v15, s[96:99], s37 offen
    s_add_u32 s37, s36, 0xc800
    buffer_load_dwordx4 v[68:71], v15, s[96:99], s37 offen
    s_add_u32 s37, s36, 0x8c00
    buffer_load_dwordx4 v[72:75], v15, s[96:99], s37 offen
    s_add_u32 s37, s36, 0xcc00
    buffer_load_dwordx4 v[76:79], v15, s[96:99], s37 offen
    s_add_u32 s37, s36, 0x10000
    buffer_load_dwordx4 v[80:83], v15, s[96:99], s37 offen
    s_add_u32 s37, s36, 0x14000
    buffer_load_dwordx4 v[84:87], v15, s[96:99], s37 offen
    s_add_u32 s37, s36, 0x10400
    buffer_load_dwordx4 v[88:91], v15, s[96:99], s37 offen
    s_add_u32 s37, s36, 0x14400
    buffer_load_dwordx4 v[92:95], v15, s[96:99], s37 offen
    s_add_u32 s37, s36, 0x10800
    buffer_load_dwordx4 v[96:99], v15, s[96:99], s37 offen
    s_add_u32 s37, s36, 0x14800
    buffer_load_dwordx4 v[100:103], v15, s[96:99], s37 offen
    s_add_u32 s37, s36, 0x10c00
    buffer_load_dwordx4 v[104:107], v15, s[96:99], s37 offen
    s_add_u32 s37, s36, 0x14c00
    buffer_load_dwordx4 v[108:111], v15, s[96:99], s37 offen
    s_waitcnt vmcnt(16)
    v_perm_b32 v112, v20, v16, s34
    v_perm_b32 v113, v28, v24, s34
    v_perm_b32 v114, v36, v32, s34
    v_perm_b32 v115, v44, v40, s34
    ds_write_b128 v7, v[112:115] offset:0
    v_perm_b32 v116, v20, v16, s35
    v_perm_b32 v117, v28, v24, s35
    v_perm_b32 v118, v36, v32, s35
    v_perm_b32 v119, v44, v40, s35
    ds_write_b128 v7, v[116:119] offset:1024
    v_perm_b32 v120, v21, v17, s34
    v_perm_b32 v121, v29, v25, s34
    v_perm_b32 v122, v37, v33, s34
    v_perm_b32 v123, v45, v41, s34
    ds_write_b128 v7, v[120:123] offset:2048
    v_perm_b32 v124, v21, v17, s35
    v_perm_b32 v125, v29, v25, s35
    v_perm_b32 v126, v37, v33, s35
    v_perm_b32 v127, v45, v41, s35
    ds_write_b128 v7, v[124:127] offset:3072
    s_waitcnt lgkmcnt(0)
    v_perm_b32 v112, v22, v18, s34
    v_perm_b32 v113, v30, v26, s34
    v_perm_b32 v114, v38, v34, s34
    v_perm_b32 v115, v46, v42, s34
    ds_write_b128 v7, v[112:115] offset:4096
    v_perm_b32 v116, v22, v18, s35
    v_perm_b32 v117, v30, v26, s35
    v_perm_b32 v118, v38, v34, s35
    v_perm_b32 v119, v46, v42, s35
    ds_write_b128 v7, v[116:119] offset:5120
    v_perm_b32 v120, v23, v19, s34
    v_perm_b32 v121, v31, v27, s34
    v_perm_b32 v122, v39, v35, s34
    v_perm_b32 v123, v47, v43, s34
    ds_write_b128 v7, v[120:123] offset:6144
    v_perm_b32 v124, v23, v19, s35
    v_perm_b32 v125, v31, v27, s35
    v_perm_b32 v126, v39, v35, s35
    v_perm_b32 v127, v47, v43, s35
    ds_write_b128 v7, v[124:127] offset:7168
    s_waitcnt lgkmcnt(0)
    s_add_u32 s37, s36, 0x18000
    buffer_load_dwordx4 v[16:19], v15, s[96:99], s37 offen
    s_add_u32 s37, s36, 0x1c000
    buffer_load_dwordx4 v[20:23], v15, s[96:99], s37 offen
    s_add_u32 s37, s36, 0x18400
    buffer_load_dwordx4 v[24:27], v15, s[96:99], s37 offen
    s_add_u32 s37, s36, 0x1c400
    buffer_load_dwordx4 v[28:31], v15, s[96:99], s37 offen
    s_add_u32 s37, s36, 0x18800
    buffer_load_dwordx4 v[32:35], v15, s[96:99], s37 offen
    s_add_u32 s37, s36, 0x1c800
    buffer_load_dwordx4 v[36:39], v15, s[96:99], s37 offen
    s_add_u32 s37, s36, 0x18c00
    buffer_load_dwordx4 v[40:43], v15, s[96:99], s37 offen
    s_add_u32 s37, s36, 0x1cc00
    buffer_load_dwordx4 v[44:47], v15, s[96:99], s37 offen
    s_waitcnt vmcnt(16)
    v_perm_b32 v112, v52, v48, s34
    v_perm_b32 v113, v60, v56, s34
    v_perm_b32 v114, v68, v64, s34
    v_perm_b32 v115, v76, v72, s34
    ds_write_b128 v7, v[112:115] offset:8192
    v_perm_b32 v116, v52, v48, s35
    v_perm_b32 v117, v60, v56, s35
    v_perm_b32 v118, v68, v64, s35
    v_perm_b32 v119, v76, v72, s35
    ds_write_b128 v7, v[116:119] offset:9216
    v_perm_b32 v120, v53, v49, s34
    v_perm_b32 v121, v61, v57, s34
    v_perm_b32 v122, v69, v65, s34
    v_perm_b32 v123, v77, v73, s34
    ds_write_b128 v7, v[120:123] offset:10240
    v_perm_b32 v124, v53, v49, s35
    v_perm_b32 v125, v61, v57, s35
    v_perm_b32 v126, v69, v65, s35
    v_perm_b32 v127, v77, v73, s35
    ds_write_b128 v7, v[124:127] offset:11264
    s_waitcnt lgkmcnt(0)
    v_perm_b32 v112, v54, v50, s34
    v_perm_b32 v113, v62, v58, s34
    v_perm_b32 v114, v70, v66, s34
    v_perm_b32 v115, v78, v74, s34
    ds_write_b128 v7, v[112:115] offset:12288
    v_perm_b32 v116, v54, v50, s35
    v_perm_b32 v117, v62, v58, s35
    v_perm_b32 v118, v70, v66, s35
    v_perm_b32 v119, v78, v74, s35
    ds_write_b128 v7, v[116:119] offset:13312
    v_perm_b32 v120, v55, v51, s34
    v_perm_b32 v121, v63, v59, s34
    v_perm_b32 v122, v71, v67, s34
    v_perm_b32 v123, v79, v75, s34
    ds_write_b128 v7, v[120:123] offset:14336
    v_perm_b32 v124, v55, v51, s35
    v_perm_b32 v125, v63, v59, s35
    v_perm_b32 v126, v71, v67, s35
    v_perm_b32 v127, v79, v75, s35
    ds_write_b128 v7, v[124:127] offset:15360
    s_waitcnt lgkmcnt(0)
    s_waitcnt vmcnt(8)
    v_perm_b32 v112, v84, v80, s34
    v_perm_b32 v113, v92, v88, s34
    v_perm_b32 v114, v100, v96, s34
    v_perm_b32 v115, v108, v104, s34
    ds_write_b128 v7, v[112:115] offset:16384
    v_perm_b32 v116, v84, v80, s35
    v_perm_b32 v117, v92, v88, s35
    v_perm_b32 v118, v100, v96, s35
    v_perm_b32 v119, v108, v104, s35
    ds_write_b128 v7, v[116:119] offset:17408
    v_perm_b32 v120, v85, v81, s34
    v_perm_b32 v121, v93, v89, s34
    v_perm_b32 v122, v101, v97, s34
    v_perm_b32 v123, v109, v105, s34
    ds_write_b128 v7, v[120:123] offset:18432
    v_perm_b32 v124, v85, v81, s35
    v_perm_b32 v125, v93, v89, s35
    v_perm_b32 v126, v101, v97, s35
    v_perm_b32 v127, v109, v105, s35
    ds_write_b128 v7, v[124:127] offset:19456
    s_waitcnt lgkmcnt(0)
    v_perm_b32 v112, v86, v82, s34
    v_perm_b32 v113, v94, v90, s34
    v_perm_b32 v114, v102, v98, s34
    v_perm_b32 v115, v110, v106, s34
    ds_write_b128 v7, v[112:115] offset:20480
    v_perm_b32 v116, v86, v82, s35
    v_perm_b32 v117, v94, v90, s35
    v_perm_b32 v118, v102, v98, s35
    v_perm_b32 v119, v110, v106, s35
    ds_write_b128 v7, v[116:119] offset:21504
    v_perm_b32 v120, v87, v83, s34
    v_perm_b32 v121, v95, v91, s34
    v_perm_b32 v122, v103, v99, s34
    v_perm_b32 v123, v111, v107, s34
    ds_write_b128 v7, v[120:123] offset:22528
    v_perm_b32 v124, v87, v83, s35
    v_perm_b32 v125, v95, v91, s35
    v_perm_b32 v126, v103, v99, s35
    v_perm_b32 v127, v111, v107, s35
    ds_write_b128 v7, v[124:127] offset:23552
    s_waitcnt lgkmcnt(0)
    s_waitcnt vmcnt(0)
    v_perm_b32 v112, v20, v16, s34
    v_perm_b32 v113, v28, v24, s34
    v_perm_b32 v114, v36, v32, s34
    v_perm_b32 v115, v44, v40, s34
    ds_write_b128 v7, v[112:115] offset:24576
    v_perm_b32 v116, v20, v16, s35
    v_perm_b32 v117, v28, v24, s35
    v_perm_b32 v118, v36, v32, s35
    v_perm_b32 v119, v44, v40, s35
    ds_write_b128 v7, v[116:119] offset:25600
    v_perm_b32 v120, v21, v17, s34
    v_perm_b32 v121, v29, v25, s34
    v_perm_b32 v122, v37, v33, s34
    v_perm_b32 v123, v45, v41, s34
    ds_write_b128 v7, v[120:123] offset:26624
    v_perm_b32 v124, v21, v17, s35
    v_perm_b32 v125, v29, v25, s35
    v_perm_b32 v126, v37, v33, s35
    v_perm_b32 v127, v45, v41, s35
    ds_write_b128 v7, v[124:127] offset:27648
    s_waitcnt lgkmcnt(0)
    v_perm_b32 v112, v22, v18, s34
    v_perm_b32 v113, v30, v26, s34
    v_perm_b32 v114, v38, v34, s34
    v_perm_b32 v115, v46, v42, s34
    ds_write_b128 v7, v[112:115] offset:28672
    v_perm_b32 v116, v22, v18, s35
    v_perm_b32 v117, v30, v26, s35
    v_perm_b32 v118, v38, v34, s35
    v_perm_b32 v119, v46, v42, s35
    ds_write_b128 v7, v[116:119] offset:29696
    v_perm_b32 v120, v23, v19, s34
    v_perm_b32 v121, v31, v27, s34
    v_perm_b32 v122, v39, v35, s34
    v_perm_b32 v123, v47, v43, s34
    ds_write_b128 v7, v[120:123] offset:30720
    v_perm_b32 v124, v23, v19, s35
    v_perm_b32 v125, v31, v27, s35
    v_perm_b32 v126, v39, v35, s35
    v_perm_b32 v127, v47, v43, s35
    ds_write_b128 v7, v[124:127] offset:31744
    s_waitcnt lgkmcnt(0)
    s_lshl_b32 s25, s22, 7
    s_add_u32 s25, s25, 0x192000
    v_lshrrev_b32 v15, 2, v1
    v_and_b32 v15, 127, v15
L_TPI:
    buffer_load_dword v14, v15, s[8:11], s25 offen sc1
    s_add_u32 s32, s32, 1
    s_cmp_gt_u32 s32, 200000
    s_waitcnt vmcnt(0)
    s_cbranch_scc1 L_TPI_ok
    v_cmp_eq_u32 vcc, 0, v14
    s_cbranch_vccz L_TPI_ok
    s_sleep 8
    s_branch L_TPI
L_TPI_ok:
    s_mov_b32 s23, s22
    s_mov_b32 s29, 0
    s_mov_b32 s30, 0x40000000
    s_mul_i32 s24, s23, 0x82000
    s_lshl_b32 s36, s20, 14
    s_add_u32 s24, s24, s36
    s_add_u32 s24, s24, 0x1000000
    s_add_u32 s36, s24, 0
    s_add_u32 s37, s36, 0x7000000
    buffer_load_dwordx4 a[32:35], v1, s[8:11], s36 offen offset:0 sc1
    buffer_load_dwordx4 a[0:3], v1, s[8:11], s37 offen offset:0 sc1
    buffer_load_dwordx4 a[36:39], v1, s[8:11], s36 offen offset:1024 sc1
    buffer_load_dwordx4 a[4:7], v1, s[8:11], s37 offen offset:1024 sc1
    buffer_load_dwordx4 a[40:43], v1, s[8:11], s36 offen offset:2048 sc1
    buffer_load_dwordx4 a[8:11], v1, s[8:11], s37 offen offset:2048 sc1
    buffer_load_dwordx4 a[44:47], v1, s[8:11], s36 offen offset:3072 sc1
    buffer_load_dwordx4 a[12:15], v1, s[8:11], s37 offen offset:3072 sc1
    s_add_u32 s36, s24, 4096
    s_add_u32 s37, s36, 0x7000000
    buffer_load_dwordx4 a[48:51], v1, s[8:11], s36 offen offset:0 sc1
    buffer_load_dwordx4 a[16:19], v1, s[8:11], s37 offen offset:0 sc1
    buffer_load_dwordx4 a[52:55], v1, s[8:11], s36 offen offset:1024 sc1
    buffer_load_dwordx4 a[20:23], v1, s[8:11], s37 offen offset:1024 sc1
    buffer_load_dwordx4 a[56:59], v1, s[8:11], s36 offen offset:2048 sc1
    buffer_load_dwordx4 a[24:27], v1, s[8:11], s37 offen offset:2048 sc1
    buffer_load_dwordx4 a[60:63], v1, s[8:11], s36 offen offset:3072 sc1
    buffer_load_dwordx4 a[28:31], v1, s[8:11], s37 offen offset:3072 sc1
    s_lshr_b32 s36, s21, 1
    s_lshl_b32 s36, s36, 3
    s_xor_b32 s37, s36, 8
    s_add_u32 s24, s24, 8192
    s_add_u32 s36, s36, s24
    s_add_u32 s37, s37, s24
    buffer_load_dwordx2 a[64:65], v2, s[8:11], s36 offen offset:0 sc1
    buffer_load_dwordx2 a[66:67], v2, s[8:11], s37 offen offset:0 sc1
    buffer_load_dwordx2 a[68:69], v2, s[8:11], s36 offen offset:1024 sc1
    buffer_load_dwordx2 a[70:71], v2, s[8:11], s37 offen offset:1024 sc1
L_P2:
    s_and_b32 s36, s29, 1
    s_lshl_b32 s36, s36, 20
    s_lshl_b32 s26, s22, 21
    s_add_u32 s26, s26, s36
    s_add_u32 s26, s26, 0x4000000
    s_bfe_u32 s27, s29, 0x10001
    s_lshl_b32 s24, s23, 13
    s_add_u32 s24, s24, 0x100000
    s_max_u32 s25, s23, 1
    s_lshl_b32 s25, s25, 13
    s_add_u32 s25, s25, 0xfe000
    buffer_load_dwordx4 v[48:51], v2, s[8:11], s24 offen sc1
    buffer_load_dwordx4 v[52:55], v2, s[8:11], s24 offen offset:1024 sc1
    s_lshl_b32 s36, s23, 5
    s_add_u32 s36, s36, s20
    s_lshl_b32 s36, s36, 10
    buffer_load_dword a72, v12, s[12:15], s36 offen
    buffer_load_dword a73, v12, s[92:95], 0 offen
    s_waitcnt vmcnt(4)
    v_cmp_ne_u32 vcc, 0, v1
    v_mov_b32 v15, 0x40000000
    v_mov_b32 v14, 0
    v_cndmask_b32 v15, v1, v15, vcc
    buffer_store_dword v14, v15, s[8:11], s30 offen sc1
    v_mfma_f32_16x16x32_bf16 v[80:83], a[32:35], a[0:3], 0
    v_mfma_f32_16x16x32_bf16 v[80:83], a[36:39], a[4:7], v[80:83]
    v_mfma_f32_16x16x32_bf16 v[80:83], a[40:43], a[8:11], v[80:83]
    v_mfma_f32_16x16x32_bf16 v[80:83], a[44:47], a[12:15], v[80:83]
    v_mfma_f32_16x16x32_bf16 v[88:91], a[48:51], a[16:19], 0
    v_mfma_f32_16x16x32_bf16 v[88:91], a[52:55], a[20:23], v[88:91]
    v_mfma_f32_16x16x32_bf16 v[88:91], a[56:59], a[24:27], v[88:91]
    v_mfma_f32_16x16x32_bf16 v[88:91], a[60:63], a[28:31], v[88:91]
    v_mfma_f32_16x16x32_bf16 v[84:87], a[32:35], a[16:19], 0
    v_mfma_f32_16x16x32_bf16 v[84:87], a[36:39], a[20:23], v[84:87]
    v_mfma_f32_16x16x32_bf16 v[84:87], a[40:43], a[24:27], v[84:87]
    v_mfma_f32_16x16x32_bf16 v[84:87], a[44:47], a[28:31], v[84:87]
    v_cndmask_b32 v80, v13, v80, s[64:65]
    v_cndmask_b32 v81, v13, v81, s[66:67]
    v_cndmask_b32 v82, v13, v82, s[68:69]
    v_cndmask_b32 v83, v13, v83, s[70:71]
    v_cndmask_b32 v88, v13, v88, s[64:65]
    v_cndmask_b32 v89, v13, v89, s[66:67]
    v_cndmask_b32 v90, v13, v90, s[68:69]
    v_cndmask_b32 v91, v13, v91, s[70:71]
    v_max_f32 v116, v80, v81
    v_max3_f32 v116, v116, v82, v83
    v_max_f32 v117, v84, v85
    v_max3_f32 v117, v117, v86, v87
    v_max3_f32 v117, v117, v88, v89
    v_max3_f32 v117, v117, v90, v91
    v_mov_b32 v14, v116
    s_nop 1
    v_permlane16_swap_b32 v116, v14
    v_max_f32 v116, v116, v14
    v_mov_b32 v14, v117
    s_nop 1
    v_permlane16_swap_b32 v117, v14
    v_max_f32 v117, v117, v14
    v_mov_b32 v14, v116
    s_nop 1
    v_permlane32_swap_b32 v116, v14
    v_max_f32 v116, v116, v14
    v_mov_b32 v14, v117
    s_nop 1
    v_permlane32_swap_b32 v117, v14
    v_max_f32 v117, v117, v14
    v_sub_f32 v80, v80, v116
    v_exp_f32 v80, v80
    v_sub_f32 v81, v81, v116
    v_exp_f32 v81, v81
    v_sub_f32 v82, v82, v116
    v_exp_f32 v82, v82
    v_sub_f32 v83, v83, v116
    v_exp_f32 v83, v83
    v_sub_f32 v84, v84, v117
    v_exp_f32 v84, v84
    v_sub_f32 v85, v85, v117
    v_exp_f32 v85, v85
    v_sub_f32 v86, v86, v117
    v_exp_f32 v86, v86
    v_sub_f32 v87, v87, v117
    v_exp_f32 v87, v87
    v_sub_f32 v88, v88, v117
    v_exp_f32 v88, v88
    v_sub_f32 v89, v89, v117
    v_exp_f32 v89, v89
    v_sub_f32 v90, v90, v117
    v_exp_f32 v90, v90
    v_sub_f32 v91, v91, v117
    v_exp_f32 v91, v91
    v_cvt_pk_bf16_f32 v100, v80, v81
    v_cvt_pk_bf16_f32 v101, v82, v83
    v_mov_b64 v[102:103], 0
    v_cvt_pk_bf16_f32 v104, v84, v85
    v_cvt_pk_bf16_f32 v105, v86, v87
    v_cvt_pk_bf16_f32 v106, v88, v89
    v_cvt_pk_bf16_f32 v107, v90, v91
    v_mov_b64 v[108:109], s[4:5]
    v_mov_b64 v[110:111], s[4:5]
    v_cndmask_b32 v112, 0, v108, s[72:73]
    v_cndmask_b32 v113, 0, v108, s[72:73]
    v_mfma_f32_16x16x32_bf16 v[16:19], v[108:111], v[100:103], 0
    v_mfma_f32_16x16x32_bf16 v[24:27], a[64:67], v[100:103], 0
    v_mfma_f32_16x16x32_bf16 v[28:31], a[68:71], v[100:103], 0
    v_mfma_f32_16x16x32_bf16 v[20:23], v[108:111], v[104:107], 0
    v_mfma_f32_16x16x32_bf16 v[32:35], a[64:67], v[104:107], 0
    v_mfma_f32_16x16x32_bf16 v[36:39], a[68:71], v[104:107], 0
    s_branch L_P2_chk
L_P2_far:
    buffer_load_dword v14, v2, s[8:11], s25 offen sc1
    s_add_u32 s32, s32, 1
    s_cmp_gt_u32 s32, 200000
    s_waitcnt vmcnt(0)
    s_cbranch_scc1 L_P2_poll
    v_cmp_eq_u32 vcc, -1, v14
    s_cbranch_vccz L_P2_near
    s_sleep 12
    s_branch L_P2_far
L_P2_near:
    s_mov_b32 s25, 0x40000000
L_P2_poll:
    buffer_load_dwordx4 v[48:51], v2, s[8:11], s24 offen sc1
    buffer_load_dwordx4 v[52:55], v2, s[8:11], s24 offen offset:1024 sc1
L_P2_chk:
    s_add_u32 s32, s32, 1
    s_waitcnt vmcnt(0)
    ds_write_b128 v2, v[48:51] offset:20480
    ds_write_b128 v2, v[52:55] offset:21504
    v_max3_u32 v14, v48, v49, v50
    v_max3_u32 v15, v51, v52, v53
    v_max3_u32 v14, v14, v54, v55
    v_max_u32 v14, v14, v15
    v_cmp_eq_u32 vcc, -1, v14
    s_cbranch_vccz L_P2_got
    s_cmp_gt_u32 s32, 200000
    s_cbranch_scc1 L_P2_got
    s_cmp_eq_u32 s25, 0x40000000
    s_cbranch_scc1 L_P2_poll
    s_branch L_P2_far
L_P2_got:
    s_waitcnt lgkmcnt(0)
    s_barrier
    ds_read_b128 v[48:51], v8 offset:0
    ds_read_b128 v[52:55], v8 offset:2048
    ds_read_b128 v[56:59], v8 offset:4096
    ds_read_b128 v[60:63], v8 offset:6144
    s_waitcnt lgkmcnt(3)
    v_mfma_f32_16x16x32_bf16 v[80:83], a[128:131], v[48:51], 0
    v_mfma_f32_16x16x32_bf16 v[84:87], a[132:135], v[48:51], 0
    ds_read_b128 v[48:51], v8 offset:512
    s_waitcnt lgkmcnt(3)
    v_mfma_f32_16x16x32_bf16 v[80:83], a[136:139], v[52:55], v[80:83]
    v_mfma_f32_16x16x32_bf16 v[84:87], a[140:143], v[52:55], v[84:87]
    ds_read_b128 v[52:55], v8 offset:2560
    s_waitcnt lgkmcnt(3)
    v_mfma_f32_16x16x32_bf16 v[80:83], a[144:147], v[56:59], v[80:83]
    v_mfma_f32_16x16x32_bf16 v[84:87], a[148:151], v[56:59], v[84:87]
    ds_read_b128 v[56:59], v8 offset:4608
    s_waitcnt lgkmcnt(3)
    v_mfma_f32_16x16x32_bf16 v[80:83], a[152:155], v[60:63], v[80:83]
    v_mfma_f32_16x16x32_bf16 v[84:87], a[156:159], v[60:63], v[84:87]
    ds_read_b128 v[60:63], v8 offset:6656
    s_waitcnt lgkmcnt(3)
    v_mfma_f32_16x16x32_bf16 v[80:83], a[160:163], v[48:51], v[80:83]
    v_mfma_f32_16x16x32_bf16 v[84:87], a[164:167], v[48:51], v[84:87]
    ds_read_b128 v[48:51], v8 offset:1024
    s_waitcnt lgkmcnt(3)
    v_mfma_f32_16x16x32_bf16 v[80:83], a[168:171], v[52:55], v[80:83]
    v_mfma_f32_16x16x32_bf16 v[84:87], a[172:175], v[52:55], v[84:87]
    ds_read_b128 v[52:55], v8 offset:3072
    s_waitcnt lgkmcnt(3)
    v_mfma_f32_16x16x32_bf16 v[80:83], a[176:179], v[56:59], v[80:83]
    v_mfma_f32_16x16x32_bf16 v[84:87], a[180:183], v[56:59], v[84:87]
    ds_read_b128 v[56:59], v8 offset:5120
    s_waitcnt lgkmcnt(3)
    v_mfma_f32_16x16x32_bf16 v[80:83], a[184:187], v[60:63], v[80:83]
    v_mfma_f32_16x16x32_bf16 v[84:87], a[188:191], v[60:63], v[84:87]
    ds_read_b128 v[60:63], v8 offset:7168
    s_waitcnt lgkmcnt(3)
    v_mfma_f32_16x16x32_bf16 v[80:83], a[192:195], v[48:51], v[80:83]
    v_mfma_f32_16x16x32_bf16 v[84:87], a[196:199], v[48:51], v[84:87]
    ds_read_b128 v[48:51], v8 offset:1536
    s_waitcnt lgkmcnt(3)
    v_mfma_f32_16x16x32_bf16 v[80:83], a[200:203], v[52:55], v[80:83]
    v_mfma_f32_16x16x32_bf16 v[84:87], a[204:207], v[52:55], v[84:87]
    ds_read_b128 v[52:55], v8 offset:3584
    s_waitcnt lgkmcnt(3)
    v_mfma_f32_16x16x32_bf16 v[80:83], a[208:211], v[56:59], v[80:83]
    v_mfma_f32_16x16x32_bf16 v[84:87], a[212:215], v[56:59], v[84:87]
    ds_read_b128 v[56:59], v8 offset:5632
    s_waitcnt lgkmcnt(3)
    v_mfma_f32_16x16x32_bf16 v[80:83], a[216:219], v[60:63], v[80:83]
    v_mfma_f32_16x16x32_bf16 v[84:87], a[220:223], v[60:63], v[84:87]
    ds_read_b128 v[60:63], v8 offset:7680
    s_waitcnt lgkmcnt(3)
    v_mfma_f32_16x16x32_bf16 v[80:83], a[224:227], v[48:51], v[80:83]
    v_mfma_f32_16x16x32_bf16 v[84:87], a[228:231], v[48:51], v[84:87]
    ds_read_b128 v[48:51], v8 offset:0
    s_waitcnt lgkmcnt(3)
    v_mfma_f32_16x16x32_bf16 v[80:83], a[232:235], v[52:55], v[80:83]
    v_mfma_f32_16x16x32_bf16 v[84:87], a[236:239], v[52:55], v[84:87]
    ds_read_b128 v[52:55], v8 offset:2048
    s_waitcnt lgkmcnt(3)
    v_mfma_f32_16x16x32_bf16 v[80:83], a[240:243], v[56:59], v[80:83]
    v_mfma_f32_16x16x32_bf16 v[84:87], a[244:247], v[56:59], v[84:87]
    ds_read_b128 v[56:59], v8 offset:4096
    s_waitcnt lgkmcnt(3)
    v_mfma_f32_16x16x32_bf16 v[80:83], a[248:251], v[60:63], v[80:83]
    v_mfma_f32_16x16x32_bf16 v[84:87], a[252:255], v[60:63], v[84:87]
    ds_read_b128 v[60:63], v8 offset:6144
    s_waitcnt lgkmcnt(3)
    v_mfma_f32_16x16x32_bf16 v[40:43], v[48:51], v[128:131], 0
    v_mfma_f32_16x16x32_bf16 v[44:47], v[48:51], v[132:135], 0
    ds_read_b128 v[48:51], v8 offset:512
    s_waitcnt lgkmcnt(3)
    v_mfma_f32_16x16x32_bf16 v[40:43], v[52:55], v[136:139], v[40:43]
    v_mfma_f32_16x16x32_bf16 v[44:47], v[52:55], v[140:143], v[44:47]
    ds_read_b128 v[52:55], v8 offset:2560
    s_waitcnt lgkmcnt(3)
    v_mfma_f32_16x16x32_bf16 v[40:43], v[56:59], v[144:147], v[40:43]
    v_mfma_f32_16x16x32_bf16 v[44:47], v[56:59], v[148:151], v[44:47]
    v_mul_f32 v80, s33, v80
    v_mul_f32 v81, s33, v81
    v_mul_f32 v82, s33, v82
    v_mul_f32 v83, s33, v83
    ds_read_b128 v[56:59], v8 offset:4608
    s_waitcnt lgkmcnt(3)
    v_mfma_f32_16x16x32_bf16 v[40:43], v[60:63], v[152:155], v[40:43]
    v_mfma_f32_16x16x32_bf16 v[44:47], v[60:63], v[156:159], v[44:47]
    v_mul_f32 v84, s33, v84
    v_mul_f32 v85, s33, v85
    v_mul_f32 v86, s33, v86
    v_mul_f32 v87, s33, v87
    ds_read_b128 v[60:63], v8 offset:6656
    s_waitcnt lgkmcnt(3)
    v_mfma_f32_16x16x32_bf16 v[40:43], v[48:51], v[160:163], v[40:43]
    v_mfma_f32_16x16x32_bf16 v[44:47], v[48:51], v[164:167], v[44:47]
    v_cvt_pk_bf16_f32 v88, v80, v84
    v_cvt_pk_bf16_f32 v89, v81, v85
    v_cvt_pk_bf16_f32 v90, v82, v86
    v_cvt_pk_bf16_f32 v91, v83, v87
    ds_write_b128 v9, v[88:91] offset:16384
    ds_read_b128 v[48:51], v8 offset:1024
    s_waitcnt lgkmcnt(4)
    v_mfma_f32_16x16x32_bf16 v[40:43], v[52:55], v[168:171], v[40:43]
    v_mfma_f32_16x16x32_bf16 v[44:47], v[52:55], v[172:175], v[44:47]
    ds_read_b128 v[52:55], v8 offset:3072
    s_waitcnt lgkmcnt(4)
    v_mfma_f32_16x16x32_bf16 v[40:43], v[56:59], v[176:179], v[40:43]
    v_mfma_f32_16x16x32_bf16 v[44:47], v[56:59], v[180:183], v[44:47]
    ds_read_b128 v[56:59], v8 offset:5120
    s_waitcnt lgkmcnt(4)
    v_mfma_f32_16x16x32_bf16 v[40:43], v[60:63], v[184:187], v[40:43]
    v_mfma_f32_16x16x32_bf16 v[44:47], v[60:63], v[188:191], v[44:47]
    s_waitcnt lgkmcnt(3)
    s_barrier
    ds_read_b128 v[64:67], v1 offset:16384
    ds_read_b128 v[68:71], v1 offset:17408
    ds_read_b128 v[72:75], v1 offset:18432
    ds_read_b128 v[76:79], v1 offset:19456
    ds_read_b128 v[60:63], v8 offset:7168
    s_waitcnt lgkmcnt(7)
    v_mfma_f32_16x16x32_bf16 v[40:43], v[48:51], v[192:195], v[40:43]
    v_mfma_f32_16x16x32_bf16 v[44:47], v[48:51], v[196:199], v[44:47]
    ds_read_b128 v[48:51], v8 offset:1536
    s_waitcnt lgkmcnt(7)
    v_mfma_f32_16x16x32_bf16 v[40:43], v[52:55], v[200:203], v[40:43]
    v_mfma_f32_16x16x32_bf16 v[44:47], v[52:55], v[204:207], v[44:47]
    s_waitcnt lgkmcnt(2)
    v_mfma_f32_16x16x32_bf16 v[92:95], v[64:67], a[0:3], 0
    v_mfma_f32_16x16x32_bf16 v[96:99], v[64:67], a[16:19], 0
    v_mfma_f32_16x16x32_bf16 v[92:95], v[68:71], a[4:7], v[92:95]
    v_mfma_f32_16x16x32_bf16 v[96:99], v[68:71], a[20:23], v[96:99]
    v_mfma_f32_16x16x32_bf16 v[92:95], v[72:75], a[8:11], v[92:95]
    v_mfma_f32_16x16x32_bf16 v[96:99], v[72:75], a[24:27], v[96:99]
    v_mfma_f32_16x16x32_bf16 v[92:95], v[76:79], a[12:15], v[92:95]
    v_mfma_f32_16x16x32_bf16 v[96:99], v[76:79], a[28:31], v[96:99]
    ds_read_b128 v[52:55], v8 offset:3584
    s_waitcnt lgkmcnt(3)
    v_mfma_f32_16x16x32_bf16 v[40:43], v[56:59], v[208:211], v[40:43]
    v_mfma_f32_16x16x32_bf16 v[44:47], v[56:59], v[212:215], v[44:47]
    ds_read_b128 v[56:59], v8 offset:5632
    s_waitcnt lgkmcnt(3)
    v_mfma_f32_16x16x32_bf16 v[40:43], v[60:63], v[216:219], v[40:43]
    v_mfma_f32_16x16x32_bf16 v[44:47], v[60:63], v[220:223], v[44:47]
    v_max3_f32 v118, v92, v93, v94
    v_max3_f32 v118, v118, v95, v116
    v_max3_f32 v119, v96, v97, v98
    v_max3_f32 v119, v119, v99, v117
    v_mov_b32 v14, v118
    v_mov_b32 v15, v119
    ds_read_b128 v[60:63], v8 offset:7680
    s_waitcnt lgkmcnt(3)
    v_mfma_f32_16x16x32_bf16 v[40:43], v[48:51], v[224:227], v[40:43]
    v_mfma_f32_16x16x32_bf16 v[44:47], v[48:51], v[228:231], v[44:47]
    v_permlane16_swap_b32 v118, v14
    v_permlane16_swap_b32 v119, v15
    v_max_f32 v118, v118, v14
    v_max_f32 v119, v119, v15
    v_sub_f32 v92, v92, v118
    v_exp_f32 v92, v92
    s_waitcnt lgkmcnt(2)
    v_mfma_f32_16x16x32_bf16 v[40:43], v[52:55], v[232:235], v[40:43]
    v_mfma_f32_16x16x32_bf16 v[44:47], v[52:55], v[236:239], v[44:47]
    v_sub_f32 v93, v93, v118
    v_exp_f32 v93, v93
    v_sub_f32 v94, v94, v118
    v_exp_f32 v94, v94
    v_sub_f32 v95, v95, v118
    v_exp_f32 v95, v95
    s_waitcnt lgkmcnt(1)
    v_mfma_f32_16x16x32_bf16 v[40:43], v[56:59], v[240:243], v[40:43]
    v_mfma_f32_16x16x32_bf16 v[44:47], v[56:59], v[244:247], v[44:47]
    v_sub_f32 v104, v116, v118
    v_exp_f32 v104, v104
    v_cvt_pk_bf16_f32 v100, v92, v93
    v_cvt_pk_bf16_f32 v101, v94, v95
    v_sub_f32 v96, v96, v119
    v_exp_f32 v96, v96
    s_waitcnt lgkmcnt(0)
    v_mfma_f32_16x16x32_bf16 v[40:43], v[60:63], v[248:251], v[40:43]
    v_mfma_f32_16x16x32_bf16 v[44:47], v[60:63], v[252:255], v[44:47]
    v_sub_f32 v97, v97, v119
    v_exp_f32 v97, v97
    v_sub_f32 v98, v98, v119
    v_exp_f32 v98, v98
    v_sub_f32 v99, v99, v119
    v_exp_f32 v99, v99
    v_sub_f32 v105, v117, v119
    v_exp_f32 v105, v105
    v_cvt_pk_bf16_f32 v102, v96, v97
    v_cvt_pk_bf16_f32 v103, v98, v99
    v_mfma_f32_16x16x16_bf16 v[48:51], v[112:113], v[100:101], 0
    s_nop 0
    v_mfma_f32_16x16x16_bf16 v[52:55], v[112:113], v[102:103], 0
    v_cvt_pk_bf16_f32 v80, v40, v41
    v_cndmask_b32 v80, 0, v80, s[72:73]
    v_cvt_pk_bf16_f32 v81, v42, v43
    v_cndmask_b32 v81, 0, v81, s[72:73]
    v_cvt_pk_bf16_f32 v82, v44, v45
    v_cndmask_b32 v82, 0, v82, s[72:73]
    v_cvt_pk_bf16_f32 v83, v46, v47
    v_cndmask_b32 v83, 0, v83, s[72:73]
    v_mfma_f32_16x16x16_bf16 v[56:59], v[80:81], v[100:101], 0
    s_nop 0
    v_mfma_f32_16x16x16_bf16 v[60:63], v[82:83], v[100:101], 0
    v_mfma_f32_16x16x16_bf16 v[64:67], v[80:81], v[102:103], 0
    v_mfma_f32_16x16x16_bf16 v[68:71], v[82:83], v[102:103], 0
    v_fma_f32 v48, v16, v104, v48
    v_rcp_f32 v48, v48
    v_fma_f32 v52, v20, v105, v52
    v_rcp_f32 v52, v52
    v_fma_f32 v56, v24, v104, v56
    v_fma_f32 v57, v25, v104, v57
    v_fma_f32 v58, v26, v104, v58
    v_fma_f32 v59, v27, v104, v59
    v_fma_f32 v60, v28, v104, v60
    v_fma_f32 v61, v29, v104, v61
    v_fma_f32 v62, v30, v104, v62
    v_fma_f32 v63, v31, v104, v63
    v_pk_mul_f32 v[56:57], v[56:57], v[48:49] op_sel_hi:[1,0]
    v_pk_mul_f32 v[58:59], v[58:59], v[48:49] op_sel_hi:[1,0]
    v_pk_mul_f32 v[60:61], v[60:61], v[48:49] op_sel_hi:[1,0]
    v_pk_mul_f32 v[62:63], v[62:63], v[48:49] op_sel_hi:[1,0]
    v_cvt_pk_bf16_f32 v72, v56, v60
    v_cvt_pk_bf16_f32 v73, v57, v61
    v_cvt_pk_bf16_f32 v74, v58, v62
    v_cvt_pk_bf16_f32 v75, v59, v63
    ds_write_b128 v9, v[72:75] offset:0
    v_fma_f32 v64, v32, v105, v64
    v_fma_f32 v65, v33, v105, v65
    v_fma_f32 v66, v34, v105, v66
    v_fma_f32 v67, v35, v105, v67
    v_fma_f32 v68, v36, v105, v68
    v_fma_f32 v69, v37, v105, v69
    v_fma_f32 v70, v38, v105, v70
    v_fma_f32 v71, v39, v105, v71
    v_pk_mul_f32 v[64:65], v[64:65], v[52:53] op_sel_hi:[1,0]
    v_pk_mul_f32 v[66:67], v[66:67], v[52:53] op_sel_hi:[1,0]
    v_pk_mul_f32 v[68:69], v[68:69], v[52:53] op_sel_hi:[1,0]
    v_pk_mul_f32 v[70:71], v[70:71], v[52:53] op_sel_hi:[1,0]
    v_cvt_pk_bf16_f32 v76, v64, v68
    v_cvt_pk_bf16_f32 v77, v65, v69
    v_cvt_pk_bf16_f32 v78, v66, v70
    v_cvt_pk_bf16_f32 v79, v67, v71
    ds_write_b128 v9, v[76:79] offset:4096
    s_waitcnt lgkmcnt(0)
    s_barrier
    ds_read_b128 v[16:19], v1 offset:0
    ds_read_b128 v[20:23], v1 offset:1024
    ds_read_b128 v[24:27], v1 offset:2048
    ds_read_b128 v[28:31], v1 offset:3072
    ds_read_b128 v[32:35], v1 offset:4096
    ds_read_b128 v[36:39], v1 offset:5120
    ds_read_b128 v[40:43], v1 offset:6144
    ds_read_b128 v[44:47], v1 offset:7168
    ds_read_b128 v[48:51], v7 offset:0
    ds_read_b128 v[52:55], v7 offset:1024
    ds_read_b128 v[56:59], v7 offset:2048
    s_lshl_b32 s36, s20, 10
    s_add_u32 s25, s26, s36
    s_waitcnt lgkmcnt(2)
    v_mfma_f32_16x16x32_bf16 v[64:67], v[16:19], v[48:51], 0
    ds_read_b128 v[60:63], v7 offset:3072
    s_waitcnt lgkmcnt(2)
    v_mfma_f32_16x16x32_bf16 v[68:71], v[16:19], v[52:55], 0
    ds_read_b128 v[48:51], v7 offset:4096
    s_waitcnt lgkmcnt(2)
    v_mfma_f32_16x16x32_bf16 v[72:75], v[16:19], v[56:59], 0
    ds_read_b128 v[52:55], v7 offset:5120
    s_waitcnt lgkmcnt(2)
    v_mfma_f32_16x16x32_bf16 v[76:79], v[16:19], v[60:63], 0
    ds_read_b128 v[56:59], v7 offset:6144
    s_waitcnt lgkmcnt(2)
    v_mfma_f32_16x16x32_bf16 v[80:83], v[16:19], v[48:51], 0
    ds_read_b128 v[60:63], v7 offset:7168
    s_waitcnt lgkmcnt(2)
    v_mfma_f32_16x16x32_bf16 v[84:87], v[16:19], v[52:55], 0
    ds_read_b128 v[48:51], v7 offset:8192
    s_waitcnt lgkmcnt(2)
    v_mfma_f32_16x16x32_bf16 v[88:91], v[16:19], v[56:59], 0
    ds_read_b128 v[52:55], v7 offset:9216
    s_waitcnt lgkmcnt(2)
    v_mfma_f32_16x16x32_bf16 v[92:95], v[16:19], v[60:63], 0
    ds_read_b128 v[56:59], v7 offset:10240
    s_waitcnt lgkmcnt(2)
    v_mfma_f32_16x16x32_bf16 v[64:67], v[20:23], v[48:51], v[64:67]
    ds_read_b128 v[60:63], v7 offset:11264
    s_waitcnt lgkmcnt(2)
    v_mfma_f32_16x16x32_bf16 v[68:71], v[20:23], v[52:55], v[68:71]
    ds_read_b128 v[48:51], v7 offset:12288
    s_waitcnt lgkmcnt(2)
    v_mfma_f32_16x16x32_bf16 v[72:75], v[20:23], v[56:59], v[72:75]
    ds_read_b128 v[52:55], v7 offset:13312
    s_waitcnt lgkmcnt(2)
    v_mfma_f32_16x16x32_bf16 v[76:79], v[20:23], v[60:63], v[76:79]
    ds_read_b128 v[56:59], v7 offset:14336
    s_waitcnt lgkmcnt(2)
    v_mfma_f32_16x16x32_bf16 v[80:83], v[20:23], v[48:51], v[80:83]
    ds_read_b128 v[60:63], v7 offset:15360
    s_waitcnt lgkmcnt(2)
    v_mfma_f32_16x16x32_bf16 v[84:87], v[20:23], v[52:55], v[84:87]
    ds_read_b128 v[48:51], v7 offset:16384
    s_waitcnt lgkmcnt(2)
    v_mfma_f32_16x16x32_bf16 v[88:91], v[20:23], v[56:59], v[88:91]
    ds_read_b128 v[52:55], v7 offset:17408
    s_waitcnt lgkmcnt(2)
    v_mfma_f32_16x16x32_bf16 v[92:95], v[20:23], v[60:63], v[92:95]
    ds_read_b128 v[56:59], v7 offset:18432
    s_waitcnt lgkmcnt(2)
    v_mfma_f32_16x16x32_bf16 v[64:67], v[24:27], v[48:51], v[64:67]
    ds_read_b128 v[60:63], v7 offset:19456
    s_waitcnt lgkmcnt(2)
    v_mfma_f32_16x16x32_bf16 v[68:71], v[24:27], v[52:55], v[68:71]
    ds_read_b128 v[48:51], v7 offset:20480
    s_waitcnt lgkmcnt(2)
    v_mfma_f32_16x16x32_bf16 v[72:75], v[24:27], v[56:59], v[72:75]
    ds_read_b128 v[52:55], v7 offset:21504
    s_waitcnt lgkmcnt(2)
    v_mfma_f32_16x16x32_bf16 v[76:79], v[24:27], v[60:63], v[76:79]
    ds_read_b128 v[56:59], v7 offset:22528
    s_waitcnt lgkmcnt(2)
    v_mfma_f32_16x16x32_bf16 v[80:83], v[24:27], v[48:51], v[80:83]
    ds_read_b128 v[60:63], v7 offset:23552
    s_waitcnt lgkmcnt(2)
    v_mfma_f32_16x16x32_bf16 v[84:87], v[24:27], v[52:55], v[84:87]
    ds_read_b128 v[48:51], v7 offset:24576
    s_waitcnt lgkmcnt(2)
    v_mfma_f32_16x16x32_bf16 v[88:91], v[24:27], v[56:59], v[88:91]
    ds_read_b128 v[52:55], v7 offset:25600
    s_waitcnt lgkmcnt(2)
    v_mfma_f32_16x16x32_bf16 v[92:95], v[24:27], v[60:63], v[92:95]
    ds_read_b128 v[56:59], v7 offset:26624
    s_waitcnt lgkmcnt(2)
    v_mfma_f32_16x16x32_bf16 v[64:67], v[28:31], v[48:51], v[64:67]
    ds_read_b128 v[60:63], v7 offset:27648
    s_waitcnt lgkmcnt(2)
    v_mfma_f32_16x16x32_bf16 v[68:71], v[28:31], v[52:55], v[68:71]
    ds_read_b128 v[48:51], v7 offset:28672
    s_waitcnt lgkmcnt(2)
    v_mfma_f32_16x16x32_bf16 v[72:75], v[28:31], v[56:59], v[72:75]
    ds_read_b128 v[52:55], v7 offset:29696
    s_waitcnt lgkmcnt(2)
    v_mfma_f32_16x16x32_bf16 v[76:79], v[28:31], v[60:63], v[76:79]
    ds_read_b128 v[56:59], v7 offset:30720
    s_waitcnt lgkmcnt(2)
    v_mfma_f32_16x16x32_bf16 v[80:83], v[28:31], v[48:51], v[80:83]
    ds_read_b128 v[60:63], v7 offset:31744
    s_waitcnt lgkmcnt(2)
    v_mfma_f32_16x16x32_bf16 v[84:87], v[28:31], v[52:55], v[84:87]
    ds_read_b128 v[48:51], v7 offset:0
    s_waitcnt lgkmcnt(2)
    v_mfma_f32_16x16x32_bf16 v[88:91], v[28:31], v[56:59], v[88:91]
    ds_read_b128 v[52:55], v7 offset:1024
    s_waitcnt lgkmcnt(2)
    v_mfma_f32_16x16x32_bf16 v[92:95], v[28:31], v[60:63], v[92:95]
    ds_read_b128 v[56:59], v7 offset:2048
    s_waitcnt lgkmcnt(2)
    v_mfma_f32_16x16x32_bf16 v[96:99], v[32:35], v[48:51], 0
    ds_read_b128 v[60:63], v7 offset:3072
    s_waitcnt lgkmcnt(2)
    v_mfma_f32_16x16x32_bf16 v[100:103], v[32:35], v[52:55], 0
    ds_read_b128 v[48:51], v7 offset:4096
    s_waitcnt lgkmcnt(2)
    v_mfma_f32_16x16x32_bf16 v[104:107], v[32:35], v[56:59], 0
    ds_read_b128 v[52:55], v7 offset:5120
    s_waitcnt lgkmcnt(2)
    v_mfma_f32_16x16x32_bf16 v[108:111], v[32:35], v[60:63], 0
    ds_read_b128 v[56:59], v7 offset:6144
    v_cvt_pk_bf16_f32 v16, v64, v68
    s_waitcnt lgkmcnt(2)
    v_mfma_f32_16x16x32_bf16 v[112:115], v[32:35], v[48:51], 0
    ds_read_b128 v[60:63], v7 offset:7168
    v_cvt_pk_bf16_f32 v17, v72, v76
    s_waitcnt lgkmcnt(2)
    v_mfma_f32_16x16x32_bf16 v[116:119], v[32:35], v[52:55], 0
    ds_read_b128 v[48:51], v7 offset:8192
    v_cvt_pk_bf16_f32 v18, v80, v84
    s_waitcnt lgkmcnt(2)
    v_mfma_f32_16x16x32_bf16 v[120:123], v[32:35], v[56:59], 0
    ds_read_b128 v[52:55], v7 offset:9216
    v_cvt_pk_bf16_f32 v19, v88, v92
    s_waitcnt lgkmcnt(2)
    v_mfma_f32_16x16x32_bf16 v[124:127], v[32:35], v[60:63], 0
    ds_read_b128 v[56:59], v7 offset:10240
    v_and_or_b32 v16, v16, -2, s27
    s_waitcnt lgkmcnt(2)
    v_mfma_f32_16x16x32_bf16 v[96:99], v[36:39], v[48:51], v[96:99]
    ds_read_b128 v[60:63], v7 offset:11264
    s_add_u32 s36, s25, 0x0
    s_waitcnt lgkmcnt(2)
    v_mfma_f32_16x16x32_bf16 v[100:103], v[36:39], v[52:55], v[100:103]
    ds_read_b128 v[48:51], v7 offset:12288
    buffer_store_dwordx4 v[16:19], v10, s[8:11], s36 offen sc1
    s_waitcnt lgkmcnt(2)
    v_mfma_f32_16x16x32_bf16 v[104:107], v[36:39], v[56:59], v[104:107]
    ds_read_b128 v[52:55], v7 offset:13312
    v_cvt_pk_bf16_f32 v20, v65, v69
    s_waitcnt lgkmcnt(2)
    v_mfma_f32_16x16x32_bf16 v[108:111], v[36:39], v[60:63], v[108:111]
    ds_read_b128 v[56:59], v7 offset:14336
    v_cvt_pk_bf16_f32 v21, v73, v77
    s_waitcnt lgkmcnt(2)
    v_mfma_f32_16x16x32_bf16 v[112:115], v[36:39], v[48:51], v[112:115]
    ds_read_b128 v[60:63], v7 offset:15360
    v_cvt_pk_bf16_f32 v22, v81, v85
    s_waitcnt lgkmcnt(2)
    v_mfma_f32_16x16x32_bf16 v[116:119], v[36:39], v[52:55], v[116:119]
    ds_read_b128 v[48:51], v7 offset:16384
    v_cvt_pk_bf16_f32 v23, v89, v93
    s_waitcnt lgkmcnt(2)
    v_mfma_f32_16x16x32_bf16 v[120:123], v[36:39], v[56:59], v[120:123]
    ds_read_b128 v[52:55], v7 offset:17408
    v_and_or_b32 v20, v20, -2, s27
    s_waitcnt lgkmcnt(2)
    v_mfma_f32_16x16x32_bf16 v[124:127], v[36:39], v[60:63], v[124:127]
    ds_read_b128 v[56:59], v7 offset:18432
    s_add_u32 s36, s25, 0x8000
    s_waitcnt lgkmcnt(2)
    v_mfma_f32_16x16x32_bf16 v[96:99], v[40:43], v[48:51], v[96:99]
    ds_read_b128 v[60:63], v7 offset:19456
    buffer_store_dwordx4 v[20:23], v10, s[8:11], s36 offen sc1
    s_waitcnt lgkmcnt(2)
    v_mfma_f32_16x16x32_bf16 v[100:103], v[40:43], v[52:55], v[100:103]
    ds_read_b128 v[48:51], v7 offset:20480
    v_cvt_pk_bf16_f32 v24, v66, v70
    s_waitcnt lgkmcnt(2)
    v_mfma_f32_16x16x32_bf16 v[104:107], v[40:43], v[56:59], v[104:107]
    ds_read_b128 v[52:55], v7 offset:21504
    v_cvt_pk_bf16_f32 v25, v74, v78
    s_waitcnt lgkmcnt(2)
    v_mfma_f32_16x16x32_bf16 v[108:111], v[40:43], v[60:63], v[108:111]
    ds_read_b128 v[56:59], v7 offset:22528
    v_cvt_pk_bf16_f32 v26, v82, v86
    s_waitcnt lgkmcnt(2)
    v_mfma_f32_16x16x32_bf16 v[112:115], v[40:43], v[48:51], v[112:115]
    ds_read_b128 v[60:63], v7 offset:23552
    v_cvt_pk_bf16_f32 v27, v90, v94
    s_waitcnt lgkmcnt(2)
    v_mfma_f32_16x16x32_bf16 v[116:119], v[40:43], v[52:55], v[116:119]
    ds_read_b128 v[48:51], v7 offset:24576
    v_and_or_b32 v24, v24, -2, s27
    s_waitcnt lgkmcnt(2)
    v_mfma_f32_16x16x32_bf16 v[120:123], v[40:43], v[56:59], v[120:123]
    ds_read_b128 v[52:55], v7 offset:25600
    s_add_u32 s36, s25, 0x10000
    s_waitcnt lgkmcnt(2)
    v_mfma_f32_16x16x32_bf16 v[124:127], v[40:43], v[60:63], v[124:127]
    ds_read_b128 v[56:59], v7 offset:26624
    buffer_store_dwordx4 v[24:27], v10, s[8:11], s36 offen sc1
    s_waitcnt lgkmcnt(2)
    v_mfma_f32_16x16x32_bf16 v[96:99], v[44:47], v[48:51], v[96:99]
    ds_read_b128 v[60:63], v7 offset:27648
    v_cvt_pk_bf16_f32 v28, v67, v71
    s_waitcnt lgkmcnt(2)
    v_mfma_f32_16x16x32_bf16 v[100:103], v[44:47], v[52:55], v[100:103]
    ds_read_b128 v[48:51], v7 offset:28672
    v_cvt_pk_bf16_f32 v29, v75, v79
    s_waitcnt lgkmcnt(2)
    v_mfma_f32_16x16x32_bf16 v[104:107], v[44:47], v[56:59], v[104:107]
    ds_read_b128 v[52:55], v7 offset:29696
    v_cvt_pk_bf16_f32 v30, v83, v87
    s_waitcnt lgkmcnt(2)
    v_mfma_f32_16x16x32_bf16 v[108:111], v[44:47], v[60:63], v[108:111]
    ds_read_b128 v[56:59], v7 offset:30720
    v_cvt_pk_bf16_f32 v31, v91, v95
    s_waitcnt lgkmcnt(2)
    v_mfma_f32_16x16x32_bf16 v[112:115], v[44:47], v[48:51], v[112:115]
    ds_read_b128 v[60:63], v7 offset:31744
    v_and_or_b32 v28, v28, -2, s27
    s_waitcnt lgkmcnt(2)
    v_mfma_f32_16x16x32_bf16 v[116:119], v[44:47], v[52:55], v[116:119]
    s_add_u32 s36, s25, 0x18000
    s_waitcnt lgkmcnt(1)
    v_mfma_f32_16x16x32_bf16 v[120:123], v[44:47], v[56:59], v[120:123]
    buffer_store_dwordx4 v[28:31], v10, s[8:11], s36 offen sc1
    s_waitcnt lgkmcnt(0)
    v_mfma_f32_16x16x32_bf16 v[124:127], v[44:47], v[60:63], v[124:127]
    v_cvt_pk_bf16_f32 v32, v96, v100
    v_cvt_pk_bf16_f32 v33, v104, v108
    v_cvt_pk_bf16_f32 v34, v112, v116
    s_nop 4
    v_cvt_pk_bf16_f32 v35, v120, v124
    v_and_or_b32 v32, v32, -2, s27
    s_add_u32 s36, s25, 0x80000
    buffer_store_dwordx4 v[32:35], v10, s[8:11], s36 offen sc1
    v_cvt_pk_bf16_f32 v36, v97, v101
    v_cvt_pk_bf16_f32 v37, v105, v109
    v_cvt_pk_bf16_f32 v38, v113, v117
    v_cvt_pk_bf16_f32 v39, v121, v125
    v_and_or_b32 v36, v36, -2, s27
    s_add_u32 s36, s25, 0x88000
    buffer_store_dwordx4 v[36:39], v10, s[8:11], s36 offen sc1
    v_cvt_pk_bf16_f32 v40, v98, v102
    v_cvt_pk_bf16_f32 v41, v106, v110
    v_cvt_pk_bf16_f32 v42, v114, v118
    v_cvt_pk_bf16_f32 v43, v122, v126
    v_and_or_b32 v40, v40, -2, s27
    s_add_u32 s36, s25, 0x90000
    buffer_store_dwordx4 v[40:43], v10, s[8:11], s36 offen sc1
    v_cvt_pk_bf16_f32 v44, v99, v103
    v_cvt_pk_bf16_f32 v45, v107, v111
    v_cvt_pk_bf16_f32 v46, v115, v119
    v_cvt_pk_bf16_f32 v47, v123, v127
    v_and_or_b32 v44, v44, -2, s27
    s_add_u32 s36, s25, 0x98000
    buffer_store_dwordx4 v[44:47], v10, s[8:11], s36 offen sc1
    s_add_u32 s38, s23, 6
    s_cmp_ge_u32 s38, 64
    s_cbranch_scc1 L_P2_last
    s_mul_i32 s24, s38, 0x82000
    s_lshl_b32 s36, s20, 14
    s_add_u32 s24, s24, s36
    s_add_u32 s24, s24, 0x1000000
    s_add_u32 s36, s24, 0
    s_add_u32 s37, s36, 0x7000000
    buffer_load_dwordx4 a[32:35], v1, s[8:11], s36 offen offset:0 sc1
    buffer_load_dwordx4 a[0:3], v1, s[8:11], s37 offen offset:0 sc1
    buffer_load_dwordx4 a[36:39], v1, s[8:11], s36 offen offset:1024 sc1
    buffer_load_dwordx4 a[4:7], v1, s[8:11], s37 offen offset:1024 sc1
    buffer_load_dwordx4 a[40:43], v1, s[8:11], s36 offen offset:2048 sc1
    buffer_load_dwordx4 a[8:11], v1, s[8:11], s37 offen offset:2048 sc1
    buffer_load_dwordx4 a[44:47], v1, s[8:11], s36 offen offset:3072 sc1
    buffer_load_dwordx4 a[12:15], v1, s[8:11], s37 offen offset:3072 sc1
    s_add_u32 s36, s24, 4096
    s_add_u32 s37, s36, 0x7000000
    buffer_load_dwordx4 a[48:51], v1, s[8:11], s36 offen offset:0 sc1
    buffer_load_dwordx4 a[16:19], v1, s[8:11], s37 offen offset:0 sc1
    buffer_load_dwordx4 a[52:55], v1, s[8:11], s36 offen offset:1024 sc1
    buffer_load_dwordx4 a[20:23], v1, s[8:11], s37 offen offset:1024 sc1
    buffer_load_dwordx4 a[56:59], v1, s[8:11], s36 offen offset:2048 sc1
    buffer_load_dwordx4 a[24:27], v1, s[8:11], s37 offen offset:2048 sc1
    buffer_load_dwordx4 a[60:63], v1, s[8:11], s36 offen offset:3072 sc1
    buffer_load_dwordx4 a[28:31], v1, s[8:11], s37 offen offset:3072 sc1
    s_lshr_b32 s36, s21, 1
    s_lshl_b32 s36, s36, 3
    s_xor_b32 s37, s36, 8
    s_add_u32 s24, s24, 8192
    s_add_u32 s36, s36, s24
    s_add_u32 s37, s37, s24
    buffer_load_dwordx2 a[64:65], v2, s[8:11], s36 offen offset:0 sc1
    buffer_load_dwordx2 a[66:67], v2, s[8:11], s37 offen offset:0 sc1
    buffer_load_dwordx2 a[68:69], v2, s[8:11], s36 offen offset:1024 sc1
    buffer_load_dwordx2 a[70:71], v2, s[8:11], s37 offen offset:1024 sc1
L_P2_last:
    s_lshl_b32 s24, s23, 5
    s_add_u32 s24, s24, s20
    s_lshl_b32 s24, s24, 10
    v_accvgpr_read_b32 v52, a72
    v_accvgpr_read_b32 v53, a73
    v_and_b32 v15, 15, v0
    v_mov_b32 v48, 0
    v_mov_b32 v14, 0x3f80
    v_cmp_eq_u32 vcc, 0, v15
    s_nop 1
    v_cndmask_b32 v48, v48, v14, vcc
    v_mov_b32 v14, 0x3f800000
    v_cmp_eq_u32 vcc, 1, v15
    s_nop 1
    v_cndmask_b32 v48, v48, v14, vcc
    v_mov_b32 v49, 0
    v_mov_b32 v14, 0x3f80
    v_cmp_eq_u32 vcc, 4, v15
    s_nop 1
    v_cndmask_b32 v49, v49, v14, vcc
    v_mov_b32 v14, 0x3f800000
    v_cmp_eq_u32 vcc, 5, v15
    s_nop 1
    v_cndmask_b32 v49, v49, v14, vcc
    v_mov_b32 v50, 0
    v_mov_b32 v14, 0x3f80
    v_cmp_eq_u32 vcc, 8, v15
    s_nop 1
    v_cndmask_b32 v50, v50, v14, vcc
    v_mov_b32 v14, 0x3f800000
    v_cmp_eq_u32 vcc, 9, v15
    s_nop 1
    v_cndmask_b32 v50, v50, v14, vcc
    v_mov_b32 v51, 0
    v_mov_b32 v14, 0x3f80
    v_cmp_eq_u32 vcc, 12, v15
    s_nop 1
    v_cndmask_b32 v51, v51, v14, vcc
    v_mov_b32 v14, 0x3f800000
    v_cmp_eq_u32 vcc, 13, v15
    s_nop 1
    v_cndmask_b32 v51, v51, v14, vcc
    s_lshl_b32 s25, s20, 15
    s_add_u32 s25, s25, s26
L_P3_poll:
    s_add_u32 s36, s25, 0
    buffer_load_dwordx4 v[80:83], v11, s[8:11], s36 offen sc1
    s_add_u32 s36, s25, 4096
    buffer_load_dwordx4 v[84:87], v11, s[8:11], s36 offen sc1
    s_add_u32 s36, s25, 8192
    buffer_load_dwordx4 v[88:91], v11, s[8:11], s36 offen sc1
    s_add_u32 s36, s25, 12288
    buffer_load_dwordx4 v[92:95], v11, s[8:11], s36 offen sc1
    s_add_u32 s36, s25, 16384
    buffer_load_dwordx4 v[96:99], v11, s[8:11], s36 offen sc1
    s_add_u32 s36, s25, 20480
    buffer_load_dwordx4 v[100:103], v11, s[8:11], s36 offen sc1
    s_add_u32 s36, s25, 24576
    buffer_load_dwordx4 v[104:107], v11, s[8:11], s36 offen sc1
    s_add_u32 s36, s25, 28672
    buffer_load_dwordx4 v[108:111], v11, s[8:11], s36 offen sc1
    s_mov_b64 exec, -1
    s_add_u32 s32, s32, 1
    s_cmp_gt_u32 s32, 200000
    s_waitcnt vmcnt(7)
    v_mfma_f32_16x16x32_bf16 v[56:59], v[48:51], v[80:83], 0
    s_waitcnt vmcnt(6)
    v_mfma_f32_16x16x32_bf16 v[56:59], v[48:51], v[84:87], v[56:59]
    v_bitop3_b32 v60, v80, v84, s27 bitop3:0x7e
    s_waitcnt vmcnt(5)
    v_mfma_f32_16x16x32_bf16 v[56:59], v[48:51], v[88:91], v[56:59]
    s_waitcnt vmcnt(4)
    v_mfma_f32_16x16x32_bf16 v[56:59], v[48:51], v[92:95], v[56:59]
    v_bitop3_b32 v61, v88, v92, s27 bitop3:0x7e
    s_waitcnt vmcnt(3)
    v_mfma_f32_16x16x32_bf16 v[56:59], v[48:51], v[96:99], v[56:59]
    s_waitcnt vmcnt(2)
    v_mfma_f32_16x16x32_bf16 v[56:59], v[48:51], v[100:103], v[56:59]
    v_bitop3_b32 v62, v96, v100, s27 bitop3:0x7e
    s_waitcnt vmcnt(1)
    v_mfma_f32_16x16x32_bf16 v[56:59], v[48:51], v[104:107], v[56:59]
    s_waitcnt vmcnt(0)
    v_mfma_f32_16x16x32_bf16 v[56:59], v[48:51], v[108:111], v[56:59]
    v_bitop3_b32 v63, v104, v108, s27 bitop3:0x7e
    v_or3_b32 v14, v60, v61, v62
    v_bitop3_b32 v14, v14, v63, 1 bitop3:0xa8
    s_cbranch_scc1 L_P3_got
    v_cmp_ne_u32 vcc, 0, v14
    s_cbranch_vccz L_P3_got
    s_mov_b64 exec, vcc
    s_branch L_P3_poll
L_P3_got:
    s_nop 4
    v_cvt_pk_bf16_f32 v62, v56, v57
    v_lshlrev_b32 v65, 16, v62
    v_and_b32 v66, 0xffff0000, v62
    v_lshlrev_b32 v60, 16, v52
    v_and_b32 v61, 0xffff0000, v52
    v_add_f32 v60, v60, v65
    v_add_f32 v61, v61, v66
    v_cvt_pk_bf16_f32 v62, v60, v61
    v_lshlrev_b32 v60, 16, v62
    v_and_b32 v61, 0xffff0000, v62
    v_add_f32 v63, v60, v61
    v_mul_f32 v64, v60, v60
    v_fmac_f32 v64, v61, v61
    v_add_f32_dpp v63, v63, v63 quad_perm:[1,0,3,2] row_mask:0xf bank_mask:0xf
    s_nop 0
    v_add_f32_dpp v64, v64, v64 quad_perm:[1,0,3,2] row_mask:0xf bank_mask:0xf
    v_add_f32_dpp v63, v63, v63 quad_perm:[2,3,0,1] row_mask:0xf bank_mask:0xf
    s_nop 0
    v_add_f32_dpp v64, v64, v64 quad_perm:[2,3,0,1] row_mask:0xf bank_mask:0xf
    v_add_f32_dpp v63, v63, v63 row_half_mirror row_mask:0xf bank_mask:0xf
    s_nop 0
    v_add_f32_dpp v64, v64, v64 row_half_mirror row_mask:0xf bank_mask:0xf
    v_add_f32_dpp v63, v63, v63 row_mirror row_mask:0xf bank_mask:0xf
    s_nop 0
    v_add_f32_dpp v64, v64, v64 row_mirror row_mask:0xf bank_mask:0xf
    v_mov_b32 v14, v63
    s_nop 1
    v_permlane16_swap_b32 v63, v14
    v_add_f32 v63, v63, v14
    v_mov_b32 v14, v64
    s_nop 1
    v_permlane16_swap_b32 v64, v14
    v_add_f32 v64, v64, v14
    v_mov_b32 v14, v63
    s_nop 1
    v_permlane32_swap_b32 v63, v14
    v_add_f32 v63, v63, v14
    v_mov_b32 v14, v64
    s_nop 1
    v_permlane32_swap_b32 v64, v14
    v_add_f32 v64, v64, v14
    v_mov_b32 v15, s21
    v_lshlrev_b32 v15, 3, v15
    v_add_u32 v15, 28672, v15
    ds_write2_b32 v15, v63, v64 offset0:0 offset1:1
    s_add_u32 s36, s24, 0x400000
    buffer_store_dword v62, v12, s[8:11], s36 offen sc1
    s_waitcnt lgkmcnt(0)
    s_barrier
    v_mov_b32 v15, 28672
    ds_read_b128 v[68:71], v15
    ds_read_b128 v[72:75], v15 offset:16
    s_waitcnt lgkmcnt(0)
    v_add_f32 v63, v68, v70
    v_add_f32 v63, v63, v72
    v_add_f32 v63, v63, v74
    v_mul_f32 v63, 0x3b000000, v63
    v_add_f32 v64, v69, v71
    v_add_f32 v64, v64, v73
    v_add_f32 v64, v64, v75
    v_mul_f32 v64, 0x3b000000, v64
    v_fma_f32 v64, -v63, v63, v64
    v_max_f32 v64, 0, v64
    v_cvt_pk_bf16_f32 v14, v63, v64
    v_lshlrev_b32 v63, 16, v14
    v_and_b32 v64, 0xffff0000, v14
    v_add_f32 v64, 0x3727c5ac, v64
    v_cvt_pk_bf16_f32 v14, v64, v64
    v_lshlrev_b32 v64, 16, v14
    v_sqrt_f32 v64, v64
    s_nop 0
    v_cvt_pk_bf16_f32 v14, v64, v64
    v_lshlrev_b32 v64, 16, v14
    v_rcp_f32 v64, v64
    v_sub_f32 v65, v60, v63
    v_sub_f32 v66, v61, v63
    v_cvt_pk_bf16_f32 v14, v65, v66
    v_lshlrev_b32 v65, 16, v14
    v_and_b32 v66, 0xffff0000, v14
    v_mul_f32 v65, v65, v64
    v_mul_f32 v66, v66, v64
    v_cvt_pk_bf16_f32 v67, v65, v66
    v_lshlrev_b32 v65, 16, v67
    v_and_b32 v66, 0xffff0000, v67
    v_lshlrev_b32 v68, 16, v53
    v_and_b32 v69, 0xffff0000, v53
    v_mul_f32 v63, v65, v68
    v_fmac_f32 v63, v66, v69
    s_nop 1
    v_add_f32_dpp v63, v63, v63 quad_perm:[1,0,3,2] row_mask:0xf bank_mask:0xf
    s_nop 1
    v_add_f32_dpp v63, v63, v63 quad_perm:[2,3,0,1] row_mask:0xf bank_mask:0xf
    s_nop 1
    v_add_f32_dpp v63, v63, v63 row_half_mirror row_mask:0xf bank_mask:0xf
    s_nop 1
    v_add_f32_dpp v63, v63, v63 row_mirror row_mask:0xf bank_mask:0xf
    v_mov_b32 v14, v63
    s_nop 1
    v_permlane16_swap_b32 v63, v14
    v_add_f32 v63, v63, v14
    v_mov_b32 v14, v63
    s_nop 1
    v_permlane32_swap_b32 v63, v14
    v_add_f32 v63, v63, v14
    s_lshr_b32 s25, s24, 6
    s_lshl_b32 s37, s21, 2
    s_add_u32 s25, s25, s37
    s_add_u32 s36, s25, 0x194000
    v_cmp_ne_u32 vcc, 0, v1
    v_mov_b32 v15, 0x40000000
    s_nop 0
    v_cndmask_b32 v15, v1, v15, vcc
    buffer_store_dword v63, v15, s[8:11], s36 offen sc1
    v_add_f32 v60, v60, v65
    v_add_f32 v61, v61, v66
    v_cvt_pk_bf16_f32 v62, v60, v61
    buffer_store_dword v62, v12, s[60:63], s24 offen sc1
    s_add_u32 s36, s24, 0x600000
    buffer_store_dword v67, v12, s[8:11], s36 offen sc1
    s_add_u32 s30, s25, 0x1b8000
    s_add_u32 s29, s29, 1
    s_barrier
    s_add_u32 s23, s23, 6
    s_cmp_lt_u32 s23, 64
    s_cbranch_scc1 L_P2
    s_waitcnt vmcnt(0)
    v_cmp_ne_u32 vcc, 0, v1
    v_mov_b32 v15, 0x40000000
    v_mov_b32 v14, 0
    v_cndmask_b32 v15, v1, v15, vcc
    buffer_store_dword v14, v15, s[8:11], s30 offen sc1
    s_branch L_end
L_mlp:
    s_mov_b32 s12, s44
    s_and_b32 s13, s45, 0xffff
    s_mov_b32 s14, 0x200000
    s_mov_b32 s15, 0x20000
    s_mov_b32 s60, s82
    s_and_b32 s61, s83, 0xffff
    s_mov_b32 s62, 0x200000
    s_mov_b32 s63, 0x20000
    s_mov_b32 s92, s80
    s_and_b32 s93, s81, 0xffff
    s_mov_b32 s94, 0x400
    s_mov_b32 s95, 0x20000
    v_mov_b32 v1, 0x0
    v_bfe_u32 v14, v0, 0, 1
    s_mov_b32 s38, 0x10
    v_mad_u32_u24 v1, v14, s38, v1
    v_bfe_u32 v14, v0, 1, 1
    s_mov_b32 s38, 0x20
    v_mad_u32_u24 v1, v14, s38, v1
    v_bfe_u32 v14, v0, 2, 1
    s_mov_b32 s38, 0x40
    v_mad_u32_u24 v1, v14, s38, v1
    v_bfe_u32 v14, v0, 3, 1
    s_mov_b32 s38, 0x80
    v_mad_u32_u24 v1, v14, s38, v1
    v_bfe_u32 v14, v0, 4, 1
    s_mov_b32 s38, 0x100
    v_mad_u32_u24 v1, v14, s38, v1
    v_bfe_u32 v14, v0, 5, 1
    s_mov_b32 s38, 0x200
    v_mad_u32_u24 v1, v14, s38, v1
    v_mov_b32 v2, 0x0
    v_bfe_u32 v14, v0, 0, 1
    s_mov_b32 s38, 0x10
    v_mad_u32_u24 v2, v14, s38, v2
    v_bfe_u32 v14, v0, 1, 1
    s_mov_b32 s38, 0x20
    v_mad_u32_u24 v2, v14, s38, v2
    v_bfe_u32 v14, v0, 2, 1
    s_mov_b32 s38, 0x40
    v_mad_u32_u24 v2, v14, s38, v2
    v_bfe_u32 v14, v0, 3, 1
    s_mov_b32 s38, 0x80
    v_mad_u32_u24 v2, v14, s38, v2
    v_bfe_u32 v14, v0, 4, 1
    s_mov_b32 s38, 0x100
    v_mad_u32_u24 v2, v14, s38, v2
    v_bfe_u32 v14, v0, 5, 1
    s_mov_b32 s38, 0x200
    v_mad_u32_u24 v2, v14, s38, v2
    v_bfe_u32 v14, v0, 6, 1
    s_mov_b32 s38, 0x800
    v_mad_u32_u24 v2, v14, s38, v2
    v_bfe_u32 v14, v0, 7, 1
    s_mov_b32 s38, 0x1000
    v_mad_u32_u24 v2, v14, s38, v2
    v_mov_b32 v9, 0x0
    v_bfe_u32 v14, v0, 0, 1
    s_mov_b32 s38, 0x10
    v_mad_u32_u24 v9, v14, s38, v9
    v_bfe_u32 v14, v0, 1, 1
    s_mov_b32 s38, 0x20
    v_mad_u32_u24 v9, v14, s38, v9
    v_bfe_u32 v14, v0, 2, 1
    s_mov_b32 s38, 0x40
    v_mad_u32_u24 v9, v14, s38, v9
    v_bfe_u32 v14, v0, 3, 1
    s_mov_b32 s38, 0x80
    v_mad_u32_u24 v9, v14, s38, v9
    v_bfe_u32 v14, v0, 4, 1
    s_mov_b32 s38, 0x100
    v_mad_u32_u24 v9, v14, s38, v9
    v_bfe_u32 v14, v0, 5, 1
    s_mov_b32 s38, 0x200
    v_mad_u32_u24 v9, v14, s38, v9
    v_bfe_u32 v14, v0, 6, 1
    s_mov_b32 s38, 0x400
    v_mad_u32_u24 v9, v14, s38, v9
    v_bfe_u32 v14, v0, 7, 1
    s_mov_b32 s38, 0x800
    v_mad_u32_u24 v9, v14, s38, v9
    v_mov_b32 v7, 0x8000
    v_bfe_u32 v14, v0, 0, 1
    s_mov_b32 s38, 0x10
    v_mad_u32_u24 v7, v14, s38, v7
    v_bfe_u32 v14, v0, 1, 1
    s_mov_b32 s38, 0x20
    v_mad_u32_u24 v7, v14, s38, v7
    v_bfe_u32 v14, v0, 2, 1
    s_mov_b32 s38, 0x40
    v_mad_u32_u24 v7, v14, s38, v7
    v_bfe_u32 v14, v0, 3, 1
    s_mov_b32 s38, 0x80
    v_mad_u32_u24 v7, v14, s38, v7
    v_bfe_u32 v14, v0, 4, 1
    s_mov_b32 s38, 0x100
    v_mad_u32_u24 v7, v14, s38, v7
    v_bfe_u32 v14, v0, 5, 1
    s_mov_b32 s38, 0x200
    v_mad_u32_u24 v7, v14, s38, v7
    v_bfe_u32 v14, v0, 6, 1
    s_mov_b32 s38, 0x8000
    v_mad_u32_u24 v7, v14, s38, v7
    v_bfe_u32 v14, v0, 7, 1
    s_mov_b32 s38, 0x10000
    v_mad_u32_u24 v7, v14, s38, v7
    v_mov_b32 v3, 0x0
    v_bfe_u32 v14, v0, 0, 1
    s_mov_b32 s38, 0x10
    v_mad_u32_u24 v3, v14, s38, v3
    v_bfe_u32 v14, v0, 1, 1
    s_mov_b32 s38, 0x20
    v_mad_u32_u24 v3, v14, s38, v3
    v_bfe_u32 v14, v0, 2, 1
    s_mov_b32 s38, 0x40
    v_mad_u32_u24 v3, v14, s38, v3
    v_bfe_u32 v14, v0, 3, 1
    s_mov_b32 s38, 0x400
    v_mad_u32_u24 v3, v14, s38, v3
    v_bfe_u32 v14, v0, 4, 1
    s_mov_b32 s38, 0x800
    v_mad_u32_u24 v3, v14, s38, v3
    v_bfe_u32 v14, v0, 5, 1
    s_mov_b32 s38, 0x1000
    v_mad_u32_u24 v3, v14, s38, v3
    v_bfe_u32 v14, v0, 6, 1
    s_mov_b32 s38, 0x2000
    v_mad_u32_u24 v3, v14, s38, v3
    v_bfe_u32 v14, v0, 7, 1
    s_mov_b32 s38, 0x4000
    v_mad_u32_u24 v3, v14, s38, v3
    v_mov_b32 v4, 0x0
    v_bfe_u32 v14, v0, 0, 1
    s_mov_b32 s38, 0x100
    v_mad_u32_u24 v4, v14, s38, v4
    v_bfe_u32 v14, v0, 1, 1
    s_mov_b32 s38, 0x200
    v_mad_u32_u24 v4, v14, s38, v4
    v_bfe_u32 v14, v0, 2, 1
    s_mov_b32 s38, 0x400
    v_mad_u32_u24 v4, v14, s38, v4
    v_bfe_u32 v14, v0, 6, 1
    s_mov_b32 s38, 0x80
    v_mad_u32_u24 v4, v14, s38, v4
    v_bfe_u32 v14, v0, 7, 1
    s_mov_b32 s38, 0x4000
    v_mad_u32_u24 v4, v14, s38, v4
    v_lshrrev_b32 v15, 3, v0
    v_xor_b32 v15, v15, v0
    v_and_b32 v15, 7, v15
    v_lshl_add_u32 v4, v15, 4, v4
    v_bfe_u32 v15, v0, 4, 2
    v_lshlrev_b32 v15, 4, v15
    v_xor_b32 v5, v15, v1
    v_xor_b32 v6, 64, v5
    v_mov_b32 v8, 0x5000
    v_bfe_u32 v14, v0, 0, 1
    s_mov_b32 s38, 0x10
    v_mad_u32_u24 v8, v14, s38, v8
    v_bfe_u32 v14, v0, 1, 1
    s_mov_b32 s38, 0x40
    v_mad_u32_u24 v8, v14, s38, v8
    v_bfe_u32 v14, v0, 2, 1
    s_mov_b32 s38, 0x80
    v_mad_u32_u24 v8, v14, s38, v8
    v_bfe_u32 v14, v0, 4, 1
    s_mov_b32 s38, 0x20
    v_mad_u32_u24 v8, v14, s38, v8
    v_bfe_u32 v14, v0, 5, 1
    s_mov_b32 s38, 0x100
    v_mad_u32_u24 v8, v14, s38, v8
    v_mov_b32 v10, 0x0
    v_bfe_u32 v14, v0, 0, 1
    s_mov_b32 s38, 0x10
    v_mad_u32_u24 v10, v14, s38, v10
    v_bfe_u32 v14, v0, 1, 1
    s_mov_b32 s38, 0x20
    v_mad_u32_u24 v10, v14, s38, v10
    v_bfe_u32 v14, v0, 2, 1
    s_mov_b32 s38, 0x40
    v_mad_u32_u24 v10, v14, s38, v10
    v_bfe_u32 v14, v0, 3, 1
    s_mov_b32 s38, 0x80
    v_mad_u32_u24 v10, v14, s38, v10
    v_bfe_u32 v14, v0, 4, 1
    s_mov_b32 s38, 0x20000
    v_mad_u32_u24 v10, v14, s38, v10
    v_bfe_u32 v14, v0, 5, 1
    s_mov_b32 s38, 0x40000
    v_mad_u32_u24 v10, v14, s38, v10
    v_bfe_u32 v14, v0, 6, 1
    s_mov_b32 s38, 0x100
    v_mad_u32_u24 v10, v14, s38, v10
    v_bfe_u32 v14, v0, 7, 1
    s_mov_b32 s38, 0x200
    v_mad_u32_u24 v10, v14, s38, v10
    v_mov_b32 v11, 0x0
    v_bfe_u32 v14, v0, 0, 1
    s_mov_b32 s38, 0x10
    v_mad_u32_u24 v11, v14, s38, v11
    v_bfe_u32 v14, v0, 1, 1
    s_mov_b32 s38, 0x20
    v_mad_u32_u24 v11, v14, s38, v11
    v_bfe_u32 v14, v0, 2, 1
    s_mov_b32 s38, 0x40
    v_mad_u32_u24 v11, v14, s38, v11
    v_bfe_u32 v14, v0, 3, 1
    s_mov_b32 s38, 0x80
    v_mad_u32_u24 v11, v14, s38, v11
    v_bfe_u32 v14, v0, 4, 1
    s_mov_b32 s38, 0x400
    v_mad_u32_u24 v11, v14, s38, v11
    v_bfe_u32 v14, v0, 5, 1
    s_mov_b32 s38, 0x800
    v_mad_u32_u24 v11, v14, s38, v11
    v_bfe_u32 v14, v0, 6, 1
    s_mov_b32 s38, 0x100
    v_mad_u32_u24 v11, v14, s38, v11
    v_bfe_u32 v14, v0, 7, 1
    s_mov_b32 s38, 0x200
    v_mad_u32_u24 v11, v14, s38, v11
    v_mov_b32 v12, 0x0
    v_bfe_u32 v14, v0, 0, 1
    s_mov_b32 s38, 0x10
    v_mad_u32_u24 v12, v14, s38, v12
    v_bfe_u32 v14, v0, 1, 1
    s_mov_b32 s38, 0x20
    v_mad_u32_u24 v12, v14, s38, v12
    v_bfe_u32 v14, v0, 2, 1
    s_mov_b32 s38, 0x40
    v_mad_u32_u24 v12, v14, s38, v12
    v_bfe_u32 v14, v0, 3, 1
    s_mov_b32 s38, 0x80
    v_mad_u32_u24 v12, v14, s38, v12
    v_bfe_u32 v14, v0, 4, 1
    s_mov_b32 s38, 0x4
    v_mad_u32_u24 v12, v14, s38, v12
    v_bfe_u32 v14, v0, 5, 1
    s_mov_b32 s38, 0x8
    v_mad_u32_u24 v12, v14, s38, v12
    v_bfe_u32 v14, v0, 6, 1
    s_mov_b32 s38, 0x100
    v_mad_u32_u24 v12, v14, s38, v12
    v_bfe_u32 v14, v0, 7, 1
    s_mov_b32 s38, 0x200
    v_mad_u32_u24 v12, v14, s38, v12
    v_mov_b32 v13, 0xf149f2ca
    v_and_b32 v14, 15, v0
    v_bfe_u32 v15, v0, 4, 2
    v_cmp_gt_u32 s[72:73], 2, v15
    v_lshlrev_b32 v15, 2, v15
    v_cmp_le_u32 s[64:65], v15, v14
    v_add_u32 v15, 1, v15
    v_cmp_le_u32 s[66:67], v15, v14
    v_add_u32 v15, 1, v15
    v_cmp_le_u32 s[68:69], v15, v14
    v_add_u32 v15, 1, v15
    v_cmp_le_u32 s[70:71], v15, v14
    v_add_u32 v15, 1, v15
    s_mov_b32 s34, 0x05040100
    s_mov_b32 s35, 0x07060302
    s_mov_b32 s33, 0x3e0293ee
    s_mov_b32 s32, 0
    s_mov_b32 s4, 0x3f803f80
    s_mov_b32 s5, 0x3f803f80
    s_lshr_b32 s20, s2, 3
    s_lshr_b32 s23, s2, 3
    s_lshl_b32 s23, s23, 1
    s_lshl_b32 s36, s23, 15
    buffer_load_dwordx4 v[96:99], v3, s[12:15], s36 offen offset:0
    buffer_load_dwordx4 v[100:103], v3, s[12:15], s36 offen offset:128
    buffer_load_dwordx4 v[104:107], v3, s[12:15], s36 offen offset:256
    buffer_load_dwordx4 v[108:111], v3, s[12:15], s36 offen offset:384
    buffer_load_dwordx4 v[112:115], v3, s[12:15], s36 offen offset:512
    buffer_load_dwordx4 v[116:119], v3, s[12:15], s36 offen offset:640
    buffer_load_dwordx4 v[120:123], v3, s[12:15], s36 offen offset:768
    buffer_load_dwordx4 v[124:127], v3, s[12:15], s36 offen offset:896
    s_add_u32 s36, s36, 0x8000
    buffer_load_dwordx4 v[128:131], v3, s[12:15], s36 offen offset:0
    buffer_load_dwordx4 v[132:135], v3, s[12:15], s36 offen offset:128
    buffer_load_dwordx4 v[136:139], v3, s[12:15], s36 offen offset:256
    buffer_load_dwordx4 v[140:143], v3, s[12:15], s36 offen offset:384
    buffer_load_dwordx4 v[144:147], v3, s[12:15], s36 offen offset:512
    buffer_load_dwordx4 v[148:151], v3, s[12:15], s36 offen offset:640
    buffer_load_dwordx4 v[152:155], v3, s[12:15], s36 offen offset:768
    buffer_load_dwordx4 v[156:159], v3, s[12:15], s36 offen offset:896
    s_mov_b32 s96, s46
    s_and_b32 s97, s47, 0xffff
    s_mov_b32 s98, 0x2000
    s_mov_b32 s99, 0x20000
    v_mov_b32 v68, 0x0
    v_bfe_u32 v14, v0, 0, 1
    s_mov_b32 s38, 0x8
    v_mad_u32_u24 v68, v14, s38, v68
    v_bfe_u32 v14, v0, 1, 1
    s_mov_b32 s38, 0x10
    v_mad_u32_u24 v68, v14, s38, v68
    v_bfe_u32 v14, v0, 2, 1
    s_mov_b32 s38, 0x10000
    v_mad_u32_u24 v68, v14, s38, v68
    v_bfe_u32 v14, v0, 3, 1
    s_mov_b32 s38, 0x10000
    v_mad_u32_u24 v68, v14, s38, v68
    v_bfe_u32 v14, v0, 4, 1
    s_mov_b32 s38, 0x400
    v_mad_u32_u24 v68, v14, s38, v68
    v_bfe_u32 v14, v0, 5, 1
    s_mov_b32 s38, 0x4
    v_mad_u32_u24 v68, v14, s38, v68
    v_bfe_u32 v14, v0, 6, 1
    s_mov_b32 s38, 0x40
    v_mad_u32_u24 v68, v14, s38, v68
    v_bfe_u32 v14, v0, 7, 1
    s_mov_b32 s38, 0x80
    v_mad_u32_u24 v68, v14, s38, v68
    v_mov_b32 v70, s20
    v_mov_b32 v69, 0x0
    v_bfe_u32 v14, v70, 0, 1
    s_mov_b32 s38, 0x20
    v_mad_u32_u24 v69, v14, s38, v69
    v_bfe_u32 v14, v70, 1, 1
    s_mov_b32 s38, 0x800
    v_mad_u32_u24 v69, v14, s38, v69
    v_bfe_u32 v14, v70, 2, 1
    s_mov_b32 s38, 0x1000
    v_mad_u32_u24 v69, v14, s38, v69
    v_bfe_u32 v14, v70, 3, 1
    s_mov_b32 s38, 0x100
    v_mad_u32_u24 v69, v14, s38, v69
    v_bfe_u32 v14, v70, 4, 1
    s_mov_b32 s38, 0x200
    v_mad_u32_u24 v69, v14, s38, v69
    v_add_u32 v68, v68, v69
    buffer_load_dword v72, v68, s[96:99], 0 offen
    v_mov_b32 v64, -1
    v_mov_b32 v65, -1
    v_mov_b32 v66, -1
    v_mov_b32 v67, -1
    s_lshl_b32 s36, s20, 13
    s_add_u32 s36, s36, 0x0
    buffer_store_dwordx4 v[64:67], v2, s[8:11], s36 offen sc1
    buffer_store_dwordx4 v[64:67], v2, s[8:11], s36 offen offset:1024 sc1
    s_lshl_b32 s36, s20, 14
    s_add_u32 s36, s36, 0x100000
    s_add_u32 s37, s36, 0x2000
    buffer_store_dwordx4 v[64:67], v2, s[8:11], s36 offen sc1
    buffer_store_dwordx4 v[64:67], v2, s[8:11], s36 offen offset:1024 sc1
    buffer_store_dwordx4 v[64:67], v2, s[8:11], s37 offen sc1
    buffer_store_dwordx4 v[64:67], v2, s[8:11], s37 offen offset:1024 sc1
    s_mul_i32 s36, s20, 0x104000
    s_add_u32 s36, s36, 0x1102000
    s_add_u32 s37, s36, 0x82000
    buffer_store_dwordx4 v[64:67], v2, s[8:11], s36 offen sc1
    buffer_store_dwordx4 v[64:67], v2, s[8:11], s36 offen offset:1024 sc1
    buffer_store_dwordx4 v[64:67], v2, s[8:11], s37 offen sc1
    buffer_store_dwordx4 v[64:67], v2, s[8:11], s37 offen offset:1024 sc1
    v_lshlrev_b32 v68, 2, v0
    s_lshl_b32 s36, s20, 10
    s_add_u32 s37, s36, 0x194000
    buffer_store_dword v64, v68, s[8:11], s37 offen sc1
    s_add_u32 s37, s36, 0x1b0000
    buffer_store_dword v64, v68, s[8:11], s37 offen sc1
    s_add_u32 s37, s36, 0x1b8000
    buffer_store_dword v64, v68, s[8:11], s37 offen sc1
    v_mov_b32 v69, 0x40000000
    v_cmp_lt_u32 vcc, 63, v0
    s_nop 1
    v_cndmask_b32 v68, v68, v69, vcc
    v_mov_b32 v73, 0
    s_lshl_b32 s36, s20, 8
    s_add_u32 s36, s36, 0x190000
    s_add_u32 s37, s36, 0x2000
    buffer_store_dword v73, v68, s[8:11], s36 offen sc1
    buffer_store_dword v73, v68, s[8:11], s37 offen sc1
    v_mov_b32 v71, 0x80000
    v_bfe_u32 v14, v0, 0, 1
    s_mov_b32 s38, 0x8
    v_mad_u32_u24 v71, v14, s38, v71
    v_bfe_u32 v14, v0, 1, 1
    s_mov_b32 s38, 0x20
    v_mad_u32_u24 v71, v14, s38, v71
    v_bfe_u32 v14, v0, 4, 1
    s_mov_b32 s38, 0x10
    v_mad_u32_u24 v71, v14, s38, v71
    v_bfe_u32 v14, v0, 5, 1
    s_mov_b32 s38, 0x4
    v_mad_u32_u24 v71, v14, s38, v71
    v_bfe_u32 v14, v0, 6, 1
    s_mov_b32 s38, 0x800
    v_mad_u32_u24 v71, v14, s38, v71
    v_bfe_u32 v14, v0, 7, 1
    s_mov_b32 s38, 0x1000
    v_mad_u32_u24 v71, v14, s38, v71
    v_mov_b32 v69, s20
    v_mov_b32 v68, 0x0
    v_bfe_u32 v14, v69, 0, 1
    s_mov_b32 s38, 0x100
    v_mad_u32_u24 v68, v14, s38, v68
    v_bfe_u32 v14, v69, 1, 1
    s_mov_b32 s38, 0x40
    v_mad_u32_u24 v68, v14, s38, v68
    v_bfe_u32 v14, v69, 2, 1
    s_mov_b32 s38, 0x80
    v_mad_u32_u24 v68, v14, s38, v68
    v_bfe_u32 v14, v69, 3, 1
    s_mov_b32 s38, 0x200
    v_mad_u32_u24 v68, v14, s38, v68
    v_bfe_u32 v14, v69, 4, 1
    s_mov_b32 s38, 0x400
    v_mad_u32_u24 v68, v14, s38, v68
    v_add_u32 v71, v68, v71
    v_and_b32 v68, 12, v0
    v_cmp_ne_u32 vcc, 0, v68
    v_mov_b32 v68, 0x40000000
    s_nop 0
    v_cndmask_b32 v71, v71, v68, vcc
    s_waitcnt vmcnt(15)
    s_mov_b32 s36, 0x1000000
    buffer_store_dword v72, v71, s[8:11], s36 offen sc1
L_XN:
    v_mov_b32 v88, 0
    v_mov_b32 v89, 0
    v_dot2_f32_bf16 v88, v96, s4, v88
    v_dot2_f32_bf16 v89, v96, v96, v89
    v_dot2_f32_bf16 v88, v97, s4, v88
    v_dot2_f32_bf16 v89, v97, v97, v89
    v_dot2_f32_bf16 v88, v98, s4, v88
    v_dot2_f32_bf16 v89, v98, v98, v89
    v_dot2_f32_bf16 v88, v99, s4, v88
    v_dot2_f32_bf16 v89, v99, v99, v89
    v_dot2_f32_bf16 v88, v100, s4, v88
    v_dot2_f32_bf16 v89, v100, v100, v89
    v_dot2_f32_bf16 v88, v101, s4, v88
    v_dot2_f32_bf16 v89, v101, v101, v89
    v_dot2_f32_bf16 v88, v102, s4, v88
    v_dot2_f32_bf16 v89, v102, v102, v89
    v_dot2_f32_bf16 v88, v103, s4, v88
    v_dot2_f32_bf16 v89, v103, v103, v89
    v_dot2_f32_bf16 v88, v104, s4, v88
    v_dot2_f32_bf16 v89, v104, v104, v89
    v_dot2_f32_bf16 v88, v105, s4, v88
    v_dot2_f32_bf16 v89, v105, v105, v89
    v_dot2_f32_bf16 v88, v106, s4, v88
    v_dot2_f32_bf16 v89, v106, v106, v89
    v_dot2_f32_bf16 v88, v107, s4, v88
    v_dot2_f32_bf16 v89, v107, v107, v89
    v_dot2_f32_bf16 v88, v108, s4, v88
    v_dot2_f32_bf16 v89, v108, v108, v89
    v_dot2_f32_bf16 v88, v109, s4, v88
    v_dot2_f32_bf16 v89, v109, v109, v89
    v_dot2_f32_bf16 v88, v110, s4, v88
    v_dot2_f32_bf16 v89, v110, v110, v89
    v_dot2_f32_bf16 v88, v111, s4, v88
    v_dot2_f32_bf16 v89, v111, v111, v89
    v_dot2_f32_bf16 v88, v112, s4, v88
    v_dot2_f32_bf16 v89, v112, v112, v89
    v_dot2_f32_bf16 v88, v113, s4, v88
    v_dot2_f32_bf16 v89, v113, v113, v89
    v_dot2_f32_bf16 v88, v114, s4, v88
    v_dot2_f32_bf16 v89, v114, v114, v89
    v_dot2_f32_bf16 v88, v115, s4, v88
    v_dot2_f32_bf16 v89, v115, v115, v89
    v_dot2_f32_bf16 v88, v116, s4, v88
    v_dot2_f32_bf16 v89, v116, v116, v89
    v_dot2_f32_bf16 v88, v117, s4, v88
    v_dot2_f32_bf16 v89, v117, v117, v89
    v_dot2_f32_bf16 v88, v118, s4, v88
    v_dot2_f32_bf16 v89, v118, v118, v89
    v_dot2_f32_bf16 v88, v119, s4, v88
    v_dot2_f32_bf16 v89, v119, v119, v89
    v_dot2_f32_bf16 v88, v120, s4, v88
    v_dot2_f32_bf16 v89, v120, v120, v89
    v_dot2_f32_bf16 v88, v121, s4, v88
    v_dot2_f32_bf16 v89, v121, v121, v89
    v_dot2_f32_bf16 v88, v122, s4, v88
    v_dot2_f32_bf16 v89, v122, v122, v89
    v_dot2_f32_bf16 v88, v123, s4, v88
    v_dot2_f32_bf16 v89, v123, v123, v89
    v_dot2_f32_bf16 v88, v124, s4, v88
    v_dot2_f32_bf16 v89, v124, v124, v89
    v_dot2_f32_bf16 v88, v125, s4, v88
    v_dot2_f32_bf16 v89, v125, v125, v89
    v_dot2_f32_bf16 v88, v126, s4, v88
    v_dot2_f32_bf16 v89, v126, v126, v89
    v_dot2_f32_bf16 v88, v127, s4, v88
    v_dot2_f32_bf16 v89, v127, v127, v89
    s_nop 3
    v_add_f32_dpp v88, v88, v88 quad_perm:[1,0,3,2] row_mask:0xf bank_mask:0xf
    v_add_f32_dpp v89, v89, v89 quad_perm:[1,0,3,2] row_mask:0xf bank_mask:0xf
    s_nop 0
    v_add_f32_dpp v88, v88, v88 quad_perm:[2,3,0,1] row_mask:0xf bank_mask:0xf
    v_add_f32_dpp v89, v89, v89 quad_perm:[2,3,0,1] row_mask:0xf bank_mask:0xf
    s_nop 0
    v_add_f32_dpp v88, v88, v88 row_half_mirror row_mask:0xf bank_mask:0xf
    v_add_f32_dpp v89, v89, v89 row_half_mirror row_mask:0xf bank_mask:0xf
    v_mul_f32 v88, 0x3b000000, v88
    v_mul_f32 v89, 0x3b000000, v89
    v_fma_f32 v89, -v88, v88, v89
    v_max_f32 v89, 0, v89
    v_cvt_pk_bf16_f32 v14, v88, v89
    v_lshlrev_b32 v88, 16, v14
    v_and_b32 v89, 0xffff0000, v14
    v_add_f32 v89, 0x3727c5ac, v89
    v_cvt_pk_bf16_f32 v14, v89, v89
    v_lshlrev_b32 v89, 16, v14
    v_sqrt_f32 v89, v89
    s_nop 0
    v_cvt_pk_bf16_f32 v14, v89, v89
    v_lshlrev_b32 v89, 16, v14
    v_rcp_f32 v89, v89
    v_lshlrev_b32 v90, 16, v96
    v_and_b32 v91, 0xffff0000, v96
    v_sub_f32 v90, v90, v88
    v_sub_f32 v91, v91, v88
    v_cvt_pk_bf16_f32 v96, v90, v91
    v_lshlrev_b32 v90, 16, v96
    v_and_b32 v91, 0xffff0000, v96
    v_mul_f32 v90, v90, v89
    v_mul_f32 v91, v91, v89
    v_cvt_pk_bf16_f32 v96, v90, v91
    v_lshlrev_b32 v90, 16, v97
    v_and_b32 v91, 0xffff0000, v97
    v_sub_f32 v90, v90, v88
    v_sub_f32 v91, v91, v88
    v_cvt_pk_bf16_f32 v97, v90, v91
    v_lshlrev_b32 v90, 16, v97
    v_and_b32 v91, 0xffff0000, v97
    v_mul_f32 v90, v90, v89
    v_mul_f32 v91, v91, v89
    v_cvt_pk_bf16_f32 v97, v90, v91
    v_lshlrev_b32 v90, 16, v98
    v_and_b32 v91, 0xffff0000, v98
    v_sub_f32 v90, v90, v88
    v_sub_f32 v91, v91, v88
    v_cvt_pk_bf16_f32 v98, v90, v91
    v_lshlrev_b32 v90, 16, v98
    v_and_b32 v91, 0xffff0000, v98
    v_mul_f32 v90, v90, v89
    v_mul_f32 v91, v91, v89
    v_cvt_pk_bf16_f32 v98, v90, v91
    v_lshlrev_b32 v90, 16, v99
    v_and_b32 v91, 0xffff0000, v99
    v_sub_f32 v90, v90, v88
    v_sub_f32 v91, v91, v88
    v_cvt_pk_bf16_f32 v99, v90, v91
    v_lshlrev_b32 v90, 16, v99
    v_and_b32 v91, 0xffff0000, v99
    v_mul_f32 v90, v90, v89
    v_mul_f32 v91, v91, v89
    v_cvt_pk_bf16_f32 v99, v90, v91
    ds_write_b128 v4, v[96:99] offset:0
    v_lshlrev_b32 v90, 16, v100
    v_and_b32 v91, 0xffff0000, v100
    v_sub_f32 v90, v90, v88
    v_sub_f32 v91, v91, v88
    v_cvt_pk_bf16_f32 v100, v90, v91
    v_lshlrev_b32 v90, 16, v100
    v_and_b32 v91, 0xffff0000, v100
    v_mul_f32 v90, v90, v89
    v_mul_f32 v91, v91, v89
    v_cvt_pk_bf16_f32 v100, v90, v91
    v_lshlrev_b32 v90, 16, v101
    v_and_b32 v91, 0xffff0000, v101
    v_sub_f32 v90, v90, v88
    v_sub_f32 v91, v91, v88
    v_cvt_pk_bf16_f32 v101, v90, v91
    v_lshlrev_b32 v90, 16, v101
    v_and_b32 v91, 0xffff0000, v101
    v_mul_f32 v90, v90, v89
    v_mul_f32 v91, v91, v89
    v_cvt_pk_bf16_f32 v101, v90, v91
    v_lshlrev_b32 v90, 16, v102
    v_and_b32 v91, 0xffff0000, v102
    v_sub_f32 v90, v90, v88
    v_sub_f32 v91, v91, v88
    v_cvt_pk_bf16_f32 v102, v90, v91
    v_lshlrev_b32 v90, 16, v102
    v_and_b32 v91, 0xffff0000, v102
    v_mul_f32 v90, v90, v89
    v_mul_f32 v91, v91, v89
    v_cvt_pk_bf16_f32 v102, v90, v91
    v_lshlrev_b32 v90, 16, v103
    v_and_b32 v91, 0xffff0000, v103
    v_sub_f32 v90, v90, v88
    v_sub_f32 v91, v91, v88
    v_cvt_pk_bf16_f32 v103, v90, v91
    v_lshlrev_b32 v90, 16, v103
    v_and_b32 v91, 0xffff0000, v103
    v_mul_f32 v90, v90, v89
    v_mul_f32 v91, v91, v89
    v_cvt_pk_bf16_f32 v103, v90, v91
    ds_write_b128 v4, v[100:103] offset:2048
    v_lshlrev_b32 v90, 16, v104
    v_and_b32 v91, 0xffff0000, v104
    v_sub_f32 v90, v90, v88
    v_sub_f32 v91, v91, v88
    v_cvt_pk_bf16_f32 v104, v90, v91
    v_lshlrev_b32 v90, 16, v104
    v_and_b32 v91, 0xffff0000, v104
    v_mul_f32 v90, v90, v89
    v_mul_f32 v91, v91, v89
    v_cvt_pk_bf16_f32 v104, v90, v91
    v_lshlrev_b32 v90, 16, v105
    v_and_b32 v91, 0xffff0000, v105
    v_sub_f32 v90, v90, v88
    v_sub_f32 v91, v91, v88
    v_cvt_pk_bf16_f32 v105, v90, v91
    v_lshlrev_b32 v90, 16, v105
    v_and_b32 v91, 0xffff0000, v105
    v_mul_f32 v90, v90, v89
    v_mul_f32 v91, v91, v89
    v_cvt_pk_bf16_f32 v105, v90, v91
    v_lshlrev_b32 v90, 16, v106
    v_and_b32 v91, 0xffff0000, v106
    v_sub_f32 v90, v90, v88
    v_sub_f32 v91, v91, v88
    v_cvt_pk_bf16_f32 v106, v90, v91
    v_lshlrev_b32 v90, 16, v106
    v_and_b32 v91, 0xffff0000, v106
    v_mul_f32 v90, v90, v89
    v_mul_f32 v91, v91, v89
    v_cvt_pk_bf16_f32 v106, v90, v91
    v_lshlrev_b32 v90, 16, v107
    v_and_b32 v91, 0xffff0000, v107
    v_sub_f32 v90, v90, v88
    v_sub_f32 v91, v91, v88
    v_cvt_pk_bf16_f32 v107, v90, v91
    v_lshlrev_b32 v90, 16, v107
    v_and_b32 v91, 0xffff0000, v107
    v_mul_f32 v90, v90, v89
    v_mul_f32 v91, v91, v89
    v_cvt_pk_bf16_f32 v107, v90, v91
    ds_write_b128 v4, v[104:107] offset:4096
    v_lshlrev_b32 v90, 16, v108
    v_and_b32 v91, 0xffff0000, v108
    v_sub_f32 v90, v90, v88
    v_sub_f32 v91, v91, v88
    v_cvt_pk_bf16_f32 v108, v90, v91
    v_lshlrev_b32 v90, 16, v108
    v_and_b32 v91, 0xffff0000, v108
    v_mul_f32 v90, v90, v89
    v_mul_f32 v91, v91, v89
    v_cvt_pk_bf16_f32 v108, v90, v91
    v_lshlrev_b32 v90, 16, v109
    v_and_b32 v91, 0xffff0000, v109
    v_sub_f32 v90, v90, v88
    v_sub_f32 v91, v91, v88
    v_cvt_pk_bf16_f32 v109, v90, v91
    v_lshlrev_b32 v90, 16, v109
    v_and_b32 v91, 0xffff0000, v109
    v_mul_f32 v90, v90, v89
    v_mul_f32 v91, v91, v89
    v_cvt_pk_bf16_f32 v109, v90, v91
    v_lshlrev_b32 v90, 16, v110
    v_and_b32 v91, 0xffff0000, v110
    v_sub_f32 v90, v90, v88
    v_sub_f32 v91, v91, v88
    v_cvt_pk_bf16_f32 v110, v90, v91
    v_lshlrev_b32 v90, 16, v110
    v_and_b32 v91, 0xffff0000, v110
    v_mul_f32 v90, v90, v89
    v_mul_f32 v91, v91, v89
    v_cvt_pk_bf16_f32 v110, v90, v91
    v_lshlrev_b32 v90, 16, v111
    v_and_b32 v91, 0xffff0000, v111
    v_sub_f32 v90, v90, v88
    v_sub_f32 v91, v91, v88
    v_cvt_pk_bf16_f32 v111, v90, v91
    v_lshlrev_b32 v90, 16, v111
    v_and_b32 v91, 0xffff0000, v111
    v_mul_f32 v90, v90, v89
    v_mul_f32 v91, v91, v89
    v_cvt_pk_bf16_f32 v111, v90, v91
    ds_write_b128 v4, v[108:111] offset:6144
    v_lshlrev_b32 v90, 16, v112
    v_and_b32 v91, 0xffff0000, v112
    v_sub_f32 v90, v90, v88
    v_sub_f32 v91, v91, v88
    v_cvt_pk_bf16_f32 v112, v90, v91
    v_lshlrev_b32 v90, 16, v112
    v_and_b32 v91, 0xffff0000, v112
    v_mul_f32 v90, v90, v89
    v_mul_f32 v91, v91, v89
    v_cvt_pk_bf16_f32 v112, v90, v91
    v_lshlrev_b32 v90, 16, v113
    v_and_b32 v91, 0xffff0000, v113
    v_sub_f32 v90, v90, v88
    v_sub_f32 v91, v91, v88
    v_cvt_pk_bf16_f32 v113, v90, v91
    v_lshlrev_b32 v90, 16, v113
    v_and_b32 v91, 0xffff0000, v113
    v_mul_f32 v90, v90, v89
    v_mul_f32 v91, v91, v89
    v_cvt_pk_bf16_f32 v113, v90, v91
    v_lshlrev_b32 v90, 16, v114
    v_and_b32 v91, 0xffff0000, v114
    v_sub_f32 v90, v90, v88
    v_sub_f32 v91, v91, v88
    v_cvt_pk_bf16_f32 v114, v90, v91
    v_lshlrev_b32 v90, 16, v114
    v_and_b32 v91, 0xffff0000, v114
    v_mul_f32 v90, v90, v89
    v_mul_f32 v91, v91, v89
    v_cvt_pk_bf16_f32 v114, v90, v91
    v_lshlrev_b32 v90, 16, v115
    v_and_b32 v91, 0xffff0000, v115
    v_sub_f32 v90, v90, v88
    v_sub_f32 v91, v91, v88
    v_cvt_pk_bf16_f32 v115, v90, v91
    v_lshlrev_b32 v90, 16, v115
    v_and_b32 v91, 0xffff0000, v115
    v_mul_f32 v90, v90, v89
    v_mul_f32 v91, v91, v89
    v_cvt_pk_bf16_f32 v115, v90, v91
    ds_write_b128 v4, v[112:115] offset:8192
    v_lshlrev_b32 v90, 16, v116
    v_and_b32 v91, 0xffff0000, v116
    v_sub_f32 v90, v90, v88
    v_sub_f32 v91, v91, v88
    v_cvt_pk_bf16_f32 v116, v90, v91
    v_lshlrev_b32 v90, 16, v116
    v_and_b32 v91, 0xffff0000, v116
    v_mul_f32 v90, v90, v89
    v_mul_f32 v91, v91, v89
    v_cvt_pk_bf16_f32 v116, v90, v91
    v_lshlrev_b32 v90, 16, v117
    v_and_b32 v91, 0xffff0000, v117
    v_sub_f32 v90, v90, v88
    v_sub_f32 v91, v91, v88
    v_cvt_pk_bf16_f32 v117, v90, v91
    v_lshlrev_b32 v90, 16, v117
    v_and_b32 v91, 0xffff0000, v117
    v_mul_f32 v90, v90, v89
    v_mul_f32 v91, v91, v89
    v_cvt_pk_bf16_f32 v117, v90, v91
    v_lshlrev_b32 v90, 16, v118
    v_and_b32 v91, 0xffff0000, v118
    v_sub_f32 v90, v90, v88
    v_sub_f32 v91, v91, v88
    v_cvt_pk_bf16_f32 v118, v90, v91
    v_lshlrev_b32 v90, 16, v118
    v_and_b32 v91, 0xffff0000, v118
    v_mul_f32 v90, v90, v89
    v_mul_f32 v91, v91, v89
    v_cvt_pk_bf16_f32 v118, v90, v91
    v_lshlrev_b32 v90, 16, v119
    v_and_b32 v91, 0xffff0000, v119
    v_sub_f32 v90, v90, v88
    v_sub_f32 v91, v91, v88
    v_cvt_pk_bf16_f32 v119, v90, v91
    v_lshlrev_b32 v90, 16, v119
    v_and_b32 v91, 0xffff0000, v119
    v_mul_f32 v90, v90, v89
    v_mul_f32 v91, v91, v89
    v_cvt_pk_bf16_f32 v119, v90, v91
    ds_write_b128 v4, v[116:119] offset:10240
    v_lshlrev_b32 v90, 16, v120
    v_and_b32 v91, 0xffff0000, v120
    v_sub_f32 v90, v90, v88
    v_sub_f32 v91, v91, v88
    v_cvt_pk_bf16_f32 v120, v90, v91
    v_lshlrev_b32 v90, 16, v120
    v_and_b32 v91, 0xffff0000, v120
    v_mul_f32 v90, v90, v89
    v_mul_f32 v91, v91, v89
    v_cvt_pk_bf16_f32 v120, v90, v91
    v_lshlrev_b32 v90, 16, v121
    v_and_b32 v91, 0xffff0000, v121
    v_sub_f32 v90, v90, v88
    v_sub_f32 v91, v91, v88
    v_cvt_pk_bf16_f32 v121, v90, v91
    v_lshlrev_b32 v90, 16, v121
    v_and_b32 v91, 0xffff0000, v121
    v_mul_f32 v90, v90, v89
    v_mul_f32 v91, v91, v89
    v_cvt_pk_bf16_f32 v121, v90, v91
    v_lshlrev_b32 v90, 16, v122
    v_and_b32 v91, 0xffff0000, v122
    v_sub_f32 v90, v90, v88
    v_sub_f32 v91, v91, v88
    v_cvt_pk_bf16_f32 v122, v90, v91
    v_lshlrev_b32 v90, 16, v122
    v_and_b32 v91, 0xffff0000, v122
    v_mul_f32 v90, v90, v89
    v_mul_f32 v91, v91, v89
    v_cvt_pk_bf16_f32 v122, v90, v91
    v_lshlrev_b32 v90, 16, v123
    v_and_b32 v91, 0xffff0000, v123
    v_sub_f32 v90, v90, v88
    v_sub_f32 v91, v91, v88
    v_cvt_pk_bf16_f32 v123, v90, v91
    v_lshlrev_b32 v90, 16, v123
    v_and_b32 v91, 0xffff0000, v123
    v_mul_f32 v90, v90, v89
    v_mul_f32 v91, v91, v89
    v_cvt_pk_bf16_f32 v123, v90, v91
    ds_write_b128 v4, v[120:123] offset:12288
    v_lshlrev_b32 v90, 16, v124
    v_and_b32 v91, 0xffff0000, v124
    v_sub_f32 v90, v90, v88
    v_sub_f32 v91, v91, v88
    v_cvt_pk_bf16_f32 v124, v90, v91
    v_lshlrev_b32 v90, 16, v124
    v_and_b32 v91, 0xffff0000, v124
    v_mul_f32 v90, v90, v89
    v_mul_f32 v91, v91, v89
    v_cvt_pk_bf16_f32 v124, v90, v91
    v_lshlrev_b32 v90, 16, v125
    v_and_b32 v91, 0xffff0000, v125
    v_sub_f32 v90, v90, v88
    v_sub_f32 v91, v91, v88
    v_cvt_pk_bf16_f32 v125, v90, v91
    v_lshlrev_b32 v90, 16, v125
    v_and_b32 v91, 0xffff0000, v125
    v_mul_f32 v90, v90, v89
    v_mul_f32 v91, v91, v89
    v_cvt_pk_bf16_f32 v125, v90, v91
    v_lshlrev_b32 v90, 16, v126
    v_and_b32 v91, 0xffff0000, v126
    v_sub_f32 v90, v90, v88
    v_sub_f32 v91, v91, v88
    v_cvt_pk_bf16_f32 v126, v90, v91
    v_lshlrev_b32 v90, 16, v126
    v_and_b32 v91, 0xffff0000, v126
    v_mul_f32 v90, v90, v89
    v_mul_f32 v91, v91, v89
    v_cvt_pk_bf16_f32 v126, v90, v91
    v_lshlrev_b32 v90, 16, v127
    v_and_b32 v91, 0xffff0000, v127
    v_sub_f32 v90, v90, v88
    v_sub_f32 v91, v91, v88
    v_cvt_pk_bf16_f32 v127, v90, v91
    v_lshlrev_b32 v90, 16, v127
    v_and_b32 v91, 0xffff0000, v127
    v_mul_f32 v90, v90, v89
    v_mul_f32 v91, v91, v89
    v_cvt_pk_bf16_f32 v127, v90, v91
    ds_write_b128 v4, v[124:127] offset:14336
    s_waitcnt lgkmcnt(0)
    s_barrier
    s_lshl_b32 s24, s23, 15
    s_add_u32 s24, s24, 0x800000
    ds_read_b128 v[24:27], v9 offset:0
    ds_read_b128 v[28:31], v9 offset:4096
    ds_read_b128 v[32:35], v9 offset:8192
    ds_read_b128 v[36:39], v9 offset:12288
    ds_read_b128 v[40:43], v9 offset:16384
    ds_read_b128 v[44:47], v9 offset:20480
    ds_read_b128 v[48:51], v9 offset:24576
    ds_read_b128 v[52:55], v9 offset:28672
    s_waitcnt lgkmcnt(7)
    s_add_u32 s36, s24, 0
    buffer_store_dwordx4 v[24:27], v9, s[8:11], s36 offen sc1
    s_waitcnt lgkmcnt(6)
    s_add_u32 s36, s24, 4096
    buffer_store_dwordx4 v[28:31], v9, s[8:11], s36 offen sc1
    s_waitcnt lgkmcnt(5)
    s_add_u32 s36, s24, 8192
    buffer_store_dwordx4 v[32:35], v9, s[8:11], s36 offen sc1
    s_waitcnt lgkmcnt(4)
    s_add_u32 s36, s24, 12288
    buffer_store_dwordx4 v[36:39], v9, s[8:11], s36 offen sc1
    s_waitcnt lgkmcnt(3)
    s_add_u32 s36, s24, 16384
    buffer_store_dwordx4 v[40:43], v9, s[8:11], s36 offen sc1
    s_waitcnt lgkmcnt(2)
    s_add_u32 s36, s24, 20480
    buffer_store_dwordx4 v[44:47], v9, s[8:11], s36 offen sc1
    s_waitcnt lgkmcnt(1)
    s_add_u32 s36, s24, 24576
    buffer_store_dwordx4 v[48:51], v9, s[8:11], s36 offen sc1
    s_waitcnt lgkmcnt(0)
    s_add_u32 s36, s24, 28672
    buffer_store_dwordx4 v[52:55], v9, s[8:11], s36 offen sc1
    s_barrier
    v_mov_b64 v[96:97], v[128:129]
    v_mov_b64 v[98:99], v[130:131]
    v_mov_b64 v[100:101], v[132:133]
    v_mov_b64 v[102:103], v[134:135]
    v_mov_b64 v[104:105], v[136:137]
    v_mov_b64 v[106:107], v[138:139]
    v_mov_b64 v[108:109], v[140:141]
    v_mov_b64 v[110:111], v[142:143]
    v_mov_b64 v[112:113], v[144:145]
    v_mov_b64 v[114:115], v[146:147]
    v_mov_b64 v[116:117], v[148:149]
    v_mov_b64 v[118:119], v[150:151]
    v_mov_b64 v[120:121], v[152:153]
    v_mov_b64 v[122:123], v[154:155]
    v_mov_b64 v[124:125], v[156:157]
    v_mov_b64 v[126:127], v[158:159]
    s_add_u32 s23, s23, 1
    s_bitcmp1_b32 s23, 0
    s_cbranch_scc1 L_XN
    s_waitcnt vmcnt(0)
    s_barrier
    v_mov_b32 v14, 1
    s_lshl_b32 s37, s20, 2
    v_lshlrev_b32 v15, 20, v0
    buffer_store_dword v14, v15, s[16:19], s37 offen sc1
    s_lshr_b32 s20, s2, 3
    s_mov_b32 s34, 0x05040100
    s_mov_b32 s35, 0x07060302
    s_mov_b32 s32, 0
    s_mov_b32 s64, s84
    s_and_b32 s65, s85, 0xffff
    s_mov_b32 s66, 0x1c0000
    s_mov_b32 s67, 0x20000
    s_mov_b32 s68, s86
    s_and_b32 s69, s87, 0xffff
    s_mov_b32 s70, 0x1c0000
    s_mov_b32 s71, 0x20000
    s_mov_b32 s76, s88
    s_and_b32 s77, s89, 0xffff
    s_mov_b32 s78, 0x1c0000
    s_mov_b32 s79, 0x20000
    v_and_b32 v3, 31, v0
    v_lshlrev_b32 v3, 2, v3
L_M_hs:
    buffer_load_dword v5, v3, s[16:19], 0 offen sc1
    s_add_u32 s32, s32, 1
    s_cmp_gt_u32 s32, 200000
    s_waitcnt vmcnt(0)
    s_cbranch_scc1 L_M_hs_ok
    v_cmp_eq_u32 vcc, 0, v5
    s_cbranch_vccz L_M_hs_ok
    s_sleep 16
    s_branch L_M_hs
L_M_hs_ok:
    v_lshlrev_b32 v3, 4, v0
L_M00_rp:
    s_mov_b32 s36, 0x194000
    buffer_load_dwordx4 v[16:19], v3, s[8:11], s36 offen sc1
    s_add_u32 s32, s32, 1
    v_mov_b32 v5, 0
    s_waitcnt vmcnt(0)
    v_max3_u32 v5, v5, v16, v17
    v_max3_u32 v5, v5, v18, v19
    s_cmp_gt_u32 s32, 200000
    s_cbranch_scc1 L_M00_rp_ok
    v_cmp_eq_u32 vcc, -1, v5
    s_cbranch_vccz L_M00_rp_ok
    s_sleep 64
    s_branch L_M00_rp
L_M00_rp_ok:
    v_add_f32 v16, v16, v17
    v_add_f32 v18, v18, v19
    v_add_f32 v16, v16, v18
    v_cvt_pk_bf16_f32 v5, v16, v16
    v_lshlrev_b32 v16, 16, v5
    v_ashrrev_i32 v5, 31, v16
    v_or_b32 v5, 0x80000000, v5
    v_xor_b32 v5, v5, v16
    v_and_b32 v5, 0xffff0000, v5
    v_sub_u32 v6, 2047, v0
    v_or_b32 v120, v5, v6
    v_lshrrev_b32 v1, 5, v0
    v_and_b32 v2, 31, v0
    s_mov_b32 s36, 229376
    v_mul_lo_u32 v4, v1, s36
    v_lshl_add_u32 v4, v2, 2, v4
    v_mov_b32 v5, 0x40000000
    v_cmp_lt_u32 vcc, 27, v2
    s_nop 1
    v_cndmask_b32 v4, v4, v5, vcc
    s_mul_i32 s23, s20, 112
    s_add_u32 s36, s23, 0
    buffer_load_dword v16, v4, s[64:67], s36 offen
    s_add_u32 s36, s23, 3584
    buffer_load_dword v17, v4, s[64:67], s36 offen
    s_add_u32 s36, s23, 7168
    buffer_load_dword v18, v4, s[64:67], s36 offen
    s_add_u32 s36, s23, 10752
    buffer_load_dword v19, v4, s[64:67], s36 offen
    s_add_u32 s36, s23, 14336
    buffer_load_dword v20, v4, s[64:67], s36 offen
    s_add_u32 s36, s23, 17920
    buffer_load_dword v21, v4, s[64:67], s36 offen
    s_add_u32 s36, s23, 21504
    buffer_load_dword v22, v4, s[64:67], s36 offen
    s_add_u32 s36, s23, 25088
    buffer_load_dword v23, v4, s[64:67], s36 offen
    s_add_u32 s36, s23, 28672
    buffer_load_dword v24, v4, s[64:67], s36 offen
    s_add_u32 s36, s23, 32256
    buffer_load_dword v25, v4, s[64:67], s36 offen
    s_add_u32 s36, s23, 35840
    buffer_load_dword v26, v4, s[64:67], s36 offen
    s_add_u32 s36, s23, 39424
    buffer_load_dword v27, v4, s[64:67], s36 offen
    s_add_u32 s36, s23, 43008
    buffer_load_dword v28, v4, s[64:67], s36 offen
    s_add_u32 s36, s23, 46592
    buffer_load_dword v29, v4, s[64:67], s36 offen
    s_add_u32 s36, s23, 50176
    buffer_load_dword v30, v4, s[64:67], s36 offen
    s_add_u32 s36, s23, 53760
    buffer_load_dword v31, v4, s[64:67], s36 offen
    s_add_u32 s36, s23, 57344
    buffer_load_dword v32, v4, s[64:67], s36 offen
    s_add_u32 s36, s23, 60928
    buffer_load_dword v33, v4, s[64:67], s36 offen
    s_add_u32 s36, s23, 64512
    buffer_load_dword v34, v4, s[64:67], s36 offen
    s_add_u32 s36, s23, 68096
    buffer_load_dword v35, v4, s[64:67], s36 offen
    s_add_u32 s36, s23, 71680
    buffer_load_dword v36, v4, s[64:67], s36 offen
    s_add_u32 s36, s23, 75264
    buffer_load_dword v37, v4, s[64:67], s36 offen
    s_add_u32 s36, s23, 78848
    buffer_load_dword v38, v4, s[64:67], s36 offen
    s_add_u32 s36, s23, 82432
    buffer_load_dword v39, v4, s[64:67], s36 offen
    s_add_u32 s36, s23, 86016
    buffer_load_dword v40, v4, s[64:67], s36 offen
    s_add_u32 s36, s23, 89600
    buffer_load_dword v41, v4, s[64:67], s36 offen
    s_add_u32 s36, s23, 93184
    buffer_load_dword v42, v4, s[64:67], s36 offen
    s_add_u32 s36, s23, 96768
    buffer_load_dword v43, v4, s[64:67], s36 offen
    s_add_u32 s36, s23, 100352
    buffer_load_dword v44, v4, s[64:67], s36 offen
    s_add_u32 s36, s23, 103936
    buffer_load_dword v45, v4, s[64:67], s36 offen
    s_add_u32 s36, s23, 107520
    buffer_load_dword v46, v4, s[64:67], s36 offen
    s_add_u32 s36, s23, 111104
    buffer_load_dword v47, v4, s[64:67], s36 offen
    s_waitcnt vmcnt(0)
    v_perm_b32 v128, v17, v16, s34
    v_perm_b32 v129, v19, v18, s34
    v_perm_b32 v130, v21, v20, s34
    v_perm_b32 v131, v23, v22, s34
    v_perm_b32 v132, v25, v24, s34
    v_perm_b32 v133, v27, v26, s34
    v_perm_b32 v134, v29, v28, s34
    v_perm_b32 v135, v31, v30, s34
    v_perm_b32 v136, v33, v32, s34
    v_perm_b32 v137, v35, v34, s34
    v_perm_b32 v138, v37, v36, s34
    v_perm_b32 v139, v39, v38, s34
    v_perm_b32 v140, v41, v40, s34
    v_perm_b32 v141, v43, v42, s34
    v_perm_b32 v142, v45, v44, s34
    v_perm_b32 v143, v47, v46, s34
    v_perm_b32 v160, v17, v16, s35
    v_perm_b32 v161, v19, v18, s35
    v_perm_b32 v162, v21, v20, s35
    v_perm_b32 v163, v23, v22, s35
    v_perm_b32 v164, v25, v24, s35
    v_perm_b32 v165, v27, v26, s35
    v_perm_b32 v166, v29, v28, s35
    v_perm_b32 v167, v31, v30, s35
    v_perm_b32 v168, v33, v32, s35
    v_perm_b32 v169, v35, v34, s35
    v_perm_b32 v170, v37, v36, s35
    v_perm_b32 v171, v39, v38, s35
    v_perm_b32 v172, v41, v40, s35
    v_perm_b32 v173, v43, v42, s35
    v_perm_b32 v174, v45, v44, s35
    v_perm_b32 v175, v47, v46, s35
    s_add_u32 s36, s23, 114688
    buffer_load_dword v16, v4, s[64:67], s36 offen
    s_add_u32 s36, s23, 118272
    buffer_load_dword v17, v4, s[64:67], s36 offen
    s_add_u32 s36, s23, 121856
    buffer_load_dword v18, v4, s[64:67], s36 offen
    s_add_u32 s36, s23, 125440
    buffer_load_dword v19, v4, s[64:67], s36 offen
    s_add_u32 s36, s23, 129024
    buffer_load_dword v20, v4, s[64:67], s36 offen
    s_add_u32 s36, s23, 132608
    buffer_load_dword v21, v4, s[64:67], s36 offen
    s_add_u32 s36, s23, 136192
    buffer_load_dword v22, v4, s[64:67], s36 offen
    s_add_u32 s36, s23, 139776
    buffer_load_dword v23, v4, s[64:67], s36 offen
    s_add_u32 s36, s23, 143360
    buffer_load_dword v24, v4, s[64:67], s36 offen
    s_add_u32 s36, s23, 146944
    buffer_load_dword v25, v4, s[64:67], s36 offen
    s_add_u32 s36, s23, 150528
    buffer_load_dword v26, v4, s[64:67], s36 offen
    s_add_u32 s36, s23, 154112
    buffer_load_dword v27, v4, s[64:67], s36 offen
    s_add_u32 s36, s23, 157696
    buffer_load_dword v28, v4, s[64:67], s36 offen
    s_add_u32 s36, s23, 161280
    buffer_load_dword v29, v4, s[64:67], s36 offen
    s_add_u32 s36, s23, 164864
    buffer_load_dword v30, v4, s[64:67], s36 offen
    s_add_u32 s36, s23, 168448
    buffer_load_dword v31, v4, s[64:67], s36 offen
    s_add_u32 s36, s23, 172032
    buffer_load_dword v32, v4, s[64:67], s36 offen
    s_add_u32 s36, s23, 175616
    buffer_load_dword v33, v4, s[64:67], s36 offen
    s_add_u32 s36, s23, 179200
    buffer_load_dword v34, v4, s[64:67], s36 offen
    s_add_u32 s36, s23, 182784
    buffer_load_dword v35, v4, s[64:67], s36 offen
    s_add_u32 s36, s23, 186368
    buffer_load_dword v36, v4, s[64:67], s36 offen
    s_add_u32 s36, s23, 189952
    buffer_load_dword v37, v4, s[64:67], s36 offen
    s_add_u32 s36, s23, 193536
    buffer_load_dword v38, v4, s[64:67], s36 offen
    s_add_u32 s36, s23, 197120
    buffer_load_dword v39, v4, s[64:67], s36 offen
    s_add_u32 s36, s23, 200704
    buffer_load_dword v40, v4, s[64:67], s36 offen
    s_add_u32 s36, s23, 204288
    buffer_load_dword v41, v4, s[64:67], s36 offen
    s_add_u32 s36, s23, 207872
    buffer_load_dword v42, v4, s[64:67], s36 offen
    s_add_u32 s36, s23, 211456
    buffer_load_dword v43, v4, s[64:67], s36 offen
    s_add_u32 s36, s23, 215040
    buffer_load_dword v44, v4, s[64:67], s36 offen
    s_add_u32 s36, s23, 218624
    buffer_load_dword v45, v4, s[64:67], s36 offen
    s_add_u32 s36, s23, 222208
    buffer_load_dword v46, v4, s[64:67], s36 offen
    s_add_u32 s36, s23, 225792
    buffer_load_dword v47, v4, s[64:67], s36 offen
    s_waitcnt vmcnt(0)
    v_perm_b32 v144, v17, v16, s34
    v_perm_b32 v145, v19, v18, s34
    v_perm_b32 v146, v21, v20, s34
    v_perm_b32 v147, v23, v22, s34
    v_perm_b32 v148, v25, v24, s34
    v_perm_b32 v149, v27, v26, s34
    v_perm_b32 v150, v29, v28, s34
    v_perm_b32 v151, v31, v30, s34
    v_perm_b32 v152, v33, v32, s34
    v_perm_b32 v153, v35, v34, s34
    v_perm_b32 v154, v37, v36, s34
    v_perm_b32 v155, v39, v38, s34
    v_perm_b32 v156, v41, v40, s34
    v_perm_b32 v157, v43, v42, s34
    v_perm_b32 v158, v45, v44, s34
    v_perm_b32 v159, v47, v46, s34
    v_perm_b32 v176, v17, v16, s35
    v_perm_b32 v177, v19, v18, s35
    v_perm_b32 v178, v21, v20, s35
    v_perm_b32 v179, v23, v22, s35
    v_perm_b32 v180, v25, v24, s35
    v_perm_b32 v181, v27, v26, s35
    v_perm_b32 v182, v29, v28, s35
    v_perm_b32 v183, v31, v30, s35
    v_perm_b32 v184, v33, v32, s35
    v_perm_b32 v185, v35, v34, s35
    v_perm_b32 v186, v37, v36, s35
    v_perm_b32 v187, v39, v38, s35
    v_perm_b32 v188, v41, v40, s35
    v_perm_b32 v189, v43, v42, s35
    v_perm_b32 v190, v45, v44, s35
    v_perm_b32 v191, v47, v46, s35
    s_add_u32 s36, s23, 0
    buffer_load_dword v16, v4, s[68:71], s36 offen
    s_add_u32 s36, s23, 3584
    buffer_load_dword v17, v4, s[68:71], s36 offen
    s_add_u32 s36, s23, 7168
    buffer_load_dword v18, v4, s[68:71], s36 offen
    s_add_u32 s36, s23, 10752
    buffer_load_dword v19, v4, s[68:71], s36 offen
    s_add_u32 s36, s23, 14336
    buffer_load_dword v20, v4, s[68:71], s36 offen
    s_add_u32 s36, s23, 17920
    buffer_load_dword v21, v4, s[68:71], s36 offen
    s_add_u32 s36, s23, 21504
    buffer_load_dword v22, v4, s[68:71], s36 offen
    s_add_u32 s36, s23, 25088
    buffer_load_dword v23, v4, s[68:71], s36 offen
    s_add_u32 s36, s23, 28672
    buffer_load_dword v24, v4, s[68:71], s36 offen
    s_add_u32 s36, s23, 32256
    buffer_load_dword v25, v4, s[68:71], s36 offen
    s_add_u32 s36, s23, 35840
    buffer_load_dword v26, v4, s[68:71], s36 offen
    s_add_u32 s36, s23, 39424
    buffer_load_dword v27, v4, s[68:71], s36 offen
    s_add_u32 s36, s23, 43008
    buffer_load_dword v28, v4, s[68:71], s36 offen
    s_add_u32 s36, s23, 46592
    buffer_load_dword v29, v4, s[68:71], s36 offen
    s_add_u32 s36, s23, 50176
    buffer_load_dword v30, v4, s[68:71], s36 offen
    s_add_u32 s36, s23, 53760
    buffer_load_dword v31, v4, s[68:71], s36 offen
    s_add_u32 s36, s23, 57344
    buffer_load_dword v32, v4, s[68:71], s36 offen
    s_add_u32 s36, s23, 60928
    buffer_load_dword v33, v4, s[68:71], s36 offen
    s_add_u32 s36, s23, 64512
    buffer_load_dword v34, v4, s[68:71], s36 offen
    s_add_u32 s36, s23, 68096
    buffer_load_dword v35, v4, s[68:71], s36 offen
    s_add_u32 s36, s23, 71680
    buffer_load_dword v36, v4, s[68:71], s36 offen
    s_add_u32 s36, s23, 75264
    buffer_load_dword v37, v4, s[68:71], s36 offen
    s_add_u32 s36, s23, 78848
    buffer_load_dword v38, v4, s[68:71], s36 offen
    s_add_u32 s36, s23, 82432
    buffer_load_dword v39, v4, s[68:71], s36 offen
    s_add_u32 s36, s23, 86016
    buffer_load_dword v40, v4, s[68:71], s36 offen
    s_add_u32 s36, s23, 89600
    buffer_load_dword v41, v4, s[68:71], s36 offen
    s_add_u32 s36, s23, 93184
    buffer_load_dword v42, v4, s[68:71], s36 offen
    s_add_u32 s36, s23, 96768
    buffer_load_dword v43, v4, s[68:71], s36 offen
    s_add_u32 s36, s23, 100352
    buffer_load_dword v44, v4, s[68:71], s36 offen
    s_add_u32 s36, s23, 103936
    buffer_load_dword v45, v4, s[68:71], s36 offen
    s_add_u32 s36, s23, 107520
    buffer_load_dword v46, v4, s[68:71], s36 offen
    s_add_u32 s36, s23, 111104
    buffer_load_dword v47, v4, s[68:71], s36 offen
    s_waitcnt vmcnt(0)
    v_perm_b32 v192, v17, v16, s34
    v_perm_b32 v193, v19, v18, s34
    v_perm_b32 v194, v21, v20, s34
    v_perm_b32 v195, v23, v22, s34
    v_perm_b32 v196, v25, v24, s34
    v_perm_b32 v197, v27, v26, s34
    v_perm_b32 v198, v29, v28, s34
    v_perm_b32 v199, v31, v30, s34
    v_perm_b32 v200, v33, v32, s34
    v_perm_b32 v201, v35, v34, s34
    v_perm_b32 v202, v37, v36, s34
    v_perm_b32 v203, v39, v38, s34
    v_perm_b32 v204, v41, v40, s34
    v_perm_b32 v205, v43, v42, s34
    v_perm_b32 v206, v45, v44, s34
    v_perm_b32 v207, v47, v46, s34
    v_perm_b32 v224, v17, v16, s35
    v_perm_b32 v225, v19, v18, s35
    v_perm_b32 v226, v21, v20, s35
    v_perm_b32 v227, v23, v22, s35
    v_perm_b32 v228, v25, v24, s35
    v_perm_b32 v229, v27, v26, s35
    v_perm_b32 v230, v29, v28, s35
    v_perm_b32 v231, v31, v30, s35
    v_perm_b32 v232, v33, v32, s35
    v_perm_b32 v233, v35, v34, s35
    v_perm_b32 v234, v37, v36, s35
    v_perm_b32 v235, v39, v38, s35
    v_perm_b32 v236, v41, v40, s35
    v_perm_b32 v237, v43, v42, s35
    v_perm_b32 v238, v45, v44, s35
    v_perm_b32 v239, v47, v46, s35
    s_add_u32 s36, s23, 114688
    buffer_load_dword v16, v4, s[68:71], s36 offen
    s_add_u32 s36, s23, 118272
    buffer_load_dword v17, v4, s[68:71], s36 offen
    s_add_u32 s36, s23, 121856
    buffer_load_dword v18, v4, s[68:71], s36 offen
    s_add_u32 s36, s23, 125440
    buffer_load_dword v19, v4, s[68:71], s36 offen
    s_add_u32 s36, s23, 129024
    buffer_load_dword v20, v4, s[68:71], s36 offen
    s_add_u32 s36, s23, 132608
    buffer_load_dword v21, v4, s[68:71], s36 offen
    s_add_u32 s36, s23, 136192
    buffer_load_dword v22, v4, s[68:71], s36 offen
    s_add_u32 s36, s23, 139776
    buffer_load_dword v23, v4, s[68:71], s36 offen
    s_add_u32 s36, s23, 143360
    buffer_load_dword v24, v4, s[68:71], s36 offen
    s_add_u32 s36, s23, 146944
    buffer_load_dword v25, v4, s[68:71], s36 offen
    s_add_u32 s36, s23, 150528
    buffer_load_dword v26, v4, s[68:71], s36 offen
    s_add_u32 s36, s23, 154112
    buffer_load_dword v27, v4, s[68:71], s36 offen
    s_add_u32 s36, s23, 157696
    buffer_load_dword v28, v4, s[68:71], s36 offen
    s_add_u32 s36, s23, 161280
    buffer_load_dword v29, v4, s[68:71], s36 offen
    s_add_u32 s36, s23, 164864
    buffer_load_dword v30, v4, s[68:71], s36 offen
    s_add_u32 s36, s23, 168448
    buffer_load_dword v31, v4, s[68:71], s36 offen
    s_add_u32 s36, s23, 172032
    buffer_load_dword v32, v4, s[68:71], s36 offen
    s_add_u32 s36, s23, 175616
    buffer_load_dword v33, v4, s[68:71], s36 offen
    s_add_u32 s36, s23, 179200
    buffer_load_dword v34, v4, s[68:71], s36 offen
    s_add_u32 s36, s23, 182784
    buffer_load_dword v35, v4, s[68:71], s36 offen
    s_add_u32 s36, s23, 186368
    buffer_load_dword v36, v4, s[68:71], s36 offen
    s_add_u32 s36, s23, 189952
    buffer_load_dword v37, v4, s[68:71], s36 offen
    s_add_u32 s36, s23, 193536
    buffer_load_dword v38, v4, s[68:71], s36 offen
    s_add_u32 s36, s23, 197120
    buffer_load_dword v39, v4, s[68:71], s36 offen
    s_add_u32 s36, s23, 200704
    buffer_load_dword v40, v4, s[68:71], s36 offen
    s_add_u32 s36, s23, 204288
    buffer_load_dword v41, v4, s[68:71], s36 offen
    s_add_u32 s36, s23, 207872
    buffer_load_dword v42, v4, s[68:71], s36 offen
    s_add_u32 s36, s23, 211456
    buffer_load_dword v43, v4, s[68:71], s36 offen
    s_add_u32 s36, s23, 215040
    buffer_load_dword v44, v4, s[68:71], s36 offen
    s_add_u32 s36, s23, 218624
    buffer_load_dword v45, v4, s[68:71], s36 offen
    s_add_u32 s36, s23, 222208
    buffer_load_dword v46, v4, s[68:71], s36 offen
    s_add_u32 s36, s23, 225792
    buffer_load_dword v47, v4, s[68:71], s36 offen
    s_waitcnt vmcnt(0)
    v_perm_b32 v208, v17, v16, s34
    v_perm_b32 v209, v19, v18, s34
    v_perm_b32 v210, v21, v20, s34
    v_perm_b32 v211, v23, v22, s34
    v_perm_b32 v212, v25, v24, s34
    v_perm_b32 v213, v27, v26, s34
    v_perm_b32 v214, v29, v28, s34
    v_perm_b32 v215, v31, v30, s34
    v_perm_b32 v216, v33, v32, s34
    v_perm_b32 v217, v35, v34, s34
    v_perm_b32 v218, v37, v36, s34
    v_perm_b32 v219, v39, v38, s34
    v_perm_b32 v220, v41, v40, s34
    v_perm_b32 v221, v43, v42, s34
    v_perm_b32 v222, v45, v44, s34
    v_perm_b32 v223, v47, v46, s34
    v_perm_b32 v240, v17, v16, s35
    v_perm_b32 v241, v19, v18, s35
    v_perm_b32 v242, v21, v20, s35
    v_perm_b32 v243, v23, v22, s35
    v_perm_b32 v244, v25, v24, s35
    v_perm_b32 v245, v27, v26, s35
    v_perm_b32 v246, v29, v28, s35
    v_perm_b32 v247, v31, v30, s35
    v_perm_b32 v248, v33, v32, s35
    v_perm_b32 v249, v35, v34, s35
    v_perm_b32 v250, v37, v36, s35
    v_perm_b32 v251, v39, v38, s35
    v_perm_b32 v252, v41, v40, s35
    v_perm_b32 v253, v43, v42, s35
    v_perm_b32 v254, v45, v44, s35
    v_perm_b32 v255, v47, v46, s35
    v_lshrrev_b32 v3, 3, v0
    v_mul_u32_u24 v4, 57344, v3
    v_and_b32 v3, 7, v0
    v_lshl_add_u32 v4, v3, 2, v4
    s_lshl_b32 s37, s20, 5
    s_add_u32 s36, s37, 0
    buffer_load_dword v16, v4, s[76:79], s36 offen
    s_add_u32 s36, s37, 1024
    buffer_load_dword v17, v4, s[76:79], s36 offen
    s_add_u32 s36, s37, 2048
    buffer_load_dword v18, v4, s[76:79], s36 offen
    s_add_u32 s36, s37, 3072
    buffer_load_dword v19, v4, s[76:79], s36 offen
    s_add_u32 s36, s37, 4096
    buffer_load_dword v20, v4, s[76:79], s36 offen
    s_add_u32 s36, s37, 5120
    buffer_load_dword v21, v4, s[76:79], s36 offen
    s_add_u32 s36, s37, 6144
    buffer_load_dword v22, v4, s[76:79], s36 offen
    s_add_u32 s36, s37, 7168
    buffer_load_dword v23, v4, s[76:79], s36 offen
    s_add_u32 s36, s37, 8192
    buffer_load_dword v24, v4, s[76:79], s36 offen
    s_add_u32 s36, s37, 9216
    buffer_load_dword v25, v4, s[76:79], s36 offen
    s_add_u32 s36, s37, 10240
    buffer_load_dword v26, v4, s[76:79], s36 offen
    s_add_u32 s36, s37, 11264
    buffer_load_dword v27, v4, s[76:79], s36 offen
    s_add_u32 s36, s37, 12288
    buffer_load_dword v28, v4, s[76:79], s36 offen
    s_add_u32 s36, s37, 13312
    buffer_load_dword v29, v4, s[76:79], s36 offen
    s_add_u32 s36, s37, 14336
    buffer_load_dword v30, v4, s[76:79], s36 offen
    s_add_u32 s36, s37, 15360
    buffer_load_dword v31, v4, s[76:79], s36 offen
    s_add_u32 s36, s37, 16384
    buffer_load_dword v32, v4, s[76:79], s36 offen
    s_add_u32 s36, s37, 17408
    buffer_load_dword v33, v4, s[76:79], s36 offen
    s_add_u32 s36, s37, 18432
    buffer_load_dword v34, v4, s[76:79], s36 offen
    s_add_u32 s36, s37, 19456
    buffer_load_dword v35, v4, s[76:79], s36 offen
    s_add_u32 s36, s37, 20480
    buffer_load_dword v36, v4, s[76:79], s36 offen
    s_add_u32 s36, s37, 21504
    buffer_load_dword v37, v4, s[76:79], s36 offen
    s_add_u32 s36, s37, 22528
    buffer_load_dword v38, v4, s[76:79], s36 offen
    s_add_u32 s36, s37, 23552
    buffer_load_dword v39, v4, s[76:79], s36 offen
    s_add_u32 s36, s37, 24576
    buffer_load_dword v40, v4, s[76:79], s36 offen
    s_add_u32 s36, s37, 25600
    buffer_load_dword v41, v4, s[76:79], s36 offen
    s_add_u32 s36, s37, 26624
    buffer_load_dword v42, v4, s[76:79], s36 offen
    s_add_u32 s36, s37, 27648
    buffer_load_dword v43, v4, s[76:79], s36 offen
    s_waitcnt vmcnt(0)
    v_perm_b32 v64, v17, v16, s34
    v_perm_b32 v65, v19, v18, s34
    v_perm_b32 v66, v21, v20, s34
    v_perm_b32 v67, v23, v22, s34
    v_perm_b32 v68, v25, v24, s34
    v_perm_b32 v69, v27, v26, s34
    v_perm_b32 v70, v29, v28, s34
    v_perm_b32 v71, v31, v30, s34
    v_perm_b32 v72, v33, v32, s34
    v_perm_b32 v73, v35, v34, s34
    v_perm_b32 v74, v37, v36, s34
    v_perm_b32 v75, v39, v38, s34
    v_perm_b32 v76, v41, v40, s34
    v_perm_b32 v77, v43, v42, s34
    v_perm_b32 v92, v17, v16, s35
    v_perm_b32 v93, v19, v18, s35
    v_perm_b32 v94, v21, v20, s35
    v_perm_b32 v95, v23, v22, s35
    v_perm_b32 v96, v25, v24, s35
    v_perm_b32 v97, v27, v26, s35
    v_perm_b32 v98, v29, v28, s35
    v_perm_b32 v99, v31, v30, s35
    v_perm_b32 v100, v33, v32, s35
    v_perm_b32 v101, v35, v34, s35
    v_perm_b32 v102, v37, v36, s35
    v_perm_b32 v103, v39, v38, s35
    v_perm_b32 v104, v41, v40, s35
    v_perm_b32 v105, v43, v42, s35
    s_add_u32 s36, s37, 28672
    buffer_load_dword v16, v4, s[76:79], s36 offen
    s_add_u32 s36, s37, 29696
    buffer_load_dword v17, v4, s[76:79], s36 offen
    s_add_u32 s36, s37, 30720
    buffer_load_dword v18, v4, s[76:79], s36 offen
    s_add_u32 s36, s37, 31744
    buffer_load_dword v19, v4, s[76:79], s36 offen
    s_add_u32 s36, s37, 32768
    buffer_load_dword v20, v4, s[76:79], s36 offen
    s_add_u32 s36, s37, 33792
    buffer_load_dword v21, v4, s[76:79], s36 offen
    s_add_u32 s36, s37, 34816
    buffer_load_dword v22, v4, s[76:79], s36 offen
    s_add_u32 s36, s37, 35840
    buffer_load_dword v23, v4, s[76:79], s36 offen
    s_add_u32 s36, s37, 36864
    buffer_load_dword v24, v4, s[76:79], s36 offen
    s_add_u32 s36, s37, 37888
    buffer_load_dword v25, v4, s[76:79], s36 offen
    s_add_u32 s36, s37, 38912
    buffer_load_dword v26, v4, s[76:79], s36 offen
    s_add_u32 s36, s37, 39936
    buffer_load_dword v27, v4, s[76:79], s36 offen
    s_add_u32 s36, s37, 40960
    buffer_load_dword v28, v4, s[76:79], s36 offen
    s_add_u32 s36, s37, 41984
    buffer_load_dword v29, v4, s[76:79], s36 offen
    s_add_u32 s36, s37, 43008
    buffer_load_dword v30, v4, s[76:79], s36 offen
    s_add_u32 s36, s37, 44032
    buffer_load_dword v31, v4, s[76:79], s36 offen
    s_add_u32 s36, s37, 45056
    buffer_load_dword v32, v4, s[76:79], s36 offen
    s_add_u32 s36, s37, 46080
    buffer_load_dword v33, v4, s[76:79], s36 offen
    s_add_u32 s36, s37, 47104
    buffer_load_dword v34, v4, s[76:79], s36 offen
    s_add_u32 s36, s37, 48128
    buffer_load_dword v35, v4, s[76:79], s36 offen
    s_add_u32 s36, s37, 49152
    buffer_load_dword v36, v4, s[76:79], s36 offen
    s_add_u32 s36, s37, 50176
    buffer_load_dword v37, v4, s[76:79], s36 offen
    s_add_u32 s36, s37, 51200
    buffer_load_dword v38, v4, s[76:79], s36 offen
    s_add_u32 s36, s37, 52224
    buffer_load_dword v39, v4, s[76:79], s36 offen
    s_add_u32 s36, s37, 53248
    buffer_load_dword v40, v4, s[76:79], s36 offen
    s_add_u32 s36, s37, 54272
    buffer_load_dword v41, v4, s[76:79], s36 offen
    s_add_u32 s36, s37, 55296
    buffer_load_dword v42, v4, s[76:79], s36 offen
    s_add_u32 s36, s37, 56320
    buffer_load_dword v43, v4, s[76:79], s36 offen
    s_waitcnt vmcnt(0)
    v_perm_b32 v78, v17, v16, s34
    v_perm_b32 v79, v19, v18, s34
    v_perm_b32 v80, v21, v20, s34
    v_perm_b32 v81, v23, v22, s34
    v_perm_b32 v82, v25, v24, s34
    v_perm_b32 v83, v27, v26, s34
    v_perm_b32 v84, v29, v28, s34
    v_perm_b32 v85, v31, v30, s34
    v_perm_b32 v86, v33, v32, s34
    v_perm_b32 v87, v35, v34, s34
    v_perm_b32 v88, v37, v36, s34
    v_perm_b32 v89, v39, v38, s34
    v_perm_b32 v90, v41, v40, s34
    v_perm_b32 v91, v43, v42, s34
    v_perm_b32 v106, v17, v16, s35
    v_perm_b32 v107, v19, v18, s35
    v_perm_b32 v108, v21, v20, s35
    v_perm_b32 v109, v23, v22, s35
    v_perm_b32 v110, v25, v24, s35
    v_perm_b32 v111, v27, v26, s35
    v_perm_b32 v112, v29, v28, s35
    v_perm_b32 v113, v31, v30, s35
    v_perm_b32 v114, v33, v32, s35
    v_perm_b32 v115, v35, v34, s35
    v_perm_b32 v116, v37, v36, s35
    v_perm_b32 v117, v39, v38, s35
    v_perm_b32 v118, v41, v40, s35
    v_perm_b32 v119, v43, v42, s35
    s_mov_b32 s24, 0
    s_mov_b64 s[28:29], 0
    v_mov_b32 v12, 0x40000000
    v_mov_b32 v13, 0
    v_lshlrev_b32 v3, 4, v0
L_M06_rp:
    s_mov_b32 s36, 0x19a000
    buffer_load_dwordx4 v[40:43], v3, s[8:11], s36 offen sc1
    s_add_u32 s32, s32, 1
    v_mov_b32 v5, 0
    s_waitcnt vmcnt(0)
    v_max3_u32 v5, v5, v40, v41
    v_max3_u32 v5, v5, v42, v43
    s_cmp_gt_u32 s32, 200000
    s_cbranch_scc1 L_M06_rp_ok
    v_cmp_eq_u32 vcc, -1, v5
    s_cbranch_vccz L_M06_rp_ok
    s_sleep 32
    s_branch L_M06_rp
L_M06_rp_ok:
    v_add_f32 v40, v40, v41
    v_add_f32 v42, v42, v43
    v_add_f32 v40, v40, v42
    v_cvt_pk_bf16_f32 v5, v40, v40
    v_lshlrev_b32 v40, 16, v5
    v_ashrrev_i32 v5, 31, v40
    v_or_b32 v5, 0x80000000, v5
    v_xor_b32 v5, v5, v40
    v_and_b32 v5, 0xffff0000, v5
    v_sub_u32 v6, 511, v0
    v_or_b32 v126, v5, v6
    v_lshlrev_b32 v3, 4, v0
L_M01_rp:
    s_mov_b32 s36, 0x195000
    buffer_load_dwordx4 v[20:23], v3, s[8:11], s36 offen sc1
    s_mov_b32 s36, 0x196000
    buffer_load_dwordx4 v[24:27], v3, s[8:11], s36 offen sc1
    s_mov_b32 s36, 0x197000
    buffer_load_dwordx4 v[28:31], v3, s[8:11], s36 offen sc1
    s_mov_b32 s36, 0x198000
    buffer_load_dwordx4 v[32:35], v3, s[8:11], s36 offen sc1
    s_mov_b32 s36, 0x199000
    buffer_load_dwordx4 v[36:39], v3, s[8:11], s36 offen sc1
    s_add_u32 s32, s32, 1
    v_mov_b32 v5, 0
    s_waitcnt vmcnt(0)
    v_max3_u32 v5, v5, v20, v21
    v_max3_u32 v5, v5, v22, v23
    v_max3_u32 v5, v5, v24, v25
    v_max3_u32 v5, v5, v26, v27
    v_max3_u32 v5, v5, v28, v29
    v_max3_u32 v5, v5, v30, v31
    v_max3_u32 v5, v5, v32, v33
    v_max3_u32 v5, v5, v34, v35
    v_max3_u32 v5, v5, v36, v37
    v_max3_u32 v5, v5, v38, v39
    s_cmp_gt_u32 s32, 200000
    s_cbranch_scc1 L_M01_rp_ok
    v_cmp_eq_u32 vcc, -1, v5
    s_cbranch_vccz L_M01_rp_ok
    s_sleep 8
    s_branch L_M01_rp
L_M01_rp_ok:
    v_add_f32 v20, v20, v21
    v_add_f32 v22, v22, v23
    v_add_f32 v20, v20, v22
    v_cvt_pk_bf16_f32 v5, v20, v20
    v_lshlrev_b32 v20, 16, v5
    v_ashrrev_i32 v5, 31, v20
    v_or_b32 v5, 0x80000000, v5
    v_xor_b32 v5, v5, v20
    v_and_b32 v5, 0xffff0000, v5
    v_sub_u32 v6, 1791, v0
    v_or_b32 v121, v5, v6
    v_add_f32 v24, v24, v25
    v_add_f32 v26, v26, v27
    v_add_f32 v24, v24, v26
    v_cvt_pk_bf16_f32 v5, v24, v24
    v_lshlrev_b32 v24, 16, v5
    v_ashrrev_i32 v5, 31, v24
    v_or_b32 v5, 0x80000000, v5
    v_xor_b32 v5, v5, v24
    v_and_b32 v5, 0xffff0000, v5
    v_sub_u32 v6, 1535, v0
    v_or_b32 v122, v5, v6
    v_add_f32 v28, v28, v29
    v_add_f32 v30, v30, v31
    v_add_f32 v28, v28, v30
    v_cvt_pk_bf16_f32 v5, v28, v28
    v_lshlrev_b32 v28, 16, v5
    v_ashrrev_i32 v5, 31, v28
    v_or_b32 v5, 0x80000000, v5
    v_xor_b32 v5, v5, v28
    v_and_b32 v5, 0xffff0000, v5
    v_sub_u32 v6, 1279, v0
    v_or_b32 v123, v5, v6
    v_add_f32 v32, v32, v33
    v_add_f32 v34, v34, v35
    v_add_f32 v32, v32, v34
    v_cvt_pk_bf16_f32 v5, v32, v32
    v_lshlrev_b32 v32, 16, v5
    v_ashrrev_i32 v5, 31, v32
    v_or_b32 v5, 0x80000000, v5
    v_xor_b32 v5, v5, v32
    v_and_b32 v5, 0xffff0000, v5
    v_sub_u32 v6, 1023, v0
    v_or_b32 v124, v5, v6
    v_add_f32 v36, v36, v37
    v_add_f32 v38, v38, v39
    v_add_f32 v36, v36, v38
    v_cvt_pk_bf16_f32 v5, v36, v36
    v_lshlrev_b32 v36, 16, v5
    v_ashrrev_i32 v5, 31, v36
    v_or_b32 v5, 0x80000000, v5
    v_xor_b32 v5, v5, v36
    v_and_b32 v5, 0xffff0000, v5
    v_sub_u32 v6, 767, v0
    v_or_b32 v125, v5, v6
    v_max_u32 v5, v120, v121
    v_min_u32 v6, v120, v121
    v_med3_u32 v6, v5, v6, v122
    v_max_u32 v5, v5, v122
    v_med3_u32 v6, v5, v6, v123
    v_max_u32 v5, v5, v123
    v_med3_u32 v6, v5, v6, v124
    v_max_u32 v5, v5, v124
    v_med3_u32 v6, v5, v6, v125
    v_max_u32 v5, v5, v125
    v_med3_u32 v6, v5, v6, v126
    v_max_u32 v5, v5, v126
    v_mov_b32 v120, v5
    v_mov_b32 v121, v6
    s_mov_b32 s25, 32
L_M_round:
    v_lshlrev_b32 v3, 4, v0
    v_cmp_gt_u32 s[74:75], s25, v0
L_M7_rp:
    s_mov_b32 s36, 0x19b000
    buffer_load_dwordx4 v[44:47], v3, s[8:11], s36 offen sc1
    s_add_u32 s32, s32, 1
    v_mov_b32 v5, 0
    s_waitcnt vmcnt(0)
    v_max3_u32 v5, v5, v44, v45
    v_max3_u32 v5, v5, v46, v47
    v_cndmask_b32 v5, 0, v5, s[74:75]
    s_cmp_gt_u32 s32, 200000
    s_cbranch_scc1 L_M7_rp_ok
    v_cmp_eq_u32 vcc, -1, v5
    s_cbranch_vccnz L_M7_rp
L_M7_rp_ok:
    v_add_f32 v44, v44, v45
    v_add_f32 v46, v46, v47
    v_add_f32 v44, v44, v46
    v_cvt_pk_bf16_f32 v5, v44, v44
    v_lshlrev_b32 v44, 16, v5
    v_ashrrev_i32 v5, 31, v44
    v_or_b32 v5, 0x80000000, v5
    v_xor_b32 v5, v5, v44
    v_and_b32 v5, 0xffff0000, v5
    v_sub_u32 v6, 255, v0
    v_or_b32 v127, v5, v6
    v_cndmask_b32 v127, 0, v127, s[74:75]
    v_max_u32 v5, v120, v127
    v_med3_u32 v6, v120, v121, v127
    s_nop 0
    v_mov_b32_dpp v7, v5 quad_perm:[1,0,3,2] row_mask:0xf bank_mask:0xf
    v_mov_b32_dpp v8, v6 quad_perm:[1,0,3,2] row_mask:0xf bank_mask:0xf
    v_min_u32 v9, v5, v7
    v_max_u32 v5, v5, v7
    v_max3_u32 v6, v6, v8, v9
    s_nop 0
    v_mov_b32_dpp v7, v5 quad_perm:[2,3,0,1] row_mask:0xf bank_mask:0xf
    v_mov_b32_dpp v8, v6 quad_perm:[2,3,0,1] row_mask:0xf bank_mask:0xf
    v_min_u32 v9, v5, v7
    v_max_u32 v5, v5, v7
    v_max3_u32 v6, v6, v8, v9
    s_nop 0
    v_mov_b32_dpp v7, v5 row_half_mirror row_mask:0xf bank_mask:0xf
    v_mov_b32_dpp v8, v6 row_half_mirror row_mask:0xf bank_mask:0xf
    v_min_u32 v9, v5, v7
    v_max_u32 v5, v5, v7
    v_max3_u32 v6, v6, v8, v9
    s_nop 0
    v_mov_b32_dpp v7, v5 row_mirror row_mask:0xf bank_mask:0xf
    v_mov_b32_dpp v8, v6 row_mirror row_mask:0xf bank_mask:0xf
    v_min_u32 v9, v5, v7
    v_max_u32 v5, v5, v7
    v_max3_u32 v6, v6, v8, v9
    v_lshrrev_b32 v9, 4, v0
    v_lshlrev_b32 v9, 3, v9
    s_barrier
    ds_write2_b32 v9, v5, v6 offset0:0 offset1:1
    v_and_b32 v9, 15, v0
    v_lshlrev_b32 v9, 3, v9
    s_waitcnt lgkmcnt(0)
    s_barrier
    ds_read2_b32 v[10:11], v9 offset0:0 offset1:1
    s_waitcnt lgkmcnt(0)
    v_mov_b32 v5, v10
    v_mov_b32 v6, v11
    s_nop 0
    v_mov_b32_dpp v7, v5 quad_perm:[1,0,3,2] row_mask:0xf bank_mask:0xf
    v_mov_b32_dpp v8, v6 quad_perm:[1,0,3,2] row_mask:0xf bank_mask:0xf
    v_min_u32 v9, v5, v7
    v_max_u32 v5, v5, v7
    v_max3_u32 v6, v6, v8, v9
    s_nop 0
    v_mov_b32_dpp v7, v5 quad_perm:[2,3,0,1] row_mask:0xf bank_mask:0xf
    v_mov_b32_dpp v8, v6 quad_perm:[2,3,0,1] row_mask:0xf bank_mask:0xf
    v_min_u32 v9, v5, v7
    v_max_u32 v5, v5, v7
    v_max3_u32 v6, v6, v8, v9
    s_nop 0
    v_mov_b32_dpp v7, v5 row_half_mirror row_mask:0xf bank_mask:0xf
    v_mov_b32_dpp v8, v6 row_half_mirror row_mask:0xf bank_mask:0xf
    v_min_u32 v9, v5, v7
    v_max_u32 v5, v5, v7
    v_max3_u32 v6, v6, v8, v9
    s_nop 0
    v_mov_b32_dpp v7, v5 row_mirror row_mask:0xf bank_mask:0xf
    v_mov_b32_dpp v8, v6 row_mirror row_mask:0xf bank_mask:0xf
    v_min_u32 v9, v5, v7
    v_max_u32 v5, v5, v7
    v_max3_u32 v6, v6, v8, v9
    v_readfirstlane_b32 s26, v5
    v_readfirstlane_b32 s27, v6
    s_nop 3
    s_cmp_eq_u64 s[26:27], s[28:29]
    s_cbranch_scc1 L_M_next
    s_mov_b64 s[28:29], s[26:27]
    s_and_b32 s36, s26, 0x7ff
    s_sub_u32 s30, 2047, s36
    s_and_b32 s36, s26, 0xffff0000
    s_xor_b32 s37, s36, 0x80000000
    s_xor_b32 s40, s36, 0xffff0000
    s_bitcmp1_b32 s36, 31
    s_cselect_b32 s40, s37, s40
    s_and_b32 s36, s27, 0x7ff
    s_sub_u32 s31, 2047, s36
    s_and_b32 s36, s27, 0xffff0000
    s_xor_b32 s37, s36, 0x80000000
    s_xor_b32 s41, s36, 0xffff0000
    s_bitcmp1_b32 s36, 31
    s_cselect_b32 s41, s37, s41
    v_mov_b32 v8, 0
L_M_rows:
    s_lshl_b32 s36, s30, 4
    s_add_u32 s36, s36, 0x1b8000
    buffer_load_dwordx4 v[16:19], v8, s[8:11], s36 offen sc1
    s_lshl_b32 s36, s31, 4
    s_add_u32 s36, s36, 0x1b8000
    buffer_load_dwordx4 v[20:23], v8, s[8:11], s36 offen sc1
    s_add_u32 s32, s32, 1
    s_cmp_gt_u32 s32, 200000
    s_waitcnt vmcnt(0)
    v_or3_b32 v5, v16, v17, v18
    v_or3_b32 v5, v5, v19, v20
    v_or3_b32 v5, v5, v21, v22
    v_or_b32 v5, v5, v23
    s_cbranch_scc1 L_M_rows_ok
    v_cmp_ne_u32 vcc, 0, v5
    s_cbranch_vccnz L_M_rows
L_M_rows_ok:
    v_bfe_u32 v9, v0, 6, 1
    v_cmp_ne_u32 vcc, 0, v9
    v_mov_b32 v5, s30
    v_mov_b32 v6, s31
    v_cndmask_b32 v7, v5, v6, vcc
    v_lshlrev_b32 v7, 10, v7
    v_and_b32 v8, 63, v0
    v_lshl_add_u32 v7, v8, 4, v7
    s_mov_b32 s37, 0x600000
    buffer_load_dwordx4 v[16:19], v7, s[8:11], s37 offen sc1
    v_bfe_u32 v9, v0, 3, 1
    v_cmp_ne_u32 vcc, 0, v9
    s_nop 1
    v_cndmask_b32 v12, v5, v6, vcc
    v_mov_b32 v5, s40
    v_mov_b32 v6, s41
    v_cndmask_b32 v11, v5, v6, vcc
    v_lshlrev_b32 v12, 10, v12
    v_and_b32 v3, 7, v0
    v_lshl_add_u32 v12, v3, 2, v12
    s_lshl_b32 s36, s20, 5
    v_add_u32 v12, s36, v12
    v_mov_b32 v7, 0x40000000
    v_cmp_lt_u32 vcc, 15, v0
    s_nop 1
    v_cndmask_b32 v12, v12, v7, vcc
    s_mov_b32 s36, 0x400000
    buffer_load_dword v14, v12, s[8:11], s36 offen sc1
    buffer_load_dword v15, v12, s[8:11], s37 offen sc1
    v_and_b32 v8, 127, v0
    v_lshlrev_b32 v8, 4, v8
    s_waitcnt vmcnt(2)
    ds_write_b128 v8, v[16:19] offset:4096
    s_waitcnt lgkmcnt(0)
    s_barrier
    v_mov_b64 v[48:49], 0
    v_mov_b64 v[50:51], 0
    v_mov_b64 v[52:53], 0
    v_mov_b64 v[54:55], 0
    v_lshlrev_b32 v8, 7, v1
    ds_read_b128 v[16:19], v8 offset:4096
    ds_read_b128 v[20:23], v8 offset:4112
    ds_read_b128 v[24:27], v8 offset:4128
    ds_read_b128 v[28:31], v8 offset:4144
    ds_read_b128 v[32:35], v8 offset:5120
    ds_read_b128 v[36:39], v8 offset:5136
    ds_read_b128 v[40:43], v8 offset:5152
    ds_read_b128 v[44:47], v8 offset:5168
    s_waitcnt lgkmcnt(0)
    v_dot2_f32_bf16 v48, v16, v128, v48
    v_dot2_f32_bf16 v49, v16, v160, v49
    v_dot2_f32_bf16 v50, v32, v128, v50
    v_dot2_f32_bf16 v51, v32, v160, v51
    v_dot2_f32_bf16 v52, v16, v192, v52
    v_dot2_f32_bf16 v53, v16, v224, v53
    v_dot2_f32_bf16 v54, v32, v192, v54
    v_dot2_f32_bf16 v55, v32, v224, v55
    v_dot2_f32_bf16 v48, v17, v129, v48
    v_dot2_f32_bf16 v49, v17, v161, v49
    v_dot2_f32_bf16 v50, v33, v129, v50
    v_dot2_f32_bf16 v51, v33, v161, v51
    v_dot2_f32_bf16 v52, v17, v193, v52
    v_dot2_f32_bf16 v53, v17, v225, v53
    v_dot2_f32_bf16 v54, v33, v193, v54
    v_dot2_f32_bf16 v55, v33, v225, v55
    v_dot2_f32_bf16 v48, v18, v130, v48
    v_dot2_f32_bf16 v49, v18, v162, v49
    v_dot2_f32_bf16 v50, v34, v130, v50
    v_dot2_f32_bf16 v51, v34, v162, v51
    v_dot2_f32_bf16 v52, v18, v194, v52
    v_dot2_f32_bf16 v53, v18, v226, v53
    v_dot2_f32_bf16 v54, v34, v194, v54
    v_dot2_f32_bf16 v55, v34, v226, v55
    v_dot2_f32_bf16 v48, v19, v131, v48
    v_dot2_f32_bf16 v49, v19, v163, v49
    v_dot2_f32_bf16 v50, v35, v131, v50
    v_dot2_f32_bf16 v51, v35, v163, v51
    v_dot2_f32_bf16 v52, v19, v195, v52
    v_dot2_f32_bf16 v53, v19, v227, v53
    v_dot2_f32_bf16 v54, v35, v195, v54
    v_dot2_f32_bf16 v55, v35, v227, v55
    v_dot2_f32_bf16 v48, v20, v132, v48
    v_dot2_f32_bf16 v49, v20, v164, v49
    v_dot2_f32_bf16 v50, v36, v132, v50
    v_dot2_f32_bf16 v51, v36, v164, v51
    v_dot2_f32_bf16 v52, v20, v196, v52
    v_dot2_f32_bf16 v53, v20, v228, v53
    v_dot2_f32_bf16 v54, v36, v196, v54
    v_dot2_f32_bf16 v55, v36, v228, v55
    v_dot2_f32_bf16 v48, v21, v133, v48
    v_dot2_f32_bf16 v49, v21, v165, v49
    v_dot2_f32_bf16 v50, v37, v133, v50
    v_dot2_f32_bf16 v51, v37, v165, v51
    v_dot2_f32_bf16 v52, v21, v197, v52
    v_dot2_f32_bf16 v53, v21, v229, v53
    v_dot2_f32_bf16 v54, v37, v197, v54
    v_dot2_f32_bf16 v55, v37, v229, v55
    v_dot2_f32_bf16 v48, v22, v134, v48
    v_dot2_f32_bf16 v49, v22, v166, v49
    v_dot2_f32_bf16 v50, v38, v134, v50
    v_dot2_f32_bf16 v51, v38, v166, v51
    v_dot2_f32_bf16 v52, v22, v198, v52
    v_dot2_f32_bf16 v53, v22, v230, v53
    v_dot2_f32_bf16 v54, v38, v198, v54
    v_dot2_f32_bf16 v55, v38, v230, v55
    v_dot2_f32_bf16 v48, v23, v135, v48
    v_dot2_f32_bf16 v49, v23, v167, v49
    v_dot2_f32_bf16 v50, v39, v135, v50
    v_dot2_f32_bf16 v51, v39, v167, v51
    v_dot2_f32_bf16 v52, v23, v199, v52
    v_dot2_f32_bf16 v53, v23, v231, v53
    v_dot2_f32_bf16 v54, v39, v199, v54
    v_dot2_f32_bf16 v55, v39, v231, v55
    v_dot2_f32_bf16 v48, v24, v136, v48
    v_dot2_f32_bf16 v49, v24, v168, v49
    v_dot2_f32_bf16 v50, v40, v136, v50
    v_dot2_f32_bf16 v51, v40, v168, v51
    v_dot2_f32_bf16 v52, v24, v200, v52
    v_dot2_f32_bf16 v53, v24, v232, v53
    v_dot2_f32_bf16 v54, v40, v200, v54
    v_dot2_f32_bf16 v55, v40, v232, v55
    v_dot2_f32_bf16 v48, v25, v137, v48
    v_dot2_f32_bf16 v49, v25, v169, v49
    v_dot2_f32_bf16 v50, v41, v137, v50
    v_dot2_f32_bf16 v51, v41, v169, v51
    v_dot2_f32_bf16 v52, v25, v201, v52
    v_dot2_f32_bf16 v53, v25, v233, v53
    v_dot2_f32_bf16 v54, v41, v201, v54
    v_dot2_f32_bf16 v55, v41, v233, v55
    v_dot2_f32_bf16 v48, v26, v138, v48
    v_dot2_f32_bf16 v49, v26, v170, v49
    v_dot2_f32_bf16 v50, v42, v138, v50
    v_dot2_f32_bf16 v51, v42, v170, v51
    v_dot2_f32_bf16 v52, v26, v202, v52
    v_dot2_f32_bf16 v53, v26, v234, v53
    v_dot2_f32_bf16 v54, v42, v202, v54
    v_dot2_f32_bf16 v55, v42, v234, v55
    v_dot2_f32_bf16 v48, v27, v139, v48
    v_dot2_f32_bf16 v49, v27, v171, v49
    v_dot2_f32_bf16 v50, v43, v139, v50
    v_dot2_f32_bf16 v51, v43, v171, v51
    v_dot2_f32_bf16 v52, v27, v203, v52
    v_dot2_f32_bf16 v53, v27, v235, v53
    v_dot2_f32_bf16 v54, v43, v203, v54
    v_dot2_f32_bf16 v55, v43, v235, v55
    v_dot2_f32_bf16 v48, v28, v140, v48
    v_dot2_f32_bf16 v49, v28, v172, v49
    v_dot2_f32_bf16 v50, v44, v140, v50
    v_dot2_f32_bf16 v51, v44, v172, v51
    v_dot2_f32_bf16 v52, v28, v204, v52
    v_dot2_f32_bf16 v53, v28, v236, v53
    v_dot2_f32_bf16 v54, v44, v204, v54
    v_dot2_f32_bf16 v55, v44, v236, v55
    v_dot2_f32_bf16 v48, v29, v141, v48
    v_dot2_f32_bf16 v49, v29, v173, v49
    v_dot2_f32_bf16 v50, v45, v141, v50
    v_dot2_f32_bf16 v51, v45, v173, v51
    v_dot2_f32_bf16 v52, v29, v205, v52
    v_dot2_f32_bf16 v53, v29, v237, v53
    v_dot2_f32_bf16 v54, v45, v205, v54
    v_dot2_f32_bf16 v55, v45, v237, v55
    v_dot2_f32_bf16 v48, v30, v142, v48
    v_dot2_f32_bf16 v49, v30, v174, v49
    v_dot2_f32_bf16 v50, v46, v142, v50
    v_dot2_f32_bf16 v51, v46, v174, v51
    v_dot2_f32_bf16 v52, v30, v206, v52
    v_dot2_f32_bf16 v53, v30, v238, v53
    v_dot2_f32_bf16 v54, v46, v206, v54
    v_dot2_f32_bf16 v55, v46, v238, v55
    v_dot2_f32_bf16 v48, v31, v143, v48
    v_dot2_f32_bf16 v49, v31, v175, v49
    v_dot2_f32_bf16 v50, v47, v143, v50
    v_dot2_f32_bf16 v51, v47, v175, v51
    v_dot2_f32_bf16 v52, v31, v207, v52
    v_dot2_f32_bf16 v53, v31, v239, v53
    v_dot2_f32_bf16 v54, v47, v207, v54
    v_dot2_f32_bf16 v55, v47, v239, v55
    ds_read_b128 v[16:19], v8 offset:4160
    ds_read_b128 v[20:23], v8 offset:4176
    ds_read_b128 v[24:27], v8 offset:4192
    ds_read_b128 v[28:31], v8 offset:4208
    ds_read_b128 v[32:35], v8 offset:5184
    ds_read_b128 v[36:39], v8 offset:5200
    ds_read_b128 v[40:43], v8 offset:5216
    ds_read_b128 v[44:47], v8 offset:5232
    s_waitcnt lgkmcnt(0)
    v_dot2_f32_bf16 v48, v16, v144, v48
    v_dot2_f32_bf16 v49, v16, v176, v49
    v_dot2_f32_bf16 v50, v32, v144, v50
    v_dot2_f32_bf16 v51, v32, v176, v51
    v_dot2_f32_bf16 v52, v16, v208, v52
    v_dot2_f32_bf16 v53, v16, v240, v53
    v_dot2_f32_bf16 v54, v32, v208, v54
    v_dot2_f32_bf16 v55, v32, v240, v55
    v_dot2_f32_bf16 v48, v17, v145, v48
    v_dot2_f32_bf16 v49, v17, v177, v49
    v_dot2_f32_bf16 v50, v33, v145, v50
    v_dot2_f32_bf16 v51, v33, v177, v51
    v_dot2_f32_bf16 v52, v17, v209, v52
    v_dot2_f32_bf16 v53, v17, v241, v53
    v_dot2_f32_bf16 v54, v33, v209, v54
    v_dot2_f32_bf16 v55, v33, v241, v55
    v_dot2_f32_bf16 v48, v18, v146, v48
    v_dot2_f32_bf16 v49, v18, v178, v49
    v_dot2_f32_bf16 v50, v34, v146, v50
    v_dot2_f32_bf16 v51, v34, v178, v51
    v_dot2_f32_bf16 v52, v18, v210, v52
    v_dot2_f32_bf16 v53, v18, v242, v53
    v_dot2_f32_bf16 v54, v34, v210, v54
    v_dot2_f32_bf16 v55, v34, v242, v55
    v_dot2_f32_bf16 v48, v19, v147, v48
    v_dot2_f32_bf16 v49, v19, v179, v49
    v_dot2_f32_bf16 v50, v35, v147, v50
    v_dot2_f32_bf16 v51, v35, v179, v51
    v_dot2_f32_bf16 v52, v19, v211, v52
    v_dot2_f32_bf16 v53, v19, v243, v53
    v_dot2_f32_bf16 v54, v35, v211, v54
    v_dot2_f32_bf16 v55, v35, v243, v55
    v_dot2_f32_bf16 v48, v20, v148, v48
    v_dot2_f32_bf16 v49, v20, v180, v49
    v_dot2_f32_bf16 v50, v36, v148, v50
    v_dot2_f32_bf16 v51, v36, v180, v51
    v_dot2_f32_bf16 v52, v20, v212, v52
    v_dot2_f32_bf16 v53, v20, v244, v53
    v_dot2_f32_bf16 v54, v36, v212, v54
    v_dot2_f32_bf16 v55, v36, v244, v55
    v_dot2_f32_bf16 v48, v21, v149, v48
    v_dot2_f32_bf16 v49, v21, v181, v49
    v_dot2_f32_bf16 v50, v37, v149, v50
    v_dot2_f32_bf16 v51, v37, v181, v51
    v_dot2_f32_bf16 v52, v21, v213, v52
    v_dot2_f32_bf16 v53, v21, v245, v53
    v_dot2_f32_bf16 v54, v37, v213, v54
    v_dot2_f32_bf16 v55, v37, v245, v55
    v_dot2_f32_bf16 v48, v22, v150, v48
    v_dot2_f32_bf16 v49, v22, v182, v49
    v_dot2_f32_bf16 v50, v38, v150, v50
    v_dot2_f32_bf16 v51, v38, v182, v51
    v_dot2_f32_bf16 v52, v22, v214, v52
    v_dot2_f32_bf16 v53, v22, v246, v53
    v_dot2_f32_bf16 v54, v38, v214, v54
    v_dot2_f32_bf16 v55, v38, v246, v55
    v_dot2_f32_bf16 v48, v23, v151, v48
    v_dot2_f32_bf16 v49, v23, v183, v49
    v_dot2_f32_bf16 v50, v39, v151, v50
    v_dot2_f32_bf16 v51, v39, v183, v51
    v_dot2_f32_bf16 v52, v23, v215, v52
    v_dot2_f32_bf16 v53, v23, v247, v53
    v_dot2_f32_bf16 v54, v39, v215, v54
    v_dot2_f32_bf16 v55, v39, v247, v55
    v_dot2_f32_bf16 v48, v24, v152, v48
    v_dot2_f32_bf16 v49, v24, v184, v49
    v_dot2_f32_bf16 v50, v40, v152, v50
    v_dot2_f32_bf16 v51, v40, v184, v51
    v_dot2_f32_bf16 v52, v24, v216, v52
    v_dot2_f32_bf16 v53, v24, v248, v53
    v_dot2_f32_bf16 v54, v40, v216, v54
    v_dot2_f32_bf16 v55, v40, v248, v55
    v_dot2_f32_bf16 v48, v25, v153, v48
    v_dot2_f32_bf16 v49, v25, v185, v49
    v_dot2_f32_bf16 v50, v41, v153, v50
    v_dot2_f32_bf16 v51, v41, v185, v51
    v_dot2_f32_bf16 v52, v25, v217, v52
    v_dot2_f32_bf16 v53, v25, v249, v53
    v_dot2_f32_bf16 v54, v41, v217, v54
    v_dot2_f32_bf16 v55, v41, v249, v55
    v_dot2_f32_bf16 v48, v26, v154, v48
    v_dot2_f32_bf16 v49, v26, v186, v49
    v_dot2_f32_bf16 v50, v42, v154, v50
    v_dot2_f32_bf16 v51, v42, v186, v51
    v_dot2_f32_bf16 v52, v26, v218, v52
    v_dot2_f32_bf16 v53, v26, v250, v53
    v_dot2_f32_bf16 v54, v42, v218, v54
    v_dot2_f32_bf16 v55, v42, v250, v55
    v_dot2_f32_bf16 v48, v27, v155, v48
    v_dot2_f32_bf16 v49, v27, v187, v49
    v_dot2_f32_bf16 v50, v43, v155, v50
    v_dot2_f32_bf16 v51, v43, v187, v51
    v_dot2_f32_bf16 v52, v27, v219, v52
    v_dot2_f32_bf16 v53, v27, v251, v53
    v_dot2_f32_bf16 v54, v43, v219, v54
    v_dot2_f32_bf16 v55, v43, v251, v55
    v_dot2_f32_bf16 v48, v28, v156, v48
    v_dot2_f32_bf16 v49, v28, v188, v49
    v_dot2_f32_bf16 v50, v44, v156, v50
    v_dot2_f32_bf16 v51, v44, v188, v51
    v_dot2_f32_bf16 v52, v28, v220, v52
    v_dot2_f32_bf16 v53, v28, v252, v53
    v_dot2_f32_bf16 v54, v44, v220, v54
    v_dot2_f32_bf16 v55, v44, v252, v55
    v_dot2_f32_bf16 v48, v29, v157, v48
    v_dot2_f32_bf16 v49, v29, v189, v49
    v_dot2_f32_bf16 v50, v45, v157, v50
    v_dot2_f32_bf16 v51, v45, v189, v51
    v_dot2_f32_bf16 v52, v29, v221, v52
    v_dot2_f32_bf16 v53, v29, v253, v53
    v_dot2_f32_bf16 v54, v45, v221, v54
    v_dot2_f32_bf16 v55, v45, v253, v55
    v_dot2_f32_bf16 v48, v30, v158, v48
    v_dot2_f32_bf16 v49, v30, v190, v49
    v_dot2_f32_bf16 v50, v46, v158, v50
    v_dot2_f32_bf16 v51, v46, v190, v51
    v_dot2_f32_bf16 v52, v30, v222, v52
    v_dot2_f32_bf16 v53, v30, v254, v53
    v_dot2_f32_bf16 v54, v46, v222, v54
    v_dot2_f32_bf16 v55, v46, v254, v55
    v_dot2_f32_bf16 v48, v31, v159, v48
    v_dot2_f32_bf16 v49, v31, v191, v49
    v_dot2_f32_bf16 v50, v47, v159, v50
    v_dot2_f32_bf16 v51, v47, v191, v51
    v_dot2_f32_bf16 v52, v31, v223, v52
    v_dot2_f32_bf16 v53, v31, v255, v53
    v_dot2_f32_bf16 v54, v47, v223, v54
    v_dot2_f32_bf16 v55, v47, v255, v55
    s_nop 3
    v_lshlrev_b32 v7, 5, v0
    ds_write_b128 v7, v[48:51] offset:8192
    ds_write_b128 v7, v[52:55] offset:8208
    s_waitcnt lgkmcnt(0)
    s_barrier
    v_lshlrev_b32 v7, 5, v2
    v_bfe_u32 v8, v0, 5, 1
    v_lshl_add_u32 v7, v8, 3, v7
    ds_read_b64 v[16:17], v7 offset:8192
    ds_read_b64 v[18:19], v7 offset:8208
    ds_read_b64 v[20:21], v7 offset:9216
    ds_read_b64 v[22:23], v7 offset:9232
    ds_read_b64 v[24:25], v7 offset:10240
    ds_read_b64 v[26:27], v7 offset:10256
    ds_read_b64 v[28:29], v7 offset:11264
    ds_read_b64 v[30:31], v7 offset:11280
    s_waitcnt lgkmcnt(0)
    ds_read_b64 v[32:33], v7 offset:12288
    ds_read_b64 v[34:35], v7 offset:12304
    ds_read_b64 v[36:37], v7 offset:13312
    ds_read_b64 v[38:39], v7 offset:13328
    ds_read_b64 v[40:41], v7 offset:14336
    ds_read_b64 v[42:43], v7 offset:14352
    ds_read_b64 v[44:45], v7 offset:15360
    ds_read_b64 v[46:47], v7 offset:15376
    s_waitcnt lgkmcnt(0)
    v_add_f32 v16, v16, v20
    v_add_f32 v16, v16, v24
    v_add_f32 v16, v16, v28
    v_add_f32 v16, v16, v32
    v_add_f32 v16, v16, v36
    v_add_f32 v16, v16, v40
    v_add_f32 v16, v16, v44
    v_cvt_pk_bf16_f32 v5, v16, v16
    v_lshlrev_b32 v16, 16, v5
    v_add_f32 v17, v17, v21
    v_add_f32 v17, v17, v25
    v_add_f32 v17, v17, v29
    v_add_f32 v17, v17, v33
    v_add_f32 v17, v17, v37
    v_add_f32 v17, v17, v41
    v_add_f32 v17, v17, v45
    v_cvt_pk_bf16_f32 v5, v17, v17
    v_lshlrev_b32 v17, 16, v5
    v_add_f32 v18, v18, v22
    v_add_f32 v18, v18, v26
    v_add_f32 v18, v18, v30
    v_add_f32 v18, v18, v34
    v_add_f32 v18, v18, v38
    v_add_f32 v18, v18, v42
    v_add_f32 v18, v18, v46
    v_cvt_pk_bf16_f32 v5, v18, v18
    v_lshlrev_b32 v18, 16, v5
    v_add_f32 v19, v19, v23
    v_add_f32 v19, v19, v27
    v_add_f32 v19, v19, v31
    v_add_f32 v19, v19, v35
    v_add_f32 v19, v19, v39
    v_add_f32 v19, v19, v43
    v_add_f32 v19, v19, v47
    v_cvt_pk_bf16_f32 v5, v19, v19
    v_lshlrev_b32 v19, 16, v5
    v_mul_f32 v6, 0xbfb8aa3b, v16
    v_exp_f32 v6, v6
    s_nop 0
    v_add_f32 v6, 1.0, v6
    v_rcp_f32 v6, v6
    s_nop 0
    v_mul_f32 v16, v16, v6
    v_cvt_pk_bf16_f32 v5, v16, v16
    v_lshlrev_b32 v16, 16, v5
    v_mul_f32 v16, v16, v18
    v_mul_f32 v6, 0xbfb8aa3b, v17
    v_exp_f32 v6, v6
    s_nop 0
    v_add_f32 v6, 1.0, v6
    v_rcp_f32 v6, v6
    s_nop 0
    v_mul_f32 v17, v17, v6
    v_cvt_pk_bf16_f32 v5, v17, v17
    v_lshlrev_b32 v17, 16, v5
    v_mul_f32 v17, v17, v19
    v_cvt_pk_bf16_f32 v16, v16, v17
    v_mul_u32_u24 v8, 3584, v8
    v_lshl_add_u32 v7, v2, 2, v8
    v_mov_b32 v6, 0x40000000
    v_cmp_lt_u32 vcc, 27, v2
    s_nop 1
    v_cndmask_b32 v7, v7, v6, vcc
    v_cmp_lt_u32 vcc, 63, v0
    s_nop 1
    v_cndmask_b32 v7, v7, v6, vcc
    s_mul_i32 s37, s24, 8192
    s_add_u32 s37, s37, 0x1b0000
    s_add_u32 s36, s37, s23
    buffer_store_dword v16, v7, s[8:11], s36 offen sc1
    v_lshlrev_b32 v7, 4, v0
    v_add_u32 v8, 4096, v7
    v_cmp_lt_u32 vcc, 191, v0
    s_nop 1
    v_cndmask_b32 v8, v8, v6, vcc
L_M_act:
    buffer_load_dwordx4 v[20:23], v7, s[8:11], s37 offen sc1
    buffer_load_dwordx4 v[24:27], v8, s[8:11], s37 offen sc1
    s_add_u32 s32, s32, 1
    s_cmp_gt_u32 s32, 200000
    s_waitcnt vmcnt(0)
    v_max3_u32 v5, v20, v21, v22
    v_max3_u32 v5, v5, v23, v24
    v_max3_u32 v5, v5, v25, v26
    v_max_u32 v5, v5, v27
    s_cbranch_scc1 L_M_act_ok
    v_cmp_eq_u32 vcc, -1, v5
    s_cbranch_vccnz L_M_act
L_M_act_ok:
    ds_write_b128 v7, v[20:23] offset:16384
    ds_write_b128 v7, v[24:27] offset:20480
    s_waitcnt lgkmcnt(0)
    s_barrier
    v_lshrrev_b32 v7, 3, v0
    v_mul_u32_u24 v7, 112, v7
    v_mov_b64 v[48:49], 0
    v_mov_b64 v[50:51], 0
    ds_read_b128 v[16:19], v7 offset:16384
    ds_read_b128 v[20:23], v7 offset:16400
    ds_read_b128 v[24:27], v7 offset:16416
    ds_read_b128 v[28:31], v7 offset:16432
    ds_read_b128 v[32:35], v7 offset:16448
    ds_read_b128 v[36:39], v7 offset:16464
    ds_read_b128 v[40:43], v7 offset:16480
    s_waitcnt lgkmcnt(0)
    v_dot2_f32_bf16 v48, v16, v64, v48
    v_dot2_f32_bf16 v49, v16, v92, v49
    v_dot2_f32_bf16 v48, v17, v65, v48
    v_dot2_f32_bf16 v49, v17, v93, v49
    v_dot2_f32_bf16 v48, v18, v66, v48
    v_dot2_f32_bf16 v49, v18, v94, v49
    v_dot2_f32_bf16 v48, v19, v67, v48
    v_dot2_f32_bf16 v49, v19, v95, v49
    v_dot2_f32_bf16 v48, v20, v68, v48
    v_dot2_f32_bf16 v49, v20, v96, v49
    v_dot2_f32_bf16 v48, v21, v69, v48
    v_dot2_f32_bf16 v49, v21, v97, v49
    v_dot2_f32_bf16 v48, v22, v70, v48
    v_dot2_f32_bf16 v49, v22, v98, v49
    v_dot2_f32_bf16 v48, v23, v71, v48
    v_dot2_f32_bf16 v49, v23, v99, v49
    v_dot2_f32_bf16 v48, v24, v72, v48
    v_dot2_f32_bf16 v49, v24, v100, v49
    v_dot2_f32_bf16 v48, v25, v73, v48
    v_dot2_f32_bf16 v49, v25, v101, v49
    v_dot2_f32_bf16 v48, v26, v74, v48
    v_dot2_f32_bf16 v49, v26, v102, v49
    v_dot2_f32_bf16 v48, v27, v75, v48
    v_dot2_f32_bf16 v49, v27, v103, v49
    v_dot2_f32_bf16 v48, v28, v76, v48
    v_dot2_f32_bf16 v49, v28, v104, v49
    v_dot2_f32_bf16 v48, v29, v77, v48
    v_dot2_f32_bf16 v49, v29, v105, v49
    v_dot2_f32_bf16 v48, v30, v78, v48
    v_dot2_f32_bf16 v49, v30, v106, v49
    v_dot2_f32_bf16 v48, v31, v79, v48
    v_dot2_f32_bf16 v49, v31, v107, v49
    v_dot2_f32_bf16 v48, v32, v80, v48
    v_dot2_f32_bf16 v49, v32, v108, v49
    v_dot2_f32_bf16 v48, v33, v81, v48
    v_dot2_f32_bf16 v49, v33, v109, v49
    v_dot2_f32_bf16 v48, v34, v82, v48
    v_dot2_f32_bf16 v49, v34, v110, v49
    v_dot2_f32_bf16 v48, v35, v83, v48
    v_dot2_f32_bf16 v49, v35, v111, v49
    v_dot2_f32_bf16 v48, v36, v84, v48
    v_dot2_f32_bf16 v49, v36, v112, v49
    v_dot2_f32_bf16 v48, v37, v85, v48
    v_dot2_f32_bf16 v49, v37, v113, v49
    v_dot2_f32_bf16 v48, v38, v86, v48
    v_dot2_f32_bf16 v49, v38, v114, v49
    v_dot2_f32_bf16 v48, v39, v87, v48
    v_dot2_f32_bf16 v49, v39, v115, v49
    v_dot2_f32_bf16 v48, v40, v88, v48
    v_dot2_f32_bf16 v49, v40, v116, v49
    v_dot2_f32_bf16 v48, v41, v89, v48
    v_dot2_f32_bf16 v49, v41, v117, v49
    v_dot2_f32_bf16 v48, v42, v90, v48
    v_dot2_f32_bf16 v49, v42, v118, v49
    v_dot2_f32_bf16 v48, v43, v91, v48
    v_dot2_f32_bf16 v49, v43, v119, v49
    ds_read_b128 v[16:19], v7 offset:19968
    ds_read_b128 v[20:23], v7 offset:19984
    ds_read_b128 v[24:27], v7 offset:20000
    ds_read_b128 v[28:31], v7 offset:20016
    ds_read_b128 v[32:35], v7 offset:20032
    ds_read_b128 v[36:39], v7 offset:20048
    ds_read_b128 v[40:43], v7 offset:20064
    s_waitcnt lgkmcnt(0)
    v_dot2_f32_bf16 v50, v16, v64, v50
    v_dot2_f32_bf16 v51, v16, v92, v51
    v_dot2_f32_bf16 v50, v17, v65, v50
    v_dot2_f32_bf16 v51, v17, v93, v51
    v_dot2_f32_bf16 v50, v18, v66, v50
    v_dot2_f32_bf16 v51, v18, v94, v51
    v_dot2_f32_bf16 v50, v19, v67, v50
    v_dot2_f32_bf16 v51, v19, v95, v51
    v_dot2_f32_bf16 v50, v20, v68, v50
    v_dot2_f32_bf16 v51, v20, v96, v51
    v_dot2_f32_bf16 v50, v21, v69, v50
    v_dot2_f32_bf16 v51, v21, v97, v51
    v_dot2_f32_bf16 v50, v22, v70, v50
    v_dot2_f32_bf16 v51, v22, v98, v51
    v_dot2_f32_bf16 v50, v23, v71, v50
    v_dot2_f32_bf16 v51, v23, v99, v51
    v_dot2_f32_bf16 v50, v24, v72, v50
    v_dot2_f32_bf16 v51, v24, v100, v51
    v_dot2_f32_bf16 v50, v25, v73, v50
    v_dot2_f32_bf16 v51, v25, v101, v51
    v_dot2_f32_bf16 v50, v26, v74, v50
    v_dot2_f32_bf16 v51, v26, v102, v51
    v_dot2_f32_bf16 v50, v27, v75, v50
    v_dot2_f32_bf16 v51, v27, v103, v51
    v_dot2_f32_bf16 v50, v28, v76, v50
    v_dot2_f32_bf16 v51, v28, v104, v51
    v_dot2_f32_bf16 v50, v29, v77, v50
    v_dot2_f32_bf16 v51, v29, v105, v51
    v_dot2_f32_bf16 v50, v30, v78, v50
    v_dot2_f32_bf16 v51, v30, v106, v51
    v_dot2_f32_bf16 v50, v31, v79, v50
    v_dot2_f32_bf16 v51, v31, v107, v51
    v_dot2_f32_bf16 v50, v32, v80, v50
    v_dot2_f32_bf16 v51, v32, v108, v51
    v_dot2_f32_bf16 v50, v33, v81, v50
    v_dot2_f32_bf16 v51, v33, v109, v51
    v_dot2_f32_bf16 v50, v34, v82, v50
    v_dot2_f32_bf16 v51, v34, v110, v51
    v_dot2_f32_bf16 v50, v35, v83, v50
    v_dot2_f32_bf16 v51, v35, v111, v51
    v_dot2_f32_bf16 v50, v36, v84, v50
    v_dot2_f32_bf16 v51, v36, v112, v51
    v_dot2_f32_bf16 v50, v37, v85, v50
    v_dot2_f32_bf16 v51, v37, v113, v51
    v_dot2_f32_bf16 v50, v38, v86, v50
    v_dot2_f32_bf16 v51, v38, v114, v51
    v_dot2_f32_bf16 v50, v39, v87, v50
    v_dot2_f32_bf16 v51, v39, v115, v51
    v_dot2_f32_bf16 v50, v40, v88, v50
    v_dot2_f32_bf16 v51, v40, v116, v51
    v_dot2_f32_bf16 v50, v41, v89, v50
    v_dot2_f32_bf16 v51, v41, v117, v51
    v_dot2_f32_bf16 v50, v42, v90, v50
    v_dot2_f32_bf16 v51, v42, v118, v51
    v_dot2_f32_bf16 v50, v43, v91, v50
    v_dot2_f32_bf16 v51, v43, v119, v51
    s_nop 3
    v_add_f32_dpp v48, v48, v48 row_ror:8 row_mask:0xf bank_mask:0xf
    v_add_f32_dpp v49, v49, v49 row_ror:8 row_mask:0xf bank_mask:0xf
    v_add_f32_dpp v50, v50, v50 row_ror:8 row_mask:0xf bank_mask:0xf
    v_add_f32_dpp v51, v51, v51 row_ror:8 row_mask:0xf bank_mask:0xf
    v_mov_b32 v5, v48
    s_nop 1
    v_permlane16_swap_b32 v48, v5
    v_add_f32 v48, v48, v5
    v_mov_b32 v5, v49
    s_nop 1
    v_permlane16_swap_b32 v49, v5
    v_add_f32 v49, v49, v5
    v_mov_b32 v5, v50
    s_nop 1
    v_permlane16_swap_b32 v50, v5
    v_add_f32 v50, v50, v5
    v_mov_b32 v5, v51
    s_nop 1
    v_permlane16_swap_b32 v51, v5
    v_add_f32 v51, v51, v5
    v_mov_b32 v5, v48
    s_nop 1
    v_permlane32_swap_b32 v48, v5
    v_add_f32 v48, v48, v5
    v_mov_b32 v5, v49
    s_nop 1
    v_permlane32_swap_b32 v49, v5
    v_add_f32 v49, v49, v5
    v_mov_b32 v5, v50
    s_nop 1
    v_permlane32_swap_b32 v50, v5
    v_add_f32 v50, v50, v5
    v_mov_b32 v5, v51
    s_nop 1
    v_permlane32_swap_b32 v51, v5
    v_add_f32 v51, v51, v5
    v_lshrrev_b32 v7, 6, v0
    v_lshlrev_b32 v7, 7, v7
    v_lshl_add_u32 v7, v3, 4, v7
    ds_write_b128 v7, v[48:51] offset:1024
    s_waitcnt lgkmcnt(0)
    s_barrier
    v_lshlrev_b32 v7, 4, v3
    v_lshl_add_u32 v7, v9, 3, v7
    ds_read_b64 v[16:17], v7 offset:1024
    ds_read_b64 v[18:19], v7 offset:1152
    ds_read_b64 v[20:21], v7 offset:1280
    ds_read_b64 v[22:23], v7 offset:1408
    v_mul_f32 v10, 0xbfb8aa3b, v11
    v_exp_f32 v10, v10
    s_nop 0
    v_add_f32 v10, 1.0, v10
    v_rcp_f32 v10, v10
    s_nop 0
    v_cvt_pk_bf16_f32 v5, v10, v10
    v_lshlrev_b32 v10, 16, v5
    s_waitcnt lgkmcnt(0)
    v_lshlrev_b32 v24, 16, v15
    v_and_b32 v25, 0xffff0000, v15
    v_lshlrev_b32 v26, 16, v14
    v_and_b32 v27, 0xffff0000, v14
    v_add_f32 v16, v16, v18
    v_add_f32 v20, v20, v22
    v_add_f32 v16, v16, v20
    v_cvt_pk_bf16_f32 v5, v16, v16
    v_lshlrev_b32 v16, 16, v5
    v_mul_f32 v16, v16, v10
    v_cvt_pk_bf16_f32 v5, v16, v16
    v_lshlrev_b32 v16, 16, v5
    v_add_f32 v16, v16, v24
    v_cvt_pk_bf16_f32 v5, v16, v16
    v_lshlrev_b32 v16, 16, v5
    v_add_f32 v16, v16, v26
    v_add_f32 v17, v17, v19
    v_add_f32 v21, v21, v23
    v_add_f32 v17, v17, v21
    v_cvt_pk_bf16_f32 v5, v17, v17
    v_lshlrev_b32 v17, 16, v5
    v_mul_f32 v17, v17, v10
    v_cvt_pk_bf16_f32 v5, v17, v17
    v_lshlrev_b32 v17, 16, v5
    v_add_f32 v17, v17, v25
    v_cvt_pk_bf16_f32 v5, v17, v17
    v_lshlrev_b32 v17, 16, v5
    v_add_f32 v17, v17, v27
    v_cvt_pk_bf16_f32 v13, v16, v17
L_M_next:
    s_add_u32 s24, s24, 1
    s_mov_b32 s25, 192
    s_cmp_eq_u32 s24, 1
    s_cbranch_scc1 L_M_round
    s_mov_b32 s25, 256
    s_cmp_eq_u32 s24, 2
    s_cbranch_scc1 L_M_round
    buffer_store_dword v13, v12, s[60:63], 0 offen sc1
L_end:
    s_endpgm
.section .rodata,"a"
.p2align 6
.amdhsa_kernel sequential_preLN__memory_aug_recurrent_mem_tr__moe_arch_mod__prompt_kernel
  .amdhsa_next_free_vgpr 512
  .amdhsa_next_free_sgpr 102
  .amdhsa_accum_offset 256
  .amdhsa_group_segment_fixed_size 0
  .amdhsa_kernarg_size 120
  .amdhsa_user_sgpr_count 2
  .amdhsa_user_sgpr_kernarg_segment_ptr 1
  .amdhsa_system_sgpr_workgroup_id_x 1
.end_amdhsa_kernel
```

```asm
; @launch grid=(256,1,1) block=(256,1,1) lds=163840
.amdgcn_target "amdgcn-amd-amdhsa--gfx950"
.text
.globl sequential_preLN__memory_aug_recurrent_mem_tr__moe_arch_mod__prompt_kernel
.p2align 8
.type sequential_preLN__memory_aug_recurrent_mem_tr__moe_arch_mod__prompt_kernel,@function
sequential_preLN__memory_aug_recurrent_mem_tr__moe_arch_mod__prompt_kernel:
    s_cmp_ge_u32 s2, 256
    s_cbranch_scc1 L_end
    s_load_dwordx8 s[44:51], s[0:1], 0
    s_load_dwordx4 s[52:55], s[0:1], 32
    s_load_dwordx4 s[56:59], s[0:1], 104
    s_load_dwordx2 s[80:81], s[0:1], 64
    s_load_dwordx2 s[82:83], s[0:1], 96
    s_load_dwordx4 s[84:87], s[0:1], 72
    s_load_dwordx2 s[88:89], s[0:1], 88
    v_lshrrev_b32 v1, 6, v0
    s_nop 0
    v_readfirstlane_b32 s21, v1
    s_waitcnt lgkmcnt(0)
    s_mov_b32 s8, s58
    s_and_b32 s9, s59, 0xffff
    s_mov_b32 s10, 0x10000000
    s_mov_b32 s11, 0x20000
    s_mov_b32 s16, s56
    s_and_b32 s17, s57, 0xffff
    s_mov_b32 s18, 0x100
    s_mov_b32 s19, 0x20000
    s_and_b32 s3, s2, 7
    s_cmp_lg_u32 s3, 0
    s_cbranch_scc1 L_worker
    s_lshr_b32 s20, s2, 3
    v_lshrrev_b32 v28, 6, v0
    v_bfe_u32 v29, v0, 4, 2
    v_lshl_add_u32 v28, v28, 5, v29
    v_and_b32 v16, 15, v0
    v_lshlrev_b32 v16, 4, v16
    v_lshl_add_u32 v16, v28, 13, v16
    v_bfe_u32 v29, v0, 4, 1
    v_lshlrev_b32 v29, 5, v29
    v_xor_b32 v16, v16, v29
    v_xor_b32 v17, 64, v16
    v_xor_b32 v18, 128, v16
    v_xor_b32 v19, 192, v16
    s_add_u32 s28, s21, 1
    s_lshl_b32 s28, s28, 15
    s_lshl_b32 s3, s20, 8
    s_mov_b32 s60, s52
    s_and_b32 s61, s53, 0xffff
    s_mov_b32 s62, 0x400000
    s_mov_b32 s63, 0x20000
    s_add_u32 m0, s28, 0
    s_add_u32 s37, s3, 0x0
    buffer_load_dwordx4 v16, s[60:63], s37 offen lds
    s_add_u32 m0, s28, 1024
    s_add_u32 s37, s3, 0x8000
    buffer_load_dwordx4 v17, s[60:63], s37 offen lds
    s_add_u32 m0, s28, 2048
    s_add_u32 s37, s3, 0x10000
    buffer_load_dwordx4 v18, s[60:63], s37 offen lds
    s_add_u32 m0, s28, 3072
    s_add_u32 s37, s3, 0x18000
    buffer_load_dwordx4 v19, s[60:63], s37 offen lds
    s_add_u32 m0, s28, 4096
    s_add_u32 s37, s3, 0x20000
    buffer_load_dwordx4 v16, s[60:63], s37 offen lds
    s_add_u32 m0, s28, 5120
    s_add_u32 s37, s3, 0x28000
    buffer_load_dwordx4 v17, s[60:63], s37 offen lds
    s_add_u32 m0, s28, 6144
    s_add_u32 s37, s3, 0x30000
    buffer_load_dwordx4 v18, s[60:63], s37 offen lds
    s_add_u32 m0, s28, 7168
    s_add_u32 s37, s3, 0x38000
    buffer_load_dwordx4 v19, s[60:63], s37 offen lds
    s_add_u32 m0, s28, 8192
    s_add_u32 s37, s3, 0x100000
    buffer_load_dwordx4 v16, s[60:63], s37 offen lds
    s_add_u32 m0, s28, 9216
    s_add_u32 s37, s3, 0x108000
    buffer_load_dwordx4 v17, s[60:63], s37 offen lds
    s_add_u32 m0, s28, 10240
    s_add_u32 s37, s3, 0x110000
    buffer_load_dwordx4 v18, s[60:63], s37 offen lds
    s_add_u32 m0, s28, 11264
    s_add_u32 s37, s3, 0x118000
    buffer_load_dwordx4 v19, s[60:63], s37 offen lds
    s_add_u32 m0, s28, 12288
    s_add_u32 s37, s3, 0x120000
    buffer_load_dwordx4 v16, s[60:63], s37 offen lds
    s_add_u32 m0, s28, 13312
    s_add_u32 s37, s3, 0x128000
    buffer_load_dwordx4 v17, s[60:63], s37 offen lds
    s_add_u32 m0, s28, 14336
    s_add_u32 s37, s3, 0x130000
    buffer_load_dwordx4 v18, s[60:63], s37 offen lds
    s_add_u32 m0, s28, 15360
    s_add_u32 s37, s3, 0x138000
    buffer_load_dwordx4 v19, s[60:63], s37 offen lds
    s_add_u32 m0, s28, 16384
    s_add_u32 s37, s3, 0x200000
    buffer_load_dwordx4 v16, s[60:63], s37 offen lds
    s_add_u32 m0, s28, 17408
    s_add_u32 s37, s3, 0x208000
    buffer_load_dwordx4 v17, s[60:63], s37 offen lds
    s_add_u32 m0, s28, 18432
    s_add_u32 s37, s3, 0x210000
    buffer_load_dwordx4 v18, s[60:63], s37 offen lds
    s_add_u32 m0, s28, 19456
    s_add_u32 s37, s3, 0x218000
    buffer_load_dwordx4 v19, s[60:63], s37 offen lds
    s_add_u32 m0, s28, 20480
    s_add_u32 s37, s3, 0x220000
    buffer_load_dwordx4 v16, s[60:63], s37 offen lds
    s_add_u32 m0, s28, 21504
    s_add_u32 s37, s3, 0x228000
    buffer_load_dwordx4 v17, s[60:63], s37 offen lds
    s_add_u32 m0, s28, 22528
    s_add_u32 s37, s3, 0x230000
    buffer_load_dwordx4 v18, s[60:63], s37 offen lds
    s_add_u32 m0, s28, 23552
    s_add_u32 s37, s3, 0x238000
    buffer_load_dwordx4 v19, s[60:63], s37 offen lds
    v_mov_b32 v20, 0x0
    v_bfe_u32 v14, v0, 0, 1
    s_mov_b32 s38, 0x8
    v_mad_u32_u24 v20, v14, s38, v20
    v_bfe_u32 v14, v0, 1, 1
    s_mov_b32 s38, 0x10
    v_mad_u32_u24 v20, v14, s38, v20
    v_bfe_u32 v14, v0, 2, 1
    s_mov_b32 s38, 0x100
    v_mad_u32_u24 v20, v14, s38, v20
    v_bfe_u32 v14, v0, 3, 1
    s_mov_b32 s38, 0x800
    v_mad_u32_u24 v20, v14, s38, v20
    v_bfe_u32 v14, v0, 4, 1
    s_mov_b32 s38, 0x400
    v_mad_u32_u24 v20, v14, s38, v20
    v_bfe_u32 v14, v0, 5, 1
    s_mov_b32 s38, 0x1000
    v_mad_u32_u24 v20, v14, s38, v20
    v_mov_b32 v28, 0x0
    v_bfe_u32 v14, v0, 2, 1
    s_mov_b32 s38, 0x20
    v_mad_u32_u24 v28, v14, s38, v28
    v_bfe_u32 v14, v0, 3, 1
    s_mov_b32 s38, 0x80
    v_mad_u32_u24 v28, v14, s38, v28
    v_bfe_u32 v14, v0, 4, 1
    s_mov_b32 s38, 0x40
    v_mad_u32_u24 v28, v14, s38, v28
    v_mov_b32 v29, 0x0
    v_bfe_u32 v14, v0, 6, 1
    s_mov_b32 s38, 0x40
    v_mad_u32_u24 v29, v14, s38, v29
    v_bfe_u32 v14, v0, 7, 1
    s_mov_b32 s38, 0x80
    v_mad_u32_u24 v29, v14, s38, v29
    v_xor_b32 v28, v28, v29
    v_add_u32 v28, v28, v20
    s_xor_b32 s36, s21, 0
    s_add_u32 s36, s36, 1
    s_lshl_b32 s36, s36, 15
    v_add_u32 v20, s36, v28
    v_xor_b32 v21, 32, v20
    s_xor_b32 s36, s21, 1
    s_add_u32 s36, s36, 1
    s_lshl_b32 s36, s36, 15
    v_add_u32 v22, s36, v28
    v_xor_b32 v23, 32, v22
    s_xor_b32 s36, s21, 2
    s_add_u32 s36, s36, 1
    s_lshl_b32 s36, s36, 15
    v_add_u32 v24, s36, v28
    v_xor_b32 v25, 32, v24
    s_xor_b32 s36, s21, 3
    s_add_u32 s36, s36, 1
    s_lshl_b32 s36, s36, 15
    v_add_u32 v26, s36, v28
    v_xor_b32 v27, 32, v26
    v_mov_b32 v11, 0x0
    v_bfe_u32 v14, v0, 0, 1
    s_mov_b32 s38, 0x4
    v_mad_u32_u24 v11, v14, s38, v11
    v_bfe_u32 v14, v0, 1, 1
    s_mov_b32 s38, 0x8
    v_mad_u32_u24 v11, v14, s38, v11
    v_bfe_u32 v14, v0, 2, 1
    s_mov_b32 s38, 0x10
    v_mad_u32_u24 v11, v14, s38, v11
    v_bfe_u32 v14, v0, 3, 1
    s_mov_b32 s38, 0x20
    v_mad_u32_u24 v11, v14, s38, v11
    v_bfe_u32 v14, v0, 4, 1
    s_mov_b32 s38, 0x800
    v_mad_u32_u24 v11, v14, s38, v11
    v_bfe_u32 v14, v0, 5, 1
    s_mov_b32 s38, 0x1000
    v_mad_u32_u24 v11, v14, s38, v11
    v_bfe_u32 v14, v0, 6, 1
    s_mov_b32 s38, 0x100
    v_mad_u32_u24 v11, v14, s38, v11
    v_bfe_u32 v14, v0, 7, 1
    s_mov_b32 s38, 0x200
    v_mad_u32_u24 v11, v14, s38, v11
    s_mov_b32 s92, s54
    s_and_b32 s93, s55, 0xffff
    s_mov_b32 s94, 0x400000
    s_mov_b32 s95, 0x20000
    s_lshl_b32 s29, s20, 17
    s_xor_b32 s36, s21, 3
    s_lshl_b32 s36, s36, 15
    s_add_u32 s36, s36, s29
    s_add_u32 s37, s36, 0x80
    buffer_load_dword v32, v11, s[92:95], s37 offen
    s_add_u32 s37, s36, 0x4080
    buffer_load_dword v33, v11, s[92:95], s37 offen
    s_add_u32 s37, s36, 0x480
    buffer_load_dword v34, v11, s[92:95], s37 offen
    s_add_u32 s37, s36, 0x4480
    buffer_load_dword v35, v11, s[92:95], s37 offen
    s_add_u32 s37, s36, 0x2080
    buffer_load_dword v36, v11, s[92:95], s37 offen
    s_add_u32 s37, s36, 0x6080
    buffer_load_dword v37, v11, s[92:95], s37 offen
    s_add_u32 s37, s36, 0x2480
    buffer_load_dword v38, v11, s[92:95], s37 offen
    s_add_u32 s37, s36, 0x6480
    buffer_load_dword v39, v11, s[92:95], s37 offen
    s_add_u32 s37, s36, 0xc0
    buffer_load_dword v40, v11, s[92:95], s37 offen
    s_add_u32 s37, s36, 0x40c0
    buffer_load_dword v41, v11, s[92:95], s37 offen
    s_add_u32 s37, s36, 0x4c0
    buffer_load_dword v42, v11, s[92:95], s37 offen
    s_add_u32 s37, s36, 0x44c0
    buffer_load_dword v43, v11, s[92:95], s37 offen
    s_add_u32 s37, s36, 0x20c0
    buffer_load_dword v44, v11, s[92:95], s37 offen
    s_add_u32 s37, s36, 0x60c0
    buffer_load_dword v45, v11, s[92:95], s37 offen
    s_add_u32 s37, s36, 0x24c0
    buffer_load_dword v46, v11, s[92:95], s37 offen
    s_add_u32 s37, s36, 0x64c0
    buffer_load_dword v47, v11, s[92:95], s37 offen
    s_getreg_b32 s36, hwreg(HW_REG_XCC_ID)
    s_and_b32 s36, s36, 15
    s_or_b32 s36, s36, 0x100
    v_mov_b32 v30, s36
    s_lshl_b32 s37, s20, 2
    v_lshlrev_b32 v31, 20, v0
    buffer_store_dword v30, v31, s[16:19], s37 offen offset:128 sc1
    s_mov_b32 s12, s46
    s_and_b32 s13, s47, 0xffff
    s_mov_b32 s14, 0x2000
    s_mov_b32 s15, 0x20000
    v_mov_b32 v104, 0x0
    v_bfe_u32 v14, v0, 0, 1
    s_mov_b32 s38, 0x8
    v_mad_u32_u24 v104, v14, s38, v104
    v_bfe_u32 v14, v0, 1, 1
    s_mov_b32 s38, 0x10
    v_mad_u32_u24 v104, v14, s38, v104
    v_bfe_u32 v14, v0, 2, 1
    s_mov_b32 s38, 0x10000
    v_mad_u32_u24 v104, v14, s38, v104
    v_bfe_u32 v14, v0, 3, 1
    s_mov_b32 s38, 0x10000
    v_mad_u32_u24 v104, v14, s38, v104
    v_bfe_u32 v14, v0, 4, 1
    s_mov_b32 s38, 0x400
    v_mad_u32_u24 v104, v14, s38, v104
    v_bfe_u32 v14, v0, 5, 1
    s_mov_b32 s38, 0x4
    v_mad_u32_u24 v104, v14, s38, v104
    v_bfe_u32 v14, v0, 6, 1
    s_mov_b32 s38, 0x40
    v_mad_u32_u24 v104, v14, s38, v104
    v_bfe_u32 v14, v0, 7, 1
    s_mov_b32 s38, 0x80
    v_mad_u32_u24 v104, v14, s38, v104
    v_mov_b32 v106, s20
    v_mov_b32 v105, 0x0
    v_bfe_u32 v14, v106, 0, 1
    s_mov_b32 s38, 0x20
    v_mad_u32_u24 v105, v14, s38, v105
    v_bfe_u32 v14, v106, 1, 1
    s_mov_b32 s38, 0x800
    v_mad_u32_u24 v105, v14, s38, v105
    v_bfe_u32 v14, v106, 2, 1
    s_mov_b32 s38, 0x1000
    v_mad_u32_u24 v105, v14, s38, v105
    v_bfe_u32 v14, v106, 3, 1
    s_mov_b32 s38, 0x100
    v_mad_u32_u24 v105, v14, s38, v105
    v_bfe_u32 v14, v106, 4, 1
    s_mov_b32 s38, 0x200
    v_mad_u32_u24 v105, v14, s38, v105
    v_add_u32 v104, v104, v105
    buffer_load_dword v12, v104, s[12:15], 0 offen
    v_mov_b32 v1, 0x4444
    v_bfe_u32 v14, v0, 1, 1
    s_mov_b32 s38, 0xaaaa
    v_mad_u32_u24 v1, v14, s38, v1
    v_mov_b32 v3, 0x0
    v_bfe_u32 v14, v0, 0, 1
    s_mov_b32 s38, 0x10
    v_mad_u32_u24 v3, v14, s38, v3
    v_bfe_u32 v14, v0, 1, 1
    s_mov_b32 s38, 0x20
    v_mad_u32_u24 v3, v14, s38, v3
    v_bfe_u32 v14, v0, 2, 1
    s_mov_b32 s38, 0x40
    v_mad_u32_u24 v3, v14, s38, v3
    v_bfe_u32 v14, v0, 3, 1
    s_mov_b32 s38, 0x80
    v_mad_u32_u24 v3, v14, s38, v3
    v_bfe_u32 v14, v0, 4, 1
    s_mov_b32 s38, 0x100
    v_mad_u32_u24 v3, v14, s38, v3
    v_bfe_u32 v14, v0, 5, 1
    s_mov_b32 s38, 0x200
    v_mad_u32_u24 v3, v14, s38, v3
    v_mov_b32 v2, 0x0
    v_bfe_u32 v14, v0, 0, 1
    s_mov_b32 s38, 0x10
    v_mad_u32_u24 v2, v14, s38, v2
    v_bfe_u32 v14, v0, 1, 1
    s_mov_b32 s38, 0x20
    v_mad_u32_u24 v2, v14, s38, v2
    v_bfe_u32 v14, v0, 2, 1
    s_mov_b32 s38, 0x40
    v_mad_u32_u24 v2, v14, s38, v2
    v_bfe_u32 v14, v0, 3, 1
    s_mov_b32 s38, 0x80
    v_mad_u32_u24 v2, v14, s38, v2
    v_bfe_u32 v14, v0, 4, 1
    s_mov_b32 s38, 0x100
    v_mad_u32_u24 v2, v14, s38, v2
    v_bfe_u32 v14, v0, 5, 1
    s_mov_b32 s38, 0x200
    v_mad_u32_u24 v2, v14, s38, v2
    v_bfe_u32 v14, v0, 6, 1
    s_mov_b32 s38, 0x800
    v_mad_u32_u24 v2, v14, s38, v2
    v_bfe_u32 v14, v0, 7, 1
    s_mov_b32 s38, 0x1000
    v_mad_u32_u24 v2, v14, s38, v2
    v_mov_b32 v4, 0x8000
    v_bfe_u32 v14, v0, 0, 1
    s_mov_b32 s38, 0x10
    v_mad_u32_u24 v4, v14, s38, v4
    v_bfe_u32 v14, v0, 1, 1
    s_mov_b32 s38, 0x20
    v_mad_u32_u24 v4, v14, s38, v4
    v_bfe_u32 v14, v0, 2, 1
    s_mov_b32 s38, 0x40
    v_mad_u32_u24 v4, v14, s38, v4
    v_bfe_u32 v14, v0, 3, 1
    s_mov_b32 s38, 0x80
    v_mad_u32_u24 v4, v14, s38, v4
    v_bfe_u32 v14, v0, 4, 1
    s_mov_b32 s38, 0x100
    v_mad_u32_u24 v4, v14, s38, v4
    v_bfe_u32 v14, v0, 5, 1
    s_mov_b32 s38, 0x200
    v_mad_u32_u24 v4, v14, s38, v4
    v_bfe_u32 v14, v0, 6, 1
    s_mov_b32 s38, 0x8000
    v_mad_u32_u24 v4, v14, s38, v4
    v_bfe_u32 v14, v0, 7, 1
    s_mov_b32 s38, 0x10000
    v_mad_u32_u24 v4, v14, s38, v4
    v_mov_b32 v5, 0x4000
    v_bfe_u32 v14, v0, 0, 1
    s_mov_b32 s38, 0x4
    v_mad_u32_u24 v5, v14, s38, v5
    v_bfe_u32 v14, v0, 1, 1
    s_mov_b32 s38, 0x8
    v_mad_u32_u24 v5, v14, s38, v5
    v_bfe_u32 v14, v0, 2, 1
    s_mov_b32 s38, 0x10
    v_mad_u32_u24 v5, v14, s38, v5
    v_bfe_u32 v14, v0, 3, 1
    s_mov_b32 s38, 0x20
    v_mad_u32_u24 v5, v14, s38, v5
    v_bfe_u32 v14, v0, 4, 1
    s_mov_b32 s38, 0x240
    v_mad_u32_u24 v5, v14, s38, v5
    v_bfe_u32 v14, v0, 5, 1
    s_mov_b32 s38, 0x480
    v_mad_u32_u24 v5, v14, s38, v5
    v_bfe_u32 v14, v0, 6, 1
    s_mov_b32 s38, 0x40
    v_mad_u32_u24 v5, v14, s38, v5
    v_bfe_u32 v14, v0, 7, 1
    s_mov_b32 s38, 0x80
    v_mad_u32_u24 v5, v14, s38, v5
    v_mov_b32 v6, 0x4000
    v_bfe_u32 v14, v0, 0, 1
    s_mov_b32 s38, 0x120
    v_mad_u32_u24 v6, v14, s38, v6
    v_bfe_u32 v14, v0, 2, 1
    s_mov_b32 s38, 0x240
    v_mad_u32_u24 v6, v14, s38, v6
    v_bfe_u32 v14, v0, 3, 1
    s_mov_b32 s38, 0x480
    v_mad_u32_u24 v6, v14, s38, v6
    v_bfe_u32 v14, v0, 4, 1
    s_mov_b32 s38, 0x10
    v_mad_u32_u24 v6, v14, s38, v6
    v_bfe_u32 v14, v0, 5, 1
    s_mov_b32 s38, 0x20
    v_mad_u32_u24 v6, v14, s38, v6
    v_add_u32 v7, 2304, v5
    v_xor_b32 v8, 0x1000, v2
    v_mov_b32 v104, 0x0
    v_bfe_u32 v14, v0, 3, 1
    s_mov_b32 s38, 0x1
    v_mad_u32_u24 v104, v14, s38, v104
    v_bfe_u32 v14, v0, 4, 1
    s_mov_b32 s38, 0x2
    v_mad_u32_u24 v104, v14, s38, v104
    v_bfe_u32 v14, v0, 5, 1
    s_mov_b32 s38, 0x4
    v_mad_u32_u24 v104, v14, s38, v104
    v_bfe_u32 v14, v0, 6, 1
    s_mov_b32 s38, 0x8
    v_mad_u32_u24 v104, v14, s38, v104
    v_bfe_u32 v14, v0, 7, 1
    s_mov_b32 s38, 0x10
    v_mad_u32_u24 v104, v14, s38, v104
    v_add_u32 v104, s20, v104
    v_and_b32 v104, 31, v104
    v_lshlrev_b32 v104, 6, v104
    v_mov_b32 v9, 0x0
    v_bfe_u32 v14, v0, 0, 1
    s_mov_b32 s38, 0x8
    v_mad_u32_u24 v9, v14, s38, v9
    v_bfe_u32 v14, v0, 1, 1
    s_mov_b32 s38, 0x10
    v_mad_u32_u24 v9, v14, s38, v9
    v_bfe_u32 v14, v0, 2, 1
    s_mov_b32 s38, 0x20
    v_mad_u32_u24 v9, v14, s38, v9
    v_bfe_u32 v14, v0, 3, 1
    s_mov_b32 s38, 0x2000
    v_mad_u32_u24 v9, v14, s38, v9
    v_bfe_u32 v14, v0, 4, 1
    s_mov_b32 s38, 0x4000
    v_mad_u32_u24 v9, v14, s38, v9
    v_bfe_u32 v14, v0, 5, 1
    s_mov_b32 s38, 0x8000
    v_mad_u32_u24 v9, v14, s38, v9
    v_bfe_u32 v14, v0, 6, 1
    s_mov_b32 s38, 0x10000
    v_mad_u32_u24 v9, v14, s38, v9
    v_bfe_u32 v14, v0, 7, 1
    s_mov_b32 s38, 0x20000
    v_mad_u32_u24 v9, v14, s38, v9
    v_add_u32 v9, v9, v104
    v_mov_b32 v10, 0x80000
    v_bfe_u32 v14, v0, 0, 1
    s_mov_b32 s38, 0x8
    v_mad_u32_u24 v10, v14, s38, v10
    v_bfe_u32 v14, v0, 1, 1
    s_mov_b32 s38, 0x20
    v_mad_u32_u24 v10, v14, s38, v10
    v_bfe_u32 v14, v0, 4, 1
    s_mov_b32 s38, 0x10
    v_mad_u32_u24 v10, v14, s38, v10
    v_bfe_u32 v14, v0, 5, 1
    s_mov_b32 s38, 0x4
    v_mad_u32_u24 v10, v14, s38, v10
    v_bfe_u32 v14, v0, 6, 1
    s_mov_b32 s38, 0x800
    v_mad_u32_u24 v10, v14, s38, v10
    v_bfe_u32 v14, v0, 7, 1
    s_mov_b32 s38, 0x1000
    v_mad_u32_u24 v10, v14, s38, v10
    v_mov_b32 v105, s20
    v_mov_b32 v104, 0x0
    v_bfe_u32 v14, v105, 0, 1
    s_mov_b32 s38, 0x100
    v_mad_u32_u24 v104, v14, s38, v104
    v_bfe_u32 v14, v105, 1, 1
    s_mov_b32 s38, 0x40
    v_mad_u32_u24 v104, v14, s38, v104
    v_bfe_u32 v14, v105, 2, 1
    s_mov_b32 s38, 0x80
    v_mad_u32_u24 v104, v14, s38, v104
    v_bfe_u32 v14, v105, 3, 1
    s_mov_b32 s38, 0x200
    v_mad_u32_u24 v104, v14, s38, v104
    v_bfe_u32 v14, v105, 4, 1
    s_mov_b32 s38, 0x400
    v_mad_u32_u24 v104, v14, s38, v104
    v_add_u32 v10, v104, v10
    v_and_b32 v104, 12, v0
    v_cmp_ne_u32 vcc, 0, v104
    v_mov_b32 v104, 0x40000000
    s_nop 0
    v_cndmask_b32 v10, v10, v104, vcc
    s_lshl_b32 s6, s20, 13
    s_add_u32 s6, s6, 0x0
    s_mov_b32 s26, 4096
    v_and_b32 v104, 15, v0
    v_mov_b32 v100, 0
    v_mov_b32 v105, 0x3f80
    v_cmp_eq_u32 vcc, 0, v104
    s_nop 1
    v_cndmask_b32 v100, v100, v105, vcc
    v_mov_b32 v105, 0x3f800000
    v_cmp_eq_u32 vcc, 1, v104
    s_nop 1
    v_cndmask_b32 v100, v100, v105, vcc
    v_mov_b32 v101, 0
    v_mov_b32 v105, 0x3f80
    v_cmp_eq_u32 vcc, 4, v104
    s_nop 1
    v_cndmask_b32 v101, v101, v105, vcc
    v_mov_b32 v105, 0x3f800000
    v_cmp_eq_u32 vcc, 5, v104
    s_nop 1
    v_cndmask_b32 v101, v101, v105, vcc
    v_mov_b32 v102, 0
    v_mov_b32 v105, 0x3f80
    v_cmp_eq_u32 vcc, 8, v104
    s_nop 1
    v_cndmask_b32 v102, v102, v105, vcc
    v_mov_b32 v105, 0x3f800000
    v_cmp_eq_u32 vcc, 9, v104
    s_nop 1
    v_cndmask_b32 v102, v102, v105, vcc
    v_mov_b32 v103, 0
    v_mov_b32 v105, 0x3f80
    v_cmp_eq_u32 vcc, 12, v104
    s_nop 1
    v_cndmask_b32 v103, v103, v105, vcc
    v_mov_b32 v105, 0x3f800000
    v_cmp_eq_u32 vcc, 13, v104
    s_nop 1
    v_cndmask_b32 v103, v103, v105, vcc
    ds_write_b128 v3, v[100:103] offset:23040
    s_mov_b32 s34, 0x05040100
    s_mov_b32 s35, 0x07060302
    s_mov_b32 s33, 0x3e0293ee
    s_mov_b32 s40, 0x4e800000
    s_mov_b32 s32, 0
    s_mov_b32 s4, 0x3f803f80
    s_mov_b32 s5, 0x3f803f80
    s_lshl_b32 s36, s20, 14
    s_lshr_b32 s37, s21, 1
    s_lshl_b32 s37, s37, 12
    s_add_u32 s25, s36, s37
    s_lshl_b32 s37, s21, 11
    s_add_u32 s39, s36, s37
    s_add_u32 s39, s39, 8192
    v_mov_b32 v104, 0x0
    v_bfe_u32 v14, v0, 0, 1
    s_mov_b32 s38, 0x80
    v_mad_u32_u24 v104, v14, s38, v104
    v_bfe_u32 v14, v0, 1, 1
    s_mov_b32 s38, 0x100
    v_mad_u32_u24 v104, v14, s38, v104
    v_bfe_u32 v14, v0, 2, 1
    s_mov_b32 s38, 0x200
    v_mad_u32_u24 v104, v14, s38, v104
    v_bfe_u32 v14, v0, 3, 1
    s_mov_b32 s38, 0x400
    v_mad_u32_u24 v104, v14, s38, v104
    v_bfe_u32 v14, v0, 4, 1
    s_mov_b32 s38, 0x800
    v_mad_u32_u24 v104, v14, s38, v104
    v_bfe_u32 v14, v0, 6, 1
    s_mov_b32 s38, 0x1000
    v_mad_u32_u24 v104, v14, s38, v104
    v_bfe_u32 v14, v0, 7, 1
    s_mov_b32 s38, 0x2000
    v_mad_u32_u24 v104, v14, s38, v104
    s_lshl_b32 s36, s20, 14
    v_add_u32 v104, s36, v104
    s_lshl_b32 s36, s20, 8
    s_lshr_b32 s37, s21, 1
    s_lshl_b32 s37, s37, 7
    s_add_u32 s36, s36, s37
    s_add_u32 s36, s36, 0x102100
    v_and_b32 v14, 63, v0
    v_mov_b32 v105, 0x40000000
    v_cmp_lt_u32 vcc, 32, v14
    s_nop 1
    v_cndmask_b32 v104, v104, v105, vcc
    v_mov_b32 v105, s36
    v_cmp_eq_u32 vcc, 32, v14
    s_nop 1
    v_cndmask_b32 v104, v104, v105, vcc
    s_lshl_b32 s36, s20, 2
    s_add_u32 s36, s36, 0x104100
    v_mov_b32 v105, s36
    v_cmp_eq_u32 vcc, 33, v14
    s_nop 1
    v_cndmask_b32 v0, v104, v105, vcc
    s_waitcnt vmcnt(34)
    s_barrier
    ds_read_b64_tr_b16 a[160:161], v20 offset:0
    ds_read_b64_tr_b16 a[162:163], v20 offset:512
    ds_read_b64_tr_b16 a[168:169], v21 offset:0
    ds_read_b64_tr_b16 a[170:171], v21 offset:512
    ds_read_b64_tr_b16 a[192:193], v22 offset:0
    ds_read_b64_tr_b16 a[194:195], v22 offset:512
    ds_read_b64_tr_b16 a[200:201], v23 offset:0
    ds_read_b64_tr_b16 a[202:203], v23 offset:512
    ds_read_b64_tr_b16 a[224:225], v24 offset:0
    ds_read_b64_tr_b16 a[226:227], v24 offset:512
    ds_read_b64_tr_b16 a[232:233], v25 offset:0
    ds_read_b64_tr_b16 a[234:235], v25 offset:512
    s_waitcnt lgkmcnt(4)
    ds_read_b64_tr_b16 v[128:129], v26 offset:0
    ds_read_b64_tr_b16 v[130:131], v26 offset:512
    ds_read_b64_tr_b16 v[136:137], v27 offset:0
    ds_read_b64_tr_b16 v[138:139], v27 offset:512
    s_waitcnt lgkmcnt(0)
    s_barrier
    s_add_u32 m0, s28, 0
    s_add_u32 s37, s3, 0x300000
    buffer_load_dwordx4 v16, s[60:63], s37 offen lds
    s_add_u32 m0, s28, 1024
    s_add_u32 s37, s3, 0x308000
    buffer_load_dwordx4 v17, s[60:63], s37 offen lds
    s_add_u32 m0, s28, 2048
    s_add_u32 s37, s3, 0x310000
    buffer_load_dwordx4 v18, s[60:63], s37 offen lds
    s_add_u32 m0, s28, 3072
    s_add_u32 s37, s3, 0x318000
    buffer_load_dwordx4 v19, s[60:63], s37 offen lds
    s_add_u32 m0, s28, 4096
    s_add_u32 s37, s3, 0x320000
    buffer_load_dwordx4 v16, s[60:63], s37 offen lds
    s_add_u32 m0, s28, 5120
    s_add_u32 s37, s3, 0x328000
    buffer_load_dwordx4 v17, s[60:63], s37 offen lds
    s_add_u32 m0, s28, 6144
    s_add_u32 s37, s3, 0x330000
    buffer_load_dwordx4 v18, s[60:63], s37 offen lds
    s_add_u32 m0, s28, 7168
    s_add_u32 s37, s3, 0x338000
    buffer_load_dwordx4 v19, s[60:63], s37 offen lds
    s_xor_b32 s36, s21, 2
    s_lshl_b32 s36, s36, 15
    s_add_u32 s36, s36, s29
    s_add_u32 s37, s36, 0x80
    buffer_load_dword v48, v11, s[92:95], s37 offen
    s_add_u32 s37, s36, 0x4080
    buffer_load_dword v49, v11, s[92:95], s37 offen
    s_add_u32 s37, s36, 0x480
    buffer_load_dword v50, v11, s[92:95], s37 offen
    s_add_u32 s37, s36, 0x4480
    buffer_load_dword v51, v11, s[92:95], s37 offen
    s_add_u32 s37, s36, 0x2080
    buffer_load_dword v52, v11, s[92:95], s37 offen
    s_add_u32 s37, s36, 0x6080
    buffer_load_dword v53, v11, s[92:95], s37 offen
    s_add_u32 s37, s36, 0x2480
    buffer_load_dword v54, v11, s[92:95], s37 offen
    s_add_u32 s37, s36, 0x6480
    buffer_load_dword v55, v11, s[92:95], s37 offen
    s_add_u32 s37, s36, 0xc0
    buffer_load_dword v56, v11, s[92:95], s37 offen
    s_add_u32 s37, s36, 0x40c0
    buffer_load_dword v57, v11, s[92:95], s37 offen
    s_add_u32 s37, s36, 0x4c0
    buffer_load_dword v58, v11, s[92:95], s37 offen
    s_add_u32 s37, s36, 0x44c0
    buffer_load_dword v59, v11, s[92:95], s37 offen
    s_add_u32 s37, s36, 0x20c0
    buffer_load_dword v60, v11, s[92:95], s37 offen
    s_add_u32 s37, s36, 0x60c0
    buffer_load_dword v61, v11, s[92:95], s37 offen
    s_add_u32 s37, s36, 0x24c0
    buffer_load_dword v62, v11, s[92:95], s37 offen
    s_add_u32 s37, s36, 0x64c0
    buffer_load_dword v63, v11, s[92:95], s37 offen
    s_waitcnt vmcnt(50)
    s_barrier
    ds_read_b64_tr_b16 a[164:165], v20 offset:8192
    ds_read_b64_tr_b16 a[166:167], v20 offset:8704
    ds_read_b64_tr_b16 a[172:173], v21 offset:8192
    ds_read_b64_tr_b16 a[174:175], v21 offset:8704
    ds_read_b64_tr_b16 a[196:197], v22 offset:8192
    ds_read_b64_tr_b16 a[198:199], v22 offset:8704
    ds_read_b64_tr_b16 a[204:205], v23 offset:8192
    ds_read_b64_tr_b16 a[206:207], v23 offset:8704
    ds_read_b64_tr_b16 a[228:229], v24 offset:8192
    ds_read_b64_tr_b16 a[230:231], v24 offset:8704
    ds_read_b64_tr_b16 a[236:237], v25 offset:8192
    ds_read_b64_tr_b16 a[238:239], v25 offset:8704
    s_waitcnt lgkmcnt(4)
    ds_read_b64_tr_b16 v[132:133], v26 offset:8192
    ds_read_b64_tr_b16 v[134:135], v26 offset:8704
    ds_read_b64_tr_b16 v[140:141], v27 offset:8192
    ds_read_b64_tr_b16 v[142:143], v27 offset:8704
    s_waitcnt lgkmcnt(0)
    s_barrier
    s_mov_b32 s88, s50
    s_and_b32 s89, s51, 0xffff
    s_mov_b32 s90, 0x400000
    s_mov_b32 s91, 0x20000
    s_add_u32 m0, s28, 8192
    s_add_u32 s37, s3, 0x0
    buffer_load_dwordx4 v16, s[88:91], s37 offen lds
    s_add_u32 m0, s28, 9216
    s_add_u32 s37, s3, 0x8000
    buffer_load_dwordx4 v17, s[88:91], s37 offen lds
    s_add_u32 m0, s28, 10240
    s_add_u32 s37, s3, 0x10000
    buffer_load_dwordx4 v18, s[88:91], s37 offen lds
    s_add_u32 m0, s28, 11264
    s_add_u32 s37, s3, 0x18000
    buffer_load_dwordx4 v19, s[88:91], s37 offen lds
    s_add_u32 m0, s28, 12288
    s_add_u32 s37, s3, 0x20000
    buffer_load_dwordx4 v16, s[88:91], s37 offen lds
    s_add_u32 m0, s28, 13312
    s_add_u32 s37, s3, 0x28000
    buffer_load_dwordx4 v17, s[88:91], s37 offen lds
    s_add_u32 m0, s28, 14336
    s_add_u32 s37, s3, 0x30000
    buffer_load_dwordx4 v18, s[88:91], s37 offen lds
    s_add_u32 m0, s28, 15360
    s_add_u32 s37, s3, 0x38000
    buffer_load_dwordx4 v19, s[88:91], s37 offen lds
    s_waitcnt vmcnt(34)
    v_perm_b32 v120, v33, v32, s34
    v_perm_b32 v121, v33, v32, s35
    v_perm_b32 v122, v35, v34, s34
    v_perm_b32 v123, v35, v34, s35
    v_perm_b32 v124, v37, v36, s34
    v_perm_b32 v125, v37, v36, s35
    v_perm_b32 v126, v39, v38, s34
    v_perm_b32 v127, v39, v38, s35
    ds_write_b128 v4, v[120:123] offset:24576
    ds_write_b128 v4, v[124:127] offset:25600
    s_waitcnt lgkmcnt(0)
    v_perm_b32 v120, v41, v40, s34
    v_perm_b32 v121, v41, v40, s35
    v_perm_b32 v122, v43, v42, s34
    v_perm_b32 v123, v43, v42, s35
    v_perm_b32 v124, v45, v44, s34
    v_perm_b32 v125, v45, v44, s35
    v_perm_b32 v126, v47, v46, s34
    v_perm_b32 v127, v47, v46, s35
    ds_write_b128 v4, v[120:123] offset:30720
    ds_write_b128 v4, v[124:127] offset:31744
    s_waitcnt lgkmcnt(0)
    s_xor_b32 s36, s21, 1
    s_lshl_b32 s36, s36, 15
    s_add_u32 s36, s36, s29
    s_add_u32 s37, s36, 0x80
    buffer_load_dword v80, v11, s[92:95], s37 offen
    s_add_u32 s37, s36, 0x4080
    buffer_load_dword v81, v11, s[92:95], s37 offen
    s_add_u32 s37, s36, 0x480
    buffer_load_dword v82, v11, s[92:95], s37 offen
    s_add_u32 s37, s36, 0x4480
    buffer_load_dword v83, v11, s[92:95], s37 offen
    s_add_u32 s37, s36, 0x2080
    buffer_load_dword v84, v11, s[92:95], s37 offen
    s_add_u32 s37, s36, 0x6080
    buffer_load_dword v85, v11, s[92:95], s37 offen
    s_add_u32 s37, s36, 0x2480
    buffer_load_dword v86, v11, s[92:95], s37 offen
    s_add_u32 s37, s36, 0x6480
    buffer_load_dword v87, v11, s[92:95], s37 offen
    s_add_u32 s37, s36, 0xc0
    buffer_load_dword v88, v11, s[92:95], s37 offen
    s_add_u32 s37, s36, 0x40c0
    buffer_load_dword v89, v11, s[92:95], s37 offen
    s_add_u32 s37, s36, 0x4c0
    buffer_load_dword v90, v11, s[92:95], s37 offen
    s_add_u32 s37, s36, 0x44c0
    buffer_load_dword v91, v11, s[92:95], s37 offen
    s_add_u32 s37, s36, 0x20c0
    buffer_load_dword v92, v11, s[92:95], s37 offen
    s_add_u32 s37, s36, 0x60c0
    buffer_load_dword v93, v11, s[92:95], s37 offen
    s_add_u32 s37, s36, 0x24c0
    buffer_load_dword v94, v11, s[92:95], s37 offen
    s_add_u32 s37, s36, 0x64c0
    buffer_load_dword v95, v11, s[92:95], s37 offen
    s_barrier
    ds_read_b64_tr_b16 a[176:177], v20 offset:16384
    ds_read_b64_tr_b16 a[178:179], v20 offset:16896
    ds_read_b64_tr_b16 a[184:185], v21 offset:16384
    ds_read_b64_tr_b16 a[186:187], v21 offset:16896
    ds_read_b64_tr_b16 a[208:209], v22 offset:16384
    ds_read_b64_tr_b16 a[210:211], v22 offset:16896
    ds_read_b64_tr_b16 a[216:217], v23 offset:16384
    ds_read_b64_tr_b16 a[218:219], v23 offset:16896
    ds_read_b64_tr_b16 a[240:241], v24 offset:16384
    ds_read_b64_tr_b16 a[242:243], v24 offset:16896
    ds_read_b64_tr_b16 a[248:249], v25 offset:16384
    ds_read_b64_tr_b16 a[250:251], v25 offset:16896
    s_waitcnt lgkmcnt(4)
    ds_read_b64_tr_b16 v[144:145], v26 offset:16384
    ds_read_b64_tr_b16 v[146:147], v26 offset:16896
    ds_read_b64_tr_b16 v[152:153], v27 offset:16384
    ds_read_b64_tr_b16 v[154:155], v27 offset:16896
    s_waitcnt lgkmcnt(0)
    s_barrier
    s_add_u32 m0, s28, 16384
    s_add_u32 s37, s3, 0x100000
    buffer_load_dwordx4 v16, s[88:91], s37 offen lds
    s_add_u32 m0, s28, 17408
    s_add_u32 s37, s3, 0x108000
    buffer_load_dwordx4 v17, s[88:91], s37 offen lds
    s_add_u32 m0, s28, 18432
    s_add_u32 s37, s3, 0x110000
    buffer_load_dwordx4 v18, s[88:91], s37 offen lds
    s_add_u32 m0, s28, 19456
    s_add_u32 s37, s3, 0x118000
    buffer_load_dwordx4 v19, s[88:91], s37 offen lds
    s_add_u32 m0, s28, 20480
    s_add_u32 s37, s3, 0x120000
    buffer_load_dwordx4 v16, s[88:91], s37 offen lds
    s_add_u32 m0, s28, 21504
    s_add_u32 s37, s3, 0x128000
    buffer_load_dwordx4 v17, s[88:91], s37 offen lds
    s_add_u32 m0, s28, 22528
    s_add_u32 s37, s3, 0x130000
    buffer_load_dwordx4 v18, s[88:91], s37 offen lds
    s_add_u32 m0, s28, 23552
    s_add_u32 s37, s3, 0x138000
    buffer_load_dwordx4 v19, s[88:91], s37 offen lds
    s_waitcnt vmcnt(32)
    v_perm_b32 v232, v49, v48, s34
    v_perm_b32 v233, v49, v48, s35
    v_perm_b32 v234, v51, v50, s34
    v_perm_b32 v235, v51, v50, s35
    v_perm_b32 v236, v53, v52, s34
    v_perm_b32 v237, v53, v52, s35
    v_perm_b32 v238, v55, v54, s34
    v_perm_b32 v239, v55, v54, s35
    v_perm_b32 v120, v57, v56, s34
    v_perm_b32 v121, v57, v56, s35
    v_perm_b32 v122, v59, v58, s34
    v_perm_b32 v123, v59, v58, s35
    v_perm_b32 v124, v61, v60, s34
    v_perm_b32 v125, v61, v60, s35
    v_perm_b32 v126, v63, v62, s34
    v_perm_b32 v127, v63, v62, s35
    ds_write_b128 v4, v[120:123] offset:28672
    ds_write_b128 v4, v[124:127] offset:29696
    s_waitcnt lgkmcnt(0)
    s_xor_b32 s36, s21, 3
    s_lshl_b32 s36, s36, 15
    s_add_u32 s36, s36, s29
    s_add_u32 s37, s36, 0x0
    buffer_load_dword v32, v11, s[92:95], s37 offen
    s_add_u32 s37, s36, 0x4000
    buffer_load_dword v33, v11, s[92:95], s37 offen
    s_add_u32 s37, s36, 0x400
    buffer_load_dword v34, v11, s[92:95], s37 offen
    s_add_u32 s37, s36, 0x4400
    buffer_load_dword v35, v11, s[92:95], s37 offen
    s_add_u32 s37, s36, 0x2000
    buffer_load_dword v36, v11, s[92:95], s37 offen
    s_add_u32 s37, s36, 0x6000
    buffer_load_dword v37, v11, s[92:95], s37 offen
    s_add_u32 s37, s36, 0x2400
    buffer_load_dword v38, v11, s[92:95], s37 offen
    s_add_u32 s37, s36, 0x6400
    buffer_load_dword v39, v11, s[92:95], s37 offen
    s_add_u32 s37, s36, 0x40
    buffer_load_dword v40, v11, s[92:95], s37 offen
    s_add_u32 s37, s36, 0x4040
    buffer_load_dword v41, v11, s[92:95], s37 offen
    s_add_u32 s37, s36, 0x440
    buffer_load_dword v42, v11, s[92:95], s37 offen
    s_add_u32 s37, s36, 0x4440
    buffer_load_dword v43, v11, s[92:95], s37 offen
    s_add_u32 s37, s36, 0x2040
    buffer_load_dword v44, v11, s[92:95], s37 offen
    s_add_u32 s37, s36, 0x6040
    buffer_load_dword v45, v11, s[92:95], s37 offen
    s_add_u32 s37, s36, 0x2440
    buffer_load_dword v46, v11, s[92:95], s37 offen
    s_add_u32 s37, s36, 0x6440
    buffer_load_dword v47, v11, s[92:95], s37 offen
    s_barrier
    ds_read_b64_tr_b16 a[180:181], v20 offset:0
    ds_read_b64_tr_b16 a[182:183], v20 offset:512
    ds_read_b64_tr_b16 a[188:189], v21 offset:0
    ds_read_b64_tr_b16 a[190:191], v21 offset:512
    ds_read_b64_tr_b16 a[212:213], v22 offset:0
    ds_read_b64_tr_b16 a[214:215], v22 offset:512
    ds_read_b64_tr_b16 a[220:221], v23 offset:0
    ds_read_b64_tr_b16 a[222:223], v23 offset:512
    ds_read_b64_tr_b16 a[244:245], v24 offset:0
    ds_read_b64_tr_b16 a[246:247], v24 offset:512
    ds_read_b64_tr_b16 a[252:253], v25 offset:0
    ds_read_b64_tr_b16 a[254:255], v25 offset:512
    s_waitcnt lgkmcnt(4)
    ds_read_b64_tr_b16 v[148:149], v26 offset:0
    ds_read_b64_tr_b16 v[150:151], v26 offset:512
    ds_read_b64_tr_b16 v[156:157], v27 offset:0
    ds_read_b64_tr_b16 v[158:159], v27 offset:512
    s_waitcnt lgkmcnt(0)
    s_barrier
    s_add_u32 m0, s28, 0
    s_add_u32 s37, s3, 0x200000
    buffer_load_dwordx4 v16, s[88:91], s37 offen lds
    s_add_u32 m0, s28, 1024
    s_add_u32 s37, s3, 0x208000
    buffer_load_dwordx4 v17, s[88:91], s37 offen lds
    s_add_u32 m0, s28, 2048
    s_add_u32 s37, s3, 0x210000
    buffer_load_dwordx4 v18, s[88:91], s37 offen lds
    s_add_u32 m0, s28, 3072
    s_add_u32 s37, s3, 0x218000
    buffer_load_dwordx4 v19, s[88:91], s37 offen lds
    s_add_u32 m0, s28, 4096
    s_add_u32 s37, s3, 0x220000
    buffer_load_dwordx4 v16, s[88:91], s37 offen lds
    s_add_u32 m0, s28, 5120
    s_add_u32 s37, s3, 0x228000
    buffer_load_dwordx4 v17, s[88:91], s37 offen lds
    s_add_u32 m0, s28, 6144
    s_add_u32 s37, s3, 0x230000
    buffer_load_dwordx4 v18, s[88:91], s37 offen lds
    s_add_u32 m0, s28, 7168
    s_add_u32 s37, s3, 0x238000
    buffer_load_dwordx4 v19, s[88:91], s37 offen lds
    s_waitcnt vmcnt(32)
    v_perm_b32 v208, v81, v80, s34
    v_perm_b32 v209, v81, v80, s35
    v_perm_b32 v210, v83, v82, s34
    v_perm_b32 v211, v83, v82, s35
    v_perm_b32 v212, v85, v84, s34
    v_perm_b32 v213, v85, v84, s35
    v_perm_b32 v214, v87, v86, s34
    v_perm_b32 v215, v87, v86, s35
    v_perm_b32 v120, v89, v88, s34
    v_perm_b32 v121, v89, v88, s35
    v_perm_b32 v122, v91, v90, s34
    v_perm_b32 v123, v91, v90, s35
    v_perm_b32 v124, v93, v92, s34
    v_perm_b32 v125, v93, v92, s35
    v_perm_b32 v126, v95, v94, s34
    v_perm_b32 v127, v95, v94, s35
    ds_write_b128 v4, v[120:123] offset:26624
    ds_write_b128 v4, v[124:127] offset:27648
    s_waitcnt lgkmcnt(0)
    s_xor_b32 s36, s21, 2
    s_lshl_b32 s36, s36, 15
    s_add_u32 s36, s36, s29
    s_add_u32 s37, s36, 0x0
    buffer_load_dword v48, v11, s[92:95], s37 offen
    s_add_u32 s37, s36, 0x4000
    buffer_load_dword v49, v11, s[92:95], s37 offen
    s_add_u32 s37, s36, 0x400
    buffer_load_dword v50, v11, s[92:95], s37 offen
    s_add_u32 s37, s36, 0x4400
    buffer_load_dword v51, v11, s[92:95], s37 offen
    s_add_u32 s37, s36, 0x2000
    buffer_load_dword v52, v11, s[92:95], s37 offen
    s_add_u32 s37, s36, 0x6000
    buffer_load_dword v53, v11, s[92:95], s37 offen
    s_add_u32 s37, s36, 0x2400
    buffer_load_dword v54, v11, s[92:95], s37 offen
    s_add_u32 s37, s36, 0x6400
    buffer_load_dword v55, v11, s[92:95], s37 offen
    s_add_u32 s37, s36, 0x40
    buffer_load_dword v56, v11, s[92:95], s37 offen
    s_add_u32 s37, s36, 0x4040
    buffer_load_dword v57, v11, s[92:95], s37 offen
    s_add_u32 s37, s36, 0x440
    buffer_load_dword v58, v11, s[92:95], s37 offen
    s_add_u32 s37, s36, 0x4440
    buffer_load_dword v59, v11, s[92:95], s37 offen
    s_add_u32 s37, s36, 0x2040
    buffer_load_dword v60, v11, s[92:95], s37 offen
    s_add_u32 s37, s36, 0x6040
    buffer_load_dword v61, v11, s[92:95], s37 offen
    s_add_u32 s37, s36, 0x2440
    buffer_load_dword v62, v11, s[92:95], s37 offen
    s_add_u32 s37, s36, 0x6440
    buffer_load_dword v63, v11, s[92:95], s37 offen
    s_barrier
    ds_read_b64_tr_b16 v[64:65], v20 offset:8192
    ds_read_b64_tr_b16 v[66:67], v20 offset:8704
    ds_read_b64_tr_b16 v[72:73], v21 offset:8192
    ds_read_b64_tr_b16 v[74:75], v21 offset:8704
    ds_read_b64_tr_b16 v[96:97], v22 offset:8192
    ds_read_b64_tr_b16 v[98:99], v22 offset:8704
    ds_read_b64_tr_b16 v[104:105], v23 offset:8192
    ds_read_b64_tr_b16 v[106:107], v23 offset:8704
    ds_read_b64_tr_b16 a[112:113], v24 offset:8192
    ds_read_b64_tr_b16 a[114:115], v24 offset:8704
    ds_read_b64_tr_b16 a[120:121], v25 offset:8192
    ds_read_b64_tr_b16 a[122:123], v25 offset:8704
    s_waitcnt lgkmcnt(4)
    ds_read_b64_tr_b16 a[144:145], v26 offset:8192
    ds_read_b64_tr_b16 a[146:147], v26 offset:8704
    ds_read_b64_tr_b16 a[152:153], v27 offset:8192
    ds_read_b64_tr_b16 a[154:155], v27 offset:8704
    s_waitcnt lgkmcnt(0)
    s_barrier
    s_add_u32 m0, s28, 8192
    s_add_u32 s37, s3, 0x300000
    buffer_load_dwordx4 v16, s[88:91], s37 offen lds
    s_add_u32 m0, s28, 9216
    s_add_u32 s37, s3, 0x308000
    buffer_load_dwordx4 v17, s[88:91], s37 offen lds
    s_add_u32 m0, s28, 10240
    s_add_u32 s37, s3, 0x310000
    buffer_load_dwordx4 v18, s[88:91], s37 offen lds
    s_add_u32 m0, s28, 11264
    s_add_u32 s37, s3, 0x318000
    buffer_load_dwordx4 v19, s[88:91], s37 offen lds
    s_add_u32 m0, s28, 12288
    s_add_u32 s37, s3, 0x320000
    buffer_load_dwordx4 v16, s[88:91], s37 offen lds
    s_add_u32 m0, s28, 13312
    s_add_u32 s37, s3, 0x328000
    buffer_load_dwordx4 v17, s[88:91], s37 offen lds
    s_add_u32 m0, s28, 14336
    s_add_u32 s37, s3, 0x330000
    buffer_load_dwordx4 v18, s[88:91], s37 offen lds
    s_add_u32 m0, s28, 15360
    s_add_u32 s37, s3, 0x338000
    buffer_load_dwordx4 v19, s[88:91], s37 offen lds
    s_waitcnt vmcnt(32)
    v_perm_b32 v240, v33, v32, s34
    v_perm_b32 v241, v33, v32, s35
    v_perm_b32 v242, v35, v34, s34
    v_perm_b32 v243, v35, v34, s35
    v_perm_b32 v244, v37, v36, s34
    v_perm_b32 v245, v37, v36, s35
    v_perm_b32 v246, v39, v38, s34
    v_perm_b32 v247, v39, v38, s35
    v_perm_b32 v248, v41, v40, s34
    v_perm_b32 v249, v41, v40, s35
    v_perm_b32 v250, v43, v42, s34
    v_perm_b32 v251, v43, v42, s35
    v_perm_b32 v252, v45, v44, s34
    v_perm_b32 v253, v45, v44, s35
    v_perm_b32 v254, v47, v46, s34
    v_perm_b32 v255, v47, v46, s35
    s_xor_b32 s36, s21, 1
    s_lshl_b32 s36, s36, 15
    s_add_u32 s36, s36, s29
    s_add_u32 s37, s36, 0x0
    buffer_load_dword v80, v11, s[92:95], s37 offen
    s_add_u32 s37, s36, 0x4000
    buffer_load_dword v81, v11, s[92:95], s37 offen
    s_add_u32 s37, s36, 0x400
    buffer_load_dword v82, v11, s[92:95], s37 offen
    s_add_u32 s37, s36, 0x4400
    buffer_load_dword v83, v11, s[92:95], s37 offen
    s_add_u32 s37, s36, 0x2000
    buffer_load_dword v84, v11, s[92:95], s37 offen
    s_add_u32 s37, s36, 0x6000
    buffer_load_dword v85, v11, s[92:95], s37 offen
    s_add_u32 s37, s36, 0x2400
    buffer_load_dword v86, v11, s[92:95], s37 offen
    s_add_u32 s37, s36, 0x6400
    buffer_load_dword v87, v11, s[92:95], s37 offen
    s_add_u32 s37, s36, 0x40
    buffer_load_dword v88, v11, s[92:95], s37 offen
    s_add_u32 s37, s36, 0x4040
    buffer_load_dword v89, v11, s[92:95], s37 offen
    s_add_u32 s37, s36, 0x440
    buffer_load_dword v90, v11, s[92:95], s37 offen
    s_add_u32 s37, s36, 0x4440
    buffer_load_dword v91, v11, s[92:95], s37 offen
    s_add_u32 s37, s36, 0x2040
    buffer_load_dword v92, v11, s[92:95], s37 offen
    s_add_u32 s37, s36, 0x6040
    buffer_load_dword v93, v11, s[92:95], s37 offen
    s_add_u32 s37, s36, 0x2440
    buffer_load_dword v94, v11, s[92:95], s37 offen
    s_add_u32 s37, s36, 0x6440
    buffer_load_dword v95, v11, s[92:95], s37 offen
    s_barrier
    ds_read_b64_tr_b16 v[68:69], v20 offset:16384
    ds_read_b64_tr_b16 v[70:71], v20 offset:16896
    ds_read_b64_tr_b16 v[76:77], v21 offset:16384
    ds_read_b64_tr_b16 v[78:79], v21 offset:16896
    ds_read_b64_tr_b16 v[100:101], v22 offset:16384
    ds_read_b64_tr_b16 v[102:103], v22 offset:16896
    ds_read_b64_tr_b16 v[108:109], v23 offset:16384
    ds_read_b64_tr_b16 v[110:111], v23 offset:16896
    ds_read_b64_tr_b16 a[116:117], v24 offset:16384
    ds_read_b64_tr_b16 a[118:119], v24 offset:16896
    ds_read_b64_tr_b16 a[124:125], v25 offset:16384
    ds_read_b64_tr_b16 a[126:127], v25 offset:16896
    s_waitcnt lgkmcnt(4)
    ds_read_b64_tr_b16 a[148:149], v26 offset:16384
    ds_read_b64_tr_b16 a[150:151], v26 offset:16896
    ds_read_b64_tr_b16 a[156:157], v27 offset:16384
    ds_read_b64_tr_b16 a[158:159], v27 offset:16896
    s_waitcnt lgkmcnt(0)
    s_barrier
    s_mov_b32 s96, s48
    s_and_b32 s97, s49, 0xffff
    s_mov_b32 s98, 0x400000
    s_mov_b32 s99, 0x20000
    s_add_u32 m0, s28, 16384
    s_add_u32 s37, s3, 0x0
    buffer_load_dwordx4 v16, s[96:99], s37 offen lds
    s_add_u32 m0, s28, 17408
    s_add_u32 s37, s3, 0x8000
    buffer_load_dwordx4 v17, s[96:99], s37 offen lds
    s_add_u32 m0, s28, 18432
    s_add_u32 s37, s3, 0x10000
    buffer_load_dwordx4 v18, s[96:99], s37 offen lds
    s_add_u32 m0, s28, 19456
    s_add_u32 s37, s3, 0x18000
    buffer_load_dwordx4 v19, s[96:99], s37 offen lds
    s_add_u32 m0, s28, 20480
    s_add_u32 s37, s3, 0x20000
    buffer_load_dwordx4 v16, s[96:99], s37 offen lds
    s_add_u32 m0, s28, 21504
    s_add_u32 s37, s3, 0x28000
    buffer_load_dwordx4 v17, s[96:99], s37 offen lds
    s_add_u32 m0, s28, 22528
    s_add_u32 s37, s3, 0x30000
    buffer_load_dwordx4 v18, s[96:99], s37 offen lds
    s_add_u32 m0, s28, 23552
    s_add_u32 s37, s3, 0x38000
    buffer_load_dwordx4 v19, s[96:99], s37 offen lds
    s_waitcnt vmcnt(32)
    v_perm_b32 v216, v49, v48, s34
    v_perm_b32 v217, v49, v48, s35
    v_perm_b32 v218, v51, v50, s34
    v_perm_b32 v219, v51, v50, s35
    v_perm_b32 v220, v53, v52, s34
    v_perm_b32 v221, v53, v52, s35
    v_perm_b32 v222, v55, v54, s34
    v_perm_b32 v223, v55, v54, s35
    v_perm_b32 v224, v57, v56, s34
    v_perm_b32 v225, v57, v56, s35
    v_perm_b32 v226, v59, v58, s34
    v_perm_b32 v227, v59, v58, s35
    v_perm_b32 v228, v61, v60, s34
    v_perm_b32 v229, v61, v60, s35
    v_perm_b32 v230, v63, v62, s34
    v_perm_b32 v231, v63, v62, s35
    s_xor_b32 s36, s21, 0
    s_lshl_b32 s36, s36, 15
    s_add_u32 s36, s36, s29
    s_add_u32 s37, s36, 0x80
    buffer_load_dword v32, v11, s[92:95], s37 offen
    s_add_u32 s37, s36, 0x4080
    buffer_load_dword v33, v11, s[92:95], s37 offen
    s_add_u32 s37, s36, 0x480
    buffer_load_dword v34, v11, s[92:95], s37 offen
    s_add_u32 s37, s36, 0x4480
    buffer_load_dword v35, v11, s[92:95], s37 offen
    s_add_u32 s37, s36, 0x2080
    buffer_load_dword v36, v11, s[92:95], s37 offen
    s_add_u32 s37, s36, 0x6080
    buffer_load_dword v37, v11, s[92:95], s37 offen
    s_add_u32 s37, s36, 0x2480
    buffer_load_dword v38, v11, s[92:95], s37 offen
    s_add_u32 s37, s36, 0x6480
    buffer_load_dword v39, v11, s[92:95], s37 offen
    s_add_u32 s37, s36, 0xc0
    buffer_load_dword v40, v11, s[92:95], s37 offen
    s_add_u32 s37, s36, 0x40c0
    buffer_load_dword v41, v11, s[92:95], s37 offen
    s_add_u32 s37, s36, 0x4c0
    buffer_load_dword v42, v11, s[92:95], s37 offen
    s_add_u32 s37, s36, 0x44c0
    buffer_load_dword v43, v11, s[92:95], s37 offen
    s_add_u32 s37, s36, 0x20c0
    buffer_load_dword v44, v11, s[92:95], s37 offen
    s_add_u32 s37, s36, 0x60c0
    buffer_load_dword v45, v11, s[92:95], s37 offen
    s_add_u32 s37, s36, 0x24c0
    buffer_load_dword v46, v11, s[92:95], s37 offen
    s_add_u32 s37, s36, 0x64c0
    buffer_load_dword v47, v11, s[92:95], s37 offen
    s_barrier
    ds_read_b64_tr_b16 a[80:81], v20 offset:0
    ds_read_b64_tr_b16 a[82:83], v20 offset:512
    ds_read_b64_tr_b16 a[88:89], v21 offset:0
    ds_read_b64_tr_b16 a[90:91], v21 offset:512
    ds_read_b64_tr_b16 a[96:97], v22 offset:0
    ds_read_b64_tr_b16 a[98:99], v22 offset:512
    ds_read_b64_tr_b16 a[104:105], v23 offset:0
    ds_read_b64_tr_b16 a[106:107], v23 offset:512
    ds_read_b64_tr_b16 a[128:129], v24 offset:0
    ds_read_b64_tr_b16 a[130:131], v24 offset:512
    ds_read_b64_tr_b16 a[136:137], v25 offset:0
    ds_read_b64_tr_b16 a[138:139], v25 offset:512
    s_waitcnt lgkmcnt(4)
    ds_read_b64_tr_b16 v[112:113], v26 offset:0
    ds_read_b64_tr_b16 v[114:115], v26 offset:512
    ds_read_b64_tr_b16 v[120:121], v27 offset:0
    ds_read_b64_tr_b16 v[122:123], v27 offset:512
    s_waitcnt lgkmcnt(0)
    s_barrier
    s_add_u32 m0, s28, 0
    s_add_u32 s37, s3, 0x100000
    buffer_load_dwordx4 v16, s[96:99], s37 offen lds
    s_add_u32 m0, s28, 1024
    s_add_u32 s37, s3, 0x108000
    buffer_load_dwordx4 v17, s[96:99], s37 offen lds
    s_add_u32 m0, s28, 2048
    s_add_u32 s37, s3, 0x110000
    buffer_load_dwordx4 v18, s[96:99], s37 offen lds
    s_add_u32 m0, s28, 3072
    s_add_u32 s37, s3, 0x118000
    buffer_load_dwordx4 v19, s[96:99], s37 offen lds
    s_add_u32 m0, s28, 4096
    s_add_u32 s37, s3, 0x120000
    buffer_load_dwordx4 v16, s[96:99], s37 offen lds
    s_add_u32 m0, s28, 5120
    s_add_u32 s37, s3, 0x128000
    buffer_load_dwordx4 v17, s[96:99], s37 offen lds
    s_add_u32 m0, s28, 6144
    s_add_u32 s37, s3, 0x130000
    buffer_load_dwordx4 v18, s[96:99], s37 offen lds
    s_add_u32 m0, s28, 7168
    s_add_u32 s37, s3, 0x138000
    buffer_load_dwordx4 v19, s[96:99], s37 offen lds
    s_waitcnt vmcnt(32)
    v_perm_b32 v192, v81, v80, s34
    v_perm_b32 v193, v81, v80, s35
    v_perm_b32 v194, v83, v82, s34
    v_perm_b32 v195, v83, v82, s35
    v_perm_b32 v196, v85, v84, s34
    v_perm_b32 v197, v85, v84, s35
    v_perm_b32 v198, v87, v86, s34
    v_perm_b32 v199, v87, v86, s35
    v_perm_b32 v200, v89, v88, s34
    v_perm_b32 v201, v89, v88, s35
    v_perm_b32 v202, v91, v90, s34
    v_perm_b32 v203, v91, v90, s35
    v_perm_b32 v204, v93, v92, s34
    v_perm_b32 v205, v93, v92, s35
    v_perm_b32 v206, v95, v94, s34
    v_perm_b32 v207, v95, v94, s35
    s_xor_b32 s36, s21, 0
    s_lshl_b32 s36, s36, 15
    s_add_u32 s36, s36, s29
    s_add_u32 s37, s36, 0x0
    buffer_load_dword v48, v11, s[92:95], s37 offen
    s_add_u32 s37, s36, 0x4000
    buffer_load_dword v49, v11, s[92:95], s37 offen
    s_add_u32 s37, s36, 0x400
    buffer_load_dword v50, v11, s[92:95], s37 offen
    s_add_u32 s37, s36, 0x4400
    buffer_load_dword v51, v11, s[92:95], s37 offen
    s_add_u32 s37, s36, 0x2000
    buffer_load_dword v52, v11, s[92:95], s37 offen
    s_add_u32 s37, s36, 0x6000
    buffer_load_dword v53, v11, s[92:95], s37 offen
    s_add_u32 s37, s36, 0x2400
    buffer_load_dword v54, v11, s[92:95], s37 offen
    s_add_u32 s37, s36, 0x6400
    buffer_load_dword v55, v11, s[92:95], s37 offen
    s_add_u32 s37, s36, 0x40
    buffer_load_dword v56, v11, s[92:95], s37 offen
    s_add_u32 s37, s36, 0x4040
    buffer_load_dword v57, v11, s[92:95], s37 offen
    s_add_u32 s37, s36, 0x440
    buffer_load_dword v58, v11, s[92:95], s37 offen
    s_add_u32 s37, s36, 0x4440
    buffer_load_dword v59, v11, s[92:95], s37 offen
    s_add_u32 s37, s36, 0x2040
    buffer_load_dword v60, v11, s[92:95], s37 offen
    s_add_u32 s37, s36, 0x6040
    buffer_load_dword v61, v11, s[92:95], s37 offen
    s_add_u32 s37, s36, 0x2440
    buffer_load_dword v62, v11, s[92:95], s37 offen
    s_add_u32 s37, s36, 0x6440
    buffer_load_dword v63, v11, s[92:95], s37 offen
    s_barrier
    ds_read_b64_tr_b16 a[84:85], v20 offset:8192
    ds_read_b64_tr_b16 a[86:87], v20 offset:8704
    ds_read_b64_tr_b16 a[92:93], v21 offset:8192
    ds_read_b64_tr_b16 a[94:95], v21 offset:8704
    ds_read_b64_tr_b16 a[100:101], v22 offset:8192
    ds_read_b64_tr_b16 a[102:103], v22 offset:8704
    ds_read_b64_tr_b16 a[108:109], v23 offset:8192
    ds_read_b64_tr_b16 a[110:111], v23 offset:8704
    ds_read_b64_tr_b16 a[132:133], v24 offset:8192
    ds_read_b64_tr_b16 a[134:135], v24 offset:8704
    ds_read_b64_tr_b16 a[140:141], v25 offset:8192
    ds_read_b64_tr_b16 a[142:143], v25 offset:8704
    s_waitcnt lgkmcnt(4)
    ds_read_b64_tr_b16 v[116:117], v26 offset:8192
    ds_read_b64_tr_b16 v[118:119], v26 offset:8704
    ds_read_b64_tr_b16 v[124:125], v27 offset:8192
    ds_read_b64_tr_b16 v[126:127], v27 offset:8704
    s_waitcnt lgkmcnt(0)
    s_barrier
    s_add_u32 m0, s28, 8192
    s_add_u32 s37, s3, 0x200000
    buffer_load_dwordx4 v16, s[96:99], s37 offen lds
    s_add_u32 m0, s28, 9216
    s_add_u32 s37, s3, 0x208000
    buffer_load_dwordx4 v17, s[96:99], s37 offen lds
    s_add_u32 m0, s28, 10240
    s_add_u32 s37, s3, 0x210000
    buffer_load_dwordx4 v18, s[96:99], s37 offen lds
    s_add_u32 m0, s28, 11264
    s_add_u32 s37, s3, 0x218000
    buffer_load_dwordx4 v19, s[96:99], s37 offen lds
    s_add_u32 m0, s28, 12288
    s_add_u32 s37, s3, 0x220000
    buffer_load_dwordx4 v16, s[96:99], s37 offen lds
    s_add_u32 m0, s28, 13312
    s_add_u32 s37, s3, 0x228000
    buffer_load_dwordx4 v17, s[96:99], s37 offen lds
    s_add_u32 m0, s28, 14336
    s_add_u32 s37, s3, 0x230000
    buffer_load_dwordx4 v18, s[96:99], s37 offen lds
    s_add_u32 m0, s28, 15360
    s_add_u32 s37, s3, 0x238000
    buffer_load_dwordx4 v19, s[96:99], s37 offen lds
    s_waitcnt vmcnt(32)
    v_perm_b32 v176, v33, v32, s34
    v_perm_b32 v177, v33, v32, s35
    v_perm_b32 v178, v35, v34, s34
    v_perm_b32 v179, v35, v34, s35
    v_perm_b32 v180, v37, v36, s34
    v_perm_b32 v181, v37, v36, s35
    v_perm_b32 v182, v39, v38, s34
    v_perm_b32 v183, v39, v38, s35
    v_perm_b32 v184, v41, v40, s34
    v_perm_b32 v185, v41, v40, s35
    v_perm_b32 v186, v43, v42, s34
    v_perm_b32 v187, v43, v42, s35
    v_perm_b32 v188, v45, v44, s34
    v_perm_b32 v189, v45, v44, s35
    v_perm_b32 v190, v47, v46, s34
    v_perm_b32 v191, v47, v46, s35
    v_lshrrev_b32 v31, 2, v3
    buffer_load_dword v30, v31, s[16:19], 0 offen sc1
    s_barrier
    ds_read_b64_tr_b16 v[32:33], v20 offset:16384
    ds_read_b64_tr_b16 v[34:35], v20 offset:16896
    ds_read_b64_tr_b16 v[40:41], v21 offset:16384
    ds_read_b64_tr_b16 v[42:43], v21 offset:16896
    ds_read_b64_tr_b16 a[0:1], v22 offset:16384
    ds_read_b64_tr_b16 a[2:3], v22 offset:16896
    ds_read_b64_tr_b16 a[8:9], v23 offset:16384
    ds_read_b64_tr_b16 a[10:11], v23 offset:16896
    ds_read_b64_tr_b16 a[32:33], v24 offset:16384
    ds_read_b64_tr_b16 a[34:35], v24 offset:16896
    ds_read_b64_tr_b16 a[40:41], v25 offset:16384
    ds_read_b64_tr_b16 a[42:43], v25 offset:16896
    s_waitcnt lgkmcnt(4)
    ds_read_b64_tr_b16 a[64:65], v26 offset:16384
    ds_read_b64_tr_b16 a[66:67], v26 offset:16896
    ds_read_b64_tr_b16 a[72:73], v27 offset:16384
    ds_read_b64_tr_b16 a[74:75], v27 offset:16896
    s_waitcnt lgkmcnt(0)
    s_barrier
    s_add_u32 m0, s28, 16384
    s_add_u32 s37, s3, 0x300000
    buffer_load_dwordx4 v16, s[96:99], s37 offen lds
    s_add_u32 m0, s28, 17408
    s_add_u32 s37, s3, 0x308000
    buffer_load_dwordx4 v17, s[96:99], s37 offen lds
    s_add_u32 m0, s28, 18432
    s_add_u32 s37, s3, 0x310000
    buffer_load_dwordx4 v18, s[96:99], s37 offen lds
    s_add_u32 m0, s28, 19456
    s_add_u32 s37, s3, 0x318000
    buffer_load_dwordx4 v19, s[96:99], s37 offen lds
    s_add_u32 m0, s28, 20480
    s_add_u32 s37, s3, 0x320000
    buffer_load_dwordx4 v16, s[96:99], s37 offen lds
    s_add_u32 m0, s28, 21504
    s_add_u32 s37, s3, 0x328000
    buffer_load_dwordx4 v17, s[96:99], s37 offen lds
    s_add_u32 m0, s28, 22528
    s_add_u32 s37, s3, 0x330000
    buffer_load_dwordx4 v18, s[96:99], s37 offen lds
    s_add_u32 m0, s28, 23552
    s_add_u32 s37, s3, 0x338000
    buffer_load_dwordx4 v19, s[96:99], s37 offen lds
    s_waitcnt vmcnt(17)
    v_perm_b32 v160, v49, v48, s34
    v_perm_b32 v161, v49, v48, s35
    v_perm_b32 v162, v51, v50, s34
    v_perm_b32 v163, v51, v50, s35
    v_perm_b32 v164, v53, v52, s34
    v_perm_b32 v165, v53, v52, s35
    v_perm_b32 v166, v55, v54, s34
    v_perm_b32 v167, v55, v54, s35
    v_perm_b32 v168, v57, v56, s34
    v_perm_b32 v169, v57, v56, s35
    v_perm_b32 v170, v59, v58, s34
    v_perm_b32 v171, v59, v58, s35
    v_perm_b32 v172, v61, v60, s34
    v_perm_b32 v173, v61, v60, s35
    v_perm_b32 v174, v63, v62, s34
    v_perm_b32 v175, v63, v62, s35
    s_waitcnt vmcnt(8)
    s_mov_b32 s41, 1
L_HS:
    v_cmp_eq_u32 vcc, 0, v30
    s_cbranch_vccz L_HS_ok
    buffer_load_dword v30, v31, s[16:19], 0 offen sc1
    s_add_u32 s32, s32, 1
    s_cmp_gt_u32 s32, 200000
    s_waitcnt vmcnt(0)
    s_cbranch_scc0 L_HS
    s_branch L_HS_done
L_HS_ok:
    v_readlane_b32 s36, v30, 63
    s_nop 1
    v_cmp_ne_u32 vcc, s36, v30
    s_nop 1
    s_cmp_lg_u32 vcc_hi, 0
    s_cselect_b32 s41, 1, 0
L_HS_done:
    s_mov_b32 s7, 0xf7df00
    buffer_load_dword v15, v0, s[8:11], s7 offen sc1
    s_barrier
    ds_read_b64_tr_b16 v[36:37], v20 offset:0
    ds_read_b64_tr_b16 v[38:39], v20 offset:512
    ds_read_b64_tr_b16 v[44:45], v21 offset:0
    ds_read_b64_tr_b16 v[46:47], v21 offset:512
    ds_read_b64_tr_b16 a[4:5], v22 offset:0
    ds_read_b64_tr_b16 a[6:7], v22 offset:512
    ds_read_b64_tr_b16 a[12:13], v23 offset:0
    ds_read_b64_tr_b16 a[14:15], v23 offset:512
    ds_read_b64_tr_b16 a[36:37], v24 offset:0
    ds_read_b64_tr_b16 a[38:39], v24 offset:512
    ds_read_b64_tr_b16 a[44:45], v25 offset:0
    ds_read_b64_tr_b16 a[46:47], v25 offset:512
    s_waitcnt lgkmcnt(4)
    ds_read_b64_tr_b16 a[68:69], v26 offset:0
    ds_read_b64_tr_b16 a[70:71], v26 offset:512
    ds_read_b64_tr_b16 a[76:77], v27 offset:0
    ds_read_b64_tr_b16 a[78:79], v27 offset:512
    s_waitcnt lgkmcnt(0)
    s_barrier
    s_barrier
    ds_read_b64_tr_b16 v[48:49], v20 offset:8192
    ds_read_b64_tr_b16 v[50:51], v20 offset:8704
    ds_read_b64_tr_b16 v[56:57], v21 offset:8192
    ds_read_b64_tr_b16 v[58:59], v21 offset:8704
    ds_read_b64_tr_b16 a[16:17], v22 offset:8192
    ds_read_b64_tr_b16 a[18:19], v22 offset:8704
    ds_read_b64_tr_b16 a[24:25], v23 offset:8192
    ds_read_b64_tr_b16 a[26:27], v23 offset:8704
    ds_read_b64_tr_b16 a[48:49], v24 offset:8192
    ds_read_b64_tr_b16 a[50:51], v24 offset:8704
    ds_read_b64_tr_b16 a[56:57], v25 offset:8192
    ds_read_b64_tr_b16 a[58:59], v25 offset:8704
    s_waitcnt lgkmcnt(4)
    ds_read_b64_tr_b16 v[80:81], v26 offset:8192
    ds_read_b64_tr_b16 v[82:83], v26 offset:8704
    ds_read_b64_tr_b16 v[88:89], v27 offset:8192
    ds_read_b64_tr_b16 v[90:91], v27 offset:8704
    s_waitcnt lgkmcnt(0)
    s_barrier
    s_waitcnt vmcnt(0)
L_F0:
    v_readlane_b32 s36, v15, 33
    s_nop 1
    s_cmp_lg_u32 s36, 0
    s_cbranch_scc1 L_F0_ok
    buffer_load_dword v15, v0, s[8:11], s7 offen sc1
    s_add_u32 s32, s32, 1
    s_cmp_gt_u32 s32, 200000
    s_waitcnt vmcnt(0)
    s_cbranch_scc0 L_F0
L_F0_ok:
    s_mov_b32 s7, 0x1000000
    buffer_load_dword v15, v0, s[8:11], s7 offen sc1
    s_barrier
    ds_read_b64_tr_b16 v[52:53], v20 offset:16384
    ds_read_b64_tr_b16 v[54:55], v20 offset:16896
    ds_read_b64_tr_b16 v[60:61], v21 offset:16384
    ds_read_b64_tr_b16 v[62:63], v21 offset:16896
    ds_read_b64_tr_b16 a[20:21], v22 offset:16384
    ds_read_b64_tr_b16 a[22:23], v22 offset:16896
    ds_read_b64_tr_b16 a[28:29], v23 offset:16384
    ds_read_b64_tr_b16 a[30:31], v23 offset:16896
    ds_read_b64_tr_b16 a[52:53], v24 offset:16384
    ds_read_b64_tr_b16 a[54:55], v24 offset:16896
    ds_read_b64_tr_b16 a[60:61], v25 offset:16384
    ds_read_b64_tr_b16 a[62:63], v25 offset:16896
    s_waitcnt lgkmcnt(4)
    ds_read_b64_tr_b16 v[84:85], v26 offset:16384
    ds_read_b64_tr_b16 v[86:87], v26 offset:16896
    ds_read_b64_tr_b16 v[92:93], v27 offset:16384
    ds_read_b64_tr_b16 v[94:95], v27 offset:16896
    s_waitcnt lgkmcnt(0)
    s_barrier
    ds_write_b128 v4, v[32:35] offset:0
    ds_write_b128 v4, v[36:39] offset:1024
    ds_write_b128 v4, v[40:43] offset:2048
    ds_write_b128 v4, v[44:47] offset:3072
    ds_write_b128 v4, v[48:51] offset:4096
    ds_write_b128 v4, v[52:55] offset:5120
    ds_write_b128 v4, v[56:59] offset:6144
    ds_write_b128 v4, v[60:63] offset:7168
    s_waitcnt lgkmcnt(0)
    ds_write_b128 v4, v[64:67] offset:8192
    ds_write_b128 v4, v[68:71] offset:9216
    ds_write_b128 v4, v[72:75] offset:10240
    ds_write_b128 v4, v[76:79] offset:11264
    ds_write_b128 v4, v[80:83] offset:12288
    ds_write_b128 v4, v[84:87] offset:13312
    ds_write_b128 v4, v[88:91] offset:14336
    ds_write_b128 v4, v[92:95] offset:15360
    s_waitcnt lgkmcnt(0)
    ds_write_b128 v4, v[96:99] offset:16384
    ds_write_b128 v4, v[100:103] offset:17408
    ds_write_b128 v4, v[104:107] offset:18432
    ds_write_b128 v4, v[108:111] offset:19456
    ds_write_b128 v4, v[112:115] offset:20480
    ds_write_b128 v4, v[116:119] offset:21504
    ds_write_b128 v4, v[120:123] offset:22528
    ds_write_b128 v4, v[124:127] offset:23552
    s_waitcnt lgkmcnt(0)
    s_waitcnt lgkmcnt(0)
    s_cmp_lg_u32 s41, 0
    s_cbranch_scc1 L_slow_start
L_fast_start:
    s_mov_b32 s22, 0
    s_mov_b32 s23, 0x1000000
    s_mov_b32 s27, 0
    s_mov_b32 s31, 0x80000
    s_mov_b32 s61, 0x40000000
    s_mov_b32 s91, 0
    ds_read_b128 v[104:107], v4 offset:0
    ds_read_b128 v[108:111], v4 offset:1024
    ds_read_b128 v[112:115], v4 offset:2048
    ds_read_b128 v[116:119], v4 offset:3072
    ds_read_b128 v[88:91], v4 offset:4096
    ds_read_b128 v[92:95], v4 offset:5120
    ds_read_b128 v[96:99], v4 offset:6144
    ds_read_b128 v[100:103], v4 offset:7168
    ds_read_b128 v[72:75], v4 offset:8192
    ds_read_b128 v[76:79], v4 offset:9216
    ds_read_b128 v[80:83], v4 offset:10240
    ds_read_b128 v[84:87], v4 offset:11264
    v_mov_b64 v[48:49], 0
    v_mov_b64 v[50:51], 0
    v_mov_b64 v[52:53], 0
    v_mov_b64 v[54:55], 0
    v_mov_b64 v[56:57], 0
    v_mov_b64 v[58:59], 0
    v_mov_b64 v[60:61], 0
    v_mov_b64 v[62:63], 0
    v_mov_b64 v[64:65], 0
    v_mov_b64 v[66:67], 0
    v_mov_b64 v[68:69], 0
    v_mov_b64 v[70:71], 0
    s_add_u32 s7, s23, 0x80000
    buffer_load_dwordx4 v[16:19], v2, s[8:11], s7 offen sc1
    buffer_load_dwordx4 v[20:23], v2, s[8:11], s7 offen offset:1024 sc1
    s_waitcnt vmcnt(2)
L_fast_step:
    v_readlane_b32 s36, v15, 33
    s_add_u32 s24, s23, 0x82100
    s_cmp_eq_u32 s36, 0
    s_cbranch_scc1 L_fast_refresh
L_fast_fresh:
    s_add_u32 s29, s23, s25
    s_add_u32 s30, s23, s39
    s_xor_b32 s28, s27, 1
    s_add_u32 s90, s22, 1
    s_nop 15
L_fast_retrym:
    buffer_load_dwordx4 v[16:19], v2, s[8:11], s7 offen sc1
    buffer_load_dwordx4 v[20:23], v2, s[8:11], s7 offen offset:1024 sc1
    s_add_u32 s32, s32, 1
    s_cmp_gt_u32 s32, 200000
    s_cselect_b32 s94, -1, -2
    v_xor_b32 v28, 0x800, v2
    v_xor_b32 v44, 0x1800, v2
    v_mov_b64 v[48:49], 0
    v_mov_b64 v[50:51], 0
    v_mov_b64 v[52:53], 0
    v_mov_b64 v[54:55], 0
L_fast_waitm:
    s_waitcnt vmcnt(3) lgkmcnt(0)
L_fast_gotm:
    v_max3_u32 v14, v16, v17, v18
    v_max_u32 v14, v14, v19
    v_smfmac_f32_16x16x64_bf16 v[48:51], v[16:19], v[104:111], v1
    s_waitcnt vmcnt(2)
    v_max3_u32 v14, v14, v20, v21
    v_smfmac_f32_16x16x64_bf16 v[52:55], v[16:19], v[112:119], v1
    v_max3_u32 v14, v14, v22, v23
    v_cmp_lt_u32 vcc, s94, v14
    v_smfmac_f32_16x16x64_bf16 v[48:51], v[20:23], v[88:95], v1
    ds_write_b128 v2, v[16:19] offset:0
    s_cbranch_vccnz L_fast_retrym
    v_smfmac_f32_16x16x64_bf16 v[52:55], v[20:23], v[96:103], v1
    ds_write_b128 v2, v[20:23] offset:1024
    v_smfmac_f32_16x16x64_bf16 v[56:59], v[16:19], v[72:79], v1
    buffer_load_dwordx4 v[104:107], v3, s[8:11], s29 offen offset:0 sc1
    buffer_load_dwordx4 v[120:123], v3, s[8:11], s30 offen offset:0 sc1
    v_smfmac_f32_16x16x64_bf16 v[60:63], v[16:19], v[80:87], v1
    buffer_load_dwordx4 v[108:111], v3, s[8:11], s29 offen offset:1024 sc1
    buffer_load_dwordx4 v[124:127], v3, s[8:11], s30 offen offset:1024 sc1
    v_smfmac_f32_16x16x64_bf16 v[56:59], v[20:23], a[80:87], v1
    buffer_load_dwordx4 v[112:115], v3, s[8:11], s29 offen offset:2048 sc1
    buffer_load_dwordx4 v[116:119], v3, s[8:11], s29 offen offset:3072 sc1
    v_smfmac_f32_16x16x64_bf16 v[60:63], v[20:23], a[88:95], v1
    s_waitcnt lgkmcnt(0)
    s_barrier
    ds_read_b128 v[24:27], v28 offset:0
    v_smfmac_f32_16x16x64_bf16 v[64:67], v[16:19], a[160:167], v1
    ds_read_b128 v[28:31], v28 offset:1024
    v_smfmac_f32_16x16x64_bf16 v[68:71], v[16:19], a[168:175], v1
    buffer_load_dword v15, v0, s[8:11], s24 offen sc1
    v_smfmac_f32_16x16x64_bf16 v[64:67], v[20:23], a[176:183], v1
    ds_read_b128 v[32:35], v8 offset:0
    v_smfmac_f32_16x16x64_bf16 v[68:71], v[20:23], a[184:191], v1
    ds_read_b128 v[36:39], v8 offset:1024
    s_waitcnt lgkmcnt(3)
    v_smfmac_f32_16x16x64_bf16 v[48:51], v[24:27], a[0:7], v1
    ds_read_b128 v[40:43], v44 offset:0
    v_smfmac_f32_16x16x64_bf16 v[52:55], v[24:27], a[8:15], v1
    ds_read_b128 v[44:47], v44 offset:1024
    s_waitcnt lgkmcnt(4)
    v_smfmac_f32_16x16x64_bf16 v[48:51], v[28:31], a[16:23], v1
    ds_read_b128 v[88:91], v4 offset:12288
    v_smfmac_f32_16x16x64_bf16 v[52:55], v[28:31], a[24:31], v1
    ds_read_b128 v[92:95], v4 offset:13312
    s_waitcnt lgkmcnt(4)
    v_smfmac_f32_16x16x64_bf16 v[48:51], v[32:35], a[32:39], v1
    ds_read_b128 v[96:99], v4 offset:14336
    v_smfmac_f32_16x16x64_bf16 v[52:55], v[32:35], a[40:47], v1
    ds_read_b128 v[100:103], v4 offset:15360
    s_waitcnt lgkmcnt(4)
    v_smfmac_f32_16x16x64_bf16 v[48:51], v[36:39], a[48:55], v1
    v_smfmac_f32_16x16x64_bf16 v[52:55], v[36:39], a[56:63], v1
    ds_read_b128 v[72:75], v4 offset:16384
    v_smfmac_f32_16x16x64_bf16 v[48:51], v[40:43], a[64:71], v1
    v_smfmac_f32_16x16x64_bf16 v[52:55], v[40:43], a[72:79], v1
    ds_read_b128 v[76:79], v4 offset:17408
    s_waitcnt lgkmcnt(2)
    v_smfmac_f32_16x16x64_bf16 v[48:51], v[44:47], v[88:95], v1
    ds_read_b128 v[80:83], v4 offset:18432
    v_smfmac_f32_16x16x64_bf16 v[52:55], v[44:47], v[96:103], v1
    ds_read_b128 v[84:87], v4 offset:19456
    v_smfmac_f32_16x16x64_bf16 v[56:59], v[28:31], a[96:103], v1
    ds_read_b128 v[88:91], v4 offset:20480
    v_smfmac_f32_16x16x64_bf16 v[60:63], v[28:31], a[104:111], v1
    ds_read_b128 v[92:95], v4 offset:21504
    v_smfmac_f32_16x16x64_bf16 v[56:59], v[32:35], a[112:119], v1
    ds_read_b128 v[96:99], v4 offset:22528
    v_add_f32 v48, v48, v50
    v_add_f32 v49, v49, v51
    v_smfmac_f32_16x16x64_bf16 v[60:63], v[32:35], a[120:127], v1
    ds_read_b128 v[100:103], v4 offset:23552
    v_add_f32 v52, v52, v54
    v_add_f32 v53, v53, v55
    v_smfmac_f32_16x16x64_bf16 v[56:59], v[36:39], a[128:135], v1
    s_waitcnt lgkmcnt(4)
    v_cvt_pk_bf16_f32 v50, v48, v52
    v_cvt_pk_bf16_f32 v51, v49, v53
    v_smfmac_f32_16x16x64_bf16 v[56:59], v[24:27], v[72:79], v1
    ds_write2_b32 v5, v50, v51 offset0:0 offset1:72
    v_smfmac_f32_16x16x64_bf16 v[60:63], v[24:27], v[80:87], v1
    v_smfmac_f32_16x16x64_bf16 v[60:63], v[36:39], a[136:143], v1
    v_smfmac_f32_16x16x64_bf16 v[56:59], v[40:43], a[144:151], v1
    buffer_store_dword v12, v10, s[8:11], s31 offen sc1
    v_smfmac_f32_16x16x64_bf16 v[60:63], v[40:43], a[152:159], v1
    s_waitcnt lgkmcnt(0)
    s_barrier
    v_smfmac_f32_16x16x64_bf16 v[56:59], v[44:47], v[88:95], v1
    ds_read_b128 v[72:75], v6 offset:0
    v_smfmac_f32_16x16x64_bf16 v[60:63], v[44:47], v[96:103], v1
    ds_read_b128 v[76:79], v6 offset:64
    v_smfmac_f32_16x16x64_bf16 v[64:67], v[24:27], a[192:199], v1
    ds_read_b128 v[80:83], v6 offset:128
    v_smfmac_f32_16x16x64_bf16 v[68:71], v[24:27], a[200:207], v1
    ds_read_b128 v[84:87], v6 offset:192
    s_waitcnt vmcnt(2) lgkmcnt(3)
    v_mfma_f32_16x16x32_bf16 v[48:51], v[104:107], v[72:75], 0
    s_waitcnt lgkmcnt(2)
    v_add_f32 v56, v56, v58
    v_add_f32 v57, v57, v59
    v_mfma_f32_16x16x32_bf16 v[48:51], v[108:111], v[76:79], v[48:51]
    s_waitcnt lgkmcnt(1)
    v_add_f32 v60, v60, v62
    v_add_f32 v61, v61, v63
    v_mfma_f32_16x16x32_bf16 v[48:51], v[112:115], v[80:83], v[48:51]
    s_waitcnt lgkmcnt(0)
    v_cvt_pk_bf16_f32 v58, v56, v60
    v_cvt_pk_bf16_f32 v59, v57, v61
    v_mfma_f32_16x16x32_bf16 v[48:51], v[116:119], v[84:87], v[48:51]
    ds_write2_b32 v7, v58, v59 offset0:0 offset1:72
    v_smfmac_f32_16x16x64_bf16 v[64:67], v[28:31], a[208:215], v1
    v_mov_b64 v[104:105], s[4:5]
    v_smfmac_f32_16x16x64_bf16 v[68:71], v[28:31], a[216:223], v1
    s_nop 1
    v_mov_b64 v[106:107], s[4:5]
    v_smfmac_f32_16x16x64_bf16 v[64:67], v[32:35], a[224:231], v1
    v_exp_f32 v48, v48
    v_smfmac_f32_16x16x64_bf16 v[68:71], v[32:35], a[232:239], v1
    s_waitcnt lgkmcnt(0)
    s_barrier
    v_exp_f32 v49, v49
    v_smfmac_f32_16x16x64_bf16 v[64:67], v[36:39], a[240:247], v1
    ds_read_b128 v[88:91], v6 offset:2304
    v_exp_f32 v50, v50
    v_smfmac_f32_16x16x64_bf16 v[68:71], v[36:39], a[248:255], v1
    ds_read_b128 v[92:95], v6 offset:2368
    v_exp_f32 v51, v51
    v_smfmac_f32_16x16x64_bf16 v[64:67], v[40:43], v[128:135], v1
    ds_read_b128 v[96:99], v6 offset:2432
    v_cvt_pk_bf16_f32 v108, v48, v49
    v_cvt_pk_bf16_f32 v109, v50, v51
    v_smfmac_f32_16x16x64_bf16 v[68:71], v[40:43], v[136:143], v1
    ds_read_b128 v[100:103], v6 offset:2496
    ds_write_b64 v2, v[108:109] offset:8192
    s_waitcnt lgkmcnt(4)
    v_mfma_f32_16x16x32_bf16 v[52:55], v[88:91], v[72:75], 0
    s_waitcnt lgkmcnt(3)
    v_mov_b32 v113, 0
    v_mov_b32 v115, 0
    v_mfma_f32_16x16x32_bf16 v[52:55], v[92:95], v[76:79], v[52:55]
    s_waitcnt lgkmcnt(2)
    v_mov_b32 v117, 0
    v_mov_b64 v[16:17], 0
    v_mfma_f32_16x16x32_bf16 v[52:55], v[96:99], v[80:83], v[52:55]
    s_waitcnt lgkmcnt(1)
    v_mov_b64 v[18:19], 0
    v_mov_b64 v[20:21], 0
    v_mfma_f32_16x16x32_bf16 v[52:55], v[100:103], v[84:87], v[52:55]
    s_waitcnt lgkmcnt(0)
    s_barrier
    v_smfmac_f32_16x16x64_bf16 v[64:67], v[44:47], v[144:151], v1
    ds_read_b64 v[110:111], v8 offset:8192
    v_mov_b64 v[22:23], 0
    v_smfmac_f32_16x16x64_bf16 v[68:71], v[44:47], v[152:159], v1
    v_mov_b64 v[24:25], 0
    v_mov_b64 v[26:27], 0
    v_mul_f32 v52, s33, v52
    v_mul_f32 v53, s33, v53
    v_exp_f32 v52, v52
    s_waitcnt lgkmcnt(0)
    v_mfma_f32_16x16x32_bf16 v[48:51], v[104:107], v[108:111], 0
    v_exp_f32 v53, v53
    v_add_f32 v64, v64, v66
    v_mfma_f32_16x16x32_bf16 v[56:59], v[120:123], v[108:111], 0
    v_cvt_pk_bf16_f32 v112, v52, v53
    v_add_f32 v65, v65, v67
    v_mfma_f32_16x16x32_bf16 v[60:63], v[124:127], v[108:111], 0
    v_cvt_pk_bf16_f32 v114, v64, v65
    v_add_f32 v68, v68, v70
    v_mfma_f32_16x16x16_bf16 v[48:51], v[104:105], v[112:113], v[48:51]
    v_add_f32 v69, v69, v71
    v_cvt_pk_bf16_f32 v116, v68, v69
    v_mfma_f32_16x16x16_bf16 v[56:59], v[114:115], v[112:113], v[56:59]
    v_mov_b64 v[28:29], 0
    v_mov_b64 v[30:31], 0
    v_mfma_f32_16x16x16_bf16 v[60:63], v[116:117], v[112:113], v[60:63]
    v_xor_b32 v32, 0x800, v2
    v_xor_b32 v40, 0x1800, v2
    v_rcp_f32 v118, v48
    s_nop 0
    v_max_f32 v14, v118, v48
    v_cmp_nge_f32 vcc, s40, v14
    v_pk_mul_f32 v[56:57], v[56:57], v[118:119] op_sel_hi:[1,0]
    v_pk_mul_f32 v[58:59], v[58:59], v[118:119] op_sel_hi:[1,0]
    v_pk_mul_f32 v[60:61], v[60:61], v[118:119] op_sel_hi:[1,0]
    v_pk_mul_f32 v[62:63], v[62:63], v[118:119] op_sel_hi:[1,0]
    v_cvt_pk_bf16_f32 v52, v56, v60
    v_cvt_pk_bf16_f32 v53, v57, v61
    v_cvt_pk_bf16_f32 v54, v58, v62
    v_cvt_pk_bf16_f32 v55, v59, v63
L_fast_rejoin:
    ds_write_b128 v2, v[52:55] offset:9216
    s_nop 0
    v_smfmac_f32_16x16x64_bf16 v[16:19], v[52:55], v[160:167], v1
    v_smfmac_f32_16x16x64_bf16 v[20:23], v[52:55], v[168:175], v1
    v_smfmac_f32_16x16x64_bf16 v[24:27], v[52:55], v[176:183], v1
    s_waitcnt lgkmcnt(0)
    s_barrier
    ds_read_b128 v[32:35], v32 offset:9216
    ds_read_b128 v[36:39], v8 offset:9216
    v_smfmac_f32_16x16x64_bf16 v[28:31], v[52:55], v[184:191], v1
    ds_read_b128 v[40:43], v40 offset:9216
    ds_read_b128 v[88:91], v4 offset:24576
    ds_read_b128 v[92:95], v4 offset:25600
    s_waitcnt lgkmcnt(4)
    v_smfmac_f32_16x16x64_bf16 v[16:19], v[32:35], v[192:199], v1
    ds_read_b128 v[96:99], v4 offset:26624
    s_waitcnt lgkmcnt(4)
    v_smfmac_f32_16x16x64_bf16 v[16:19], v[36:39], v[216:223], v1
    ds_read_b128 v[100:103], v4 offset:27648
    s_waitcnt lgkmcnt(4)
    v_smfmac_f32_16x16x64_bf16 v[16:19], v[40:43], v[240:247], v1
    ds_read_b128 v[72:75], v4 offset:28672
    s_cmp_lg_u64 vcc, 0
    v_smfmac_f32_16x16x64_bf16 v[20:23], v[32:35], v[200:207], v1
    ds_read_b128 v[76:79], v4 offset:29696
    s_cselect_b32 s60, s28, s27
    v_smfmac_f32_16x16x64_bf16 v[20:23], v[36:39], v[224:231], v1
    ds_read_b128 v[80:83], v4 offset:30720
    s_nop 0
    v_cvt_pk_bf16_f32 v56, v16, v18
    v_smfmac_f32_16x16x64_bf16 v[20:23], v[40:43], v[248:255], v1
    ds_read_b128 v[84:87], v4 offset:31744
    v_cvt_pk_bf16_f32 v57, v17, v19
    v_and_or_b32 v56, v56, -2, s60
    v_smfmac_f32_16x16x64_bf16 v[24:27], v[32:35], v[208:215], v1
    buffer_store_dwordx2 v[56:57], v9, s[8:11], 0 offen offset:0
    v_smfmac_f32_16x16x64_bf16 v[24:27], v[36:39], v[232:239], v1
    s_waitcnt lgkmcnt(4)
    s_nop 0
    v_cvt_pk_bf16_f32 v58, v20, v22
    v_smfmac_f32_16x16x64_bf16 v[24:27], v[40:43], v[88:95], v1
    ds_read_b128 v[64:67], v3 offset:23040
    v_cvt_pk_bf16_f32 v59, v21, v23
    v_and_or_b32 v58, v58, -2, s60
    v_smfmac_f32_16x16x64_bf16 v[28:31], v[32:35], v[96:103], v1
    buffer_store_dwordx2 v[58:59], v9, s[8:11], 0 offen offset:2048
    s_waitcnt lgkmcnt(1)
    v_smfmac_f32_16x16x64_bf16 v[28:31], v[36:39], v[72:79], v1
    s_nop 1
    v_cvt_pk_bf16_f32 v60, v24, v26
    v_smfmac_f32_16x16x64_bf16 v[28:31], v[40:43], v[80:87], v1
    v_cvt_pk_bf16_f32 v61, v25, v27
    v_and_or_b32 v60, v60, -2, s60
    buffer_store_dwordx2 v[60:61], v9, s[8:11], s26 offen offset:0
    s_nop 4
    v_cvt_pk_bf16_f32 v62, v28, v30
    v_cvt_pk_bf16_f32 v63, v29, v31
    v_and_or_b32 v62, v62, -2, s60
    buffer_store_dwordx2 v[62:63], v9, s[8:11], s26 offen offset:2048
L_fast_stored:
    s_cmp_lg_u32 s60, s27
    s_cbranch_scc1 L_fast_safe
    ds_read_b128 v[104:107], v4 offset:0
    ds_read_b128 v[108:111], v4 offset:1024
    ds_read_b128 v[112:115], v4 offset:2048
    ds_read_b128 v[116:119], v4 offset:3072
    ds_read_b128 v[88:91], v4 offset:4096
    ds_read_b128 v[92:95], v4 offset:5120
    ds_read_b128 v[96:99], v4 offset:6144
    ds_read_b128 v[100:103], v4 offset:7168
    ds_read_b128 v[72:75], v4 offset:8192
    ds_read_b128 v[76:79], v4 offset:9216
    ds_read_b128 v[80:83], v4 offset:10240
    ds_read_b128 v[84:87], v4 offset:11264
    s_cmp_lt_u32 s21, 1
    s_cbranch_scc1 L_fast_pollp
    s_nop 13
    s_cmp_lt_u32 s21, 2
    s_cbranch_scc1 L_fast_pollp
    s_nop 13
    s_cmp_lt_u32 s21, 3
    s_cbranch_scc1 L_fast_pollp
    s_nop 13
L_fast_pollp:
    buffer_load_dwordx4 v[120:123], v2, s[8:11], s6 offen sc1
    buffer_load_dwordx4 v[124:127], v2, s[8:11], s6 offen offset:1024 sc1
    v_mov_b64 v[56:57], 0
    v_mov_b64 v[58:59], 0
    v_mov_b64 v[60:61], 0
    v_mov_b64 v[62:63], 0
    s_nop 15
    s_nop 15
    buffer_load_dwordx4 v[32:35], v2, s[8:11], s6 offen sc1
    buffer_load_dwordx4 v[36:39], v2, s[8:11], s6 offen offset:1024 sc1
    s_add_u32 s7, s24, 0x80000
    s_waitcnt vmcnt(3) lgkmcnt(0)
    v_mfma_f32_16x16x32_bf16 v[68:71], v[64:67], v[120:123], 0
    v_bitop3_b32 v14, v120, v122, s27 bitop3:0x7e
    s_waitcnt vmcnt(2)
    v_mfma_f32_16x16x32_bf16 v[68:71], v[64:67], v[124:127], v[68:71]
    v_bitop3_b32 v11, v124, v126, s27 bitop3:0x7e
    v_bitop3_b32 v14, v14, v11, 1 bitop3:0xa8
    v_cmp_ne_u32 vcc, 0, v14
    s_nop 2
    s_cmp_eq_u64 vcc, 0
    s_cselect_b32 s36, s24, s61
    v_add_f32_dpp v68, v68, v68 row_ror:8 row_mask:0xf bank_mask:0xf
    v_add_f32_dpp v69, v69, v69 row_ror:8 row_mask:0xf bank_mask:0xf
    s_nop 0
    v_add_f32_dpp v68, v68, v68 row_ror:4 row_mask:0xf bank_mask:0xf
    v_add_f32_dpp v69, v69, v69 row_ror:4 row_mask:0xf bank_mask:0xf
    v_cvt_pk_bf16_f32 v12, v68, v69
    buffer_store_dword v12, v10, s[8:11], s36 offen
    s_cbranch_scc1 L_fast_gotp
L_fast_retryp:
    buffer_load_dwordx4 v[120:123], v2, s[8:11], s6 offen sc1
    buffer_load_dwordx4 v[124:127], v2, s[8:11], s6 offen offset:1024 sc1
    s_waitcnt vmcnt(4) lgkmcnt(0)
    v_mfma_f32_16x16x32_bf16 v[68:71], v[64:67], v[32:35], 0
    v_bitop3_b32 v14, v32, v34, s27 bitop3:0x7e
    s_waitcnt vmcnt(3)
    v_mfma_f32_16x16x32_bf16 v[68:71], v[64:67], v[36:39], v[68:71]
    v_bitop3_b32 v11, v36, v38, s27 bitop3:0x7e
    v_bitop3_b32 v14, v14, v11, 1 bitop3:0xa8
    v_cmp_ne_u32 vcc, 0, v14
    s_nop 2
    s_cmp_eq_u64 vcc, 0
    s_cselect_b32 s36, s24, s61
    v_add_f32_dpp v68, v68, v68 row_ror:8 row_mask:0xf bank_mask:0xf
    v_add_f32_dpp v69, v69, v69 row_ror:8 row_mask:0xf bank_mask:0xf
    s_nop 0
    v_add_f32_dpp v68, v68, v68 row_ror:4 row_mask:0xf bank_mask:0xf
    v_add_f32_dpp v69, v69, v69 row_ror:4 row_mask:0xf bank_mask:0xf
    v_cvt_pk_bf16_f32 v12, v68, v69
    buffer_store_dword v12, v10, s[8:11], s36 offen
    s_cbranch_scc1 L_fast_gotp
    buffer_load_dwordx4 v[32:35], v2, s[8:11], s6 offen sc1
    buffer_load_dwordx4 v[36:39], v2, s[8:11], s6 offen offset:1024 sc1
    s_waitcnt vmcnt(4) lgkmcnt(0)
    v_mfma_f32_16x16x32_bf16 v[68:71], v[64:67], v[120:123], 0
    v_bitop3_b32 v14, v120, v122, s27 bitop3:0x7e
    s_waitcnt vmcnt(3)
    v_mfma_f32_16x16x32_bf16 v[68:71], v[64:67], v[124:127], v[68:71]
    v_bitop3_b32 v11, v124, v126, s27 bitop3:0x7e
    v_bitop3_b32 v14, v14, v11, 1 bitop3:0xa8
    v_cmp_ne_u32 vcc, 0, v14
    s_nop 2
    s_cmp_eq_u64 vcc, 0
    s_cselect_b32 s36, s24, s61
    v_add_f32_dpp v68, v68, v68 row_ror:8 row_mask:0xf bank_mask:0xf
    v_add_f32_dpp v69, v69, v69 row_ror:8 row_mask:0xf bank_mask:0xf
    s_nop 0
    v_add_f32_dpp v68, v68, v68 row_ror:4 row_mask:0xf bank_mask:0xf
    v_add_f32_dpp v69, v69, v69 row_ror:4 row_mask:0xf bank_mask:0xf
    v_cvt_pk_bf16_f32 v12, v68, v69
    buffer_store_dword v12, v10, s[8:11], s36 offen
    s_cbranch_scc1 L_fast_gotp
    s_add_u32 s32, s32, 1
    s_cmp_le_u32 s32, 200000
    s_cbranch_scc1 L_fast_retryp
    s_mov_b32 s36, s24
    buffer_store_dword v12, v10, s[8:11], s36 offen
L_fast_gotp:
    s_add_u32 s31, s31, 0x2000
    s_cmp_ge_u32 s90, 63
    s_cbranch_scc1 L_fast_last
    s_mov_b32 s23, s24
    s_mov_b32 s22, s90
    s_mov_b32 s27, s28
    v_mov_b64 v[64:65], 0
    v_mov_b64 v[66:67], 0
    v_mov_b64 v[68:69], 0
    v_mov_b64 v[70:71], 0
    s_nop 15
    s_nop 11
    buffer_load_dwordx4 v[16:19], v2, s[8:11], s7 offen sc1
    buffer_load_dwordx4 v[20:23], v2, s[8:11], s7 offen offset:1024 sc1
    s_branch L_fast_step
L_fast_last:
    buffer_store_dword v12, v10, s[8:11], s31 offen sc1
    s_branch L_fast_done
L_fast_refresh:
    buffer_load_dword v15, v0, s[8:11], s23 offen sc1
    s_add_u32 s32, s32, 1
    s_cmp_le_u32 s32, 200000
    s_waitcnt vmcnt(0)
    s_cbranch_scc1 L_fast_step
    s_branch L_fast_fresh
L_fast_safe:
    s_nop 11
    s_waitcnt vmcnt(0) lgkmcnt(0)
    s_barrier
    ds_read_b128 v[72:75], v6 offset:0
    ds_read_b128 v[88:91], v6 offset:2304
    ds_read_b128 v[76:79], v6 offset:64
    ds_read_b128 v[92:95], v6 offset:2368
    ds_read_b128 v[80:83], v6 offset:128
    ds_read_b128 v[96:99], v6 offset:2432
    ds_read_b128 v[84:87], v6 offset:192
    ds_read_b128 v[100:103], v6 offset:2496
    s_xor_b32 s36, s25, 0x1000
    s_add_u32 s36, s36, s23
    buffer_load_dwordx4 v[16:19], v3, s[8:11], s29 offen offset:0 sc1
    buffer_load_dwordx4 v[32:35], v3, s[8:11], s36 offen offset:0 sc1
    buffer_load_dwordx4 v[20:23], v3, s[8:11], s29 offen offset:1024 sc1
    buffer_load_dwordx4 v[36:39], v3, s[8:11], s36 offen offset:1024 sc1
    buffer_load_dwordx4 v[24:27], v3, s[8:11], s29 offen offset:2048 sc1
    buffer_load_dwordx4 v[40:43], v3, s[8:11], s36 offen offset:2048 sc1
    buffer_load_dwordx4 v[28:31], v3, s[8:11], s29 offen offset:3072 sc1
    buffer_load_dwordx4 v[44:47], v3, s[8:11], s36 offen offset:3072 sc1
    s_waitcnt vmcnt(0) lgkmcnt(0)
    v_mfma_f32_16x16x32_bf16 v[48:51], v[16:19], v[72:75], 0
    v_mfma_f32_16x16x32_bf16 v[48:51], v[20:23], v[76:79], v[48:51]
    v_mfma_f32_16x16x32_bf16 v[48:51], v[24:27], v[80:83], v[48:51]
    v_mfma_f32_16x16x32_bf16 v[48:51], v[28:31], v[84:87], v[48:51]
    v_mfma_f32_16x16x32_bf16 v[52:55], v[32:35], v[72:75], 0
    v_mfma_f32_16x16x32_bf16 v[52:55], v[36:39], v[76:79], v[52:55]
    v_mfma_f32_16x16x32_bf16 v[52:55], v[40:43], v[80:83], v[52:55]
    v_mfma_f32_16x16x32_bf16 v[52:55], v[44:47], v[84:87], v[52:55]
    v_mfma_f32_16x16x32_bf16 v[56:59], v[88:91], v[72:75], 0
    v_mfma_f32_16x16x32_bf16 v[56:59], v[92:95], v[76:79], v[56:59]
    v_mfma_f32_16x16x32_bf16 v[56:59], v[96:99], v[80:83], v[56:59]
    v_mfma_f32_16x16x32_bf16 v[56:59], v[100:103], v[84:87], v[56:59]
    s_nop 7
    v_mul_f32 v56, s33, v56
    v_mul_f32 v57, s33, v57
    v_max3_f32 v16, v48, v49, v50
    v_max3_f32 v16, v16, v51, v52
    v_max3_f32 v16, v16, v53, v54
    v_max3_f32 v16, v16, v55, v56
    v_max_f32 v16, v16, v57
    v_mov_b32 v17, v16
    s_nop 1
    v_permlane16_swap_b32 v16, v17
    v_max_f32 v16, v16, v17
    v_mov_b32 v17, v16
    s_nop 1
    v_permlane32_swap_b32 v16, v17
    v_max_f32 v16, v16, v17
    v_sub_f32 v48, v48, v16
    v_exp_f32 v48, v48
    v_sub_f32 v49, v49, v16
    v_exp_f32 v49, v49
    v_sub_f32 v50, v50, v16
    v_exp_f32 v50, v50
    v_sub_f32 v51, v51, v16
    v_exp_f32 v51, v51
    v_sub_f32 v52, v52, v16
    v_exp_f32 v52, v52
    v_sub_f32 v53, v53, v16
    v_exp_f32 v53, v53
    v_sub_f32 v54, v54, v16
    v_exp_f32 v54, v54
    v_sub_f32 v55, v55, v16
    v_exp_f32 v55, v55
    v_sub_f32 v56, v56, v16
    v_exp_f32 v56, v56
    v_sub_f32 v57, v57, v16
    v_exp_f32 v57, v57
    v_cvt_pk_bf16_f32 v108, v48, v49
    v_cvt_pk_bf16_f32 v109, v50, v51
    v_cvt_pk_bf16_f32 v110, v52, v53
    v_cvt_pk_bf16_f32 v111, v54, v55
    v_cvt_pk_bf16_f32 v112, v56, v57
    s_nop 0
    v_mfma_f32_16x16x32_bf16 v[48:51], v[104:107], v[108:111], 0
    v_mfma_f32_16x16x32_bf16 v[56:59], v[120:123], v[108:111], 0
    v_mfma_f32_16x16x32_bf16 v[60:63], v[124:127], v[108:111], 0
    s_nop 3
    v_mfma_f32_16x16x16_bf16 v[48:51], v[104:105], v[112:113], v[48:51]
    v_mfma_f32_16x16x16_bf16 v[56:59], v[114:115], v[112:113], v[56:59]
    v_mfma_f32_16x16x16_bf16 v[60:63], v[116:117], v[112:113], v[60:63]
    s_nop 5
    v_rcp_f32 v118, v48
    s_nop 0
    v_mul_f32 v56, v56, v118
    v_mul_f32 v57, v57, v118
    v_mul_f32 v58, v58, v118
    v_mul_f32 v59, v59, v118
    v_mul_f32 v60, v60, v118
    v_mul_f32 v61, v61, v118
    v_mul_f32 v62, v62, v118
    v_mul_f32 v63, v63, v118
    v_cvt_pk_bf16_f32 v52, v56, v60
    v_cvt_pk_bf16_f32 v53, v57, v61
    v_cvt_pk_bf16_f32 v54, v58, v62
    v_cvt_pk_bf16_f32 v55, v59, v63
    v_mov_b32 v16, 0
    v_mov_b32 v17, 0
    v_mov_b32 v18, 0
    v_mov_b32 v19, 0
    v_mov_b32 v20, 0
    v_mov_b32 v21, 0
    v_mov_b32 v22, 0
    v_mov_b32 v23, 0
    v_mov_b32 v24, 0
    v_mov_b32 v25, 0
    v_mov_b32 v26, 0
    v_mov_b32 v27, 0
    v_mov_b32 v28, 0
    v_mov_b32 v29, 0
    v_mov_b32 v30, 0
    v_mov_b32 v31, 0
    v_xor_b32 v32, 0x800, v2
    v_xor_b32 v40, 0x1800, v2
    s_mov_b64 vcc, 0
    s_branch L_fast_rejoin
L_fast_done:
    s_branch L_end
L_slow_start:
    s_mov_b32 s22, 0
    s_mov_b32 s23, 0x1000000
    s_mov_b32 s27, 0
    s_mov_b32 s31, 0x80000
    s_mov_b32 s61, 0x40000000
    s_mov_b32 s91, 0
    ds_read_b128 v[104:107], v4 offset:0
    ds_read_b128 v[108:111], v4 offset:1024
    ds_read_b128 v[112:115], v4 offset:2048
    ds_read_b128 v[116:119], v4 offset:3072
    ds_read_b128 v[88:91], v4 offset:4096
    ds_read_b128 v[92:95], v4 offset:5120
    ds_read_b128 v[96:99], v4 offset:6144
    ds_read_b128 v[100:103], v4 offset:7168
    ds_read_b128 v[72:75], v4 offset:8192
    ds_read_b128 v[76:79], v4 offset:9216
    ds_read_b128 v[80:83], v4 offset:10240
    ds_read_b128 v[84:87], v4 offset:11264
    v_mov_b64 v[48:49], 0
    v_mov_b64 v[50:51], 0
    v_mov_b64 v[52:53], 0
    v_mov_b64 v[54:55], 0
    v_mov_b64 v[56:57], 0
    v_mov_b64 v[58:59], 0
    v_mov_b64 v[60:61], 0
    v_mov_b64 v[62:63], 0
    v_mov_b64 v[64:65], 0
    v_mov_b64 v[66:67], 0
    v_mov_b64 v[68:69], 0
    v_mov_b64 v[70:71], 0
    s_add_u32 s7, s23, 0x80000
    buffer_load_dwordx4 v[16:19], v2, s[8:11], s7 offen sc1
    buffer_load_dwordx4 v[20:23], v2, s[8:11], s7 offen offset:1024 sc1
    s_waitcnt vmcnt(2)
L_slow_step:
    v_readlane_b32 s36, v15, 33
    s_add_u32 s24, s23, 0x82100
    s_cmp_eq_u32 s36, 0
    s_cbranch_scc1 L_slow_refresh
L_slow_fresh:
    s_add_u32 s29, s23, s25
    s_add_u32 s30, s23, s39
    s_xor_b32 s28, s27, 1
    s_add_u32 s90, s22, 1
    s_nop 15
L_slow_retrym:
    buffer_load_dwordx4 v[16:19], v2, s[8:11], s7 offen sc1
    buffer_load_dwordx4 v[20:23], v2, s[8:11], s7 offen offset:1024 sc1
    s_add_u32 s32, s32, 1
    s_cmp_gt_u32 s32, 200000
    s_cselect_b32 s94, -1, -2
    v_xor_b32 v28, 0x800, v2
    v_xor_b32 v44, 0x1800, v2
    v_mov_b64 v[48:49], 0
    v_mov_b64 v[50:51], 0
    v_mov_b64 v[52:53], 0
    v_mov_b64 v[54:55], 0
L_slow_waitm:
    s_waitcnt vmcnt(3) lgkmcnt(0)
L_slow_gotm:
    v_max3_u32 v14, v16, v17, v18
    v_max_u32 v14, v14, v19
    v_smfmac_f32_16x16x64_bf16 v[48:51], v[16:19], v[104:111], v1
    s_waitcnt vmcnt(2)
    v_max3_u32 v14, v14, v20, v21
    v_smfmac_f32_16x16x64_bf16 v[52:55], v[16:19], v[112:119], v1
    v_max3_u32 v14, v14, v22, v23
    v_cmp_lt_u32 vcc, s94, v14
    v_smfmac_f32_16x16x64_bf16 v[48:51], v[20:23], v[88:95], v1
    ds_write_b128 v2, v[16:19] offset:0
    s_cbranch_vccnz L_slow_retrym
    v_smfmac_f32_16x16x64_bf16 v[52:55], v[20:23], v[96:103], v1
    ds_write_b128 v2, v[20:23] offset:1024
    v_smfmac_f32_16x16x64_bf16 v[56:59], v[16:19], v[72:79], v1
    buffer_load_dwordx4 v[104:107], v3, s[8:11], s29 offen offset:0 sc1
    buffer_load_dwordx4 v[120:123], v3, s[8:11], s30 offen offset:0 sc1
    v_smfmac_f32_16x16x64_bf16 v[60:63], v[16:19], v[80:87], v1
    buffer_load_dwordx4 v[108:111], v3, s[8:11], s29 offen offset:1024 sc1
    buffer_load_dwordx4 v[124:127], v3, s[8:11], s30 offen offset:1024 sc1
    v_smfmac_f32_16x16x64_bf16 v[56:59], v[20:23], a[80:87], v1
    buffer_load_dwordx4 v[112:115], v3, s[8:11], s29 offen offset:2048 sc1
    buffer_load_dwordx4 v[116:119], v3, s[8:11], s29 offen offset:3072 sc1
    v_smfmac_f32_16x16x64_bf16 v[60:63], v[20:23], a[88:95], v1
    s_waitcnt lgkmcnt(0)
    s_barrier
    ds_read_b128 v[24:27], v28 offset:0
    v_smfmac_f32_16x16x64_bf16 v[64:67], v[16:19], a[160:167], v1
    ds_read_b128 v[28:31], v28 offset:1024
    v_smfmac_f32_16x16x64_bf16 v[68:71], v[16:19], a[168:175], v1
    buffer_load_dword v15, v0, s[8:11], s24 offen sc1
    v_smfmac_f32_16x16x64_bf16 v[64:67], v[20:23], a[176:183], v1
    ds_read_b128 v[32:35], v8 offset:0
    v_smfmac_f32_16x16x64_bf16 v[68:71], v[20:23], a[184:191], v1
    ds_read_b128 v[36:39], v8 offset:1024
    s_waitcnt lgkmcnt(3)
    v_smfmac_f32_16x16x64_bf16 v[48:51], v[24:27], a[0:7], v1
    ds_read_b128 v[40:43], v44 offset:0
    v_smfmac_f32_16x16x64_bf16 v[52:55], v[24:27], a[8:15], v1
    ds_read_b128 v[44:47], v44 offset:1024
    s_waitcnt lgkmcnt(4)
    v_smfmac_f32_16x16x64_bf16 v[48:51], v[28:31], a[16:23], v1
    ds_read_b128 v[88:91], v4 offset:12288
    v_smfmac_f32_16x16x64_bf16 v[52:55], v[28:31], a[24:31], v1
    ds_read_b128 v[92:95], v4 offset:13312
    s_waitcnt lgkmcnt(4)
    v_smfmac_f32_16x16x64_bf16 v[48:51], v[32:35], a[32:39], v1
    ds_read_b128 v[96:99], v4 offset:14336
    v_smfmac_f32_16x16x64_bf16 v[52:55], v[32:35], a[40:47], v1
    ds_read_b128 v[100:103], v4 offset:15360
    s_waitcnt lgkmcnt(4)
    v_smfmac_f32_16x16x64_bf16 v[48:51], v[36:39], a[48:55], v1
    v_smfmac_f32_16x16x64_bf16 v[52:55], v[36:39], a[56:63], v1
    ds_read_b128 v[72:75], v4 offset:16384
    v_smfmac_f32_16x16x64_bf16 v[48:51], v[40:43], a[64:71], v1
    v_smfmac_f32_16x16x64_bf16 v[52:55], v[40:43], a[72:79], v1
    ds_read_b128 v[76:79], v4 offset:17408
    s_waitcnt lgkmcnt(2)
    v_smfmac_f32_16x16x64_bf16 v[48:51], v[44:47], v[88:95], v1
    ds_read_b128 v[80:83], v4 offset:18432
    v_smfmac_f32_16x16x64_bf16 v[52:55], v[44:47], v[96:103], v1
    ds_read_b128 v[84:87], v4 offset:19456
    v_smfmac_f32_16x16x64_bf16 v[56:59], v[28:31], a[96:103], v1
    ds_read_b128 v[88:91], v4 offset:20480
    v_smfmac_f32_16x16x64_bf16 v[60:63], v[28:31], a[104:111], v1
    ds_read_b128 v[92:95], v4 offset:21504
    v_smfmac_f32_16x16x64_bf16 v[56:59], v[32:35], a[112:119], v1
    ds_read_b128 v[96:99], v4 offset:22528
    v_add_f32 v48, v48, v50
    v_add_f32 v49, v49, v51
    v_smfmac_f32_16x16x64_bf16 v[60:63], v[32:35], a[120:127], v1
    ds_read_b128 v[100:103], v4 offset:23552
    v_add_f32 v52, v52, v54
    v_add_f32 v53, v53, v55
    v_smfmac_f32_16x16x64_bf16 v[56:59], v[36:39], a[128:135], v1
    s_waitcnt lgkmcnt(4)
    v_cvt_pk_bf16_f32 v50, v48, v52
    v_cvt_pk_bf16_f32 v51, v49, v53
    v_smfmac_f32_16x16x64_bf16 v[56:59], v[24:27], v[72:79], v1
    ds_write2_b32 v5, v50, v51 offset0:0 offset1:72
    v_smfmac_f32_16x16x64_bf16 v[60:63], v[24:27], v[80:87], v1
    v_smfmac_f32_16x16x64_bf16 v[60:63], v[36:39], a[136:143], v1
    v_smfmac_f32_16x16x64_bf16 v[56:59], v[40:43], a[144:151], v1
    buffer_store_dword v12, v10, s[8:11], s31 offen sc1
    v_smfmac_f32_16x16x64_bf16 v[60:63], v[40:43], a[152:159], v1
    s_waitcnt lgkmcnt(0)
    s_barrier
    v_smfmac_f32_16x16x64_bf16 v[56:59], v[44:47], v[88:95], v1
    ds_read_b128 v[72:75], v6 offset:0
    v_smfmac_f32_16x16x64_bf16 v[60:63], v[44:47], v[96:103], v1
    ds_read_b128 v[76:79], v6 offset:64
    v_smfmac_f32_16x16x64_bf16 v[64:67], v[24:27], a[192:199], v1
    ds_read_b128 v[80:83], v6 offset:128
    v_smfmac_f32_16x16x64_bf16 v[68:71], v[24:27], a[200:207], v1
    ds_read_b128 v[84:87], v6 offset:192
    s_waitcnt vmcnt(2) lgkmcnt(3)
    v_mfma_f32_16x16x32_bf16 v[48:51], v[104:107], v[72:75], 0
    s_waitcnt lgkmcnt(2)
    v_add_f32 v56, v56, v58
    v_add_f32 v57, v57, v59
    v_mfma_f32_16x16x32_bf16 v[48:51], v[108:111], v[76:79], v[48:51]
    s_waitcnt lgkmcnt(1)
    v_add_f32 v60, v60, v62
    v_add_f32 v61, v61, v63
    v_mfma_f32_16x16x32_bf16 v[48:51], v[112:115], v[80:83], v[48:51]
    s_waitcnt lgkmcnt(0)
    v_cvt_pk_bf16_f32 v58, v56, v60
    v_cvt_pk_bf16_f32 v59, v57, v61
    v_mfma_f32_16x16x32_bf16 v[48:51], v[116:119], v[84:87], v[48:51]
    ds_write2_b32 v7, v58, v59 offset0:0 offset1:72
    v_smfmac_f32_16x16x64_bf16 v[64:67], v[28:31], a[208:215], v1
    v_mov_b64 v[104:105], s[4:5]
    v_smfmac_f32_16x16x64_bf16 v[68:71], v[28:31], a[216:223], v1
    s_nop 1
    v_mov_b64 v[106:107], s[4:5]
    v_smfmac_f32_16x16x64_bf16 v[64:67], v[32:35], a[224:231], v1
    v_exp_f32 v48, v48
    v_smfmac_f32_16x16x64_bf16 v[68:71], v[32:35], a[232:239], v1
    s_waitcnt lgkmcnt(0)
    s_barrier
    v_exp_f32 v49, v49
    v_smfmac_f32_16x16x64_bf16 v[64:67], v[36:39], a[240:247], v1
    ds_read_b128 v[88:91], v6 offset:2304
    v_exp_f32 v50, v50
    v_smfmac_f32_16x16x64_bf16 v[68:71], v[36:39], a[248:255], v1
    ds_read_b128 v[92:95], v6 offset:2368
    v_exp_f32 v51, v51
    v_smfmac_f32_16x16x64_bf16 v[64:67], v[40:43], v[128:135], v1
    ds_read_b128 v[96:99], v6 offset:2432
    v_cvt_pk_bf16_f32 v108, v48, v49
    v_cvt_pk_bf16_f32 v109, v50, v51
    v_smfmac_f32_16x16x64_bf16 v[68:71], v[40:43], v[136:143], v1
    ds_read_b128 v[100:103], v6 offset:2496
    ds_write_b64 v2, v[108:109] offset:8192
    s_waitcnt lgkmcnt(4)
    v_mfma_f32_16x16x32_bf16 v[52:55], v[88:91], v[72:75], 0
    s_waitcnt lgkmcnt(3)
    v_mov_b32 v113, 0
    v_mov_b32 v115, 0
    v_mfma_f32_16x16x32_bf16 v[52:55], v[92:95], v[76:79], v[52:55]
    s_waitcnt lgkmcnt(2)
    v_mov_b32 v117, 0
    v_mov_b64 v[16:17], 0
    v_mfma_f32_16x16x32_bf16 v[52:55], v[96:99], v[80:83], v[52:55]
    s_waitcnt lgkmcnt(1)
    v_mov_b64 v[18:19], 0
    v_mov_b64 v[20:21], 0
    v_mfma_f32_16x16x32_bf16 v[52:55], v[100:103], v[84:87], v[52:55]
    s_waitcnt lgkmcnt(0)
    s_barrier
    v_smfmac_f32_16x16x64_bf16 v[64:67], v[44:47], v[144:151], v1
    ds_read_b64 v[110:111], v8 offset:8192
    v_mov_b64 v[22:23], 0
    v_smfmac_f32_16x16x64_bf16 v[68:71], v[44:47], v[152:159], v1
    v_mov_b64 v[24:25], 0
    v_mov_b64 v[26:27], 0
    v_mul_f32 v52, s33, v52
    v_mul_f32 v53, s33, v53
    v_exp_f32 v52, v52
    s_waitcnt lgkmcnt(0)
    v_mfma_f32_16x16x32_bf16 v[48:51], v[104:107], v[108:111], 0
    v_exp_f32 v53, v53
    v_add_f32 v64, v64, v66
    v_mfma_f32_16x16x32_bf16 v[56:59], v[120:123], v[108:111], 0
    v_cvt_pk_bf16_f32 v112, v52, v53
    v_add_f32 v65, v65, v67
    v_mfma_f32_16x16x32_bf16 v[60:63], v[124:127], v[108:111], 0
    v_cvt_pk_bf16_f32 v114, v64, v65
    v_add_f32 v68, v68, v70
    v_mfma_f32_16x16x16_bf16 v[48:51], v[104:105], v[112:113], v[48:51]
    v_add_f32 v69, v69, v71
    v_cvt_pk_bf16_f32 v116, v68, v69
    v_mfma_f32_16x16x16_bf16 v[56:59], v[114:115], v[112:113], v[56:59]
    v_mov_b64 v[28:29], 0
    v_mov_b64 v[30:31], 0
    v_mfma_f32_16x16x16_bf16 v[60:63], v[116:117], v[112:113], v[60:63]
    v_xor_b32 v32, 0x800, v2
    v_xor_b32 v40, 0x1800, v2
    v_rcp_f32 v118, v48
    s_nop 0
    v_max_f32 v14, v118, v48
    v_cmp_nge_f32 vcc, s40, v14
    v_pk_mul_f32 v[56:57], v[56:57], v[118:119] op_sel_hi:[1,0]
    v_pk_mul_f32 v[58:59], v[58:59], v[118:119] op_sel_hi:[1,0]
    v_pk_mul_f32 v[60:61], v[60:61], v[118:119] op_sel_hi:[1,0]
    v_pk_mul_f32 v[62:63], v[62:63], v[118:119] op_sel_hi:[1,0]
    v_cvt_pk_bf16_f32 v52, v56, v60
    v_cvt_pk_bf16_f32 v53, v57, v61
    v_cvt_pk_bf16_f32 v54, v58, v62
    v_cvt_pk_bf16_f32 v55, v59, v63
L_slow_rejoin:
    ds_write_b128 v2, v[52:55] offset:9216
    s_nop 0
    v_smfmac_f32_16x16x64_bf16 v[16:19], v[52:55], v[160:167], v1
    v_smfmac_f32_16x16x64_bf16 v[20:23], v[52:55], v[168:175], v1
    v_smfmac_f32_16x16x64_bf16 v[24:27], v[52:55], v[176:183], v1
    s_waitcnt lgkmcnt(0)
    s_barrier
    ds_read_b128 v[32:35], v32 offset:9216
    ds_read_b128 v[36:39], v8 offset:9216
    v_smfmac_f32_16x16x64_bf16 v[28:31], v[52:55], v[184:191], v1
    ds_read_b128 v[40:43], v40 offset:9216
    ds_read_b128 v[88:91], v4 offset:24576
    ds_read_b128 v[92:95], v4 offset:25600
    s_waitcnt lgkmcnt(4)
    v_smfmac_f32_16x16x64_bf16 v[16:19], v[32:35], v[192:199], v1
    ds_read_b128 v[96:99], v4 offset:26624
    s_waitcnt lgkmcnt(4)
    v_smfmac_f32_16x16x64_bf16 v[16:19], v[36:39], v[216:223], v1
    ds_read_b128 v[100:103], v4 offset:27648
    s_waitcnt lgkmcnt(4)
    v_smfmac_f32_16x16x64_bf16 v[16:19], v[40:43], v[240:247], v1
    ds_read_b128 v[72:75], v4 offset:28672
    s_cmp_lg_u64 vcc, 0
    v_smfmac_f32_16x16x64_bf16 v[20:23], v[32:35], v[200:207], v1
    ds_read_b128 v[76:79], v4 offset:29696
    s_cselect_b32 s60, s28, s27
    v_smfmac_f32_16x16x64_bf16 v[20:23], v[36:39], v[224:231], v1
    ds_read_b128 v[80:83], v4 offset:30720
    s_nop 0
    v_cvt_pk_bf16_f32 v56, v16, v18
    v_smfmac_f32_16x16x64_bf16 v[20:23], v[40:43], v[248:255], v1
    ds_read_b128 v[84:87], v4 offset:31744
    v_cvt_pk_bf16_f32 v57, v17, v19
    v_and_or_b32 v56, v56, -2, s60
    v_smfmac_f32_16x16x64_bf16 v[24:27], v[32:35], v[208:215], v1
    buffer_store_dwordx2 v[56:57], v9, s[8:11], 0 offen offset:0 sc1
    v_smfmac_f32_16x16x64_bf16 v[24:27], v[36:39], v[232:239], v1
    s_waitcnt lgkmcnt(4)
    s_nop 0
    v_cvt_pk_bf16_f32 v58, v20, v22
    v_smfmac_f32_16x16x64_bf16 v[24:27], v[40:43], v[88:95], v1
    ds_read_b128 v[64:67], v3 offset:23040
    v_cvt_pk_bf16_f32 v59, v21, v23
    v_and_or_b32 v58, v58, -2, s60
    v_smfmac_f32_16x16x64_bf16 v[28:31], v[32:35], v[96:103], v1
    buffer_store_dwordx2 v[58:59], v9, s[8:11], 0 offen offset:2048 sc1
    s_waitcnt lgkmcnt(1)
    v_smfmac_f32_16x16x64_bf16 v[28:31], v[36:39], v[72:79], v1
    s_nop 1
    v_cvt_pk_bf16_f32 v60, v24, v26
    v_smfmac_f32_16x16x64_bf16 v[28:31], v[40:43], v[80:87], v1
    v_cvt_pk_bf16_f32 v61, v25, v27
    v_and_or_b32 v60, v60, -2, s60
    buffer_store_dwordx2 v[60:61], v9, s[8:11], s26 offen offset:0 sc1
    s_nop 4
    v_cvt_pk_bf16_f32 v62, v28, v30
    v_cvt_pk_bf16_f32 v63, v29, v31
    v_and_or_b32 v62, v62, -2, s60
    buffer_store_dwordx2 v[62:63], v9, s[8:11], s26 offen offset:2048 sc1
L_slow_stored:
    s_cmp_lg_u32 s60, s27
    s_cbranch_scc1 L_slow_safe
    ds_read_b128 v[104:107], v4 offset:0
    ds_read_b128 v[108:111], v4 offset:1024
    ds_read_b128 v[112:115], v4 offset:2048
    ds_read_b128 v[116:119], v4 offset:3072
    ds_read_b128 v[88:91], v4 offset:4096
    ds_read_b128 v[92:95], v4 offset:5120
    ds_read_b128 v[96:99], v4 offset:6144
    ds_read_b128 v[100:103], v4 offset:7168
    ds_read_b128 v[72:75], v4 offset:8192
    ds_read_b128 v[76:79], v4 offset:9216
    ds_read_b128 v[80:83], v4 offset:10240
    ds_read_b128 v[84:87], v4 offset:11264
    s_cmp_lt_u32 s21, 1
    s_cbranch_scc1 L_slow_pollp
    s_nop 13
    s_cmp_lt_u32 s21, 2
    s_cbranch_scc1 L_slow_pollp
    s_nop 13
    s_cmp_lt_u32 s21, 3
    s_cbranch_scc1 L_slow_pollp
    s_nop 13
L_slow_pollp:
    buffer_load_dwordx4 v[120:123], v2, s[8:11], s6 offen sc1
    buffer_load_dwordx4 v[124:127], v2, s[8:11], s6 offen offset:1024 sc1
    v_mov_b64 v[56:57], 0
    v_mov_b64 v[58:59], 0
    v_mov_b64 v[60:61], 0
    v_mov_b64 v[62:63], 0
    s_nop 15
    s_nop 15
    buffer_load_dwordx4 v[32:35], v2, s[8:11], s6 offen sc1
    buffer_load_dwordx4 v[36:39], v2, s[8:11], s6 offen offset:1024 sc1
    s_add_u32 s7, s24, 0x80000
    s_waitcnt vmcnt(3) lgkmcnt(0)
    v_mfma_f32_16x16x32_bf16 v[68:71], v[64:67], v[120:123], 0
    v_bitop3_b32 v14, v120, v122, s27 bitop3:0x7e
    s_waitcnt vmcnt(2)
    v_mfma_f32_16x16x32_bf16 v[68:71], v[64:67], v[124:127], v[68:71]
    v_bitop3_b32 v11, v124, v126, s27 bitop3:0x7e
    v_bitop3_b32 v14, v14, v11, 1 bitop3:0xa8
    v_cmp_ne_u32 vcc, 0, v14
    s_nop 2
    s_cmp_eq_u64 vcc, 0
    s_cselect_b32 s36, s24, s61
    v_add_f32_dpp v68, v68, v68 row_ror:8 row_mask:0xf bank_mask:0xf
    v_add_f32_dpp v69, v69, v69 row_ror:8 row_mask:0xf bank_mask:0xf
    s_nop 0
    v_add_f32_dpp v68, v68, v68 row_ror:4 row_mask:0xf bank_mask:0xf
    v_add_f32_dpp v69, v69, v69 row_ror:4 row_mask:0xf bank_mask:0xf
    v_cvt_pk_bf16_f32 v12, v68, v69
    buffer_store_dword v12, v10, s[8:11], s36 offen sc1
    s_cbranch_scc1 L_slow_gotp
L_slow_retryp:
    buffer_load_dwordx4 v[120:123], v2, s[8:11], s6 offen sc1
    buffer_load_dwordx4 v[124:127], v2, s[8:11], s6 offen offset:1024 sc1
    s_waitcnt vmcnt(4) lgkmcnt(0)
    v_mfma_f32_16x16x32_bf16 v[68:71], v[64:67], v[32:35], 0
    v_bitop3_b32 v14, v32, v34, s27 bitop3:0x7e
    s_waitcnt vmcnt(3)
    v_mfma_f32_16x16x32_bf16 v[68:71], v[64:67], v[36:39], v[68:71]
    v_bitop3_b32 v11, v36, v38, s27 bitop3:0x7e
    v_bitop3_b32 v14, v14, v11, 1 bitop3:0xa8
    v_cmp_ne_u32 vcc, 0, v14
    s_nop 2
    s_cmp_eq_u64 vcc, 0
    s_cselect_b32 s36, s24, s61
    v_add_f32_dpp v68, v68, v68 row_ror:8 row_mask:0xf bank_mask:0xf
    v_add_f32_dpp v69, v69, v69 row_ror:8 row_mask:0xf bank_mask:0xf
    s_nop 0
    v_add_f32_dpp v68, v68, v68 row_ror:4 row_mask:0xf bank_mask:0xf
    v_add_f32_dpp v69, v69, v69 row_ror:4 row_mask:0xf bank_mask:0xf
    v_cvt_pk_bf16_f32 v12, v68, v69
    buffer_store_dword v12, v10, s[8:11], s36 offen sc1
    s_cbranch_scc1 L_slow_gotp
    buffer_load_dwordx4 v[32:35], v2, s[8:11], s6 offen sc1
    buffer_load_dwordx4 v[36:39], v2, s[8:11], s6 offen offset:1024 sc1
    s_waitcnt vmcnt(4) lgkmcnt(0)
    v_mfma_f32_16x16x32_bf16 v[68:71], v[64:67], v[120:123], 0
    v_bitop3_b32 v14, v120, v122, s27 bitop3:0x7e
    s_waitcnt vmcnt(3)
    v_mfma_f32_16x16x32_bf16 v[68:71], v[64:67], v[124:127], v[68:71]
    v_bitop3_b32 v11, v124, v126, s27 bitop3:0x7e
    v_bitop3_b32 v14, v14, v11, 1 bitop3:0xa8
    v_cmp_ne_u32 vcc, 0, v14
    s_nop 2
    s_cmp_eq_u64 vcc, 0
    s_cselect_b32 s36, s24, s61
    v_add_f32_dpp v68, v68, v68 row_ror:8 row_mask:0xf bank_mask:0xf
    v_add_f32_dpp v69, v69, v69 row_ror:8 row_mask:0xf bank_mask:0xf
    s_nop 0
    v_add_f32_dpp v68, v68, v68 row_ror:4 row_mask:0xf bank_mask:0xf
    v_add_f32_dpp v69, v69, v69 row_ror:4 row_mask:0xf bank_mask:0xf
    v_cvt_pk_bf16_f32 v12, v68, v69
    buffer_store_dword v12, v10, s[8:11], s36 offen sc1
    s_cbranch_scc1 L_slow_gotp
    s_add_u32 s32, s32, 1
    s_cmp_le_u32 s32, 200000
    s_cbranch_scc1 L_slow_retryp
    s_mov_b32 s36, s24
    buffer_store_dword v12, v10, s[8:11], s36 offen sc1
L_slow_gotp:
    s_add_u32 s31, s31, 0x2000
    s_cmp_ge_u32 s90, 63
    s_cbranch_scc1 L_slow_last
    s_mov_b32 s23, s24
    s_mov_b32 s22, s90
    s_mov_b32 s27, s28
    v_mov_b64 v[64:65], 0
    v_mov_b64 v[66:67], 0
    v_mov_b64 v[68:69], 0
    v_mov_b64 v[70:71], 0
    s_nop 15
    s_nop 11
    buffer_load_dwordx4 v[16:19], v2, s[8:11], s7 offen sc1
    buffer_load_dwordx4 v[20:23], v2, s[8:11], s7 offen offset:1024 sc1
    s_branch L_slow_step
L_slow_last:
    buffer_store_dword v12, v10, s[8:11], s31 offen sc1
    s_branch L_slow_done
L_slow_refresh:
    buffer_load_dword v15, v0, s[8:11], s23 offen sc1
    s_add_u32 s32, s32, 1
    s_cmp_le_u32 s32, 200000
    s_waitcnt vmcnt(0)
    s_cbranch_scc1 L_slow_step
    s_branch L_slow_fresh
L_slow_safe:
    s_nop 11
    s_waitcnt vmcnt(0) lgkmcnt(0)
    s_barrier
    ds_read_b128 v[72:75], v6 offset:0
    ds_read_b128 v[88:91], v6 offset:2304
    ds_read_b128 v[76:79], v6 offset:64
    ds_read_b128 v[92:95], v6 offset:2368
    ds_read_b128 v[80:83], v6 offset:128
    ds_read_b128 v[96:99], v6 offset:2432
    ds_read_b128 v[84:87], v6 offset:192
    ds_read_b128 v[100:103], v6 offset:2496
    s_xor_b32 s36, s25, 0x1000
    s_add_u32 s36, s36, s23
    buffer_load_dwordx4 v[16:19], v3, s[8:11], s29 offen offset:0 sc1
    buffer_load_dwordx4 v[32:35], v3, s[8:11], s36 offen offset:0 sc1
    buffer_load_dwordx4 v[20:23], v3, s[8:11], s29 offen offset:1024 sc1
    buffer_load_dwordx4 v[36:39], v3, s[8:11], s36 offen offset:1024 sc1
    buffer_load_dwordx4 v[24:27], v3, s[8:11], s29 offen offset:2048 sc1
    buffer_load_dwordx4 v[40:43], v3, s[8:11], s36 offen offset:2048 sc1
    buffer_load_dwordx4 v[28:31], v3, s[8:11], s29 offen offset:3072 sc1
    buffer_load_dwordx4 v[44:47], v3, s[8:11], s36 offen offset:3072 sc1
    s_waitcnt vmcnt(0) lgkmcnt(0)
    v_mfma_f32_16x16x32_bf16 v[48:51], v[16:19], v[72:75], 0
    v_mfma_f32_16x16x32_bf16 v[48:51], v[20:23], v[76:79], v[48:51]
    v_mfma_f32_16x16x32_bf16 v[48:51], v[24:27], v[80:83], v[48:51]
    v_mfma_f32_16x16x32_bf16 v[48:51], v[28:31], v[84:87], v[48:51]
    v_mfma_f32_16x16x32_bf16 v[52:55], v[32:35], v[72:75], 0
    v_mfma_f32_16x16x32_bf16 v[52:55], v[36:39], v[76:79], v[52:55]
    v_mfma_f32_16x16x32_bf16 v[52:55], v[40:43], v[80:83], v[52:55]
    v_mfma_f32_16x16x32_bf16 v[52:55], v[44:47], v[84:87], v[52:55]
    v_mfma_f32_16x16x32_bf16 v[56:59], v[88:91], v[72:75], 0
    v_mfma_f32_16x16x32_bf16 v[56:59], v[92:95], v[76:79], v[56:59]
    v_mfma_f32_16x16x32_bf16 v[56:59], v[96:99], v[80:83], v[56:59]
    v_mfma_f32_16x16x32_bf16 v[56:59], v[100:103], v[84:87], v[56:59]
    s_nop 7
    v_mul_f32 v56, s33, v56
    v_mul_f32 v57, s33, v57
    v_max3_f32 v16, v48, v49, v50
    v_max3_f32 v16, v16, v51, v52
    v_max3_f32 v16, v16, v53, v54
    v_max3_f32 v16, v16, v55, v56
    v_max_f32 v16, v16, v57
    v_mov_b32 v17, v16
    s_nop 1
    v_permlane16_swap_b32 v16, v17
    v_max_f32 v16, v16, v17
    v_mov_b32 v17, v16
    s_nop 1
    v_permlane32_swap_b32 v16, v17
    v_max_f32 v16, v16, v17
    v_sub_f32 v48, v48, v16
    v_exp_f32 v48, v48
    v_sub_f32 v49, v49, v16
    v_exp_f32 v49, v49
    v_sub_f32 v50, v50, v16
    v_exp_f32 v50, v50
    v_sub_f32 v51, v51, v16
    v_exp_f32 v51, v51
    v_sub_f32 v52, v52, v16
    v_exp_f32 v52, v52
    v_sub_f32 v53, v53, v16
    v_exp_f32 v53, v53
    v_sub_f32 v54, v54, v16
    v_exp_f32 v54, v54
    v_sub_f32 v55, v55, v16
    v_exp_f32 v55, v55
    v_sub_f32 v56, v56, v16
    v_exp_f32 v56, v56
    v_sub_f32 v57, v57, v16
    v_exp_f32 v57, v57
    v_cvt_pk_bf16_f32 v108, v48, v49
    v_cvt_pk_bf16_f32 v109, v50, v51
    v_cvt_pk_bf16_f32 v110, v52, v53
    v_cvt_pk_bf16_f32 v111, v54, v55
    v_cvt_pk_bf16_f32 v112, v56, v57
    s_nop 0
    v_mfma_f32_16x16x32_bf16 v[48:51], v[104:107], v[108:111], 0
    v_mfma_f32_16x16x32_bf16 v[56:59], v[120:123], v[108:111], 0
    v_mfma_f32_16x16x32_bf16 v[60:63], v[124:127], v[108:111], 0
    s_nop 3
    v_mfma_f32_16x16x16_bf16 v[48:51], v[104:105], v[112:113], v[48:51]
    v_mfma_f32_16x16x16_bf16 v[56:59], v[114:115], v[112:113], v[56:59]
    v_mfma_f32_16x16x16_bf16 v[60:63], v[116:117], v[112:113], v[60:63]
    s_nop 5
    v_rcp_f32 v118, v48
    s_nop 0
    v_mul_f32 v56, v56, v118
    v_mul_f32 v57, v57, v118
    v_mul_f32 v58, v58, v118
    v_mul_f32 v59, v59, v118
    v_mul_f32 v60, v60, v118
    v_mul_f32 v61, v61, v118
    v_mul_f32 v62, v62, v118
    v_mul_f32 v63, v63, v118
    v_cvt_pk_bf16_f32 v52, v56, v60
    v_cvt_pk_bf16_f32 v53, v57, v61
    v_cvt_pk_bf16_f32 v54, v58, v62
    v_cvt_pk_bf16_f32 v55, v59, v63
    v_mov_b32 v16, 0
    v_mov_b32 v17, 0
    v_mov_b32 v18, 0
    v_mov_b32 v19, 0
    v_mov_b32 v20, 0
    v_mov_b32 v21, 0
    v_mov_b32 v22, 0
    v_mov_b32 v23, 0
    v_mov_b32 v24, 0
    v_mov_b32 v25, 0
    v_mov_b32 v26, 0
    v_mov_b32 v27, 0
    v_mov_b32 v28, 0
    v_mov_b32 v29, 0
    v_mov_b32 v30, 0
    v_mov_b32 v31, 0
    v_xor_b32 v32, 0x800, v2
    v_xor_b32 v40, 0x1800, v2
    s_mov_b64 vcc, 0
    s_branch L_slow_rejoin
L_slow_done:
    s_branch L_end
L_worker:
    s_cmp_eq_u32 s3, 7
    s_cbranch_scc1 L_mlp
    s_and_b32 s36, s2, 7
    s_sub_u32 s36, s36, 1
    s_lshl_b32 s36, s36, 5
    s_lshr_b32 s37, s2, 3
    s_add_u32 s36, s36, s37
    s_mul_i32 s20, s36, 10923
    s_lshr_b32 s20, s20, 16
    s_mul_i32 s37, s20, 6
    s_sub_u32 s22, s36, s37
    v_lshrrev_b32 v28, 6, v0
    v_bfe_u32 v29, v0, 4, 2
    v_lshl_add_u32 v28, v28, 5, v29
    v_and_b32 v16, 15, v0
    v_lshlrev_b32 v16, 4, v16
    v_lshl_add_u32 v16, v28, 13, v16
    v_bfe_u32 v29, v0, 4, 2
    v_lshlrev_b32 v29, 5, v29
    v_xor_b32 v16, v16, v29
    v_xor_b32 v17, 0, v16
    v_xor_b32 v18, 128, v16
    v_xor_b32 v19, 128, v16
    s_add_u32 s28, s21, 1
    s_lshl_b32 s28, s28, 15
    s_lshl_b32 s3, s20, 8
    s_mov_b32 s76, s52
    s_and_b32 s77, s53, 0xffff
    s_mov_b32 s78, 0x400000
    s_mov_b32 s79, 0x20000
    s_add_u32 m0, s28, 0
    s_add_u32 s37, s3, 0x0
    buffer_load_dwordx4 v16, s[76:79], s37 offen lds
    s_add_u32 m0, s28, 1024
    s_add_u32 s37, s3, 0x8000
    buffer_load_dwordx4 v17, s[76:79], s37 offen lds
    s_add_u32 m0, s28, 2048
    s_add_u32 s37, s3, 0x10000
    buffer_load_dwordx4 v18, s[76:79], s37 offen lds
    s_add_u32 m0, s28, 3072
    s_add_u32 s37, s3, 0x18000
    buffer_load_dwordx4 v19, s[76:79], s37 offen lds
    s_add_u32 m0, s28, 4096
    s_add_u32 s37, s3, 0x20000
    buffer_load_dwordx4 v16, s[76:79], s37 offen lds
    s_add_u32 m0, s28, 5120
    s_add_u32 s37, s3, 0x28000
    buffer_load_dwordx4 v17, s[76:79], s37 offen lds
    s_add_u32 m0, s28, 6144
    s_add_u32 s37, s3, 0x30000
    buffer_load_dwordx4 v18, s[76:79], s37 offen lds
    s_add_u32 m0, s28, 7168
    s_add_u32 s37, s3, 0x38000
    buffer_load_dwordx4 v19, s[76:79], s37 offen lds
    s_add_u32 m0, s28, 8192
    s_add_u32 s37, s3, 0x100000
    buffer_load_dwordx4 v16, s[76:79], s37 offen lds
    s_add_u32 m0, s28, 9216
    s_add_u32 s37, s3, 0x108000
    buffer_load_dwordx4 v17, s[76:79], s37 offen lds
    s_add_u32 m0, s28, 10240
    s_add_u32 s37, s3, 0x110000
    buffer_load_dwordx4 v18, s[76:79], s37 offen lds
    s_add_u32 m0, s28, 11264
    s_add_u32 s37, s3, 0x118000
    buffer_load_dwordx4 v19, s[76:79], s37 offen lds
    s_add_u32 m0, s28, 12288
    s_add_u32 s37, s3, 0x120000
    buffer_load_dwordx4 v16, s[76:79], s37 offen lds
    s_add_u32 m0, s28, 13312
    s_add_u32 s37, s3, 0x128000
    buffer_load_dwordx4 v17, s[76:79], s37 offen lds
    s_add_u32 m0, s28, 14336
    s_add_u32 s37, s3, 0x130000
    buffer_load_dwordx4 v18, s[76:79], s37 offen lds
    s_add_u32 m0, s28, 15360
    s_add_u32 s37, s3, 0x138000
    buffer_load_dwordx4 v19, s[76:79], s37 offen lds
    s_add_u32 m0, s28, 16384
    s_add_u32 s37, s3, 0x200000
    buffer_load_dwordx4 v16, s[76:79], s37 offen lds
    s_add_u32 m0, s28, 17408
    s_add_u32 s37, s3, 0x208000
    buffer_load_dwordx4 v17, s[76:79], s37 offen lds
    s_add_u32 m0, s28, 18432
    s_add_u32 s37, s3, 0x210000
    buffer_load_dwordx4 v18, s[76:79], s37 offen lds
    s_add_u32 m0, s28, 19456
    s_add_u32 s37, s3, 0x218000
    buffer_load_dwordx4 v19, s[76:79], s37 offen lds
    s_add_u32 m0, s28, 20480
    s_add_u32 s37, s3, 0x220000
    buffer_load_dwordx4 v16, s[76:79], s37 offen lds
    s_add_u32 m0, s28, 21504
    s_add_u32 s37, s3, 0x228000
    buffer_load_dwordx4 v17, s[76:79], s37 offen lds
    s_add_u32 m0, s28, 22528
    s_add_u32 s37, s3, 0x230000
    buffer_load_dwordx4 v18, s[76:79], s37 offen lds
    s_add_u32 m0, s28, 23552
    s_add_u32 s37, s3, 0x238000
    buffer_load_dwordx4 v19, s[76:79], s37 offen lds
    s_add_u32 m0, s28, 24576
    s_add_u32 s37, s3, 0x300000
    buffer_load_dwordx4 v16, s[76:79], s37 offen lds
    s_add_u32 m0, s28, 25600
    s_add_u32 s37, s3, 0x308000
    buffer_load_dwordx4 v17, s[76:79], s37 offen lds
    s_add_u32 m0, s28, 26624
    s_add_u32 s37, s3, 0x310000
    buffer_load_dwordx4 v18, s[76:79], s37 offen lds
    s_add_u32 m0, s28, 27648
    s_add_u32 s37, s3, 0x318000
    buffer_load_dwordx4 v19, s[76:79], s37 offen lds
    s_add_u32 m0, s28, 28672
    s_add_u32 s37, s3, 0x320000
    buffer_load_dwordx4 v16, s[76:79], s37 offen lds
    s_add_u32 m0, s28, 29696
    s_add_u32 s37, s3, 0x328000
    buffer_load_dwordx4 v17, s[76:79], s37 offen lds
    s_add_u32 m0, s28, 30720
    s_add_u32 s37, s3, 0x330000
    buffer_load_dwordx4 v18, s[76:79], s37 offen lds
    s_add_u32 m0, s28, 31744
    s_add_u32 s37, s3, 0x338000
    buffer_load_dwordx4 v19, s[76:79], s37 offen lds
    v_mov_b32 v20, 0x0
    v_bfe_u32 v14, v0, 0, 1
    s_mov_b32 s38, 0x8
    v_mad_u32_u24 v20, v14, s38, v20
    v_bfe_u32 v14, v0, 1, 1
    s_mov_b32 s38, 0x10
    v_mad_u32_u24 v20, v14, s38, v20
    v_bfe_u32 v14, v0, 2, 1
    s_mov_b32 s38, 0x100
    v_mad_u32_u24 v20, v14, s38, v20
    v_bfe_u32 v14, v0, 3, 1
    s_mov_b32 s38, 0x200
    v_mad_u32_u24 v20, v14, s38, v20
    v_bfe_u32 v14, v0, 4, 1
    s_mov_b32 s38, 0x800
    v_mad_u32_u24 v20, v14, s38, v20
    v_bfe_u32 v14, v0, 5, 1
    s_mov_b32 s38, 0x1000
    v_mad_u32_u24 v20, v14, s38, v20
    v_mov_b32 v28, 0x0
    v_bfe_u32 v14, v0, 2, 1
    s_mov_b32 s38, 0x20
    v_mad_u32_u24 v28, v14, s38, v28
    v_bfe_u32 v14, v0, 3, 1
    s_mov_b32 s38, 0x40
    v_mad_u32_u24 v28, v14, s38, v28
    v_bfe_u32 v14, v0, 4, 1
    s_mov_b32 s38, 0x80
    v_mad_u32_u24 v28, v14, s38, v28
    v_mov_b32 v29, 0x0
    v_bfe_u32 v14, v0, 6, 1
    s_mov_b32 s38, 0x40
    v_mad_u32_u24 v29, v14, s38, v29
    v_bfe_u32 v14, v0, 7, 1
    s_mov_b32 s38, 0x80
    v_mad_u32_u24 v29, v14, s38, v29
    v_xor_b32 v28, v28, v29
    v_add_u32 v28, v28, v20
    v_add_u32 v20, 0x8000, v28
    v_xor_b32 v21, 32, v20
    v_add_u32 v22, 0x10000, v28
    v_xor_b32 v23, 32, v22
    v_add_u32 v24, 0x18000, v28
    v_xor_b32 v25, 32, v24
    v_add_u32 v26, 0x20000, v28
    v_xor_b32 v27, 32, v26
    s_mov_b32 s12, s54
    s_and_b32 s13, s55, 0xffff
    s_mov_b32 s14, 0x400000
    s_mov_b32 s15, 0x20000
    s_lshl_b32 s24, s20, 17
    s_and_b32 s25, s22, 3
    s_lshl_b32 s25, s25, 15
    s_add_u32 s24, s24, s25
    v_lshlrev_b32 v30, 7, v0
    buffer_load_dword v31, v30, s[12:15], s24 offen
    s_mov_b32 s12, s44
    s_and_b32 s13, s45, 0xffff
    s_mov_b32 s14, 0x200000
    s_mov_b32 s15, 0x20000
    s_mov_b32 s60, s82
    s_and_b32 s61, s83, 0xffff
    s_mov_b32 s62, 0x200000
    s_mov_b32 s63, 0x20000
    s_mov_b32 s92, s80
    s_and_b32 s93, s81, 0xffff
    s_mov_b32 s94, 0x400
    s_mov_b32 s95, 0x20000
    v_mov_b32 v1, 0x0
    v_bfe_u32 v14, v0, 0, 1
    s_mov_b32 s38, 0x10
    v_mad_u32_u24 v1, v14, s38, v1
    v_bfe_u32 v14, v0, 1, 1
    s_mov_b32 s38, 0x20
    v_mad_u32_u24 v1, v14, s38, v1
    v_bfe_u32 v14, v0, 2, 1
    s_mov_b32 s38, 0x40
    v_mad_u32_u24 v1, v14, s38, v1
    v_bfe_u32 v14, v0, 3, 1
    s_mov_b32 s38, 0x80
    v_mad_u32_u24 v1, v14, s38, v1
    v_bfe_u32 v14, v0, 4, 1
    s_mov_b32 s38, 0x100
    v_mad_u32_u24 v1, v14, s38, v1
    v_bfe_u32 v14, v0, 5, 1
    s_mov_b32 s38, 0x200
    v_mad_u32_u24 v1, v14, s38, v1
    v_mov_b32 v2, 0x0
    v_bfe_u32 v14, v0, 0, 1
    s_mov_b32 s38, 0x10
    v_mad_u32_u24 v2, v14, s38, v2
    v_bfe_u32 v14, v0, 1, 1
    s_mov_b32 s38, 0x20
    v_mad_u32_u24 v2, v14, s38, v2
    v_bfe_u32 v14, v0, 2, 1
    s_mov_b32 s38, 0x40
    v_mad_u32_u24 v2, v14, s38, v2
    v_bfe_u32 v14, v0, 3, 1
    s_mov_b32 s38, 0x80
    v_mad_u32_u24 v2, v14, s38, v2
    v_bfe_u32 v14, v0, 4, 1
    s_mov_b32 s38, 0x100
    v_mad_u32_u24 v2, v14, s38, v2
    v_bfe_u32 v14, v0, 5, 1
    s_mov_b32 s38, 0x200
    v_mad_u32_u24 v2, v14, s38, v2
    v_bfe_u32 v14, v0, 6, 1
    s_mov_b32 s38, 0x800
    v_mad_u32_u24 v2, v14, s38, v2
    v_bfe_u32 v14, v0, 7, 1
    s_mov_b32 s38, 0x1000
    v_mad_u32_u24 v2, v14, s38, v2
    v_mov_b32 v9, 0x0
    v_bfe_u32 v14, v0, 0, 1
    s_mov_b32 s38, 0x10
    v_mad_u32_u24 v9, v14, s38, v9
    v_bfe_u32 v14, v0, 1, 1
    s_mov_b32 s38, 0x20
    v_mad_u32_u24 v9, v14, s38, v9
    v_bfe_u32 v14, v0, 2, 1
    s_mov_b32 s38, 0x40
    v_mad_u32_u24 v9, v14, s38, v9
    v_bfe_u32 v14, v0, 3, 1
    s_mov_b32 s38, 0x80
    v_mad_u32_u24 v9, v14, s38, v9
    v_bfe_u32 v14, v0, 4, 1
    s_mov_b32 s38, 0x100
    v_mad_u32_u24 v9, v14, s38, v9
    v_bfe_u32 v14, v0, 5, 1
    s_mov_b32 s38, 0x200
    v_mad_u32_u24 v9, v14, s38, v9
    v_bfe_u32 v14, v0, 6, 1
    s_mov_b32 s38, 0x400
    v_mad_u32_u24 v9, v14, s38, v9
    v_bfe_u32 v14, v0, 7, 1
    s_mov_b32 s38, 0x800
    v_mad_u32_u24 v9, v14, s38, v9
    v_mov_b32 v7, 0x8000
    v_bfe_u32 v14, v0, 0, 1
    s_mov_b32 s38, 0x10
    v_mad_u32_u24 v7, v14, s38, v7
    v_bfe_u32 v14, v0, 1, 1
    s_mov_b32 s38, 0x20
    v_mad_u32_u24 v7, v14, s38, v7
    v_bfe_u32 v14, v0, 2, 1
    s_mov_b32 s38, 0x40
    v_mad_u32_u24 v7, v14, s38, v7
    v_bfe_u32 v14, v0, 3, 1
    s_mov_b32 s38, 0x80
    v_mad_u32_u24 v7, v14, s38, v7
    v_bfe_u32 v14, v0, 4, 1
    s_mov_b32 s38, 0x100
    v_mad_u32_u24 v7, v14, s38, v7
    v_bfe_u32 v14, v0, 5, 1
    s_mov_b32 s38, 0x200
    v_mad_u32_u24 v7, v14, s38, v7
    v_bfe_u32 v14, v0, 6, 1
    s_mov_b32 s38, 0x8000
    v_mad_u32_u24 v7, v14, s38, v7
    v_bfe_u32 v14, v0, 7, 1
    s_mov_b32 s38, 0x10000
    v_mad_u32_u24 v7, v14, s38, v7
    v_mov_b32 v3, 0x0
    v_bfe_u32 v14, v0, 0, 1
    s_mov_b32 s38, 0x10
    v_mad_u32_u24 v3, v14, s38, v3
    v_bfe_u32 v14, v0, 1, 1
    s_mov_b32 s38, 0x20
    v_mad_u32_u24 v3, v14, s38, v3
    v_bfe_u32 v14, v0, 2, 1
    s_mov_b32 s38, 0x40
    v_mad_u32_u24 v3, v14, s38, v3
    v_bfe_u32 v14, v0, 3, 1
    s_mov_b32 s38, 0x400
    v_mad_u32_u24 v3, v14, s38, v3
    v_bfe_u32 v14, v0, 4, 1
    s_mov_b32 s38, 0x800
    v_mad_u32_u24 v3, v14, s38, v3
    v_bfe_u32 v14, v0, 5, 1
    s_mov_b32 s38, 0x1000
    v_mad_u32_u24 v3, v14, s38, v3
    v_bfe_u32 v14, v0, 6, 1
    s_mov_b32 s38, 0x2000
    v_mad_u32_u24 v3, v14, s38, v3
    v_bfe_u32 v14, v0, 7, 1
    s_mov_b32 s38, 0x4000
    v_mad_u32_u24 v3, v14, s38, v3
    v_mov_b32 v4, 0x0
    v_bfe_u32 v14, v0, 0, 1
    s_mov_b32 s38, 0x100
    v_mad_u32_u24 v4, v14, s38, v4
    v_bfe_u32 v14, v0, 1, 1
    s_mov_b32 s38, 0x200
    v_mad_u32_u24 v4, v14, s38, v4
    v_bfe_u32 v14, v0, 2, 1
    s_mov_b32 s38, 0x400
    v_mad_u32_u24 v4, v14, s38, v4
    v_bfe_u32 v14, v0, 6, 1
    s_mov_b32 s38, 0x80
    v_mad_u32_u24 v4, v14, s38, v4
    v_bfe_u32 v14, v0, 7, 1
    s_mov_b32 s38, 0x4000
    v_mad_u32_u24 v4, v14, s38, v4
    v_lshrrev_b32 v15, 3, v0
    v_xor_b32 v15, v15, v0
    v_and_b32 v15, 7, v15
    v_lshl_add_u32 v4, v15, 4, v4
    v_bfe_u32 v15, v0, 4, 2
    v_lshlrev_b32 v15, 4, v15
    v_xor_b32 v5, v15, v1
    v_xor_b32 v6, 64, v5
    v_mov_b32 v8, 0x5000
    v_bfe_u32 v14, v0, 0, 1
    s_mov_b32 s38, 0x10
    v_mad_u32_u24 v8, v14, s38, v8
    v_bfe_u32 v14, v0, 1, 1
    s_mov_b32 s38, 0x40
    v_mad_u32_u24 v8, v14, s38, v8
    v_bfe_u32 v14, v0, 2, 1
    s_mov_b32 s38, 0x80
    v_mad_u32_u24 v8, v14, s38, v8
    v_bfe_u32 v14, v0, 4, 1
    s_mov_b32 s38, 0x20
    v_mad_u32_u24 v8, v14, s38, v8
    v_bfe_u32 v14, v0, 5, 1
    s_mov_b32 s38, 0x100
    v_mad_u32_u24 v8, v14, s38, v8
    v_mov_b32 v10, 0x0
    v_bfe_u32 v14, v0, 0, 1
    s_mov_b32 s38, 0x10
    v_mad_u32_u24 v10, v14, s38, v10
    v_bfe_u32 v14, v0, 1, 1
    s_mov_b32 s38, 0x20
    v_mad_u32_u24 v10, v14, s38, v10
    v_bfe_u32 v14, v0, 2, 1
    s_mov_b32 s38, 0x40
    v_mad_u32_u24 v10, v14, s38, v10
    v_bfe_u32 v14, v0, 3, 1
    s_mov_b32 s38, 0x80
    v_mad_u32_u24 v10, v14, s38, v10
    v_bfe_u32 v14, v0, 4, 1
    s_mov_b32 s38, 0x20000
    v_mad_u32_u24 v10, v14, s38, v10
    v_bfe_u32 v14, v0, 5, 1
    s_mov_b32 s38, 0x40000
    v_mad_u32_u24 v10, v14, s38, v10
    v_bfe_u32 v14, v0, 6, 1
    s_mov_b32 s38, 0x100
    v_mad_u32_u24 v10, v14, s38, v10
    v_bfe_u32 v14, v0, 7, 1
    s_mov_b32 s38, 0x200
    v_mad_u32_u24 v10, v14, s38, v10
    v_mov_b32 v11, 0x0
    v_bfe_u32 v14, v0, 0, 1
    s_mov_b32 s38, 0x10
    v_mad_u32_u24 v11, v14, s38, v11
    v_bfe_u32 v14, v0, 1, 1
    s_mov_b32 s38, 0x20
    v_mad_u32_u24 v11, v14, s38, v11
    v_bfe_u32 v14, v0, 2, 1
    s_mov_b32 s38, 0x40
    v_mad_u32_u24 v11, v14, s38, v11
    v_bfe_u32 v14, v0, 3, 1
    s_mov_b32 s38, 0x80
    v_mad_u32_u24 v11, v14, s38, v11
    v_bfe_u32 v14, v0, 4, 1
    s_mov_b32 s38, 0x400
    v_mad_u32_u24 v11, v14, s38, v11
    v_bfe_u32 v14, v0, 5, 1
    s_mov_b32 s38, 0x800
    v_mad_u32_u24 v11, v14, s38, v11
    v_bfe_u32 v14, v0, 6, 1
    s_mov_b32 s38, 0x100
    v_mad_u32_u24 v11, v14, s38, v11
    v_bfe_u32 v14, v0, 7, 1
    s_mov_b32 s38, 0x200
    v_mad_u32_u24 v11, v14, s38, v11
    v_mov_b32 v12, 0x0
    v_bfe_u32 v14, v0, 0, 1
    s_mov_b32 s38, 0x10
    v_mad_u32_u24 v12, v14, s38, v12
    v_bfe_u32 v14, v0, 1, 1
    s_mov_b32 s38, 0x20
    v_mad_u32_u24 v12, v14, s38, v12
    v_bfe_u32 v14, v0, 2, 1
    s_mov_b32 s38, 0x40
    v_mad_u32_u24 v12, v14, s38, v12
    v_bfe_u32 v14, v0, 3, 1
    s_mov_b32 s38, 0x80
    v_mad_u32_u24 v12, v14, s38, v12
    v_bfe_u32 v14, v0, 4, 1
    s_mov_b32 s38, 0x4
    v_mad_u32_u24 v12, v14, s38, v12
    v_bfe_u32 v14, v0, 5, 1
    s_mov_b32 s38, 0x8
    v_mad_u32_u24 v12, v14, s38, v12
    v_bfe_u32 v14, v0, 6, 1
    s_mov_b32 s38, 0x100
    v_mad_u32_u24 v12, v14, s38, v12
    v_bfe_u32 v14, v0, 7, 1
    s_mov_b32 s38, 0x200
    v_mad_u32_u24 v12, v14, s38, v12
    v_mov_b32 v13, 0xf149f2ca
    v_and_b32 v14, 15, v0
    v_bfe_u32 v15, v0, 4, 2
    v_cmp_gt_u32 s[72:73], 2, v15
    v_lshlrev_b32 v15, 2, v15
    v_cmp_le_u32 s[64:65], v15, v14
    v_add_u32 v15, 1, v15
    v_cmp_le_u32 s[66:67], v15, v14
    v_add_u32 v15, 1, v15
    v_cmp_le_u32 s[68:69], v15, v14
    v_add_u32 v15, 1, v15
    v_cmp_le_u32 s[70:71], v15, v14
    v_add_u32 v15, 1, v15
    s_mov_b32 s34, 0x05040100
    s_mov_b32 s35, 0x07060302
    s_mov_b32 s33, 0x3e0293ee
    s_mov_b32 s32, 0
    s_mov_b32 s4, 0x3f803f80
    s_mov_b32 s5, 0x3f803f80
    s_mov_b32 s23, s22
    s_lshl_b32 s36, s23, 15
    buffer_load_dwordx4 v[96:99], v3, s[12:15], s36 offen offset:0
    buffer_load_dwordx4 v[100:103], v3, s[12:15], s36 offen offset:128
    buffer_load_dwordx4 v[104:107], v3, s[12:15], s36 offen offset:256
    buffer_load_dwordx4 v[108:111], v3, s[12:15], s36 offen offset:384
    buffer_load_dwordx4 v[112:115], v3, s[12:15], s36 offen offset:512
    buffer_load_dwordx4 v[116:119], v3, s[12:15], s36 offen offset:640
    buffer_load_dwordx4 v[120:123], v3, s[12:15], s36 offen offset:768
    buffer_load_dwordx4 v[124:127], v3, s[12:15], s36 offen offset:896
    s_waitcnt vmcnt(33)
    s_barrier
    ds_read_b64_tr_b16 v[128:129], v20 offset:0
    ds_read_b64_tr_b16 v[130:131], v20 offset:1024
    ds_read_b64_tr_b16 v[132:133], v21 offset:0
    ds_read_b64_tr_b16 v[134:135], v21 offset:1024
    ds_read_b64_tr_b16 v[136:137], v22 offset:0
    ds_read_b64_tr_b16 v[138:139], v22 offset:1024
    ds_read_b64_tr_b16 v[140:141], v23 offset:0
    ds_read_b64_tr_b16 v[142:143], v23 offset:1024
    ds_read_b64_tr_b16 v[144:145], v24 offset:0
    ds_read_b64_tr_b16 v[146:147], v24 offset:1024
    ds_read_b64_tr_b16 v[148:149], v25 offset:0
    ds_read_b64_tr_b16 v[150:151], v25 offset:1024
    s_waitcnt lgkmcnt(4)
    ds_read_b64_tr_b16 v[152:153], v26 offset:0
    ds_read_b64_tr_b16 v[154:155], v26 offset:1024
    ds_read_b64_tr_b16 v[156:157], v27 offset:0
    ds_read_b64_tr_b16 v[158:159], v27 offset:1024
    s_waitcnt lgkmcnt(0)
    s_barrier
    s_mov_b32 s40, s50
    s_and_b32 s41, s51, 0xffff
    s_mov_b32 s42, 0x400000
    s_mov_b32 s43, 0x20000
    s_add_u32 m0, s28, 0
    s_add_u32 s37, s3, 0x0
    buffer_load_dwordx4 v16, s[40:43], s37 offen lds
    s_add_u32 m0, s28, 1024
    s_add_u32 s37, s3, 0x8000
    buffer_load_dwordx4 v17, s[40:43], s37 offen lds
    s_add_u32 m0, s28, 2048
    s_add_u32 s37, s3, 0x10000
    buffer_load_dwordx4 v18, s[40:43], s37 offen lds
    s_add_u32 m0, s28, 3072
    s_add_u32 s37, s3, 0x18000
    buffer_load_dwordx4 v19, s[40:43], s37 offen lds
    s_add_u32 m0, s28, 4096
    s_add_u32 s37, s3, 0x20000
    buffer_load_dwordx4 v16, s[40:43], s37 offen lds
    s_add_u32 m0, s28, 5120
    s_add_u32 s37, s3, 0x28000
    buffer_load_dwordx4 v17, s[40:43], s37 offen lds
    s_add_u32 m0, s28, 6144
    s_add_u32 s37, s3, 0x30000
    buffer_load_dwordx4 v18, s[40:43], s37 offen lds
    s_add_u32 m0, s28, 7168
    s_add_u32 s37, s3, 0x38000
    buffer_load_dwordx4 v19, s[40:43], s37 offen lds
    s_waitcnt vmcnt(33)
    s_barrier
    ds_read_b64_tr_b16 v[160:161], v20 offset:8192
    ds_read_b64_tr_b16 v[162:163], v20 offset:9216
    ds_read_b64_tr_b16 v[164:165], v21 offset:8192
    ds_read_b64_tr_b16 v[166:167], v21 offset:9216
    ds_read_b64_tr_b16 v[168:169], v22 offset:8192
    ds_read_b64_tr_b16 v[170:171], v22 offset:9216
    ds_read_b64_tr_b16 v[172:173], v23 offset:8192
    ds_read_b64_tr_b16 v[174:175], v23 offset:9216
    ds_read_b64_tr_b16 v[176:177], v24 offset:8192
    ds_read_b64_tr_b16 v[178:179], v24 offset:9216
    ds_read_b64_tr_b16 v[180:181], v25 offset:8192
    ds_read_b64_tr_b16 v[182:183], v25 offset:9216
    s_waitcnt lgkmcnt(4)
    ds_read_b64_tr_b16 v[184:185], v26 offset:8192
    ds_read_b64_tr_b16 v[186:187], v26 offset:9216
    ds_read_b64_tr_b16 v[188:189], v27 offset:8192
    ds_read_b64_tr_b16 v[190:191], v27 offset:9216
    s_waitcnt lgkmcnt(0)
    s_barrier
    s_add_u32 m0, s28, 8192
    s_add_u32 s37, s3, 0x100000
    buffer_load_dwordx4 v16, s[40:43], s37 offen lds
    s_add_u32 m0, s28, 9216
    s_add_u32 s37, s3, 0x108000
    buffer_load_dwordx4 v17, s[40:43], s37 offen lds
    s_add_u32 m0, s28, 10240
    s_add_u32 s37, s3, 0x110000
    buffer_load_dwordx4 v18, s[40:43], s37 offen lds
    s_add_u32 m0, s28, 11264
    s_add_u32 s37, s3, 0x118000
    buffer_load_dwordx4 v19, s[40:43], s37 offen lds
    s_add_u32 m0, s28, 12288
    s_add_u32 s37, s3, 0x120000
    buffer_load_dwordx4 v16, s[40:43], s37 offen lds
    s_add_u32 m0, s28, 13312
    s_add_u32 s37, s3, 0x128000
    buffer_load_dwordx4 v17, s[40:43], s37 offen lds
    s_add_u32 m0, s28, 14336
    s_add_u32 s37, s3, 0x130000
    buffer_load_dwordx4 v18, s[40:43], s37 offen lds
    s_add_u32 m0, s28, 15360
    s_add_u32 s37, s3, 0x138000
    buffer_load_dwordx4 v19, s[40:43], s37 offen lds
    s_waitcnt vmcnt(33)
    s_barrier
    ds_read_b64_tr_b16 v[192:193], v20 offset:16384
    ds_read_b64_tr_b16 v[194:195], v20 offset:17408
    ds_read_b64_tr_b16 v[196:197], v21 offset:16384
    ds_read_b64_tr_b16 v[198:199], v21 offset:17408
    ds_read_b64_tr_b16 v[200:201], v22 offset:16384
    ds_read_b64_tr_b16 v[202:203], v22 offset:17408
    ds_read_b64_tr_b16 v[204:205], v23 offset:16384
    ds_read_b64_tr_b16 v[206:207], v23 offset:17408
    ds_read_b64_tr_b16 v[208:209], v24 offset:16384
    ds_read_b64_tr_b16 v[210:211], v24 offset:17408
    ds_read_b64_tr_b16 v[212:213], v25 offset:16384
    ds_read_b64_tr_b16 v[214:215], v25 offset:17408
    s_waitcnt lgkmcnt(4)
    ds_read_b64_tr_b16 v[216:217], v26 offset:16384
    ds_read_b64_tr_b16 v[218:219], v26 offset:17408
    ds_read_b64_tr_b16 v[220:221], v27 offset:16384
    ds_read_b64_tr_b16 v[222:223], v27 offset:17408
    s_waitcnt lgkmcnt(0)
    s_barrier
    s_add_u32 m0, s28, 16384
    s_add_u32 s37, s3, 0x200000
    buffer_load_dwordx4 v16, s[40:43], s37 offen lds
    s_add_u32 m0, s28, 17408
    s_add_u32 s37, s3, 0x208000
    buffer_load_dwordx4 v17, s[40:43], s37 offen lds
    s_add_u32 m0, s28, 18432
    s_add_u32 s37, s3, 0x210000
    buffer_load_dwordx4 v18, s[40:43], s37 offen lds
    s_add_u32 m0, s28, 19456
    s_add_u32 s37, s3, 0x218000
    buffer_load_dwordx4 v19, s[40:43], s37 offen lds
    s_add_u32 m0, s28, 20480
    s_add_u32 s37, s3, 0x220000
    buffer_load_dwordx4 v16, s[40:43], s37 offen lds
    s_add_u32 m0, s28, 21504
    s_add_u32 s37, s3, 0x228000
    buffer_load_dwordx4 v17, s[40:43], s37 offen lds
    s_add_u32 m0, s28, 22528
    s_add_u32 s37, s3, 0x230000
    buffer_load_dwordx4 v18, s[40:43], s37 offen lds
    s_add_u32 m0, s28, 23552
    s_add_u32 s37, s3, 0x238000
    buffer_load_dwordx4 v19, s[40:43], s37 offen lds
    s_waitcnt vmcnt(33)
    s_barrier
    ds_read_b64_tr_b16 v[224:225], v20 offset:24576
    ds_read_b64_tr_b16 v[226:227], v20 offset:25600
    ds_read_b64_tr_b16 v[228:229], v21 offset:24576
    ds_read_b64_tr_b16 v[230:231], v21 offset:25600
    ds_read_b64_tr_b16 v[232:233], v22 offset:24576
    ds_read_b64_tr_b16 v[234:235], v22 offset:25600
    ds_read_b64_tr_b16 v[236:237], v23 offset:24576
    ds_read_b64_tr_b16 v[238:239], v23 offset:25600
    ds_read_b64_tr_b16 v[240:241], v24 offset:24576
    ds_read_b64_tr_b16 v[242:243], v24 offset:25600
    ds_read_b64_tr_b16 v[244:245], v25 offset:24576
    ds_read_b64_tr_b16 v[246:247], v25 offset:25600
    s_waitcnt lgkmcnt(4)
    ds_read_b64_tr_b16 v[248:249], v26 offset:24576
    ds_read_b64_tr_b16 v[250:251], v26 offset:25600
    ds_read_b64_tr_b16 v[252:253], v27 offset:24576
    ds_read_b64_tr_b16 v[254:255], v27 offset:25600
    s_waitcnt lgkmcnt(0)
    s_barrier
    s_add_u32 m0, s28, 24576
    s_add_u32 s37, s3, 0x300000
    buffer_load_dwordx4 v16, s[40:43], s37 offen lds
    s_add_u32 m0, s28, 25600
    s_add_u32 s37, s3, 0x308000
    buffer_load_dwordx4 v17, s[40:43], s37 offen lds
    s_add_u32 m0, s28, 26624
    s_add_u32 s37, s3, 0x310000
    buffer_load_dwordx4 v18, s[40:43], s37 offen lds
    s_add_u32 m0, s28, 27648
    s_add_u32 s37, s3, 0x318000
    buffer_load_dwordx4 v19, s[40:43], s37 offen lds
    s_add_u32 m0, s28, 28672
    s_add_u32 s37, s3, 0x320000
    buffer_load_dwordx4 v16, s[40:43], s37 offen lds
    s_add_u32 m0, s28, 29696
    s_add_u32 s37, s3, 0x328000
    buffer_load_dwordx4 v17, s[40:43], s37 offen lds
    s_add_u32 m0, s28, 30720
    s_add_u32 s37, s3, 0x330000
    buffer_load_dwordx4 v18, s[40:43], s37 offen lds
    s_add_u32 m0, s28, 31744
    s_add_u32 s37, s3, 0x338000
    buffer_load_dwordx4 v19, s[40:43], s37 offen lds
    s_waitcnt vmcnt(32)
    v_mov_b32 v88, 0
    v_mov_b32 v89, 0
    v_dot2_f32_bf16 v88, v96, s4, v88
    v_dot2_f32_bf16 v89, v96, v96, v89
    v_dot2_f32_bf16 v88, v97, s4, v88
    v_dot2_f32_bf16 v89, v97, v97, v89
    v_dot2_f32_bf16 v88, v98, s4, v88
    v_dot2_f32_bf16 v89, v98, v98, v89
    v_dot2_f32_bf16 v88, v99, s4, v88
    v_dot2_f32_bf16 v89, v99, v99, v89
    v_dot2_f32_bf16 v88, v100, s4, v88
    v_dot2_f32_bf16 v89, v100, v100, v89
    v_dot2_f32_bf16 v88, v101, s4, v88
    v_dot2_f32_bf16 v89, v101, v101, v89
    v_dot2_f32_bf16 v88, v102, s4, v88
    v_dot2_f32_bf16 v89, v102, v102, v89
    v_dot2_f32_bf16 v88, v103, s4, v88
    v_dot2_f32_bf16 v89, v103, v103, v89
    v_dot2_f32_bf16 v88, v104, s4, v88
    v_dot2_f32_bf16 v89, v104, v104, v89
    v_dot2_f32_bf16 v88, v105, s4, v88
    v_dot2_f32_bf16 v89, v105, v105, v89
    v_dot2_f32_bf16 v88, v106, s4, v88
    v_dot2_f32_bf16 v89, v106, v106, v89
    v_dot2_f32_bf16 v88, v107, s4, v88
    v_dot2_f32_bf16 v89, v107, v107, v89
    v_dot2_f32_bf16 v88, v108, s4, v88
    v_dot2_f32_bf16 v89, v108, v108, v89
    v_dot2_f32_bf16 v88, v109, s4, v88
    v_dot2_f32_bf16 v89, v109, v109, v89
    v_dot2_f32_bf16 v88, v110, s4, v88
    v_dot2_f32_bf16 v89, v110, v110, v89
    v_dot2_f32_bf16 v88, v111, s4, v88
    v_dot2_f32_bf16 v89, v111, v111, v89
    v_dot2_f32_bf16 v88, v112, s4, v88
    v_dot2_f32_bf16 v89, v112, v112, v89
    v_dot2_f32_bf16 v88, v113, s4, v88
    v_dot2_f32_bf16 v89, v113, v113, v89
    v_dot2_f32_bf16 v88, v114, s4, v88
    v_dot2_f32_bf16 v89, v114, v114, v89
    v_dot2_f32_bf16 v88, v115, s4, v88
    v_dot2_f32_bf16 v89, v115, v115, v89
    v_dot2_f32_bf16 v88, v116, s4, v88
    v_dot2_f32_bf16 v89, v116, v116, v89
    v_dot2_f32_bf16 v88, v117, s4, v88
    v_dot2_f32_bf16 v89, v117, v117, v89
    v_dot2_f32_bf16 v88, v118, s4, v88
    v_dot2_f32_bf16 v89, v118, v118, v89
    v_dot2_f32_bf16 v88, v119, s4, v88
    v_dot2_f32_bf16 v89, v119, v119, v89
    v_dot2_f32_bf16 v88, v120, s4, v88
    v_dot2_f32_bf16 v89, v120, v120, v89
    v_dot2_f32_bf16 v88, v121, s4, v88
    v_dot2_f32_bf16 v89, v121, v121, v89
    v_dot2_f32_bf16 v88, v122, s4, v88
    v_dot2_f32_bf16 v89, v122, v122, v89
    v_dot2_f32_bf16 v88, v123, s4, v88
    v_dot2_f32_bf16 v89, v123, v123, v89
    v_dot2_f32_bf16 v88, v124, s4, v88
    v_dot2_f32_bf16 v89, v124, v124, v89
    v_dot2_f32_bf16 v88, v125, s4, v88
    v_dot2_f32_bf16 v89, v125, v125, v89
    v_dot2_f32_bf16 v88, v126, s4, v88
    v_dot2_f32_bf16 v89, v126, v126, v89
    v_dot2_f32_bf16 v88, v127, s4, v88
    v_dot2_f32_bf16 v89, v127, v127, v89
    s_nop 3
    v_add_f32_dpp v88, v88, v88 quad_perm:[1,0,3,2] row_mask:0xf bank_mask:0xf
    v_add_f32_dpp v89, v89, v89 quad_perm:[1,0,3,2] row_mask:0xf bank_mask:0xf
    s_nop 0
    v_add_f32_dpp v88, v88, v88 quad_perm:[2,3,0,1] row_mask:0xf bank_mask:0xf
    v_add_f32_dpp v89, v89, v89 quad_perm:[2,3,0,1] row_mask:0xf bank_mask:0xf
    s_nop 0
    v_add_f32_dpp v88, v88, v88 row_half_mirror row_mask:0xf bank_mask:0xf
    v_add_f32_dpp v89, v89, v89 row_half_mirror row_mask:0xf bank_mask:0xf
    v_mul_f32 v88, 0x3b000000, v88
    v_mul_f32 v89, 0x3b000000, v89
    v_fma_f32 v89, -v88, v88, v89
    v_max_f32 v89, 0, v89
    v_cvt_pk_bf16_f32 v14, v88, v89
    v_lshlrev_b32 v88, 16, v14
    v_and_b32 v89, 0xffff0000, v14
    v_add_f32 v89, 0x3727c5ac, v89
    v_cvt_pk_bf16_f32 v14, v89, v89
    v_lshlrev_b32 v89, 16, v14
    v_sqrt_f32 v89, v89
    s_nop 0
    v_cvt_pk_bf16_f32 v14, v89, v89
    v_lshlrev_b32 v89, 16, v14
    v_rcp_f32 v89, v89
    v_lshlrev_b32 v90, 16, v96
    v_and_b32 v91, 0xffff0000, v96
    v_sub_f32 v90, v90, v88
    v_sub_f32 v91, v91, v88
    v_cvt_pk_bf16_f32 v96, v90, v91
    v_lshlrev_b32 v90, 16, v96
    v_and_b32 v91, 0xffff0000, v96
    v_mul_f32 v90, v90, v89
    v_mul_f32 v91, v91, v89
    v_cvt_pk_bf16_f32 v96, v90, v91
    v_lshlrev_b32 v90, 16, v97
    v_and_b32 v91, 0xffff0000, v97
    v_sub_f32 v90, v90, v88
    v_sub_f32 v91, v91, v88
    v_cvt_pk_bf16_f32 v97, v90, v91
    v_lshlrev_b32 v90, 16, v97
    v_and_b32 v91, 0xffff0000, v97
    v_mul_f32 v90, v90, v89
    v_mul_f32 v91, v91, v89
    v_cvt_pk_bf16_f32 v97, v90, v91
    v_lshlrev_b32 v90, 16, v98
    v_and_b32 v91, 0xffff0000, v98
    v_sub_f32 v90, v90, v88
    v_sub_f32 v91, v91, v88
    v_cvt_pk_bf16_f32 v98, v90, v91
    v_lshlrev_b32 v90, 16, v98
    v_and_b32 v91, 0xffff0000, v98
    v_mul_f32 v90, v90, v89
    v_mul_f32 v91, v91, v89
    v_cvt_pk_bf16_f32 v98, v90, v91
    v_lshlrev_b32 v90, 16, v99
    v_and_b32 v91, 0xffff0000, v99
    v_sub_f32 v90, v90, v88
    v_sub_f32 v91, v91, v88
    v_cvt_pk_bf16_f32 v99, v90, v91
    v_lshlrev_b32 v90, 16, v99
    v_and_b32 v91, 0xffff0000, v99
    v_mul_f32 v90, v90, v89
    v_mul_f32 v91, v91, v89
    v_cvt_pk_bf16_f32 v99, v90, v91
    ds_write_b128 v4, v[96:99] offset:0
    v_lshlrev_b32 v90, 16, v100
    v_and_b32 v91, 0xffff0000, v100
    v_sub_f32 v90, v90, v88
    v_sub_f32 v91, v91, v88
    v_cvt_pk_bf16_f32 v100, v90, v91
    v_lshlrev_b32 v90, 16, v100
    v_and_b32 v91, 0xffff0000, v100
    v_mul_f32 v90, v90, v89
    v_mul_f32 v91, v91, v89
    v_cvt_pk_bf16_f32 v100, v90, v91
    v_lshlrev_b32 v90, 16, v101
    v_and_b32 v91, 0xffff0000, v101
    v_sub_f32 v90, v90, v88
    v_sub_f32 v91, v91, v88
    v_cvt_pk_bf16_f32 v101, v90, v91
    v_lshlrev_b32 v90, 16, v101
    v_and_b32 v91, 0xffff0000, v101
    v_mul_f32 v90, v90, v89
    v_mul_f32 v91, v91, v89
    v_cvt_pk_bf16_f32 v101, v90, v91
    v_lshlrev_b32 v90, 16, v102
    v_and_b32 v91, 0xffff0000, v102
    v_sub_f32 v90, v90, v88
    v_sub_f32 v91, v91, v88
    v_cvt_pk_bf16_f32 v102, v90, v91
    v_lshlrev_b32 v90, 16, v102
    v_and_b32 v91, 0xffff0000, v102
    v_mul_f32 v90, v90, v89
    v_mul_f32 v91, v91, v89
    v_cvt_pk_bf16_f32 v102, v90, v91
    v_lshlrev_b32 v90, 16, v103
    v_and_b32 v91, 0xffff0000, v103
    v_sub_f32 v90, v90, v88
    v_sub_f32 v91, v91, v88
    v_cvt_pk_bf16_f32 v103, v90, v91
    v_lshlrev_b32 v90, 16, v103
    v_and_b32 v91, 0xffff0000, v103
    v_mul_f32 v90, v90, v89
    v_mul_f32 v91, v91, v89
    v_cvt_pk_bf16_f32 v103, v90, v91
    ds_write_b128 v4, v[100:103] offset:2048
    v_lshlrev_b32 v90, 16, v104
    v_and_b32 v91, 0xffff0000, v104
    v_sub_f32 v90, v90, v88
    v_sub_f32 v91, v91, v88
    v_cvt_pk_bf16_f32 v104, v90, v91
    v_lshlrev_b32 v90, 16, v104
    v_and_b32 v91, 0xffff0000, v104
    v_mul_f32 v90, v90, v89
    v_mul_f32 v91, v91, v89
    v_cvt_pk_bf16_f32 v104, v90, v91
    v_lshlrev_b32 v90, 16, v105
    v_and_b32 v91, 0xffff0000, v105
    v_sub_f32 v90, v90, v88
    v_sub_f32 v91, v91, v88
    v_cvt_pk_bf16_f32 v105, v90, v91
    v_lshlrev_b32 v90, 16, v105
    v_and_b32 v91, 0xffff0000, v105
    v_mul_f32 v90, v90, v89
    v_mul_f32 v91, v91, v89
    v_cvt_pk_bf16_f32 v105, v90, v91
    v_lshlrev_b32 v90, 16, v106
    v_and_b32 v91, 0xffff0000, v106
    v_sub_f32 v90, v90, v88
    v_sub_f32 v91, v91, v88
    v_cvt_pk_bf16_f32 v106, v90, v91
    v_lshlrev_b32 v90, 16, v106
    v_and_b32 v91, 0xffff0000, v106
    v_mul_f32 v90, v90, v89
    v_mul_f32 v91, v91, v89
    v_cvt_pk_bf16_f32 v106, v90, v91
    v_lshlrev_b32 v90, 16, v107
    v_and_b32 v91, 0xffff0000, v107
    v_sub_f32 v90, v90, v88
    v_sub_f32 v91, v91, v88
    v_cvt_pk_bf16_f32 v107, v90, v91
    v_lshlrev_b32 v90, 16, v107
    v_and_b32 v91, 0xffff0000, v107
    v_mul_f32 v90, v90, v89
    v_mul_f32 v91, v91, v89
    v_cvt_pk_bf16_f32 v107, v90, v91
    ds_write_b128 v4, v[104:107] offset:4096
    v_lshlrev_b32 v90, 16, v108
    v_and_b32 v91, 0xffff0000, v108
    v_sub_f32 v90, v90, v88
    v_sub_f32 v91, v91, v88
    v_cvt_pk_bf16_f32 v108, v90, v91
    v_lshlrev_b32 v90, 16, v108
    v_and_b32 v91, 0xffff0000, v108
    v_mul_f32 v90, v90, v89
    v_mul_f32 v91, v91, v89
    v_cvt_pk_bf16_f32 v108, v90, v91
    v_lshlrev_b32 v90, 16, v109
    v_and_b32 v91, 0xffff0000, v109
    v_sub_f32 v90, v90, v88
    v_sub_f32 v91, v91, v88
    v_cvt_pk_bf16_f32 v109, v90, v91
    v_lshlrev_b32 v90, 16, v109
    v_and_b32 v91, 0xffff0000, v109
    v_mul_f32 v90, v90, v89
    v_mul_f32 v91, v91, v89
    v_cvt_pk_bf16_f32 v109, v90, v91
    v_lshlrev_b32 v90, 16, v110
    v_and_b32 v91, 0xffff0000, v110
    v_sub_f32 v90, v90, v88
    v_sub_f32 v91, v91, v88
    v_cvt_pk_bf16_f32 v110, v90, v91
    v_lshlrev_b32 v90, 16, v110
    v_and_b32 v91, 0xffff0000, v110
    v_mul_f32 v90, v90, v89
    v_mul_f32 v91, v91, v89
    v_cvt_pk_bf16_f32 v110, v90, v91
    v_lshlrev_b32 v90, 16, v111
    v_and_b32 v91, 0xffff0000, v111
    v_sub_f32 v90, v90, v88
    v_sub_f32 v91, v91, v88
    v_cvt_pk_bf16_f32 v111, v90, v91
    v_lshlrev_b32 v90, 16, v111
    v_and_b32 v91, 0xffff0000, v111
    v_mul_f32 v90, v90, v89
    v_mul_f32 v91, v91, v89
    v_cvt_pk_bf16_f32 v111, v90, v91
    ds_write_b128 v4, v[108:111] offset:6144
    v_lshlrev_b32 v90, 16, v112
    v_and_b32 v91, 0xffff0000, v112
    v_sub_f32 v90, v90, v88
    v_sub_f32 v91, v91, v88
    v_cvt_pk_bf16_f32 v112, v90, v91
    v_lshlrev_b32 v90, 16, v112
    v_and_b32 v91, 0xffff0000, v112
    v_mul_f32 v90, v90, v89
    v_mul_f32 v91, v91, v89
    v_cvt_pk_bf16_f32 v112, v90, v91
    v_lshlrev_b32 v90, 16, v113
    v_and_b32 v91, 0xffff0000, v113
    v_sub_f32 v90, v90, v88
    v_sub_f32 v91, v91, v88
    v_cvt_pk_bf16_f32 v113, v90, v91
    v_lshlrev_b32 v90, 16, v113
    v_and_b32 v91, 0xffff0000, v113
    v_mul_f32 v90, v90, v89
    v_mul_f32 v91, v91, v89
    v_cvt_pk_bf16_f32 v113, v90, v91
    v_lshlrev_b32 v90, 16, v114
    v_and_b32 v91, 0xffff0000, v114
    v_sub_f32 v90, v90, v88
    v_sub_f32 v91, v91, v88
    v_cvt_pk_bf16_f32 v114, v90, v91
    v_lshlrev_b32 v90, 16, v114
    v_and_b32 v91, 0xffff0000, v114
    v_mul_f32 v90, v90, v89
    v_mul_f32 v91, v91, v89
    v_cvt_pk_bf16_f32 v114, v90, v91
    v_lshlrev_b32 v90, 16, v115
    v_and_b32 v91, 0xffff0000, v115
    v_sub_f32 v90, v90, v88
    v_sub_f32 v91, v91, v88
    v_cvt_pk_bf16_f32 v115, v90, v91
    v_lshlrev_b32 v90, 16, v115
    v_and_b32 v91, 0xffff0000, v115
    v_mul_f32 v90, v90, v89
    v_mul_f32 v91, v91, v89
    v_cvt_pk_bf16_f32 v115, v90, v91
    ds_write_b128 v4, v[112:115] offset:8192
    v_lshlrev_b32 v90, 16, v116
    v_and_b32 v91, 0xffff0000, v116
    v_sub_f32 v90, v90, v88
    v_sub_f32 v91, v91, v88
    v_cvt_pk_bf16_f32 v116, v90, v91
    v_lshlrev_b32 v90, 16, v116
    v_and_b32 v91, 0xffff0000, v116
    v_mul_f32 v90, v90, v89
    v_mul_f32 v91, v91, v89
    v_cvt_pk_bf16_f32 v116, v90, v91
    v_lshlrev_b32 v90, 16, v117
    v_and_b32 v91, 0xffff0000, v117
    v_sub_f32 v90, v90, v88
    v_sub_f32 v91, v91, v88
    v_cvt_pk_bf16_f32 v117, v90, v91
    v_lshlrev_b32 v90, 16, v117
    v_and_b32 v91, 0xffff0000, v117
    v_mul_f32 v90, v90, v89
    v_mul_f32 v91, v91, v89
    v_cvt_pk_bf16_f32 v117, v90, v91
    v_lshlrev_b32 v90, 16, v118
    v_and_b32 v91, 0xffff0000, v118
    v_sub_f32 v90, v90, v88
    v_sub_f32 v91, v91, v88
    v_cvt_pk_bf16_f32 v118, v90, v91
    v_lshlrev_b32 v90, 16, v118
    v_and_b32 v91, 0xffff0000, v118
    v_mul_f32 v90, v90, v89
    v_mul_f32 v91, v91, v89
    v_cvt_pk_bf16_f32 v118, v90, v91
    v_lshlrev_b32 v90, 16, v119
    v_and_b32 v91, 0xffff0000, v119
    v_sub_f32 v90, v90, v88
    v_sub_f32 v91, v91, v88
    v_cvt_pk_bf16_f32 v119, v90, v91
    v_lshlrev_b32 v90, 16, v119
    v_and_b32 v91, 0xffff0000, v119
    v_mul_f32 v90, v90, v89
    v_mul_f32 v91, v91, v89
    v_cvt_pk_bf16_f32 v119, v90, v91
    ds_write_b128 v4, v[116:119] offset:10240
    v_lshlrev_b32 v90, 16, v120
    v_and_b32 v91, 0xffff0000, v120
    v_sub_f32 v90, v90, v88
    v_sub_f32 v91, v91, v88
    v_cvt_pk_bf16_f32 v120, v90, v91
    v_lshlrev_b32 v90, 16, v120
    v_and_b32 v91, 0xffff0000, v120
    v_mul_f32 v90, v90, v89
    v_mul_f32 v91, v91, v89
    v_cvt_pk_bf16_f32 v120, v90, v91
    v_lshlrev_b32 v90, 16, v121
    v_and_b32 v91, 0xffff0000, v121
    v_sub_f32 v90, v90, v88
    v_sub_f32 v91, v91, v88
    v_cvt_pk_bf16_f32 v121, v90, v91
    v_lshlrev_b32 v90, 16, v121
    v_and_b32 v91, 0xffff0000, v121
    v_mul_f32 v90, v90, v89
    v_mul_f32 v91, v91, v89
    v_cvt_pk_bf16_f32 v121, v90, v91
    v_lshlrev_b32 v90, 16, v122
    v_and_b32 v91, 0xffff0000, v122
    v_sub_f32 v90, v90, v88
    v_sub_f32 v91, v91, v88
    v_cvt_pk_bf16_f32 v122, v90, v91
    v_lshlrev_b32 v90, 16, v122
    v_and_b32 v91, 0xffff0000, v122
    v_mul_f32 v90, v90, v89
    v_mul_f32 v91, v91, v89
    v_cvt_pk_bf16_f32 v122, v90, v91
    v_lshlrev_b32 v90, 16, v123
    v_and_b32 v91, 0xffff0000, v123
    v_sub_f32 v90, v90, v88
    v_sub_f32 v91, v91, v88
    v_cvt_pk_bf16_f32 v123, v90, v91
    v_lshlrev_b32 v90, 16, v123
    v_and_b32 v91, 0xffff0000, v123
    v_mul_f32 v90, v90, v89
    v_mul_f32 v91, v91, v89
    v_cvt_pk_bf16_f32 v123, v90, v91
    ds_write_b128 v4, v[120:123] offset:12288
    v_lshlrev_b32 v90, 16, v124
    v_and_b32 v91, 0xffff0000, v124
    v_sub_f32 v90, v90, v88
    v_sub_f32 v91, v91, v88
    v_cvt_pk_bf16_f32 v124, v90, v91
    v_lshlrev_b32 v90, 16, v124
    v_and_b32 v91, 0xffff0000, v124
    v_mul_f32 v90, v90, v89
    v_mul_f32 v91, v91, v89
    v_cvt_pk_bf16_f32 v124, v90, v91
    v_lshlrev_b32 v90, 16, v125
    v_and_b32 v91, 0xffff0000, v125
    v_sub_f32 v90, v90, v88
    v_sub_f32 v91, v91, v88
    v_cvt_pk_bf16_f32 v125, v90, v91
    v_lshlrev_b32 v90, 16, v125
    v_and_b32 v91, 0xffff0000, v125
    v_mul_f32 v90, v90, v89
    v_mul_f32 v91, v91, v89
    v_cvt_pk_bf16_f32 v125, v90, v91
    v_lshlrev_b32 v90, 16, v126
    v_and_b32 v91, 0xffff0000, v126
    v_sub_f32 v90, v90, v88
    v_sub_f32 v91, v91, v88
    v_cvt_pk_bf16_f32 v126, v90, v91
    v_lshlrev_b32 v90, 16, v126
    v_and_b32 v91, 0xffff0000, v126
    v_mul_f32 v90, v90, v89
    v_mul_f32 v91, v91, v89
    v_cvt_pk_bf16_f32 v126, v90, v91
    v_lshlrev_b32 v90, 16, v127
    v_and_b32 v91, 0xffff0000, v127
    v_sub_f32 v90, v90, v88
    v_sub_f32 v91, v91, v88
    v_cvt_pk_bf16_f32 v127, v90, v91
    v_lshlrev_b32 v90, 16, v127
    v_and_b32 v91, 0xffff0000, v127
    v_mul_f32 v90, v90, v89
    v_mul_f32 v91, v91, v89
    v_cvt_pk_bf16_f32 v127, v90, v91
    ds_write_b128 v4, v[124:127] offset:14336
    s_lshr_b32 s36, s21, 1
    s_lshl_b32 s36, s36, 14
    s_xor_b32 s37, s36, 16384
    v_add_u32 v80, s36, v5
    v_add_u32 v81, s37, v5
    v_add_u32 v82, s36, v6
    v_add_u32 v83, s37, v6
    s_mov_b32 s31, 0
    s_waitcnt vmcnt(24)
    s_barrier
    ds_read_b64_tr_b16 a[128:129], v20 offset:0
    ds_read_b64_tr_b16 a[130:131], v20 offset:1024
    ds_read_b64_tr_b16 a[132:133], v21 offset:0
    ds_read_b64_tr_b16 a[134:135], v21 offset:1024
    ds_read_b64_tr_b16 a[136:137], v22 offset:0
    ds_read_b64_tr_b16 a[138:139], v22 offset:1024
    ds_read_b64_tr_b16 a[140:141], v23 offset:0
    ds_read_b64_tr_b16 a[142:143], v23 offset:1024
    ds_read_b64_tr_b16 a[144:145], v24 offset:0
    ds_read_b64_tr_b16 a[146:147], v24 offset:1024
    ds_read_b64_tr_b16 a[148:149], v25 offset:0
    ds_read_b64_tr_b16 a[150:151], v25 offset:1024
    s_waitcnt lgkmcnt(4)
    ds_read_b64_tr_b16 a[152:153], v26 offset:0
    ds_read_b64_tr_b16 a[154:155], v26 offset:1024
    ds_read_b64_tr_b16 a[156:157], v27 offset:0
    ds_read_b64_tr_b16 a[158:159], v27 offset:1024
    s_waitcnt lgkmcnt(0)
    s_barrier
    s_mov_b32 s96, s48
    s_and_b32 s97, s49, 0xffff
    s_mov_b32 s98, 0x400000
    s_mov_b32 s99, 0x20000
    s_add_u32 m0, s28, 0
    s_add_u32 s37, s3, 0x0
    buffer_load_dwordx4 v16, s[96:99], s37 offen lds
    s_add_u32 m0, s28, 1024
    s_add_u32 s37, s3, 0x8000
    buffer_load_dwordx4 v17, s[96:99], s37 offen lds
    s_add_u32 m0, s28, 2048
    s_add_u32 s37, s3, 0x10000
    buffer_load_dwordx4 v18, s[96:99], s37 offen lds
    s_add_u32 m0, s28, 3072
    s_add_u32 s37, s3, 0x18000
    buffer_load_dwordx4 v19, s[96:99], s37 offen lds
    s_add_u32 m0, s28, 4096
    s_add_u32 s37, s3, 0x20000
    buffer_load_dwordx4 v16, s[96:99], s37 offen lds
    s_add_u32 m0, s28, 5120
    s_add_u32 s37, s3, 0x28000
    buffer_load_dwordx4 v17, s[96:99], s37 offen lds
    s_add_u32 m0, s28, 6144
    s_add_u32 s37, s3, 0x30000
    buffer_load_dwordx4 v18, s[96:99], s37 offen lds
    s_add_u32 m0, s28, 7168
    s_add_u32 s37, s3, 0x38000
    buffer_load_dwordx4 v19, s[96:99], s37 offen lds
    s_waitcnt vmcnt(24)
    s_barrier
    ds_read_b64_tr_b16 a[160:161], v20 offset:8192
    ds_read_b64_tr_b16 a[162:163], v20 offset:9216
    ds_read_b64_tr_b16 a[164:165], v21 offset:8192
    ds_read_b64_tr_b16 a[166:167], v21 offset:9216
    ds_read_b64_tr_b16 a[168:169], v22 offset:8192
    ds_read_b64_tr_b16 a[170:171], v22 offset:9216
    ds_read_b64_tr_b16 a[172:173], v23 offset:8192
    ds_read_b64_tr_b16 a[174:175], v23 offset:9216
    ds_read_b64_tr_b16 a[176:177], v24 offset:8192
    ds_read_b64_tr_b16 a[178:179], v24 offset:9216
    ds_read_b64_tr_b16 a[180:181], v25 offset:8192
    ds_read_b64_tr_b16 a[182:183], v25 offset:9216
    s_waitcnt lgkmcnt(4)
    ds_read_b64_tr_b16 a[184:185], v26 offset:8192
    ds_read_b64_tr_b16 a[186:187], v26 offset:9216
    ds_read_b64_tr_b16 a[188:189], v27 offset:8192
    ds_read_b64_tr_b16 a[190:191], v27 offset:9216
    s_waitcnt lgkmcnt(0)
    s_barrier
    s_add_u32 m0, s28, 8192
    s_add_u32 s37, s3, 0x100000
    buffer_load_dwordx4 v16, s[96:99], s37 offen lds
    s_add_u32 m0, s28, 9216
    s_add_u32 s37, s3, 0x108000
    buffer_load_dwordx4 v17, s[96:99], s37 offen lds
    s_add_u32 m0, s28, 10240
    s_add_u32 s37, s3, 0x110000
    buffer_load_dwordx4 v18, s[96:99], s37 offen lds
    s_add_u32 m0, s28, 11264
    s_add_u32 s37, s3, 0x118000
    buffer_load_dwordx4 v19, s[96:99], s37 offen lds
    s_add_u32 m0, s28, 12288
    s_add_u32 s37, s3, 0x120000
    buffer_load_dwordx4 v16, s[96:99], s37 offen lds
    s_add_u32 m0, s28, 13312
    s_add_u32 s37, s3, 0x128000
    buffer_load_dwordx4 v17, s[96:99], s37 offen lds
    s_add_u32 m0, s28, 14336
    s_add_u32 s37, s3, 0x130000
    buffer_load_dwordx4 v18, s[96:99], s37 offen lds
    s_add_u32 m0, s28, 15360
    s_add_u32 s37, s3, 0x138000
    buffer_load_dwordx4 v19, s[96:99], s37 offen lds
    s_waitcnt vmcnt(24)
    s_barrier
    ds_read_b64_tr_b16 a[192:193], v20 offset:16384
    ds_read_b64_tr_b16 a[194:195], v20 offset:17408
    ds_read_b64_tr_b16 a[196:197], v21 offset:16384
    ds_read_b64_tr_b16 a[198:199], v21 offset:17408
    ds_read_b64_tr_b16 a[200:201], v22 offset:16384
    ds_read_b64_tr_b16 a[202:203], v22 offset:17408
    ds_read_b64_tr_b16 a[204:205], v23 offset:16384
    ds_read_b64_tr_b16 a[206:207], v23 offset:17408
    ds_read_b64_tr_b16 a[208:209], v24 offset:16384
    ds_read_b64_tr_b16 a[210:211], v24 offset:17408
    ds_read_b64_tr_b16 a[212:213], v25 offset:16384
    ds_read_b64_tr_b16 a[214:215], v25 offset:17408
    s_waitcnt lgkmcnt(4)
    ds_read_b64_tr_b16 a[216:217], v26 offset:16384
    ds_read_b64_tr_b16 a[218:219], v26 offset:17408
    ds_read_b64_tr_b16 a[220:221], v27 offset:16384
    ds_read_b64_tr_b16 a[222:223], v27 offset:17408
    s_waitcnt lgkmcnt(0)
    s_barrier
    s_add_u32 m0, s28, 16384
    s_add_u32 s37, s3, 0x200000
    buffer_load_dwordx4 v16, s[96:99], s37 offen lds
    s_add_u32 m0, s28, 17408
    s_add_u32 s37, s3, 0x208000
    buffer_load_dwordx4 v17, s[96:99], s37 offen lds
    s_add_u32 m0, s28, 18432
    s_add_u32 s37, s3, 0x210000
    buffer_load_dwordx4 v18, s[96:99], s37 offen lds
    s_add_u32 m0, s28, 19456
    s_add_u32 s37, s3, 0x218000
    buffer_load_dwordx4 v19, s[96:99], s37 offen lds
    s_add_u32 m0, s28, 20480
    s_add_u32 s37, s3, 0x220000
    buffer_load_dwordx4 v16, s[96:99], s37 offen lds
    s_add_u32 m0, s28, 21504
    s_add_u32 s37, s3, 0x228000
    buffer_load_dwordx4 v17, s[96:99], s37 offen lds
    s_add_u32 m0, s28, 22528
    s_add_u32 s37, s3, 0x230000
    buffer_load_dwordx4 v18, s[96:99], s37 offen lds
    s_add_u32 m0, s28, 23552
    s_add_u32 s37, s3, 0x238000
    buffer_load_dwordx4 v19, s[96:99], s37 offen lds
    s_waitcnt vmcnt(24)
    s_barrier
    ds_read_b64_tr_b16 a[224:225], v20 offset:24576
    ds_read_b64_tr_b16 a[226:227], v20 offset:25600
    ds_read_b64_tr_b16 a[228:229], v21 offset:24576
    ds_read_b64_tr_b16 a[230:231], v21 offset:25600
    ds_read_b64_tr_b16 a[232:233], v22 offset:24576
    ds_read_b64_tr_b16 a[234:235], v22 offset:25600
    ds_read_b64_tr_b16 a[236:237], v23 offset:24576
    ds_read_b64_tr_b16 a[238:239], v23 offset:25600
    ds_read_b64_tr_b16 a[240:241], v24 offset:24576
    ds_read_b64_tr_b16 a[242:243], v24 offset:25600
    ds_read_b64_tr_b16 a[244:245], v25 offset:24576
    ds_read_b64_tr_b16 a[246:247], v25 offset:25600
    s_waitcnt lgkmcnt(4)
    ds_read_b64_tr_b16 a[248:249], v26 offset:24576
    ds_read_b64_tr_b16 a[250:251], v26 offset:25600
    ds_read_b64_tr_b16 a[252:253], v27 offset:24576
    ds_read_b64_tr_b16 a[254:255], v27 offset:25600
    s_waitcnt lgkmcnt(0)
    s_barrier
    s_add_u32 m0, s28, 24576
    s_add_u32 s37, s3, 0x300000
    buffer_load_dwordx4 v16, s[96:99], s37 offen lds
    s_add_u32 m0, s28, 25600
    s_add_u32 s37, s3, 0x308000
    buffer_load_dwordx4 v17, s[96:99], s37 offen lds
    s_add_u32 m0, s28, 26624
    s_add_u32 s37, s3, 0x310000
    buffer_load_dwordx4 v18, s[96:99], s37 offen lds
    s_add_u32 m0, s28, 27648
    s_add_u32 s37, s3, 0x318000
    buffer_load_dwordx4 v19, s[96:99], s37 offen lds
    s_add_u32 m0, s28, 28672
    s_add_u32 s37, s3, 0x320000
    buffer_load_dwordx4 v16, s[96:99], s37 offen lds
    s_add_u32 m0, s28, 29696
    s_add_u32 s37, s3, 0x328000
    buffer_load_dwordx4 v17, s[96:99], s37 offen lds
    s_add_u32 m0, s28, 30720
    s_add_u32 s37, s3, 0x330000
    buffer_load_dwordx4 v18, s[96:99], s37 offen lds
    s_add_u32 m0, s28, 31744
    s_add_u32 s37, s3, 0x338000
    buffer_load_dwordx4 v19, s[96:99], s37 offen lds
    ds_read_b128 v[64:67], v80 offset:0
    ds_read_b128 v[68:71], v81 offset:0
    ds_read_b128 v[72:75], v82 offset:1024
    ds_read_b128 v[76:79], v83 offset:1024
    s_waitcnt lgkmcnt(2)
    v_mfma_f32_16x16x32_bf16 v[32:35], a[128:131], v[64:67], 0
    v_mfma_f32_16x16x32_bf16 v[36:39], a[128:131], v[68:71], 0
    v_mfma_f32_16x16x32_bf16 v[40:43], a[132:135], v[64:67], 0
    v_mfma_f32_16x16x32_bf16 v[44:47], a[132:135], v[68:71], 0
    v_mfma_f32_16x16x32_bf16 v[48:51], v[64:67], v[128:131], 0
    v_mfma_f32_16x16x32_bf16 v[56:59], v[68:71], v[128:131], 0
    v_mfma_f32_16x16x32_bf16 v[52:55], v[64:67], v[132:135], 0
    v_mfma_f32_16x16x32_bf16 v[60:63], v[68:71], v[132:135], 0
    ds_read_b128 v[64:67], v80 offset:2048
    ds_read_b128 v[68:71], v81 offset:2048
    s_waitcnt lgkmcnt(2)
    v_mfma_f32_16x16x32_bf16 v[32:35], a[136:139], v[72:75], v[32:35]
    v_mfma_f32_16x16x32_bf16 v[36:39], a[136:139], v[76:79], v[36:39]
    v_mfma_f32_16x16x32_bf16 v[40:43], a[140:143], v[72:75], v[40:43]
    v_mfma_f32_16x16x32_bf16 v[44:47], a[140:143], v[76:79], v[44:47]
    v_mfma_f32_16x16x32_bf16 v[48:51], v[72:75], v[136:139], v[48:51]
    v_mfma_f32_16x16x32_bf16 v[56:59], v[76:79], v[136:139], v[56:59]
    v_mfma_f32_16x16x32_bf16 v[52:55], v[72:75], v[140:143], v[52:55]
    v_mfma_f32_16x16x32_bf16 v[60:63], v[76:79], v[140:143], v[60:63]
    ds_read_b128 v[72:75], v82 offset:3072
    ds_read_b128 v[76:79], v83 offset:3072
    s_waitcnt lgkmcnt(2)
    v_mfma_f32_16x16x32_bf16 v[32:35], a[144:147], v[64:67], v[32:35]
    v_mfma_f32_16x16x32_bf16 v[36:39], a[144:147], v[68:71], v[36:39]
    v_mfma_f32_16x16x32_bf16 v[40:43], a[148:151], v[64:67], v[40:43]
    v_mfma_f32_16x16x32_bf16 v[44:47], a[148:151], v[68:71], v[44:47]
    v_mfma_f32_16x16x32_bf16 v[48:51], v[64:67], v[144:147], v[48:51]
    v_mfma_f32_16x16x32_bf16 v[56:59], v[68:71], v[144:147], v[56:59]
    v_mfma_f32_16x16x32_bf16 v[52:55], v[64:67], v[148:151], v[52:55]
    v_mfma_f32_16x16x32_bf16 v[60:63], v[68:71], v[148:151], v[60:63]
    ds_read_b128 v[64:67], v80 offset:4096
    ds_read_b128 v[68:71], v81 offset:4096
    s_waitcnt lgkmcnt(2)
    v_mfma_f32_16x16x32_bf16 v[32:35], a[152:155], v[72:75], v[32:35]
    v_mfma_f32_16x16x32_bf16 v[36:39], a[152:155], v[76:79], v[36:39]
    v_mfma_f32_16x16x32_bf16 v[40:43], a[156:159], v[72:75], v[40:43]
    v_mfma_f32_16x16x32_bf16 v[44:47], a[156:159], v[76:79], v[44:47]
    v_mfma_f32_16x16x32_bf16 v[48:51], v[72:75], v[152:155], v[48:51]
    v_mfma_f32_16x16x32_bf16 v[56:59], v[76:79], v[152:155], v[56:59]
    v_mfma_f32_16x16x32_bf16 v[52:55], v[72:75], v[156:159], v[52:55]
    v_mfma_f32_16x16x32_bf16 v[60:63], v[76:79], v[156:159], v[60:63]
    ds_read_b128 v[72:75], v82 offset:5120
    ds_read_b128 v[76:79], v83 offset:5120
    s_waitcnt lgkmcnt(2)
    v_mfma_f32_16x16x32_bf16 v[32:35], a[160:163], v[64:67], v[32:35]
    v_mfma_f32_16x16x32_bf16 v[36:39], a[160:163], v[68:71], v[36:39]
    v_mfma_f32_16x16x32_bf16 v[40:43], a[164:167], v[64:67], v[40:43]
    v_mfma_f32_16x16x32_bf16 v[44:47], a[164:167], v[68:71], v[44:47]
    v_mfma_f32_16x16x32_bf16 v[48:51], v[64:67], v[160:163], v[48:51]
    v_mfma_f32_16x16x32_bf16 v[56:59], v[68:71], v[160:163], v[56:59]
    v_mfma_f32_16x16x32_bf16 v[52:55], v[64:67], v[164:167], v[52:55]
    v_mfma_f32_16x16x32_bf16 v[60:63], v[68:71], v[164:167], v[60:63]
    ds_read_b128 v[64:67], v80 offset:6144
    ds_read_b128 v[68:71], v81 offset:6144
    s_waitcnt lgkmcnt(2)
    v_mfma_f32_16x16x32_bf16 v[32:35], a[168:171], v[72:75], v[32:35]
    v_mfma_f32_16x16x32_bf16 v[36:39], a[168:171], v[76:79], v[36:39]
    v_mfma_f32_16x16x32_bf16 v[40:43], a[172:175], v[72:75], v[40:43]
    v_mfma_f32_16x16x32_bf16 v[44:47], a[172:175], v[76:79], v[44:47]
    v_mfma_f32_16x16x32_bf16 v[48:51], v[72:75], v[168:171], v[48:51]
    v_mfma_f32_16x16x32_bf16 v[56:59], v[76:79], v[168:171], v[56:59]
    v_mfma_f32_16x16x32_bf16 v[52:55], v[72:75], v[172:175], v[52:55]
    v_mfma_f32_16x16x32_bf16 v[60:63], v[76:79], v[172:175], v[60:63]
    ds_read_b128 v[72:75], v82 offset:7168
    ds_read_b128 v[76:79], v83 offset:7168
    s_waitcnt lgkmcnt(2)
    v_mfma_f32_16x16x32_bf16 v[32:35], a[176:179], v[64:67], v[32:35]
    v_mfma_f32_16x16x32_bf16 v[36:39], a[176:179], v[68:71], v[36:39]
    v_mfma_f32_16x16x32_bf16 v[40:43], a[180:183], v[64:67], v[40:43]
    v_mfma_f32_16x16x32_bf16 v[44:47], a[180:183], v[68:71], v[44:47]
    v_mfma_f32_16x16x32_bf16 v[48:51], v[64:67], v[176:179], v[48:51]
    v_mfma_f32_16x16x32_bf16 v[56:59], v[68:71], v[176:179], v[56:59]
    v_mfma_f32_16x16x32_bf16 v[52:55], v[64:67], v[180:183], v[52:55]
    v_mfma_f32_16x16x32_bf16 v[60:63], v[68:71], v[180:183], v[60:63]
    ds_read_b128 v[64:67], v80 offset:8192
    ds_read_b128 v[68:71], v81 offset:8192
    s_waitcnt lgkmcnt(2)
    v_mfma_f32_16x16x32_bf16 v[32:35], a[184:187], v[72:75], v[32:35]
    v_mfma_f32_16x16x32_bf16 v[36:39], a[184:187], v[76:79], v[36:39]
    v_mfma_f32_16x16x32_bf16 v[40:43], a[188:191], v[72:75], v[40:43]
    v_mfma_f32_16x16x32_bf16 v[44:47], a[188:191], v[76:79], v[44:47]
    v_mfma_f32_16x16x32_bf16 v[48:51], v[72:75], v[184:187], v[48:51]
    v_mfma_f32_16x16x32_bf16 v[56:59], v[76:79], v[184:187], v[56:59]
    v_mfma_f32_16x16x32_bf16 v[52:55], v[72:75], v[188:191], v[52:55]
    v_mfma_f32_16x16x32_bf16 v[60:63], v[76:79], v[188:191], v[60:63]
    ds_read_b128 v[72:75], v82 offset:9216
    ds_read_b128 v[76:79], v83 offset:9216
    s_waitcnt lgkmcnt(2)
    v_mfma_f32_16x16x32_bf16 v[32:35], a[192:195], v[64:67], v[32:35]
    v_mfma_f32_16x16x32_bf16 v[36:39], a[192:195], v[68:71], v[36:39]
    v_mfma_f32_16x16x32_bf16 v[40:43], a[196:199], v[64:67], v[40:43]
    v_mfma_f32_16x16x32_bf16 v[44:47], a[196:199], v[68:71], v[44:47]
    v_mfma_f32_16x16x32_bf16 v[48:51], v[64:67], v[192:195], v[48:51]
    v_mfma_f32_16x16x32_bf16 v[56:59], v[68:71], v[192:195], v[56:59]
    v_mfma_f32_16x16x32_bf16 v[52:55], v[64:67], v[196:199], v[52:55]
    v_mfma_f32_16x16x32_bf16 v[60:63], v[68:71], v[196:199], v[60:63]
    ds_read_b128 v[64:67], v80 offset:10240
    ds_read_b128 v[68:71], v81 offset:10240
    s_waitcnt lgkmcnt(2)
    v_mfma_f32_16x16x32_bf16 v[32:35], a[200:203], v[72:75], v[32:35]
    v_mfma_f32_16x16x32_bf16 v[36:39], a[200:203], v[76:79], v[36:39]
    v_mfma_f32_16x16x32_bf16 v[40:43], a[204:207], v[72:75], v[40:43]
    v_mfma_f32_16x16x32_bf16 v[44:47], a[204:207], v[76:79], v[44:47]
    v_mfma_f32_16x16x32_bf16 v[48:51], v[72:75], v[200:203], v[48:51]
    v_mfma_f32_16x16x32_bf16 v[56:59], v[76:79], v[200:203], v[56:59]
    v_mfma_f32_16x16x32_bf16 v[52:55], v[72:75], v[204:207], v[52:55]
    v_mfma_f32_16x16x32_bf16 v[60:63], v[76:79], v[204:207], v[60:63]
    ds_read_b128 v[72:75], v82 offset:11264
    ds_read_b128 v[76:79], v83 offset:11264
    s_waitcnt lgkmcnt(2)
    v_mfma_f32_16x16x32_bf16 v[32:35], a[208:211], v[64:67], v[32:35]
    v_mfma_f32_16x16x32_bf16 v[36:39], a[208:211], v[68:71], v[36:39]
    v_mfma_f32_16x16x32_bf16 v[40:43], a[212:215], v[64:67], v[40:43]
    v_mfma_f32_16x16x32_bf16 v[44:47], a[212:215], v[68:71], v[44:47]
    v_mfma_f32_16x16x32_bf16 v[48:51], v[64:67], v[208:211], v[48:51]
    v_mfma_f32_16x16x32_bf16 v[56:59], v[68:71], v[208:211], v[56:59]
    v_mfma_f32_16x16x32_bf16 v[52:55], v[64:67], v[212:215], v[52:55]
    v_mfma_f32_16x16x32_bf16 v[60:63], v[68:71], v[212:215], v[60:63]
    ds_read_b128 v[64:67], v80 offset:12288
    ds_read_b128 v[68:71], v81 offset:12288
    s_waitcnt lgkmcnt(2)
    v_mfma_f32_16x16x32_bf16 v[32:35], a[216:219], v[72:75], v[32:35]
    v_mfma_f32_16x16x32_bf16 v[36:39], a[216:219], v[76:79], v[36:39]
    v_mfma_f32_16x16x32_bf16 v[40:43], a[220:223], v[72:75], v[40:43]
    v_mfma_f32_16x16x32_bf16 v[44:47], a[220:223], v[76:79], v[44:47]
    v_mfma_f32_16x16x32_bf16 v[48:51], v[72:75], v[216:219], v[48:51]
    v_mfma_f32_16x16x32_bf16 v[56:59], v[76:79], v[216:219], v[56:59]
    v_mfma_f32_16x16x32_bf16 v[52:55], v[72:75], v[220:223], v[52:55]
    v_mfma_f32_16x16x32_bf16 v[60:63], v[76:79], v[220:223], v[60:63]
    ds_read_b128 v[72:75], v82 offset:13312
    ds_read_b128 v[76:79], v83 offset:13312
    s_waitcnt lgkmcnt(2)
    v_mfma_f32_16x16x32_bf16 v[32:35], a[224:227], v[64:67], v[32:35]
    v_mfma_f32_16x16x32_bf16 v[36:39], a[224:227], v[68:71], v[36:39]
    v_mfma_f32_16x16x32_bf16 v[40:43], a[228:231], v[64:67], v[40:43]
    v_mfma_f32_16x16x32_bf16 v[44:47], a[228:231], v[68:71], v[44:47]
    v_mfma_f32_16x16x32_bf16 v[48:51], v[64:67], v[224:227], v[48:51]
    v_mfma_f32_16x16x32_bf16 v[56:59], v[68:71], v[224:227], v[56:59]
    v_mfma_f32_16x16x32_bf16 v[52:55], v[64:67], v[228:231], v[52:55]
    v_mfma_f32_16x16x32_bf16 v[60:63], v[68:71], v[228:231], v[60:63]
    ds_read_b128 v[64:67], v80 offset:14336
    ds_read_b128 v[68:71], v81 offset:14336
    s_waitcnt lgkmcnt(2)
    v_mfma_f32_16x16x32_bf16 v[32:35], a[232:235], v[72:75], v[32:35]
    v_mfma_f32_16x16x32_bf16 v[36:39], a[232:235], v[76:79], v[36:39]
    v_mfma_f32_16x16x32_bf16 v[40:43], a[236:239], v[72:75], v[40:43]
    v_mfma_f32_16x16x32_bf16 v[44:47], a[236:239], v[76:79], v[44:47]
    v_mfma_f32_16x16x32_bf16 v[48:51], v[72:75], v[232:235], v[48:51]
    v_mfma_f32_16x16x32_bf16 v[56:59], v[76:79], v[232:235], v[56:59]
    v_mfma_f32_16x16x32_bf16 v[52:55], v[72:75], v[236:239], v[52:55]
    v_mfma_f32_16x16x32_bf16 v[60:63], v[76:79], v[236:239], v[60:63]
    ds_read_b128 v[72:75], v82 offset:15360
    ds_read_b128 v[76:79], v83 offset:15360
    s_waitcnt lgkmcnt(2)
    v_mfma_f32_16x16x32_bf16 v[32:35], a[240:243], v[64:67], v[32:35]
    v_mfma_f32_16x16x32_bf16 v[36:39], a[240:243], v[68:71], v[36:39]
    v_mfma_f32_16x16x32_bf16 v[40:43], a[244:247], v[64:67], v[40:43]
    v_mfma_f32_16x16x32_bf16 v[44:47], a[244:247], v[68:71], v[44:47]
    v_mfma_f32_16x16x32_bf16 v[48:51], v[64:67], v[240:243], v[48:51]
    v_mfma_f32_16x16x32_bf16 v[56:59], v[68:71], v[240:243], v[56:59]
    v_mfma_f32_16x16x32_bf16 v[52:55], v[64:67], v[244:247], v[52:55]
    v_mfma_f32_16x16x32_bf16 v[60:63], v[68:71], v[244:247], v[60:63]
    s_waitcnt lgkmcnt(0)
    v_mfma_f32_16x16x32_bf16 v[32:35], a[248:251], v[72:75], v[32:35]
    v_mfma_f32_16x16x32_bf16 v[36:39], a[248:251], v[76:79], v[36:39]
    v_mfma_f32_16x16x32_bf16 v[40:43], a[252:255], v[72:75], v[40:43]
    v_mfma_f32_16x16x32_bf16 v[44:47], a[252:255], v[76:79], v[44:47]
    v_mfma_f32_16x16x32_bf16 v[48:51], v[72:75], v[248:251], v[48:51]
    v_mfma_f32_16x16x32_bf16 v[56:59], v[76:79], v[248:251], v[56:59]
    v_mfma_f32_16x16x32_bf16 v[52:55], v[72:75], v[252:255], v[52:55]
    v_mfma_f32_16x16x32_bf16 v[60:63], v[76:79], v[252:255], v[60:63]
    s_nop 0
    v_mul_f32 v32, s33, v32
    v_mul_f32 v33, s33, v33
    v_mul_f32 v34, s33, v34
    v_mul_f32 v35, s33, v35
    v_mul_f32 v36, s33, v36
    v_mul_f32 v37, s33, v37
    v_mul_f32 v38, s33, v38
    v_mul_f32 v39, s33, v39
    v_mul_f32 v40, s33, v40
    v_mul_f32 v41, s33, v41
    v_mul_f32 v42, s33, v42
    v_mul_f32 v43, s33, v43
    v_mul_f32 v44, s33, v44
    v_mul_f32 v45, s33, v45
    v_mul_f32 v46, s33, v46
    v_mul_f32 v47, s33, v47
    v_cvt_pk_bf16_f32 v88, v32, v40
    v_cvt_pk_bf16_f32 v89, v33, v41
    v_cvt_pk_bf16_f32 v90, v34, v42
    v_cvt_pk_bf16_f32 v91, v35, v43
    v_cvt_pk_bf16_f32 v92, v36, v44
    v_cvt_pk_bf16_f32 v93, v37, v45
    v_cvt_pk_bf16_f32 v94, v38, v46
    v_cvt_pk_bf16_f32 v95, v39, v47
    v_cvt_pk_bf16_f32 v96, v48, v49
    v_cvt_pk_bf16_f32 v97, v50, v51
    v_cvt_pk_bf16_f32 v98, v56, v57
    v_cvt_pk_bf16_f32 v99, v58, v59
    v_cvt_pk_bf16_f32 v100, v52, v53
    v_cvt_pk_bf16_f32 v101, v54, v55
    v_cvt_pk_bf16_f32 v102, v60, v61
    v_cvt_pk_bf16_f32 v103, v62, v63
    s_mul_i32 s24, s23, 0x82100
    s_lshl_b32 s36, s20, 14
    s_add_u32 s24, s24, s36
    s_add_u32 s24, s24, 0x1000000
    s_lshr_b32 s36, s21, 1
    s_lshl_b32 s36, s36, 12
    s_xor_b32 s37, s36, 4096
    s_add_u32 s36, s36, s24
    s_add_u32 s37, s37, s24
    buffer_store_dwordx4 v[88:91], v9, s[8:11], s36 offen sc1
    buffer_store_dwordx4 v[92:95], v9, s[8:11], s37 offen sc1
    s_add_u32 s24, s24, 8192
    buffer_store_dwordx4 v[96:99], v2, s[8:11], s24 offen sc1
    buffer_store_dwordx4 v[100:103], v2, s[8:11], s24 offen offset:1024 sc1
    s_mul_i32 s25, s23, 0x82100
    s_lshl_b32 s36, s20, 2
    s_add_u32 s25, s25, s36
    s_add_u32 s25, s25, 0x1082000
    v_lshrrev_b32 v15, 2, v1
    v_and_b32 v15, 127, v15
L_WHS:
    buffer_load_dword v14, v15, s[16:19], 0 offen sc1
    s_add_u32 s32, s32, 1
    s_cmp_gt_u32 s32, 200000
    s_cbranch_scc1 L_WHS_done
    s_waitcnt vmcnt(0)
    v_cmp_eq_u32 vcc, 0, v14
    s_cbranch_vccnz L_WHS
L_WHS_done:
    s_waitcnt vmcnt(0)
    s_barrier
    v_cmp_ne_u32 vcc, 0, v0
    v_mov_b32 v15, 0x40000000
    v_mov_b32 v14, 1
    v_cndmask_b32 v15, v0, v15, vcc
    buffer_store_dword v14, v15, s[8:11], s25 offen sc1
    s_barrier
    ds_read_b64_tr_b16 a[0:1], v20 offset:0
    ds_read_b64_tr_b16 a[2:3], v20 offset:1024
    ds_read_b64_tr_b16 a[4:5], v21 offset:0
    ds_read_b64_tr_b16 a[6:7], v21 offset:1024
    ds_read_b64_tr_b16 a[8:9], v22 offset:0
    ds_read_b64_tr_b16 a[10:11], v22 offset:1024
    ds_read_b64_tr_b16 a[12:13], v23 offset:0
    ds_read_b64_tr_b16 a[14:15], v23 offset:1024
    ds_read_b64_tr_b16 a[16:17], v24 offset:0
    ds_read_b64_tr_b16 a[18:19], v24 offset:1024
    ds_read_b64_tr_b16 a[20:21], v25 offset:0
    ds_read_b64_tr_b16 a[22:23], v25 offset:1024
    s_waitcnt lgkmcnt(4)
    ds_read_b64_tr_b16 a[24:25], v26 offset:0
    ds_read_b64_tr_b16 a[26:27], v26 offset:1024
    ds_read_b64_tr_b16 a[28:29], v27 offset:0
    ds_read_b64_tr_b16 a[30:31], v27 offset:1024
    s_waitcnt lgkmcnt(0)
    s_barrier
    s_barrier
    ds_read_b64_tr_b16 a[32:33], v20 offset:8192
    ds_read_b64_tr_b16 a[34:35], v20 offset:9216
    ds_read_b64_tr_b16 a[36:37], v21 offset:8192
    ds_read_b64_tr_b16 a[38:39], v21 offset:9216
    ds_read_b64_tr_b16 a[40:41], v22 offset:8192
    ds_read_b64_tr_b16 a[42:43], v22 offset:9216
    ds_read_b64_tr_b16 a[44:45], v23 offset:8192
    ds_read_b64_tr_b16 a[46:47], v23 offset:9216
    ds_read_b64_tr_b16 a[48:49], v24 offset:8192
    ds_read_b64_tr_b16 a[50:51], v24 offset:9216
    ds_read_b64_tr_b16 a[52:53], v25 offset:8192
    ds_read_b64_tr_b16 a[54:55], v25 offset:9216
    s_waitcnt lgkmcnt(4)
    ds_read_b64_tr_b16 a[56:57], v26 offset:8192
    ds_read_b64_tr_b16 a[58:59], v26 offset:9216
    ds_read_b64_tr_b16 a[60:61], v27 offset:8192
    ds_read_b64_tr_b16 a[62:63], v27 offset:9216
    s_waitcnt lgkmcnt(0)
    s_barrier
    s_barrier
    ds_read_b64_tr_b16 a[64:65], v20 offset:16384
    ds_read_b64_tr_b16 a[66:67], v20 offset:17408
    ds_read_b64_tr_b16 a[68:69], v21 offset:16384
    ds_read_b64_tr_b16 a[70:71], v21 offset:17408
    ds_read_b64_tr_b16 a[72:73], v22 offset:16384
    ds_read_b64_tr_b16 a[74:75], v22 offset:17408
    ds_read_b64_tr_b16 a[76:77], v23 offset:16384
    ds_read_b64_tr_b16 a[78:79], v23 offset:17408
    ds_read_b64_tr_b16 a[80:81], v24 offset:16384
    ds_read_b64_tr_b16 a[82:83], v24 offset:17408
    ds_read_b64_tr_b16 a[84:85], v25 offset:16384
    ds_read_b64_tr_b16 a[86:87], v25 offset:17408
    s_waitcnt lgkmcnt(4)
    ds_read_b64_tr_b16 a[88:89], v26 offset:16384
    ds_read_b64_tr_b16 a[90:91], v26 offset:17408
    ds_read_b64_tr_b16 a[92:93], v27 offset:16384
    ds_read_b64_tr_b16 a[94:95], v27 offset:17408
    s_waitcnt lgkmcnt(0)
    s_barrier
    s_barrier
    ds_read_b64_tr_b16 a[96:97], v20 offset:24576
    ds_read_b64_tr_b16 a[98:99], v20 offset:25600
    ds_read_b64_tr_b16 a[100:101], v21 offset:24576
    ds_read_b64_tr_b16 a[102:103], v21 offset:25600
    ds_read_b64_tr_b16 a[104:105], v22 offset:24576
    ds_read_b64_tr_b16 a[106:107], v22 offset:25600
    ds_read_b64_tr_b16 a[108:109], v23 offset:24576
    ds_read_b64_tr_b16 a[110:111], v23 offset:25600
    ds_read_b64_tr_b16 a[112:113], v24 offset:24576
    ds_read_b64_tr_b16 a[114:115], v24 offset:25600
    ds_read_b64_tr_b16 a[116:117], v25 offset:24576
    ds_read_b64_tr_b16 a[118:119], v25 offset:25600
    s_waitcnt lgkmcnt(4)
    ds_read_b64_tr_b16 a[120:121], v26 offset:24576
    ds_read_b64_tr_b16 a[122:123], v26 offset:25600
    ds_read_b64_tr_b16 a[124:125], v27 offset:24576
    ds_read_b64_tr_b16 a[126:127], v27 offset:25600
    s_waitcnt lgkmcnt(0)
    s_barrier
L_P1:
    s_waitcnt vmcnt(6)
    s_barrier
    s_xor_b32 s31, s31, 32768
    s_add_u32 s24, s23, 6
    s_min_u32 s24, s24, 63
    s_lshl_b32 s36, s24, 15
    s_add_u32 s36, s36, 0x800000
    s_lshl_b32 s37, s21, 10
    s_add_u32 s37, s37, s31
    s_add_u32 m0, s37, 0
    s_add_u32 s38, s36, 0
    buffer_load_dwordx4 v9, s[8:11], s38 offen sc1 lds
    s_add_u32 m0, s37, 4096
    s_add_u32 s38, s36, 4096
    buffer_load_dwordx4 v9, s[8:11], s38 offen sc1 lds
    s_add_u32 m0, s37, 8192
    s_add_u32 s38, s36, 8192
    buffer_load_dwordx4 v9, s[8:11], s38 offen sc1 lds
    s_add_u32 m0, s37, 12288
    s_add_u32 s38, s36, 12288
    buffer_load_dwordx4 v9, s[8:11], s38 offen sc1 lds
    s_add_u32 m0, s37, 16384
    s_add_u32 s38, s36, 16384
    buffer_load_dwordx4 v9, s[8:11], s38 offen sc1 lds
    s_add_u32 m0, s37, 20480
    s_add_u32 s38, s36, 20480
    buffer_load_dwordx4 v9, s[8:11], s38 offen sc1 lds
    s_add_u32 m0, s37, 24576
    s_add_u32 s38, s36, 24576
    buffer_load_dwordx4 v9, s[8:11], s38 offen sc1 lds
    s_add_u32 m0, s37, 28672
    s_add_u32 s38, s36, 28672
    buffer_load_dwordx4 v9, s[8:11], s38 offen sc1 lds
    ds_read_b128 v[64:67], v80 offset:0
    ds_read_b128 v[68:71], v81 offset:0
    ds_read_b128 v[72:75], v82 offset:1024
    ds_read_b128 v[76:79], v83 offset:1024
    s_waitcnt lgkmcnt(2)
    v_mfma_f32_16x16x32_bf16 v[32:35], a[128:131], v[64:67], 0
    v_mfma_f32_16x16x32_bf16 v[36:39], a[128:131], v[68:71], 0
    v_mfma_f32_16x16x32_bf16 v[40:43], a[132:135], v[64:67], 0
    v_mfma_f32_16x16x32_bf16 v[44:47], a[132:135], v[68:71], 0
    v_mfma_f32_16x16x32_bf16 v[48:51], v[64:67], v[128:131], 0
    v_mfma_f32_16x16x32_bf16 v[56:59], v[68:71], v[128:131], 0
    v_mfma_f32_16x16x32_bf16 v[52:55], v[64:67], v[132:135], 0
    v_mfma_f32_16x16x32_bf16 v[60:63], v[68:71], v[132:135], 0
    v_mfma_f32_16x16x32_bf16 v[16:19], a[0:3], v[64:67], 0
    v_mfma_f32_16x16x32_bf16 v[20:23], a[0:3], v[68:71], 0
    v_mfma_f32_16x16x32_bf16 v[24:27], a[4:7], v[64:67], 0
    v_mfma_f32_16x16x32_bf16 v[28:31], a[4:7], v[68:71], 0
    ds_read_b128 v[64:67], v80 offset:2048
    ds_read_b128 v[68:71], v81 offset:2048
    s_waitcnt lgkmcnt(2)
    v_mfma_f32_16x16x32_bf16 v[32:35], a[136:139], v[72:75], v[32:35]
    v_mfma_f32_16x16x32_bf16 v[36:39], a[136:139], v[76:79], v[36:39]
    v_mfma_f32_16x16x32_bf16 v[40:43], a[140:143], v[72:75], v[40:43]
    v_mfma_f32_16x16x32_bf16 v[44:47], a[140:143], v[76:79], v[44:47]
    v_mfma_f32_16x16x32_bf16 v[48:51], v[72:75], v[136:139], v[48:51]
    v_mfma_f32_16x16x32_bf16 v[56:59], v[76:79], v[136:139], v[56:59]
    v_mfma_f32_16x16x32_bf16 v[52:55], v[72:75], v[140:143], v[52:55]
    v_mfma_f32_16x16x32_bf16 v[60:63], v[76:79], v[140:143], v[60:63]
    v_mfma_f32_16x16x32_bf16 v[16:19], a[8:11], v[72:75], v[16:19]
    v_mfma_f32_16x16x32_bf16 v[20:23], a[8:11], v[76:79], v[20:23]
    v_mfma_f32_16x16x32_bf16 v[24:27], a[12:15], v[72:75], v[24:27]
    v_mfma_f32_16x16x32_bf16 v[28:31], a[12:15], v[76:79], v[28:31]
    ds_read_b128 v[72:75], v82 offset:3072
    ds_read_b128 v[76:79], v83 offset:3072
    s_waitcnt lgkmcnt(2)
    v_mfma_f32_16x16x32_bf16 v[32:35], a[144:147], v[64:67], v[32:35]
    v_mfma_f32_16x16x32_bf16 v[36:39], a[144:147], v[68:71], v[36:39]
    v_mfma_f32_16x16x32_bf16 v[40:43], a[148:151], v[64:67], v[40:43]
    v_mfma_f32_16x16x32_bf16 v[44:47], a[148:151], v[68:71], v[44:47]
    v_mfma_f32_16x16x32_bf16 v[48:51], v[64:67], v[144:147], v[48:51]
    v_mfma_f32_16x16x32_bf16 v[56:59], v[68:71], v[144:147], v[56:59]
    v_mfma_f32_16x16x32_bf16 v[52:55], v[64:67], v[148:151], v[52:55]
    v_mfma_f32_16x16x32_bf16 v[60:63], v[68:71], v[148:151], v[60:63]
    v_mfma_f32_16x16x32_bf16 v[16:19], a[16:19], v[64:67], v[16:19]
    v_mfma_f32_16x16x32_bf16 v[20:23], a[16:19], v[68:71], v[20:23]
    v_mfma_f32_16x16x32_bf16 v[24:27], a[20:23], v[64:67], v[24:27]
    v_mfma_f32_16x16x32_bf16 v[28:31], a[20:23], v[68:71], v[28:31]
    ds_read_b128 v[64:67], v80 offset:4096
    ds_read_b128 v[68:71], v81 offset:4096
    s_waitcnt lgkmcnt(2)
    v_mfma_f32_16x16x32_bf16 v[32:35], a[152:155], v[72:75], v[32:35]
    v_mfma_f32_16x16x32_bf16 v[36:39], a[152:155], v[76:79], v[36:39]
    v_mfma_f32_16x16x32_bf16 v[40:43], a[156:159], v[72:75], v[40:43]
    v_mfma_f32_16x16x32_bf16 v[44:47], a[156:159], v[76:79], v[44:47]
    v_mfma_f32_16x16x32_bf16 v[48:51], v[72:75], v[152:155], v[48:51]
    v_mfma_f32_16x16x32_bf16 v[56:59], v[76:79], v[152:155], v[56:59]
    v_mfma_f32_16x16x32_bf16 v[52:55], v[72:75], v[156:159], v[52:55]
    v_mfma_f32_16x16x32_bf16 v[60:63], v[76:79], v[156:159], v[60:63]
    v_mfma_f32_16x16x32_bf16 v[16:19], a[24:27], v[72:75], v[16:19]
    v_mfma_f32_16x16x32_bf16 v[20:23], a[24:27], v[76:79], v[20:23]
    v_mfma_f32_16x16x32_bf16 v[24:27], a[28:31], v[72:75], v[24:27]
    v_mfma_f32_16x16x32_bf16 v[28:31], a[28:31], v[76:79], v[28:31]
    ds_read_b128 v[72:75], v82 offset:5120
    ds_read_b128 v[76:79], v83 offset:5120
    s_waitcnt lgkmcnt(2)
    v_mfma_f32_16x16x32_bf16 v[32:35], a[160:163], v[64:67], v[32:35]
    v_mfma_f32_16x16x32_bf16 v[36:39], a[160:163], v[68:71], v[36:39]
    v_mfma_f32_16x16x32_bf16 v[40:43], a[164:167], v[64:67], v[40:43]
    v_mfma_f32_16x16x32_bf16 v[44:47], a[164:167], v[68:71], v[44:47]
    v_mfma_f32_16x16x32_bf16 v[48:51], v[64:67], v[160:163], v[48:51]
    v_mfma_f32_16x16x32_bf16 v[56:59], v[68:71], v[160:163], v[56:59]
    v_mfma_f32_16x16x32_bf16 v[52:55], v[64:67], v[164:167], v[52:55]
    v_mfma_f32_16x16x32_bf16 v[60:63], v[68:71], v[164:167], v[60:63]
    v_mfma_f32_16x16x32_bf16 v[16:19], a[32:35], v[64:67], v[16:19]
    v_mfma_f32_16x16x32_bf16 v[20:23], a[32:35], v[68:71], v[20:23]
    v_mfma_f32_16x16x32_bf16 v[24:27], a[36:39], v[64:67], v[24:27]
    v_mfma_f32_16x16x32_bf16 v[28:31], a[36:39], v[68:71], v[28:31]
    ds_read_b128 v[64:67], v80 offset:6144
    ds_read_b128 v[68:71], v81 offset:6144
    s_waitcnt lgkmcnt(2)
    v_mfma_f32_16x16x32_bf16 v[32:35], a[168:171], v[72:75], v[32:35]
    v_mfma_f32_16x16x32_bf16 v[36:39], a[168:171], v[76:79], v[36:39]
    v_mfma_f32_16x16x32_bf16 v[40:43], a[172:175], v[72:75], v[40:43]
    v_mfma_f32_16x16x32_bf16 v[44:47], a[172:175], v[76:79], v[44:47]
    v_mfma_f32_16x16x32_bf16 v[48:51], v[72:75], v[168:171], v[48:51]
    v_mfma_f32_16x16x32_bf16 v[56:59], v[76:79], v[168:171], v[56:59]
    v_mfma_f32_16x16x32_bf16 v[52:55], v[72:75], v[172:175], v[52:55]
    v_mfma_f32_16x16x32_bf16 v[60:63], v[76:79], v[172:175], v[60:63]
    v_mfma_f32_16x16x32_bf16 v[16:19], a[40:43], v[72:75], v[16:19]
    v_mfma_f32_16x16x32_bf16 v[20:23], a[40:43], v[76:79], v[20:23]
    v_mfma_f32_16x16x32_bf16 v[24:27], a[44:47], v[72:75], v[24:27]
    v_mfma_f32_16x16x32_bf16 v[28:31], a[44:47], v[76:79], v[28:31]
    ds_read_b128 v[72:75], v82 offset:7168
    ds_read_b128 v[76:79], v83 offset:7168
    s_waitcnt lgkmcnt(2)
    s_waitcnt vmcnt(8)
    s_barrier
    v_cmp_ne_u32 vcc, 0, v0
    v_mov_b32 v15, 0x40000000
    v_mov_b32 v14, 1
    v_cndmask_b32 v15, v0, v15, vcc
    buffer_store_dword v14, v15, s[8:11], s25 offen sc1
    v_mfma_f32_16x16x32_bf16 v[32:35], a[176:179], v[64:67], v[32:35]
    v_mfma_f32_16x16x32_bf16 v[36:39], a[176:179], v[68:71], v[36:39]
    v_mfma_f32_16x16x32_bf16 v[40:43], a[180:183], v[64:67], v[40:43]
    v_mfma_f32_16x16x32_bf16 v[44:47], a[180:183], v[68:71], v[44:47]
    v_mfma_f32_16x16x32_bf16 v[48:51], v[64:67], v[176:179], v[48:51]
    v_mfma_f32_16x16x32_bf16 v[56:59], v[68:71], v[176:179], v[56:59]
    v_mfma_f32_16x16x32_bf16 v[52:55], v[64:67], v[180:183], v[52:55]
    v_mfma_f32_16x16x32_bf16 v[60:63], v[68:71], v[180:183], v[60:63]
    v_mfma_f32_16x16x32_bf16 v[16:19], a[48:51], v[64:67], v[16:19]
    v_mfma_f32_16x16x32_bf16 v[20:23], a[48:51], v[68:71], v[20:23]
    v_mfma_f32_16x16x32_bf16 v[24:27], a[52:55], v[64:67], v[24:27]
    v_mfma_f32_16x16x32_bf16 v[28:31], a[52:55], v[68:71], v[28:31]
    ds_read_b128 v[64:67], v80 offset:8192
    ds_read_b128 v[68:71], v81 offset:8192
    s_waitcnt lgkmcnt(2)
    v_mfma_f32_16x16x32_bf16 v[32:35], a[184:187], v[72:75], v[32:35]
    v_mfma_f32_16x16x32_bf16 v[36:39], a[184:187], v[76:79], v[36:39]
    v_mfma_f32_16x16x32_bf16 v[40:43], a[188:191], v[72:75], v[40:43]
    v_mfma_f32_16x16x32_bf16 v[44:47], a[188:191], v[76:79], v[44:47]
    v_mfma_f32_16x16x32_bf16 v[48:51], v[72:75], v[184:187], v[48:51]
    v_mfma_f32_16x16x32_bf16 v[56:59], v[76:79], v[184:187], v[56:59]
    v_mfma_f32_16x16x32_bf16 v[52:55], v[72:75], v[188:191], v[52:55]
    v_mfma_f32_16x16x32_bf16 v[60:63], v[76:79], v[188:191], v[60:63]
    v_mfma_f32_16x16x32_bf16 v[16:19], a[56:59], v[72:75], v[16:19]
    v_mfma_f32_16x16x32_bf16 v[20:23], a[56:59], v[76:79], v[20:23]
    v_mfma_f32_16x16x32_bf16 v[24:27], a[60:63], v[72:75], v[24:27]
    v_mfma_f32_16x16x32_bf16 v[28:31], a[60:63], v[76:79], v[28:31]
    ds_read_b128 v[72:75], v82 offset:9216
    ds_read_b128 v[76:79], v83 offset:9216
    s_waitcnt lgkmcnt(2)
    v_mfma_f32_16x16x32_bf16 v[32:35], a[192:195], v[64:67], v[32:35]
    v_mfma_f32_16x16x32_bf16 v[36:39], a[192:195], v[68:71], v[36:39]
    v_mfma_f32_16x16x32_bf16 v[40:43], a[196:199], v[64:67], v[40:43]
    v_mfma_f32_16x16x32_bf16 v[44:47], a[196:199], v[68:71], v[44:47]
    v_mfma_f32_16x16x32_bf16 v[48:51], v[64:67], v[192:195], v[48:51]
    v_mfma_f32_16x16x32_bf16 v[56:59], v[68:71], v[192:195], v[56:59]
    v_mfma_f32_16x16x32_bf16 v[52:55], v[64:67], v[196:199], v[52:55]
    v_mfma_f32_16x16x32_bf16 v[60:63], v[68:71], v[196:199], v[60:63]
    v_mfma_f32_16x16x32_bf16 v[16:19], a[64:67], v[64:67], v[16:19]
    v_mfma_f32_16x16x32_bf16 v[20:23], a[64:67], v[68:71], v[20:23]
    v_mfma_f32_16x16x32_bf16 v[24:27], a[68:71], v[64:67], v[24:27]
    v_mfma_f32_16x16x32_bf16 v[28:31], a[68:71], v[68:71], v[28:31]
    ds_read_b128 v[64:67], v80 offset:10240
    ds_read_b128 v[68:71], v81 offset:10240
    s_waitcnt lgkmcnt(2)
    v_mfma_f32_16x16x32_bf16 v[32:35], a[200:203], v[72:75], v[32:35]
    v_mfma_f32_16x16x32_bf16 v[36:39], a[200:203], v[76:79], v[36:39]
    v_mfma_f32_16x16x32_bf16 v[40:43], a[204:207], v[72:75], v[40:43]
    v_mfma_f32_16x16x32_bf16 v[44:47], a[204:207], v[76:79], v[44:47]
    v_mfma_f32_16x16x32_bf16 v[48:51], v[72:75], v[200:203], v[48:51]
    v_mfma_f32_16x16x32_bf16 v[56:59], v[76:79], v[200:203], v[56:59]
    v_mfma_f32_16x16x32_bf16 v[52:55], v[72:75], v[204:207], v[52:55]
    v_mfma_f32_16x16x32_bf16 v[60:63], v[76:79], v[204:207], v[60:63]
    v_mfma_f32_16x16x32_bf16 v[16:19], a[72:75], v[72:75], v[16:19]
    v_mfma_f32_16x16x32_bf16 v[20:23], a[72:75], v[76:79], v[20:23]
    v_mfma_f32_16x16x32_bf16 v[24:27], a[76:79], v[72:75], v[24:27]
    v_mfma_f32_16x16x32_bf16 v[28:31], a[76:79], v[76:79], v[28:31]
    ds_read_b128 v[72:75], v82 offset:11264
    ds_read_b128 v[76:79], v83 offset:11264
    s_waitcnt lgkmcnt(2)
    v_mfma_f32_16x16x32_bf16 v[32:35], a[208:211], v[64:67], v[32:35]
    v_mfma_f32_16x16x32_bf16 v[36:39], a[208:211], v[68:71], v[36:39]
    v_mfma_f32_16x16x32_bf16 v[40:43], a[212:215], v[64:67], v[40:43]
    v_mfma_f32_16x16x32_bf16 v[44:47], a[212:215], v[68:71], v[44:47]
    v_mfma_f32_16x16x32_bf16 v[48:51], v[64:67], v[208:211], v[48:51]
    v_mfma_f32_16x16x32_bf16 v[56:59], v[68:71], v[208:211], v[56:59]
    v_mfma_f32_16x16x32_bf16 v[52:55], v[64:67], v[212:215], v[52:55]
    v_mfma_f32_16x16x32_bf16 v[60:63], v[68:71], v[212:215], v[60:63]
    v_mfma_f32_16x16x32_bf16 v[16:19], a[80:83], v[64:67], v[16:19]
    v_mfma_f32_16x16x32_bf16 v[20:23], a[80:83], v[68:71], v[20:23]
    v_mfma_f32_16x16x32_bf16 v[24:27], a[84:87], v[64:67], v[24:27]
    v_mfma_f32_16x16x32_bf16 v[28:31], a[84:87], v[68:71], v[28:31]
    ds_read_b128 v[64:67], v80 offset:12288
    ds_read_b128 v[68:71], v81 offset:12288
    s_waitcnt lgkmcnt(2)
    v_mfma_f32_16x16x32_bf16 v[32:35], a[216:219], v[72:75], v[32:35]
    v_mfma_f32_16x16x32_bf16 v[36:39], a[216:219], v[76:79], v[36:39]
    v_mfma_f32_16x16x32_bf16 v[40:43], a[220:223], v[72:75], v[40:43]
    v_mfma_f32_16x16x32_bf16 v[44:47], a[220:223], v[76:79], v[44:47]
    v_mfma_f32_16x16x32_bf16 v[48:51], v[72:75], v[216:219], v[48:51]
    v_mfma_f32_16x16x32_bf16 v[56:59], v[76:79], v[216:219], v[56:59]
    v_mfma_f32_16x16x32_bf16 v[52:55], v[72:75], v[220:223], v[52:55]
    v_mfma_f32_16x16x32_bf16 v[60:63], v[76:79], v[220:223], v[60:63]
    v_mfma_f32_16x16x32_bf16 v[16:19], a[88:91], v[72:75], v[16:19]
    v_mfma_f32_16x16x32_bf16 v[20:23], a[88:91], v[76:79], v[20:23]
    v_mfma_f32_16x16x32_bf16 v[24:27], a[92:95], v[72:75], v[24:27]
    v_mfma_f32_16x16x32_bf16 v[28:31], a[92:95], v[76:79], v[28:31]
    ds_read_b128 v[72:75], v82 offset:13312
    ds_read_b128 v[76:79], v83 offset:13312
    s_waitcnt lgkmcnt(2)
    v_mfma_f32_16x16x32_bf16 v[32:35], a[224:227], v[64:67], v[32:35]
    v_mfma_f32_16x16x32_bf16 v[36:39], a[224:227], v[68:71], v[36:39]
    v_mfma_f32_16x16x32_bf16 v[40:43], a[228:231], v[64:67], v[40:43]
    v_mfma_f32_16x16x32_bf16 v[44:47], a[228:231], v[68:71], v[44:47]
    v_mfma_f32_16x16x32_bf16 v[48:51], v[64:67], v[224:227], v[48:51]
    v_mfma_f32_16x16x32_bf16 v[56:59], v[68:71], v[224:227], v[56:59]
    v_mfma_f32_16x16x32_bf16 v[52:55], v[64:67], v[228:231], v[52:55]
    v_mfma_f32_16x16x32_bf16 v[60:63], v[68:71], v[228:231], v[60:63]
    v_mfma_f32_16x16x32_bf16 v[16:19], a[96:99], v[64:67], v[16:19]
    v_mfma_f32_16x16x32_bf16 v[20:23], a[96:99], v[68:71], v[20:23]
    v_mfma_f32_16x16x32_bf16 v[24:27], a[100:103], v[64:67], v[24:27]
    v_mfma_f32_16x16x32_bf16 v[28:31], a[100:103], v[68:71], v[28:31]
    ds_read_b128 v[64:67], v80 offset:14336
    ds_read_b128 v[68:71], v81 offset:14336
    s_waitcnt lgkmcnt(2)
    v_mfma_f32_16x16x32_bf16 v[32:35], a[232:235], v[72:75], v[32:35]
    v_mfma_f32_16x16x32_bf16 v[36:39], a[232:235], v[76:79], v[36:39]
    v_mfma_f32_16x16x32_bf16 v[40:43], a[236:239], v[72:75], v[40:43]
    v_mfma_f32_16x16x32_bf16 v[44:47], a[236:239], v[76:79], v[44:47]
    v_mfma_f32_16x16x32_bf16 v[48:51], v[72:75], v[232:235], v[48:51]
    v_mfma_f32_16x16x32_bf16 v[56:59], v[76:79], v[232:235], v[56:59]
    v_mfma_f32_16x16x32_bf16 v[52:55], v[72:75], v[236:239], v[52:55]
    v_mfma_f32_16x16x32_bf16 v[60:63], v[76:79], v[236:239], v[60:63]
    v_mfma_f32_16x16x32_bf16 v[16:19], a[104:107], v[72:75], v[16:19]
    v_mfma_f32_16x16x32_bf16 v[20:23], a[104:107], v[76:79], v[20:23]
    v_mfma_f32_16x16x32_bf16 v[24:27], a[108:111], v[72:75], v[24:27]
    v_mfma_f32_16x16x32_bf16 v[28:31], a[108:111], v[76:79], v[28:31]
    ds_read_b128 v[72:75], v82 offset:15360
    ds_read_b128 v[76:79], v83 offset:15360
    s_waitcnt lgkmcnt(2)
    v_mfma_f32_16x16x32_bf16 v[32:35], a[240:243], v[64:67], v[32:35]
    v_mfma_f32_16x16x32_bf16 v[36:39], a[240:243], v[68:71], v[36:39]
    v_mfma_f32_16x16x32_bf16 v[40:43], a[244:247], v[64:67], v[40:43]
    v_mfma_f32_16x16x32_bf16 v[44:47], a[244:247], v[68:71], v[44:47]
    v_mfma_f32_16x16x32_bf16 v[48:51], v[64:67], v[240:243], v[48:51]
    v_mfma_f32_16x16x32_bf16 v[56:59], v[68:71], v[240:243], v[56:59]
    v_mfma_f32_16x16x32_bf16 v[52:55], v[64:67], v[244:247], v[52:55]
    v_mfma_f32_16x16x32_bf16 v[60:63], v[68:71], v[244:247], v[60:63]
    v_mfma_f32_16x16x32_bf16 v[16:19], a[112:115], v[64:67], v[16:19]
    v_mfma_f32_16x16x32_bf16 v[20:23], a[112:115], v[68:71], v[20:23]
    v_mfma_f32_16x16x32_bf16 v[24:27], a[116:119], v[64:67], v[24:27]
    v_mfma_f32_16x16x32_bf16 v[28:31], a[116:119], v[68:71], v[28:31]
    s_waitcnt lgkmcnt(0)
    v_mfma_f32_16x16x32_bf16 v[32:35], a[248:251], v[72:75], v[32:35]
    v_mfma_f32_16x16x32_bf16 v[36:39], a[248:251], v[76:79], v[36:39]
    v_mfma_f32_16x16x32_bf16 v[40:43], a[252:255], v[72:75], v[40:43]
    v_mfma_f32_16x16x32_bf16 v[44:47], a[252:255], v[76:79], v[44:47]
    v_mfma_f32_16x16x32_bf16 v[48:51], v[72:75], v[248:251], v[48:51]
    v_mfma_f32_16x16x32_bf16 v[56:59], v[76:79], v[248:251], v[56:59]
    v_mfma_f32_16x16x32_bf16 v[52:55], v[72:75], v[252:255], v[52:55]
    v_mfma_f32_16x16x32_bf16 v[60:63], v[76:79], v[252:255], v[60:63]
    v_mfma_f32_16x16x32_bf16 v[16:19], a[120:123], v[72:75], v[16:19]
    v_mfma_f32_16x16x32_bf16 v[20:23], a[120:123], v[76:79], v[20:23]
    v_mfma_f32_16x16x32_bf16 v[24:27], a[124:127], v[72:75], v[24:27]
    v_mfma_f32_16x16x32_bf16 v[28:31], a[124:127], v[76:79], v[28:31]
    v_xor_b32 v80, 0x8000, v80
    v_xor_b32 v81, 0x8000, v81
    v_xor_b32 v82, 0x8000, v82
    v_xor_b32 v83, 0x8000, v83
    v_mul_f32 v32, s33, v32
    v_mul_f32 v33, s33, v33
    v_mul_f32 v34, s33, v34
    v_mul_f32 v35, s33, v35
    v_mul_f32 v36, s33, v36
    v_mul_f32 v37, s33, v37
    v_mul_f32 v38, s33, v38
    v_mul_f32 v39, s33, v39
    v_mul_f32 v40, s33, v40
    v_mul_f32 v41, s33, v41
    v_mul_f32 v42, s33, v42
    v_mul_f32 v43, s33, v43
    v_mul_f32 v44, s33, v44
    v_mul_f32 v45, s33, v45
    v_mul_f32 v46, s33, v46
    v_mul_f32 v47, s33, v47
    v_cvt_pk_bf16_f32 v88, v32, v40
    v_cvt_pk_bf16_f32 v89, v33, v41
    v_cvt_pk_bf16_f32 v90, v34, v42
    v_cvt_pk_bf16_f32 v91, v35, v43
    v_cvt_pk_bf16_f32 v92, v36, v44
    v_cvt_pk_bf16_f32 v93, v37, v45
    v_cvt_pk_bf16_f32 v94, v38, v46
    v_cvt_pk_bf16_f32 v95, v39, v47
    v_cvt_pk_bf16_f32 v96, v48, v49
    v_cvt_pk_bf16_f32 v97, v50, v51
    v_cvt_pk_bf16_f32 v98, v56, v57
    v_cvt_pk_bf16_f32 v99, v58, v59
    v_cvt_pk_bf16_f32 v100, v52, v53
    v_cvt_pk_bf16_f32 v101, v54, v55
    v_cvt_pk_bf16_f32 v102, v60, v61
    v_cvt_pk_bf16_f32 v103, v62, v63
    v_cvt_pk_bf16_f32 v104, v16, v24
    v_cvt_pk_bf16_f32 v105, v17, v25
    v_cvt_pk_bf16_f32 v106, v18, v26
    v_cvt_pk_bf16_f32 v107, v19, v27
    v_cvt_pk_bf16_f32 v108, v20, v28
    v_cvt_pk_bf16_f32 v109, v21, v29
    v_cvt_pk_bf16_f32 v110, v22, v30
    v_cvt_pk_bf16_f32 v111, v23, v31
    s_mul_i32 s24, s23, 0x82100
    s_lshl_b32 s36, s20, 14
    s_add_u32 s24, s24, s36
    s_add_u32 s24, s24, 0x1000000
    s_lshr_b32 s36, s21, 1
    s_lshl_b32 s36, s36, 12
    s_xor_b32 s37, s36, 4096
    s_add_u32 s36, s36, s24
    s_add_u32 s37, s37, s24
    buffer_store_dwordx4 v[88:91], v9, s[8:11], s36 offen sc1
    buffer_store_dwordx4 v[92:95], v9, s[8:11], s37 offen sc1
    s_add_u32 s24, s24, 8192
    buffer_store_dwordx4 v[96:99], v2, s[8:11], s24 offen sc1
    buffer_store_dwordx4 v[100:103], v2, s[8:11], s24 offen offset:1024 sc1
    s_add_u32 s36, s36, 0x7000000
    s_add_u32 s37, s37, 0x7000000
    buffer_store_dwordx4 v[104:107], v9, s[8:11], s36 offen sc1
    buffer_store_dwordx4 v[108:111], v9, s[8:11], s37 offen sc1
    s_mul_i32 s25, s23, 0x82100
    s_lshl_b32 s36, s20, 2
    s_add_u32 s25, s25, s36
    s_add_u32 s25, s25, 0x1082000
    s_add_u32 s23, s23, 6
    s_cmp_lt_u32 s23, 64
    s_cbranch_scc1 L_P1
    v_mov_b32 v20, -1
    v_mov_b32 v21, -1
    v_mov_b32 v22, -1
    v_mov_b32 v23, -1
    s_lshl_b32 s24, s22, 21
    s_lshl_b32 s36, s20, 15
    s_add_u32 s24, s24, s36
    s_add_u32 s36, s24, 0x4000000
    buffer_store_dwordx4 v[20:23], v11, s[8:11], s36 offen sc1
    s_add_u32 s36, s24, 0x4001000
    buffer_store_dwordx4 v[20:23], v11, s[8:11], s36 offen sc1
    s_add_u32 s36, s24, 0x4002000
    buffer_store_dwordx4 v[20:23], v11, s[8:11], s36 offen sc1
    s_add_u32 s36, s24, 0x4003000
    buffer_store_dwordx4 v[20:23], v11, s[8:11], s36 offen sc1
    s_add_u32 s36, s24, 0x4004000
    buffer_store_dwordx4 v[20:23], v11, s[8:11], s36 offen sc1
    s_add_u32 s36, s24, 0x4005000
    buffer_store_dwordx4 v[20:23], v11, s[8:11], s36 offen sc1
    s_add_u32 s36, s24, 0x4006000
    buffer_store_dwordx4 v[20:23], v11, s[8:11], s36 offen sc1
    s_add_u32 s36, s24, 0x4007000
    buffer_store_dwordx4 v[20:23], v11, s[8:11], s36 offen sc1
    s_add_u32 s36, s24, 0x4100000
    buffer_store_dwordx4 v[20:23], v11, s[8:11], s36 offen sc1
    s_add_u32 s36, s24, 0x4101000
    buffer_store_dwordx4 v[20:23], v11, s[8:11], s36 offen sc1
    s_add_u32 s36, s24, 0x4102000
    buffer_store_dwordx4 v[20:23], v11, s[8:11], s36 offen sc1
    s_add_u32 s36, s24, 0x4103000
    buffer_store_dwordx4 v[20:23], v11, s[8:11], s36 offen sc1
    s_add_u32 s36, s24, 0x4104000
    buffer_store_dwordx4 v[20:23], v11, s[8:11], s36 offen sc1
    s_add_u32 s36, s24, 0x4105000
    buffer_store_dwordx4 v[20:23], v11, s[8:11], s36 offen sc1
    s_add_u32 s36, s24, 0x4106000
    buffer_store_dwordx4 v[20:23], v11, s[8:11], s36 offen sc1
    s_add_u32 s36, s24, 0x4107000
    buffer_store_dwordx4 v[20:23], v11, s[8:11], s36 offen sc1
    s_waitcnt vmcnt(0)
    s_barrier
    v_cmp_ne_u32 vcc, 0, v0
    v_mov_b32 v15, 0x40000000
    v_mov_b32 v14, 1
    v_cndmask_b32 v15, v0, v15, vcc
    buffer_store_dword v14, v15, s[8:11], s25 offen sc1
    s_lshl_b32 s25, s22, 7
    s_lshl_b32 s36, s20, 2
    s_add_u32 s36, s36, s25
    s_add_u32 s36, s36, 0x192000
    v_cmp_ne_u32 vcc, 0, v0
    v_mov_b32 v15, 0x40000000
    v_mov_b32 v14, 1
    v_cndmask_b32 v15, v0, v15, vcc
    buffer_store_dword v14, v15, s[8:11], s36 offen sc1
    s_mov_b32 s96, s54
    s_and_b32 s97, s55, 0xffff
    s_mov_b32 s98, 0x400000
    s_mov_b32 s99, 0x20000
    v_mov_b32 v15, 0x0
    v_bfe_u32 v14, v0, 0, 1
    s_mov_b32 s38, 0x10
    v_mad_u32_u24 v15, v14, s38, v15
    v_bfe_u32 v14, v0, 1, 1
    s_mov_b32 s38, 0x20
    v_mad_u32_u24 v15, v14, s38, v15
    v_bfe_u32 v14, v0, 2, 1
    s_mov_b32 s38, 0x40
    v_mad_u32_u24 v15, v14, s38, v15
    v_bfe_u32 v14, v0, 3, 1
    s_mov_b32 s38, 0x80
    v_mad_u32_u24 v15, v14, s38, v15
    v_bfe_u32 v14, v0, 4, 1
    s_mov_b32 s38, 0x1000
    v_mad_u32_u24 v15, v14, s38, v15
    v_bfe_u32 v14, v0, 5, 1
    s_mov_b32 s38, 0x2000
    v_mad_u32_u24 v15, v14, s38, v15
    v_bfe_u32 v14, v0, 6, 1
    s_mov_b32 s38, 0x100
    v_mad_u32_u24 v15, v14, s38, v15
    v_bfe_u32 v14, v0, 7, 1
    s_mov_b32 s38, 0x200
    v_mad_u32_u24 v15, v14, s38, v15
    s_lshl_b32 s36, s20, 17
    s_add_u32 s37, s36, 0x0
    buffer_load_dwordx4 v[16:19], v15, s[96:99], s37 offen
    s_add_u32 s37, s36, 0x4000
    buffer_load_dwordx4 v[20:23], v15, s[96:99], s37 offen
    s_add_u32 s37, s36, 0x400
    buffer_load_dwordx4 v[24:27], v15, s[96:99], s37 offen
    s_add_u32 s37, s36, 0x4400
    buffer_load_dwordx4 v[28:31], v15, s[96:99], s37 offen
    s_add_u32 s37, s36, 0x800
    buffer_load_dwordx4 v[32:35], v15, s[96:99], s37 offen
    s_add_u32 s37, s36, 0x4800
    buffer_load_dwordx4 v[36:39], v15, s[96:99], s37 offen
    s_add_u32 s37, s36, 0xc00
    buffer_load_dwordx4 v[40:43], v15, s[96:99], s37 offen
    s_add_u32 s37, s36, 0x4c00
    buffer_load_dwordx4 v[44:47], v15, s[96:99], s37 offen
    s_add_u32 s37, s36, 0x8000
    buffer_load_dwordx4 v[48:51], v15, s[96:99], s37 offen
    s_add_u32 s37, s36, 0xc000
    buffer_load_dwordx4 v[52:55], v15, s[96:99], s37 offen
    s_add_u32 s37, s36, 0x8400
    buffer_load_dwordx4 v[56:59], v15, s[96:99], s37 offen
    s_add_u32 s37, s36, 0xc400
    buffer_load_dwordx4 v[60:63], v15, s[96:99], s37 offen
    s_add_u32 s37, s36, 0x8800
    buffer_load_dwordx4 v[64:67], v15, s[96:99], s37 offen
    s_add_u32 s37, s36, 0xc800
    buffer_load_dwordx4 v[68:71], v15, s[96:99], s37 offen
    s_add_u32 s37, s36, 0x8c00
    buffer_load_dwordx4 v[72:75], v15, s[96:99], s37 offen
    s_add_u32 s37, s36, 0xcc00
    buffer_load_dwordx4 v[76:79], v15, s[96:99], s37 offen
    s_add_u32 s37, s36, 0x10000
    buffer_load_dwordx4 v[80:83], v15, s[96:99], s37 offen
    s_add_u32 s37, s36, 0x14000
    buffer_load_dwordx4 v[84:87], v15, s[96:99], s37 offen
    s_add_u32 s37, s36, 0x10400
    buffer_load_dwordx4 v[88:91], v15, s[96:99], s37 offen
    s_add_u32 s37, s36, 0x14400
    buffer_load_dwordx4 v[92:95], v15, s[96:99], s37 offen
    s_add_u32 s37, s36, 0x10800
    buffer_load_dwordx4 v[96:99], v15, s[96:99], s37 offen
    s_add_u32 s37, s36, 0x14800
    buffer_load_dwordx4 v[100:103], v15, s[96:99], s37 offen
    s_add_u32 s37, s36, 0x10c00
    buffer_load_dwordx4 v[104:107], v15, s[96:99], s37 offen
    s_add_u32 s37, s36, 0x14c00
    buffer_load_dwordx4 v[108:111], v15, s[96:99], s37 offen
    s_waitcnt vmcnt(16)
    v_perm_b32 v112, v20, v16, s34
    v_perm_b32 v113, v28, v24, s34
    v_perm_b32 v114, v36, v32, s34
    v_perm_b32 v115, v44, v40, s34
    ds_write_b128 v7, v[112:115] offset:0
    v_perm_b32 v116, v20, v16, s35
    v_perm_b32 v117, v28, v24, s35
    v_perm_b32 v118, v36, v32, s35
    v_perm_b32 v119, v44, v40, s35
    ds_write_b128 v7, v[116:119] offset:1024
    v_perm_b32 v120, v21, v17, s34
    v_perm_b32 v121, v29, v25, s34
    v_perm_b32 v122, v37, v33, s34
    v_perm_b32 v123, v45, v41, s34
    ds_write_b128 v7, v[120:123] offset:2048
    v_perm_b32 v124, v21, v17, s35
    v_perm_b32 v125, v29, v25, s35
    v_perm_b32 v126, v37, v33, s35
    v_perm_b32 v127, v45, v41, s35
    ds_write_b128 v7, v[124:127] offset:3072
    s_waitcnt lgkmcnt(0)
    v_perm_b32 v112, v22, v18, s34
    v_perm_b32 v113, v30, v26, s34
    v_perm_b32 v114, v38, v34, s34
    v_perm_b32 v115, v46, v42, s34
    ds_write_b128 v7, v[112:115] offset:4096
    v_perm_b32 v116, v22, v18, s35
    v_perm_b32 v117, v30, v26, s35
    v_perm_b32 v118, v38, v34, s35
    v_perm_b32 v119, v46, v42, s35
    ds_write_b128 v7, v[116:119] offset:5120
    v_perm_b32 v120, v23, v19, s34
    v_perm_b32 v121, v31, v27, s34
    v_perm_b32 v122, v39, v35, s34
    v_perm_b32 v123, v47, v43, s34
    ds_write_b128 v7, v[120:123] offset:6144
    v_perm_b32 v124, v23, v19, s35
    v_perm_b32 v125, v31, v27, s35
    v_perm_b32 v126, v39, v35, s35
    v_perm_b32 v127, v47, v43, s35
    ds_write_b128 v7, v[124:127] offset:7168
    s_waitcnt lgkmcnt(0)
    s_add_u32 s37, s36, 0x18000
    buffer_load_dwordx4 v[16:19], v15, s[96:99], s37 offen
    s_add_u32 s37, s36, 0x1c000
    buffer_load_dwordx4 v[20:23], v15, s[96:99], s37 offen
    s_add_u32 s37, s36, 0x18400
    buffer_load_dwordx4 v[24:27], v15, s[96:99], s37 offen
    s_add_u32 s37, s36, 0x1c400
    buffer_load_dwordx4 v[28:31], v15, s[96:99], s37 offen
    s_add_u32 s37, s36, 0x18800
    buffer_load_dwordx4 v[32:35], v15, s[96:99], s37 offen
    s_add_u32 s37, s36, 0x1c800
    buffer_load_dwordx4 v[36:39], v15, s[96:99], s37 offen
    s_add_u32 s37, s36, 0x18c00
    buffer_load_dwordx4 v[40:43], v15, s[96:99], s37 offen
    s_add_u32 s37, s36, 0x1cc00
    buffer_load_dwordx4 v[44:47], v15, s[96:99], s37 offen
    s_waitcnt vmcnt(16)
    v_perm_b32 v112, v52, v48, s34
    v_perm_b32 v113, v60, v56, s34
    v_perm_b32 v114, v68, v64, s34
    v_perm_b32 v115, v76, v72, s34
    ds_write_b128 v7, v[112:115] offset:8192
    v_perm_b32 v116, v52, v48, s35
    v_perm_b32 v117, v60, v56, s35
    v_perm_b32 v118, v68, v64, s35
    v_perm_b32 v119, v76, v72, s35
    ds_write_b128 v7, v[116:119] offset:9216
    v_perm_b32 v120, v53, v49, s34
    v_perm_b32 v121, v61, v57, s34
    v_perm_b32 v122, v69, v65, s34
    v_perm_b32 v123, v77, v73, s34
    ds_write_b128 v7, v[120:123] offset:10240
    v_perm_b32 v124, v53, v49, s35
    v_perm_b32 v125, v61, v57, s35
    v_perm_b32 v126, v69, v65, s35
    v_perm_b32 v127, v77, v73, s35
    ds_write_b128 v7, v[124:127] offset:11264
    s_waitcnt lgkmcnt(0)
    v_perm_b32 v112, v54, v50, s34
    v_perm_b32 v113, v62, v58, s34
    v_perm_b32 v114, v70, v66, s34
    v_perm_b32 v115, v78, v74, s34
    ds_write_b128 v7, v[112:115] offset:12288
    v_perm_b32 v116, v54, v50, s35
    v_perm_b32 v117, v62, v58, s35
    v_perm_b32 v118, v70, v66, s35
    v_perm_b32 v119, v78, v74, s35
    ds_write_b128 v7, v[116:119] offset:13312
    v_perm_b32 v120, v55, v51, s34
    v_perm_b32 v121, v63, v59, s34
    v_perm_b32 v122, v71, v67, s34
    v_perm_b32 v123, v79, v75, s34
    ds_write_b128 v7, v[120:123] offset:14336
    v_perm_b32 v124, v55, v51, s35
    v_perm_b32 v125, v63, v59, s35
    v_perm_b32 v126, v71, v67, s35
    v_perm_b32 v127, v79, v75, s35
    ds_write_b128 v7, v[124:127] offset:15360
    s_waitcnt lgkmcnt(0)
    s_waitcnt vmcnt(8)
    v_perm_b32 v112, v84, v80, s34
    v_perm_b32 v113, v92, v88, s34
    v_perm_b32 v114, v100, v96, s34
    v_perm_b32 v115, v108, v104, s34
    ds_write_b128 v7, v[112:115] offset:16384
    v_perm_b32 v116, v84, v80, s35
    v_perm_b32 v117, v92, v88, s35
    v_perm_b32 v118, v100, v96, s35
    v_perm_b32 v119, v108, v104, s35
    ds_write_b128 v7, v[116:119] offset:17408
    v_perm_b32 v120, v85, v81, s34
    v_perm_b32 v121, v93, v89, s34
    v_perm_b32 v122, v101, v97, s34
    v_perm_b32 v123, v109, v105, s34
    ds_write_b128 v7, v[120:123] offset:18432
    v_perm_b32 v124, v85, v81, s35
    v_perm_b32 v125, v93, v89, s35
    v_perm_b32 v126, v101, v97, s35
    v_perm_b32 v127, v109, v105, s35
    ds_write_b128 v7, v[124:127] offset:19456
    s_waitcnt lgkmcnt(0)
    v_perm_b32 v112, v86, v82, s34
    v_perm_b32 v113, v94, v90, s34
    v_perm_b32 v114, v102, v98, s34
    v_perm_b32 v115, v110, v106, s34
    ds_write_b128 v7, v[112:115] offset:20480
    v_perm_b32 v116, v86, v82, s35
    v_perm_b32 v117, v94, v90, s35
    v_perm_b32 v118, v102, v98, s35
    v_perm_b32 v119, v110, v106, s35
    ds_write_b128 v7, v[116:119] offset:21504
    v_perm_b32 v120, v87, v83, s34
    v_perm_b32 v121, v95, v91, s34
    v_perm_b32 v122, v103, v99, s34
    v_perm_b32 v123, v111, v107, s34
    ds_write_b128 v7, v[120:123] offset:22528
    v_perm_b32 v124, v87, v83, s35
    v_perm_b32 v125, v95, v91, s35
    v_perm_b32 v126, v103, v99, s35
    v_perm_b32 v127, v111, v107, s35
    ds_write_b128 v7, v[124:127] offset:23552
    s_waitcnt lgkmcnt(0)
    s_waitcnt vmcnt(0)
    v_perm_b32 v112, v20, v16, s34
    v_perm_b32 v113, v28, v24, s34
    v_perm_b32 v114, v36, v32, s34
    v_perm_b32 v115, v44, v40, s34
    ds_write_b128 v7, v[112:115] offset:24576
    v_perm_b32 v116, v20, v16, s35
    v_perm_b32 v117, v28, v24, s35
    v_perm_b32 v118, v36, v32, s35
    v_perm_b32 v119, v44, v40, s35
    ds_write_b128 v7, v[116:119] offset:25600
    v_perm_b32 v120, v21, v17, s34
    v_perm_b32 v121, v29, v25, s34
    v_perm_b32 v122, v37, v33, s34
    v_perm_b32 v123, v45, v41, s34
    ds_write_b128 v7, v[120:123] offset:26624
    v_perm_b32 v124, v21, v17, s35
    v_perm_b32 v125, v29, v25, s35
    v_perm_b32 v126, v37, v33, s35
    v_perm_b32 v127, v45, v41, s35
    ds_write_b128 v7, v[124:127] offset:27648
    s_waitcnt lgkmcnt(0)
    v_perm_b32 v112, v22, v18, s34
    v_perm_b32 v113, v30, v26, s34
    v_perm_b32 v114, v38, v34, s34
    v_perm_b32 v115, v46, v42, s34
    ds_write_b128 v7, v[112:115] offset:28672
    v_perm_b32 v116, v22, v18, s35
    v_perm_b32 v117, v30, v26, s35
    v_perm_b32 v118, v38, v34, s35
    v_perm_b32 v119, v46, v42, s35
    ds_write_b128 v7, v[116:119] offset:29696
    v_perm_b32 v120, v23, v19, s34
    v_perm_b32 v121, v31, v27, s34
    v_perm_b32 v122, v39, v35, s34
    v_perm_b32 v123, v47, v43, s34
    ds_write_b128 v7, v[120:123] offset:30720
    v_perm_b32 v124, v23, v19, s35
    v_perm_b32 v125, v31, v27, s35
    v_perm_b32 v126, v39, v35, s35
    v_perm_b32 v127, v47, v43, s35
    ds_write_b128 v7, v[124:127] offset:31744
    s_waitcnt lgkmcnt(0)
    s_lshl_b32 s25, s22, 7
    s_add_u32 s25, s25, 0x192000
    v_lshrrev_b32 v15, 2, v1
    v_and_b32 v15, 127, v15
L_TPI:
    buffer_load_dword v14, v15, s[8:11], s25 offen sc1
    s_add_u32 s32, s32, 1
    s_cmp_gt_u32 s32, 200000
    s_waitcnt vmcnt(0)
    s_cbranch_scc1 L_TPI_ok
    v_cmp_eq_u32 vcc, 0, v14
    s_cbranch_vccz L_TPI_ok
    s_sleep 8
    s_branch L_TPI
L_TPI_ok:
    s_mov_b32 s23, s22
    s_mov_b32 s29, 0
    s_mov_b32 s30, 0x40000000
    s_mul_i32 s24, s23, 0x82100
    s_lshl_b32 s36, s20, 14
    s_add_u32 s24, s24, s36
    s_add_u32 s24, s24, 0x1000000
    s_add_u32 s36, s24, 0
    s_add_u32 s37, s36, 0x7000000
    buffer_load_dwordx4 a[32:35], v1, s[8:11], s36 offen offset:0 sc1
    buffer_load_dwordx4 a[0:3], v1, s[8:11], s37 offen offset:0 sc1
    buffer_load_dwordx4 a[36:39], v1, s[8:11], s36 offen offset:1024 sc1
    buffer_load_dwordx4 a[4:7], v1, s[8:11], s37 offen offset:1024 sc1
    buffer_load_dwordx4 a[40:43], v1, s[8:11], s36 offen offset:2048 sc1
    buffer_load_dwordx4 a[8:11], v1, s[8:11], s37 offen offset:2048 sc1
    buffer_load_dwordx4 a[44:47], v1, s[8:11], s36 offen offset:3072 sc1
    buffer_load_dwordx4 a[12:15], v1, s[8:11], s37 offen offset:3072 sc1
    s_add_u32 s36, s24, 4096
    s_add_u32 s37, s36, 0x7000000
    buffer_load_dwordx4 a[48:51], v1, s[8:11], s36 offen offset:0 sc1
    buffer_load_dwordx4 a[16:19], v1, s[8:11], s37 offen offset:0 sc1
    buffer_load_dwordx4 a[52:55], v1, s[8:11], s36 offen offset:1024 sc1
    buffer_load_dwordx4 a[20:23], v1, s[8:11], s37 offen offset:1024 sc1
    buffer_load_dwordx4 a[56:59], v1, s[8:11], s36 offen offset:2048 sc1
    buffer_load_dwordx4 a[24:27], v1, s[8:11], s37 offen offset:2048 sc1
    buffer_load_dwordx4 a[60:63], v1, s[8:11], s36 offen offset:3072 sc1
    buffer_load_dwordx4 a[28:31], v1, s[8:11], s37 offen offset:3072 sc1
    s_lshr_b32 s36, s21, 1
    s_lshl_b32 s36, s36, 3
    s_xor_b32 s37, s36, 8
    s_add_u32 s24, s24, 8192
    s_add_u32 s36, s36, s24
    s_add_u32 s37, s37, s24
    buffer_load_dwordx2 a[64:65], v2, s[8:11], s36 offen offset:0 sc1
    buffer_load_dwordx2 a[66:67], v2, s[8:11], s37 offen offset:0 sc1
    buffer_load_dwordx2 a[68:69], v2, s[8:11], s36 offen offset:1024 sc1
    buffer_load_dwordx2 a[70:71], v2, s[8:11], s37 offen offset:1024 sc1
L_P2:
    s_and_b32 s36, s29, 1
    s_lshl_b32 s36, s36, 20
    s_lshl_b32 s26, s22, 21
    s_add_u32 s26, s26, s36
    s_add_u32 s26, s26, 0x4000000
    s_bfe_u32 s27, s29, 0x10001
    s_lshl_b32 s24, s23, 13
    s_add_u32 s24, s24, 0x100000
    s_max_u32 s25, s23, 1
    s_lshl_b32 s25, s25, 13
    s_add_u32 s25, s25, 0xfe000
    buffer_load_dwordx4 v[48:51], v2, s[8:11], s24 offen sc1
    buffer_load_dwordx4 v[52:55], v2, s[8:11], s24 offen offset:1024 sc1
    s_lshl_b32 s36, s23, 5
    s_add_u32 s36, s36, s20
    s_lshl_b32 s36, s36, 10
    buffer_load_dword a72, v12, s[12:15], s36 offen
    buffer_load_dword a73, v12, s[92:95], 0 offen
    s_waitcnt vmcnt(4)
    v_cmp_ne_u32 vcc, 0, v1
    v_mov_b32 v15, 0x40000000
    v_mov_b32 v14, 0
    v_cndmask_b32 v15, v1, v15, vcc
    buffer_store_dword v14, v15, s[8:11], s30 offen sc1
    v_mfma_f32_16x16x32_bf16 v[80:83], a[32:35], a[0:3], 0
    v_mfma_f32_16x16x32_bf16 v[80:83], a[36:39], a[4:7], v[80:83]
    v_mfma_f32_16x16x32_bf16 v[80:83], a[40:43], a[8:11], v[80:83]
    v_mfma_f32_16x16x32_bf16 v[80:83], a[44:47], a[12:15], v[80:83]
    v_mfma_f32_16x16x32_bf16 v[88:91], a[48:51], a[16:19], 0
    v_mfma_f32_16x16x32_bf16 v[88:91], a[52:55], a[20:23], v[88:91]
    v_mfma_f32_16x16x32_bf16 v[88:91], a[56:59], a[24:27], v[88:91]
    v_mfma_f32_16x16x32_bf16 v[88:91], a[60:63], a[28:31], v[88:91]
    v_mfma_f32_16x16x32_bf16 v[84:87], a[32:35], a[16:19], 0
    v_mfma_f32_16x16x32_bf16 v[84:87], a[36:39], a[20:23], v[84:87]
    v_mfma_f32_16x16x32_bf16 v[84:87], a[40:43], a[24:27], v[84:87]
    v_mfma_f32_16x16x32_bf16 v[84:87], a[44:47], a[28:31], v[84:87]
    v_cndmask_b32 v80, v13, v80, s[64:65]
    v_cndmask_b32 v81, v13, v81, s[66:67]
    v_cndmask_b32 v82, v13, v82, s[68:69]
    v_cndmask_b32 v83, v13, v83, s[70:71]
    v_cndmask_b32 v88, v13, v88, s[64:65]
    v_cndmask_b32 v89, v13, v89, s[66:67]
    v_cndmask_b32 v90, v13, v90, s[68:69]
    v_cndmask_b32 v91, v13, v91, s[70:71]
    v_max_f32 v116, v80, v81
    v_max3_f32 v116, v116, v82, v83
    v_max_f32 v117, v84, v85
    v_max3_f32 v117, v117, v86, v87
    v_max3_f32 v117, v117, v88, v89
    v_max3_f32 v117, v117, v90, v91
    v_mov_b32 v14, v116
    s_nop 1
    v_permlane16_swap_b32 v116, v14
    v_max_f32 v116, v116, v14
    v_mov_b32 v14, v117
    s_nop 1
    v_permlane16_swap_b32 v117, v14
    v_max_f32 v117, v117, v14
    v_mov_b32 v14, v116
    s_nop 1
    v_permlane32_swap_b32 v116, v14
    v_max_f32 v116, v116, v14
    v_mov_b32 v14, v117
    s_nop 1
    v_permlane32_swap_b32 v117, v14
    v_max_f32 v117, v117, v14
    v_sub_f32 v80, v80, v116
    v_exp_f32 v80, v80
    v_sub_f32 v81, v81, v116
    v_exp_f32 v81, v81
    v_sub_f32 v82, v82, v116
    v_exp_f32 v82, v82
    v_sub_f32 v83, v83, v116
    v_exp_f32 v83, v83
    v_sub_f32 v84, v84, v117
    v_exp_f32 v84, v84
    v_sub_f32 v85, v85, v117
    v_exp_f32 v85, v85
    v_sub_f32 v86, v86, v117
    v_exp_f32 v86, v86
    v_sub_f32 v87, v87, v117
    v_exp_f32 v87, v87
    v_sub_f32 v88, v88, v117
    v_exp_f32 v88, v88
    v_sub_f32 v89, v89, v117
    v_exp_f32 v89, v89
    v_sub_f32 v90, v90, v117
    v_exp_f32 v90, v90
    v_sub_f32 v91, v91, v117
    v_exp_f32 v91, v91
    v_cvt_pk_bf16_f32 v100, v80, v81
    v_cvt_pk_bf16_f32 v101, v82, v83
    v_mov_b64 v[102:103], 0
    v_cvt_pk_bf16_f32 v104, v84, v85
    v_cvt_pk_bf16_f32 v105, v86, v87
    v_cvt_pk_bf16_f32 v106, v88, v89
    v_cvt_pk_bf16_f32 v107, v90, v91
    v_mov_b64 v[108:109], s[4:5]
    v_mov_b64 v[110:111], s[4:5]
    v_cndmask_b32 v112, 0, v108, s[72:73]
    v_cndmask_b32 v113, 0, v108, s[72:73]
    v_mfma_f32_16x16x32_bf16 v[16:19], v[108:111], v[100:103], 0
    v_mfma_f32_16x16x32_bf16 v[24:27], a[64:67], v[100:103], 0
    v_mfma_f32_16x16x32_bf16 v[28:31], a[68:71], v[100:103], 0
    v_mfma_f32_16x16x32_bf16 v[20:23], v[108:111], v[104:107], 0
    v_mfma_f32_16x16x32_bf16 v[32:35], a[64:67], v[104:107], 0
    v_mfma_f32_16x16x32_bf16 v[36:39], a[68:71], v[104:107], 0
    s_branch L_P2_chk
L_P2_far:
    buffer_load_dword v14, v2, s[8:11], s25 offen sc1
    s_add_u32 s32, s32, 1
    s_cmp_gt_u32 s32, 200000
    s_waitcnt vmcnt(0)
    s_cbranch_scc1 L_P2_poll
    v_cmp_eq_u32 vcc, -1, v14
    s_cbranch_vccz L_P2_near
    s_sleep 12
    s_branch L_P2_far
L_P2_near:
    s_mov_b32 s25, 0x40000000
L_P2_poll:
    buffer_load_dwordx4 v[48:51], v2, s[8:11], s24 offen sc1
    buffer_load_dwordx4 v[52:55], v2, s[8:11], s24 offen offset:1024 sc1
L_P2_chk:
    s_add_u32 s32, s32, 1
    s_waitcnt vmcnt(0)
    ds_write_b128 v2, v[48:51] offset:20480
    ds_write_b128 v2, v[52:55] offset:21504
    v_max3_u32 v14, v48, v49, v50
    v_max3_u32 v15, v51, v52, v53
    v_max3_u32 v14, v14, v54, v55
    v_max_u32 v14, v14, v15
    v_cmp_eq_u32 vcc, -1, v14
    s_cbranch_vccz L_P2_got
    s_cmp_gt_u32 s32, 200000
    s_cbranch_scc1 L_P2_got
    s_cmp_eq_u32 s25, 0x40000000
    s_cbranch_scc1 L_P2_poll
    s_branch L_P2_far
L_P2_got:
    s_waitcnt lgkmcnt(0)
    s_barrier
    ds_read_b128 v[48:51], v8 offset:0
    ds_read_b128 v[52:55], v8 offset:2048
    ds_read_b128 v[56:59], v8 offset:4096
    ds_read_b128 v[60:63], v8 offset:6144
    s_waitcnt lgkmcnt(3)
    v_mfma_f32_16x16x32_bf16 v[80:83], a[128:131], v[48:51], 0
    v_mfma_f32_16x16x32_bf16 v[84:87], a[132:135], v[48:51], 0
    ds_read_b128 v[48:51], v8 offset:512
    s_waitcnt lgkmcnt(3)
    v_mfma_f32_16x16x32_bf16 v[80:83], a[136:139], v[52:55], v[80:83]
    v_mfma_f32_16x16x32_bf16 v[84:87], a[140:143], v[52:55], v[84:87]
    ds_read_b128 v[52:55], v8 offset:2560
    s_waitcnt lgkmcnt(3)
    v_mfma_f32_16x16x32_bf16 v[80:83], a[144:147], v[56:59], v[80:83]
    v_mfma_f32_16x16x32_bf16 v[84:87], a[148:151], v[56:59], v[84:87]
    ds_read_b128 v[56:59], v8 offset:4608
    s_waitcnt lgkmcnt(3)
    v_mfma_f32_16x16x32_bf16 v[80:83], a[152:155], v[60:63], v[80:83]
    v_mfma_f32_16x16x32_bf16 v[84:87], a[156:159], v[60:63], v[84:87]
    ds_read_b128 v[60:63], v8 offset:6656
    s_waitcnt lgkmcnt(3)
    v_mfma_f32_16x16x32_bf16 v[80:83], a[160:163], v[48:51], v[80:83]
    v_mfma_f32_16x16x32_bf16 v[84:87], a[164:167], v[48:51], v[84:87]
    ds_read_b128 v[48:51], v8 offset:1024
    s_waitcnt lgkmcnt(3)
    v_mfma_f32_16x16x32_bf16 v[80:83], a[168:171], v[52:55], v[80:83]
    v_mfma_f32_16x16x32_bf16 v[84:87], a[172:175], v[52:55], v[84:87]
    ds_read_b128 v[52:55], v8 offset:3072
    s_waitcnt lgkmcnt(3)
    v_mfma_f32_16x16x32_bf16 v[80:83], a[176:179], v[56:59], v[80:83]
    v_mfma_f32_16x16x32_bf16 v[84:87], a[180:183], v[56:59], v[84:87]
    ds_read_b128 v[56:59], v8 offset:5120
    s_waitcnt lgkmcnt(3)
    v_mfma_f32_16x16x32_bf16 v[80:83], a[184:187], v[60:63], v[80:83]
    v_mfma_f32_16x16x32_bf16 v[84:87], a[188:191], v[60:63], v[84:87]
    ds_read_b128 v[60:63], v8 offset:7168
    s_waitcnt lgkmcnt(3)
    v_mfma_f32_16x16x32_bf16 v[80:83], a[192:195], v[48:51], v[80:83]
    v_mfma_f32_16x16x32_bf16 v[84:87], a[196:199], v[48:51], v[84:87]
    ds_read_b128 v[48:51], v8 offset:1536
    s_waitcnt lgkmcnt(3)
    v_mfma_f32_16x16x32_bf16 v[80:83], a[200:203], v[52:55], v[80:83]
    v_mfma_f32_16x16x32_bf16 v[84:87], a[204:207], v[52:55], v[84:87]
    ds_read_b128 v[52:55], v8 offset:3584
    s_waitcnt lgkmcnt(3)
    v_mfma_f32_16x16x32_bf16 v[80:83], a[208:211], v[56:59], v[80:83]
    v_mfma_f32_16x16x32_bf16 v[84:87], a[212:215], v[56:59], v[84:87]
    ds_read_b128 v[56:59], v8 offset:5632
    s_waitcnt lgkmcnt(3)
    v_mfma_f32_16x16x32_bf16 v[80:83], a[216:219], v[60:63], v[80:83]
    v_mfma_f32_16x16x32_bf16 v[84:87], a[220:223], v[60:63], v[84:87]
    ds_read_b128 v[60:63], v8 offset:7680
    s_waitcnt lgkmcnt(3)
    v_mfma_f32_16x16x32_bf16 v[80:83], a[224:227], v[48:51], v[80:83]
    v_mfma_f32_16x16x32_bf16 v[84:87], a[228:231], v[48:51], v[84:87]
    ds_read_b128 v[48:51], v8 offset:0
    s_waitcnt lgkmcnt(3)
    v_mfma_f32_16x16x32_bf16 v[80:83], a[232:235], v[52:55], v[80:83]
    v_mfma_f32_16x16x32_bf16 v[84:87], a[236:239], v[52:55], v[84:87]
    ds_read_b128 v[52:55], v8 offset:2048
    s_waitcnt lgkmcnt(3)
    v_mfma_f32_16x16x32_bf16 v[80:83], a[240:243], v[56:59], v[80:83]
    v_mfma_f32_16x16x32_bf16 v[84:87], a[244:247], v[56:59], v[84:87]
    ds_read_b128 v[56:59], v8 offset:4096
    s_waitcnt lgkmcnt(3)
    v_mfma_f32_16x16x32_bf16 v[80:83], a[248:251], v[60:63], v[80:83]
    v_mfma_f32_16x16x32_bf16 v[84:87], a[252:255], v[60:63], v[84:87]
    ds_read_b128 v[60:63], v8 offset:6144
    s_waitcnt lgkmcnt(3)
    v_mfma_f32_16x16x32_bf16 v[40:43], v[48:51], v[128:131], 0
    v_mfma_f32_16x16x32_bf16 v[44:47], v[48:51], v[132:135], 0
    ds_read_b128 v[48:51], v8 offset:512
    s_waitcnt lgkmcnt(3)
    v_mfma_f32_16x16x32_bf16 v[40:43], v[52:55], v[136:139], v[40:43]
    v_mfma_f32_16x16x32_bf16 v[44:47], v[52:55], v[140:143], v[44:47]
    ds_read_b128 v[52:55], v8 offset:2560
    s_waitcnt lgkmcnt(3)
    v_mfma_f32_16x16x32_bf16 v[40:43], v[56:59], v[144:147], v[40:43]
    v_mfma_f32_16x16x32_bf16 v[44:47], v[56:59], v[148:151], v[44:47]
    v_mul_f32 v80, s33, v80
    v_mul_f32 v81, s33, v81
    v_mul_f32 v82, s33, v82
    v_mul_f32 v83, s33, v83
    ds_read_b128 v[56:59], v8 offset:4608
    s_waitcnt lgkmcnt(3)
    v_mfma_f32_16x16x32_bf16 v[40:43], v[60:63], v[152:155], v[40:43]
    v_mfma_f32_16x16x32_bf16 v[44:47], v[60:63], v[156:159], v[44:47]
    v_mul_f32 v84, s33, v84
    v_mul_f32 v85, s33, v85
    v_mul_f32 v86, s33, v86
    v_mul_f32 v87, s33, v87
    ds_read_b128 v[60:63], v8 offset:6656
    s_waitcnt lgkmcnt(3)
    v_mfma_f32_16x16x32_bf16 v[40:43], v[48:51], v[160:163], v[40:43]
    v_mfma_f32_16x16x32_bf16 v[44:47], v[48:51], v[164:167], v[44:47]
    v_cvt_pk_bf16_f32 v88, v80, v84
    v_cvt_pk_bf16_f32 v89, v81, v85
    v_cvt_pk_bf16_f32 v90, v82, v86
    v_cvt_pk_bf16_f32 v91, v83, v87
    ds_write_b128 v9, v[88:91] offset:16384
    ds_read_b128 v[48:51], v8 offset:1024
    s_waitcnt lgkmcnt(4)
    v_mfma_f32_16x16x32_bf16 v[40:43], v[52:55], v[168:171], v[40:43]
    v_mfma_f32_16x16x32_bf16 v[44:47], v[52:55], v[172:175], v[44:47]
    ds_read_b128 v[52:55], v8 offset:3072
    s_waitcnt lgkmcnt(4)
    v_mfma_f32_16x16x32_bf16 v[40:43], v[56:59], v[176:179], v[40:43]
    v_mfma_f32_16x16x32_bf16 v[44:47], v[56:59], v[180:183], v[44:47]
    ds_read_b128 v[56:59], v8 offset:5120
    s_waitcnt lgkmcnt(4)
    v_mfma_f32_16x16x32_bf16 v[40:43], v[60:63], v[184:187], v[40:43]
    v_mfma_f32_16x16x32_bf16 v[44:47], v[60:63], v[188:191], v[44:47]
    s_waitcnt lgkmcnt(3)
    s_barrier
    ds_read_b128 v[64:67], v1 offset:16384
    ds_read_b128 v[68:71], v1 offset:17408
    ds_read_b128 v[72:75], v1 offset:18432
    ds_read_b128 v[76:79], v1 offset:19456
    ds_read_b128 v[60:63], v8 offset:7168
    s_waitcnt lgkmcnt(7)
    v_mfma_f32_16x16x32_bf16 v[40:43], v[48:51], v[192:195], v[40:43]
    v_mfma_f32_16x16x32_bf16 v[44:47], v[48:51], v[196:199], v[44:47]
    ds_read_b128 v[48:51], v8 offset:1536
    s_waitcnt lgkmcnt(7)
    v_mfma_f32_16x16x32_bf16 v[40:43], v[52:55], v[200:203], v[40:43]
    v_mfma_f32_16x16x32_bf16 v[44:47], v[52:55], v[204:207], v[44:47]
    s_waitcnt lgkmcnt(2)
    v_mfma_f32_16x16x32_bf16 v[92:95], v[64:67], a[0:3], 0
    v_mfma_f32_16x16x32_bf16 v[96:99], v[64:67], a[16:19], 0
    v_mfma_f32_16x16x32_bf16 v[92:95], v[68:71], a[4:7], v[92:95]
    v_mfma_f32_16x16x32_bf16 v[96:99], v[68:71], a[20:23], v[96:99]
    v_mfma_f32_16x16x32_bf16 v[92:95], v[72:75], a[8:11], v[92:95]
    v_mfma_f32_16x16x32_bf16 v[96:99], v[72:75], a[24:27], v[96:99]
    v_mfma_f32_16x16x32_bf16 v[92:95], v[76:79], a[12:15], v[92:95]
    v_mfma_f32_16x16x32_bf16 v[96:99], v[76:79], a[28:31], v[96:99]
    ds_read_b128 v[52:55], v8 offset:3584
    s_waitcnt lgkmcnt(3)
    v_mfma_f32_16x16x32_bf16 v[40:43], v[56:59], v[208:211], v[40:43]
    v_mfma_f32_16x16x32_bf16 v[44:47], v[56:59], v[212:215], v[44:47]
    ds_read_b128 v[56:59], v8 offset:5632
    s_waitcnt lgkmcnt(3)
    v_mfma_f32_16x16x32_bf16 v[40:43], v[60:63], v[216:219], v[40:43]
    v_mfma_f32_16x16x32_bf16 v[44:47], v[60:63], v[220:223], v[44:47]
    v_max3_f32 v118, v92, v93, v94
    v_max3_f32 v118, v118, v95, v116
    v_max3_f32 v119, v96, v97, v98
    v_max3_f32 v119, v119, v99, v117
    v_mov_b32 v14, v118
    v_mov_b32 v15, v119
    ds_read_b128 v[60:63], v8 offset:7680
    s_waitcnt lgkmcnt(3)
    v_mfma_f32_16x16x32_bf16 v[40:43], v[48:51], v[224:227], v[40:43]
    v_mfma_f32_16x16x32_bf16 v[44:47], v[48:51], v[228:231], v[44:47]
    v_permlane16_swap_b32 v118, v14
    v_permlane16_swap_b32 v119, v15
    v_max_f32 v118, v118, v14
    v_max_f32 v119, v119, v15
    v_sub_f32 v92, v92, v118
    v_exp_f32 v92, v92
    s_waitcnt lgkmcnt(2)
    v_mfma_f32_16x16x32_bf16 v[40:43], v[52:55], v[232:235], v[40:43]
    v_mfma_f32_16x16x32_bf16 v[44:47], v[52:55], v[236:239], v[44:47]
    v_sub_f32 v93, v93, v118
    v_exp_f32 v93, v93
    v_sub_f32 v94, v94, v118
    v_exp_f32 v94, v94
    v_sub_f32 v95, v95, v118
    v_exp_f32 v95, v95
    s_waitcnt lgkmcnt(1)
    v_mfma_f32_16x16x32_bf16 v[40:43], v[56:59], v[240:243], v[40:43]
    v_mfma_f32_16x16x32_bf16 v[44:47], v[56:59], v[244:247], v[44:47]
    v_sub_f32 v104, v116, v118
    v_exp_f32 v104, v104
    v_cvt_pk_bf16_f32 v100, v92, v93
    v_cvt_pk_bf16_f32 v101, v94, v95
    v_sub_f32 v96, v96, v119
    v_exp_f32 v96, v96
    s_waitcnt lgkmcnt(0)
    v_mfma_f32_16x16x32_bf16 v[40:43], v[60:63], v[248:251], v[40:43]
    v_mfma_f32_16x16x32_bf16 v[44:47], v[60:63], v[252:255], v[44:47]
    v_sub_f32 v97, v97, v119
    v_exp_f32 v97, v97
    v_sub_f32 v98, v98, v119
    v_exp_f32 v98, v98
    v_sub_f32 v99, v99, v119
    v_exp_f32 v99, v99
    v_sub_f32 v105, v117, v119
    v_exp_f32 v105, v105
    v_cvt_pk_bf16_f32 v102, v96, v97
    v_cvt_pk_bf16_f32 v103, v98, v99
    v_mfma_f32_16x16x16_bf16 v[48:51], v[112:113], v[100:101], 0
    s_nop 0
    v_mfma_f32_16x16x16_bf16 v[52:55], v[112:113], v[102:103], 0
    v_cvt_pk_bf16_f32 v80, v40, v41
    v_cndmask_b32 v80, 0, v80, s[72:73]
    v_cvt_pk_bf16_f32 v81, v42, v43
    v_cndmask_b32 v81, 0, v81, s[72:73]
    v_cvt_pk_bf16_f32 v82, v44, v45
    v_cndmask_b32 v82, 0, v82, s[72:73]
    v_cvt_pk_bf16_f32 v83, v46, v47
    v_cndmask_b32 v83, 0, v83, s[72:73]
    v_mfma_f32_16x16x16_bf16 v[56:59], v[80:81], v[100:101], 0
    s_nop 0
    v_mfma_f32_16x16x16_bf16 v[60:63], v[82:83], v[100:101], 0
    v_mfma_f32_16x16x16_bf16 v[64:67], v[80:81], v[102:103], 0
    v_mfma_f32_16x16x16_bf16 v[68:71], v[82:83], v[102:103], 0
    v_fma_f32 v48, v16, v104, v48
    v_rcp_f32 v48, v48
    v_fma_f32 v52, v20, v105, v52
    v_rcp_f32 v52, v52
    v_fma_f32 v56, v24, v104, v56
    v_fma_f32 v57, v25, v104, v57
    v_fma_f32 v58, v26, v104, v58
    v_fma_f32 v59, v27, v104, v59
    v_fma_f32 v60, v28, v104, v60
    v_fma_f32 v61, v29, v104, v61
    v_fma_f32 v62, v30, v104, v62
    v_fma_f32 v63, v31, v104, v63
    v_pk_mul_f32 v[56:57], v[56:57], v[48:49] op_sel_hi:[1,0]
    v_pk_mul_f32 v[58:59], v[58:59], v[48:49] op_sel_hi:[1,0]
    v_pk_mul_f32 v[60:61], v[60:61], v[48:49] op_sel_hi:[1,0]
    v_pk_mul_f32 v[62:63], v[62:63], v[48:49] op_sel_hi:[1,0]
    v_cvt_pk_bf16_f32 v72, v56, v60
    v_cvt_pk_bf16_f32 v73, v57, v61
    v_cvt_pk_bf16_f32 v74, v58, v62
    v_cvt_pk_bf16_f32 v75, v59, v63
    ds_write_b128 v9, v[72:75] offset:0
    v_fma_f32 v64, v32, v105, v64
    v_fma_f32 v65, v33, v105, v65
    v_fma_f32 v66, v34, v105, v66
    v_fma_f32 v67, v35, v105, v67
    v_fma_f32 v68, v36, v105, v68
    v_fma_f32 v69, v37, v105, v69
    v_fma_f32 v70, v38, v105, v70
    v_fma_f32 v71, v39, v105, v71
    v_pk_mul_f32 v[64:65], v[64:65], v[52:53] op_sel_hi:[1,0]
    v_pk_mul_f32 v[66:67], v[66:67], v[52:53] op_sel_hi:[1,0]
    v_pk_mul_f32 v[68:69], v[68:69], v[52:53] op_sel_hi:[1,0]
    v_pk_mul_f32 v[70:71], v[70:71], v[52:53] op_sel_hi:[1,0]
    v_cvt_pk_bf16_f32 v76, v64, v68
    v_cvt_pk_bf16_f32 v77, v65, v69
    v_cvt_pk_bf16_f32 v78, v66, v70
    v_cvt_pk_bf16_f32 v79, v67, v71
    ds_write_b128 v9, v[76:79] offset:4096
    s_waitcnt lgkmcnt(0)
    s_barrier
    ds_read_b128 v[16:19], v1 offset:0
    ds_read_b128 v[20:23], v1 offset:1024
    ds_read_b128 v[24:27], v1 offset:2048
    ds_read_b128 v[28:31], v1 offset:3072
    ds_read_b128 v[32:35], v1 offset:4096
    ds_read_b128 v[36:39], v1 offset:5120
    ds_read_b128 v[40:43], v1 offset:6144
    ds_read_b128 v[44:47], v1 offset:7168
    ds_read_b128 v[48:51], v7 offset:0
    ds_read_b128 v[52:55], v7 offset:1024
    ds_read_b128 v[56:59], v7 offset:2048
    s_lshl_b32 s36, s20, 10
    s_add_u32 s25, s26, s36
    s_waitcnt lgkmcnt(2)
    v_mfma_f32_16x16x32_bf16 v[64:67], v[16:19], v[48:51], 0
    ds_read_b128 v[60:63], v7 offset:3072
    s_waitcnt lgkmcnt(2)
    v_mfma_f32_16x16x32_bf16 v[68:71], v[16:19], v[52:55], 0
    ds_read_b128 v[48:51], v7 offset:4096
    s_waitcnt lgkmcnt(2)
    v_mfma_f32_16x16x32_bf16 v[72:75], v[16:19], v[56:59], 0
    ds_read_b128 v[52:55], v7 offset:5120
    s_waitcnt lgkmcnt(2)
    v_mfma_f32_16x16x32_bf16 v[76:79], v[16:19], v[60:63], 0
    ds_read_b128 v[56:59], v7 offset:6144
    s_waitcnt lgkmcnt(2)
    v_mfma_f32_16x16x32_bf16 v[80:83], v[16:19], v[48:51], 0
    ds_read_b128 v[60:63], v7 offset:7168
    s_waitcnt lgkmcnt(2)
    v_mfma_f32_16x16x32_bf16 v[84:87], v[16:19], v[52:55], 0
    ds_read_b128 v[48:51], v7 offset:8192
    s_waitcnt lgkmcnt(2)
    v_mfma_f32_16x16x32_bf16 v[88:91], v[16:19], v[56:59], 0
    ds_read_b128 v[52:55], v7 offset:9216
    s_waitcnt lgkmcnt(2)
    v_mfma_f32_16x16x32_bf16 v[92:95], v[16:19], v[60:63], 0
    ds_read_b128 v[56:59], v7 offset:10240
    s_waitcnt lgkmcnt(2)
    v_mfma_f32_16x16x32_bf16 v[64:67], v[20:23], v[48:51], v[64:67]
    ds_read_b128 v[60:63], v7 offset:11264
    s_waitcnt lgkmcnt(2)
    v_mfma_f32_16x16x32_bf16 v[68:71], v[20:23], v[52:55], v[68:71]
    ds_read_b128 v[48:51], v7 offset:12288
    s_waitcnt lgkmcnt(2)
    v_mfma_f32_16x16x32_bf16 v[72:75], v[20:23], v[56:59], v[72:75]
    ds_read_b128 v[52:55], v7 offset:13312
    s_waitcnt lgkmcnt(2)
    v_mfma_f32_16x16x32_bf16 v[76:79], v[20:23], v[60:63], v[76:79]
    ds_read_b128 v[56:59], v7 offset:14336
    s_waitcnt lgkmcnt(2)
    v_mfma_f32_16x16x32_bf16 v[80:83], v[20:23], v[48:51], v[80:83]
    ds_read_b128 v[60:63], v7 offset:15360
    s_waitcnt lgkmcnt(2)
    v_mfma_f32_16x16x32_bf16 v[84:87], v[20:23], v[52:55], v[84:87]
    ds_read_b128 v[48:51], v7 offset:16384
    s_waitcnt lgkmcnt(2)
    v_mfma_f32_16x16x32_bf16 v[88:91], v[20:23], v[56:59], v[88:91]
    ds_read_b128 v[52:55], v7 offset:17408
    s_waitcnt lgkmcnt(2)
    v_mfma_f32_16x16x32_bf16 v[92:95], v[20:23], v[60:63], v[92:95]
    ds_read_b128 v[56:59], v7 offset:18432
    s_waitcnt lgkmcnt(2)
    v_mfma_f32_16x16x32_bf16 v[64:67], v[24:27], v[48:51], v[64:67]
    ds_read_b128 v[60:63], v7 offset:19456
    s_waitcnt lgkmcnt(2)
    v_mfma_f32_16x16x32_bf16 v[68:71], v[24:27], v[52:55], v[68:71]
    ds_read_b128 v[48:51], v7 offset:20480
    s_waitcnt lgkmcnt(2)
    v_mfma_f32_16x16x32_bf16 v[72:75], v[24:27], v[56:59], v[72:75]
    ds_read_b128 v[52:55], v7 offset:21504
    s_waitcnt lgkmcnt(2)
    v_mfma_f32_16x16x32_bf16 v[76:79], v[24:27], v[60:63], v[76:79]
    ds_read_b128 v[56:59], v7 offset:22528
    s_waitcnt lgkmcnt(2)
    v_mfma_f32_16x16x32_bf16 v[80:83], v[24:27], v[48:51], v[80:83]
    ds_read_b128 v[60:63], v7 offset:23552
    s_waitcnt lgkmcnt(2)
    v_mfma_f32_16x16x32_bf16 v[84:87], v[24:27], v[52:55], v[84:87]
    ds_read_b128 v[48:51], v7 offset:24576
    s_waitcnt lgkmcnt(2)
    v_mfma_f32_16x16x32_bf16 v[88:91], v[24:27], v[56:59], v[88:91]
    ds_read_b128 v[52:55], v7 offset:25600
    s_waitcnt lgkmcnt(2)
    v_mfma_f32_16x16x32_bf16 v[92:95], v[24:27], v[60:63], v[92:95]
    ds_read_b128 v[56:59], v7 offset:26624
    s_waitcnt lgkmcnt(2)
    v_mfma_f32_16x16x32_bf16 v[64:67], v[28:31], v[48:51], v[64:67]
    ds_read_b128 v[60:63], v7 offset:27648
    s_waitcnt lgkmcnt(2)
    v_mfma_f32_16x16x32_bf16 v[68:71], v[28:31], v[52:55], v[68:71]
    ds_read_b128 v[48:51], v7 offset:28672
    s_waitcnt lgkmcnt(2)
    v_mfma_f32_16x16x32_bf16 v[72:75], v[28:31], v[56:59], v[72:75]
    ds_read_b128 v[52:55], v7 offset:29696
    s_waitcnt lgkmcnt(2)
    v_mfma_f32_16x16x32_bf16 v[76:79], v[28:31], v[60:63], v[76:79]
    ds_read_b128 v[56:59], v7 offset:30720
    s_waitcnt lgkmcnt(2)
    v_mfma_f32_16x16x32_bf16 v[80:83], v[28:31], v[48:51], v[80:83]
    ds_read_b128 v[60:63], v7 offset:31744
    s_waitcnt lgkmcnt(2)
    v_mfma_f32_16x16x32_bf16 v[84:87], v[28:31], v[52:55], v[84:87]
    ds_read_b128 v[48:51], v7 offset:0
    s_waitcnt lgkmcnt(2)
    v_mfma_f32_16x16x32_bf16 v[88:91], v[28:31], v[56:59], v[88:91]
    ds_read_b128 v[52:55], v7 offset:1024
    s_waitcnt lgkmcnt(2)
    v_mfma_f32_16x16x32_bf16 v[92:95], v[28:31], v[60:63], v[92:95]
    ds_read_b128 v[56:59], v7 offset:2048
    s_waitcnt lgkmcnt(2)
    v_mfma_f32_16x16x32_bf16 v[96:99], v[32:35], v[48:51], 0
    ds_read_b128 v[60:63], v7 offset:3072
    s_waitcnt lgkmcnt(2)
    v_mfma_f32_16x16x32_bf16 v[100:103], v[32:35], v[52:55], 0
    ds_read_b128 v[48:51], v7 offset:4096
    s_waitcnt lgkmcnt(2)
    v_mfma_f32_16x16x32_bf16 v[104:107], v[32:35], v[56:59], 0
    ds_read_b128 v[52:55], v7 offset:5120
    s_waitcnt lgkmcnt(2)
    v_mfma_f32_16x16x32_bf16 v[108:111], v[32:35], v[60:63], 0
    ds_read_b128 v[56:59], v7 offset:6144
    v_cvt_pk_bf16_f32 v16, v64, v68
    s_waitcnt lgkmcnt(2)
    v_mfma_f32_16x16x32_bf16 v[112:115], v[32:35], v[48:51], 0
    ds_read_b128 v[60:63], v7 offset:7168
    v_cvt_pk_bf16_f32 v17, v72, v76
    s_waitcnt lgkmcnt(2)
    v_mfma_f32_16x16x32_bf16 v[116:119], v[32:35], v[52:55], 0
    ds_read_b128 v[48:51], v7 offset:8192
    v_cvt_pk_bf16_f32 v18, v80, v84
    s_waitcnt lgkmcnt(2)
    v_mfma_f32_16x16x32_bf16 v[120:123], v[32:35], v[56:59], 0
    ds_read_b128 v[52:55], v7 offset:9216
    v_cvt_pk_bf16_f32 v19, v88, v92
    s_waitcnt lgkmcnt(2)
    v_mfma_f32_16x16x32_bf16 v[124:127], v[32:35], v[60:63], 0
    ds_read_b128 v[56:59], v7 offset:10240
    v_and_or_b32 v16, v16, -2, s27
    s_waitcnt lgkmcnt(2)
    v_mfma_f32_16x16x32_bf16 v[96:99], v[36:39], v[48:51], v[96:99]
    ds_read_b128 v[60:63], v7 offset:11264
    s_add_u32 s36, s25, 0x0
    s_waitcnt lgkmcnt(2)
    v_mfma_f32_16x16x32_bf16 v[100:103], v[36:39], v[52:55], v[100:103]
    ds_read_b128 v[48:51], v7 offset:12288
    buffer_store_dwordx4 v[16:19], v10, s[8:11], s36 offen sc1
    s_waitcnt lgkmcnt(2)
    v_mfma_f32_16x16x32_bf16 v[104:107], v[36:39], v[56:59], v[104:107]
    ds_read_b128 v[52:55], v7 offset:13312
    v_cvt_pk_bf16_f32 v20, v65, v69
    s_waitcnt lgkmcnt(2)
    v_mfma_f32_16x16x32_bf16 v[108:111], v[36:39], v[60:63], v[108:111]
    ds_read_b128 v[56:59], v7 offset:14336
    v_cvt_pk_bf16_f32 v21, v73, v77
    s_waitcnt lgkmcnt(2)
    v_mfma_f32_16x16x32_bf16 v[112:115], v[36:39], v[48:51], v[112:115]
    ds_read_b128 v[60:63], v7 offset:15360
    v_cvt_pk_bf16_f32 v22, v81, v85
    s_waitcnt lgkmcnt(2)
    v_mfma_f32_16x16x32_bf16 v[116:119], v[36:39], v[52:55], v[116:119]
    ds_read_b128 v[48:51], v7 offset:16384
    v_cvt_pk_bf16_f32 v23, v89, v93
    s_waitcnt lgkmcnt(2)
    v_mfma_f32_16x16x32_bf16 v[120:123], v[36:39], v[56:59], v[120:123]
    ds_read_b128 v[52:55], v7 offset:17408
    v_and_or_b32 v20, v20, -2, s27
    s_waitcnt lgkmcnt(2)
    v_mfma_f32_16x16x32_bf16 v[124:127], v[36:39], v[60:63], v[124:127]
    ds_read_b128 v[56:59], v7 offset:18432
    s_add_u32 s36, s25, 0x8000
    s_waitcnt lgkmcnt(2)
    v_mfma_f32_16x16x32_bf16 v[96:99], v[40:43], v[48:51], v[96:99]
    ds_read_b128 v[60:63], v7 offset:19456
    buffer_store_dwordx4 v[20:23], v10, s[8:11], s36 offen sc1
    s_waitcnt lgkmcnt(2)
    v_mfma_f32_16x16x32_bf16 v[100:103], v[40:43], v[52:55], v[100:103]
    ds_read_b128 v[48:51], v7 offset:20480
    v_cvt_pk_bf16_f32 v24, v66, v70
    s_waitcnt lgkmcnt(2)
    v_mfma_f32_16x16x32_bf16 v[104:107], v[40:43], v[56:59], v[104:107]
    ds_read_b128 v[52:55], v7 offset:21504
    v_cvt_pk_bf16_f32 v25, v74, v78
    s_waitcnt lgkmcnt(2)
    v_mfma_f32_16x16x32_bf16 v[108:111], v[40:43], v[60:63], v[108:111]
    ds_read_b128 v[56:59], v7 offset:22528
    v_cvt_pk_bf16_f32 v26, v82, v86
    s_waitcnt lgkmcnt(2)
    v_mfma_f32_16x16x32_bf16 v[112:115], v[40:43], v[48:51], v[112:115]
    ds_read_b128 v[60:63], v7 offset:23552
    v_cvt_pk_bf16_f32 v27, v90, v94
    s_waitcnt lgkmcnt(2)
    v_mfma_f32_16x16x32_bf16 v[116:119], v[40:43], v[52:55], v[116:119]
    ds_read_b128 v[48:51], v7 offset:24576
    v_and_or_b32 v24, v24, -2, s27
    s_waitcnt lgkmcnt(2)
    v_mfma_f32_16x16x32_bf16 v[120:123], v[40:43], v[56:59], v[120:123]
    ds_read_b128 v[52:55], v7 offset:25600
    s_add_u32 s36, s25, 0x10000
    s_waitcnt lgkmcnt(2)
    v_mfma_f32_16x16x32_bf16 v[124:127], v[40:43], v[60:63], v[124:127]
    ds_read_b128 v[56:59], v7 offset:26624
    buffer_store_dwordx4 v[24:27], v10, s[8:11], s36 offen sc1
    s_waitcnt lgkmcnt(2)
    v_mfma_f32_16x16x32_bf16 v[96:99], v[44:47], v[48:51], v[96:99]
    ds_read_b128 v[60:63], v7 offset:27648
    v_cvt_pk_bf16_f32 v28, v67, v71
    s_waitcnt lgkmcnt(2)
    v_mfma_f32_16x16x32_bf16 v[100:103], v[44:47], v[52:55], v[100:103]
    ds_read_b128 v[48:51], v7 offset:28672
    v_cvt_pk_bf16_f32 v29, v75, v79
    s_waitcnt lgkmcnt(2)
    v_mfma_f32_16x16x32_bf16 v[104:107], v[44:47], v[56:59], v[104:107]
    ds_read_b128 v[52:55], v7 offset:29696
    v_cvt_pk_bf16_f32 v30, v83, v87
    s_waitcnt lgkmcnt(2)
    v_mfma_f32_16x16x32_bf16 v[108:111], v[44:47], v[60:63], v[108:111]
    ds_read_b128 v[56:59], v7 offset:30720
    v_cvt_pk_bf16_f32 v31, v91, v95
    s_waitcnt lgkmcnt(2)
    v_mfma_f32_16x16x32_bf16 v[112:115], v[44:47], v[48:51], v[112:115]
    ds_read_b128 v[60:63], v7 offset:31744
    v_and_or_b32 v28, v28, -2, s27
    s_waitcnt lgkmcnt(2)
    v_mfma_f32_16x16x32_bf16 v[116:119], v[44:47], v[52:55], v[116:119]
    s_add_u32 s36, s25, 0x18000
    s_waitcnt lgkmcnt(1)
    v_mfma_f32_16x16x32_bf16 v[120:123], v[44:47], v[56:59], v[120:123]
    buffer_store_dwordx4 v[28:31], v10, s[8:11], s36 offen sc1
    s_waitcnt lgkmcnt(0)
    v_mfma_f32_16x16x32_bf16 v[124:127], v[44:47], v[60:63], v[124:127]
    v_cvt_pk_bf16_f32 v32, v96, v100
    v_cvt_pk_bf16_f32 v33, v104, v108
    v_cvt_pk_bf16_f32 v34, v112, v116
    s_nop 4
    v_cvt_pk_bf16_f32 v35, v120, v124
    v_and_or_b32 v32, v32, -2, s27
    s_add_u32 s36, s25, 0x80000
    buffer_store_dwordx4 v[32:35], v10, s[8:11], s36 offen sc1
    v_cvt_pk_bf16_f32 v36, v97, v101
    v_cvt_pk_bf16_f32 v37, v105, v109
    v_cvt_pk_bf16_f32 v38, v113, v117
    v_cvt_pk_bf16_f32 v39, v121, v125
    v_and_or_b32 v36, v36, -2, s27
    s_add_u32 s36, s25, 0x88000
    buffer_store_dwordx4 v[36:39], v10, s[8:11], s36 offen sc1
    v_cvt_pk_bf16_f32 v40, v98, v102
    v_cvt_pk_bf16_f32 v41, v106, v110
    v_cvt_pk_bf16_f32 v42, v114, v118
    v_cvt_pk_bf16_f32 v43, v122, v126
    v_and_or_b32 v40, v40, -2, s27
    s_add_u32 s36, s25, 0x90000
    buffer_store_dwordx4 v[40:43], v10, s[8:11], s36 offen sc1
    v_cvt_pk_bf16_f32 v44, v99, v103
    v_cvt_pk_bf16_f32 v45, v107, v111
    v_cvt_pk_bf16_f32 v46, v115, v119
    v_cvt_pk_bf16_f32 v47, v123, v127
    v_and_or_b32 v44, v44, -2, s27
    s_add_u32 s36, s25, 0x98000
    buffer_store_dwordx4 v[44:47], v10, s[8:11], s36 offen sc1
    s_add_u32 s38, s23, 6
    s_cmp_ge_u32 s38, 64
    s_cbranch_scc1 L_P2_last
    s_mul_i32 s24, s38, 0x82100
    s_lshl_b32 s36, s20, 14
    s_add_u32 s24, s24, s36
    s_add_u32 s24, s24, 0x1000000
    s_add_u32 s36, s24, 0
    s_add_u32 s37, s36, 0x7000000
    buffer_load_dwordx4 a[32:35], v1, s[8:11], s36 offen offset:0 sc1
    buffer_load_dwordx4 a[0:3], v1, s[8:11], s37 offen offset:0 sc1
    buffer_load_dwordx4 a[36:39], v1, s[8:11], s36 offen offset:1024 sc1
    buffer_load_dwordx4 a[4:7], v1, s[8:11], s37 offen offset:1024 sc1
    buffer_load_dwordx4 a[40:43], v1, s[8:11], s36 offen offset:2048 sc1
    buffer_load_dwordx4 a[8:11], v1, s[8:11], s37 offen offset:2048 sc1
    buffer_load_dwordx4 a[44:47], v1, s[8:11], s36 offen offset:3072 sc1
    buffer_load_dwordx4 a[12:15], v1, s[8:11], s37 offen offset:3072 sc1
    s_add_u32 s36, s24, 4096
    s_add_u32 s37, s36, 0x7000000
    buffer_load_dwordx4 a[48:51], v1, s[8:11], s36 offen offset:0 sc1
    buffer_load_dwordx4 a[16:19], v1, s[8:11], s37 offen offset:0 sc1
    buffer_load_dwordx4 a[52:55], v1, s[8:11], s36 offen offset:1024 sc1
    buffer_load_dwordx4 a[20:23], v1, s[8:11], s37 offen offset:1024 sc1
    buffer_load_dwordx4 a[56:59], v1, s[8:11], s36 offen offset:2048 sc1
    buffer_load_dwordx4 a[24:27], v1, s[8:11], s37 offen offset:2048 sc1
    buffer_load_dwordx4 a[60:63], v1, s[8:11], s36 offen offset:3072 sc1
    buffer_load_dwordx4 a[28:31], v1, s[8:11], s37 offen offset:3072 sc1
    s_lshr_b32 s36, s21, 1
    s_lshl_b32 s36, s36, 3
    s_xor_b32 s37, s36, 8
    s_add_u32 s24, s24, 8192
    s_add_u32 s36, s36, s24
    s_add_u32 s37, s37, s24
    buffer_load_dwordx2 a[64:65], v2, s[8:11], s36 offen offset:0 sc1
    buffer_load_dwordx2 a[66:67], v2, s[8:11], s37 offen offset:0 sc1
    buffer_load_dwordx2 a[68:69], v2, s[8:11], s36 offen offset:1024 sc1
    buffer_load_dwordx2 a[70:71], v2, s[8:11], s37 offen offset:1024 sc1
L_P2_last:
    s_lshl_b32 s24, s23, 5
    s_add_u32 s24, s24, s20
    s_lshl_b32 s24, s24, 10
    v_accvgpr_read_b32 v52, a72
    v_accvgpr_read_b32 v53, a73
    v_and_b32 v15, 15, v0
    v_mov_b32 v48, 0
    v_mov_b32 v14, 0x3f80
    v_cmp_eq_u32 vcc, 0, v15
    s_nop 1
    v_cndmask_b32 v48, v48, v14, vcc
    v_mov_b32 v14, 0x3f800000
    v_cmp_eq_u32 vcc, 1, v15
    s_nop 1
    v_cndmask_b32 v48, v48, v14, vcc
    v_mov_b32 v49, 0
    v_mov_b32 v14, 0x3f80
    v_cmp_eq_u32 vcc, 4, v15
    s_nop 1
    v_cndmask_b32 v49, v49, v14, vcc
    v_mov_b32 v14, 0x3f800000
    v_cmp_eq_u32 vcc, 5, v15
    s_nop 1
    v_cndmask_b32 v49, v49, v14, vcc
    v_mov_b32 v50, 0
    v_mov_b32 v14, 0x3f80
    v_cmp_eq_u32 vcc, 8, v15
    s_nop 1
    v_cndmask_b32 v50, v50, v14, vcc
    v_mov_b32 v14, 0x3f800000
    v_cmp_eq_u32 vcc, 9, v15
    s_nop 1
    v_cndmask_b32 v50, v50, v14, vcc
    v_mov_b32 v51, 0
    v_mov_b32 v14, 0x3f80
    v_cmp_eq_u32 vcc, 12, v15
    s_nop 1
    v_cndmask_b32 v51, v51, v14, vcc
    v_mov_b32 v14, 0x3f800000
    v_cmp_eq_u32 vcc, 13, v15
    s_nop 1
    v_cndmask_b32 v51, v51, v14, vcc
    s_lshl_b32 s25, s20, 15
    s_add_u32 s25, s25, s26
L_P3_poll:
    s_add_u32 s36, s25, 0
    buffer_load_dwordx4 v[80:83], v11, s[8:11], s36 offen sc1
    s_add_u32 s36, s25, 4096
    buffer_load_dwordx4 v[84:87], v11, s[8:11], s36 offen sc1
    s_add_u32 s36, s25, 8192
    buffer_load_dwordx4 v[88:91], v11, s[8:11], s36 offen sc1
    s_add_u32 s36, s25, 12288
    buffer_load_dwordx4 v[92:95], v11, s[8:11], s36 offen sc1
    s_add_u32 s36, s25, 16384
    buffer_load_dwordx4 v[96:99], v11, s[8:11], s36 offen sc1
    s_add_u32 s36, s25, 20480
    buffer_load_dwordx4 v[100:103], v11, s[8:11], s36 offen sc1
    s_add_u32 s36, s25, 24576
    buffer_load_dwordx4 v[104:107], v11, s[8:11], s36 offen sc1
    s_add_u32 s36, s25, 28672
    buffer_load_dwordx4 v[108:111], v11, s[8:11], s36 offen sc1
    s_mov_b64 exec, -1
    s_add_u32 s32, s32, 1
    s_cmp_gt_u32 s32, 200000
    s_waitcnt vmcnt(7)
    v_mfma_f32_16x16x32_bf16 v[56:59], v[48:51], v[80:83], 0
    s_waitcnt vmcnt(6)
    v_mfma_f32_16x16x32_bf16 v[56:59], v[48:51], v[84:87], v[56:59]
    v_bitop3_b32 v60, v80, v84, s27 bitop3:0x7e
    s_waitcnt vmcnt(5)
    v_mfma_f32_16x16x32_bf16 v[56:59], v[48:51], v[88:91], v[56:59]
    s_waitcnt vmcnt(4)
    v_mfma_f32_16x16x32_bf16 v[56:59], v[48:51], v[92:95], v[56:59]
    v_bitop3_b32 v61, v88, v92, s27 bitop3:0x7e
    s_waitcnt vmcnt(3)
    v_mfma_f32_16x16x32_bf16 v[56:59], v[48:51], v[96:99], v[56:59]
    s_waitcnt vmcnt(2)
    v_mfma_f32_16x16x32_bf16 v[56:59], v[48:51], v[100:103], v[56:59]
    v_bitop3_b32 v62, v96, v100, s27 bitop3:0x7e
    s_waitcnt vmcnt(1)
    v_mfma_f32_16x16x32_bf16 v[56:59], v[48:51], v[104:107], v[56:59]
    s_waitcnt vmcnt(0)
    v_mfma_f32_16x16x32_bf16 v[56:59], v[48:51], v[108:111], v[56:59]
    v_bitop3_b32 v63, v104, v108, s27 bitop3:0x7e
    v_or3_b32 v14, v60, v61, v62
    v_bitop3_b32 v14, v14, v63, 1 bitop3:0xa8
    s_cbranch_scc1 L_P3_got
    v_cmp_ne_u32 vcc, 0, v14
    s_cbranch_vccz L_P3_got
    s_mov_b64 exec, vcc
    s_branch L_P3_poll
L_P3_got:
    s_nop 4
    v_cvt_pk_bf16_f32 v62, v56, v57
    v_lshlrev_b32 v65, 16, v62
    v_and_b32 v66, 0xffff0000, v62
    v_lshlrev_b32 v60, 16, v52
    v_and_b32 v61, 0xffff0000, v52
    v_add_f32 v60, v60, v65
    v_add_f32 v61, v61, v66
    v_cvt_pk_bf16_f32 v62, v60, v61
    v_lshlrev_b32 v60, 16, v62
    v_and_b32 v61, 0xffff0000, v62
    v_add_f32 v63, v60, v61
    v_mul_f32 v64, v60, v60
    v_fmac_f32 v64, v61, v61
    v_add_f32_dpp v63, v63, v63 quad_perm:[1,0,3,2] row_mask:0xf bank_mask:0xf
    s_nop 0
    v_add_f32_dpp v64, v64, v64 quad_perm:[1,0,3,2] row_mask:0xf bank_mask:0xf
    v_add_f32_dpp v63, v63, v63 quad_perm:[2,3,0,1] row_mask:0xf bank_mask:0xf
    s_nop 0
    v_add_f32_dpp v64, v64, v64 quad_perm:[2,3,0,1] row_mask:0xf bank_mask:0xf
    v_add_f32_dpp v63, v63, v63 row_half_mirror row_mask:0xf bank_mask:0xf
    s_nop 0
    v_add_f32_dpp v64, v64, v64 row_half_mirror row_mask:0xf bank_mask:0xf
    v_add_f32_dpp v63, v63, v63 row_mirror row_mask:0xf bank_mask:0xf
    s_nop 0
    v_add_f32_dpp v64, v64, v64 row_mirror row_mask:0xf bank_mask:0xf
    v_mov_b32 v14, v63
    s_nop 1
    v_permlane16_swap_b32 v63, v14
    v_add_f32 v63, v63, v14
    v_mov_b32 v14, v64
    s_nop 1
    v_permlane16_swap_b32 v64, v14
    v_add_f32 v64, v64, v14
    v_mov_b32 v14, v63
    s_nop 1
    v_permlane32_swap_b32 v63, v14
    v_add_f32 v63, v63, v14
    v_mov_b32 v14, v64
    s_nop 1
    v_permlane32_swap_b32 v64, v14
    v_add_f32 v64, v64, v14
    v_mov_b32 v15, s21
    v_lshlrev_b32 v15, 3, v15
    v_add_u32 v15, 28672, v15
    ds_write2_b32 v15, v63, v64 offset0:0 offset1:1
    s_add_u32 s36, s24, 0x400000
    buffer_store_dword v62, v12, s[8:11], s36 offen sc1
    s_waitcnt lgkmcnt(0)
    s_barrier
    v_mov_b32 v15, 28672
    ds_read_b128 v[68:71], v15
    ds_read_b128 v[72:75], v15 offset:16
    s_waitcnt lgkmcnt(0)
    v_add_f32 v63, v68, v70
    v_add_f32 v63, v63, v72
    v_add_f32 v63, v63, v74
    v_mul_f32 v63, 0x3b000000, v63
    v_add_f32 v64, v69, v71
    v_add_f32 v64, v64, v73
    v_add_f32 v64, v64, v75
    v_mul_f32 v64, 0x3b000000, v64
    v_fma_f32 v64, -v63, v63, v64
    v_max_f32 v64, 0, v64
    v_cvt_pk_bf16_f32 v14, v63, v64
    v_lshlrev_b32 v63, 16, v14
    v_and_b32 v64, 0xffff0000, v14
    v_add_f32 v64, 0x3727c5ac, v64
    v_cvt_pk_bf16_f32 v14, v64, v64
    v_lshlrev_b32 v64, 16, v14
    v_sqrt_f32 v64, v64
    s_nop 0
    v_cvt_pk_bf16_f32 v14, v64, v64
    v_lshlrev_b32 v64, 16, v14
    v_rcp_f32 v64, v64
    v_sub_f32 v65, v60, v63
    v_sub_f32 v66, v61, v63
    v_cvt_pk_bf16_f32 v14, v65, v66
    v_lshlrev_b32 v65, 16, v14
    v_and_b32 v66, 0xffff0000, v14
    v_mul_f32 v65, v65, v64
    v_mul_f32 v66, v66, v64
    v_cvt_pk_bf16_f32 v67, v65, v66
    v_lshlrev_b32 v65, 16, v67
    v_and_b32 v66, 0xffff0000, v67
    v_lshlrev_b32 v68, 16, v53
    v_and_b32 v69, 0xffff0000, v53
    v_mul_f32 v63, v65, v68
    v_fmac_f32 v63, v66, v69
    s_nop 1
    v_add_f32_dpp v63, v63, v63 quad_perm:[1,0,3,2] row_mask:0xf bank_mask:0xf
    s_nop 1
    v_add_f32_dpp v63, v63, v63 quad_perm:[2,3,0,1] row_mask:0xf bank_mask:0xf
    s_nop 1
    v_add_f32_dpp v63, v63, v63 row_half_mirror row_mask:0xf bank_mask:0xf
    s_nop 1
    v_add_f32_dpp v63, v63, v63 row_mirror row_mask:0xf bank_mask:0xf
    v_mov_b32 v14, v63
    s_nop 1
    v_permlane16_swap_b32 v63, v14
    v_add_f32 v63, v63, v14
    v_mov_b32 v14, v63
    s_nop 1
    v_permlane32_swap_b32 v63, v14
    v_add_f32 v63, v63, v14
    s_lshr_b32 s25, s24, 6
    s_lshl_b32 s37, s21, 2
    s_add_u32 s25, s25, s37
    s_add_u32 s36, s25, 0x194000
    v_cmp_ne_u32 vcc, 0, v1
    v_mov_b32 v15, 0x40000000
    s_nop 0
    v_cndmask_b32 v15, v1, v15, vcc
    buffer_store_dword v63, v15, s[8:11], s36 offen sc1
    v_add_f32 v60, v60, v65
    v_add_f32 v61, v61, v66
    v_cvt_pk_bf16_f32 v62, v60, v61
    buffer_store_dword v62, v12, s[60:63], s24 offen sc1
    s_add_u32 s36, s24, 0x600000
    buffer_store_dword v67, v12, s[8:11], s36 offen sc1
    s_add_u32 s30, s25, 0x1b8000
    s_add_u32 s29, s29, 1
    s_barrier
    s_add_u32 s23, s23, 6
    s_cmp_lt_u32 s23, 64
    s_cbranch_scc1 L_P2
    s_waitcnt vmcnt(0)
    v_cmp_ne_u32 vcc, 0, v1
    v_mov_b32 v15, 0x40000000
    v_mov_b32 v14, 0
    v_cndmask_b32 v15, v1, v15, vcc
    buffer_store_dword v14, v15, s[8:11], s30 offen sc1
    s_branch L_end
L_mlp:
    s_mov_b32 s12, s44
    s_and_b32 s13, s45, 0xffff
    s_mov_b32 s14, 0x200000
    s_mov_b32 s15, 0x20000
    s_mov_b32 s60, s82
    s_and_b32 s61, s83, 0xffff
    s_mov_b32 s62, 0x200000
    s_mov_b32 s63, 0x20000
    s_mov_b32 s92, s80
    s_and_b32 s93, s81, 0xffff
    s_mov_b32 s94, 0x400
    s_mov_b32 s95, 0x20000
    v_mov_b32 v1, 0x0
    v_bfe_u32 v14, v0, 0, 1
    s_mov_b32 s38, 0x10
    v_mad_u32_u24 v1, v14, s38, v1
    v_bfe_u32 v14, v0, 1, 1
    s_mov_b32 s38, 0x20
    v_mad_u32_u24 v1, v14, s38, v1
    v_bfe_u32 v14, v0, 2, 1
    s_mov_b32 s38, 0x40
    v_mad_u32_u24 v1, v14, s38, v1
    v_bfe_u32 v14, v0, 3, 1
    s_mov_b32 s38, 0x80
    v_mad_u32_u24 v1, v14, s38, v1
    v_bfe_u32 v14, v0, 4, 1
    s_mov_b32 s38, 0x100
    v_mad_u32_u24 v1, v14, s38, v1
    v_bfe_u32 v14, v0, 5, 1
    s_mov_b32 s38, 0x200
    v_mad_u32_u24 v1, v14, s38, v1
    v_mov_b32 v2, 0x0
    v_bfe_u32 v14, v0, 0, 1
    s_mov_b32 s38, 0x10
    v_mad_u32_u24 v2, v14, s38, v2
    v_bfe_u32 v14, v0, 1, 1
    s_mov_b32 s38, 0x20
    v_mad_u32_u24 v2, v14, s38, v2
    v_bfe_u32 v14, v0, 2, 1
    s_mov_b32 s38, 0x40
    v_mad_u32_u24 v2, v14, s38, v2
    v_bfe_u32 v14, v0, 3, 1
    s_mov_b32 s38, 0x80
    v_mad_u32_u24 v2, v14, s38, v2
    v_bfe_u32 v14, v0, 4, 1
    s_mov_b32 s38, 0x100
    v_mad_u32_u24 v2, v14, s38, v2
    v_bfe_u32 v14, v0, 5, 1
    s_mov_b32 s38, 0x200
    v_mad_u32_u24 v2, v14, s38, v2
    v_bfe_u32 v14, v0, 6, 1
    s_mov_b32 s38, 0x800
    v_mad_u32_u24 v2, v14, s38, v2
    v_bfe_u32 v14, v0, 7, 1
    s_mov_b32 s38, 0x1000
    v_mad_u32_u24 v2, v14, s38, v2
    v_mov_b32 v9, 0x0
    v_bfe_u32 v14, v0, 0, 1
    s_mov_b32 s38, 0x10
    v_mad_u32_u24 v9, v14, s38, v9
    v_bfe_u32 v14, v0, 1, 1
    s_mov_b32 s38, 0x20
    v_mad_u32_u24 v9, v14, s38, v9
    v_bfe_u32 v14, v0, 2, 1
    s_mov_b32 s38, 0x40
    v_mad_u32_u24 v9, v14, s38, v9
    v_bfe_u32 v14, v0, 3, 1
    s_mov_b32 s38, 0x80
    v_mad_u32_u24 v9, v14, s38, v9
    v_bfe_u32 v14, v0, 4, 1
    s_mov_b32 s38, 0x100
    v_mad_u32_u24 v9, v14, s38, v9
    v_bfe_u32 v14, v0, 5, 1
    s_mov_b32 s38, 0x200
    v_mad_u32_u24 v9, v14, s38, v9
    v_bfe_u32 v14, v0, 6, 1
    s_mov_b32 s38, 0x400
    v_mad_u32_u24 v9, v14, s38, v9
    v_bfe_u32 v14, v0, 7, 1
    s_mov_b32 s38, 0x800
    v_mad_u32_u24 v9, v14, s38, v9
    v_mov_b32 v7, 0x8000
    v_bfe_u32 v14, v0, 0, 1
    s_mov_b32 s38, 0x10
    v_mad_u32_u24 v7, v14, s38, v7
    v_bfe_u32 v14, v0, 1, 1
    s_mov_b32 s38, 0x20
    v_mad_u32_u24 v7, v14, s38, v7
    v_bfe_u32 v14, v0, 2, 1
    s_mov_b32 s38, 0x40
    v_mad_u32_u24 v7, v14, s38, v7
    v_bfe_u32 v14, v0, 3, 1
    s_mov_b32 s38, 0x80
    v_mad_u32_u24 v7, v14, s38, v7
    v_bfe_u32 v14, v0, 4, 1
    s_mov_b32 s38, 0x100
    v_mad_u32_u24 v7, v14, s38, v7
    v_bfe_u32 v14, v0, 5, 1
    s_mov_b32 s38, 0x200
    v_mad_u32_u24 v7, v14, s38, v7
    v_bfe_u32 v14, v0, 6, 1
    s_mov_b32 s38, 0x8000
    v_mad_u32_u24 v7, v14, s38, v7
    v_bfe_u32 v14, v0, 7, 1
    s_mov_b32 s38, 0x10000
    v_mad_u32_u24 v7, v14, s38, v7
    v_mov_b32 v3, 0x0
    v_bfe_u32 v14, v0, 0, 1
    s_mov_b32 s38, 0x10
    v_mad_u32_u24 v3, v14, s38, v3
    v_bfe_u32 v14, v0, 1, 1
    s_mov_b32 s38, 0x20
    v_mad_u32_u24 v3, v14, s38, v3
    v_bfe_u32 v14, v0, 2, 1
    s_mov_b32 s38, 0x40
    v_mad_u32_u24 v3, v14, s38, v3
    v_bfe_u32 v14, v0, 3, 1
    s_mov_b32 s38, 0x400
    v_mad_u32_u24 v3, v14, s38, v3
    v_bfe_u32 v14, v0, 4, 1
    s_mov_b32 s38, 0x800
    v_mad_u32_u24 v3, v14, s38, v3
    v_bfe_u32 v14, v0, 5, 1
    s_mov_b32 s38, 0x1000
    v_mad_u32_u24 v3, v14, s38, v3
    v_bfe_u32 v14, v0, 6, 1
    s_mov_b32 s38, 0x2000
    v_mad_u32_u24 v3, v14, s38, v3
    v_bfe_u32 v14, v0, 7, 1
    s_mov_b32 s38, 0x4000
    v_mad_u32_u24 v3, v14, s38, v3
    v_mov_b32 v4, 0x0
    v_bfe_u32 v14, v0, 0, 1
    s_mov_b32 s38, 0x100
    v_mad_u32_u24 v4, v14, s38, v4
    v_bfe_u32 v14, v0, 1, 1
    s_mov_b32 s38, 0x200
    v_mad_u32_u24 v4, v14, s38, v4
    v_bfe_u32 v14, v0, 2, 1
    s_mov_b32 s38, 0x400
    v_mad_u32_u24 v4, v14, s38, v4
    v_bfe_u32 v14, v0, 6, 1
    s_mov_b32 s38, 0x80
    v_mad_u32_u24 v4, v14, s38, v4
    v_bfe_u32 v14, v0, 7, 1
    s_mov_b32 s38, 0x4000
    v_mad_u32_u24 v4, v14, s38, v4
    v_lshrrev_b32 v15, 3, v0
    v_xor_b32 v15, v15, v0
    v_and_b32 v15, 7, v15
    v_lshl_add_u32 v4, v15, 4, v4
    v_bfe_u32 v15, v0, 4, 2
    v_lshlrev_b32 v15, 4, v15
    v_xor_b32 v5, v15, v1
    v_xor_b32 v6, 64, v5
    v_mov_b32 v8, 0x5000
    v_bfe_u32 v14, v0, 0, 1
    s_mov_b32 s38, 0x10
    v_mad_u32_u24 v8, v14, s38, v8
    v_bfe_u32 v14, v0, 1, 1
    s_mov_b32 s38, 0x40
    v_mad_u32_u24 v8, v14, s38, v8
    v_bfe_u32 v14, v0, 2, 1
    s_mov_b32 s38, 0x80
    v_mad_u32_u24 v8, v14, s38, v8
    v_bfe_u32 v14, v0, 4, 1
    s_mov_b32 s38, 0x20
    v_mad_u32_u24 v8, v14, s38, v8
    v_bfe_u32 v14, v0, 5, 1
    s_mov_b32 s38, 0x100
    v_mad_u32_u24 v8, v14, s38, v8
    v_mov_b32 v10, 0x0
    v_bfe_u32 v14, v0, 0, 1
    s_mov_b32 s38, 0x10
    v_mad_u32_u24 v10, v14, s38, v10
    v_bfe_u32 v14, v0, 1, 1
    s_mov_b32 s38, 0x20
    v_mad_u32_u24 v10, v14, s38, v10
    v_bfe_u32 v14, v0, 2, 1
    s_mov_b32 s38, 0x40
    v_mad_u32_u24 v10, v14, s38, v10
    v_bfe_u32 v14, v0, 3, 1
    s_mov_b32 s38, 0x80
    v_mad_u32_u24 v10, v14, s38, v10
    v_bfe_u32 v14, v0, 4, 1
    s_mov_b32 s38, 0x20000
    v_mad_u32_u24 v10, v14, s38, v10
    v_bfe_u32 v14, v0, 5, 1
    s_mov_b32 s38, 0x40000
    v_mad_u32_u24 v10, v14, s38, v10
    v_bfe_u32 v14, v0, 6, 1
    s_mov_b32 s38, 0x100
    v_mad_u32_u24 v10, v14, s38, v10
    v_bfe_u32 v14, v0, 7, 1
    s_mov_b32 s38, 0x200
    v_mad_u32_u24 v10, v14, s38, v10
    v_mov_b32 v11, 0x0
    v_bfe_u32 v14, v0, 0, 1
    s_mov_b32 s38, 0x10
    v_mad_u32_u24 v11, v14, s38, v11
    v_bfe_u32 v14, v0, 1, 1
    s_mov_b32 s38, 0x20
    v_mad_u32_u24 v11, v14, s38, v11
    v_bfe_u32 v14, v0, 2, 1
    s_mov_b32 s38, 0x40
    v_mad_u32_u24 v11, v14, s38, v11
    v_bfe_u32 v14, v0, 3, 1
    s_mov_b32 s38, 0x80
    v_mad_u32_u24 v11, v14, s38, v11
    v_bfe_u32 v14, v0, 4, 1
    s_mov_b32 s38, 0x400
    v_mad_u32_u24 v11, v14, s38, v11
    v_bfe_u32 v14, v0, 5, 1
    s_mov_b32 s38, 0x800
    v_mad_u32_u24 v11, v14, s38, v11
    v_bfe_u32 v14, v0, 6, 1
    s_mov_b32 s38, 0x100
    v_mad_u32_u24 v11, v14, s38, v11
    v_bfe_u32 v14, v0, 7, 1
    s_mov_b32 s38, 0x200
    v_mad_u32_u24 v11, v14, s38, v11
    v_mov_b32 v12, 0x0
    v_bfe_u32 v14, v0, 0, 1
    s_mov_b32 s38, 0x10
    v_mad_u32_u24 v12, v14, s38, v12
    v_bfe_u32 v14, v0, 1, 1
    s_mov_b32 s38, 0x20
    v_mad_u32_u24 v12, v14, s38, v12
    v_bfe_u32 v14, v0, 2, 1
    s_mov_b32 s38, 0x40
    v_mad_u32_u24 v12, v14, s38, v12
    v_bfe_u32 v14, v0, 3, 1
    s_mov_b32 s38, 0x80
    v_mad_u32_u24 v12, v14, s38, v12
    v_bfe_u32 v14, v0, 4, 1
    s_mov_b32 s38, 0x4
    v_mad_u32_u24 v12, v14, s38, v12
    v_bfe_u32 v14, v0, 5, 1
    s_mov_b32 s38, 0x8
    v_mad_u32_u24 v12, v14, s38, v12
    v_bfe_u32 v14, v0, 6, 1
    s_mov_b32 s38, 0x100
    v_mad_u32_u24 v12, v14, s38, v12
    v_bfe_u32 v14, v0, 7, 1
    s_mov_b32 s38, 0x200
    v_mad_u32_u24 v12, v14, s38, v12
    v_mov_b32 v13, 0xf149f2ca
    v_and_b32 v14, 15, v0
    v_bfe_u32 v15, v0, 4, 2
    v_cmp_gt_u32 s[72:73], 2, v15
    v_lshlrev_b32 v15, 2, v15
    v_cmp_le_u32 s[64:65], v15, v14
    v_add_u32 v15, 1, v15
    v_cmp_le_u32 s[66:67], v15, v14
    v_add_u32 v15, 1, v15
    v_cmp_le_u32 s[68:69], v15, v14
    v_add_u32 v15, 1, v15
    v_cmp_le_u32 s[70:71], v15, v14
    v_add_u32 v15, 1, v15
    s_mov_b32 s34, 0x05040100
    s_mov_b32 s35, 0x07060302
    s_mov_b32 s33, 0x3e0293ee
    s_mov_b32 s32, 0
    s_mov_b32 s4, 0x3f803f80
    s_mov_b32 s5, 0x3f803f80
    s_lshr_b32 s20, s2, 3
    s_lshr_b32 s23, s2, 3
    s_lshl_b32 s23, s23, 1
    s_lshl_b32 s36, s23, 15
    buffer_load_dwordx4 v[96:99], v3, s[12:15], s36 offen offset:0
    buffer_load_dwordx4 v[100:103], v3, s[12:15], s36 offen offset:128
    buffer_load_dwordx4 v[104:107], v3, s[12:15], s36 offen offset:256
    buffer_load_dwordx4 v[108:111], v3, s[12:15], s36 offen offset:384
    buffer_load_dwordx4 v[112:115], v3, s[12:15], s36 offen offset:512
    buffer_load_dwordx4 v[116:119], v3, s[12:15], s36 offen offset:640
    buffer_load_dwordx4 v[120:123], v3, s[12:15], s36 offen offset:768
    buffer_load_dwordx4 v[124:127], v3, s[12:15], s36 offen offset:896
    s_add_u32 s36, s36, 0x8000
    buffer_load_dwordx4 v[128:131], v3, s[12:15], s36 offen offset:0
    buffer_load_dwordx4 v[132:135], v3, s[12:15], s36 offen offset:128
    buffer_load_dwordx4 v[136:139], v3, s[12:15], s36 offen offset:256
    buffer_load_dwordx4 v[140:143], v3, s[12:15], s36 offen offset:384
    buffer_load_dwordx4 v[144:147], v3, s[12:15], s36 offen offset:512
    buffer_load_dwordx4 v[148:151], v3, s[12:15], s36 offen offset:640
    buffer_load_dwordx4 v[152:155], v3, s[12:15], s36 offen offset:768
    buffer_load_dwordx4 v[156:159], v3, s[12:15], s36 offen offset:896
    s_mov_b32 s96, s46
    s_and_b32 s97, s47, 0xffff
    s_mov_b32 s98, 0x2000
    s_mov_b32 s99, 0x20000
    v_mov_b32 v68, 0x0
    v_bfe_u32 v14, v0, 0, 1
    s_mov_b32 s38, 0x8
    v_mad_u32_u24 v68, v14, s38, v68
    v_bfe_u32 v14, v0, 1, 1
    s_mov_b32 s38, 0x10
    v_mad_u32_u24 v68, v14, s38, v68
    v_bfe_u32 v14, v0, 2, 1
    s_mov_b32 s38, 0x10000
    v_mad_u32_u24 v68, v14, s38, v68
    v_bfe_u32 v14, v0, 3, 1
    s_mov_b32 s38, 0x10000
    v_mad_u32_u24 v68, v14, s38, v68
    v_bfe_u32 v14, v0, 4, 1
    s_mov_b32 s38, 0x400
    v_mad_u32_u24 v68, v14, s38, v68
    v_bfe_u32 v14, v0, 5, 1
    s_mov_b32 s38, 0x4
    v_mad_u32_u24 v68, v14, s38, v68
    v_bfe_u32 v14, v0, 6, 1
    s_mov_b32 s38, 0x40
    v_mad_u32_u24 v68, v14, s38, v68
    v_bfe_u32 v14, v0, 7, 1
    s_mov_b32 s38, 0x80
    v_mad_u32_u24 v68, v14, s38, v68
    v_mov_b32 v70, s20
    v_mov_b32 v69, 0x0
    v_bfe_u32 v14, v70, 0, 1
    s_mov_b32 s38, 0x20
    v_mad_u32_u24 v69, v14, s38, v69
    v_bfe_u32 v14, v70, 1, 1
    s_mov_b32 s38, 0x800
    v_mad_u32_u24 v69, v14, s38, v69
    v_bfe_u32 v14, v70, 2, 1
    s_mov_b32 s38, 0x1000
    v_mad_u32_u24 v69, v14, s38, v69
    v_bfe_u32 v14, v70, 3, 1
    s_mov_b32 s38, 0x100
    v_mad_u32_u24 v69, v14, s38, v69
    v_bfe_u32 v14, v70, 4, 1
    s_mov_b32 s38, 0x200
    v_mad_u32_u24 v69, v14, s38, v69
    v_add_u32 v68, v68, v69
    buffer_load_dword v72, v68, s[96:99], 0 offen
    v_mov_b32 v64, -1
    v_mov_b32 v65, -1
    v_mov_b32 v66, -1
    v_mov_b32 v67, -1
    s_lshl_b32 s36, s20, 13
    s_add_u32 s36, s36, 0x0
    buffer_store_dwordx4 v[64:67], v2, s[8:11], s36 offen sc1
    buffer_store_dwordx4 v[64:67], v2, s[8:11], s36 offen offset:1024 sc1
    s_lshl_b32 s36, s20, 14
    s_add_u32 s36, s36, 0x100000
    s_add_u32 s37, s36, 0x2000
    buffer_store_dwordx4 v[64:67], v2, s[8:11], s36 offen sc1
    buffer_store_dwordx4 v[64:67], v2, s[8:11], s36 offen offset:1024 sc1
    buffer_store_dwordx4 v[64:67], v2, s[8:11], s37 offen sc1
    buffer_store_dwordx4 v[64:67], v2, s[8:11], s37 offen offset:1024 sc1
    s_mul_i32 s36, s20, 0x104200
    s_add_u32 s36, s36, 0x1102100
    s_add_u32 s37, s36, 0x82100
    buffer_store_dwordx4 v[64:67], v2, s[8:11], s36 offen sc1
    buffer_store_dwordx4 v[64:67], v2, s[8:11], s36 offen offset:1024 sc1
    buffer_store_dwordx4 v[64:67], v2, s[8:11], s37 offen sc1
    buffer_store_dwordx4 v[64:67], v2, s[8:11], s37 offen offset:1024 sc1
    v_lshlrev_b32 v68, 2, v0
    s_lshl_b32 s36, s20, 10
    s_add_u32 s37, s36, 0x194000
    buffer_store_dword v64, v68, s[8:11], s37 offen sc1
    s_add_u32 s37, s36, 0x1b0000
    buffer_store_dword v64, v68, s[8:11], s37 offen sc1
    s_add_u32 s37, s36, 0x1b8000
    buffer_store_dword v64, v68, s[8:11], s37 offen sc1
    v_mov_b32 v69, 0x40000000
    v_cmp_lt_u32 vcc, 63, v0
    s_nop 1
    v_cndmask_b32 v68, v68, v69, vcc
    v_mov_b32 v73, 0
    s_lshl_b32 s36, s20, 8
    s_add_u32 s37, s36, 0x192000
    buffer_store_dword v73, v68, s[8:11], s37 offen sc1
    s_mul_i32 s36, s20, 0x104200
    s_add_u32 s36, s36, 0x1082000
    s_add_u32 s37, s36, 0x82100
    buffer_store_dword v73, v68, s[8:11], s36 offen sc1
    buffer_store_dword v73, v68, s[8:11], s37 offen sc1
    v_mov_b32 v71, 0x80000
    v_bfe_u32 v14, v0, 0, 1
    s_mov_b32 s38, 0x8
    v_mad_u32_u24 v71, v14, s38, v71
    v_bfe_u32 v14, v0, 1, 1
    s_mov_b32 s38, 0x20
    v_mad_u32_u24 v71, v14, s38, v71
    v_bfe_u32 v14, v0, 4, 1
    s_mov_b32 s38, 0x10
    v_mad_u32_u24 v71, v14, s38, v71
    v_bfe_u32 v14, v0, 5, 1
    s_mov_b32 s38, 0x4
    v_mad_u32_u24 v71, v14, s38, v71
    v_bfe_u32 v14, v0, 6, 1
    s_mov_b32 s38, 0x800
    v_mad_u32_u24 v71, v14, s38, v71
    v_bfe_u32 v14, v0, 7, 1
    s_mov_b32 s38, 0x1000
    v_mad_u32_u24 v71, v14, s38, v71
    v_mov_b32 v69, s20
    v_mov_b32 v68, 0x0
    v_bfe_u32 v14, v69, 0, 1
    s_mov_b32 s38, 0x100
    v_mad_u32_u24 v68, v14, s38, v68
    v_bfe_u32 v14, v69, 1, 1
    s_mov_b32 s38, 0x40
    v_mad_u32_u24 v68, v14, s38, v68
    v_bfe_u32 v14, v69, 2, 1
    s_mov_b32 s38, 0x80
    v_mad_u32_u24 v68, v14, s38, v68
    v_bfe_u32 v14, v69, 3, 1
    s_mov_b32 s38, 0x200
    v_mad_u32_u24 v68, v14, s38, v68
    v_bfe_u32 v14, v69, 4, 1
    s_mov_b32 s38, 0x400
    v_mad_u32_u24 v68, v14, s38, v68
    v_add_u32 v71, v68, v71
    v_and_b32 v68, 12, v0
    v_cmp_ne_u32 vcc, 0, v68
    v_mov_b32 v68, 0x40000000
    s_nop 0
    v_cndmask_b32 v71, v71, v68, vcc
    s_waitcnt vmcnt(16)
    s_mov_b32 s36, 0x1000000
    buffer_store_dword v72, v71, s[8:11], s36 offen sc1
L_XN:
    v_mov_b32 v88, 0
    v_mov_b32 v89, 0
    v_dot2_f32_bf16 v88, v96, s4, v88
    v_dot2_f32_bf16 v89, v96, v96, v89
    v_dot2_f32_bf16 v88, v97, s4, v88
    v_dot2_f32_bf16 v89, v97, v97, v89
    v_dot2_f32_bf16 v88, v98, s4, v88
    v_dot2_f32_bf16 v89, v98, v98, v89
    v_dot2_f32_bf16 v88, v99, s4, v88
    v_dot2_f32_bf16 v89, v99, v99, v89
    v_dot2_f32_bf16 v88, v100, s4, v88
    v_dot2_f32_bf16 v89, v100, v100, v89
    v_dot2_f32_bf16 v88, v101, s4, v88
    v_dot2_f32_bf16 v89, v101, v101, v89
    v_dot2_f32_bf16 v88, v102, s4, v88
    v_dot2_f32_bf16 v89, v102, v102, v89
    v_dot2_f32_bf16 v88, v103, s4, v88
    v_dot2_f32_bf16 v89, v103, v103, v89
    v_dot2_f32_bf16 v88, v104, s4, v88
    v_dot2_f32_bf16 v89, v104, v104, v89
    v_dot2_f32_bf16 v88, v105, s4, v88
    v_dot2_f32_bf16 v89, v105, v105, v89
    v_dot2_f32_bf16 v88, v106, s4, v88
    v_dot2_f32_bf16 v89, v106, v106, v89
    v_dot2_f32_bf16 v88, v107, s4, v88
    v_dot2_f32_bf16 v89, v107, v107, v89
    v_dot2_f32_bf16 v88, v108, s4, v88
    v_dot2_f32_bf16 v89, v108, v108, v89
    v_dot2_f32_bf16 v88, v109, s4, v88
    v_dot2_f32_bf16 v89, v109, v109, v89
    v_dot2_f32_bf16 v88, v110, s4, v88
    v_dot2_f32_bf16 v89, v110, v110, v89
    v_dot2_f32_bf16 v88, v111, s4, v88
    v_dot2_f32_bf16 v89, v111, v111, v89
    v_dot2_f32_bf16 v88, v112, s4, v88
    v_dot2_f32_bf16 v89, v112, v112, v89
    v_dot2_f32_bf16 v88, v113, s4, v88
    v_dot2_f32_bf16 v89, v113, v113, v89
    v_dot2_f32_bf16 v88, v114, s4, v88
    v_dot2_f32_bf16 v89, v114, v114, v89
    v_dot2_f32_bf16 v88, v115, s4, v88
    v_dot2_f32_bf16 v89, v115, v115, v89
    v_dot2_f32_bf16 v88, v116, s4, v88
    v_dot2_f32_bf16 v89, v116, v116, v89
    v_dot2_f32_bf16 v88, v117, s4, v88
    v_dot2_f32_bf16 v89, v117, v117, v89
    v_dot2_f32_bf16 v88, v118, s4, v88
    v_dot2_f32_bf16 v89, v118, v118, v89
    v_dot2_f32_bf16 v88, v119, s4, v88
    v_dot2_f32_bf16 v89, v119, v119, v89
    v_dot2_f32_bf16 v88, v120, s4, v88
    v_dot2_f32_bf16 v89, v120, v120, v89
    v_dot2_f32_bf16 v88, v121, s4, v88
    v_dot2_f32_bf16 v89, v121, v121, v89
    v_dot2_f32_bf16 v88, v122, s4, v88
    v_dot2_f32_bf16 v89, v122, v122, v89
    v_dot2_f32_bf16 v88, v123, s4, v88
    v_dot2_f32_bf16 v89, v123, v123, v89
    v_dot2_f32_bf16 v88, v124, s4, v88
    v_dot2_f32_bf16 v89, v124, v124, v89
    v_dot2_f32_bf16 v88, v125, s4, v88
    v_dot2_f32_bf16 v89, v125, v125, v89
    v_dot2_f32_bf16 v88, v126, s4, v88
    v_dot2_f32_bf16 v89, v126, v126, v89
    v_dot2_f32_bf16 v88, v127, s4, v88
    v_dot2_f32_bf16 v89, v127, v127, v89
    s_nop 3
    v_add_f32_dpp v88, v88, v88 quad_perm:[1,0,3,2] row_mask:0xf bank_mask:0xf
    v_add_f32_dpp v89, v89, v89 quad_perm:[1,0,3,2] row_mask:0xf bank_mask:0xf
    s_nop 0
    v_add_f32_dpp v88, v88, v88 quad_perm:[2,3,0,1] row_mask:0xf bank_mask:0xf
    v_add_f32_dpp v89, v89, v89 quad_perm:[2,3,0,1] row_mask:0xf bank_mask:0xf
    s_nop 0
    v_add_f32_dpp v88, v88, v88 row_half_mirror row_mask:0xf bank_mask:0xf
    v_add_f32_dpp v89, v89, v89 row_half_mirror row_mask:0xf bank_mask:0xf
    v_mul_f32 v88, 0x3b000000, v88
    v_mul_f32 v89, 0x3b000000, v89
    v_fma_f32 v89, -v88, v88, v89
    v_max_f32 v89, 0, v89
    v_cvt_pk_bf16_f32 v14, v88, v89
    v_lshlrev_b32 v88, 16, v14
    v_and_b32 v89, 0xffff0000, v14
    v_add_f32 v89, 0x3727c5ac, v89
    v_cvt_pk_bf16_f32 v14, v89, v89
    v_lshlrev_b32 v89, 16, v14
    v_sqrt_f32 v89, v89
    s_nop 0
    v_cvt_pk_bf16_f32 v14, v89, v89
    v_lshlrev_b32 v89, 16, v14
    v_rcp_f32 v89, v89
    v_lshlrev_b32 v90, 16, v96
    v_and_b32 v91, 0xffff0000, v96
    v_sub_f32 v90, v90, v88
    v_sub_f32 v91, v91, v88
    v_cvt_pk_bf16_f32 v96, v90, v91
    v_lshlrev_b32 v90, 16, v96
    v_and_b32 v91, 0xffff0000, v96
    v_mul_f32 v90, v90, v89
    v_mul_f32 v91, v91, v89
    v_cvt_pk_bf16_f32 v96, v90, v91
    v_lshlrev_b32 v90, 16, v97
    v_and_b32 v91, 0xffff0000, v97
    v_sub_f32 v90, v90, v88
    v_sub_f32 v91, v91, v88
    v_cvt_pk_bf16_f32 v97, v90, v91
    v_lshlrev_b32 v90, 16, v97
    v_and_b32 v91, 0xffff0000, v97
    v_mul_f32 v90, v90, v89
    v_mul_f32 v91, v91, v89
    v_cvt_pk_bf16_f32 v97, v90, v91
    v_lshlrev_b32 v90, 16, v98
    v_and_b32 v91, 0xffff0000, v98
    v_sub_f32 v90, v90, v88
    v_sub_f32 v91, v91, v88
    v_cvt_pk_bf16_f32 v98, v90, v91
    v_lshlrev_b32 v90, 16, v98
    v_and_b32 v91, 0xffff0000, v98
    v_mul_f32 v90, v90, v89
    v_mul_f32 v91, v91, v89
    v_cvt_pk_bf16_f32 v98, v90, v91
    v_lshlrev_b32 v90, 16, v99
    v_and_b32 v91, 0xffff0000, v99
    v_sub_f32 v90, v90, v88
    v_sub_f32 v91, v91, v88
    v_cvt_pk_bf16_f32 v99, v90, v91
    v_lshlrev_b32 v90, 16, v99
    v_and_b32 v91, 0xffff0000, v99
    v_mul_f32 v90, v90, v89
    v_mul_f32 v91, v91, v89
    v_cvt_pk_bf16_f32 v99, v90, v91
    ds_write_b128 v4, v[96:99] offset:0
    v_lshlrev_b32 v90, 16, v100
    v_and_b32 v91, 0xffff0000, v100
    v_sub_f32 v90, v90, v88
    v_sub_f32 v91, v91, v88
    v_cvt_pk_bf16_f32 v100, v90, v91
    v_lshlrev_b32 v90, 16, v100
    v_and_b32 v91, 0xffff0000, v100
    v_mul_f32 v90, v90, v89
    v_mul_f32 v91, v91, v89
    v_cvt_pk_bf16_f32 v100, v90, v91
    v_lshlrev_b32 v90, 16, v101
    v_and_b32 v91, 0xffff0000, v101
    v_sub_f32 v90, v90, v88
    v_sub_f32 v91, v91, v88
    v_cvt_pk_bf16_f32 v101, v90, v91
    v_lshlrev_b32 v90, 16, v101
    v_and_b32 v91, 0xffff0000, v101
    v_mul_f32 v90, v90, v89
    v_mul_f32 v91, v91, v89
    v_cvt_pk_bf16_f32 v101, v90, v91
    v_lshlrev_b32 v90, 16, v102
    v_and_b32 v91, 0xffff0000, v102
    v_sub_f32 v90, v90, v88
    v_sub_f32 v91, v91, v88
    v_cvt_pk_bf16_f32 v102, v90, v91
    v_lshlrev_b32 v90, 16, v102
    v_and_b32 v91, 0xffff0000, v102
    v_mul_f32 v90, v90, v89
    v_mul_f32 v91, v91, v89
    v_cvt_pk_bf16_f32 v102, v90, v91
    v_lshlrev_b32 v90, 16, v103
    v_and_b32 v91, 0xffff0000, v103
    v_sub_f32 v90, v90, v88
    v_sub_f32 v91, v91, v88
    v_cvt_pk_bf16_f32 v103, v90, v91
    v_lshlrev_b32 v90, 16, v103
    v_and_b32 v91, 0xffff0000, v103
    v_mul_f32 v90, v90, v89
    v_mul_f32 v91, v91, v89
    v_cvt_pk_bf16_f32 v103, v90, v91
    ds_write_b128 v4, v[100:103] offset:2048
    v_lshlrev_b32 v90, 16, v104
    v_and_b32 v91, 0xffff0000, v104
    v_sub_f32 v90, v90, v88
    v_sub_f32 v91, v91, v88
    v_cvt_pk_bf16_f32 v104, v90, v91
    v_lshlrev_b32 v90, 16, v104
    v_and_b32 v91, 0xffff0000, v104
    v_mul_f32 v90, v90, v89
    v_mul_f32 v91, v91, v89
    v_cvt_pk_bf16_f32 v104, v90, v91
    v_lshlrev_b32 v90, 16, v105
    v_and_b32 v91, 0xffff0000, v105
    v_sub_f32 v90, v90, v88
    v_sub_f32 v91, v91, v88
    v_cvt_pk_bf16_f32 v105, v90, v91
    v_lshlrev_b32 v90, 16, v105
    v_and_b32 v91, 0xffff0000, v105
    v_mul_f32 v90, v90, v89
    v_mul_f32 v91, v91, v89
    v_cvt_pk_bf16_f32 v105, v90, v91
    v_lshlrev_b32 v90, 16, v106
    v_and_b32 v91, 0xffff0000, v106
    v_sub_f32 v90, v90, v88
    v_sub_f32 v91, v91, v88
    v_cvt_pk_bf16_f32 v106, v90, v91
    v_lshlrev_b32 v90, 16, v106
    v_and_b32 v91, 0xffff0000, v106
    v_mul_f32 v90, v90, v89
    v_mul_f32 v91, v91, v89
    v_cvt_pk_bf16_f32 v106, v90, v91
    v_lshlrev_b32 v90, 16, v107
    v_and_b32 v91, 0xffff0000, v107
    v_sub_f32 v90, v90, v88
    v_sub_f32 v91, v91, v88
    v_cvt_pk_bf16_f32 v107, v90, v91
    v_lshlrev_b32 v90, 16, v107
    v_and_b32 v91, 0xffff0000, v107
    v_mul_f32 v90, v90, v89
    v_mul_f32 v91, v91, v89
    v_cvt_pk_bf16_f32 v107, v90, v91
    ds_write_b128 v4, v[104:107] offset:4096
    v_lshlrev_b32 v90, 16, v108
    v_and_b32 v91, 0xffff0000, v108
    v_sub_f32 v90, v90, v88
    v_sub_f32 v91, v91, v88
    v_cvt_pk_bf16_f32 v108, v90, v91
    v_lshlrev_b32 v90, 16, v108
    v_and_b32 v91, 0xffff0000, v108
    v_mul_f32 v90, v90, v89
    v_mul_f32 v91, v91, v89
    v_cvt_pk_bf16_f32 v108, v90, v91
    v_lshlrev_b32 v90, 16, v109
    v_and_b32 v91, 0xffff0000, v109
    v_sub_f32 v90, v90, v88
    v_sub_f32 v91, v91, v88
    v_cvt_pk_bf16_f32 v109, v90, v91
    v_lshlrev_b32 v90, 16, v109
    v_and_b32 v91, 0xffff0000, v109
    v_mul_f32 v90, v90, v89
    v_mul_f32 v91, v91, v89
    v_cvt_pk_bf16_f32 v109, v90, v91
    v_lshlrev_b32 v90, 16, v110
    v_and_b32 v91, 0xffff0000, v110
    v_sub_f32 v90, v90, v88
    v_sub_f32 v91, v91, v88
    v_cvt_pk_bf16_f32 v110, v90, v91
    v_lshlrev_b32 v90, 16, v110
    v_and_b32 v91, 0xffff0000, v110
    v_mul_f32 v90, v90, v89
    v_mul_f32 v91, v91, v89
    v_cvt_pk_bf16_f32 v110, v90, v91
    v_lshlrev_b32 v90, 16, v111
    v_and_b32 v91, 0xffff0000, v111
    v_sub_f32 v90, v90, v88
    v_sub_f32 v91, v91, v88
    v_cvt_pk_bf16_f32 v111, v90, v91
    v_lshlrev_b32 v90, 16, v111
    v_and_b32 v91, 0xffff0000, v111
    v_mul_f32 v90, v90, v89
    v_mul_f32 v91, v91, v89
    v_cvt_pk_bf16_f32 v111, v90, v91
    ds_write_b128 v4, v[108:111] offset:6144
    v_lshlrev_b32 v90, 16, v112
    v_and_b32 v91, 0xffff0000, v112
    v_sub_f32 v90, v90, v88
    v_sub_f32 v91, v91, v88
    v_cvt_pk_bf16_f32 v112, v90, v91
    v_lshlrev_b32 v90, 16, v112
    v_and_b32 v91, 0xffff0000, v112
    v_mul_f32 v90, v90, v89
    v_mul_f32 v91, v91, v89
    v_cvt_pk_bf16_f32 v112, v90, v91
    v_lshlrev_b32 v90, 16, v113
    v_and_b32 v91, 0xffff0000, v113
    v_sub_f32 v90, v90, v88
    v_sub_f32 v91, v91, v88
    v_cvt_pk_bf16_f32 v113, v90, v91
    v_lshlrev_b32 v90, 16, v113
    v_and_b32 v91, 0xffff0000, v113
    v_mul_f32 v90, v90, v89
    v_mul_f32 v91, v91, v89
    v_cvt_pk_bf16_f32 v113, v90, v91
    v_lshlrev_b32 v90, 16, v114
    v_and_b32 v91, 0xffff0000, v114
    v_sub_f32 v90, v90, v88
    v_sub_f32 v91, v91, v88
    v_cvt_pk_bf16_f32 v114, v90, v91
    v_lshlrev_b32 v90, 16, v114
    v_and_b32 v91, 0xffff0000, v114
    v_mul_f32 v90, v90, v89
    v_mul_f32 v91, v91, v89
    v_cvt_pk_bf16_f32 v114, v90, v91
    v_lshlrev_b32 v90, 16, v115
    v_and_b32 v91, 0xffff0000, v115
    v_sub_f32 v90, v90, v88
    v_sub_f32 v91, v91, v88
    v_cvt_pk_bf16_f32 v115, v90, v91
    v_lshlrev_b32 v90, 16, v115
    v_and_b32 v91, 0xffff0000, v115
    v_mul_f32 v90, v90, v89
    v_mul_f32 v91, v91, v89
    v_cvt_pk_bf16_f32 v115, v90, v91
    ds_write_b128 v4, v[112:115] offset:8192
    v_lshlrev_b32 v90, 16, v116
    v_and_b32 v91, 0xffff0000, v116
    v_sub_f32 v90, v90, v88
    v_sub_f32 v91, v91, v88
    v_cvt_pk_bf16_f32 v116, v90, v91
    v_lshlrev_b32 v90, 16, v116
    v_and_b32 v91, 0xffff0000, v116
    v_mul_f32 v90, v90, v89
    v_mul_f32 v91, v91, v89
    v_cvt_pk_bf16_f32 v116, v90, v91
    v_lshlrev_b32 v90, 16, v117
    v_and_b32 v91, 0xffff0000, v117
    v_sub_f32 v90, v90, v88
    v_sub_f32 v91, v91, v88
    v_cvt_pk_bf16_f32 v117, v90, v91
    v_lshlrev_b32 v90, 16, v117
    v_and_b32 v91, 0xffff0000, v117
    v_mul_f32 v90, v90, v89
    v_mul_f32 v91, v91, v89
    v_cvt_pk_bf16_f32 v117, v90, v91
    v_lshlrev_b32 v90, 16, v118
    v_and_b32 v91, 0xffff0000, v118
    v_sub_f32 v90, v90, v88
    v_sub_f32 v91, v91, v88
    v_cvt_pk_bf16_f32 v118, v90, v91
    v_lshlrev_b32 v90, 16, v118
    v_and_b32 v91, 0xffff0000, v118
    v_mul_f32 v90, v90, v89
    v_mul_f32 v91, v91, v89
    v_cvt_pk_bf16_f32 v118, v90, v91
    v_lshlrev_b32 v90, 16, v119
    v_and_b32 v91, 0xffff0000, v119
    v_sub_f32 v90, v90, v88
    v_sub_f32 v91, v91, v88
    v_cvt_pk_bf16_f32 v119, v90, v91
    v_lshlrev_b32 v90, 16, v119
    v_and_b32 v91, 0xffff0000, v119
    v_mul_f32 v90, v90, v89
    v_mul_f32 v91, v91, v89
    v_cvt_pk_bf16_f32 v119, v90, v91
    ds_write_b128 v4, v[116:119] offset:10240
    v_lshlrev_b32 v90, 16, v120
    v_and_b32 v91, 0xffff0000, v120
    v_sub_f32 v90, v90, v88
    v_sub_f32 v91, v91, v88
    v_cvt_pk_bf16_f32 v120, v90, v91
    v_lshlrev_b32 v90, 16, v120
    v_and_b32 v91, 0xffff0000, v120
    v_mul_f32 v90, v90, v89
    v_mul_f32 v91, v91, v89
    v_cvt_pk_bf16_f32 v120, v90, v91
    v_lshlrev_b32 v90, 16, v121
    v_and_b32 v91, 0xffff0000, v121
    v_sub_f32 v90, v90, v88
    v_sub_f32 v91, v91, v88
    v_cvt_pk_bf16_f32 v121, v90, v91
    v_lshlrev_b32 v90, 16, v121
    v_and_b32 v91, 0xffff0000, v121
    v_mul_f32 v90, v90, v89
    v_mul_f32 v91, v91, v89
    v_cvt_pk_bf16_f32 v121, v90, v91
    v_lshlrev_b32 v90, 16, v122
    v_and_b32 v91, 0xffff0000, v122
    v_sub_f32 v90, v90, v88
    v_sub_f32 v91, v91, v88
    v_cvt_pk_bf16_f32 v122, v90, v91
    v_lshlrev_b32 v90, 16, v122
    v_and_b32 v91, 0xffff0000, v122
    v_mul_f32 v90, v90, v89
    v_mul_f32 v91, v91, v89
    v_cvt_pk_bf16_f32 v122, v90, v91
    v_lshlrev_b32 v90, 16, v123
    v_and_b32 v91, 0xffff0000, v123
    v_sub_f32 v90, v90, v88
    v_sub_f32 v91, v91, v88
    v_cvt_pk_bf16_f32 v123, v90, v91
    v_lshlrev_b32 v90, 16, v123
    v_and_b32 v91, 0xffff0000, v123
    v_mul_f32 v90, v90, v89
    v_mul_f32 v91, v91, v89
    v_cvt_pk_bf16_f32 v123, v90, v91
    ds_write_b128 v4, v[120:123] offset:12288
    v_lshlrev_b32 v90, 16, v124
    v_and_b32 v91, 0xffff0000, v124
    v_sub_f32 v90, v90, v88
    v_sub_f32 v91, v91, v88
    v_cvt_pk_bf16_f32 v124, v90, v91
    v_lshlrev_b32 v90, 16, v124
    v_and_b32 v91, 0xffff0000, v124
    v_mul_f32 v90, v90, v89
    v_mul_f32 v91, v91, v89
    v_cvt_pk_bf16_f32 v124, v90, v91
    v_lshlrev_b32 v90, 16, v125
    v_and_b32 v91, 0xffff0000, v125
    v_sub_f32 v90, v90, v88
    v_sub_f32 v91, v91, v88
    v_cvt_pk_bf16_f32 v125, v90, v91
    v_lshlrev_b32 v90, 16, v125
    v_and_b32 v91, 0xffff0000, v125
    v_mul_f32 v90, v90, v89
    v_mul_f32 v91, v91, v89
    v_cvt_pk_bf16_f32 v125, v90, v91
    v_lshlrev_b32 v90, 16, v126
    v_and_b32 v91, 0xffff0000, v126
    v_sub_f32 v90, v90, v88
    v_sub_f32 v91, v91, v88
    v_cvt_pk_bf16_f32 v126, v90, v91
    v_lshlrev_b32 v90, 16, v126
    v_and_b32 v91, 0xffff0000, v126
    v_mul_f32 v90, v90, v89
    v_mul_f32 v91, v91, v89
    v_cvt_pk_bf16_f32 v126, v90, v91
    v_lshlrev_b32 v90, 16, v127
    v_and_b32 v91, 0xffff0000, v127
    v_sub_f32 v90, v90, v88
    v_sub_f32 v91, v91, v88
    v_cvt_pk_bf16_f32 v127, v90, v91
    v_lshlrev_b32 v90, 16, v127
    v_and_b32 v91, 0xffff0000, v127
    v_mul_f32 v90, v90, v89
    v_mul_f32 v91, v91, v89
    v_cvt_pk_bf16_f32 v127, v90, v91
    ds_write_b128 v4, v[124:127] offset:14336
    s_waitcnt lgkmcnt(0)
    s_barrier
    s_lshl_b32 s24, s23, 15
    s_add_u32 s24, s24, 0x800000
    ds_read_b128 v[24:27], v9 offset:0
    ds_read_b128 v[28:31], v9 offset:4096
    ds_read_b128 v[32:35], v9 offset:8192
    ds_read_b128 v[36:39], v9 offset:12288
    ds_read_b128 v[40:43], v9 offset:16384
    ds_read_b128 v[44:47], v9 offset:20480
    ds_read_b128 v[48:51], v9 offset:24576
    ds_read_b128 v[52:55], v9 offset:28672
    s_waitcnt lgkmcnt(7)
    s_add_u32 s36, s24, 0
    buffer_store_dwordx4 v[24:27], v9, s[8:11], s36 offen sc1
    s_waitcnt lgkmcnt(6)
    s_add_u32 s36, s24, 4096
    buffer_store_dwordx4 v[28:31], v9, s[8:11], s36 offen sc1
    s_waitcnt lgkmcnt(5)
    s_add_u32 s36, s24, 8192
    buffer_store_dwordx4 v[32:35], v9, s[8:11], s36 offen sc1
    s_waitcnt lgkmcnt(4)
    s_add_u32 s36, s24, 12288
    buffer_store_dwordx4 v[36:39], v9, s[8:11], s36 offen sc1
    s_waitcnt lgkmcnt(3)
    s_add_u32 s36, s24, 16384
    buffer_store_dwordx4 v[40:43], v9, s[8:11], s36 offen sc1
    s_waitcnt lgkmcnt(2)
    s_add_u32 s36, s24, 20480
    buffer_store_dwordx4 v[44:47], v9, s[8:11], s36 offen sc1
    s_waitcnt lgkmcnt(1)
    s_add_u32 s36, s24, 24576
    buffer_store_dwordx4 v[48:51], v9, s[8:11], s36 offen sc1
    s_waitcnt lgkmcnt(0)
    s_add_u32 s36, s24, 28672
    buffer_store_dwordx4 v[52:55], v9, s[8:11], s36 offen sc1
    s_barrier
    v_mov_b64 v[96:97], v[128:129]
    v_mov_b64 v[98:99], v[130:131]
    v_mov_b64 v[100:101], v[132:133]
    v_mov_b64 v[102:103], v[134:135]
    v_mov_b64 v[104:105], v[136:137]
    v_mov_b64 v[106:107], v[138:139]
    v_mov_b64 v[108:109], v[140:141]
    v_mov_b64 v[110:111], v[142:143]
    v_mov_b64 v[112:113], v[144:145]
    v_mov_b64 v[114:115], v[146:147]
    v_mov_b64 v[116:117], v[148:149]
    v_mov_b64 v[118:119], v[150:151]
    v_mov_b64 v[120:121], v[152:153]
    v_mov_b64 v[122:123], v[154:155]
    v_mov_b64 v[124:125], v[156:157]
    v_mov_b64 v[126:127], v[158:159]
    s_add_u32 s23, s23, 1
    s_bitcmp1_b32 s23, 0
    s_cbranch_scc1 L_XN
    s_waitcnt vmcnt(0)
    s_barrier
    v_mov_b32 v14, 1
    s_lshl_b32 s37, s20, 2
    v_lshlrev_b32 v15, 20, v0
    buffer_store_dword v14, v15, s[16:19], s37 offen sc1
    s_lshr_b32 s20, s2, 3
    s_mov_b32 s34, 0x05040100
    s_mov_b32 s35, 0x07060302
    s_mov_b32 s32, 0
    s_mov_b32 s64, s84
    s_and_b32 s65, s85, 0xffff
    s_mov_b32 s66, 0x1c0000
    s_mov_b32 s67, 0x20000
    s_mov_b32 s68, s86
    s_and_b32 s69, s87, 0xffff
    s_mov_b32 s70, 0x1c0000
    s_mov_b32 s71, 0x20000
    s_mov_b32 s76, s88
    s_and_b32 s77, s89, 0xffff
    s_mov_b32 s78, 0x1c0000
    s_mov_b32 s79, 0x20000
    v_and_b32 v3, 31, v0
    v_lshlrev_b32 v3, 2, v3
L_M_hs:
    buffer_load_dword v5, v3, s[16:19], 0 offen sc1
    s_add_u32 s32, s32, 1
    s_cmp_gt_u32 s32, 200000
    s_waitcnt vmcnt(0)
    s_cbranch_scc1 L_M_hs_ok
    v_cmp_eq_u32 vcc, 0, v5
    s_cbranch_vccz L_M_hs_ok
    s_sleep 16
    s_branch L_M_hs
L_M_hs_ok:
    v_lshlrev_b32 v3, 4, v0
L_M00_rp:
    s_mov_b32 s36, 0x194000
    buffer_load_dwordx4 v[16:19], v3, s[8:11], s36 offen sc1
    s_add_u32 s32, s32, 1
    v_mov_b32 v5, 0
    s_waitcnt vmcnt(0)
    v_max3_u32 v5, v5, v16, v17
    v_max3_u32 v5, v5, v18, v19
    s_cmp_gt_u32 s32, 200000
    s_cbranch_scc1 L_M00_rp_ok
    v_cmp_eq_u32 vcc, -1, v5
    s_cbranch_vccz L_M00_rp_ok
    s_sleep 64
    s_branch L_M00_rp
L_M00_rp_ok:
    v_add_f32 v16, v16, v17
    v_add_f32 v18, v18, v19
    v_add_f32 v16, v16, v18
    v_cvt_pk_bf16_f32 v5, v16, v16
    v_lshlrev_b32 v16, 16, v5
    v_ashrrev_i32 v5, 31, v16
    v_or_b32 v5, 0x80000000, v5
    v_xor_b32 v5, v5, v16
    v_and_b32 v5, 0xffff0000, v5
    v_sub_u32 v6, 2047, v0
    v_or_b32 v120, v5, v6
    v_lshrrev_b32 v1, 5, v0
    v_and_b32 v2, 31, v0
    s_mov_b32 s36, 229376
    v_mul_lo_u32 v4, v1, s36
    v_lshl_add_u32 v4, v2, 2, v4
    v_mov_b32 v5, 0x40000000
    v_cmp_lt_u32 vcc, 27, v2
    s_nop 1
    v_cndmask_b32 v4, v4, v5, vcc
    s_mul_i32 s23, s20, 112
    s_add_u32 s36, s23, 0
    buffer_load_dword v16, v4, s[64:67], s36 offen
    s_add_u32 s36, s23, 3584
    buffer_load_dword v17, v4, s[64:67], s36 offen
    s_add_u32 s36, s23, 7168
    buffer_load_dword v18, v4, s[64:67], s36 offen
    s_add_u32 s36, s23, 10752
    buffer_load_dword v19, v4, s[64:67], s36 offen
    s_add_u32 s36, s23, 14336
    buffer_load_dword v20, v4, s[64:67], s36 offen
    s_add_u32 s36, s23, 17920
    buffer_load_dword v21, v4, s[64:67], s36 offen
    s_add_u32 s36, s23, 21504
    buffer_load_dword v22, v4, s[64:67], s36 offen
    s_add_u32 s36, s23, 25088
    buffer_load_dword v23, v4, s[64:67], s36 offen
    s_add_u32 s36, s23, 28672
    buffer_load_dword v24, v4, s[64:67], s36 offen
    s_add_u32 s36, s23, 32256
    buffer_load_dword v25, v4, s[64:67], s36 offen
    s_add_u32 s36, s23, 35840
    buffer_load_dword v26, v4, s[64:67], s36 offen
    s_add_u32 s36, s23, 39424
    buffer_load_dword v27, v4, s[64:67], s36 offen
    s_add_u32 s36, s23, 43008
    buffer_load_dword v28, v4, s[64:67], s36 offen
    s_add_u32 s36, s23, 46592
    buffer_load_dword v29, v4, s[64:67], s36 offen
    s_add_u32 s36, s23, 50176
    buffer_load_dword v30, v4, s[64:67], s36 offen
    s_add_u32 s36, s23, 53760
    buffer_load_dword v31, v4, s[64:67], s36 offen
    s_add_u32 s36, s23, 57344
    buffer_load_dword v32, v4, s[64:67], s36 offen
    s_add_u32 s36, s23, 60928
    buffer_load_dword v33, v4, s[64:67], s36 offen
    s_add_u32 s36, s23, 64512
    buffer_load_dword v34, v4, s[64:67], s36 offen
    s_add_u32 s36, s23, 68096
    buffer_load_dword v35, v4, s[64:67], s36 offen
    s_add_u32 s36, s23, 71680
    buffer_load_dword v36, v4, s[64:67], s36 offen
    s_add_u32 s36, s23, 75264
    buffer_load_dword v37, v4, s[64:67], s36 offen
    s_add_u32 s36, s23, 78848
    buffer_load_dword v38, v4, s[64:67], s36 offen
    s_add_u32 s36, s23, 82432
    buffer_load_dword v39, v4, s[64:67], s36 offen
    s_add_u32 s36, s23, 86016
    buffer_load_dword v40, v4, s[64:67], s36 offen
    s_add_u32 s36, s23, 89600
    buffer_load_dword v41, v4, s[64:67], s36 offen
    s_add_u32 s36, s23, 93184
    buffer_load_dword v42, v4, s[64:67], s36 offen
    s_add_u32 s36, s23, 96768
    buffer_load_dword v43, v4, s[64:67], s36 offen
    s_add_u32 s36, s23, 100352
    buffer_load_dword v44, v4, s[64:67], s36 offen
    s_add_u32 s36, s23, 103936
    buffer_load_dword v45, v4, s[64:67], s36 offen
    s_add_u32 s36, s23, 107520
    buffer_load_dword v46, v4, s[64:67], s36 offen
    s_add_u32 s36, s23, 111104
    buffer_load_dword v47, v4, s[64:67], s36 offen
    s_waitcnt vmcnt(0)
    v_perm_b32 v128, v17, v16, s34
    v_perm_b32 v129, v19, v18, s34
    v_perm_b32 v130, v21, v20, s34
    v_perm_b32 v131, v23, v22, s34
    v_perm_b32 v132, v25, v24, s34
    v_perm_b32 v133, v27, v26, s34
    v_perm_b32 v134, v29, v28, s34
    v_perm_b32 v135, v31, v30, s34
    v_perm_b32 v136, v33, v32, s34
    v_perm_b32 v137, v35, v34, s34
    v_perm_b32 v138, v37, v36, s34
    v_perm_b32 v139, v39, v38, s34
    v_perm_b32 v140, v41, v40, s34
    v_perm_b32 v141, v43, v42, s34
    v_perm_b32 v142, v45, v44, s34
    v_perm_b32 v143, v47, v46, s34
    v_perm_b32 v160, v17, v16, s35
    v_perm_b32 v161, v19, v18, s35
    v_perm_b32 v162, v21, v20, s35
    v_perm_b32 v163, v23, v22, s35
    v_perm_b32 v164, v25, v24, s35
    v_perm_b32 v165, v27, v26, s35
    v_perm_b32 v166, v29, v28, s35
    v_perm_b32 v167, v31, v30, s35
    v_perm_b32 v168, v33, v32, s35
    v_perm_b32 v169, v35, v34, s35
    v_perm_b32 v170, v37, v36, s35
    v_perm_b32 v171, v39, v38, s35
    v_perm_b32 v172, v41, v40, s35
    v_perm_b32 v173, v43, v42, s35
    v_perm_b32 v174, v45, v44, s35
    v_perm_b32 v175, v47, v46, s35
    s_add_u32 s36, s23, 114688
    buffer_load_dword v16, v4, s[64:67], s36 offen
    s_add_u32 s36, s23, 118272
    buffer_load_dword v17, v4, s[64:67], s36 offen
    s_add_u32 s36, s23, 121856
    buffer_load_dword v18, v4, s[64:67], s36 offen
    s_add_u32 s36, s23, 125440
    buffer_load_dword v19, v4, s[64:67], s36 offen
    s_add_u32 s36, s23, 129024
    buffer_load_dword v20, v4, s[64:67], s36 offen
    s_add_u32 s36, s23, 132608
    buffer_load_dword v21, v4, s[64:67], s36 offen
    s_add_u32 s36, s23, 136192
    buffer_load_dword v22, v4, s[64:67], s36 offen
    s_add_u32 s36, s23, 139776
    buffer_load_dword v23, v4, s[64:67], s36 offen
    s_add_u32 s36, s23, 143360
    buffer_load_dword v24, v4, s[64:67], s36 offen
    s_add_u32 s36, s23, 146944
    buffer_load_dword v25, v4, s[64:67], s36 offen
    s_add_u32 s36, s23, 150528
    buffer_load_dword v26, v4, s[64:67], s36 offen
    s_add_u32 s36, s23, 154112
    buffer_load_dword v27, v4, s[64:67], s36 offen
    s_add_u32 s36, s23, 157696
    buffer_load_dword v28, v4, s[64:67], s36 offen
    s_add_u32 s36, s23, 161280
    buffer_load_dword v29, v4, s[64:67], s36 offen
    s_add_u32 s36, s23, 164864
    buffer_load_dword v30, v4, s[64:67], s36 offen
    s_add_u32 s36, s23, 168448
    buffer_load_dword v31, v4, s[64:67], s36 offen
    s_add_u32 s36, s23, 172032
    buffer_load_dword v32, v4, s[64:67], s36 offen
    s_add_u32 s36, s23, 175616
    buffer_load_dword v33, v4, s[64:67], s36 offen
    s_add_u32 s36, s23, 179200
    buffer_load_dword v34, v4, s[64:67], s36 offen
    s_add_u32 s36, s23, 182784
    buffer_load_dword v35, v4, s[64:67], s36 offen
    s_add_u32 s36, s23, 186368
    buffer_load_dword v36, v4, s[64:67], s36 offen
    s_add_u32 s36, s23, 189952
    buffer_load_dword v37, v4, s[64:67], s36 offen
    s_add_u32 s36, s23, 193536
    buffer_load_dword v38, v4, s[64:67], s36 offen
    s_add_u32 s36, s23, 197120
    buffer_load_dword v39, v4, s[64:67], s36 offen
    s_add_u32 s36, s23, 200704
    buffer_load_dword v40, v4, s[64:67], s36 offen
    s_add_u32 s36, s23, 204288
    buffer_load_dword v41, v4, s[64:67], s36 offen
    s_add_u32 s36, s23, 207872
    buffer_load_dword v42, v4, s[64:67], s36 offen
    s_add_u32 s36, s23, 211456
    buffer_load_dword v43, v4, s[64:67], s36 offen
    s_add_u32 s36, s23, 215040
    buffer_load_dword v44, v4, s[64:67], s36 offen
    s_add_u32 s36, s23, 218624
    buffer_load_dword v45, v4, s[64:67], s36 offen
    s_add_u32 s36, s23, 222208
    buffer_load_dword v46, v4, s[64:67], s36 offen
    s_add_u32 s36, s23, 225792
    buffer_load_dword v47, v4, s[64:67], s36 offen
    s_waitcnt vmcnt(0)
    v_perm_b32 v144, v17, v16, s34
    v_perm_b32 v145, v19, v18, s34
    v_perm_b32 v146, v21, v20, s34
    v_perm_b32 v147, v23, v22, s34
    v_perm_b32 v148, v25, v24, s34
    v_perm_b32 v149, v27, v26, s34
    v_perm_b32 v150, v29, v28, s34
    v_perm_b32 v151, v31, v30, s34
    v_perm_b32 v152, v33, v32, s34
    v_perm_b32 v153, v35, v34, s34
    v_perm_b32 v154, v37, v36, s34
    v_perm_b32 v155, v39, v38, s34
    v_perm_b32 v156, v41, v40, s34
    v_perm_b32 v157, v43, v42, s34
    v_perm_b32 v158, v45, v44, s34
    v_perm_b32 v159, v47, v46, s34
    v_perm_b32 v176, v17, v16, s35
    v_perm_b32 v177, v19, v18, s35
    v_perm_b32 v178, v21, v20, s35
    v_perm_b32 v179, v23, v22, s35
    v_perm_b32 v180, v25, v24, s35
    v_perm_b32 v181, v27, v26, s35
    v_perm_b32 v182, v29, v28, s35
    v_perm_b32 v183, v31, v30, s35
    v_perm_b32 v184, v33, v32, s35
    v_perm_b32 v185, v35, v34, s35
    v_perm_b32 v186, v37, v36, s35
    v_perm_b32 v187, v39, v38, s35
    v_perm_b32 v188, v41, v40, s35
    v_perm_b32 v189, v43, v42, s35
    v_perm_b32 v190, v45, v44, s35
    v_perm_b32 v191, v47, v46, s35
    s_add_u32 s36, s23, 0
    buffer_load_dword v16, v4, s[68:71], s36 offen
    s_add_u32 s36, s23, 3584
    buffer_load_dword v17, v4, s[68:71], s36 offen
    s_add_u32 s36, s23, 7168
    buffer_load_dword v18, v4, s[68:71], s36 offen
    s_add_u32 s36, s23, 10752
    buffer_load_dword v19, v4, s[68:71], s36 offen
    s_add_u32 s36, s23, 14336
    buffer_load_dword v20, v4, s[68:71], s36 offen
    s_add_u32 s36, s23, 17920
    buffer_load_dword v21, v4, s[68:71], s36 offen
    s_add_u32 s36, s23, 21504
    buffer_load_dword v22, v4, s[68:71], s36 offen
    s_add_u32 s36, s23, 25088
    buffer_load_dword v23, v4, s[68:71], s36 offen
    s_add_u32 s36, s23, 28672
    buffer_load_dword v24, v4, s[68:71], s36 offen
    s_add_u32 s36, s23, 32256
    buffer_load_dword v25, v4, s[68:71], s36 offen
    s_add_u32 s36, s23, 35840
    buffer_load_dword v26, v4, s[68:71], s36 offen
    s_add_u32 s36, s23, 39424
    buffer_load_dword v27, v4, s[68:71], s36 offen
    s_add_u32 s36, s23, 43008
    buffer_load_dword v28, v4, s[68:71], s36 offen
    s_add_u32 s36, s23, 46592
    buffer_load_dword v29, v4, s[68:71], s36 offen
    s_add_u32 s36, s23, 50176
    buffer_load_dword v30, v4, s[68:71], s36 offen
    s_add_u32 s36, s23, 53760
    buffer_load_dword v31, v4, s[68:71], s36 offen
    s_add_u32 s36, s23, 57344
    buffer_load_dword v32, v4, s[68:71], s36 offen
    s_add_u32 s36, s23, 60928
    buffer_load_dword v33, v4, s[68:71], s36 offen
    s_add_u32 s36, s23, 64512
    buffer_load_dword v34, v4, s[68:71], s36 offen
    s_add_u32 s36, s23, 68096
    buffer_load_dword v35, v4, s[68:71], s36 offen
    s_add_u32 s36, s23, 71680
    buffer_load_dword v36, v4, s[68:71], s36 offen
    s_add_u32 s36, s23, 75264
    buffer_load_dword v37, v4, s[68:71], s36 offen
    s_add_u32 s36, s23, 78848
    buffer_load_dword v38, v4, s[68:71], s36 offen
    s_add_u32 s36, s23, 82432
    buffer_load_dword v39, v4, s[68:71], s36 offen
    s_add_u32 s36, s23, 86016
    buffer_load_dword v40, v4, s[68:71], s36 offen
    s_add_u32 s36, s23, 89600
    buffer_load_dword v41, v4, s[68:71], s36 offen
    s_add_u32 s36, s23, 93184
    buffer_load_dword v42, v4, s[68:71], s36 offen
    s_add_u32 s36, s23, 96768
    buffer_load_dword v43, v4, s[68:71], s36 offen
    s_add_u32 s36, s23, 100352
    buffer_load_dword v44, v4, s[68:71], s36 offen
    s_add_u32 s36, s23, 103936
    buffer_load_dword v45, v4, s[68:71], s36 offen
    s_add_u32 s36, s23, 107520
    buffer_load_dword v46, v4, s[68:71], s36 offen
    s_add_u32 s36, s23, 111104
    buffer_load_dword v47, v4, s[68:71], s36 offen
    s_waitcnt vmcnt(0)
    v_perm_b32 v192, v17, v16, s34
    v_perm_b32 v193, v19, v18, s34
    v_perm_b32 v194, v21, v20, s34
    v_perm_b32 v195, v23, v22, s34
    v_perm_b32 v196, v25, v24, s34
    v_perm_b32 v197, v27, v26, s34
    v_perm_b32 v198, v29, v28, s34
    v_perm_b32 v199, v31, v30, s34
    v_perm_b32 v200, v33, v32, s34
    v_perm_b32 v201, v35, v34, s34
    v_perm_b32 v202, v37, v36, s34
    v_perm_b32 v203, v39, v38, s34
    v_perm_b32 v204, v41, v40, s34
    v_perm_b32 v205, v43, v42, s34
    v_perm_b32 v206, v45, v44, s34
    v_perm_b32 v207, v47, v46, s34
    v_perm_b32 v224, v17, v16, s35
    v_perm_b32 v225, v19, v18, s35
    v_perm_b32 v226, v21, v20, s35
    v_perm_b32 v227, v23, v22, s35
    v_perm_b32 v228, v25, v24, s35
    v_perm_b32 v229, v27, v26, s35
    v_perm_b32 v230, v29, v28, s35
    v_perm_b32 v231, v31, v30, s35
    v_perm_b32 v232, v33, v32, s35
    v_perm_b32 v233, v35, v34, s35
    v_perm_b32 v234, v37, v36, s35
    v_perm_b32 v235, v39, v38, s35
    v_perm_b32 v236, v41, v40, s35
    v_perm_b32 v237, v43, v42, s35
    v_perm_b32 v238, v45, v44, s35
    v_perm_b32 v239, v47, v46, s35
    s_add_u32 s36, s23, 114688
    buffer_load_dword v16, v4, s[68:71], s36 offen
    s_add_u32 s36, s23, 118272
    buffer_load_dword v17, v4, s[68:71], s36 offen
    s_add_u32 s36, s23, 121856
    buffer_load_dword v18, v4, s[68:71], s36 offen
    s_add_u32 s36, s23, 125440
    buffer_load_dword v19, v4, s[68:71], s36 offen
    s_add_u32 s36, s23, 129024
    buffer_load_dword v20, v4, s[68:71], s36 offen
    s_add_u32 s36, s23, 132608
    buffer_load_dword v21, v4, s[68:71], s36 offen
    s_add_u32 s36, s23, 136192
    buffer_load_dword v22, v4, s[68:71], s36 offen
    s_add_u32 s36, s23, 139776
    buffer_load_dword v23, v4, s[68:71], s36 offen
    s_add_u32 s36, s23, 143360
    buffer_load_dword v24, v4, s[68:71], s36 offen
    s_add_u32 s36, s23, 146944
    buffer_load_dword v25, v4, s[68:71], s36 offen
    s_add_u32 s36, s23, 150528
    buffer_load_dword v26, v4, s[68:71], s36 offen
    s_add_u32 s36, s23, 154112
    buffer_load_dword v27, v4, s[68:71], s36 offen
    s_add_u32 s36, s23, 157696
    buffer_load_dword v28, v4, s[68:71], s36 offen
    s_add_u32 s36, s23, 161280
    buffer_load_dword v29, v4, s[68:71], s36 offen
    s_add_u32 s36, s23, 164864
    buffer_load_dword v30, v4, s[68:71], s36 offen
    s_add_u32 s36, s23, 168448
    buffer_load_dword v31, v4, s[68:71], s36 offen
    s_add_u32 s36, s23, 172032
    buffer_load_dword v32, v4, s[68:71], s36 offen
    s_add_u32 s36, s23, 175616
    buffer_load_dword v33, v4, s[68:71], s36 offen
    s_add_u32 s36, s23, 179200
    buffer_load_dword v34, v4, s[68:71], s36 offen
    s_add_u32 s36, s23, 182784
    buffer_load_dword v35, v4, s[68:71], s36 offen
    s_add_u32 s36, s23, 186368
    buffer_load_dword v36, v4, s[68:71], s36 offen
    s_add_u32 s36, s23, 189952
    buffer_load_dword v37, v4, s[68:71], s36 offen
    s_add_u32 s36, s23, 193536
    buffer_load_dword v38, v4, s[68:71], s36 offen
    s_add_u32 s36, s23, 197120
    buffer_load_dword v39, v4, s[68:71], s36 offen
    s_add_u32 s36, s23, 200704
    buffer_load_dword v40, v4, s[68:71], s36 offen
    s_add_u32 s36, s23, 204288
    buffer_load_dword v41, v4, s[68:71], s36 offen
    s_add_u32 s36, s23, 207872
    buffer_load_dword v42, v4, s[68:71], s36 offen
    s_add_u32 s36, s23, 211456
    buffer_load_dword v43, v4, s[68:71], s36 offen
    s_add_u32 s36, s23, 215040
    buffer_load_dword v44, v4, s[68:71], s36 offen
    s_add_u32 s36, s23, 218624
    buffer_load_dword v45, v4, s[68:71], s36 offen
    s_add_u32 s36, s23, 222208
    buffer_load_dword v46, v4, s[68:71], s36 offen
    s_add_u32 s36, s23, 225792
    buffer_load_dword v47, v4, s[68:71], s36 offen
    s_waitcnt vmcnt(0)
    v_perm_b32 v208, v17, v16, s34
    v_perm_b32 v209, v19, v18, s34
    v_perm_b32 v210, v21, v20, s34
    v_perm_b32 v211, v23, v22, s34
    v_perm_b32 v212, v25, v24, s34
    v_perm_b32 v213, v27, v26, s34
    v_perm_b32 v214, v29, v28, s34
    v_perm_b32 v215, v31, v30, s34
    v_perm_b32 v216, v33, v32, s34
    v_perm_b32 v217, v35, v34, s34
    v_perm_b32 v218, v37, v36, s34
    v_perm_b32 v219, v39, v38, s34
    v_perm_b32 v220, v41, v40, s34
    v_perm_b32 v221, v43, v42, s34
    v_perm_b32 v222, v45, v44, s34
    v_perm_b32 v223, v47, v46, s34
    v_perm_b32 v240, v17, v16, s35
    v_perm_b32 v241, v19, v18, s35
    v_perm_b32 v242, v21, v20, s35
    v_perm_b32 v243, v23, v22, s35
    v_perm_b32 v244, v25, v24, s35
    v_perm_b32 v245, v27, v26, s35
    v_perm_b32 v246, v29, v28, s35
    v_perm_b32 v247, v31, v30, s35
    v_perm_b32 v248, v33, v32, s35
    v_perm_b32 v249, v35, v34, s35
    v_perm_b32 v250, v37, v36, s35
    v_perm_b32 v251, v39, v38, s35
    v_perm_b32 v252, v41, v40, s35
    v_perm_b32 v253, v43, v42, s35
    v_perm_b32 v254, v45, v44, s35
    v_perm_b32 v255, v47, v46, s35
    v_lshrrev_b32 v3, 3, v0
    v_mul_u32_u24 v4, 57344, v3
    v_and_b32 v3, 7, v0
    v_lshl_add_u32 v4, v3, 2, v4
    s_lshl_b32 s37, s20, 5
    s_add_u32 s36, s37, 0
    buffer_load_dword v16, v4, s[76:79], s36 offen
    s_add_u32 s36, s37, 1024
    buffer_load_dword v17, v4, s[76:79], s36 offen
    s_add_u32 s36, s37, 2048
    buffer_load_dword v18, v4, s[76:79], s36 offen
    s_add_u32 s36, s37, 3072
    buffer_load_dword v19, v4, s[76:79], s36 offen
    s_add_u32 s36, s37, 4096
    buffer_load_dword v20, v4, s[76:79], s36 offen
    s_add_u32 s36, s37, 5120
    buffer_load_dword v21, v4, s[76:79], s36 offen
    s_add_u32 s36, s37, 6144
    buffer_load_dword v22, v4, s[76:79], s36 offen
    s_add_u32 s36, s37, 7168
    buffer_load_dword v23, v4, s[76:79], s36 offen
    s_add_u32 s36, s37, 8192
    buffer_load_dword v24, v4, s[76:79], s36 offen
    s_add_u32 s36, s37, 9216
    buffer_load_dword v25, v4, s[76:79], s36 offen
    s_add_u32 s36, s37, 10240
    buffer_load_dword v26, v4, s[76:79], s36 offen
    s_add_u32 s36, s37, 11264
    buffer_load_dword v27, v4, s[76:79], s36 offen
    s_add_u32 s36, s37, 12288
    buffer_load_dword v28, v4, s[76:79], s36 offen
    s_add_u32 s36, s37, 13312
    buffer_load_dword v29, v4, s[76:79], s36 offen
    s_add_u32 s36, s37, 14336
    buffer_load_dword v30, v4, s[76:79], s36 offen
    s_add_u32 s36, s37, 15360
    buffer_load_dword v31, v4, s[76:79], s36 offen
    s_add_u32 s36, s37, 16384
    buffer_load_dword v32, v4, s[76:79], s36 offen
    s_add_u32 s36, s37, 17408
    buffer_load_dword v33, v4, s[76:79], s36 offen
    s_add_u32 s36, s37, 18432
    buffer_load_dword v34, v4, s[76:79], s36 offen
    s_add_u32 s36, s37, 19456
    buffer_load_dword v35, v4, s[76:79], s36 offen
    s_add_u32 s36, s37, 20480
    buffer_load_dword v36, v4, s[76:79], s36 offen
    s_add_u32 s36, s37, 21504
    buffer_load_dword v37, v4, s[76:79], s36 offen
    s_add_u32 s36, s37, 22528
    buffer_load_dword v38, v4, s[76:79], s36 offen
    s_add_u32 s36, s37, 23552
    buffer_load_dword v39, v4, s[76:79], s36 offen
    s_add_u32 s36, s37, 24576
    buffer_load_dword v40, v4, s[76:79], s36 offen
    s_add_u32 s36, s37, 25600
    buffer_load_dword v41, v4, s[76:79], s36 offen
    s_add_u32 s36, s37, 26624
    buffer_load_dword v42, v4, s[76:79], s36 offen
    s_add_u32 s36, s37, 27648
    buffer_load_dword v43, v4, s[76:79], s36 offen
    s_waitcnt vmcnt(0)
    v_perm_b32 v64, v17, v16, s34
    v_perm_b32 v65, v19, v18, s34
    v_perm_b32 v66, v21, v20, s34
    v_perm_b32 v67, v23, v22, s34
    v_perm_b32 v68, v25, v24, s34
    v_perm_b32 v69, v27, v26, s34
    v_perm_b32 v70, v29, v28, s34
    v_perm_b32 v71, v31, v30, s34
    v_perm_b32 v72, v33, v32, s34
    v_perm_b32 v73, v35, v34, s34
    v_perm_b32 v74, v37, v36, s34
    v_perm_b32 v75, v39, v38, s34
    v_perm_b32 v76, v41, v40, s34
    v_perm_b32 v77, v43, v42, s34
    v_perm_b32 v92, v17, v16, s35
    v_perm_b32 v93, v19, v18, s35
    v_perm_b32 v94, v21, v20, s35
    v_perm_b32 v95, v23, v22, s35
    v_perm_b32 v96, v25, v24, s35
    v_perm_b32 v97, v27, v26, s35
    v_perm_b32 v98, v29, v28, s35
    v_perm_b32 v99, v31, v30, s35
    v_perm_b32 v100, v33, v32, s35
    v_perm_b32 v101, v35, v34, s35
    v_perm_b32 v102, v37, v36, s35
    v_perm_b32 v103, v39, v38, s35
    v_perm_b32 v104, v41, v40, s35
    v_perm_b32 v105, v43, v42, s35
    s_add_u32 s36, s37, 28672
    buffer_load_dword v16, v4, s[76:79], s36 offen
    s_add_u32 s36, s37, 29696
    buffer_load_dword v17, v4, s[76:79], s36 offen
    s_add_u32 s36, s37, 30720
    buffer_load_dword v18, v4, s[76:79], s36 offen
    s_add_u32 s36, s37, 31744
    buffer_load_dword v19, v4, s[76:79], s36 offen
    s_add_u32 s36, s37, 32768
    buffer_load_dword v20, v4, s[76:79], s36 offen
    s_add_u32 s36, s37, 33792
    buffer_load_dword v21, v4, s[76:79], s36 offen
    s_add_u32 s36, s37, 34816
    buffer_load_dword v22, v4, s[76:79], s36 offen
    s_add_u32 s36, s37, 35840
    buffer_load_dword v23, v4, s[76:79], s36 offen
    s_add_u32 s36, s37, 36864
    buffer_load_dword v24, v4, s[76:79], s36 offen
    s_add_u32 s36, s37, 37888
    buffer_load_dword v25, v4, s[76:79], s36 offen
    s_add_u32 s36, s37, 38912
    buffer_load_dword v26, v4, s[76:79], s36 offen
    s_add_u32 s36, s37, 39936
    buffer_load_dword v27, v4, s[76:79], s36 offen
    s_add_u32 s36, s37, 40960
    buffer_load_dword v28, v4, s[76:79], s36 offen
    s_add_u32 s36, s37, 41984
    buffer_load_dword v29, v4, s[76:79], s36 offen
    s_add_u32 s36, s37, 43008
    buffer_load_dword v30, v4, s[76:79], s36 offen
    s_add_u32 s36, s37, 44032
    buffer_load_dword v31, v4, s[76:79], s36 offen
    s_add_u32 s36, s37, 45056
    buffer_load_dword v32, v4, s[76:79], s36 offen
    s_add_u32 s36, s37, 46080
    buffer_load_dword v33, v4, s[76:79], s36 offen
    s_add_u32 s36, s37, 47104
    buffer_load_dword v34, v4, s[76:79], s36 offen
    s_add_u32 s36, s37, 48128
    buffer_load_dword v35, v4, s[76:79], s36 offen
    s_add_u32 s36, s37, 49152
    buffer_load_dword v36, v4, s[76:79], s36 offen
    s_add_u32 s36, s37, 50176
    buffer_load_dword v37, v4, s[76:79], s36 offen
    s_add_u32 s36, s37, 51200
    buffer_load_dword v38, v4, s[76:79], s36 offen
    s_add_u32 s36, s37, 52224
    buffer_load_dword v39, v4, s[76:79], s36 offen
    s_add_u32 s36, s37, 53248
    buffer_load_dword v40, v4, s[76:79], s36 offen
    s_add_u32 s36, s37, 54272
    buffer_load_dword v41, v4, s[76:79], s36 offen
    s_add_u32 s36, s37, 55296
    buffer_load_dword v42, v4, s[76:79], s36 offen
    s_add_u32 s36, s37, 56320
    buffer_load_dword v43, v4, s[76:79], s36 offen
    s_waitcnt vmcnt(0)
    v_perm_b32 v78, v17, v16, s34
    v_perm_b32 v79, v19, v18, s34
    v_perm_b32 v80, v21, v20, s34
    v_perm_b32 v81, v23, v22, s34
    v_perm_b32 v82, v25, v24, s34
    v_perm_b32 v83, v27, v26, s34
    v_perm_b32 v84, v29, v28, s34
    v_perm_b32 v85, v31, v30, s34
    v_perm_b32 v86, v33, v32, s34
    v_perm_b32 v87, v35, v34, s34
    v_perm_b32 v88, v37, v36, s34
    v_perm_b32 v89, v39, v38, s34
    v_perm_b32 v90, v41, v40, s34
    v_perm_b32 v91, v43, v42, s34
    v_perm_b32 v106, v17, v16, s35
    v_perm_b32 v107, v19, v18, s35
    v_perm_b32 v108, v21, v20, s35
    v_perm_b32 v109, v23, v22, s35
    v_perm_b32 v110, v25, v24, s35
    v_perm_b32 v111, v27, v26, s35
    v_perm_b32 v112, v29, v28, s35
    v_perm_b32 v113, v31, v30, s35
    v_perm_b32 v114, v33, v32, s35
    v_perm_b32 v115, v35, v34, s35
    v_perm_b32 v116, v37, v36, s35
    v_perm_b32 v117, v39, v38, s35
    v_perm_b32 v118, v41, v40, s35
    v_perm_b32 v119, v43, v42, s35
    s_mov_b32 s42, 0xffff0000
    s_mov_b32 s24, 0
    s_mov_b64 s[28:29], 0
    v_mov_b32 v12, 0x40000000
    v_mov_b32 v13, 0
    v_lshlrev_b32 v3, 4, v0
L_M06_rp:
    s_mov_b32 s36, 0x19a000
    buffer_load_dwordx4 v[40:43], v3, s[8:11], s36 offen sc1
    s_add_u32 s32, s32, 1
    v_mov_b32 v5, 0
    s_waitcnt vmcnt(0)
    v_max3_u32 v5, v5, v40, v41
    v_max3_u32 v5, v5, v42, v43
    s_cmp_gt_u32 s32, 200000
    s_cbranch_scc1 L_M06_rp_ok
    v_cmp_eq_u32 vcc, -1, v5
    s_cbranch_vccz L_M06_rp_ok
    s_sleep 32
    s_branch L_M06_rp
L_M06_rp_ok:
    v_add_f32 v40, v40, v41
    v_add_f32 v42, v42, v43
    v_add_f32 v40, v40, v42
    v_cvt_pk_bf16_f32 v5, v40, v40
    v_lshlrev_b32 v40, 16, v5
    v_ashrrev_i32 v5, 31, v40
    v_or_b32 v5, 0x80000000, v5
    v_xor_b32 v5, v5, v40
    v_and_b32 v5, 0xffff0000, v5
    v_sub_u32 v6, 511, v0
    v_or_b32 v126, v5, v6
    v_lshlrev_b32 v3, 4, v0
L_M01_rp:
    s_mov_b32 s36, 0x195000
    buffer_load_dwordx4 v[20:23], v3, s[8:11], s36 offen sc1
    s_mov_b32 s36, 0x196000
    buffer_load_dwordx4 v[24:27], v3, s[8:11], s36 offen sc1
    s_mov_b32 s36, 0x197000
    buffer_load_dwordx4 v[28:31], v3, s[8:11], s36 offen sc1
    s_mov_b32 s36, 0x198000
    buffer_load_dwordx4 v[32:35], v3, s[8:11], s36 offen sc1
    s_mov_b32 s36, 0x199000
    buffer_load_dwordx4 v[36:39], v3, s[8:11], s36 offen sc1
    s_add_u32 s32, s32, 1
    v_mov_b32 v5, 0
    s_waitcnt vmcnt(0)
    v_max3_u32 v5, v5, v20, v21
    v_max3_u32 v5, v5, v22, v23
    v_max3_u32 v5, v5, v24, v25
    v_max3_u32 v5, v5, v26, v27
    v_max3_u32 v5, v5, v28, v29
    v_max3_u32 v5, v5, v30, v31
    v_max3_u32 v5, v5, v32, v33
    v_max3_u32 v5, v5, v34, v35
    v_max3_u32 v5, v5, v36, v37
    v_max3_u32 v5, v5, v38, v39
    s_cmp_gt_u32 s32, 200000
    s_cbranch_scc1 L_M01_rp_ok
    v_cmp_eq_u32 vcc, -1, v5
    s_cbranch_vccz L_M01_rp_ok
    s_sleep 8
    s_branch L_M01_rp
L_M01_rp_ok:
    v_add_f32 v20, v20, v21
    v_add_f32 v22, v22, v23
    v_add_f32 v20, v20, v22
    v_cvt_pk_bf16_f32 v5, v20, v20
    v_lshlrev_b32 v20, 16, v5
    v_ashrrev_i32 v5, 31, v20
    v_or_b32 v5, 0x80000000, v5
    v_xor_b32 v5, v5, v20
    v_and_b32 v5, 0xffff0000, v5
    v_sub_u32 v6, 1791, v0
    v_or_b32 v121, v5, v6
    v_add_f32 v24, v24, v25
    v_add_f32 v26, v26, v27
    v_add_f32 v24, v24, v26
    v_cvt_pk_bf16_f32 v5, v24, v24
    v_lshlrev_b32 v24, 16, v5
    v_ashrrev_i32 v5, 31, v24
    v_or_b32 v5, 0x80000000, v5
    v_xor_b32 v5, v5, v24
    v_and_b32 v5, 0xffff0000, v5
    v_sub_u32 v6, 1535, v0
    v_or_b32 v122, v5, v6
    v_add_f32 v28, v28, v29
    v_add_f32 v30, v30, v31
    v_add_f32 v28, v28, v30
    v_cvt_pk_bf16_f32 v5, v28, v28
    v_lshlrev_b32 v28, 16, v5
    v_ashrrev_i32 v5, 31, v28
    v_or_b32 v5, 0x80000000, v5
    v_xor_b32 v5, v5, v28
    v_and_b32 v5, 0xffff0000, v5
    v_sub_u32 v6, 1279, v0
    v_or_b32 v123, v5, v6
    v_add_f32 v32, v32, v33
    v_add_f32 v34, v34, v35
    v_add_f32 v32, v32, v34
    v_cvt_pk_bf16_f32 v5, v32, v32
    v_lshlrev_b32 v32, 16, v5
    v_ashrrev_i32 v5, 31, v32
    v_or_b32 v5, 0x80000000, v5
    v_xor_b32 v5, v5, v32
    v_and_b32 v5, 0xffff0000, v5
    v_sub_u32 v6, 1023, v0
    v_or_b32 v124, v5, v6
    v_add_f32 v36, v36, v37
    v_add_f32 v38, v38, v39
    v_add_f32 v36, v36, v38
    v_cvt_pk_bf16_f32 v5, v36, v36
    v_lshlrev_b32 v36, 16, v5
    v_ashrrev_i32 v5, 31, v36
    v_or_b32 v5, 0x80000000, v5
    v_xor_b32 v5, v5, v36
    v_and_b32 v5, 0xffff0000, v5
    v_sub_u32 v6, 767, v0
    v_or_b32 v125, v5, v6
    v_max_u32 v5, v120, v121
    v_min_u32 v6, v120, v121
    v_med3_u32 v6, v5, v6, v122
    v_max_u32 v5, v5, v122
    v_med3_u32 v6, v5, v6, v123
    v_max_u32 v5, v5, v123
    v_med3_u32 v6, v5, v6, v124
    v_max_u32 v5, v5, v124
    v_med3_u32 v6, v5, v6, v125
    v_max_u32 v5, v5, v125
    v_med3_u32 v6, v5, v6, v126
    v_max_u32 v5, v5, v126
    v_mov_b32 v120, v5
    v_mov_b32 v121, v6
    s_mov_b32 s25, 32
L_M_round:
    v_lshlrev_b32 v3, 4, v0
    v_cmp_gt_u32 s[74:75], s25, v0
L_M7_rp:
    s_mov_b32 s36, 0x19b000
    buffer_load_dwordx4 v[44:47], v3, s[8:11], s36 offen sc1
    s_add_u32 s32, s32, 1
    v_mov_b32 v5, 0
    s_waitcnt vmcnt(0)
    v_max3_u32 v5, v5, v44, v45
    v_max3_u32 v5, v5, v46, v47
    v_cndmask_b32 v5, 0, v5, s[74:75]
    s_cmp_gt_u32 s32, 200000
    s_cbranch_scc1 L_M7_rp_ok
    v_cmp_eq_u32 vcc, -1, v5
    s_cbranch_vccnz L_M7_rp
L_M7_rp_ok:
    v_add_f32 v44, v44, v45
    v_add_f32 v46, v46, v47
    v_add_f32 v44, v44, v46
    v_cvt_pk_bf16_f32 v5, v44, v44
    v_lshlrev_b32 v44, 16, v5
    v_ashrrev_i32 v5, 31, v44
    v_or_b32 v5, 0x80000000, v5
    v_xor_b32 v5, v5, v44
    v_and_b32 v5, 0xffff0000, v5
    v_sub_u32 v6, 255, v0
    v_or_b32 v127, v5, v6
    v_cndmask_b32 v127, 0, v127, s[74:75]
    v_max_u32 v5, v120, v127
    v_med3_u32 v6, v120, v121, v127
    s_nop 0
    v_mov_b32_dpp v7, v5 quad_perm:[1,0,3,2] row_mask:0xf bank_mask:0xf
    v_mov_b32_dpp v8, v6 quad_perm:[1,0,3,2] row_mask:0xf bank_mask:0xf
    v_min_u32 v9, v5, v7
    v_max_u32 v5, v5, v7
    v_max3_u32 v6, v6, v8, v9
    s_nop 0
    v_mov_b32_dpp v7, v5 quad_perm:[2,3,0,1] row_mask:0xf bank_mask:0xf
    v_mov_b32_dpp v8, v6 quad_perm:[2,3,0,1] row_mask:0xf bank_mask:0xf
    v_min_u32 v9, v5, v7
    v_max_u32 v5, v5, v7
    v_max3_u32 v6, v6, v8, v9
    s_nop 0
    v_mov_b32_dpp v7, v5 row_half_mirror row_mask:0xf bank_mask:0xf
    v_mov_b32_dpp v8, v6 row_half_mirror row_mask:0xf bank_mask:0xf
    v_min_u32 v9, v5, v7
    v_max_u32 v5, v5, v7
    v_max3_u32 v6, v6, v8, v9
    s_nop 0
    v_mov_b32_dpp v7, v5 row_mirror row_mask:0xf bank_mask:0xf
    v_mov_b32_dpp v8, v6 row_mirror row_mask:0xf bank_mask:0xf
    v_min_u32 v9, v5, v7
    v_max_u32 v5, v5, v7
    v_max3_u32 v6, v6, v8, v9
    v_lshrrev_b32 v9, 4, v0
    v_lshlrev_b32 v9, 3, v9
    s_barrier
    ds_write2_b32 v9, v5, v6 offset0:0 offset1:1
    v_and_b32 v9, 15, v0
    v_lshlrev_b32 v9, 3, v9
    s_waitcnt lgkmcnt(0)
    s_barrier
    ds_read2_b32 v[10:11], v9 offset0:0 offset1:1
    s_waitcnt lgkmcnt(0)
    v_mov_b32 v5, v10
    v_mov_b32 v6, v11
    s_nop 0
    v_mov_b32_dpp v7, v5 quad_perm:[1,0,3,2] row_mask:0xf bank_mask:0xf
    v_mov_b32_dpp v8, v6 quad_perm:[1,0,3,2] row_mask:0xf bank_mask:0xf
    v_min_u32 v9, v5, v7
    v_max_u32 v5, v5, v7
    v_max3_u32 v6, v6, v8, v9
    s_nop 0
    v_mov_b32_dpp v7, v5 quad_perm:[2,3,0,1] row_mask:0xf bank_mask:0xf
    v_mov_b32_dpp v8, v6 quad_perm:[2,3,0,1] row_mask:0xf bank_mask:0xf
    v_min_u32 v9, v5, v7
    v_max_u32 v5, v5, v7
    v_max3_u32 v6, v6, v8, v9
    s_nop 0
    v_mov_b32_dpp v7, v5 row_half_mirror row_mask:0xf bank_mask:0xf
    v_mov_b32_dpp v8, v6 row_half_mirror row_mask:0xf bank_mask:0xf
    v_min_u32 v9, v5, v7
    v_max_u32 v5, v5, v7
    v_max3_u32 v6, v6, v8, v9
    s_nop 0
    v_mov_b32_dpp v7, v5 row_mirror row_mask:0xf bank_mask:0xf
    v_mov_b32_dpp v8, v6 row_mirror row_mask:0xf bank_mask:0xf
    v_min_u32 v9, v5, v7
    v_max_u32 v5, v5, v7
    v_max3_u32 v6, v6, v8, v9
    v_readfirstlane_b32 s26, v5
    v_readfirstlane_b32 s27, v6
    s_nop 3
    s_cmp_eq_u64 s[26:27], s[28:29]
    s_cbranch_scc1 L_M_next
    s_mov_b64 s[28:29], s[26:27]
    buffer_store_dword v13, v12, s[60:63], 0 offen sc1
    s_and_b32 s36, s26, 0x7ff
    s_sub_u32 s30, 2047, s36
    s_and_b32 s36, s26, 0xffff0000
    s_xor_b32 s37, s36, 0x80000000
    s_xor_b32 s40, s36, 0xffff0000
    s_bitcmp1_b32 s36, 31
    s_cselect_b32 s40, s37, s40
    s_and_b32 s36, s27, 0x7ff
    s_sub_u32 s31, 2047, s36
    s_and_b32 s36, s27, 0xffff0000
    s_xor_b32 s37, s36, 0x80000000
    s_xor_b32 s41, s36, 0xffff0000
    s_bitcmp1_b32 s36, 31
    s_cselect_b32 s41, s37, s41
    v_mov_b32 v8, 0
L_M_rows:
    s_lshl_b32 s36, s30, 4
    s_add_u32 s36, s36, 0x1b8000
    buffer_load_dwordx4 v[16:19], v8, s[8:11], s36 offen sc1
    s_lshl_b32 s36, s31, 4
    s_add_u32 s36, s36, 0x1b8000
    buffer_load_dwordx4 v[20:23], v8, s[8:11], s36 offen sc1
    s_add_u32 s32, s32, 1
    s_cmp_gt_u32 s32, 200000
    s_waitcnt vmcnt(0)
    v_or3_b32 v5, v16, v17, v18
    v_or3_b32 v5, v5, v19, v20
    v_or3_b32 v5, v5, v21, v22
    v_or_b32 v5, v5, v23
    s_cbranch_scc1 L_M_rows_ok
    v_cmp_ne_u32 vcc, 0, v5
    s_cbranch_vccnz L_M_rows
L_M_rows_ok:
    v_bfe_u32 v9, v0, 6, 1
    v_cmp_ne_u32 vcc, 0, v9
    v_mov_b32 v5, s30
    v_mov_b32 v6, s31
    v_cndmask_b32 v7, v5, v6, vcc
    v_lshlrev_b32 v7, 10, v7
    v_and_b32 v8, 63, v0
    v_lshl_add_u32 v7, v8, 4, v7
    s_mov_b32 s37, 0x600000
    buffer_load_dwordx4 v[16:19], v7, s[8:11], s37 offen sc1
    v_bfe_u32 v9, v0, 3, 1
    v_cmp_ne_u32 vcc, 0, v9
    s_nop 1
    v_cndmask_b32 v12, v5, v6, vcc
    v_mov_b32 v5, s40
    v_mov_b32 v6, s41
    v_cndmask_b32 v11, v5, v6, vcc
    v_lshlrev_b32 v12, 10, v12
    v_and_b32 v3, 7, v0
    v_lshl_add_u32 v12, v3, 2, v12
    s_lshl_b32 s36, s20, 5
    v_add_u32 v12, s36, v12
    v_mov_b32 v7, 0x40000000
    v_cmp_lt_u32 vcc, 15, v0
    s_nop 1
    v_cndmask_b32 v12, v12, v7, vcc
    s_mov_b32 s36, 0x400000
    buffer_load_dword v14, v12, s[8:11], s36 offen sc1
    buffer_load_dword v15, v12, s[8:11], s37 offen sc1
    v_and_b32 v8, 127, v0
    v_lshlrev_b32 v8, 4, v8
    s_waitcnt vmcnt(2)
    ds_write_b128 v8, v[16:19] offset:4096
    s_waitcnt lgkmcnt(0)
    s_barrier
    v_mov_b64 v[48:49], 0
    v_mov_b64 v[50:51], 0
    v_mov_b64 v[52:53], 0
    v_mov_b64 v[54:55], 0
    v_lshlrev_b32 v8, 7, v1
    ds_read_b128 v[16:19], v8 offset:4096
    ds_read_b128 v[20:23], v8 offset:4112
    ds_read_b128 v[24:27], v8 offset:4128
    ds_read_b128 v[28:31], v8 offset:4144
    ds_read_b128 v[32:35], v8 offset:5120
    ds_read_b128 v[36:39], v8 offset:5136
    ds_read_b128 v[40:43], v8 offset:5152
    ds_read_b128 v[44:47], v8 offset:5168
    s_waitcnt lgkmcnt(0)
    v_dot2_f32_bf16 v48, v16, v128, v48
    v_dot2_f32_bf16 v49, v16, v160, v49
    v_dot2_f32_bf16 v50, v32, v128, v50
    v_dot2_f32_bf16 v51, v32, v160, v51
    v_dot2_f32_bf16 v52, v16, v192, v52
    v_dot2_f32_bf16 v53, v16, v224, v53
    v_dot2_f32_bf16 v54, v32, v192, v54
    v_dot2_f32_bf16 v55, v32, v224, v55
    v_dot2_f32_bf16 v48, v17, v129, v48
    v_dot2_f32_bf16 v49, v17, v161, v49
    v_dot2_f32_bf16 v50, v33, v129, v50
    v_dot2_f32_bf16 v51, v33, v161, v51
    v_dot2_f32_bf16 v52, v17, v193, v52
    v_dot2_f32_bf16 v53, v17, v225, v53
    v_dot2_f32_bf16 v54, v33, v193, v54
    v_dot2_f32_bf16 v55, v33, v225, v55
    v_dot2_f32_bf16 v48, v18, v130, v48
    v_dot2_f32_bf16 v49, v18, v162, v49
    v_dot2_f32_bf16 v50, v34, v130, v50
    v_dot2_f32_bf16 v51, v34, v162, v51
    v_dot2_f32_bf16 v52, v18, v194, v52
    v_dot2_f32_bf16 v53, v18, v226, v53
    v_dot2_f32_bf16 v54, v34, v194, v54
    v_dot2_f32_bf16 v55, v34, v226, v55
    v_dot2_f32_bf16 v48, v19, v131, v48
    v_dot2_f32_bf16 v49, v19, v163, v49
    v_dot2_f32_bf16 v50, v35, v131, v50
    v_dot2_f32_bf16 v51, v35, v163, v51
    v_dot2_f32_bf16 v52, v19, v195, v52
    v_dot2_f32_bf16 v53, v19, v227, v53
    v_dot2_f32_bf16 v54, v35, v195, v54
    v_dot2_f32_bf16 v55, v35, v227, v55
    v_dot2_f32_bf16 v48, v20, v132, v48
    v_dot2_f32_bf16 v49, v20, v164, v49
    v_dot2_f32_bf16 v50, v36, v132, v50
    v_dot2_f32_bf16 v51, v36, v164, v51
    v_dot2_f32_bf16 v52, v20, v196, v52
    v_dot2_f32_bf16 v53, v20, v228, v53
    v_dot2_f32_bf16 v54, v36, v196, v54
    v_dot2_f32_bf16 v55, v36, v228, v55
    v_dot2_f32_bf16 v48, v21, v133, v48
    v_dot2_f32_bf16 v49, v21, v165, v49
    v_dot2_f32_bf16 v50, v37, v133, v50
    v_dot2_f32_bf16 v51, v37, v165, v51
    v_dot2_f32_bf16 v52, v21, v197, v52
    v_dot2_f32_bf16 v53, v21, v229, v53
    v_dot2_f32_bf16 v54, v37, v197, v54
    v_dot2_f32_bf16 v55, v37, v229, v55
    v_dot2_f32_bf16 v48, v22, v134, v48
    v_dot2_f32_bf16 v49, v22, v166, v49
    v_dot2_f32_bf16 v50, v38, v134, v50
    v_dot2_f32_bf16 v51, v38, v166, v51
    v_dot2_f32_bf16 v52, v22, v198, v52
    v_dot2_f32_bf16 v53, v22, v230, v53
    v_dot2_f32_bf16 v54, v38, v198, v54
    v_dot2_f32_bf16 v55, v38, v230, v55
    v_dot2_f32_bf16 v48, v23, v135, v48
    v_dot2_f32_bf16 v49, v23, v167, v49
    v_dot2_f32_bf16 v50, v39, v135, v50
    v_dot2_f32_bf16 v51, v39, v167, v51
    v_dot2_f32_bf16 v52, v23, v199, v52
    v_dot2_f32_bf16 v53, v23, v231, v53
    v_dot2_f32_bf16 v54, v39, v199, v54
    v_dot2_f32_bf16 v55, v39, v231, v55
    v_dot2_f32_bf16 v48, v24, v136, v48
    v_dot2_f32_bf16 v49, v24, v168, v49
    v_dot2_f32_bf16 v50, v40, v136, v50
    v_dot2_f32_bf16 v51, v40, v168, v51
    v_dot2_f32_bf16 v52, v24, v200, v52
    v_dot2_f32_bf16 v53, v24, v232, v53
    v_dot2_f32_bf16 v54, v40, v200, v54
    v_dot2_f32_bf16 v55, v40, v232, v55
    v_dot2_f32_bf16 v48, v25, v137, v48
    v_dot2_f32_bf16 v49, v25, v169, v49
    v_dot2_f32_bf16 v50, v41, v137, v50
    v_dot2_f32_bf16 v51, v41, v169, v51
    v_dot2_f32_bf16 v52, v25, v201, v52
    v_dot2_f32_bf16 v53, v25, v233, v53
    v_dot2_f32_bf16 v54, v41, v201, v54
    v_dot2_f32_bf16 v55, v41, v233, v55
    v_dot2_f32_bf16 v48, v26, v138, v48
    v_dot2_f32_bf16 v49, v26, v170, v49
    v_dot2_f32_bf16 v50, v42, v138, v50
    v_dot2_f32_bf16 v51, v42, v170, v51
    v_dot2_f32_bf16 v52, v26, v202, v52
    v_dot2_f32_bf16 v53, v26, v234, v53
    v_dot2_f32_bf16 v54, v42, v202, v54
    v_dot2_f32_bf16 v55, v42, v234, v55
    v_dot2_f32_bf16 v48, v27, v139, v48
    v_dot2_f32_bf16 v49, v27, v171, v49
    v_dot2_f32_bf16 v50, v43, v139, v50
    v_dot2_f32_bf16 v51, v43, v171, v51
    v_dot2_f32_bf16 v52, v27, v203, v52
    v_dot2_f32_bf16 v53, v27, v235, v53
    v_dot2_f32_bf16 v54, v43, v203, v54
    v_dot2_f32_bf16 v55, v43, v235, v55
    v_dot2_f32_bf16 v48, v28, v140, v48
    v_dot2_f32_bf16 v49, v28, v172, v49
    v_dot2_f32_bf16 v50, v44, v140, v50
    v_dot2_f32_bf16 v51, v44, v172, v51
    v_dot2_f32_bf16 v52, v28, v204, v52
    v_dot2_f32_bf16 v53, v28, v236, v53
    v_dot2_f32_bf16 v54, v44, v204, v54
    v_dot2_f32_bf16 v55, v44, v236, v55
    v_dot2_f32_bf16 v48, v29, v141, v48
    v_dot2_f32_bf16 v49, v29, v173, v49
    v_dot2_f32_bf16 v50, v45, v141, v50
    v_dot2_f32_bf16 v51, v45, v173, v51
    v_dot2_f32_bf16 v52, v29, v205, v52
    v_dot2_f32_bf16 v53, v29, v237, v53
    v_dot2_f32_bf16 v54, v45, v205, v54
    v_dot2_f32_bf16 v55, v45, v237, v55
    v_dot2_f32_bf16 v48, v30, v142, v48
    v_dot2_f32_bf16 v49, v30, v174, v49
    v_dot2_f32_bf16 v50, v46, v142, v50
    v_dot2_f32_bf16 v51, v46, v174, v51
    v_dot2_f32_bf16 v52, v30, v206, v52
    v_dot2_f32_bf16 v53, v30, v238, v53
    v_dot2_f32_bf16 v54, v46, v206, v54
    v_dot2_f32_bf16 v55, v46, v238, v55
    v_dot2_f32_bf16 v48, v31, v143, v48
    v_dot2_f32_bf16 v49, v31, v175, v49
    v_dot2_f32_bf16 v50, v47, v143, v50
    v_dot2_f32_bf16 v51, v47, v175, v51
    v_dot2_f32_bf16 v52, v31, v207, v52
    v_dot2_f32_bf16 v53, v31, v239, v53
    v_dot2_f32_bf16 v54, v47, v207, v54
    v_dot2_f32_bf16 v55, v47, v239, v55
    ds_read_b128 v[16:19], v8 offset:4160
    ds_read_b128 v[20:23], v8 offset:4176
    ds_read_b128 v[24:27], v8 offset:4192
    ds_read_b128 v[28:31], v8 offset:4208
    ds_read_b128 v[32:35], v8 offset:5184
    ds_read_b128 v[36:39], v8 offset:5200
    ds_read_b128 v[40:43], v8 offset:5216
    ds_read_b128 v[44:47], v8 offset:5232
    s_waitcnt lgkmcnt(0)
    v_dot2_f32_bf16 v48, v16, v144, v48
    v_dot2_f32_bf16 v49, v16, v176, v49
    v_dot2_f32_bf16 v50, v32, v144, v50
    v_dot2_f32_bf16 v51, v32, v176, v51
    v_dot2_f32_bf16 v52, v16, v208, v52
    v_dot2_f32_bf16 v53, v16, v240, v53
    v_dot2_f32_bf16 v54, v32, v208, v54
    v_dot2_f32_bf16 v55, v32, v240, v55
    v_dot2_f32_bf16 v48, v17, v145, v48
    v_dot2_f32_bf16 v49, v17, v177, v49
    v_dot2_f32_bf16 v50, v33, v145, v50
    v_dot2_f32_bf16 v51, v33, v177, v51
    v_dot2_f32_bf16 v52, v17, v209, v52
    v_dot2_f32_bf16 v53, v17, v241, v53
    v_dot2_f32_bf16 v54, v33, v209, v54
    v_dot2_f32_bf16 v55, v33, v241, v55
    v_dot2_f32_bf16 v48, v18, v146, v48
    v_dot2_f32_bf16 v49, v18, v178, v49
    v_dot2_f32_bf16 v50, v34, v146, v50
    v_dot2_f32_bf16 v51, v34, v178, v51
    v_dot2_f32_bf16 v52, v18, v210, v52
    v_dot2_f32_bf16 v53, v18, v242, v53
    v_dot2_f32_bf16 v54, v34, v210, v54
    v_dot2_f32_bf16 v55, v34, v242, v55
    v_dot2_f32_bf16 v48, v19, v147, v48
    v_dot2_f32_bf16 v49, v19, v179, v49
    v_dot2_f32_bf16 v50, v35, v147, v50
    v_dot2_f32_bf16 v51, v35, v179, v51
    v_dot2_f32_bf16 v52, v19, v211, v52
    v_dot2_f32_bf16 v53, v19, v243, v53
    v_dot2_f32_bf16 v54, v35, v211, v54
    v_dot2_f32_bf16 v55, v35, v243, v55
    v_dot2_f32_bf16 v48, v20, v148, v48
    v_dot2_f32_bf16 v49, v20, v180, v49
    v_dot2_f32_bf16 v50, v36, v148, v50
    v_dot2_f32_bf16 v51, v36, v180, v51
    v_dot2_f32_bf16 v52, v20, v212, v52
    v_dot2_f32_bf16 v53, v20, v244, v53
    v_dot2_f32_bf16 v54, v36, v212, v54
    v_dot2_f32_bf16 v55, v36, v244, v55
    v_dot2_f32_bf16 v48, v21, v149, v48
    v_dot2_f32_bf16 v49, v21, v181, v49
    v_dot2_f32_bf16 v50, v37, v149, v50
    v_dot2_f32_bf16 v51, v37, v181, v51
    v_dot2_f32_bf16 v52, v21, v213, v52
    v_dot2_f32_bf16 v53, v21, v245, v53
    v_dot2_f32_bf16 v54, v37, v213, v54
    v_dot2_f32_bf16 v55, v37, v245, v55
    v_dot2_f32_bf16 v48, v22, v150, v48
    v_dot2_f32_bf16 v49, v22, v182, v49
    v_dot2_f32_bf16 v50, v38, v150, v50
    v_dot2_f32_bf16 v51, v38, v182, v51
    v_dot2_f32_bf16 v52, v22, v214, v52
    v_dot2_f32_bf16 v53, v22, v246, v53
    v_dot2_f32_bf16 v54, v38, v214, v54
    v_dot2_f32_bf16 v55, v38, v246, v55
    v_dot2_f32_bf16 v48, v23, v151, v48
    v_dot2_f32_bf16 v49, v23, v183, v49
    v_dot2_f32_bf16 v50, v39, v151, v50
    v_dot2_f32_bf16 v51, v39, v183, v51
    v_dot2_f32_bf16 v52, v23, v215, v52
    v_dot2_f32_bf16 v53, v23, v247, v53
    v_dot2_f32_bf16 v54, v39, v215, v54
    v_dot2_f32_bf16 v55, v39, v247, v55
    v_dot2_f32_bf16 v48, v24, v152, v48
    v_dot2_f32_bf16 v49, v24, v184, v49
    v_dot2_f32_bf16 v50, v40, v152, v50
    v_dot2_f32_bf16 v51, v40, v184, v51
    v_dot2_f32_bf16 v52, v24, v216, v52
    v_dot2_f32_bf16 v53, v24, v248, v53
    v_dot2_f32_bf16 v54, v40, v216, v54
    v_dot2_f32_bf16 v55, v40, v248, v55
    v_dot2_f32_bf16 v48, v25, v153, v48
    v_dot2_f32_bf16 v49, v25, v185, v49
    v_dot2_f32_bf16 v50, v41, v153, v50
    v_dot2_f32_bf16 v51, v41, v185, v51
    v_dot2_f32_bf16 v52, v25, v217, v52
    v_dot2_f32_bf16 v53, v25, v249, v53
    v_dot2_f32_bf16 v54, v41, v217, v54
    v_dot2_f32_bf16 v55, v41, v249, v55
    v_dot2_f32_bf16 v48, v26, v154, v48
    v_dot2_f32_bf16 v49, v26, v186, v49
    v_dot2_f32_bf16 v50, v42, v154, v50
    v_dot2_f32_bf16 v51, v42, v186, v51
    v_dot2_f32_bf16 v52, v26, v218, v52
    v_dot2_f32_bf16 v53, v26, v250, v53
    v_dot2_f32_bf16 v54, v42, v218, v54
    v_dot2_f32_bf16 v55, v42, v250, v55
    v_dot2_f32_bf16 v48, v27, v155, v48
    v_dot2_f32_bf16 v49, v27, v187, v49
    v_dot2_f32_bf16 v50, v43, v155, v50
    v_dot2_f32_bf16 v51, v43, v187, v51
    v_dot2_f32_bf16 v52, v27, v219, v52
    v_dot2_f32_bf16 v53, v27, v251, v53
    v_dot2_f32_bf16 v54, v43, v219, v54
    v_dot2_f32_bf16 v55, v43, v251, v55
    v_dot2_f32_bf16 v48, v28, v156, v48
    v_dot2_f32_bf16 v49, v28, v188, v49
    v_dot2_f32_bf16 v50, v44, v156, v50
    v_dot2_f32_bf16 v51, v44, v188, v51
    v_dot2_f32_bf16 v52, v28, v220, v52
    v_dot2_f32_bf16 v53, v28, v252, v53
    v_dot2_f32_bf16 v54, v44, v220, v54
    v_dot2_f32_bf16 v55, v44, v252, v55
    v_dot2_f32_bf16 v48, v29, v157, v48
    v_dot2_f32_bf16 v49, v29, v189, v49
    v_dot2_f32_bf16 v50, v45, v157, v50
    v_dot2_f32_bf16 v51, v45, v189, v51
    v_dot2_f32_bf16 v52, v29, v221, v52
    v_dot2_f32_bf16 v53, v29, v253, v53
    v_dot2_f32_bf16 v54, v45, v221, v54
    v_dot2_f32_bf16 v55, v45, v253, v55
    v_dot2_f32_bf16 v48, v30, v158, v48
    v_dot2_f32_bf16 v49, v30, v190, v49
    v_dot2_f32_bf16 v50, v46, v158, v50
    v_dot2_f32_bf16 v51, v46, v190, v51
    v_dot2_f32_bf16 v52, v30, v222, v52
    v_dot2_f32_bf16 v53, v30, v254, v53
    v_dot2_f32_bf16 v54, v46, v222, v54
    v_dot2_f32_bf16 v55, v46, v254, v55
    v_dot2_f32_bf16 v48, v31, v159, v48
    v_dot2_f32_bf16 v49, v31, v191, v49
    v_dot2_f32_bf16 v50, v47, v159, v50
    v_dot2_f32_bf16 v51, v47, v191, v51
    v_dot2_f32_bf16 v52, v31, v223, v52
    v_dot2_f32_bf16 v53, v31, v255, v53
    v_dot2_f32_bf16 v54, v47, v223, v54
    v_dot2_f32_bf16 v55, v47, v255, v55
    s_nop 3
    v_lshlrev_b32 v7, 5, v0
    ds_write_b128 v7, v[48:51] offset:8192
    ds_write_b128 v7, v[52:55] offset:8208
    s_waitcnt lgkmcnt(0)
    s_barrier
    v_lshlrev_b32 v7, 5, v2
    v_bfe_u32 v8, v0, 5, 1
    v_lshl_add_u32 v7, v8, 3, v7
    ds_read_b64 v[16:17], v7 offset:8192
    ds_read_b64 v[18:19], v7 offset:8208
    ds_read_b64 v[20:21], v7 offset:9216
    ds_read_b64 v[22:23], v7 offset:9232
    ds_read_b64 v[24:25], v7 offset:10240
    ds_read_b64 v[26:27], v7 offset:10256
    ds_read_b64 v[28:29], v7 offset:11264
    ds_read_b64 v[30:31], v7 offset:11280
    s_waitcnt lgkmcnt(0)
    ds_read_b64 v[32:33], v7 offset:12288
    ds_read_b64 v[34:35], v7 offset:12304
    ds_read_b64 v[36:37], v7 offset:13312
    ds_read_b64 v[38:39], v7 offset:13328
    ds_read_b64 v[40:41], v7 offset:14336
    ds_read_b64 v[42:43], v7 offset:14352
    ds_read_b64 v[44:45], v7 offset:15360
    ds_read_b64 v[46:47], v7 offset:15376
    s_waitcnt lgkmcnt(0)
    v_add_f32 v16, v16, v20
    v_add_f32 v16, v16, v24
    v_add_f32 v16, v16, v28
    v_add_f32 v16, v16, v32
    v_add_f32 v16, v16, v36
    v_add_f32 v16, v16, v40
    v_add_f32 v16, v16, v44
    v_cvt_pk_bf16_f32 v5, v16, v16
    v_lshlrev_b32 v16, 16, v5
    v_add_f32 v17, v17, v21
    v_add_f32 v17, v17, v25
    v_add_f32 v17, v17, v29
    v_add_f32 v17, v17, v33
    v_add_f32 v17, v17, v37
    v_add_f32 v17, v17, v41
    v_add_f32 v17, v17, v45
    v_cvt_pk_bf16_f32 v5, v17, v17
    v_lshlrev_b32 v17, 16, v5
    v_add_f32 v18, v18, v22
    v_add_f32 v18, v18, v26
    v_add_f32 v18, v18, v30
    v_add_f32 v18, v18, v34
    v_add_f32 v18, v18, v38
    v_add_f32 v18, v18, v42
    v_add_f32 v18, v18, v46
    v_cvt_pk_bf16_f32 v5, v18, v18
    v_lshlrev_b32 v18, 16, v5
    v_add_f32 v19, v19, v23
    v_add_f32 v19, v19, v27
    v_add_f32 v19, v19, v31
    v_add_f32 v19, v19, v35
    v_add_f32 v19, v19, v39
    v_add_f32 v19, v19, v43
    v_add_f32 v19, v19, v47
    v_cvt_pk_bf16_f32 v5, v19, v19
    v_lshlrev_b32 v19, 16, v5
    v_mul_f32 v6, 0xbfb8aa3b, v16
    v_exp_f32 v6, v6
    s_nop 0
    v_add_f32 v6, 1.0, v6
    v_rcp_f32 v6, v6
    s_nop 0
    v_mul_f32 v16, v16, v6
    v_cvt_pk_bf16_f32 v5, v16, v16
    v_lshlrev_b32 v16, 16, v5
    v_mul_f32 v16, v16, v18
    v_mul_f32 v6, 0xbfb8aa3b, v17
    v_exp_f32 v6, v6
    s_nop 0
    v_add_f32 v6, 1.0, v6
    v_rcp_f32 v6, v6
    s_nop 0
    v_mul_f32 v17, v17, v6
    v_cvt_pk_bf16_f32 v5, v17, v17
    v_lshlrev_b32 v17, 16, v5
    v_mul_f32 v17, v17, v19
    v_cvt_pk_bf16_f32 v16, v16, v17
    v_mul_u32_u24 v8, 3584, v8
    v_lshl_add_u32 v7, v2, 2, v8
    v_mov_b32 v6, 0x40000000
    v_cmp_lt_u32 vcc, 27, v2
    s_nop 1
    v_cndmask_b32 v7, v7, v6, vcc
    v_cmp_lt_u32 vcc, 63, v0
    s_nop 1
    v_cndmask_b32 v7, v7, v6, vcc
    s_mul_i32 s37, s24, 8192
    s_add_u32 s37, s37, 0x1b0000
    s_add_u32 s36, s37, s23
    buffer_store_dword v16, v7, s[8:11], s36 offen sc1
    v_lshlrev_b32 v7, 4, v0
    v_add_u32 v8, 4096, v7
    v_cmp_lt_u32 vcc, 191, v0
    s_nop 1
    v_cndmask_b32 v8, v8, v6, vcc
L_M_act:
    buffer_load_dwordx4 v[20:23], v7, s[8:11], s37 offen sc1
    buffer_load_dwordx4 v[24:27], v8, s[8:11], s37 offen sc1
    s_add_u32 s32, s32, 1
    s_cmp_gt_u32 s32, 200000
    s_waitcnt vmcnt(0)
    v_max3_u32 v5, v20, v21, v22
    v_max3_u32 v5, v5, v23, v24
    v_max3_u32 v5, v5, v25, v26
    v_max_u32 v5, v5, v27
    s_cbranch_scc1 L_M_act_ok
    v_cmp_eq_u32 vcc, -1, v5
    s_cbranch_vccnz L_M_act
L_M_act_ok:
    ds_write_b128 v7, v[20:23] offset:16384
    ds_write_b128 v7, v[24:27] offset:20480
    s_waitcnt lgkmcnt(0)
    s_barrier
    v_lshrrev_b32 v7, 3, v0
    v_mul_u32_u24 v7, 112, v7
    v_mov_b64 v[48:49], 0
    v_mov_b64 v[50:51], 0
    ds_read_b128 v[16:19], v7 offset:16384
    ds_read_b128 v[20:23], v7 offset:16400
    ds_read_b128 v[24:27], v7 offset:16416
    ds_read_b128 v[28:31], v7 offset:16432
    ds_read_b128 v[32:35], v7 offset:16448
    ds_read_b128 v[36:39], v7 offset:16464
    ds_read_b128 v[40:43], v7 offset:16480
    s_waitcnt lgkmcnt(0)
    v_dot2_f32_bf16 v48, v16, v64, v48
    v_dot2_f32_bf16 v49, v16, v92, v49
    v_dot2_f32_bf16 v48, v17, v65, v48
    v_dot2_f32_bf16 v49, v17, v93, v49
    v_dot2_f32_bf16 v48, v18, v66, v48
    v_dot2_f32_bf16 v49, v18, v94, v49
    v_dot2_f32_bf16 v48, v19, v67, v48
    v_dot2_f32_bf16 v49, v19, v95, v49
    v_dot2_f32_bf16 v48, v20, v68, v48
    v_dot2_f32_bf16 v49, v20, v96, v49
    v_dot2_f32_bf16 v48, v21, v69, v48
    v_dot2_f32_bf16 v49, v21, v97, v49
    v_dot2_f32_bf16 v48, v22, v70, v48
    v_dot2_f32_bf16 v49, v22, v98, v49
    v_dot2_f32_bf16 v48, v23, v71, v48
    v_dot2_f32_bf16 v49, v23, v99, v49
    v_dot2_f32_bf16 v48, v24, v72, v48
    v_dot2_f32_bf16 v49, v24, v100, v49
    v_dot2_f32_bf16 v48, v25, v73, v48
    v_dot2_f32_bf16 v49, v25, v101, v49
    v_dot2_f32_bf16 v48, v26, v74, v48
    v_dot2_f32_bf16 v49, v26, v102, v49
    v_dot2_f32_bf16 v48, v27, v75, v48
    v_dot2_f32_bf16 v49, v27, v103, v49
    v_dot2_f32_bf16 v48, v28, v76, v48
    v_dot2_f32_bf16 v49, v28, v104, v49
    v_dot2_f32_bf16 v48, v29, v77, v48
    v_dot2_f32_bf16 v49, v29, v105, v49
    v_dot2_f32_bf16 v48, v30, v78, v48
    v_dot2_f32_bf16 v49, v30, v106, v49
    v_dot2_f32_bf16 v48, v31, v79, v48
    v_dot2_f32_bf16 v49, v31, v107, v49
    v_dot2_f32_bf16 v48, v32, v80, v48
    v_dot2_f32_bf16 v49, v32, v108, v49
    v_dot2_f32_bf16 v48, v33, v81, v48
    v_dot2_f32_bf16 v49, v33, v109, v49
    v_dot2_f32_bf16 v48, v34, v82, v48
    v_dot2_f32_bf16 v49, v34, v110, v49
    v_dot2_f32_bf16 v48, v35, v83, v48
    v_dot2_f32_bf16 v49, v35, v111, v49
    v_dot2_f32_bf16 v48, v36, v84, v48
    v_dot2_f32_bf16 v49, v36, v112, v49
    v_dot2_f32_bf16 v48, v37, v85, v48
    v_dot2_f32_bf16 v49, v37, v113, v49
    v_dot2_f32_bf16 v48, v38, v86, v48
    v_dot2_f32_bf16 v49, v38, v114, v49
    v_dot2_f32_bf16 v48, v39, v87, v48
    v_dot2_f32_bf16 v49, v39, v115, v49
    v_dot2_f32_bf16 v48, v40, v88, v48
    v_dot2_f32_bf16 v49, v40, v116, v49
    v_dot2_f32_bf16 v48, v41, v89, v48
    v_dot2_f32_bf16 v49, v41, v117, v49
    v_dot2_f32_bf16 v48, v42, v90, v48
    v_dot2_f32_bf16 v49, v42, v118, v49
    v_dot2_f32_bf16 v48, v43, v91, v48
    v_dot2_f32_bf16 v49, v43, v119, v49
    ds_read_b128 v[16:19], v7 offset:19968
    ds_read_b128 v[20:23], v7 offset:19984
    ds_read_b128 v[24:27], v7 offset:20000
    ds_read_b128 v[28:31], v7 offset:20016
    ds_read_b128 v[32:35], v7 offset:20032
    ds_read_b128 v[36:39], v7 offset:20048
    ds_read_b128 v[40:43], v7 offset:20064
    s_waitcnt lgkmcnt(0)
    v_dot2_f32_bf16 v50, v16, v64, v50
    v_dot2_f32_bf16 v51, v16, v92, v51
    v_dot2_f32_bf16 v50, v17, v65, v50
    v_dot2_f32_bf16 v51, v17, v93, v51
    v_dot2_f32_bf16 v50, v18, v66, v50
    v_dot2_f32_bf16 v51, v18, v94, v51
    v_dot2_f32_bf16 v50, v19, v67, v50
    v_dot2_f32_bf16 v51, v19, v95, v51
    v_dot2_f32_bf16 v50, v20, v68, v50
    v_dot2_f32_bf16 v51, v20, v96, v51
    v_dot2_f32_bf16 v50, v21, v69, v50
    v_dot2_f32_bf16 v51, v21, v97, v51
    v_dot2_f32_bf16 v50, v22, v70, v50
    v_dot2_f32_bf16 v51, v22, v98, v51
    v_dot2_f32_bf16 v50, v23, v71, v50
    v_dot2_f32_bf16 v51, v23, v99, v51
    v_dot2_f32_bf16 v50, v24, v72, v50
    v_dot2_f32_bf16 v51, v24, v100, v51
    v_dot2_f32_bf16 v50, v25, v73, v50
    v_dot2_f32_bf16 v51, v25, v101, v51
    v_dot2_f32_bf16 v50, v26, v74, v50
    v_dot2_f32_bf16 v51, v26, v102, v51
    v_dot2_f32_bf16 v50, v27, v75, v50
    v_dot2_f32_bf16 v51, v27, v103, v51
    v_dot2_f32_bf16 v50, v28, v76, v50
    v_dot2_f32_bf16 v51, v28, v104, v51
    v_dot2_f32_bf16 v50, v29, v77, v50
    v_dot2_f32_bf16 v51, v29, v105, v51
    v_dot2_f32_bf16 v50, v30, v78, v50
    v_dot2_f32_bf16 v51, v30, v106, v51
    v_dot2_f32_bf16 v50, v31, v79, v50
    v_dot2_f32_bf16 v51, v31, v107, v51
    v_dot2_f32_bf16 v50, v32, v80, v50
    v_dot2_f32_bf16 v51, v32, v108, v51
    v_dot2_f32_bf16 v50, v33, v81, v50
    v_dot2_f32_bf16 v51, v33, v109, v51
    v_dot2_f32_bf16 v50, v34, v82, v50
    v_dot2_f32_bf16 v51, v34, v110, v51
    v_dot2_f32_bf16 v50, v35, v83, v50
    v_dot2_f32_bf16 v51, v35, v111, v51
    v_dot2_f32_bf16 v50, v36, v84, v50
    v_dot2_f32_bf16 v51, v36, v112, v51
    v_dot2_f32_bf16 v50, v37, v85, v50
    v_dot2_f32_bf16 v51, v37, v113, v51
    v_dot2_f32_bf16 v50, v38, v86, v50
    v_dot2_f32_bf16 v51, v38, v114, v51
    v_dot2_f32_bf16 v50, v39, v87, v50
    v_dot2_f32_bf16 v51, v39, v115, v51
    v_dot2_f32_bf16 v50, v40, v88, v50
    v_dot2_f32_bf16 v51, v40, v116, v51
    v_dot2_f32_bf16 v50, v41, v89, v50
    v_dot2_f32_bf16 v51, v41, v117, v51
    v_dot2_f32_bf16 v50, v42, v90, v50
    v_dot2_f32_bf16 v51, v42, v118, v51
    v_dot2_f32_bf16 v50, v43, v91, v50
    v_dot2_f32_bf16 v51, v43, v119, v51
    s_nop 3
    v_add_f32_dpp v48, v48, v48 row_ror:8 row_mask:0xf bank_mask:0xf
    v_add_f32_dpp v49, v49, v49 row_ror:8 row_mask:0xf bank_mask:0xf
    v_add_f32_dpp v50, v50, v50 row_ror:8 row_mask:0xf bank_mask:0xf
    v_add_f32_dpp v51, v51, v51 row_ror:8 row_mask:0xf bank_mask:0xf
    v_mov_b32 v5, v48
    s_nop 1
    v_permlane16_swap_b32 v48, v5
    v_add_f32 v48, v48, v5
    v_mov_b32 v5, v49
    s_nop 1
    v_permlane16_swap_b32 v49, v5
    v_add_f32 v49, v49, v5
    v_mov_b32 v5, v50
    s_nop 1
    v_permlane16_swap_b32 v50, v5
    v_add_f32 v50, v50, v5
    v_mov_b32 v5, v51
    s_nop 1
    v_permlane16_swap_b32 v51, v5
    v_add_f32 v51, v51, v5
    v_mov_b32 v5, v48
    s_nop 1
    v_permlane32_swap_b32 v48, v5
    v_add_f32 v48, v48, v5
    v_mov_b32 v5, v49
    s_nop 1
    v_permlane32_swap_b32 v49, v5
    v_add_f32 v49, v49, v5
    v_mov_b32 v5, v50
    s_nop 1
    v_permlane32_swap_b32 v50, v5
    v_add_f32 v50, v50, v5
    v_mov_b32 v5, v51
    s_nop 1
    v_permlane32_swap_b32 v51, v5
    v_add_f32 v51, v51, v5
    v_lshrrev_b32 v7, 6, v0
    v_lshlrev_b32 v7, 7, v7
    v_lshl_add_u32 v7, v3, 4, v7
    ds_write_b128 v7, v[48:51] offset:1024
    s_waitcnt lgkmcnt(0)
    s_barrier
    v_lshlrev_b32 v7, 4, v3
    v_lshl_add_u32 v7, v9, 3, v7
    ds_read_b64 v[16:17], v7 offset:1024
    ds_read_b64 v[18:19], v7 offset:1152
    ds_read_b64 v[20:21], v7 offset:1280
    ds_read_b64 v[22:23], v7 offset:1408
    v_mul_f32 v10, 0xbfb8aa3b, v11
    v_exp_f32 v10, v10
    s_nop 0
    v_add_f32 v10, 1.0, v10
    v_rcp_f32 v10, v10
    s_nop 0
    v_cvt_pk_bf16_f32 v5, v10, v10
    v_lshlrev_b32 v10, 16, v5
    s_waitcnt lgkmcnt(0)
    v_lshlrev_b32 v24, 16, v15
    v_and_b32 v25, 0xffff0000, v15
    v_lshlrev_b32 v26, 16, v14
    v_and_b32 v27, 0xffff0000, v14
    v_add_f32 v16, v16, v18
    v_add_f32 v20, v20, v22
    v_add_f32 v16, v16, v20
    v_cvt_pk_bf16_f32 v5, v16, v16
    v_lshlrev_b32 v16, 16, v5
    v_mul_f32 v16, v16, v10
    v_cvt_pk_bf16_f32 v5, v16, v16
    v_lshlrev_b32 v16, 16, v5
    v_add_f32 v16, v16, v24
    v_cvt_pk_bf16_f32 v5, v16, v16
    v_lshlrev_b32 v16, 16, v5
    v_add_f32 v16, v16, v26
    v_add_f32 v17, v17, v19
    v_add_f32 v21, v21, v23
    v_add_f32 v17, v17, v21
    v_cvt_pk_bf16_f32 v5, v17, v17
    v_lshlrev_b32 v17, 16, v5
    v_mul_f32 v17, v17, v10
    v_cvt_pk_bf16_f32 v5, v17, v17
    v_lshlrev_b32 v17, 16, v5
    v_add_f32 v17, v17, v25
    v_cvt_pk_bf16_f32 v5, v17, v17
    v_lshlrev_b32 v17, 16, v5
    v_add_f32 v17, v17, v27
    v_cvt_pk_bf16_f32 v16, v16, v17
    buffer_store_dword v16, v12, s[60:63], 0 offen sc1
    v_add_f32 v24, v24, v26
    v_add_f32 v25, v25, v27
    v_cvt_pk_bf16_f32 v13, v24, v25
L_M_next:
    s_add_u32 s24, s24, 1
    s_mov_b32 s25, 192
    s_cmp_eq_u32 s24, 1
    s_cbranch_scc1 L_M_round
    s_cmp_eq_u32 s24, 3
    s_cbranch_scc1 L_end
    s_mov_b32 s25, 256
    v_and_b32 v7, 63, v0
    v_lshlrev_b32 v3, 4, v7
    s_mov_b32 s36, 0x19bc00
    v_sub_u32 v7, 63, v7
L_M_fin:
    buffer_load_dwordx4 v[16:19], v3, s[8:11], s36 offen sc1
    s_add_u32 s32, s32, 1
    s_cmp_gt_u32 s32, 200000
    s_cselect_b32 s37, -1, -2
    s_waitcnt vmcnt(0)
    v_max3_u32 v5, v16, v17, v18
    v_max_u32 v5, v5, v19
    v_cmp_lt_u32 vcc, s37, v5
    s_cbranch_vccnz L_M_fin
    v_add_f32 v16, v16, v17
    v_add_f32 v18, v18, v19
    v_add_f32 v16, v16, v18
    v_cvt_pk_bf16_f32 v5, v16, v16
    v_lshlrev_b32 v16, 16, v5
    v_ashrrev_i32 v5, 31, v16
    v_or_b32 v5, 0x80000000, v5
    v_xor_b32 v5, v5, v16
    v_and_or_b32 v5, v5, s42, v7
    v_cmp_lt_u32 vcc, s29, v5
    s_cbranch_vccnz L_M_round
L_end:
    s_endpgm
.section .rodata,"a"
.p2align 6
.amdhsa_kernel sequential_preLN__memory_aug_recurrent_mem_tr__moe_arch_mod__prompt_kernel
  .amdhsa_next_free_vgpr 512
  .amdhsa_next_free_sgpr 102
  .amdhsa_accum_offset 256
  .amdhsa_group_segment_fixed_size 0
  .amdhsa_kernarg_size 120
  .amdhsa_user_sgpr_count 2
  .amdhsa_user_sgpr_kernarg_segment_ptr 1
  .amdhsa_system_sgpr_workgroup_id_x 1
.end_amdhsa_kernel
```

```asm
; @launch grid=(256,1,1) block=(256,1,1) lds=163840
.amdgcn_target "amdgcn-amd-amdhsa--gfx950"
.text
.globl sequential_preLN__memory_aug_recurrent_mem_tr__moe_arch_mod__prompt_kernel
.p2align 8
.type sequential_preLN__memory_aug_recurrent_mem_tr__moe_arch_mod__prompt_kernel,@function
sequential_preLN__memory_aug_recurrent_mem_tr__moe_arch_mod__prompt_kernel:
    s_cmp_ge_u32 s2, 256
    s_cbranch_scc1 L_end
    s_load_dwordx8 s[44:51], s[0:1], 0
    s_load_dwordx4 s[52:55], s[0:1], 32
    s_load_dwordx4 s[56:59], s[0:1], 104
    s_load_dwordx2 s[80:81], s[0:1], 64
    s_load_dwordx2 s[82:83], s[0:1], 96
    s_load_dwordx4 s[84:87], s[0:1], 72
    s_load_dwordx2 s[88:89], s[0:1], 88
    v_lshrrev_b32 v1, 6, v0
    s_nop 0
    v_readfirstlane_b32 s21, v1
    s_waitcnt lgkmcnt(0)
    s_mov_b32 s8, s58
    s_and_b32 s9, s59, 0xffff
    s_mov_b32 s10, 0x10000000
    s_mov_b32 s11, 0x20000
    s_mov_b32 s16, s56
    s_and_b32 s17, s57, 0xffff
    s_mov_b32 s18, 0x100
    s_mov_b32 s19, 0x20000
    s_and_b32 s3, s2, 7
    s_cmp_lg_u32 s3, 0
    s_cbranch_scc1 L_worker
    s_lshr_b32 s20, s2, 3
    v_lshrrev_b32 v28, 6, v0
    v_bfe_u32 v29, v0, 4, 2
    v_lshl_add_u32 v28, v28, 5, v29
    v_and_b32 v16, 15, v0
    v_lshlrev_b32 v16, 4, v16
    v_lshl_add_u32 v16, v28, 13, v16
    v_bfe_u32 v29, v0, 4, 1
    v_lshlrev_b32 v29, 5, v29
    v_xor_b32 v16, v16, v29
    v_xor_b32 v17, 64, v16
    v_xor_b32 v18, 128, v16
    v_xor_b32 v19, 192, v16
    s_add_u32 s28, s21, 1
    s_lshl_b32 s28, s28, 15
    s_lshl_b32 s3, s20, 8
    s_mov_b32 s60, s52
    s_and_b32 s61, s53, 0xffff
    s_mov_b32 s62, 0x400000
    s_mov_b32 s63, 0x20000
    s_add_u32 m0, s28, 0
    s_add_u32 s37, s3, 0x0
    buffer_load_dwordx4 v16, s[60:63], s37 offen lds
    s_add_u32 m0, s28, 1024
    s_add_u32 s37, s3, 0x8000
    buffer_load_dwordx4 v17, s[60:63], s37 offen lds
    s_add_u32 m0, s28, 2048
    s_add_u32 s37, s3, 0x10000
    buffer_load_dwordx4 v18, s[60:63], s37 offen lds
    s_add_u32 m0, s28, 3072
    s_add_u32 s37, s3, 0x18000
    buffer_load_dwordx4 v19, s[60:63], s37 offen lds
    s_add_u32 m0, s28, 4096
    s_add_u32 s37, s3, 0x20000
    buffer_load_dwordx4 v16, s[60:63], s37 offen lds
    s_add_u32 m0, s28, 5120
    s_add_u32 s37, s3, 0x28000
    buffer_load_dwordx4 v17, s[60:63], s37 offen lds
    s_add_u32 m0, s28, 6144
    s_add_u32 s37, s3, 0x30000
    buffer_load_dwordx4 v18, s[60:63], s37 offen lds
    s_add_u32 m0, s28, 7168
    s_add_u32 s37, s3, 0x38000
    buffer_load_dwordx4 v19, s[60:63], s37 offen lds
    s_add_u32 m0, s28, 8192
    s_add_u32 s37, s3, 0x100000
    buffer_load_dwordx4 v16, s[60:63], s37 offen lds
    s_add_u32 m0, s28, 9216
    s_add_u32 s37, s3, 0x108000
    buffer_load_dwordx4 v17, s[60:63], s37 offen lds
    s_add_u32 m0, s28, 10240
    s_add_u32 s37, s3, 0x110000
    buffer_load_dwordx4 v18, s[60:63], s37 offen lds
    s_add_u32 m0, s28, 11264
    s_add_u32 s37, s3, 0x118000
    buffer_load_dwordx4 v19, s[60:63], s37 offen lds
    s_add_u32 m0, s28, 12288
    s_add_u32 s37, s3, 0x120000
    buffer_load_dwordx4 v16, s[60:63], s37 offen lds
    s_add_u32 m0, s28, 13312
    s_add_u32 s37, s3, 0x128000
    buffer_load_dwordx4 v17, s[60:63], s37 offen lds
    s_add_u32 m0, s28, 14336
    s_add_u32 s37, s3, 0x130000
    buffer_load_dwordx4 v18, s[60:63], s37 offen lds
    s_add_u32 m0, s28, 15360
    s_add_u32 s37, s3, 0x138000
    buffer_load_dwordx4 v19, s[60:63], s37 offen lds
    s_add_u32 m0, s28, 16384
    s_add_u32 s37, s3, 0x200000
    buffer_load_dwordx4 v16, s[60:63], s37 offen lds
    s_add_u32 m0, s28, 17408
    s_add_u32 s37, s3, 0x208000
    buffer_load_dwordx4 v17, s[60:63], s37 offen lds
    s_add_u32 m0, s28, 18432
    s_add_u32 s37, s3, 0x210000
    buffer_load_dwordx4 v18, s[60:63], s37 offen lds
    s_add_u32 m0, s28, 19456
    s_add_u32 s37, s3, 0x218000
    buffer_load_dwordx4 v19, s[60:63], s37 offen lds
    s_add_u32 m0, s28, 20480
    s_add_u32 s37, s3, 0x220000
    buffer_load_dwordx4 v16, s[60:63], s37 offen lds
    s_add_u32 m0, s28, 21504
    s_add_u32 s37, s3, 0x228000
    buffer_load_dwordx4 v17, s[60:63], s37 offen lds
    s_add_u32 m0, s28, 22528
    s_add_u32 s37, s3, 0x230000
    buffer_load_dwordx4 v18, s[60:63], s37 offen lds
    s_add_u32 m0, s28, 23552
    s_add_u32 s37, s3, 0x238000
    buffer_load_dwordx4 v19, s[60:63], s37 offen lds
    v_mov_b32 v20, 0x0
    v_bfe_u32 v14, v0, 0, 1
    s_mov_b32 s38, 0x8
    v_mad_u32_u24 v20, v14, s38, v20
    v_bfe_u32 v14, v0, 1, 1
    s_mov_b32 s38, 0x10
    v_mad_u32_u24 v20, v14, s38, v20
    v_bfe_u32 v14, v0, 2, 1
    s_mov_b32 s38, 0x100
    v_mad_u32_u24 v20, v14, s38, v20
    v_bfe_u32 v14, v0, 3, 1
    s_mov_b32 s38, 0x800
    v_mad_u32_u24 v20, v14, s38, v20
    v_bfe_u32 v14, v0, 4, 1
    s_mov_b32 s38, 0x400
    v_mad_u32_u24 v20, v14, s38, v20
    v_bfe_u32 v14, v0, 5, 1
    s_mov_b32 s38, 0x1000
    v_mad_u32_u24 v20, v14, s38, v20
    v_mov_b32 v28, 0x0
    v_bfe_u32 v14, v0, 2, 1
    s_mov_b32 s38, 0x20
    v_mad_u32_u24 v28, v14, s38, v28
    v_bfe_u32 v14, v0, 3, 1
    s_mov_b32 s38, 0x80
    v_mad_u32_u24 v28, v14, s38, v28
    v_bfe_u32 v14, v0, 4, 1
    s_mov_b32 s38, 0x40
    v_mad_u32_u24 v28, v14, s38, v28
    v_mov_b32 v29, 0x0
    v_bfe_u32 v14, v0, 6, 1
    s_mov_b32 s38, 0x40
    v_mad_u32_u24 v29, v14, s38, v29
    v_bfe_u32 v14, v0, 7, 1
    s_mov_b32 s38, 0x80
    v_mad_u32_u24 v29, v14, s38, v29
    v_xor_b32 v28, v28, v29
    v_add_u32 v28, v28, v20
    s_xor_b32 s36, s21, 0
    s_add_u32 s36, s36, 1
    s_lshl_b32 s36, s36, 15
    v_add_u32 v20, s36, v28
    v_xor_b32 v21, 32, v20
    s_xor_b32 s36, s21, 1
    s_add_u32 s36, s36, 1
    s_lshl_b32 s36, s36, 15
    v_add_u32 v22, s36, v28
    v_xor_b32 v23, 32, v22
    s_xor_b32 s36, s21, 2
    s_add_u32 s36, s36, 1
    s_lshl_b32 s36, s36, 15
    v_add_u32 v24, s36, v28
    v_xor_b32 v25, 32, v24
    s_xor_b32 s36, s21, 3
    s_add_u32 s36, s36, 1
    s_lshl_b32 s36, s36, 15
    v_add_u32 v26, s36, v28
    v_xor_b32 v27, 32, v26
    v_mov_b32 v11, 0x0
    v_bfe_u32 v14, v0, 0, 1
    s_mov_b32 s38, 0x4
    v_mad_u32_u24 v11, v14, s38, v11
    v_bfe_u32 v14, v0, 1, 1
    s_mov_b32 s38, 0x8
    v_mad_u32_u24 v11, v14, s38, v11
    v_bfe_u32 v14, v0, 2, 1
    s_mov_b32 s38, 0x10
    v_mad_u32_u24 v11, v14, s38, v11
    v_bfe_u32 v14, v0, 3, 1
    s_mov_b32 s38, 0x20
    v_mad_u32_u24 v11, v14, s38, v11
    v_bfe_u32 v14, v0, 4, 1
    s_mov_b32 s38, 0x800
    v_mad_u32_u24 v11, v14, s38, v11
    v_bfe_u32 v14, v0, 5, 1
    s_mov_b32 s38, 0x1000
    v_mad_u32_u24 v11, v14, s38, v11
    v_bfe_u32 v14, v0, 6, 1
    s_mov_b32 s38, 0x100
    v_mad_u32_u24 v11, v14, s38, v11
    v_bfe_u32 v14, v0, 7, 1
    s_mov_b32 s38, 0x200
    v_mad_u32_u24 v11, v14, s38, v11
    s_mov_b32 s92, s54
    s_and_b32 s93, s55, 0xffff
    s_mov_b32 s94, 0x400000
    s_mov_b32 s95, 0x20000
    s_lshl_b32 s29, s20, 17
    s_xor_b32 s36, s21, 3
    s_lshl_b32 s36, s36, 15
    s_add_u32 s36, s36, s29
    s_add_u32 s37, s36, 0x80
    buffer_load_dword v32, v11, s[92:95], s37 offen
    s_add_u32 s37, s36, 0x4080
    buffer_load_dword v33, v11, s[92:95], s37 offen
    s_add_u32 s37, s36, 0x480
    buffer_load_dword v34, v11, s[92:95], s37 offen
    s_add_u32 s37, s36, 0x4480
    buffer_load_dword v35, v11, s[92:95], s37 offen
    s_add_u32 s37, s36, 0x2080
    buffer_load_dword v36, v11, s[92:95], s37 offen
    s_add_u32 s37, s36, 0x6080
    buffer_load_dword v37, v11, s[92:95], s37 offen
    s_add_u32 s37, s36, 0x2480
    buffer_load_dword v38, v11, s[92:95], s37 offen
    s_add_u32 s37, s36, 0x6480
    buffer_load_dword v39, v11, s[92:95], s37 offen
    s_add_u32 s37, s36, 0xc0
    buffer_load_dword v40, v11, s[92:95], s37 offen
    s_add_u32 s37, s36, 0x40c0
    buffer_load_dword v41, v11, s[92:95], s37 offen
    s_add_u32 s37, s36, 0x4c0
    buffer_load_dword v42, v11, s[92:95], s37 offen
    s_add_u32 s37, s36, 0x44c0
    buffer_load_dword v43, v11, s[92:95], s37 offen
    s_add_u32 s37, s36, 0x20c0
    buffer_load_dword v44, v11, s[92:95], s37 offen
    s_add_u32 s37, s36, 0x60c0
    buffer_load_dword v45, v11, s[92:95], s37 offen
    s_add_u32 s37, s36, 0x24c0
    buffer_load_dword v46, v11, s[92:95], s37 offen
    s_add_u32 s37, s36, 0x64c0
    buffer_load_dword v47, v11, s[92:95], s37 offen
    s_getreg_b32 s36, hwreg(HW_REG_XCC_ID)
    s_and_b32 s36, s36, 15
    s_or_b32 s36, s36, 0x100
    v_mov_b32 v30, s36
    s_lshl_b32 s37, s20, 2
    v_lshlrev_b32 v31, 20, v0
    buffer_store_dword v30, v31, s[16:19], s37 offen offset:128 sc1
    s_mov_b32 s12, s46
    s_and_b32 s13, s47, 0xffff
    s_mov_b32 s14, 0x2000
    s_mov_b32 s15, 0x20000
    v_mov_b32 v104, 0x0
    v_bfe_u32 v14, v0, 0, 1
    s_mov_b32 s38, 0x8
    v_mad_u32_u24 v104, v14, s38, v104
    v_bfe_u32 v14, v0, 1, 1
    s_mov_b32 s38, 0x10
    v_mad_u32_u24 v104, v14, s38, v104
    v_bfe_u32 v14, v0, 2, 1
    s_mov_b32 s38, 0x10000
    v_mad_u32_u24 v104, v14, s38, v104
    v_bfe_u32 v14, v0, 3, 1
    s_mov_b32 s38, 0x10000
    v_mad_u32_u24 v104, v14, s38, v104
    v_bfe_u32 v14, v0, 4, 1
    s_mov_b32 s38, 0x400
    v_mad_u32_u24 v104, v14, s38, v104
    v_bfe_u32 v14, v0, 5, 1
    s_mov_b32 s38, 0x4
    v_mad_u32_u24 v104, v14, s38, v104
    v_bfe_u32 v14, v0, 6, 1
    s_mov_b32 s38, 0x40
    v_mad_u32_u24 v104, v14, s38, v104
    v_bfe_u32 v14, v0, 7, 1
    s_mov_b32 s38, 0x80
    v_mad_u32_u24 v104, v14, s38, v104
    v_mov_b32 v106, s20
    v_mov_b32 v105, 0x0
    v_bfe_u32 v14, v106, 0, 1
    s_mov_b32 s38, 0x20
    v_mad_u32_u24 v105, v14, s38, v105
    v_bfe_u32 v14, v106, 1, 1
    s_mov_b32 s38, 0x800
    v_mad_u32_u24 v105, v14, s38, v105
    v_bfe_u32 v14, v106, 2, 1
    s_mov_b32 s38, 0x1000
    v_mad_u32_u24 v105, v14, s38, v105
    v_bfe_u32 v14, v106, 3, 1
    s_mov_b32 s38, 0x100
    v_mad_u32_u24 v105, v14, s38, v105
    v_bfe_u32 v14, v106, 4, 1
    s_mov_b32 s38, 0x200
    v_mad_u32_u24 v105, v14, s38, v105
    v_add_u32 v104, v104, v105
    buffer_load_dword v12, v104, s[12:15], 0 offen
    v_mov_b32 v1, 0x4444
    v_bfe_u32 v14, v0, 1, 1
    s_mov_b32 s38, 0xaaaa
    v_mad_u32_u24 v1, v14, s38, v1
    v_mov_b32 v3, 0x0
    v_bfe_u32 v14, v0, 0, 1
    s_mov_b32 s38, 0x10
    v_mad_u32_u24 v3, v14, s38, v3
    v_bfe_u32 v14, v0, 1, 1
    s_mov_b32 s38, 0x20
    v_mad_u32_u24 v3, v14, s38, v3
    v_bfe_u32 v14, v0, 2, 1
    s_mov_b32 s38, 0x40
    v_mad_u32_u24 v3, v14, s38, v3
    v_bfe_u32 v14, v0, 3, 1
    s_mov_b32 s38, 0x80
    v_mad_u32_u24 v3, v14, s38, v3
    v_bfe_u32 v14, v0, 4, 1
    s_mov_b32 s38, 0x100
    v_mad_u32_u24 v3, v14, s38, v3
    v_bfe_u32 v14, v0, 5, 1
    s_mov_b32 s38, 0x200
    v_mad_u32_u24 v3, v14, s38, v3
    v_mov_b32 v2, 0x0
    v_bfe_u32 v14, v0, 0, 1
    s_mov_b32 s38, 0x10
    v_mad_u32_u24 v2, v14, s38, v2
    v_bfe_u32 v14, v0, 1, 1
    s_mov_b32 s38, 0x20
    v_mad_u32_u24 v2, v14, s38, v2
    v_bfe_u32 v14, v0, 2, 1
    s_mov_b32 s38, 0x40
    v_mad_u32_u24 v2, v14, s38, v2
    v_bfe_u32 v14, v0, 3, 1
    s_mov_b32 s38, 0x80
    v_mad_u32_u24 v2, v14, s38, v2
    v_bfe_u32 v14, v0, 4, 1
    s_mov_b32 s38, 0x100
    v_mad_u32_u24 v2, v14, s38, v2
    v_bfe_u32 v14, v0, 5, 1
    s_mov_b32 s38, 0x200
    v_mad_u32_u24 v2, v14, s38, v2
    v_bfe_u32 v14, v0, 6, 1
    s_mov_b32 s38, 0x800
    v_mad_u32_u24 v2, v14, s38, v2
    v_bfe_u32 v14, v0, 7, 1
    s_mov_b32 s38, 0x1000
    v_mad_u32_u24 v2, v14, s38, v2
    v_mov_b32 v4, 0x8000
    v_bfe_u32 v14, v0, 0, 1
    s_mov_b32 s38, 0x10
    v_mad_u32_u24 v4, v14, s38, v4
    v_bfe_u32 v14, v0, 1, 1
    s_mov_b32 s38, 0x20
    v_mad_u32_u24 v4, v14, s38, v4
    v_bfe_u32 v14, v0, 2, 1
    s_mov_b32 s38, 0x40
    v_mad_u32_u24 v4, v14, s38, v4
    v_bfe_u32 v14, v0, 3, 1
    s_mov_b32 s38, 0x80
    v_mad_u32_u24 v4, v14, s38, v4
    v_bfe_u32 v14, v0, 4, 1
    s_mov_b32 s38, 0x100
    v_mad_u32_u24 v4, v14, s38, v4
    v_bfe_u32 v14, v0, 5, 1
    s_mov_b32 s38, 0x200
    v_mad_u32_u24 v4, v14, s38, v4
    v_bfe_u32 v14, v0, 6, 1
    s_mov_b32 s38, 0x8000
    v_mad_u32_u24 v4, v14, s38, v4
    v_bfe_u32 v14, v0, 7, 1
    s_mov_b32 s38, 0x10000
    v_mad_u32_u24 v4, v14, s38, v4
    v_mov_b32 v5, 0x4000
    v_bfe_u32 v14, v0, 0, 1
    s_mov_b32 s38, 0x4
    v_mad_u32_u24 v5, v14, s38, v5
    v_bfe_u32 v14, v0, 1, 1
    s_mov_b32 s38, 0x8
    v_mad_u32_u24 v5, v14, s38, v5
    v_bfe_u32 v14, v0, 2, 1
    s_mov_b32 s38, 0x10
    v_mad_u32_u24 v5, v14, s38, v5
    v_bfe_u32 v14, v0, 3, 1
    s_mov_b32 s38, 0x20
    v_mad_u32_u24 v5, v14, s38, v5
    v_bfe_u32 v14, v0, 4, 1
    s_mov_b32 s38, 0x240
    v_mad_u32_u24 v5, v14, s38, v5
    v_bfe_u32 v14, v0, 5, 1
    s_mov_b32 s38, 0x480
    v_mad_u32_u24 v5, v14, s38, v5
    v_bfe_u32 v14, v0, 6, 1
    s_mov_b32 s38, 0x40
    v_mad_u32_u24 v5, v14, s38, v5
    v_bfe_u32 v14, v0, 7, 1
    s_mov_b32 s38, 0x80
    v_mad_u32_u24 v5, v14, s38, v5
    v_mov_b32 v6, 0x4000
    v_bfe_u32 v14, v0, 0, 1
    s_mov_b32 s38, 0x120
    v_mad_u32_u24 v6, v14, s38, v6
    v_bfe_u32 v14, v0, 2, 1
    s_mov_b32 s38, 0x240
    v_mad_u32_u24 v6, v14, s38, v6
    v_bfe_u32 v14, v0, 3, 1
    s_mov_b32 s38, 0x480
    v_mad_u32_u24 v6, v14, s38, v6
    v_bfe_u32 v14, v0, 4, 1
    s_mov_b32 s38, 0x10
    v_mad_u32_u24 v6, v14, s38, v6
    v_bfe_u32 v14, v0, 5, 1
    s_mov_b32 s38, 0x20
    v_mad_u32_u24 v6, v14, s38, v6
    v_add_u32 v7, 2304, v5
    v_xor_b32 v8, 0x1000, v2
    v_mov_b32 v104, 0x0
    v_bfe_u32 v14, v0, 3, 1
    s_mov_b32 s38, 0x1
    v_mad_u32_u24 v104, v14, s38, v104
    v_bfe_u32 v14, v0, 4, 1
    s_mov_b32 s38, 0x2
    v_mad_u32_u24 v104, v14, s38, v104
    v_bfe_u32 v14, v0, 5, 1
    s_mov_b32 s38, 0x4
    v_mad_u32_u24 v104, v14, s38, v104
    v_bfe_u32 v14, v0, 6, 1
    s_mov_b32 s38, 0x8
    v_mad_u32_u24 v104, v14, s38, v104
    v_bfe_u32 v14, v0, 7, 1
    s_mov_b32 s38, 0x10
    v_mad_u32_u24 v104, v14, s38, v104
    v_add_u32 v104, s20, v104
    v_and_b32 v104, 31, v104
    v_lshlrev_b32 v104, 6, v104
    v_mov_b32 v9, 0x0
    v_bfe_u32 v14, v0, 0, 1
    s_mov_b32 s38, 0x8
    v_mad_u32_u24 v9, v14, s38, v9
    v_bfe_u32 v14, v0, 1, 1
    s_mov_b32 s38, 0x10
    v_mad_u32_u24 v9, v14, s38, v9
    v_bfe_u32 v14, v0, 2, 1
    s_mov_b32 s38, 0x20
    v_mad_u32_u24 v9, v14, s38, v9
    v_bfe_u32 v14, v0, 3, 1
    s_mov_b32 s38, 0x2000
    v_mad_u32_u24 v9, v14, s38, v9
    v_bfe_u32 v14, v0, 4, 1
    s_mov_b32 s38, 0x4000
    v_mad_u32_u24 v9, v14, s38, v9
    v_bfe_u32 v14, v0, 5, 1
    s_mov_b32 s38, 0x8000
    v_mad_u32_u24 v9, v14, s38, v9
    v_bfe_u32 v14, v0, 6, 1
    s_mov_b32 s38, 0x10000
    v_mad_u32_u24 v9, v14, s38, v9
    v_bfe_u32 v14, v0, 7, 1
    s_mov_b32 s38, 0x20000
    v_mad_u32_u24 v9, v14, s38, v9
    v_add_u32 v9, v9, v104
    v_mov_b32 v10, 0x80000
    v_bfe_u32 v14, v0, 0, 1
    s_mov_b32 s38, 0x8
    v_mad_u32_u24 v10, v14, s38, v10
    v_bfe_u32 v14, v0, 1, 1
    s_mov_b32 s38, 0x20
    v_mad_u32_u24 v10, v14, s38, v10
    v_bfe_u32 v14, v0, 4, 1
    s_mov_b32 s38, 0x10
    v_mad_u32_u24 v10, v14, s38, v10
    v_bfe_u32 v14, v0, 5, 1
    s_mov_b32 s38, 0x4
    v_mad_u32_u24 v10, v14, s38, v10
    v_bfe_u32 v14, v0, 6, 1
    s_mov_b32 s38, 0x800
    v_mad_u32_u24 v10, v14, s38, v10
    v_bfe_u32 v14, v0, 7, 1
    s_mov_b32 s38, 0x1000
    v_mad_u32_u24 v10, v14, s38, v10
    v_mov_b32 v105, s20
    v_mov_b32 v104, 0x0
    v_bfe_u32 v14, v105, 0, 1
    s_mov_b32 s38, 0x100
    v_mad_u32_u24 v104, v14, s38, v104
    v_bfe_u32 v14, v105, 1, 1
    s_mov_b32 s38, 0x40
    v_mad_u32_u24 v104, v14, s38, v104
    v_bfe_u32 v14, v105, 2, 1
    s_mov_b32 s38, 0x80
    v_mad_u32_u24 v104, v14, s38, v104
    v_bfe_u32 v14, v105, 3, 1
    s_mov_b32 s38, 0x200
    v_mad_u32_u24 v104, v14, s38, v104
    v_bfe_u32 v14, v105, 4, 1
    s_mov_b32 s38, 0x400
    v_mad_u32_u24 v104, v14, s38, v104
    v_add_u32 v10, v104, v10
    v_and_b32 v104, 12, v0
    v_cmp_ne_u32 vcc, 0, v104
    v_mov_b32 v104, 0x40000000
    s_nop 0
    v_cndmask_b32 v10, v10, v104, vcc
    v_mov_b32 v13, 0x0
    v_bfe_u32 v14, v0, 0, 1
    s_mov_b32 s38, 0x10
    v_mad_u32_u24 v13, v14, s38, v13
    v_bfe_u32 v14, v0, 1, 1
    s_mov_b32 s38, 0x8
    v_mad_u32_u24 v13, v14, s38, v13
    v_bfe_u32 v14, v0, 2, 1
    s_mov_b32 s38, 0x20
    v_mad_u32_u24 v13, v14, s38, v13
    v_bfe_u32 v14, v0, 3, 1
    s_mov_b32 s38, 0x40
    v_mad_u32_u24 v13, v14, s38, v13
    v_bfe_u32 v14, v0, 4, 1
    s_mov_b32 s38, 0x80
    v_mad_u32_u24 v13, v14, s38, v13
    v_bfe_u32 v14, v0, 5, 1
    s_mov_b32 s38, 0x100
    v_mad_u32_u24 v13, v14, s38, v13
    v_bfe_u32 v14, v0, 6, 1
    s_mov_b32 s38, 0x800
    v_mad_u32_u24 v13, v14, s38, v13
    v_bfe_u32 v14, v0, 7, 1
    s_mov_b32 s38, 0x1000
    v_mad_u32_u24 v13, v14, s38, v13
    s_lshl_b32 s6, s20, 13
    s_add_u32 s6, s6, 0x0
    s_mov_b32 s26, 4096
    v_and_b32 v104, 15, v0
    v_mov_b32 v100, 0
    v_mov_b32 v105, 0x3f80
    v_cmp_eq_u32 vcc, 0, v104
    s_nop 1
    v_cndmask_b32 v100, v100, v105, vcc
    v_mov_b32 v105, 0x3f800000
    v_cmp_eq_u32 vcc, 1, v104
    s_nop 1
    v_cndmask_b32 v100, v100, v105, vcc
    v_mov_b32 v101, 0
    v_mov_b32 v105, 0x3f80
    v_cmp_eq_u32 vcc, 4, v104
    s_nop 1
    v_cndmask_b32 v101, v101, v105, vcc
    v_mov_b32 v105, 0x3f800000
    v_cmp_eq_u32 vcc, 5, v104
    s_nop 1
    v_cndmask_b32 v101, v101, v105, vcc
    v_mov_b32 v102, 0
    v_mov_b32 v105, 0x3f80
    v_cmp_eq_u32 vcc, 8, v104
    s_nop 1
    v_cndmask_b32 v102, v102, v105, vcc
    v_mov_b32 v105, 0x3f800000
    v_cmp_eq_u32 vcc, 9, v104
    s_nop 1
    v_cndmask_b32 v102, v102, v105, vcc
    v_mov_b32 v103, 0
    v_mov_b32 v105, 0x3f80
    v_cmp_eq_u32 vcc, 12, v104
    s_nop 1
    v_cndmask_b32 v103, v103, v105, vcc
    v_mov_b32 v105, 0x3f800000
    v_cmp_eq_u32 vcc, 13, v104
    s_nop 1
    v_cndmask_b32 v103, v103, v105, vcc
    ds_write_b128 v3, v[100:103] offset:23040
    s_mov_b32 s34, 0x05040100
    s_mov_b32 s35, 0x07060302
    s_mov_b32 s33, 0x3e0293ee
    s_mov_b32 s40, 0x4e800000
    s_mov_b32 s32, 0
    s_mov_b32 s4, 0x3f803f80
    s_mov_b32 s5, 0x3f803f80
    s_lshl_b32 s36, s20, 14
    s_lshr_b32 s37, s21, 1
    s_lshl_b32 s37, s37, 12
    s_add_u32 s25, s36, s37
    s_lshl_b32 s37, s21, 11
    s_add_u32 s39, s36, s37
    s_add_u32 s39, s39, 8192
    v_mov_b32 v104, 0x0
    v_bfe_u32 v14, v0, 0, 1
    s_mov_b32 s38, 0x80
    v_mad_u32_u24 v104, v14, s38, v104
    v_bfe_u32 v14, v0, 1, 1
    s_mov_b32 s38, 0x100
    v_mad_u32_u24 v104, v14, s38, v104
    v_bfe_u32 v14, v0, 2, 1
    s_mov_b32 s38, 0x200
    v_mad_u32_u24 v104, v14, s38, v104
    v_bfe_u32 v14, v0, 3, 1
    s_mov_b32 s38, 0x400
    v_mad_u32_u24 v104, v14, s38, v104
    v_bfe_u32 v14, v0, 4, 1
    s_mov_b32 s38, 0x800
    v_mad_u32_u24 v104, v14, s38, v104
    v_bfe_u32 v14, v0, 6, 1
    s_mov_b32 s38, 0x1000
    v_mad_u32_u24 v104, v14, s38, v104
    v_bfe_u32 v14, v0, 7, 1
    s_mov_b32 s38, 0x2000
    v_mad_u32_u24 v104, v14, s38, v104
    s_lshl_b32 s36, s20, 14
    v_add_u32 v104, s36, v104
    s_lshl_b32 s36, s20, 8
    s_lshr_b32 s37, s21, 1
    s_lshl_b32 s37, s37, 7
    s_add_u32 s36, s36, s37
    s_add_u32 s36, s36, 0x102100
    v_and_b32 v14, 63, v0
    v_mov_b32 v105, 0x40000000
    v_cmp_lt_u32 vcc, 32, v14
    s_nop 1
    v_cndmask_b32 v104, v104, v105, vcc
    v_mov_b32 v105, s36
    v_cmp_eq_u32 vcc, 32, v14
    s_nop 1
    v_cndmask_b32 v104, v104, v105, vcc
    s_lshl_b32 s36, s20, 2
    s_add_u32 s36, s36, 0x104100
    v_mov_b32 v105, s36
    v_cmp_eq_u32 vcc, 33, v14
    s_nop 1
    v_cndmask_b32 v0, v104, v105, vcc
    s_waitcnt vmcnt(34)
    s_barrier
    ds_read_b64_tr_b16 a[160:161], v20 offset:0
    ds_read_b64_tr_b16 a[162:163], v20 offset:512
    ds_read_b64_tr_b16 a[168:169], v21 offset:0
    ds_read_b64_tr_b16 a[170:171], v21 offset:512
    ds_read_b64_tr_b16 a[192:193], v22 offset:0
    ds_read_b64_tr_b16 a[194:195], v22 offset:512
    ds_read_b64_tr_b16 a[200:201], v23 offset:0
    ds_read_b64_tr_b16 a[202:203], v23 offset:512
    ds_read_b64_tr_b16 a[224:225], v24 offset:0
    ds_read_b64_tr_b16 a[226:227], v24 offset:512
    ds_read_b64_tr_b16 a[232:233], v25 offset:0
    ds_read_b64_tr_b16 a[234:235], v25 offset:512
    s_waitcnt lgkmcnt(4)
    ds_read_b64_tr_b16 v[128:129], v26 offset:0
    ds_read_b64_tr_b16 v[130:131], v26 offset:512
    ds_read_b64_tr_b16 v[136:137], v27 offset:0
    ds_read_b64_tr_b16 v[138:139], v27 offset:512
    s_waitcnt lgkmcnt(0)
    s_barrier
    s_add_u32 m0, s28, 0
    s_add_u32 s37, s3, 0x300000
    buffer_load_dwordx4 v16, s[60:63], s37 offen lds
    s_add_u32 m0, s28, 1024
    s_add_u32 s37, s3, 0x308000
    buffer_load_dwordx4 v17, s[60:63], s37 offen lds
    s_add_u32 m0, s28, 2048
    s_add_u32 s37, s3, 0x310000
    buffer_load_dwordx4 v18, s[60:63], s37 offen lds
    s_add_u32 m0, s28, 3072
    s_add_u32 s37, s3, 0x318000
    buffer_load_dwordx4 v19, s[60:63], s37 offen lds
    s_add_u32 m0, s28, 4096
    s_add_u32 s37, s3, 0x320000
    buffer_load_dwordx4 v16, s[60:63], s37 offen lds
    s_add_u32 m0, s28, 5120
    s_add_u32 s37, s3, 0x328000
    buffer_load_dwordx4 v17, s[60:63], s37 offen lds
    s_add_u32 m0, s28, 6144
    s_add_u32 s37, s3, 0x330000
    buffer_load_dwordx4 v18, s[60:63], s37 offen lds
    s_add_u32 m0, s28, 7168
    s_add_u32 s37, s3, 0x338000
    buffer_load_dwordx4 v19, s[60:63], s37 offen lds
    s_xor_b32 s36, s21, 2
    s_lshl_b32 s36, s36, 15
    s_add_u32 s36, s36, s29
    s_add_u32 s37, s36, 0x80
    buffer_load_dword v48, v11, s[92:95], s37 offen
    s_add_u32 s37, s36, 0x4080
    buffer_load_dword v49, v11, s[92:95], s37 offen
    s_add_u32 s37, s36, 0x480
    buffer_load_dword v50, v11, s[92:95], s37 offen
    s_add_u32 s37, s36, 0x4480
    buffer_load_dword v51, v11, s[92:95], s37 offen
    s_add_u32 s37, s36, 0x2080
    buffer_load_dword v52, v11, s[92:95], s37 offen
    s_add_u32 s37, s36, 0x6080
    buffer_load_dword v53, v11, s[92:95], s37 offen
    s_add_u32 s37, s36, 0x2480
    buffer_load_dword v54, v11, s[92:95], s37 offen
    s_add_u32 s37, s36, 0x6480
    buffer_load_dword v55, v11, s[92:95], s37 offen
    s_add_u32 s37, s36, 0xc0
    buffer_load_dword v56, v11, s[92:95], s37 offen
    s_add_u32 s37, s36, 0x40c0
    buffer_load_dword v57, v11, s[92:95], s37 offen
    s_add_u32 s37, s36, 0x4c0
    buffer_load_dword v58, v11, s[92:95], s37 offen
    s_add_u32 s37, s36, 0x44c0
    buffer_load_dword v59, v11, s[92:95], s37 offen
    s_add_u32 s37, s36, 0x20c0
    buffer_load_dword v60, v11, s[92:95], s37 offen
    s_add_u32 s37, s36, 0x60c0
    buffer_load_dword v61, v11, s[92:95], s37 offen
    s_add_u32 s37, s36, 0x24c0
    buffer_load_dword v62, v11, s[92:95], s37 offen
    s_add_u32 s37, s36, 0x64c0
    buffer_load_dword v63, v11, s[92:95], s37 offen
    s_waitcnt vmcnt(50)
    s_barrier
    ds_read_b64_tr_b16 a[164:165], v20 offset:8192
    ds_read_b64_tr_b16 a[166:167], v20 offset:8704
    ds_read_b64_tr_b16 a[172:173], v21 offset:8192
    ds_read_b64_tr_b16 a[174:175], v21 offset:8704
    ds_read_b64_tr_b16 a[196:197], v22 offset:8192
    ds_read_b64_tr_b16 a[198:199], v22 offset:8704
    ds_read_b64_tr_b16 a[204:205], v23 offset:8192
    ds_read_b64_tr_b16 a[206:207], v23 offset:8704
    ds_read_b64_tr_b16 a[228:229], v24 offset:8192
    ds_read_b64_tr_b16 a[230:231], v24 offset:8704
    ds_read_b64_tr_b16 a[236:237], v25 offset:8192
    ds_read_b64_tr_b16 a[238:239], v25 offset:8704
    s_waitcnt lgkmcnt(4)
    ds_read_b64_tr_b16 v[132:133], v26 offset:8192
    ds_read_b64_tr_b16 v[134:135], v26 offset:8704
    ds_read_b64_tr_b16 v[140:141], v27 offset:8192
    ds_read_b64_tr_b16 v[142:143], v27 offset:8704
    s_waitcnt lgkmcnt(0)
    s_barrier
    s_mov_b32 s88, s50
    s_and_b32 s89, s51, 0xffff
    s_mov_b32 s90, 0x400000
    s_mov_b32 s91, 0x20000
    s_add_u32 m0, s28, 8192
    s_add_u32 s37, s3, 0x0
    buffer_load_dwordx4 v16, s[88:91], s37 offen lds
    s_add_u32 m0, s28, 9216
    s_add_u32 s37, s3, 0x8000
    buffer_load_dwordx4 v17, s[88:91], s37 offen lds
    s_add_u32 m0, s28, 10240
    s_add_u32 s37, s3, 0x10000
    buffer_load_dwordx4 v18, s[88:91], s37 offen lds
    s_add_u32 m0, s28, 11264
    s_add_u32 s37, s3, 0x18000
    buffer_load_dwordx4 v19, s[88:91], s37 offen lds
    s_add_u32 m0, s28, 12288
    s_add_u32 s37, s3, 0x20000
    buffer_load_dwordx4 v16, s[88:91], s37 offen lds
    s_add_u32 m0, s28, 13312
    s_add_u32 s37, s3, 0x28000
    buffer_load_dwordx4 v17, s[88:91], s37 offen lds
    s_add_u32 m0, s28, 14336
    s_add_u32 s37, s3, 0x30000
    buffer_load_dwordx4 v18, s[88:91], s37 offen lds
    s_add_u32 m0, s28, 15360
    s_add_u32 s37, s3, 0x38000
    buffer_load_dwordx4 v19, s[88:91], s37 offen lds
    s_waitcnt vmcnt(34)
    v_perm_b32 v120, v33, v32, s34
    v_perm_b32 v121, v33, v32, s35
    v_perm_b32 v122, v35, v34, s34
    v_perm_b32 v123, v35, v34, s35
    v_perm_b32 v124, v37, v36, s34
    v_perm_b32 v125, v37, v36, s35
    v_perm_b32 v126, v39, v38, s34
    v_perm_b32 v127, v39, v38, s35
    ds_write_b128 v4, v[120:123] offset:24576
    ds_write_b128 v4, v[124:127] offset:25600
    s_waitcnt lgkmcnt(0)
    v_perm_b32 v120, v41, v40, s34
    v_perm_b32 v121, v41, v40, s35
    v_perm_b32 v122, v43, v42, s34
    v_perm_b32 v123, v43, v42, s35
    v_perm_b32 v124, v45, v44, s34
    v_perm_b32 v125, v45, v44, s35
    v_perm_b32 v126, v47, v46, s34
    v_perm_b32 v127, v47, v46, s35
    ds_write_b128 v4, v[120:123] offset:30720
    ds_write_b128 v4, v[124:127] offset:31744
    s_waitcnt lgkmcnt(0)
    s_xor_b32 s36, s21, 1
    s_lshl_b32 s36, s36, 15
    s_add_u32 s36, s36, s29
    s_add_u32 s37, s36, 0x80
    buffer_load_dword v80, v11, s[92:95], s37 offen
    s_add_u32 s37, s36, 0x4080
    buffer_load_dword v81, v11, s[92:95], s37 offen
    s_add_u32 s37, s36, 0x480
    buffer_load_dword v82, v11, s[92:95], s37 offen
    s_add_u32 s37, s36, 0x4480
    buffer_load_dword v83, v11, s[92:95], s37 offen
    s_add_u32 s37, s36, 0x2080
    buffer_load_dword v84, v11, s[92:95], s37 offen
    s_add_u32 s37, s36, 0x6080
    buffer_load_dword v85, v11, s[92:95], s37 offen
    s_add_u32 s37, s36, 0x2480
    buffer_load_dword v86, v11, s[92:95], s37 offen
    s_add_u32 s37, s36, 0x6480
    buffer_load_dword v87, v11, s[92:95], s37 offen
    s_add_u32 s37, s36, 0xc0
    buffer_load_dword v88, v11, s[92:95], s37 offen
    s_add_u32 s37, s36, 0x40c0
    buffer_load_dword v89, v11, s[92:95], s37 offen
    s_add_u32 s37, s36, 0x4c0
    buffer_load_dword v90, v11, s[92:95], s37 offen
    s_add_u32 s37, s36, 0x44c0
    buffer_load_dword v91, v11, s[92:95], s37 offen
    s_add_u32 s37, s36, 0x20c0
    buffer_load_dword v92, v11, s[92:95], s37 offen
    s_add_u32 s37, s36, 0x60c0
    buffer_load_dword v93, v11, s[92:95], s37 offen
    s_add_u32 s37, s36, 0x24c0
    buffer_load_dword v94, v11, s[92:95], s37 offen
    s_add_u32 s37, s36, 0x64c0
    buffer_load_dword v95, v11, s[92:95], s37 offen
    s_barrier
    ds_read_b64_tr_b16 a[176:177], v20 offset:16384
    ds_read_b64_tr_b16 a[178:179], v20 offset:16896
    ds_read_b64_tr_b16 a[184:185], v21 offset:16384
    ds_read_b64_tr_b16 a[186:187], v21 offset:16896
    ds_read_b64_tr_b16 a[208:209], v22 offset:16384
    ds_read_b64_tr_b16 a[210:211], v22 offset:16896
    ds_read_b64_tr_b16 a[216:217], v23 offset:16384
    ds_read_b64_tr_b16 a[218:219], v23 offset:16896
    ds_read_b64_tr_b16 a[240:241], v24 offset:16384
    ds_read_b64_tr_b16 a[242:243], v24 offset:16896
    ds_read_b64_tr_b16 a[248:249], v25 offset:16384
    ds_read_b64_tr_b16 a[250:251], v25 offset:16896
    s_waitcnt lgkmcnt(4)
    ds_read_b64_tr_b16 v[144:145], v26 offset:16384
    ds_read_b64_tr_b16 v[146:147], v26 offset:16896
    ds_read_b64_tr_b16 v[152:153], v27 offset:16384
    ds_read_b64_tr_b16 v[154:155], v27 offset:16896
    s_waitcnt lgkmcnt(0)
    s_barrier
    s_add_u32 m0, s28, 16384
    s_add_u32 s37, s3, 0x100000
    buffer_load_dwordx4 v16, s[88:91], s37 offen lds
    s_add_u32 m0, s28, 17408
    s_add_u32 s37, s3, 0x108000
    buffer_load_dwordx4 v17, s[88:91], s37 offen lds
    s_add_u32 m0, s28, 18432
    s_add_u32 s37, s3, 0x110000
    buffer_load_dwordx4 v18, s[88:91], s37 offen lds
    s_add_u32 m0, s28, 19456
    s_add_u32 s37, s3, 0x118000
    buffer_load_dwordx4 v19, s[88:91], s37 offen lds
    s_add_u32 m0, s28, 20480
    s_add_u32 s37, s3, 0x120000
    buffer_load_dwordx4 v16, s[88:91], s37 offen lds
    s_add_u32 m0, s28, 21504
    s_add_u32 s37, s3, 0x128000
    buffer_load_dwordx4 v17, s[88:91], s37 offen lds
    s_add_u32 m0, s28, 22528
    s_add_u32 s37, s3, 0x130000
    buffer_load_dwordx4 v18, s[88:91], s37 offen lds
    s_add_u32 m0, s28, 23552
    s_add_u32 s37, s3, 0x138000
    buffer_load_dwordx4 v19, s[88:91], s37 offen lds
    s_waitcnt vmcnt(32)
    v_perm_b32 v232, v49, v48, s34
    v_perm_b32 v233, v49, v48, s35
    v_perm_b32 v234, v51, v50, s34
    v_perm_b32 v235, v51, v50, s35
    v_perm_b32 v236, v53, v52, s34
    v_perm_b32 v237, v53, v52, s35
    v_perm_b32 v238, v55, v54, s34
    v_perm_b32 v239, v55, v54, s35
    v_perm_b32 v120, v57, v56, s34
    v_perm_b32 v121, v57, v56, s35
    v_perm_b32 v122, v59, v58, s34
    v_perm_b32 v123, v59, v58, s35
    v_perm_b32 v124, v61, v60, s34
    v_perm_b32 v125, v61, v60, s35
    v_perm_b32 v126, v63, v62, s34
    v_perm_b32 v127, v63, v62, s35
    ds_write_b128 v4, v[120:123] offset:28672
    ds_write_b128 v4, v[124:127] offset:29696
    s_waitcnt lgkmcnt(0)
    s_xor_b32 s36, s21, 3
    s_lshl_b32 s36, s36, 15
    s_add_u32 s36, s36, s29
    s_add_u32 s37, s36, 0x0
    buffer_load_dword v32, v11, s[92:95], s37 offen
    s_add_u32 s37, s36, 0x4000
    buffer_load_dword v33, v11, s[92:95], s37 offen
    s_add_u32 s37, s36, 0x400
    buffer_load_dword v34, v11, s[92:95], s37 offen
    s_add_u32 s37, s36, 0x4400
    buffer_load_dword v35, v11, s[92:95], s37 offen
    s_add_u32 s37, s36, 0x2000
    buffer_load_dword v36, v11, s[92:95], s37 offen
    s_add_u32 s37, s36, 0x6000
    buffer_load_dword v37, v11, s[92:95], s37 offen
    s_add_u32 s37, s36, 0x2400
    buffer_load_dword v38, v11, s[92:95], s37 offen
    s_add_u32 s37, s36, 0x6400
    buffer_load_dword v39, v11, s[92:95], s37 offen
    s_add_u32 s37, s36, 0x40
    buffer_load_dword v40, v11, s[92:95], s37 offen
    s_add_u32 s37, s36, 0x4040
    buffer_load_dword v41, v11, s[92:95], s37 offen
    s_add_u32 s37, s36, 0x440
    buffer_load_dword v42, v11, s[92:95], s37 offen
    s_add_u32 s37, s36, 0x4440
    buffer_load_dword v43, v11, s[92:95], s37 offen
    s_add_u32 s37, s36, 0x2040
    buffer_load_dword v44, v11, s[92:95], s37 offen
    s_add_u32 s37, s36, 0x6040
    buffer_load_dword v45, v11, s[92:95], s37 offen
    s_add_u32 s37, s36, 0x2440
    buffer_load_dword v46, v11, s[92:95], s37 offen
    s_add_u32 s37, s36, 0x6440
    buffer_load_dword v47, v11, s[92:95], s37 offen
    s_barrier
    ds_read_b64_tr_b16 a[180:181], v20 offset:0
    ds_read_b64_tr_b16 a[182:183], v20 offset:512
    ds_read_b64_tr_b16 a[188:189], v21 offset:0
    ds_read_b64_tr_b16 a[190:191], v21 offset:512
    ds_read_b64_tr_b16 a[212:213], v22 offset:0
    ds_read_b64_tr_b16 a[214:215], v22 offset:512
    ds_read_b64_tr_b16 a[220:221], v23 offset:0
    ds_read_b64_tr_b16 a[222:223], v23 offset:512
    ds_read_b64_tr_b16 a[244:245], v24 offset:0
    ds_read_b64_tr_b16 a[246:247], v24 offset:512
    ds_read_b64_tr_b16 a[252:253], v25 offset:0
    ds_read_b64_tr_b16 a[254:255], v25 offset:512
    s_waitcnt lgkmcnt(4)
    ds_read_b64_tr_b16 v[148:149], v26 offset:0
    ds_read_b64_tr_b16 v[150:151], v26 offset:512
    ds_read_b64_tr_b16 v[156:157], v27 offset:0
    ds_read_b64_tr_b16 v[158:159], v27 offset:512
    s_waitcnt lgkmcnt(0)
    s_barrier
    s_add_u32 m0, s28, 0
    s_add_u32 s37, s3, 0x200000
    buffer_load_dwordx4 v16, s[88:91], s37 offen lds
    s_add_u32 m0, s28, 1024
    s_add_u32 s37, s3, 0x208000
    buffer_load_dwordx4 v17, s[88:91], s37 offen lds
    s_add_u32 m0, s28, 2048
    s_add_u32 s37, s3, 0x210000
    buffer_load_dwordx4 v18, s[88:91], s37 offen lds
    s_add_u32 m0, s28, 3072
    s_add_u32 s37, s3, 0x218000
    buffer_load_dwordx4 v19, s[88:91], s37 offen lds
    s_add_u32 m0, s28, 4096
    s_add_u32 s37, s3, 0x220000
    buffer_load_dwordx4 v16, s[88:91], s37 offen lds
    s_add_u32 m0, s28, 5120
    s_add_u32 s37, s3, 0x228000
    buffer_load_dwordx4 v17, s[88:91], s37 offen lds
    s_add_u32 m0, s28, 6144
    s_add_u32 s37, s3, 0x230000
    buffer_load_dwordx4 v18, s[88:91], s37 offen lds
    s_add_u32 m0, s28, 7168
    s_add_u32 s37, s3, 0x238000
    buffer_load_dwordx4 v19, s[88:91], s37 offen lds
    s_waitcnt vmcnt(32)
    v_perm_b32 v208, v81, v80, s34
    v_perm_b32 v209, v81, v80, s35
    v_perm_b32 v210, v83, v82, s34
    v_perm_b32 v211, v83, v82, s35
    v_perm_b32 v212, v85, v84, s34
    v_perm_b32 v213, v85, v84, s35
    v_perm_b32 v214, v87, v86, s34
    v_perm_b32 v215, v87, v86, s35
    v_perm_b32 v120, v89, v88, s34
    v_perm_b32 v121, v89, v88, s35
    v_perm_b32 v122, v91, v90, s34
    v_perm_b32 v123, v91, v90, s35
    v_perm_b32 v124, v93, v92, s34
    v_perm_b32 v125, v93, v92, s35
    v_perm_b32 v126, v95, v94, s34
    v_perm_b32 v127, v95, v94, s35
    ds_write_b128 v4, v[120:123] offset:26624
    ds_write_b128 v4, v[124:127] offset:27648
    s_waitcnt lgkmcnt(0)
    s_xor_b32 s36, s21, 2
    s_lshl_b32 s36, s36, 15
    s_add_u32 s36, s36, s29
    s_add_u32 s37, s36, 0x0
    buffer_load_dword v48, v11, s[92:95], s37 offen
    s_add_u32 s37, s36, 0x4000
    buffer_load_dword v49, v11, s[92:95], s37 offen
    s_add_u32 s37, s36, 0x400
    buffer_load_dword v50, v11, s[92:95], s37 offen
    s_add_u32 s37, s36, 0x4400
    buffer_load_dword v51, v11, s[92:95], s37 offen
    s_add_u32 s37, s36, 0x2000
    buffer_load_dword v52, v11, s[92:95], s37 offen
    s_add_u32 s37, s36, 0x6000
    buffer_load_dword v53, v11, s[92:95], s37 offen
    s_add_u32 s37, s36, 0x2400
    buffer_load_dword v54, v11, s[92:95], s37 offen
    s_add_u32 s37, s36, 0x6400
    buffer_load_dword v55, v11, s[92:95], s37 offen
    s_add_u32 s37, s36, 0x40
    buffer_load_dword v56, v11, s[92:95], s37 offen
    s_add_u32 s37, s36, 0x4040
    buffer_load_dword v57, v11, s[92:95], s37 offen
    s_add_u32 s37, s36, 0x440
    buffer_load_dword v58, v11, s[92:95], s37 offen
    s_add_u32 s37, s36, 0x4440
    buffer_load_dword v59, v11, s[92:95], s37 offen
    s_add_u32 s37, s36, 0x2040
    buffer_load_dword v60, v11, s[92:95], s37 offen
    s_add_u32 s37, s36, 0x6040
    buffer_load_dword v61, v11, s[92:95], s37 offen
    s_add_u32 s37, s36, 0x2440
    buffer_load_dword v62, v11, s[92:95], s37 offen
    s_add_u32 s37, s36, 0x6440
    buffer_load_dword v63, v11, s[92:95], s37 offen
    s_barrier
    ds_read_b64_tr_b16 v[64:65], v20 offset:8192
    ds_read_b64_tr_b16 v[66:67], v20 offset:8704
    ds_read_b64_tr_b16 v[72:73], v21 offset:8192
    ds_read_b64_tr_b16 v[74:75], v21 offset:8704
    ds_read_b64_tr_b16 v[96:97], v22 offset:8192
    ds_read_b64_tr_b16 v[98:99], v22 offset:8704
    ds_read_b64_tr_b16 v[104:105], v23 offset:8192
    ds_read_b64_tr_b16 v[106:107], v23 offset:8704
    ds_read_b64_tr_b16 a[112:113], v24 offset:8192
    ds_read_b64_tr_b16 a[114:115], v24 offset:8704
    ds_read_b64_tr_b16 a[120:121], v25 offset:8192
    ds_read_b64_tr_b16 a[122:123], v25 offset:8704
    s_waitcnt lgkmcnt(4)
    ds_read_b64_tr_b16 a[144:145], v26 offset:8192
    ds_read_b64_tr_b16 a[146:147], v26 offset:8704
    ds_read_b64_tr_b16 a[152:153], v27 offset:8192
    ds_read_b64_tr_b16 a[154:155], v27 offset:8704
    s_waitcnt lgkmcnt(0)
    s_barrier
    s_add_u32 m0, s28, 8192
    s_add_u32 s37, s3, 0x300000
    buffer_load_dwordx4 v16, s[88:91], s37 offen lds
    s_add_u32 m0, s28, 9216
    s_add_u32 s37, s3, 0x308000
    buffer_load_dwordx4 v17, s[88:91], s37 offen lds
    s_add_u32 m0, s28, 10240
    s_add_u32 s37, s3, 0x310000
    buffer_load_dwordx4 v18, s[88:91], s37 offen lds
    s_add_u32 m0, s28, 11264
    s_add_u32 s37, s3, 0x318000
    buffer_load_dwordx4 v19, s[88:91], s37 offen lds
    s_add_u32 m0, s28, 12288
    s_add_u32 s37, s3, 0x320000
    buffer_load_dwordx4 v16, s[88:91], s37 offen lds
    s_add_u32 m0, s28, 13312
    s_add_u32 s37, s3, 0x328000
    buffer_load_dwordx4 v17, s[88:91], s37 offen lds
    s_add_u32 m0, s28, 14336
    s_add_u32 s37, s3, 0x330000
    buffer_load_dwordx4 v18, s[88:91], s37 offen lds
    s_add_u32 m0, s28, 15360
    s_add_u32 s37, s3, 0x338000
    buffer_load_dwordx4 v19, s[88:91], s37 offen lds
    s_waitcnt vmcnt(32)
    v_perm_b32 v240, v33, v32, s34
    v_perm_b32 v241, v33, v32, s35
    v_perm_b32 v242, v35, v34, s34
    v_perm_b32 v243, v35, v34, s35
    v_perm_b32 v244, v37, v36, s34
    v_perm_b32 v245, v37, v36, s35
    v_perm_b32 v246, v39, v38, s34
    v_perm_b32 v247, v39, v38, s35
    v_perm_b32 v248, v41, v40, s34
    v_perm_b32 v249, v41, v40, s35
    v_perm_b32 v250, v43, v42, s34
    v_perm_b32 v251, v43, v42, s35
    v_perm_b32 v252, v45, v44, s34
    v_perm_b32 v253, v45, v44, s35
    v_perm_b32 v254, v47, v46, s34
    v_perm_b32 v255, v47, v46, s35
    s_xor_b32 s36, s21, 1
    s_lshl_b32 s36, s36, 15
    s_add_u32 s36, s36, s29
    s_add_u32 s37, s36, 0x0
    buffer_load_dword v80, v11, s[92:95], s37 offen
    s_add_u32 s37, s36, 0x4000
    buffer_load_dword v81, v11, s[92:95], s37 offen
    s_add_u32 s37, s36, 0x400
    buffer_load_dword v82, v11, s[92:95], s37 offen
    s_add_u32 s37, s36, 0x4400
    buffer_load_dword v83, v11, s[92:95], s37 offen
    s_add_u32 s37, s36, 0x2000
    buffer_load_dword v84, v11, s[92:95], s37 offen
    s_add_u32 s37, s36, 0x6000
    buffer_load_dword v85, v11, s[92:95], s37 offen
    s_add_u32 s37, s36, 0x2400
    buffer_load_dword v86, v11, s[92:95], s37 offen
    s_add_u32 s37, s36, 0x6400
    buffer_load_dword v87, v11, s[92:95], s37 offen
    s_add_u32 s37, s36, 0x40
    buffer_load_dword v88, v11, s[92:95], s37 offen
    s_add_u32 s37, s36, 0x4040
    buffer_load_dword v89, v11, s[92:95], s37 offen
    s_add_u32 s37, s36, 0x440
    buffer_load_dword v90, v11, s[92:95], s37 offen
    s_add_u32 s37, s36, 0x4440
    buffer_load_dword v91, v11, s[92:95], s37 offen
    s_add_u32 s37, s36, 0x2040
    buffer_load_dword v92, v11, s[92:95], s37 offen
    s_add_u32 s37, s36, 0x6040
    buffer_load_dword v93, v11, s[92:95], s37 offen
    s_add_u32 s37, s36, 0x2440
    buffer_load_dword v94, v11, s[92:95], s37 offen
    s_add_u32 s37, s36, 0x6440
    buffer_load_dword v95, v11, s[92:95], s37 offen
    s_barrier
    ds_read_b64_tr_b16 v[68:69], v20 offset:16384
    ds_read_b64_tr_b16 v[70:71], v20 offset:16896
    ds_read_b64_tr_b16 v[76:77], v21 offset:16384
    ds_read_b64_tr_b16 v[78:79], v21 offset:16896
    ds_read_b64_tr_b16 v[100:101], v22 offset:16384
    ds_read_b64_tr_b16 v[102:103], v22 offset:16896
    ds_read_b64_tr_b16 v[108:109], v23 offset:16384
    ds_read_b64_tr_b16 v[110:111], v23 offset:16896
    ds_read_b64_tr_b16 a[116:117], v24 offset:16384
    ds_read_b64_tr_b16 a[118:119], v24 offset:16896
    ds_read_b64_tr_b16 a[124:125], v25 offset:16384
    ds_read_b64_tr_b16 a[126:127], v25 offset:16896
    s_waitcnt lgkmcnt(4)
    ds_read_b64_tr_b16 a[148:149], v26 offset:16384
    ds_read_b64_tr_b16 a[150:151], v26 offset:16896
    ds_read_b64_tr_b16 a[156:157], v27 offset:16384
    ds_read_b64_tr_b16 a[158:159], v27 offset:16896
    s_waitcnt lgkmcnt(0)
    s_barrier
    s_mov_b32 s96, s48
    s_and_b32 s97, s49, 0xffff
    s_mov_b32 s98, 0x400000
    s_mov_b32 s99, 0x20000
    s_add_u32 m0, s28, 16384
    s_add_u32 s37, s3, 0x0
    buffer_load_dwordx4 v16, s[96:99], s37 offen lds
    s_add_u32 m0, s28, 17408
    s_add_u32 s37, s3, 0x8000
    buffer_load_dwordx4 v17, s[96:99], s37 offen lds
    s_add_u32 m0, s28, 18432
    s_add_u32 s37, s3, 0x10000
    buffer_load_dwordx4 v18, s[96:99], s37 offen lds
    s_add_u32 m0, s28, 19456
    s_add_u32 s37, s3, 0x18000
    buffer_load_dwordx4 v19, s[96:99], s37 offen lds
    s_add_u32 m0, s28, 20480
    s_add_u32 s37, s3, 0x20000
    buffer_load_dwordx4 v16, s[96:99], s37 offen lds
    s_add_u32 m0, s28, 21504
    s_add_u32 s37, s3, 0x28000
    buffer_load_dwordx4 v17, s[96:99], s37 offen lds
    s_add_u32 m0, s28, 22528
    s_add_u32 s37, s3, 0x30000
    buffer_load_dwordx4 v18, s[96:99], s37 offen lds
    s_add_u32 m0, s28, 23552
    s_add_u32 s37, s3, 0x38000
    buffer_load_dwordx4 v19, s[96:99], s37 offen lds
    s_waitcnt vmcnt(32)
    v_perm_b32 v216, v49, v48, s34
    v_perm_b32 v217, v49, v48, s35
    v_perm_b32 v218, v51, v50, s34
    v_perm_b32 v219, v51, v50, s35
    v_perm_b32 v220, v53, v52, s34
    v_perm_b32 v221, v53, v52, s35
    v_perm_b32 v222, v55, v54, s34
    v_perm_b32 v223, v55, v54, s35
    v_perm_b32 v224, v57, v56, s34
    v_perm_b32 v225, v57, v56, s35
    v_perm_b32 v226, v59, v58, s34
    v_perm_b32 v227, v59, v58, s35
    v_perm_b32 v228, v61, v60, s34
    v_perm_b32 v229, v61, v60, s35
    v_perm_b32 v230, v63, v62, s34
    v_perm_b32 v231, v63, v62, s35
    s_xor_b32 s36, s21, 0
    s_lshl_b32 s36, s36, 15
    s_add_u32 s36, s36, s29
    s_add_u32 s37, s36, 0x80
    buffer_load_dword v32, v11, s[92:95], s37 offen
    s_add_u32 s37, s36, 0x4080
    buffer_load_dword v33, v11, s[92:95], s37 offen
    s_add_u32 s37, s36, 0x480
    buffer_load_dword v34, v11, s[92:95], s37 offen
    s_add_u32 s37, s36, 0x4480
    buffer_load_dword v35, v11, s[92:95], s37 offen
    s_add_u32 s37, s36, 0x2080
    buffer_load_dword v36, v11, s[92:95], s37 offen
    s_add_u32 s37, s36, 0x6080
    buffer_load_dword v37, v11, s[92:95], s37 offen
    s_add_u32 s37, s36, 0x2480
    buffer_load_dword v38, v11, s[92:95], s37 offen
    s_add_u32 s37, s36, 0x6480
    buffer_load_dword v39, v11, s[92:95], s37 offen
    s_add_u32 s37, s36, 0xc0
    buffer_load_dword v40, v11, s[92:95], s37 offen
    s_add_u32 s37, s36, 0x40c0
    buffer_load_dword v41, v11, s[92:95], s37 offen
    s_add_u32 s37, s36, 0x4c0
    buffer_load_dword v42, v11, s[92:95], s37 offen
    s_add_u32 s37, s36, 0x44c0
    buffer_load_dword v43, v11, s[92:95], s37 offen
    s_add_u32 s37, s36, 0x20c0
    buffer_load_dword v44, v11, s[92:95], s37 offen
    s_add_u32 s37, s36, 0x60c0
    buffer_load_dword v45, v11, s[92:95], s37 offen
    s_add_u32 s37, s36, 0x24c0
    buffer_load_dword v46, v11, s[92:95], s37 offen
    s_add_u32 s37, s36, 0x64c0
    buffer_load_dword v47, v11, s[92:95], s37 offen
    s_barrier
    ds_read_b64_tr_b16 a[80:81], v20 offset:0
    ds_read_b64_tr_b16 a[82:83], v20 offset:512
    ds_read_b64_tr_b16 a[88:89], v21 offset:0
    ds_read_b64_tr_b16 a[90:91], v21 offset:512
    ds_read_b64_tr_b16 a[96:97], v22 offset:0
    ds_read_b64_tr_b16 a[98:99], v22 offset:512
    ds_read_b64_tr_b16 a[104:105], v23 offset:0
    ds_read_b64_tr_b16 a[106:107], v23 offset:512
    ds_read_b64_tr_b16 a[128:129], v24 offset:0
    ds_read_b64_tr_b16 a[130:131], v24 offset:512
    ds_read_b64_tr_b16 a[136:137], v25 offset:0
    ds_read_b64_tr_b16 a[138:139], v25 offset:512
    s_waitcnt lgkmcnt(4)
    ds_read_b64_tr_b16 v[112:113], v26 offset:0
    ds_read_b64_tr_b16 v[114:115], v26 offset:512
    ds_read_b64_tr_b16 v[120:121], v27 offset:0
    ds_read_b64_tr_b16 v[122:123], v27 offset:512
    s_waitcnt lgkmcnt(0)
    s_barrier
    s_add_u32 m0, s28, 0
    s_add_u32 s37, s3, 0x100000
    buffer_load_dwordx4 v16, s[96:99], s37 offen lds
    s_add_u32 m0, s28, 1024
    s_add_u32 s37, s3, 0x108000
    buffer_load_dwordx4 v17, s[96:99], s37 offen lds
    s_add_u32 m0, s28, 2048
    s_add_u32 s37, s3, 0x110000
    buffer_load_dwordx4 v18, s[96:99], s37 offen lds
    s_add_u32 m0, s28, 3072
    s_add_u32 s37, s3, 0x118000
    buffer_load_dwordx4 v19, s[96:99], s37 offen lds
    s_add_u32 m0, s28, 4096
    s_add_u32 s37, s3, 0x120000
    buffer_load_dwordx4 v16, s[96:99], s37 offen lds
    s_add_u32 m0, s28, 5120
    s_add_u32 s37, s3, 0x128000
    buffer_load_dwordx4 v17, s[96:99], s37 offen lds
    s_add_u32 m0, s28, 6144
    s_add_u32 s37, s3, 0x130000
    buffer_load_dwordx4 v18, s[96:99], s37 offen lds
    s_add_u32 m0, s28, 7168
    s_add_u32 s37, s3, 0x138000
    buffer_load_dwordx4 v19, s[96:99], s37 offen lds
    s_waitcnt vmcnt(32)
    v_perm_b32 v192, v81, v80, s34
    v_perm_b32 v193, v81, v80, s35
    v_perm_b32 v194, v83, v82, s34
    v_perm_b32 v195, v83, v82, s35
    v_perm_b32 v196, v85, v84, s34
    v_perm_b32 v197, v85, v84, s35
    v_perm_b32 v198, v87, v86, s34
    v_perm_b32 v199, v87, v86, s35
    v_perm_b32 v200, v89, v88, s34
    v_perm_b32 v201, v89, v88, s35
    v_perm_b32 v202, v91, v90, s34
    v_perm_b32 v203, v91, v90, s35
    v_perm_b32 v204, v93, v92, s34
    v_perm_b32 v205, v93, v92, s35
    v_perm_b32 v206, v95, v94, s34
    v_perm_b32 v207, v95, v94, s35
    s_xor_b32 s36, s21, 0
    s_lshl_b32 s36, s36, 15
    s_add_u32 s36, s36, s29
    s_add_u32 s37, s36, 0x0
    buffer_load_dword v48, v11, s[92:95], s37 offen
    s_add_u32 s37, s36, 0x4000
    buffer_load_dword v49, v11, s[92:95], s37 offen
    s_add_u32 s37, s36, 0x400
    buffer_load_dword v50, v11, s[92:95], s37 offen
    s_add_u32 s37, s36, 0x4400
    buffer_load_dword v51, v11, s[92:95], s37 offen
    s_add_u32 s37, s36, 0x2000
    buffer_load_dword v52, v11, s[92:95], s37 offen
    s_add_u32 s37, s36, 0x6000
    buffer_load_dword v53, v11, s[92:95], s37 offen
    s_add_u32 s37, s36, 0x2400
    buffer_load_dword v54, v11, s[92:95], s37 offen
    s_add_u32 s37, s36, 0x6400
    buffer_load_dword v55, v11, s[92:95], s37 offen
    s_add_u32 s37, s36, 0x40
    buffer_load_dword v56, v11, s[92:95], s37 offen
    s_add_u32 s37, s36, 0x4040
    buffer_load_dword v57, v11, s[92:95], s37 offen
    s_add_u32 s37, s36, 0x440
    buffer_load_dword v58, v11, s[92:95], s37 offen
    s_add_u32 s37, s36, 0x4440
    buffer_load_dword v59, v11, s[92:95], s37 offen
    s_add_u32 s37, s36, 0x2040
    buffer_load_dword v60, v11, s[92:95], s37 offen
    s_add_u32 s37, s36, 0x6040
    buffer_load_dword v61, v11, s[92:95], s37 offen
    s_add_u32 s37, s36, 0x2440
    buffer_load_dword v62, v11, s[92:95], s37 offen
    s_add_u32 s37, s36, 0x6440
    buffer_load_dword v63, v11, s[92:95], s37 offen
    s_barrier
    ds_read_b64_tr_b16 a[84:85], v20 offset:8192
    ds_read_b64_tr_b16 a[86:87], v20 offset:8704
    ds_read_b64_tr_b16 a[92:93], v21 offset:8192
    ds_read_b64_tr_b16 a[94:95], v21 offset:8704
    ds_read_b64_tr_b16 a[100:101], v22 offset:8192
    ds_read_b64_tr_b16 a[102:103], v22 offset:8704
    ds_read_b64_tr_b16 a[108:109], v23 offset:8192
    ds_read_b64_tr_b16 a[110:111], v23 offset:8704
    ds_read_b64_tr_b16 a[132:133], v24 offset:8192
    ds_read_b64_tr_b16 a[134:135], v24 offset:8704
    ds_read_b64_tr_b16 a[140:141], v25 offset:8192
    ds_read_b64_tr_b16 a[142:143], v25 offset:8704
    s_waitcnt lgkmcnt(4)
    ds_read_b64_tr_b16 v[116:117], v26 offset:8192
    ds_read_b64_tr_b16 v[118:119], v26 offset:8704
    ds_read_b64_tr_b16 v[124:125], v27 offset:8192
    ds_read_b64_tr_b16 v[126:127], v27 offset:8704
    s_waitcnt lgkmcnt(0)
    s_barrier
    s_add_u32 m0, s28, 8192
    s_add_u32 s37, s3, 0x200000
    buffer_load_dwordx4 v16, s[96:99], s37 offen lds
    s_add_u32 m0, s28, 9216
    s_add_u32 s37, s3, 0x208000
    buffer_load_dwordx4 v17, s[96:99], s37 offen lds
    s_add_u32 m0, s28, 10240
    s_add_u32 s37, s3, 0x210000
    buffer_load_dwordx4 v18, s[96:99], s37 offen lds
    s_add_u32 m0, s28, 11264
    s_add_u32 s37, s3, 0x218000
    buffer_load_dwordx4 v19, s[96:99], s37 offen lds
    s_add_u32 m0, s28, 12288
    s_add_u32 s37, s3, 0x220000
    buffer_load_dwordx4 v16, s[96:99], s37 offen lds
    s_add_u32 m0, s28, 13312
    s_add_u32 s37, s3, 0x228000
    buffer_load_dwordx4 v17, s[96:99], s37 offen lds
    s_add_u32 m0, s28, 14336
    s_add_u32 s37, s3, 0x230000
    buffer_load_dwordx4 v18, s[96:99], s37 offen lds
    s_add_u32 m0, s28, 15360
    s_add_u32 s37, s3, 0x238000
    buffer_load_dwordx4 v19, s[96:99], s37 offen lds
    s_waitcnt vmcnt(32)
    v_perm_b32 v176, v33, v32, s34
    v_perm_b32 v177, v33, v32, s35
    v_perm_b32 v178, v35, v34, s34
    v_perm_b32 v179, v35, v34, s35
    v_perm_b32 v180, v37, v36, s34
    v_perm_b32 v181, v37, v36, s35
    v_perm_b32 v182, v39, v38, s34
    v_perm_b32 v183, v39, v38, s35
    v_perm_b32 v184, v41, v40, s34
    v_perm_b32 v185, v41, v40, s35
    v_perm_b32 v186, v43, v42, s34
    v_perm_b32 v187, v43, v42, s35
    v_perm_b32 v188, v45, v44, s34
    v_perm_b32 v189, v45, v44, s35
    v_perm_b32 v190, v47, v46, s34
    v_perm_b32 v191, v47, v46, s35
    v_lshrrev_b32 v31, 2, v3
    buffer_load_dword v30, v31, s[16:19], 0 offen sc1
    s_barrier
    ds_read_b64_tr_b16 v[32:33], v20 offset:16384
    ds_read_b64_tr_b16 v[34:35], v20 offset:16896
    ds_read_b64_tr_b16 v[40:41], v21 offset:16384
    ds_read_b64_tr_b16 v[42:43], v21 offset:16896
    ds_read_b64_tr_b16 a[0:1], v22 offset:16384
    ds_read_b64_tr_b16 a[2:3], v22 offset:16896
    ds_read_b64_tr_b16 a[8:9], v23 offset:16384
    ds_read_b64_tr_b16 a[10:11], v23 offset:16896
    ds_read_b64_tr_b16 a[32:33], v24 offset:16384
    ds_read_b64_tr_b16 a[34:35], v24 offset:16896
    ds_read_b64_tr_b16 a[40:41], v25 offset:16384
    ds_read_b64_tr_b16 a[42:43], v25 offset:16896
    s_waitcnt lgkmcnt(4)
    ds_read_b64_tr_b16 a[64:65], v26 offset:16384
    ds_read_b64_tr_b16 a[66:67], v26 offset:16896
    ds_read_b64_tr_b16 a[72:73], v27 offset:16384
    ds_read_b64_tr_b16 a[74:75], v27 offset:16896
    s_waitcnt lgkmcnt(0)
    s_barrier
    s_add_u32 m0, s28, 16384
    s_add_u32 s37, s3, 0x300000
    buffer_load_dwordx4 v16, s[96:99], s37 offen lds
    s_add_u32 m0, s28, 17408
    s_add_u32 s37, s3, 0x308000
    buffer_load_dwordx4 v17, s[96:99], s37 offen lds
    s_add_u32 m0, s28, 18432
    s_add_u32 s37, s3, 0x310000
    buffer_load_dwordx4 v18, s[96:99], s37 offen lds
    s_add_u32 m0, s28, 19456
    s_add_u32 s37, s3, 0x318000
    buffer_load_dwordx4 v19, s[96:99], s37 offen lds
    s_add_u32 m0, s28, 20480
    s_add_u32 s37, s3, 0x320000
    buffer_load_dwordx4 v16, s[96:99], s37 offen lds
    s_add_u32 m0, s28, 21504
    s_add_u32 s37, s3, 0x328000
    buffer_load_dwordx4 v17, s[96:99], s37 offen lds
    s_add_u32 m0, s28, 22528
    s_add_u32 s37, s3, 0x330000
    buffer_load_dwordx4 v18, s[96:99], s37 offen lds
    s_add_u32 m0, s28, 23552
    s_add_u32 s37, s3, 0x338000
    buffer_load_dwordx4 v19, s[96:99], s37 offen lds
    s_waitcnt vmcnt(17)
    v_perm_b32 v160, v49, v48, s34
    v_perm_b32 v161, v49, v48, s35
    v_perm_b32 v162, v51, v50, s34
    v_perm_b32 v163, v51, v50, s35
    v_perm_b32 v164, v53, v52, s34
    v_perm_b32 v165, v53, v52, s35
    v_perm_b32 v166, v55, v54, s34
    v_perm_b32 v167, v55, v54, s35
    v_perm_b32 v168, v57, v56, s34
    v_perm_b32 v169, v57, v56, s35
    v_perm_b32 v170, v59, v58, s34
    v_perm_b32 v171, v59, v58, s35
    v_perm_b32 v172, v61, v60, s34
    v_perm_b32 v173, v61, v60, s35
    v_perm_b32 v174, v63, v62, s34
    v_perm_b32 v175, v63, v62, s35
    s_waitcnt vmcnt(8)
    s_mov_b32 s41, 1
L_HS:
    v_cmp_eq_u32 vcc, 0, v30
    s_cbranch_vccz L_HS_ok
    buffer_load_dword v30, v31, s[16:19], 0 offen sc1
    s_add_u32 s32, s32, 1
    s_cmp_gt_u32 s32, 200000
    s_waitcnt vmcnt(0)
    s_cbranch_scc0 L_HS
    s_branch L_HS_done
L_HS_ok:
    v_readlane_b32 s36, v30, 63
    s_nop 1
    v_cmp_ne_u32 vcc, s36, v30
    s_nop 1
    s_cmp_lg_u32 vcc_hi, 0
    s_cselect_b32 s41, 1, 0
L_HS_done:
    s_mov_b32 s7, 0xf7df00
    buffer_load_dword v15, v0, s[8:11], s7 offen sc1
    s_barrier
    ds_read_b64_tr_b16 v[36:37], v20 offset:0
    ds_read_b64_tr_b16 v[38:39], v20 offset:512
    ds_read_b64_tr_b16 v[44:45], v21 offset:0
    ds_read_b64_tr_b16 v[46:47], v21 offset:512
    ds_read_b64_tr_b16 a[4:5], v22 offset:0
    ds_read_b64_tr_b16 a[6:7], v22 offset:512
    ds_read_b64_tr_b16 a[12:13], v23 offset:0
    ds_read_b64_tr_b16 a[14:15], v23 offset:512
    ds_read_b64_tr_b16 a[36:37], v24 offset:0
    ds_read_b64_tr_b16 a[38:39], v24 offset:512
    ds_read_b64_tr_b16 a[44:45], v25 offset:0
    ds_read_b64_tr_b16 a[46:47], v25 offset:512
    s_waitcnt lgkmcnt(4)
    ds_read_b64_tr_b16 a[68:69], v26 offset:0
    ds_read_b64_tr_b16 a[70:71], v26 offset:512
    ds_read_b64_tr_b16 a[76:77], v27 offset:0
    ds_read_b64_tr_b16 a[78:79], v27 offset:512
    s_waitcnt lgkmcnt(0)
    s_barrier
    s_barrier
    ds_read_b64_tr_b16 v[48:49], v20 offset:8192
    ds_read_b64_tr_b16 v[50:51], v20 offset:8704
    ds_read_b64_tr_b16 v[56:57], v21 offset:8192
    ds_read_b64_tr_b16 v[58:59], v21 offset:8704
    ds_read_b64_tr_b16 a[16:17], v22 offset:8192
    ds_read_b64_tr_b16 a[18:19], v22 offset:8704
    ds_read_b64_tr_b16 a[24:25], v23 offset:8192
    ds_read_b64_tr_b16 a[26:27], v23 offset:8704
    ds_read_b64_tr_b16 a[48:49], v24 offset:8192
    ds_read_b64_tr_b16 a[50:51], v24 offset:8704
    ds_read_b64_tr_b16 a[56:57], v25 offset:8192
    ds_read_b64_tr_b16 a[58:59], v25 offset:8704
    s_waitcnt lgkmcnt(4)
    ds_read_b64_tr_b16 v[80:81], v26 offset:8192
    ds_read_b64_tr_b16 v[82:83], v26 offset:8704
    ds_read_b64_tr_b16 v[88:89], v27 offset:8192
    ds_read_b64_tr_b16 v[90:91], v27 offset:8704
    s_waitcnt lgkmcnt(0)
    s_barrier
    s_waitcnt vmcnt(0)
L_F0:
    v_readlane_b32 s36, v15, 33
    s_nop 1
    s_cmp_lg_u32 s36, 0
    s_cbranch_scc1 L_F0_ok
    buffer_load_dword v15, v0, s[8:11], s7 offen sc1
    s_add_u32 s32, s32, 1
    s_cmp_gt_u32 s32, 200000
    s_waitcnt vmcnt(0)
    s_cbranch_scc0 L_F0
L_F0_ok:
    s_mov_b32 s7, 0x1000000
    buffer_load_dword v15, v0, s[8:11], s7 offen sc1
    s_barrier
    ds_read_b64_tr_b16 v[52:53], v20 offset:16384
    ds_read_b64_tr_b16 v[54:55], v20 offset:16896
    ds_read_b64_tr_b16 v[60:61], v21 offset:16384
    ds_read_b64_tr_b16 v[62:63], v21 offset:16896
    ds_read_b64_tr_b16 a[20:21], v22 offset:16384
    ds_read_b64_tr_b16 a[22:23], v22 offset:16896
    ds_read_b64_tr_b16 a[28:29], v23 offset:16384
    ds_read_b64_tr_b16 a[30:31], v23 offset:16896
    ds_read_b64_tr_b16 a[52:53], v24 offset:16384
    ds_read_b64_tr_b16 a[54:55], v24 offset:16896
    ds_read_b64_tr_b16 a[60:61], v25 offset:16384
    ds_read_b64_tr_b16 a[62:63], v25 offset:16896
    s_waitcnt lgkmcnt(4)
    ds_read_b64_tr_b16 v[84:85], v26 offset:16384
    ds_read_b64_tr_b16 v[86:87], v26 offset:16896
    ds_read_b64_tr_b16 v[92:93], v27 offset:16384
    ds_read_b64_tr_b16 v[94:95], v27 offset:16896
    s_waitcnt lgkmcnt(0)
    s_barrier
    ds_write_b128 v4, v[32:35] offset:0
    ds_write_b128 v4, v[36:39] offset:1024
    ds_write_b128 v4, v[40:43] offset:2048
    ds_write_b128 v4, v[44:47] offset:3072
    ds_write_b128 v4, v[48:51] offset:4096
    ds_write_b128 v4, v[52:55] offset:5120
    ds_write_b128 v4, v[56:59] offset:6144
    ds_write_b128 v4, v[60:63] offset:7168
    s_waitcnt lgkmcnt(0)
    ds_write_b128 v4, v[64:67] offset:8192
    ds_write_b128 v4, v[68:71] offset:9216
    ds_write_b128 v4, v[72:75] offset:10240
    ds_write_b128 v4, v[76:79] offset:11264
    ds_write_b128 v4, v[80:83] offset:12288
    ds_write_b128 v4, v[84:87] offset:13312
    ds_write_b128 v4, v[88:91] offset:14336
    ds_write_b128 v4, v[92:95] offset:15360
    s_waitcnt lgkmcnt(0)
    ds_write_b128 v4, v[96:99] offset:16384
    ds_write_b128 v4, v[100:103] offset:17408
    ds_write_b128 v4, v[104:107] offset:18432
    ds_write_b128 v4, v[108:111] offset:19456
    ds_write_b128 v4, v[112:115] offset:20480
    ds_write_b128 v4, v[116:119] offset:21504
    ds_write_b128 v4, v[120:123] offset:22528
    ds_write_b128 v4, v[124:127] offset:23552
    s_waitcnt lgkmcnt(0)
    s_waitcnt lgkmcnt(0)
    s_cmp_lg_u32 s41, 0
    s_cbranch_scc1 L_slow_start
L_fast_start:
    s_mov_b32 s22, 0
    s_mov_b32 s23, 0x1000000
    s_mov_b32 s27, 0
    s_mov_b32 s31, 0x80000
    s_mov_b32 s61, 0x40000000
    s_mov_b32 s96, 0x800
    s_mov_b32 s97, 0x1000
    s_mov_b32 s98, 0x1800
    s_mov_b32 s92, 0xcccccccc
    s_mov_b32 s93, 0xcccccccc
    s_mov_b32 s91, 0
    ds_read_b128 v[104:107], v4 offset:0
    ds_read_b128 v[108:111], v4 offset:1024
    ds_read_b128 v[112:115], v4 offset:2048
    ds_read_b128 v[116:119], v4 offset:3072
    ds_read_b128 v[88:91], v4 offset:4096
    ds_read_b128 v[92:95], v4 offset:5120
    ds_read_b128 v[96:99], v4 offset:6144
    ds_read_b128 v[100:103], v4 offset:7168
    ds_read_b128 v[72:75], v4 offset:8192
    ds_read_b128 v[76:79], v4 offset:9216
    ds_read_b128 v[80:83], v4 offset:10240
    ds_read_b128 v[84:87], v4 offset:11264
    v_mov_b64 v[48:49], 0
    v_mov_b64 v[50:51], 0
    v_mov_b64 v[52:53], 0
    v_mov_b64 v[54:55], 0
    v_mov_b64 v[56:57], 0
    v_mov_b64 v[58:59], 0
    v_mov_b64 v[60:61], 0
    v_mov_b64 v[62:63], 0
    v_mov_b64 v[64:65], 0
    v_mov_b64 v[66:67], 0
    v_mov_b64 v[68:69], 0
    v_mov_b64 v[70:71], 0
    s_add_u32 s7, s23, 0x80000
    buffer_load_dwordx4 v[16:19], v2, s[8:11], s7 offen sc1
    buffer_load_dwordx4 v[20:23], v2, s[8:11], s7 offen offset:1024 sc1
    s_waitcnt vmcnt(2)
L_fast_step:
    v_readlane_b32 s36, v15, 33
    s_add_u32 s24, s23, 0x82100
    s_cmp_eq_u32 s36, 0
    s_cbranch_scc1 L_fast_refresh
L_fast_fresh:
    s_add_u32 s29, s23, s25
    s_add_u32 s30, s23, s39
    s_xor_b32 s28, s27, 1
    s_add_u32 s90, s22, 1
    s_nop 15
L_fast_retrym:
    buffer_load_dwordx4 v[16:19], v2, s[8:11], s7 offen sc1
    buffer_load_dwordx4 v[20:23], v2, s[8:11], s7 offen offset:1024 sc1
L_fast_prem:
    s_add_u32 s32, s32, 1
    s_cmp_gt_u32 s32, 200000
    s_cselect_b32 s94, -1, -2
    v_xor_b32 v28, 0x800, v2
    v_xor_b32 v44, 0x1800, v2
    v_mov_b64 v[48:49], 0
    v_mov_b64 v[50:51], 0
    v_mov_b64 v[52:53], 0
    v_mov_b64 v[54:55], 0
L_fast_waitm:
    s_waitcnt vmcnt(3) lgkmcnt(0)
L_fast_gotm:
    v_max3_u32 v14, v16, v17, v18
    v_max_u32 v14, v14, v19
    v_smfmac_f32_16x16x64_bf16 v[48:51], v[16:19], v[104:111], v1
    s_waitcnt vmcnt(2)
    v_max3_u32 v14, v14, v20, v21
    v_smfmac_f32_16x16x64_bf16 v[52:55], v[16:19], v[112:119], v1
    v_max3_u32 v14, v14, v22, v23
    v_cmp_lt_u32 vcc, s94, v14
    v_smfmac_f32_16x16x64_bf16 v[48:51], v[20:23], v[88:95], v1
    ds_write_b128 v2, v[16:19] offset:0
    s_cbranch_vccnz L_fast_retrym
    v_smfmac_f32_16x16x64_bf16 v[52:55], v[20:23], v[96:103], v1
    ds_write_b128 v2, v[20:23] offset:1024
    v_smfmac_f32_16x16x64_bf16 v[56:59], v[16:19], v[72:79], v1
    buffer_load_dwordx4 v[104:107], v3, s[8:11], s29 offen offset:0 sc1
    buffer_load_dwordx4 v[120:123], v3, s[8:11], s30 offen offset:0 sc1
    v_smfmac_f32_16x16x64_bf16 v[60:63], v[16:19], v[80:87], v1
    buffer_load_dwordx4 v[108:111], v3, s[8:11], s29 offen offset:1024 sc1
    buffer_load_dwordx4 v[124:127], v3, s[8:11], s30 offen offset:1024 sc1
    v_smfmac_f32_16x16x64_bf16 v[56:59], v[20:23], a[80:87], v1
    buffer_load_dwordx4 v[112:115], v3, s[8:11], s29 offen offset:2048 sc1
    buffer_load_dwordx4 v[116:119], v3, s[8:11], s29 offen offset:3072 sc1
    v_smfmac_f32_16x16x64_bf16 v[60:63], v[20:23], a[88:95], v1
    s_waitcnt lgkmcnt(0)
    s_barrier
    ds_read_b128 v[24:27], v28 offset:0
    v_smfmac_f32_16x16x64_bf16 v[64:67], v[16:19], a[160:167], v1
    ds_read_b128 v[28:31], v28 offset:1024
    v_smfmac_f32_16x16x64_bf16 v[68:71], v[16:19], a[168:175], v1
    buffer_load_dword v15, v0, s[8:11], s24 offen sc1
    v_smfmac_f32_16x16x64_bf16 v[64:67], v[20:23], a[176:183], v1
    ds_read_b128 v[32:35], v8 offset:0
    v_smfmac_f32_16x16x64_bf16 v[68:71], v[20:23], a[184:191], v1
    ds_read_b128 v[36:39], v8 offset:1024
    s_waitcnt lgkmcnt(3)
    v_smfmac_f32_16x16x64_bf16 v[48:51], v[24:27], a[0:7], v1
    ds_read_b128 v[40:43], v44 offset:0
    v_smfmac_f32_16x16x64_bf16 v[52:55], v[24:27], a[8:15], v1
    ds_read_b128 v[44:47], v44 offset:1024
    s_waitcnt lgkmcnt(4)
    v_smfmac_f32_16x16x64_bf16 v[48:51], v[28:31], a[16:23], v1
    ds_read_b128 v[88:91], v4 offset:12288
    v_smfmac_f32_16x16x64_bf16 v[52:55], v[28:31], a[24:31], v1
    ds_read_b128 v[92:95], v4 offset:13312
    s_waitcnt lgkmcnt(4)
    v_smfmac_f32_16x16x64_bf16 v[48:51], v[32:35], a[32:39], v1
    ds_read_b128 v[96:99], v4 offset:14336
    v_smfmac_f32_16x16x64_bf16 v[52:55], v[32:35], a[40:47], v1
    ds_read_b128 v[100:103], v4 offset:15360
    s_waitcnt lgkmcnt(4)
    v_smfmac_f32_16x16x64_bf16 v[48:51], v[36:39], a[48:55], v1
    v_smfmac_f32_16x16x64_bf16 v[52:55], v[36:39], a[56:63], v1
    ds_read_b128 v[72:75], v4 offset:16384
    v_smfmac_f32_16x16x64_bf16 v[48:51], v[40:43], a[64:71], v1
    v_smfmac_f32_16x16x64_bf16 v[52:55], v[40:43], a[72:79], v1
    ds_read_b128 v[76:79], v4 offset:17408
    s_waitcnt lgkmcnt(2)
    v_smfmac_f32_16x16x64_bf16 v[48:51], v[44:47], v[88:95], v1
    ds_read_b128 v[80:83], v4 offset:18432
    v_smfmac_f32_16x16x64_bf16 v[52:55], v[44:47], v[96:103], v1
    ds_read_b128 v[84:87], v4 offset:19456
    v_smfmac_f32_16x16x64_bf16 v[56:59], v[28:31], a[96:103], v1
    ds_read_b128 v[88:91], v4 offset:20480
    v_smfmac_f32_16x16x64_bf16 v[60:63], v[28:31], a[104:111], v1
    ds_read_b128 v[92:95], v4 offset:21504
    v_smfmac_f32_16x16x64_bf16 v[56:59], v[32:35], a[112:119], v1
    ds_read_b128 v[96:99], v4 offset:22528
    v_add_f32 v48, v48, v50
    v_add_f32 v49, v49, v51
    v_smfmac_f32_16x16x64_bf16 v[60:63], v[32:35], a[120:127], v1
    ds_read_b128 v[100:103], v4 offset:23552
    v_add_f32 v52, v52, v54
    v_add_f32 v53, v53, v55
    v_smfmac_f32_16x16x64_bf16 v[56:59], v[36:39], a[128:135], v1
    s_waitcnt lgkmcnt(4)
    v_cvt_pk_bf16_f32 v50, v48, v52
    v_cvt_pk_bf16_f32 v51, v49, v53
    v_smfmac_f32_16x16x64_bf16 v[56:59], v[24:27], v[72:79], v1
    ds_write2_b32 v5, v50, v51 offset0:0 offset1:72
    v_smfmac_f32_16x16x64_bf16 v[60:63], v[24:27], v[80:87], v1
    v_smfmac_f32_16x16x64_bf16 v[60:63], v[36:39], a[136:143], v1
    v_smfmac_f32_16x16x64_bf16 v[56:59], v[40:43], a[144:151], v1
    buffer_store_dword v12, v10, s[8:11], s31 offen sc1
    v_smfmac_f32_16x16x64_bf16 v[60:63], v[40:43], a[152:159], v1
    s_waitcnt lgkmcnt(0)
    s_barrier
    v_smfmac_f32_16x16x64_bf16 v[56:59], v[44:47], v[88:95], v1
    ds_read_b128 v[72:75], v6 offset:0
    v_smfmac_f32_16x16x64_bf16 v[60:63], v[44:47], v[96:103], v1
    ds_read_b128 v[76:79], v6 offset:64
    v_smfmac_f32_16x16x64_bf16 v[64:67], v[24:27], a[192:199], v1
    ds_read_b128 v[80:83], v6 offset:128
    v_smfmac_f32_16x16x64_bf16 v[68:71], v[24:27], a[200:207], v1
    ds_read_b128 v[84:87], v6 offset:192
    s_waitcnt vmcnt(2) lgkmcnt(3)
    v_mfma_f32_16x16x32_bf16 v[48:51], v[104:107], v[72:75], 0
    s_waitcnt lgkmcnt(2)
    v_add_f32 v56, v56, v58
    v_add_f32 v57, v57, v59
    v_mfma_f32_16x16x32_bf16 v[48:51], v[108:111], v[76:79], v[48:51]
    s_waitcnt lgkmcnt(1)
    v_add_f32 v60, v60, v62
    v_add_f32 v61, v61, v63
    v_mfma_f32_16x16x32_bf16 v[48:51], v[112:115], v[80:83], v[48:51]
    s_waitcnt lgkmcnt(0)
    v_cvt_pk_bf16_f32 v58, v56, v60
    v_cvt_pk_bf16_f32 v59, v57, v61
    v_mfma_f32_16x16x32_bf16 v[48:51], v[116:119], v[84:87], v[48:51]
    ds_write2_b32 v7, v58, v59 offset0:0 offset1:72
    v_smfmac_f32_16x16x64_bf16 v[64:67], v[28:31], a[208:215], v1
    v_mov_b64 v[104:105], s[4:5]
    v_smfmac_f32_16x16x64_bf16 v[68:71], v[28:31], a[216:223], v1
    s_nop 1
    v_mov_b64 v[106:107], s[4:5]
    v_smfmac_f32_16x16x64_bf16 v[64:67], v[32:35], a[224:231], v1
    v_exp_f32 v48, v48
    v_smfmac_f32_16x16x64_bf16 v[68:71], v[32:35], a[232:239], v1
    s_waitcnt lgkmcnt(0)
    s_barrier
    v_exp_f32 v49, v49
    v_smfmac_f32_16x16x64_bf16 v[64:67], v[36:39], a[240:247], v1
    ds_read_b128 v[88:91], v6 offset:2304
    v_exp_f32 v50, v50
    v_smfmac_f32_16x16x64_bf16 v[68:71], v[36:39], a[248:255], v1
    ds_read_b128 v[92:95], v6 offset:2368
    v_exp_f32 v51, v51
    v_smfmac_f32_16x16x64_bf16 v[64:67], v[40:43], v[128:135], v1
    ds_read_b128 v[96:99], v6 offset:2432
    v_cvt_pk_bf16_f32 v108, v48, v49
    v_cvt_pk_bf16_f32 v109, v50, v51
    v_smfmac_f32_16x16x64_bf16 v[68:71], v[40:43], v[136:143], v1
    ds_read_b128 v[100:103], v6 offset:2496
    ds_write_b64 v2, v[108:109] offset:8192
    s_waitcnt lgkmcnt(4)
    v_mfma_f32_16x16x32_bf16 v[52:55], v[88:91], v[72:75], 0
    s_waitcnt lgkmcnt(3)
    v_mov_b32 v113, 0
    v_mov_b32 v115, 0
    v_mfma_f32_16x16x32_bf16 v[52:55], v[92:95], v[76:79], v[52:55]
    s_waitcnt lgkmcnt(2)
    v_mov_b32 v117, 0
    v_mov_b64 v[16:17], 0
    v_mfma_f32_16x16x32_bf16 v[52:55], v[96:99], v[80:83], v[52:55]
    s_waitcnt lgkmcnt(1)
    v_mov_b64 v[18:19], 0
    v_mov_b64 v[20:21], 0
    v_mfma_f32_16x16x32_bf16 v[52:55], v[100:103], v[84:87], v[52:55]
    s_waitcnt lgkmcnt(0)
    s_barrier
    v_smfmac_f32_16x16x64_bf16 v[64:67], v[44:47], v[144:151], v1
    ds_read_b64 v[110:111], v8 offset:8192
    v_mov_b64 v[22:23], 0
    v_smfmac_f32_16x16x64_bf16 v[68:71], v[44:47], v[152:159], v1
    v_mov_b64 v[24:25], 0
    v_mov_b64 v[26:27], 0
    v_mul_f32 v52, s33, v52
    v_mul_f32 v53, s33, v53
    v_exp_f32 v52, v52
    s_waitcnt lgkmcnt(0)
    v_mfma_f32_16x16x32_bf16 v[48:51], v[104:107], v[108:111], 0
    v_exp_f32 v53, v53
    v_add_f32 v64, v64, v66
    v_mfma_f32_16x16x32_bf16 v[56:59], v[120:123], v[108:111], 0
    v_cvt_pk_bf16_f32 v112, v52, v53
    v_add_f32 v65, v65, v67
    v_mfma_f32_16x16x32_bf16 v[60:63], v[124:127], v[108:111], 0
    v_cvt_pk_bf16_f32 v114, v64, v65
    v_add_f32 v68, v68, v70
    v_mfma_f32_16x16x16_bf16 v[48:51], v[104:105], v[112:113], v[48:51]
    v_add_f32 v69, v69, v71
    v_cvt_pk_bf16_f32 v116, v68, v69
    v_mfma_f32_16x16x16_bf16 v[56:59], v[114:115], v[112:113], v[56:59]
    v_mov_b64 v[28:29], 0
    v_mov_b64 v[30:31], 0
    v_mfma_f32_16x16x16_bf16 v[60:63], v[116:117], v[112:113], v[60:63]
    v_bitop3_b32 v32, v13, s96, -9 bitop3:0x28
    v_bitop3_b32 v36, v13, s97, -9 bitop3:0x28
    v_rcp_f32 v118, v48
    v_bitop3_b32 v40, v13, s98, -9 bitop3:0x28
    v_max_f32 v14, v118, v48
    v_cmp_nge_f32 vcc, s40, v14
    v_pk_mul_f32 v[56:57], v[56:57], v[118:119] op_sel_hi:[1,0]
    v_pk_mul_f32 v[58:59], v[58:59], v[118:119] op_sel_hi:[1,0]
    v_pk_mul_f32 v[60:61], v[60:61], v[118:119] op_sel_hi:[1,0]
    v_pk_mul_f32 v[62:63], v[62:63], v[118:119] op_sel_hi:[1,0]
    v_cvt_pk_bf16_f32 v52, v56, v60
    v_cvt_pk_bf16_f32 v54, v58, v62
    v_cvt_pk_bf16_f32 v53, v57, v61
    v_cvt_pk_bf16_f32 v55, v59, v63
L_fast_rejoin:
    v_cndmask_b32 v50, v52, v54, s[92:93]
    v_cndmask_b32 v51, v53, v55, s[92:93]
    ds_write_b64 v13, v[50:51] offset:9216
    v_smfmac_f32_16x16x64_bf16 v[16:19], v[52:55], v[160:167], v1
    v_smfmac_f32_16x16x64_bf16 v[20:23], v[52:55], v[168:175], v1
    s_waitcnt lgkmcnt(0)
    s_barrier
    ds_read_b128 v[32:35], v32 offset:9216
    ds_read_b128 v[36:39], v36 offset:9216
    v_smfmac_f32_16x16x64_bf16 v[24:27], v[52:55], v[176:183], v1
    ds_read_b128 v[40:43], v40 offset:9216
    v_smfmac_f32_16x16x64_bf16 v[28:31], v[52:55], v[184:191], v1
    ds_read_b128 v[88:91], v4 offset:24576
    ds_read_b128 v[92:95], v4 offset:25600
    s_waitcnt lgkmcnt(4)
    v_smfmac_f32_16x16x64_bf16 v[16:19], v[32:35], v[192:199], v1
    ds_read_b128 v[96:99], v4 offset:26624
    s_waitcnt lgkmcnt(4)
    v_smfmac_f32_16x16x64_bf16 v[16:19], v[36:39], v[216:223], v1
    ds_read_b128 v[100:103], v4 offset:27648
    s_waitcnt lgkmcnt(4)
    v_smfmac_f32_16x16x64_bf16 v[16:19], v[40:43], v[240:247], v1
    ds_read_b128 v[72:75], v4 offset:28672
    s_cmp_lg_u64 vcc, 0
    v_smfmac_f32_16x16x64_bf16 v[20:23], v[32:35], v[200:207], v1
    ds_read_b128 v[76:79], v4 offset:29696
    s_cselect_b32 s60, s28, s27
    v_smfmac_f32_16x16x64_bf16 v[20:23], v[36:39], v[224:231], v1
    ds_read_b128 v[80:83], v4 offset:30720
    s_nop 0
    v_cvt_pk_bf16_f32 v56, v16, v18
    v_smfmac_f32_16x16x64_bf16 v[20:23], v[40:43], v[248:255], v1
    ds_read_b128 v[84:87], v4 offset:31744
    v_cvt_pk_bf16_f32 v57, v17, v19
    v_and_or_b32 v56, v56, -2, s60
    v_smfmac_f32_16x16x64_bf16 v[24:27], v[32:35], v[208:215], v1
    buffer_store_dwordx2 v[56:57], v9, s[8:11], 0 offen offset:0
    v_smfmac_f32_16x16x64_bf16 v[24:27], v[36:39], v[232:239], v1
    s_waitcnt lgkmcnt(4)
    s_nop 0
    v_cvt_pk_bf16_f32 v58, v20, v22
    v_smfmac_f32_16x16x64_bf16 v[24:27], v[40:43], v[88:95], v1
    ds_read_b128 v[64:67], v3 offset:23040
    v_cvt_pk_bf16_f32 v59, v21, v23
    v_and_or_b32 v58, v58, -2, s60
    v_smfmac_f32_16x16x64_bf16 v[28:31], v[32:35], v[96:103], v1
    buffer_store_dwordx2 v[58:59], v9, s[8:11], 0 offen offset:2048
    s_waitcnt lgkmcnt(1)
    v_smfmac_f32_16x16x64_bf16 v[28:31], v[36:39], v[72:79], v1
    s_nop 1
    v_cvt_pk_bf16_f32 v60, v24, v26
    v_smfmac_f32_16x16x64_bf16 v[28:31], v[40:43], v[80:87], v1
    s_nop 2
    v_cvt_pk_bf16_f32 v61, v25, v27
    v_and_or_b32 v60, v60, -2, s60
    buffer_store_dwordx2 v[60:61], v9, s[8:11], s26 offen offset:0
    s_nop 1
    v_cvt_pk_bf16_f32 v62, v28, v30
    v_cvt_pk_bf16_f32 v63, v29, v31
    v_and_or_b32 v62, v62, -2, s60
    buffer_store_dwordx2 v[62:63], v9, s[8:11], s26 offen offset:2048
L_fast_stored:
    s_cmp_lg_u32 s60, s27
    s_cbranch_scc1 L_fast_safe
    ds_read_b128 v[104:107], v4 offset:0
    ds_read_b128 v[108:111], v4 offset:1024
    ds_read_b128 v[112:115], v4 offset:2048
    ds_read_b128 v[116:119], v4 offset:3072
    ds_read_b128 v[88:91], v4 offset:4096
    ds_read_b128 v[92:95], v4 offset:5120
    ds_read_b128 v[96:99], v4 offset:6144
    ds_read_b128 v[100:103], v4 offset:7168
    ds_read_b128 v[72:75], v4 offset:8192
    ds_read_b128 v[76:79], v4 offset:9216
    ds_read_b128 v[80:83], v4 offset:10240
    ds_read_b128 v[84:87], v4 offset:11264
    s_cmp_lt_u32 s21, 1
    s_cbranch_scc1 L_fast_pollp
    s_nop 13
    s_cmp_lt_u32 s21, 2
    s_cbranch_scc1 L_fast_pollp
    s_nop 13
    s_cmp_lt_u32 s21, 3
    s_cbranch_scc1 L_fast_pollp
    s_nop 13
L_fast_pollp:
    buffer_load_dwordx4 v[120:123], v2, s[8:11], s6 offen sc1
    buffer_load_dwordx4 v[124:127], v2, s[8:11], s6 offen offset:1024 sc1
    v_mov_b64 v[56:57], 0
    v_mov_b64 v[58:59], 0
    v_mov_b64 v[60:61], 0
    v_mov_b64 v[62:63], 0
    s_nop 15
    s_nop 15
    buffer_load_dwordx4 v[32:35], v2, s[8:11], s6 offen sc1
    buffer_load_dwordx4 v[36:39], v2, s[8:11], s6 offen offset:1024 sc1
L_fast_prep:
    s_add_u32 s7, s24, 0x80000
    s_waitcnt vmcnt(3) lgkmcnt(0)
    v_mfma_f32_16x16x32_bf16 v[68:71], v[64:67], v[120:123], 0
    v_bitop3_b32 v14, v120, v122, s27 bitop3:0x7e
    s_waitcnt vmcnt(2)
    v_mfma_f32_16x16x32_bf16 v[68:71], v[64:67], v[124:127], v[68:71]
    v_bitop3_b32 v11, v124, v126, s27 bitop3:0x7e
    v_bitop3_b32 v14, v14, v11, 1 bitop3:0xa8
    v_cmp_ne_u32 vcc, 0, v14
    s_nop 2
    s_cmp_eq_u64 vcc, 0
    s_cselect_b32 s36, s24, s61
    v_add_f32_dpp v68, v68, v68 row_ror:8 row_mask:0xf bank_mask:0xf
    v_add_f32_dpp v69, v69, v69 row_ror:8 row_mask:0xf bank_mask:0xf
    s_nop 0
    v_add_f32_dpp v68, v68, v68 row_ror:4 row_mask:0xf bank_mask:0xf
    v_add_f32_dpp v69, v69, v69 row_ror:4 row_mask:0xf bank_mask:0xf
    v_cvt_pk_bf16_f32 v12, v68, v69
    buffer_store_dword v12, v10, s[8:11], s36 offen
    s_cbranch_scc1 L_fast_gotp
L_fast_retryp:
    buffer_load_dwordx4 v[120:123], v2, s[8:11], s6 offen sc1
    buffer_load_dwordx4 v[124:127], v2, s[8:11], s6 offen offset:1024 sc1
    s_waitcnt vmcnt(4) lgkmcnt(0)
    v_mfma_f32_16x16x32_bf16 v[68:71], v[64:67], v[32:35], 0
    v_bitop3_b32 v14, v32, v34, s27 bitop3:0x7e
    s_waitcnt vmcnt(3)
    v_mfma_f32_16x16x32_bf16 v[68:71], v[64:67], v[36:39], v[68:71]
    v_bitop3_b32 v11, v36, v38, s27 bitop3:0x7e
    v_bitop3_b32 v14, v14, v11, 1 bitop3:0xa8
    v_cmp_ne_u32 vcc, 0, v14
    s_nop 2
    s_cmp_eq_u64 vcc, 0
    s_cselect_b32 s36, s24, s61
    v_add_f32_dpp v68, v68, v68 row_ror:8 row_mask:0xf bank_mask:0xf
    v_add_f32_dpp v69, v69, v69 row_ror:8 row_mask:0xf bank_mask:0xf
    s_nop 0
    v_add_f32_dpp v68, v68, v68 row_ror:4 row_mask:0xf bank_mask:0xf
    v_add_f32_dpp v69, v69, v69 row_ror:4 row_mask:0xf bank_mask:0xf
    v_cvt_pk_bf16_f32 v12, v68, v69
    buffer_store_dword v12, v10, s[8:11], s36 offen
    s_cbranch_scc1 L_fast_gotp
    buffer_load_dwordx4 v[32:35], v2, s[8:11], s6 offen sc1
    buffer_load_dwordx4 v[36:39], v2, s[8:11], s6 offen offset:1024 sc1
    s_waitcnt vmcnt(4) lgkmcnt(0)
    v_mfma_f32_16x16x32_bf16 v[68:71], v[64:67], v[120:123], 0
    v_bitop3_b32 v14, v120, v122, s27 bitop3:0x7e
    s_waitcnt vmcnt(3)
    v_mfma_f32_16x16x32_bf16 v[68:71], v[64:67], v[124:127], v[68:71]
    v_bitop3_b32 v11, v124, v126, s27 bitop3:0x7e
    v_bitop3_b32 v14, v14, v11, 1 bitop3:0xa8
    v_cmp_ne_u32 vcc, 0, v14
    s_nop 2
    s_cmp_eq_u64 vcc, 0
    s_cselect_b32 s36, s24, s61
    v_add_f32_dpp v68, v68, v68 row_ror:8 row_mask:0xf bank_mask:0xf
    v_add_f32_dpp v69, v69, v69 row_ror:8 row_mask:0xf bank_mask:0xf
    s_nop 0
    v_add_f32_dpp v68, v68, v68 row_ror:4 row_mask:0xf bank_mask:0xf
    v_add_f32_dpp v69, v69, v69 row_ror:4 row_mask:0xf bank_mask:0xf
    v_cvt_pk_bf16_f32 v12, v68, v69
    buffer_store_dword v12, v10, s[8:11], s36 offen
    s_cbranch_scc1 L_fast_gotp
    s_add_u32 s32, s32, 1
    s_cmp_le_u32 s32, 200000
    s_cbranch_scc1 L_fast_retryp
    s_mov_b32 s36, s24
    buffer_store_dword v12, v10, s[8:11], s36 offen
L_fast_gotp:
    s_add_u32 s31, s31, 0x2000
    s_cmp_ge_u32 s90, 63
    s_cbranch_scc1 L_fast_last
    s_mov_b32 s23, s24
    s_mov_b32 s22, s90
    s_mov_b32 s27, s28
    v_mov_b64 v[64:65], 0
    v_mov_b64 v[66:67], 0
    v_mov_b64 v[68:69], 0
    v_mov_b64 v[70:71], 0
    s_nop 15
    s_nop 11
    buffer_load_dwordx4 v[16:19], v2, s[8:11], s7 offen sc1
    buffer_load_dwordx4 v[20:23], v2, s[8:11], s7 offen offset:1024 sc1
    s_branch L_fast_step
L_fast_last:
    buffer_store_dword v12, v10, s[8:11], s31 offen sc1
    s_branch L_fast_done
L_fast_refresh:
    buffer_load_dword v15, v0, s[8:11], s23 offen sc1
    s_add_u32 s32, s32, 1
    s_cmp_le_u32 s32, 200000
    s_waitcnt vmcnt(0)
    s_cbranch_scc1 L_fast_step
    s_branch L_fast_fresh
L_fast_safe:
    s_nop 11
    s_waitcnt vmcnt(0) lgkmcnt(0)
    s_barrier
    ds_read_b128 v[72:75], v6 offset:0
    ds_read_b128 v[88:91], v6 offset:2304
    ds_read_b128 v[76:79], v6 offset:64
    ds_read_b128 v[92:95], v6 offset:2368
    ds_read_b128 v[80:83], v6 offset:128
    ds_read_b128 v[96:99], v6 offset:2432
    ds_read_b128 v[84:87], v6 offset:192
    ds_read_b128 v[100:103], v6 offset:2496
    s_xor_b32 s36, s25, 0x1000
    s_add_u32 s36, s36, s23
    buffer_load_dwordx4 v[16:19], v3, s[8:11], s29 offen offset:0 sc1
    buffer_load_dwordx4 v[32:35], v3, s[8:11], s36 offen offset:0 sc1
    buffer_load_dwordx4 v[20:23], v3, s[8:11], s29 offen offset:1024 sc1
    buffer_load_dwordx4 v[36:39], v3, s[8:11], s36 offen offset:1024 sc1
    buffer_load_dwordx4 v[24:27], v3, s[8:11], s29 offen offset:2048 sc1
    buffer_load_dwordx4 v[40:43], v3, s[8:11], s36 offen offset:2048 sc1
    buffer_load_dwordx4 v[28:31], v3, s[8:11], s29 offen offset:3072 sc1
    buffer_load_dwordx4 v[44:47], v3, s[8:11], s36 offen offset:3072 sc1
    s_waitcnt vmcnt(0) lgkmcnt(0)
    v_mfma_f32_16x16x32_bf16 v[48:51], v[16:19], v[72:75], 0
    v_mfma_f32_16x16x32_bf16 v[48:51], v[20:23], v[76:79], v[48:51]
    v_mfma_f32_16x16x32_bf16 v[48:51], v[24:27], v[80:83], v[48:51]
    v_mfma_f32_16x16x32_bf16 v[48:51], v[28:31], v[84:87], v[48:51]
    v_mfma_f32_16x16x32_bf16 v[52:55], v[32:35], v[72:75], 0
    v_mfma_f32_16x16x32_bf16 v[52:55], v[36:39], v[76:79], v[52:55]
    v_mfma_f32_16x16x32_bf16 v[52:55], v[40:43], v[80:83], v[52:55]
    v_mfma_f32_16x16x32_bf16 v[52:55], v[44:47], v[84:87], v[52:55]
    v_mfma_f32_16x16x32_bf16 v[56:59], v[88:91], v[72:75], 0
    v_mfma_f32_16x16x32_bf16 v[56:59], v[92:95], v[76:79], v[56:59]
    v_mfma_f32_16x16x32_bf16 v[56:59], v[96:99], v[80:83], v[56:59]
    v_mfma_f32_16x16x32_bf16 v[56:59], v[100:103], v[84:87], v[56:59]
    s_nop 7
    v_mul_f32 v56, s33, v56
    v_mul_f32 v57, s33, v57
    v_max3_f32 v16, v48, v49, v50
    v_max3_f32 v16, v16, v51, v52
    v_max3_f32 v16, v16, v53, v54
    v_max3_f32 v16, v16, v55, v56
    v_max_f32 v16, v16, v57
    v_mov_b32 v17, v16
    s_nop 1
    v_permlane16_swap_b32 v16, v17
    v_max_f32 v16, v16, v17
    v_mov_b32 v17, v16
    s_nop 1
    v_permlane32_swap_b32 v16, v17
    v_max_f32 v16, v16, v17
    v_sub_f32 v48, v48, v16
    v_exp_f32 v48, v48
    v_sub_f32 v49, v49, v16
    v_exp_f32 v49, v49
    v_sub_f32 v50, v50, v16
    v_exp_f32 v50, v50
    v_sub_f32 v51, v51, v16
    v_exp_f32 v51, v51
    v_sub_f32 v52, v52, v16
    v_exp_f32 v52, v52
    v_sub_f32 v53, v53, v16
    v_exp_f32 v53, v53
    v_sub_f32 v54, v54, v16
    v_exp_f32 v54, v54
    v_sub_f32 v55, v55, v16
    v_exp_f32 v55, v55
    v_sub_f32 v56, v56, v16
    v_exp_f32 v56, v56
    v_sub_f32 v57, v57, v16
    v_exp_f32 v57, v57
    v_cvt_pk_bf16_f32 v108, v48, v49
    v_cvt_pk_bf16_f32 v109, v50, v51
    v_cvt_pk_bf16_f32 v110, v52, v53
    v_cvt_pk_bf16_f32 v111, v54, v55
    v_cvt_pk_bf16_f32 v112, v56, v57
    s_nop 0
    v_mfma_f32_16x16x32_bf16 v[48:51], v[104:107], v[108:111], 0
    v_mfma_f32_16x16x32_bf16 v[56:59], v[120:123], v[108:111], 0
    v_mfma_f32_16x16x32_bf16 v[60:63], v[124:127], v[108:111], 0
    s_nop 3
    v_mfma_f32_16x16x16_bf16 v[48:51], v[104:105], v[112:113], v[48:51]
    v_mfma_f32_16x16x16_bf16 v[56:59], v[114:115], v[112:113], v[56:59]
    v_mfma_f32_16x16x16_bf16 v[60:63], v[116:117], v[112:113], v[60:63]
    s_nop 5
    v_rcp_f32 v118, v48
    s_nop 0
    v_mul_f32 v56, v56, v118
    v_mul_f32 v57, v57, v118
    v_mul_f32 v58, v58, v118
    v_mul_f32 v59, v59, v118
    v_mul_f32 v60, v60, v118
    v_mul_f32 v61, v61, v118
    v_mul_f32 v62, v62, v118
    v_mul_f32 v63, v63, v118
    v_cvt_pk_bf16_f32 v52, v56, v60
    v_cvt_pk_bf16_f32 v53, v57, v61
    v_cvt_pk_bf16_f32 v54, v58, v62
    v_cvt_pk_bf16_f32 v55, v59, v63
    v_mov_b32 v16, 0
    v_mov_b32 v17, 0
    v_mov_b32 v18, 0
    v_mov_b32 v19, 0
    v_mov_b32 v20, 0
    v_mov_b32 v21, 0
    v_mov_b32 v22, 0
    v_mov_b32 v23, 0
    v_mov_b32 v24, 0
    v_mov_b32 v25, 0
    v_mov_b32 v26, 0
    v_mov_b32 v27, 0
    v_mov_b32 v28, 0
    v_mov_b32 v29, 0
    v_mov_b32 v30, 0
    v_mov_b32 v31, 0
    v_bitop3_b32 v32, v13, s96, -9 bitop3:0x28
    v_bitop3_b32 v36, v13, s97, -9 bitop3:0x28
    v_bitop3_b32 v40, v13, s98, -9 bitop3:0x28
    s_mov_b64 vcc, 0
    s_branch L_fast_rejoin
L_fast_done:
    s_branch L_end
L_slow_start:
    s_mov_b32 s22, 0
    s_mov_b32 s23, 0x1000000
    s_mov_b32 s27, 0
    s_mov_b32 s31, 0x80000
    s_mov_b32 s61, 0x40000000
    s_mov_b32 s96, 0x800
    s_mov_b32 s97, 0x1000
    s_mov_b32 s98, 0x1800
    s_mov_b32 s92, 0xcccccccc
    s_mov_b32 s93, 0xcccccccc
    s_mov_b32 s91, 0
    ds_read_b128 v[104:107], v4 offset:0
    ds_read_b128 v[108:111], v4 offset:1024
    ds_read_b128 v[112:115], v4 offset:2048
    ds_read_b128 v[116:119], v4 offset:3072
    ds_read_b128 v[88:91], v4 offset:4096
    ds_read_b128 v[92:95], v4 offset:5120
    ds_read_b128 v[96:99], v4 offset:6144
    ds_read_b128 v[100:103], v4 offset:7168
    ds_read_b128 v[72:75], v4 offset:8192
    ds_read_b128 v[76:79], v4 offset:9216
    ds_read_b128 v[80:83], v4 offset:10240
    ds_read_b128 v[84:87], v4 offset:11264
    v_mov_b64 v[48:49], 0
    v_mov_b64 v[50:51], 0
    v_mov_b64 v[52:53], 0
    v_mov_b64 v[54:55], 0
    v_mov_b64 v[56:57], 0
    v_mov_b64 v[58:59], 0
    v_mov_b64 v[60:61], 0
    v_mov_b64 v[62:63], 0
    v_mov_b64 v[64:65], 0
    v_mov_b64 v[66:67], 0
    v_mov_b64 v[68:69], 0
    v_mov_b64 v[70:71], 0
    s_add_u32 s7, s23, 0x80000
    buffer_load_dwordx4 v[16:19], v2, s[8:11], s7 offen sc1
    buffer_load_dwordx4 v[20:23], v2, s[8:11], s7 offen offset:1024 sc1
    s_waitcnt vmcnt(2)
L_slow_step:
    v_readlane_b32 s36, v15, 33
    s_add_u32 s24, s23, 0x82100
    s_cmp_eq_u32 s36, 0
    s_cbranch_scc1 L_slow_refresh
L_slow_fresh:
    s_add_u32 s29, s23, s25
    s_add_u32 s30, s23, s39
    s_xor_b32 s28, s27, 1
    s_add_u32 s90, s22, 1
    s_nop 15
L_slow_retrym:
    buffer_load_dwordx4 v[16:19], v2, s[8:11], s7 offen sc1
    buffer_load_dwordx4 v[20:23], v2, s[8:11], s7 offen offset:1024 sc1
L_slow_prem:
    s_add_u32 s32, s32, 1
    s_cmp_gt_u32 s32, 200000
    s_cselect_b32 s94, -1, -2
    v_xor_b32 v28, 0x800, v2
    v_xor_b32 v44, 0x1800, v2
    v_mov_b64 v[48:49], 0
    v_mov_b64 v[50:51], 0
    v_mov_b64 v[52:53], 0
    v_mov_b64 v[54:55], 0
L_slow_waitm:
    s_waitcnt vmcnt(3) lgkmcnt(0)
L_slow_gotm:
    v_max3_u32 v14, v16, v17, v18
    v_max_u32 v14, v14, v19
    v_smfmac_f32_16x16x64_bf16 v[48:51], v[16:19], v[104:111], v1
    s_waitcnt vmcnt(2)
    v_max3_u32 v14, v14, v20, v21
    v_smfmac_f32_16x16x64_bf16 v[52:55], v[16:19], v[112:119], v1
    v_max3_u32 v14, v14, v22, v23
    v_cmp_lt_u32 vcc, s94, v14
    v_smfmac_f32_16x16x64_bf16 v[48:51], v[20:23], v[88:95], v1
    ds_write_b128 v2, v[16:19] offset:0
    s_cbranch_vccnz L_slow_retrym
    v_smfmac_f32_16x16x64_bf16 v[52:55], v[20:23], v[96:103], v1
    ds_write_b128 v2, v[20:23] offset:1024
    v_smfmac_f32_16x16x64_bf16 v[56:59], v[16:19], v[72:79], v1
    buffer_load_dwordx4 v[104:107], v3, s[8:11], s29 offen offset:0 sc1
    buffer_load_dwordx4 v[120:123], v3, s[8:11], s30 offen offset:0 sc1
    v_smfmac_f32_16x16x64_bf16 v[60:63], v[16:19], v[80:87], v1
    buffer_load_dwordx4 v[108:111], v3, s[8:11], s29 offen offset:1024 sc1
    buffer_load_dwordx4 v[124:127], v3, s[8:11], s30 offen offset:1024 sc1
    v_smfmac_f32_16x16x64_bf16 v[56:59], v[20:23], a[80:87], v1
    buffer_load_dwordx4 v[112:115], v3, s[8:11], s29 offen offset:2048 sc1
    buffer_load_dwordx4 v[116:119], v3, s[8:11], s29 offen offset:3072 sc1
    v_smfmac_f32_16x16x64_bf16 v[60:63], v[20:23], a[88:95], v1
    s_waitcnt lgkmcnt(0)
    s_barrier
    ds_read_b128 v[24:27], v28 offset:0
    v_smfmac_f32_16x16x64_bf16 v[64:67], v[16:19], a[160:167], v1
    ds_read_b128 v[28:31], v28 offset:1024
    v_smfmac_f32_16x16x64_bf16 v[68:71], v[16:19], a[168:175], v1
    buffer_load_dword v15, v0, s[8:11], s24 offen sc1
    v_smfmac_f32_16x16x64_bf16 v[64:67], v[20:23], a[176:183], v1
    ds_read_b128 v[32:35], v8 offset:0
    v_smfmac_f32_16x16x64_bf16 v[68:71], v[20:23], a[184:191], v1
    ds_read_b128 v[36:39], v8 offset:1024
    s_waitcnt lgkmcnt(3)
    v_smfmac_f32_16x16x64_bf16 v[48:51], v[24:27], a[0:7], v1
    ds_read_b128 v[40:43], v44 offset:0
    v_smfmac_f32_16x16x64_bf16 v[52:55], v[24:27], a[8:15], v1
    ds_read_b128 v[44:47], v44 offset:1024
    s_waitcnt lgkmcnt(4)
    v_smfmac_f32_16x16x64_bf16 v[48:51], v[28:31], a[16:23], v1
    ds_read_b128 v[88:91], v4 offset:12288
    v_smfmac_f32_16x16x64_bf16 v[52:55], v[28:31], a[24:31], v1
    ds_read_b128 v[92:95], v4 offset:13312
    s_waitcnt lgkmcnt(4)
    v_smfmac_f32_16x16x64_bf16 v[48:51], v[32:35], a[32:39], v1
    ds_read_b128 v[96:99], v4 offset:14336
    v_smfmac_f32_16x16x64_bf16 v[52:55], v[32:35], a[40:47], v1
    ds_read_b128 v[100:103], v4 offset:15360
    s_waitcnt lgkmcnt(4)
    v_smfmac_f32_16x16x64_bf16 v[48:51], v[36:39], a[48:55], v1
    v_smfmac_f32_16x16x64_bf16 v[52:55], v[36:39], a[56:63], v1
    ds_read_b128 v[72:75], v4 offset:16384
    v_smfmac_f32_16x16x64_bf16 v[48:51], v[40:43], a[64:71], v1
    v_smfmac_f32_16x16x64_bf16 v[52:55], v[40:43], a[72:79], v1
    ds_read_b128 v[76:79], v4 offset:17408
    s_waitcnt lgkmcnt(2)
    v_smfmac_f32_16x16x64_bf16 v[48:51], v[44:47], v[88:95], v1
    ds_read_b128 v[80:83], v4 offset:18432
    v_smfmac_f32_16x16x64_bf16 v[52:55], v[44:47], v[96:103], v1
    ds_read_b128 v[84:87], v4 offset:19456
    v_smfmac_f32_16x16x64_bf16 v[56:59], v[28:31], a[96:103], v1
    ds_read_b128 v[88:91], v4 offset:20480
    v_smfmac_f32_16x16x64_bf16 v[60:63], v[28:31], a[104:111], v1
    ds_read_b128 v[92:95], v4 offset:21504
    v_smfmac_f32_16x16x64_bf16 v[56:59], v[32:35], a[112:119], v1
    ds_read_b128 v[96:99], v4 offset:22528
    v_add_f32 v48, v48, v50
    v_add_f32 v49, v49, v51
    v_smfmac_f32_16x16x64_bf16 v[60:63], v[32:35], a[120:127], v1
    ds_read_b128 v[100:103], v4 offset:23552
    v_add_f32 v52, v52, v54
    v_add_f32 v53, v53, v55
    v_smfmac_f32_16x16x64_bf16 v[56:59], v[36:39], a[128:135], v1
    s_waitcnt lgkmcnt(4)
    v_cvt_pk_bf16_f32 v50, v48, v52
    v_cvt_pk_bf16_f32 v51, v49, v53
    v_smfmac_f32_16x16x64_bf16 v[56:59], v[24:27], v[72:79], v1
    ds_write2_b32 v5, v50, v51 offset0:0 offset1:72
    v_smfmac_f32_16x16x64_bf16 v[60:63], v[24:27], v[80:87], v1
    v_smfmac_f32_16x16x64_bf16 v[60:63], v[36:39], a[136:143], v1
    v_smfmac_f32_16x16x64_bf16 v[56:59], v[40:43], a[144:151], v1
    buffer_store_dword v12, v10, s[8:11], s31 offen sc1
    v_smfmac_f32_16x16x64_bf16 v[60:63], v[40:43], a[152:159], v1
    s_waitcnt lgkmcnt(0)
    s_barrier
    v_smfmac_f32_16x16x64_bf16 v[56:59], v[44:47], v[88:95], v1
    ds_read_b128 v[72:75], v6 offset:0
    v_smfmac_f32_16x16x64_bf16 v[60:63], v[44:47], v[96:103], v1
    ds_read_b128 v[76:79], v6 offset:64
    v_smfmac_f32_16x16x64_bf16 v[64:67], v[24:27], a[192:199], v1
    ds_read_b128 v[80:83], v6 offset:128
    v_smfmac_f32_16x16x64_bf16 v[68:71], v[24:27], a[200:207], v1
    ds_read_b128 v[84:87], v6 offset:192
    s_waitcnt vmcnt(2) lgkmcnt(3)
    v_mfma_f32_16x16x32_bf16 v[48:51], v[104:107], v[72:75], 0
    s_waitcnt lgkmcnt(2)
    v_add_f32 v56, v56, v58
    v_add_f32 v57, v57, v59
    v_mfma_f32_16x16x32_bf16 v[48:51], v[108:111], v[76:79], v[48:51]
    s_waitcnt lgkmcnt(1)
    v_add_f32 v60, v60, v62
    v_add_f32 v61, v61, v63
    v_mfma_f32_16x16x32_bf16 v[48:51], v[112:115], v[80:83], v[48:51]
    s_waitcnt lgkmcnt(0)
    v_cvt_pk_bf16_f32 v58, v56, v60
    v_cvt_pk_bf16_f32 v59, v57, v61
    v_mfma_f32_16x16x32_bf16 v[48:51], v[116:119], v[84:87], v[48:51]
    ds_write2_b32 v7, v58, v59 offset0:0 offset1:72
    v_smfmac_f32_16x16x64_bf16 v[64:67], v[28:31], a[208:215], v1
    v_mov_b64 v[104:105], s[4:5]
    v_smfmac_f32_16x16x64_bf16 v[68:71], v[28:31], a[216:223], v1
    s_nop 1
    v_mov_b64 v[106:107], s[4:5]
    v_smfmac_f32_16x16x64_bf16 v[64:67], v[32:35], a[224:231], v1
    v_exp_f32 v48, v48
    v_smfmac_f32_16x16x64_bf16 v[68:71], v[32:35], a[232:239], v1
    s_waitcnt lgkmcnt(0)
    s_barrier
    v_exp_f32 v49, v49
    v_smfmac_f32_16x16x64_bf16 v[64:67], v[36:39], a[240:247], v1
    ds_read_b128 v[88:91], v6 offset:2304
    v_exp_f32 v50, v50
    v_smfmac_f32_16x16x64_bf16 v[68:71], v[36:39], a[248:255], v1
    ds_read_b128 v[92:95], v6 offset:2368
    v_exp_f32 v51, v51
    v_smfmac_f32_16x16x64_bf16 v[64:67], v[40:43], v[128:135], v1
    ds_read_b128 v[96:99], v6 offset:2432
    v_cvt_pk_bf16_f32 v108, v48, v49
    v_cvt_pk_bf16_f32 v109, v50, v51
    v_smfmac_f32_16x16x64_bf16 v[68:71], v[40:43], v[136:143], v1
    ds_read_b128 v[100:103], v6 offset:2496
    ds_write_b64 v2, v[108:109] offset:8192
    s_waitcnt lgkmcnt(4)
    v_mfma_f32_16x16x32_bf16 v[52:55], v[88:91], v[72:75], 0
    s_waitcnt lgkmcnt(3)
    v_mov_b32 v113, 0
    v_mov_b32 v115, 0
    v_mfma_f32_16x16x32_bf16 v[52:55], v[92:95], v[76:79], v[52:55]
    s_waitcnt lgkmcnt(2)
    v_mov_b32 v117, 0
    v_mov_b64 v[16:17], 0
    v_mfma_f32_16x16x32_bf16 v[52:55], v[96:99], v[80:83], v[52:55]
    s_waitcnt lgkmcnt(1)
    v_mov_b64 v[18:19], 0
    v_mov_b64 v[20:21], 0
    v_mfma_f32_16x16x32_bf16 v[52:55], v[100:103], v[84:87], v[52:55]
    s_waitcnt lgkmcnt(0)
    s_barrier
    v_smfmac_f32_16x16x64_bf16 v[64:67], v[44:47], v[144:151], v1
    ds_read_b64 v[110:111], v8 offset:8192
    v_mov_b64 v[22:23], 0
    v_smfmac_f32_16x16x64_bf16 v[68:71], v[44:47], v[152:159], v1
    v_mov_b64 v[24:25], 0
    v_mov_b64 v[26:27], 0
    v_mul_f32 v52, s33, v52
    v_mul_f32 v53, s33, v53
    v_exp_f32 v52, v52
    s_waitcnt lgkmcnt(0)
    v_mfma_f32_16x16x32_bf16 v[48:51], v[104:107], v[108:111], 0
    v_exp_f32 v53, v53
    v_add_f32 v64, v64, v66
    v_mfma_f32_16x16x32_bf16 v[56:59], v[120:123], v[108:111], 0
    v_cvt_pk_bf16_f32 v112, v52, v53
    v_add_f32 v65, v65, v67
    v_mfma_f32_16x16x32_bf16 v[60:63], v[124:127], v[108:111], 0
    v_cvt_pk_bf16_f32 v114, v64, v65
    v_add_f32 v68, v68, v70
    v_mfma_f32_16x16x16_bf16 v[48:51], v[104:105], v[112:113], v[48:51]
    v_add_f32 v69, v69, v71
    v_cvt_pk_bf16_f32 v116, v68, v69
    v_mfma_f32_16x16x16_bf16 v[56:59], v[114:115], v[112:113], v[56:59]
    v_mov_b64 v[28:29], 0
    v_mov_b64 v[30:31], 0
    v_mfma_f32_16x16x16_bf16 v[60:63], v[116:117], v[112:113], v[60:63]
    v_bitop3_b32 v32, v13, s96, -9 bitop3:0x28
    v_bitop3_b32 v36, v13, s97, -9 bitop3:0x28
    v_rcp_f32 v118, v48
    v_bitop3_b32 v40, v13, s98, -9 bitop3:0x28
    v_max_f32 v14, v118, v48
    v_cmp_nge_f32 vcc, s40, v14
    v_pk_mul_f32 v[56:57], v[56:57], v[118:119] op_sel_hi:[1,0]
    v_pk_mul_f32 v[58:59], v[58:59], v[118:119] op_sel_hi:[1,0]
    v_pk_mul_f32 v[60:61], v[60:61], v[118:119] op_sel_hi:[1,0]
    v_pk_mul_f32 v[62:63], v[62:63], v[118:119] op_sel_hi:[1,0]
    v_cvt_pk_bf16_f32 v52, v56, v60
    v_cvt_pk_bf16_f32 v54, v58, v62
    v_cvt_pk_bf16_f32 v53, v57, v61
    v_cvt_pk_bf16_f32 v55, v59, v63
L_slow_rejoin:
    v_cndmask_b32 v50, v52, v54, s[92:93]
    v_cndmask_b32 v51, v53, v55, s[92:93]
    ds_write_b64 v13, v[50:51] offset:9216
    v_smfmac_f32_16x16x64_bf16 v[16:19], v[52:55], v[160:167], v1
    v_smfmac_f32_16x16x64_bf16 v[20:23], v[52:55], v[168:175], v1
    s_waitcnt lgkmcnt(0)
    s_barrier
    ds_read_b128 v[32:35], v32 offset:9216
    ds_read_b128 v[36:39], v36 offset:9216
    v_smfmac_f32_16x16x64_bf16 v[24:27], v[52:55], v[176:183], v1
    ds_read_b128 v[40:43], v40 offset:9216
    v_smfmac_f32_16x16x64_bf16 v[28:31], v[52:55], v[184:191], v1
    ds_read_b128 v[88:91], v4 offset:24576
    ds_read_b128 v[92:95], v4 offset:25600
    s_waitcnt lgkmcnt(4)
    v_smfmac_f32_16x16x64_bf16 v[16:19], v[32:35], v[192:199], v1
    ds_read_b128 v[96:99], v4 offset:26624
    s_waitcnt lgkmcnt(4)
    v_smfmac_f32_16x16x64_bf16 v[16:19], v[36:39], v[216:223], v1
    ds_read_b128 v[100:103], v4 offset:27648
    s_waitcnt lgkmcnt(4)
    v_smfmac_f32_16x16x64_bf16 v[16:19], v[40:43], v[240:247], v1
    ds_read_b128 v[72:75], v4 offset:28672
    s_cmp_lg_u64 vcc, 0
    v_smfmac_f32_16x16x64_bf16 v[20:23], v[32:35], v[200:207], v1
    ds_read_b128 v[76:79], v4 offset:29696
    s_cselect_b32 s60, s28, s27
    v_smfmac_f32_16x16x64_bf16 v[20:23], v[36:39], v[224:231], v1
    ds_read_b128 v[80:83], v4 offset:30720
    s_nop 0
    v_cvt_pk_bf16_f32 v56, v16, v18
    v_smfmac_f32_16x16x64_bf16 v[20:23], v[40:43], v[248:255], v1
    ds_read_b128 v[84:87], v4 offset:31744
    v_cvt_pk_bf16_f32 v57, v17, v19
    v_and_or_b32 v56, v56, -2, s60
    v_smfmac_f32_16x16x64_bf16 v[24:27], v[32:35], v[208:215], v1
    buffer_store_dwordx2 v[56:57], v9, s[8:11], 0 offen offset:0 sc1
    v_smfmac_f32_16x16x64_bf16 v[24:27], v[36:39], v[232:239], v1
    s_waitcnt lgkmcnt(4)
    s_nop 0
    v_cvt_pk_bf16_f32 v58, v20, v22
    v_smfmac_f32_16x16x64_bf16 v[24:27], v[40:43], v[88:95], v1
    ds_read_b128 v[64:67], v3 offset:23040
    v_cvt_pk_bf16_f32 v59, v21, v23
    v_and_or_b32 v58, v58, -2, s60
    v_smfmac_f32_16x16x64_bf16 v[28:31], v[32:35], v[96:103], v1
    buffer_store_dwordx2 v[58:59], v9, s[8:11], 0 offen offset:2048 sc1
    s_waitcnt lgkmcnt(1)
    v_smfmac_f32_16x16x64_bf16 v[28:31], v[36:39], v[72:79], v1
    s_nop 1
    v_cvt_pk_bf16_f32 v60, v24, v26
    v_smfmac_f32_16x16x64_bf16 v[28:31], v[40:43], v[80:87], v1
    s_nop 2
    v_cvt_pk_bf16_f32 v61, v25, v27
    v_and_or_b32 v60, v60, -2, s60
    buffer_store_dwordx2 v[60:61], v9, s[8:11], s26 offen offset:0 sc1
    s_nop 1
    v_cvt_pk_bf16_f32 v62, v28, v30
    v_cvt_pk_bf16_f32 v63, v29, v31
    v_and_or_b32 v62, v62, -2, s60
    buffer_store_dwordx2 v[62:63], v9, s[8:11], s26 offen offset:2048 sc1
L_slow_stored:
    s_cmp_lg_u32 s60, s27
    s_cbranch_scc1 L_slow_safe
    ds_read_b128 v[104:107], v4 offset:0
    ds_read_b128 v[108:111], v4 offset:1024
    ds_read_b128 v[112:115], v4 offset:2048
    ds_read_b128 v[116:119], v4 offset:3072
    ds_read_b128 v[88:91], v4 offset:4096
    ds_read_b128 v[92:95], v4 offset:5120
    ds_read_b128 v[96:99], v4 offset:6144
    ds_read_b128 v[100:103], v4 offset:7168
    ds_read_b128 v[72:75], v4 offset:8192
    ds_read_b128 v[76:79], v4 offset:9216
    ds_read_b128 v[80:83], v4 offset:10240
    ds_read_b128 v[84:87], v4 offset:11264
    s_cmp_lt_u32 s21, 1
    s_cbranch_scc1 L_slow_pollp
    s_nop 13
    s_cmp_lt_u32 s21, 2
    s_cbranch_scc1 L_slow_pollp
    s_nop 13
    s_cmp_lt_u32 s21, 3
    s_cbranch_scc1 L_slow_pollp
    s_nop 13
L_slow_pollp:
    buffer_load_dwordx4 v[120:123], v2, s[8:11], s6 offen sc1
    buffer_load_dwordx4 v[124:127], v2, s[8:11], s6 offen offset:1024 sc1
    v_mov_b64 v[56:57], 0
    v_mov_b64 v[58:59], 0
    v_mov_b64 v[60:61], 0
    v_mov_b64 v[62:63], 0
    s_nop 15
    s_nop 15
    buffer_load_dwordx4 v[32:35], v2, s[8:11], s6 offen sc1
    buffer_load_dwordx4 v[36:39], v2, s[8:11], s6 offen offset:1024 sc1
L_slow_prep:
    s_add_u32 s7, s24, 0x80000
    s_waitcnt vmcnt(3) lgkmcnt(0)
    v_mfma_f32_16x16x32_bf16 v[68:71], v[64:67], v[120:123], 0
    v_bitop3_b32 v14, v120, v122, s27 bitop3:0x7e
    s_waitcnt vmcnt(2)
    v_mfma_f32_16x16x32_bf16 v[68:71], v[64:67], v[124:127], v[68:71]
    v_bitop3_b32 v11, v124, v126, s27 bitop3:0x7e
    v_bitop3_b32 v14, v14, v11, 1 bitop3:0xa8
    v_cmp_ne_u32 vcc, 0, v14
    s_nop 2
    s_cmp_eq_u64 vcc, 0
    s_cselect_b32 s36, s24, s61
    v_add_f32_dpp v68, v68, v68 row_ror:8 row_mask:0xf bank_mask:0xf
    v_add_f32_dpp v69, v69, v69 row_ror:8 row_mask:0xf bank_mask:0xf
    s_nop 0
    v_add_f32_dpp v68, v68, v68 row_ror:4 row_mask:0xf bank_mask:0xf
    v_add_f32_dpp v69, v69, v69 row_ror:4 row_mask:0xf bank_mask:0xf
    v_cvt_pk_bf16_f32 v12, v68, v69
    buffer_store_dword v12, v10, s[8:11], s36 offen sc1
    s_cbranch_scc1 L_slow_gotp
L_slow_retryp:
    buffer_load_dwordx4 v[120:123], v2, s[8:11], s6 offen sc1
    buffer_load_dwordx4 v[124:127], v2, s[8:11], s6 offen offset:1024 sc1
    s_waitcnt vmcnt(4) lgkmcnt(0)
    v_mfma_f32_16x16x32_bf16 v[68:71], v[64:67], v[32:35], 0
    v_bitop3_b32 v14, v32, v34, s27 bitop3:0x7e
    s_waitcnt vmcnt(3)
    v_mfma_f32_16x16x32_bf16 v[68:71], v[64:67], v[36:39], v[68:71]
    v_bitop3_b32 v11, v36, v38, s27 bitop3:0x7e
    v_bitop3_b32 v14, v14, v11, 1 bitop3:0xa8
    v_cmp_ne_u32 vcc, 0, v14
    s_nop 2
    s_cmp_eq_u64 vcc, 0
    s_cselect_b32 s36, s24, s61
    v_add_f32_dpp v68, v68, v68 row_ror:8 row_mask:0xf bank_mask:0xf
    v_add_f32_dpp v69, v69, v69 row_ror:8 row_mask:0xf bank_mask:0xf
    s_nop 0
    v_add_f32_dpp v68, v68, v68 row_ror:4 row_mask:0xf bank_mask:0xf
    v_add_f32_dpp v69, v69, v69 row_ror:4 row_mask:0xf bank_mask:0xf
    v_cvt_pk_bf16_f32 v12, v68, v69
    buffer_store_dword v12, v10, s[8:11], s36 offen sc1
    s_cbranch_scc1 L_slow_gotp
    buffer_load_dwordx4 v[32:35], v2, s[8:11], s6 offen sc1
    buffer_load_dwordx4 v[36:39], v2, s[8:11], s6 offen offset:1024 sc1
    s_waitcnt vmcnt(4) lgkmcnt(0)
    v_mfma_f32_16x16x32_bf16 v[68:71], v[64:67], v[120:123], 0
    v_bitop3_b32 v14, v120, v122, s27 bitop3:0x7e
    s_waitcnt vmcnt(3)
    v_mfma_f32_16x16x32_bf16 v[68:71], v[64:67], v[124:127], v[68:71]
    v_bitop3_b32 v11, v124, v126, s27 bitop3:0x7e
    v_bitop3_b32 v14, v14, v11, 1 bitop3:0xa8
    v_cmp_ne_u32 vcc, 0, v14
    s_nop 2
    s_cmp_eq_u64 vcc, 0
    s_cselect_b32 s36, s24, s61
    v_add_f32_dpp v68, v68, v68 row_ror:8 row_mask:0xf bank_mask:0xf
    v_add_f32_dpp v69, v69, v69 row_ror:8 row_mask:0xf bank_mask:0xf
    s_nop 0
    v_add_f32_dpp v68, v68, v68 row_ror:4 row_mask:0xf bank_mask:0xf
    v_add_f32_dpp v69, v69, v69 row_ror:4 row_mask:0xf bank_mask:0xf
    v_cvt_pk_bf16_f32 v12, v68, v69
    buffer_store_dword v12, v10, s[8:11], s36 offen sc1
    s_cbranch_scc1 L_slow_gotp
    s_add_u32 s32, s32, 1
    s_cmp_le_u32 s32, 200000
    s_cbranch_scc1 L_slow_retryp
    s_mov_b32 s36, s24
    buffer_store_dword v12, v10, s[8:11], s36 offen sc1
L_slow_gotp:
    s_add_u32 s31, s31, 0x2000
    s_cmp_ge_u32 s90, 63
    s_cbranch_scc1 L_slow_last
    s_mov_b32 s23, s24
    s_mov_b32 s22, s90
    s_mov_b32 s27, s28
    v_mov_b64 v[64:65], 0
    v_mov_b64 v[66:67], 0
    v_mov_b64 v[68:69], 0
    v_mov_b64 v[70:71], 0
    s_nop 15
    s_nop 11
    buffer_load_dwordx4 v[16:19], v2, s[8:11], s7 offen sc1
    buffer_load_dwordx4 v[20:23], v2, s[8:11], s7 offen offset:1024 sc1
    s_branch L_slow_step
L_slow_last:
    buffer_store_dword v12, v10, s[8:11], s31 offen sc1
    s_branch L_slow_done
L_slow_refresh:
    buffer_load_dword v15, v0, s[8:11], s23 offen sc1
    s_add_u32 s32, s32, 1
    s_cmp_le_u32 s32, 200000
    s_waitcnt vmcnt(0)
    s_cbranch_scc1 L_slow_step
    s_branch L_slow_fresh
L_slow_safe:
    s_nop 11
    s_waitcnt vmcnt(0) lgkmcnt(0)
    s_barrier
    ds_read_b128 v[72:75], v6 offset:0
    ds_read_b128 v[88:91], v6 offset:2304
    ds_read_b128 v[76:79], v6 offset:64
    ds_read_b128 v[92:95], v6 offset:2368
    ds_read_b128 v[80:83], v6 offset:128
    ds_read_b128 v[96:99], v6 offset:2432
    ds_read_b128 v[84:87], v6 offset:192
    ds_read_b128 v[100:103], v6 offset:2496
    s_xor_b32 s36, s25, 0x1000
    s_add_u32 s36, s36, s23
    buffer_load_dwordx4 v[16:19], v3, s[8:11], s29 offen offset:0 sc1
    buffer_load_dwordx4 v[32:35], v3, s[8:11], s36 offen offset:0 sc1
    buffer_load_dwordx4 v[20:23], v3, s[8:11], s29 offen offset:1024 sc1
    buffer_load_dwordx4 v[36:39], v3, s[8:11], s36 offen offset:1024 sc1
    buffer_load_dwordx4 v[24:27], v3, s[8:11], s29 offen offset:2048 sc1
    buffer_load_dwordx4 v[40:43], v3, s[8:11], s36 offen offset:2048 sc1
    buffer_load_dwordx4 v[28:31], v3, s[8:11], s29 offen offset:3072 sc1
    buffer_load_dwordx4 v[44:47], v3, s[8:11], s36 offen offset:3072 sc1
    s_waitcnt vmcnt(0) lgkmcnt(0)
    v_mfma_f32_16x16x32_bf16 v[48:51], v[16:19], v[72:75], 0
    v_mfma_f32_16x16x32_bf16 v[48:51], v[20:23], v[76:79], v[48:51]
    v_mfma_f32_16x16x32_bf16 v[48:51], v[24:27], v[80:83], v[48:51]
    v_mfma_f32_16x16x32_bf16 v[48:51], v[28:31], v[84:87], v[48:51]
    v_mfma_f32_16x16x32_bf16 v[52:55], v[32:35], v[72:75], 0
    v_mfma_f32_16x16x32_bf16 v[52:55], v[36:39], v[76:79], v[52:55]
    v_mfma_f32_16x16x32_bf16 v[52:55], v[40:43], v[80:83], v[52:55]
    v_mfma_f32_16x16x32_bf16 v[52:55], v[44:47], v[84:87], v[52:55]
    v_mfma_f32_16x16x32_bf16 v[56:59], v[88:91], v[72:75], 0
    v_mfma_f32_16x16x32_bf16 v[56:59], v[92:95], v[76:79], v[56:59]
    v_mfma_f32_16x16x32_bf16 v[56:59], v[96:99], v[80:83], v[56:59]
    v_mfma_f32_16x16x32_bf16 v[56:59], v[100:103], v[84:87], v[56:59]
    s_nop 7
    v_mul_f32 v56, s33, v56
    v_mul_f32 v57, s33, v57
    v_max3_f32 v16, v48, v49, v50
    v_max3_f32 v16, v16, v51, v52
    v_max3_f32 v16, v16, v53, v54
    v_max3_f32 v16, v16, v55, v56
    v_max_f32 v16, v16, v57
    v_mov_b32 v17, v16
    s_nop 1
    v_permlane16_swap_b32 v16, v17
    v_max_f32 v16, v16, v17
    v_mov_b32 v17, v16
    s_nop 1
    v_permlane32_swap_b32 v16, v17
    v_max_f32 v16, v16, v17
    v_sub_f32 v48, v48, v16
    v_exp_f32 v48, v48
    v_sub_f32 v49, v49, v16
    v_exp_f32 v49, v49
    v_sub_f32 v50, v50, v16
    v_exp_f32 v50, v50
    v_sub_f32 v51, v51, v16
    v_exp_f32 v51, v51
    v_sub_f32 v52, v52, v16
    v_exp_f32 v52, v52
    v_sub_f32 v53, v53, v16
    v_exp_f32 v53, v53
    v_sub_f32 v54, v54, v16
    v_exp_f32 v54, v54
    v_sub_f32 v55, v55, v16
    v_exp_f32 v55, v55
    v_sub_f32 v56, v56, v16
    v_exp_f32 v56, v56
    v_sub_f32 v57, v57, v16
    v_exp_f32 v57, v57
    v_cvt_pk_bf16_f32 v108, v48, v49
    v_cvt_pk_bf16_f32 v109, v50, v51
    v_cvt_pk_bf16_f32 v110, v52, v53
    v_cvt_pk_bf16_f32 v111, v54, v55
    v_cvt_pk_bf16_f32 v112, v56, v57
    s_nop 0
    v_mfma_f32_16x16x32_bf16 v[48:51], v[104:107], v[108:111], 0
    v_mfma_f32_16x16x32_bf16 v[56:59], v[120:123], v[108:111], 0
    v_mfma_f32_16x16x32_bf16 v[60:63], v[124:127], v[108:111], 0
    s_nop 3
    v_mfma_f32_16x16x16_bf16 v[48:51], v[104:105], v[112:113], v[48:51]
    v_mfma_f32_16x16x16_bf16 v[56:59], v[114:115], v[112:113], v[56:59]
    v_mfma_f32_16x16x16_bf16 v[60:63], v[116:117], v[112:113], v[60:63]
    s_nop 5
    v_rcp_f32 v118, v48
    s_nop 0
    v_mul_f32 v56, v56, v118
    v_mul_f32 v57, v57, v118
    v_mul_f32 v58, v58, v118
    v_mul_f32 v59, v59, v118
    v_mul_f32 v60, v60, v118
    v_mul_f32 v61, v61, v118
    v_mul_f32 v62, v62, v118
    v_mul_f32 v63, v63, v118
    v_cvt_pk_bf16_f32 v52, v56, v60
    v_cvt_pk_bf16_f32 v53, v57, v61
    v_cvt_pk_bf16_f32 v54, v58, v62
    v_cvt_pk_bf16_f32 v55, v59, v63
    v_mov_b32 v16, 0
    v_mov_b32 v17, 0
    v_mov_b32 v18, 0
    v_mov_b32 v19, 0
    v_mov_b32 v20, 0
    v_mov_b32 v21, 0
    v_mov_b32 v22, 0
    v_mov_b32 v23, 0
    v_mov_b32 v24, 0
    v_mov_b32 v25, 0
    v_mov_b32 v26, 0
    v_mov_b32 v27, 0
    v_mov_b32 v28, 0
    v_mov_b32 v29, 0
    v_mov_b32 v30, 0
    v_mov_b32 v31, 0
    v_bitop3_b32 v32, v13, s96, -9 bitop3:0x28
    v_bitop3_b32 v36, v13, s97, -9 bitop3:0x28
    v_bitop3_b32 v40, v13, s98, -9 bitop3:0x28
    s_mov_b64 vcc, 0
    s_branch L_slow_rejoin
L_slow_done:
    s_branch L_end
L_worker:
    s_cmp_eq_u32 s3, 7
    s_cbranch_scc1 L_mlp
    s_and_b32 s36, s2, 7
    s_sub_u32 s36, s36, 1
    s_lshl_b32 s36, s36, 5
    s_lshr_b32 s37, s2, 3
    s_add_u32 s36, s36, s37
    s_mul_i32 s20, s36, 10923
    s_lshr_b32 s20, s20, 16
    s_mul_i32 s37, s20, 6
    s_sub_u32 s22, s36, s37
    v_lshrrev_b32 v28, 6, v0
    v_bfe_u32 v29, v0, 4, 2
    v_lshl_add_u32 v28, v28, 5, v29
    v_and_b32 v16, 15, v0
    v_lshlrev_b32 v16, 4, v16
    v_lshl_add_u32 v16, v28, 13, v16
    v_bfe_u32 v29, v0, 4, 2
    v_lshlrev_b32 v29, 5, v29
    v_xor_b32 v16, v16, v29
    v_xor_b32 v17, 0, v16
    v_xor_b32 v18, 128, v16
    v_xor_b32 v19, 128, v16
    s_add_u32 s28, s21, 1
    s_lshl_b32 s28, s28, 15
    s_lshl_b32 s3, s20, 8
    s_mov_b32 s76, s52
    s_and_b32 s77, s53, 0xffff
    s_mov_b32 s78, 0x400000
    s_mov_b32 s79, 0x20000
    s_add_u32 m0, s28, 0
    s_add_u32 s37, s3, 0x0
    buffer_load_dwordx4 v16, s[76:79], s37 offen lds
    s_add_u32 m0, s28, 1024
    s_add_u32 s37, s3, 0x8000
    buffer_load_dwordx4 v17, s[76:79], s37 offen lds
    s_add_u32 m0, s28, 2048
    s_add_u32 s37, s3, 0x10000
    buffer_load_dwordx4 v18, s[76:79], s37 offen lds
    s_add_u32 m0, s28, 3072
    s_add_u32 s37, s3, 0x18000
    buffer_load_dwordx4 v19, s[76:79], s37 offen lds
    s_add_u32 m0, s28, 4096
    s_add_u32 s37, s3, 0x20000
    buffer_load_dwordx4 v16, s[76:79], s37 offen lds
    s_add_u32 m0, s28, 5120
    s_add_u32 s37, s3, 0x28000
    buffer_load_dwordx4 v17, s[76:79], s37 offen lds
    s_add_u32 m0, s28, 6144
    s_add_u32 s37, s3, 0x30000
    buffer_load_dwordx4 v18, s[76:79], s37 offen lds
    s_add_u32 m0, s28, 7168
    s_add_u32 s37, s3, 0x38000
    buffer_load_dwordx4 v19, s[76:79], s37 offen lds
    s_add_u32 m0, s28, 8192
    s_add_u32 s37, s3, 0x100000
    buffer_load_dwordx4 v16, s[76:79], s37 offen lds
    s_add_u32 m0, s28, 9216
    s_add_u32 s37, s3, 0x108000
    buffer_load_dwordx4 v17, s[76:79], s37 offen lds
    s_add_u32 m0, s28, 10240
    s_add_u32 s37, s3, 0x110000
    buffer_load_dwordx4 v18, s[76:79], s37 offen lds
    s_add_u32 m0, s28, 11264
    s_add_u32 s37, s3, 0x118000
    buffer_load_dwordx4 v19, s[76:79], s37 offen lds
    s_add_u32 m0, s28, 12288
    s_add_u32 s37, s3, 0x120000
    buffer_load_dwordx4 v16, s[76:79], s37 offen lds
    s_add_u32 m0, s28, 13312
    s_add_u32 s37, s3, 0x128000
    buffer_load_dwordx4 v17, s[76:79], s37 offen lds
    s_add_u32 m0, s28, 14336
    s_add_u32 s37, s3, 0x130000
    buffer_load_dwordx4 v18, s[76:79], s37 offen lds
    s_add_u32 m0, s28, 15360
    s_add_u32 s37, s3, 0x138000
    buffer_load_dwordx4 v19, s[76:79], s37 offen lds
    s_add_u32 m0, s28, 16384
    s_add_u32 s37, s3, 0x200000
    buffer_load_dwordx4 v16, s[76:79], s37 offen lds
    s_add_u32 m0, s28, 17408
    s_add_u32 s37, s3, 0x208000
    buffer_load_dwordx4 v17, s[76:79], s37 offen lds
    s_add_u32 m0, s28, 18432
    s_add_u32 s37, s3, 0x210000
    buffer_load_dwordx4 v18, s[76:79], s37 offen lds
    s_add_u32 m0, s28, 19456
    s_add_u32 s37, s3, 0x218000
    buffer_load_dwordx4 v19, s[76:79], s37 offen lds
    s_add_u32 m0, s28, 20480
    s_add_u32 s37, s3, 0x220000
    buffer_load_dwordx4 v16, s[76:79], s37 offen lds
    s_add_u32 m0, s28, 21504
    s_add_u32 s37, s3, 0x228000
    buffer_load_dwordx4 v17, s[76:79], s37 offen lds
    s_add_u32 m0, s28, 22528
    s_add_u32 s37, s3, 0x230000
    buffer_load_dwordx4 v18, s[76:79], s37 offen lds
    s_add_u32 m0, s28, 23552
    s_add_u32 s37, s3, 0x238000
    buffer_load_dwordx4 v19, s[76:79], s37 offen lds
    s_add_u32 m0, s28, 24576
    s_add_u32 s37, s3, 0x300000
    buffer_load_dwordx4 v16, s[76:79], s37 offen lds
    s_add_u32 m0, s28, 25600
    s_add_u32 s37, s3, 0x308000
    buffer_load_dwordx4 v17, s[76:79], s37 offen lds
    s_add_u32 m0, s28, 26624
    s_add_u32 s37, s3, 0x310000
    buffer_load_dwordx4 v18, s[76:79], s37 offen lds
    s_add_u32 m0, s28, 27648
    s_add_u32 s37, s3, 0x318000
    buffer_load_dwordx4 v19, s[76:79], s37 offen lds
    s_add_u32 m0, s28, 28672
    s_add_u32 s37, s3, 0x320000
    buffer_load_dwordx4 v16, s[76:79], s37 offen lds
    s_add_u32 m0, s28, 29696
    s_add_u32 s37, s3, 0x328000
    buffer_load_dwordx4 v17, s[76:79], s37 offen lds
    s_add_u32 m0, s28, 30720
    s_add_u32 s37, s3, 0x330000
    buffer_load_dwordx4 v18, s[76:79], s37 offen lds
    s_add_u32 m0, s28, 31744
    s_add_u32 s37, s3, 0x338000
    buffer_load_dwordx4 v19, s[76:79], s37 offen lds
    v_mov_b32 v20, 0x0
    v_bfe_u32 v14, v0, 0, 1
    s_mov_b32 s38, 0x8
    v_mad_u32_u24 v20, v14, s38, v20
    v_bfe_u32 v14, v0, 1, 1
    s_mov_b32 s38, 0x10
    v_mad_u32_u24 v20, v14, s38, v20
    v_bfe_u32 v14, v0, 2, 1
    s_mov_b32 s38, 0x100
    v_mad_u32_u24 v20, v14, s38, v20
    v_bfe_u32 v14, v0, 3, 1
    s_mov_b32 s38, 0x200
    v_mad_u32_u24 v20, v14, s38, v20
    v_bfe_u32 v14, v0, 4, 1
    s_mov_b32 s38, 0x800
    v_mad_u32_u24 v20, v14, s38, v20
    v_bfe_u32 v14, v0, 5, 1
    s_mov_b32 s38, 0x1000
    v_mad_u32_u24 v20, v14, s38, v20
    v_mov_b32 v28, 0x0
    v_bfe_u32 v14, v0, 2, 1
    s_mov_b32 s38, 0x20
    v_mad_u32_u24 v28, v14, s38, v28
    v_bfe_u32 v14, v0, 3, 1
    s_mov_b32 s38, 0x40
    v_mad_u32_u24 v28, v14, s38, v28
    v_bfe_u32 v14, v0, 4, 1
    s_mov_b32 s38, 0x80
    v_mad_u32_u24 v28, v14, s38, v28
    v_mov_b32 v29, 0x0
    v_bfe_u32 v14, v0, 6, 1
    s_mov_b32 s38, 0x40
    v_mad_u32_u24 v29, v14, s38, v29
    v_bfe_u32 v14, v0, 7, 1
    s_mov_b32 s38, 0x80
    v_mad_u32_u24 v29, v14, s38, v29
    v_xor_b32 v28, v28, v29
    v_add_u32 v28, v28, v20
    v_add_u32 v20, 0x8000, v28
    v_xor_b32 v21, 32, v20
    v_add_u32 v22, 0x10000, v28
    v_xor_b32 v23, 32, v22
    v_add_u32 v24, 0x18000, v28
    v_xor_b32 v25, 32, v24
    v_add_u32 v26, 0x20000, v28
    v_xor_b32 v27, 32, v26
    s_mov_b32 s12, s54
    s_and_b32 s13, s55, 0xffff
    s_mov_b32 s14, 0x400000
    s_mov_b32 s15, 0x20000
    s_lshl_b32 s24, s20, 17
    s_and_b32 s25, s22, 3
    s_lshl_b32 s25, s25, 15
    s_add_u32 s24, s24, s25
    v_lshlrev_b32 v30, 7, v0
    buffer_load_dword v31, v30, s[12:15], s24 offen
    s_mov_b32 s12, s44
    s_and_b32 s13, s45, 0xffff
    s_mov_b32 s14, 0x200000
    s_mov_b32 s15, 0x20000
    s_mov_b32 s60, s82
    s_and_b32 s61, s83, 0xffff
    s_mov_b32 s62, 0x200000
    s_mov_b32 s63, 0x20000
    s_mov_b32 s92, s80
    s_and_b32 s93, s81, 0xffff
    s_mov_b32 s94, 0x400
    s_mov_b32 s95, 0x20000
    v_mov_b32 v1, 0x0
    v_bfe_u32 v14, v0, 0, 1
    s_mov_b32 s38, 0x10
    v_mad_u32_u24 v1, v14, s38, v1
    v_bfe_u32 v14, v0, 1, 1
    s_mov_b32 s38, 0x20
    v_mad_u32_u24 v1, v14, s38, v1
    v_bfe_u32 v14, v0, 2, 1
    s_mov_b32 s38, 0x40
    v_mad_u32_u24 v1, v14, s38, v1
    v_bfe_u32 v14, v0, 3, 1
    s_mov_b32 s38, 0x80
    v_mad_u32_u24 v1, v14, s38, v1
    v_bfe_u32 v14, v0, 4, 1
    s_mov_b32 s38, 0x100
    v_mad_u32_u24 v1, v14, s38, v1
    v_bfe_u32 v14, v0, 5, 1
    s_mov_b32 s38, 0x200
    v_mad_u32_u24 v1, v14, s38, v1
    v_mov_b32 v2, 0x0
    v_bfe_u32 v14, v0, 0, 1
    s_mov_b32 s38, 0x10
    v_mad_u32_u24 v2, v14, s38, v2
    v_bfe_u32 v14, v0, 1, 1
    s_mov_b32 s38, 0x20
    v_mad_u32_u24 v2, v14, s38, v2
    v_bfe_u32 v14, v0, 2, 1
    s_mov_b32 s38, 0x40
    v_mad_u32_u24 v2, v14, s38, v2
    v_bfe_u32 v14, v0, 3, 1
    s_mov_b32 s38, 0x80
    v_mad_u32_u24 v2, v14, s38, v2
    v_bfe_u32 v14, v0, 4, 1
    s_mov_b32 s38, 0x100
    v_mad_u32_u24 v2, v14, s38, v2
    v_bfe_u32 v14, v0, 5, 1
    s_mov_b32 s38, 0x200
    v_mad_u32_u24 v2, v14, s38, v2
    v_bfe_u32 v14, v0, 6, 1
    s_mov_b32 s38, 0x800
    v_mad_u32_u24 v2, v14, s38, v2
    v_bfe_u32 v14, v0, 7, 1
    s_mov_b32 s38, 0x1000
    v_mad_u32_u24 v2, v14, s38, v2
    v_mov_b32 v9, 0x0
    v_bfe_u32 v14, v0, 0, 1
    s_mov_b32 s38, 0x10
    v_mad_u32_u24 v9, v14, s38, v9
    v_bfe_u32 v14, v0, 1, 1
    s_mov_b32 s38, 0x20
    v_mad_u32_u24 v9, v14, s38, v9
    v_bfe_u32 v14, v0, 2, 1
    s_mov_b32 s38, 0x40
    v_mad_u32_u24 v9, v14, s38, v9
    v_bfe_u32 v14, v0, 3, 1
    s_mov_b32 s38, 0x80
    v_mad_u32_u24 v9, v14, s38, v9
    v_bfe_u32 v14, v0, 4, 1
    s_mov_b32 s38, 0x100
    v_mad_u32_u24 v9, v14, s38, v9
    v_bfe_u32 v14, v0, 5, 1
    s_mov_b32 s38, 0x200
    v_mad_u32_u24 v9, v14, s38, v9
    v_bfe_u32 v14, v0, 6, 1
    s_mov_b32 s38, 0x400
    v_mad_u32_u24 v9, v14, s38, v9
    v_bfe_u32 v14, v0, 7, 1
    s_mov_b32 s38, 0x800
    v_mad_u32_u24 v9, v14, s38, v9
    v_mov_b32 v7, 0x8000
    v_bfe_u32 v14, v0, 0, 1
    s_mov_b32 s38, 0x10
    v_mad_u32_u24 v7, v14, s38, v7
    v_bfe_u32 v14, v0, 1, 1
    s_mov_b32 s38, 0x20
    v_mad_u32_u24 v7, v14, s38, v7
    v_bfe_u32 v14, v0, 2, 1
    s_mov_b32 s38, 0x40
    v_mad_u32_u24 v7, v14, s38, v7
    v_bfe_u32 v14, v0, 3, 1
    s_mov_b32 s38, 0x80
    v_mad_u32_u24 v7, v14, s38, v7
    v_bfe_u32 v14, v0, 4, 1
    s_mov_b32 s38, 0x100
    v_mad_u32_u24 v7, v14, s38, v7
    v_bfe_u32 v14, v0, 5, 1
    s_mov_b32 s38, 0x200
    v_mad_u32_u24 v7, v14, s38, v7
    v_bfe_u32 v14, v0, 6, 1
    s_mov_b32 s38, 0x8000
    v_mad_u32_u24 v7, v14, s38, v7
    v_bfe_u32 v14, v0, 7, 1
    s_mov_b32 s38, 0x10000
    v_mad_u32_u24 v7, v14, s38, v7
    v_mov_b32 v3, 0x0
    v_bfe_u32 v14, v0, 0, 1
    s_mov_b32 s38, 0x10
    v_mad_u32_u24 v3, v14, s38, v3
    v_bfe_u32 v14, v0, 1, 1
    s_mov_b32 s38, 0x20
    v_mad_u32_u24 v3, v14, s38, v3
    v_bfe_u32 v14, v0, 2, 1
    s_mov_b32 s38, 0x40
    v_mad_u32_u24 v3, v14, s38, v3
    v_bfe_u32 v14, v0, 3, 1
    s_mov_b32 s38, 0x400
    v_mad_u32_u24 v3, v14, s38, v3
    v_bfe_u32 v14, v0, 4, 1
    s_mov_b32 s38, 0x800
    v_mad_u32_u24 v3, v14, s38, v3
    v_bfe_u32 v14, v0, 5, 1
    s_mov_b32 s38, 0x1000
    v_mad_u32_u24 v3, v14, s38, v3
    v_bfe_u32 v14, v0, 6, 1
    s_mov_b32 s38, 0x2000
    v_mad_u32_u24 v3, v14, s38, v3
    v_bfe_u32 v14, v0, 7, 1
    s_mov_b32 s38, 0x4000
    v_mad_u32_u24 v3, v14, s38, v3
    v_mov_b32 v4, 0x0
    v_bfe_u32 v14, v0, 0, 1
    s_mov_b32 s38, 0x100
    v_mad_u32_u24 v4, v14, s38, v4
    v_bfe_u32 v14, v0, 1, 1
    s_mov_b32 s38, 0x200
    v_mad_u32_u24 v4, v14, s38, v4
    v_bfe_u32 v14, v0, 2, 1
    s_mov_b32 s38, 0x400
    v_mad_u32_u24 v4, v14, s38, v4
    v_bfe_u32 v14, v0, 6, 1
    s_mov_b32 s38, 0x80
    v_mad_u32_u24 v4, v14, s38, v4
    v_bfe_u32 v14, v0, 7, 1
    s_mov_b32 s38, 0x4000
    v_mad_u32_u24 v4, v14, s38, v4
    v_lshrrev_b32 v15, 3, v0
    v_xor_b32 v15, v15, v0
    v_and_b32 v15, 7, v15
    v_lshl_add_u32 v4, v15, 4, v4
    v_bfe_u32 v15, v0, 4, 2
    v_lshlrev_b32 v15, 4, v15
    v_xor_b32 v5, v15, v1
    v_xor_b32 v6, 64, v5
    v_mov_b32 v8, 0x5000
    v_bfe_u32 v14, v0, 0, 1
    s_mov_b32 s38, 0x10
    v_mad_u32_u24 v8, v14, s38, v8
    v_bfe_u32 v14, v0, 1, 1
    s_mov_b32 s38, 0x40
    v_mad_u32_u24 v8, v14, s38, v8
    v_bfe_u32 v14, v0, 2, 1
    s_mov_b32 s38, 0x80
    v_mad_u32_u24 v8, v14, s38, v8
    v_bfe_u32 v14, v0, 4, 1
    s_mov_b32 s38, 0x20
    v_mad_u32_u24 v8, v14, s38, v8
    v_bfe_u32 v14, v0, 5, 1
    s_mov_b32 s38, 0x100
    v_mad_u32_u24 v8, v14, s38, v8
    v_mov_b32 v10, 0x0
    v_bfe_u32 v14, v0, 0, 1
    s_mov_b32 s38, 0x10
    v_mad_u32_u24 v10, v14, s38, v10
    v_bfe_u32 v14, v0, 1, 1
    s_mov_b32 s38, 0x20
    v_mad_u32_u24 v10, v14, s38, v10
    v_bfe_u32 v14, v0, 2, 1
    s_mov_b32 s38, 0x40
    v_mad_u32_u24 v10, v14, s38, v10
    v_bfe_u32 v14, v0, 3, 1
    s_mov_b32 s38, 0x80
    v_mad_u32_u24 v10, v14, s38, v10
    v_bfe_u32 v14, v0, 4, 1
    s_mov_b32 s38, 0x20000
    v_mad_u32_u24 v10, v14, s38, v10
    v_bfe_u32 v14, v0, 5, 1
    s_mov_b32 s38, 0x40000
    v_mad_u32_u24 v10, v14, s38, v10
    v_bfe_u32 v14, v0, 6, 1
    s_mov_b32 s38, 0x100
    v_mad_u32_u24 v10, v14, s38, v10
    v_bfe_u32 v14, v0, 7, 1
    s_mov_b32 s38, 0x200
    v_mad_u32_u24 v10, v14, s38, v10
    v_mov_b32 v11, 0x0
    v_bfe_u32 v14, v0, 0, 1
    s_mov_b32 s38, 0x10
    v_mad_u32_u24 v11, v14, s38, v11
    v_bfe_u32 v14, v0, 1, 1
    s_mov_b32 s38, 0x20
    v_mad_u32_u24 v11, v14, s38, v11
    v_bfe_u32 v14, v0, 2, 1
    s_mov_b32 s38, 0x40
    v_mad_u32_u24 v11, v14, s38, v11
    v_bfe_u32 v14, v0, 3, 1
    s_mov_b32 s38, 0x80
    v_mad_u32_u24 v11, v14, s38, v11
    v_bfe_u32 v14, v0, 4, 1
    s_mov_b32 s38, 0x400
    v_mad_u32_u24 v11, v14, s38, v11
    v_bfe_u32 v14, v0, 5, 1
    s_mov_b32 s38, 0x800
    v_mad_u32_u24 v11, v14, s38, v11
    v_bfe_u32 v14, v0, 6, 1
    s_mov_b32 s38, 0x100
    v_mad_u32_u24 v11, v14, s38, v11
    v_bfe_u32 v14, v0, 7, 1
    s_mov_b32 s38, 0x200
    v_mad_u32_u24 v11, v14, s38, v11
    v_mov_b32 v12, 0x0
    v_bfe_u32 v14, v0, 0, 1
    s_mov_b32 s38, 0x10
    v_mad_u32_u24 v12, v14, s38, v12
    v_bfe_u32 v14, v0, 1, 1
    s_mov_b32 s38, 0x20
    v_mad_u32_u24 v12, v14, s38, v12
    v_bfe_u32 v14, v0, 2, 1
    s_mov_b32 s38, 0x40
    v_mad_u32_u24 v12, v14, s38, v12
    v_bfe_u32 v14, v0, 3, 1
    s_mov_b32 s38, 0x80
    v_mad_u32_u24 v12, v14, s38, v12
    v_bfe_u32 v14, v0, 4, 1
    s_mov_b32 s38, 0x4
    v_mad_u32_u24 v12, v14, s38, v12
    v_bfe_u32 v14, v0, 5, 1
    s_mov_b32 s38, 0x8
    v_mad_u32_u24 v12, v14, s38, v12
    v_bfe_u32 v14, v0, 6, 1
    s_mov_b32 s38, 0x100
    v_mad_u32_u24 v12, v14, s38, v12
    v_bfe_u32 v14, v0, 7, 1
    s_mov_b32 s38, 0x200
    v_mad_u32_u24 v12, v14, s38, v12
    v_mov_b32 v13, 0xf149f2ca
    v_and_b32 v14, 15, v0
    v_bfe_u32 v15, v0, 4, 2
    v_cmp_gt_u32 s[72:73], 2, v15
    v_lshlrev_b32 v15, 2, v15
    v_cmp_le_u32 s[64:65], v15, v14
    v_add_u32 v15, 1, v15
    v_cmp_le_u32 s[66:67], v15, v14
    v_add_u32 v15, 1, v15
    v_cmp_le_u32 s[68:69], v15, v14
    v_add_u32 v15, 1, v15
    v_cmp_le_u32 s[70:71], v15, v14
    v_add_u32 v15, 1, v15
    s_mov_b32 s34, 0x05040100
    s_mov_b32 s35, 0x07060302
    s_mov_b32 s33, 0x3e0293ee
    s_mov_b32 s32, 0
    s_mov_b32 s4, 0x3f803f80
    s_mov_b32 s5, 0x3f803f80
    s_mov_b32 s23, s22
    s_lshl_b32 s36, s23, 15
    buffer_load_dwordx4 v[96:99], v3, s[12:15], s36 offen offset:0
    buffer_load_dwordx4 v[100:103], v3, s[12:15], s36 offen offset:128
    buffer_load_dwordx4 v[104:107], v3, s[12:15], s36 offen offset:256
    buffer_load_dwordx4 v[108:111], v3, s[12:15], s36 offen offset:384
    buffer_load_dwordx4 v[112:115], v3, s[12:15], s36 offen offset:512
    buffer_load_dwordx4 v[116:119], v3, s[12:15], s36 offen offset:640
    buffer_load_dwordx4 v[120:123], v3, s[12:15], s36 offen offset:768
    buffer_load_dwordx4 v[124:127], v3, s[12:15], s36 offen offset:896
    s_waitcnt vmcnt(33)
    s_barrier
    ds_read_b64_tr_b16 v[128:129], v20 offset:0
    ds_read_b64_tr_b16 v[130:131], v20 offset:1024
    ds_read_b64_tr_b16 v[132:133], v21 offset:0
    ds_read_b64_tr_b16 v[134:135], v21 offset:1024
    ds_read_b64_tr_b16 v[136:137], v22 offset:0
    ds_read_b64_tr_b16 v[138:139], v22 offset:1024
    ds_read_b64_tr_b16 v[140:141], v23 offset:0
    ds_read_b64_tr_b16 v[142:143], v23 offset:1024
    ds_read_b64_tr_b16 v[144:145], v24 offset:0
    ds_read_b64_tr_b16 v[146:147], v24 offset:1024
    ds_read_b64_tr_b16 v[148:149], v25 offset:0
    ds_read_b64_tr_b16 v[150:151], v25 offset:1024
    s_waitcnt lgkmcnt(4)
    ds_read_b64_tr_b16 v[152:153], v26 offset:0
    ds_read_b64_tr_b16 v[154:155], v26 offset:1024
    ds_read_b64_tr_b16 v[156:157], v27 offset:0
    ds_read_b64_tr_b16 v[158:159], v27 offset:1024
    s_waitcnt lgkmcnt(0)
    s_barrier
    s_mov_b32 s40, s50
    s_and_b32 s41, s51, 0xffff
    s_mov_b32 s42, 0x400000
    s_mov_b32 s43, 0x20000
    s_add_u32 m0, s28, 0
    s_add_u32 s37, s3, 0x0
    buffer_load_dwordx4 v16, s[40:43], s37 offen lds
    s_add_u32 m0, s28, 1024
    s_add_u32 s37, s3, 0x8000
    buffer_load_dwordx4 v17, s[40:43], s37 offen lds
    s_add_u32 m0, s28, 2048
    s_add_u32 s37, s3, 0x10000
    buffer_load_dwordx4 v18, s[40:43], s37 offen lds
    s_add_u32 m0, s28, 3072
    s_add_u32 s37, s3, 0x18000
    buffer_load_dwordx4 v19, s[40:43], s37 offen lds
    s_add_u32 m0, s28, 4096
    s_add_u32 s37, s3, 0x20000
    buffer_load_dwordx4 v16, s[40:43], s37 offen lds
    s_add_u32 m0, s28, 5120
    s_add_u32 s37, s3, 0x28000
    buffer_load_dwordx4 v17, s[40:43], s37 offen lds
    s_add_u32 m0, s28, 6144
    s_add_u32 s37, s3, 0x30000
    buffer_load_dwordx4 v18, s[40:43], s37 offen lds
    s_add_u32 m0, s28, 7168
    s_add_u32 s37, s3, 0x38000
    buffer_load_dwordx4 v19, s[40:43], s37 offen lds
    s_waitcnt vmcnt(33)
    s_barrier
    ds_read_b64_tr_b16 v[160:161], v20 offset:8192
    ds_read_b64_tr_b16 v[162:163], v20 offset:9216
    ds_read_b64_tr_b16 v[164:165], v21 offset:8192
    ds_read_b64_tr_b16 v[166:167], v21 offset:9216
    ds_read_b64_tr_b16 v[168:169], v22 offset:8192
    ds_read_b64_tr_b16 v[170:171], v22 offset:9216
    ds_read_b64_tr_b16 v[172:173], v23 offset:8192
    ds_read_b64_tr_b16 v[174:175], v23 offset:9216
    ds_read_b64_tr_b16 v[176:177], v24 offset:8192
    ds_read_b64_tr_b16 v[178:179], v24 offset:9216
    ds_read_b64_tr_b16 v[180:181], v25 offset:8192
    ds_read_b64_tr_b16 v[182:183], v25 offset:9216
    s_waitcnt lgkmcnt(4)
    ds_read_b64_tr_b16 v[184:185], v26 offset:8192
    ds_read_b64_tr_b16 v[186:187], v26 offset:9216
    ds_read_b64_tr_b16 v[188:189], v27 offset:8192
    ds_read_b64_tr_b16 v[190:191], v27 offset:9216
    s_waitcnt lgkmcnt(0)
    s_barrier
    s_add_u32 m0, s28, 8192
    s_add_u32 s37, s3, 0x100000
    buffer_load_dwordx4 v16, s[40:43], s37 offen lds
    s_add_u32 m0, s28, 9216
    s_add_u32 s37, s3, 0x108000
    buffer_load_dwordx4 v17, s[40:43], s37 offen lds
    s_add_u32 m0, s28, 10240
    s_add_u32 s37, s3, 0x110000
    buffer_load_dwordx4 v18, s[40:43], s37 offen lds
    s_add_u32 m0, s28, 11264
    s_add_u32 s37, s3, 0x118000
    buffer_load_dwordx4 v19, s[40:43], s37 offen lds
    s_add_u32 m0, s28, 12288
    s_add_u32 s37, s3, 0x120000
    buffer_load_dwordx4 v16, s[40:43], s37 offen lds
    s_add_u32 m0, s28, 13312
    s_add_u32 s37, s3, 0x128000
    buffer_load_dwordx4 v17, s[40:43], s37 offen lds
    s_add_u32 m0, s28, 14336
    s_add_u32 s37, s3, 0x130000
    buffer_load_dwordx4 v18, s[40:43], s37 offen lds
    s_add_u32 m0, s28, 15360
    s_add_u32 s37, s3, 0x138000
    buffer_load_dwordx4 v19, s[40:43], s37 offen lds
    s_waitcnt vmcnt(33)
    s_barrier
    ds_read_b64_tr_b16 v[192:193], v20 offset:16384
    ds_read_b64_tr_b16 v[194:195], v20 offset:17408
    ds_read_b64_tr_b16 v[196:197], v21 offset:16384
    ds_read_b64_tr_b16 v[198:199], v21 offset:17408
    ds_read_b64_tr_b16 v[200:201], v22 offset:16384
    ds_read_b64_tr_b16 v[202:203], v22 offset:17408
    ds_read_b64_tr_b16 v[204:205], v23 offset:16384
    ds_read_b64_tr_b16 v[206:207], v23 offset:17408
    ds_read_b64_tr_b16 v[208:209], v24 offset:16384
    ds_read_b64_tr_b16 v[210:211], v24 offset:17408
    ds_read_b64_tr_b16 v[212:213], v25 offset:16384
    ds_read_b64_tr_b16 v[214:215], v25 offset:17408
    s_waitcnt lgkmcnt(4)
    ds_read_b64_tr_b16 v[216:217], v26 offset:16384
    ds_read_b64_tr_b16 v[218:219], v26 offset:17408
    ds_read_b64_tr_b16 v[220:221], v27 offset:16384
    ds_read_b64_tr_b16 v[222:223], v27 offset:17408
    s_waitcnt lgkmcnt(0)
    s_barrier
    s_add_u32 m0, s28, 16384
    s_add_u32 s37, s3, 0x200000
    buffer_load_dwordx4 v16, s[40:43], s37 offen lds
    s_add_u32 m0, s28, 17408
    s_add_u32 s37, s3, 0x208000
    buffer_load_dwordx4 v17, s[40:43], s37 offen lds
    s_add_u32 m0, s28, 18432
    s_add_u32 s37, s3, 0x210000
    buffer_load_dwordx4 v18, s[40:43], s37 offen lds
    s_add_u32 m0, s28, 19456
    s_add_u32 s37, s3, 0x218000
    buffer_load_dwordx4 v19, s[40:43], s37 offen lds
    s_add_u32 m0, s28, 20480
    s_add_u32 s37, s3, 0x220000
    buffer_load_dwordx4 v16, s[40:43], s37 offen lds
    s_add_u32 m0, s28, 21504
    s_add_u32 s37, s3, 0x228000
    buffer_load_dwordx4 v17, s[40:43], s37 offen lds
    s_add_u32 m0, s28, 22528
    s_add_u32 s37, s3, 0x230000
    buffer_load_dwordx4 v18, s[40:43], s37 offen lds
    s_add_u32 m0, s28, 23552
    s_add_u32 s37, s3, 0x238000
    buffer_load_dwordx4 v19, s[40:43], s37 offen lds
    s_waitcnt vmcnt(33)
    s_barrier
    ds_read_b64_tr_b16 v[224:225], v20 offset:24576
    ds_read_b64_tr_b16 v[226:227], v20 offset:25600
    ds_read_b64_tr_b16 v[228:229], v21 offset:24576
    ds_read_b64_tr_b16 v[230:231], v21 offset:25600
    ds_read_b64_tr_b16 v[232:233], v22 offset:24576
    ds_read_b64_tr_b16 v[234:235], v22 offset:25600
    ds_read_b64_tr_b16 v[236:237], v23 offset:24576
    ds_read_b64_tr_b16 v[238:239], v23 offset:25600
    ds_read_b64_tr_b16 v[240:241], v24 offset:24576
    ds_read_b64_tr_b16 v[242:243], v24 offset:25600
    ds_read_b64_tr_b16 v[244:245], v25 offset:24576
    ds_read_b64_tr_b16 v[246:247], v25 offset:25600
    s_waitcnt lgkmcnt(4)
    ds_read_b64_tr_b16 v[248:249], v26 offset:24576
    ds_read_b64_tr_b16 v[250:251], v26 offset:25600
    ds_read_b64_tr_b16 v[252:253], v27 offset:24576
    ds_read_b64_tr_b16 v[254:255], v27 offset:25600
    s_waitcnt lgkmcnt(0)
    s_barrier
    s_add_u32 m0, s28, 24576
    s_add_u32 s37, s3, 0x300000
    buffer_load_dwordx4 v16, s[40:43], s37 offen lds
    s_add_u32 m0, s28, 25600
    s_add_u32 s37, s3, 0x308000
    buffer_load_dwordx4 v17, s[40:43], s37 offen lds
    s_add_u32 m0, s28, 26624
    s_add_u32 s37, s3, 0x310000
    buffer_load_dwordx4 v18, s[40:43], s37 offen lds
    s_add_u32 m0, s28, 27648
    s_add_u32 s37, s3, 0x318000
    buffer_load_dwordx4 v19, s[40:43], s37 offen lds
    s_add_u32 m0, s28, 28672
    s_add_u32 s37, s3, 0x320000
    buffer_load_dwordx4 v16, s[40:43], s37 offen lds
    s_add_u32 m0, s28, 29696
    s_add_u32 s37, s3, 0x328000
    buffer_load_dwordx4 v17, s[40:43], s37 offen lds
    s_add_u32 m0, s28, 30720
    s_add_u32 s37, s3, 0x330000
    buffer_load_dwordx4 v18, s[40:43], s37 offen lds
    s_add_u32 m0, s28, 31744
    s_add_u32 s37, s3, 0x338000
    buffer_load_dwordx4 v19, s[40:43], s37 offen lds
    s_waitcnt vmcnt(32)
    v_mov_b32 v88, 0
    v_mov_b32 v89, 0
    v_dot2_f32_bf16 v88, v96, s4, v88
    v_dot2_f32_bf16 v89, v96, v96, v89
    v_dot2_f32_bf16 v88, v97, s4, v88
    v_dot2_f32_bf16 v89, v97, v97, v89
    v_dot2_f32_bf16 v88, v98, s4, v88
    v_dot2_f32_bf16 v89, v98, v98, v89
    v_dot2_f32_bf16 v88, v99, s4, v88
    v_dot2_f32_bf16 v89, v99, v99, v89
    v_dot2_f32_bf16 v88, v100, s4, v88
    v_dot2_f32_bf16 v89, v100, v100, v89
    v_dot2_f32_bf16 v88, v101, s4, v88
    v_dot2_f32_bf16 v89, v101, v101, v89
    v_dot2_f32_bf16 v88, v102, s4, v88
    v_dot2_f32_bf16 v89, v102, v102, v89
    v_dot2_f32_bf16 v88, v103, s4, v88
    v_dot2_f32_bf16 v89, v103, v103, v89
    v_dot2_f32_bf16 v88, v104, s4, v88
    v_dot2_f32_bf16 v89, v104, v104, v89
    v_dot2_f32_bf16 v88, v105, s4, v88
    v_dot2_f32_bf16 v89, v105, v105, v89
    v_dot2_f32_bf16 v88, v106, s4, v88
    v_dot2_f32_bf16 v89, v106, v106, v89
    v_dot2_f32_bf16 v88, v107, s4, v88
    v_dot2_f32_bf16 v89, v107, v107, v89
    v_dot2_f32_bf16 v88, v108, s4, v88
    v_dot2_f32_bf16 v89, v108, v108, v89
    v_dot2_f32_bf16 v88, v109, s4, v88
    v_dot2_f32_bf16 v89, v109, v109, v89
    v_dot2_f32_bf16 v88, v110, s4, v88
    v_dot2_f32_bf16 v89, v110, v110, v89
    v_dot2_f32_bf16 v88, v111, s4, v88
    v_dot2_f32_bf16 v89, v111, v111, v89
    v_dot2_f32_bf16 v88, v112, s4, v88
    v_dot2_f32_bf16 v89, v112, v112, v89
    v_dot2_f32_bf16 v88, v113, s4, v88
    v_dot2_f32_bf16 v89, v113, v113, v89
    v_dot2_f32_bf16 v88, v114, s4, v88
    v_dot2_f32_bf16 v89, v114, v114, v89
    v_dot2_f32_bf16 v88, v115, s4, v88
    v_dot2_f32_bf16 v89, v115, v115, v89
    v_dot2_f32_bf16 v88, v116, s4, v88
    v_dot2_f32_bf16 v89, v116, v116, v89
    v_dot2_f32_bf16 v88, v117, s4, v88
    v_dot2_f32_bf16 v89, v117, v117, v89
    v_dot2_f32_bf16 v88, v118, s4, v88
    v_dot2_f32_bf16 v89, v118, v118, v89
    v_dot2_f32_bf16 v88, v119, s4, v88
    v_dot2_f32_bf16 v89, v119, v119, v89
    v_dot2_f32_bf16 v88, v120, s4, v88
    v_dot2_f32_bf16 v89, v120, v120, v89
    v_dot2_f32_bf16 v88, v121, s4, v88
    v_dot2_f32_bf16 v89, v121, v121, v89
    v_dot2_f32_bf16 v88, v122, s4, v88
    v_dot2_f32_bf16 v89, v122, v122, v89
    v_dot2_f32_bf16 v88, v123, s4, v88
    v_dot2_f32_bf16 v89, v123, v123, v89
    v_dot2_f32_bf16 v88, v124, s4, v88
    v_dot2_f32_bf16 v89, v124, v124, v89
    v_dot2_f32_bf16 v88, v125, s4, v88
    v_dot2_f32_bf16 v89, v125, v125, v89
    v_dot2_f32_bf16 v88, v126, s4, v88
    v_dot2_f32_bf16 v89, v126, v126, v89
    v_dot2_f32_bf16 v88, v127, s4, v88
    v_dot2_f32_bf16 v89, v127, v127, v89
    s_nop 3
    v_add_f32_dpp v88, v88, v88 quad_perm:[1,0,3,2] row_mask:0xf bank_mask:0xf
    v_add_f32_dpp v89, v89, v89 quad_perm:[1,0,3,2] row_mask:0xf bank_mask:0xf
    s_nop 0
    v_add_f32_dpp v88, v88, v88 quad_perm:[2,3,0,1] row_mask:0xf bank_mask:0xf
    v_add_f32_dpp v89, v89, v89 quad_perm:[2,3,0,1] row_mask:0xf bank_mask:0xf
    s_nop 0
    v_add_f32_dpp v88, v88, v88 row_half_mirror row_mask:0xf bank_mask:0xf
    v_add_f32_dpp v89, v89, v89 row_half_mirror row_mask:0xf bank_mask:0xf
    v_mul_f32 v88, 0x3b000000, v88
    v_mul_f32 v89, 0x3b000000, v89
    v_fma_f32 v89, -v88, v88, v89
    v_max_f32 v89, 0, v89
    v_cvt_pk_bf16_f32 v14, v88, v89
    v_lshlrev_b32 v88, 16, v14
    v_and_b32 v89, 0xffff0000, v14
    v_add_f32 v89, 0x3727c5ac, v89
    v_cvt_pk_bf16_f32 v14, v89, v89
    v_lshlrev_b32 v89, 16, v14
    v_sqrt_f32 v89, v89
    s_nop 0
    v_cvt_pk_bf16_f32 v14, v89, v89
    v_lshlrev_b32 v89, 16, v14
    v_rcp_f32 v89, v89
    v_lshlrev_b32 v90, 16, v96
    v_and_b32 v91, 0xffff0000, v96
    v_sub_f32 v90, v90, v88
    v_sub_f32 v91, v91, v88
    v_cvt_pk_bf16_f32 v96, v90, v91
    v_lshlrev_b32 v90, 16, v96
    v_and_b32 v91, 0xffff0000, v96
    v_mul_f32 v90, v90, v89
    v_mul_f32 v91, v91, v89
    v_cvt_pk_bf16_f32 v96, v90, v91
    v_lshlrev_b32 v90, 16, v97
    v_and_b32 v91, 0xffff0000, v97
    v_sub_f32 v90, v90, v88
    v_sub_f32 v91, v91, v88
    v_cvt_pk_bf16_f32 v97, v90, v91
    v_lshlrev_b32 v90, 16, v97
    v_and_b32 v91, 0xffff0000, v97
    v_mul_f32 v90, v90, v89
    v_mul_f32 v91, v91, v89
    v_cvt_pk_bf16_f32 v97, v90, v91
    v_lshlrev_b32 v90, 16, v98
    v_and_b32 v91, 0xffff0000, v98
    v_sub_f32 v90, v90, v88
    v_sub_f32 v91, v91, v88
    v_cvt_pk_bf16_f32 v98, v90, v91
    v_lshlrev_b32 v90, 16, v98
    v_and_b32 v91, 0xffff0000, v98
    v_mul_f32 v90, v90, v89
    v_mul_f32 v91, v91, v89
    v_cvt_pk_bf16_f32 v98, v90, v91
    v_lshlrev_b32 v90, 16, v99
    v_and_b32 v91, 0xffff0000, v99
    v_sub_f32 v90, v90, v88
    v_sub_f32 v91, v91, v88
    v_cvt_pk_bf16_f32 v99, v90, v91
    v_lshlrev_b32 v90, 16, v99
    v_and_b32 v91, 0xffff0000, v99
    v_mul_f32 v90, v90, v89
    v_mul_f32 v91, v91, v89
    v_cvt_pk_bf16_f32 v99, v90, v91
    ds_write_b128 v4, v[96:99] offset:0
    v_lshlrev_b32 v90, 16, v100
    v_and_b32 v91, 0xffff0000, v100
    v_sub_f32 v90, v90, v88
    v_sub_f32 v91, v91, v88
    v_cvt_pk_bf16_f32 v100, v90, v91
    v_lshlrev_b32 v90, 16, v100
    v_and_b32 v91, 0xffff0000, v100
    v_mul_f32 v90, v90, v89
    v_mul_f32 v91, v91, v89
    v_cvt_pk_bf16_f32 v100, v90, v91
    v_lshlrev_b32 v90, 16, v101
    v_and_b32 v91, 0xffff0000, v101
    v_sub_f32 v90, v90, v88
    v_sub_f32 v91, v91, v88
    v_cvt_pk_bf16_f32 v101, v90, v91
    v_lshlrev_b32 v90, 16, v101
    v_and_b32 v91, 0xffff0000, v101
    v_mul_f32 v90, v90, v89
    v_mul_f32 v91, v91, v89
    v_cvt_pk_bf16_f32 v101, v90, v91
    v_lshlrev_b32 v90, 16, v102
    v_and_b32 v91, 0xffff0000, v102
    v_sub_f32 v90, v90, v88
    v_sub_f32 v91, v91, v88
    v_cvt_pk_bf16_f32 v102, v90, v91
    v_lshlrev_b32 v90, 16, v102
    v_and_b32 v91, 0xffff0000, v102
    v_mul_f32 v90, v90, v89
    v_mul_f32 v91, v91, v89
    v_cvt_pk_bf16_f32 v102, v90, v91
    v_lshlrev_b32 v90, 16, v103
    v_and_b32 v91, 0xffff0000, v103
    v_sub_f32 v90, v90, v88
    v_sub_f32 v91, v91, v88
    v_cvt_pk_bf16_f32 v103, v90, v91
    v_lshlrev_b32 v90, 16, v103
    v_and_b32 v91, 0xffff0000, v103
    v_mul_f32 v90, v90, v89
    v_mul_f32 v91, v91, v89
    v_cvt_pk_bf16_f32 v103, v90, v91
    ds_write_b128 v4, v[100:103] offset:2048
    v_lshlrev_b32 v90, 16, v104
    v_and_b32 v91, 0xffff0000, v104
    v_sub_f32 v90, v90, v88
    v_sub_f32 v91, v91, v88
    v_cvt_pk_bf16_f32 v104, v90, v91
    v_lshlrev_b32 v90, 16, v104
    v_and_b32 v91, 0xffff0000, v104
    v_mul_f32 v90, v90, v89
    v_mul_f32 v91, v91, v89
    v_cvt_pk_bf16_f32 v104, v90, v91
    v_lshlrev_b32 v90, 16, v105
    v_and_b32 v91, 0xffff0000, v105
    v_sub_f32 v90, v90, v88
    v_sub_f32 v91, v91, v88
    v_cvt_pk_bf16_f32 v105, v90, v91
    v_lshlrev_b32 v90, 16, v105
    v_and_b32 v91, 0xffff0000, v105
    v_mul_f32 v90, v90, v89
    v_mul_f32 v91, v91, v89
    v_cvt_pk_bf16_f32 v105, v90, v91
    v_lshlrev_b32 v90, 16, v106
    v_and_b32 v91, 0xffff0000, v106
    v_sub_f32 v90, v90, v88
    v_sub_f32 v91, v91, v88
    v_cvt_pk_bf16_f32 v106, v90, v91
    v_lshlrev_b32 v90, 16, v106
    v_and_b32 v91, 0xffff0000, v106
    v_mul_f32 v90, v90, v89
    v_mul_f32 v91, v91, v89
    v_cvt_pk_bf16_f32 v106, v90, v91
    v_lshlrev_b32 v90, 16, v107
    v_and_b32 v91, 0xffff0000, v107
    v_sub_f32 v90, v90, v88
    v_sub_f32 v91, v91, v88
    v_cvt_pk_bf16_f32 v107, v90, v91
    v_lshlrev_b32 v90, 16, v107
    v_and_b32 v91, 0xffff0000, v107
    v_mul_f32 v90, v90, v89
    v_mul_f32 v91, v91, v89
    v_cvt_pk_bf16_f32 v107, v90, v91
    ds_write_b128 v4, v[104:107] offset:4096
    v_lshlrev_b32 v90, 16, v108
    v_and_b32 v91, 0xffff0000, v108
    v_sub_f32 v90, v90, v88
    v_sub_f32 v91, v91, v88
    v_cvt_pk_bf16_f32 v108, v90, v91
    v_lshlrev_b32 v90, 16, v108
    v_and_b32 v91, 0xffff0000, v108
    v_mul_f32 v90, v90, v89
    v_mul_f32 v91, v91, v89
    v_cvt_pk_bf16_f32 v108, v90, v91
    v_lshlrev_b32 v90, 16, v109
    v_and_b32 v91, 0xffff0000, v109
    v_sub_f32 v90, v90, v88
    v_sub_f32 v91, v91, v88
    v_cvt_pk_bf16_f32 v109, v90, v91
    v_lshlrev_b32 v90, 16, v109
    v_and_b32 v91, 0xffff0000, v109
    v_mul_f32 v90, v90, v89
    v_mul_f32 v91, v91, v89
    v_cvt_pk_bf16_f32 v109, v90, v91
    v_lshlrev_b32 v90, 16, v110
    v_and_b32 v91, 0xffff0000, v110
    v_sub_f32 v90, v90, v88
    v_sub_f32 v91, v91, v88
    v_cvt_pk_bf16_f32 v110, v90, v91
    v_lshlrev_b32 v90, 16, v110
    v_and_b32 v91, 0xffff0000, v110
    v_mul_f32 v90, v90, v89
    v_mul_f32 v91, v91, v89
    v_cvt_pk_bf16_f32 v110, v90, v91
    v_lshlrev_b32 v90, 16, v111
    v_and_b32 v91, 0xffff0000, v111
    v_sub_f32 v90, v90, v88
    v_sub_f32 v91, v91, v88
    v_cvt_pk_bf16_f32 v111, v90, v91
    v_lshlrev_b32 v90, 16, v111
    v_and_b32 v91, 0xffff0000, v111
    v_mul_f32 v90, v90, v89
    v_mul_f32 v91, v91, v89
    v_cvt_pk_bf16_f32 v111, v90, v91
    ds_write_b128 v4, v[108:111] offset:6144
    v_lshlrev_b32 v90, 16, v112
    v_and_b32 v91, 0xffff0000, v112
    v_sub_f32 v90, v90, v88
    v_sub_f32 v91, v91, v88
    v_cvt_pk_bf16_f32 v112, v90, v91
    v_lshlrev_b32 v90, 16, v112
    v_and_b32 v91, 0xffff0000, v112
    v_mul_f32 v90, v90, v89
    v_mul_f32 v91, v91, v89
    v_cvt_pk_bf16_f32 v112, v90, v91
    v_lshlrev_b32 v90, 16, v113
    v_and_b32 v91, 0xffff0000, v113
    v_sub_f32 v90, v90, v88
    v_sub_f32 v91, v91, v88
    v_cvt_pk_bf16_f32 v113, v90, v91
    v_lshlrev_b32 v90, 16, v113
    v_and_b32 v91, 0xffff0000, v113
    v_mul_f32 v90, v90, v89
    v_mul_f32 v91, v91, v89
    v_cvt_pk_bf16_f32 v113, v90, v91
    v_lshlrev_b32 v90, 16, v114
    v_and_b32 v91, 0xffff0000, v114
    v_sub_f32 v90, v90, v88
    v_sub_f32 v91, v91, v88
    v_cvt_pk_bf16_f32 v114, v90, v91
    v_lshlrev_b32 v90, 16, v114
    v_and_b32 v91, 0xffff0000, v114
    v_mul_f32 v90, v90, v89
    v_mul_f32 v91, v91, v89
    v_cvt_pk_bf16_f32 v114, v90, v91
    v_lshlrev_b32 v90, 16, v115
    v_and_b32 v91, 0xffff0000, v115
    v_sub_f32 v90, v90, v88
    v_sub_f32 v91, v91, v88
    v_cvt_pk_bf16_f32 v115, v90, v91
    v_lshlrev_b32 v90, 16, v115
    v_and_b32 v91, 0xffff0000, v115
    v_mul_f32 v90, v90, v89
    v_mul_f32 v91, v91, v89
    v_cvt_pk_bf16_f32 v115, v90, v91
    ds_write_b128 v4, v[112:115] offset:8192
    v_lshlrev_b32 v90, 16, v116
    v_and_b32 v91, 0xffff0000, v116
    v_sub_f32 v90, v90, v88
    v_sub_f32 v91, v91, v88
    v_cvt_pk_bf16_f32 v116, v90, v91
    v_lshlrev_b32 v90, 16, v116
    v_and_b32 v91, 0xffff0000, v116
    v_mul_f32 v90, v90, v89
    v_mul_f32 v91, v91, v89
    v_cvt_pk_bf16_f32 v116, v90, v91
    v_lshlrev_b32 v90, 16, v117
    v_and_b32 v91, 0xffff0000, v117
    v_sub_f32 v90, v90, v88
    v_sub_f32 v91, v91, v88
    v_cvt_pk_bf16_f32 v117, v90, v91
    v_lshlrev_b32 v90, 16, v117
    v_and_b32 v91, 0xffff0000, v117
    v_mul_f32 v90, v90, v89
    v_mul_f32 v91, v91, v89
    v_cvt_pk_bf16_f32 v117, v90, v91
    v_lshlrev_b32 v90, 16, v118
    v_and_b32 v91, 0xffff0000, v118
    v_sub_f32 v90, v90, v88
    v_sub_f32 v91, v91, v88
    v_cvt_pk_bf16_f32 v118, v90, v91
    v_lshlrev_b32 v90, 16, v118
    v_and_b32 v91, 0xffff0000, v118
    v_mul_f32 v90, v90, v89
    v_mul_f32 v91, v91, v89
    v_cvt_pk_bf16_f32 v118, v90, v91
    v_lshlrev_b32 v90, 16, v119
    v_and_b32 v91, 0xffff0000, v119
    v_sub_f32 v90, v90, v88
    v_sub_f32 v91, v91, v88
    v_cvt_pk_bf16_f32 v119, v90, v91
    v_lshlrev_b32 v90, 16, v119
    v_and_b32 v91, 0xffff0000, v119
    v_mul_f32 v90, v90, v89
    v_mul_f32 v91, v91, v89
    v_cvt_pk_bf16_f32 v119, v90, v91
    ds_write_b128 v4, v[116:119] offset:10240
    v_lshlrev_b32 v90, 16, v120
    v_and_b32 v91, 0xffff0000, v120
    v_sub_f32 v90, v90, v88
    v_sub_f32 v91, v91, v88
    v_cvt_pk_bf16_f32 v120, v90, v91
    v_lshlrev_b32 v90, 16, v120
    v_and_b32 v91, 0xffff0000, v120
    v_mul_f32 v90, v90, v89
    v_mul_f32 v91, v91, v89
    v_cvt_pk_bf16_f32 v120, v90, v91
    v_lshlrev_b32 v90, 16, v121
    v_and_b32 v91, 0xffff0000, v121
    v_sub_f32 v90, v90, v88
    v_sub_f32 v91, v91, v88
    v_cvt_pk_bf16_f32 v121, v90, v91
    v_lshlrev_b32 v90, 16, v121
    v_and_b32 v91, 0xffff0000, v121
    v_mul_f32 v90, v90, v89
    v_mul_f32 v91, v91, v89
    v_cvt_pk_bf16_f32 v121, v90, v91
    v_lshlrev_b32 v90, 16, v122
    v_and_b32 v91, 0xffff0000, v122
    v_sub_f32 v90, v90, v88
    v_sub_f32 v91, v91, v88
    v_cvt_pk_bf16_f32 v122, v90, v91
    v_lshlrev_b32 v90, 16, v122
    v_and_b32 v91, 0xffff0000, v122
    v_mul_f32 v90, v90, v89
    v_mul_f32 v91, v91, v89
    v_cvt_pk_bf16_f32 v122, v90, v91
    v_lshlrev_b32 v90, 16, v123
    v_and_b32 v91, 0xffff0000, v123
    v_sub_f32 v90, v90, v88
    v_sub_f32 v91, v91, v88
    v_cvt_pk_bf16_f32 v123, v90, v91
    v_lshlrev_b32 v90, 16, v123
    v_and_b32 v91, 0xffff0000, v123
    v_mul_f32 v90, v90, v89
    v_mul_f32 v91, v91, v89
    v_cvt_pk_bf16_f32 v123, v90, v91
    ds_write_b128 v4, v[120:123] offset:12288
    v_lshlrev_b32 v90, 16, v124
    v_and_b32 v91, 0xffff0000, v124
    v_sub_f32 v90, v90, v88
    v_sub_f32 v91, v91, v88
    v_cvt_pk_bf16_f32 v124, v90, v91
    v_lshlrev_b32 v90, 16, v124
    v_and_b32 v91, 0xffff0000, v124
    v_mul_f32 v90, v90, v89
    v_mul_f32 v91, v91, v89
    v_cvt_pk_bf16_f32 v124, v90, v91
    v_lshlrev_b32 v90, 16, v125
    v_and_b32 v91, 0xffff0000, v125
    v_sub_f32 v90, v90, v88
    v_sub_f32 v91, v91, v88
    v_cvt_pk_bf16_f32 v125, v90, v91
    v_lshlrev_b32 v90, 16, v125
    v_and_b32 v91, 0xffff0000, v125
    v_mul_f32 v90, v90, v89
    v_mul_f32 v91, v91, v89
    v_cvt_pk_bf16_f32 v125, v90, v91
    v_lshlrev_b32 v90, 16, v126
    v_and_b32 v91, 0xffff0000, v126
    v_sub_f32 v90, v90, v88
    v_sub_f32 v91, v91, v88
    v_cvt_pk_bf16_f32 v126, v90, v91
    v_lshlrev_b32 v90, 16, v126
    v_and_b32 v91, 0xffff0000, v126
    v_mul_f32 v90, v90, v89
    v_mul_f32 v91, v91, v89
    v_cvt_pk_bf16_f32 v126, v90, v91
    v_lshlrev_b32 v90, 16, v127
    v_and_b32 v91, 0xffff0000, v127
    v_sub_f32 v90, v90, v88
    v_sub_f32 v91, v91, v88
    v_cvt_pk_bf16_f32 v127, v90, v91
    v_lshlrev_b32 v90, 16, v127
    v_and_b32 v91, 0xffff0000, v127
    v_mul_f32 v90, v90, v89
    v_mul_f32 v91, v91, v89
    v_cvt_pk_bf16_f32 v127, v90, v91
    ds_write_b128 v4, v[124:127] offset:14336
    s_lshr_b32 s36, s21, 1
    s_lshl_b32 s36, s36, 14
    s_xor_b32 s37, s36, 16384
    v_add_u32 v80, s36, v5
    v_add_u32 v81, s37, v5
    v_add_u32 v82, s36, v6
    v_add_u32 v83, s37, v6
    s_mov_b32 s31, 0
    s_waitcnt vmcnt(24)
    s_barrier
    ds_read_b64_tr_b16 a[128:129], v20 offset:0
    ds_read_b64_tr_b16 a[130:131], v20 offset:1024
    ds_read_b64_tr_b16 a[132:133], v21 offset:0
    ds_read_b64_tr_b16 a[134:135], v21 offset:1024
    ds_read_b64_tr_b16 a[136:137], v22 offset:0
    ds_read_b64_tr_b16 a[138:139], v22 offset:1024
    ds_read_b64_tr_b16 a[140:141], v23 offset:0
    ds_read_b64_tr_b16 a[142:143], v23 offset:1024
    ds_read_b64_tr_b16 a[144:145], v24 offset:0
    ds_read_b64_tr_b16 a[146:147], v24 offset:1024
    ds_read_b64_tr_b16 a[148:149], v25 offset:0
    ds_read_b64_tr_b16 a[150:151], v25 offset:1024
    s_waitcnt lgkmcnt(4)
    ds_read_b64_tr_b16 a[152:153], v26 offset:0
    ds_read_b64_tr_b16 a[154:155], v26 offset:1024
    ds_read_b64_tr_b16 a[156:157], v27 offset:0
    ds_read_b64_tr_b16 a[158:159], v27 offset:1024
    s_waitcnt lgkmcnt(0)
    s_barrier
    s_mov_b32 s96, s48
    s_and_b32 s97, s49, 0xffff
    s_mov_b32 s98, 0x400000
    s_mov_b32 s99, 0x20000
    s_add_u32 m0, s28, 0
    s_add_u32 s37, s3, 0x0
    buffer_load_dwordx4 v16, s[96:99], s37 offen lds
    s_add_u32 m0, s28, 1024
    s_add_u32 s37, s3, 0x8000
    buffer_load_dwordx4 v17, s[96:99], s37 offen lds
    s_add_u32 m0, s28, 2048
    s_add_u32 s37, s3, 0x10000
    buffer_load_dwordx4 v18, s[96:99], s37 offen lds
    s_add_u32 m0, s28, 3072
    s_add_u32 s37, s3, 0x18000
    buffer_load_dwordx4 v19, s[96:99], s37 offen lds
    s_add_u32 m0, s28, 4096
    s_add_u32 s37, s3, 0x20000
    buffer_load_dwordx4 v16, s[96:99], s37 offen lds
    s_add_u32 m0, s28, 5120
    s_add_u32 s37, s3, 0x28000
    buffer_load_dwordx4 v17, s[96:99], s37 offen lds
    s_add_u32 m0, s28, 6144
    s_add_u32 s37, s3, 0x30000
    buffer_load_dwordx4 v18, s[96:99], s37 offen lds
    s_add_u32 m0, s28, 7168
    s_add_u32 s37, s3, 0x38000
    buffer_load_dwordx4 v19, s[96:99], s37 offen lds
    s_waitcnt vmcnt(24)
    s_barrier
    ds_read_b64_tr_b16 a[160:161], v20 offset:8192
    ds_read_b64_tr_b16 a[162:163], v20 offset:9216
    ds_read_b64_tr_b16 a[164:165], v21 offset:8192
    ds_read_b64_tr_b16 a[166:167], v21 offset:9216
    ds_read_b64_tr_b16 a[168:169], v22 offset:8192
    ds_read_b64_tr_b16 a[170:171], v22 offset:9216
    ds_read_b64_tr_b16 a[172:173], v23 offset:8192
    ds_read_b64_tr_b16 a[174:175], v23 offset:9216
    ds_read_b64_tr_b16 a[176:177], v24 offset:8192
    ds_read_b64_tr_b16 a[178:179], v24 offset:9216
    ds_read_b64_tr_b16 a[180:181], v25 offset:8192
    ds_read_b64_tr_b16 a[182:183], v25 offset:9216
    s_waitcnt lgkmcnt(4)
    ds_read_b64_tr_b16 a[184:185], v26 offset:8192
    ds_read_b64_tr_b16 a[186:187], v26 offset:9216
    ds_read_b64_tr_b16 a[188:189], v27 offset:8192
    ds_read_b64_tr_b16 a[190:191], v27 offset:9216
    s_waitcnt lgkmcnt(0)
    s_barrier
    s_add_u32 m0, s28, 8192
    s_add_u32 s37, s3, 0x100000
    buffer_load_dwordx4 v16, s[96:99], s37 offen lds
    s_add_u32 m0, s28, 9216
    s_add_u32 s37, s3, 0x108000
    buffer_load_dwordx4 v17, s[96:99], s37 offen lds
    s_add_u32 m0, s28, 10240
    s_add_u32 s37, s3, 0x110000
    buffer_load_dwordx4 v18, s[96:99], s37 offen lds
    s_add_u32 m0, s28, 11264
    s_add_u32 s37, s3, 0x118000
    buffer_load_dwordx4 v19, s[96:99], s37 offen lds
    s_add_u32 m0, s28, 12288
    s_add_u32 s37, s3, 0x120000
    buffer_load_dwordx4 v16, s[96:99], s37 offen lds
    s_add_u32 m0, s28, 13312
    s_add_u32 s37, s3, 0x128000
    buffer_load_dwordx4 v17, s[96:99], s37 offen lds
    s_add_u32 m0, s28, 14336
    s_add_u32 s37, s3, 0x130000
    buffer_load_dwordx4 v18, s[96:99], s37 offen lds
    s_add_u32 m0, s28, 15360
    s_add_u32 s37, s3, 0x138000
    buffer_load_dwordx4 v19, s[96:99], s37 offen lds
    s_waitcnt vmcnt(24)
    s_barrier
    ds_read_b64_tr_b16 a[192:193], v20 offset:16384
    ds_read_b64_tr_b16 a[194:195], v20 offset:17408
    ds_read_b64_tr_b16 a[196:197], v21 offset:16384
    ds_read_b64_tr_b16 a[198:199], v21 offset:17408
    ds_read_b64_tr_b16 a[200:201], v22 offset:16384
    ds_read_b64_tr_b16 a[202:203], v22 offset:17408
    ds_read_b64_tr_b16 a[204:205], v23 offset:16384
    ds_read_b64_tr_b16 a[206:207], v23 offset:17408
    ds_read_b64_tr_b16 a[208:209], v24 offset:16384
    ds_read_b64_tr_b16 a[210:211], v24 offset:17408
    ds_read_b64_tr_b16 a[212:213], v25 offset:16384
    ds_read_b64_tr_b16 a[214:215], v25 offset:17408
    s_waitcnt lgkmcnt(4)
    ds_read_b64_tr_b16 a[216:217], v26 offset:16384
    ds_read_b64_tr_b16 a[218:219], v26 offset:17408
    ds_read_b64_tr_b16 a[220:221], v27 offset:16384
    ds_read_b64_tr_b16 a[222:223], v27 offset:17408
    s_waitcnt lgkmcnt(0)
    s_barrier
    s_add_u32 m0, s28, 16384
    s_add_u32 s37, s3, 0x200000
    buffer_load_dwordx4 v16, s[96:99], s37 offen lds
    s_add_u32 m0, s28, 17408
    s_add_u32 s37, s3, 0x208000
    buffer_load_dwordx4 v17, s[96:99], s37 offen lds
    s_add_u32 m0, s28, 18432
    s_add_u32 s37, s3, 0x210000
    buffer_load_dwordx4 v18, s[96:99], s37 offen lds
    s_add_u32 m0, s28, 19456
    s_add_u32 s37, s3, 0x218000
    buffer_load_dwordx4 v19, s[96:99], s37 offen lds
    s_add_u32 m0, s28, 20480
    s_add_u32 s37, s3, 0x220000
    buffer_load_dwordx4 v16, s[96:99], s37 offen lds
    s_add_u32 m0, s28, 21504
    s_add_u32 s37, s3, 0x228000
    buffer_load_dwordx4 v17, s[96:99], s37 offen lds
    s_add_u32 m0, s28, 22528
    s_add_u32 s37, s3, 0x230000
    buffer_load_dwordx4 v18, s[96:99], s37 offen lds
    s_add_u32 m0, s28, 23552
    s_add_u32 s37, s3, 0x238000
    buffer_load_dwordx4 v19, s[96:99], s37 offen lds
    s_waitcnt vmcnt(24)
    s_barrier
    ds_read_b64_tr_b16 a[224:225], v20 offset:24576
    ds_read_b64_tr_b16 a[226:227], v20 offset:25600
    ds_read_b64_tr_b16 a[228:229], v21 offset:24576
    ds_read_b64_tr_b16 a[230:231], v21 offset:25600
    ds_read_b64_tr_b16 a[232:233], v22 offset:24576
    ds_read_b64_tr_b16 a[234:235], v22 offset:25600
    ds_read_b64_tr_b16 a[236:237], v23 offset:24576
    ds_read_b64_tr_b16 a[238:239], v23 offset:25600
    ds_read_b64_tr_b16 a[240:241], v24 offset:24576
    ds_read_b64_tr_b16 a[242:243], v24 offset:25600
    ds_read_b64_tr_b16 a[244:245], v25 offset:24576
    ds_read_b64_tr_b16 a[246:247], v25 offset:25600
    s_waitcnt lgkmcnt(4)
    ds_read_b64_tr_b16 a[248:249], v26 offset:24576
    ds_read_b64_tr_b16 a[250:251], v26 offset:25600
    ds_read_b64_tr_b16 a[252:253], v27 offset:24576
    ds_read_b64_tr_b16 a[254:255], v27 offset:25600
    s_waitcnt lgkmcnt(0)
    s_barrier
    s_add_u32 m0, s28, 24576
    s_add_u32 s37, s3, 0x300000
    buffer_load_dwordx4 v16, s[96:99], s37 offen lds
    s_add_u32 m0, s28, 25600
    s_add_u32 s37, s3, 0x308000
    buffer_load_dwordx4 v17, s[96:99], s37 offen lds
    s_add_u32 m0, s28, 26624
    s_add_u32 s37, s3, 0x310000
    buffer_load_dwordx4 v18, s[96:99], s37 offen lds
    s_add_u32 m0, s28, 27648
    s_add_u32 s37, s3, 0x318000
    buffer_load_dwordx4 v19, s[96:99], s37 offen lds
    s_add_u32 m0, s28, 28672
    s_add_u32 s37, s3, 0x320000
    buffer_load_dwordx4 v16, s[96:99], s37 offen lds
    s_add_u32 m0, s28, 29696
    s_add_u32 s37, s3, 0x328000
    buffer_load_dwordx4 v17, s[96:99], s37 offen lds
    s_add_u32 m0, s28, 30720
    s_add_u32 s37, s3, 0x330000
    buffer_load_dwordx4 v18, s[96:99], s37 offen lds
    s_add_u32 m0, s28, 31744
    s_add_u32 s37, s3, 0x338000
    buffer_load_dwordx4 v19, s[96:99], s37 offen lds
    ds_read_b128 v[64:67], v80 offset:0
    ds_read_b128 v[68:71], v81 offset:0
    ds_read_b128 v[72:75], v82 offset:1024
    ds_read_b128 v[76:79], v83 offset:1024
    s_waitcnt lgkmcnt(2)
    v_mfma_f32_16x16x32_bf16 v[32:35], a[128:131], v[64:67], 0
    v_mfma_f32_16x16x32_bf16 v[36:39], a[128:131], v[68:71], 0
    v_mfma_f32_16x16x32_bf16 v[40:43], a[132:135], v[64:67], 0
    v_mfma_f32_16x16x32_bf16 v[44:47], a[132:135], v[68:71], 0
    v_mfma_f32_16x16x32_bf16 v[48:51], v[64:67], v[128:131], 0
    v_mfma_f32_16x16x32_bf16 v[56:59], v[68:71], v[128:131], 0
    v_mfma_f32_16x16x32_bf16 v[52:55], v[64:67], v[132:135], 0
    v_mfma_f32_16x16x32_bf16 v[60:63], v[68:71], v[132:135], 0
    ds_read_b128 v[64:67], v80 offset:2048
    ds_read_b128 v[68:71], v81 offset:2048
    s_waitcnt lgkmcnt(2)
    v_mfma_f32_16x16x32_bf16 v[32:35], a[136:139], v[72:75], v[32:35]
    v_mfma_f32_16x16x32_bf16 v[36:39], a[136:139], v[76:79], v[36:39]
    v_mfma_f32_16x16x32_bf16 v[40:43], a[140:143], v[72:75], v[40:43]
    v_mfma_f32_16x16x32_bf16 v[44:47], a[140:143], v[76:79], v[44:47]
    v_mfma_f32_16x16x32_bf16 v[48:51], v[72:75], v[136:139], v[48:51]
    v_mfma_f32_16x16x32_bf16 v[56:59], v[76:79], v[136:139], v[56:59]
    v_mfma_f32_16x16x32_bf16 v[52:55], v[72:75], v[140:143], v[52:55]
    v_mfma_f32_16x16x32_bf16 v[60:63], v[76:79], v[140:143], v[60:63]
    ds_read_b128 v[72:75], v82 offset:3072
    ds_read_b128 v[76:79], v83 offset:3072
    s_waitcnt lgkmcnt(2)
    v_mfma_f32_16x16x32_bf16 v[32:35], a[144:147], v[64:67], v[32:35]
    v_mfma_f32_16x16x32_bf16 v[36:39], a[144:147], v[68:71], v[36:39]
    v_mfma_f32_16x16x32_bf16 v[40:43], a[148:151], v[64:67], v[40:43]
    v_mfma_f32_16x16x32_bf16 v[44:47], a[148:151], v[68:71], v[44:47]
    v_mfma_f32_16x16x32_bf16 v[48:51], v[64:67], v[144:147], v[48:51]
    v_mfma_f32_16x16x32_bf16 v[56:59], v[68:71], v[144:147], v[56:59]
    v_mfma_f32_16x16x32_bf16 v[52:55], v[64:67], v[148:151], v[52:55]
    v_mfma_f32_16x16x32_bf16 v[60:63], v[68:71], v[148:151], v[60:63]
    ds_read_b128 v[64:67], v80 offset:4096
    ds_read_b128 v[68:71], v81 offset:4096
    s_waitcnt lgkmcnt(2)
    v_mfma_f32_16x16x32_bf16 v[32:35], a[152:155], v[72:75], v[32:35]
    v_mfma_f32_16x16x32_bf16 v[36:39], a[152:155], v[76:79], v[36:39]
    v_mfma_f32_16x16x32_bf16 v[40:43], a[156:159], v[72:75], v[40:43]
    v_mfma_f32_16x16x32_bf16 v[44:47], a[156:159], v[76:79], v[44:47]
    v_mfma_f32_16x16x32_bf16 v[48:51], v[72:75], v[152:155], v[48:51]
    v_mfma_f32_16x16x32_bf16 v[56:59], v[76:79], v[152:155], v[56:59]
    v_mfma_f32_16x16x32_bf16 v[52:55], v[72:75], v[156:159], v[52:55]
    v_mfma_f32_16x16x32_bf16 v[60:63], v[76:79], v[156:159], v[60:63]
    ds_read_b128 v[72:75], v82 offset:5120
    ds_read_b128 v[76:79], v83 offset:5120
    s_waitcnt lgkmcnt(2)
    v_mfma_f32_16x16x32_bf16 v[32:35], a[160:163], v[64:67], v[32:35]
    v_mfma_f32_16x16x32_bf16 v[36:39], a[160:163], v[68:71], v[36:39]
    v_mfma_f32_16x16x32_bf16 v[40:43], a[164:167], v[64:67], v[40:43]
    v_mfma_f32_16x16x32_bf16 v[44:47], a[164:167], v[68:71], v[44:47]
    v_mfma_f32_16x16x32_bf16 v[48:51], v[64:67], v[160:163], v[48:51]
    v_mfma_f32_16x16x32_bf16 v[56:59], v[68:71], v[160:163], v[56:59]
    v_mfma_f32_16x16x32_bf16 v[52:55], v[64:67], v[164:167], v[52:55]
    v_mfma_f32_16x16x32_bf16 v[60:63], v[68:71], v[164:167], v[60:63]
    ds_read_b128 v[64:67], v80 offset:6144
    ds_read_b128 v[68:71], v81 offset:6144
    s_waitcnt lgkmcnt(2)
    v_mfma_f32_16x16x32_bf16 v[32:35], a[168:171], v[72:75], v[32:35]
    v_mfma_f32_16x16x32_bf16 v[36:39], a[168:171], v[76:79], v[36:39]
    v_mfma_f32_16x16x32_bf16 v[40:43], a[172:175], v[72:75], v[40:43]
    v_mfma_f32_16x16x32_bf16 v[44:47], a[172:175], v[76:79], v[44:47]
    v_mfma_f32_16x16x32_bf16 v[48:51], v[72:75], v[168:171], v[48:51]
    v_mfma_f32_16x16x32_bf16 v[56:59], v[76:79], v[168:171], v[56:59]
    v_mfma_f32_16x16x32_bf16 v[52:55], v[72:75], v[172:175], v[52:55]
    v_mfma_f32_16x16x32_bf16 v[60:63], v[76:79], v[172:175], v[60:63]
    ds_read_b128 v[72:75], v82 offset:7168
    ds_read_b128 v[76:79], v83 offset:7168
    s_waitcnt lgkmcnt(2)
    v_mfma_f32_16x16x32_bf16 v[32:35], a[176:179], v[64:67], v[32:35]
    v_mfma_f32_16x16x32_bf16 v[36:39], a[176:179], v[68:71], v[36:39]
    v_mfma_f32_16x16x32_bf16 v[40:43], a[180:183], v[64:67], v[40:43]
    v_mfma_f32_16x16x32_bf16 v[44:47], a[180:183], v[68:71], v[44:47]
    v_mfma_f32_16x16x32_bf16 v[48:51], v[64:67], v[176:179], v[48:51]
    v_mfma_f32_16x16x32_bf16 v[56:59], v[68:71], v[176:179], v[56:59]
    v_mfma_f32_16x16x32_bf16 v[52:55], v[64:67], v[180:183], v[52:55]
    v_mfma_f32_16x16x32_bf16 v[60:63], v[68:71], v[180:183], v[60:63]
    ds_read_b128 v[64:67], v80 offset:8192
    ds_read_b128 v[68:71], v81 offset:8192
    s_waitcnt lgkmcnt(2)
    v_mfma_f32_16x16x32_bf16 v[32:35], a[184:187], v[72:75], v[32:35]
    v_mfma_f32_16x16x32_bf16 v[36:39], a[184:187], v[76:79], v[36:39]
    v_mfma_f32_16x16x32_bf16 v[40:43], a[188:191], v[72:75], v[40:43]
    v_mfma_f32_16x16x32_bf16 v[44:47], a[188:191], v[76:79], v[44:47]
    v_mfma_f32_16x16x32_bf16 v[48:51], v[72:75], v[184:187], v[48:51]
    v_mfma_f32_16x16x32_bf16 v[56:59], v[76:79], v[184:187], v[56:59]
    v_mfma_f32_16x16x32_bf16 v[52:55], v[72:75], v[188:191], v[52:55]
    v_mfma_f32_16x16x32_bf16 v[60:63], v[76:79], v[188:191], v[60:63]
    ds_read_b128 v[72:75], v82 offset:9216
    ds_read_b128 v[76:79], v83 offset:9216
    s_waitcnt lgkmcnt(2)
    v_mfma_f32_16x16x32_bf16 v[32:35], a[192:195], v[64:67], v[32:35]
    v_mfma_f32_16x16x32_bf16 v[36:39], a[192:195], v[68:71], v[36:39]
    v_mfma_f32_16x16x32_bf16 v[40:43], a[196:199], v[64:67], v[40:43]
    v_mfma_f32_16x16x32_bf16 v[44:47], a[196:199], v[68:71], v[44:47]
    v_mfma_f32_16x16x32_bf16 v[48:51], v[64:67], v[192:195], v[48:51]
    v_mfma_f32_16x16x32_bf16 v[56:59], v[68:71], v[192:195], v[56:59]
    v_mfma_f32_16x16x32_bf16 v[52:55], v[64:67], v[196:199], v[52:55]
    v_mfma_f32_16x16x32_bf16 v[60:63], v[68:71], v[196:199], v[60:63]
    ds_read_b128 v[64:67], v80 offset:10240
    ds_read_b128 v[68:71], v81 offset:10240
    s_waitcnt lgkmcnt(2)
    v_mfma_f32_16x16x32_bf16 v[32:35], a[200:203], v[72:75], v[32:35]
    v_mfma_f32_16x16x32_bf16 v[36:39], a[200:203], v[76:79], v[36:39]
    v_mfma_f32_16x16x32_bf16 v[40:43], a[204:207], v[72:75], v[40:43]
    v_mfma_f32_16x16x32_bf16 v[44:47], a[204:207], v[76:79], v[44:47]
    v_mfma_f32_16x16x32_bf16 v[48:51], v[72:75], v[200:203], v[48:51]
    v_mfma_f32_16x16x32_bf16 v[56:59], v[76:79], v[200:203], v[56:59]
    v_mfma_f32_16x16x32_bf16 v[52:55], v[72:75], v[204:207], v[52:55]
    v_mfma_f32_16x16x32_bf16 v[60:63], v[76:79], v[204:207], v[60:63]
    ds_read_b128 v[72:75], v82 offset:11264
    ds_read_b128 v[76:79], v83 offset:11264
    s_waitcnt lgkmcnt(2)
    v_mfma_f32_16x16x32_bf16 v[32:35], a[208:211], v[64:67], v[32:35]
    v_mfma_f32_16x16x32_bf16 v[36:39], a[208:211], v[68:71], v[36:39]
    v_mfma_f32_16x16x32_bf16 v[40:43], a[212:215], v[64:67], v[40:43]
    v_mfma_f32_16x16x32_bf16 v[44:47], a[212:215], v[68:71], v[44:47]
    v_mfma_f32_16x16x32_bf16 v[48:51], v[64:67], v[208:211], v[48:51]
    v_mfma_f32_16x16x32_bf16 v[56:59], v[68:71], v[208:211], v[56:59]
    v_mfma_f32_16x16x32_bf16 v[52:55], v[64:67], v[212:215], v[52:55]
    v_mfma_f32_16x16x32_bf16 v[60:63], v[68:71], v[212:215], v[60:63]
    ds_read_b128 v[64:67], v80 offset:12288
    ds_read_b128 v[68:71], v81 offset:12288
    s_waitcnt lgkmcnt(2)
    v_mfma_f32_16x16x32_bf16 v[32:35], a[216:219], v[72:75], v[32:35]
    v_mfma_f32_16x16x32_bf16 v[36:39], a[216:219], v[76:79], v[36:39]
    v_mfma_f32_16x16x32_bf16 v[40:43], a[220:223], v[72:75], v[40:43]
    v_mfma_f32_16x16x32_bf16 v[44:47], a[220:223], v[76:79], v[44:47]
    v_mfma_f32_16x16x32_bf16 v[48:51], v[72:75], v[216:219], v[48:51]
    v_mfma_f32_16x16x32_bf16 v[56:59], v[76:79], v[216:219], v[56:59]
    v_mfma_f32_16x16x32_bf16 v[52:55], v[72:75], v[220:223], v[52:55]
    v_mfma_f32_16x16x32_bf16 v[60:63], v[76:79], v[220:223], v[60:63]
    ds_read_b128 v[72:75], v82 offset:13312
    ds_read_b128 v[76:79], v83 offset:13312
    s_waitcnt lgkmcnt(2)
    v_mfma_f32_16x16x32_bf16 v[32:35], a[224:227], v[64:67], v[32:35]
    v_mfma_f32_16x16x32_bf16 v[36:39], a[224:227], v[68:71], v[36:39]
    v_mfma_f32_16x16x32_bf16 v[40:43], a[228:231], v[64:67], v[40:43]
    v_mfma_f32_16x16x32_bf16 v[44:47], a[228:231], v[68:71], v[44:47]
    v_mfma_f32_16x16x32_bf16 v[48:51], v[64:67], v[224:227], v[48:51]
    v_mfma_f32_16x16x32_bf16 v[56:59], v[68:71], v[224:227], v[56:59]
    v_mfma_f32_16x16x32_bf16 v[52:55], v[64:67], v[228:231], v[52:55]
    v_mfma_f32_16x16x32_bf16 v[60:63], v[68:71], v[228:231], v[60:63]
    ds_read_b128 v[64:67], v80 offset:14336
    ds_read_b128 v[68:71], v81 offset:14336
    s_waitcnt lgkmcnt(2)
    v_mfma_f32_16x16x32_bf16 v[32:35], a[232:235], v[72:75], v[32:35]
    v_mfma_f32_16x16x32_bf16 v[36:39], a[232:235], v[76:79], v[36:39]
    v_mfma_f32_16x16x32_bf16 v[40:43], a[236:239], v[72:75], v[40:43]
    v_mfma_f32_16x16x32_bf16 v[44:47], a[236:239], v[76:79], v[44:47]
    v_mfma_f32_16x16x32_bf16 v[48:51], v[72:75], v[232:235], v[48:51]
    v_mfma_f32_16x16x32_bf16 v[56:59], v[76:79], v[232:235], v[56:59]
    v_mfma_f32_16x16x32_bf16 v[52:55], v[72:75], v[236:239], v[52:55]
    v_mfma_f32_16x16x32_bf16 v[60:63], v[76:79], v[236:239], v[60:63]
    ds_read_b128 v[72:75], v82 offset:15360
    ds_read_b128 v[76:79], v83 offset:15360
    s_waitcnt lgkmcnt(2)
    v_mfma_f32_16x16x32_bf16 v[32:35], a[240:243], v[64:67], v[32:35]
    v_mfma_f32_16x16x32_bf16 v[36:39], a[240:243], v[68:71], v[36:39]
    v_mfma_f32_16x16x32_bf16 v[40:43], a[244:247], v[64:67], v[40:43]
    v_mfma_f32_16x16x32_bf16 v[44:47], a[244:247], v[68:71], v[44:47]
    v_mfma_f32_16x16x32_bf16 v[48:51], v[64:67], v[240:243], v[48:51]
    v_mfma_f32_16x16x32_bf16 v[56:59], v[68:71], v[240:243], v[56:59]
    v_mfma_f32_16x16x32_bf16 v[52:55], v[64:67], v[244:247], v[52:55]
    v_mfma_f32_16x16x32_bf16 v[60:63], v[68:71], v[244:247], v[60:63]
    s_waitcnt lgkmcnt(0)
    v_mfma_f32_16x16x32_bf16 v[32:35], a[248:251], v[72:75], v[32:35]
    v_mfma_f32_16x16x32_bf16 v[36:39], a[248:251], v[76:79], v[36:39]
    v_mfma_f32_16x16x32_bf16 v[40:43], a[252:255], v[72:75], v[40:43]
    v_mfma_f32_16x16x32_bf16 v[44:47], a[252:255], v[76:79], v[44:47]
    v_mfma_f32_16x16x32_bf16 v[48:51], v[72:75], v[248:251], v[48:51]
    v_mfma_f32_16x16x32_bf16 v[56:59], v[76:79], v[248:251], v[56:59]
    v_mfma_f32_16x16x32_bf16 v[52:55], v[72:75], v[252:255], v[52:55]
    v_mfma_f32_16x16x32_bf16 v[60:63], v[76:79], v[252:255], v[60:63]
    s_nop 0
    v_mul_f32 v32, s33, v32
    v_mul_f32 v33, s33, v33
    v_mul_f32 v34, s33, v34
    v_mul_f32 v35, s33, v35
    v_mul_f32 v36, s33, v36
    v_mul_f32 v37, s33, v37
    v_mul_f32 v38, s33, v38
    v_mul_f32 v39, s33, v39
    v_mul_f32 v40, s33, v40
    v_mul_f32 v41, s33, v41
    v_mul_f32 v42, s33, v42
    v_mul_f32 v43, s33, v43
    v_mul_f32 v44, s33, v44
    v_mul_f32 v45, s33, v45
    v_mul_f32 v46, s33, v46
    v_mul_f32 v47, s33, v47
    v_cvt_pk_bf16_f32 v88, v32, v40
    v_cvt_pk_bf16_f32 v89, v33, v41
    v_cvt_pk_bf16_f32 v90, v34, v42
    v_cvt_pk_bf16_f32 v91, v35, v43
    v_cvt_pk_bf16_f32 v92, v36, v44
    v_cvt_pk_bf16_f32 v93, v37, v45
    v_cvt_pk_bf16_f32 v94, v38, v46
    v_cvt_pk_bf16_f32 v95, v39, v47
    v_cvt_pk_bf16_f32 v96, v48, v49
    v_cvt_pk_bf16_f32 v97, v50, v51
    v_cvt_pk_bf16_f32 v98, v56, v57
    v_cvt_pk_bf16_f32 v99, v58, v59
    v_cvt_pk_bf16_f32 v100, v52, v53
    v_cvt_pk_bf16_f32 v101, v54, v55
    v_cvt_pk_bf16_f32 v102, v60, v61
    v_cvt_pk_bf16_f32 v103, v62, v63
    s_mul_i32 s24, s23, 0x82100
    s_lshl_b32 s36, s20, 14
    s_add_u32 s24, s24, s36
    s_add_u32 s24, s24, 0x1000000
    s_mov_b32 s30, s24
    s_lshr_b32 s36, s21, 1
    s_lshl_b32 s36, s36, 12
    s_xor_b32 s37, s36, 4096
    s_add_u32 s36, s36, s24
    s_add_u32 s37, s37, s24
    buffer_store_dwordx4 v[88:91], v9, s[8:11], s36 offen sc1
    buffer_store_dwordx4 v[92:95], v9, s[8:11], s37 offen sc1
    s_add_u32 s24, s24, 8192
    buffer_store_dwordx4 v[96:99], v2, s[8:11], s24 offen sc1
    buffer_store_dwordx4 v[100:103], v2, s[8:11], s24 offen offset:1024 sc1
    s_mul_i32 s25, s23, 0x82100
    s_lshl_b32 s36, s20, 2
    s_add_u32 s25, s25, s36
    s_add_u32 s25, s25, 0x1082000
    v_lshrrev_b32 v15, 2, v1
    v_and_b32 v15, 127, v15
L_WHS:
    buffer_load_dword v14, v15, s[16:19], 0 offen sc1
    s_add_u32 s32, s32, 1
    s_cmp_gt_u32 s32, 200000
    s_cbranch_scc1 L_WHS_done
    s_waitcnt vmcnt(0)
    v_cmp_eq_u32 vcc, 0, v14
    s_cbranch_vccnz L_WHS
L_WHS_done:
    s_waitcnt vmcnt(0)
    s_barrier
    v_cmp_ne_u32 vcc, 0, v0
    v_mov_b32 v15, 0x40000000
    v_mov_b32 v14, 1
    v_cndmask_b32 v15, v0, v15, vcc
    buffer_store_dword v14, v15, s[8:11], s25 offen sc1
    s_barrier
    ds_read_b64_tr_b16 a[0:1], v20 offset:0
    ds_read_b64_tr_b16 a[2:3], v20 offset:1024
    ds_read_b64_tr_b16 a[4:5], v21 offset:0
    ds_read_b64_tr_b16 a[6:7], v21 offset:1024
    ds_read_b64_tr_b16 a[8:9], v22 offset:0
    ds_read_b64_tr_b16 a[10:11], v22 offset:1024
    ds_read_b64_tr_b16 a[12:13], v23 offset:0
    ds_read_b64_tr_b16 a[14:15], v23 offset:1024
    ds_read_b64_tr_b16 a[16:17], v24 offset:0
    ds_read_b64_tr_b16 a[18:19], v24 offset:1024
    ds_read_b64_tr_b16 a[20:21], v25 offset:0
    ds_read_b64_tr_b16 a[22:23], v25 offset:1024
    s_waitcnt lgkmcnt(4)
    ds_read_b64_tr_b16 a[24:25], v26 offset:0
    ds_read_b64_tr_b16 a[26:27], v26 offset:1024
    ds_read_b64_tr_b16 a[28:29], v27 offset:0
    ds_read_b64_tr_b16 a[30:31], v27 offset:1024
    s_waitcnt lgkmcnt(0)
    s_barrier
    s_barrier
    ds_read_b64_tr_b16 a[32:33], v20 offset:8192
    ds_read_b64_tr_b16 a[34:35], v20 offset:9216
    ds_read_b64_tr_b16 a[36:37], v21 offset:8192
    ds_read_b64_tr_b16 a[38:39], v21 offset:9216
    ds_read_b64_tr_b16 a[40:41], v22 offset:8192
    ds_read_b64_tr_b16 a[42:43], v22 offset:9216
    ds_read_b64_tr_b16 a[44:45], v23 offset:8192
    ds_read_b64_tr_b16 a[46:47], v23 offset:9216
    ds_read_b64_tr_b16 a[48:49], v24 offset:8192
    ds_read_b64_tr_b16 a[50:51], v24 offset:9216
    ds_read_b64_tr_b16 a[52:53], v25 offset:8192
    ds_read_b64_tr_b16 a[54:55], v25 offset:9216
    s_waitcnt lgkmcnt(4)
    ds_read_b64_tr_b16 a[56:57], v26 offset:8192
    ds_read_b64_tr_b16 a[58:59], v26 offset:9216
    ds_read_b64_tr_b16 a[60:61], v27 offset:8192
    ds_read_b64_tr_b16 a[62:63], v27 offset:9216
    s_waitcnt lgkmcnt(0)
    s_barrier
    s_barrier
    ds_read_b64_tr_b16 a[64:65], v20 offset:16384
    ds_read_b64_tr_b16 a[66:67], v20 offset:17408
    ds_read_b64_tr_b16 a[68:69], v21 offset:16384
    ds_read_b64_tr_b16 a[70:71], v21 offset:17408
    ds_read_b64_tr_b16 a[72:73], v22 offset:16384
    ds_read_b64_tr_b16 a[74:75], v22 offset:17408
    ds_read_b64_tr_b16 a[76:77], v23 offset:16384
    ds_read_b64_tr_b16 a[78:79], v23 offset:17408
    ds_read_b64_tr_b16 a[80:81], v24 offset:16384
    ds_read_b64_tr_b16 a[82:83], v24 offset:17408
    ds_read_b64_tr_b16 a[84:85], v25 offset:16384
    ds_read_b64_tr_b16 a[86:87], v25 offset:17408
    s_waitcnt lgkmcnt(4)
    ds_read_b64_tr_b16 a[88:89], v26 offset:16384
    ds_read_b64_tr_b16 a[90:91], v26 offset:17408
    ds_read_b64_tr_b16 a[92:93], v27 offset:16384
    ds_read_b64_tr_b16 a[94:95], v27 offset:17408
    s_waitcnt lgkmcnt(0)
    s_barrier
    s_barrier
    ds_read_b64_tr_b16 a[96:97], v20 offset:24576
    ds_read_b64_tr_b16 a[98:99], v20 offset:25600
    ds_read_b64_tr_b16 a[100:101], v21 offset:24576
    ds_read_b64_tr_b16 a[102:103], v21 offset:25600
    ds_read_b64_tr_b16 a[104:105], v22 offset:24576
    ds_read_b64_tr_b16 a[106:107], v22 offset:25600
    ds_read_b64_tr_b16 a[108:109], v23 offset:24576
    ds_read_b64_tr_b16 a[110:111], v23 offset:25600
    ds_read_b64_tr_b16 a[112:113], v24 offset:24576
    ds_read_b64_tr_b16 a[114:115], v24 offset:25600
    ds_read_b64_tr_b16 a[116:117], v25 offset:24576
    ds_read_b64_tr_b16 a[118:119], v25 offset:25600
    s_waitcnt lgkmcnt(4)
    ds_read_b64_tr_b16 a[120:121], v26 offset:24576
    ds_read_b64_tr_b16 a[122:123], v26 offset:25600
    ds_read_b64_tr_b16 a[124:125], v27 offset:24576
    ds_read_b64_tr_b16 a[126:127], v27 offset:25600
    s_waitcnt lgkmcnt(0)
    s_barrier
L_P1:
    s_waitcnt vmcnt(6)
    s_barrier
    s_xor_b32 s31, s31, 32768
    s_add_u32 s24, s23, 6
    s_min_u32 s24, s24, 63
    s_lshl_b32 s36, s24, 15
    s_add_u32 s36, s36, 0x800000
    s_lshl_b32 s37, s21, 10
    s_add_u32 s37, s37, s31
    s_add_u32 m0, s37, 0
    s_add_u32 s38, s36, 0
    buffer_load_dwordx4 v9, s[8:11], s38 offen sc1 lds
    s_add_u32 m0, s37, 4096
    s_add_u32 s38, s36, 4096
    buffer_load_dwordx4 v9, s[8:11], s38 offen sc1 lds
    s_add_u32 m0, s37, 8192
    s_add_u32 s38, s36, 8192
    buffer_load_dwordx4 v9, s[8:11], s38 offen sc1 lds
    s_add_u32 m0, s37, 12288
    s_add_u32 s38, s36, 12288
    buffer_load_dwordx4 v9, s[8:11], s38 offen sc1 lds
    s_add_u32 m0, s37, 16384
    s_add_u32 s38, s36, 16384
    buffer_load_dwordx4 v9, s[8:11], s38 offen sc1 lds
    s_add_u32 m0, s37, 20480
    s_add_u32 s38, s36, 20480
    buffer_load_dwordx4 v9, s[8:11], s38 offen sc1 lds
    s_add_u32 m0, s37, 24576
    s_add_u32 s38, s36, 24576
    buffer_load_dwordx4 v9, s[8:11], s38 offen sc1 lds
    s_add_u32 m0, s37, 28672
    s_add_u32 s38, s36, 28672
    buffer_load_dwordx4 v9, s[8:11], s38 offen sc1 lds
    ds_read_b128 v[64:67], v80 offset:0
    ds_read_b128 v[68:71], v81 offset:0
    ds_read_b128 v[72:75], v82 offset:1024
    ds_read_b128 v[76:79], v83 offset:1024
    s_waitcnt lgkmcnt(2)
    v_mfma_f32_16x16x32_bf16 v[32:35], a[128:131], v[64:67], 0
    v_mfma_f32_16x16x32_bf16 v[36:39], a[128:131], v[68:71], 0
    v_mfma_f32_16x16x32_bf16 v[40:43], a[132:135], v[64:67], 0
    v_mfma_f32_16x16x32_bf16 v[44:47], a[132:135], v[68:71], 0
    v_mfma_f32_16x16x32_bf16 v[48:51], v[64:67], v[128:131], 0
    v_mfma_f32_16x16x32_bf16 v[56:59], v[68:71], v[128:131], 0
    v_mfma_f32_16x16x32_bf16 v[52:55], v[64:67], v[132:135], 0
    v_mfma_f32_16x16x32_bf16 v[60:63], v[68:71], v[132:135], 0
    v_mfma_f32_16x16x32_bf16 v[16:19], a[0:3], v[64:67], 0
    v_mfma_f32_16x16x32_bf16 v[20:23], a[0:3], v[68:71], 0
    v_mfma_f32_16x16x32_bf16 v[24:27], a[4:7], v[64:67], 0
    v_mfma_f32_16x16x32_bf16 v[28:31], a[4:7], v[68:71], 0
    ds_read_b128 v[64:67], v80 offset:2048
    ds_read_b128 v[68:71], v81 offset:2048
    s_waitcnt lgkmcnt(2)
    v_mfma_f32_16x16x32_bf16 v[32:35], a[136:139], v[72:75], v[32:35]
    v_mfma_f32_16x16x32_bf16 v[36:39], a[136:139], v[76:79], v[36:39]
    v_mfma_f32_16x16x32_bf16 v[40:43], a[140:143], v[72:75], v[40:43]
    v_mfma_f32_16x16x32_bf16 v[44:47], a[140:143], v[76:79], v[44:47]
    v_mfma_f32_16x16x32_bf16 v[48:51], v[72:75], v[136:139], v[48:51]
    v_mfma_f32_16x16x32_bf16 v[56:59], v[76:79], v[136:139], v[56:59]
    v_mfma_f32_16x16x32_bf16 v[52:55], v[72:75], v[140:143], v[52:55]
    v_mfma_f32_16x16x32_bf16 v[60:63], v[76:79], v[140:143], v[60:63]
    v_mfma_f32_16x16x32_bf16 v[16:19], a[8:11], v[72:75], v[16:19]
    v_mfma_f32_16x16x32_bf16 v[20:23], a[8:11], v[76:79], v[20:23]
    v_mfma_f32_16x16x32_bf16 v[24:27], a[12:15], v[72:75], v[24:27]
    v_mfma_f32_16x16x32_bf16 v[28:31], a[12:15], v[76:79], v[28:31]
    ds_read_b128 v[72:75], v82 offset:3072
    ds_read_b128 v[76:79], v83 offset:3072
    s_waitcnt lgkmcnt(2)
    v_mfma_f32_16x16x32_bf16 v[32:35], a[144:147], v[64:67], v[32:35]
    v_mfma_f32_16x16x32_bf16 v[36:39], a[144:147], v[68:71], v[36:39]
    v_mfma_f32_16x16x32_bf16 v[40:43], a[148:151], v[64:67], v[40:43]
    v_mfma_f32_16x16x32_bf16 v[44:47], a[148:151], v[68:71], v[44:47]
    v_mfma_f32_16x16x32_bf16 v[48:51], v[64:67], v[144:147], v[48:51]
    v_mfma_f32_16x16x32_bf16 v[56:59], v[68:71], v[144:147], v[56:59]
    v_mfma_f32_16x16x32_bf16 v[52:55], v[64:67], v[148:151], v[52:55]
    v_mfma_f32_16x16x32_bf16 v[60:63], v[68:71], v[148:151], v[60:63]
    v_mfma_f32_16x16x32_bf16 v[16:19], a[16:19], v[64:67], v[16:19]
    v_mfma_f32_16x16x32_bf16 v[20:23], a[16:19], v[68:71], v[20:23]
    v_mfma_f32_16x16x32_bf16 v[24:27], a[20:23], v[64:67], v[24:27]
    v_mfma_f32_16x16x32_bf16 v[28:31], a[20:23], v[68:71], v[28:31]
    ds_read_b128 v[64:67], v80 offset:4096
    ds_read_b128 v[68:71], v81 offset:4096
    s_waitcnt lgkmcnt(2)
    v_mfma_f32_16x16x32_bf16 v[32:35], a[152:155], v[72:75], v[32:35]
    v_mfma_f32_16x16x32_bf16 v[36:39], a[152:155], v[76:79], v[36:39]
    v_mfma_f32_16x16x32_bf16 v[40:43], a[156:159], v[72:75], v[40:43]
    v_mfma_f32_16x16x32_bf16 v[44:47], a[156:159], v[76:79], v[44:47]
    v_mfma_f32_16x16x32_bf16 v[48:51], v[72:75], v[152:155], v[48:51]
    v_mfma_f32_16x16x32_bf16 v[56:59], v[76:79], v[152:155], v[56:59]
    v_mfma_f32_16x16x32_bf16 v[52:55], v[72:75], v[156:159], v[52:55]
    v_mfma_f32_16x16x32_bf16 v[60:63], v[76:79], v[156:159], v[60:63]
    v_mfma_f32_16x16x32_bf16 v[16:19], a[24:27], v[72:75], v[16:19]
    v_mfma_f32_16x16x32_bf16 v[20:23], a[24:27], v[76:79], v[20:23]
    v_mfma_f32_16x16x32_bf16 v[24:27], a[28:31], v[72:75], v[24:27]
    v_mfma_f32_16x16x32_bf16 v[28:31], a[28:31], v[76:79], v[28:31]
    ds_read_b128 v[72:75], v82 offset:5120
    ds_read_b128 v[76:79], v83 offset:5120
    s_waitcnt lgkmcnt(2)
    v_mfma_f32_16x16x32_bf16 v[32:35], a[160:163], v[64:67], v[32:35]
    v_mfma_f32_16x16x32_bf16 v[36:39], a[160:163], v[68:71], v[36:39]
    v_mfma_f32_16x16x32_bf16 v[40:43], a[164:167], v[64:67], v[40:43]
    v_mfma_f32_16x16x32_bf16 v[44:47], a[164:167], v[68:71], v[44:47]
    v_mfma_f32_16x16x32_bf16 v[48:51], v[64:67], v[160:163], v[48:51]
    v_mfma_f32_16x16x32_bf16 v[56:59], v[68:71], v[160:163], v[56:59]
    v_mfma_f32_16x16x32_bf16 v[52:55], v[64:67], v[164:167], v[52:55]
    v_mfma_f32_16x16x32_bf16 v[60:63], v[68:71], v[164:167], v[60:63]
    v_mfma_f32_16x16x32_bf16 v[16:19], a[32:35], v[64:67], v[16:19]
    v_mfma_f32_16x16x32_bf16 v[20:23], a[32:35], v[68:71], v[20:23]
    v_mfma_f32_16x16x32_bf16 v[24:27], a[36:39], v[64:67], v[24:27]
    v_mfma_f32_16x16x32_bf16 v[28:31], a[36:39], v[68:71], v[28:31]
    ds_read_b128 v[64:67], v80 offset:6144
    ds_read_b128 v[68:71], v81 offset:6144
    s_waitcnt lgkmcnt(2)
    v_mfma_f32_16x16x32_bf16 v[32:35], a[168:171], v[72:75], v[32:35]
    v_mfma_f32_16x16x32_bf16 v[36:39], a[168:171], v[76:79], v[36:39]
    v_mfma_f32_16x16x32_bf16 v[40:43], a[172:175], v[72:75], v[40:43]
    v_mfma_f32_16x16x32_bf16 v[44:47], a[172:175], v[76:79], v[44:47]
    v_mfma_f32_16x16x32_bf16 v[48:51], v[72:75], v[168:171], v[48:51]
    v_mfma_f32_16x16x32_bf16 v[56:59], v[76:79], v[168:171], v[56:59]
    v_mfma_f32_16x16x32_bf16 v[52:55], v[72:75], v[172:175], v[52:55]
    v_mfma_f32_16x16x32_bf16 v[60:63], v[76:79], v[172:175], v[60:63]
    v_mfma_f32_16x16x32_bf16 v[16:19], a[40:43], v[72:75], v[16:19]
    v_mfma_f32_16x16x32_bf16 v[20:23], a[40:43], v[76:79], v[20:23]
    v_mfma_f32_16x16x32_bf16 v[24:27], a[44:47], v[72:75], v[24:27]
    v_mfma_f32_16x16x32_bf16 v[28:31], a[44:47], v[76:79], v[28:31]
    ds_read_b128 v[72:75], v82 offset:7168
    ds_read_b128 v[76:79], v83 offset:7168
    s_waitcnt lgkmcnt(2)
    s_waitcnt vmcnt(8)
    s_barrier
    v_cmp_ne_u32 vcc, 0, v0
    v_mov_b32 v15, 0x40000000
    v_mov_b32 v14, 1
    v_cndmask_b32 v15, v0, v15, vcc
    buffer_store_dword v14, v15, s[8:11], s25 offen sc1
    v_mfma_f32_16x16x32_bf16 v[32:35], a[176:179], v[64:67], v[32:35]
    v_mfma_f32_16x16x32_bf16 v[36:39], a[176:179], v[68:71], v[36:39]
    v_mfma_f32_16x16x32_bf16 v[40:43], a[180:183], v[64:67], v[40:43]
    v_mfma_f32_16x16x32_bf16 v[44:47], a[180:183], v[68:71], v[44:47]
    v_mfma_f32_16x16x32_bf16 v[48:51], v[64:67], v[176:179], v[48:51]
    v_mfma_f32_16x16x32_bf16 v[56:59], v[68:71], v[176:179], v[56:59]
    v_mfma_f32_16x16x32_bf16 v[52:55], v[64:67], v[180:183], v[52:55]
    v_mfma_f32_16x16x32_bf16 v[60:63], v[68:71], v[180:183], v[60:63]
    v_mfma_f32_16x16x32_bf16 v[16:19], a[48:51], v[64:67], v[16:19]
    v_mfma_f32_16x16x32_bf16 v[20:23], a[48:51], v[68:71], v[20:23]
    v_mfma_f32_16x16x32_bf16 v[24:27], a[52:55], v[64:67], v[24:27]
    v_mfma_f32_16x16x32_bf16 v[28:31], a[52:55], v[68:71], v[28:31]
    ds_read_b128 v[64:67], v80 offset:8192
    ds_read_b128 v[68:71], v81 offset:8192
    s_waitcnt lgkmcnt(2)
    v_mfma_f32_16x16x32_bf16 v[32:35], a[184:187], v[72:75], v[32:35]
    v_mfma_f32_16x16x32_bf16 v[36:39], a[184:187], v[76:79], v[36:39]
    v_mfma_f32_16x16x32_bf16 v[40:43], a[188:191], v[72:75], v[40:43]
    v_mfma_f32_16x16x32_bf16 v[44:47], a[188:191], v[76:79], v[44:47]
    v_mfma_f32_16x16x32_bf16 v[48:51], v[72:75], v[184:187], v[48:51]
    v_mfma_f32_16x16x32_bf16 v[56:59], v[76:79], v[184:187], v[56:59]
    v_mfma_f32_16x16x32_bf16 v[52:55], v[72:75], v[188:191], v[52:55]
    v_mfma_f32_16x16x32_bf16 v[60:63], v[76:79], v[188:191], v[60:63]
    v_mfma_f32_16x16x32_bf16 v[16:19], a[56:59], v[72:75], v[16:19]
    v_mfma_f32_16x16x32_bf16 v[20:23], a[56:59], v[76:79], v[20:23]
    v_mfma_f32_16x16x32_bf16 v[24:27], a[60:63], v[72:75], v[24:27]
    v_mfma_f32_16x16x32_bf16 v[28:31], a[60:63], v[76:79], v[28:31]
    ds_read_b128 v[72:75], v82 offset:9216
    ds_read_b128 v[76:79], v83 offset:9216
    s_waitcnt lgkmcnt(2)
    v_mfma_f32_16x16x32_bf16 v[32:35], a[192:195], v[64:67], v[32:35]
    v_mfma_f32_16x16x32_bf16 v[36:39], a[192:195], v[68:71], v[36:39]
    v_mfma_f32_16x16x32_bf16 v[40:43], a[196:199], v[64:67], v[40:43]
    v_mfma_f32_16x16x32_bf16 v[44:47], a[196:199], v[68:71], v[44:47]
    v_mfma_f32_16x16x32_bf16 v[48:51], v[64:67], v[192:195], v[48:51]
    v_mfma_f32_16x16x32_bf16 v[56:59], v[68:71], v[192:195], v[56:59]
    v_mfma_f32_16x16x32_bf16 v[52:55], v[64:67], v[196:199], v[52:55]
    v_mfma_f32_16x16x32_bf16 v[60:63], v[68:71], v[196:199], v[60:63]
    v_mfma_f32_16x16x32_bf16 v[16:19], a[64:67], v[64:67], v[16:19]
    v_mfma_f32_16x16x32_bf16 v[20:23], a[64:67], v[68:71], v[20:23]
    v_mfma_f32_16x16x32_bf16 v[24:27], a[68:71], v[64:67], v[24:27]
    v_mfma_f32_16x16x32_bf16 v[28:31], a[68:71], v[68:71], v[28:31]
    ds_read_b128 v[64:67], v80 offset:10240
    ds_read_b128 v[68:71], v81 offset:10240
    s_waitcnt lgkmcnt(2)
    v_mfma_f32_16x16x32_bf16 v[32:35], a[200:203], v[72:75], v[32:35]
    v_mfma_f32_16x16x32_bf16 v[36:39], a[200:203], v[76:79], v[36:39]
    v_mfma_f32_16x16x32_bf16 v[40:43], a[204:207], v[72:75], v[40:43]
    v_mfma_f32_16x16x32_bf16 v[44:47], a[204:207], v[76:79], v[44:47]
    v_mfma_f32_16x16x32_bf16 v[48:51], v[72:75], v[200:203], v[48:51]
    v_mfma_f32_16x16x32_bf16 v[56:59], v[76:79], v[200:203], v[56:59]
    v_mfma_f32_16x16x32_bf16 v[52:55], v[72:75], v[204:207], v[52:55]
    v_mfma_f32_16x16x32_bf16 v[60:63], v[76:79], v[204:207], v[60:63]
    v_mfma_f32_16x16x32_bf16 v[16:19], a[72:75], v[72:75], v[16:19]
    v_mfma_f32_16x16x32_bf16 v[20:23], a[72:75], v[76:79], v[20:23]
    v_mfma_f32_16x16x32_bf16 v[24:27], a[76:79], v[72:75], v[24:27]
    v_mfma_f32_16x16x32_bf16 v[28:31], a[76:79], v[76:79], v[28:31]
    ds_read_b128 v[72:75], v82 offset:11264
    ds_read_b128 v[76:79], v83 offset:11264
    s_waitcnt lgkmcnt(2)
    v_mfma_f32_16x16x32_bf16 v[32:35], a[208:211], v[64:67], v[32:35]
    v_mfma_f32_16x16x32_bf16 v[36:39], a[208:211], v[68:71], v[36:39]
    v_mfma_f32_16x16x32_bf16 v[40:43], a[212:215], v[64:67], v[40:43]
    v_mfma_f32_16x16x32_bf16 v[44:47], a[212:215], v[68:71], v[44:47]
    v_mfma_f32_16x16x32_bf16 v[48:51], v[64:67], v[208:211], v[48:51]
    v_mfma_f32_16x16x32_bf16 v[56:59], v[68:71], v[208:211], v[56:59]
    v_mfma_f32_16x16x32_bf16 v[52:55], v[64:67], v[212:215], v[52:55]
    v_mfma_f32_16x16x32_bf16 v[60:63], v[68:71], v[212:215], v[60:63]
    v_mfma_f32_16x16x32_bf16 v[16:19], a[80:83], v[64:67], v[16:19]
    v_mfma_f32_16x16x32_bf16 v[20:23], a[80:83], v[68:71], v[20:23]
    v_mfma_f32_16x16x32_bf16 v[24:27], a[84:87], v[64:67], v[24:27]
    v_mfma_f32_16x16x32_bf16 v[28:31], a[84:87], v[68:71], v[28:31]
    ds_read_b128 v[64:67], v80 offset:12288
    ds_read_b128 v[68:71], v81 offset:12288
    s_waitcnt lgkmcnt(2)
    v_mfma_f32_16x16x32_bf16 v[32:35], a[216:219], v[72:75], v[32:35]
    v_mfma_f32_16x16x32_bf16 v[36:39], a[216:219], v[76:79], v[36:39]
    v_mfma_f32_16x16x32_bf16 v[40:43], a[220:223], v[72:75], v[40:43]
    v_mfma_f32_16x16x32_bf16 v[44:47], a[220:223], v[76:79], v[44:47]
    v_mfma_f32_16x16x32_bf16 v[48:51], v[72:75], v[216:219], v[48:51]
    v_mfma_f32_16x16x32_bf16 v[56:59], v[76:79], v[216:219], v[56:59]
    v_mfma_f32_16x16x32_bf16 v[52:55], v[72:75], v[220:223], v[52:55]
    v_mfma_f32_16x16x32_bf16 v[60:63], v[76:79], v[220:223], v[60:63]
    v_mfma_f32_16x16x32_bf16 v[16:19], a[88:91], v[72:75], v[16:19]
    v_mfma_f32_16x16x32_bf16 v[20:23], a[88:91], v[76:79], v[20:23]
    v_mfma_f32_16x16x32_bf16 v[24:27], a[92:95], v[72:75], v[24:27]
    v_mfma_f32_16x16x32_bf16 v[28:31], a[92:95], v[76:79], v[28:31]
    ds_read_b128 v[72:75], v82 offset:13312
    ds_read_b128 v[76:79], v83 offset:13312
    s_waitcnt lgkmcnt(2)
    v_mfma_f32_16x16x32_bf16 v[32:35], a[224:227], v[64:67], v[32:35]
    v_mfma_f32_16x16x32_bf16 v[36:39], a[224:227], v[68:71], v[36:39]
    v_mfma_f32_16x16x32_bf16 v[40:43], a[228:231], v[64:67], v[40:43]
    v_mfma_f32_16x16x32_bf16 v[44:47], a[228:231], v[68:71], v[44:47]
    v_mfma_f32_16x16x32_bf16 v[48:51], v[64:67], v[224:227], v[48:51]
    v_mfma_f32_16x16x32_bf16 v[56:59], v[68:71], v[224:227], v[56:59]
    v_mfma_f32_16x16x32_bf16 v[52:55], v[64:67], v[228:231], v[52:55]
    v_mfma_f32_16x16x32_bf16 v[60:63], v[68:71], v[228:231], v[60:63]
    v_mfma_f32_16x16x32_bf16 v[16:19], a[96:99], v[64:67], v[16:19]
    v_mfma_f32_16x16x32_bf16 v[20:23], a[96:99], v[68:71], v[20:23]
    v_mfma_f32_16x16x32_bf16 v[24:27], a[100:103], v[64:67], v[24:27]
    v_mfma_f32_16x16x32_bf16 v[28:31], a[100:103], v[68:71], v[28:31]
    ds_read_b128 v[64:67], v80 offset:14336
    ds_read_b128 v[68:71], v81 offset:14336
    s_waitcnt lgkmcnt(2)
    v_mfma_f32_16x16x32_bf16 v[32:35], a[232:235], v[72:75], v[32:35]
    v_mfma_f32_16x16x32_bf16 v[36:39], a[232:235], v[76:79], v[36:39]
    v_mfma_f32_16x16x32_bf16 v[40:43], a[236:239], v[72:75], v[40:43]
    v_mfma_f32_16x16x32_bf16 v[44:47], a[236:239], v[76:79], v[44:47]
    v_mfma_f32_16x16x32_bf16 v[48:51], v[72:75], v[232:235], v[48:51]
    v_mfma_f32_16x16x32_bf16 v[56:59], v[76:79], v[232:235], v[56:59]
    v_mfma_f32_16x16x32_bf16 v[52:55], v[72:75], v[236:239], v[52:55]
    v_mfma_f32_16x16x32_bf16 v[60:63], v[76:79], v[236:239], v[60:63]
    v_mfma_f32_16x16x32_bf16 v[16:19], a[104:107], v[72:75], v[16:19]
    v_mfma_f32_16x16x32_bf16 v[20:23], a[104:107], v[76:79], v[20:23]
    v_mfma_f32_16x16x32_bf16 v[24:27], a[108:111], v[72:75], v[24:27]
    v_mfma_f32_16x16x32_bf16 v[28:31], a[108:111], v[76:79], v[28:31]
    ds_read_b128 v[72:75], v82 offset:15360
    ds_read_b128 v[76:79], v83 offset:15360
    s_waitcnt lgkmcnt(2)
    v_mfma_f32_16x16x32_bf16 v[32:35], a[240:243], v[64:67], v[32:35]
    v_mfma_f32_16x16x32_bf16 v[36:39], a[240:243], v[68:71], v[36:39]
    v_mfma_f32_16x16x32_bf16 v[40:43], a[244:247], v[64:67], v[40:43]
    v_mfma_f32_16x16x32_bf16 v[44:47], a[244:247], v[68:71], v[44:47]
    v_mfma_f32_16x16x32_bf16 v[48:51], v[64:67], v[240:243], v[48:51]
    v_mfma_f32_16x16x32_bf16 v[56:59], v[68:71], v[240:243], v[56:59]
    v_mfma_f32_16x16x32_bf16 v[52:55], v[64:67], v[244:247], v[52:55]
    v_mfma_f32_16x16x32_bf16 v[60:63], v[68:71], v[244:247], v[60:63]
    v_mfma_f32_16x16x32_bf16 v[16:19], a[112:115], v[64:67], v[16:19]
    v_mfma_f32_16x16x32_bf16 v[20:23], a[112:115], v[68:71], v[20:23]
    v_mfma_f32_16x16x32_bf16 v[24:27], a[116:119], v[64:67], v[24:27]
    v_mfma_f32_16x16x32_bf16 v[28:31], a[116:119], v[68:71], v[28:31]
    s_waitcnt lgkmcnt(0)
    v_mfma_f32_16x16x32_bf16 v[32:35], a[248:251], v[72:75], v[32:35]
    v_mfma_f32_16x16x32_bf16 v[36:39], a[248:251], v[76:79], v[36:39]
    v_mfma_f32_16x16x32_bf16 v[40:43], a[252:255], v[72:75], v[40:43]
    v_mfma_f32_16x16x32_bf16 v[44:47], a[252:255], v[76:79], v[44:47]
    v_mfma_f32_16x16x32_bf16 v[48:51], v[72:75], v[248:251], v[48:51]
    v_mfma_f32_16x16x32_bf16 v[56:59], v[76:79], v[248:251], v[56:59]
    v_mfma_f32_16x16x32_bf16 v[52:55], v[72:75], v[252:255], v[52:55]
    v_mfma_f32_16x16x32_bf16 v[60:63], v[76:79], v[252:255], v[60:63]
    v_mfma_f32_16x16x32_bf16 v[16:19], a[120:123], v[72:75], v[16:19]
    v_mfma_f32_16x16x32_bf16 v[20:23], a[120:123], v[76:79], v[20:23]
    v_mfma_f32_16x16x32_bf16 v[24:27], a[124:127], v[72:75], v[24:27]
    v_mfma_f32_16x16x32_bf16 v[28:31], a[124:127], v[76:79], v[28:31]
    v_xor_b32 v80, 0x8000, v80
    v_xor_b32 v81, 0x8000, v81
    v_xor_b32 v82, 0x8000, v82
    v_xor_b32 v83, 0x8000, v83
    v_mul_f32 v32, s33, v32
    v_mul_f32 v33, s33, v33
    v_mul_f32 v34, s33, v34
    v_mul_f32 v35, s33, v35
    v_mul_f32 v36, s33, v36
    v_mul_f32 v37, s33, v37
    v_mul_f32 v38, s33, v38
    v_mul_f32 v39, s33, v39
    v_mul_f32 v40, s33, v40
    v_mul_f32 v41, s33, v41
    v_mul_f32 v42, s33, v42
    v_mul_f32 v43, s33, v43
    v_mul_f32 v44, s33, v44
    v_mul_f32 v45, s33, v45
    v_mul_f32 v46, s33, v46
    v_mul_f32 v47, s33, v47
    v_cvt_pk_bf16_f32 v88, v32, v40
    v_cvt_pk_bf16_f32 v89, v33, v41
    v_cvt_pk_bf16_f32 v90, v34, v42
    v_cvt_pk_bf16_f32 v91, v35, v43
    v_cvt_pk_bf16_f32 v92, v36, v44
    v_cvt_pk_bf16_f32 v93, v37, v45
    v_cvt_pk_bf16_f32 v94, v38, v46
    v_cvt_pk_bf16_f32 v95, v39, v47
    v_cvt_pk_bf16_f32 v96, v48, v49
    v_cvt_pk_bf16_f32 v97, v50, v51
    v_cvt_pk_bf16_f32 v98, v56, v57
    v_cvt_pk_bf16_f32 v99, v58, v59
    v_cvt_pk_bf16_f32 v100, v52, v53
    v_cvt_pk_bf16_f32 v101, v54, v55
    v_cvt_pk_bf16_f32 v102, v60, v61
    v_cvt_pk_bf16_f32 v103, v62, v63
    v_cvt_pk_bf16_f32 v104, v16, v24
    v_cvt_pk_bf16_f32 v105, v17, v25
    v_cvt_pk_bf16_f32 v106, v18, v26
    v_cvt_pk_bf16_f32 v107, v19, v27
    v_cvt_pk_bf16_f32 v108, v20, v28
    v_cvt_pk_bf16_f32 v109, v21, v29
    v_cvt_pk_bf16_f32 v110, v22, v30
    v_cvt_pk_bf16_f32 v111, v23, v31
    s_mul_i32 s24, s23, 0x82100
    s_lshl_b32 s36, s20, 14
    s_add_u32 s24, s24, s36
    s_add_u32 s24, s24, 0x1000000
    s_mov_b32 s30, s24
    s_lshr_b32 s36, s21, 1
    s_lshl_b32 s36, s36, 12
    s_xor_b32 s37, s36, 4096
    s_add_u32 s36, s36, s24
    s_add_u32 s37, s37, s24
    buffer_store_dwordx4 v[88:91], v9, s[8:11], s36 offen sc1
    buffer_store_dwordx4 v[92:95], v9, s[8:11], s37 offen sc1
    s_add_u32 s24, s24, 8192
    buffer_store_dwordx4 v[96:99], v2, s[8:11], s24 offen sc1
    buffer_store_dwordx4 v[100:103], v2, s[8:11], s24 offen offset:1024 sc1
    s_add_u32 s36, s36, 0x7000000
    s_add_u32 s37, s37, 0x7000000
    buffer_store_dwordx4 v[104:107], v9, s[8:11], s36 offen sc1
    buffer_store_dwordx4 v[108:111], v9, s[8:11], s37 offen sc1
    s_mul_i32 s25, s23, 0x82100
    s_lshl_b32 s36, s20, 2
    s_add_u32 s25, s25, s36
    s_add_u32 s25, s25, 0x1082000
    s_add_u32 s23, s23, 6
    s_cmp_lt_u32 s23, 64
    s_cbranch_scc1 L_P1
    v_mov_b32 v20, -1
    v_mov_b32 v21, -1
    v_mov_b32 v22, -1
    v_mov_b32 v23, -1
    s_lshl_b32 s24, s22, 21
    s_lshl_b32 s36, s20, 15
    s_add_u32 s24, s24, s36
    s_add_u32 s36, s24, 0x4000000
    buffer_store_dwordx4 v[20:23], v11, s[8:11], s36 offen sc1
    s_add_u32 s36, s24, 0x4001000
    buffer_store_dwordx4 v[20:23], v11, s[8:11], s36 offen sc1
    s_add_u32 s36, s24, 0x4002000
    buffer_store_dwordx4 v[20:23], v11, s[8:11], s36 offen sc1
    s_add_u32 s36, s24, 0x4003000
    buffer_store_dwordx4 v[20:23], v11, s[8:11], s36 offen sc1
    s_add_u32 s36, s24, 0x4004000
    buffer_store_dwordx4 v[20:23], v11, s[8:11], s36 offen sc1
    s_add_u32 s36, s24, 0x4005000
    buffer_store_dwordx4 v[20:23], v11, s[8:11], s36 offen sc1
    s_add_u32 s36, s24, 0x4006000
    buffer_store_dwordx4 v[20:23], v11, s[8:11], s36 offen sc1
    s_add_u32 s36, s24, 0x4007000
    buffer_store_dwordx4 v[20:23], v11, s[8:11], s36 offen sc1
    s_add_u32 s36, s24, 0x4100000
    buffer_store_dwordx4 v[20:23], v11, s[8:11], s36 offen sc1
    s_add_u32 s36, s24, 0x4101000
    buffer_store_dwordx4 v[20:23], v11, s[8:11], s36 offen sc1
    s_add_u32 s36, s24, 0x4102000
    buffer_store_dwordx4 v[20:23], v11, s[8:11], s36 offen sc1
    s_add_u32 s36, s24, 0x4103000
    buffer_store_dwordx4 v[20:23], v11, s[8:11], s36 offen sc1
    s_add_u32 s36, s24, 0x4104000
    buffer_store_dwordx4 v[20:23], v11, s[8:11], s36 offen sc1
    s_add_u32 s36, s24, 0x4105000
    buffer_store_dwordx4 v[20:23], v11, s[8:11], s36 offen sc1
    s_add_u32 s36, s24, 0x4106000
    buffer_store_dwordx4 v[20:23], v11, s[8:11], s36 offen sc1
    s_add_u32 s36, s24, 0x4107000
    buffer_store_dwordx4 v[20:23], v11, s[8:11], s36 offen sc1
    s_waitcnt vmcnt(0)
    s_barrier
    v_cmp_ne_u32 vcc, 0, v0
    v_mov_b32 v15, 0x40000000
    v_mov_b32 v14, 1
    v_cndmask_b32 v15, v0, v15, vcc
    buffer_store_dword v14, v15, s[8:11], s25 offen sc1
    s_lshl_b32 s25, s22, 7
    s_lshl_b32 s36, s20, 2
    s_add_u32 s36, s36, s25
    s_add_u32 s36, s36, 0x192000
    v_cmp_ne_u32 vcc, 0, v0
    v_mov_b32 v15, 0x40000000
    v_mov_b32 v14, 1
    v_cndmask_b32 v15, v0, v15, vcc
    buffer_store_dword v14, v15, s[8:11], s36 offen sc1
    s_mov_b32 s96, s54
    s_and_b32 s97, s55, 0xffff
    s_mov_b32 s98, 0x400000
    s_mov_b32 s99, 0x20000
    v_mov_b32 v15, 0x0
    v_bfe_u32 v14, v0, 0, 1
    s_mov_b32 s38, 0x10
    v_mad_u32_u24 v15, v14, s38, v15
    v_bfe_u32 v14, v0, 1, 1
    s_mov_b32 s38, 0x20
    v_mad_u32_u24 v15, v14, s38, v15
    v_bfe_u32 v14, v0, 2, 1
    s_mov_b32 s38, 0x40
    v_mad_u32_u24 v15, v14, s38, v15
    v_bfe_u32 v14, v0, 3, 1
    s_mov_b32 s38, 0x80
    v_mad_u32_u24 v15, v14, s38, v15
    v_bfe_u32 v14, v0, 4, 1
    s_mov_b32 s38, 0x1000
    v_mad_u32_u24 v15, v14, s38, v15
    v_bfe_u32 v14, v0, 5, 1
    s_mov_b32 s38, 0x2000
    v_mad_u32_u24 v15, v14, s38, v15
    v_bfe_u32 v14, v0, 6, 1
    s_mov_b32 s38, 0x100
    v_mad_u32_u24 v15, v14, s38, v15
    v_bfe_u32 v14, v0, 7, 1
    s_mov_b32 s38, 0x200
    v_mad_u32_u24 v15, v14, s38, v15
    s_lshl_b32 s36, s20, 17
    s_add_u32 s37, s36, 0x0
    buffer_load_dwordx4 v[16:19], v15, s[96:99], s37 offen
    s_add_u32 s37, s36, 0x4000
    buffer_load_dwordx4 v[20:23], v15, s[96:99], s37 offen
    s_add_u32 s37, s36, 0x400
    buffer_load_dwordx4 v[24:27], v15, s[96:99], s37 offen
    s_add_u32 s37, s36, 0x4400
    buffer_load_dwordx4 v[28:31], v15, s[96:99], s37 offen
    s_add_u32 s37, s36, 0x800
    buffer_load_dwordx4 v[32:35], v15, s[96:99], s37 offen
    s_add_u32 s37, s36, 0x4800
    buffer_load_dwordx4 v[36:39], v15, s[96:99], s37 offen
    s_add_u32 s37, s36, 0xc00
    buffer_load_dwordx4 v[40:43], v15, s[96:99], s37 offen
    s_add_u32 s37, s36, 0x4c00
    buffer_load_dwordx4 v[44:47], v15, s[96:99], s37 offen
    s_add_u32 s37, s36, 0x8000
    buffer_load_dwordx4 v[48:51], v15, s[96:99], s37 offen
    s_add_u32 s37, s36, 0xc000
    buffer_load_dwordx4 v[52:55], v15, s[96:99], s37 offen
    s_add_u32 s37, s36, 0x8400
    buffer_load_dwordx4 v[56:59], v15, s[96:99], s37 offen
    s_add_u32 s37, s36, 0xc400
    buffer_load_dwordx4 v[60:63], v15, s[96:99], s37 offen
    s_add_u32 s37, s36, 0x8800
    buffer_load_dwordx4 v[64:67], v15, s[96:99], s37 offen
    s_add_u32 s37, s36, 0xc800
    buffer_load_dwordx4 v[68:71], v15, s[96:99], s37 offen
    s_add_u32 s37, s36, 0x8c00
    buffer_load_dwordx4 v[72:75], v15, s[96:99], s37 offen
    s_add_u32 s37, s36, 0xcc00
    buffer_load_dwordx4 v[76:79], v15, s[96:99], s37 offen
    s_add_u32 s37, s36, 0x10000
    buffer_load_dwordx4 v[80:83], v15, s[96:99], s37 offen
    s_add_u32 s37, s36, 0x14000
    buffer_load_dwordx4 v[84:87], v15, s[96:99], s37 offen
    s_add_u32 s37, s36, 0x10400
    buffer_load_dwordx4 v[88:91], v15, s[96:99], s37 offen
    s_add_u32 s37, s36, 0x14400
    buffer_load_dwordx4 v[92:95], v15, s[96:99], s37 offen
    s_add_u32 s37, s36, 0x10800
    buffer_load_dwordx4 v[96:99], v15, s[96:99], s37 offen
    s_add_u32 s37, s36, 0x14800
    buffer_load_dwordx4 v[100:103], v15, s[96:99], s37 offen
    s_add_u32 s37, s36, 0x10c00
    buffer_load_dwordx4 v[104:107], v15, s[96:99], s37 offen
    s_add_u32 s37, s36, 0x14c00
    buffer_load_dwordx4 v[108:111], v15, s[96:99], s37 offen
    s_waitcnt vmcnt(16)
    v_perm_b32 v112, v20, v16, s34
    v_perm_b32 v113, v28, v24, s34
    v_perm_b32 v114, v36, v32, s34
    v_perm_b32 v115, v44, v40, s34
    ds_write_b128 v7, v[112:115] offset:0
    v_perm_b32 v116, v20, v16, s35
    v_perm_b32 v117, v28, v24, s35
    v_perm_b32 v118, v36, v32, s35
    v_perm_b32 v119, v44, v40, s35
    ds_write_b128 v7, v[116:119] offset:1024
    v_perm_b32 v120, v21, v17, s34
    v_perm_b32 v121, v29, v25, s34
    v_perm_b32 v122, v37, v33, s34
    v_perm_b32 v123, v45, v41, s34
    ds_write_b128 v7, v[120:123] offset:2048
    v_perm_b32 v124, v21, v17, s35
    v_perm_b32 v125, v29, v25, s35
    v_perm_b32 v126, v37, v33, s35
    v_perm_b32 v127, v45, v41, s35
    ds_write_b128 v7, v[124:127] offset:3072
    s_waitcnt lgkmcnt(0)
    v_perm_b32 v112, v22, v18, s34
    v_perm_b32 v113, v30, v26, s34
    v_perm_b32 v114, v38, v34, s34
    v_perm_b32 v115, v46, v42, s34
    ds_write_b128 v7, v[112:115] offset:4096
    v_perm_b32 v116, v22, v18, s35
    v_perm_b32 v117, v30, v26, s35
    v_perm_b32 v118, v38, v34, s35
    v_perm_b32 v119, v46, v42, s35
    ds_write_b128 v7, v[116:119] offset:5120
    v_perm_b32 v120, v23, v19, s34
    v_perm_b32 v121, v31, v27, s34
    v_perm_b32 v122, v39, v35, s34
    v_perm_b32 v123, v47, v43, s34
    ds_write_b128 v7, v[120:123] offset:6144
    v_perm_b32 v124, v23, v19, s35
    v_perm_b32 v125, v31, v27, s35
    v_perm_b32 v126, v39, v35, s35
    v_perm_b32 v127, v47, v43, s35
    ds_write_b128 v7, v[124:127] offset:7168
    s_waitcnt lgkmcnt(0)
    s_add_u32 s37, s36, 0x18000
    buffer_load_dwordx4 v[16:19], v15, s[96:99], s37 offen
    s_add_u32 s37, s36, 0x1c000
    buffer_load_dwordx4 v[20:23], v15, s[96:99], s37 offen
    s_add_u32 s37, s36, 0x18400
    buffer_load_dwordx4 v[24:27], v15, s[96:99], s37 offen
    s_add_u32 s37, s36, 0x1c400
    buffer_load_dwordx4 v[28:31], v15, s[96:99], s37 offen
    s_add_u32 s37, s36, 0x18800
    buffer_load_dwordx4 v[32:35], v15, s[96:99], s37 offen
    s_add_u32 s37, s36, 0x1c800
    buffer_load_dwordx4 v[36:39], v15, s[96:99], s37 offen
    s_add_u32 s37, s36, 0x18c00
    buffer_load_dwordx4 v[40:43], v15, s[96:99], s37 offen
    s_add_u32 s37, s36, 0x1cc00
    buffer_load_dwordx4 v[44:47], v15, s[96:99], s37 offen
    s_waitcnt vmcnt(16)
    v_perm_b32 v112, v52, v48, s34
    v_perm_b32 v113, v60, v56, s34
    v_perm_b32 v114, v68, v64, s34
    v_perm_b32 v115, v76, v72, s34
    ds_write_b128 v7, v[112:115] offset:8192
    v_perm_b32 v116, v52, v48, s35
    v_perm_b32 v117, v60, v56, s35
    v_perm_b32 v118, v68, v64, s35
    v_perm_b32 v119, v76, v72, s35
    ds_write_b128 v7, v[116:119] offset:9216
    v_perm_b32 v120, v53, v49, s34
    v_perm_b32 v121, v61, v57, s34
    v_perm_b32 v122, v69, v65, s34
    v_perm_b32 v123, v77, v73, s34
    ds_write_b128 v7, v[120:123] offset:10240
    v_perm_b32 v124, v53, v49, s35
    v_perm_b32 v125, v61, v57, s35
    v_perm_b32 v126, v69, v65, s35
    v_perm_b32 v127, v77, v73, s35
    ds_write_b128 v7, v[124:127] offset:11264
    s_waitcnt lgkmcnt(0)
    v_perm_b32 v112, v54, v50, s34
    v_perm_b32 v113, v62, v58, s34
    v_perm_b32 v114, v70, v66, s34
    v_perm_b32 v115, v78, v74, s34
    ds_write_b128 v7, v[112:115] offset:12288
    v_perm_b32 v116, v54, v50, s35
    v_perm_b32 v117, v62, v58, s35
    v_perm_b32 v118, v70, v66, s35
    v_perm_b32 v119, v78, v74, s35
    ds_write_b128 v7, v[116:119] offset:13312
    v_perm_b32 v120, v55, v51, s34
    v_perm_b32 v121, v63, v59, s34
    v_perm_b32 v122, v71, v67, s34
    v_perm_b32 v123, v79, v75, s34
    ds_write_b128 v7, v[120:123] offset:14336
    v_perm_b32 v124, v55, v51, s35
    v_perm_b32 v125, v63, v59, s35
    v_perm_b32 v126, v71, v67, s35
    v_perm_b32 v127, v79, v75, s35
    ds_write_b128 v7, v[124:127] offset:15360
    s_waitcnt lgkmcnt(0)
    s_waitcnt vmcnt(8)
    v_perm_b32 v112, v84, v80, s34
    v_perm_b32 v113, v92, v88, s34
    v_perm_b32 v114, v100, v96, s34
    v_perm_b32 v115, v108, v104, s34
    ds_write_b128 v7, v[112:115] offset:16384
    v_perm_b32 v116, v84, v80, s35
    v_perm_b32 v117, v92, v88, s35
    v_perm_b32 v118, v100, v96, s35
    v_perm_b32 v119, v108, v104, s35
    ds_write_b128 v7, v[116:119] offset:17408
    v_perm_b32 v120, v85, v81, s34
    v_perm_b32 v121, v93, v89, s34
    v_perm_b32 v122, v101, v97, s34
    v_perm_b32 v123, v109, v105, s34
    ds_write_b128 v7, v[120:123] offset:18432
    v_perm_b32 v124, v85, v81, s35
    v_perm_b32 v125, v93, v89, s35
    v_perm_b32 v126, v101, v97, s35
    v_perm_b32 v127, v109, v105, s35
    ds_write_b128 v7, v[124:127] offset:19456
    s_waitcnt lgkmcnt(0)
    v_perm_b32 v112, v86, v82, s34
    v_perm_b32 v113, v94, v90, s34
    v_perm_b32 v114, v102, v98, s34
    v_perm_b32 v115, v110, v106, s34
    ds_write_b128 v7, v[112:115] offset:20480
    v_perm_b32 v116, v86, v82, s35
    v_perm_b32 v117, v94, v90, s35
    v_perm_b32 v118, v102, v98, s35
    v_perm_b32 v119, v110, v106, s35
    ds_write_b128 v7, v[116:119] offset:21504
    v_perm_b32 v120, v87, v83, s34
    v_perm_b32 v121, v95, v91, s34
    v_perm_b32 v122, v103, v99, s34
    v_perm_b32 v123, v111, v107, s34
    ds_write_b128 v7, v[120:123] offset:22528
    v_perm_b32 v124, v87, v83, s35
    v_perm_b32 v125, v95, v91, s35
    v_perm_b32 v126, v103, v99, s35
    v_perm_b32 v127, v111, v107, s35
    ds_write_b128 v7, v[124:127] offset:23552
    s_waitcnt lgkmcnt(0)
    s_waitcnt vmcnt(0)
    v_perm_b32 v112, v20, v16, s34
    v_perm_b32 v113, v28, v24, s34
    v_perm_b32 v114, v36, v32, s34
    v_perm_b32 v115, v44, v40, s34
    ds_write_b128 v7, v[112:115] offset:24576
    v_perm_b32 v116, v20, v16, s35
    v_perm_b32 v117, v28, v24, s35
    v_perm_b32 v118, v36, v32, s35
    v_perm_b32 v119, v44, v40, s35
    ds_write_b128 v7, v[116:119] offset:25600
    v_perm_b32 v120, v21, v17, s34
    v_perm_b32 v121, v29, v25, s34
    v_perm_b32 v122, v37, v33, s34
    v_perm_b32 v123, v45, v41, s34
    ds_write_b128 v7, v[120:123] offset:26624
    v_perm_b32 v124, v21, v17, s35
    v_perm_b32 v125, v29, v25, s35
    v_perm_b32 v126, v37, v33, s35
    v_perm_b32 v127, v45, v41, s35
    ds_write_b128 v7, v[124:127] offset:27648
    s_waitcnt lgkmcnt(0)
    v_perm_b32 v112, v22, v18, s34
    v_perm_b32 v113, v30, v26, s34
    v_perm_b32 v114, v38, v34, s34
    v_perm_b32 v115, v46, v42, s34
    ds_write_b128 v7, v[112:115] offset:28672
    v_perm_b32 v116, v22, v18, s35
    v_perm_b32 v117, v30, v26, s35
    v_perm_b32 v118, v38, v34, s35
    v_perm_b32 v119, v46, v42, s35
    ds_write_b128 v7, v[116:119] offset:29696
    v_perm_b32 v120, v23, v19, s34
    v_perm_b32 v121, v31, v27, s34
    v_perm_b32 v122, v39, v35, s34
    v_perm_b32 v123, v47, v43, s34
    ds_write_b128 v7, v[120:123] offset:30720
    v_perm_b32 v124, v23, v19, s35
    v_perm_b32 v125, v31, v27, s35
    v_perm_b32 v126, v39, v35, s35
    v_perm_b32 v127, v47, v43, s35
    ds_write_b128 v7, v[124:127] offset:31744
    s_waitcnt lgkmcnt(0)
    s_lshl_b32 s25, s22, 7
    s_add_u32 s25, s25, 0x192000
    v_lshrrev_b32 v15, 2, v1
    v_and_b32 v15, 127, v15
L_TPI:
    buffer_load_dword v14, v15, s[8:11], s25 offen sc1
    s_add_u32 s32, s32, 1
    s_cmp_gt_u32 s32, 200000
    s_waitcnt vmcnt(0)
    s_cbranch_scc1 L_TPI_ok
    v_cmp_eq_u32 vcc, 0, v14
    s_cbranch_vccz L_TPI_ok
    s_sleep 8
    s_branch L_TPI
L_TPI_ok:
    s_mov_b32 s23, s22
    s_mov_b32 s29, 0
    s_mov_b32 s30, 0x40000000
    s_mul_i32 s24, s23, 0x82100
    s_lshl_b32 s36, s20, 14
    s_add_u32 s24, s24, s36
    s_add_u32 s24, s24, 0x1000000
    s_add_u32 s36, s24, 0
    s_add_u32 s37, s36, 0x7000000
    buffer_load_dwordx4 a[32:35], v1, s[8:11], s36 offen offset:0 sc1
    buffer_load_dwordx4 a[0:3], v1, s[8:11], s37 offen offset:0 sc1
    buffer_load_dwordx4 a[36:39], v1, s[8:11], s36 offen offset:1024 sc1
    buffer_load_dwordx4 a[4:7], v1, s[8:11], s37 offen offset:1024 sc1
    buffer_load_dwordx4 a[40:43], v1, s[8:11], s36 offen offset:2048 sc1
    buffer_load_dwordx4 a[8:11], v1, s[8:11], s37 offen offset:2048 sc1
    buffer_load_dwordx4 a[44:47], v1, s[8:11], s36 offen offset:3072 sc1
    buffer_load_dwordx4 a[12:15], v1, s[8:11], s37 offen offset:3072 sc1
    s_add_u32 s36, s24, 4096
    s_add_u32 s37, s36, 0x7000000
    buffer_load_dwordx4 a[48:51], v1, s[8:11], s36 offen offset:0 sc1
    buffer_load_dwordx4 a[16:19], v1, s[8:11], s37 offen offset:0 sc1
    buffer_load_dwordx4 a[52:55], v1, s[8:11], s36 offen offset:1024 sc1
    buffer_load_dwordx4 a[20:23], v1, s[8:11], s37 offen offset:1024 sc1
    buffer_load_dwordx4 a[56:59], v1, s[8:11], s36 offen offset:2048 sc1
    buffer_load_dwordx4 a[24:27], v1, s[8:11], s37 offen offset:2048 sc1
    buffer_load_dwordx4 a[60:63], v1, s[8:11], s36 offen offset:3072 sc1
    buffer_load_dwordx4 a[28:31], v1, s[8:11], s37 offen offset:3072 sc1
    s_lshr_b32 s36, s21, 1
    s_lshl_b32 s36, s36, 3
    s_xor_b32 s37, s36, 8
    s_add_u32 s24, s24, 8192
    s_add_u32 s36, s36, s24
    s_add_u32 s37, s37, s24
    buffer_load_dwordx2 a[64:65], v2, s[8:11], s36 offen offset:0 sc1
    buffer_load_dwordx2 a[66:67], v2, s[8:11], s37 offen offset:0 sc1
    buffer_load_dwordx2 a[68:69], v2, s[8:11], s36 offen offset:1024 sc1
    buffer_load_dwordx2 a[70:71], v2, s[8:11], s37 offen offset:1024 sc1
L_P2:
    s_and_b32 s36, s29, 1
    s_lshl_b32 s36, s36, 20
    s_lshl_b32 s26, s22, 21
    s_add_u32 s26, s26, s36
    s_add_u32 s26, s26, 0x4000000
    s_bfe_u32 s27, s29, 0x10001
    s_lshl_b32 s24, s23, 13
    s_add_u32 s24, s24, 0x100000
    s_max_u32 s25, s23, 1
    s_lshl_b32 s25, s25, 13
    s_add_u32 s25, s25, 0xfe000
    buffer_load_dwordx4 v[48:51], v2, s[8:11], s24 offen sc1
    buffer_load_dwordx4 v[52:55], v2, s[8:11], s24 offen offset:1024 sc1
    s_lshl_b32 s36, s23, 5
    s_add_u32 s36, s36, s20
    s_lshl_b32 s36, s36, 10
    buffer_load_dword a72, v12, s[12:15], s36 offen
    buffer_load_dword a73, v12, s[92:95], 0 offen
    s_waitcnt vmcnt(4)
    v_cmp_ne_u32 vcc, 0, v1
    v_mov_b32 v15, 0x40000000
    v_mov_b32 v14, 0
    v_cndmask_b32 v15, v1, v15, vcc
    buffer_store_dword v14, v15, s[8:11], s30 offen sc1
    v_mfma_f32_16x16x32_bf16 v[80:83], a[32:35], a[0:3], 0
    v_mfma_f32_16x16x32_bf16 v[80:83], a[36:39], a[4:7], v[80:83]
    v_mfma_f32_16x16x32_bf16 v[80:83], a[40:43], a[8:11], v[80:83]
    v_mfma_f32_16x16x32_bf16 v[80:83], a[44:47], a[12:15], v[80:83]
    v_mfma_f32_16x16x32_bf16 v[88:91], a[48:51], a[16:19], 0
    v_mfma_f32_16x16x32_bf16 v[88:91], a[52:55], a[20:23], v[88:91]
    v_mfma_f32_16x16x32_bf16 v[88:91], a[56:59], a[24:27], v[88:91]
    v_mfma_f32_16x16x32_bf16 v[88:91], a[60:63], a[28:31], v[88:91]
    v_mfma_f32_16x16x32_bf16 v[84:87], a[32:35], a[16:19], 0
    v_mfma_f32_16x16x32_bf16 v[84:87], a[36:39], a[20:23], v[84:87]
    v_mfma_f32_16x16x32_bf16 v[84:87], a[40:43], a[24:27], v[84:87]
    v_mfma_f32_16x16x32_bf16 v[84:87], a[44:47], a[28:31], v[84:87]
    v_cndmask_b32 v80, v13, v80, s[64:65]
    v_cndmask_b32 v81, v13, v81, s[66:67]
    v_cndmask_b32 v82, v13, v82, s[68:69]
    v_cndmask_b32 v83, v13, v83, s[70:71]
    v_cndmask_b32 v88, v13, v88, s[64:65]
    v_cndmask_b32 v89, v13, v89, s[66:67]
    v_cndmask_b32 v90, v13, v90, s[68:69]
    v_cndmask_b32 v91, v13, v91, s[70:71]
    v_max_f32 v116, v80, v81
    v_max3_f32 v116, v116, v82, v83
    v_max_f32 v117, v84, v85
    v_max3_f32 v117, v117, v86, v87
    v_max3_f32 v117, v117, v88, v89
    v_max3_f32 v117, v117, v90, v91
    v_mov_b32 v14, v116
    s_nop 1
    v_permlane16_swap_b32 v116, v14
    v_max_f32 v116, v116, v14
    v_mov_b32 v14, v117
    s_nop 1
    v_permlane16_swap_b32 v117, v14
    v_max_f32 v117, v117, v14
    v_mov_b32 v14, v116
    s_nop 1
    v_permlane32_swap_b32 v116, v14
    v_max_f32 v116, v116, v14
    v_mov_b32 v14, v117
    s_nop 1
    v_permlane32_swap_b32 v117, v14
    v_max_f32 v117, v117, v14
    v_sub_f32 v80, v80, v116
    v_exp_f32 v80, v80
    v_sub_f32 v81, v81, v116
    v_exp_f32 v81, v81
    v_sub_f32 v82, v82, v116
    v_exp_f32 v82, v82
    v_sub_f32 v83, v83, v116
    v_exp_f32 v83, v83
    v_sub_f32 v84, v84, v117
    v_exp_f32 v84, v84
    v_sub_f32 v85, v85, v117
    v_exp_f32 v85, v85
    v_sub_f32 v86, v86, v117
    v_exp_f32 v86, v86
    v_sub_f32 v87, v87, v117
    v_exp_f32 v87, v87
    v_sub_f32 v88, v88, v117
    v_exp_f32 v88, v88
    v_sub_f32 v89, v89, v117
    v_exp_f32 v89, v89
    v_sub_f32 v90, v90, v117
    v_exp_f32 v90, v90
    v_sub_f32 v91, v91, v117
    v_exp_f32 v91, v91
    v_cvt_pk_bf16_f32 v100, v80, v81
    v_cvt_pk_bf16_f32 v101, v82, v83
    v_mov_b64 v[102:103], 0
    v_cvt_pk_bf16_f32 v104, v84, v85
    v_cvt_pk_bf16_f32 v105, v86, v87
    v_cvt_pk_bf16_f32 v106, v88, v89
    v_cvt_pk_bf16_f32 v107, v90, v91
    v_mov_b64 v[108:109], s[4:5]
    v_mov_b64 v[110:111], s[4:5]
    v_cndmask_b32 v112, 0, v108, s[72:73]
    v_cndmask_b32 v113, 0, v108, s[72:73]
    v_mfma_f32_16x16x32_bf16 v[16:19], v[108:111], v[100:103], 0
    v_mfma_f32_16x16x32_bf16 v[24:27], a[64:67], v[100:103], 0
    v_mfma_f32_16x16x32_bf16 v[28:31], a[68:71], v[100:103], 0
    v_mfma_f32_16x16x32_bf16 v[20:23], v[108:111], v[104:107], 0
    v_mfma_f32_16x16x32_bf16 v[32:35], a[64:67], v[104:107], 0
    v_mfma_f32_16x16x32_bf16 v[36:39], a[68:71], v[104:107], 0
    s_branch L_P2_chk
L_P2_far:
    buffer_load_dword v14, v2, s[8:11], s25 offen sc1
    s_add_u32 s32, s32, 1
    s_cmp_gt_u32 s32, 200000
    s_waitcnt vmcnt(0)
    s_cbranch_scc1 L_P2_poll
    v_cmp_eq_u32 vcc, -1, v14
    s_cbranch_vccz L_P2_near
    s_sleep 12
    s_branch L_P2_far
L_P2_near:
    s_mov_b32 s25, 0x40000000
L_P2_poll:
    buffer_load_dwordx4 v[48:51], v2, s[8:11], s24 offen sc1
    buffer_load_dwordx4 v[52:55], v2, s[8:11], s24 offen offset:1024 sc1
L_P2_chk:
    s_add_u32 s32, s32, 1
    s_waitcnt vmcnt(0)
    ds_write_b128 v2, v[48:51] offset:20480
    ds_write_b128 v2, v[52:55] offset:21504
    v_max3_u32 v14, v48, v49, v50
    v_max3_u32 v15, v51, v52, v53
    v_max3_u32 v14, v14, v54, v55
    v_max_u32 v14, v14, v15
    v_cmp_eq_u32 vcc, -1, v14
    s_cbranch_vccz L_P2_got
    s_cmp_gt_u32 s32, 200000
    s_cbranch_scc1 L_P2_got
    s_cmp_eq_u32 s25, 0x40000000
    s_cbranch_scc1 L_P2_poll
    s_branch L_P2_far
L_P2_got:
    s_waitcnt lgkmcnt(0)
    s_barrier
    ds_read_b128 v[48:51], v8 offset:0
    ds_read_b128 v[52:55], v8 offset:2048
    ds_read_b128 v[56:59], v8 offset:4096
    ds_read_b128 v[60:63], v8 offset:6144
    s_waitcnt lgkmcnt(3)
    v_mfma_f32_16x16x32_bf16 v[80:83], a[128:131], v[48:51], 0
    v_mfma_f32_16x16x32_bf16 v[84:87], a[132:135], v[48:51], 0
    ds_read_b128 v[48:51], v8 offset:512
    s_waitcnt lgkmcnt(3)
    v_mfma_f32_16x16x32_bf16 v[80:83], a[136:139], v[52:55], v[80:83]
    v_mfma_f32_16x16x32_bf16 v[84:87], a[140:143], v[52:55], v[84:87]
    ds_read_b128 v[52:55], v8 offset:2560
    s_waitcnt lgkmcnt(3)
    v_mfma_f32_16x16x32_bf16 v[80:83], a[144:147], v[56:59], v[80:83]
    v_mfma_f32_16x16x32_bf16 v[84:87], a[148:151], v[56:59], v[84:87]
    ds_read_b128 v[56:59], v8 offset:4608
    s_waitcnt lgkmcnt(3)
    v_mfma_f32_16x16x32_bf16 v[80:83], a[152:155], v[60:63], v[80:83]
    v_mfma_f32_16x16x32_bf16 v[84:87], a[156:159], v[60:63], v[84:87]
    ds_read_b128 v[60:63], v8 offset:6656
    s_waitcnt lgkmcnt(3)
    v_mfma_f32_16x16x32_bf16 v[80:83], a[160:163], v[48:51], v[80:83]
    v_mfma_f32_16x16x32_bf16 v[84:87], a[164:167], v[48:51], v[84:87]
    ds_read_b128 v[48:51], v8 offset:1024
    s_waitcnt lgkmcnt(3)
    v_mfma_f32_16x16x32_bf16 v[80:83], a[168:171], v[52:55], v[80:83]
    v_mfma_f32_16x16x32_bf16 v[84:87], a[172:175], v[52:55], v[84:87]
    ds_read_b128 v[52:55], v8 offset:3072
    s_waitcnt lgkmcnt(3)
    v_mfma_f32_16x16x32_bf16 v[80:83], a[176:179], v[56:59], v[80:83]
    v_mfma_f32_16x16x32_bf16 v[84:87], a[180:183], v[56:59], v[84:87]
    ds_read_b128 v[56:59], v8 offset:5120
    s_waitcnt lgkmcnt(3)
    v_mfma_f32_16x16x32_bf16 v[80:83], a[184:187], v[60:63], v[80:83]
    v_mfma_f32_16x16x32_bf16 v[84:87], a[188:191], v[60:63], v[84:87]
    ds_read_b128 v[60:63], v8 offset:7168
    s_waitcnt lgkmcnt(3)
    v_mfma_f32_16x16x32_bf16 v[80:83], a[192:195], v[48:51], v[80:83]
    v_mfma_f32_16x16x32_bf16 v[84:87], a[196:199], v[48:51], v[84:87]
    ds_read_b128 v[48:51], v8 offset:1536
    s_waitcnt lgkmcnt(3)
    v_mfma_f32_16x16x32_bf16 v[80:83], a[200:203], v[52:55], v[80:83]
    v_mfma_f32_16x16x32_bf16 v[84:87], a[204:207], v[52:55], v[84:87]
    ds_read_b128 v[52:55], v8 offset:3584
    s_waitcnt lgkmcnt(3)
    v_mfma_f32_16x16x32_bf16 v[80:83], a[208:211], v[56:59], v[80:83]
    v_mfma_f32_16x16x32_bf16 v[84:87], a[212:215], v[56:59], v[84:87]
    ds_read_b128 v[56:59], v8 offset:5632
    s_waitcnt lgkmcnt(3)
    v_mfma_f32_16x16x32_bf16 v[80:83], a[216:219], v[60:63], v[80:83]
    v_mfma_f32_16x16x32_bf16 v[84:87], a[220:223], v[60:63], v[84:87]
    ds_read_b128 v[60:63], v8 offset:7680
    s_waitcnt lgkmcnt(3)
    v_mfma_f32_16x16x32_bf16 v[80:83], a[224:227], v[48:51], v[80:83]
    v_mfma_f32_16x16x32_bf16 v[84:87], a[228:231], v[48:51], v[84:87]
    ds_read_b128 v[48:51], v8 offset:0
    s_waitcnt lgkmcnt(3)
    v_mfma_f32_16x16x32_bf16 v[80:83], a[232:235], v[52:55], v[80:83]
    v_mfma_f32_16x16x32_bf16 v[84:87], a[236:239], v[52:55], v[84:87]
    ds_read_b128 v[52:55], v8 offset:2048
    s_waitcnt lgkmcnt(3)
    v_mfma_f32_16x16x32_bf16 v[80:83], a[240:243], v[56:59], v[80:83]
    v_mfma_f32_16x16x32_bf16 v[84:87], a[244:247], v[56:59], v[84:87]
    ds_read_b128 v[56:59], v8 offset:4096
    s_waitcnt lgkmcnt(3)
    v_mfma_f32_16x16x32_bf16 v[80:83], a[248:251], v[60:63], v[80:83]
    v_mfma_f32_16x16x32_bf16 v[84:87], a[252:255], v[60:63], v[84:87]
    ds_read_b128 v[60:63], v8 offset:6144
    s_waitcnt lgkmcnt(3)
    v_mfma_f32_16x16x32_bf16 v[40:43], v[48:51], v[128:131], 0
    v_mfma_f32_16x16x32_bf16 v[44:47], v[48:51], v[132:135], 0
    ds_read_b128 v[48:51], v8 offset:512
    s_waitcnt lgkmcnt(3)
    v_mfma_f32_16x16x32_bf16 v[40:43], v[52:55], v[136:139], v[40:43]
    v_mfma_f32_16x16x32_bf16 v[44:47], v[52:55], v[140:143], v[44:47]
    ds_read_b128 v[52:55], v8 offset:2560
    s_waitcnt lgkmcnt(3)
    v_mfma_f32_16x16x32_bf16 v[40:43], v[56:59], v[144:147], v[40:43]
    v_mfma_f32_16x16x32_bf16 v[44:47], v[56:59], v[148:151], v[44:47]
    v_mul_f32 v80, s33, v80
    v_mul_f32 v81, s33, v81
    v_mul_f32 v82, s33, v82
    v_mul_f32 v83, s33, v83
    ds_read_b128 v[56:59], v8 offset:4608
    s_waitcnt lgkmcnt(3)
    v_mfma_f32_16x16x32_bf16 v[40:43], v[60:63], v[152:155], v[40:43]
    v_mfma_f32_16x16x32_bf16 v[44:47], v[60:63], v[156:159], v[44:47]
    v_mul_f32 v84, s33, v84
    v_mul_f32 v85, s33, v85
    v_mul_f32 v86, s33, v86
    v_mul_f32 v87, s33, v87
    ds_read_b128 v[60:63], v8 offset:6656
    s_waitcnt lgkmcnt(3)
    v_mfma_f32_16x16x32_bf16 v[40:43], v[48:51], v[160:163], v[40:43]
    v_mfma_f32_16x16x32_bf16 v[44:47], v[48:51], v[164:167], v[44:47]
    v_cvt_pk_bf16_f32 v88, v80, v84
    v_cvt_pk_bf16_f32 v89, v81, v85
    v_cvt_pk_bf16_f32 v90, v82, v86
    v_cvt_pk_bf16_f32 v91, v83, v87
    ds_write_b128 v9, v[88:91] offset:16384
    ds_read_b128 v[48:51], v8 offset:1024
    s_waitcnt lgkmcnt(4)
    v_mfma_f32_16x16x32_bf16 v[40:43], v[52:55], v[168:171], v[40:43]
    v_mfma_f32_16x16x32_bf16 v[44:47], v[52:55], v[172:175], v[44:47]
    ds_read_b128 v[52:55], v8 offset:3072
    s_waitcnt lgkmcnt(4)
    v_mfma_f32_16x16x32_bf16 v[40:43], v[56:59], v[176:179], v[40:43]
    v_mfma_f32_16x16x32_bf16 v[44:47], v[56:59], v[180:183], v[44:47]
    ds_read_b128 v[56:59], v8 offset:5120
    s_waitcnt lgkmcnt(4)
    v_mfma_f32_16x16x32_bf16 v[40:43], v[60:63], v[184:187], v[40:43]
    v_mfma_f32_16x16x32_bf16 v[44:47], v[60:63], v[188:191], v[44:47]
    s_waitcnt lgkmcnt(3)
    s_barrier
    ds_read_b128 v[64:67], v1 offset:16384
    ds_read_b128 v[68:71], v1 offset:17408
    ds_read_b128 v[72:75], v1 offset:18432
    ds_read_b128 v[76:79], v1 offset:19456
    ds_read_b128 v[60:63], v8 offset:7168
    s_waitcnt lgkmcnt(7)
    v_mfma_f32_16x16x32_bf16 v[40:43], v[48:51], v[192:195], v[40:43]
    v_mfma_f32_16x16x32_bf16 v[44:47], v[48:51], v[196:199], v[44:47]
    ds_read_b128 v[48:51], v8 offset:1536
    s_waitcnt lgkmcnt(7)
    v_mfma_f32_16x16x32_bf16 v[40:43], v[52:55], v[200:203], v[40:43]
    v_mfma_f32_16x16x32_bf16 v[44:47], v[52:55], v[204:207], v[44:47]
    s_waitcnt lgkmcnt(2)
    v_mfma_f32_16x16x32_bf16 v[92:95], v[64:67], a[0:3], 0
    v_mfma_f32_16x16x32_bf16 v[96:99], v[64:67], a[16:19], 0
    v_mfma_f32_16x16x32_bf16 v[92:95], v[68:71], a[4:7], v[92:95]
    v_mfma_f32_16x16x32_bf16 v[96:99], v[68:71], a[20:23], v[96:99]
    v_mfma_f32_16x16x32_bf16 v[92:95], v[72:75], a[8:11], v[92:95]
    v_mfma_f32_16x16x32_bf16 v[96:99], v[72:75], a[24:27], v[96:99]
    v_mfma_f32_16x16x32_bf16 v[92:95], v[76:79], a[12:15], v[92:95]
    v_mfma_f32_16x16x32_bf16 v[96:99], v[76:79], a[28:31], v[96:99]
    ds_read_b128 v[52:55], v8 offset:3584
    s_waitcnt lgkmcnt(3)
    v_mfma_f32_16x16x32_bf16 v[40:43], v[56:59], v[208:211], v[40:43]
    v_mfma_f32_16x16x32_bf16 v[44:47], v[56:59], v[212:215], v[44:47]
    ds_read_b128 v[56:59], v8 offset:5632
    s_waitcnt lgkmcnt(3)
    v_mfma_f32_16x16x32_bf16 v[40:43], v[60:63], v[216:219], v[40:43]
    v_mfma_f32_16x16x32_bf16 v[44:47], v[60:63], v[220:223], v[44:47]
    v_max3_f32 v118, v92, v93, v94
    v_max3_f32 v118, v118, v95, v116
    v_max3_f32 v119, v96, v97, v98
    v_max3_f32 v119, v119, v99, v117
    v_mov_b32 v14, v118
    v_mov_b32 v15, v119
    ds_read_b128 v[60:63], v8 offset:7680
    s_waitcnt lgkmcnt(3)
    v_mfma_f32_16x16x32_bf16 v[40:43], v[48:51], v[224:227], v[40:43]
    v_mfma_f32_16x16x32_bf16 v[44:47], v[48:51], v[228:231], v[44:47]
    v_permlane16_swap_b32 v118, v14
    v_permlane16_swap_b32 v119, v15
    v_max_f32 v118, v118, v14
    v_max_f32 v119, v119, v15
    v_sub_f32 v92, v92, v118
    v_exp_f32 v92, v92
    s_waitcnt lgkmcnt(2)
    v_mfma_f32_16x16x32_bf16 v[40:43], v[52:55], v[232:235], v[40:43]
    v_mfma_f32_16x16x32_bf16 v[44:47], v[52:55], v[236:239], v[44:47]
    v_sub_f32 v93, v93, v118
    v_exp_f32 v93, v93
    v_sub_f32 v94, v94, v118
    v_exp_f32 v94, v94
    v_sub_f32 v95, v95, v118
    v_exp_f32 v95, v95
    s_waitcnt lgkmcnt(1)
    v_mfma_f32_16x16x32_bf16 v[40:43], v[56:59], v[240:243], v[40:43]
    v_mfma_f32_16x16x32_bf16 v[44:47], v[56:59], v[244:247], v[44:47]
    v_sub_f32 v104, v116, v118
    v_exp_f32 v104, v104
    v_cvt_pk_bf16_f32 v100, v92, v93
    v_cvt_pk_bf16_f32 v101, v94, v95
    v_sub_f32 v96, v96, v119
    v_exp_f32 v96, v96
    s_waitcnt lgkmcnt(0)
    v_mfma_f32_16x16x32_bf16 v[40:43], v[60:63], v[248:251], v[40:43]
    v_mfma_f32_16x16x32_bf16 v[44:47], v[60:63], v[252:255], v[44:47]
    v_sub_f32 v97, v97, v119
    v_exp_f32 v97, v97
    v_sub_f32 v98, v98, v119
    v_exp_f32 v98, v98
    v_sub_f32 v99, v99, v119
    v_exp_f32 v99, v99
    v_sub_f32 v105, v117, v119
    v_exp_f32 v105, v105
    v_cvt_pk_bf16_f32 v102, v96, v97
    v_cvt_pk_bf16_f32 v103, v98, v99
    v_mfma_f32_16x16x16_bf16 v[48:51], v[112:113], v[100:101], 0
    s_nop 0
    v_mfma_f32_16x16x16_bf16 v[52:55], v[112:113], v[102:103], 0
    v_cvt_pk_bf16_f32 v80, v40, v41
    v_cndmask_b32 v80, 0, v80, s[72:73]
    v_cvt_pk_bf16_f32 v81, v42, v43
    v_cndmask_b32 v81, 0, v81, s[72:73]
    v_cvt_pk_bf16_f32 v82, v44, v45
    v_cndmask_b32 v82, 0, v82, s[72:73]
    v_cvt_pk_bf16_f32 v83, v46, v47
    v_cndmask_b32 v83, 0, v83, s[72:73]
    v_mfma_f32_16x16x16_bf16 v[56:59], v[80:81], v[100:101], 0
    s_nop 0
    v_mfma_f32_16x16x16_bf16 v[60:63], v[82:83], v[100:101], 0
    v_mfma_f32_16x16x16_bf16 v[64:67], v[80:81], v[102:103], 0
    v_mfma_f32_16x16x16_bf16 v[68:71], v[82:83], v[102:103], 0
    v_fma_f32 v48, v16, v104, v48
    v_rcp_f32 v48, v48
    v_fma_f32 v52, v20, v105, v52
    v_rcp_f32 v52, v52
    v_fma_f32 v56, v24, v104, v56
    v_fma_f32 v57, v25, v104, v57
    v_fma_f32 v58, v26, v104, v58
    v_fma_f32 v59, v27, v104, v59
    v_fma_f32 v60, v28, v104, v60
    v_fma_f32 v61, v29, v104, v61
    v_fma_f32 v62, v30, v104, v62
    v_fma_f32 v63, v31, v104, v63
    v_pk_mul_f32 v[56:57], v[56:57], v[48:49] op_sel_hi:[1,0]
    v_pk_mul_f32 v[58:59], v[58:59], v[48:49] op_sel_hi:[1,0]
    v_pk_mul_f32 v[60:61], v[60:61], v[48:49] op_sel_hi:[1,0]
    v_pk_mul_f32 v[62:63], v[62:63], v[48:49] op_sel_hi:[1,0]
    v_cvt_pk_bf16_f32 v72, v56, v60
    v_cvt_pk_bf16_f32 v73, v57, v61
    v_cvt_pk_bf16_f32 v74, v58, v62
    v_cvt_pk_bf16_f32 v75, v59, v63
    ds_write_b128 v9, v[72:75] offset:0
    v_fma_f32 v64, v32, v105, v64
    v_fma_f32 v65, v33, v105, v65
    v_fma_f32 v66, v34, v105, v66
    v_fma_f32 v67, v35, v105, v67
    v_fma_f32 v68, v36, v105, v68
    v_fma_f32 v69, v37, v105, v69
    v_fma_f32 v70, v38, v105, v70
    v_fma_f32 v71, v39, v105, v71
    v_pk_mul_f32 v[64:65], v[64:65], v[52:53] op_sel_hi:[1,0]
    v_pk_mul_f32 v[66:67], v[66:67], v[52:53] op_sel_hi:[1,0]
    v_pk_mul_f32 v[68:69], v[68:69], v[52:53] op_sel_hi:[1,0]
    v_pk_mul_f32 v[70:71], v[70:71], v[52:53] op_sel_hi:[1,0]
    v_cvt_pk_bf16_f32 v76, v64, v68
    v_cvt_pk_bf16_f32 v77, v65, v69
    v_cvt_pk_bf16_f32 v78, v66, v70
    v_cvt_pk_bf16_f32 v79, v67, v71
    ds_write_b128 v9, v[76:79] offset:4096
    s_waitcnt lgkmcnt(0)
    s_barrier
    ds_read_b128 v[16:19], v1 offset:0
    ds_read_b128 v[20:23], v1 offset:1024
    ds_read_b128 v[24:27], v1 offset:2048
    ds_read_b128 v[28:31], v1 offset:3072
    ds_read_b128 v[32:35], v1 offset:4096
    ds_read_b128 v[36:39], v1 offset:5120
    ds_read_b128 v[40:43], v1 offset:6144
    ds_read_b128 v[44:47], v1 offset:7168
    ds_read_b128 v[48:51], v7 offset:0
    ds_read_b128 v[52:55], v7 offset:1024
    ds_read_b128 v[56:59], v7 offset:2048
    s_lshl_b32 s36, s20, 10
    s_add_u32 s25, s26, s36
    s_waitcnt lgkmcnt(2)
    v_mfma_f32_16x16x32_bf16 v[64:67], v[16:19], v[48:51], 0
    ds_read_b128 v[60:63], v7 offset:3072
    s_waitcnt lgkmcnt(2)
    v_mfma_f32_16x16x32_bf16 v[68:71], v[16:19], v[52:55], 0
    ds_read_b128 v[48:51], v7 offset:4096
    s_waitcnt lgkmcnt(2)
    v_mfma_f32_16x16x32_bf16 v[72:75], v[16:19], v[56:59], 0
    ds_read_b128 v[52:55], v7 offset:5120
    s_waitcnt lgkmcnt(2)
    v_mfma_f32_16x16x32_bf16 v[76:79], v[16:19], v[60:63], 0
    ds_read_b128 v[56:59], v7 offset:6144
    s_waitcnt lgkmcnt(2)
    v_mfma_f32_16x16x32_bf16 v[80:83], v[16:19], v[48:51], 0
    ds_read_b128 v[60:63], v7 offset:7168
    s_waitcnt lgkmcnt(2)
    v_mfma_f32_16x16x32_bf16 v[84:87], v[16:19], v[52:55], 0
    ds_read_b128 v[48:51], v7 offset:8192
    s_waitcnt lgkmcnt(2)
    v_mfma_f32_16x16x32_bf16 v[88:91], v[16:19], v[56:59], 0
    ds_read_b128 v[52:55], v7 offset:9216
    s_waitcnt lgkmcnt(2)
    v_mfma_f32_16x16x32_bf16 v[92:95], v[16:19], v[60:63], 0
    ds_read_b128 v[56:59], v7 offset:10240
    s_waitcnt lgkmcnt(2)
    v_mfma_f32_16x16x32_bf16 v[64:67], v[20:23], v[48:51], v[64:67]
    ds_read_b128 v[60:63], v7 offset:11264
    s_waitcnt lgkmcnt(2)
    v_mfma_f32_16x16x32_bf16 v[68:71], v[20:23], v[52:55], v[68:71]
    ds_read_b128 v[48:51], v7 offset:12288
    s_waitcnt lgkmcnt(2)
    v_mfma_f32_16x16x32_bf16 v[72:75], v[20:23], v[56:59], v[72:75]
    ds_read_b128 v[52:55], v7 offset:13312
    s_waitcnt lgkmcnt(2)
    v_mfma_f32_16x16x32_bf16 v[76:79], v[20:23], v[60:63], v[76:79]
    ds_read_b128 v[56:59], v7 offset:14336
    s_waitcnt lgkmcnt(2)
    v_mfma_f32_16x16x32_bf16 v[80:83], v[20:23], v[48:51], v[80:83]
    ds_read_b128 v[60:63], v7 offset:15360
    s_waitcnt lgkmcnt(2)
    v_mfma_f32_16x16x32_bf16 v[84:87], v[20:23], v[52:55], v[84:87]
    ds_read_b128 v[48:51], v7 offset:16384
    s_waitcnt lgkmcnt(2)
    v_mfma_f32_16x16x32_bf16 v[88:91], v[20:23], v[56:59], v[88:91]
    ds_read_b128 v[52:55], v7 offset:17408
    s_waitcnt lgkmcnt(2)
    v_mfma_f32_16x16x32_bf16 v[92:95], v[20:23], v[60:63], v[92:95]
    ds_read_b128 v[56:59], v7 offset:18432
    s_waitcnt lgkmcnt(2)
    v_mfma_f32_16x16x32_bf16 v[64:67], v[24:27], v[48:51], v[64:67]
    ds_read_b128 v[60:63], v7 offset:19456
    s_waitcnt lgkmcnt(2)
    v_mfma_f32_16x16x32_bf16 v[68:71], v[24:27], v[52:55], v[68:71]
    ds_read_b128 v[48:51], v7 offset:20480
    s_waitcnt lgkmcnt(2)
    v_mfma_f32_16x16x32_bf16 v[72:75], v[24:27], v[56:59], v[72:75]
    ds_read_b128 v[52:55], v7 offset:21504
    s_waitcnt lgkmcnt(2)
    v_mfma_f32_16x16x32_bf16 v[76:79], v[24:27], v[60:63], v[76:79]
    ds_read_b128 v[56:59], v7 offset:22528
    s_waitcnt lgkmcnt(2)
    v_mfma_f32_16x16x32_bf16 v[80:83], v[24:27], v[48:51], v[80:83]
    ds_read_b128 v[60:63], v7 offset:23552
    s_waitcnt lgkmcnt(2)
    v_mfma_f32_16x16x32_bf16 v[84:87], v[24:27], v[52:55], v[84:87]
    ds_read_b128 v[48:51], v7 offset:24576
    s_waitcnt lgkmcnt(2)
    v_mfma_f32_16x16x32_bf16 v[88:91], v[24:27], v[56:59], v[88:91]
    ds_read_b128 v[52:55], v7 offset:25600
    s_waitcnt lgkmcnt(2)
    v_mfma_f32_16x16x32_bf16 v[92:95], v[24:27], v[60:63], v[92:95]
    ds_read_b128 v[56:59], v7 offset:26624
    s_waitcnt lgkmcnt(2)
    v_mfma_f32_16x16x32_bf16 v[64:67], v[28:31], v[48:51], v[64:67]
    ds_read_b128 v[60:63], v7 offset:27648
    s_waitcnt lgkmcnt(2)
    v_mfma_f32_16x16x32_bf16 v[68:71], v[28:31], v[52:55], v[68:71]
    ds_read_b128 v[48:51], v7 offset:28672
    s_waitcnt lgkmcnt(2)
    v_mfma_f32_16x16x32_bf16 v[72:75], v[28:31], v[56:59], v[72:75]
    ds_read_b128 v[52:55], v7 offset:29696
    s_waitcnt lgkmcnt(2)
    v_mfma_f32_16x16x32_bf16 v[76:79], v[28:31], v[60:63], v[76:79]
    ds_read_b128 v[56:59], v7 offset:30720
    s_waitcnt lgkmcnt(2)
    v_mfma_f32_16x16x32_bf16 v[80:83], v[28:31], v[48:51], v[80:83]
    ds_read_b128 v[60:63], v7 offset:31744
    s_waitcnt lgkmcnt(2)
    v_mfma_f32_16x16x32_bf16 v[84:87], v[28:31], v[52:55], v[84:87]
    ds_read_b128 v[48:51], v7 offset:0
    s_waitcnt lgkmcnt(2)
    v_mfma_f32_16x16x32_bf16 v[88:91], v[28:31], v[56:59], v[88:91]
    ds_read_b128 v[52:55], v7 offset:1024
    s_waitcnt lgkmcnt(2)
    v_mfma_f32_16x16x32_bf16 v[92:95], v[28:31], v[60:63], v[92:95]
    ds_read_b128 v[56:59], v7 offset:2048
    s_waitcnt lgkmcnt(2)
    v_mfma_f32_16x16x32_bf16 v[96:99], v[32:35], v[48:51], 0
    ds_read_b128 v[60:63], v7 offset:3072
    s_waitcnt lgkmcnt(2)
    v_mfma_f32_16x16x32_bf16 v[100:103], v[32:35], v[52:55], 0
    ds_read_b128 v[48:51], v7 offset:4096
    s_waitcnt lgkmcnt(2)
    v_mfma_f32_16x16x32_bf16 v[104:107], v[32:35], v[56:59], 0
    ds_read_b128 v[52:55], v7 offset:5120
    s_waitcnt lgkmcnt(2)
    v_mfma_f32_16x16x32_bf16 v[108:111], v[32:35], v[60:63], 0
    ds_read_b128 v[56:59], v7 offset:6144
    v_cvt_pk_bf16_f32 v16, v64, v68
    s_waitcnt lgkmcnt(2)
    v_mfma_f32_16x16x32_bf16 v[112:115], v[32:35], v[48:51], 0
    ds_read_b128 v[60:63], v7 offset:7168
    v_cvt_pk_bf16_f32 v17, v72, v76
    s_waitcnt lgkmcnt(2)
    v_mfma_f32_16x16x32_bf16 v[116:119], v[32:35], v[52:55], 0
    ds_read_b128 v[48:51], v7 offset:8192
    v_cvt_pk_bf16_f32 v18, v80, v84
    s_waitcnt lgkmcnt(2)
    v_mfma_f32_16x16x32_bf16 v[120:123], v[32:35], v[56:59], 0
    ds_read_b128 v[52:55], v7 offset:9216
    v_cvt_pk_bf16_f32 v19, v88, v92
    s_waitcnt lgkmcnt(2)
    v_mfma_f32_16x16x32_bf16 v[124:127], v[32:35], v[60:63], 0
    ds_read_b128 v[56:59], v7 offset:10240
    v_and_or_b32 v16, v16, -2, s27
    s_waitcnt lgkmcnt(2)
    v_mfma_f32_16x16x32_bf16 v[96:99], v[36:39], v[48:51], v[96:99]
    ds_read_b128 v[60:63], v7 offset:11264
    s_add_u32 s36, s25, 0x0
    s_waitcnt lgkmcnt(2)
    v_mfma_f32_16x16x32_bf16 v[100:103], v[36:39], v[52:55], v[100:103]
    ds_read_b128 v[48:51], v7 offset:12288
    buffer_store_dwordx4 v[16:19], v10, s[8:11], s36 offen sc1
    s_waitcnt lgkmcnt(2)
    v_mfma_f32_16x16x32_bf16 v[104:107], v[36:39], v[56:59], v[104:107]
    ds_read_b128 v[52:55], v7 offset:13312
    v_cvt_pk_bf16_f32 v20, v65, v69
    s_waitcnt lgkmcnt(2)
    v_mfma_f32_16x16x32_bf16 v[108:111], v[36:39], v[60:63], v[108:111]
    ds_read_b128 v[56:59], v7 offset:14336
    v_cvt_pk_bf16_f32 v21, v73, v77
    s_waitcnt lgkmcnt(2)
    v_mfma_f32_16x16x32_bf16 v[112:115], v[36:39], v[48:51], v[112:115]
    ds_read_b128 v[60:63], v7 offset:15360
    v_cvt_pk_bf16_f32 v22, v81, v85
    s_waitcnt lgkmcnt(2)
    v_mfma_f32_16x16x32_bf16 v[116:119], v[36:39], v[52:55], v[116:119]
    ds_read_b128 v[48:51], v7 offset:16384
    v_cvt_pk_bf16_f32 v23, v89, v93
    s_waitcnt lgkmcnt(2)
    v_mfma_f32_16x16x32_bf16 v[120:123], v[36:39], v[56:59], v[120:123]
    ds_read_b128 v[52:55], v7 offset:17408
    v_and_or_b32 v20, v20, -2, s27
    s_waitcnt lgkmcnt(2)
    v_mfma_f32_16x16x32_bf16 v[124:127], v[36:39], v[60:63], v[124:127]
    ds_read_b128 v[56:59], v7 offset:18432
    s_add_u32 s36, s25, 0x8000
    s_waitcnt lgkmcnt(2)
    v_mfma_f32_16x16x32_bf16 v[96:99], v[40:43], v[48:51], v[96:99]
    ds_read_b128 v[60:63], v7 offset:19456
    buffer_store_dwordx4 v[20:23], v10, s[8:11], s36 offen sc1
    s_waitcnt lgkmcnt(2)
    v_mfma_f32_16x16x32_bf16 v[100:103], v[40:43], v[52:55], v[100:103]
    ds_read_b128 v[48:51], v7 offset:20480
    v_cvt_pk_bf16_f32 v24, v66, v70
    s_waitcnt lgkmcnt(2)
    v_mfma_f32_16x16x32_bf16 v[104:107], v[40:43], v[56:59], v[104:107]
    ds_read_b128 v[52:55], v7 offset:21504
    v_cvt_pk_bf16_f32 v25, v74, v78
    s_waitcnt lgkmcnt(2)
    v_mfma_f32_16x16x32_bf16 v[108:111], v[40:43], v[60:63], v[108:111]
    ds_read_b128 v[56:59], v7 offset:22528
    v_cvt_pk_bf16_f32 v26, v82, v86
    s_waitcnt lgkmcnt(2)
    v_mfma_f32_16x16x32_bf16 v[112:115], v[40:43], v[48:51], v[112:115]
    ds_read_b128 v[60:63], v7 offset:23552
    v_cvt_pk_bf16_f32 v27, v90, v94
    s_waitcnt lgkmcnt(2)
    v_mfma_f32_16x16x32_bf16 v[116:119], v[40:43], v[52:55], v[116:119]
    ds_read_b128 v[48:51], v7 offset:24576
    v_and_or_b32 v24, v24, -2, s27
    s_waitcnt lgkmcnt(2)
    v_mfma_f32_16x16x32_bf16 v[120:123], v[40:43], v[56:59], v[120:123]
    ds_read_b128 v[52:55], v7 offset:25600
    s_add_u32 s36, s25, 0x10000
    s_waitcnt lgkmcnt(2)
    v_mfma_f32_16x16x32_bf16 v[124:127], v[40:43], v[60:63], v[124:127]
    ds_read_b128 v[56:59], v7 offset:26624
    buffer_store_dwordx4 v[24:27], v10, s[8:11], s36 offen sc1
    s_waitcnt lgkmcnt(2)
    v_mfma_f32_16x16x32_bf16 v[96:99], v[44:47], v[48:51], v[96:99]
    ds_read_b128 v[60:63], v7 offset:27648
    v_cvt_pk_bf16_f32 v28, v67, v71
    s_waitcnt lgkmcnt(2)
    v_mfma_f32_16x16x32_bf16 v[100:103], v[44:47], v[52:55], v[100:103]
    ds_read_b128 v[48:51], v7 offset:28672
    v_cvt_pk_bf16_f32 v29, v75, v79
    s_waitcnt lgkmcnt(2)
    v_mfma_f32_16x16x32_bf16 v[104:107], v[44:47], v[56:59], v[104:107]
    ds_read_b128 v[52:55], v7 offset:29696
    v_cvt_pk_bf16_f32 v30, v83, v87
    s_waitcnt lgkmcnt(2)
    v_mfma_f32_16x16x32_bf16 v[108:111], v[44:47], v[60:63], v[108:111]
    ds_read_b128 v[56:59], v7 offset:30720
    v_cvt_pk_bf16_f32 v31, v91, v95
    s_waitcnt lgkmcnt(2)
    v_mfma_f32_16x16x32_bf16 v[112:115], v[44:47], v[48:51], v[112:115]
    ds_read_b128 v[60:63], v7 offset:31744
    v_and_or_b32 v28, v28, -2, s27
    s_waitcnt lgkmcnt(2)
    v_mfma_f32_16x16x32_bf16 v[116:119], v[44:47], v[52:55], v[116:119]
    s_add_u32 s36, s25, 0x18000
    s_waitcnt lgkmcnt(1)
    v_mfma_f32_16x16x32_bf16 v[120:123], v[44:47], v[56:59], v[120:123]
    buffer_store_dwordx4 v[28:31], v10, s[8:11], s36 offen sc1
    s_waitcnt lgkmcnt(0)
    v_mfma_f32_16x16x32_bf16 v[124:127], v[44:47], v[60:63], v[124:127]
    v_cvt_pk_bf16_f32 v32, v96, v100
    v_cvt_pk_bf16_f32 v33, v104, v108
    v_cvt_pk_bf16_f32 v34, v112, v116
    s_nop 4
    v_cvt_pk_bf16_f32 v35, v120, v124
    v_and_or_b32 v32, v32, -2, s27
    s_add_u32 s36, s25, 0x80000
    buffer_store_dwordx4 v[32:35], v10, s[8:11], s36 offen sc1
    v_cvt_pk_bf16_f32 v36, v97, v101
    v_cvt_pk_bf16_f32 v37, v105, v109
    v_cvt_pk_bf16_f32 v38, v113, v117
    v_cvt_pk_bf16_f32 v39, v121, v125
    v_and_or_b32 v36, v36, -2, s27
    s_add_u32 s36, s25, 0x88000
    buffer_store_dwordx4 v[36:39], v10, s[8:11], s36 offen sc1
    v_cvt_pk_bf16_f32 v40, v98, v102
    v_cvt_pk_bf16_f32 v41, v106, v110
    v_cvt_pk_bf16_f32 v42, v114, v118
    v_cvt_pk_bf16_f32 v43, v122, v126
    v_and_or_b32 v40, v40, -2, s27
    s_add_u32 s36, s25, 0x90000
    buffer_store_dwordx4 v[40:43], v10, s[8:11], s36 offen sc1
    v_cvt_pk_bf16_f32 v44, v99, v103
    v_cvt_pk_bf16_f32 v45, v107, v111
    v_cvt_pk_bf16_f32 v46, v115, v119
    v_cvt_pk_bf16_f32 v47, v123, v127
    v_and_or_b32 v44, v44, -2, s27
    s_add_u32 s36, s25, 0x98000
    buffer_store_dwordx4 v[44:47], v10, s[8:11], s36 offen sc1
    s_add_u32 s38, s23, 6
    s_cmp_ge_u32 s38, 64
    s_cbranch_scc1 L_P2_last
    s_mul_i32 s24, s38, 0x82100
    s_lshl_b32 s36, s20, 14
    s_add_u32 s24, s24, s36
    s_add_u32 s24, s24, 0x1000000
    s_add_u32 s36, s24, 0
    s_add_u32 s37, s36, 0x7000000
    buffer_load_dwordx4 a[32:35], v1, s[8:11], s36 offen offset:0 sc1
    buffer_load_dwordx4 a[0:3], v1, s[8:11], s37 offen offset:0 sc1
    buffer_load_dwordx4 a[36:39], v1, s[8:11], s36 offen offset:1024 sc1
    buffer_load_dwordx4 a[4:7], v1, s[8:11], s37 offen offset:1024 sc1
    buffer_load_dwordx4 a[40:43], v1, s[8:11], s36 offen offset:2048 sc1
    buffer_load_dwordx4 a[8:11], v1, s[8:11], s37 offen offset:2048 sc1
    buffer_load_dwordx4 a[44:47], v1, s[8:11], s36 offen offset:3072 sc1
    buffer_load_dwordx4 a[12:15], v1, s[8:11], s37 offen offset:3072 sc1
    s_add_u32 s36, s24, 4096
    s_add_u32 s37, s36, 0x7000000
    buffer_load_dwordx4 a[48:51], v1, s[8:11], s36 offen offset:0 sc1
    buffer_load_dwordx4 a[16:19], v1, s[8:11], s37 offen offset:0 sc1
    buffer_load_dwordx4 a[52:55], v1, s[8:11], s36 offen offset:1024 sc1
    buffer_load_dwordx4 a[20:23], v1, s[8:11], s37 offen offset:1024 sc1
    buffer_load_dwordx4 a[56:59], v1, s[8:11], s36 offen offset:2048 sc1
    buffer_load_dwordx4 a[24:27], v1, s[8:11], s37 offen offset:2048 sc1
    buffer_load_dwordx4 a[60:63], v1, s[8:11], s36 offen offset:3072 sc1
    buffer_load_dwordx4 a[28:31], v1, s[8:11], s37 offen offset:3072 sc1
    s_lshr_b32 s36, s21, 1
    s_lshl_b32 s36, s36, 3
    s_xor_b32 s37, s36, 8
    s_add_u32 s24, s24, 8192
    s_add_u32 s36, s36, s24
    s_add_u32 s37, s37, s24
    buffer_load_dwordx2 a[64:65], v2, s[8:11], s36 offen offset:0 sc1
    buffer_load_dwordx2 a[66:67], v2, s[8:11], s37 offen offset:0 sc1
    buffer_load_dwordx2 a[68:69], v2, s[8:11], s36 offen offset:1024 sc1
    buffer_load_dwordx2 a[70:71], v2, s[8:11], s37 offen offset:1024 sc1
L_P2_last:
    s_lshl_b32 s24, s23, 5
    s_add_u32 s24, s24, s20
    s_lshl_b32 s24, s24, 10
    v_accvgpr_read_b32 v52, a72
    v_accvgpr_read_b32 v53, a73
    v_and_b32 v15, 15, v0
    v_mov_b32 v48, 0
    v_mov_b32 v14, 0x3f80
    v_cmp_eq_u32 vcc, 0, v15
    s_nop 1
    v_cndmask_b32 v48, v48, v14, vcc
    v_mov_b32 v14, 0x3f800000
    v_cmp_eq_u32 vcc, 1, v15
    s_nop 1
    v_cndmask_b32 v48, v48, v14, vcc
    v_mov_b32 v49, 0
    v_mov_b32 v14, 0x3f80
    v_cmp_eq_u32 vcc, 4, v15
    s_nop 1
    v_cndmask_b32 v49, v49, v14, vcc
    v_mov_b32 v14, 0x3f800000
    v_cmp_eq_u32 vcc, 5, v15
    s_nop 1
    v_cndmask_b32 v49, v49, v14, vcc
    v_mov_b32 v50, 0
    v_mov_b32 v14, 0x3f80
    v_cmp_eq_u32 vcc, 8, v15
    s_nop 1
    v_cndmask_b32 v50, v50, v14, vcc
    v_mov_b32 v14, 0x3f800000
    v_cmp_eq_u32 vcc, 9, v15
    s_nop 1
    v_cndmask_b32 v50, v50, v14, vcc
    v_mov_b32 v51, 0
    v_mov_b32 v14, 0x3f80
    v_cmp_eq_u32 vcc, 12, v15
    s_nop 1
    v_cndmask_b32 v51, v51, v14, vcc
    v_mov_b32 v14, 0x3f800000
    v_cmp_eq_u32 vcc, 13, v15
    s_nop 1
    v_cndmask_b32 v51, v51, v14, vcc
    s_lshl_b32 s25, s20, 15
    s_add_u32 s25, s25, s26
L_P3_poll:
    s_add_u32 s36, s25, 0
    buffer_load_dwordx4 v[80:83], v11, s[8:11], s36 offen sc1
    s_add_u32 s36, s25, 4096
    buffer_load_dwordx4 v[84:87], v11, s[8:11], s36 offen sc1
    s_add_u32 s36, s25, 8192
    buffer_load_dwordx4 v[88:91], v11, s[8:11], s36 offen sc1
    s_add_u32 s36, s25, 12288
    buffer_load_dwordx4 v[92:95], v11, s[8:11], s36 offen sc1
    s_add_u32 s36, s25, 16384
    buffer_load_dwordx4 v[96:99], v11, s[8:11], s36 offen sc1
    s_add_u32 s36, s25, 20480
    buffer_load_dwordx4 v[100:103], v11, s[8:11], s36 offen sc1
    s_add_u32 s36, s25, 24576
    buffer_load_dwordx4 v[104:107], v11, s[8:11], s36 offen sc1
    s_add_u32 s36, s25, 28672
    buffer_load_dwordx4 v[108:111], v11, s[8:11], s36 offen sc1
    s_mov_b64 exec, -1
    s_add_u32 s32, s32, 1
    s_cmp_gt_u32 s32, 200000
    s_waitcnt vmcnt(7)
    v_mfma_f32_16x16x32_bf16 v[56:59], v[48:51], v[80:83], 0
    s_waitcnt vmcnt(6)
    v_mfma_f32_16x16x32_bf16 v[56:59], v[48:51], v[84:87], v[56:59]
    v_bitop3_b32 v60, v80, v84, s27 bitop3:0x7e
    s_waitcnt vmcnt(5)
    v_mfma_f32_16x16x32_bf16 v[56:59], v[48:51], v[88:91], v[56:59]
    s_waitcnt vmcnt(4)
    v_mfma_f32_16x16x32_bf16 v[56:59], v[48:51], v[92:95], v[56:59]
    v_bitop3_b32 v61, v88, v92, s27 bitop3:0x7e
    s_waitcnt vmcnt(3)
    v_mfma_f32_16x16x32_bf16 v[56:59], v[48:51], v[96:99], v[56:59]
    s_waitcnt vmcnt(2)
    v_mfma_f32_16x16x32_bf16 v[56:59], v[48:51], v[100:103], v[56:59]
    v_bitop3_b32 v62, v96, v100, s27 bitop3:0x7e
    s_waitcnt vmcnt(1)
    v_mfma_f32_16x16x32_bf16 v[56:59], v[48:51], v[104:107], v[56:59]
    s_waitcnt vmcnt(0)
    v_mfma_f32_16x16x32_bf16 v[56:59], v[48:51], v[108:111], v[56:59]
    v_bitop3_b32 v63, v104, v108, s27 bitop3:0x7e
    v_or3_b32 v14, v60, v61, v62
    v_bitop3_b32 v14, v14, v63, 1 bitop3:0xa8
    s_cbranch_scc1 L_P3_got
    v_cmp_ne_u32 vcc, 0, v14
    s_cbranch_vccz L_P3_got
    s_mov_b64 exec, vcc
    s_branch L_P3_poll
L_P3_got:
    s_nop 4
    v_cvt_pk_bf16_f32 v62, v56, v57
    v_lshlrev_b32 v65, 16, v62
    v_and_b32 v66, 0xffff0000, v62
    v_lshlrev_b32 v60, 16, v52
    v_and_b32 v61, 0xffff0000, v52
    v_add_f32 v60, v60, v65
    v_add_f32 v61, v61, v66
    v_cvt_pk_bf16_f32 v62, v60, v61
    v_lshlrev_b32 v60, 16, v62
    v_and_b32 v61, 0xffff0000, v62
    v_add_f32 v63, v60, v61
    v_mul_f32 v64, v60, v60
    v_fmac_f32 v64, v61, v61
    v_add_f32_dpp v63, v63, v63 quad_perm:[1,0,3,2] row_mask:0xf bank_mask:0xf
    s_nop 0
    v_add_f32_dpp v64, v64, v64 quad_perm:[1,0,3,2] row_mask:0xf bank_mask:0xf
    v_add_f32_dpp v63, v63, v63 quad_perm:[2,3,0,1] row_mask:0xf bank_mask:0xf
    s_nop 0
    v_add_f32_dpp v64, v64, v64 quad_perm:[2,3,0,1] row_mask:0xf bank_mask:0xf
    v_add_f32_dpp v63, v63, v63 row_half_mirror row_mask:0xf bank_mask:0xf
    s_nop 0
    v_add_f32_dpp v64, v64, v64 row_half_mirror row_mask:0xf bank_mask:0xf
    v_add_f32_dpp v63, v63, v63 row_mirror row_mask:0xf bank_mask:0xf
    s_nop 0
    v_add_f32_dpp v64, v64, v64 row_mirror row_mask:0xf bank_mask:0xf
    v_mov_b32 v14, v63
    s_nop 1
    v_permlane16_swap_b32 v63, v14
    v_add_f32 v63, v63, v14
    v_mov_b32 v14, v64
    s_nop 1
    v_permlane16_swap_b32 v64, v14
    v_add_f32 v64, v64, v14
    v_mov_b32 v14, v63
    s_nop 1
    v_permlane32_swap_b32 v63, v14
    v_add_f32 v63, v63, v14
    v_mov_b32 v14, v64
    s_nop 1
    v_permlane32_swap_b32 v64, v14
    v_add_f32 v64, v64, v14
    v_mov_b32 v15, s21
    v_lshlrev_b32 v15, 3, v15
    v_add_u32 v15, 28672, v15
    ds_write2_b32 v15, v63, v64 offset0:0 offset1:1
    s_add_u32 s36, s24, 0x400000
    buffer_store_dword v62, v12, s[8:11], s36 offen sc1
    s_waitcnt lgkmcnt(0)
    s_barrier
    v_mov_b32 v15, 28672
    ds_read_b128 v[68:71], v15
    ds_read_b128 v[72:75], v15 offset:16
    s_waitcnt lgkmcnt(0)
    v_add_f32 v63, v68, v70
    v_add_f32 v63, v63, v72
    v_add_f32 v63, v63, v74
    v_mul_f32 v63, 0x3b000000, v63
    v_add_f32 v64, v69, v71
    v_add_f32 v64, v64, v73
    v_add_f32 v64, v64, v75
    v_mul_f32 v64, 0x3b000000, v64
    v_fma_f32 v64, -v63, v63, v64
    v_max_f32 v64, 0, v64
    v_cvt_pk_bf16_f32 v14, v63, v64
    v_lshlrev_b32 v63, 16, v14
    v_and_b32 v64, 0xffff0000, v14
    v_add_f32 v64, 0x3727c5ac, v64
    v_cvt_pk_bf16_f32 v14, v64, v64
    v_lshlrev_b32 v64, 16, v14
    v_sqrt_f32 v64, v64
    s_nop 0
    v_cvt_pk_bf16_f32 v14, v64, v64
    v_lshlrev_b32 v64, 16, v14
    v_rcp_f32 v64, v64
    v_sub_f32 v65, v60, v63
    v_sub_f32 v66, v61, v63
    v_cvt_pk_bf16_f32 v14, v65, v66
    v_lshlrev_b32 v65, 16, v14
    v_and_b32 v66, 0xffff0000, v14
    v_mul_f32 v65, v65, v64
    v_mul_f32 v66, v66, v64
    v_cvt_pk_bf16_f32 v67, v65, v66
    v_lshlrev_b32 v65, 16, v67
    v_and_b32 v66, 0xffff0000, v67
    v_lshlrev_b32 v68, 16, v53
    v_and_b32 v69, 0xffff0000, v53
    v_mul_f32 v63, v65, v68
    v_fmac_f32 v63, v66, v69
    s_nop 1
    v_add_f32_dpp v63, v63, v63 quad_perm:[1,0,3,2] row_mask:0xf bank_mask:0xf
    s_nop 1
    v_add_f32_dpp v63, v63, v63 quad_perm:[2,3,0,1] row_mask:0xf bank_mask:0xf
    s_nop 1
    v_add_f32_dpp v63, v63, v63 row_half_mirror row_mask:0xf bank_mask:0xf
    s_nop 1
    v_add_f32_dpp v63, v63, v63 row_mirror row_mask:0xf bank_mask:0xf
    v_mov_b32 v14, v63
    s_nop 1
    v_permlane16_swap_b32 v63, v14
    v_add_f32 v63, v63, v14
    v_mov_b32 v14, v63
    s_nop 1
    v_permlane32_swap_b32 v63, v14
    v_add_f32 v63, v63, v14
    s_lshr_b32 s25, s24, 6
    s_lshl_b32 s37, s21, 2
    s_add_u32 s25, s25, s37
    s_add_u32 s36, s25, 0x194000
    v_cmp_ne_u32 vcc, 0, v1
    v_mov_b32 v15, 0x40000000
    s_nop 0
    v_cndmask_b32 v15, v1, v15, vcc
    buffer_store_dword v63, v15, s[8:11], s36 offen sc1
    v_add_f32 v60, v60, v65
    v_add_f32 v61, v61, v66
    v_cvt_pk_bf16_f32 v62, v60, v61
    buffer_store_dword v62, v12, s[60:63], s24 offen sc1
    s_add_u32 s36, s24, 0x600000
    buffer_store_dword v67, v12, s[8:11], s36 offen sc1
    s_add_u32 s30, s25, 0x1b8000
    s_add_u32 s29, s29, 1
    s_barrier
    s_add_u32 s23, s23, 6
    s_cmp_lt_u32 s23, 64
    s_cbranch_scc1 L_P2
    s_waitcnt vmcnt(0)
    v_cmp_ne_u32 vcc, 0, v1
    v_mov_b32 v15, 0x40000000
    v_mov_b32 v14, 0
    v_cndmask_b32 v15, v1, v15, vcc
    buffer_store_dword v14, v15, s[8:11], s30 offen sc1
    s_branch L_end
L_mlp:
    s_mov_b32 s12, s44
    s_and_b32 s13, s45, 0xffff
    s_mov_b32 s14, 0x200000
    s_mov_b32 s15, 0x20000
    s_mov_b32 s60, s82
    s_and_b32 s61, s83, 0xffff
    s_mov_b32 s62, 0x200000
    s_mov_b32 s63, 0x20000
    s_mov_b32 s92, s80
    s_and_b32 s93, s81, 0xffff
    s_mov_b32 s94, 0x400
    s_mov_b32 s95, 0x20000
    v_mov_b32 v1, 0x0
    v_bfe_u32 v14, v0, 0, 1
    s_mov_b32 s38, 0x10
    v_mad_u32_u24 v1, v14, s38, v1
    v_bfe_u32 v14, v0, 1, 1
    s_mov_b32 s38, 0x20
    v_mad_u32_u24 v1, v14, s38, v1
    v_bfe_u32 v14, v0, 2, 1
    s_mov_b32 s38, 0x40
    v_mad_u32_u24 v1, v14, s38, v1
    v_bfe_u32 v14, v0, 3, 1
    s_mov_b32 s38, 0x80
    v_mad_u32_u24 v1, v14, s38, v1
    v_bfe_u32 v14, v0, 4, 1
    s_mov_b32 s38, 0x100
    v_mad_u32_u24 v1, v14, s38, v1
    v_bfe_u32 v14, v0, 5, 1
    s_mov_b32 s38, 0x200
    v_mad_u32_u24 v1, v14, s38, v1
    v_mov_b32 v2, 0x0
    v_bfe_u32 v14, v0, 0, 1
    s_mov_b32 s38, 0x10
    v_mad_u32_u24 v2, v14, s38, v2
    v_bfe_u32 v14, v0, 1, 1
    s_mov_b32 s38, 0x20
    v_mad_u32_u24 v2, v14, s38, v2
    v_bfe_u32 v14, v0, 2, 1
    s_mov_b32 s38, 0x40
    v_mad_u32_u24 v2, v14, s38, v2
    v_bfe_u32 v14, v0, 3, 1
    s_mov_b32 s38, 0x80
    v_mad_u32_u24 v2, v14, s38, v2
    v_bfe_u32 v14, v0, 4, 1
    s_mov_b32 s38, 0x100
    v_mad_u32_u24 v2, v14, s38, v2
    v_bfe_u32 v14, v0, 5, 1
    s_mov_b32 s38, 0x200
    v_mad_u32_u24 v2, v14, s38, v2
    v_bfe_u32 v14, v0, 6, 1
    s_mov_b32 s38, 0x800
    v_mad_u32_u24 v2, v14, s38, v2
    v_bfe_u32 v14, v0, 7, 1
    s_mov_b32 s38, 0x1000
    v_mad_u32_u24 v2, v14, s38, v2
    v_mov_b32 v9, 0x0
    v_bfe_u32 v14, v0, 0, 1
    s_mov_b32 s38, 0x10
    v_mad_u32_u24 v9, v14, s38, v9
    v_bfe_u32 v14, v0, 1, 1
    s_mov_b32 s38, 0x20
    v_mad_u32_u24 v9, v14, s38, v9
    v_bfe_u32 v14, v0, 2, 1
    s_mov_b32 s38, 0x40
    v_mad_u32_u24 v9, v14, s38, v9
    v_bfe_u32 v14, v0, 3, 1
    s_mov_b32 s38, 0x80
    v_mad_u32_u24 v9, v14, s38, v9
    v_bfe_u32 v14, v0, 4, 1
    s_mov_b32 s38, 0x100
    v_mad_u32_u24 v9, v14, s38, v9
    v_bfe_u32 v14, v0, 5, 1
    s_mov_b32 s38, 0x200
    v_mad_u32_u24 v9, v14, s38, v9
    v_bfe_u32 v14, v0, 6, 1
    s_mov_b32 s38, 0x400
    v_mad_u32_u24 v9, v14, s38, v9
    v_bfe_u32 v14, v0, 7, 1
    s_mov_b32 s38, 0x800
    v_mad_u32_u24 v9, v14, s38, v9
    v_mov_b32 v7, 0x8000
    v_bfe_u32 v14, v0, 0, 1
    s_mov_b32 s38, 0x10
    v_mad_u32_u24 v7, v14, s38, v7
    v_bfe_u32 v14, v0, 1, 1
    s_mov_b32 s38, 0x20
    v_mad_u32_u24 v7, v14, s38, v7
    v_bfe_u32 v14, v0, 2, 1
    s_mov_b32 s38, 0x40
    v_mad_u32_u24 v7, v14, s38, v7
    v_bfe_u32 v14, v0, 3, 1
    s_mov_b32 s38, 0x80
    v_mad_u32_u24 v7, v14, s38, v7
    v_bfe_u32 v14, v0, 4, 1
    s_mov_b32 s38, 0x100
    v_mad_u32_u24 v7, v14, s38, v7
    v_bfe_u32 v14, v0, 5, 1
    s_mov_b32 s38, 0x200
    v_mad_u32_u24 v7, v14, s38, v7
    v_bfe_u32 v14, v0, 6, 1
    s_mov_b32 s38, 0x8000
    v_mad_u32_u24 v7, v14, s38, v7
    v_bfe_u32 v14, v0, 7, 1
    s_mov_b32 s38, 0x10000
    v_mad_u32_u24 v7, v14, s38, v7
    v_mov_b32 v3, 0x0
    v_bfe_u32 v14, v0, 0, 1
    s_mov_b32 s38, 0x10
    v_mad_u32_u24 v3, v14, s38, v3
    v_bfe_u32 v14, v0, 1, 1
    s_mov_b32 s38, 0x20
    v_mad_u32_u24 v3, v14, s38, v3
    v_bfe_u32 v14, v0, 2, 1
    s_mov_b32 s38, 0x40
    v_mad_u32_u24 v3, v14, s38, v3
    v_bfe_u32 v14, v0, 3, 1
    s_mov_b32 s38, 0x400
    v_mad_u32_u24 v3, v14, s38, v3
    v_bfe_u32 v14, v0, 4, 1
    s_mov_b32 s38, 0x800
    v_mad_u32_u24 v3, v14, s38, v3
    v_bfe_u32 v14, v0, 5, 1
    s_mov_b32 s38, 0x1000
    v_mad_u32_u24 v3, v14, s38, v3
    v_bfe_u32 v14, v0, 6, 1
    s_mov_b32 s38, 0x2000
    v_mad_u32_u24 v3, v14, s38, v3
    v_bfe_u32 v14, v0, 7, 1
    s_mov_b32 s38, 0x4000
    v_mad_u32_u24 v3, v14, s38, v3
    v_mov_b32 v4, 0x0
    v_bfe_u32 v14, v0, 0, 1
    s_mov_b32 s38, 0x100
    v_mad_u32_u24 v4, v14, s38, v4
    v_bfe_u32 v14, v0, 1, 1
    s_mov_b32 s38, 0x200
    v_mad_u32_u24 v4, v14, s38, v4
    v_bfe_u32 v14, v0, 2, 1
    s_mov_b32 s38, 0x400
    v_mad_u32_u24 v4, v14, s38, v4
    v_bfe_u32 v14, v0, 6, 1
    s_mov_b32 s38, 0x80
    v_mad_u32_u24 v4, v14, s38, v4
    v_bfe_u32 v14, v0, 7, 1
    s_mov_b32 s38, 0x4000
    v_mad_u32_u24 v4, v14, s38, v4
    v_lshrrev_b32 v15, 3, v0
    v_xor_b32 v15, v15, v0
    v_and_b32 v15, 7, v15
    v_lshl_add_u32 v4, v15, 4, v4
    v_bfe_u32 v15, v0, 4, 2
    v_lshlrev_b32 v15, 4, v15
    v_xor_b32 v5, v15, v1
    v_xor_b32 v6, 64, v5
    v_mov_b32 v8, 0x5000
    v_bfe_u32 v14, v0, 0, 1
    s_mov_b32 s38, 0x10
    v_mad_u32_u24 v8, v14, s38, v8
    v_bfe_u32 v14, v0, 1, 1
    s_mov_b32 s38, 0x40
    v_mad_u32_u24 v8, v14, s38, v8
    v_bfe_u32 v14, v0, 2, 1
    s_mov_b32 s38, 0x80
    v_mad_u32_u24 v8, v14, s38, v8
    v_bfe_u32 v14, v0, 4, 1
    s_mov_b32 s38, 0x20
    v_mad_u32_u24 v8, v14, s38, v8
    v_bfe_u32 v14, v0, 5, 1
    s_mov_b32 s38, 0x100
    v_mad_u32_u24 v8, v14, s38, v8
    v_mov_b32 v10, 0x0
    v_bfe_u32 v14, v0, 0, 1
    s_mov_b32 s38, 0x10
    v_mad_u32_u24 v10, v14, s38, v10
    v_bfe_u32 v14, v0, 1, 1
    s_mov_b32 s38, 0x20
    v_mad_u32_u24 v10, v14, s38, v10
    v_bfe_u32 v14, v0, 2, 1
    s_mov_b32 s38, 0x40
    v_mad_u32_u24 v10, v14, s38, v10
    v_bfe_u32 v14, v0, 3, 1
    s_mov_b32 s38, 0x80
    v_mad_u32_u24 v10, v14, s38, v10
    v_bfe_u32 v14, v0, 4, 1
    s_mov_b32 s38, 0x20000
    v_mad_u32_u24 v10, v14, s38, v10
    v_bfe_u32 v14, v0, 5, 1
    s_mov_b32 s38, 0x40000
    v_mad_u32_u24 v10, v14, s38, v10
    v_bfe_u32 v14, v0, 6, 1
    s_mov_b32 s38, 0x100
    v_mad_u32_u24 v10, v14, s38, v10
    v_bfe_u32 v14, v0, 7, 1
    s_mov_b32 s38, 0x200
    v_mad_u32_u24 v10, v14, s38, v10
    v_mov_b32 v11, 0x0
    v_bfe_u32 v14, v0, 0, 1
    s_mov_b32 s38, 0x10
    v_mad_u32_u24 v11, v14, s38, v11
    v_bfe_u32 v14, v0, 1, 1
    s_mov_b32 s38, 0x20
    v_mad_u32_u24 v11, v14, s38, v11
    v_bfe_u32 v14, v0, 2, 1
    s_mov_b32 s38, 0x40
    v_mad_u32_u24 v11, v14, s38, v11
    v_bfe_u32 v14, v0, 3, 1
    s_mov_b32 s38, 0x80
    v_mad_u32_u24 v11, v14, s38, v11
    v_bfe_u32 v14, v0, 4, 1
    s_mov_b32 s38, 0x400
    v_mad_u32_u24 v11, v14, s38, v11
    v_bfe_u32 v14, v0, 5, 1
    s_mov_b32 s38, 0x800
    v_mad_u32_u24 v11, v14, s38, v11
    v_bfe_u32 v14, v0, 6, 1
    s_mov_b32 s38, 0x100
    v_mad_u32_u24 v11, v14, s38, v11
    v_bfe_u32 v14, v0, 7, 1
    s_mov_b32 s38, 0x200
    v_mad_u32_u24 v11, v14, s38, v11
    v_mov_b32 v12, 0x0
    v_bfe_u32 v14, v0, 0, 1
    s_mov_b32 s38, 0x10
    v_mad_u32_u24 v12, v14, s38, v12
    v_bfe_u32 v14, v0, 1, 1
    s_mov_b32 s38, 0x20
    v_mad_u32_u24 v12, v14, s38, v12
    v_bfe_u32 v14, v0, 2, 1
    s_mov_b32 s38, 0x40
    v_mad_u32_u24 v12, v14, s38, v12
    v_bfe_u32 v14, v0, 3, 1
    s_mov_b32 s38, 0x80
    v_mad_u32_u24 v12, v14, s38, v12
    v_bfe_u32 v14, v0, 4, 1
    s_mov_b32 s38, 0x4
    v_mad_u32_u24 v12, v14, s38, v12
    v_bfe_u32 v14, v0, 5, 1
    s_mov_b32 s38, 0x8
    v_mad_u32_u24 v12, v14, s38, v12
    v_bfe_u32 v14, v0, 6, 1
    s_mov_b32 s38, 0x100
    v_mad_u32_u24 v12, v14, s38, v12
    v_bfe_u32 v14, v0, 7, 1
    s_mov_b32 s38, 0x200
    v_mad_u32_u24 v12, v14, s38, v12
    v_mov_b32 v13, 0xf149f2ca
    v_and_b32 v14, 15, v0
    v_bfe_u32 v15, v0, 4, 2
    v_cmp_gt_u32 s[72:73], 2, v15
    v_lshlrev_b32 v15, 2, v15
    v_cmp_le_u32 s[64:65], v15, v14
    v_add_u32 v15, 1, v15
    v_cmp_le_u32 s[66:67], v15, v14
    v_add_u32 v15, 1, v15
    v_cmp_le_u32 s[68:69], v15, v14
    v_add_u32 v15, 1, v15
    v_cmp_le_u32 s[70:71], v15, v14
    v_add_u32 v15, 1, v15
    s_mov_b32 s34, 0x05040100
    s_mov_b32 s35, 0x07060302
    s_mov_b32 s33, 0x3e0293ee
    s_mov_b32 s32, 0
    s_mov_b32 s4, 0x3f803f80
    s_mov_b32 s5, 0x3f803f80
    s_lshr_b32 s20, s2, 3
    s_lshr_b32 s23, s2, 3
    s_lshl_b32 s23, s23, 1
    s_lshl_b32 s36, s23, 15
    buffer_load_dwordx4 v[96:99], v3, s[12:15], s36 offen offset:0
    buffer_load_dwordx4 v[100:103], v3, s[12:15], s36 offen offset:128
    buffer_load_dwordx4 v[104:107], v3, s[12:15], s36 offen offset:256
    buffer_load_dwordx4 v[108:111], v3, s[12:15], s36 offen offset:384
    buffer_load_dwordx4 v[112:115], v3, s[12:15], s36 offen offset:512
    buffer_load_dwordx4 v[116:119], v3, s[12:15], s36 offen offset:640
    buffer_load_dwordx4 v[120:123], v3, s[12:15], s36 offen offset:768
    buffer_load_dwordx4 v[124:127], v3, s[12:15], s36 offen offset:896
    s_add_u32 s36, s36, 0x8000
    buffer_load_dwordx4 v[128:131], v3, s[12:15], s36 offen offset:0
    buffer_load_dwordx4 v[132:135], v3, s[12:15], s36 offen offset:128
    buffer_load_dwordx4 v[136:139], v3, s[12:15], s36 offen offset:256
    buffer_load_dwordx4 v[140:143], v3, s[12:15], s36 offen offset:384
    buffer_load_dwordx4 v[144:147], v3, s[12:15], s36 offen offset:512
    buffer_load_dwordx4 v[148:151], v3, s[12:15], s36 offen offset:640
    buffer_load_dwordx4 v[152:155], v3, s[12:15], s36 offen offset:768
    buffer_load_dwordx4 v[156:159], v3, s[12:15], s36 offen offset:896
    s_mov_b32 s96, s46
    s_and_b32 s97, s47, 0xffff
    s_mov_b32 s98, 0x2000
    s_mov_b32 s99, 0x20000
    v_mov_b32 v68, 0x0
    v_bfe_u32 v14, v0, 0, 1
    s_mov_b32 s38, 0x8
    v_mad_u32_u24 v68, v14, s38, v68
    v_bfe_u32 v14, v0, 1, 1
    s_mov_b32 s38, 0x10
    v_mad_u32_u24 v68, v14, s38, v68
    v_bfe_u32 v14, v0, 2, 1
    s_mov_b32 s38, 0x10000
    v_mad_u32_u24 v68, v14, s38, v68
    v_bfe_u32 v14, v0, 3, 1
    s_mov_b32 s38, 0x10000
    v_mad_u32_u24 v68, v14, s38, v68
    v_bfe_u32 v14, v0, 4, 1
    s_mov_b32 s38, 0x400
    v_mad_u32_u24 v68, v14, s38, v68
    v_bfe_u32 v14, v0, 5, 1
    s_mov_b32 s38, 0x4
    v_mad_u32_u24 v68, v14, s38, v68
    v_bfe_u32 v14, v0, 6, 1
    s_mov_b32 s38, 0x40
    v_mad_u32_u24 v68, v14, s38, v68
    v_bfe_u32 v14, v0, 7, 1
    s_mov_b32 s38, 0x80
    v_mad_u32_u24 v68, v14, s38, v68
    v_mov_b32 v70, s20
    v_mov_b32 v69, 0x0
    v_bfe_u32 v14, v70, 0, 1
    s_mov_b32 s38, 0x20
    v_mad_u32_u24 v69, v14, s38, v69
    v_bfe_u32 v14, v70, 1, 1
    s_mov_b32 s38, 0x800
    v_mad_u32_u24 v69, v14, s38, v69
    v_bfe_u32 v14, v70, 2, 1
    s_mov_b32 s38, 0x1000
    v_mad_u32_u24 v69, v14, s38, v69
    v_bfe_u32 v14, v70, 3, 1
    s_mov_b32 s38, 0x100
    v_mad_u32_u24 v69, v14, s38, v69
    v_bfe_u32 v14, v70, 4, 1
    s_mov_b32 s38, 0x200
    v_mad_u32_u24 v69, v14, s38, v69
    v_add_u32 v68, v68, v69
    buffer_load_dword v72, v68, s[96:99], 0 offen
    v_mov_b32 v64, -1
    v_mov_b32 v65, -1
    v_mov_b32 v66, -1
    v_mov_b32 v67, -1
    s_lshl_b32 s36, s20, 13
    s_add_u32 s36, s36, 0x0
    buffer_store_dwordx4 v[64:67], v2, s[8:11], s36 offen sc1
    buffer_store_dwordx4 v[64:67], v2, s[8:11], s36 offen offset:1024 sc1
    s_lshl_b32 s36, s20, 14
    s_add_u32 s36, s36, 0x100000
    s_add_u32 s37, s36, 0x2000
    buffer_store_dwordx4 v[64:67], v2, s[8:11], s36 offen sc1
    buffer_store_dwordx4 v[64:67], v2, s[8:11], s36 offen offset:1024 sc1
    buffer_store_dwordx4 v[64:67], v2, s[8:11], s37 offen sc1
    buffer_store_dwordx4 v[64:67], v2, s[8:11], s37 offen offset:1024 sc1
    s_mul_i32 s36, s20, 0x104200
    s_add_u32 s36, s36, 0x1102100
    s_add_u32 s37, s36, 0x82100
    buffer_store_dwordx4 v[64:67], v2, s[8:11], s36 offen sc1
    buffer_store_dwordx4 v[64:67], v2, s[8:11], s36 offen offset:1024 sc1
    buffer_store_dwordx4 v[64:67], v2, s[8:11], s37 offen sc1
    buffer_store_dwordx4 v[64:67], v2, s[8:11], s37 offen offset:1024 sc1
    v_lshlrev_b32 v68, 2, v0
    s_lshl_b32 s36, s20, 10
    s_add_u32 s37, s36, 0x194000
    buffer_store_dword v64, v68, s[8:11], s37 offen sc1
    s_add_u32 s37, s36, 0x1b0000
    buffer_store_dword v64, v68, s[8:11], s37 offen sc1
    s_add_u32 s37, s36, 0x1b8000
    buffer_store_dword v64, v68, s[8:11], s37 offen sc1
    v_mov_b32 v69, 0x40000000
    v_cmp_lt_u32 vcc, 63, v0
    s_nop 1
    v_cndmask_b32 v68, v68, v69, vcc
    v_mov_b32 v73, 0
    s_lshl_b32 s36, s20, 8
    s_add_u32 s37, s36, 0x192000
    buffer_store_dword v73, v68, s[8:11], s37 offen sc1
    s_mul_i32 s36, s20, 0x104200
    s_add_u32 s36, s36, 0x1082000
    s_add_u32 s37, s36, 0x82100
    buffer_store_dword v73, v68, s[8:11], s36 offen sc1
    buffer_store_dword v73, v68, s[8:11], s37 offen sc1
    v_mov_b32 v71, 0x80000
    v_bfe_u32 v14, v0, 0, 1
    s_mov_b32 s38, 0x8
    v_mad_u32_u24 v71, v14, s38, v71
    v_bfe_u32 v14, v0, 1, 1
    s_mov_b32 s38, 0x20
    v_mad_u32_u24 v71, v14, s38, v71
    v_bfe_u32 v14, v0, 4, 1
    s_mov_b32 s38, 0x10
    v_mad_u32_u24 v71, v14, s38, v71
    v_bfe_u32 v14, v0, 5, 1
    s_mov_b32 s38, 0x4
    v_mad_u32_u24 v71, v14, s38, v71
    v_bfe_u32 v14, v0, 6, 1
    s_mov_b32 s38, 0x800
    v_mad_u32_u24 v71, v14, s38, v71
    v_bfe_u32 v14, v0, 7, 1
    s_mov_b32 s38, 0x1000
    v_mad_u32_u24 v71, v14, s38, v71
    v_mov_b32 v69, s20
    v_mov_b32 v68, 0x0
    v_bfe_u32 v14, v69, 0, 1
    s_mov_b32 s38, 0x100
    v_mad_u32_u24 v68, v14, s38, v68
    v_bfe_u32 v14, v69, 1, 1
    s_mov_b32 s38, 0x40
    v_mad_u32_u24 v68, v14, s38, v68
    v_bfe_u32 v14, v69, 2, 1
    s_mov_b32 s38, 0x80
    v_mad_u32_u24 v68, v14, s38, v68
    v_bfe_u32 v14, v69, 3, 1
    s_mov_b32 s38, 0x200
    v_mad_u32_u24 v68, v14, s38, v68
    v_bfe_u32 v14, v69, 4, 1
    s_mov_b32 s38, 0x400
    v_mad_u32_u24 v68, v14, s38, v68
    v_add_u32 v71, v68, v71
    v_and_b32 v68, 12, v0
    v_cmp_ne_u32 vcc, 0, v68
    v_mov_b32 v68, 0x40000000
    s_nop 0
    v_cndmask_b32 v71, v71, v68, vcc
    s_waitcnt vmcnt(16)
    s_mov_b32 s36, 0x1000000
    buffer_store_dword v72, v71, s[8:11], s36 offen sc1
L_XN:
    v_mov_b32 v88, 0
    v_mov_b32 v89, 0
    v_dot2_f32_bf16 v88, v96, s4, v88
    v_dot2_f32_bf16 v89, v96, v96, v89
    v_dot2_f32_bf16 v88, v97, s4, v88
    v_dot2_f32_bf16 v89, v97, v97, v89
    v_dot2_f32_bf16 v88, v98, s4, v88
    v_dot2_f32_bf16 v89, v98, v98, v89
    v_dot2_f32_bf16 v88, v99, s4, v88
    v_dot2_f32_bf16 v89, v99, v99, v89
    v_dot2_f32_bf16 v88, v100, s4, v88
    v_dot2_f32_bf16 v89, v100, v100, v89
    v_dot2_f32_bf16 v88, v101, s4, v88
    v_dot2_f32_bf16 v89, v101, v101, v89
    v_dot2_f32_bf16 v88, v102, s4, v88
    v_dot2_f32_bf16 v89, v102, v102, v89
    v_dot2_f32_bf16 v88, v103, s4, v88
    v_dot2_f32_bf16 v89, v103, v103, v89
    v_dot2_f32_bf16 v88, v104, s4, v88
    v_dot2_f32_bf16 v89, v104, v104, v89
    v_dot2_f32_bf16 v88, v105, s4, v88
    v_dot2_f32_bf16 v89, v105, v105, v89
    v_dot2_f32_bf16 v88, v106, s4, v88
    v_dot2_f32_bf16 v89, v106, v106, v89
    v_dot2_f32_bf16 v88, v107, s4, v88
    v_dot2_f32_bf16 v89, v107, v107, v89
    v_dot2_f32_bf16 v88, v108, s4, v88
    v_dot2_f32_bf16 v89, v108, v108, v89
    v_dot2_f32_bf16 v88, v109, s4, v88
    v_dot2_f32_bf16 v89, v109, v109, v89
    v_dot2_f32_bf16 v88, v110, s4, v88
    v_dot2_f32_bf16 v89, v110, v110, v89
    v_dot2_f32_bf16 v88, v111, s4, v88
    v_dot2_f32_bf16 v89, v111, v111, v89
    v_dot2_f32_bf16 v88, v112, s4, v88
    v_dot2_f32_bf16 v89, v112, v112, v89
    v_dot2_f32_bf16 v88, v113, s4, v88
    v_dot2_f32_bf16 v89, v113, v113, v89
    v_dot2_f32_bf16 v88, v114, s4, v88
    v_dot2_f32_bf16 v89, v114, v114, v89
    v_dot2_f32_bf16 v88, v115, s4, v88
    v_dot2_f32_bf16 v89, v115, v115, v89
    v_dot2_f32_bf16 v88, v116, s4, v88
    v_dot2_f32_bf16 v89, v116, v116, v89
    v_dot2_f32_bf16 v88, v117, s4, v88
    v_dot2_f32_bf16 v89, v117, v117, v89
    v_dot2_f32_bf16 v88, v118, s4, v88
    v_dot2_f32_bf16 v89, v118, v118, v89
    v_dot2_f32_bf16 v88, v119, s4, v88
    v_dot2_f32_bf16 v89, v119, v119, v89
    v_dot2_f32_bf16 v88, v120, s4, v88
    v_dot2_f32_bf16 v89, v120, v120, v89
    v_dot2_f32_bf16 v88, v121, s4, v88
    v_dot2_f32_bf16 v89, v121, v121, v89
    v_dot2_f32_bf16 v88, v122, s4, v88
    v_dot2_f32_bf16 v89, v122, v122, v89
    v_dot2_f32_bf16 v88, v123, s4, v88
    v_dot2_f32_bf16 v89, v123, v123, v89
    v_dot2_f32_bf16 v88, v124, s4, v88
    v_dot2_f32_bf16 v89, v124, v124, v89
    v_dot2_f32_bf16 v88, v125, s4, v88
    v_dot2_f32_bf16 v89, v125, v125, v89
    v_dot2_f32_bf16 v88, v126, s4, v88
    v_dot2_f32_bf16 v89, v126, v126, v89
    v_dot2_f32_bf16 v88, v127, s4, v88
    v_dot2_f32_bf16 v89, v127, v127, v89
    s_nop 3
    v_add_f32_dpp v88, v88, v88 quad_perm:[1,0,3,2] row_mask:0xf bank_mask:0xf
    v_add_f32_dpp v89, v89, v89 quad_perm:[1,0,3,2] row_mask:0xf bank_mask:0xf
    s_nop 0
    v_add_f32_dpp v88, v88, v88 quad_perm:[2,3,0,1] row_mask:0xf bank_mask:0xf
    v_add_f32_dpp v89, v89, v89 quad_perm:[2,3,0,1] row_mask:0xf bank_mask:0xf
    s_nop 0
    v_add_f32_dpp v88, v88, v88 row_half_mirror row_mask:0xf bank_mask:0xf
    v_add_f32_dpp v89, v89, v89 row_half_mirror row_mask:0xf bank_mask:0xf
    v_mul_f32 v88, 0x3b000000, v88
    v_mul_f32 v89, 0x3b000000, v89
    v_fma_f32 v89, -v88, v88, v89
    v_max_f32 v89, 0, v89
    v_cvt_pk_bf16_f32 v14, v88, v89
    v_lshlrev_b32 v88, 16, v14
    v_and_b32 v89, 0xffff0000, v14
    v_add_f32 v89, 0x3727c5ac, v89
    v_cvt_pk_bf16_f32 v14, v89, v89
    v_lshlrev_b32 v89, 16, v14
    v_sqrt_f32 v89, v89
    s_nop 0
    v_cvt_pk_bf16_f32 v14, v89, v89
    v_lshlrev_b32 v89, 16, v14
    v_rcp_f32 v89, v89
    v_lshlrev_b32 v90, 16, v96
    v_and_b32 v91, 0xffff0000, v96
    v_sub_f32 v90, v90, v88
    v_sub_f32 v91, v91, v88
    v_cvt_pk_bf16_f32 v96, v90, v91
    v_lshlrev_b32 v90, 16, v96
    v_and_b32 v91, 0xffff0000, v96
    v_mul_f32 v90, v90, v89
    v_mul_f32 v91, v91, v89
    v_cvt_pk_bf16_f32 v96, v90, v91
    v_lshlrev_b32 v90, 16, v97
    v_and_b32 v91, 0xffff0000, v97
    v_sub_f32 v90, v90, v88
    v_sub_f32 v91, v91, v88
    v_cvt_pk_bf16_f32 v97, v90, v91
    v_lshlrev_b32 v90, 16, v97
    v_and_b32 v91, 0xffff0000, v97
    v_mul_f32 v90, v90, v89
    v_mul_f32 v91, v91, v89
    v_cvt_pk_bf16_f32 v97, v90, v91
    v_lshlrev_b32 v90, 16, v98
    v_and_b32 v91, 0xffff0000, v98
    v_sub_f32 v90, v90, v88
    v_sub_f32 v91, v91, v88
    v_cvt_pk_bf16_f32 v98, v90, v91
    v_lshlrev_b32 v90, 16, v98
    v_and_b32 v91, 0xffff0000, v98
    v_mul_f32 v90, v90, v89
    v_mul_f32 v91, v91, v89
    v_cvt_pk_bf16_f32 v98, v90, v91
    v_lshlrev_b32 v90, 16, v99
    v_and_b32 v91, 0xffff0000, v99
    v_sub_f32 v90, v90, v88
    v_sub_f32 v91, v91, v88
    v_cvt_pk_bf16_f32 v99, v90, v91
    v_lshlrev_b32 v90, 16, v99
    v_and_b32 v91, 0xffff0000, v99
    v_mul_f32 v90, v90, v89
    v_mul_f32 v91, v91, v89
    v_cvt_pk_bf16_f32 v99, v90, v91
    ds_write_b128 v4, v[96:99] offset:0
    v_lshlrev_b32 v90, 16, v100
    v_and_b32 v91, 0xffff0000, v100
    v_sub_f32 v90, v90, v88
    v_sub_f32 v91, v91, v88
    v_cvt_pk_bf16_f32 v100, v90, v91
    v_lshlrev_b32 v90, 16, v100
    v_and_b32 v91, 0xffff0000, v100
    v_mul_f32 v90, v90, v89
    v_mul_f32 v91, v91, v89
    v_cvt_pk_bf16_f32 v100, v90, v91
    v_lshlrev_b32 v90, 16, v101
    v_and_b32 v91, 0xffff0000, v101
    v_sub_f32 v90, v90, v88
    v_sub_f32 v91, v91, v88
    v_cvt_pk_bf16_f32 v101, v90, v91
    v_lshlrev_b32 v90, 16, v101
    v_and_b32 v91, 0xffff0000, v101
    v_mul_f32 v90, v90, v89
    v_mul_f32 v91, v91, v89
    v_cvt_pk_bf16_f32 v101, v90, v91
    v_lshlrev_b32 v90, 16, v102
    v_and_b32 v91, 0xffff0000, v102
    v_sub_f32 v90, v90, v88
    v_sub_f32 v91, v91, v88
    v_cvt_pk_bf16_f32 v102, v90, v91
    v_lshlrev_b32 v90, 16, v102
    v_and_b32 v91, 0xffff0000, v102
    v_mul_f32 v90, v90, v89
    v_mul_f32 v91, v91, v89
    v_cvt_pk_bf16_f32 v102, v90, v91
    v_lshlrev_b32 v90, 16, v103
    v_and_b32 v91, 0xffff0000, v103
    v_sub_f32 v90, v90, v88
    v_sub_f32 v91, v91, v88
    v_cvt_pk_bf16_f32 v103, v90, v91
    v_lshlrev_b32 v90, 16, v103
    v_and_b32 v91, 0xffff0000, v103
    v_mul_f32 v90, v90, v89
    v_mul_f32 v91, v91, v89
    v_cvt_pk_bf16_f32 v103, v90, v91
    ds_write_b128 v4, v[100:103] offset:2048
    v_lshlrev_b32 v90, 16, v104
    v_and_b32 v91, 0xffff0000, v104
    v_sub_f32 v90, v90, v88
    v_sub_f32 v91, v91, v88
    v_cvt_pk_bf16_f32 v104, v90, v91
    v_lshlrev_b32 v90, 16, v104
    v_and_b32 v91, 0xffff0000, v104
    v_mul_f32 v90, v90, v89
    v_mul_f32 v91, v91, v89
    v_cvt_pk_bf16_f32 v104, v90, v91
    v_lshlrev_b32 v90, 16, v105
    v_and_b32 v91, 0xffff0000, v105
    v_sub_f32 v90, v90, v88
    v_sub_f32 v91, v91, v88
    v_cvt_pk_bf16_f32 v105, v90, v91
    v_lshlrev_b32 v90, 16, v105
    v_and_b32 v91, 0xffff0000, v105
    v_mul_f32 v90, v90, v89
    v_mul_f32 v91, v91, v89
    v_cvt_pk_bf16_f32 v105, v90, v91
    v_lshlrev_b32 v90, 16, v106
    v_and_b32 v91, 0xffff0000, v106
    v_sub_f32 v90, v90, v88
    v_sub_f32 v91, v91, v88
    v_cvt_pk_bf16_f32 v106, v90, v91
    v_lshlrev_b32 v90, 16, v106
    v_and_b32 v91, 0xffff0000, v106
    v_mul_f32 v90, v90, v89
    v_mul_f32 v91, v91, v89
    v_cvt_pk_bf16_f32 v106, v90, v91
    v_lshlrev_b32 v90, 16, v107
    v_and_b32 v91, 0xffff0000, v107
    v_sub_f32 v90, v90, v88
    v_sub_f32 v91, v91, v88
    v_cvt_pk_bf16_f32 v107, v90, v91
    v_lshlrev_b32 v90, 16, v107
    v_and_b32 v91, 0xffff0000, v107
    v_mul_f32 v90, v90, v89
    v_mul_f32 v91, v91, v89
    v_cvt_pk_bf16_f32 v107, v90, v91
    ds_write_b128 v4, v[104:107] offset:4096
    v_lshlrev_b32 v90, 16, v108
    v_and_b32 v91, 0xffff0000, v108
    v_sub_f32 v90, v90, v88
    v_sub_f32 v91, v91, v88
    v_cvt_pk_bf16_f32 v108, v90, v91
    v_lshlrev_b32 v90, 16, v108
    v_and_b32 v91, 0xffff0000, v108
    v_mul_f32 v90, v90, v89
    v_mul_f32 v91, v91, v89
    v_cvt_pk_bf16_f32 v108, v90, v91
    v_lshlrev_b32 v90, 16, v109
    v_and_b32 v91, 0xffff0000, v109
    v_sub_f32 v90, v90, v88
    v_sub_f32 v91, v91, v88
    v_cvt_pk_bf16_f32 v109, v90, v91
    v_lshlrev_b32 v90, 16, v109
    v_and_b32 v91, 0xffff0000, v109
    v_mul_f32 v90, v90, v89
    v_mul_f32 v91, v91, v89
    v_cvt_pk_bf16_f32 v109, v90, v91
    v_lshlrev_b32 v90, 16, v110
    v_and_b32 v91, 0xffff0000, v110
    v_sub_f32 v90, v90, v88
    v_sub_f32 v91, v91, v88
    v_cvt_pk_bf16_f32 v110, v90, v91
    v_lshlrev_b32 v90, 16, v110
    v_and_b32 v91, 0xffff0000, v110
    v_mul_f32 v90, v90, v89
    v_mul_f32 v91, v91, v89
    v_cvt_pk_bf16_f32 v110, v90, v91
    v_lshlrev_b32 v90, 16, v111
    v_and_b32 v91, 0xffff0000, v111
    v_sub_f32 v90, v90, v88
    v_sub_f32 v91, v91, v88
    v_cvt_pk_bf16_f32 v111, v90, v91
    v_lshlrev_b32 v90, 16, v111
    v_and_b32 v91, 0xffff0000, v111
    v_mul_f32 v90, v90, v89
    v_mul_f32 v91, v91, v89
    v_cvt_pk_bf16_f32 v111, v90, v91
    ds_write_b128 v4, v[108:111] offset:6144
    v_lshlrev_b32 v90, 16, v112
    v_and_b32 v91, 0xffff0000, v112
    v_sub_f32 v90, v90, v88
    v_sub_f32 v91, v91, v88
    v_cvt_pk_bf16_f32 v112, v90, v91
    v_lshlrev_b32 v90, 16, v112
    v_and_b32 v91, 0xffff0000, v112
    v_mul_f32 v90, v90, v89
    v_mul_f32 v91, v91, v89
    v_cvt_pk_bf16_f32 v112, v90, v91
    v_lshlrev_b32 v90, 16, v113
    v_and_b32 v91, 0xffff0000, v113
    v_sub_f32 v90, v90, v88
    v_sub_f32 v91, v91, v88
    v_cvt_pk_bf16_f32 v113, v90, v91
    v_lshlrev_b32 v90, 16, v113
    v_and_b32 v91, 0xffff0000, v113
    v_mul_f32 v90, v90, v89
    v_mul_f32 v91, v91, v89
    v_cvt_pk_bf16_f32 v113, v90, v91
    v_lshlrev_b32 v90, 16, v114
    v_and_b32 v91, 0xffff0000, v114
    v_sub_f32 v90, v90, v88
    v_sub_f32 v91, v91, v88
    v_cvt_pk_bf16_f32 v114, v90, v91
    v_lshlrev_b32 v90, 16, v114
    v_and_b32 v91, 0xffff0000, v114
    v_mul_f32 v90, v90, v89
    v_mul_f32 v91, v91, v89
    v_cvt_pk_bf16_f32 v114, v90, v91
    v_lshlrev_b32 v90, 16, v115
    v_and_b32 v91, 0xffff0000, v115
    v_sub_f32 v90, v90, v88
    v_sub_f32 v91, v91, v88
    v_cvt_pk_bf16_f32 v115, v90, v91
    v_lshlrev_b32 v90, 16, v115
    v_and_b32 v91, 0xffff0000, v115
    v_mul_f32 v90, v90, v89
    v_mul_f32 v91, v91, v89
    v_cvt_pk_bf16_f32 v115, v90, v91
    ds_write_b128 v4, v[112:115] offset:8192
    v_lshlrev_b32 v90, 16, v116
    v_and_b32 v91, 0xffff0000, v116
    v_sub_f32 v90, v90, v88
    v_sub_f32 v91, v91, v88
    v_cvt_pk_bf16_f32 v116, v90, v91
    v_lshlrev_b32 v90, 16, v116
    v_and_b32 v91, 0xffff0000, v116
    v_mul_f32 v90, v90, v89
    v_mul_f32 v91, v91, v89
    v_cvt_pk_bf16_f32 v116, v90, v91
    v_lshlrev_b32 v90, 16, v117
    v_and_b32 v91, 0xffff0000, v117
    v_sub_f32 v90, v90, v88
    v_sub_f32 v91, v91, v88
    v_cvt_pk_bf16_f32 v117, v90, v91
    v_lshlrev_b32 v90, 16, v117
    v_and_b32 v91, 0xffff0000, v117
    v_mul_f32 v90, v90, v89
    v_mul_f32 v91, v91, v89
    v_cvt_pk_bf16_f32 v117, v90, v91
    v_lshlrev_b32 v90, 16, v118
    v_and_b32 v91, 0xffff0000, v118
    v_sub_f32 v90, v90, v88
    v_sub_f32 v91, v91, v88
    v_cvt_pk_bf16_f32 v118, v90, v91
    v_lshlrev_b32 v90, 16, v118
    v_and_b32 v91, 0xffff0000, v118
    v_mul_f32 v90, v90, v89
    v_mul_f32 v91, v91, v89
    v_cvt_pk_bf16_f32 v118, v90, v91
    v_lshlrev_b32 v90, 16, v119
    v_and_b32 v91, 0xffff0000, v119
    v_sub_f32 v90, v90, v88
    v_sub_f32 v91, v91, v88
    v_cvt_pk_bf16_f32 v119, v90, v91
    v_lshlrev_b32 v90, 16, v119
    v_and_b32 v91, 0xffff0000, v119
    v_mul_f32 v90, v90, v89
    v_mul_f32 v91, v91, v89
    v_cvt_pk_bf16_f32 v119, v90, v91
    ds_write_b128 v4, v[116:119] offset:10240
    v_lshlrev_b32 v90, 16, v120
    v_and_b32 v91, 0xffff0000, v120
    v_sub_f32 v90, v90, v88
    v_sub_f32 v91, v91, v88
    v_cvt_pk_bf16_f32 v120, v90, v91
    v_lshlrev_b32 v90, 16, v120
    v_and_b32 v91, 0xffff0000, v120
    v_mul_f32 v90, v90, v89
    v_mul_f32 v91, v91, v89
    v_cvt_pk_bf16_f32 v120, v90, v91
    v_lshlrev_b32 v90, 16, v121
    v_and_b32 v91, 0xffff0000, v121
    v_sub_f32 v90, v90, v88
    v_sub_f32 v91, v91, v88
    v_cvt_pk_bf16_f32 v121, v90, v91
    v_lshlrev_b32 v90, 16, v121
    v_and_b32 v91, 0xffff0000, v121
    v_mul_f32 v90, v90, v89
    v_mul_f32 v91, v91, v89
    v_cvt_pk_bf16_f32 v121, v90, v91
    v_lshlrev_b32 v90, 16, v122
    v_and_b32 v91, 0xffff0000, v122
    v_sub_f32 v90, v90, v88
    v_sub_f32 v91, v91, v88
    v_cvt_pk_bf16_f32 v122, v90, v91
    v_lshlrev_b32 v90, 16, v122
    v_and_b32 v91, 0xffff0000, v122
    v_mul_f32 v90, v90, v89
    v_mul_f32 v91, v91, v89
    v_cvt_pk_bf16_f32 v122, v90, v91
    v_lshlrev_b32 v90, 16, v123
    v_and_b32 v91, 0xffff0000, v123
    v_sub_f32 v90, v90, v88
    v_sub_f32 v91, v91, v88
    v_cvt_pk_bf16_f32 v123, v90, v91
    v_lshlrev_b32 v90, 16, v123
    v_and_b32 v91, 0xffff0000, v123
    v_mul_f32 v90, v90, v89
    v_mul_f32 v91, v91, v89
    v_cvt_pk_bf16_f32 v123, v90, v91
    ds_write_b128 v4, v[120:123] offset:12288
    v_lshlrev_b32 v90, 16, v124
    v_and_b32 v91, 0xffff0000, v124
    v_sub_f32 v90, v90, v88
    v_sub_f32 v91, v91, v88
    v_cvt_pk_bf16_f32 v124, v90, v91
    v_lshlrev_b32 v90, 16, v124
    v_and_b32 v91, 0xffff0000, v124
    v_mul_f32 v90, v90, v89
    v_mul_f32 v91, v91, v89
    v_cvt_pk_bf16_f32 v124, v90, v91
    v_lshlrev_b32 v90, 16, v125
    v_and_b32 v91, 0xffff0000, v125
    v_sub_f32 v90, v90, v88
    v_sub_f32 v91, v91, v88
    v_cvt_pk_bf16_f32 v125, v90, v91
    v_lshlrev_b32 v90, 16, v125
    v_and_b32 v91, 0xffff0000, v125
    v_mul_f32 v90, v90, v89
    v_mul_f32 v91, v91, v89
    v_cvt_pk_bf16_f32 v125, v90, v91
    v_lshlrev_b32 v90, 16, v126
    v_and_b32 v91, 0xffff0000, v126
    v_sub_f32 v90, v90, v88
    v_sub_f32 v91, v91, v88
    v_cvt_pk_bf16_f32 v126, v90, v91
    v_lshlrev_b32 v90, 16, v126
    v_and_b32 v91, 0xffff0000, v126
    v_mul_f32 v90, v90, v89
    v_mul_f32 v91, v91, v89
    v_cvt_pk_bf16_f32 v126, v90, v91
    v_lshlrev_b32 v90, 16, v127
    v_and_b32 v91, 0xffff0000, v127
    v_sub_f32 v90, v90, v88
    v_sub_f32 v91, v91, v88
    v_cvt_pk_bf16_f32 v127, v90, v91
    v_lshlrev_b32 v90, 16, v127
    v_and_b32 v91, 0xffff0000, v127
    v_mul_f32 v90, v90, v89
    v_mul_f32 v91, v91, v89
    v_cvt_pk_bf16_f32 v127, v90, v91
    ds_write_b128 v4, v[124:127] offset:14336
    s_waitcnt lgkmcnt(0)
    s_barrier
    s_lshl_b32 s24, s23, 15
    s_add_u32 s24, s24, 0x800000
    ds_read_b128 v[24:27], v9 offset:0
    ds_read_b128 v[28:31], v9 offset:4096
    ds_read_b128 v[32:35], v9 offset:8192
    ds_read_b128 v[36:39], v9 offset:12288
    ds_read_b128 v[40:43], v9 offset:16384
    ds_read_b128 v[44:47], v9 offset:20480
    ds_read_b128 v[48:51], v9 offset:24576
    ds_read_b128 v[52:55], v9 offset:28672
    s_waitcnt lgkmcnt(7)
    s_add_u32 s36, s24, 0
    buffer_store_dwordx4 v[24:27], v9, s[8:11], s36 offen sc1
    s_waitcnt lgkmcnt(6)
    s_add_u32 s36, s24, 4096
    buffer_store_dwordx4 v[28:31], v9, s[8:11], s36 offen sc1
    s_waitcnt lgkmcnt(5)
    s_add_u32 s36, s24, 8192
    buffer_store_dwordx4 v[32:35], v9, s[8:11], s36 offen sc1
    s_waitcnt lgkmcnt(4)
    s_add_u32 s36, s24, 12288
    buffer_store_dwordx4 v[36:39], v9, s[8:11], s36 offen sc1
    s_waitcnt lgkmcnt(3)
    s_add_u32 s36, s24, 16384
    buffer_store_dwordx4 v[40:43], v9, s[8:11], s36 offen sc1
    s_waitcnt lgkmcnt(2)
    s_add_u32 s36, s24, 20480
    buffer_store_dwordx4 v[44:47], v9, s[8:11], s36 offen sc1
    s_waitcnt lgkmcnt(1)
    s_add_u32 s36, s24, 24576
    buffer_store_dwordx4 v[48:51], v9, s[8:11], s36 offen sc1
    s_waitcnt lgkmcnt(0)
    s_add_u32 s36, s24, 28672
    buffer_store_dwordx4 v[52:55], v9, s[8:11], s36 offen sc1
    s_barrier
    v_mov_b64 v[96:97], v[128:129]
    v_mov_b64 v[98:99], v[130:131]
    v_mov_b64 v[100:101], v[132:133]
    v_mov_b64 v[102:103], v[134:135]
    v_mov_b64 v[104:105], v[136:137]
    v_mov_b64 v[106:107], v[138:139]
    v_mov_b64 v[108:109], v[140:141]
    v_mov_b64 v[110:111], v[142:143]
    v_mov_b64 v[112:113], v[144:145]
    v_mov_b64 v[114:115], v[146:147]
    v_mov_b64 v[116:117], v[148:149]
    v_mov_b64 v[118:119], v[150:151]
    v_mov_b64 v[120:121], v[152:153]
    v_mov_b64 v[122:123], v[154:155]
    v_mov_b64 v[124:125], v[156:157]
    v_mov_b64 v[126:127], v[158:159]
    s_add_u32 s23, s23, 1
    s_bitcmp1_b32 s23, 0
    s_cbranch_scc1 L_XN
    s_waitcnt vmcnt(0)
    s_barrier
    v_mov_b32 v14, 1
    s_lshl_b32 s37, s20, 2
    v_lshlrev_b32 v15, 20, v0
    buffer_store_dword v14, v15, s[16:19], s37 offen sc1
    s_lshr_b32 s20, s2, 3
    s_mov_b32 s34, 0x05040100
    s_mov_b32 s35, 0x07060302
    s_mov_b32 s32, 0
    s_mov_b32 s64, s84
    s_and_b32 s65, s85, 0xffff
    s_mov_b32 s66, 0x1c0000
    s_mov_b32 s67, 0x20000
    s_mov_b32 s68, s86
    s_and_b32 s69, s87, 0xffff
    s_mov_b32 s70, 0x1c0000
    s_mov_b32 s71, 0x20000
    s_mov_b32 s76, s88
    s_and_b32 s77, s89, 0xffff
    s_mov_b32 s78, 0x1c0000
    s_mov_b32 s79, 0x20000
    v_and_b32 v3, 31, v0
    v_lshlrev_b32 v3, 2, v3
L_M_hs:
    buffer_load_dword v5, v3, s[16:19], 0 offen sc1
    s_add_u32 s32, s32, 1
    s_cmp_gt_u32 s32, 200000
    s_waitcnt vmcnt(0)
    s_cbranch_scc1 L_M_hs_ok
    v_cmp_eq_u32 vcc, 0, v5
    s_cbranch_vccz L_M_hs_ok
    s_sleep 16
    s_branch L_M_hs
L_M_hs_ok:
    v_lshlrev_b32 v3, 4, v0
L_M00_rp:
    s_mov_b32 s36, 0x194000
    buffer_load_dwordx4 v[16:19], v3, s[8:11], s36 offen sc1
    s_add_u32 s32, s32, 1
    v_mov_b32 v5, 0
    s_waitcnt vmcnt(0)
    v_max3_u32 v5, v5, v16, v17
    v_max3_u32 v5, v5, v18, v19
    s_cmp_gt_u32 s32, 200000
    s_cbranch_scc1 L_M00_rp_ok
    v_cmp_eq_u32 vcc, -1, v5
    s_cbranch_vccz L_M00_rp_ok
    s_sleep 64
    s_branch L_M00_rp
L_M00_rp_ok:
    v_add_f32 v16, v16, v17
    v_add_f32 v18, v18, v19
    v_add_f32 v16, v16, v18
    v_cvt_pk_bf16_f32 v5, v16, v16
    v_lshlrev_b32 v16, 16, v5
    v_ashrrev_i32 v5, 31, v16
    v_or_b32 v5, 0x80000000, v5
    v_xor_b32 v5, v5, v16
    v_and_b32 v5, 0xffff0000, v5
    v_sub_u32 v6, 2047, v0
    v_or_b32 v120, v5, v6
    v_lshrrev_b32 v1, 5, v0
    v_and_b32 v2, 31, v0
    s_mov_b32 s36, 229376
    v_mul_lo_u32 v4, v1, s36
    v_lshl_add_u32 v4, v2, 2, v4
    v_mov_b32 v5, 0x40000000
    v_cmp_lt_u32 vcc, 27, v2
    s_nop 1
    v_cndmask_b32 v4, v4, v5, vcc
    s_mul_i32 s23, s20, 112
    s_add_u32 s36, s23, 0
    buffer_load_dword v16, v4, s[64:67], s36 offen
    s_add_u32 s36, s23, 3584
    buffer_load_dword v17, v4, s[64:67], s36 offen
    s_add_u32 s36, s23, 7168
    buffer_load_dword v18, v4, s[64:67], s36 offen
    s_add_u32 s36, s23, 10752
    buffer_load_dword v19, v4, s[64:67], s36 offen
    s_add_u32 s36, s23, 14336
    buffer_load_dword v20, v4, s[64:67], s36 offen
    s_add_u32 s36, s23, 17920
    buffer_load_dword v21, v4, s[64:67], s36 offen
    s_add_u32 s36, s23, 21504
    buffer_load_dword v22, v4, s[64:67], s36 offen
    s_add_u32 s36, s23, 25088
    buffer_load_dword v23, v4, s[64:67], s36 offen
    s_add_u32 s36, s23, 28672
    buffer_load_dword v24, v4, s[64:67], s36 offen
    s_add_u32 s36, s23, 32256
    buffer_load_dword v25, v4, s[64:67], s36 offen
    s_add_u32 s36, s23, 35840
    buffer_load_dword v26, v4, s[64:67], s36 offen
    s_add_u32 s36, s23, 39424
    buffer_load_dword v27, v4, s[64:67], s36 offen
    s_add_u32 s36, s23, 43008
    buffer_load_dword v28, v4, s[64:67], s36 offen
    s_add_u32 s36, s23, 46592
    buffer_load_dword v29, v4, s[64:67], s36 offen
    s_add_u32 s36, s23, 50176
    buffer_load_dword v30, v4, s[64:67], s36 offen
    s_add_u32 s36, s23, 53760
    buffer_load_dword v31, v4, s[64:67], s36 offen
    s_add_u32 s36, s23, 57344
    buffer_load_dword v32, v4, s[64:67], s36 offen
    s_add_u32 s36, s23, 60928
    buffer_load_dword v33, v4, s[64:67], s36 offen
    s_add_u32 s36, s23, 64512
    buffer_load_dword v34, v4, s[64:67], s36 offen
    s_add_u32 s36, s23, 68096
    buffer_load_dword v35, v4, s[64:67], s36 offen
    s_add_u32 s36, s23, 71680
    buffer_load_dword v36, v4, s[64:67], s36 offen
    s_add_u32 s36, s23, 75264
    buffer_load_dword v37, v4, s[64:67], s36 offen
    s_add_u32 s36, s23, 78848
    buffer_load_dword v38, v4, s[64:67], s36 offen
    s_add_u32 s36, s23, 82432
    buffer_load_dword v39, v4, s[64:67], s36 offen
    s_add_u32 s36, s23, 86016
    buffer_load_dword v40, v4, s[64:67], s36 offen
    s_add_u32 s36, s23, 89600
    buffer_load_dword v41, v4, s[64:67], s36 offen
    s_add_u32 s36, s23, 93184
    buffer_load_dword v42, v4, s[64:67], s36 offen
    s_add_u32 s36, s23, 96768
    buffer_load_dword v43, v4, s[64:67], s36 offen
    s_add_u32 s36, s23, 100352
    buffer_load_dword v44, v4, s[64:67], s36 offen
    s_add_u32 s36, s23, 103936
    buffer_load_dword v45, v4, s[64:67], s36 offen
    s_add_u32 s36, s23, 107520
    buffer_load_dword v46, v4, s[64:67], s36 offen
    s_add_u32 s36, s23, 111104
    buffer_load_dword v47, v4, s[64:67], s36 offen
    s_waitcnt vmcnt(0)
    v_perm_b32 v128, v17, v16, s34
    v_perm_b32 v129, v19, v18, s34
    v_perm_b32 v130, v21, v20, s34
    v_perm_b32 v131, v23, v22, s34
    v_perm_b32 v132, v25, v24, s34
    v_perm_b32 v133, v27, v26, s34
    v_perm_b32 v134, v29, v28, s34
    v_perm_b32 v135, v31, v30, s34
    v_perm_b32 v136, v33, v32, s34
    v_perm_b32 v137, v35, v34, s34
    v_perm_b32 v138, v37, v36, s34
    v_perm_b32 v139, v39, v38, s34
    v_perm_b32 v140, v41, v40, s34
    v_perm_b32 v141, v43, v42, s34
    v_perm_b32 v142, v45, v44, s34
    v_perm_b32 v143, v47, v46, s34
    v_perm_b32 v160, v17, v16, s35
    v_perm_b32 v161, v19, v18, s35
    v_perm_b32 v162, v21, v20, s35
    v_perm_b32 v163, v23, v22, s35
    v_perm_b32 v164, v25, v24, s35
    v_perm_b32 v165, v27, v26, s35
    v_perm_b32 v166, v29, v28, s35
    v_perm_b32 v167, v31, v30, s35
    v_perm_b32 v168, v33, v32, s35
    v_perm_b32 v169, v35, v34, s35
    v_perm_b32 v170, v37, v36, s35
    v_perm_b32 v171, v39, v38, s35
    v_perm_b32 v172, v41, v40, s35
    v_perm_b32 v173, v43, v42, s35
    v_perm_b32 v174, v45, v44, s35
    v_perm_b32 v175, v47, v46, s35
    s_add_u32 s36, s23, 114688
    buffer_load_dword v16, v4, s[64:67], s36 offen
    s_add_u32 s36, s23, 118272
    buffer_load_dword v17, v4, s[64:67], s36 offen
    s_add_u32 s36, s23, 121856
    buffer_load_dword v18, v4, s[64:67], s36 offen
    s_add_u32 s36, s23, 125440
    buffer_load_dword v19, v4, s[64:67], s36 offen
    s_add_u32 s36, s23, 129024
    buffer_load_dword v20, v4, s[64:67], s36 offen
    s_add_u32 s36, s23, 132608
    buffer_load_dword v21, v4, s[64:67], s36 offen
    s_add_u32 s36, s23, 136192
    buffer_load_dword v22, v4, s[64:67], s36 offen
    s_add_u32 s36, s23, 139776
    buffer_load_dword v23, v4, s[64:67], s36 offen
    s_add_u32 s36, s23, 143360
    buffer_load_dword v24, v4, s[64:67], s36 offen
    s_add_u32 s36, s23, 146944
    buffer_load_dword v25, v4, s[64:67], s36 offen
    s_add_u32 s36, s23, 150528
    buffer_load_dword v26, v4, s[64:67], s36 offen
    s_add_u32 s36, s23, 154112
    buffer_load_dword v27, v4, s[64:67], s36 offen
    s_add_u32 s36, s23, 157696
    buffer_load_dword v28, v4, s[64:67], s36 offen
    s_add_u32 s36, s23, 161280
    buffer_load_dword v29, v4, s[64:67], s36 offen
    s_add_u32 s36, s23, 164864
    buffer_load_dword v30, v4, s[64:67], s36 offen
    s_add_u32 s36, s23, 168448
    buffer_load_dword v31, v4, s[64:67], s36 offen
    s_add_u32 s36, s23, 172032
    buffer_load_dword v32, v4, s[64:67], s36 offen
    s_add_u32 s36, s23, 175616
    buffer_load_dword v33, v4, s[64:67], s36 offen
    s_add_u32 s36, s23, 179200
    buffer_load_dword v34, v4, s[64:67], s36 offen
    s_add_u32 s36, s23, 182784
    buffer_load_dword v35, v4, s[64:67], s36 offen
    s_add_u32 s36, s23, 186368
    buffer_load_dword v36, v4, s[64:67], s36 offen
    s_add_u32 s36, s23, 189952
    buffer_load_dword v37, v4, s[64:67], s36 offen
    s_add_u32 s36, s23, 193536
    buffer_load_dword v38, v4, s[64:67], s36 offen
    s_add_u32 s36, s23, 197120
    buffer_load_dword v39, v4, s[64:67], s36 offen
    s_add_u32 s36, s23, 200704
    buffer_load_dword v40, v4, s[64:67], s36 offen
    s_add_u32 s36, s23, 204288
    buffer_load_dword v41, v4, s[64:67], s36 offen
    s_add_u32 s36, s23, 207872
    buffer_load_dword v42, v4, s[64:67], s36 offen
    s_add_u32 s36, s23, 211456
    buffer_load_dword v43, v4, s[64:67], s36 offen
    s_add_u32 s36, s23, 215040
    buffer_load_dword v44, v4, s[64:67], s36 offen
    s_add_u32 s36, s23, 218624
    buffer_load_dword v45, v4, s[64:67], s36 offen
    s_add_u32 s36, s23, 222208
    buffer_load_dword v46, v4, s[64:67], s36 offen
    s_add_u32 s36, s23, 225792
    buffer_load_dword v47, v4, s[64:67], s36 offen
    s_waitcnt vmcnt(0)
    v_perm_b32 v144, v17, v16, s34
    v_perm_b32 v145, v19, v18, s34
    v_perm_b32 v146, v21, v20, s34
    v_perm_b32 v147, v23, v22, s34
    v_perm_b32 v148, v25, v24, s34
    v_perm_b32 v149, v27, v26, s34
    v_perm_b32 v150, v29, v28, s34
    v_perm_b32 v151, v31, v30, s34
    v_perm_b32 v152, v33, v32, s34
    v_perm_b32 v153, v35, v34, s34
    v_perm_b32 v154, v37, v36, s34
    v_perm_b32 v155, v39, v38, s34
    v_perm_b32 v156, v41, v40, s34
    v_perm_b32 v157, v43, v42, s34
    v_perm_b32 v158, v45, v44, s34
    v_perm_b32 v159, v47, v46, s34
    v_perm_b32 v176, v17, v16, s35
    v_perm_b32 v177, v19, v18, s35
    v_perm_b32 v178, v21, v20, s35
    v_perm_b32 v179, v23, v22, s35
    v_perm_b32 v180, v25, v24, s35
    v_perm_b32 v181, v27, v26, s35
    v_perm_b32 v182, v29, v28, s35
    v_perm_b32 v183, v31, v30, s35
    v_perm_b32 v184, v33, v32, s35
    v_perm_b32 v185, v35, v34, s35
    v_perm_b32 v186, v37, v36, s35
    v_perm_b32 v187, v39, v38, s35
    v_perm_b32 v188, v41, v40, s35
    v_perm_b32 v189, v43, v42, s35
    v_perm_b32 v190, v45, v44, s35
    v_perm_b32 v191, v47, v46, s35
    s_add_u32 s36, s23, 0
    buffer_load_dword v16, v4, s[68:71], s36 offen
    s_add_u32 s36, s23, 3584
    buffer_load_dword v17, v4, s[68:71], s36 offen
    s_add_u32 s36, s23, 7168
    buffer_load_dword v18, v4, s[68:71], s36 offen
    s_add_u32 s36, s23, 10752
    buffer_load_dword v19, v4, s[68:71], s36 offen
    s_add_u32 s36, s23, 14336
    buffer_load_dword v20, v4, s[68:71], s36 offen
    s_add_u32 s36, s23, 17920
    buffer_load_dword v21, v4, s[68:71], s36 offen
    s_add_u32 s36, s23, 21504
    buffer_load_dword v22, v4, s[68:71], s36 offen
    s_add_u32 s36, s23, 25088
    buffer_load_dword v23, v4, s[68:71], s36 offen
    s_add_u32 s36, s23, 28672
    buffer_load_dword v24, v4, s[68:71], s36 offen
    s_add_u32 s36, s23, 32256
    buffer_load_dword v25, v4, s[68:71], s36 offen
    s_add_u32 s36, s23, 35840
    buffer_load_dword v26, v4, s[68:71], s36 offen
    s_add_u32 s36, s23, 39424
    buffer_load_dword v27, v4, s[68:71], s36 offen
    s_add_u32 s36, s23, 43008
    buffer_load_dword v28, v4, s[68:71], s36 offen
    s_add_u32 s36, s23, 46592
    buffer_load_dword v29, v4, s[68:71], s36 offen
    s_add_u32 s36, s23, 50176
    buffer_load_dword v30, v4, s[68:71], s36 offen
    s_add_u32 s36, s23, 53760
    buffer_load_dword v31, v4, s[68:71], s36 offen
    s_add_u32 s36, s23, 57344
    buffer_load_dword v32, v4, s[68:71], s36 offen
    s_add_u32 s36, s23, 60928
    buffer_load_dword v33, v4, s[68:71], s36 offen
    s_add_u32 s36, s23, 64512
    buffer_load_dword v34, v4, s[68:71], s36 offen
    s_add_u32 s36, s23, 68096
    buffer_load_dword v35, v4, s[68:71], s36 offen
    s_add_u32 s36, s23, 71680
    buffer_load_dword v36, v4, s[68:71], s36 offen
    s_add_u32 s36, s23, 75264
    buffer_load_dword v37, v4, s[68:71], s36 offen
    s_add_u32 s36, s23, 78848
    buffer_load_dword v38, v4, s[68:71], s36 offen
    s_add_u32 s36, s23, 82432
    buffer_load_dword v39, v4, s[68:71], s36 offen
    s_add_u32 s36, s23, 86016
    buffer_load_dword v40, v4, s[68:71], s36 offen
    s_add_u32 s36, s23, 89600
    buffer_load_dword v41, v4, s[68:71], s36 offen
    s_add_u32 s36, s23, 93184
    buffer_load_dword v42, v4, s[68:71], s36 offen
    s_add_u32 s36, s23, 96768
    buffer_load_dword v43, v4, s[68:71], s36 offen
    s_add_u32 s36, s23, 100352
    buffer_load_dword v44, v4, s[68:71], s36 offen
    s_add_u32 s36, s23, 103936
    buffer_load_dword v45, v4, s[68:71], s36 offen
    s_add_u32 s36, s23, 107520
    buffer_load_dword v46, v4, s[68:71], s36 offen
    s_add_u32 s36, s23, 111104
    buffer_load_dword v47, v4, s[68:71], s36 offen
    s_waitcnt vmcnt(0)
    v_perm_b32 v192, v17, v16, s34
    v_perm_b32 v193, v19, v18, s34
    v_perm_b32 v194, v21, v20, s34
    v_perm_b32 v195, v23, v22, s34
    v_perm_b32 v196, v25, v24, s34
    v_perm_b32 v197, v27, v26, s34
    v_perm_b32 v198, v29, v28, s34
    v_perm_b32 v199, v31, v30, s34
    v_perm_b32 v200, v33, v32, s34
    v_perm_b32 v201, v35, v34, s34
    v_perm_b32 v202, v37, v36, s34
    v_perm_b32 v203, v39, v38, s34
    v_perm_b32 v204, v41, v40, s34
    v_perm_b32 v205, v43, v42, s34
    v_perm_b32 v206, v45, v44, s34
    v_perm_b32 v207, v47, v46, s34
    v_perm_b32 v224, v17, v16, s35
    v_perm_b32 v225, v19, v18, s35
    v_perm_b32 v226, v21, v20, s35
    v_perm_b32 v227, v23, v22, s35
    v_perm_b32 v228, v25, v24, s35
    v_perm_b32 v229, v27, v26, s35
    v_perm_b32 v230, v29, v28, s35
    v_perm_b32 v231, v31, v30, s35
    v_perm_b32 v232, v33, v32, s35
    v_perm_b32 v233, v35, v34, s35
    v_perm_b32 v234, v37, v36, s35
    v_perm_b32 v235, v39, v38, s35
    v_perm_b32 v236, v41, v40, s35
    v_perm_b32 v237, v43, v42, s35
    v_perm_b32 v238, v45, v44, s35
    v_perm_b32 v239, v47, v46, s35
    s_add_u32 s36, s23, 114688
    buffer_load_dword v16, v4, s[68:71], s36 offen
    s_add_u32 s36, s23, 118272
    buffer_load_dword v17, v4, s[68:71], s36 offen
    s_add_u32 s36, s23, 121856
    buffer_load_dword v18, v4, s[68:71], s36 offen
    s_add_u32 s36, s23, 125440
    buffer_load_dword v19, v4, s[68:71], s36 offen
    s_add_u32 s36, s23, 129024
    buffer_load_dword v20, v4, s[68:71], s36 offen
    s_add_u32 s36, s23, 132608
    buffer_load_dword v21, v4, s[68:71], s36 offen
    s_add_u32 s36, s23, 136192
    buffer_load_dword v22, v4, s[68:71], s36 offen
    s_add_u32 s36, s23, 139776
    buffer_load_dword v23, v4, s[68:71], s36 offen
    s_add_u32 s36, s23, 143360
    buffer_load_dword v24, v4, s[68:71], s36 offen
    s_add_u32 s36, s23, 146944
    buffer_load_dword v25, v4, s[68:71], s36 offen
    s_add_u32 s36, s23, 150528
    buffer_load_dword v26, v4, s[68:71], s36 offen
    s_add_u32 s36, s23, 154112
    buffer_load_dword v27, v4, s[68:71], s36 offen
    s_add_u32 s36, s23, 157696
    buffer_load_dword v28, v4, s[68:71], s36 offen
    s_add_u32 s36, s23, 161280
    buffer_load_dword v29, v4, s[68:71], s36 offen
    s_add_u32 s36, s23, 164864
    buffer_load_dword v30, v4, s[68:71], s36 offen
    s_add_u32 s36, s23, 168448
    buffer_load_dword v31, v4, s[68:71], s36 offen
    s_add_u32 s36, s23, 172032
    buffer_load_dword v32, v4, s[68:71], s36 offen
    s_add_u32 s36, s23, 175616
    buffer_load_dword v33, v4, s[68:71], s36 offen
    s_add_u32 s36, s23, 179200
    buffer_load_dword v34, v4, s[68:71], s36 offen
    s_add_u32 s36, s23, 182784
    buffer_load_dword v35, v4, s[68:71], s36 offen
    s_add_u32 s36, s23, 186368
    buffer_load_dword v36, v4, s[68:71], s36 offen
    s_add_u32 s36, s23, 189952
    buffer_load_dword v37, v4, s[68:71], s36 offen
    s_add_u32 s36, s23, 193536
    buffer_load_dword v38, v4, s[68:71], s36 offen
    s_add_u32 s36, s23, 197120
    buffer_load_dword v39, v4, s[68:71], s36 offen
    s_add_u32 s36, s23, 200704
    buffer_load_dword v40, v4, s[68:71], s36 offen
    s_add_u32 s36, s23, 204288
    buffer_load_dword v41, v4, s[68:71], s36 offen
    s_add_u32 s36, s23, 207872
    buffer_load_dword v42, v4, s[68:71], s36 offen
    s_add_u32 s36, s23, 211456
    buffer_load_dword v43, v4, s[68:71], s36 offen
    s_add_u32 s36, s23, 215040
    buffer_load_dword v44, v4, s[68:71], s36 offen
    s_add_u32 s36, s23, 218624
    buffer_load_dword v45, v4, s[68:71], s36 offen
    s_add_u32 s36, s23, 222208
    buffer_load_dword v46, v4, s[68:71], s36 offen
    s_add_u32 s36, s23, 225792
    buffer_load_dword v47, v4, s[68:71], s36 offen
    s_waitcnt vmcnt(0)
    v_perm_b32 v208, v17, v16, s34
    v_perm_b32 v209, v19, v18, s34
    v_perm_b32 v210, v21, v20, s34
    v_perm_b32 v211, v23, v22, s34
    v_perm_b32 v212, v25, v24, s34
    v_perm_b32 v213, v27, v26, s34
    v_perm_b32 v214, v29, v28, s34
    v_perm_b32 v215, v31, v30, s34
    v_perm_b32 v216, v33, v32, s34
    v_perm_b32 v217, v35, v34, s34
    v_perm_b32 v218, v37, v36, s34
    v_perm_b32 v219, v39, v38, s34
    v_perm_b32 v220, v41, v40, s34
    v_perm_b32 v221, v43, v42, s34
    v_perm_b32 v222, v45, v44, s34
    v_perm_b32 v223, v47, v46, s34
    v_perm_b32 v240, v17, v16, s35
    v_perm_b32 v241, v19, v18, s35
    v_perm_b32 v242, v21, v20, s35
    v_perm_b32 v243, v23, v22, s35
    v_perm_b32 v244, v25, v24, s35
    v_perm_b32 v245, v27, v26, s35
    v_perm_b32 v246, v29, v28, s35
    v_perm_b32 v247, v31, v30, s35
    v_perm_b32 v248, v33, v32, s35
    v_perm_b32 v249, v35, v34, s35
    v_perm_b32 v250, v37, v36, s35
    v_perm_b32 v251, v39, v38, s35
    v_perm_b32 v252, v41, v40, s35
    v_perm_b32 v253, v43, v42, s35
    v_perm_b32 v254, v45, v44, s35
    v_perm_b32 v255, v47, v46, s35
    v_lshrrev_b32 v3, 3, v0
    v_mul_u32_u24 v4, 57344, v3
    v_and_b32 v3, 7, v0
    v_lshl_add_u32 v4, v3, 2, v4
    s_lshl_b32 s37, s20, 5
    s_add_u32 s36, s37, 0
    buffer_load_dword v16, v4, s[76:79], s36 offen
    s_add_u32 s36, s37, 1024
    buffer_load_dword v17, v4, s[76:79], s36 offen
    s_add_u32 s36, s37, 2048
    buffer_load_dword v18, v4, s[76:79], s36 offen
    s_add_u32 s36, s37, 3072
    buffer_load_dword v19, v4, s[76:79], s36 offen
    s_add_u32 s36, s37, 4096
    buffer_load_dword v20, v4, s[76:79], s36 offen
    s_add_u32 s36, s37, 5120
    buffer_load_dword v21, v4, s[76:79], s36 offen
    s_add_u32 s36, s37, 6144
    buffer_load_dword v22, v4, s[76:79], s36 offen
    s_add_u32 s36, s37, 7168
    buffer_load_dword v23, v4, s[76:79], s36 offen
    s_add_u32 s36, s37, 8192
    buffer_load_dword v24, v4, s[76:79], s36 offen
    s_add_u32 s36, s37, 9216
    buffer_load_dword v25, v4, s[76:79], s36 offen
    s_add_u32 s36, s37, 10240
    buffer_load_dword v26, v4, s[76:79], s36 offen
    s_add_u32 s36, s37, 11264
    buffer_load_dword v27, v4, s[76:79], s36 offen
    s_add_u32 s36, s37, 12288
    buffer_load_dword v28, v4, s[76:79], s36 offen
    s_add_u32 s36, s37, 13312
    buffer_load_dword v29, v4, s[76:79], s36 offen
    s_add_u32 s36, s37, 14336
    buffer_load_dword v30, v4, s[76:79], s36 offen
    s_add_u32 s36, s37, 15360
    buffer_load_dword v31, v4, s[76:79], s36 offen
    s_add_u32 s36, s37, 16384
    buffer_load_dword v32, v4, s[76:79], s36 offen
    s_add_u32 s36, s37, 17408
    buffer_load_dword v33, v4, s[76:79], s36 offen
    s_add_u32 s36, s37, 18432
    buffer_load_dword v34, v4, s[76:79], s36 offen
    s_add_u32 s36, s37, 19456
    buffer_load_dword v35, v4, s[76:79], s36 offen
    s_add_u32 s36, s37, 20480
    buffer_load_dword v36, v4, s[76:79], s36 offen
    s_add_u32 s36, s37, 21504
    buffer_load_dword v37, v4, s[76:79], s36 offen
    s_add_u32 s36, s37, 22528
    buffer_load_dword v38, v4, s[76:79], s36 offen
    s_add_u32 s36, s37, 23552
    buffer_load_dword v39, v4, s[76:79], s36 offen
    s_add_u32 s36, s37, 24576
    buffer_load_dword v40, v4, s[76:79], s36 offen
    s_add_u32 s36, s37, 25600
    buffer_load_dword v41, v4, s[76:79], s36 offen
    s_add_u32 s36, s37, 26624
    buffer_load_dword v42, v4, s[76:79], s36 offen
    s_add_u32 s36, s37, 27648
    buffer_load_dword v43, v4, s[76:79], s36 offen
    s_waitcnt vmcnt(0)
    v_perm_b32 v64, v17, v16, s34
    v_perm_b32 v65, v19, v18, s34
    v_perm_b32 v66, v21, v20, s34
    v_perm_b32 v67, v23, v22, s34
    v_perm_b32 v68, v25, v24, s34
    v_perm_b32 v69, v27, v26, s34
    v_perm_b32 v70, v29, v28, s34
    v_perm_b32 v71, v31, v30, s34
    v_perm_b32 v72, v33, v32, s34
    v_perm_b32 v73, v35, v34, s34
    v_perm_b32 v74, v37, v36, s34
    v_perm_b32 v75, v39, v38, s34
    v_perm_b32 v76, v41, v40, s34
    v_perm_b32 v77, v43, v42, s34
    v_perm_b32 v92, v17, v16, s35
    v_perm_b32 v93, v19, v18, s35
    v_perm_b32 v94, v21, v20, s35
    v_perm_b32 v95, v23, v22, s35
    v_perm_b32 v96, v25, v24, s35
    v_perm_b32 v97, v27, v26, s35
    v_perm_b32 v98, v29, v28, s35
    v_perm_b32 v99, v31, v30, s35
    v_perm_b32 v100, v33, v32, s35
    v_perm_b32 v101, v35, v34, s35
    v_perm_b32 v102, v37, v36, s35
    v_perm_b32 v103, v39, v38, s35
    v_perm_b32 v104, v41, v40, s35
    v_perm_b32 v105, v43, v42, s35
    s_add_u32 s36, s37, 28672
    buffer_load_dword v16, v4, s[76:79], s36 offen
    s_add_u32 s36, s37, 29696
    buffer_load_dword v17, v4, s[76:79], s36 offen
    s_add_u32 s36, s37, 30720
    buffer_load_dword v18, v4, s[76:79], s36 offen
    s_add_u32 s36, s37, 31744
    buffer_load_dword v19, v4, s[76:79], s36 offen
    s_add_u32 s36, s37, 32768
    buffer_load_dword v20, v4, s[76:79], s36 offen
    s_add_u32 s36, s37, 33792
    buffer_load_dword v21, v4, s[76:79], s36 offen
    s_add_u32 s36, s37, 34816
    buffer_load_dword v22, v4, s[76:79], s36 offen
    s_add_u32 s36, s37, 35840
    buffer_load_dword v23, v4, s[76:79], s36 offen
    s_add_u32 s36, s37, 36864
    buffer_load_dword v24, v4, s[76:79], s36 offen
    s_add_u32 s36, s37, 37888
    buffer_load_dword v25, v4, s[76:79], s36 offen
    s_add_u32 s36, s37, 38912
    buffer_load_dword v26, v4, s[76:79], s36 offen
    s_add_u32 s36, s37, 39936
    buffer_load_dword v27, v4, s[76:79], s36 offen
    s_add_u32 s36, s37, 40960
    buffer_load_dword v28, v4, s[76:79], s36 offen
    s_add_u32 s36, s37, 41984
    buffer_load_dword v29, v4, s[76:79], s36 offen
    s_add_u32 s36, s37, 43008
    buffer_load_dword v30, v4, s[76:79], s36 offen
    s_add_u32 s36, s37, 44032
    buffer_load_dword v31, v4, s[76:79], s36 offen
    s_add_u32 s36, s37, 45056
    buffer_load_dword v32, v4, s[76:79], s36 offen
    s_add_u32 s36, s37, 46080
    buffer_load_dword v33, v4, s[76:79], s36 offen
    s_add_u32 s36, s37, 47104
    buffer_load_dword v34, v4, s[76:79], s36 offen
    s_add_u32 s36, s37, 48128
    buffer_load_dword v35, v4, s[76:79], s36 offen
    s_add_u32 s36, s37, 49152
    buffer_load_dword v36, v4, s[76:79], s36 offen
    s_add_u32 s36, s37, 50176
    buffer_load_dword v37, v4, s[76:79], s36 offen
    s_add_u32 s36, s37, 51200
    buffer_load_dword v38, v4, s[76:79], s36 offen
    s_add_u32 s36, s37, 52224
    buffer_load_dword v39, v4, s[76:79], s36 offen
    s_add_u32 s36, s37, 53248
    buffer_load_dword v40, v4, s[76:79], s36 offen
    s_add_u32 s36, s37, 54272
    buffer_load_dword v41, v4, s[76:79], s36 offen
    s_add_u32 s36, s37, 55296
    buffer_load_dword v42, v4, s[76:79], s36 offen
    s_add_u32 s36, s37, 56320
    buffer_load_dword v43, v4, s[76:79], s36 offen
    s_waitcnt vmcnt(0)
    v_perm_b32 v78, v17, v16, s34
    v_perm_b32 v79, v19, v18, s34
    v_perm_b32 v80, v21, v20, s34
    v_perm_b32 v81, v23, v22, s34
    v_perm_b32 v82, v25, v24, s34
    v_perm_b32 v83, v27, v26, s34
    v_perm_b32 v84, v29, v28, s34
    v_perm_b32 v85, v31, v30, s34
    v_perm_b32 v86, v33, v32, s34
    v_perm_b32 v87, v35, v34, s34
    v_perm_b32 v88, v37, v36, s34
    v_perm_b32 v89, v39, v38, s34
    v_perm_b32 v90, v41, v40, s34
    v_perm_b32 v91, v43, v42, s34
    v_perm_b32 v106, v17, v16, s35
    v_perm_b32 v107, v19, v18, s35
    v_perm_b32 v108, v21, v20, s35
    v_perm_b32 v109, v23, v22, s35
    v_perm_b32 v110, v25, v24, s35
    v_perm_b32 v111, v27, v26, s35
    v_perm_b32 v112, v29, v28, s35
    v_perm_b32 v113, v31, v30, s35
    v_perm_b32 v114, v33, v32, s35
    v_perm_b32 v115, v35, v34, s35
    v_perm_b32 v116, v37, v36, s35
    v_perm_b32 v117, v39, v38, s35
    v_perm_b32 v118, v41, v40, s35
    v_perm_b32 v119, v43, v42, s35
    s_mov_b32 s42, 0xffff0000
    s_mov_b32 s24, 0
    s_mov_b64 s[28:29], 0
    v_mov_b32 v12, 0x40000000
    v_mov_b32 v13, 0
    v_lshlrev_b32 v3, 4, v0
L_M06_rp:
    s_mov_b32 s36, 0x19a000
    buffer_load_dwordx4 v[40:43], v3, s[8:11], s36 offen sc1
    s_add_u32 s32, s32, 1
    v_mov_b32 v5, 0
    s_waitcnt vmcnt(0)
    v_max3_u32 v5, v5, v40, v41
    v_max3_u32 v5, v5, v42, v43
    s_cmp_gt_u32 s32, 200000
    s_cbranch_scc1 L_M06_rp_ok
    v_cmp_eq_u32 vcc, -1, v5
    s_cbranch_vccz L_M06_rp_ok
    s_sleep 32
    s_branch L_M06_rp
L_M06_rp_ok:
    v_add_f32 v40, v40, v41
    v_add_f32 v42, v42, v43
    v_add_f32 v40, v40, v42
    v_cvt_pk_bf16_f32 v5, v40, v40
    v_lshlrev_b32 v40, 16, v5
    v_ashrrev_i32 v5, 31, v40
    v_or_b32 v5, 0x80000000, v5
    v_xor_b32 v5, v5, v40
    v_and_b32 v5, 0xffff0000, v5
    v_sub_u32 v6, 511, v0
    v_or_b32 v126, v5, v6
    v_lshlrev_b32 v3, 4, v0
L_M01_rp:
    s_mov_b32 s36, 0x195000
    buffer_load_dwordx4 v[20:23], v3, s[8:11], s36 offen sc1
    s_mov_b32 s36, 0x196000
    buffer_load_dwordx4 v[24:27], v3, s[8:11], s36 offen sc1
    s_mov_b32 s36, 0x197000
    buffer_load_dwordx4 v[28:31], v3, s[8:11], s36 offen sc1
    s_mov_b32 s36, 0x198000
    buffer_load_dwordx4 v[32:35], v3, s[8:11], s36 offen sc1
    s_mov_b32 s36, 0x199000
    buffer_load_dwordx4 v[36:39], v3, s[8:11], s36 offen sc1
    s_add_u32 s32, s32, 1
    v_mov_b32 v5, 0
    s_waitcnt vmcnt(0)
    v_max3_u32 v5, v5, v20, v21
    v_max3_u32 v5, v5, v22, v23
    v_max3_u32 v5, v5, v24, v25
    v_max3_u32 v5, v5, v26, v27
    v_max3_u32 v5, v5, v28, v29
    v_max3_u32 v5, v5, v30, v31
    v_max3_u32 v5, v5, v32, v33
    v_max3_u32 v5, v5, v34, v35
    v_max3_u32 v5, v5, v36, v37
    v_max3_u32 v5, v5, v38, v39
    s_cmp_gt_u32 s32, 200000
    s_cbranch_scc1 L_M01_rp_ok
    v_cmp_eq_u32 vcc, -1, v5
    s_cbranch_vccz L_M01_rp_ok
    s_sleep 8
    s_branch L_M01_rp
L_M01_rp_ok:
    v_add_f32 v20, v20, v21
    v_add_f32 v22, v22, v23
    v_add_f32 v20, v20, v22
    v_cvt_pk_bf16_f32 v5, v20, v20
    v_lshlrev_b32 v20, 16, v5
    v_ashrrev_i32 v5, 31, v20
    v_or_b32 v5, 0x80000000, v5
    v_xor_b32 v5, v5, v20
    v_and_b32 v5, 0xffff0000, v5
    v_sub_u32 v6, 1791, v0
    v_or_b32 v121, v5, v6
    v_add_f32 v24, v24, v25
    v_add_f32 v26, v26, v27
    v_add_f32 v24, v24, v26
    v_cvt_pk_bf16_f32 v5, v24, v24
    v_lshlrev_b32 v24, 16, v5
    v_ashrrev_i32 v5, 31, v24
    v_or_b32 v5, 0x80000000, v5
    v_xor_b32 v5, v5, v24
    v_and_b32 v5, 0xffff0000, v5
    v_sub_u32 v6, 1535, v0
    v_or_b32 v122, v5, v6
    v_add_f32 v28, v28, v29
    v_add_f32 v30, v30, v31
    v_add_f32 v28, v28, v30
    v_cvt_pk_bf16_f32 v5, v28, v28
    v_lshlrev_b32 v28, 16, v5
    v_ashrrev_i32 v5, 31, v28
    v_or_b32 v5, 0x80000000, v5
    v_xor_b32 v5, v5, v28
    v_and_b32 v5, 0xffff0000, v5
    v_sub_u32 v6, 1279, v0
    v_or_b32 v123, v5, v6
    v_add_f32 v32, v32, v33
    v_add_f32 v34, v34, v35
    v_add_f32 v32, v32, v34
    v_cvt_pk_bf16_f32 v5, v32, v32
    v_lshlrev_b32 v32, 16, v5
    v_ashrrev_i32 v5, 31, v32
    v_or_b32 v5, 0x80000000, v5
    v_xor_b32 v5, v5, v32
    v_and_b32 v5, 0xffff0000, v5
    v_sub_u32 v6, 1023, v0
    v_or_b32 v124, v5, v6
    v_add_f32 v36, v36, v37
    v_add_f32 v38, v38, v39
    v_add_f32 v36, v36, v38
    v_cvt_pk_bf16_f32 v5, v36, v36
    v_lshlrev_b32 v36, 16, v5
    v_ashrrev_i32 v5, 31, v36
    v_or_b32 v5, 0x80000000, v5
    v_xor_b32 v5, v5, v36
    v_and_b32 v5, 0xffff0000, v5
    v_sub_u32 v6, 767, v0
    v_or_b32 v125, v5, v6
    v_max_u32 v5, v120, v121
    v_min_u32 v6, v120, v121
    v_med3_u32 v6, v5, v6, v122
    v_max_u32 v5, v5, v122
    v_med3_u32 v6, v5, v6, v123
    v_max_u32 v5, v5, v123
    v_med3_u32 v6, v5, v6, v124
    v_max_u32 v5, v5, v124
    v_med3_u32 v6, v5, v6, v125
    v_max_u32 v5, v5, v125
    v_med3_u32 v6, v5, v6, v126
    v_max_u32 v5, v5, v126
    v_mov_b32 v120, v5
    v_mov_b32 v121, v6
    s_mov_b32 s25, 32
L_M_round:
    v_lshlrev_b32 v3, 4, v0
    v_cmp_gt_u32 s[74:75], s25, v0
L_M7_rp:
    s_mov_b32 s36, 0x19b000
    buffer_load_dwordx4 v[44:47], v3, s[8:11], s36 offen sc1
    s_add_u32 s32, s32, 1
    v_mov_b32 v5, 0
    s_waitcnt vmcnt(0)
    v_max3_u32 v5, v5, v44, v45
    v_max3_u32 v5, v5, v46, v47
    v_cndmask_b32 v5, 0, v5, s[74:75]
    s_cmp_gt_u32 s32, 200000
    s_cbranch_scc1 L_M7_rp_ok
    v_cmp_eq_u32 vcc, -1, v5
    s_cbranch_vccnz L_M7_rp
L_M7_rp_ok:
    v_add_f32 v44, v44, v45
    v_add_f32 v46, v46, v47
    v_add_f32 v44, v44, v46
    v_cvt_pk_bf16_f32 v5, v44, v44
    v_lshlrev_b32 v44, 16, v5
    v_ashrrev_i32 v5, 31, v44
    v_or_b32 v5, 0x80000000, v5
    v_xor_b32 v5, v5, v44
    v_and_b32 v5, 0xffff0000, v5
    v_sub_u32 v6, 255, v0
    v_or_b32 v127, v5, v6
    v_cndmask_b32 v127, 0, v127, s[74:75]
    v_max_u32 v5, v120, v127
    v_med3_u32 v6, v120, v121, v127
    s_nop 0
    v_mov_b32_dpp v7, v5 quad_perm:[1,0,3,2] row_mask:0xf bank_mask:0xf
    v_mov_b32_dpp v8, v6 quad_perm:[1,0,3,2] row_mask:0xf bank_mask:0xf
    v_min_u32 v9, v5, v7
    v_max_u32 v5, v5, v7
    v_max3_u32 v6, v6, v8, v9
    s_nop 0
    v_mov_b32_dpp v7, v5 quad_perm:[2,3,0,1] row_mask:0xf bank_mask:0xf
    v_mov_b32_dpp v8, v6 quad_perm:[2,3,0,1] row_mask:0xf bank_mask:0xf
    v_min_u32 v9, v5, v7
    v_max_u32 v5, v5, v7
    v_max3_u32 v6, v6, v8, v9
    s_nop 0
    v_mov_b32_dpp v7, v5 row_half_mirror row_mask:0xf bank_mask:0xf
    v_mov_b32_dpp v8, v6 row_half_mirror row_mask:0xf bank_mask:0xf
    v_min_u32 v9, v5, v7
    v_max_u32 v5, v5, v7
    v_max3_u32 v6, v6, v8, v9
    s_nop 0
    v_mov_b32_dpp v7, v5 row_mirror row_mask:0xf bank_mask:0xf
    v_mov_b32_dpp v8, v6 row_mirror row_mask:0xf bank_mask:0xf
    v_min_u32 v9, v5, v7
    v_max_u32 v5, v5, v7
    v_max3_u32 v6, v6, v8, v9
    v_lshrrev_b32 v9, 4, v0
    v_lshlrev_b32 v9, 3, v9
    s_barrier
    ds_write2_b32 v9, v5, v6 offset0:0 offset1:1
    v_and_b32 v9, 15, v0
    v_lshlrev_b32 v9, 3, v9
    s_waitcnt lgkmcnt(0)
    s_barrier
    ds_read2_b32 v[10:11], v9 offset0:0 offset1:1
    s_waitcnt lgkmcnt(0)
    v_mov_b32 v5, v10
    v_mov_b32 v6, v11
    s_nop 0
    v_mov_b32_dpp v7, v5 quad_perm:[1,0,3,2] row_mask:0xf bank_mask:0xf
    v_mov_b32_dpp v8, v6 quad_perm:[1,0,3,2] row_mask:0xf bank_mask:0xf
    v_min_u32 v9, v5, v7
    v_max_u32 v5, v5, v7
    v_max3_u32 v6, v6, v8, v9
    s_nop 0
    v_mov_b32_dpp v7, v5 quad_perm:[2,3,0,1] row_mask:0xf bank_mask:0xf
    v_mov_b32_dpp v8, v6 quad_perm:[2,3,0,1] row_mask:0xf bank_mask:0xf
    v_min_u32 v9, v5, v7
    v_max_u32 v5, v5, v7
    v_max3_u32 v6, v6, v8, v9
    s_nop 0
    v_mov_b32_dpp v7, v5 row_half_mirror row_mask:0xf bank_mask:0xf
    v_mov_b32_dpp v8, v6 row_half_mirror row_mask:0xf bank_mask:0xf
    v_min_u32 v9, v5, v7
    v_max_u32 v5, v5, v7
    v_max3_u32 v6, v6, v8, v9
    s_nop 0
    v_mov_b32_dpp v7, v5 row_mirror row_mask:0xf bank_mask:0xf
    v_mov_b32_dpp v8, v6 row_mirror row_mask:0xf bank_mask:0xf
    v_min_u32 v9, v5, v7
    v_max_u32 v5, v5, v7
    v_max3_u32 v6, v6, v8, v9
    v_readfirstlane_b32 s26, v5
    v_readfirstlane_b32 s27, v6
    s_nop 3
    s_cmp_eq_u64 s[26:27], s[28:29]
    s_cbranch_scc1 L_M_next
    s_mov_b64 s[28:29], s[26:27]
    buffer_store_dword v13, v12, s[60:63], 0 offen sc1
    s_and_b32 s36, s26, 0x7ff
    s_sub_u32 s30, 2047, s36
    s_and_b32 s36, s26, 0xffff0000
    s_xor_b32 s37, s36, 0x80000000
    s_xor_b32 s40, s36, 0xffff0000
    s_bitcmp1_b32 s36, 31
    s_cselect_b32 s40, s37, s40
    s_and_b32 s36, s27, 0x7ff
    s_sub_u32 s31, 2047, s36
    s_and_b32 s36, s27, 0xffff0000
    s_xor_b32 s37, s36, 0x80000000
    s_xor_b32 s41, s36, 0xffff0000
    s_bitcmp1_b32 s36, 31
    s_cselect_b32 s41, s37, s41
    v_mov_b32 v8, 0
L_M_rows:
    s_lshl_b32 s36, s30, 4
    s_add_u32 s36, s36, 0x1b8000
    buffer_load_dwordx4 v[16:19], v8, s[8:11], s36 offen sc1
    s_lshl_b32 s36, s31, 4
    s_add_u32 s36, s36, 0x1b8000
    buffer_load_dwordx4 v[20:23], v8, s[8:11], s36 offen sc1
    s_add_u32 s32, s32, 1
    s_cmp_gt_u32 s32, 200000
    s_waitcnt vmcnt(0)
    v_or3_b32 v5, v16, v17, v18
    v_or3_b32 v5, v5, v19, v20
    v_or3_b32 v5, v5, v21, v22
    v_or_b32 v5, v5, v23
    s_cbranch_scc1 L_M_rows_ok
    v_cmp_ne_u32 vcc, 0, v5
    s_cbranch_vccnz L_M_rows
L_M_rows_ok:
    v_bfe_u32 v9, v0, 6, 1
    v_cmp_ne_u32 vcc, 0, v9
    v_mov_b32 v5, s30
    v_mov_b32 v6, s31
    v_cndmask_b32 v7, v5, v6, vcc
    v_lshlrev_b32 v7, 10, v7
    v_and_b32 v8, 63, v0
    v_lshl_add_u32 v7, v8, 4, v7
    s_mov_b32 s37, 0x600000
    buffer_load_dwordx4 v[16:19], v7, s[8:11], s37 offen sc1
    v_bfe_u32 v9, v0, 3, 1
    v_cmp_ne_u32 vcc, 0, v9
    s_nop 1
    v_cndmask_b32 v12, v5, v6, vcc
    v_mov_b32 v5, s40
    v_mov_b32 v6, s41
    v_cndmask_b32 v11, v5, v6, vcc
    v_lshlrev_b32 v12, 10, v12
    v_and_b32 v3, 7, v0
    v_lshl_add_u32 v12, v3, 2, v12
    s_lshl_b32 s36, s20, 5
    v_add_u32 v12, s36, v12
    v_mov_b32 v7, 0x40000000
    v_cmp_lt_u32 vcc, 15, v0
    s_nop 1
    v_cndmask_b32 v12, v12, v7, vcc
    s_mov_b32 s36, 0x400000
    buffer_load_dword v14, v12, s[8:11], s36 offen sc1
    buffer_load_dword v15, v12, s[8:11], s37 offen sc1
    v_and_b32 v8, 127, v0
    v_lshlrev_b32 v8, 4, v8
    s_waitcnt vmcnt(2)
    ds_write_b128 v8, v[16:19] offset:4096
    s_waitcnt lgkmcnt(0)
    s_barrier
    v_mov_b64 v[48:49], 0
    v_mov_b64 v[50:51], 0
    v_mov_b64 v[52:53], 0
    v_mov_b64 v[54:55], 0
    v_lshlrev_b32 v8, 7, v1
    ds_read_b128 v[16:19], v8 offset:4096
    ds_read_b128 v[20:23], v8 offset:4112
    ds_read_b128 v[24:27], v8 offset:4128
    ds_read_b128 v[28:31], v8 offset:4144
    ds_read_b128 v[32:35], v8 offset:5120
    ds_read_b128 v[36:39], v8 offset:5136
    ds_read_b128 v[40:43], v8 offset:5152
    ds_read_b128 v[44:47], v8 offset:5168
    s_waitcnt lgkmcnt(0)
    v_dot2_f32_bf16 v48, v16, v128, v48
    v_dot2_f32_bf16 v49, v16, v160, v49
    v_dot2_f32_bf16 v50, v32, v128, v50
    v_dot2_f32_bf16 v51, v32, v160, v51
    v_dot2_f32_bf16 v52, v16, v192, v52
    v_dot2_f32_bf16 v53, v16, v224, v53
    v_dot2_f32_bf16 v54, v32, v192, v54
    v_dot2_f32_bf16 v55, v32, v224, v55
    v_dot2_f32_bf16 v48, v17, v129, v48
    v_dot2_f32_bf16 v49, v17, v161, v49
    v_dot2_f32_bf16 v50, v33, v129, v50
    v_dot2_f32_bf16 v51, v33, v161, v51
    v_dot2_f32_bf16 v52, v17, v193, v52
    v_dot2_f32_bf16 v53, v17, v225, v53
    v_dot2_f32_bf16 v54, v33, v193, v54
    v_dot2_f32_bf16 v55, v33, v225, v55
    v_dot2_f32_bf16 v48, v18, v130, v48
    v_dot2_f32_bf16 v49, v18, v162, v49
    v_dot2_f32_bf16 v50, v34, v130, v50
    v_dot2_f32_bf16 v51, v34, v162, v51
    v_dot2_f32_bf16 v52, v18, v194, v52
    v_dot2_f32_bf16 v53, v18, v226, v53
    v_dot2_f32_bf16 v54, v34, v194, v54
    v_dot2_f32_bf16 v55, v34, v226, v55
    v_dot2_f32_bf16 v48, v19, v131, v48
    v_dot2_f32_bf16 v49, v19, v163, v49
    v_dot2_f32_bf16 v50, v35, v131, v50
    v_dot2_f32_bf16 v51, v35, v163, v51
    v_dot2_f32_bf16 v52, v19, v195, v52
    v_dot2_f32_bf16 v53, v19, v227, v53
    v_dot2_f32_bf16 v54, v35, v195, v54
    v_dot2_f32_bf16 v55, v35, v227, v55
    v_dot2_f32_bf16 v48, v20, v132, v48
    v_dot2_f32_bf16 v49, v20, v164, v49
    v_dot2_f32_bf16 v50, v36, v132, v50
    v_dot2_f32_bf16 v51, v36, v164, v51
    v_dot2_f32_bf16 v52, v20, v196, v52
    v_dot2_f32_bf16 v53, v20, v228, v53
    v_dot2_f32_bf16 v54, v36, v196, v54
    v_dot2_f32_bf16 v55, v36, v228, v55
    v_dot2_f32_bf16 v48, v21, v133, v48
    v_dot2_f32_bf16 v49, v21, v165, v49
    v_dot2_f32_bf16 v50, v37, v133, v50
    v_dot2_f32_bf16 v51, v37, v165, v51
    v_dot2_f32_bf16 v52, v21, v197, v52
    v_dot2_f32_bf16 v53, v21, v229, v53
    v_dot2_f32_bf16 v54, v37, v197, v54
    v_dot2_f32_bf16 v55, v37, v229, v55
    v_dot2_f32_bf16 v48, v22, v134, v48
    v_dot2_f32_bf16 v49, v22, v166, v49
    v_dot2_f32_bf16 v50, v38, v134, v50
    v_dot2_f32_bf16 v51, v38, v166, v51
    v_dot2_f32_bf16 v52, v22, v198, v52
    v_dot2_f32_bf16 v53, v22, v230, v53
    v_dot2_f32_bf16 v54, v38, v198, v54
    v_dot2_f32_bf16 v55, v38, v230, v55
    v_dot2_f32_bf16 v48, v23, v135, v48
    v_dot2_f32_bf16 v49, v23, v167, v49
    v_dot2_f32_bf16 v50, v39, v135, v50
    v_dot2_f32_bf16 v51, v39, v167, v51
    v_dot2_f32_bf16 v52, v23, v199, v52
    v_dot2_f32_bf16 v53, v23, v231, v53
    v_dot2_f32_bf16 v54, v39, v199, v54
    v_dot2_f32_bf16 v55, v39, v231, v55
    v_dot2_f32_bf16 v48, v24, v136, v48
    v_dot2_f32_bf16 v49, v24, v168, v49
    v_dot2_f32_bf16 v50, v40, v136, v50
    v_dot2_f32_bf16 v51, v40, v168, v51
    v_dot2_f32_bf16 v52, v24, v200, v52
    v_dot2_f32_bf16 v53, v24, v232, v53
    v_dot2_f32_bf16 v54, v40, v200, v54
    v_dot2_f32_bf16 v55, v40, v232, v55
    v_dot2_f32_bf16 v48, v25, v137, v48
    v_dot2_f32_bf16 v49, v25, v169, v49
    v_dot2_f32_bf16 v50, v41, v137, v50
    v_dot2_f32_bf16 v51, v41, v169, v51
    v_dot2_f32_bf16 v52, v25, v201, v52
    v_dot2_f32_bf16 v53, v25, v233, v53
    v_dot2_f32_bf16 v54, v41, v201, v54
    v_dot2_f32_bf16 v55, v41, v233, v55
    v_dot2_f32_bf16 v48, v26, v138, v48
    v_dot2_f32_bf16 v49, v26, v170, v49
    v_dot2_f32_bf16 v50, v42, v138, v50
    v_dot2_f32_bf16 v51, v42, v170, v51
    v_dot2_f32_bf16 v52, v26, v202, v52
    v_dot2_f32_bf16 v53, v26, v234, v53
    v_dot2_f32_bf16 v54, v42, v202, v54
    v_dot2_f32_bf16 v55, v42, v234, v55
    v_dot2_f32_bf16 v48, v27, v139, v48
    v_dot2_f32_bf16 v49, v27, v171, v49
    v_dot2_f32_bf16 v50, v43, v139, v50
    v_dot2_f32_bf16 v51, v43, v171, v51
    v_dot2_f32_bf16 v52, v27, v203, v52
    v_dot2_f32_bf16 v53, v27, v235, v53
    v_dot2_f32_bf16 v54, v43, v203, v54
    v_dot2_f32_bf16 v55, v43, v235, v55
    v_dot2_f32_bf16 v48, v28, v140, v48
    v_dot2_f32_bf16 v49, v28, v172, v49
    v_dot2_f32_bf16 v50, v44, v140, v50
    v_dot2_f32_bf16 v51, v44, v172, v51
    v_dot2_f32_bf16 v52, v28, v204, v52
    v_dot2_f32_bf16 v53, v28, v236, v53
    v_dot2_f32_bf16 v54, v44, v204, v54
    v_dot2_f32_bf16 v55, v44, v236, v55
    v_dot2_f32_bf16 v48, v29, v141, v48
    v_dot2_f32_bf16 v49, v29, v173, v49
    v_dot2_f32_bf16 v50, v45, v141, v50
    v_dot2_f32_bf16 v51, v45, v173, v51
    v_dot2_f32_bf16 v52, v29, v205, v52
    v_dot2_f32_bf16 v53, v29, v237, v53
    v_dot2_f32_bf16 v54, v45, v205, v54
    v_dot2_f32_bf16 v55, v45, v237, v55
    v_dot2_f32_bf16 v48, v30, v142, v48
    v_dot2_f32_bf16 v49, v30, v174, v49
    v_dot2_f32_bf16 v50, v46, v142, v50
    v_dot2_f32_bf16 v51, v46, v174, v51
    v_dot2_f32_bf16 v52, v30, v206, v52
    v_dot2_f32_bf16 v53, v30, v238, v53
    v_dot2_f32_bf16 v54, v46, v206, v54
    v_dot2_f32_bf16 v55, v46, v238, v55
    v_dot2_f32_bf16 v48, v31, v143, v48
    v_dot2_f32_bf16 v49, v31, v175, v49
    v_dot2_f32_bf16 v50, v47, v143, v50
    v_dot2_f32_bf16 v51, v47, v175, v51
    v_dot2_f32_bf16 v52, v31, v207, v52
    v_dot2_f32_bf16 v53, v31, v239, v53
    v_dot2_f32_bf16 v54, v47, v207, v54
    v_dot2_f32_bf16 v55, v47, v239, v55
    ds_read_b128 v[16:19], v8 offset:4160
    ds_read_b128 v[20:23], v8 offset:4176
    ds_read_b128 v[24:27], v8 offset:4192
    ds_read_b128 v[28:31], v8 offset:4208
    ds_read_b128 v[32:35], v8 offset:5184
    ds_read_b128 v[36:39], v8 offset:5200
    ds_read_b128 v[40:43], v8 offset:5216
    ds_read_b128 v[44:47], v8 offset:5232
    s_waitcnt lgkmcnt(0)
    v_dot2_f32_bf16 v48, v16, v144, v48
    v_dot2_f32_bf16 v49, v16, v176, v49
    v_dot2_f32_bf16 v50, v32, v144, v50
    v_dot2_f32_bf16 v51, v32, v176, v51
    v_dot2_f32_bf16 v52, v16, v208, v52
    v_dot2_f32_bf16 v53, v16, v240, v53
    v_dot2_f32_bf16 v54, v32, v208, v54
    v_dot2_f32_bf16 v55, v32, v240, v55
    v_dot2_f32_bf16 v48, v17, v145, v48
    v_dot2_f32_bf16 v49, v17, v177, v49
    v_dot2_f32_bf16 v50, v33, v145, v50
    v_dot2_f32_bf16 v51, v33, v177, v51
    v_dot2_f32_bf16 v52, v17, v209, v52
    v_dot2_f32_bf16 v53, v17, v241, v53
    v_dot2_f32_bf16 v54, v33, v209, v54
    v_dot2_f32_bf16 v55, v33, v241, v55
    v_dot2_f32_bf16 v48, v18, v146, v48
    v_dot2_f32_bf16 v49, v18, v178, v49
    v_dot2_f32_bf16 v50, v34, v146, v50
    v_dot2_f32_bf16 v51, v34, v178, v51
    v_dot2_f32_bf16 v52, v18, v210, v52
    v_dot2_f32_bf16 v53, v18, v242, v53
    v_dot2_f32_bf16 v54, v34, v210, v54
    v_dot2_f32_bf16 v55, v34, v242, v55
    v_dot2_f32_bf16 v48, v19, v147, v48
    v_dot2_f32_bf16 v49, v19, v179, v49
    v_dot2_f32_bf16 v50, v35, v147, v50
    v_dot2_f32_bf16 v51, v35, v179, v51
    v_dot2_f32_bf16 v52, v19, v211, v52
    v_dot2_f32_bf16 v53, v19, v243, v53
    v_dot2_f32_bf16 v54, v35, v211, v54
    v_dot2_f32_bf16 v55, v35, v243, v55
    v_dot2_f32_bf16 v48, v20, v148, v48
    v_dot2_f32_bf16 v49, v20, v180, v49
    v_dot2_f32_bf16 v50, v36, v148, v50
    v_dot2_f32_bf16 v51, v36, v180, v51
    v_dot2_f32_bf16 v52, v20, v212, v52
    v_dot2_f32_bf16 v53, v20, v244, v53
    v_dot2_f32_bf16 v54, v36, v212, v54
    v_dot2_f32_bf16 v55, v36, v244, v55
    v_dot2_f32_bf16 v48, v21, v149, v48
    v_dot2_f32_bf16 v49, v21, v181, v49
    v_dot2_f32_bf16 v50, v37, v149, v50
    v_dot2_f32_bf16 v51, v37, v181, v51
    v_dot2_f32_bf16 v52, v21, v213, v52
    v_dot2_f32_bf16 v53, v21, v245, v53
    v_dot2_f32_bf16 v54, v37, v213, v54
    v_dot2_f32_bf16 v55, v37, v245, v55
    v_dot2_f32_bf16 v48, v22, v150, v48
    v_dot2_f32_bf16 v49, v22, v182, v49
    v_dot2_f32_bf16 v50, v38, v150, v50
    v_dot2_f32_bf16 v51, v38, v182, v51
    v_dot2_f32_bf16 v52, v22, v214, v52
    v_dot2_f32_bf16 v53, v22, v246, v53
    v_dot2_f32_bf16 v54, v38, v214, v54
    v_dot2_f32_bf16 v55, v38, v246, v55
    v_dot2_f32_bf16 v48, v23, v151, v48
    v_dot2_f32_bf16 v49, v23, v183, v49
    v_dot2_f32_bf16 v50, v39, v151, v50
    v_dot2_f32_bf16 v51, v39, v183, v51
    v_dot2_f32_bf16 v52, v23, v215, v52
    v_dot2_f32_bf16 v53, v23, v247, v53
    v_dot2_f32_bf16 v54, v39, v215, v54
    v_dot2_f32_bf16 v55, v39, v247, v55
    v_dot2_f32_bf16 v48, v24, v152, v48
    v_dot2_f32_bf16 v49, v24, v184, v49
    v_dot2_f32_bf16 v50, v40, v152, v50
    v_dot2_f32_bf16 v51, v40, v184, v51
    v_dot2_f32_bf16 v52, v24, v216, v52
    v_dot2_f32_bf16 v53, v24, v248, v53
    v_dot2_f32_bf16 v54, v40, v216, v54
    v_dot2_f32_bf16 v55, v40, v248, v55
    v_dot2_f32_bf16 v48, v25, v153, v48
    v_dot2_f32_bf16 v49, v25, v185, v49
    v_dot2_f32_bf16 v50, v41, v153, v50
    v_dot2_f32_bf16 v51, v41, v185, v51
    v_dot2_f32_bf16 v52, v25, v217, v52
    v_dot2_f32_bf16 v53, v25, v249, v53
    v_dot2_f32_bf16 v54, v41, v217, v54
    v_dot2_f32_bf16 v55, v41, v249, v55
    v_dot2_f32_bf16 v48, v26, v154, v48
    v_dot2_f32_bf16 v49, v26, v186, v49
    v_dot2_f32_bf16 v50, v42, v154, v50
    v_dot2_f32_bf16 v51, v42, v186, v51
    v_dot2_f32_bf16 v52, v26, v218, v52
    v_dot2_f32_bf16 v53, v26, v250, v53
    v_dot2_f32_bf16 v54, v42, v218, v54
    v_dot2_f32_bf16 v55, v42, v250, v55
    v_dot2_f32_bf16 v48, v27, v155, v48
    v_dot2_f32_bf16 v49, v27, v187, v49
    v_dot2_f32_bf16 v50, v43, v155, v50
    v_dot2_f32_bf16 v51, v43, v187, v51
    v_dot2_f32_bf16 v52, v27, v219, v52
    v_dot2_f32_bf16 v53, v27, v251, v53
    v_dot2_f32_bf16 v54, v43, v219, v54
    v_dot2_f32_bf16 v55, v43, v251, v55
    v_dot2_f32_bf16 v48, v28, v156, v48
    v_dot2_f32_bf16 v49, v28, v188, v49
    v_dot2_f32_bf16 v50, v44, v156, v50
    v_dot2_f32_bf16 v51, v44, v188, v51
    v_dot2_f32_bf16 v52, v28, v220, v52
    v_dot2_f32_bf16 v53, v28, v252, v53
    v_dot2_f32_bf16 v54, v44, v220, v54
    v_dot2_f32_bf16 v55, v44, v252, v55
    v_dot2_f32_bf16 v48, v29, v157, v48
    v_dot2_f32_bf16 v49, v29, v189, v49
    v_dot2_f32_bf16 v50, v45, v157, v50
    v_dot2_f32_bf16 v51, v45, v189, v51
    v_dot2_f32_bf16 v52, v29, v221, v52
    v_dot2_f32_bf16 v53, v29, v253, v53
    v_dot2_f32_bf16 v54, v45, v221, v54
    v_dot2_f32_bf16 v55, v45, v253, v55
    v_dot2_f32_bf16 v48, v30, v158, v48
    v_dot2_f32_bf16 v49, v30, v190, v49
    v_dot2_f32_bf16 v50, v46, v158, v50
    v_dot2_f32_bf16 v51, v46, v190, v51
    v_dot2_f32_bf16 v52, v30, v222, v52
    v_dot2_f32_bf16 v53, v30, v254, v53
    v_dot2_f32_bf16 v54, v46, v222, v54
    v_dot2_f32_bf16 v55, v46, v254, v55
    v_dot2_f32_bf16 v48, v31, v159, v48
    v_dot2_f32_bf16 v49, v31, v191, v49
    v_dot2_f32_bf16 v50, v47, v159, v50
    v_dot2_f32_bf16 v51, v47, v191, v51
    v_dot2_f32_bf16 v52, v31, v223, v52
    v_dot2_f32_bf16 v53, v31, v255, v53
    v_dot2_f32_bf16 v54, v47, v223, v54
    v_dot2_f32_bf16 v55, v47, v255, v55
    s_nop 3
    v_lshlrev_b32 v7, 5, v0
    ds_write_b128 v7, v[48:51] offset:8192
    ds_write_b128 v7, v[52:55] offset:8208
    s_waitcnt lgkmcnt(0)
    s_barrier
    v_lshlrev_b32 v7, 5, v2
    v_bfe_u32 v8, v0, 5, 1
    v_lshl_add_u32 v7, v8, 3, v7
    ds_read_b64 v[16:17], v7 offset:8192
    ds_read_b64 v[18:19], v7 offset:8208
    ds_read_b64 v[20:21], v7 offset:9216
    ds_read_b64 v[22:23], v7 offset:9232
    ds_read_b64 v[24:25], v7 offset:10240
    ds_read_b64 v[26:27], v7 offset:10256
    ds_read_b64 v[28:29], v7 offset:11264
    ds_read_b64 v[30:31], v7 offset:11280
    s_waitcnt lgkmcnt(0)
    ds_read_b64 v[32:33], v7 offset:12288
    ds_read_b64 v[34:35], v7 offset:12304
    ds_read_b64 v[36:37], v7 offset:13312
    ds_read_b64 v[38:39], v7 offset:13328
    ds_read_b64 v[40:41], v7 offset:14336
    ds_read_b64 v[42:43], v7 offset:14352
    ds_read_b64 v[44:45], v7 offset:15360
    ds_read_b64 v[46:47], v7 offset:15376
    s_waitcnt lgkmcnt(0)
    v_add_f32 v16, v16, v20
    v_add_f32 v16, v16, v24
    v_add_f32 v16, v16, v28
    v_add_f32 v16, v16, v32
    v_add_f32 v16, v16, v36
    v_add_f32 v16, v16, v40
    v_add_f32 v16, v16, v44
    v_cvt_pk_bf16_f32 v5, v16, v16
    v_lshlrev_b32 v16, 16, v5
    v_add_f32 v17, v17, v21
    v_add_f32 v17, v17, v25
    v_add_f32 v17, v17, v29
    v_add_f32 v17, v17, v33
    v_add_f32 v17, v17, v37
    v_add_f32 v17, v17, v41
    v_add_f32 v17, v17, v45
    v_cvt_pk_bf16_f32 v5, v17, v17
    v_lshlrev_b32 v17, 16, v5
    v_add_f32 v18, v18, v22
    v_add_f32 v18, v18, v26
    v_add_f32 v18, v18, v30
    v_add_f32 v18, v18, v34
    v_add_f32 v18, v18, v38
    v_add_f32 v18, v18, v42
    v_add_f32 v18, v18, v46
    v_cvt_pk_bf16_f32 v5, v18, v18
    v_lshlrev_b32 v18, 16, v5
    v_add_f32 v19, v19, v23
    v_add_f32 v19, v19, v27
    v_add_f32 v19, v19, v31
    v_add_f32 v19, v19, v35
    v_add_f32 v19, v19, v39
    v_add_f32 v19, v19, v43
    v_add_f32 v19, v19, v47
    v_cvt_pk_bf16_f32 v5, v19, v19
    v_lshlrev_b32 v19, 16, v5
    v_mul_f32 v6, 0xbfb8aa3b, v16
    v_exp_f32 v6, v6
    s_nop 0
    v_add_f32 v6, 1.0, v6
    v_rcp_f32 v6, v6
    s_nop 0
    v_mul_f32 v16, v16, v6
    v_cvt_pk_bf16_f32 v5, v16, v16
    v_lshlrev_b32 v16, 16, v5
    v_mul_f32 v16, v16, v18
    v_mul_f32 v6, 0xbfb8aa3b, v17
    v_exp_f32 v6, v6
    s_nop 0
    v_add_f32 v6, 1.0, v6
    v_rcp_f32 v6, v6
    s_nop 0
    v_mul_f32 v17, v17, v6
    v_cvt_pk_bf16_f32 v5, v17, v17
    v_lshlrev_b32 v17, 16, v5
    v_mul_f32 v17, v17, v19
    v_cvt_pk_bf16_f32 v16, v16, v17
    v_mul_u32_u24 v8, 3584, v8
    v_lshl_add_u32 v7, v2, 2, v8
    v_mov_b32 v6, 0x40000000
    v_cmp_lt_u32 vcc, 27, v2
    s_nop 1
    v_cndmask_b32 v7, v7, v6, vcc
    v_cmp_lt_u32 vcc, 63, v0
    s_nop 1
    v_cndmask_b32 v7, v7, v6, vcc
    s_mul_i32 s37, s24, 8192
    s_add_u32 s37, s37, 0x1b0000
    s_add_u32 s36, s37, s23
    buffer_store_dword v16, v7, s[8:11], s36 offen sc1
    v_lshlrev_b32 v7, 4, v0
    v_add_u32 v8, 4096, v7
    v_cmp_lt_u32 vcc, 191, v0
    s_nop 1
    v_cndmask_b32 v8, v8, v6, vcc
L_M_act:
    buffer_load_dwordx4 v[20:23], v7, s[8:11], s37 offen sc1
    buffer_load_dwordx4 v[24:27], v8, s[8:11], s37 offen sc1
    s_add_u32 s32, s32, 1
    s_cmp_gt_u32 s32, 200000
    s_waitcnt vmcnt(0)
    v_max3_u32 v5, v20, v21, v22
    v_max3_u32 v5, v5, v23, v24
    v_max3_u32 v5, v5, v25, v26
    v_max_u32 v5, v5, v27
    s_cbranch_scc1 L_M_act_ok
    v_cmp_eq_u32 vcc, -1, v5
    s_cbranch_vccnz L_M_act
L_M_act_ok:
    ds_write_b128 v7, v[20:23] offset:16384
    ds_write_b128 v7, v[24:27] offset:20480
    s_waitcnt lgkmcnt(0)
    s_barrier
    v_lshrrev_b32 v7, 3, v0
    v_mul_u32_u24 v7, 112, v7
    v_mov_b64 v[48:49], 0
    v_mov_b64 v[50:51], 0
    ds_read_b128 v[16:19], v7 offset:16384
    ds_read_b128 v[20:23], v7 offset:16400
    ds_read_b128 v[24:27], v7 offset:16416
    ds_read_b128 v[28:31], v7 offset:16432
    ds_read_b128 v[32:35], v7 offset:16448
    ds_read_b128 v[36:39], v7 offset:16464
    ds_read_b128 v[40:43], v7 offset:16480
    s_waitcnt lgkmcnt(0)
    v_dot2_f32_bf16 v48, v16, v64, v48
    v_dot2_f32_bf16 v49, v16, v92, v49
    v_dot2_f32_bf16 v48, v17, v65, v48
    v_dot2_f32_bf16 v49, v17, v93, v49
    v_dot2_f32_bf16 v48, v18, v66, v48
    v_dot2_f32_bf16 v49, v18, v94, v49
    v_dot2_f32_bf16 v48, v19, v67, v48
    v_dot2_f32_bf16 v49, v19, v95, v49
    v_dot2_f32_bf16 v48, v20, v68, v48
    v_dot2_f32_bf16 v49, v20, v96, v49
    v_dot2_f32_bf16 v48, v21, v69, v48
    v_dot2_f32_bf16 v49, v21, v97, v49
    v_dot2_f32_bf16 v48, v22, v70, v48
    v_dot2_f32_bf16 v49, v22, v98, v49
    v_dot2_f32_bf16 v48, v23, v71, v48
    v_dot2_f32_bf16 v49, v23, v99, v49
    v_dot2_f32_bf16 v48, v24, v72, v48
    v_dot2_f32_bf16 v49, v24, v100, v49
    v_dot2_f32_bf16 v48, v25, v73, v48
    v_dot2_f32_bf16 v49, v25, v101, v49
    v_dot2_f32_bf16 v48, v26, v74, v48
    v_dot2_f32_bf16 v49, v26, v102, v49
    v_dot2_f32_bf16 v48, v27, v75, v48
    v_dot2_f32_bf16 v49, v27, v103, v49
    v_dot2_f32_bf16 v48, v28, v76, v48
    v_dot2_f32_bf16 v49, v28, v104, v49
    v_dot2_f32_bf16 v48, v29, v77, v48
    v_dot2_f32_bf16 v49, v29, v105, v49
    v_dot2_f32_bf16 v48, v30, v78, v48
    v_dot2_f32_bf16 v49, v30, v106, v49
    v_dot2_f32_bf16 v48, v31, v79, v48
    v_dot2_f32_bf16 v49, v31, v107, v49
    v_dot2_f32_bf16 v48, v32, v80, v48
    v_dot2_f32_bf16 v49, v32, v108, v49
    v_dot2_f32_bf16 v48, v33, v81, v48
    v_dot2_f32_bf16 v49, v33, v109, v49
    v_dot2_f32_bf16 v48, v34, v82, v48
    v_dot2_f32_bf16 v49, v34, v110, v49
    v_dot2_f32_bf16 v48, v35, v83, v48
    v_dot2_f32_bf16 v49, v35, v111, v49
    v_dot2_f32_bf16 v48, v36, v84, v48
    v_dot2_f32_bf16 v49, v36, v112, v49
    v_dot2_f32_bf16 v48, v37, v85, v48
    v_dot2_f32_bf16 v49, v37, v113, v49
    v_dot2_f32_bf16 v48, v38, v86, v48
    v_dot2_f32_bf16 v49, v38, v114, v49
    v_dot2_f32_bf16 v48, v39, v87, v48
    v_dot2_f32_bf16 v49, v39, v115, v49
    v_dot2_f32_bf16 v48, v40, v88, v48
    v_dot2_f32_bf16 v49, v40, v116, v49
    v_dot2_f32_bf16 v48, v41, v89, v48
    v_dot2_f32_bf16 v49, v41, v117, v49
    v_dot2_f32_bf16 v48, v42, v90, v48
    v_dot2_f32_bf16 v49, v42, v118, v49
    v_dot2_f32_bf16 v48, v43, v91, v48
    v_dot2_f32_bf16 v49, v43, v119, v49
    ds_read_b128 v[16:19], v7 offset:19968
    ds_read_b128 v[20:23], v7 offset:19984
    ds_read_b128 v[24:27], v7 offset:20000
    ds_read_b128 v[28:31], v7 offset:20016
    ds_read_b128 v[32:35], v7 offset:20032
    ds_read_b128 v[36:39], v7 offset:20048
    ds_read_b128 v[40:43], v7 offset:20064
    s_waitcnt lgkmcnt(0)
    v_dot2_f32_bf16 v50, v16, v64, v50
    v_dot2_f32_bf16 v51, v16, v92, v51
    v_dot2_f32_bf16 v50, v17, v65, v50
    v_dot2_f32_bf16 v51, v17, v93, v51
    v_dot2_f32_bf16 v50, v18, v66, v50
    v_dot2_f32_bf16 v51, v18, v94, v51
    v_dot2_f32_bf16 v50, v19, v67, v50
    v_dot2_f32_bf16 v51, v19, v95, v51
    v_dot2_f32_bf16 v50, v20, v68, v50
    v_dot2_f32_bf16 v51, v20, v96, v51
    v_dot2_f32_bf16 v50, v21, v69, v50
    v_dot2_f32_bf16 v51, v21, v97, v51
    v_dot2_f32_bf16 v50, v22, v70, v50
    v_dot2_f32_bf16 v51, v22, v98, v51
    v_dot2_f32_bf16 v50, v23, v71, v50
    v_dot2_f32_bf16 v51, v23, v99, v51
    v_dot2_f32_bf16 v50, v24, v72, v50
    v_dot2_f32_bf16 v51, v24, v100, v51
    v_dot2_f32_bf16 v50, v25, v73, v50
    v_dot2_f32_bf16 v51, v25, v101, v51
    v_dot2_f32_bf16 v50, v26, v74, v50
    v_dot2_f32_bf16 v51, v26, v102, v51
    v_dot2_f32_bf16 v50, v27, v75, v50
    v_dot2_f32_bf16 v51, v27, v103, v51
    v_dot2_f32_bf16 v50, v28, v76, v50
    v_dot2_f32_bf16 v51, v28, v104, v51
    v_dot2_f32_bf16 v50, v29, v77, v50
    v_dot2_f32_bf16 v51, v29, v105, v51
    v_dot2_f32_bf16 v50, v30, v78, v50
    v_dot2_f32_bf16 v51, v30, v106, v51
    v_dot2_f32_bf16 v50, v31, v79, v50
    v_dot2_f32_bf16 v51, v31, v107, v51
    v_dot2_f32_bf16 v50, v32, v80, v50
    v_dot2_f32_bf16 v51, v32, v108, v51
    v_dot2_f32_bf16 v50, v33, v81, v50
    v_dot2_f32_bf16 v51, v33, v109, v51
    v_dot2_f32_bf16 v50, v34, v82, v50
    v_dot2_f32_bf16 v51, v34, v110, v51
    v_dot2_f32_bf16 v50, v35, v83, v50
    v_dot2_f32_bf16 v51, v35, v111, v51
    v_dot2_f32_bf16 v50, v36, v84, v50
    v_dot2_f32_bf16 v51, v36, v112, v51
    v_dot2_f32_bf16 v50, v37, v85, v50
    v_dot2_f32_bf16 v51, v37, v113, v51
    v_dot2_f32_bf16 v50, v38, v86, v50
    v_dot2_f32_bf16 v51, v38, v114, v51
    v_dot2_f32_bf16 v50, v39, v87, v50
    v_dot2_f32_bf16 v51, v39, v115, v51
    v_dot2_f32_bf16 v50, v40, v88, v50
    v_dot2_f32_bf16 v51, v40, v116, v51
    v_dot2_f32_bf16 v50, v41, v89, v50
    v_dot2_f32_bf16 v51, v41, v117, v51
    v_dot2_f32_bf16 v50, v42, v90, v50
    v_dot2_f32_bf16 v51, v42, v118, v51
    v_dot2_f32_bf16 v50, v43, v91, v50
    v_dot2_f32_bf16 v51, v43, v119, v51
    s_nop 3
    v_add_f32_dpp v48, v48, v48 row_ror:8 row_mask:0xf bank_mask:0xf
    v_add_f32_dpp v49, v49, v49 row_ror:8 row_mask:0xf bank_mask:0xf
    v_add_f32_dpp v50, v50, v50 row_ror:8 row_mask:0xf bank_mask:0xf
    v_add_f32_dpp v51, v51, v51 row_ror:8 row_mask:0xf bank_mask:0xf
    v_mov_b32 v5, v48
    s_nop 1
    v_permlane16_swap_b32 v48, v5
    v_add_f32 v48, v48, v5
    v_mov_b32 v5, v49
    s_nop 1
    v_permlane16_swap_b32 v49, v5
    v_add_f32 v49, v49, v5
    v_mov_b32 v5, v50
    s_nop 1
    v_permlane16_swap_b32 v50, v5
    v_add_f32 v50, v50, v5
    v_mov_b32 v5, v51
    s_nop 1
    v_permlane16_swap_b32 v51, v5
    v_add_f32 v51, v51, v5
    v_mov_b32 v5, v48
    s_nop 1
    v_permlane32_swap_b32 v48, v5
    v_add_f32 v48, v48, v5
    v_mov_b32 v5, v49
    s_nop 1
    v_permlane32_swap_b32 v49, v5
    v_add_f32 v49, v49, v5
    v_mov_b32 v5, v50
    s_nop 1
    v_permlane32_swap_b32 v50, v5
    v_add_f32 v50, v50, v5
    v_mov_b32 v5, v51
    s_nop 1
    v_permlane32_swap_b32 v51, v5
    v_add_f32 v51, v51, v5
    v_lshrrev_b32 v7, 6, v0
    v_lshlrev_b32 v7, 7, v7
    v_lshl_add_u32 v7, v3, 4, v7
    ds_write_b128 v7, v[48:51] offset:1024
    s_waitcnt lgkmcnt(0)
    s_barrier
    v_lshlrev_b32 v7, 4, v3
    v_lshl_add_u32 v7, v9, 3, v7
    ds_read_b64 v[16:17], v7 offset:1024
    ds_read_b64 v[18:19], v7 offset:1152
    ds_read_b64 v[20:21], v7 offset:1280
    ds_read_b64 v[22:23], v7 offset:1408
    v_mul_f32 v10, 0xbfb8aa3b, v11
    v_exp_f32 v10, v10
    s_nop 0
    v_add_f32 v10, 1.0, v10
    v_rcp_f32 v10, v10
    s_nop 0
    v_cvt_pk_bf16_f32 v5, v10, v10
    v_lshlrev_b32 v10, 16, v5
    s_waitcnt lgkmcnt(0)
    v_lshlrev_b32 v24, 16, v15
    v_and_b32 v25, 0xffff0000, v15
    v_lshlrev_b32 v26, 16, v14
    v_and_b32 v27, 0xffff0000, v14
    v_add_f32 v16, v16, v18
    v_add_f32 v20, v20, v22
    v_add_f32 v16, v16, v20
    v_cvt_pk_bf16_f32 v5, v16, v16
    v_lshlrev_b32 v16, 16, v5
    v_mul_f32 v16, v16, v10
    v_cvt_pk_bf16_f32 v5, v16, v16
    v_lshlrev_b32 v16, 16, v5
    v_add_f32 v16, v16, v24
    v_cvt_pk_bf16_f32 v5, v16, v16
    v_lshlrev_b32 v16, 16, v5
    v_add_f32 v16, v16, v26
    v_add_f32 v17, v17, v19
    v_add_f32 v21, v21, v23
    v_add_f32 v17, v17, v21
    v_cvt_pk_bf16_f32 v5, v17, v17
    v_lshlrev_b32 v17, 16, v5
    v_mul_f32 v17, v17, v10
    v_cvt_pk_bf16_f32 v5, v17, v17
    v_lshlrev_b32 v17, 16, v5
    v_add_f32 v17, v17, v25
    v_cvt_pk_bf16_f32 v5, v17, v17
    v_lshlrev_b32 v17, 16, v5
    v_add_f32 v17, v17, v27
    v_cvt_pk_bf16_f32 v16, v16, v17
    buffer_store_dword v16, v12, s[60:63], 0 offen sc1
    v_add_f32 v24, v24, v26
    v_add_f32 v25, v25, v27
    v_cvt_pk_bf16_f32 v13, v24, v25
L_M_next:
    s_add_u32 s24, s24, 1
    s_mov_b32 s25, 192
    s_cmp_eq_u32 s24, 1
    s_cbranch_scc1 L_M_round
    s_cmp_eq_u32 s24, 3
    s_cbranch_scc1 L_end
    s_mov_b32 s25, 256
    v_and_b32 v7, 63, v0
    v_lshlrev_b32 v3, 4, v7
    s_mov_b32 s36, 0x19bc00
    v_sub_u32 v7, 63, v7
L_M_fin:
    buffer_load_dwordx4 v[16:19], v3, s[8:11], s36 offen sc1
    s_add_u32 s32, s32, 1
    s_cmp_gt_u32 s32, 200000
    s_cselect_b32 s37, -1, -2
    s_waitcnt vmcnt(0)
    v_max3_u32 v5, v16, v17, v18
    v_max_u32 v5, v5, v19
    v_cmp_lt_u32 vcc, s37, v5
    s_cbranch_vccnz L_M_fin
    v_add_f32 v16, v16, v17
    v_add_f32 v18, v18, v19
    v_add_f32 v16, v16, v18
    v_cvt_pk_bf16_f32 v5, v16, v16
    v_lshlrev_b32 v16, 16, v5
    v_ashrrev_i32 v5, 31, v16
    v_or_b32 v5, 0x80000000, v5
    v_xor_b32 v5, v5, v16
    v_and_or_b32 v5, v5, s42, v7
    v_cmp_lt_u32 vcc, s29, v5
    s_cbranch_vccnz L_M_round
L_end:
    s_endpgm
.section .rodata,"a"
.p2align 6
.amdhsa_kernel sequential_preLN__memory_aug_recurrent_mem_tr__moe_arch_mod__prompt_kernel
  .amdhsa_next_free_vgpr 512
  .amdhsa_next_free_sgpr 102
  .amdhsa_accum_offset 256
  .amdhsa_group_segment_fixed_size 0
  .amdhsa_kernarg_size 120
  .amdhsa_user_sgpr_count 2
  .amdhsa_user_sgpr_kernarg_segment_ptr 1
  .amdhsa_system_sgpr_workgroup_id_x 1
.end_amdhsa_kernel
```

```asm
; @launch grid=(256,1,1) block=(256,1,1) lds=163840
.amdgcn_target "amdgcn-amd-amdhsa--gfx950"
.text
.globl sequential_preLN__memory_aug_recurrent_mem_tr__moe_arch_mod__prompt_kernel
.p2align 8
.type sequential_preLN__memory_aug_recurrent_mem_tr__moe_arch_mod__prompt_kernel,@function
sequential_preLN__memory_aug_recurrent_mem_tr__moe_arch_mod__prompt_kernel:
    s_cmp_ge_u32 s2, 256
    s_cbranch_scc1 L_end
    s_load_dwordx8 s[44:51], s[0:1], 0
    s_load_dwordx4 s[52:55], s[0:1], 32
    s_load_dwordx4 s[56:59], s[0:1], 104
    s_load_dwordx2 s[80:81], s[0:1], 64
    s_load_dwordx2 s[82:83], s[0:1], 96
    s_load_dwordx4 s[84:87], s[0:1], 72
    s_load_dwordx2 s[88:89], s[0:1], 88
    v_lshrrev_b32 v1, 6, v0
    s_nop 0
    v_readfirstlane_b32 s21, v1
    s_waitcnt lgkmcnt(0)
    s_mov_b32 s8, s58
    s_and_b32 s9, s59, 0xffff
    s_mov_b32 s10, 0x10000000
    s_mov_b32 s11, 0x20000
    s_mov_b32 s16, s56
    s_and_b32 s17, s57, 0xffff
    s_mov_b32 s18, 0x100
    s_mov_b32 s19, 0x20000
    s_and_b32 s3, s2, 7
    s_cmp_lg_u32 s3, 0
    s_cbranch_scc1 L_worker
    s_lshr_b32 s20, s2, 3
    v_lshrrev_b32 v28, 6, v0
    v_bfe_u32 v29, v0, 4, 2
    v_lshl_add_u32 v28, v28, 5, v29
    v_and_b32 v16, 15, v0
    v_lshlrev_b32 v16, 4, v16
    v_lshl_add_u32 v16, v28, 13, v16
    v_bfe_u32 v29, v0, 4, 1
    v_lshlrev_b32 v29, 5, v29
    v_xor_b32 v16, v16, v29
    v_xor_b32 v17, 64, v16
    v_xor_b32 v18, 128, v16
    v_xor_b32 v19, 192, v16
    s_add_u32 s28, s21, 1
    s_lshl_b32 s28, s28, 15
    s_lshl_b32 s3, s20, 8
    s_mov_b32 s60, s52
    s_and_b32 s61, s53, 0xffff
    s_mov_b32 s62, 0x400000
    s_mov_b32 s63, 0x20000
    s_add_u32 m0, s28, 0
    s_add_u32 s37, s3, 0x0
    buffer_load_dwordx4 v16, s[60:63], s37 offen lds
    s_add_u32 m0, s28, 1024
    s_add_u32 s37, s3, 0x8000
    buffer_load_dwordx4 v17, s[60:63], s37 offen lds
    s_add_u32 m0, s28, 2048
    s_add_u32 s37, s3, 0x10000
    buffer_load_dwordx4 v18, s[60:63], s37 offen lds
    s_add_u32 m0, s28, 3072
    s_add_u32 s37, s3, 0x18000
    buffer_load_dwordx4 v19, s[60:63], s37 offen lds
    s_add_u32 m0, s28, 4096
    s_add_u32 s37, s3, 0x20000
    buffer_load_dwordx4 v16, s[60:63], s37 offen lds
    s_add_u32 m0, s28, 5120
    s_add_u32 s37, s3, 0x28000
    buffer_load_dwordx4 v17, s[60:63], s37 offen lds
    s_add_u32 m0, s28, 6144
    s_add_u32 s37, s3, 0x30000
    buffer_load_dwordx4 v18, s[60:63], s37 offen lds
    s_add_u32 m0, s28, 7168
    s_add_u32 s37, s3, 0x38000
    buffer_load_dwordx4 v19, s[60:63], s37 offen lds
    s_add_u32 m0, s28, 8192
    s_add_u32 s37, s3, 0x100000
    buffer_load_dwordx4 v16, s[60:63], s37 offen lds
    s_add_u32 m0, s28, 9216
    s_add_u32 s37, s3, 0x108000
    buffer_load_dwordx4 v17, s[60:63], s37 offen lds
    s_add_u32 m0, s28, 10240
    s_add_u32 s37, s3, 0x110000
    buffer_load_dwordx4 v18, s[60:63], s37 offen lds
    s_add_u32 m0, s28, 11264
    s_add_u32 s37, s3, 0x118000
    buffer_load_dwordx4 v19, s[60:63], s37 offen lds
    s_add_u32 m0, s28, 12288
    s_add_u32 s37, s3, 0x120000
    buffer_load_dwordx4 v16, s[60:63], s37 offen lds
    s_add_u32 m0, s28, 13312
    s_add_u32 s37, s3, 0x128000
    buffer_load_dwordx4 v17, s[60:63], s37 offen lds
    s_add_u32 m0, s28, 14336
    s_add_u32 s37, s3, 0x130000
    buffer_load_dwordx4 v18, s[60:63], s37 offen lds
    s_add_u32 m0, s28, 15360
    s_add_u32 s37, s3, 0x138000
    buffer_load_dwordx4 v19, s[60:63], s37 offen lds
    s_add_u32 m0, s28, 16384
    s_add_u32 s37, s3, 0x200000
    buffer_load_dwordx4 v16, s[60:63], s37 offen lds
    s_add_u32 m0, s28, 17408
    s_add_u32 s37, s3, 0x208000
    buffer_load_dwordx4 v17, s[60:63], s37 offen lds
    s_add_u32 m0, s28, 18432
    s_add_u32 s37, s3, 0x210000
    buffer_load_dwordx4 v18, s[60:63], s37 offen lds
    s_add_u32 m0, s28, 19456
    s_add_u32 s37, s3, 0x218000
    buffer_load_dwordx4 v19, s[60:63], s37 offen lds
    s_add_u32 m0, s28, 20480
    s_add_u32 s37, s3, 0x220000
    buffer_load_dwordx4 v16, s[60:63], s37 offen lds
    s_add_u32 m0, s28, 21504
    s_add_u32 s37, s3, 0x228000
    buffer_load_dwordx4 v17, s[60:63], s37 offen lds
    s_add_u32 m0, s28, 22528
    s_add_u32 s37, s3, 0x230000
    buffer_load_dwordx4 v18, s[60:63], s37 offen lds
    s_add_u32 m0, s28, 23552
    s_add_u32 s37, s3, 0x238000
    buffer_load_dwordx4 v19, s[60:63], s37 offen lds
    v_mov_b32 v20, 0x0
    v_bfe_u32 v14, v0, 0, 1
    s_mov_b32 s38, 0x8
    v_mad_u32_u24 v20, v14, s38, v20
    v_bfe_u32 v14, v0, 1, 1
    s_mov_b32 s38, 0x10
    v_mad_u32_u24 v20, v14, s38, v20
    v_bfe_u32 v14, v0, 2, 1
    s_mov_b32 s38, 0x100
    v_mad_u32_u24 v20, v14, s38, v20
    v_bfe_u32 v14, v0, 3, 1
    s_mov_b32 s38, 0x800
    v_mad_u32_u24 v20, v14, s38, v20
    v_bfe_u32 v14, v0, 4, 1
    s_mov_b32 s38, 0x400
    v_mad_u32_u24 v20, v14, s38, v20
    v_bfe_u32 v14, v0, 5, 1
    s_mov_b32 s38, 0x1000
    v_mad_u32_u24 v20, v14, s38, v20
    v_mov_b32 v28, 0x0
    v_bfe_u32 v14, v0, 2, 1
    s_mov_b32 s38, 0x20
    v_mad_u32_u24 v28, v14, s38, v28
    v_bfe_u32 v14, v0, 3, 1
    s_mov_b32 s38, 0x80
    v_mad_u32_u24 v28, v14, s38, v28
    v_bfe_u32 v14, v0, 4, 1
    s_mov_b32 s38, 0x40
    v_mad_u32_u24 v28, v14, s38, v28
    v_mov_b32 v29, 0x0
    v_bfe_u32 v14, v0, 6, 1
    s_mov_b32 s38, 0x40
    v_mad_u32_u24 v29, v14, s38, v29
    v_bfe_u32 v14, v0, 7, 1
    s_mov_b32 s38, 0x80
    v_mad_u32_u24 v29, v14, s38, v29
    v_xor_b32 v28, v28, v29
    v_add_u32 v28, v28, v20
    s_xor_b32 s36, s21, 0
    s_add_u32 s36, s36, 1
    s_lshl_b32 s36, s36, 15
    v_add_u32 v20, s36, v28
    v_xor_b32 v21, 32, v20
    s_xor_b32 s36, s21, 1
    s_add_u32 s36, s36, 1
    s_lshl_b32 s36, s36, 15
    v_add_u32 v22, s36, v28
    v_xor_b32 v23, 32, v22
    s_xor_b32 s36, s21, 2
    s_add_u32 s36, s36, 1
    s_lshl_b32 s36, s36, 15
    v_add_u32 v24, s36, v28
    v_xor_b32 v25, 32, v24
    s_xor_b32 s36, s21, 3
    s_add_u32 s36, s36, 1
    s_lshl_b32 s36, s36, 15
    v_add_u32 v26, s36, v28
    v_xor_b32 v27, 32, v26
    v_mov_b32 v11, 0x0
    v_bfe_u32 v14, v0, 0, 1
    s_mov_b32 s38, 0x4
    v_mad_u32_u24 v11, v14, s38, v11
    v_bfe_u32 v14, v0, 1, 1
    s_mov_b32 s38, 0x8
    v_mad_u32_u24 v11, v14, s38, v11
    v_bfe_u32 v14, v0, 2, 1
    s_mov_b32 s38, 0x10
    v_mad_u32_u24 v11, v14, s38, v11
    v_bfe_u32 v14, v0, 3, 1
    s_mov_b32 s38, 0x20
    v_mad_u32_u24 v11, v14, s38, v11
    v_bfe_u32 v14, v0, 4, 1
    s_mov_b32 s38, 0x800
    v_mad_u32_u24 v11, v14, s38, v11
    v_bfe_u32 v14, v0, 5, 1
    s_mov_b32 s38, 0x1000
    v_mad_u32_u24 v11, v14, s38, v11
    v_bfe_u32 v14, v0, 6, 1
    s_mov_b32 s38, 0x100
    v_mad_u32_u24 v11, v14, s38, v11
    v_bfe_u32 v14, v0, 7, 1
    s_mov_b32 s38, 0x200
    v_mad_u32_u24 v11, v14, s38, v11
    s_mov_b32 s92, s54
    s_and_b32 s93, s55, 0xffff
    s_mov_b32 s94, 0x400000
    s_mov_b32 s95, 0x20000
    s_lshl_b32 s29, s20, 17
    s_xor_b32 s36, s21, 3
    s_lshl_b32 s36, s36, 15
    s_add_u32 s36, s36, s29
    s_add_u32 s37, s36, 0x80
    buffer_load_dword v32, v11, s[92:95], s37 offen
    s_add_u32 s37, s36, 0x4080
    buffer_load_dword v33, v11, s[92:95], s37 offen
    s_add_u32 s37, s36, 0x480
    buffer_load_dword v34, v11, s[92:95], s37 offen
    s_add_u32 s37, s36, 0x4480
    buffer_load_dword v35, v11, s[92:95], s37 offen
    s_add_u32 s37, s36, 0x2080
    buffer_load_dword v36, v11, s[92:95], s37 offen
    s_add_u32 s37, s36, 0x6080
    buffer_load_dword v37, v11, s[92:95], s37 offen
    s_add_u32 s37, s36, 0x2480
    buffer_load_dword v38, v11, s[92:95], s37 offen
    s_add_u32 s37, s36, 0x6480
    buffer_load_dword v39, v11, s[92:95], s37 offen
    s_add_u32 s37, s36, 0xc0
    buffer_load_dword v40, v11, s[92:95], s37 offen
    s_add_u32 s37, s36, 0x40c0
    buffer_load_dword v41, v11, s[92:95], s37 offen
    s_add_u32 s37, s36, 0x4c0
    buffer_load_dword v42, v11, s[92:95], s37 offen
    s_add_u32 s37, s36, 0x44c0
    buffer_load_dword v43, v11, s[92:95], s37 offen
    s_add_u32 s37, s36, 0x20c0
    buffer_load_dword v44, v11, s[92:95], s37 offen
    s_add_u32 s37, s36, 0x60c0
    buffer_load_dword v45, v11, s[92:95], s37 offen
    s_add_u32 s37, s36, 0x24c0
    buffer_load_dword v46, v11, s[92:95], s37 offen
    s_add_u32 s37, s36, 0x64c0
    buffer_load_dword v47, v11, s[92:95], s37 offen
    s_getreg_b32 s36, hwreg(HW_REG_XCC_ID)
    s_and_b32 s36, s36, 15
    s_or_b32 s36, s36, 0x100
    v_mov_b32 v30, s36
    s_lshl_b32 s37, s20, 2
    v_lshlrev_b32 v31, 20, v0
    buffer_store_dword v30, v31, s[16:19], s37 offen offset:128 sc1
    s_mov_b32 s12, s46
    s_and_b32 s13, s47, 0xffff
    s_mov_b32 s14, 0x2000
    s_mov_b32 s15, 0x20000
    v_mov_b32 v104, 0x0
    v_bfe_u32 v14, v0, 0, 1
    s_mov_b32 s38, 0x8
    v_mad_u32_u24 v104, v14, s38, v104
    v_bfe_u32 v14, v0, 1, 1
    s_mov_b32 s38, 0x10
    v_mad_u32_u24 v104, v14, s38, v104
    v_bfe_u32 v14, v0, 2, 1
    s_mov_b32 s38, 0x10000
    v_mad_u32_u24 v104, v14, s38, v104
    v_bfe_u32 v14, v0, 3, 1
    s_mov_b32 s38, 0x10000
    v_mad_u32_u24 v104, v14, s38, v104
    v_bfe_u32 v14, v0, 4, 1
    s_mov_b32 s38, 0x400
    v_mad_u32_u24 v104, v14, s38, v104
    v_bfe_u32 v14, v0, 5, 1
    s_mov_b32 s38, 0x4
    v_mad_u32_u24 v104, v14, s38, v104
    v_bfe_u32 v14, v0, 6, 1
    s_mov_b32 s38, 0x40
    v_mad_u32_u24 v104, v14, s38, v104
    v_bfe_u32 v14, v0, 7, 1
    s_mov_b32 s38, 0x80
    v_mad_u32_u24 v104, v14, s38, v104
    v_mov_b32 v106, s20
    v_mov_b32 v105, 0x0
    v_bfe_u32 v14, v106, 0, 1
    s_mov_b32 s38, 0x20
    v_mad_u32_u24 v105, v14, s38, v105
    v_bfe_u32 v14, v106, 1, 1
    s_mov_b32 s38, 0x800
    v_mad_u32_u24 v105, v14, s38, v105
    v_bfe_u32 v14, v106, 2, 1
    s_mov_b32 s38, 0x1000
    v_mad_u32_u24 v105, v14, s38, v105
    v_bfe_u32 v14, v106, 3, 1
    s_mov_b32 s38, 0x100
    v_mad_u32_u24 v105, v14, s38, v105
    v_bfe_u32 v14, v106, 4, 1
    s_mov_b32 s38, 0x200
    v_mad_u32_u24 v105, v14, s38, v105
    v_add_u32 v104, v104, v105
    buffer_load_dword v12, v104, s[12:15], 0 offen
    v_and_b32 v104, 63, v0
    s_mov_b32 s36, 0x82100
    v_mul_lo_u32 v104, v104, s36
    s_mov_b32 s36, 0x1082080
    buffer_load_dword v126, v104, s[8:11], s36 offen
    s_mov_b32 s36, 0xf0000
    buffer_load_dword v127, off, s[8:11], s36
    v_mov_b32 v1, 0x4444
    v_bfe_u32 v14, v0, 1, 1
    s_mov_b32 s38, 0xaaaa
    v_mad_u32_u24 v1, v14, s38, v1
    v_mov_b32 v3, 0x0
    v_bfe_u32 v14, v0, 0, 1
    s_mov_b32 s38, 0x10
    v_mad_u32_u24 v3, v14, s38, v3
    v_bfe_u32 v14, v0, 1, 1
    s_mov_b32 s38, 0x20
    v_mad_u32_u24 v3, v14, s38, v3
    v_bfe_u32 v14, v0, 2, 1
    s_mov_b32 s38, 0x40
    v_mad_u32_u24 v3, v14, s38, v3
    v_bfe_u32 v14, v0, 3, 1
    s_mov_b32 s38, 0x80
    v_mad_u32_u24 v3, v14, s38, v3
    v_bfe_u32 v14, v0, 4, 1
    s_mov_b32 s38, 0x100
    v_mad_u32_u24 v3, v14, s38, v3
    v_bfe_u32 v14, v0, 5, 1
    s_mov_b32 s38, 0x200
    v_mad_u32_u24 v3, v14, s38, v3
    v_mov_b32 v2, 0x0
    v_bfe_u32 v14, v0, 0, 1
    s_mov_b32 s38, 0x10
    v_mad_u32_u24 v2, v14, s38, v2
    v_bfe_u32 v14, v0, 1, 1
    s_mov_b32 s38, 0x20
    v_mad_u32_u24 v2, v14, s38, v2
    v_bfe_u32 v14, v0, 2, 1
    s_mov_b32 s38, 0x40
    v_mad_u32_u24 v2, v14, s38, v2
    v_bfe_u32 v14, v0, 3, 1
    s_mov_b32 s38, 0x80
    v_mad_u32_u24 v2, v14, s38, v2
    v_bfe_u32 v14, v0, 4, 1
    s_mov_b32 s38, 0x100
    v_mad_u32_u24 v2, v14, s38, v2
    v_bfe_u32 v14, v0, 5, 1
    s_mov_b32 s38, 0x200
    v_mad_u32_u24 v2, v14, s38, v2
    v_bfe_u32 v14, v0, 6, 1
    s_mov_b32 s38, 0x800
    v_mad_u32_u24 v2, v14, s38, v2
    v_bfe_u32 v14, v0, 7, 1
    s_mov_b32 s38, 0x1000
    v_mad_u32_u24 v2, v14, s38, v2
    v_mov_b32 v4, 0x8000
    v_bfe_u32 v14, v0, 0, 1
    s_mov_b32 s38, 0x10
    v_mad_u32_u24 v4, v14, s38, v4
    v_bfe_u32 v14, v0, 1, 1
    s_mov_b32 s38, 0x20
    v_mad_u32_u24 v4, v14, s38, v4
    v_bfe_u32 v14, v0, 2, 1
    s_mov_b32 s38, 0x40
    v_mad_u32_u24 v4, v14, s38, v4
    v_bfe_u32 v14, v0, 3, 1
    s_mov_b32 s38, 0x80
    v_mad_u32_u24 v4, v14, s38, v4
    v_bfe_u32 v14, v0, 4, 1
    s_mov_b32 s38, 0x100
    v_mad_u32_u24 v4, v14, s38, v4
    v_bfe_u32 v14, v0, 5, 1
    s_mov_b32 s38, 0x200
    v_mad_u32_u24 v4, v14, s38, v4
    v_bfe_u32 v14, v0, 6, 1
    s_mov_b32 s38, 0x8000
    v_mad_u32_u24 v4, v14, s38, v4
    v_bfe_u32 v14, v0, 7, 1
    s_mov_b32 s38, 0x10000
    v_mad_u32_u24 v4, v14, s38, v4
    v_mov_b32 v5, 0x4000
    v_bfe_u32 v14, v0, 0, 1
    s_mov_b32 s38, 0x4
    v_mad_u32_u24 v5, v14, s38, v5
    v_bfe_u32 v14, v0, 1, 1
    s_mov_b32 s38, 0x8
    v_mad_u32_u24 v5, v14, s38, v5
    v_bfe_u32 v14, v0, 2, 1
    s_mov_b32 s38, 0x10
    v_mad_u32_u24 v5, v14, s38, v5
    v_bfe_u32 v14, v0, 3, 1
    s_mov_b32 s38, 0x20
    v_mad_u32_u24 v5, v14, s38, v5
    v_bfe_u32 v14, v0, 4, 1
    s_mov_b32 s38, 0x240
    v_mad_u32_u24 v5, v14, s38, v5
    v_bfe_u32 v14, v0, 5, 1
    s_mov_b32 s38, 0x480
    v_mad_u32_u24 v5, v14, s38, v5
    v_bfe_u32 v14, v0, 6, 1
    s_mov_b32 s38, 0x40
    v_mad_u32_u24 v5, v14, s38, v5
    v_bfe_u32 v14, v0, 7, 1
    s_mov_b32 s38, 0x80
    v_mad_u32_u24 v5, v14, s38, v5
    v_mov_b32 v6, 0x4000
    v_bfe_u32 v14, v0, 0, 1
    s_mov_b32 s38, 0x120
    v_mad_u32_u24 v6, v14, s38, v6
    v_bfe_u32 v14, v0, 2, 1
    s_mov_b32 s38, 0x240
    v_mad_u32_u24 v6, v14, s38, v6
    v_bfe_u32 v14, v0, 3, 1
    s_mov_b32 s38, 0x480
    v_mad_u32_u24 v6, v14, s38, v6
    v_bfe_u32 v14, v0, 4, 1
    s_mov_b32 s38, 0x10
    v_mad_u32_u24 v6, v14, s38, v6
    v_bfe_u32 v14, v0, 5, 1
    s_mov_b32 s38, 0x20
    v_mad_u32_u24 v6, v14, s38, v6
    v_add_u32 v7, 2304, v5
    v_xor_b32 v8, 0x1000, v2
    v_mov_b32 v104, 0x0
    v_bfe_u32 v14, v0, 3, 1
    s_mov_b32 s38, 0x1
    v_mad_u32_u24 v104, v14, s38, v104
    v_bfe_u32 v14, v0, 4, 1
    s_mov_b32 s38, 0x2
    v_mad_u32_u24 v104, v14, s38, v104
    v_bfe_u32 v14, v0, 5, 1
    s_mov_b32 s38, 0x4
    v_mad_u32_u24 v104, v14, s38, v104
    v_bfe_u32 v14, v0, 6, 1
    s_mov_b32 s38, 0x8
    v_mad_u32_u24 v104, v14, s38, v104
    v_bfe_u32 v14, v0, 7, 1
    s_mov_b32 s38, 0x10
    v_mad_u32_u24 v104, v14, s38, v104
    v_add_u32 v104, s20, v104
    v_and_b32 v104, 31, v104
    v_lshlrev_b32 v104, 6, v104
    v_mov_b32 v9, 0x0
    v_bfe_u32 v14, v0, 0, 1
    s_mov_b32 s38, 0x8
    v_mad_u32_u24 v9, v14, s38, v9
    v_bfe_u32 v14, v0, 1, 1
    s_mov_b32 s38, 0x10
    v_mad_u32_u24 v9, v14, s38, v9
    v_bfe_u32 v14, v0, 2, 1
    s_mov_b32 s38, 0x20
    v_mad_u32_u24 v9, v14, s38, v9
    v_bfe_u32 v14, v0, 3, 1
    s_mov_b32 s38, 0x2000
    v_mad_u32_u24 v9, v14, s38, v9
    v_bfe_u32 v14, v0, 4, 1
    s_mov_b32 s38, 0x4000
    v_mad_u32_u24 v9, v14, s38, v9
    v_bfe_u32 v14, v0, 5, 1
    s_mov_b32 s38, 0x8000
    v_mad_u32_u24 v9, v14, s38, v9
    v_bfe_u32 v14, v0, 6, 1
    s_mov_b32 s38, 0x10000
    v_mad_u32_u24 v9, v14, s38, v9
    v_bfe_u32 v14, v0, 7, 1
    s_mov_b32 s38, 0x20000
    v_mad_u32_u24 v9, v14, s38, v9
    v_add_u32 v9, v9, v104
    v_mov_b32 v10, 0x80000
    v_bfe_u32 v14, v0, 0, 1
    s_mov_b32 s38, 0x8
    v_mad_u32_u24 v10, v14, s38, v10
    v_bfe_u32 v14, v0, 1, 1
    s_mov_b32 s38, 0x20
    v_mad_u32_u24 v10, v14, s38, v10
    v_bfe_u32 v14, v0, 4, 1
    s_mov_b32 s38, 0x10
    v_mad_u32_u24 v10, v14, s38, v10
    v_bfe_u32 v14, v0, 5, 1
    s_mov_b32 s38, 0x4
    v_mad_u32_u24 v10, v14, s38, v10
    v_bfe_u32 v14, v0, 6, 1
    s_mov_b32 s38, 0x800
    v_mad_u32_u24 v10, v14, s38, v10
    v_bfe_u32 v14, v0, 7, 1
    s_mov_b32 s38, 0x1000
    v_mad_u32_u24 v10, v14, s38, v10
    v_mov_b32 v105, s20
    v_mov_b32 v104, 0x0
    v_bfe_u32 v14, v105, 0, 1
    s_mov_b32 s38, 0x100
    v_mad_u32_u24 v104, v14, s38, v104
    v_bfe_u32 v14, v105, 1, 1
    s_mov_b32 s38, 0x40
    v_mad_u32_u24 v104, v14, s38, v104
    v_bfe_u32 v14, v105, 2, 1
    s_mov_b32 s38, 0x80
    v_mad_u32_u24 v104, v14, s38, v104
    v_bfe_u32 v14, v105, 3, 1
    s_mov_b32 s38, 0x200
    v_mad_u32_u24 v104, v14, s38, v104
    v_bfe_u32 v14, v105, 4, 1
    s_mov_b32 s38, 0x400
    v_mad_u32_u24 v104, v14, s38, v104
    v_add_u32 v10, v104, v10
    v_and_b32 v104, 12, v0
    v_cmp_ne_u32 vcc, 0, v104
    v_mov_b32 v104, 0x40000000
    s_nop 0
    v_cndmask_b32 v10, v10, v104, vcc
    v_mov_b32 v13, 0x0
    v_bfe_u32 v14, v0, 0, 1
    s_mov_b32 s38, 0x10
    v_mad_u32_u24 v13, v14, s38, v13
    v_bfe_u32 v14, v0, 1, 1
    s_mov_b32 s38, 0x8
    v_mad_u32_u24 v13, v14, s38, v13
    v_bfe_u32 v14, v0, 2, 1
    s_mov_b32 s38, 0x20
    v_mad_u32_u24 v13, v14, s38, v13
    v_bfe_u32 v14, v0, 3, 1
    s_mov_b32 s38, 0x40
    v_mad_u32_u24 v13, v14, s38, v13
    v_bfe_u32 v14, v0, 4, 1
    s_mov_b32 s38, 0x80
    v_mad_u32_u24 v13, v14, s38, v13
    v_bfe_u32 v14, v0, 5, 1
    s_mov_b32 s38, 0x100
    v_mad_u32_u24 v13, v14, s38, v13
    v_bfe_u32 v14, v0, 6, 1
    s_mov_b32 s38, 0x800
    v_mad_u32_u24 v13, v14, s38, v13
    v_bfe_u32 v14, v0, 7, 1
    s_mov_b32 s38, 0x1000
    v_mad_u32_u24 v13, v14, s38, v13
    s_lshl_b32 s6, s20, 13
    s_add_u32 s6, s6, 0x0
    s_mov_b32 s26, 4096
    v_and_b32 v104, 15, v0
    v_mov_b32 v100, 0
    v_mov_b32 v105, 0x3f80
    v_cmp_eq_u32 vcc, 0, v104
    s_nop 1
    v_cndmask_b32 v100, v100, v105, vcc
    v_mov_b32 v105, 0x3f800000
    v_cmp_eq_u32 vcc, 1, v104
    s_nop 1
    v_cndmask_b32 v100, v100, v105, vcc
    v_mov_b32 v101, 0
    v_mov_b32 v105, 0x3f80
    v_cmp_eq_u32 vcc, 4, v104
    s_nop 1
    v_cndmask_b32 v101, v101, v105, vcc
    v_mov_b32 v105, 0x3f800000
    v_cmp_eq_u32 vcc, 5, v104
    s_nop 1
    v_cndmask_b32 v101, v101, v105, vcc
    v_mov_b32 v102, 0
    v_mov_b32 v105, 0x3f80
    v_cmp_eq_u32 vcc, 8, v104
    s_nop 1
    v_cndmask_b32 v102, v102, v105, vcc
    v_mov_b32 v105, 0x3f800000
    v_cmp_eq_u32 vcc, 9, v104
    s_nop 1
    v_cndmask_b32 v102, v102, v105, vcc
    v_mov_b32 v103, 0
    v_mov_b32 v105, 0x3f80
    v_cmp_eq_u32 vcc, 12, v104
    s_nop 1
    v_cndmask_b32 v103, v103, v105, vcc
    v_mov_b32 v105, 0x3f800000
    v_cmp_eq_u32 vcc, 13, v104
    s_nop 1
    v_cndmask_b32 v103, v103, v105, vcc
    ds_write_b128 v3, v[100:103] offset:23040
    s_mov_b32 s34, 0x05040100
    s_mov_b32 s35, 0x07060302
    s_mov_b32 s33, 0x3e0293ee
    s_mov_b32 s40, 0x4e800000
    s_mov_b32 s32, 0
    s_mov_b32 s4, 0x3f803f80
    s_mov_b32 s5, 0x3f803f80
    s_lshl_b32 s36, s20, 14
    s_lshr_b32 s37, s21, 1
    s_lshl_b32 s37, s37, 12
    s_add_u32 s25, s36, s37
    s_lshl_b32 s37, s21, 11
    s_add_u32 s39, s36, s37
    s_add_u32 s39, s39, 8192
    v_mov_b32 v104, 0x0
    v_bfe_u32 v14, v0, 0, 1
    s_mov_b32 s38, 0x80
    v_mad_u32_u24 v104, v14, s38, v104
    v_bfe_u32 v14, v0, 1, 1
    s_mov_b32 s38, 0x100
    v_mad_u32_u24 v104, v14, s38, v104
    v_bfe_u32 v14, v0, 2, 1
    s_mov_b32 s38, 0x200
    v_mad_u32_u24 v104, v14, s38, v104
    v_bfe_u32 v14, v0, 3, 1
    s_mov_b32 s38, 0x400
    v_mad_u32_u24 v104, v14, s38, v104
    v_bfe_u32 v14, v0, 4, 1
    s_mov_b32 s38, 0x800
    v_mad_u32_u24 v104, v14, s38, v104
    v_bfe_u32 v14, v0, 6, 1
    s_mov_b32 s38, 0x1000
    v_mad_u32_u24 v104, v14, s38, v104
    v_bfe_u32 v14, v0, 7, 1
    s_mov_b32 s38, 0x2000
    v_mad_u32_u24 v104, v14, s38, v104
    s_lshl_b32 s36, s20, 14
    v_add_u32 v104, s36, v104
    s_lshl_b32 s36, s20, 8
    s_lshr_b32 s37, s21, 1
    s_lshl_b32 s37, s37, 7
    s_add_u32 s36, s36, s37
    s_add_u32 s36, s36, 0x102100
    v_and_b32 v14, 63, v0
    v_mov_b32 v105, 0x40000000
    v_cmp_lt_u32 vcc, 32, v14
    s_nop 1
    v_cndmask_b32 v104, v104, v105, vcc
    v_mov_b32 v105, s36
    v_cmp_eq_u32 vcc, 32, v14
    s_nop 1
    v_cndmask_b32 v104, v104, v105, vcc
    s_lshl_b32 s36, s20, 2
    s_add_u32 s36, s36, 0x104100
    v_mov_b32 v105, s36
    v_cmp_eq_u32 vcc, 33, v14
    s_nop 1
    v_cndmask_b32 v0, v104, v105, vcc
    s_waitcnt vmcnt(36)
    s_barrier
    ds_read_b64_tr_b16 a[160:161], v20 offset:0
    ds_read_b64_tr_b16 a[162:163], v20 offset:512
    ds_read_b64_tr_b16 a[168:169], v21 offset:0
    ds_read_b64_tr_b16 a[170:171], v21 offset:512
    ds_read_b64_tr_b16 a[192:193], v22 offset:0
    ds_read_b64_tr_b16 a[194:195], v22 offset:512
    ds_read_b64_tr_b16 a[200:201], v23 offset:0
    ds_read_b64_tr_b16 a[202:203], v23 offset:512
    ds_read_b64_tr_b16 a[224:225], v24 offset:0
    ds_read_b64_tr_b16 a[226:227], v24 offset:512
    ds_read_b64_tr_b16 a[232:233], v25 offset:0
    ds_read_b64_tr_b16 a[234:235], v25 offset:512
    s_waitcnt lgkmcnt(4)
    ds_read_b64_tr_b16 v[128:129], v26 offset:0
    ds_read_b64_tr_b16 v[130:131], v26 offset:512
    ds_read_b64_tr_b16 v[136:137], v27 offset:0
    ds_read_b64_tr_b16 v[138:139], v27 offset:512
    s_waitcnt lgkmcnt(0)
    s_barrier
    s_add_u32 m0, s28, 0
    s_add_u32 s37, s3, 0x300000
    buffer_load_dwordx4 v16, s[60:63], s37 offen lds
    s_add_u32 m0, s28, 1024
    s_add_u32 s37, s3, 0x308000
    buffer_load_dwordx4 v17, s[60:63], s37 offen lds
    s_add_u32 m0, s28, 2048
    s_add_u32 s37, s3, 0x310000
    buffer_load_dwordx4 v18, s[60:63], s37 offen lds
    s_add_u32 m0, s28, 3072
    s_add_u32 s37, s3, 0x318000
    buffer_load_dwordx4 v19, s[60:63], s37 offen lds
    s_add_u32 m0, s28, 4096
    s_add_u32 s37, s3, 0x320000
    buffer_load_dwordx4 v16, s[60:63], s37 offen lds
    s_add_u32 m0, s28, 5120
    s_add_u32 s37, s3, 0x328000
    buffer_load_dwordx4 v17, s[60:63], s37 offen lds
    s_add_u32 m0, s28, 6144
    s_add_u32 s37, s3, 0x330000
    buffer_load_dwordx4 v18, s[60:63], s37 offen lds
    s_add_u32 m0, s28, 7168
    s_add_u32 s37, s3, 0x338000
    buffer_load_dwordx4 v19, s[60:63], s37 offen lds
    s_xor_b32 s36, s21, 2
    s_lshl_b32 s36, s36, 15
    s_add_u32 s36, s36, s29
    s_add_u32 s37, s36, 0x80
    buffer_load_dword v48, v11, s[92:95], s37 offen
    s_add_u32 s37, s36, 0x4080
    buffer_load_dword v49, v11, s[92:95], s37 offen
    s_add_u32 s37, s36, 0x480
    buffer_load_dword v50, v11, s[92:95], s37 offen
    s_add_u32 s37, s36, 0x4480
    buffer_load_dword v51, v11, s[92:95], s37 offen
    s_add_u32 s37, s36, 0x2080
    buffer_load_dword v52, v11, s[92:95], s37 offen
    s_add_u32 s37, s36, 0x6080
    buffer_load_dword v53, v11, s[92:95], s37 offen
    s_add_u32 s37, s36, 0x2480
    buffer_load_dword v54, v11, s[92:95], s37 offen
    s_add_u32 s37, s36, 0x6480
    buffer_load_dword v55, v11, s[92:95], s37 offen
    s_add_u32 s37, s36, 0xc0
    buffer_load_dword v56, v11, s[92:95], s37 offen
    s_add_u32 s37, s36, 0x40c0
    buffer_load_dword v57, v11, s[92:95], s37 offen
    s_add_u32 s37, s36, 0x4c0
    buffer_load_dword v58, v11, s[92:95], s37 offen
    s_add_u32 s37, s36, 0x44c0
    buffer_load_dword v59, v11, s[92:95], s37 offen
    s_add_u32 s37, s36, 0x20c0
    buffer_load_dword v60, v11, s[92:95], s37 offen
    s_add_u32 s37, s36, 0x60c0
    buffer_load_dword v61, v11, s[92:95], s37 offen
    s_add_u32 s37, s36, 0x24c0
    buffer_load_dword v62, v11, s[92:95], s37 offen
    s_add_u32 s37, s36, 0x64c0
    buffer_load_dword v63, v11, s[92:95], s37 offen
    s_waitcnt vmcnt(52)
    s_barrier
    ds_read_b64_tr_b16 a[164:165], v20 offset:8192
    ds_read_b64_tr_b16 a[166:167], v20 offset:8704
    ds_read_b64_tr_b16 a[172:173], v21 offset:8192
    ds_read_b64_tr_b16 a[174:175], v21 offset:8704
    ds_read_b64_tr_b16 a[196:197], v22 offset:8192
    ds_read_b64_tr_b16 a[198:199], v22 offset:8704
    ds_read_b64_tr_b16 a[204:205], v23 offset:8192
    ds_read_b64_tr_b16 a[206:207], v23 offset:8704
    ds_read_b64_tr_b16 a[228:229], v24 offset:8192
    ds_read_b64_tr_b16 a[230:231], v24 offset:8704
    ds_read_b64_tr_b16 a[236:237], v25 offset:8192
    ds_read_b64_tr_b16 a[238:239], v25 offset:8704
    s_waitcnt lgkmcnt(4)
    ds_read_b64_tr_b16 v[132:133], v26 offset:8192
    ds_read_b64_tr_b16 v[134:135], v26 offset:8704
    ds_read_b64_tr_b16 v[140:141], v27 offset:8192
    ds_read_b64_tr_b16 v[142:143], v27 offset:8704
    s_waitcnt lgkmcnt(0)
    s_barrier
    s_mov_b32 s88, s50
    s_and_b32 s89, s51, 0xffff
    s_mov_b32 s90, 0x400000
    s_mov_b32 s91, 0x20000
    s_add_u32 m0, s28, 8192
    s_add_u32 s37, s3, 0x0
    buffer_load_dwordx4 v16, s[88:91], s37 offen lds
    s_add_u32 m0, s28, 9216
    s_add_u32 s37, s3, 0x8000
    buffer_load_dwordx4 v17, s[88:91], s37 offen lds
    s_add_u32 m0, s28, 10240
    s_add_u32 s37, s3, 0x10000
    buffer_load_dwordx4 v18, s[88:91], s37 offen lds
    s_add_u32 m0, s28, 11264
    s_add_u32 s37, s3, 0x18000
    buffer_load_dwordx4 v19, s[88:91], s37 offen lds
    s_add_u32 m0, s28, 12288
    s_add_u32 s37, s3, 0x20000
    buffer_load_dwordx4 v16, s[88:91], s37 offen lds
    s_add_u32 m0, s28, 13312
    s_add_u32 s37, s3, 0x28000
    buffer_load_dwordx4 v17, s[88:91], s37 offen lds
    s_add_u32 m0, s28, 14336
    s_add_u32 s37, s3, 0x30000
    buffer_load_dwordx4 v18, s[88:91], s37 offen lds
    s_add_u32 m0, s28, 15360
    s_add_u32 s37, s3, 0x38000
    buffer_load_dwordx4 v19, s[88:91], s37 offen lds
    s_waitcnt vmcnt(36)
    v_perm_b32 v120, v33, v32, s34
    v_perm_b32 v121, v33, v32, s35
    v_perm_b32 v122, v35, v34, s34
    v_perm_b32 v123, v35, v34, s35
    v_perm_b32 v124, v37, v36, s34
    v_perm_b32 v125, v37, v36, s35
    v_perm_b32 v126, v39, v38, s34
    v_perm_b32 v127, v39, v38, s35
    ds_write_b128 v4, v[120:123] offset:24576
    ds_write_b128 v4, v[124:127] offset:25600
    s_waitcnt lgkmcnt(0)
    v_perm_b32 v120, v41, v40, s34
    v_perm_b32 v121, v41, v40, s35
    v_perm_b32 v122, v43, v42, s34
    v_perm_b32 v123, v43, v42, s35
    v_perm_b32 v124, v45, v44, s34
    v_perm_b32 v125, v45, v44, s35
    v_perm_b32 v126, v47, v46, s34
    v_perm_b32 v127, v47, v46, s35
    ds_write_b128 v4, v[120:123] offset:30720
    ds_write_b128 v4, v[124:127] offset:31744
    s_waitcnt lgkmcnt(0)
    s_xor_b32 s36, s21, 1
    s_lshl_b32 s36, s36, 15
    s_add_u32 s36, s36, s29
    s_add_u32 s37, s36, 0x80
    buffer_load_dword v80, v11, s[92:95], s37 offen
    s_add_u32 s37, s36, 0x4080
    buffer_load_dword v81, v11, s[92:95], s37 offen
    s_add_u32 s37, s36, 0x480
    buffer_load_dword v82, v11, s[92:95], s37 offen
    s_add_u32 s37, s36, 0x4480
    buffer_load_dword v83, v11, s[92:95], s37 offen
    s_add_u32 s37, s36, 0x2080
    buffer_load_dword v84, v11, s[92:95], s37 offen
    s_add_u32 s37, s36, 0x6080
    buffer_load_dword v85, v11, s[92:95], s37 offen
    s_add_u32 s37, s36, 0x2480
    buffer_load_dword v86, v11, s[92:95], s37 offen
    s_add_u32 s37, s36, 0x6480
    buffer_load_dword v87, v11, s[92:95], s37 offen
    s_add_u32 s37, s36, 0xc0
    buffer_load_dword v88, v11, s[92:95], s37 offen
    s_add_u32 s37, s36, 0x40c0
    buffer_load_dword v89, v11, s[92:95], s37 offen
    s_add_u32 s37, s36, 0x4c0
    buffer_load_dword v90, v11, s[92:95], s37 offen
    s_add_u32 s37, s36, 0x44c0
    buffer_load_dword v91, v11, s[92:95], s37 offen
    s_add_u32 s37, s36, 0x20c0
    buffer_load_dword v92, v11, s[92:95], s37 offen
    s_add_u32 s37, s36, 0x60c0
    buffer_load_dword v93, v11, s[92:95], s37 offen
    s_add_u32 s37, s36, 0x24c0
    buffer_load_dword v94, v11, s[92:95], s37 offen
    s_add_u32 s37, s36, 0x64c0
    buffer_load_dword v95, v11, s[92:95], s37 offen
    s_barrier
    ds_read_b64_tr_b16 a[176:177], v20 offset:16384
    ds_read_b64_tr_b16 a[178:179], v20 offset:16896
    ds_read_b64_tr_b16 a[184:185], v21 offset:16384
    ds_read_b64_tr_b16 a[186:187], v21 offset:16896
    ds_read_b64_tr_b16 a[208:209], v22 offset:16384
    ds_read_b64_tr_b16 a[210:211], v22 offset:16896
    ds_read_b64_tr_b16 a[216:217], v23 offset:16384
    ds_read_b64_tr_b16 a[218:219], v23 offset:16896
    ds_read_b64_tr_b16 a[240:241], v24 offset:16384
    ds_read_b64_tr_b16 a[242:243], v24 offset:16896
    ds_read_b64_tr_b16 a[248:249], v25 offset:16384
    ds_read_b64_tr_b16 a[250:251], v25 offset:16896
    s_waitcnt lgkmcnt(4)
    ds_read_b64_tr_b16 v[144:145], v26 offset:16384
    ds_read_b64_tr_b16 v[146:147], v26 offset:16896
    ds_read_b64_tr_b16 v[152:153], v27 offset:16384
    ds_read_b64_tr_b16 v[154:155], v27 offset:16896
    s_waitcnt lgkmcnt(0)
    s_barrier
    s_add_u32 m0, s28, 16384
    s_add_u32 s37, s3, 0x100000
    buffer_load_dwordx4 v16, s[88:91], s37 offen lds
    s_add_u32 m0, s28, 17408
    s_add_u32 s37, s3, 0x108000
    buffer_load_dwordx4 v17, s[88:91], s37 offen lds
    s_add_u32 m0, s28, 18432
    s_add_u32 s37, s3, 0x110000
    buffer_load_dwordx4 v18, s[88:91], s37 offen lds
    s_add_u32 m0, s28, 19456
    s_add_u32 s37, s3, 0x118000
    buffer_load_dwordx4 v19, s[88:91], s37 offen lds
    s_add_u32 m0, s28, 20480
    s_add_u32 s37, s3, 0x120000
    buffer_load_dwordx4 v16, s[88:91], s37 offen lds
    s_add_u32 m0, s28, 21504
    s_add_u32 s37, s3, 0x128000
    buffer_load_dwordx4 v17, s[88:91], s37 offen lds
    s_add_u32 m0, s28, 22528
    s_add_u32 s37, s3, 0x130000
    buffer_load_dwordx4 v18, s[88:91], s37 offen lds
    s_add_u32 m0, s28, 23552
    s_add_u32 s37, s3, 0x138000
    buffer_load_dwordx4 v19, s[88:91], s37 offen lds
    s_waitcnt vmcnt(32)
    v_perm_b32 v232, v49, v48, s34
    v_perm_b32 v233, v49, v48, s35
    v_perm_b32 v234, v51, v50, s34
    v_perm_b32 v235, v51, v50, s35
    v_perm_b32 v236, v53, v52, s34
    v_perm_b32 v237, v53, v52, s35
    v_perm_b32 v238, v55, v54, s34
    v_perm_b32 v239, v55, v54, s35
    v_perm_b32 v120, v57, v56, s34
    v_perm_b32 v121, v57, v56, s35
    v_perm_b32 v122, v59, v58, s34
    v_perm_b32 v123, v59, v58, s35
    v_perm_b32 v124, v61, v60, s34
    v_perm_b32 v125, v61, v60, s35
    v_perm_b32 v126, v63, v62, s34
    v_perm_b32 v127, v63, v62, s35
    ds_write_b128 v4, v[120:123] offset:28672
    ds_write_b128 v4, v[124:127] offset:29696
    s_waitcnt lgkmcnt(0)
    s_xor_b32 s36, s21, 3
    s_lshl_b32 s36, s36, 15
    s_add_u32 s36, s36, s29
    s_add_u32 s37, s36, 0x0
    buffer_load_dword v32, v11, s[92:95], s37 offen
    s_add_u32 s37, s36, 0x4000
    buffer_load_dword v33, v11, s[92:95], s37 offen
    s_add_u32 s37, s36, 0x400
    buffer_load_dword v34, v11, s[92:95], s37 offen
    s_add_u32 s37, s36, 0x4400
    buffer_load_dword v35, v11, s[92:95], s37 offen
    s_add_u32 s37, s36, 0x2000
    buffer_load_dword v36, v11, s[92:95], s37 offen
    s_add_u32 s37, s36, 0x6000
    buffer_load_dword v37, v11, s[92:95], s37 offen
    s_add_u32 s37, s36, 0x2400
    buffer_load_dword v38, v11, s[92:95], s37 offen
    s_add_u32 s37, s36, 0x6400
    buffer_load_dword v39, v11, s[92:95], s37 offen
    s_add_u32 s37, s36, 0x40
    buffer_load_dword v40, v11, s[92:95], s37 offen
    s_add_u32 s37, s36, 0x4040
    buffer_load_dword v41, v11, s[92:95], s37 offen
    s_add_u32 s37, s36, 0x440
    buffer_load_dword v42, v11, s[92:95], s37 offen
    s_add_u32 s37, s36, 0x4440
    buffer_load_dword v43, v11, s[92:95], s37 offen
    s_add_u32 s37, s36, 0x2040
    buffer_load_dword v44, v11, s[92:95], s37 offen
    s_add_u32 s37, s36, 0x6040
    buffer_load_dword v45, v11, s[92:95], s37 offen
    s_add_u32 s37, s36, 0x2440
    buffer_load_dword v46, v11, s[92:95], s37 offen
    s_add_u32 s37, s36, 0x6440
    buffer_load_dword v47, v11, s[92:95], s37 offen
    s_barrier
    ds_read_b64_tr_b16 a[180:181], v20 offset:0
    ds_read_b64_tr_b16 a[182:183], v20 offset:512
    ds_read_b64_tr_b16 a[188:189], v21 offset:0
    ds_read_b64_tr_b16 a[190:191], v21 offset:512
    ds_read_b64_tr_b16 a[212:213], v22 offset:0
    ds_read_b64_tr_b16 a[214:215], v22 offset:512
    ds_read_b64_tr_b16 a[220:221], v23 offset:0
    ds_read_b64_tr_b16 a[222:223], v23 offset:512
    ds_read_b64_tr_b16 a[244:245], v24 offset:0
    ds_read_b64_tr_b16 a[246:247], v24 offset:512
    ds_read_b64_tr_b16 a[252:253], v25 offset:0
    ds_read_b64_tr_b16 a[254:255], v25 offset:512
    s_waitcnt lgkmcnt(4)
    ds_read_b64_tr_b16 v[148:149], v26 offset:0
    ds_read_b64_tr_b16 v[150:151], v26 offset:512
    ds_read_b64_tr_b16 v[156:157], v27 offset:0
    ds_read_b64_tr_b16 v[158:159], v27 offset:512
    s_waitcnt lgkmcnt(0)
    s_barrier
    s_add_u32 m0, s28, 0
    s_add_u32 s37, s3, 0x200000
    buffer_load_dwordx4 v16, s[88:91], s37 offen lds
    s_add_u32 m0, s28, 1024
    s_add_u32 s37, s3, 0x208000
    buffer_load_dwordx4 v17, s[88:91], s37 offen lds
    s_add_u32 m0, s28, 2048
    s_add_u32 s37, s3, 0x210000
    buffer_load_dwordx4 v18, s[88:91], s37 offen lds
    s_add_u32 m0, s28, 3072
    s_add_u32 s37, s3, 0x218000
    buffer_load_dwordx4 v19, s[88:91], s37 offen lds
    s_add_u32 m0, s28, 4096
    s_add_u32 s37, s3, 0x220000
    buffer_load_dwordx4 v16, s[88:91], s37 offen lds
    s_add_u32 m0, s28, 5120
    s_add_u32 s37, s3, 0x228000
    buffer_load_dwordx4 v17, s[88:91], s37 offen lds
    s_add_u32 m0, s28, 6144
    s_add_u32 s37, s3, 0x230000
    buffer_load_dwordx4 v18, s[88:91], s37 offen lds
    s_add_u32 m0, s28, 7168
    s_add_u32 s37, s3, 0x238000
    buffer_load_dwordx4 v19, s[88:91], s37 offen lds
    s_waitcnt vmcnt(32)
    v_perm_b32 v208, v81, v80, s34
    v_perm_b32 v209, v81, v80, s35
    v_perm_b32 v210, v83, v82, s34
    v_perm_b32 v211, v83, v82, s35
    v_perm_b32 v212, v85, v84, s34
    v_perm_b32 v213, v85, v84, s35
    v_perm_b32 v214, v87, v86, s34
    v_perm_b32 v215, v87, v86, s35
    v_perm_b32 v120, v89, v88, s34
    v_perm_b32 v121, v89, v88, s35
    v_perm_b32 v122, v91, v90, s34
    v_perm_b32 v123, v91, v90, s35
    v_perm_b32 v124, v93, v92, s34
    v_perm_b32 v125, v93, v92, s35
    v_perm_b32 v126, v95, v94, s34
    v_perm_b32 v127, v95, v94, s35
    ds_write_b128 v4, v[120:123] offset:26624
    ds_write_b128 v4, v[124:127] offset:27648
    s_waitcnt lgkmcnt(0)
    s_xor_b32 s36, s21, 2
    s_lshl_b32 s36, s36, 15
    s_add_u32 s36, s36, s29
    s_add_u32 s37, s36, 0x0
    buffer_load_dword v48, v11, s[92:95], s37 offen
    s_add_u32 s37, s36, 0x4000
    buffer_load_dword v49, v11, s[92:95], s37 offen
    s_add_u32 s37, s36, 0x400
    buffer_load_dword v50, v11, s[92:95], s37 offen
    s_add_u32 s37, s36, 0x4400
    buffer_load_dword v51, v11, s[92:95], s37 offen
    s_add_u32 s37, s36, 0x2000
    buffer_load_dword v52, v11, s[92:95], s37 offen
    s_add_u32 s37, s36, 0x6000
    buffer_load_dword v53, v11, s[92:95], s37 offen
    s_add_u32 s37, s36, 0x2400
    buffer_load_dword v54, v11, s[92:95], s37 offen
    s_add_u32 s37, s36, 0x6400
    buffer_load_dword v55, v11, s[92:95], s37 offen
    s_add_u32 s37, s36, 0x40
    buffer_load_dword v56, v11, s[92:95], s37 offen
    s_add_u32 s37, s36, 0x4040
    buffer_load_dword v57, v11, s[92:95], s37 offen
    s_add_u32 s37, s36, 0x440
    buffer_load_dword v58, v11, s[92:95], s37 offen
    s_add_u32 s37, s36, 0x4440
    buffer_load_dword v59, v11, s[92:95], s37 offen
    s_add_u32 s37, s36, 0x2040
    buffer_load_dword v60, v11, s[92:95], s37 offen
    s_add_u32 s37, s36, 0x6040
    buffer_load_dword v61, v11, s[92:95], s37 offen
    s_add_u32 s37, s36, 0x2440
    buffer_load_dword v62, v11, s[92:95], s37 offen
    s_add_u32 s37, s36, 0x6440
    buffer_load_dword v63, v11, s[92:95], s37 offen
    s_barrier
    ds_read_b64_tr_b16 v[64:65], v20 offset:8192
    ds_read_b64_tr_b16 v[66:67], v20 offset:8704
    ds_read_b64_tr_b16 v[72:73], v21 offset:8192
    ds_read_b64_tr_b16 v[74:75], v21 offset:8704
    ds_read_b64_tr_b16 v[96:97], v22 offset:8192
    ds_read_b64_tr_b16 v[98:99], v22 offset:8704
    ds_read_b64_tr_b16 v[104:105], v23 offset:8192
    ds_read_b64_tr_b16 v[106:107], v23 offset:8704
    ds_read_b64_tr_b16 a[112:113], v24 offset:8192
    ds_read_b64_tr_b16 a[114:115], v24 offset:8704
    ds_read_b64_tr_b16 a[120:121], v25 offset:8192
    ds_read_b64_tr_b16 a[122:123], v25 offset:8704
    s_waitcnt lgkmcnt(4)
    ds_read_b64_tr_b16 a[144:145], v26 offset:8192
    ds_read_b64_tr_b16 a[146:147], v26 offset:8704
    ds_read_b64_tr_b16 a[152:153], v27 offset:8192
    ds_read_b64_tr_b16 a[154:155], v27 offset:8704
    s_waitcnt lgkmcnt(0)
    s_barrier
    s_add_u32 m0, s28, 8192
    s_add_u32 s37, s3, 0x300000
    buffer_load_dwordx4 v16, s[88:91], s37 offen lds
    s_add_u32 m0, s28, 9216
    s_add_u32 s37, s3, 0x308000
    buffer_load_dwordx4 v17, s[88:91], s37 offen lds
    s_add_u32 m0, s28, 10240
    s_add_u32 s37, s3, 0x310000
    buffer_load_dwordx4 v18, s[88:91], s37 offen lds
    s_add_u32 m0, s28, 11264
    s_add_u32 s37, s3, 0x318000
    buffer_load_dwordx4 v19, s[88:91], s37 offen lds
    s_add_u32 m0, s28, 12288
    s_add_u32 s37, s3, 0x320000
    buffer_load_dwordx4 v16, s[88:91], s37 offen lds
    s_add_u32 m0, s28, 13312
    s_add_u32 s37, s3, 0x328000
    buffer_load_dwordx4 v17, s[88:91], s37 offen lds
    s_add_u32 m0, s28, 14336
    s_add_u32 s37, s3, 0x330000
    buffer_load_dwordx4 v18, s[88:91], s37 offen lds
    s_add_u32 m0, s28, 15360
    s_add_u32 s37, s3, 0x338000
    buffer_load_dwordx4 v19, s[88:91], s37 offen lds
    s_waitcnt vmcnt(32)
    v_perm_b32 v240, v33, v32, s34
    v_perm_b32 v241, v33, v32, s35
    v_perm_b32 v242, v35, v34, s34
    v_perm_b32 v243, v35, v34, s35
    v_perm_b32 v244, v37, v36, s34
    v_perm_b32 v245, v37, v36, s35
    v_perm_b32 v246, v39, v38, s34
    v_perm_b32 v247, v39, v38, s35
    v_perm_b32 v248, v41, v40, s34
    v_perm_b32 v249, v41, v40, s35
    v_perm_b32 v250, v43, v42, s34
    v_perm_b32 v251, v43, v42, s35
    v_perm_b32 v252, v45, v44, s34
    v_perm_b32 v253, v45, v44, s35
    v_perm_b32 v254, v47, v46, s34
    v_perm_b32 v255, v47, v46, s35
    s_xor_b32 s36, s21, 1
    s_lshl_b32 s36, s36, 15
    s_add_u32 s36, s36, s29
    s_add_u32 s37, s36, 0x0
    buffer_load_dword v80, v11, s[92:95], s37 offen
    s_add_u32 s37, s36, 0x4000
    buffer_load_dword v81, v11, s[92:95], s37 offen
    s_add_u32 s37, s36, 0x400
    buffer_load_dword v82, v11, s[92:95], s37 offen
    s_add_u32 s37, s36, 0x4400
    buffer_load_dword v83, v11, s[92:95], s37 offen
    s_add_u32 s37, s36, 0x2000
    buffer_load_dword v84, v11, s[92:95], s37 offen
    s_add_u32 s37, s36, 0x6000
    buffer_load_dword v85, v11, s[92:95], s37 offen
    s_add_u32 s37, s36, 0x2400
    buffer_load_dword v86, v11, s[92:95], s37 offen
    s_add_u32 s37, s36, 0x6400
    buffer_load_dword v87, v11, s[92:95], s37 offen
    s_add_u32 s37, s36, 0x40
    buffer_load_dword v88, v11, s[92:95], s37 offen
    s_add_u32 s37, s36, 0x4040
    buffer_load_dword v89, v11, s[92:95], s37 offen
    s_add_u32 s37, s36, 0x440
    buffer_load_dword v90, v11, s[92:95], s37 offen
    s_add_u32 s37, s36, 0x4440
    buffer_load_dword v91, v11, s[92:95], s37 offen
    s_add_u32 s37, s36, 0x2040
    buffer_load_dword v92, v11, s[92:95], s37 offen
    s_add_u32 s37, s36, 0x6040
    buffer_load_dword v93, v11, s[92:95], s37 offen
    s_add_u32 s37, s36, 0x2440
    buffer_load_dword v94, v11, s[92:95], s37 offen
    s_add_u32 s37, s36, 0x6440
    buffer_load_dword v95, v11, s[92:95], s37 offen
    s_barrier
    ds_read_b64_tr_b16 v[68:69], v20 offset:16384
    ds_read_b64_tr_b16 v[70:71], v20 offset:16896
    ds_read_b64_tr_b16 v[76:77], v21 offset:16384
    ds_read_b64_tr_b16 v[78:79], v21 offset:16896
    ds_read_b64_tr_b16 v[100:101], v22 offset:16384
    ds_read_b64_tr_b16 v[102:103], v22 offset:16896
    ds_read_b64_tr_b16 v[108:109], v23 offset:16384
    ds_read_b64_tr_b16 v[110:111], v23 offset:16896
    ds_read_b64_tr_b16 a[116:117], v24 offset:16384
    ds_read_b64_tr_b16 a[118:119], v24 offset:16896
    ds_read_b64_tr_b16 a[124:125], v25 offset:16384
    ds_read_b64_tr_b16 a[126:127], v25 offset:16896
    s_waitcnt lgkmcnt(4)
    ds_read_b64_tr_b16 a[148:149], v26 offset:16384
    ds_read_b64_tr_b16 a[150:151], v26 offset:16896
    ds_read_b64_tr_b16 a[156:157], v27 offset:16384
    ds_read_b64_tr_b16 a[158:159], v27 offset:16896
    s_waitcnt lgkmcnt(0)
    s_barrier
    s_mov_b32 s96, s48
    s_and_b32 s97, s49, 0xffff
    s_mov_b32 s98, 0x400000
    s_mov_b32 s99, 0x20000
    s_add_u32 m0, s28, 16384
    s_add_u32 s37, s3, 0x0
    buffer_load_dwordx4 v16, s[96:99], s37 offen lds
    s_add_u32 m0, s28, 17408
    s_add_u32 s37, s3, 0x8000
    buffer_load_dwordx4 v17, s[96:99], s37 offen lds
    s_add_u32 m0, s28, 18432
    s_add_u32 s37, s3, 0x10000
    buffer_load_dwordx4 v18, s[96:99], s37 offen lds
    s_add_u32 m0, s28, 19456
    s_add_u32 s37, s3, 0x18000
    buffer_load_dwordx4 v19, s[96:99], s37 offen lds
    s_add_u32 m0, s28, 20480
    s_add_u32 s37, s3, 0x20000
    buffer_load_dwordx4 v16, s[96:99], s37 offen lds
    s_add_u32 m0, s28, 21504
    s_add_u32 s37, s3, 0x28000
    buffer_load_dwordx4 v17, s[96:99], s37 offen lds
    s_add_u32 m0, s28, 22528
    s_add_u32 s37, s3, 0x30000
    buffer_load_dwordx4 v18, s[96:99], s37 offen lds
    s_add_u32 m0, s28, 23552
    s_add_u32 s37, s3, 0x38000
    buffer_load_dwordx4 v19, s[96:99], s37 offen lds
    s_waitcnt vmcnt(32)
    v_perm_b32 v216, v49, v48, s34
    v_perm_b32 v217, v49, v48, s35
    v_perm_b32 v218, v51, v50, s34
    v_perm_b32 v219, v51, v50, s35
    v_perm_b32 v220, v53, v52, s34
    v_perm_b32 v221, v53, v52, s35
    v_perm_b32 v222, v55, v54, s34
    v_perm_b32 v223, v55, v54, s35
    v_perm_b32 v224, v57, v56, s34
    v_perm_b32 v225, v57, v56, s35
    v_perm_b32 v226, v59, v58, s34
    v_perm_b32 v227, v59, v58, s35
    v_perm_b32 v228, v61, v60, s34
    v_perm_b32 v229, v61, v60, s35
    v_perm_b32 v230, v63, v62, s34
    v_perm_b32 v231, v63, v62, s35
    s_xor_b32 s36, s21, 0
    s_lshl_b32 s36, s36, 15
    s_add_u32 s36, s36, s29
    s_add_u32 s37, s36, 0x80
    buffer_load_dword v32, v11, s[92:95], s37 offen
    s_add_u32 s37, s36, 0x4080
    buffer_load_dword v33, v11, s[92:95], s37 offen
    s_add_u32 s37, s36, 0x480
    buffer_load_dword v34, v11, s[92:95], s37 offen
    s_add_u32 s37, s36, 0x4480
    buffer_load_dword v35, v11, s[92:95], s37 offen
    s_add_u32 s37, s36, 0x2080
    buffer_load_dword v36, v11, s[92:95], s37 offen
    s_add_u32 s37, s36, 0x6080
    buffer_load_dword v37, v11, s[92:95], s37 offen
    s_add_u32 s37, s36, 0x2480
    buffer_load_dword v38, v11, s[92:95], s37 offen
    s_add_u32 s37, s36, 0x6480
    buffer_load_dword v39, v11, s[92:95], s37 offen
    s_add_u32 s37, s36, 0xc0
    buffer_load_dword v40, v11, s[92:95], s37 offen
    s_add_u32 s37, s36, 0x40c0
    buffer_load_dword v41, v11, s[92:95], s37 offen
    s_add_u32 s37, s36, 0x4c0
    buffer_load_dword v42, v11, s[92:95], s37 offen
    s_add_u32 s37, s36, 0x44c0
    buffer_load_dword v43, v11, s[92:95], s37 offen
    s_add_u32 s37, s36, 0x20c0
    buffer_load_dword v44, v11, s[92:95], s37 offen
    s_add_u32 s37, s36, 0x60c0
    buffer_load_dword v45, v11, s[92:95], s37 offen
    s_add_u32 s37, s36, 0x24c0
    buffer_load_dword v46, v11, s[92:95], s37 offen
    s_add_u32 s37, s36, 0x64c0
    buffer_load_dword v47, v11, s[92:95], s37 offen
    s_barrier
    ds_read_b64_tr_b16 a[80:81], v20 offset:0
    ds_read_b64_tr_b16 a[82:83], v20 offset:512
    ds_read_b64_tr_b16 a[88:89], v21 offset:0
    ds_read_b64_tr_b16 a[90:91], v21 offset:512
    ds_read_b64_tr_b16 a[96:97], v22 offset:0
    ds_read_b64_tr_b16 a[98:99], v22 offset:512
    ds_read_b64_tr_b16 a[104:105], v23 offset:0
    ds_read_b64_tr_b16 a[106:107], v23 offset:512
    ds_read_b64_tr_b16 a[128:129], v24 offset:0
    ds_read_b64_tr_b16 a[130:131], v24 offset:512
    ds_read_b64_tr_b16 a[136:137], v25 offset:0
    ds_read_b64_tr_b16 a[138:139], v25 offset:512
    s_waitcnt lgkmcnt(4)
    ds_read_b64_tr_b16 v[112:113], v26 offset:0
    ds_read_b64_tr_b16 v[114:115], v26 offset:512
    ds_read_b64_tr_b16 v[120:121], v27 offset:0
    ds_read_b64_tr_b16 v[122:123], v27 offset:512
    s_waitcnt lgkmcnt(0)
    s_barrier
    s_add_u32 m0, s28, 0
    s_add_u32 s37, s3, 0x100000
    buffer_load_dwordx4 v16, s[96:99], s37 offen lds
    s_add_u32 m0, s28, 1024
    s_add_u32 s37, s3, 0x108000
    buffer_load_dwordx4 v17, s[96:99], s37 offen lds
    s_add_u32 m0, s28, 2048
    s_add_u32 s37, s3, 0x110000
    buffer_load_dwordx4 v18, s[96:99], s37 offen lds
    s_add_u32 m0, s28, 3072
    s_add_u32 s37, s3, 0x118000
    buffer_load_dwordx4 v19, s[96:99], s37 offen lds
    s_add_u32 m0, s28, 4096
    s_add_u32 s37, s3, 0x120000
    buffer_load_dwordx4 v16, s[96:99], s37 offen lds
    s_add_u32 m0, s28, 5120
    s_add_u32 s37, s3, 0x128000
    buffer_load_dwordx4 v17, s[96:99], s37 offen lds
    s_add_u32 m0, s28, 6144
    s_add_u32 s37, s3, 0x130000
    buffer_load_dwordx4 v18, s[96:99], s37 offen lds
    s_add_u32 m0, s28, 7168
    s_add_u32 s37, s3, 0x138000
    buffer_load_dwordx4 v19, s[96:99], s37 offen lds
    s_waitcnt vmcnt(32)
    v_perm_b32 v192, v81, v80, s34
    v_perm_b32 v193, v81, v80, s35
    v_perm_b32 v194, v83, v82, s34
    v_perm_b32 v195, v83, v82, s35
    v_perm_b32 v196, v85, v84, s34
    v_perm_b32 v197, v85, v84, s35
    v_perm_b32 v198, v87, v86, s34
    v_perm_b32 v199, v87, v86, s35
    v_perm_b32 v200, v89, v88, s34
    v_perm_b32 v201, v89, v88, s35
    v_perm_b32 v202, v91, v90, s34
    v_perm_b32 v203, v91, v90, s35
    v_perm_b32 v204, v93, v92, s34
    v_perm_b32 v205, v93, v92, s35
    v_perm_b32 v206, v95, v94, s34
    v_perm_b32 v207, v95, v94, s35
    s_xor_b32 s36, s21, 0
    s_lshl_b32 s36, s36, 15
    s_add_u32 s36, s36, s29
    s_add_u32 s37, s36, 0x0
    buffer_load_dword v48, v11, s[92:95], s37 offen
    s_add_u32 s37, s36, 0x4000
    buffer_load_dword v49, v11, s[92:95], s37 offen
    s_add_u32 s37, s36, 0x400
    buffer_load_dword v50, v11, s[92:95], s37 offen
    s_add_u32 s37, s36, 0x4400
    buffer_load_dword v51, v11, s[92:95], s37 offen
    s_add_u32 s37, s36, 0x2000
    buffer_load_dword v52, v11, s[92:95], s37 offen
    s_add_u32 s37, s36, 0x6000
    buffer_load_dword v53, v11, s[92:95], s37 offen
    s_add_u32 s37, s36, 0x2400
    buffer_load_dword v54, v11, s[92:95], s37 offen
    s_add_u32 s37, s36, 0x6400
    buffer_load_dword v55, v11, s[92:95], s37 offen
    s_add_u32 s37, s36, 0x40
    buffer_load_dword v56, v11, s[92:95], s37 offen
    s_add_u32 s37, s36, 0x4040
    buffer_load_dword v57, v11, s[92:95], s37 offen
    s_add_u32 s37, s36, 0x440
    buffer_load_dword v58, v11, s[92:95], s37 offen
    s_add_u32 s37, s36, 0x4440
    buffer_load_dword v59, v11, s[92:95], s37 offen
    s_add_u32 s37, s36, 0x2040
    buffer_load_dword v60, v11, s[92:95], s37 offen
    s_add_u32 s37, s36, 0x6040
    buffer_load_dword v61, v11, s[92:95], s37 offen
    s_add_u32 s37, s36, 0x2440
    buffer_load_dword v62, v11, s[92:95], s37 offen
    s_add_u32 s37, s36, 0x6440
    buffer_load_dword v63, v11, s[92:95], s37 offen
    s_barrier
    ds_read_b64_tr_b16 a[84:85], v20 offset:8192
    ds_read_b64_tr_b16 a[86:87], v20 offset:8704
    ds_read_b64_tr_b16 a[92:93], v21 offset:8192
    ds_read_b64_tr_b16 a[94:95], v21 offset:8704
    ds_read_b64_tr_b16 a[100:101], v22 offset:8192
    ds_read_b64_tr_b16 a[102:103], v22 offset:8704
    ds_read_b64_tr_b16 a[108:109], v23 offset:8192
    ds_read_b64_tr_b16 a[110:111], v23 offset:8704
    ds_read_b64_tr_b16 a[132:133], v24 offset:8192
    ds_read_b64_tr_b16 a[134:135], v24 offset:8704
    ds_read_b64_tr_b16 a[140:141], v25 offset:8192
    ds_read_b64_tr_b16 a[142:143], v25 offset:8704
    s_waitcnt lgkmcnt(4)
    ds_read_b64_tr_b16 v[116:117], v26 offset:8192
    ds_read_b64_tr_b16 v[118:119], v26 offset:8704
    ds_read_b64_tr_b16 v[124:125], v27 offset:8192
    ds_read_b64_tr_b16 v[126:127], v27 offset:8704
    s_waitcnt lgkmcnt(0)
    s_barrier
    s_add_u32 m0, s28, 8192
    s_add_u32 s37, s3, 0x200000
    buffer_load_dwordx4 v16, s[96:99], s37 offen lds
    s_add_u32 m0, s28, 9216
    s_add_u32 s37, s3, 0x208000
    buffer_load_dwordx4 v17, s[96:99], s37 offen lds
    s_add_u32 m0, s28, 10240
    s_add_u32 s37, s3, 0x210000
    buffer_load_dwordx4 v18, s[96:99], s37 offen lds
    s_add_u32 m0, s28, 11264
    s_add_u32 s37, s3, 0x218000
    buffer_load_dwordx4 v19, s[96:99], s37 offen lds
    s_add_u32 m0, s28, 12288
    s_add_u32 s37, s3, 0x220000
    buffer_load_dwordx4 v16, s[96:99], s37 offen lds
    s_add_u32 m0, s28, 13312
    s_add_u32 s37, s3, 0x228000
    buffer_load_dwordx4 v17, s[96:99], s37 offen lds
    s_add_u32 m0, s28, 14336
    s_add_u32 s37, s3, 0x230000
    buffer_load_dwordx4 v18, s[96:99], s37 offen lds
    s_add_u32 m0, s28, 15360
    s_add_u32 s37, s3, 0x238000
    buffer_load_dwordx4 v19, s[96:99], s37 offen lds
    s_waitcnt vmcnt(32)
    v_perm_b32 v176, v33, v32, s34
    v_perm_b32 v177, v33, v32, s35
    v_perm_b32 v178, v35, v34, s34
    v_perm_b32 v179, v35, v34, s35
    v_perm_b32 v180, v37, v36, s34
    v_perm_b32 v181, v37, v36, s35
    v_perm_b32 v182, v39, v38, s34
    v_perm_b32 v183, v39, v38, s35
    v_perm_b32 v184, v41, v40, s34
    v_perm_b32 v185, v41, v40, s35
    v_perm_b32 v186, v43, v42, s34
    v_perm_b32 v187, v43, v42, s35
    v_perm_b32 v188, v45, v44, s34
    v_perm_b32 v189, v45, v44, s35
    v_perm_b32 v190, v47, v46, s34
    v_perm_b32 v191, v47, v46, s35
    v_lshrrev_b32 v31, 2, v3
    buffer_load_dword v30, v31, s[16:19], 0 offen sc1
    s_barrier
    ds_read_b64_tr_b16 v[32:33], v20 offset:16384
    ds_read_b64_tr_b16 v[34:35], v20 offset:16896
    ds_read_b64_tr_b16 v[40:41], v21 offset:16384
    ds_read_b64_tr_b16 v[42:43], v21 offset:16896
    ds_read_b64_tr_b16 a[0:1], v22 offset:16384
    ds_read_b64_tr_b16 a[2:3], v22 offset:16896
    ds_read_b64_tr_b16 a[8:9], v23 offset:16384
    ds_read_b64_tr_b16 a[10:11], v23 offset:16896
    ds_read_b64_tr_b16 a[32:33], v24 offset:16384
    ds_read_b64_tr_b16 a[34:35], v24 offset:16896
    ds_read_b64_tr_b16 a[40:41], v25 offset:16384
    ds_read_b64_tr_b16 a[42:43], v25 offset:16896
    s_waitcnt lgkmcnt(4)
    ds_read_b64_tr_b16 a[64:65], v26 offset:16384
    ds_read_b64_tr_b16 a[66:67], v26 offset:16896
    ds_read_b64_tr_b16 a[72:73], v27 offset:16384
    ds_read_b64_tr_b16 a[74:75], v27 offset:16896
    s_waitcnt lgkmcnt(0)
    s_barrier
    s_add_u32 m0, s28, 16384
    s_add_u32 s37, s3, 0x300000
    buffer_load_dwordx4 v16, s[96:99], s37 offen lds
    s_add_u32 m0, s28, 17408
    s_add_u32 s37, s3, 0x308000
    buffer_load_dwordx4 v17, s[96:99], s37 offen lds
    s_add_u32 m0, s28, 18432
    s_add_u32 s37, s3, 0x310000
    buffer_load_dwordx4 v18, s[96:99], s37 offen lds
    s_add_u32 m0, s28, 19456
    s_add_u32 s37, s3, 0x318000
    buffer_load_dwordx4 v19, s[96:99], s37 offen lds
    s_add_u32 m0, s28, 20480
    s_add_u32 s37, s3, 0x320000
    buffer_load_dwordx4 v16, s[96:99], s37 offen lds
    s_add_u32 m0, s28, 21504
    s_add_u32 s37, s3, 0x328000
    buffer_load_dwordx4 v17, s[96:99], s37 offen lds
    s_add_u32 m0, s28, 22528
    s_add_u32 s37, s3, 0x330000
    buffer_load_dwordx4 v18, s[96:99], s37 offen lds
    s_add_u32 m0, s28, 23552
    s_add_u32 s37, s3, 0x338000
    buffer_load_dwordx4 v19, s[96:99], s37 offen lds
    s_waitcnt vmcnt(17)
    v_perm_b32 v160, v49, v48, s34
    v_perm_b32 v161, v49, v48, s35
    v_perm_b32 v162, v51, v50, s34
    v_perm_b32 v163, v51, v50, s35
    v_perm_b32 v164, v53, v52, s34
    v_perm_b32 v165, v53, v52, s35
    v_perm_b32 v166, v55, v54, s34
    v_perm_b32 v167, v55, v54, s35
    v_perm_b32 v168, v57, v56, s34
    v_perm_b32 v169, v57, v56, s35
    v_perm_b32 v170, v59, v58, s34
    v_perm_b32 v171, v59, v58, s35
    v_perm_b32 v172, v61, v60, s34
    v_perm_b32 v173, v61, v60, s35
    v_perm_b32 v174, v63, v62, s34
    v_perm_b32 v175, v63, v62, s35
    s_waitcnt vmcnt(8)
    s_mov_b32 s41, 1
L_HS:
    v_cmp_eq_u32 vcc, 0, v30
    s_cbranch_vccz L_HS_ok
    buffer_load_dword v30, v31, s[16:19], 0 offen sc1
    s_add_u32 s32, s32, 1
    s_cmp_gt_u32 s32, 200000
    s_waitcnt vmcnt(0)
    s_cbranch_scc0 L_HS
    s_branch L_HS_done
L_HS_ok:
    v_readlane_b32 s36, v30, 63
    s_nop 1
    v_cmp_ne_u32 vcc, s36, v30
    s_nop 1
    s_cmp_lg_u32 vcc_hi, 0
    s_cselect_b32 s41, 1, 0
L_HS_done:
    s_mov_b32 s7, 0xf7df00
    buffer_load_dword v15, v0, s[8:11], s7 offen sc1
    s_barrier
    ds_read_b64_tr_b16 v[36:37], v20 offset:0
    ds_read_b64_tr_b16 v[38:39], v20 offset:512
    ds_read_b64_tr_b16 v[44:45], v21 offset:0
    ds_read_b64_tr_b16 v[46:47], v21 offset:512
    ds_read_b64_tr_b16 a[4:5], v22 offset:0
    ds_read_b64_tr_b16 a[6:7], v22 offset:512
    ds_read_b64_tr_b16 a[12:13], v23 offset:0
    ds_read_b64_tr_b16 a[14:15], v23 offset:512
    ds_read_b64_tr_b16 a[36:37], v24 offset:0
    ds_read_b64_tr_b16 a[38:39], v24 offset:512
    ds_read_b64_tr_b16 a[44:45], v25 offset:0
    ds_read_b64_tr_b16 a[46:47], v25 offset:512
    s_waitcnt lgkmcnt(4)
    ds_read_b64_tr_b16 a[68:69], v26 offset:0
    ds_read_b64_tr_b16 a[70:71], v26 offset:512
    ds_read_b64_tr_b16 a[76:77], v27 offset:0
    ds_read_b64_tr_b16 a[78:79], v27 offset:512
    s_waitcnt lgkmcnt(0)
    s_barrier
    s_barrier
    ds_read_b64_tr_b16 v[48:49], v20 offset:8192
    ds_read_b64_tr_b16 v[50:51], v20 offset:8704
    ds_read_b64_tr_b16 v[56:57], v21 offset:8192
    ds_read_b64_tr_b16 v[58:59], v21 offset:8704
    ds_read_b64_tr_b16 a[16:17], v22 offset:8192
    ds_read_b64_tr_b16 a[18:19], v22 offset:8704
    ds_read_b64_tr_b16 a[24:25], v23 offset:8192
    ds_read_b64_tr_b16 a[26:27], v23 offset:8704
    ds_read_b64_tr_b16 a[48:49], v24 offset:8192
    ds_read_b64_tr_b16 a[50:51], v24 offset:8704
    ds_read_b64_tr_b16 a[56:57], v25 offset:8192
    ds_read_b64_tr_b16 a[58:59], v25 offset:8704
    s_waitcnt lgkmcnt(4)
    ds_read_b64_tr_b16 v[80:81], v26 offset:8192
    ds_read_b64_tr_b16 v[82:83], v26 offset:8704
    ds_read_b64_tr_b16 v[88:89], v27 offset:8192
    ds_read_b64_tr_b16 v[90:91], v27 offset:8704
    s_waitcnt lgkmcnt(0)
    s_barrier
    s_waitcnt vmcnt(0)
L_F0:
    v_readlane_b32 s36, v15, 33
    s_nop 1
    s_cmp_lg_u32 s36, 0
    s_cbranch_scc1 L_F0_ok
    buffer_load_dword v15, v0, s[8:11], s7 offen sc1
    s_add_u32 s32, s32, 1
    s_cmp_gt_u32 s32, 200000
    s_waitcnt vmcnt(0)
    s_cbranch_scc0 L_F0
L_F0_ok:
    s_mov_b32 s7, 0x1000000
    buffer_load_dword v15, v0, s[8:11], s7 offen sc1
    s_barrier
    ds_read_b64_tr_b16 v[52:53], v20 offset:16384
    ds_read_b64_tr_b16 v[54:55], v20 offset:16896
    ds_read_b64_tr_b16 v[60:61], v21 offset:16384
    ds_read_b64_tr_b16 v[62:63], v21 offset:16896
    ds_read_b64_tr_b16 a[20:21], v22 offset:16384
    ds_read_b64_tr_b16 a[22:23], v22 offset:16896
    ds_read_b64_tr_b16 a[28:29], v23 offset:16384
    ds_read_b64_tr_b16 a[30:31], v23 offset:16896
    ds_read_b64_tr_b16 a[52:53], v24 offset:16384
    ds_read_b64_tr_b16 a[54:55], v24 offset:16896
    ds_read_b64_tr_b16 a[60:61], v25 offset:16384
    ds_read_b64_tr_b16 a[62:63], v25 offset:16896
    s_waitcnt lgkmcnt(4)
    ds_read_b64_tr_b16 v[84:85], v26 offset:16384
    ds_read_b64_tr_b16 v[86:87], v26 offset:16896
    ds_read_b64_tr_b16 v[92:93], v27 offset:16384
    ds_read_b64_tr_b16 v[94:95], v27 offset:16896
    s_waitcnt lgkmcnt(0)
    s_barrier
    ds_write_b128 v4, v[32:35] offset:0
    ds_write_b128 v4, v[36:39] offset:1024
    ds_write_b128 v4, v[40:43] offset:2048
    ds_write_b128 v4, v[44:47] offset:3072
    ds_write_b128 v4, v[48:51] offset:4096
    ds_write_b128 v4, v[52:55] offset:5120
    ds_write_b128 v4, v[56:59] offset:6144
    ds_write_b128 v4, v[60:63] offset:7168
    s_waitcnt lgkmcnt(0)
    ds_write_b128 v4, v[64:67] offset:8192
    ds_write_b128 v4, v[68:71] offset:9216
    ds_write_b128 v4, v[72:75] offset:10240
    ds_write_b128 v4, v[76:79] offset:11264
    ds_write_b128 v4, v[80:83] offset:12288
    ds_write_b128 v4, v[84:87] offset:13312
    ds_write_b128 v4, v[88:91] offset:14336
    ds_write_b128 v4, v[92:95] offset:15360
    s_waitcnt lgkmcnt(0)
    ds_write_b128 v4, v[96:99] offset:16384
    ds_write_b128 v4, v[100:103] offset:17408
    ds_write_b128 v4, v[104:107] offset:18432
    ds_write_b128 v4, v[108:111] offset:19456
    ds_write_b128 v4, v[112:115] offset:20480
    ds_write_b128 v4, v[116:119] offset:21504
    ds_write_b128 v4, v[120:123] offset:22528
    ds_write_b128 v4, v[124:127] offset:23552
    s_waitcnt lgkmcnt(0)
    s_waitcnt lgkmcnt(0)
    s_cmp_lg_u32 s41, 0
    s_cbranch_scc1 L_slow_start
L_fast_start:
    s_mov_b32 s22, 0
    s_mov_b32 s23, 0x1000000
    s_mov_b32 s27, 0
    s_mov_b32 s31, 0x80000
    s_mov_b32 s61, 0x40000000
    s_mov_b32 s96, 0x800
    s_mov_b32 s97, 0x1000
    s_mov_b32 s98, 0x1800
    s_mov_b32 s92, 0xcccccccc
    s_mov_b32 s93, 0xcccccccc
    s_mov_b32 s91, 0
    ds_read_b128 v[104:107], v4 offset:0
    ds_read_b128 v[108:111], v4 offset:1024
    ds_read_b128 v[112:115], v4 offset:2048
    ds_read_b128 v[116:119], v4 offset:3072
    ds_read_b128 v[88:91], v4 offset:4096
    ds_read_b128 v[92:95], v4 offset:5120
    ds_read_b128 v[96:99], v4 offset:6144
    ds_read_b128 v[100:103], v4 offset:7168
    ds_read_b128 v[72:75], v4 offset:8192
    ds_read_b128 v[76:79], v4 offset:9216
    ds_read_b128 v[80:83], v4 offset:10240
    ds_read_b128 v[84:87], v4 offset:11264
    v_mov_b64 v[48:49], 0
    v_mov_b64 v[50:51], 0
    v_mov_b64 v[52:53], 0
    v_mov_b64 v[54:55], 0
    v_mov_b64 v[56:57], 0
    v_mov_b64 v[58:59], 0
    v_mov_b64 v[60:61], 0
    v_mov_b64 v[62:63], 0
    v_mov_b64 v[64:65], 0
    v_mov_b64 v[66:67], 0
    v_mov_b64 v[68:69], 0
    v_mov_b64 v[70:71], 0
    s_add_u32 s7, s23, 0x80000
    buffer_load_dwordx4 v[16:19], v2, s[8:11], s7 offen sc1
    buffer_load_dwordx4 v[20:23], v2, s[8:11], s7 offen offset:1024 sc1
    s_waitcnt vmcnt(2)
L_fast_step:
    v_readlane_b32 s36, v15, 33
    s_add_u32 s24, s23, 0x82100
    s_cmp_eq_u32 s36, 0
    s_cbranch_scc1 L_fast_refresh
L_fast_fresh:
    s_add_u32 s29, s23, s25
    s_add_u32 s30, s23, s39
    s_xor_b32 s28, s27, 1
    s_add_u32 s90, s22, 1
    s_nop 15
L_fast_retrym:
    buffer_load_dwordx4 v[16:19], v2, s[8:11], s7 offen sc1
    buffer_load_dwordx4 v[20:23], v2, s[8:11], s7 offen offset:1024 sc1
L_fast_prem:
    s_add_u32 s32, s32, 1
    s_cmp_gt_u32 s32, 200000
    s_cselect_b32 s94, -1, -2
    v_xor_b32 v28, 0x800, v2
    v_xor_b32 v44, 0x1800, v2
    v_mov_b64 v[48:49], 0
    v_mov_b64 v[50:51], 0
    v_mov_b64 v[52:53], 0
    v_mov_b64 v[54:55], 0
L_fast_waitm:
    s_waitcnt vmcnt(3) lgkmcnt(0)
L_fast_gotm:
    v_max3_u32 v14, v16, v17, v18
    v_max_u32 v14, v14, v19
    v_smfmac_f32_16x16x64_bf16 v[48:51], v[16:19], v[104:111], v1
    s_waitcnt vmcnt(2)
    v_max3_u32 v14, v14, v20, v21
    v_smfmac_f32_16x16x64_bf16 v[52:55], v[16:19], v[112:119], v1
    v_max3_u32 v14, v14, v22, v23
    v_cmp_lt_u32 vcc, s94, v14
    v_smfmac_f32_16x16x64_bf16 v[48:51], v[20:23], v[88:95], v1
    ds_write_b128 v2, v[16:19] offset:0
    s_cbranch_vccnz L_fast_retrym
    v_smfmac_f32_16x16x64_bf16 v[52:55], v[20:23], v[96:103], v1
    ds_write_b128 v2, v[20:23] offset:1024
    v_smfmac_f32_16x16x64_bf16 v[56:59], v[16:19], v[72:79], v1
    buffer_load_dwordx4 v[104:107], v3, s[8:11], s29 offen offset:0 sc1
    buffer_load_dwordx4 v[120:123], v3, s[8:11], s30 offen offset:0 sc1
    v_smfmac_f32_16x16x64_bf16 v[60:63], v[16:19], v[80:87], v1
    buffer_load_dwordx4 v[108:111], v3, s[8:11], s29 offen offset:1024 sc1
    buffer_load_dwordx4 v[124:127], v3, s[8:11], s30 offen offset:1024 sc1
    v_smfmac_f32_16x16x64_bf16 v[56:59], v[20:23], a[80:87], v1
    buffer_load_dwordx4 v[112:115], v3, s[8:11], s29 offen offset:2048 sc1
    buffer_load_dwordx4 v[116:119], v3, s[8:11], s29 offen offset:3072 sc1
    v_smfmac_f32_16x16x64_bf16 v[60:63], v[20:23], a[88:95], v1
    s_waitcnt lgkmcnt(0)
    s_barrier
    ds_read_b128 v[24:27], v28 offset:0
    v_smfmac_f32_16x16x64_bf16 v[64:67], v[16:19], a[160:167], v1
    ds_read_b128 v[28:31], v28 offset:1024
    v_smfmac_f32_16x16x64_bf16 v[68:71], v[16:19], a[168:175], v1
    buffer_load_dword v15, v0, s[8:11], s24 offen sc1
    v_smfmac_f32_16x16x64_bf16 v[64:67], v[20:23], a[176:183], v1
    ds_read_b128 v[32:35], v8 offset:0
    v_smfmac_f32_16x16x64_bf16 v[68:71], v[20:23], a[184:191], v1
    ds_read_b128 v[36:39], v8 offset:1024
    s_waitcnt lgkmcnt(3)
    v_smfmac_f32_16x16x64_bf16 v[48:51], v[24:27], a[0:7], v1
    ds_read_b128 v[40:43], v44 offset:0
    v_smfmac_f32_16x16x64_bf16 v[52:55], v[24:27], a[8:15], v1
    ds_read_b128 v[44:47], v44 offset:1024
    s_waitcnt lgkmcnt(4)
    v_smfmac_f32_16x16x64_bf16 v[48:51], v[28:31], a[16:23], v1
    ds_read_b128 v[88:91], v4 offset:12288
    v_smfmac_f32_16x16x64_bf16 v[52:55], v[28:31], a[24:31], v1
    ds_read_b128 v[92:95], v4 offset:13312
    s_waitcnt lgkmcnt(4)
    v_smfmac_f32_16x16x64_bf16 v[48:51], v[32:35], a[32:39], v1
    ds_read_b128 v[96:99], v4 offset:14336
    v_smfmac_f32_16x16x64_bf16 v[52:55], v[32:35], a[40:47], v1
    ds_read_b128 v[100:103], v4 offset:15360
    s_waitcnt lgkmcnt(4)
    v_smfmac_f32_16x16x64_bf16 v[48:51], v[36:39], a[48:55], v1
    v_smfmac_f32_16x16x64_bf16 v[52:55], v[36:39], a[56:63], v1
    ds_read_b128 v[72:75], v4 offset:16384
    v_smfmac_f32_16x16x64_bf16 v[48:51], v[40:43], a[64:71], v1
    v_smfmac_f32_16x16x64_bf16 v[52:55], v[40:43], a[72:79], v1
    ds_read_b128 v[76:79], v4 offset:17408
    s_waitcnt lgkmcnt(2)
    v_smfmac_f32_16x16x64_bf16 v[48:51], v[44:47], v[88:95], v1
    ds_read_b128 v[80:83], v4 offset:18432
    v_smfmac_f32_16x16x64_bf16 v[52:55], v[44:47], v[96:103], v1
    ds_read_b128 v[84:87], v4 offset:19456
    v_smfmac_f32_16x16x64_bf16 v[56:59], v[28:31], a[96:103], v1
    ds_read_b128 v[88:91], v4 offset:20480
    v_smfmac_f32_16x16x64_bf16 v[60:63], v[28:31], a[104:111], v1
    ds_read_b128 v[92:95], v4 offset:21504
    v_smfmac_f32_16x16x64_bf16 v[56:59], v[32:35], a[112:119], v1
    ds_read_b128 v[96:99], v4 offset:22528
    v_add_f32 v48, v48, v50
    v_add_f32 v49, v49, v51
    v_smfmac_f32_16x16x64_bf16 v[60:63], v[32:35], a[120:127], v1
    ds_read_b128 v[100:103], v4 offset:23552
    v_add_f32 v52, v52, v54
    v_add_f32 v53, v53, v55
    v_smfmac_f32_16x16x64_bf16 v[56:59], v[36:39], a[128:135], v1
    s_waitcnt lgkmcnt(4)
    v_cvt_pk_bf16_f32 v50, v48, v52
    v_cvt_pk_bf16_f32 v51, v49, v53
    v_smfmac_f32_16x16x64_bf16 v[56:59], v[24:27], v[72:79], v1
    ds_write2_b32 v5, v50, v51 offset0:0 offset1:72
    v_smfmac_f32_16x16x64_bf16 v[60:63], v[24:27], v[80:87], v1
    v_smfmac_f32_16x16x64_bf16 v[60:63], v[36:39], a[136:143], v1
    v_smfmac_f32_16x16x64_bf16 v[56:59], v[40:43], a[144:151], v1
    buffer_store_dword v12, v10, s[8:11], s31 offen sc1
    v_smfmac_f32_16x16x64_bf16 v[60:63], v[40:43], a[152:159], v1
    s_waitcnt lgkmcnt(0)
    s_barrier
    v_smfmac_f32_16x16x64_bf16 v[56:59], v[44:47], v[88:95], v1
    ds_read_b128 v[72:75], v6 offset:0
    v_smfmac_f32_16x16x64_bf16 v[60:63], v[44:47], v[96:103], v1
    ds_read_b128 v[76:79], v6 offset:64
    v_smfmac_f32_16x16x64_bf16 v[64:67], v[24:27], a[192:199], v1
    ds_read_b128 v[80:83], v6 offset:128
    v_smfmac_f32_16x16x64_bf16 v[68:71], v[24:27], a[200:207], v1
    ds_read_b128 v[84:87], v6 offset:192
    s_waitcnt vmcnt(2) lgkmcnt(3)
    v_mfma_f32_16x16x32_bf16 v[48:51], v[104:107], v[72:75], 0
    s_waitcnt lgkmcnt(2)
    v_add_f32 v56, v56, v58
    v_add_f32 v57, v57, v59
    v_mfma_f32_16x16x32_bf16 v[48:51], v[108:111], v[76:79], v[48:51]
    s_waitcnt lgkmcnt(1)
    v_add_f32 v60, v60, v62
    v_add_f32 v61, v61, v63
    v_mfma_f32_16x16x32_bf16 v[48:51], v[112:115], v[80:83], v[48:51]
    s_waitcnt lgkmcnt(0)
    v_cvt_pk_bf16_f32 v58, v56, v60
    v_cvt_pk_bf16_f32 v59, v57, v61
    v_mfma_f32_16x16x32_bf16 v[48:51], v[116:119], v[84:87], v[48:51]
    ds_write2_b32 v7, v58, v59 offset0:0 offset1:72
    v_smfmac_f32_16x16x64_bf16 v[64:67], v[28:31], a[208:215], v1
    v_mov_b64 v[104:105], s[4:5]
    v_smfmac_f32_16x16x64_bf16 v[68:71], v[28:31], a[216:223], v1
    s_nop 1
    v_mov_b64 v[106:107], s[4:5]
    v_smfmac_f32_16x16x64_bf16 v[64:67], v[32:35], a[224:231], v1
    v_exp_f32 v48, v48
    v_smfmac_f32_16x16x64_bf16 v[68:71], v[32:35], a[232:239], v1
    s_waitcnt lgkmcnt(0)
    s_barrier
    v_exp_f32 v49, v49
    v_smfmac_f32_16x16x64_bf16 v[64:67], v[36:39], a[240:247], v1
    ds_read_b128 v[88:91], v6 offset:2304
    v_exp_f32 v50, v50
    v_smfmac_f32_16x16x64_bf16 v[68:71], v[36:39], a[248:255], v1
    ds_read_b128 v[92:95], v6 offset:2368
    v_exp_f32 v51, v51
    v_smfmac_f32_16x16x64_bf16 v[64:67], v[40:43], v[128:135], v1
    ds_read_b128 v[96:99], v6 offset:2432
    v_cvt_pk_bf16_f32 v108, v48, v49
    v_cvt_pk_bf16_f32 v109, v50, v51
    v_smfmac_f32_16x16x64_bf16 v[68:71], v[40:43], v[136:143], v1
    ds_read_b128 v[100:103], v6 offset:2496
    ds_write_b64 v2, v[108:109] offset:8192
    s_waitcnt lgkmcnt(4)
    v_mfma_f32_16x16x32_bf16 v[52:55], v[88:91], v[72:75], 0
    s_waitcnt lgkmcnt(3)
    v_mov_b32 v113, 0
    v_mov_b32 v115, 0
    v_mfma_f32_16x16x32_bf16 v[52:55], v[92:95], v[76:79], v[52:55]
    s_waitcnt lgkmcnt(2)
    v_mov_b32 v117, 0
    v_mov_b64 v[16:17], 0
    v_mfma_f32_16x16x32_bf16 v[52:55], v[96:99], v[80:83], v[52:55]
    s_waitcnt lgkmcnt(1)
    v_mov_b64 v[18:19], 0
    v_mov_b64 v[20:21], 0
    v_mfma_f32_16x16x32_bf16 v[52:55], v[100:103], v[84:87], v[52:55]
    s_waitcnt lgkmcnt(0)
    s_barrier
    v_smfmac_f32_16x16x64_bf16 v[64:67], v[44:47], v[144:151], v1
    ds_read_b64 v[110:111], v8 offset:8192
    v_mov_b64 v[22:23], 0
    v_smfmac_f32_16x16x64_bf16 v[68:71], v[44:47], v[152:159], v1
    v_mov_b64 v[24:25], 0
    v_mov_b64 v[26:27], 0
    v_mul_f32 v52, s33, v52
    v_mul_f32 v53, s33, v53
    v_exp_f32 v52, v52
    s_waitcnt lgkmcnt(0)
    v_mfma_f32_16x16x32_bf16 v[48:51], v[104:107], v[108:111], 0
    v_exp_f32 v53, v53
    v_add_f32 v64, v64, v66
    v_mfma_f32_16x16x32_bf16 v[56:59], v[120:123], v[108:111], 0
    v_cvt_pk_bf16_f32 v112, v52, v53
    v_add_f32 v65, v65, v67
    v_mfma_f32_16x16x32_bf16 v[60:63], v[124:127], v[108:111], 0
    v_cvt_pk_bf16_f32 v114, v64, v65
    v_add_f32 v68, v68, v70
    v_mfma_f32_16x16x16_bf16 v[48:51], v[104:105], v[112:113], v[48:51]
    v_add_f32 v69, v69, v71
    v_cvt_pk_bf16_f32 v116, v68, v69
    v_mfma_f32_16x16x16_bf16 v[56:59], v[114:115], v[112:113], v[56:59]
    v_mov_b64 v[28:29], 0
    v_mov_b64 v[30:31], 0
    v_mfma_f32_16x16x16_bf16 v[60:63], v[116:117], v[112:113], v[60:63]
    v_bitop3_b32 v32, v13, s96, -9 bitop3:0x28
    v_bitop3_b32 v36, v13, s97, -9 bitop3:0x28
    v_rcp_f32 v118, v48
    v_bitop3_b32 v40, v13, s98, -9 bitop3:0x28
    v_max_f32 v14, v118, v48
    v_cmp_nge_f32 vcc, s40, v14
    v_pk_mul_f32 v[56:57], v[56:57], v[118:119] op_sel_hi:[1,0]
    v_pk_mul_f32 v[58:59], v[58:59], v[118:119] op_sel_hi:[1,0]
    v_pk_mul_f32 v[60:61], v[60:61], v[118:119] op_sel_hi:[1,0]
    v_pk_mul_f32 v[62:63], v[62:63], v[118:119] op_sel_hi:[1,0]
    v_cvt_pk_bf16_f32 v52, v56, v60
    v_cvt_pk_bf16_f32 v54, v58, v62
    v_cvt_pk_bf16_f32 v53, v57, v61
    v_cvt_pk_bf16_f32 v55, v59, v63
L_fast_rejoin:
    v_cndmask_b32 v50, v52, v54, s[92:93]
    v_cndmask_b32 v51, v53, v55, s[92:93]
    ds_write_b64 v13, v[50:51] offset:9216
    v_smfmac_f32_16x16x64_bf16 v[16:19], v[52:55], v[160:167], v1
    v_smfmac_f32_16x16x64_bf16 v[20:23], v[52:55], v[168:175], v1
    s_waitcnt lgkmcnt(0)
    s_barrier
    ds_read_b128 v[32:35], v32 offset:9216
    ds_read_b128 v[36:39], v36 offset:9216
    v_smfmac_f32_16x16x64_bf16 v[24:27], v[52:55], v[176:183], v1
    ds_read_b128 v[40:43], v40 offset:9216
    v_smfmac_f32_16x16x64_bf16 v[28:31], v[52:55], v[184:191], v1
    ds_read_b128 v[88:91], v4 offset:24576
    ds_read_b128 v[92:95], v4 offset:25600
    s_waitcnt lgkmcnt(4)
    v_smfmac_f32_16x16x64_bf16 v[16:19], v[32:35], v[192:199], v1
    ds_read_b128 v[96:99], v4 offset:26624
    s_waitcnt lgkmcnt(4)
    v_smfmac_f32_16x16x64_bf16 v[16:19], v[36:39], v[216:223], v1
    ds_read_b128 v[100:103], v4 offset:27648
    s_waitcnt lgkmcnt(4)
    v_smfmac_f32_16x16x64_bf16 v[16:19], v[40:43], v[240:247], v1
    ds_read_b128 v[72:75], v4 offset:28672
    s_cmp_lg_u64 vcc, 0
    v_smfmac_f32_16x16x64_bf16 v[20:23], v[32:35], v[200:207], v1
    ds_read_b128 v[76:79], v4 offset:29696
    s_cselect_b32 s60, s28, s27
    v_smfmac_f32_16x16x64_bf16 v[20:23], v[36:39], v[224:231], v1
    ds_read_b128 v[80:83], v4 offset:30720
    s_nop 0
    v_cvt_pk_bf16_f32 v56, v16, v18
    v_smfmac_f32_16x16x64_bf16 v[20:23], v[40:43], v[248:255], v1
    ds_read_b128 v[84:87], v4 offset:31744
    v_cvt_pk_bf16_f32 v57, v17, v19
    v_and_or_b32 v56, v56, -2, s60
    v_smfmac_f32_16x16x64_bf16 v[24:27], v[32:35], v[208:215], v1
    buffer_store_dwordx2 v[56:57], v9, s[8:11], 0 offen offset:0
    v_smfmac_f32_16x16x64_bf16 v[24:27], v[36:39], v[232:239], v1
    s_waitcnt lgkmcnt(4)
    s_nop 0
    v_cvt_pk_bf16_f32 v58, v20, v22
    v_smfmac_f32_16x16x64_bf16 v[24:27], v[40:43], v[88:95], v1
    ds_read_b128 v[64:67], v3 offset:23040
    v_cvt_pk_bf16_f32 v59, v21, v23
    v_and_or_b32 v58, v58, -2, s60
    v_smfmac_f32_16x16x64_bf16 v[28:31], v[32:35], v[96:103], v1
    buffer_store_dwordx2 v[58:59], v9, s[8:11], 0 offen offset:2048
    s_waitcnt lgkmcnt(1)
    v_smfmac_f32_16x16x64_bf16 v[28:31], v[36:39], v[72:79], v1
    s_nop 1
    v_cvt_pk_bf16_f32 v60, v24, v26
    v_smfmac_f32_16x16x64_bf16 v[28:31], v[40:43], v[80:87], v1
    s_nop 2
    v_cvt_pk_bf16_f32 v61, v25, v27
    v_and_or_b32 v60, v60, -2, s60
    buffer_store_dwordx2 v[60:61], v9, s[8:11], s26 offen offset:0
    s_nop 1
    v_cvt_pk_bf16_f32 v62, v28, v30
    v_cvt_pk_bf16_f32 v63, v29, v31
    v_and_or_b32 v62, v62, -2, s60
    buffer_store_dwordx2 v[62:63], v9, s[8:11], s26 offen offset:2048
L_fast_stored:
    s_cmp_lg_u32 s60, s27
    s_cbranch_scc1 L_fast_safe
    ds_read_b128 v[104:107], v4 offset:0
    ds_read_b128 v[108:111], v4 offset:1024
    ds_read_b128 v[112:115], v4 offset:2048
    ds_read_b128 v[116:119], v4 offset:3072
    ds_read_b128 v[88:91], v4 offset:4096
    ds_read_b128 v[92:95], v4 offset:5120
    ds_read_b128 v[96:99], v4 offset:6144
    ds_read_b128 v[100:103], v4 offset:7168
    ds_read_b128 v[72:75], v4 offset:8192
    ds_read_b128 v[76:79], v4 offset:9216
    ds_read_b128 v[80:83], v4 offset:10240
    ds_read_b128 v[84:87], v4 offset:11264
    s_cmp_lt_u32 s21, 1
    s_cbranch_scc1 L_fast_pollp
    s_nop 13
    s_cmp_lt_u32 s21, 2
    s_cbranch_scc1 L_fast_pollp
    s_nop 13
    s_cmp_lt_u32 s21, 3
    s_cbranch_scc1 L_fast_pollp
    s_nop 13
L_fast_pollp:
    buffer_load_dwordx4 v[120:123], v2, s[8:11], s6 offen sc1
    buffer_load_dwordx4 v[124:127], v2, s[8:11], s6 offen offset:1024 sc1
    v_mov_b64 v[56:57], 0
    v_mov_b64 v[58:59], 0
    v_mov_b64 v[60:61], 0
    v_mov_b64 v[62:63], 0
    s_nop 15
    s_nop 15
    buffer_load_dwordx4 v[32:35], v2, s[8:11], s6 offen sc1
    buffer_load_dwordx4 v[36:39], v2, s[8:11], s6 offen offset:1024 sc1
L_fast_prep:
    s_add_u32 s7, s24, 0x80000
    s_waitcnt vmcnt(3) lgkmcnt(0)
    v_mfma_f32_16x16x32_bf16 v[68:71], v[64:67], v[120:123], 0
    v_bitop3_b32 v14, v120, v122, s27 bitop3:0x7e
    s_waitcnt vmcnt(2)
    v_mfma_f32_16x16x32_bf16 v[68:71], v[64:67], v[124:127], v[68:71]
    v_bitop3_b32 v11, v124, v126, s27 bitop3:0x7e
    v_bitop3_b32 v14, v14, v11, 1 bitop3:0xa8
    v_cmp_ne_u32 vcc, 0, v14
    s_nop 2
    s_cmp_eq_u64 vcc, 0
    s_cselect_b32 s36, s24, s61
    v_add_f32_dpp v68, v68, v68 row_ror:8 row_mask:0xf bank_mask:0xf
    v_add_f32_dpp v69, v69, v69 row_ror:8 row_mask:0xf bank_mask:0xf
    s_nop 0
    v_add_f32_dpp v68, v68, v68 row_ror:4 row_mask:0xf bank_mask:0xf
    v_add_f32_dpp v69, v69, v69 row_ror:4 row_mask:0xf bank_mask:0xf
    v_cvt_pk_bf16_f32 v12, v68, v69
    buffer_store_dword v12, v10, s[8:11], s36 offen
    s_cbranch_scc1 L_fast_gotp
L_fast_retryp:
    buffer_load_dwordx4 v[120:123], v2, s[8:11], s6 offen sc1
    buffer_load_dwordx4 v[124:127], v2, s[8:11], s6 offen offset:1024 sc1
    s_waitcnt vmcnt(4) lgkmcnt(0)
    v_mfma_f32_16x16x32_bf16 v[68:71], v[64:67], v[32:35], 0
    v_bitop3_b32 v14, v32, v34, s27 bitop3:0x7e
    s_waitcnt vmcnt(3)
    v_mfma_f32_16x16x32_bf16 v[68:71], v[64:67], v[36:39], v[68:71]
    v_bitop3_b32 v11, v36, v38, s27 bitop3:0x7e
    v_bitop3_b32 v14, v14, v11, 1 bitop3:0xa8
    v_cmp_ne_u32 vcc, 0, v14
    s_nop 2
    s_cmp_eq_u64 vcc, 0
    s_cselect_b32 s36, s24, s61
    v_add_f32_dpp v68, v68, v68 row_ror:8 row_mask:0xf bank_mask:0xf
    v_add_f32_dpp v69, v69, v69 row_ror:8 row_mask:0xf bank_mask:0xf
    s_nop 0
    v_add_f32_dpp v68, v68, v68 row_ror:4 row_mask:0xf bank_mask:0xf
    v_add_f32_dpp v69, v69, v69 row_ror:4 row_mask:0xf bank_mask:0xf
    v_cvt_pk_bf16_f32 v12, v68, v69
    buffer_store_dword v12, v10, s[8:11], s36 offen
    s_cbranch_scc1 L_fast_gotp
    buffer_load_dwordx4 v[32:35], v2, s[8:11], s6 offen sc1
    buffer_load_dwordx4 v[36:39], v2, s[8:11], s6 offen offset:1024 sc1
    s_waitcnt vmcnt(4) lgkmcnt(0)
    v_mfma_f32_16x16x32_bf16 v[68:71], v[64:67], v[120:123], 0
    v_bitop3_b32 v14, v120, v122, s27 bitop3:0x7e
    s_waitcnt vmcnt(3)
    v_mfma_f32_16x16x32_bf16 v[68:71], v[64:67], v[124:127], v[68:71]
    v_bitop3_b32 v11, v124, v126, s27 bitop3:0x7e
    v_bitop3_b32 v14, v14, v11, 1 bitop3:0xa8
    v_cmp_ne_u32 vcc, 0, v14
    s_nop 2
    s_cmp_eq_u64 vcc, 0
    s_cselect_b32 s36, s24, s61
    v_add_f32_dpp v68, v68, v68 row_ror:8 row_mask:0xf bank_mask:0xf
    v_add_f32_dpp v69, v69, v69 row_ror:8 row_mask:0xf bank_mask:0xf
    s_nop 0
    v_add_f32_dpp v68, v68, v68 row_ror:4 row_mask:0xf bank_mask:0xf
    v_add_f32_dpp v69, v69, v69 row_ror:4 row_mask:0xf bank_mask:0xf
    v_cvt_pk_bf16_f32 v12, v68, v69
    buffer_store_dword v12, v10, s[8:11], s36 offen
    s_cbranch_scc1 L_fast_gotp
    s_add_u32 s32, s32, 1
    s_cmp_le_u32 s32, 200000
    s_cbranch_scc1 L_fast_retryp
    s_mov_b32 s36, s24
    buffer_store_dword v12, v10, s[8:11], s36 offen
L_fast_gotp:
    s_add_u32 s31, s31, 0x2000
    s_cmp_ge_u32 s90, 63
    s_cbranch_scc1 L_fast_last
    s_mov_b32 s23, s24
    s_mov_b32 s22, s90
    s_mov_b32 s27, s28
    v_mov_b64 v[64:65], 0
    v_mov_b64 v[66:67], 0
    v_mov_b64 v[68:69], 0
    v_mov_b64 v[70:71], 0
    s_nop 15
    s_nop 11
    buffer_load_dwordx4 v[16:19], v2, s[8:11], s7 offen sc1
    buffer_load_dwordx4 v[20:23], v2, s[8:11], s7 offen offset:1024 sc1
    s_branch L_fast_step
L_fast_last:
    buffer_store_dword v12, v10, s[8:11], s31 offen sc1
    s_branch L_fast_done
L_fast_refresh:
    buffer_load_dword v15, v0, s[8:11], s23 offen sc1
    s_add_u32 s32, s32, 1
    s_cmp_le_u32 s32, 200000
    s_waitcnt vmcnt(0)
    s_cbranch_scc1 L_fast_step
    s_branch L_fast_fresh
L_fast_safe:
    s_nop 11
    s_waitcnt vmcnt(0) lgkmcnt(0)
    s_barrier
    ds_read_b128 v[72:75], v6 offset:0
    ds_read_b128 v[88:91], v6 offset:2304
    ds_read_b128 v[76:79], v6 offset:64
    ds_read_b128 v[92:95], v6 offset:2368
    ds_read_b128 v[80:83], v6 offset:128
    ds_read_b128 v[96:99], v6 offset:2432
    ds_read_b128 v[84:87], v6 offset:192
    ds_read_b128 v[100:103], v6 offset:2496
    s_xor_b32 s36, s25, 0x1000
    s_add_u32 s36, s36, s23
    buffer_load_dwordx4 v[16:19], v3, s[8:11], s29 offen offset:0 sc1
    buffer_load_dwordx4 v[32:35], v3, s[8:11], s36 offen offset:0 sc1
    buffer_load_dwordx4 v[20:23], v3, s[8:11], s29 offen offset:1024 sc1
    buffer_load_dwordx4 v[36:39], v3, s[8:11], s36 offen offset:1024 sc1
    buffer_load_dwordx4 v[24:27], v3, s[8:11], s29 offen offset:2048 sc1
    buffer_load_dwordx4 v[40:43], v3, s[8:11], s36 offen offset:2048 sc1
    buffer_load_dwordx4 v[28:31], v3, s[8:11], s29 offen offset:3072 sc1
    buffer_load_dwordx4 v[44:47], v3, s[8:11], s36 offen offset:3072 sc1
    s_waitcnt vmcnt(0) lgkmcnt(0)
    v_mfma_f32_16x16x32_bf16 v[48:51], v[16:19], v[72:75], 0
    v_mfma_f32_16x16x32_bf16 v[48:51], v[20:23], v[76:79], v[48:51]
    v_mfma_f32_16x16x32_bf16 v[48:51], v[24:27], v[80:83], v[48:51]
    v_mfma_f32_16x16x32_bf16 v[48:51], v[28:31], v[84:87], v[48:51]
    v_mfma_f32_16x16x32_bf16 v[52:55], v[32:35], v[72:75], 0
    v_mfma_f32_16x16x32_bf16 v[52:55], v[36:39], v[76:79], v[52:55]
    v_mfma_f32_16x16x32_bf16 v[52:55], v[40:43], v[80:83], v[52:55]
    v_mfma_f32_16x16x32_bf16 v[52:55], v[44:47], v[84:87], v[52:55]
    v_mfma_f32_16x16x32_bf16 v[56:59], v[88:91], v[72:75], 0
    v_mfma_f32_16x16x32_bf16 v[56:59], v[92:95], v[76:79], v[56:59]
    v_mfma_f32_16x16x32_bf16 v[56:59], v[96:99], v[80:83], v[56:59]
    v_mfma_f32_16x16x32_bf16 v[56:59], v[100:103], v[84:87], v[56:59]
    s_nop 7
    v_mul_f32 v56, s33, v56
    v_mul_f32 v57, s33, v57
    v_max3_f32 v16, v48, v49, v50
    v_max3_f32 v16, v16, v51, v52
    v_max3_f32 v16, v16, v53, v54
    v_max3_f32 v16, v16, v55, v56
    v_max_f32 v16, v16, v57
    v_mov_b32 v17, v16
    s_nop 1
    v_permlane16_swap_b32 v16, v17
    v_max_f32 v16, v16, v17
    v_mov_b32 v17, v16
    s_nop 1
    v_permlane32_swap_b32 v16, v17
    v_max_f32 v16, v16, v17
    v_sub_f32 v48, v48, v16
    v_exp_f32 v48, v48
    v_sub_f32 v49, v49, v16
    v_exp_f32 v49, v49
    v_sub_f32 v50, v50, v16
    v_exp_f32 v50, v50
    v_sub_f32 v51, v51, v16
    v_exp_f32 v51, v51
    v_sub_f32 v52, v52, v16
    v_exp_f32 v52, v52
    v_sub_f32 v53, v53, v16
    v_exp_f32 v53, v53
    v_sub_f32 v54, v54, v16
    v_exp_f32 v54, v54
    v_sub_f32 v55, v55, v16
    v_exp_f32 v55, v55
    v_sub_f32 v56, v56, v16
    v_exp_f32 v56, v56
    v_sub_f32 v57, v57, v16
    v_exp_f32 v57, v57
    v_cvt_pk_bf16_f32 v108, v48, v49
    v_cvt_pk_bf16_f32 v109, v50, v51
    v_cvt_pk_bf16_f32 v110, v52, v53
    v_cvt_pk_bf16_f32 v111, v54, v55
    v_cvt_pk_bf16_f32 v112, v56, v57
    s_nop 0
    v_mfma_f32_16x16x32_bf16 v[48:51], v[104:107], v[108:111], 0
    v_mfma_f32_16x16x32_bf16 v[56:59], v[120:123], v[108:111], 0
    v_mfma_f32_16x16x32_bf16 v[60:63], v[124:127], v[108:111], 0
    s_nop 3
    v_mfma_f32_16x16x16_bf16 v[48:51], v[104:105], v[112:113], v[48:51]
    v_mfma_f32_16x16x16_bf16 v[56:59], v[114:115], v[112:113], v[56:59]
    v_mfma_f32_16x16x16_bf16 v[60:63], v[116:117], v[112:113], v[60:63]
    s_nop 5
    v_rcp_f32 v118, v48
    s_nop 0
    v_mul_f32 v56, v56, v118
    v_mul_f32 v57, v57, v118
    v_mul_f32 v58, v58, v118
    v_mul_f32 v59, v59, v118
    v_mul_f32 v60, v60, v118
    v_mul_f32 v61, v61, v118
    v_mul_f32 v62, v62, v118
    v_mul_f32 v63, v63, v118
    v_cvt_pk_bf16_f32 v52, v56, v60
    v_cvt_pk_bf16_f32 v53, v57, v61
    v_cvt_pk_bf16_f32 v54, v58, v62
    v_cvt_pk_bf16_f32 v55, v59, v63
    v_mov_b32 v16, 0
    v_mov_b32 v17, 0
    v_mov_b32 v18, 0
    v_mov_b32 v19, 0
    v_mov_b32 v20, 0
    v_mov_b32 v21, 0
    v_mov_b32 v22, 0
    v_mov_b32 v23, 0
    v_mov_b32 v24, 0
    v_mov_b32 v25, 0
    v_mov_b32 v26, 0
    v_mov_b32 v27, 0
    v_mov_b32 v28, 0
    v_mov_b32 v29, 0
    v_mov_b32 v30, 0
    v_mov_b32 v31, 0
    v_bitop3_b32 v32, v13, s96, -9 bitop3:0x28
    v_bitop3_b32 v36, v13, s97, -9 bitop3:0x28
    v_bitop3_b32 v40, v13, s98, -9 bitop3:0x28
    s_mov_b64 vcc, 0
    s_branch L_fast_rejoin
L_fast_done:
    s_branch L_end
L_slow_start:
    s_mov_b32 s22, 0
    s_mov_b32 s23, 0x1000000
    s_mov_b32 s27, 0
    s_mov_b32 s31, 0x80000
    s_mov_b32 s61, 0x40000000
    s_mov_b32 s96, 0x800
    s_mov_b32 s97, 0x1000
    s_mov_b32 s98, 0x1800
    s_mov_b32 s92, 0xcccccccc
    s_mov_b32 s93, 0xcccccccc
    s_mov_b32 s91, 0
    ds_read_b128 v[104:107], v4 offset:0
    ds_read_b128 v[108:111], v4 offset:1024
    ds_read_b128 v[112:115], v4 offset:2048
    ds_read_b128 v[116:119], v4 offset:3072
    ds_read_b128 v[88:91], v4 offset:4096
    ds_read_b128 v[92:95], v4 offset:5120
    ds_read_b128 v[96:99], v4 offset:6144
    ds_read_b128 v[100:103], v4 offset:7168
    ds_read_b128 v[72:75], v4 offset:8192
    ds_read_b128 v[76:79], v4 offset:9216
    ds_read_b128 v[80:83], v4 offset:10240
    ds_read_b128 v[84:87], v4 offset:11264
    v_mov_b64 v[48:49], 0
    v_mov_b64 v[50:51], 0
    v_mov_b64 v[52:53], 0
    v_mov_b64 v[54:55], 0
    v_mov_b64 v[56:57], 0
    v_mov_b64 v[58:59], 0
    v_mov_b64 v[60:61], 0
    v_mov_b64 v[62:63], 0
    v_mov_b64 v[64:65], 0
    v_mov_b64 v[66:67], 0
    v_mov_b64 v[68:69], 0
    v_mov_b64 v[70:71], 0
    s_add_u32 s7, s23, 0x80000
    buffer_load_dwordx4 v[16:19], v2, s[8:11], s7 offen sc1
    buffer_load_dwordx4 v[20:23], v2, s[8:11], s7 offen offset:1024 sc1
    s_waitcnt vmcnt(2)
L_slow_step:
    v_readlane_b32 s36, v15, 33
    s_add_u32 s24, s23, 0x82100
    s_cmp_eq_u32 s36, 0
    s_cbranch_scc1 L_slow_refresh
L_slow_fresh:
    s_add_u32 s29, s23, s25
    s_add_u32 s30, s23, s39
    s_xor_b32 s28, s27, 1
    s_add_u32 s90, s22, 1
    s_nop 15
L_slow_retrym:
    buffer_load_dwordx4 v[16:19], v2, s[8:11], s7 offen sc1
    buffer_load_dwordx4 v[20:23], v2, s[8:11], s7 offen offset:1024 sc1
L_slow_prem:
    s_add_u32 s32, s32, 1
    s_cmp_gt_u32 s32, 200000
    s_cselect_b32 s94, -1, -2
    v_xor_b32 v28, 0x800, v2
    v_xor_b32 v44, 0x1800, v2
    v_mov_b64 v[48:49], 0
    v_mov_b64 v[50:51], 0
    v_mov_b64 v[52:53], 0
    v_mov_b64 v[54:55], 0
L_slow_waitm:
    s_waitcnt vmcnt(3) lgkmcnt(0)
L_slow_gotm:
    v_max3_u32 v14, v16, v17, v18
    v_max_u32 v14, v14, v19
    v_smfmac_f32_16x16x64_bf16 v[48:51], v[16:19], v[104:111], v1
    s_waitcnt vmcnt(2)
    v_max3_u32 v14, v14, v20, v21
    v_smfmac_f32_16x16x64_bf16 v[52:55], v[16:19], v[112:119], v1
    v_max3_u32 v14, v14, v22, v23
    v_cmp_lt_u32 vcc, s94, v14
    v_smfmac_f32_16x16x64_bf16 v[48:51], v[20:23], v[88:95], v1
    ds_write_b128 v2, v[16:19] offset:0
    s_cbranch_vccnz L_slow_retrym
    v_smfmac_f32_16x16x64_bf16 v[52:55], v[20:23], v[96:103], v1
    ds_write_b128 v2, v[20:23] offset:1024
    v_smfmac_f32_16x16x64_bf16 v[56:59], v[16:19], v[72:79], v1
    buffer_load_dwordx4 v[104:107], v3, s[8:11], s29 offen offset:0 sc1
    buffer_load_dwordx4 v[120:123], v3, s[8:11], s30 offen offset:0 sc1
    v_smfmac_f32_16x16x64_bf16 v[60:63], v[16:19], v[80:87], v1
    buffer_load_dwordx4 v[108:111], v3, s[8:11], s29 offen offset:1024 sc1
    buffer_load_dwordx4 v[124:127], v3, s[8:11], s30 offen offset:1024 sc1
    v_smfmac_f32_16x16x64_bf16 v[56:59], v[20:23], a[80:87], v1
    buffer_load_dwordx4 v[112:115], v3, s[8:11], s29 offen offset:2048 sc1
    buffer_load_dwordx4 v[116:119], v3, s[8:11], s29 offen offset:3072 sc1
    v_smfmac_f32_16x16x64_bf16 v[60:63], v[20:23], a[88:95], v1
    s_waitcnt lgkmcnt(0)
    s_barrier
    ds_read_b128 v[24:27], v28 offset:0
    v_smfmac_f32_16x16x64_bf16 v[64:67], v[16:19], a[160:167], v1
    ds_read_b128 v[28:31], v28 offset:1024
    v_smfmac_f32_16x16x64_bf16 v[68:71], v[16:19], a[168:175], v1
    buffer_load_dword v15, v0, s[8:11], s24 offen sc1
    v_smfmac_f32_16x16x64_bf16 v[64:67], v[20:23], a[176:183], v1
    ds_read_b128 v[32:35], v8 offset:0
    v_smfmac_f32_16x16x64_bf16 v[68:71], v[20:23], a[184:191], v1
    ds_read_b128 v[36:39], v8 offset:1024
    s_waitcnt lgkmcnt(3)
    v_smfmac_f32_16x16x64_bf16 v[48:51], v[24:27], a[0:7], v1
    ds_read_b128 v[40:43], v44 offset:0
    v_smfmac_f32_16x16x64_bf16 v[52:55], v[24:27], a[8:15], v1
    ds_read_b128 v[44:47], v44 offset:1024
    s_waitcnt lgkmcnt(4)
    v_smfmac_f32_16x16x64_bf16 v[48:51], v[28:31], a[16:23], v1
    ds_read_b128 v[88:91], v4 offset:12288
    v_smfmac_f32_16x16x64_bf16 v[52:55], v[28:31], a[24:31], v1
    ds_read_b128 v[92:95], v4 offset:13312
    s_waitcnt lgkmcnt(4)
    v_smfmac_f32_16x16x64_bf16 v[48:51], v[32:35], a[32:39], v1
    ds_read_b128 v[96:99], v4 offset:14336
    v_smfmac_f32_16x16x64_bf16 v[52:55], v[32:35], a[40:47], v1
    ds_read_b128 v[100:103], v4 offset:15360
    s_waitcnt lgkmcnt(4)
    v_smfmac_f32_16x16x64_bf16 v[48:51], v[36:39], a[48:55], v1
    v_smfmac_f32_16x16x64_bf16 v[52:55], v[36:39], a[56:63], v1
    ds_read_b128 v[72:75], v4 offset:16384
    v_smfmac_f32_16x16x64_bf16 v[48:51], v[40:43], a[64:71], v1
    v_smfmac_f32_16x16x64_bf16 v[52:55], v[40:43], a[72:79], v1
    ds_read_b128 v[76:79], v4 offset:17408
    s_waitcnt lgkmcnt(2)
    v_smfmac_f32_16x16x64_bf16 v[48:51], v[44:47], v[88:95], v1
    ds_read_b128 v[80:83], v4 offset:18432
    v_smfmac_f32_16x16x64_bf16 v[52:55], v[44:47], v[96:103], v1
    ds_read_b128 v[84:87], v4 offset:19456
    v_smfmac_f32_16x16x64_bf16 v[56:59], v[28:31], a[96:103], v1
    ds_read_b128 v[88:91], v4 offset:20480
    v_smfmac_f32_16x16x64_bf16 v[60:63], v[28:31], a[104:111], v1
    ds_read_b128 v[92:95], v4 offset:21504
    v_smfmac_f32_16x16x64_bf16 v[56:59], v[32:35], a[112:119], v1
    ds_read_b128 v[96:99], v4 offset:22528
    v_add_f32 v48, v48, v50
    v_add_f32 v49, v49, v51
    v_smfmac_f32_16x16x64_bf16 v[60:63], v[32:35], a[120:127], v1
    ds_read_b128 v[100:103], v4 offset:23552
    v_add_f32 v52, v52, v54
    v_add_f32 v53, v53, v55
    v_smfmac_f32_16x16x64_bf16 v[56:59], v[36:39], a[128:135], v1
    s_waitcnt lgkmcnt(4)
    v_cvt_pk_bf16_f32 v50, v48, v52
    v_cvt_pk_bf16_f32 v51, v49, v53
    v_smfmac_f32_16x16x64_bf16 v[56:59], v[24:27], v[72:79], v1
    ds_write2_b32 v5, v50, v51 offset0:0 offset1:72
    v_smfmac_f32_16x16x64_bf16 v[60:63], v[24:27], v[80:87], v1
    v_smfmac_f32_16x16x64_bf16 v[60:63], v[36:39], a[136:143], v1
    v_smfmac_f32_16x16x64_bf16 v[56:59], v[40:43], a[144:151], v1
    buffer_store_dword v12, v10, s[8:11], s31 offen sc1
    v_smfmac_f32_16x16x64_bf16 v[60:63], v[40:43], a[152:159], v1
    s_waitcnt lgkmcnt(0)
    s_barrier
    v_smfmac_f32_16x16x64_bf16 v[56:59], v[44:47], v[88:95], v1
    ds_read_b128 v[72:75], v6 offset:0
    v_smfmac_f32_16x16x64_bf16 v[60:63], v[44:47], v[96:103], v1
    ds_read_b128 v[76:79], v6 offset:64
    v_smfmac_f32_16x16x64_bf16 v[64:67], v[24:27], a[192:199], v1
    ds_read_b128 v[80:83], v6 offset:128
    v_smfmac_f32_16x16x64_bf16 v[68:71], v[24:27], a[200:207], v1
    ds_read_b128 v[84:87], v6 offset:192
    s_waitcnt vmcnt(2) lgkmcnt(3)
    v_mfma_f32_16x16x32_bf16 v[48:51], v[104:107], v[72:75], 0
    s_waitcnt lgkmcnt(2)
    v_add_f32 v56, v56, v58
    v_add_f32 v57, v57, v59
    v_mfma_f32_16x16x32_bf16 v[48:51], v[108:111], v[76:79], v[48:51]
    s_waitcnt lgkmcnt(1)
    v_add_f32 v60, v60, v62
    v_add_f32 v61, v61, v63
    v_mfma_f32_16x16x32_bf16 v[48:51], v[112:115], v[80:83], v[48:51]
    s_waitcnt lgkmcnt(0)
    v_cvt_pk_bf16_f32 v58, v56, v60
    v_cvt_pk_bf16_f32 v59, v57, v61
    v_mfma_f32_16x16x32_bf16 v[48:51], v[116:119], v[84:87], v[48:51]
    ds_write2_b32 v7, v58, v59 offset0:0 offset1:72
    v_smfmac_f32_16x16x64_bf16 v[64:67], v[28:31], a[208:215], v1
    v_mov_b64 v[104:105], s[4:5]
    v_smfmac_f32_16x16x64_bf16 v[68:71], v[28:31], a[216:223], v1
    s_nop 1
    v_mov_b64 v[106:107], s[4:5]
    v_smfmac_f32_16x16x64_bf16 v[64:67], v[32:35], a[224:231], v1
    v_exp_f32 v48, v48
    v_smfmac_f32_16x16x64_bf16 v[68:71], v[32:35], a[232:239], v1
    s_waitcnt lgkmcnt(0)
    s_barrier
    v_exp_f32 v49, v49
    v_smfmac_f32_16x16x64_bf16 v[64:67], v[36:39], a[240:247], v1
    ds_read_b128 v[88:91], v6 offset:2304
    v_exp_f32 v50, v50
    v_smfmac_f32_16x16x64_bf16 v[68:71], v[36:39], a[248:255], v1
    ds_read_b128 v[92:95], v6 offset:2368
    v_exp_f32 v51, v51
    v_smfmac_f32_16x16x64_bf16 v[64:67], v[40:43], v[128:135], v1
    ds_read_b128 v[96:99], v6 offset:2432
    v_cvt_pk_bf16_f32 v108, v48, v49
    v_cvt_pk_bf16_f32 v109, v50, v51
    v_smfmac_f32_16x16x64_bf16 v[68:71], v[40:43], v[136:143], v1
    ds_read_b128 v[100:103], v6 offset:2496
    ds_write_b64 v2, v[108:109] offset:8192
    s_waitcnt lgkmcnt(4)
    v_mfma_f32_16x16x32_bf16 v[52:55], v[88:91], v[72:75], 0
    s_waitcnt lgkmcnt(3)
    v_mov_b32 v113, 0
    v_mov_b32 v115, 0
    v_mfma_f32_16x16x32_bf16 v[52:55], v[92:95], v[76:79], v[52:55]
    s_waitcnt lgkmcnt(2)
    v_mov_b32 v117, 0
    v_mov_b64 v[16:17], 0
    v_mfma_f32_16x16x32_bf16 v[52:55], v[96:99], v[80:83], v[52:55]
    s_waitcnt lgkmcnt(1)
    v_mov_b64 v[18:19], 0
    v_mov_b64 v[20:21], 0
    v_mfma_f32_16x16x32_bf16 v[52:55], v[100:103], v[84:87], v[52:55]
    s_waitcnt lgkmcnt(0)
    s_barrier
    v_smfmac_f32_16x16x64_bf16 v[64:67], v[44:47], v[144:151], v1
    ds_read_b64 v[110:111], v8 offset:8192
    v_mov_b64 v[22:23], 0
    v_smfmac_f32_16x16x64_bf16 v[68:71], v[44:47], v[152:159], v1
    v_mov_b64 v[24:25], 0
    v_mov_b64 v[26:27], 0
    v_mul_f32 v52, s33, v52
    v_mul_f32 v53, s33, v53
    v_exp_f32 v52, v52
    s_waitcnt lgkmcnt(0)
    v_mfma_f32_16x16x32_bf16 v[48:51], v[104:107], v[108:111], 0
    v_exp_f32 v53, v53
    v_add_f32 v64, v64, v66
    v_mfma_f32_16x16x32_bf16 v[56:59], v[120:123], v[108:111], 0
    v_cvt_pk_bf16_f32 v112, v52, v53
    v_add_f32 v65, v65, v67
    v_mfma_f32_16x16x32_bf16 v[60:63], v[124:127], v[108:111], 0
    v_cvt_pk_bf16_f32 v114, v64, v65
    v_add_f32 v68, v68, v70
    v_mfma_f32_16x16x16_bf16 v[48:51], v[104:105], v[112:113], v[48:51]
    v_add_f32 v69, v69, v71
    v_cvt_pk_bf16_f32 v116, v68, v69
    v_mfma_f32_16x16x16_bf16 v[56:59], v[114:115], v[112:113], v[56:59]
    v_mov_b64 v[28:29], 0
    v_mov_b64 v[30:31], 0
    v_mfma_f32_16x16x16_bf16 v[60:63], v[116:117], v[112:113], v[60:63]
    v_bitop3_b32 v32, v13, s96, -9 bitop3:0x28
    v_bitop3_b32 v36, v13, s97, -9 bitop3:0x28
    v_rcp_f32 v118, v48
    v_bitop3_b32 v40, v13, s98, -9 bitop3:0x28
    v_max_f32 v14, v118, v48
    v_cmp_nge_f32 vcc, s40, v14
    v_pk_mul_f32 v[56:57], v[56:57], v[118:119] op_sel_hi:[1,0]
    v_pk_mul_f32 v[58:59], v[58:59], v[118:119] op_sel_hi:[1,0]
    v_pk_mul_f32 v[60:61], v[60:61], v[118:119] op_sel_hi:[1,0]
    v_pk_mul_f32 v[62:63], v[62:63], v[118:119] op_sel_hi:[1,0]
    v_cvt_pk_bf16_f32 v52, v56, v60
    v_cvt_pk_bf16_f32 v54, v58, v62
    v_cvt_pk_bf16_f32 v53, v57, v61
    v_cvt_pk_bf16_f32 v55, v59, v63
L_slow_rejoin:
    v_cndmask_b32 v50, v52, v54, s[92:93]
    v_cndmask_b32 v51, v53, v55, s[92:93]
    ds_write_b64 v13, v[50:51] offset:9216
    v_smfmac_f32_16x16x64_bf16 v[16:19], v[52:55], v[160:167], v1
    v_smfmac_f32_16x16x64_bf16 v[20:23], v[52:55], v[168:175], v1
    s_waitcnt lgkmcnt(0)
    s_barrier
    ds_read_b128 v[32:35], v32 offset:9216
    ds_read_b128 v[36:39], v36 offset:9216
    v_smfmac_f32_16x16x64_bf16 v[24:27], v[52:55], v[176:183], v1
    ds_read_b128 v[40:43], v40 offset:9216
    v_smfmac_f32_16x16x64_bf16 v[28:31], v[52:55], v[184:191], v1
    ds_read_b128 v[88:91], v4 offset:24576
    ds_read_b128 v[92:95], v4 offset:25600
    s_waitcnt lgkmcnt(4)
    v_smfmac_f32_16x16x64_bf16 v[16:19], v[32:35], v[192:199], v1
    ds_read_b128 v[96:99], v4 offset:26624
    s_waitcnt lgkmcnt(4)
    v_smfmac_f32_16x16x64_bf16 v[16:19], v[36:39], v[216:223], v1
    ds_read_b128 v[100:103], v4 offset:27648
    s_waitcnt lgkmcnt(4)
    v_smfmac_f32_16x16x64_bf16 v[16:19], v[40:43], v[240:247], v1
    ds_read_b128 v[72:75], v4 offset:28672
    s_cmp_lg_u64 vcc, 0
    v_smfmac_f32_16x16x64_bf16 v[20:23], v[32:35], v[200:207], v1
    ds_read_b128 v[76:79], v4 offset:29696
    s_cselect_b32 s60, s28, s27
    v_smfmac_f32_16x16x64_bf16 v[20:23], v[36:39], v[224:231], v1
    ds_read_b128 v[80:83], v4 offset:30720
    s_nop 0
    v_cvt_pk_bf16_f32 v56, v16, v18
    v_smfmac_f32_16x16x64_bf16 v[20:23], v[40:43], v[248:255], v1
    ds_read_b128 v[84:87], v4 offset:31744
    v_cvt_pk_bf16_f32 v57, v17, v19
    v_and_or_b32 v56, v56, -2, s60
    v_smfmac_f32_16x16x64_bf16 v[24:27], v[32:35], v[208:215], v1
    buffer_store_dwordx2 v[56:57], v9, s[8:11], 0 offen offset:0 sc1
    v_smfmac_f32_16x16x64_bf16 v[24:27], v[36:39], v[232:239], v1
    s_waitcnt lgkmcnt(4)
    s_nop 0
    v_cvt_pk_bf16_f32 v58, v20, v22
    v_smfmac_f32_16x16x64_bf16 v[24:27], v[40:43], v[88:95], v1
    ds_read_b128 v[64:67], v3 offset:23040
    v_cvt_pk_bf16_f32 v59, v21, v23
    v_and_or_b32 v58, v58, -2, s60
    v_smfmac_f32_16x16x64_bf16 v[28:31], v[32:35], v[96:103], v1
    buffer_store_dwordx2 v[58:59], v9, s[8:11], 0 offen offset:2048 sc1
    s_waitcnt lgkmcnt(1)
    v_smfmac_f32_16x16x64_bf16 v[28:31], v[36:39], v[72:79], v1
    s_nop 1
    v_cvt_pk_bf16_f32 v60, v24, v26
    v_smfmac_f32_16x16x64_bf16 v[28:31], v[40:43], v[80:87], v1
    s_nop 2
    v_cvt_pk_bf16_f32 v61, v25, v27
    v_and_or_b32 v60, v60, -2, s60
    buffer_store_dwordx2 v[60:61], v9, s[8:11], s26 offen offset:0 sc1
    s_nop 1
    v_cvt_pk_bf16_f32 v62, v28, v30
    v_cvt_pk_bf16_f32 v63, v29, v31
    v_and_or_b32 v62, v62, -2, s60
    buffer_store_dwordx2 v[62:63], v9, s[8:11], s26 offen offset:2048 sc1
L_slow_stored:
    s_cmp_lg_u32 s60, s27
    s_cbranch_scc1 L_slow_safe
    ds_read_b128 v[104:107], v4 offset:0
    ds_read_b128 v[108:111], v4 offset:1024
    ds_read_b128 v[112:115], v4 offset:2048
    ds_read_b128 v[116:119], v4 offset:3072
    ds_read_b128 v[88:91], v4 offset:4096
    ds_read_b128 v[92:95], v4 offset:5120
    ds_read_b128 v[96:99], v4 offset:6144
    ds_read_b128 v[100:103], v4 offset:7168
    ds_read_b128 v[72:75], v4 offset:8192
    ds_read_b128 v[76:79], v4 offset:9216
    ds_read_b128 v[80:83], v4 offset:10240
    ds_read_b128 v[84:87], v4 offset:11264
    s_cmp_lt_u32 s21, 1
    s_cbranch_scc1 L_slow_pollp
    s_nop 13
    s_cmp_lt_u32 s21, 2
    s_cbranch_scc1 L_slow_pollp
    s_nop 13
    s_cmp_lt_u32 s21, 3
    s_cbranch_scc1 L_slow_pollp
    s_nop 13
L_slow_pollp:
    buffer_load_dwordx4 v[120:123], v2, s[8:11], s6 offen sc1
    buffer_load_dwordx4 v[124:127], v2, s[8:11], s6 offen offset:1024 sc1
    v_mov_b64 v[56:57], 0
    v_mov_b64 v[58:59], 0
    v_mov_b64 v[60:61], 0
    v_mov_b64 v[62:63], 0
    s_nop 15
    s_nop 15
    buffer_load_dwordx4 v[32:35], v2, s[8:11], s6 offen sc1
    buffer_load_dwordx4 v[36:39], v2, s[8:11], s6 offen offset:1024 sc1
L_slow_prep:
    s_add_u32 s7, s24, 0x80000
    s_waitcnt vmcnt(3) lgkmcnt(0)
    v_mfma_f32_16x16x32_bf16 v[68:71], v[64:67], v[120:123], 0
    v_bitop3_b32 v14, v120, v122, s27 bitop3:0x7e
    s_waitcnt vmcnt(2)
    v_mfma_f32_16x16x32_bf16 v[68:71], v[64:67], v[124:127], v[68:71]
    v_bitop3_b32 v11, v124, v126, s27 bitop3:0x7e
    v_bitop3_b32 v14, v14, v11, 1 bitop3:0xa8
    v_cmp_ne_u32 vcc, 0, v14
    s_nop 2
    s_cmp_eq_u64 vcc, 0
    s_cselect_b32 s36, s24, s61
    v_add_f32_dpp v68, v68, v68 row_ror:8 row_mask:0xf bank_mask:0xf
    v_add_f32_dpp v69, v69, v69 row_ror:8 row_mask:0xf bank_mask:0xf
    s_nop 0
    v_add_f32_dpp v68, v68, v68 row_ror:4 row_mask:0xf bank_mask:0xf
    v_add_f32_dpp v69, v69, v69 row_ror:4 row_mask:0xf bank_mask:0xf
    v_cvt_pk_bf16_f32 v12, v68, v69
    buffer_store_dword v12, v10, s[8:11], s36 offen sc1
    s_cbranch_scc1 L_slow_gotp
L_slow_retryp:
    buffer_load_dwordx4 v[120:123], v2, s[8:11], s6 offen sc1
    buffer_load_dwordx4 v[124:127], v2, s[8:11], s6 offen offset:1024 sc1
    s_waitcnt vmcnt(4) lgkmcnt(0)
    v_mfma_f32_16x16x32_bf16 v[68:71], v[64:67], v[32:35], 0
    v_bitop3_b32 v14, v32, v34, s27 bitop3:0x7e
    s_waitcnt vmcnt(3)
    v_mfma_f32_16x16x32_bf16 v[68:71], v[64:67], v[36:39], v[68:71]
    v_bitop3_b32 v11, v36, v38, s27 bitop3:0x7e
    v_bitop3_b32 v14, v14, v11, 1 bitop3:0xa8
    v_cmp_ne_u32 vcc, 0, v14
    s_nop 2
    s_cmp_eq_u64 vcc, 0
    s_cselect_b32 s36, s24, s61
    v_add_f32_dpp v68, v68, v68 row_ror:8 row_mask:0xf bank_mask:0xf
    v_add_f32_dpp v69, v69, v69 row_ror:8 row_mask:0xf bank_mask:0xf
    s_nop 0
    v_add_f32_dpp v68, v68, v68 row_ror:4 row_mask:0xf bank_mask:0xf
    v_add_f32_dpp v69, v69, v69 row_ror:4 row_mask:0xf bank_mask:0xf
    v_cvt_pk_bf16_f32 v12, v68, v69
    buffer_store_dword v12, v10, s[8:11], s36 offen sc1
    s_cbranch_scc1 L_slow_gotp
    buffer_load_dwordx4 v[32:35], v2, s[8:11], s6 offen sc1
    buffer_load_dwordx4 v[36:39], v2, s[8:11], s6 offen offset:1024 sc1
    s_waitcnt vmcnt(4) lgkmcnt(0)
    v_mfma_f32_16x16x32_bf16 v[68:71], v[64:67], v[120:123], 0
    v_bitop3_b32 v14, v120, v122, s27 bitop3:0x7e
    s_waitcnt vmcnt(3)
    v_mfma_f32_16x16x32_bf16 v[68:71], v[64:67], v[124:127], v[68:71]
    v_bitop3_b32 v11, v124, v126, s27 bitop3:0x7e
    v_bitop3_b32 v14, v14, v11, 1 bitop3:0xa8
    v_cmp_ne_u32 vcc, 0, v14
    s_nop 2
    s_cmp_eq_u64 vcc, 0
    s_cselect_b32 s36, s24, s61
    v_add_f32_dpp v68, v68, v68 row_ror:8 row_mask:0xf bank_mask:0xf
    v_add_f32_dpp v69, v69, v69 row_ror:8 row_mask:0xf bank_mask:0xf
    s_nop 0
    v_add_f32_dpp v68, v68, v68 row_ror:4 row_mask:0xf bank_mask:0xf
    v_add_f32_dpp v69, v69, v69 row_ror:4 row_mask:0xf bank_mask:0xf
    v_cvt_pk_bf16_f32 v12, v68, v69
    buffer_store_dword v12, v10, s[8:11], s36 offen sc1
    s_cbranch_scc1 L_slow_gotp
    s_add_u32 s32, s32, 1
    s_cmp_le_u32 s32, 200000
    s_cbranch_scc1 L_slow_retryp
    s_mov_b32 s36, s24
    buffer_store_dword v12, v10, s[8:11], s36 offen sc1
L_slow_gotp:
    s_add_u32 s31, s31, 0x2000
    s_cmp_ge_u32 s90, 63
    s_cbranch_scc1 L_slow_last
    s_mov_b32 s23, s24
    s_mov_b32 s22, s90
    s_mov_b32 s27, s28
    v_mov_b64 v[64:65], 0
    v_mov_b64 v[66:67], 0
    v_mov_b64 v[68:69], 0
    v_mov_b64 v[70:71], 0
    s_nop 15
    s_nop 11
    buffer_load_dwordx4 v[16:19], v2, s[8:11], s7 offen sc1
    buffer_load_dwordx4 v[20:23], v2, s[8:11], s7 offen offset:1024 sc1
    s_branch L_slow_step
L_slow_last:
    buffer_store_dword v12, v10, s[8:11], s31 offen sc1
    s_branch L_slow_done
L_slow_refresh:
    buffer_load_dword v15, v0, s[8:11], s23 offen sc1
    s_add_u32 s32, s32, 1
    s_cmp_le_u32 s32, 200000
    s_waitcnt vmcnt(0)
    s_cbranch_scc1 L_slow_step
    s_branch L_slow_fresh
L_slow_safe:
    s_nop 11
    s_waitcnt vmcnt(0) lgkmcnt(0)
    s_barrier
    ds_read_b128 v[72:75], v6 offset:0
    ds_read_b128 v[88:91], v6 offset:2304
    ds_read_b128 v[76:79], v6 offset:64
    ds_read_b128 v[92:95], v6 offset:2368
    ds_read_b128 v[80:83], v6 offset:128
    ds_read_b128 v[96:99], v6 offset:2432
    ds_read_b128 v[84:87], v6 offset:192
    ds_read_b128 v[100:103], v6 offset:2496
    s_xor_b32 s36, s25, 0x1000
    s_add_u32 s36, s36, s23
    buffer_load_dwordx4 v[16:19], v3, s[8:11], s29 offen offset:0 sc1
    buffer_load_dwordx4 v[32:35], v3, s[8:11], s36 offen offset:0 sc1
    buffer_load_dwordx4 v[20:23], v3, s[8:11], s29 offen offset:1024 sc1
    buffer_load_dwordx4 v[36:39], v3, s[8:11], s36 offen offset:1024 sc1
    buffer_load_dwordx4 v[24:27], v3, s[8:11], s29 offen offset:2048 sc1
    buffer_load_dwordx4 v[40:43], v3, s[8:11], s36 offen offset:2048 sc1
    buffer_load_dwordx4 v[28:31], v3, s[8:11], s29 offen offset:3072 sc1
    buffer_load_dwordx4 v[44:47], v3, s[8:11], s36 offen offset:3072 sc1
    s_waitcnt vmcnt(0) lgkmcnt(0)
    v_mfma_f32_16x16x32_bf16 v[48:51], v[16:19], v[72:75], 0
    v_mfma_f32_16x16x32_bf16 v[48:51], v[20:23], v[76:79], v[48:51]
    v_mfma_f32_16x16x32_bf16 v[48:51], v[24:27], v[80:83], v[48:51]
    v_mfma_f32_16x16x32_bf16 v[48:51], v[28:31], v[84:87], v[48:51]
    v_mfma_f32_16x16x32_bf16 v[52:55], v[32:35], v[72:75], 0
    v_mfma_f32_16x16x32_bf16 v[52:55], v[36:39], v[76:79], v[52:55]
    v_mfma_f32_16x16x32_bf16 v[52:55], v[40:43], v[80:83], v[52:55]
    v_mfma_f32_16x16x32_bf16 v[52:55], v[44:47], v[84:87], v[52:55]
    v_mfma_f32_16x16x32_bf16 v[56:59], v[88:91], v[72:75], 0
    v_mfma_f32_16x16x32_bf16 v[56:59], v[92:95], v[76:79], v[56:59]
    v_mfma_f32_16x16x32_bf16 v[56:59], v[96:99], v[80:83], v[56:59]
    v_mfma_f32_16x16x32_bf16 v[56:59], v[100:103], v[84:87], v[56:59]
    s_nop 7
    v_mul_f32 v56, s33, v56
    v_mul_f32 v57, s33, v57
    v_max3_f32 v16, v48, v49, v50
    v_max3_f32 v16, v16, v51, v52
    v_max3_f32 v16, v16, v53, v54
    v_max3_f32 v16, v16, v55, v56
    v_max_f32 v16, v16, v57
    v_mov_b32 v17, v16
    s_nop 1
    v_permlane16_swap_b32 v16, v17
    v_max_f32 v16, v16, v17
    v_mov_b32 v17, v16
    s_nop 1
    v_permlane32_swap_b32 v16, v17
    v_max_f32 v16, v16, v17
    v_sub_f32 v48, v48, v16
    v_exp_f32 v48, v48
    v_sub_f32 v49, v49, v16
    v_exp_f32 v49, v49
    v_sub_f32 v50, v50, v16
    v_exp_f32 v50, v50
    v_sub_f32 v51, v51, v16
    v_exp_f32 v51, v51
    v_sub_f32 v52, v52, v16
    v_exp_f32 v52, v52
    v_sub_f32 v53, v53, v16
    v_exp_f32 v53, v53
    v_sub_f32 v54, v54, v16
    v_exp_f32 v54, v54
    v_sub_f32 v55, v55, v16
    v_exp_f32 v55, v55
    v_sub_f32 v56, v56, v16
    v_exp_f32 v56, v56
    v_sub_f32 v57, v57, v16
    v_exp_f32 v57, v57
    v_cvt_pk_bf16_f32 v108, v48, v49
    v_cvt_pk_bf16_f32 v109, v50, v51
    v_cvt_pk_bf16_f32 v110, v52, v53
    v_cvt_pk_bf16_f32 v111, v54, v55
    v_cvt_pk_bf16_f32 v112, v56, v57
    s_nop 0
    v_mfma_f32_16x16x32_bf16 v[48:51], v[104:107], v[108:111], 0
    v_mfma_f32_16x16x32_bf16 v[56:59], v[120:123], v[108:111], 0
    v_mfma_f32_16x16x32_bf16 v[60:63], v[124:127], v[108:111], 0
    s_nop 3
    v_mfma_f32_16x16x16_bf16 v[48:51], v[104:105], v[112:113], v[48:51]
    v_mfma_f32_16x16x16_bf16 v[56:59], v[114:115], v[112:113], v[56:59]
    v_mfma_f32_16x16x16_bf16 v[60:63], v[116:117], v[112:113], v[60:63]
    s_nop 5
    v_rcp_f32 v118, v48
    s_nop 0
    v_mul_f32 v56, v56, v118
    v_mul_f32 v57, v57, v118
    v_mul_f32 v58, v58, v118
    v_mul_f32 v59, v59, v118
    v_mul_f32 v60, v60, v118
    v_mul_f32 v61, v61, v118
    v_mul_f32 v62, v62, v118
    v_mul_f32 v63, v63, v118
    v_cvt_pk_bf16_f32 v52, v56, v60
    v_cvt_pk_bf16_f32 v53, v57, v61
    v_cvt_pk_bf16_f32 v54, v58, v62
    v_cvt_pk_bf16_f32 v55, v59, v63
    v_mov_b32 v16, 0
    v_mov_b32 v17, 0
    v_mov_b32 v18, 0
    v_mov_b32 v19, 0
    v_mov_b32 v20, 0
    v_mov_b32 v21, 0
    v_mov_b32 v22, 0
    v_mov_b32 v23, 0
    v_mov_b32 v24, 0
    v_mov_b32 v25, 0
    v_mov_b32 v26, 0
    v_mov_b32 v27, 0
    v_mov_b32 v28, 0
    v_mov_b32 v29, 0
    v_mov_b32 v30, 0
    v_mov_b32 v31, 0
    v_bitop3_b32 v32, v13, s96, -9 bitop3:0x28
    v_bitop3_b32 v36, v13, s97, -9 bitop3:0x28
    v_bitop3_b32 v40, v13, s98, -9 bitop3:0x28
    s_mov_b64 vcc, 0
    s_branch L_slow_rejoin
L_slow_done:
    s_branch L_end
L_worker:
    s_cmp_eq_u32 s3, 7
    s_cbranch_scc1 L_mlp
    s_and_b32 s36, s2, 7
    s_sub_u32 s36, s36, 1
    s_lshl_b32 s36, s36, 5
    s_lshr_b32 s37, s2, 3
    s_add_u32 s36, s36, s37
    s_mul_i32 s20, s36, 10923
    s_lshr_b32 s20, s20, 16
    s_mul_i32 s37, s20, 6
    s_sub_u32 s22, s36, s37
    v_lshrrev_b32 v28, 6, v0
    v_bfe_u32 v29, v0, 4, 2
    v_lshl_add_u32 v28, v28, 5, v29
    v_and_b32 v16, 15, v0
    v_lshlrev_b32 v16, 4, v16
    v_lshl_add_u32 v16, v28, 13, v16
    v_bfe_u32 v29, v0, 4, 2
    v_lshlrev_b32 v29, 5, v29
    v_xor_b32 v16, v16, v29
    v_xor_b32 v17, 0, v16
    v_xor_b32 v18, 128, v16
    v_xor_b32 v19, 128, v16
    s_add_u32 s28, s21, 1
    s_lshl_b32 s28, s28, 15
    s_lshl_b32 s3, s20, 8
    s_mov_b32 s76, s52
    s_and_b32 s77, s53, 0xffff
    s_mov_b32 s78, 0x400000
    s_mov_b32 s79, 0x20000
    s_add_u32 m0, s28, 0
    s_add_u32 s37, s3, 0x0
    buffer_load_dwordx4 v16, s[76:79], s37 offen lds
    s_add_u32 m0, s28, 1024
    s_add_u32 s37, s3, 0x8000
    buffer_load_dwordx4 v17, s[76:79], s37 offen lds
    s_add_u32 m0, s28, 2048
    s_add_u32 s37, s3, 0x10000
    buffer_load_dwordx4 v18, s[76:79], s37 offen lds
    s_add_u32 m0, s28, 3072
    s_add_u32 s37, s3, 0x18000
    buffer_load_dwordx4 v19, s[76:79], s37 offen lds
    s_add_u32 m0, s28, 4096
    s_add_u32 s37, s3, 0x20000
    buffer_load_dwordx4 v16, s[76:79], s37 offen lds
    s_add_u32 m0, s28, 5120
    s_add_u32 s37, s3, 0x28000
    buffer_load_dwordx4 v17, s[76:79], s37 offen lds
    s_add_u32 m0, s28, 6144
    s_add_u32 s37, s3, 0x30000
    buffer_load_dwordx4 v18, s[76:79], s37 offen lds
    s_add_u32 m0, s28, 7168
    s_add_u32 s37, s3, 0x38000
    buffer_load_dwordx4 v19, s[76:79], s37 offen lds
    s_add_u32 m0, s28, 8192
    s_add_u32 s37, s3, 0x100000
    buffer_load_dwordx4 v16, s[76:79], s37 offen lds
    s_add_u32 m0, s28, 9216
    s_add_u32 s37, s3, 0x108000
    buffer_load_dwordx4 v17, s[76:79], s37 offen lds
    s_add_u32 m0, s28, 10240
    s_add_u32 s37, s3, 0x110000
    buffer_load_dwordx4 v18, s[76:79], s37 offen lds
    s_add_u32 m0, s28, 11264
    s_add_u32 s37, s3, 0x118000
    buffer_load_dwordx4 v19, s[76:79], s37 offen lds
    s_add_u32 m0, s28, 12288
    s_add_u32 s37, s3, 0x120000
    buffer_load_dwordx4 v16, s[76:79], s37 offen lds
    s_add_u32 m0, s28, 13312
    s_add_u32 s37, s3, 0x128000
    buffer_load_dwordx4 v17, s[76:79], s37 offen lds
    s_add_u32 m0, s28, 14336
    s_add_u32 s37, s3, 0x130000
    buffer_load_dwordx4 v18, s[76:79], s37 offen lds
    s_add_u32 m0, s28, 15360
    s_add_u32 s37, s3, 0x138000
    buffer_load_dwordx4 v19, s[76:79], s37 offen lds
    s_add_u32 m0, s28, 16384
    s_add_u32 s37, s3, 0x200000
    buffer_load_dwordx4 v16, s[76:79], s37 offen lds
    s_add_u32 m0, s28, 17408
    s_add_u32 s37, s3, 0x208000
    buffer_load_dwordx4 v17, s[76:79], s37 offen lds
    s_add_u32 m0, s28, 18432
    s_add_u32 s37, s3, 0x210000
    buffer_load_dwordx4 v18, s[76:79], s37 offen lds
    s_add_u32 m0, s28, 19456
    s_add_u32 s37, s3, 0x218000
    buffer_load_dwordx4 v19, s[76:79], s37 offen lds
    s_add_u32 m0, s28, 20480
    s_add_u32 s37, s3, 0x220000
    buffer_load_dwordx4 v16, s[76:79], s37 offen lds
    s_add_u32 m0, s28, 21504
    s_add_u32 s37, s3, 0x228000
    buffer_load_dwordx4 v17, s[76:79], s37 offen lds
    s_add_u32 m0, s28, 22528
    s_add_u32 s37, s3, 0x230000
    buffer_load_dwordx4 v18, s[76:79], s37 offen lds
    s_add_u32 m0, s28, 23552
    s_add_u32 s37, s3, 0x238000
    buffer_load_dwordx4 v19, s[76:79], s37 offen lds
    s_add_u32 m0, s28, 24576
    s_add_u32 s37, s3, 0x300000
    buffer_load_dwordx4 v16, s[76:79], s37 offen lds
    s_add_u32 m0, s28, 25600
    s_add_u32 s37, s3, 0x308000
    buffer_load_dwordx4 v17, s[76:79], s37 offen lds
    s_add_u32 m0, s28, 26624
    s_add_u32 s37, s3, 0x310000
    buffer_load_dwordx4 v18, s[76:79], s37 offen lds
    s_add_u32 m0, s28, 27648
    s_add_u32 s37, s3, 0x318000
    buffer_load_dwordx4 v19, s[76:79], s37 offen lds
    s_add_u32 m0, s28, 28672
    s_add_u32 s37, s3, 0x320000
    buffer_load_dwordx4 v16, s[76:79], s37 offen lds
    s_add_u32 m0, s28, 29696
    s_add_u32 s37, s3, 0x328000
    buffer_load_dwordx4 v17, s[76:79], s37 offen lds
    s_add_u32 m0, s28, 30720
    s_add_u32 s37, s3, 0x330000
    buffer_load_dwordx4 v18, s[76:79], s37 offen lds
    s_add_u32 m0, s28, 31744
    s_add_u32 s37, s3, 0x338000
    buffer_load_dwordx4 v19, s[76:79], s37 offen lds
    v_mov_b32 v20, 0x0
    v_bfe_u32 v14, v0, 0, 1
    s_mov_b32 s38, 0x8
    v_mad_u32_u24 v20, v14, s38, v20
    v_bfe_u32 v14, v0, 1, 1
    s_mov_b32 s38, 0x10
    v_mad_u32_u24 v20, v14, s38, v20
    v_bfe_u32 v14, v0, 2, 1
    s_mov_b32 s38, 0x100
    v_mad_u32_u24 v20, v14, s38, v20
    v_bfe_u32 v14, v0, 3, 1
    s_mov_b32 s38, 0x200
    v_mad_u32_u24 v20, v14, s38, v20
    v_bfe_u32 v14, v0, 4, 1
    s_mov_b32 s38, 0x800
    v_mad_u32_u24 v20, v14, s38, v20
    v_bfe_u32 v14, v0, 5, 1
    s_mov_b32 s38, 0x1000
    v_mad_u32_u24 v20, v14, s38, v20
    v_mov_b32 v28, 0x0
    v_bfe_u32 v14, v0, 2, 1
    s_mov_b32 s38, 0x20
    v_mad_u32_u24 v28, v14, s38, v28
    v_bfe_u32 v14, v0, 3, 1
    s_mov_b32 s38, 0x40
    v_mad_u32_u24 v28, v14, s38, v28
    v_bfe_u32 v14, v0, 4, 1
    s_mov_b32 s38, 0x80
    v_mad_u32_u24 v28, v14, s38, v28
    v_mov_b32 v29, 0x0
    v_bfe_u32 v14, v0, 6, 1
    s_mov_b32 s38, 0x40
    v_mad_u32_u24 v29, v14, s38, v29
    v_bfe_u32 v14, v0, 7, 1
    s_mov_b32 s38, 0x80
    v_mad_u32_u24 v29, v14, s38, v29
    v_xor_b32 v28, v28, v29
    v_add_u32 v28, v28, v20
    v_add_u32 v20, 0x8000, v28
    v_xor_b32 v21, 32, v20
    v_add_u32 v22, 0x10000, v28
    v_xor_b32 v23, 32, v22
    v_add_u32 v24, 0x18000, v28
    v_xor_b32 v25, 32, v24
    v_add_u32 v26, 0x20000, v28
    v_xor_b32 v27, 32, v26
    s_mov_b32 s12, s54
    s_and_b32 s13, s55, 0xffff
    s_mov_b32 s14, 0x400000
    s_mov_b32 s15, 0x20000
    s_lshl_b32 s24, s20, 17
    s_and_b32 s25, s22, 3
    s_lshl_b32 s25, s25, 15
    s_add_u32 s24, s24, s25
    v_lshlrev_b32 v30, 7, v0
    buffer_load_dword v31, v30, s[12:15], s24 offen
    s_mov_b32 s12, s44
    s_and_b32 s13, s45, 0xffff
    s_mov_b32 s14, 0x200000
    s_mov_b32 s15, 0x20000
    s_mov_b32 s60, s82
    s_and_b32 s61, s83, 0xffff
    s_mov_b32 s62, 0x200000
    s_mov_b32 s63, 0x20000
    s_mov_b32 s92, s80
    s_and_b32 s93, s81, 0xffff
    s_mov_b32 s94, 0x400
    s_mov_b32 s95, 0x20000
    v_mov_b32 v1, 0x0
    v_bfe_u32 v14, v0, 0, 1
    s_mov_b32 s38, 0x10
    v_mad_u32_u24 v1, v14, s38, v1
    v_bfe_u32 v14, v0, 1, 1
    s_mov_b32 s38, 0x20
    v_mad_u32_u24 v1, v14, s38, v1
    v_bfe_u32 v14, v0, 2, 1
    s_mov_b32 s38, 0x40
    v_mad_u32_u24 v1, v14, s38, v1
    v_bfe_u32 v14, v0, 3, 1
    s_mov_b32 s38, 0x80
    v_mad_u32_u24 v1, v14, s38, v1
    v_bfe_u32 v14, v0, 4, 1
    s_mov_b32 s38, 0x100
    v_mad_u32_u24 v1, v14, s38, v1
    v_bfe_u32 v14, v0, 5, 1
    s_mov_b32 s38, 0x200
    v_mad_u32_u24 v1, v14, s38, v1
    v_mov_b32 v2, 0x0
    v_bfe_u32 v14, v0, 0, 1
    s_mov_b32 s38, 0x10
    v_mad_u32_u24 v2, v14, s38, v2
    v_bfe_u32 v14, v0, 1, 1
    s_mov_b32 s38, 0x20
    v_mad_u32_u24 v2, v14, s38, v2
    v_bfe_u32 v14, v0, 2, 1
    s_mov_b32 s38, 0x40
    v_mad_u32_u24 v2, v14, s38, v2
    v_bfe_u32 v14, v0, 3, 1
    s_mov_b32 s38, 0x80
    v_mad_u32_u24 v2, v14, s38, v2
    v_bfe_u32 v14, v0, 4, 1
    s_mov_b32 s38, 0x100
    v_mad_u32_u24 v2, v14, s38, v2
    v_bfe_u32 v14, v0, 5, 1
    s_mov_b32 s38, 0x200
    v_mad_u32_u24 v2, v14, s38, v2
    v_bfe_u32 v14, v0, 6, 1
    s_mov_b32 s38, 0x800
    v_mad_u32_u24 v2, v14, s38, v2
    v_bfe_u32 v14, v0, 7, 1
    s_mov_b32 s38, 0x1000
    v_mad_u32_u24 v2, v14, s38, v2
    v_mov_b32 v9, 0x0
    v_bfe_u32 v14, v0, 0, 1
    s_mov_b32 s38, 0x10
    v_mad_u32_u24 v9, v14, s38, v9
    v_bfe_u32 v14, v0, 1, 1
    s_mov_b32 s38, 0x20
    v_mad_u32_u24 v9, v14, s38, v9
    v_bfe_u32 v14, v0, 2, 1
    s_mov_b32 s38, 0x40
    v_mad_u32_u24 v9, v14, s38, v9
    v_bfe_u32 v14, v0, 3, 1
    s_mov_b32 s38, 0x80
    v_mad_u32_u24 v9, v14, s38, v9
    v_bfe_u32 v14, v0, 4, 1
    s_mov_b32 s38, 0x100
    v_mad_u32_u24 v9, v14, s38, v9
    v_bfe_u32 v14, v0, 5, 1
    s_mov_b32 s38, 0x200
    v_mad_u32_u24 v9, v14, s38, v9
    v_bfe_u32 v14, v0, 6, 1
    s_mov_b32 s38, 0x400
    v_mad_u32_u24 v9, v14, s38, v9
    v_bfe_u32 v14, v0, 7, 1
    s_mov_b32 s38, 0x800
    v_mad_u32_u24 v9, v14, s38, v9
    v_mov_b32 v7, 0x8000
    v_bfe_u32 v14, v0, 0, 1
    s_mov_b32 s38, 0x10
    v_mad_u32_u24 v7, v14, s38, v7
    v_bfe_u32 v14, v0, 1, 1
    s_mov_b32 s38, 0x20
    v_mad_u32_u24 v7, v14, s38, v7
    v_bfe_u32 v14, v0, 2, 1
    s_mov_b32 s38, 0x40
    v_mad_u32_u24 v7, v14, s38, v7
    v_bfe_u32 v14, v0, 3, 1
    s_mov_b32 s38, 0x80
    v_mad_u32_u24 v7, v14, s38, v7
    v_bfe_u32 v14, v0, 4, 1
    s_mov_b32 s38, 0x100
    v_mad_u32_u24 v7, v14, s38, v7
    v_bfe_u32 v14, v0, 5, 1
    s_mov_b32 s38, 0x200
    v_mad_u32_u24 v7, v14, s38, v7
    v_bfe_u32 v14, v0, 6, 1
    s_mov_b32 s38, 0x8000
    v_mad_u32_u24 v7, v14, s38, v7
    v_bfe_u32 v14, v0, 7, 1
    s_mov_b32 s38, 0x10000
    v_mad_u32_u24 v7, v14, s38, v7
    v_mov_b32 v3, 0x0
    v_bfe_u32 v14, v0, 0, 1
    s_mov_b32 s38, 0x10
    v_mad_u32_u24 v3, v14, s38, v3
    v_bfe_u32 v14, v0, 1, 1
    s_mov_b32 s38, 0x20
    v_mad_u32_u24 v3, v14, s38, v3
    v_bfe_u32 v14, v0, 2, 1
    s_mov_b32 s38, 0x40
    v_mad_u32_u24 v3, v14, s38, v3
    v_bfe_u32 v14, v0, 3, 1
    s_mov_b32 s38, 0x400
    v_mad_u32_u24 v3, v14, s38, v3
    v_bfe_u32 v14, v0, 4, 1
    s_mov_b32 s38, 0x800
    v_mad_u32_u24 v3, v14, s38, v3
    v_bfe_u32 v14, v0, 5, 1
    s_mov_b32 s38, 0x1000
    v_mad_u32_u24 v3, v14, s38, v3
    v_bfe_u32 v14, v0, 6, 1
    s_mov_b32 s38, 0x2000
    v_mad_u32_u24 v3, v14, s38, v3
    v_bfe_u32 v14, v0, 7, 1
    s_mov_b32 s38, 0x4000
    v_mad_u32_u24 v3, v14, s38, v3
    v_mov_b32 v4, 0x0
    v_bfe_u32 v14, v0, 0, 1
    s_mov_b32 s38, 0x100
    v_mad_u32_u24 v4, v14, s38, v4
    v_bfe_u32 v14, v0, 1, 1
    s_mov_b32 s38, 0x200
    v_mad_u32_u24 v4, v14, s38, v4
    v_bfe_u32 v14, v0, 2, 1
    s_mov_b32 s38, 0x400
    v_mad_u32_u24 v4, v14, s38, v4
    v_bfe_u32 v14, v0, 6, 1
    s_mov_b32 s38, 0x80
    v_mad_u32_u24 v4, v14, s38, v4
    v_bfe_u32 v14, v0, 7, 1
    s_mov_b32 s38, 0x4000
    v_mad_u32_u24 v4, v14, s38, v4
    v_lshrrev_b32 v15, 3, v0
    v_xor_b32 v15, v15, v0
    v_and_b32 v15, 7, v15
    v_lshl_add_u32 v4, v15, 4, v4
    v_bfe_u32 v15, v0, 4, 2
    v_lshlrev_b32 v15, 4, v15
    v_xor_b32 v5, v15, v1
    v_xor_b32 v6, 64, v5
    v_mov_b32 v8, 0x5000
    v_bfe_u32 v14, v0, 0, 1
    s_mov_b32 s38, 0x10
    v_mad_u32_u24 v8, v14, s38, v8
    v_bfe_u32 v14, v0, 1, 1
    s_mov_b32 s38, 0x40
    v_mad_u32_u24 v8, v14, s38, v8
    v_bfe_u32 v14, v0, 2, 1
    s_mov_b32 s38, 0x80
    v_mad_u32_u24 v8, v14, s38, v8
    v_bfe_u32 v14, v0, 4, 1
    s_mov_b32 s38, 0x20
    v_mad_u32_u24 v8, v14, s38, v8
    v_bfe_u32 v14, v0, 5, 1
    s_mov_b32 s38, 0x100
    v_mad_u32_u24 v8, v14, s38, v8
    v_mov_b32 v10, 0x0
    v_bfe_u32 v14, v0, 0, 1
    s_mov_b32 s38, 0x10
    v_mad_u32_u24 v10, v14, s38, v10
    v_bfe_u32 v14, v0, 1, 1
    s_mov_b32 s38, 0x20
    v_mad_u32_u24 v10, v14, s38, v10
    v_bfe_u32 v14, v0, 2, 1
    s_mov_b32 s38, 0x40
    v_mad_u32_u24 v10, v14, s38, v10
    v_bfe_u32 v14, v0, 3, 1
    s_mov_b32 s38, 0x80
    v_mad_u32_u24 v10, v14, s38, v10
    v_bfe_u32 v14, v0, 4, 1
    s_mov_b32 s38, 0x20000
    v_mad_u32_u24 v10, v14, s38, v10
    v_bfe_u32 v14, v0, 5, 1
    s_mov_b32 s38, 0x40000
    v_mad_u32_u24 v10, v14, s38, v10
    v_bfe_u32 v14, v0, 6, 1
    s_mov_b32 s38, 0x100
    v_mad_u32_u24 v10, v14, s38, v10
    v_bfe_u32 v14, v0, 7, 1
    s_mov_b32 s38, 0x200
    v_mad_u32_u24 v10, v14, s38, v10
    v_mov_b32 v11, 0x0
    v_bfe_u32 v14, v0, 0, 1
    s_mov_b32 s38, 0x10
    v_mad_u32_u24 v11, v14, s38, v11
    v_bfe_u32 v14, v0, 1, 1
    s_mov_b32 s38, 0x20
    v_mad_u32_u24 v11, v14, s38, v11
    v_bfe_u32 v14, v0, 2, 1
    s_mov_b32 s38, 0x40
    v_mad_u32_u24 v11, v14, s38, v11
    v_bfe_u32 v14, v0, 3, 1
    s_mov_b32 s38, 0x80
    v_mad_u32_u24 v11, v14, s38, v11
    v_bfe_u32 v14, v0, 4, 1
    s_mov_b32 s38, 0x400
    v_mad_u32_u24 v11, v14, s38, v11
    v_bfe_u32 v14, v0, 5, 1
    s_mov_b32 s38, 0x800
    v_mad_u32_u24 v11, v14, s38, v11
    v_bfe_u32 v14, v0, 6, 1
    s_mov_b32 s38, 0x100
    v_mad_u32_u24 v11, v14, s38, v11
    v_bfe_u32 v14, v0, 7, 1
    s_mov_b32 s38, 0x200
    v_mad_u32_u24 v11, v14, s38, v11
    v_mov_b32 v12, 0x0
    v_bfe_u32 v14, v0, 0, 1
    s_mov_b32 s38, 0x10
    v_mad_u32_u24 v12, v14, s38, v12
    v_bfe_u32 v14, v0, 1, 1
    s_mov_b32 s38, 0x20
    v_mad_u32_u24 v12, v14, s38, v12
    v_bfe_u32 v14, v0, 2, 1
    s_mov_b32 s38, 0x40
    v_mad_u32_u24 v12, v14, s38, v12
    v_bfe_u32 v14, v0, 3, 1
    s_mov_b32 s38, 0x80
    v_mad_u32_u24 v12, v14, s38, v12
    v_bfe_u32 v14, v0, 4, 1
    s_mov_b32 s38, 0x4
    v_mad_u32_u24 v12, v14, s38, v12
    v_bfe_u32 v14, v0, 5, 1
    s_mov_b32 s38, 0x8
    v_mad_u32_u24 v12, v14, s38, v12
    v_bfe_u32 v14, v0, 6, 1
    s_mov_b32 s38, 0x100
    v_mad_u32_u24 v12, v14, s38, v12
    v_bfe_u32 v14, v0, 7, 1
    s_mov_b32 s38, 0x200
    v_mad_u32_u24 v12, v14, s38, v12
    v_mov_b32 v13, 0xf149f2ca
    v_and_b32 v14, 15, v0
    v_bfe_u32 v15, v0, 4, 2
    v_cmp_gt_u32 s[72:73], 2, v15
    v_lshlrev_b32 v15, 2, v15
    v_cmp_le_u32 s[64:65], v15, v14
    v_add_u32 v15, 1, v15
    v_cmp_le_u32 s[66:67], v15, v14
    v_add_u32 v15, 1, v15
    v_cmp_le_u32 s[68:69], v15, v14
    v_add_u32 v15, 1, v15
    v_cmp_le_u32 s[70:71], v15, v14
    v_add_u32 v15, 1, v15
    s_mov_b32 s34, 0x05040100
    s_mov_b32 s35, 0x07060302
    s_mov_b32 s33, 0x3e0293ee
    s_mov_b32 s32, 0
    s_mov_b32 s4, 0x3f803f80
    s_mov_b32 s5, 0x3f803f80
    s_mov_b32 s23, s22
    s_lshl_b32 s36, s23, 15
    buffer_load_dwordx4 v[96:99], v3, s[12:15], s36 offen offset:0
    buffer_load_dwordx4 v[100:103], v3, s[12:15], s36 offen offset:128
    buffer_load_dwordx4 v[104:107], v3, s[12:15], s36 offen offset:256
    buffer_load_dwordx4 v[108:111], v3, s[12:15], s36 offen offset:384
    buffer_load_dwordx4 v[112:115], v3, s[12:15], s36 offen offset:512
    buffer_load_dwordx4 v[116:119], v3, s[12:15], s36 offen offset:640
    buffer_load_dwordx4 v[120:123], v3, s[12:15], s36 offen offset:768
    buffer_load_dwordx4 v[124:127], v3, s[12:15], s36 offen offset:896
    s_waitcnt vmcnt(33)
    s_barrier
    ds_read_b64_tr_b16 v[128:129], v20 offset:0
    ds_read_b64_tr_b16 v[130:131], v20 offset:1024
    ds_read_b64_tr_b16 v[132:133], v21 offset:0
    ds_read_b64_tr_b16 v[134:135], v21 offset:1024
    ds_read_b64_tr_b16 v[136:137], v22 offset:0
    ds_read_b64_tr_b16 v[138:139], v22 offset:1024
    ds_read_b64_tr_b16 v[140:141], v23 offset:0
    ds_read_b64_tr_b16 v[142:143], v23 offset:1024
    ds_read_b64_tr_b16 v[144:145], v24 offset:0
    ds_read_b64_tr_b16 v[146:147], v24 offset:1024
    ds_read_b64_tr_b16 v[148:149], v25 offset:0
    ds_read_b64_tr_b16 v[150:151], v25 offset:1024
    s_waitcnt lgkmcnt(4)
    ds_read_b64_tr_b16 v[152:153], v26 offset:0
    ds_read_b64_tr_b16 v[154:155], v26 offset:1024
    ds_read_b64_tr_b16 v[156:157], v27 offset:0
    ds_read_b64_tr_b16 v[158:159], v27 offset:1024
    s_waitcnt lgkmcnt(0)
    s_barrier
    s_mov_b32 s40, s50
    s_and_b32 s41, s51, 0xffff
    s_mov_b32 s42, 0x400000
    s_mov_b32 s43, 0x20000
    s_add_u32 m0, s28, 0
    s_add_u32 s37, s3, 0x0
    buffer_load_dwordx4 v16, s[40:43], s37 offen lds
    s_add_u32 m0, s28, 1024
    s_add_u32 s37, s3, 0x8000
    buffer_load_dwordx4 v17, s[40:43], s37 offen lds
    s_add_u32 m0, s28, 2048
    s_add_u32 s37, s3, 0x10000
    buffer_load_dwordx4 v18, s[40:43], s37 offen lds
    s_add_u32 m0, s28, 3072
    s_add_u32 s37, s3, 0x18000
    buffer_load_dwordx4 v19, s[40:43], s37 offen lds
    s_add_u32 m0, s28, 4096
    s_add_u32 s37, s3, 0x20000
    buffer_load_dwordx4 v16, s[40:43], s37 offen lds
    s_add_u32 m0, s28, 5120
    s_add_u32 s37, s3, 0x28000
    buffer_load_dwordx4 v17, s[40:43], s37 offen lds
    s_add_u32 m0, s28, 6144
    s_add_u32 s37, s3, 0x30000
    buffer_load_dwordx4 v18, s[40:43], s37 offen lds
    s_add_u32 m0, s28, 7168
    s_add_u32 s37, s3, 0x38000
    buffer_load_dwordx4 v19, s[40:43], s37 offen lds
    s_waitcnt vmcnt(33)
    s_barrier
    ds_read_b64_tr_b16 v[160:161], v20 offset:8192
    ds_read_b64_tr_b16 v[162:163], v20 offset:9216
    ds_read_b64_tr_b16 v[164:165], v21 offset:8192
    ds_read_b64_tr_b16 v[166:167], v21 offset:9216
    ds_read_b64_tr_b16 v[168:169], v22 offset:8192
    ds_read_b64_tr_b16 v[170:171], v22 offset:9216
    ds_read_b64_tr_b16 v[172:173], v23 offset:8192
    ds_read_b64_tr_b16 v[174:175], v23 offset:9216
    ds_read_b64_tr_b16 v[176:177], v24 offset:8192
    ds_read_b64_tr_b16 v[178:179], v24 offset:9216
    ds_read_b64_tr_b16 v[180:181], v25 offset:8192
    ds_read_b64_tr_b16 v[182:183], v25 offset:9216
    s_waitcnt lgkmcnt(4)
    ds_read_b64_tr_b16 v[184:185], v26 offset:8192
    ds_read_b64_tr_b16 v[186:187], v26 offset:9216
    ds_read_b64_tr_b16 v[188:189], v27 offset:8192
    ds_read_b64_tr_b16 v[190:191], v27 offset:9216
    s_waitcnt lgkmcnt(0)
    s_barrier
    s_add_u32 m0, s28, 8192
    s_add_u32 s37, s3, 0x100000
    buffer_load_dwordx4 v16, s[40:43], s37 offen lds
    s_add_u32 m0, s28, 9216
    s_add_u32 s37, s3, 0x108000
    buffer_load_dwordx4 v17, s[40:43], s37 offen lds
    s_add_u32 m0, s28, 10240
    s_add_u32 s37, s3, 0x110000
    buffer_load_dwordx4 v18, s[40:43], s37 offen lds
    s_add_u32 m0, s28, 11264
    s_add_u32 s37, s3, 0x118000
    buffer_load_dwordx4 v19, s[40:43], s37 offen lds
    s_add_u32 m0, s28, 12288
    s_add_u32 s37, s3, 0x120000
    buffer_load_dwordx4 v16, s[40:43], s37 offen lds
    s_add_u32 m0, s28, 13312
    s_add_u32 s37, s3, 0x128000
    buffer_load_dwordx4 v17, s[40:43], s37 offen lds
    s_add_u32 m0, s28, 14336
    s_add_u32 s37, s3, 0x130000
    buffer_load_dwordx4 v18, s[40:43], s37 offen lds
    s_add_u32 m0, s28, 15360
    s_add_u32 s37, s3, 0x138000
    buffer_load_dwordx4 v19, s[40:43], s37 offen lds
    s_waitcnt vmcnt(33)
    s_barrier
    ds_read_b64_tr_b16 v[192:193], v20 offset:16384
    ds_read_b64_tr_b16 v[194:195], v20 offset:17408
    ds_read_b64_tr_b16 v[196:197], v21 offset:16384
    ds_read_b64_tr_b16 v[198:199], v21 offset:17408
    ds_read_b64_tr_b16 v[200:201], v22 offset:16384
    ds_read_b64_tr_b16 v[202:203], v22 offset:17408
    ds_read_b64_tr_b16 v[204:205], v23 offset:16384
    ds_read_b64_tr_b16 v[206:207], v23 offset:17408
    ds_read_b64_tr_b16 v[208:209], v24 offset:16384
    ds_read_b64_tr_b16 v[210:211], v24 offset:17408
    ds_read_b64_tr_b16 v[212:213], v25 offset:16384
    ds_read_b64_tr_b16 v[214:215], v25 offset:17408
    s_waitcnt lgkmcnt(4)
    ds_read_b64_tr_b16 v[216:217], v26 offset:16384
    ds_read_b64_tr_b16 v[218:219], v26 offset:17408
    ds_read_b64_tr_b16 v[220:221], v27 offset:16384
    ds_read_b64_tr_b16 v[222:223], v27 offset:17408
    s_waitcnt lgkmcnt(0)
    s_barrier
    s_add_u32 m0, s28, 16384
    s_add_u32 s37, s3, 0x200000
    buffer_load_dwordx4 v16, s[40:43], s37 offen lds
    s_add_u32 m0, s28, 17408
    s_add_u32 s37, s3, 0x208000
    buffer_load_dwordx4 v17, s[40:43], s37 offen lds
    s_add_u32 m0, s28, 18432
    s_add_u32 s37, s3, 0x210000
    buffer_load_dwordx4 v18, s[40:43], s37 offen lds
    s_add_u32 m0, s28, 19456
    s_add_u32 s37, s3, 0x218000
    buffer_load_dwordx4 v19, s[40:43], s37 offen lds
    s_add_u32 m0, s28, 20480
    s_add_u32 s37, s3, 0x220000
    buffer_load_dwordx4 v16, s[40:43], s37 offen lds
    s_add_u32 m0, s28, 21504
    s_add_u32 s37, s3, 0x228000
    buffer_load_dwordx4 v17, s[40:43], s37 offen lds
    s_add_u32 m0, s28, 22528
    s_add_u32 s37, s3, 0x230000
    buffer_load_dwordx4 v18, s[40:43], s37 offen lds
    s_add_u32 m0, s28, 23552
    s_add_u32 s37, s3, 0x238000
    buffer_load_dwordx4 v19, s[40:43], s37 offen lds
    s_waitcnt vmcnt(33)
    s_barrier
    ds_read_b64_tr_b16 v[224:225], v20 offset:24576
    ds_read_b64_tr_b16 v[226:227], v20 offset:25600
    ds_read_b64_tr_b16 v[228:229], v21 offset:24576
    ds_read_b64_tr_b16 v[230:231], v21 offset:25600
    ds_read_b64_tr_b16 v[232:233], v22 offset:24576
    ds_read_b64_tr_b16 v[234:235], v22 offset:25600
    ds_read_b64_tr_b16 v[236:237], v23 offset:24576
    ds_read_b64_tr_b16 v[238:239], v23 offset:25600
    ds_read_b64_tr_b16 v[240:241], v24 offset:24576
    ds_read_b64_tr_b16 v[242:243], v24 offset:25600
    ds_read_b64_tr_b16 v[244:245], v25 offset:24576
    ds_read_b64_tr_b16 v[246:247], v25 offset:25600
    s_waitcnt lgkmcnt(4)
    ds_read_b64_tr_b16 v[248:249], v26 offset:24576
    ds_read_b64_tr_b16 v[250:251], v26 offset:25600
    ds_read_b64_tr_b16 v[252:253], v27 offset:24576
    ds_read_b64_tr_b16 v[254:255], v27 offset:25600
    s_waitcnt lgkmcnt(0)
    s_barrier
    s_add_u32 m0, s28, 24576
    s_add_u32 s37, s3, 0x300000
    buffer_load_dwordx4 v16, s[40:43], s37 offen lds
    s_add_u32 m0, s28, 25600
    s_add_u32 s37, s3, 0x308000
    buffer_load_dwordx4 v17, s[40:43], s37 offen lds
    s_add_u32 m0, s28, 26624
    s_add_u32 s37, s3, 0x310000
    buffer_load_dwordx4 v18, s[40:43], s37 offen lds
    s_add_u32 m0, s28, 27648
    s_add_u32 s37, s3, 0x318000
    buffer_load_dwordx4 v19, s[40:43], s37 offen lds
    s_add_u32 m0, s28, 28672
    s_add_u32 s37, s3, 0x320000
    buffer_load_dwordx4 v16, s[40:43], s37 offen lds
    s_add_u32 m0, s28, 29696
    s_add_u32 s37, s3, 0x328000
    buffer_load_dwordx4 v17, s[40:43], s37 offen lds
    s_add_u32 m0, s28, 30720
    s_add_u32 s37, s3, 0x330000
    buffer_load_dwordx4 v18, s[40:43], s37 offen lds
    s_add_u32 m0, s28, 31744
    s_add_u32 s37, s3, 0x338000
    buffer_load_dwordx4 v19, s[40:43], s37 offen lds
    s_waitcnt vmcnt(32)
    v_mov_b32 v88, 0
    v_mov_b32 v89, 0
    v_dot2_f32_bf16 v88, v96, s4, v88
    v_dot2_f32_bf16 v89, v96, v96, v89
    v_dot2_f32_bf16 v88, v97, s4, v88
    v_dot2_f32_bf16 v89, v97, v97, v89
    v_dot2_f32_bf16 v88, v98, s4, v88
    v_dot2_f32_bf16 v89, v98, v98, v89
    v_dot2_f32_bf16 v88, v99, s4, v88
    v_dot2_f32_bf16 v89, v99, v99, v89
    v_dot2_f32_bf16 v88, v100, s4, v88
    v_dot2_f32_bf16 v89, v100, v100, v89
    v_dot2_f32_bf16 v88, v101, s4, v88
    v_dot2_f32_bf16 v89, v101, v101, v89
    v_dot2_f32_bf16 v88, v102, s4, v88
    v_dot2_f32_bf16 v89, v102, v102, v89
    v_dot2_f32_bf16 v88, v103, s4, v88
    v_dot2_f32_bf16 v89, v103, v103, v89
    v_dot2_f32_bf16 v88, v104, s4, v88
    v_dot2_f32_bf16 v89, v104, v104, v89
    v_dot2_f32_bf16 v88, v105, s4, v88
    v_dot2_f32_bf16 v89, v105, v105, v89
    v_dot2_f32_bf16 v88, v106, s4, v88
    v_dot2_f32_bf16 v89, v106, v106, v89
    v_dot2_f32_bf16 v88, v107, s4, v88
    v_dot2_f32_bf16 v89, v107, v107, v89
    v_dot2_f32_bf16 v88, v108, s4, v88
    v_dot2_f32_bf16 v89, v108, v108, v89
    v_dot2_f32_bf16 v88, v109, s4, v88
    v_dot2_f32_bf16 v89, v109, v109, v89
    v_dot2_f32_bf16 v88, v110, s4, v88
    v_dot2_f32_bf16 v89, v110, v110, v89
    v_dot2_f32_bf16 v88, v111, s4, v88
    v_dot2_f32_bf16 v89, v111, v111, v89
    v_dot2_f32_bf16 v88, v112, s4, v88
    v_dot2_f32_bf16 v89, v112, v112, v89
    v_dot2_f32_bf16 v88, v113, s4, v88
    v_dot2_f32_bf16 v89, v113, v113, v89
    v_dot2_f32_bf16 v88, v114, s4, v88
    v_dot2_f32_bf16 v89, v114, v114, v89
    v_dot2_f32_bf16 v88, v115, s4, v88
    v_dot2_f32_bf16 v89, v115, v115, v89
    v_dot2_f32_bf16 v88, v116, s4, v88
    v_dot2_f32_bf16 v89, v116, v116, v89
    v_dot2_f32_bf16 v88, v117, s4, v88
    v_dot2_f32_bf16 v89, v117, v117, v89
    v_dot2_f32_bf16 v88, v118, s4, v88
    v_dot2_f32_bf16 v89, v118, v118, v89
    v_dot2_f32_bf16 v88, v119, s4, v88
    v_dot2_f32_bf16 v89, v119, v119, v89
    v_dot2_f32_bf16 v88, v120, s4, v88
    v_dot2_f32_bf16 v89, v120, v120, v89
    v_dot2_f32_bf16 v88, v121, s4, v88
    v_dot2_f32_bf16 v89, v121, v121, v89
    v_dot2_f32_bf16 v88, v122, s4, v88
    v_dot2_f32_bf16 v89, v122, v122, v89
    v_dot2_f32_bf16 v88, v123, s4, v88
    v_dot2_f32_bf16 v89, v123, v123, v89
    v_dot2_f32_bf16 v88, v124, s4, v88
    v_dot2_f32_bf16 v89, v124, v124, v89
    v_dot2_f32_bf16 v88, v125, s4, v88
    v_dot2_f32_bf16 v89, v125, v125, v89
    v_dot2_f32_bf16 v88, v126, s4, v88
    v_dot2_f32_bf16 v89, v126, v126, v89
    v_dot2_f32_bf16 v88, v127, s4, v88
    v_dot2_f32_bf16 v89, v127, v127, v89
    s_nop 3
    v_add_f32_dpp v88, v88, v88 quad_perm:[1,0,3,2] row_mask:0xf bank_mask:0xf
    v_add_f32_dpp v89, v89, v89 quad_perm:[1,0,3,2] row_mask:0xf bank_mask:0xf
    s_nop 0
    v_add_f32_dpp v88, v88, v88 quad_perm:[2,3,0,1] row_mask:0xf bank_mask:0xf
    v_add_f32_dpp v89, v89, v89 quad_perm:[2,3,0,1] row_mask:0xf bank_mask:0xf
    s_nop 0
    v_add_f32_dpp v88, v88, v88 row_half_mirror row_mask:0xf bank_mask:0xf
    v_add_f32_dpp v89, v89, v89 row_half_mirror row_mask:0xf bank_mask:0xf
    v_mul_f32 v88, 0x3b000000, v88
    v_mul_f32 v89, 0x3b000000, v89
    v_fma_f32 v89, -v88, v88, v89
    v_max_f32 v89, 0, v89
    v_cvt_pk_bf16_f32 v14, v88, v89
    v_lshlrev_b32 v88, 16, v14
    v_and_b32 v89, 0xffff0000, v14
    v_add_f32 v89, 0x3727c5ac, v89
    v_cvt_pk_bf16_f32 v14, v89, v89
    v_lshlrev_b32 v89, 16, v14
    v_sqrt_f32 v89, v89
    s_nop 0
    v_cvt_pk_bf16_f32 v14, v89, v89
    v_lshlrev_b32 v89, 16, v14
    v_rcp_f32 v89, v89
    v_lshlrev_b32 v90, 16, v96
    v_and_b32 v91, 0xffff0000, v96
    v_sub_f32 v90, v90, v88
    v_sub_f32 v91, v91, v88
    v_cvt_pk_bf16_f32 v96, v90, v91
    v_lshlrev_b32 v90, 16, v96
    v_and_b32 v91, 0xffff0000, v96
    v_mul_f32 v90, v90, v89
    v_mul_f32 v91, v91, v89
    v_cvt_pk_bf16_f32 v96, v90, v91
    v_lshlrev_b32 v90, 16, v97
    v_and_b32 v91, 0xffff0000, v97
    v_sub_f32 v90, v90, v88
    v_sub_f32 v91, v91, v88
    v_cvt_pk_bf16_f32 v97, v90, v91
    v_lshlrev_b32 v90, 16, v97
    v_and_b32 v91, 0xffff0000, v97
    v_mul_f32 v90, v90, v89
    v_mul_f32 v91, v91, v89
    v_cvt_pk_bf16_f32 v97, v90, v91
    v_lshlrev_b32 v90, 16, v98
    v_and_b32 v91, 0xffff0000, v98
    v_sub_f32 v90, v90, v88
    v_sub_f32 v91, v91, v88
    v_cvt_pk_bf16_f32 v98, v90, v91
    v_lshlrev_b32 v90, 16, v98
    v_and_b32 v91, 0xffff0000, v98
    v_mul_f32 v90, v90, v89
    v_mul_f32 v91, v91, v89
    v_cvt_pk_bf16_f32 v98, v90, v91
    v_lshlrev_b32 v90, 16, v99
    v_and_b32 v91, 0xffff0000, v99
    v_sub_f32 v90, v90, v88
    v_sub_f32 v91, v91, v88
    v_cvt_pk_bf16_f32 v99, v90, v91
    v_lshlrev_b32 v90, 16, v99
    v_and_b32 v91, 0xffff0000, v99
    v_mul_f32 v90, v90, v89
    v_mul_f32 v91, v91, v89
    v_cvt_pk_bf16_f32 v99, v90, v91
    ds_write_b128 v4, v[96:99] offset:0
    v_lshlrev_b32 v90, 16, v100
    v_and_b32 v91, 0xffff0000, v100
    v_sub_f32 v90, v90, v88
    v_sub_f32 v91, v91, v88
    v_cvt_pk_bf16_f32 v100, v90, v91
    v_lshlrev_b32 v90, 16, v100
    v_and_b32 v91, 0xffff0000, v100
    v_mul_f32 v90, v90, v89
    v_mul_f32 v91, v91, v89
    v_cvt_pk_bf16_f32 v100, v90, v91
    v_lshlrev_b32 v90, 16, v101
    v_and_b32 v91, 0xffff0000, v101
    v_sub_f32 v90, v90, v88
    v_sub_f32 v91, v91, v88
    v_cvt_pk_bf16_f32 v101, v90, v91
    v_lshlrev_b32 v90, 16, v101
    v_and_b32 v91, 0xffff0000, v101
    v_mul_f32 v90, v90, v89
    v_mul_f32 v91, v91, v89
    v_cvt_pk_bf16_f32 v101, v90, v91
    v_lshlrev_b32 v90, 16, v102
    v_and_b32 v91, 0xffff0000, v102
    v_sub_f32 v90, v90, v88
    v_sub_f32 v91, v91, v88
    v_cvt_pk_bf16_f32 v102, v90, v91
    v_lshlrev_b32 v90, 16, v102
    v_and_b32 v91, 0xffff0000, v102
    v_mul_f32 v90, v90, v89
    v_mul_f32 v91, v91, v89
    v_cvt_pk_bf16_f32 v102, v90, v91
    v_lshlrev_b32 v90, 16, v103
    v_and_b32 v91, 0xffff0000, v103
    v_sub_f32 v90, v90, v88
    v_sub_f32 v91, v91, v88
    v_cvt_pk_bf16_f32 v103, v90, v91
    v_lshlrev_b32 v90, 16, v103
    v_and_b32 v91, 0xffff0000, v103
    v_mul_f32 v90, v90, v89
    v_mul_f32 v91, v91, v89
    v_cvt_pk_bf16_f32 v103, v90, v91
    ds_write_b128 v4, v[100:103] offset:2048
    v_lshlrev_b32 v90, 16, v104
    v_and_b32 v91, 0xffff0000, v104
    v_sub_f32 v90, v90, v88
    v_sub_f32 v91, v91, v88
    v_cvt_pk_bf16_f32 v104, v90, v91
    v_lshlrev_b32 v90, 16, v104
    v_and_b32 v91, 0xffff0000, v104
    v_mul_f32 v90, v90, v89
    v_mul_f32 v91, v91, v89
    v_cvt_pk_bf16_f32 v104, v90, v91
    v_lshlrev_b32 v90, 16, v105
    v_and_b32 v91, 0xffff0000, v105
    v_sub_f32 v90, v90, v88
    v_sub_f32 v91, v91, v88
    v_cvt_pk_bf16_f32 v105, v90, v91
    v_lshlrev_b32 v90, 16, v105
    v_and_b32 v91, 0xffff0000, v105
    v_mul_f32 v90, v90, v89
    v_mul_f32 v91, v91, v89
    v_cvt_pk_bf16_f32 v105, v90, v91
    v_lshlrev_b32 v90, 16, v106
    v_and_b32 v91, 0xffff0000, v106
    v_sub_f32 v90, v90, v88
    v_sub_f32 v91, v91, v88
    v_cvt_pk_bf16_f32 v106, v90, v91
    v_lshlrev_b32 v90, 16, v106
    v_and_b32 v91, 0xffff0000, v106
    v_mul_f32 v90, v90, v89
    v_mul_f32 v91, v91, v89
    v_cvt_pk_bf16_f32 v106, v90, v91
    v_lshlrev_b32 v90, 16, v107
    v_and_b32 v91, 0xffff0000, v107
    v_sub_f32 v90, v90, v88
    v_sub_f32 v91, v91, v88
    v_cvt_pk_bf16_f32 v107, v90, v91
    v_lshlrev_b32 v90, 16, v107
    v_and_b32 v91, 0xffff0000, v107
    v_mul_f32 v90, v90, v89
    v_mul_f32 v91, v91, v89
    v_cvt_pk_bf16_f32 v107, v90, v91
    ds_write_b128 v4, v[104:107] offset:4096
    v_lshlrev_b32 v90, 16, v108
    v_and_b32 v91, 0xffff0000, v108
    v_sub_f32 v90, v90, v88
    v_sub_f32 v91, v91, v88
    v_cvt_pk_bf16_f32 v108, v90, v91
    v_lshlrev_b32 v90, 16, v108
    v_and_b32 v91, 0xffff0000, v108
    v_mul_f32 v90, v90, v89
    v_mul_f32 v91, v91, v89
    v_cvt_pk_bf16_f32 v108, v90, v91
    v_lshlrev_b32 v90, 16, v109
    v_and_b32 v91, 0xffff0000, v109
    v_sub_f32 v90, v90, v88
    v_sub_f32 v91, v91, v88
    v_cvt_pk_bf16_f32 v109, v90, v91
    v_lshlrev_b32 v90, 16, v109
    v_and_b32 v91, 0xffff0000, v109
    v_mul_f32 v90, v90, v89
    v_mul_f32 v91, v91, v89
    v_cvt_pk_bf16_f32 v109, v90, v91
    v_lshlrev_b32 v90, 16, v110
    v_and_b32 v91, 0xffff0000, v110
    v_sub_f32 v90, v90, v88
    v_sub_f32 v91, v91, v88
    v_cvt_pk_bf16_f32 v110, v90, v91
    v_lshlrev_b32 v90, 16, v110
    v_and_b32 v91, 0xffff0000, v110
    v_mul_f32 v90, v90, v89
    v_mul_f32 v91, v91, v89
    v_cvt_pk_bf16_f32 v110, v90, v91
    v_lshlrev_b32 v90, 16, v111
    v_and_b32 v91, 0xffff0000, v111
    v_sub_f32 v90, v90, v88
    v_sub_f32 v91, v91, v88
    v_cvt_pk_bf16_f32 v111, v90, v91
    v_lshlrev_b32 v90, 16, v111
    v_and_b32 v91, 0xffff0000, v111
    v_mul_f32 v90, v90, v89
    v_mul_f32 v91, v91, v89
    v_cvt_pk_bf16_f32 v111, v90, v91
    ds_write_b128 v4, v[108:111] offset:6144
    v_lshlrev_b32 v90, 16, v112
    v_and_b32 v91, 0xffff0000, v112
    v_sub_f32 v90, v90, v88
    v_sub_f32 v91, v91, v88
    v_cvt_pk_bf16_f32 v112, v90, v91
    v_lshlrev_b32 v90, 16, v112
    v_and_b32 v91, 0xffff0000, v112
    v_mul_f32 v90, v90, v89
    v_mul_f32 v91, v91, v89
    v_cvt_pk_bf16_f32 v112, v90, v91
    v_lshlrev_b32 v90, 16, v113
    v_and_b32 v91, 0xffff0000, v113
    v_sub_f32 v90, v90, v88
    v_sub_f32 v91, v91, v88
    v_cvt_pk_bf16_f32 v113, v90, v91
    v_lshlrev_b32 v90, 16, v113
    v_and_b32 v91, 0xffff0000, v113
    v_mul_f32 v90, v90, v89
    v_mul_f32 v91, v91, v89
    v_cvt_pk_bf16_f32 v113, v90, v91
    v_lshlrev_b32 v90, 16, v114
    v_and_b32 v91, 0xffff0000, v114
    v_sub_f32 v90, v90, v88
    v_sub_f32 v91, v91, v88
    v_cvt_pk_bf16_f32 v114, v90, v91
    v_lshlrev_b32 v90, 16, v114
    v_and_b32 v91, 0xffff0000, v114
    v_mul_f32 v90, v90, v89
    v_mul_f32 v91, v91, v89
    v_cvt_pk_bf16_f32 v114, v90, v91
    v_lshlrev_b32 v90, 16, v115
    v_and_b32 v91, 0xffff0000, v115
    v_sub_f32 v90, v90, v88
    v_sub_f32 v91, v91, v88
    v_cvt_pk_bf16_f32 v115, v90, v91
    v_lshlrev_b32 v90, 16, v115
    v_and_b32 v91, 0xffff0000, v115
    v_mul_f32 v90, v90, v89
    v_mul_f32 v91, v91, v89
    v_cvt_pk_bf16_f32 v115, v90, v91
    ds_write_b128 v4, v[112:115] offset:8192
    v_lshlrev_b32 v90, 16, v116
    v_and_b32 v91, 0xffff0000, v116
    v_sub_f32 v90, v90, v88
    v_sub_f32 v91, v91, v88
    v_cvt_pk_bf16_f32 v116, v90, v91
    v_lshlrev_b32 v90, 16, v116
    v_and_b32 v91, 0xffff0000, v116
    v_mul_f32 v90, v90, v89
    v_mul_f32 v91, v91, v89
    v_cvt_pk_bf16_f32 v116, v90, v91
    v_lshlrev_b32 v90, 16, v117
    v_and_b32 v91, 0xffff0000, v117
    v_sub_f32 v90, v90, v88
    v_sub_f32 v91, v91, v88
    v_cvt_pk_bf16_f32 v117, v90, v91
    v_lshlrev_b32 v90, 16, v117
    v_and_b32 v91, 0xffff0000, v117
    v_mul_f32 v90, v90, v89
    v_mul_f32 v91, v91, v89
    v_cvt_pk_bf16_f32 v117, v90, v91
    v_lshlrev_b32 v90, 16, v118
    v_and_b32 v91, 0xffff0000, v118
    v_sub_f32 v90, v90, v88
    v_sub_f32 v91, v91, v88
    v_cvt_pk_bf16_f32 v118, v90, v91
    v_lshlrev_b32 v90, 16, v118
    v_and_b32 v91, 0xffff0000, v118
    v_mul_f32 v90, v90, v89
    v_mul_f32 v91, v91, v89
    v_cvt_pk_bf16_f32 v118, v90, v91
    v_lshlrev_b32 v90, 16, v119
    v_and_b32 v91, 0xffff0000, v119
    v_sub_f32 v90, v90, v88
    v_sub_f32 v91, v91, v88
    v_cvt_pk_bf16_f32 v119, v90, v91
    v_lshlrev_b32 v90, 16, v119
    v_and_b32 v91, 0xffff0000, v119
    v_mul_f32 v90, v90, v89
    v_mul_f32 v91, v91, v89
    v_cvt_pk_bf16_f32 v119, v90, v91
    ds_write_b128 v4, v[116:119] offset:10240
    v_lshlrev_b32 v90, 16, v120
    v_and_b32 v91, 0xffff0000, v120
    v_sub_f32 v90, v90, v88
    v_sub_f32 v91, v91, v88
    v_cvt_pk_bf16_f32 v120, v90, v91
    v_lshlrev_b32 v90, 16, v120
    v_and_b32 v91, 0xffff0000, v120
    v_mul_f32 v90, v90, v89
    v_mul_f32 v91, v91, v89
    v_cvt_pk_bf16_f32 v120, v90, v91
    v_lshlrev_b32 v90, 16, v121
    v_and_b32 v91, 0xffff0000, v121
    v_sub_f32 v90, v90, v88
    v_sub_f32 v91, v91, v88
    v_cvt_pk_bf16_f32 v121, v90, v91
    v_lshlrev_b32 v90, 16, v121
    v_and_b32 v91, 0xffff0000, v121
    v_mul_f32 v90, v90, v89
    v_mul_f32 v91, v91, v89
    v_cvt_pk_bf16_f32 v121, v90, v91
    v_lshlrev_b32 v90, 16, v122
    v_and_b32 v91, 0xffff0000, v122
    v_sub_f32 v90, v90, v88
    v_sub_f32 v91, v91, v88
    v_cvt_pk_bf16_f32 v122, v90, v91
    v_lshlrev_b32 v90, 16, v122
    v_and_b32 v91, 0xffff0000, v122
    v_mul_f32 v90, v90, v89
    v_mul_f32 v91, v91, v89
    v_cvt_pk_bf16_f32 v122, v90, v91
    v_lshlrev_b32 v90, 16, v123
    v_and_b32 v91, 0xffff0000, v123
    v_sub_f32 v90, v90, v88
    v_sub_f32 v91, v91, v88
    v_cvt_pk_bf16_f32 v123, v90, v91
    v_lshlrev_b32 v90, 16, v123
    v_and_b32 v91, 0xffff0000, v123
    v_mul_f32 v90, v90, v89
    v_mul_f32 v91, v91, v89
    v_cvt_pk_bf16_f32 v123, v90, v91
    ds_write_b128 v4, v[120:123] offset:12288
    v_lshlrev_b32 v90, 16, v124
    v_and_b32 v91, 0xffff0000, v124
    v_sub_f32 v90, v90, v88
    v_sub_f32 v91, v91, v88
    v_cvt_pk_bf16_f32 v124, v90, v91
    v_lshlrev_b32 v90, 16, v124
    v_and_b32 v91, 0xffff0000, v124
    v_mul_f32 v90, v90, v89
    v_mul_f32 v91, v91, v89
    v_cvt_pk_bf16_f32 v124, v90, v91
    v_lshlrev_b32 v90, 16, v125
    v_and_b32 v91, 0xffff0000, v125
    v_sub_f32 v90, v90, v88
    v_sub_f32 v91, v91, v88
    v_cvt_pk_bf16_f32 v125, v90, v91
    v_lshlrev_b32 v90, 16, v125
    v_and_b32 v91, 0xffff0000, v125
    v_mul_f32 v90, v90, v89
    v_mul_f32 v91, v91, v89
    v_cvt_pk_bf16_f32 v125, v90, v91
    v_lshlrev_b32 v90, 16, v126
    v_and_b32 v91, 0xffff0000, v126
    v_sub_f32 v90, v90, v88
    v_sub_f32 v91, v91, v88
    v_cvt_pk_bf16_f32 v126, v90, v91
    v_lshlrev_b32 v90, 16, v126
    v_and_b32 v91, 0xffff0000, v126
    v_mul_f32 v90, v90, v89
    v_mul_f32 v91, v91, v89
    v_cvt_pk_bf16_f32 v126, v90, v91
    v_lshlrev_b32 v90, 16, v127
    v_and_b32 v91, 0xffff0000, v127
    v_sub_f32 v90, v90, v88
    v_sub_f32 v91, v91, v88
    v_cvt_pk_bf16_f32 v127, v90, v91
    v_lshlrev_b32 v90, 16, v127
    v_and_b32 v91, 0xffff0000, v127
    v_mul_f32 v90, v90, v89
    v_mul_f32 v91, v91, v89
    v_cvt_pk_bf16_f32 v127, v90, v91
    ds_write_b128 v4, v[124:127] offset:14336
    s_lshr_b32 s36, s21, 1
    s_lshl_b32 s36, s36, 14
    s_xor_b32 s37, s36, 16384
    v_add_u32 v80, s36, v5
    v_add_u32 v81, s37, v5
    v_add_u32 v82, s36, v6
    v_add_u32 v83, s37, v6
    s_mov_b32 s31, 0
    s_waitcnt vmcnt(24)
    s_barrier
    ds_read_b64_tr_b16 a[128:129], v20 offset:0
    ds_read_b64_tr_b16 a[130:131], v20 offset:1024
    ds_read_b64_tr_b16 a[132:133], v21 offset:0
    ds_read_b64_tr_b16 a[134:135], v21 offset:1024
    ds_read_b64_tr_b16 a[136:137], v22 offset:0
    ds_read_b64_tr_b16 a[138:139], v22 offset:1024
    ds_read_b64_tr_b16 a[140:141], v23 offset:0
    ds_read_b64_tr_b16 a[142:143], v23 offset:1024
    ds_read_b64_tr_b16 a[144:145], v24 offset:0
    ds_read_b64_tr_b16 a[146:147], v24 offset:1024
    ds_read_b64_tr_b16 a[148:149], v25 offset:0
    ds_read_b64_tr_b16 a[150:151], v25 offset:1024
    s_waitcnt lgkmcnt(4)
    ds_read_b64_tr_b16 a[152:153], v26 offset:0
    ds_read_b64_tr_b16 a[154:155], v26 offset:1024
    ds_read_b64_tr_b16 a[156:157], v27 offset:0
    ds_read_b64_tr_b16 a[158:159], v27 offset:1024
    s_waitcnt lgkmcnt(0)
    s_barrier
    s_mov_b32 s96, s48
    s_and_b32 s97, s49, 0xffff
    s_mov_b32 s98, 0x400000
    s_mov_b32 s99, 0x20000
    s_add_u32 m0, s28, 0
    s_add_u32 s37, s3, 0x0
    buffer_load_dwordx4 v16, s[96:99], s37 offen lds
    s_add_u32 m0, s28, 1024
    s_add_u32 s37, s3, 0x8000
    buffer_load_dwordx4 v17, s[96:99], s37 offen lds
    s_add_u32 m0, s28, 2048
    s_add_u32 s37, s3, 0x10000
    buffer_load_dwordx4 v18, s[96:99], s37 offen lds
    s_add_u32 m0, s28, 3072
    s_add_u32 s37, s3, 0x18000
    buffer_load_dwordx4 v19, s[96:99], s37 offen lds
    s_add_u32 m0, s28, 4096
    s_add_u32 s37, s3, 0x20000
    buffer_load_dwordx4 v16, s[96:99], s37 offen lds
    s_add_u32 m0, s28, 5120
    s_add_u32 s37, s3, 0x28000
    buffer_load_dwordx4 v17, s[96:99], s37 offen lds
    s_add_u32 m0, s28, 6144
    s_add_u32 s37, s3, 0x30000
    buffer_load_dwordx4 v18, s[96:99], s37 offen lds
    s_add_u32 m0, s28, 7168
    s_add_u32 s37, s3, 0x38000
    buffer_load_dwordx4 v19, s[96:99], s37 offen lds
    s_waitcnt vmcnt(24)
    s_barrier
    ds_read_b64_tr_b16 a[160:161], v20 offset:8192
    ds_read_b64_tr_b16 a[162:163], v20 offset:9216
    ds_read_b64_tr_b16 a[164:165], v21 offset:8192
    ds_read_b64_tr_b16 a[166:167], v21 offset:9216
    ds_read_b64_tr_b16 a[168:169], v22 offset:8192
    ds_read_b64_tr_b16 a[170:171], v22 offset:9216
    ds_read_b64_tr_b16 a[172:173], v23 offset:8192
    ds_read_b64_tr_b16 a[174:175], v23 offset:9216
    ds_read_b64_tr_b16 a[176:177], v24 offset:8192
    ds_read_b64_tr_b16 a[178:179], v24 offset:9216
    ds_read_b64_tr_b16 a[180:181], v25 offset:8192
    ds_read_b64_tr_b16 a[182:183], v25 offset:9216
    s_waitcnt lgkmcnt(4)
    ds_read_b64_tr_b16 a[184:185], v26 offset:8192
    ds_read_b64_tr_b16 a[186:187], v26 offset:9216
    ds_read_b64_tr_b16 a[188:189], v27 offset:8192
    ds_read_b64_tr_b16 a[190:191], v27 offset:9216
    s_waitcnt lgkmcnt(0)
    s_barrier
    s_add_u32 m0, s28, 8192
    s_add_u32 s37, s3, 0x100000
    buffer_load_dwordx4 v16, s[96:99], s37 offen lds
    s_add_u32 m0, s28, 9216
    s_add_u32 s37, s3, 0x108000
    buffer_load_dwordx4 v17, s[96:99], s37 offen lds
    s_add_u32 m0, s28, 10240
    s_add_u32 s37, s3, 0x110000
    buffer_load_dwordx4 v18, s[96:99], s37 offen lds
    s_add_u32 m0, s28, 11264
    s_add_u32 s37, s3, 0x118000
    buffer_load_dwordx4 v19, s[96:99], s37 offen lds
    s_add_u32 m0, s28, 12288
    s_add_u32 s37, s3, 0x120000
    buffer_load_dwordx4 v16, s[96:99], s37 offen lds
    s_add_u32 m0, s28, 13312
    s_add_u32 s37, s3, 0x128000
    buffer_load_dwordx4 v17, s[96:99], s37 offen lds
    s_add_u32 m0, s28, 14336
    s_add_u32 s37, s3, 0x130000
    buffer_load_dwordx4 v18, s[96:99], s37 offen lds
    s_add_u32 m0, s28, 15360
    s_add_u32 s37, s3, 0x138000
    buffer_load_dwordx4 v19, s[96:99], s37 offen lds
    s_waitcnt vmcnt(24)
    s_barrier
    ds_read_b64_tr_b16 a[192:193], v20 offset:16384
    ds_read_b64_tr_b16 a[194:195], v20 offset:17408
    ds_read_b64_tr_b16 a[196:197], v21 offset:16384
    ds_read_b64_tr_b16 a[198:199], v21 offset:17408
    ds_read_b64_tr_b16 a[200:201], v22 offset:16384
    ds_read_b64_tr_b16 a[202:203], v22 offset:17408
    ds_read_b64_tr_b16 a[204:205], v23 offset:16384
    ds_read_b64_tr_b16 a[206:207], v23 offset:17408
    ds_read_b64_tr_b16 a[208:209], v24 offset:16384
    ds_read_b64_tr_b16 a[210:211], v24 offset:17408
    ds_read_b64_tr_b16 a[212:213], v25 offset:16384
    ds_read_b64_tr_b16 a[214:215], v25 offset:17408
    s_waitcnt lgkmcnt(4)
    ds_read_b64_tr_b16 a[216:217], v26 offset:16384
    ds_read_b64_tr_b16 a[218:219], v26 offset:17408
    ds_read_b64_tr_b16 a[220:221], v27 offset:16384
    ds_read_b64_tr_b16 a[222:223], v27 offset:17408
    s_waitcnt lgkmcnt(0)
    s_barrier
    s_add_u32 m0, s28, 16384
    s_add_u32 s37, s3, 0x200000
    buffer_load_dwordx4 v16, s[96:99], s37 offen lds
    s_add_u32 m0, s28, 17408
    s_add_u32 s37, s3, 0x208000
    buffer_load_dwordx4 v17, s[96:99], s37 offen lds
    s_add_u32 m0, s28, 18432
    s_add_u32 s37, s3, 0x210000
    buffer_load_dwordx4 v18, s[96:99], s37 offen lds
    s_add_u32 m0, s28, 19456
    s_add_u32 s37, s3, 0x218000
    buffer_load_dwordx4 v19, s[96:99], s37 offen lds
    s_add_u32 m0, s28, 20480
    s_add_u32 s37, s3, 0x220000
    buffer_load_dwordx4 v16, s[96:99], s37 offen lds
    s_add_u32 m0, s28, 21504
    s_add_u32 s37, s3, 0x228000
    buffer_load_dwordx4 v17, s[96:99], s37 offen lds
    s_add_u32 m0, s28, 22528
    s_add_u32 s37, s3, 0x230000
    buffer_load_dwordx4 v18, s[96:99], s37 offen lds
    s_add_u32 m0, s28, 23552
    s_add_u32 s37, s3, 0x238000
    buffer_load_dwordx4 v19, s[96:99], s37 offen lds
    s_waitcnt vmcnt(24)
    s_barrier
    ds_read_b64_tr_b16 a[224:225], v20 offset:24576
    ds_read_b64_tr_b16 a[226:227], v20 offset:25600
    ds_read_b64_tr_b16 a[228:229], v21 offset:24576
    ds_read_b64_tr_b16 a[230:231], v21 offset:25600
    ds_read_b64_tr_b16 a[232:233], v22 offset:24576
    ds_read_b64_tr_b16 a[234:235], v22 offset:25600
    ds_read_b64_tr_b16 a[236:237], v23 offset:24576
    ds_read_b64_tr_b16 a[238:239], v23 offset:25600
    ds_read_b64_tr_b16 a[240:241], v24 offset:24576
    ds_read_b64_tr_b16 a[242:243], v24 offset:25600
    ds_read_b64_tr_b16 a[244:245], v25 offset:24576
    ds_read_b64_tr_b16 a[246:247], v25 offset:25600
    s_waitcnt lgkmcnt(4)
    ds_read_b64_tr_b16 a[248:249], v26 offset:24576
    ds_read_b64_tr_b16 a[250:251], v26 offset:25600
    ds_read_b64_tr_b16 a[252:253], v27 offset:24576
    ds_read_b64_tr_b16 a[254:255], v27 offset:25600
    s_waitcnt lgkmcnt(0)
    s_barrier
    s_add_u32 m0, s28, 24576
    s_add_u32 s37, s3, 0x300000
    buffer_load_dwordx4 v16, s[96:99], s37 offen lds
    s_add_u32 m0, s28, 25600
    s_add_u32 s37, s3, 0x308000
    buffer_load_dwordx4 v17, s[96:99], s37 offen lds
    s_add_u32 m0, s28, 26624
    s_add_u32 s37, s3, 0x310000
    buffer_load_dwordx4 v18, s[96:99], s37 offen lds
    s_add_u32 m0, s28, 27648
    s_add_u32 s37, s3, 0x318000
    buffer_load_dwordx4 v19, s[96:99], s37 offen lds
    s_add_u32 m0, s28, 28672
    s_add_u32 s37, s3, 0x320000
    buffer_load_dwordx4 v16, s[96:99], s37 offen lds
    s_add_u32 m0, s28, 29696
    s_add_u32 s37, s3, 0x328000
    buffer_load_dwordx4 v17, s[96:99], s37 offen lds
    s_add_u32 m0, s28, 30720
    s_add_u32 s37, s3, 0x330000
    buffer_load_dwordx4 v18, s[96:99], s37 offen lds
    s_add_u32 m0, s28, 31744
    s_add_u32 s37, s3, 0x338000
    buffer_load_dwordx4 v19, s[96:99], s37 offen lds
    ds_read_b128 v[64:67], v80 offset:0
    ds_read_b128 v[68:71], v81 offset:0
    ds_read_b128 v[72:75], v82 offset:1024
    ds_read_b128 v[76:79], v83 offset:1024
    s_waitcnt lgkmcnt(2)
    v_mfma_f32_16x16x32_bf16 v[32:35], a[128:131], v[64:67], 0
    v_mfma_f32_16x16x32_bf16 v[36:39], a[128:131], v[68:71], 0
    v_mfma_f32_16x16x32_bf16 v[40:43], a[132:135], v[64:67], 0
    v_mfma_f32_16x16x32_bf16 v[44:47], a[132:135], v[68:71], 0
    v_mfma_f32_16x16x32_bf16 v[48:51], v[64:67], v[128:131], 0
    v_mfma_f32_16x16x32_bf16 v[56:59], v[68:71], v[128:131], 0
    v_mfma_f32_16x16x32_bf16 v[52:55], v[64:67], v[132:135], 0
    v_mfma_f32_16x16x32_bf16 v[60:63], v[68:71], v[132:135], 0
    ds_read_b128 v[64:67], v80 offset:2048
    ds_read_b128 v[68:71], v81 offset:2048
    s_waitcnt lgkmcnt(2)
    v_mfma_f32_16x16x32_bf16 v[32:35], a[136:139], v[72:75], v[32:35]
    v_mfma_f32_16x16x32_bf16 v[36:39], a[136:139], v[76:79], v[36:39]
    v_mfma_f32_16x16x32_bf16 v[40:43], a[140:143], v[72:75], v[40:43]
    v_mfma_f32_16x16x32_bf16 v[44:47], a[140:143], v[76:79], v[44:47]
    v_mfma_f32_16x16x32_bf16 v[48:51], v[72:75], v[136:139], v[48:51]
    v_mfma_f32_16x16x32_bf16 v[56:59], v[76:79], v[136:139], v[56:59]
    v_mfma_f32_16x16x32_bf16 v[52:55], v[72:75], v[140:143], v[52:55]
    v_mfma_f32_16x16x32_bf16 v[60:63], v[76:79], v[140:143], v[60:63]
    ds_read_b128 v[72:75], v82 offset:3072
    ds_read_b128 v[76:79], v83 offset:3072
    s_waitcnt lgkmcnt(2)
    v_mfma_f32_16x16x32_bf16 v[32:35], a[144:147], v[64:67], v[32:35]
    v_mfma_f32_16x16x32_bf16 v[36:39], a[144:147], v[68:71], v[36:39]
    v_mfma_f32_16x16x32_bf16 v[40:43], a[148:151], v[64:67], v[40:43]
    v_mfma_f32_16x16x32_bf16 v[44:47], a[148:151], v[68:71], v[44:47]
    v_mfma_f32_16x16x32_bf16 v[48:51], v[64:67], v[144:147], v[48:51]
    v_mfma_f32_16x16x32_bf16 v[56:59], v[68:71], v[144:147], v[56:59]
    v_mfma_f32_16x16x32_bf16 v[52:55], v[64:67], v[148:151], v[52:55]
    v_mfma_f32_16x16x32_bf16 v[60:63], v[68:71], v[148:151], v[60:63]
    ds_read_b128 v[64:67], v80 offset:4096
    ds_read_b128 v[68:71], v81 offset:4096
    s_waitcnt lgkmcnt(2)
    v_mfma_f32_16x16x32_bf16 v[32:35], a[152:155], v[72:75], v[32:35]
    v_mfma_f32_16x16x32_bf16 v[36:39], a[152:155], v[76:79], v[36:39]
    v_mfma_f32_16x16x32_bf16 v[40:43], a[156:159], v[72:75], v[40:43]
    v_mfma_f32_16x16x32_bf16 v[44:47], a[156:159], v[76:79], v[44:47]
    v_mfma_f32_16x16x32_bf16 v[48:51], v[72:75], v[152:155], v[48:51]
    v_mfma_f32_16x16x32_bf16 v[56:59], v[76:79], v[152:155], v[56:59]
    v_mfma_f32_16x16x32_bf16 v[52:55], v[72:75], v[156:159], v[52:55]
    v_mfma_f32_16x16x32_bf16 v[60:63], v[76:79], v[156:159], v[60:63]
    ds_read_b128 v[72:75], v82 offset:5120
    ds_read_b128 v[76:79], v83 offset:5120
    s_waitcnt lgkmcnt(2)
    v_mfma_f32_16x16x32_bf16 v[32:35], a[160:163], v[64:67], v[32:35]
    v_mfma_f32_16x16x32_bf16 v[36:39], a[160:163], v[68:71], v[36:39]
    v_mfma_f32_16x16x32_bf16 v[40:43], a[164:167], v[64:67], v[40:43]
    v_mfma_f32_16x16x32_bf16 v[44:47], a[164:167], v[68:71], v[44:47]
    v_mfma_f32_16x16x32_bf16 v[48:51], v[64:67], v[160:163], v[48:51]
    v_mfma_f32_16x16x32_bf16 v[56:59], v[68:71], v[160:163], v[56:59]
    v_mfma_f32_16x16x32_bf16 v[52:55], v[64:67], v[164:167], v[52:55]
    v_mfma_f32_16x16x32_bf16 v[60:63], v[68:71], v[164:167], v[60:63]
    ds_read_b128 v[64:67], v80 offset:6144
    ds_read_b128 v[68:71], v81 offset:6144
    s_waitcnt lgkmcnt(2)
    v_mfma_f32_16x16x32_bf16 v[32:35], a[168:171], v[72:75], v[32:35]
    v_mfma_f32_16x16x32_bf16 v[36:39], a[168:171], v[76:79], v[36:39]
    v_mfma_f32_16x16x32_bf16 v[40:43], a[172:175], v[72:75], v[40:43]
    v_mfma_f32_16x16x32_bf16 v[44:47], a[172:175], v[76:79], v[44:47]
    v_mfma_f32_16x16x32_bf16 v[48:51], v[72:75], v[168:171], v[48:51]
    v_mfma_f32_16x16x32_bf16 v[56:59], v[76:79], v[168:171], v[56:59]
    v_mfma_f32_16x16x32_bf16 v[52:55], v[72:75], v[172:175], v[52:55]
    v_mfma_f32_16x16x32_bf16 v[60:63], v[76:79], v[172:175], v[60:63]
    ds_read_b128 v[72:75], v82 offset:7168
    ds_read_b128 v[76:79], v83 offset:7168
    s_waitcnt lgkmcnt(2)
    v_mfma_f32_16x16x32_bf16 v[32:35], a[176:179], v[64:67], v[32:35]
    v_mfma_f32_16x16x32_bf16 v[36:39], a[176:179], v[68:71], v[36:39]
    v_mfma_f32_16x16x32_bf16 v[40:43], a[180:183], v[64:67], v[40:43]
    v_mfma_f32_16x16x32_bf16 v[44:47], a[180:183], v[68:71], v[44:47]
    v_mfma_f32_16x16x32_bf16 v[48:51], v[64:67], v[176:179], v[48:51]
    v_mfma_f32_16x16x32_bf16 v[56:59], v[68:71], v[176:179], v[56:59]
    v_mfma_f32_16x16x32_bf16 v[52:55], v[64:67], v[180:183], v[52:55]
    v_mfma_f32_16x16x32_bf16 v[60:63], v[68:71], v[180:183], v[60:63]
    ds_read_b128 v[64:67], v80 offset:8192
    ds_read_b128 v[68:71], v81 offset:8192
    s_waitcnt lgkmcnt(2)
    v_mfma_f32_16x16x32_bf16 v[32:35], a[184:187], v[72:75], v[32:35]
    v_mfma_f32_16x16x32_bf16 v[36:39], a[184:187], v[76:79], v[36:39]
    v_mfma_f32_16x16x32_bf16 v[40:43], a[188:191], v[72:75], v[40:43]
    v_mfma_f32_16x16x32_bf16 v[44:47], a[188:191], v[76:79], v[44:47]
    v_mfma_f32_16x16x32_bf16 v[48:51], v[72:75], v[184:187], v[48:51]
    v_mfma_f32_16x16x32_bf16 v[56:59], v[76:79], v[184:187], v[56:59]
    v_mfma_f32_16x16x32_bf16 v[52:55], v[72:75], v[188:191], v[52:55]
    v_mfma_f32_16x16x32_bf16 v[60:63], v[76:79], v[188:191], v[60:63]
    ds_read_b128 v[72:75], v82 offset:9216
    ds_read_b128 v[76:79], v83 offset:9216
    s_waitcnt lgkmcnt(2)
    v_mfma_f32_16x16x32_bf16 v[32:35], a[192:195], v[64:67], v[32:35]
    v_mfma_f32_16x16x32_bf16 v[36:39], a[192:195], v[68:71], v[36:39]
    v_mfma_f32_16x16x32_bf16 v[40:43], a[196:199], v[64:67], v[40:43]
    v_mfma_f32_16x16x32_bf16 v[44:47], a[196:199], v[68:71], v[44:47]
    v_mfma_f32_16x16x32_bf16 v[48:51], v[64:67], v[192:195], v[48:51]
    v_mfma_f32_16x16x32_bf16 v[56:59], v[68:71], v[192:195], v[56:59]
    v_mfma_f32_16x16x32_bf16 v[52:55], v[64:67], v[196:199], v[52:55]
    v_mfma_f32_16x16x32_bf16 v[60:63], v[68:71], v[196:199], v[60:63]
    ds_read_b128 v[64:67], v80 offset:10240
    ds_read_b128 v[68:71], v81 offset:10240
    s_waitcnt lgkmcnt(2)
    v_mfma_f32_16x16x32_bf16 v[32:35], a[200:203], v[72:75], v[32:35]
    v_mfma_f32_16x16x32_bf16 v[36:39], a[200:203], v[76:79], v[36:39]
    v_mfma_f32_16x16x32_bf16 v[40:43], a[204:207], v[72:75], v[40:43]
    v_mfma_f32_16x16x32_bf16 v[44:47], a[204:207], v[76:79], v[44:47]
    v_mfma_f32_16x16x32_bf16 v[48:51], v[72:75], v[200:203], v[48:51]
    v_mfma_f32_16x16x32_bf16 v[56:59], v[76:79], v[200:203], v[56:59]
    v_mfma_f32_16x16x32_bf16 v[52:55], v[72:75], v[204:207], v[52:55]
    v_mfma_f32_16x16x32_bf16 v[60:63], v[76:79], v[204:207], v[60:63]
    ds_read_b128 v[72:75], v82 offset:11264
    ds_read_b128 v[76:79], v83 offset:11264
    s_waitcnt lgkmcnt(2)
    v_mfma_f32_16x16x32_bf16 v[32:35], a[208:211], v[64:67], v[32:35]
    v_mfma_f32_16x16x32_bf16 v[36:39], a[208:211], v[68:71], v[36:39]
    v_mfma_f32_16x16x32_bf16 v[40:43], a[212:215], v[64:67], v[40:43]
    v_mfma_f32_16x16x32_bf16 v[44:47], a[212:215], v[68:71], v[44:47]
    v_mfma_f32_16x16x32_bf16 v[48:51], v[64:67], v[208:211], v[48:51]
    v_mfma_f32_16x16x32_bf16 v[56:59], v[68:71], v[208:211], v[56:59]
    v_mfma_f32_16x16x32_bf16 v[52:55], v[64:67], v[212:215], v[52:55]
    v_mfma_f32_16x16x32_bf16 v[60:63], v[68:71], v[212:215], v[60:63]
    ds_read_b128 v[64:67], v80 offset:12288
    ds_read_b128 v[68:71], v81 offset:12288
    s_waitcnt lgkmcnt(2)
    v_mfma_f32_16x16x32_bf16 v[32:35], a[216:219], v[72:75], v[32:35]
    v_mfma_f32_16x16x32_bf16 v[36:39], a[216:219], v[76:79], v[36:39]
    v_mfma_f32_16x16x32_bf16 v[40:43], a[220:223], v[72:75], v[40:43]
    v_mfma_f32_16x16x32_bf16 v[44:47], a[220:223], v[76:79], v[44:47]
    v_mfma_f32_16x16x32_bf16 v[48:51], v[72:75], v[216:219], v[48:51]
    v_mfma_f32_16x16x32_bf16 v[56:59], v[76:79], v[216:219], v[56:59]
    v_mfma_f32_16x16x32_bf16 v[52:55], v[72:75], v[220:223], v[52:55]
    v_mfma_f32_16x16x32_bf16 v[60:63], v[76:79], v[220:223], v[60:63]
    ds_read_b128 v[72:75], v82 offset:13312
    ds_read_b128 v[76:79], v83 offset:13312
    s_waitcnt lgkmcnt(2)
    v_mfma_f32_16x16x32_bf16 v[32:35], a[224:227], v[64:67], v[32:35]
    v_mfma_f32_16x16x32_bf16 v[36:39], a[224:227], v[68:71], v[36:39]
    v_mfma_f32_16x16x32_bf16 v[40:43], a[228:231], v[64:67], v[40:43]
    v_mfma_f32_16x16x32_bf16 v[44:47], a[228:231], v[68:71], v[44:47]
    v_mfma_f32_16x16x32_bf16 v[48:51], v[64:67], v[224:227], v[48:51]
    v_mfma_f32_16x16x32_bf16 v[56:59], v[68:71], v[224:227], v[56:59]
    v_mfma_f32_16x16x32_bf16 v[52:55], v[64:67], v[228:231], v[52:55]
    v_mfma_f32_16x16x32_bf16 v[60:63], v[68:71], v[228:231], v[60:63]
    ds_read_b128 v[64:67], v80 offset:14336
    ds_read_b128 v[68:71], v81 offset:14336
    s_waitcnt lgkmcnt(2)
    v_mfma_f32_16x16x32_bf16 v[32:35], a[232:235], v[72:75], v[32:35]
    v_mfma_f32_16x16x32_bf16 v[36:39], a[232:235], v[76:79], v[36:39]
    v_mfma_f32_16x16x32_bf16 v[40:43], a[236:239], v[72:75], v[40:43]
    v_mfma_f32_16x16x32_bf16 v[44:47], a[236:239], v[76:79], v[44:47]
    v_mfma_f32_16x16x32_bf16 v[48:51], v[72:75], v[232:235], v[48:51]
    v_mfma_f32_16x16x32_bf16 v[56:59], v[76:79], v[232:235], v[56:59]
    v_mfma_f32_16x16x32_bf16 v[52:55], v[72:75], v[236:239], v[52:55]
    v_mfma_f32_16x16x32_bf16 v[60:63], v[76:79], v[236:239], v[60:63]
    ds_read_b128 v[72:75], v82 offset:15360
    ds_read_b128 v[76:79], v83 offset:15360
    s_waitcnt lgkmcnt(2)
    v_mfma_f32_16x16x32_bf16 v[32:35], a[240:243], v[64:67], v[32:35]
    v_mfma_f32_16x16x32_bf16 v[36:39], a[240:243], v[68:71], v[36:39]
    v_mfma_f32_16x16x32_bf16 v[40:43], a[244:247], v[64:67], v[40:43]
    v_mfma_f32_16x16x32_bf16 v[44:47], a[244:247], v[68:71], v[44:47]
    v_mfma_f32_16x16x32_bf16 v[48:51], v[64:67], v[240:243], v[48:51]
    v_mfma_f32_16x16x32_bf16 v[56:59], v[68:71], v[240:243], v[56:59]
    v_mfma_f32_16x16x32_bf16 v[52:55], v[64:67], v[244:247], v[52:55]
    v_mfma_f32_16x16x32_bf16 v[60:63], v[68:71], v[244:247], v[60:63]
    s_waitcnt lgkmcnt(0)
    v_mfma_f32_16x16x32_bf16 v[32:35], a[248:251], v[72:75], v[32:35]
    v_mfma_f32_16x16x32_bf16 v[36:39], a[248:251], v[76:79], v[36:39]
    v_mfma_f32_16x16x32_bf16 v[40:43], a[252:255], v[72:75], v[40:43]
    v_mfma_f32_16x16x32_bf16 v[44:47], a[252:255], v[76:79], v[44:47]
    v_mfma_f32_16x16x32_bf16 v[48:51], v[72:75], v[248:251], v[48:51]
    v_mfma_f32_16x16x32_bf16 v[56:59], v[76:79], v[248:251], v[56:59]
    v_mfma_f32_16x16x32_bf16 v[52:55], v[72:75], v[252:255], v[52:55]
    v_mfma_f32_16x16x32_bf16 v[60:63], v[76:79], v[252:255], v[60:63]
    s_nop 0
    v_mul_f32 v32, s33, v32
    v_mul_f32 v33, s33, v33
    v_mul_f32 v34, s33, v34
    v_mul_f32 v35, s33, v35
    v_mul_f32 v36, s33, v36
    v_mul_f32 v37, s33, v37
    v_mul_f32 v38, s33, v38
    v_mul_f32 v39, s33, v39
    v_mul_f32 v40, s33, v40
    v_mul_f32 v41, s33, v41
    v_mul_f32 v42, s33, v42
    v_mul_f32 v43, s33, v43
    v_mul_f32 v44, s33, v44
    v_mul_f32 v45, s33, v45
    v_mul_f32 v46, s33, v46
    v_mul_f32 v47, s33, v47
    v_cvt_pk_bf16_f32 v88, v32, v40
    v_cvt_pk_bf16_f32 v89, v33, v41
    v_cvt_pk_bf16_f32 v90, v34, v42
    v_cvt_pk_bf16_f32 v91, v35, v43
    v_cvt_pk_bf16_f32 v92, v36, v44
    v_cvt_pk_bf16_f32 v93, v37, v45
    v_cvt_pk_bf16_f32 v94, v38, v46
    v_cvt_pk_bf16_f32 v95, v39, v47
    v_cvt_pk_bf16_f32 v96, v48, v49
    v_cvt_pk_bf16_f32 v97, v50, v51
    v_cvt_pk_bf16_f32 v98, v56, v57
    v_cvt_pk_bf16_f32 v99, v58, v59
    v_cvt_pk_bf16_f32 v100, v52, v53
    v_cvt_pk_bf16_f32 v101, v54, v55
    v_cvt_pk_bf16_f32 v102, v60, v61
    v_cvt_pk_bf16_f32 v103, v62, v63
    s_mul_i32 s24, s23, 0x82100
    s_lshl_b32 s36, s20, 14
    s_add_u32 s24, s24, s36
    s_add_u32 s24, s24, 0x1000000
    s_mov_b32 s30, s24
    s_lshr_b32 s36, s21, 1
    s_lshl_b32 s36, s36, 12
    s_xor_b32 s37, s36, 4096
    s_add_u32 s36, s36, s24
    s_add_u32 s37, s37, s24
    buffer_store_dwordx4 v[88:91], v9, s[8:11], s36 offen sc1
    buffer_store_dwordx4 v[92:95], v9, s[8:11], s37 offen sc1
    s_add_u32 s24, s24, 8192
    buffer_store_dwordx4 v[96:99], v2, s[8:11], s24 offen sc1
    buffer_store_dwordx4 v[100:103], v2, s[8:11], s24 offen offset:1024 sc1
    s_mul_i32 s25, s23, 0x82100
    s_lshl_b32 s36, s20, 2
    s_add_u32 s25, s25, s36
    s_add_u32 s25, s25, 0x1082000
    v_lshrrev_b32 v15, 2, v1
    v_and_b32 v15, 127, v15
L_WHS:
    buffer_load_dword v14, v15, s[16:19], 0 offen sc1
    s_add_u32 s32, s32, 1
    s_cmp_gt_u32 s32, 200000
    s_cbranch_scc1 L_WHS_done
    s_waitcnt vmcnt(0)
    v_cmp_eq_u32 vcc, 0, v14
    s_cbranch_vccnz L_WHS
L_WHS_done:
    s_waitcnt vmcnt(0)
    s_barrier
    v_cmp_ne_u32 vcc, 0, v0
    v_mov_b32 v15, 0x40000000
    v_mov_b32 v14, 1
    v_cndmask_b32 v15, v0, v15, vcc
    buffer_store_dword v14, v15, s[8:11], s25 offen sc1
    s_barrier
    ds_read_b64_tr_b16 a[0:1], v20 offset:0
    ds_read_b64_tr_b16 a[2:3], v20 offset:1024
    ds_read_b64_tr_b16 a[4:5], v21 offset:0
    ds_read_b64_tr_b16 a[6:7], v21 offset:1024
    ds_read_b64_tr_b16 a[8:9], v22 offset:0
    ds_read_b64_tr_b16 a[10:11], v22 offset:1024
    ds_read_b64_tr_b16 a[12:13], v23 offset:0
    ds_read_b64_tr_b16 a[14:15], v23 offset:1024
    ds_read_b64_tr_b16 a[16:17], v24 offset:0
    ds_read_b64_tr_b16 a[18:19], v24 offset:1024
    ds_read_b64_tr_b16 a[20:21], v25 offset:0
    ds_read_b64_tr_b16 a[22:23], v25 offset:1024
    s_waitcnt lgkmcnt(4)
    ds_read_b64_tr_b16 a[24:25], v26 offset:0
    ds_read_b64_tr_b16 a[26:27], v26 offset:1024
    ds_read_b64_tr_b16 a[28:29], v27 offset:0
    ds_read_b64_tr_b16 a[30:31], v27 offset:1024
    s_waitcnt lgkmcnt(0)
    s_barrier
    s_barrier
    ds_read_b64_tr_b16 a[32:33], v20 offset:8192
    ds_read_b64_tr_b16 a[34:35], v20 offset:9216
    ds_read_b64_tr_b16 a[36:37], v21 offset:8192
    ds_read_b64_tr_b16 a[38:39], v21 offset:9216
    ds_read_b64_tr_b16 a[40:41], v22 offset:8192
    ds_read_b64_tr_b16 a[42:43], v22 offset:9216
    ds_read_b64_tr_b16 a[44:45], v23 offset:8192
    ds_read_b64_tr_b16 a[46:47], v23 offset:9216
    ds_read_b64_tr_b16 a[48:49], v24 offset:8192
    ds_read_b64_tr_b16 a[50:51], v24 offset:9216
    ds_read_b64_tr_b16 a[52:53], v25 offset:8192
    ds_read_b64_tr_b16 a[54:55], v25 offset:9216
    s_waitcnt lgkmcnt(4)
    ds_read_b64_tr_b16 a[56:57], v26 offset:8192
    ds_read_b64_tr_b16 a[58:59], v26 offset:9216
    ds_read_b64_tr_b16 a[60:61], v27 offset:8192
    ds_read_b64_tr_b16 a[62:63], v27 offset:9216
    s_waitcnt lgkmcnt(0)
    s_barrier
    s_barrier
    ds_read_b64_tr_b16 a[64:65], v20 offset:16384
    ds_read_b64_tr_b16 a[66:67], v20 offset:17408
    ds_read_b64_tr_b16 a[68:69], v21 offset:16384
    ds_read_b64_tr_b16 a[70:71], v21 offset:17408
    ds_read_b64_tr_b16 a[72:73], v22 offset:16384
    ds_read_b64_tr_b16 a[74:75], v22 offset:17408
    ds_read_b64_tr_b16 a[76:77], v23 offset:16384
    ds_read_b64_tr_b16 a[78:79], v23 offset:17408
    ds_read_b64_tr_b16 a[80:81], v24 offset:16384
    ds_read_b64_tr_b16 a[82:83], v24 offset:17408
    ds_read_b64_tr_b16 a[84:85], v25 offset:16384
    ds_read_b64_tr_b16 a[86:87], v25 offset:17408
    s_waitcnt lgkmcnt(4)
    ds_read_b64_tr_b16 a[88:89], v26 offset:16384
    ds_read_b64_tr_b16 a[90:91], v26 offset:17408
    ds_read_b64_tr_b16 a[92:93], v27 offset:16384
    ds_read_b64_tr_b16 a[94:95], v27 offset:17408
    s_waitcnt lgkmcnt(0)
    s_barrier
    s_barrier
    ds_read_b64_tr_b16 a[96:97], v20 offset:24576
    ds_read_b64_tr_b16 a[98:99], v20 offset:25600
    ds_read_b64_tr_b16 a[100:101], v21 offset:24576
    ds_read_b64_tr_b16 a[102:103], v21 offset:25600
    ds_read_b64_tr_b16 a[104:105], v22 offset:24576
    ds_read_b64_tr_b16 a[106:107], v22 offset:25600
    ds_read_b64_tr_b16 a[108:109], v23 offset:24576
    ds_read_b64_tr_b16 a[110:111], v23 offset:25600
    ds_read_b64_tr_b16 a[112:113], v24 offset:24576
    ds_read_b64_tr_b16 a[114:115], v24 offset:25600
    ds_read_b64_tr_b16 a[116:117], v25 offset:24576
    ds_read_b64_tr_b16 a[118:119], v25 offset:25600
    s_waitcnt lgkmcnt(4)
    ds_read_b64_tr_b16 a[120:121], v26 offset:24576
    ds_read_b64_tr_b16 a[122:123], v26 offset:25600
    ds_read_b64_tr_b16 a[124:125], v27 offset:24576
    ds_read_b64_tr_b16 a[126:127], v27 offset:25600
    s_waitcnt lgkmcnt(0)
    s_barrier
L_P1:
    s_waitcnt vmcnt(6)
    s_barrier
    s_xor_b32 s31, s31, 32768
    s_add_u32 s24, s23, 6
    s_min_u32 s24, s24, 63
    s_lshl_b32 s36, s24, 15
    s_add_u32 s36, s36, 0x800000
    s_lshl_b32 s37, s21, 10
    s_add_u32 s37, s37, s31
    s_add_u32 m0, s37, 0
    s_add_u32 s38, s36, 0
    buffer_load_dwordx4 v9, s[8:11], s38 offen sc1 lds
    s_add_u32 m0, s37, 4096
    s_add_u32 s38, s36, 4096
    buffer_load_dwordx4 v9, s[8:11], s38 offen sc1 lds
    s_add_u32 m0, s37, 8192
    s_add_u32 s38, s36, 8192
    buffer_load_dwordx4 v9, s[8:11], s38 offen sc1 lds
    s_add_u32 m0, s37, 12288
    s_add_u32 s38, s36, 12288
    buffer_load_dwordx4 v9, s[8:11], s38 offen sc1 lds
    s_add_u32 m0, s37, 16384
    s_add_u32 s38, s36, 16384
    buffer_load_dwordx4 v9, s[8:11], s38 offen sc1 lds
    s_add_u32 m0, s37, 20480
    s_add_u32 s38, s36, 20480
    buffer_load_dwordx4 v9, s[8:11], s38 offen sc1 lds
    s_add_u32 m0, s37, 24576
    s_add_u32 s38, s36, 24576
    buffer_load_dwordx4 v9, s[8:11], s38 offen sc1 lds
    s_add_u32 m0, s37, 28672
    s_add_u32 s38, s36, 28672
    buffer_load_dwordx4 v9, s[8:11], s38 offen sc1 lds
    ds_read_b128 v[64:67], v80 offset:0
    ds_read_b128 v[68:71], v81 offset:0
    ds_read_b128 v[72:75], v82 offset:1024
    ds_read_b128 v[76:79], v83 offset:1024
    s_waitcnt lgkmcnt(2)
    v_mfma_f32_16x16x32_bf16 v[32:35], a[128:131], v[64:67], 0
    v_mfma_f32_16x16x32_bf16 v[36:39], a[128:131], v[68:71], 0
    v_mfma_f32_16x16x32_bf16 v[40:43], a[132:135], v[64:67], 0
    v_mfma_f32_16x16x32_bf16 v[44:47], a[132:135], v[68:71], 0
    v_mfma_f32_16x16x32_bf16 v[48:51], v[64:67], v[128:131], 0
    v_mfma_f32_16x16x32_bf16 v[56:59], v[68:71], v[128:131], 0
    v_mfma_f32_16x16x32_bf16 v[52:55], v[64:67], v[132:135], 0
    v_mfma_f32_16x16x32_bf16 v[60:63], v[68:71], v[132:135], 0
    v_mfma_f32_16x16x32_bf16 v[16:19], a[0:3], v[64:67], 0
    v_mfma_f32_16x16x32_bf16 v[20:23], a[0:3], v[68:71], 0
    v_mfma_f32_16x16x32_bf16 v[24:27], a[4:7], v[64:67], 0
    v_mfma_f32_16x16x32_bf16 v[28:31], a[4:7], v[68:71], 0
    ds_read_b128 v[64:67], v80 offset:2048
    ds_read_b128 v[68:71], v81 offset:2048
    s_waitcnt lgkmcnt(2)
    v_mfma_f32_16x16x32_bf16 v[32:35], a[136:139], v[72:75], v[32:35]
    v_mfma_f32_16x16x32_bf16 v[36:39], a[136:139], v[76:79], v[36:39]
    v_mfma_f32_16x16x32_bf16 v[40:43], a[140:143], v[72:75], v[40:43]
    v_mfma_f32_16x16x32_bf16 v[44:47], a[140:143], v[76:79], v[44:47]
    v_mfma_f32_16x16x32_bf16 v[48:51], v[72:75], v[136:139], v[48:51]
    v_mfma_f32_16x16x32_bf16 v[56:59], v[76:79], v[136:139], v[56:59]
    v_mfma_f32_16x16x32_bf16 v[52:55], v[72:75], v[140:143], v[52:55]
    v_mfma_f32_16x16x32_bf16 v[60:63], v[76:79], v[140:143], v[60:63]
    v_mfma_f32_16x16x32_bf16 v[16:19], a[8:11], v[72:75], v[16:19]
    v_mfma_f32_16x16x32_bf16 v[20:23], a[8:11], v[76:79], v[20:23]
    v_mfma_f32_16x16x32_bf16 v[24:27], a[12:15], v[72:75], v[24:27]
    v_mfma_f32_16x16x32_bf16 v[28:31], a[12:15], v[76:79], v[28:31]
    ds_read_b128 v[72:75], v82 offset:3072
    ds_read_b128 v[76:79], v83 offset:3072
    s_waitcnt lgkmcnt(2)
    v_mfma_f32_16x16x32_bf16 v[32:35], a[144:147], v[64:67], v[32:35]
    v_mfma_f32_16x16x32_bf16 v[36:39], a[144:147], v[68:71], v[36:39]
    v_mfma_f32_16x16x32_bf16 v[40:43], a[148:151], v[64:67], v[40:43]
    v_mfma_f32_16x16x32_bf16 v[44:47], a[148:151], v[68:71], v[44:47]
    v_mfma_f32_16x16x32_bf16 v[48:51], v[64:67], v[144:147], v[48:51]
    v_mfma_f32_16x16x32_bf16 v[56:59], v[68:71], v[144:147], v[56:59]
    v_mfma_f32_16x16x32_bf16 v[52:55], v[64:67], v[148:151], v[52:55]
    v_mfma_f32_16x16x32_bf16 v[60:63], v[68:71], v[148:151], v[60:63]
    v_mfma_f32_16x16x32_bf16 v[16:19], a[16:19], v[64:67], v[16:19]
    v_mfma_f32_16x16x32_bf16 v[20:23], a[16:19], v[68:71], v[20:23]
    v_mfma_f32_16x16x32_bf16 v[24:27], a[20:23], v[64:67], v[24:27]
    v_mfma_f32_16x16x32_bf16 v[28:31], a[20:23], v[68:71], v[28:31]
    ds_read_b128 v[64:67], v80 offset:4096
    ds_read_b128 v[68:71], v81 offset:4096
    s_waitcnt lgkmcnt(2)
    v_mfma_f32_16x16x32_bf16 v[32:35], a[152:155], v[72:75], v[32:35]
    v_mfma_f32_16x16x32_bf16 v[36:39], a[152:155], v[76:79], v[36:39]
    v_mfma_f32_16x16x32_bf16 v[40:43], a[156:159], v[72:75], v[40:43]
    v_mfma_f32_16x16x32_bf16 v[44:47], a[156:159], v[76:79], v[44:47]
    v_mfma_f32_16x16x32_bf16 v[48:51], v[72:75], v[152:155], v[48:51]
    v_mfma_f32_16x16x32_bf16 v[56:59], v[76:79], v[152:155], v[56:59]
    v_mfma_f32_16x16x32_bf16 v[52:55], v[72:75], v[156:159], v[52:55]
    v_mfma_f32_16x16x32_bf16 v[60:63], v[76:79], v[156:159], v[60:63]
    v_mfma_f32_16x16x32_bf16 v[16:19], a[24:27], v[72:75], v[16:19]
    v_mfma_f32_16x16x32_bf16 v[20:23], a[24:27], v[76:79], v[20:23]
    v_mfma_f32_16x16x32_bf16 v[24:27], a[28:31], v[72:75], v[24:27]
    v_mfma_f32_16x16x32_bf16 v[28:31], a[28:31], v[76:79], v[28:31]
    ds_read_b128 v[72:75], v82 offset:5120
    ds_read_b128 v[76:79], v83 offset:5120
    s_waitcnt lgkmcnt(2)
    v_mfma_f32_16x16x32_bf16 v[32:35], a[160:163], v[64:67], v[32:35]
    v_mfma_f32_16x16x32_bf16 v[36:39], a[160:163], v[68:71], v[36:39]
    v_mfma_f32_16x16x32_bf16 v[40:43], a[164:167], v[64:67], v[40:43]
    v_mfma_f32_16x16x32_bf16 v[44:47], a[164:167], v[68:71], v[44:47]
    v_mfma_f32_16x16x32_bf16 v[48:51], v[64:67], v[160:163], v[48:51]
    v_mfma_f32_16x16x32_bf16 v[56:59], v[68:71], v[160:163], v[56:59]
    v_mfma_f32_16x16x32_bf16 v[52:55], v[64:67], v[164:167], v[52:55]
    v_mfma_f32_16x16x32_bf16 v[60:63], v[68:71], v[164:167], v[60:63]
    v_mfma_f32_16x16x32_bf16 v[16:19], a[32:35], v[64:67], v[16:19]
    v_mfma_f32_16x16x32_bf16 v[20:23], a[32:35], v[68:71], v[20:23]
    v_mfma_f32_16x16x32_bf16 v[24:27], a[36:39], v[64:67], v[24:27]
    v_mfma_f32_16x16x32_bf16 v[28:31], a[36:39], v[68:71], v[28:31]
    ds_read_b128 v[64:67], v80 offset:6144
    ds_read_b128 v[68:71], v81 offset:6144
    s_waitcnt lgkmcnt(2)
    v_mfma_f32_16x16x32_bf16 v[32:35], a[168:171], v[72:75], v[32:35]
    v_mfma_f32_16x16x32_bf16 v[36:39], a[168:171], v[76:79], v[36:39]
    v_mfma_f32_16x16x32_bf16 v[40:43], a[172:175], v[72:75], v[40:43]
    v_mfma_f32_16x16x32_bf16 v[44:47], a[172:175], v[76:79], v[44:47]
    v_mfma_f32_16x16x32_bf16 v[48:51], v[72:75], v[168:171], v[48:51]
    v_mfma_f32_16x16x32_bf16 v[56:59], v[76:79], v[168:171], v[56:59]
    v_mfma_f32_16x16x32_bf16 v[52:55], v[72:75], v[172:175], v[52:55]
    v_mfma_f32_16x16x32_bf16 v[60:63], v[76:79], v[172:175], v[60:63]
    v_mfma_f32_16x16x32_bf16 v[16:19], a[40:43], v[72:75], v[16:19]
    v_mfma_f32_16x16x32_bf16 v[20:23], a[40:43], v[76:79], v[20:23]
    v_mfma_f32_16x16x32_bf16 v[24:27], a[44:47], v[72:75], v[24:27]
    v_mfma_f32_16x16x32_bf16 v[28:31], a[44:47], v[76:79], v[28:31]
    ds_read_b128 v[72:75], v82 offset:7168
    ds_read_b128 v[76:79], v83 offset:7168
    s_waitcnt lgkmcnt(2)
    s_waitcnt vmcnt(8)
    s_barrier
    v_cmp_ne_u32 vcc, 0, v0
    v_mov_b32 v15, 0x40000000
    v_mov_b32 v14, 1
    v_cndmask_b32 v15, v0, v15, vcc
    buffer_store_dword v14, v15, s[8:11], s25 offen sc1
    v_mfma_f32_16x16x32_bf16 v[32:35], a[176:179], v[64:67], v[32:35]
    v_mfma_f32_16x16x32_bf16 v[36:39], a[176:179], v[68:71], v[36:39]
    v_mfma_f32_16x16x32_bf16 v[40:43], a[180:183], v[64:67], v[40:43]
    v_mfma_f32_16x16x32_bf16 v[44:47], a[180:183], v[68:71], v[44:47]
    v_mfma_f32_16x16x32_bf16 v[48:51], v[64:67], v[176:179], v[48:51]
    v_mfma_f32_16x16x32_bf16 v[56:59], v[68:71], v[176:179], v[56:59]
    v_mfma_f32_16x16x32_bf16 v[52:55], v[64:67], v[180:183], v[52:55]
    v_mfma_f32_16x16x32_bf16 v[60:63], v[68:71], v[180:183], v[60:63]
    v_mfma_f32_16x16x32_bf16 v[16:19], a[48:51], v[64:67], v[16:19]
    v_mfma_f32_16x16x32_bf16 v[20:23], a[48:51], v[68:71], v[20:23]
    v_mfma_f32_16x16x32_bf16 v[24:27], a[52:55], v[64:67], v[24:27]
    v_mfma_f32_16x16x32_bf16 v[28:31], a[52:55], v[68:71], v[28:31]
    ds_read_b128 v[64:67], v80 offset:8192
    ds_read_b128 v[68:71], v81 offset:8192
    s_waitcnt lgkmcnt(2)
    v_mfma_f32_16x16x32_bf16 v[32:35], a[184:187], v[72:75], v[32:35]
    v_mfma_f32_16x16x32_bf16 v[36:39], a[184:187], v[76:79], v[36:39]
    v_mfma_f32_16x16x32_bf16 v[40:43], a[188:191], v[72:75], v[40:43]
    v_mfma_f32_16x16x32_bf16 v[44:47], a[188:191], v[76:79], v[44:47]
    v_mfma_f32_16x16x32_bf16 v[48:51], v[72:75], v[184:187], v[48:51]
    v_mfma_f32_16x16x32_bf16 v[56:59], v[76:79], v[184:187], v[56:59]
    v_mfma_f32_16x16x32_bf16 v[52:55], v[72:75], v[188:191], v[52:55]
    v_mfma_f32_16x16x32_bf16 v[60:63], v[76:79], v[188:191], v[60:63]
    v_mfma_f32_16x16x32_bf16 v[16:19], a[56:59], v[72:75], v[16:19]
    v_mfma_f32_16x16x32_bf16 v[20:23], a[56:59], v[76:79], v[20:23]
    v_mfma_f32_16x16x32_bf16 v[24:27], a[60:63], v[72:75], v[24:27]
    v_mfma_f32_16x16x32_bf16 v[28:31], a[60:63], v[76:79], v[28:31]
    ds_read_b128 v[72:75], v82 offset:9216
    ds_read_b128 v[76:79], v83 offset:9216
    s_waitcnt lgkmcnt(2)
    v_mfma_f32_16x16x32_bf16 v[32:35], a[192:195], v[64:67], v[32:35]
    v_mfma_f32_16x16x32_bf16 v[36:39], a[192:195], v[68:71], v[36:39]
    v_mfma_f32_16x16x32_bf16 v[40:43], a[196:199], v[64:67], v[40:43]
    v_mfma_f32_16x16x32_bf16 v[44:47], a[196:199], v[68:71], v[44:47]
    v_mfma_f32_16x16x32_bf16 v[48:51], v[64:67], v[192:195], v[48:51]
    v_mfma_f32_16x16x32_bf16 v[56:59], v[68:71], v[192:195], v[56:59]
    v_mfma_f32_16x16x32_bf16 v[52:55], v[64:67], v[196:199], v[52:55]
    v_mfma_f32_16x16x32_bf16 v[60:63], v[68:71], v[196:199], v[60:63]
    v_mfma_f32_16x16x32_bf16 v[16:19], a[64:67], v[64:67], v[16:19]
    v_mfma_f32_16x16x32_bf16 v[20:23], a[64:67], v[68:71], v[20:23]
    v_mfma_f32_16x16x32_bf16 v[24:27], a[68:71], v[64:67], v[24:27]
    v_mfma_f32_16x16x32_bf16 v[28:31], a[68:71], v[68:71], v[28:31]
    ds_read_b128 v[64:67], v80 offset:10240
    ds_read_b128 v[68:71], v81 offset:10240
    s_waitcnt lgkmcnt(2)
    v_mfma_f32_16x16x32_bf16 v[32:35], a[200:203], v[72:75], v[32:35]
    v_mfma_f32_16x16x32_bf16 v[36:39], a[200:203], v[76:79], v[36:39]
    v_mfma_f32_16x16x32_bf16 v[40:43], a[204:207], v[72:75], v[40:43]
    v_mfma_f32_16x16x32_bf16 v[44:47], a[204:207], v[76:79], v[44:47]
    v_mfma_f32_16x16x32_bf16 v[48:51], v[72:75], v[200:203], v[48:51]
    v_mfma_f32_16x16x32_bf16 v[56:59], v[76:79], v[200:203], v[56:59]
    v_mfma_f32_16x16x32_bf16 v[52:55], v[72:75], v[204:207], v[52:55]
    v_mfma_f32_16x16x32_bf16 v[60:63], v[76:79], v[204:207], v[60:63]
    v_mfma_f32_16x16x32_bf16 v[16:19], a[72:75], v[72:75], v[16:19]
    v_mfma_f32_16x16x32_bf16 v[20:23], a[72:75], v[76:79], v[20:23]
    v_mfma_f32_16x16x32_bf16 v[24:27], a[76:79], v[72:75], v[24:27]
    v_mfma_f32_16x16x32_bf16 v[28:31], a[76:79], v[76:79], v[28:31]
    ds_read_b128 v[72:75], v82 offset:11264
    ds_read_b128 v[76:79], v83 offset:11264
    s_waitcnt lgkmcnt(2)
    v_mfma_f32_16x16x32_bf16 v[32:35], a[208:211], v[64:67], v[32:35]
    v_mfma_f32_16x16x32_bf16 v[36:39], a[208:211], v[68:71], v[36:39]
    v_mfma_f32_16x16x32_bf16 v[40:43], a[212:215], v[64:67], v[40:43]
    v_mfma_f32_16x16x32_bf16 v[44:47], a[212:215], v[68:71], v[44:47]
    v_mfma_f32_16x16x32_bf16 v[48:51], v[64:67], v[208:211], v[48:51]
    v_mfma_f32_16x16x32_bf16 v[56:59], v[68:71], v[208:211], v[56:59]
    v_mfma_f32_16x16x32_bf16 v[52:55], v[64:67], v[212:215], v[52:55]
    v_mfma_f32_16x16x32_bf16 v[60:63], v[68:71], v[212:215], v[60:63]
    v_mfma_f32_16x16x32_bf16 v[16:19], a[80:83], v[64:67], v[16:19]
    v_mfma_f32_16x16x32_bf16 v[20:23], a[80:83], v[68:71], v[20:23]
    v_mfma_f32_16x16x32_bf16 v[24:27], a[84:87], v[64:67], v[24:27]
    v_mfma_f32_16x16x32_bf16 v[28:31], a[84:87], v[68:71], v[28:31]
    ds_read_b128 v[64:67], v80 offset:12288
    ds_read_b128 v[68:71], v81 offset:12288
    s_waitcnt lgkmcnt(2)
    v_mfma_f32_16x16x32_bf16 v[32:35], a[216:219], v[72:75], v[32:35]
    v_mfma_f32_16x16x32_bf16 v[36:39], a[216:219], v[76:79], v[36:39]
    v_mfma_f32_16x16x32_bf16 v[40:43], a[220:223], v[72:75], v[40:43]
    v_mfma_f32_16x16x32_bf16 v[44:47], a[220:223], v[76:79], v[44:47]
    v_mfma_f32_16x16x32_bf16 v[48:51], v[72:75], v[216:219], v[48:51]
    v_mfma_f32_16x16x32_bf16 v[56:59], v[76:79], v[216:219], v[56:59]
    v_mfma_f32_16x16x32_bf16 v[52:55], v[72:75], v[220:223], v[52:55]
    v_mfma_f32_16x16x32_bf16 v[60:63], v[76:79], v[220:223], v[60:63]
    v_mfma_f32_16x16x32_bf16 v[16:19], a[88:91], v[72:75], v[16:19]
    v_mfma_f32_16x16x32_bf16 v[20:23], a[88:91], v[76:79], v[20:23]
    v_mfma_f32_16x16x32_bf16 v[24:27], a[92:95], v[72:75], v[24:27]
    v_mfma_f32_16x16x32_bf16 v[28:31], a[92:95], v[76:79], v[28:31]
    ds_read_b128 v[72:75], v82 offset:13312
    ds_read_b128 v[76:79], v83 offset:13312
    s_waitcnt lgkmcnt(2)
    v_mfma_f32_16x16x32_bf16 v[32:35], a[224:227], v[64:67], v[32:35]
    v_mfma_f32_16x16x32_bf16 v[36:39], a[224:227], v[68:71], v[36:39]
    v_mfma_f32_16x16x32_bf16 v[40:43], a[228:231], v[64:67], v[40:43]
    v_mfma_f32_16x16x32_bf16 v[44:47], a[228:231], v[68:71], v[44:47]
    v_mfma_f32_16x16x32_bf16 v[48:51], v[64:67], v[224:227], v[48:51]
    v_mfma_f32_16x16x32_bf16 v[56:59], v[68:71], v[224:227], v[56:59]
    v_mfma_f32_16x16x32_bf16 v[52:55], v[64:67], v[228:231], v[52:55]
    v_mfma_f32_16x16x32_bf16 v[60:63], v[68:71], v[228:231], v[60:63]
    v_mfma_f32_16x16x32_bf16 v[16:19], a[96:99], v[64:67], v[16:19]
    v_mfma_f32_16x16x32_bf16 v[20:23], a[96:99], v[68:71], v[20:23]
    v_mfma_f32_16x16x32_bf16 v[24:27], a[100:103], v[64:67], v[24:27]
    v_mfma_f32_16x16x32_bf16 v[28:31], a[100:103], v[68:71], v[28:31]
    ds_read_b128 v[64:67], v80 offset:14336
    ds_read_b128 v[68:71], v81 offset:14336
    s_waitcnt lgkmcnt(2)
    v_mfma_f32_16x16x32_bf16 v[32:35], a[232:235], v[72:75], v[32:35]
    v_mfma_f32_16x16x32_bf16 v[36:39], a[232:235], v[76:79], v[36:39]
    v_mfma_f32_16x16x32_bf16 v[40:43], a[236:239], v[72:75], v[40:43]
    v_mfma_f32_16x16x32_bf16 v[44:47], a[236:239], v[76:79], v[44:47]
    v_mfma_f32_16x16x32_bf16 v[48:51], v[72:75], v[232:235], v[48:51]
    v_mfma_f32_16x16x32_bf16 v[56:59], v[76:79], v[232:235], v[56:59]
    v_mfma_f32_16x16x32_bf16 v[52:55], v[72:75], v[236:239], v[52:55]
    v_mfma_f32_16x16x32_bf16 v[60:63], v[76:79], v[236:239], v[60:63]
    v_mfma_f32_16x16x32_bf16 v[16:19], a[104:107], v[72:75], v[16:19]
    v_mfma_f32_16x16x32_bf16 v[20:23], a[104:107], v[76:79], v[20:23]
    v_mfma_f32_16x16x32_bf16 v[24:27], a[108:111], v[72:75], v[24:27]
    v_mfma_f32_16x16x32_bf16 v[28:31], a[108:111], v[76:79], v[28:31]
    ds_read_b128 v[72:75], v82 offset:15360
    ds_read_b128 v[76:79], v83 offset:15360
    s_waitcnt lgkmcnt(2)
    v_mfma_f32_16x16x32_bf16 v[32:35], a[240:243], v[64:67], v[32:35]
    v_mfma_f32_16x16x32_bf16 v[36:39], a[240:243], v[68:71], v[36:39]
    v_mfma_f32_16x16x32_bf16 v[40:43], a[244:247], v[64:67], v[40:43]
    v_mfma_f32_16x16x32_bf16 v[44:47], a[244:247], v[68:71], v[44:47]
    v_mfma_f32_16x16x32_bf16 v[48:51], v[64:67], v[240:243], v[48:51]
    v_mfma_f32_16x16x32_bf16 v[56:59], v[68:71], v[240:243], v[56:59]
    v_mfma_f32_16x16x32_bf16 v[52:55], v[64:67], v[244:247], v[52:55]
    v_mfma_f32_16x16x32_bf16 v[60:63], v[68:71], v[244:247], v[60:63]
    v_mfma_f32_16x16x32_bf16 v[16:19], a[112:115], v[64:67], v[16:19]
    v_mfma_f32_16x16x32_bf16 v[20:23], a[112:115], v[68:71], v[20:23]
    v_mfma_f32_16x16x32_bf16 v[24:27], a[116:119], v[64:67], v[24:27]
    v_mfma_f32_16x16x32_bf16 v[28:31], a[116:119], v[68:71], v[28:31]
    s_waitcnt lgkmcnt(0)
    v_mfma_f32_16x16x32_bf16 v[32:35], a[248:251], v[72:75], v[32:35]
    v_mfma_f32_16x16x32_bf16 v[36:39], a[248:251], v[76:79], v[36:39]
    v_mfma_f32_16x16x32_bf16 v[40:43], a[252:255], v[72:75], v[40:43]
    v_mfma_f32_16x16x32_bf16 v[44:47], a[252:255], v[76:79], v[44:47]
    v_mfma_f32_16x16x32_bf16 v[48:51], v[72:75], v[248:251], v[48:51]
    v_mfma_f32_16x16x32_bf16 v[56:59], v[76:79], v[248:251], v[56:59]
    v_mfma_f32_16x16x32_bf16 v[52:55], v[72:75], v[252:255], v[52:55]
    v_mfma_f32_16x16x32_bf16 v[60:63], v[76:79], v[252:255], v[60:63]
    v_mfma_f32_16x16x32_bf16 v[16:19], a[120:123], v[72:75], v[16:19]
    v_mfma_f32_16x16x32_bf16 v[20:23], a[120:123], v[76:79], v[20:23]
    v_mfma_f32_16x16x32_bf16 v[24:27], a[124:127], v[72:75], v[24:27]
    v_mfma_f32_16x16x32_bf16 v[28:31], a[124:127], v[76:79], v[28:31]
    v_xor_b32 v80, 0x8000, v80
    v_xor_b32 v81, 0x8000, v81
    v_xor_b32 v82, 0x8000, v82
    v_xor_b32 v83, 0x8000, v83
    v_mul_f32 v32, s33, v32
    v_mul_f32 v33, s33, v33
    v_mul_f32 v34, s33, v34
    v_mul_f32 v35, s33, v35
    v_mul_f32 v36, s33, v36
    v_mul_f32 v37, s33, v37
    v_mul_f32 v38, s33, v38
    v_mul_f32 v39, s33, v39
    v_mul_f32 v40, s33, v40
    v_mul_f32 v41, s33, v41
    v_mul_f32 v42, s33, v42
    v_mul_f32 v43, s33, v43
    v_mul_f32 v44, s33, v44
    v_mul_f32 v45, s33, v45
    v_mul_f32 v46, s33, v46
    v_mul_f32 v47, s33, v47
    v_cvt_pk_bf16_f32 v88, v32, v40
    v_cvt_pk_bf16_f32 v89, v33, v41
    v_cvt_pk_bf16_f32 v90, v34, v42
    v_cvt_pk_bf16_f32 v91, v35, v43
    v_cvt_pk_bf16_f32 v92, v36, v44
    v_cvt_pk_bf16_f32 v93, v37, v45
    v_cvt_pk_bf16_f32 v94, v38, v46
    v_cvt_pk_bf16_f32 v95, v39, v47
    v_cvt_pk_bf16_f32 v96, v48, v49
    v_cvt_pk_bf16_f32 v97, v50, v51
    v_cvt_pk_bf16_f32 v98, v56, v57
    v_cvt_pk_bf16_f32 v99, v58, v59
    v_cvt_pk_bf16_f32 v100, v52, v53
    v_cvt_pk_bf16_f32 v101, v54, v55
    v_cvt_pk_bf16_f32 v102, v60, v61
    v_cvt_pk_bf16_f32 v103, v62, v63
    v_cvt_pk_bf16_f32 v104, v16, v24
    v_cvt_pk_bf16_f32 v105, v17, v25
    v_cvt_pk_bf16_f32 v106, v18, v26
    v_cvt_pk_bf16_f32 v107, v19, v27
    v_cvt_pk_bf16_f32 v108, v20, v28
    v_cvt_pk_bf16_f32 v109, v21, v29
    v_cvt_pk_bf16_f32 v110, v22, v30
    v_cvt_pk_bf16_f32 v111, v23, v31
    s_mul_i32 s24, s23, 0x82100
    s_lshl_b32 s36, s20, 14
    s_add_u32 s24, s24, s36
    s_add_u32 s24, s24, 0x1000000
    s_mov_b32 s30, s24
    s_lshr_b32 s36, s21, 1
    s_lshl_b32 s36, s36, 12
    s_xor_b32 s37, s36, 4096
    s_add_u32 s36, s36, s24
    s_add_u32 s37, s37, s24
    buffer_store_dwordx4 v[88:91], v9, s[8:11], s36 offen sc1
    buffer_store_dwordx4 v[92:95], v9, s[8:11], s37 offen sc1
    s_add_u32 s24, s24, 8192
    buffer_store_dwordx4 v[96:99], v2, s[8:11], s24 offen sc1
    buffer_store_dwordx4 v[100:103], v2, s[8:11], s24 offen offset:1024 sc1
    s_add_u32 s36, s36, 0x7000000
    s_add_u32 s37, s37, 0x7000000
    buffer_store_dwordx4 v[104:107], v9, s[8:11], s36 offen sc1
    buffer_store_dwordx4 v[108:111], v9, s[8:11], s37 offen sc1
    s_mul_i32 s25, s23, 0x82100
    s_lshl_b32 s36, s20, 2
    s_add_u32 s25, s25, s36
    s_add_u32 s25, s25, 0x1082000
    s_add_u32 s23, s23, 6
    s_cmp_lt_u32 s23, 64
    s_cbranch_scc1 L_P1
    v_mov_b32 v20, -1
    v_mov_b32 v21, -1
    v_mov_b32 v22, -1
    v_mov_b32 v23, -1
    s_lshl_b32 s24, s22, 21
    s_lshl_b32 s36, s20, 15
    s_add_u32 s24, s24, s36
    s_add_u32 s36, s24, 0x4000000
    buffer_store_dwordx4 v[20:23], v11, s[8:11], s36 offen sc1
    s_add_u32 s36, s24, 0x4001000
    buffer_store_dwordx4 v[20:23], v11, s[8:11], s36 offen sc1
    s_add_u32 s36, s24, 0x4002000
    buffer_store_dwordx4 v[20:23], v11, s[8:11], s36 offen sc1
    s_add_u32 s36, s24, 0x4003000
    buffer_store_dwordx4 v[20:23], v11, s[8:11], s36 offen sc1
    s_add_u32 s36, s24, 0x4004000
    buffer_store_dwordx4 v[20:23], v11, s[8:11], s36 offen sc1
    s_add_u32 s36, s24, 0x4005000
    buffer_store_dwordx4 v[20:23], v11, s[8:11], s36 offen sc1
    s_add_u32 s36, s24, 0x4006000
    buffer_store_dwordx4 v[20:23], v11, s[8:11], s36 offen sc1
    s_add_u32 s36, s24, 0x4007000
    buffer_store_dwordx4 v[20:23], v11, s[8:11], s36 offen sc1
    s_add_u32 s36, s24, 0x4100000
    buffer_store_dwordx4 v[20:23], v11, s[8:11], s36 offen sc1
    s_add_u32 s36, s24, 0x4101000
    buffer_store_dwordx4 v[20:23], v11, s[8:11], s36 offen sc1
    s_add_u32 s36, s24, 0x4102000
    buffer_store_dwordx4 v[20:23], v11, s[8:11], s36 offen sc1
    s_add_u32 s36, s24, 0x4103000
    buffer_store_dwordx4 v[20:23], v11, s[8:11], s36 offen sc1
    s_add_u32 s36, s24, 0x4104000
    buffer_store_dwordx4 v[20:23], v11, s[8:11], s36 offen sc1
    s_add_u32 s36, s24, 0x4105000
    buffer_store_dwordx4 v[20:23], v11, s[8:11], s36 offen sc1
    s_add_u32 s36, s24, 0x4106000
    buffer_store_dwordx4 v[20:23], v11, s[8:11], s36 offen sc1
    s_add_u32 s36, s24, 0x4107000
    buffer_store_dwordx4 v[20:23], v11, s[8:11], s36 offen sc1
    s_waitcnt vmcnt(0)
    s_barrier
    v_cmp_ne_u32 vcc, 0, v0
    v_mov_b32 v15, 0x40000000
    v_mov_b32 v14, 1
    v_cndmask_b32 v15, v0, v15, vcc
    buffer_store_dword v14, v15, s[8:11], s25 offen sc1
    s_lshl_b32 s25, s22, 7
    s_lshl_b32 s36, s20, 2
    s_add_u32 s36, s36, s25
    s_add_u32 s36, s36, 0x192000
    v_cmp_ne_u32 vcc, 0, v0
    v_mov_b32 v15, 0x40000000
    v_mov_b32 v14, 1
    v_cndmask_b32 v15, v0, v15, vcc
    buffer_store_dword v14, v15, s[8:11], s36 offen sc1
    s_mov_b32 s96, s54
    s_and_b32 s97, s55, 0xffff
    s_mov_b32 s98, 0x400000
    s_mov_b32 s99, 0x20000
    v_mov_b32 v15, 0x0
    v_bfe_u32 v14, v0, 0, 1
    s_mov_b32 s38, 0x10
    v_mad_u32_u24 v15, v14, s38, v15
    v_bfe_u32 v14, v0, 1, 1
    s_mov_b32 s38, 0x20
    v_mad_u32_u24 v15, v14, s38, v15
    v_bfe_u32 v14, v0, 2, 1
    s_mov_b32 s38, 0x40
    v_mad_u32_u24 v15, v14, s38, v15
    v_bfe_u32 v14, v0, 3, 1
    s_mov_b32 s38, 0x80
    v_mad_u32_u24 v15, v14, s38, v15
    v_bfe_u32 v14, v0, 4, 1
    s_mov_b32 s38, 0x1000
    v_mad_u32_u24 v15, v14, s38, v15
    v_bfe_u32 v14, v0, 5, 1
    s_mov_b32 s38, 0x2000
    v_mad_u32_u24 v15, v14, s38, v15
    v_bfe_u32 v14, v0, 6, 1
    s_mov_b32 s38, 0x100
    v_mad_u32_u24 v15, v14, s38, v15
    v_bfe_u32 v14, v0, 7, 1
    s_mov_b32 s38, 0x200
    v_mad_u32_u24 v15, v14, s38, v15
    s_lshl_b32 s36, s20, 17
    s_add_u32 s37, s36, 0x0
    buffer_load_dwordx4 v[16:19], v15, s[96:99], s37 offen
    s_add_u32 s37, s36, 0x4000
    buffer_load_dwordx4 v[20:23], v15, s[96:99], s37 offen
    s_add_u32 s37, s36, 0x400
    buffer_load_dwordx4 v[24:27], v15, s[96:99], s37 offen
    s_add_u32 s37, s36, 0x4400
    buffer_load_dwordx4 v[28:31], v15, s[96:99], s37 offen
    s_add_u32 s37, s36, 0x800
    buffer_load_dwordx4 v[32:35], v15, s[96:99], s37 offen
    s_add_u32 s37, s36, 0x4800
    buffer_load_dwordx4 v[36:39], v15, s[96:99], s37 offen
    s_add_u32 s37, s36, 0xc00
    buffer_load_dwordx4 v[40:43], v15, s[96:99], s37 offen
    s_add_u32 s37, s36, 0x4c00
    buffer_load_dwordx4 v[44:47], v15, s[96:99], s37 offen
    s_add_u32 s37, s36, 0x8000
    buffer_load_dwordx4 v[48:51], v15, s[96:99], s37 offen
    s_add_u32 s37, s36, 0xc000
    buffer_load_dwordx4 v[52:55], v15, s[96:99], s37 offen
    s_add_u32 s37, s36, 0x8400
    buffer_load_dwordx4 v[56:59], v15, s[96:99], s37 offen
    s_add_u32 s37, s36, 0xc400
    buffer_load_dwordx4 v[60:63], v15, s[96:99], s37 offen
    s_add_u32 s37, s36, 0x8800
    buffer_load_dwordx4 v[64:67], v15, s[96:99], s37 offen
    s_add_u32 s37, s36, 0xc800
    buffer_load_dwordx4 v[68:71], v15, s[96:99], s37 offen
    s_add_u32 s37, s36, 0x8c00
    buffer_load_dwordx4 v[72:75], v15, s[96:99], s37 offen
    s_add_u32 s37, s36, 0xcc00
    buffer_load_dwordx4 v[76:79], v15, s[96:99], s37 offen
    s_add_u32 s37, s36, 0x10000
    buffer_load_dwordx4 v[80:83], v15, s[96:99], s37 offen
    s_add_u32 s37, s36, 0x14000
    buffer_load_dwordx4 v[84:87], v15, s[96:99], s37 offen
    s_add_u32 s37, s36, 0x10400
    buffer_load_dwordx4 v[88:91], v15, s[96:99], s37 offen
    s_add_u32 s37, s36, 0x14400
    buffer_load_dwordx4 v[92:95], v15, s[96:99], s37 offen
    s_add_u32 s37, s36, 0x10800
    buffer_load_dwordx4 v[96:99], v15, s[96:99], s37 offen
    s_add_u32 s37, s36, 0x14800
    buffer_load_dwordx4 v[100:103], v15, s[96:99], s37 offen
    s_add_u32 s37, s36, 0x10c00
    buffer_load_dwordx4 v[104:107], v15, s[96:99], s37 offen
    s_add_u32 s37, s36, 0x14c00
    buffer_load_dwordx4 v[108:111], v15, s[96:99], s37 offen
    s_waitcnt vmcnt(16)
    v_perm_b32 v112, v20, v16, s34
    v_perm_b32 v113, v28, v24, s34
    v_perm_b32 v114, v36, v32, s34
    v_perm_b32 v115, v44, v40, s34
    ds_write_b128 v7, v[112:115] offset:0
    v_perm_b32 v116, v20, v16, s35
    v_perm_b32 v117, v28, v24, s35
    v_perm_b32 v118, v36, v32, s35
    v_perm_b32 v119, v44, v40, s35
    ds_write_b128 v7, v[116:119] offset:1024
    v_perm_b32 v120, v21, v17, s34
    v_perm_b32 v121, v29, v25, s34
    v_perm_b32 v122, v37, v33, s34
    v_perm_b32 v123, v45, v41, s34
    ds_write_b128 v7, v[120:123] offset:2048
    v_perm_b32 v124, v21, v17, s35
    v_perm_b32 v125, v29, v25, s35
    v_perm_b32 v126, v37, v33, s35
    v_perm_b32 v127, v45, v41, s35
    ds_write_b128 v7, v[124:127] offset:3072
    s_waitcnt lgkmcnt(0)
    v_perm_b32 v112, v22, v18, s34
    v_perm_b32 v113, v30, v26, s34
    v_perm_b32 v114, v38, v34, s34
    v_perm_b32 v115, v46, v42, s34
    ds_write_b128 v7, v[112:115] offset:4096
    v_perm_b32 v116, v22, v18, s35
    v_perm_b32 v117, v30, v26, s35
    v_perm_b32 v118, v38, v34, s35
    v_perm_b32 v119, v46, v42, s35
    ds_write_b128 v7, v[116:119] offset:5120
    v_perm_b32 v120, v23, v19, s34
    v_perm_b32 v121, v31, v27, s34
    v_perm_b32 v122, v39, v35, s34
    v_perm_b32 v123, v47, v43, s34
    ds_write_b128 v7, v[120:123] offset:6144
    v_perm_b32 v124, v23, v19, s35
    v_perm_b32 v125, v31, v27, s35
    v_perm_b32 v126, v39, v35, s35
    v_perm_b32 v127, v47, v43, s35
    ds_write_b128 v7, v[124:127] offset:7168
    s_waitcnt lgkmcnt(0)
    s_add_u32 s37, s36, 0x18000
    buffer_load_dwordx4 v[16:19], v15, s[96:99], s37 offen
    s_add_u32 s37, s36, 0x1c000
    buffer_load_dwordx4 v[20:23], v15, s[96:99], s37 offen
    s_add_u32 s37, s36, 0x18400
    buffer_load_dwordx4 v[24:27], v15, s[96:99], s37 offen
    s_add_u32 s37, s36, 0x1c400
    buffer_load_dwordx4 v[28:31], v15, s[96:99], s37 offen
    s_add_u32 s37, s36, 0x18800
    buffer_load_dwordx4 v[32:35], v15, s[96:99], s37 offen
    s_add_u32 s37, s36, 0x1c800
    buffer_load_dwordx4 v[36:39], v15, s[96:99], s37 offen
    s_add_u32 s37, s36, 0x18c00
    buffer_load_dwordx4 v[40:43], v15, s[96:99], s37 offen
    s_add_u32 s37, s36, 0x1cc00
    buffer_load_dwordx4 v[44:47], v15, s[96:99], s37 offen
    s_waitcnt vmcnt(16)
    v_perm_b32 v112, v52, v48, s34
    v_perm_b32 v113, v60, v56, s34
    v_perm_b32 v114, v68, v64, s34
    v_perm_b32 v115, v76, v72, s34
    ds_write_b128 v7, v[112:115] offset:8192
    v_perm_b32 v116, v52, v48, s35
    v_perm_b32 v117, v60, v56, s35
    v_perm_b32 v118, v68, v64, s35
    v_perm_b32 v119, v76, v72, s35
    ds_write_b128 v7, v[116:119] offset:9216
    v_perm_b32 v120, v53, v49, s34
    v_perm_b32 v121, v61, v57, s34
    v_perm_b32 v122, v69, v65, s34
    v_perm_b32 v123, v77, v73, s34
    ds_write_b128 v7, v[120:123] offset:10240
    v_perm_b32 v124, v53, v49, s35
    v_perm_b32 v125, v61, v57, s35
    v_perm_b32 v126, v69, v65, s35
    v_perm_b32 v127, v77, v73, s35
    ds_write_b128 v7, v[124:127] offset:11264
    s_waitcnt lgkmcnt(0)
    v_perm_b32 v112, v54, v50, s34
    v_perm_b32 v113, v62, v58, s34
    v_perm_b32 v114, v70, v66, s34
    v_perm_b32 v115, v78, v74, s34
    ds_write_b128 v7, v[112:115] offset:12288
    v_perm_b32 v116, v54, v50, s35
    v_perm_b32 v117, v62, v58, s35
    v_perm_b32 v118, v70, v66, s35
    v_perm_b32 v119, v78, v74, s35
    ds_write_b128 v7, v[116:119] offset:13312
    v_perm_b32 v120, v55, v51, s34
    v_perm_b32 v121, v63, v59, s34
    v_perm_b32 v122, v71, v67, s34
    v_perm_b32 v123, v79, v75, s34
    ds_write_b128 v7, v[120:123] offset:14336
    v_perm_b32 v124, v55, v51, s35
    v_perm_b32 v125, v63, v59, s35
    v_perm_b32 v126, v71, v67, s35
    v_perm_b32 v127, v79, v75, s35
    ds_write_b128 v7, v[124:127] offset:15360
    s_waitcnt lgkmcnt(0)
    s_waitcnt vmcnt(8)
    v_perm_b32 v112, v84, v80, s34
    v_perm_b32 v113, v92, v88, s34
    v_perm_b32 v114, v100, v96, s34
    v_perm_b32 v115, v108, v104, s34
    ds_write_b128 v7, v[112:115] offset:16384
    v_perm_b32 v116, v84, v80, s35
    v_perm_b32 v117, v92, v88, s35
    v_perm_b32 v118, v100, v96, s35
    v_perm_b32 v119, v108, v104, s35
    ds_write_b128 v7, v[116:119] offset:17408
    v_perm_b32 v120, v85, v81, s34
    v_perm_b32 v121, v93, v89, s34
    v_perm_b32 v122, v101, v97, s34
    v_perm_b32 v123, v109, v105, s34
    ds_write_b128 v7, v[120:123] offset:18432
    v_perm_b32 v124, v85, v81, s35
    v_perm_b32 v125, v93, v89, s35
    v_perm_b32 v126, v101, v97, s35
    v_perm_b32 v127, v109, v105, s35
    ds_write_b128 v7, v[124:127] offset:19456
    s_waitcnt lgkmcnt(0)
    v_perm_b32 v112, v86, v82, s34
    v_perm_b32 v113, v94, v90, s34
    v_perm_b32 v114, v102, v98, s34
    v_perm_b32 v115, v110, v106, s34
    ds_write_b128 v7, v[112:115] offset:20480
    v_perm_b32 v116, v86, v82, s35
    v_perm_b32 v117, v94, v90, s35
    v_perm_b32 v118, v102, v98, s35
    v_perm_b32 v119, v110, v106, s35
    ds_write_b128 v7, v[116:119] offset:21504
    v_perm_b32 v120, v87, v83, s34
    v_perm_b32 v121, v95, v91, s34
    v_perm_b32 v122, v103, v99, s34
    v_perm_b32 v123, v111, v107, s34
    ds_write_b128 v7, v[120:123] offset:22528
    v_perm_b32 v124, v87, v83, s35
    v_perm_b32 v125, v95, v91, s35
    v_perm_b32 v126, v103, v99, s35
    v_perm_b32 v127, v111, v107, s35
    ds_write_b128 v7, v[124:127] offset:23552
    s_waitcnt lgkmcnt(0)
    s_waitcnt vmcnt(0)
    v_perm_b32 v112, v20, v16, s34
    v_perm_b32 v113, v28, v24, s34
    v_perm_b32 v114, v36, v32, s34
    v_perm_b32 v115, v44, v40, s34
    ds_write_b128 v7, v[112:115] offset:24576
    v_perm_b32 v116, v20, v16, s35
    v_perm_b32 v117, v28, v24, s35
    v_perm_b32 v118, v36, v32, s35
    v_perm_b32 v119, v44, v40, s35
    ds_write_b128 v7, v[116:119] offset:25600
    v_perm_b32 v120, v21, v17, s34
    v_perm_b32 v121, v29, v25, s34
    v_perm_b32 v122, v37, v33, s34
    v_perm_b32 v123, v45, v41, s34
    ds_write_b128 v7, v[120:123] offset:26624
    v_perm_b32 v124, v21, v17, s35
    v_perm_b32 v125, v29, v25, s35
    v_perm_b32 v126, v37, v33, s35
    v_perm_b32 v127, v45, v41, s35
    ds_write_b128 v7, v[124:127] offset:27648
    s_waitcnt lgkmcnt(0)
    v_perm_b32 v112, v22, v18, s34
    v_perm_b32 v113, v30, v26, s34
    v_perm_b32 v114, v38, v34, s34
    v_perm_b32 v115, v46, v42, s34
    ds_write_b128 v7, v[112:115] offset:28672
    v_perm_b32 v116, v22, v18, s35
    v_perm_b32 v117, v30, v26, s35
    v_perm_b32 v118, v38, v34, s35
    v_perm_b32 v119, v46, v42, s35
    ds_write_b128 v7, v[116:119] offset:29696
    v_perm_b32 v120, v23, v19, s34
    v_perm_b32 v121, v31, v27, s34
    v_perm_b32 v122, v39, v35, s34
    v_perm_b32 v123, v47, v43, s34
    ds_write_b128 v7, v[120:123] offset:30720
    v_perm_b32 v124, v23, v19, s35
    v_perm_b32 v125, v31, v27, s35
    v_perm_b32 v126, v39, v35, s35
    v_perm_b32 v127, v47, v43, s35
    ds_write_b128 v7, v[124:127] offset:31744
    s_waitcnt lgkmcnt(0)
    s_lshl_b32 s25, s22, 7
    s_add_u32 s25, s25, 0x192000
    v_lshrrev_b32 v15, 2, v1
    v_and_b32 v15, 127, v15
L_TPI:
    buffer_load_dword v14, v15, s[8:11], s25 offen sc1
    s_add_u32 s32, s32, 1
    s_cmp_gt_u32 s32, 200000
    s_waitcnt vmcnt(0)
    s_cbranch_scc1 L_TPI_ok
    v_cmp_eq_u32 vcc, 0, v14
    s_cbranch_vccz L_TPI_ok
    s_sleep 8
    s_branch L_TPI
L_TPI_ok:
    s_mov_b32 s23, s22
    s_mov_b32 s29, 0
    s_mov_b32 s30, 0x40000000
    s_mul_i32 s24, s23, 0x82100
    s_lshl_b32 s36, s20, 14
    s_add_u32 s24, s24, s36
    s_add_u32 s24, s24, 0x1000000
    s_add_u32 s36, s24, 0
    s_add_u32 s37, s36, 0x7000000
    buffer_load_dwordx4 a[32:35], v1, s[8:11], s36 offen offset:0 sc1
    buffer_load_dwordx4 a[0:3], v1, s[8:11], s37 offen offset:0 sc1
    buffer_load_dwordx4 a[36:39], v1, s[8:11], s36 offen offset:1024 sc1
    buffer_load_dwordx4 a[4:7], v1, s[8:11], s37 offen offset:1024 sc1
    buffer_load_dwordx4 a[40:43], v1, s[8:11], s36 offen offset:2048 sc1
    buffer_load_dwordx4 a[8:11], v1, s[8:11], s37 offen offset:2048 sc1
    buffer_load_dwordx4 a[44:47], v1, s[8:11], s36 offen offset:3072 sc1
    buffer_load_dwordx4 a[12:15], v1, s[8:11], s37 offen offset:3072 sc1
    s_add_u32 s36, s24, 4096
    s_add_u32 s37, s36, 0x7000000
    buffer_load_dwordx4 a[48:51], v1, s[8:11], s36 offen offset:0 sc1
    buffer_load_dwordx4 a[16:19], v1, s[8:11], s37 offen offset:0 sc1
    buffer_load_dwordx4 a[52:55], v1, s[8:11], s36 offen offset:1024 sc1
    buffer_load_dwordx4 a[20:23], v1, s[8:11], s37 offen offset:1024 sc1
    buffer_load_dwordx4 a[56:59], v1, s[8:11], s36 offen offset:2048 sc1
    buffer_load_dwordx4 a[24:27], v1, s[8:11], s37 offen offset:2048 sc1
    buffer_load_dwordx4 a[60:63], v1, s[8:11], s36 offen offset:3072 sc1
    buffer_load_dwordx4 a[28:31], v1, s[8:11], s37 offen offset:3072 sc1
    s_lshr_b32 s36, s21, 1
    s_lshl_b32 s36, s36, 3
    s_xor_b32 s37, s36, 8
    s_add_u32 s24, s24, 8192
    s_add_u32 s36, s36, s24
    s_add_u32 s37, s37, s24
    buffer_load_dwordx2 a[64:65], v2, s[8:11], s36 offen offset:0 sc1
    buffer_load_dwordx2 a[66:67], v2, s[8:11], s37 offen offset:0 sc1
    buffer_load_dwordx2 a[68:69], v2, s[8:11], s36 offen offset:1024 sc1
    buffer_load_dwordx2 a[70:71], v2, s[8:11], s37 offen offset:1024 sc1
L_P2:
    s_and_b32 s36, s29, 1
    s_lshl_b32 s36, s36, 20
    s_lshl_b32 s26, s22, 21
    s_add_u32 s26, s26, s36
    s_add_u32 s26, s26, 0x4000000
    s_bfe_u32 s27, s29, 0x10001
    s_lshl_b32 s24, s23, 13
    s_add_u32 s24, s24, 0x100000
    s_max_u32 s25, s23, 1
    s_lshl_b32 s25, s25, 13
    s_add_u32 s25, s25, 0xfe000
    buffer_load_dwordx4 v[48:51], v2, s[8:11], s24 offen sc1
    buffer_load_dwordx4 v[52:55], v2, s[8:11], s24 offen offset:1024 sc1
    s_lshl_b32 s36, s23, 5
    s_add_u32 s36, s36, s20
    s_lshl_b32 s36, s36, 10
    buffer_load_dword a72, v12, s[12:15], s36 offen
    buffer_load_dword a73, v12, s[92:95], 0 offen
    s_waitcnt vmcnt(4)
    v_cmp_ne_u32 vcc, 0, v1
    v_mov_b32 v15, 0x40000000
    v_mov_b32 v14, 0
    v_cndmask_b32 v15, v1, v15, vcc
    buffer_store_dword v14, v15, s[8:11], s30 offen sc1
    v_mfma_f32_16x16x32_bf16 v[80:83], a[32:35], a[0:3], 0
    v_mfma_f32_16x16x32_bf16 v[80:83], a[36:39], a[4:7], v[80:83]
    v_mfma_f32_16x16x32_bf16 v[80:83], a[40:43], a[8:11], v[80:83]
    v_mfma_f32_16x16x32_bf16 v[80:83], a[44:47], a[12:15], v[80:83]
    v_mfma_f32_16x16x32_bf16 v[88:91], a[48:51], a[16:19], 0
    v_mfma_f32_16x16x32_bf16 v[88:91], a[52:55], a[20:23], v[88:91]
    v_mfma_f32_16x16x32_bf16 v[88:91], a[56:59], a[24:27], v[88:91]
    v_mfma_f32_16x16x32_bf16 v[88:91], a[60:63], a[28:31], v[88:91]
    v_mfma_f32_16x16x32_bf16 v[84:87], a[32:35], a[16:19], 0
    v_mfma_f32_16x16x32_bf16 v[84:87], a[36:39], a[20:23], v[84:87]
    v_mfma_f32_16x16x32_bf16 v[84:87], a[40:43], a[24:27], v[84:87]
    v_mfma_f32_16x16x32_bf16 v[84:87], a[44:47], a[28:31], v[84:87]
    v_cndmask_b32 v80, v13, v80, s[64:65]
    v_cndmask_b32 v81, v13, v81, s[66:67]
    v_cndmask_b32 v82, v13, v82, s[68:69]
    v_cndmask_b32 v83, v13, v83, s[70:71]
    v_cndmask_b32 v88, v13, v88, s[64:65]
    v_cndmask_b32 v89, v13, v89, s[66:67]
    v_cndmask_b32 v90, v13, v90, s[68:69]
    v_cndmask_b32 v91, v13, v91, s[70:71]
    v_max_f32 v116, v80, v81
    v_max3_f32 v116, v116, v82, v83
    v_max_f32 v117, v84, v85
    v_max3_f32 v117, v117, v86, v87
    v_max3_f32 v117, v117, v88, v89
    v_max3_f32 v117, v117, v90, v91
    v_mov_b32 v14, v116
    s_nop 1
    v_permlane16_swap_b32 v116, v14
    v_max_f32 v116, v116, v14
    v_mov_b32 v14, v117
    s_nop 1
    v_permlane16_swap_b32 v117, v14
    v_max_f32 v117, v117, v14
    v_mov_b32 v14, v116
    s_nop 1
    v_permlane32_swap_b32 v116, v14
    v_max_f32 v116, v116, v14
    v_mov_b32 v14, v117
    s_nop 1
    v_permlane32_swap_b32 v117, v14
    v_max_f32 v117, v117, v14
    v_sub_f32 v80, v80, v116
    v_exp_f32 v80, v80
    v_sub_f32 v81, v81, v116
    v_exp_f32 v81, v81
    v_sub_f32 v82, v82, v116
    v_exp_f32 v82, v82
    v_sub_f32 v83, v83, v116
    v_exp_f32 v83, v83
    v_sub_f32 v84, v84, v117
    v_exp_f32 v84, v84
    v_sub_f32 v85, v85, v117
    v_exp_f32 v85, v85
    v_sub_f32 v86, v86, v117
    v_exp_f32 v86, v86
    v_sub_f32 v87, v87, v117
    v_exp_f32 v87, v87
    v_sub_f32 v88, v88, v117
    v_exp_f32 v88, v88
    v_sub_f32 v89, v89, v117
    v_exp_f32 v89, v89
    v_sub_f32 v90, v90, v117
    v_exp_f32 v90, v90
    v_sub_f32 v91, v91, v117
    v_exp_f32 v91, v91
    v_cvt_pk_bf16_f32 v100, v80, v81
    v_cvt_pk_bf16_f32 v101, v82, v83
    v_mov_b64 v[102:103], 0
    v_cvt_pk_bf16_f32 v104, v84, v85
    v_cvt_pk_bf16_f32 v105, v86, v87
    v_cvt_pk_bf16_f32 v106, v88, v89
    v_cvt_pk_bf16_f32 v107, v90, v91
    v_mov_b64 v[108:109], s[4:5]
    v_mov_b64 v[110:111], s[4:5]
    v_cndmask_b32 v112, 0, v108, s[72:73]
    v_cndmask_b32 v113, 0, v108, s[72:73]
    v_mfma_f32_16x16x32_bf16 v[16:19], v[108:111], v[100:103], 0
    v_mfma_f32_16x16x32_bf16 v[24:27], a[64:67], v[100:103], 0
    v_mfma_f32_16x16x32_bf16 v[28:31], a[68:71], v[100:103], 0
    v_mfma_f32_16x16x32_bf16 v[20:23], v[108:111], v[104:107], 0
    v_mfma_f32_16x16x32_bf16 v[32:35], a[64:67], v[104:107], 0
    v_mfma_f32_16x16x32_bf16 v[36:39], a[68:71], v[104:107], 0
    s_branch L_P2_chk
L_P2_far:
    buffer_load_dword v14, v2, s[8:11], s25 offen sc1
    s_add_u32 s32, s32, 1
    s_cmp_gt_u32 s32, 200000
    s_waitcnt vmcnt(0)
    s_cbranch_scc1 L_P2_poll
    v_cmp_eq_u32 vcc, -1, v14
    s_cbranch_vccz L_P2_near
    s_sleep 12
    s_branch L_P2_far
L_P2_near:
    s_mov_b32 s25, 0x40000000
L_P2_poll:
    buffer_load_dwordx4 v[48:51], v2, s[8:11], s24 offen sc1
    buffer_load_dwordx4 v[52:55], v2, s[8:11], s24 offen offset:1024 sc1
L_P2_chk:
    s_add_u32 s32, s32, 1
    s_waitcnt vmcnt(0)
    ds_write_b128 v2, v[48:51] offset:20480
    ds_write_b128 v2, v[52:55] offset:21504
    v_max3_u32 v14, v48, v49, v50
    v_max3_u32 v15, v51, v52, v53
    v_max3_u32 v14, v14, v54, v55
    v_max_u32 v14, v14, v15
    v_cmp_eq_u32 vcc, -1, v14
    s_cbranch_vccz L_P2_got
    s_cmp_gt_u32 s32, 200000
    s_cbranch_scc1 L_P2_got
    s_cmp_eq_u32 s25, 0x40000000
    s_cbranch_scc1 L_P2_poll
    s_branch L_P2_far
L_P2_got:
    s_waitcnt lgkmcnt(0)
    s_barrier
    ds_read_b128 v[48:51], v8 offset:0
    ds_read_b128 v[52:55], v8 offset:2048
    ds_read_b128 v[56:59], v8 offset:4096
    ds_read_b128 v[60:63], v8 offset:6144
    s_waitcnt lgkmcnt(3)
    v_mfma_f32_16x16x32_bf16 v[80:83], a[128:131], v[48:51], 0
    v_mfma_f32_16x16x32_bf16 v[84:87], a[132:135], v[48:51], 0
    ds_read_b128 v[48:51], v8 offset:512
    s_waitcnt lgkmcnt(3)
    v_mfma_f32_16x16x32_bf16 v[80:83], a[136:139], v[52:55], v[80:83]
    v_mfma_f32_16x16x32_bf16 v[84:87], a[140:143], v[52:55], v[84:87]
    ds_read_b128 v[52:55], v8 offset:2560
    s_waitcnt lgkmcnt(3)
    v_mfma_f32_16x16x32_bf16 v[80:83], a[144:147], v[56:59], v[80:83]
    v_mfma_f32_16x16x32_bf16 v[84:87], a[148:151], v[56:59], v[84:87]
    ds_read_b128 v[56:59], v8 offset:4608
    s_waitcnt lgkmcnt(3)
    v_mfma_f32_16x16x32_bf16 v[80:83], a[152:155], v[60:63], v[80:83]
    v_mfma_f32_16x16x32_bf16 v[84:87], a[156:159], v[60:63], v[84:87]
    ds_read_b128 v[60:63], v8 offset:6656
    s_waitcnt lgkmcnt(3)
    v_mfma_f32_16x16x32_bf16 v[80:83], a[160:163], v[48:51], v[80:83]
    v_mfma_f32_16x16x32_bf16 v[84:87], a[164:167], v[48:51], v[84:87]
    ds_read_b128 v[48:51], v8 offset:1024
    s_waitcnt lgkmcnt(3)
    v_mfma_f32_16x16x32_bf16 v[80:83], a[168:171], v[52:55], v[80:83]
    v_mfma_f32_16x16x32_bf16 v[84:87], a[172:175], v[52:55], v[84:87]
    ds_read_b128 v[52:55], v8 offset:3072
    s_waitcnt lgkmcnt(3)
    v_mfma_f32_16x16x32_bf16 v[80:83], a[176:179], v[56:59], v[80:83]
    v_mfma_f32_16x16x32_bf16 v[84:87], a[180:183], v[56:59], v[84:87]
    ds_read_b128 v[56:59], v8 offset:5120
    s_waitcnt lgkmcnt(3)
    v_mfma_f32_16x16x32_bf16 v[80:83], a[184:187], v[60:63], v[80:83]
    v_mfma_f32_16x16x32_bf16 v[84:87], a[188:191], v[60:63], v[84:87]
    ds_read_b128 v[60:63], v8 offset:7168
    s_waitcnt lgkmcnt(3)
    v_mfma_f32_16x16x32_bf16 v[80:83], a[192:195], v[48:51], v[80:83]
    v_mfma_f32_16x16x32_bf16 v[84:87], a[196:199], v[48:51], v[84:87]
    ds_read_b128 v[48:51], v8 offset:1536
    s_waitcnt lgkmcnt(3)
    v_mfma_f32_16x16x32_bf16 v[80:83], a[200:203], v[52:55], v[80:83]
    v_mfma_f32_16x16x32_bf16 v[84:87], a[204:207], v[52:55], v[84:87]
    ds_read_b128 v[52:55], v8 offset:3584
    s_waitcnt lgkmcnt(3)
    v_mfma_f32_16x16x32_bf16 v[80:83], a[208:211], v[56:59], v[80:83]
    v_mfma_f32_16x16x32_bf16 v[84:87], a[212:215], v[56:59], v[84:87]
    ds_read_b128 v[56:59], v8 offset:5632
    s_waitcnt lgkmcnt(3)
    v_mfma_f32_16x16x32_bf16 v[80:83], a[216:219], v[60:63], v[80:83]
    v_mfma_f32_16x16x32_bf16 v[84:87], a[220:223], v[60:63], v[84:87]
    ds_read_b128 v[60:63], v8 offset:7680
    s_waitcnt lgkmcnt(3)
    v_mfma_f32_16x16x32_bf16 v[80:83], a[224:227], v[48:51], v[80:83]
    v_mfma_f32_16x16x32_bf16 v[84:87], a[228:231], v[48:51], v[84:87]
    ds_read_b128 v[48:51], v8 offset:0
    s_waitcnt lgkmcnt(3)
    v_mfma_f32_16x16x32_bf16 v[80:83], a[232:235], v[52:55], v[80:83]
    v_mfma_f32_16x16x32_bf16 v[84:87], a[236:239], v[52:55], v[84:87]
    ds_read_b128 v[52:55], v8 offset:2048
    s_waitcnt lgkmcnt(3)
    v_mfma_f32_16x16x32_bf16 v[80:83], a[240:243], v[56:59], v[80:83]
    v_mfma_f32_16x16x32_bf16 v[84:87], a[244:247], v[56:59], v[84:87]
    ds_read_b128 v[56:59], v8 offset:4096
    s_waitcnt lgkmcnt(3)
    v_mfma_f32_16x16x32_bf16 v[80:83], a[248:251], v[60:63], v[80:83]
    v_mfma_f32_16x16x32_bf16 v[84:87], a[252:255], v[60:63], v[84:87]
    ds_read_b128 v[60:63], v8 offset:6144
    s_waitcnt lgkmcnt(3)
    v_mfma_f32_16x16x32_bf16 v[40:43], v[48:51], v[128:131], 0
    v_mfma_f32_16x16x32_bf16 v[44:47], v[48:51], v[132:135], 0
    ds_read_b128 v[48:51], v8 offset:512
    s_waitcnt lgkmcnt(3)
    v_mfma_f32_16x16x32_bf16 v[40:43], v[52:55], v[136:139], v[40:43]
    v_mfma_f32_16x16x32_bf16 v[44:47], v[52:55], v[140:143], v[44:47]
    ds_read_b128 v[52:55], v8 offset:2560
    s_waitcnt lgkmcnt(3)
    v_mfma_f32_16x16x32_bf16 v[40:43], v[56:59], v[144:147], v[40:43]
    v_mfma_f32_16x16x32_bf16 v[44:47], v[56:59], v[148:151], v[44:47]
    v_mul_f32 v80, s33, v80
    v_mul_f32 v81, s33, v81
    v_mul_f32 v82, s33, v82
    v_mul_f32 v83, s33, v83
    ds_read_b128 v[56:59], v8 offset:4608
    s_waitcnt lgkmcnt(3)
    v_mfma_f32_16x16x32_bf16 v[40:43], v[60:63], v[152:155], v[40:43]
    v_mfma_f32_16x16x32_bf16 v[44:47], v[60:63], v[156:159], v[44:47]
    v_mul_f32 v84, s33, v84
    v_mul_f32 v85, s33, v85
    v_mul_f32 v86, s33, v86
    v_mul_f32 v87, s33, v87
    ds_read_b128 v[60:63], v8 offset:6656
    s_waitcnt lgkmcnt(3)
    v_mfma_f32_16x16x32_bf16 v[40:43], v[48:51], v[160:163], v[40:43]
    v_mfma_f32_16x16x32_bf16 v[44:47], v[48:51], v[164:167], v[44:47]
    v_cvt_pk_bf16_f32 v88, v80, v84
    v_cvt_pk_bf16_f32 v89, v81, v85
    v_cvt_pk_bf16_f32 v90, v82, v86
    v_cvt_pk_bf16_f32 v91, v83, v87
    ds_write_b128 v9, v[88:91] offset:16384
    ds_read_b128 v[48:51], v8 offset:1024
    s_waitcnt lgkmcnt(4)
    v_mfma_f32_16x16x32_bf16 v[40:43], v[52:55], v[168:171], v[40:43]
    v_mfma_f32_16x16x32_bf16 v[44:47], v[52:55], v[172:175], v[44:47]
    ds_read_b128 v[52:55], v8 offset:3072
    s_waitcnt lgkmcnt(4)
    v_mfma_f32_16x16x32_bf16 v[40:43], v[56:59], v[176:179], v[40:43]
    v_mfma_f32_16x16x32_bf16 v[44:47], v[56:59], v[180:183], v[44:47]
    ds_read_b128 v[56:59], v8 offset:5120
    s_waitcnt lgkmcnt(4)
    v_mfma_f32_16x16x32_bf16 v[40:43], v[60:63], v[184:187], v[40:43]
    v_mfma_f32_16x16x32_bf16 v[44:47], v[60:63], v[188:191], v[44:47]
    s_waitcnt lgkmcnt(3)
    s_barrier
    ds_read_b128 v[64:67], v1 offset:16384
    ds_read_b128 v[68:71], v1 offset:17408
    ds_read_b128 v[72:75], v1 offset:18432
    ds_read_b128 v[76:79], v1 offset:19456
    ds_read_b128 v[60:63], v8 offset:7168
    s_waitcnt lgkmcnt(7)
    v_mfma_f32_16x16x32_bf16 v[40:43], v[48:51], v[192:195], v[40:43]
    v_mfma_f32_16x16x32_bf16 v[44:47], v[48:51], v[196:199], v[44:47]
    ds_read_b128 v[48:51], v8 offset:1536
    s_waitcnt lgkmcnt(7)
    v_mfma_f32_16x16x32_bf16 v[40:43], v[52:55], v[200:203], v[40:43]
    v_mfma_f32_16x16x32_bf16 v[44:47], v[52:55], v[204:207], v[44:47]
    s_waitcnt lgkmcnt(2)
    v_mfma_f32_16x16x32_bf16 v[92:95], v[64:67], a[0:3], 0
    v_mfma_f32_16x16x32_bf16 v[96:99], v[64:67], a[16:19], 0
    v_mfma_f32_16x16x32_bf16 v[92:95], v[68:71], a[4:7], v[92:95]
    v_mfma_f32_16x16x32_bf16 v[96:99], v[68:71], a[20:23], v[96:99]
    v_mfma_f32_16x16x32_bf16 v[92:95], v[72:75], a[8:11], v[92:95]
    v_mfma_f32_16x16x32_bf16 v[96:99], v[72:75], a[24:27], v[96:99]
    v_mfma_f32_16x16x32_bf16 v[92:95], v[76:79], a[12:15], v[92:95]
    v_mfma_f32_16x16x32_bf16 v[96:99], v[76:79], a[28:31], v[96:99]
    ds_read_b128 v[52:55], v8 offset:3584
    s_waitcnt lgkmcnt(3)
    v_mfma_f32_16x16x32_bf16 v[40:43], v[56:59], v[208:211], v[40:43]
    v_mfma_f32_16x16x32_bf16 v[44:47], v[56:59], v[212:215], v[44:47]
    ds_read_b128 v[56:59], v8 offset:5632
    s_waitcnt lgkmcnt(3)
    v_mfma_f32_16x16x32_bf16 v[40:43], v[60:63], v[216:219], v[40:43]
    v_mfma_f32_16x16x32_bf16 v[44:47], v[60:63], v[220:223], v[44:47]
    v_max3_f32 v118, v92, v93, v94
    v_max3_f32 v118, v118, v95, v116
    v_max3_f32 v119, v96, v97, v98
    v_max3_f32 v119, v119, v99, v117
    v_mov_b32 v14, v118
    v_mov_b32 v15, v119
    ds_read_b128 v[60:63], v8 offset:7680
    s_waitcnt lgkmcnt(3)
    v_mfma_f32_16x16x32_bf16 v[40:43], v[48:51], v[224:227], v[40:43]
    v_mfma_f32_16x16x32_bf16 v[44:47], v[48:51], v[228:231], v[44:47]
    v_permlane16_swap_b32 v118, v14
    v_permlane16_swap_b32 v119, v15
    v_max_f32 v118, v118, v14
    v_max_f32 v119, v119, v15
    v_sub_f32 v92, v92, v118
    v_exp_f32 v92, v92
    s_waitcnt lgkmcnt(2)
    v_mfma_f32_16x16x32_bf16 v[40:43], v[52:55], v[232:235], v[40:43]
    v_mfma_f32_16x16x32_bf16 v[44:47], v[52:55], v[236:239], v[44:47]
    v_sub_f32 v93, v93, v118
    v_exp_f32 v93, v93
    v_sub_f32 v94, v94, v118
    v_exp_f32 v94, v94
    v_sub_f32 v95, v95, v118
    v_exp_f32 v95, v95
    s_waitcnt lgkmcnt(1)
    v_mfma_f32_16x16x32_bf16 v[40:43], v[56:59], v[240:243], v[40:43]
    v_mfma_f32_16x16x32_bf16 v[44:47], v[56:59], v[244:247], v[44:47]
    v_sub_f32 v104, v116, v118
    v_exp_f32 v104, v104
    v_cvt_pk_bf16_f32 v100, v92, v93
    v_cvt_pk_bf16_f32 v101, v94, v95
    v_sub_f32 v96, v96, v119
    v_exp_f32 v96, v96
    s_waitcnt lgkmcnt(0)
    v_mfma_f32_16x16x32_bf16 v[40:43], v[60:63], v[248:251], v[40:43]
    v_mfma_f32_16x16x32_bf16 v[44:47], v[60:63], v[252:255], v[44:47]
    v_sub_f32 v97, v97, v119
    v_exp_f32 v97, v97
    v_sub_f32 v98, v98, v119
    v_exp_f32 v98, v98
    v_sub_f32 v99, v99, v119
    v_exp_f32 v99, v99
    v_sub_f32 v105, v117, v119
    v_exp_f32 v105, v105
    v_cvt_pk_bf16_f32 v102, v96, v97
    v_cvt_pk_bf16_f32 v103, v98, v99
    v_mfma_f32_16x16x16_bf16 v[48:51], v[112:113], v[100:101], 0
    s_nop 0
    v_mfma_f32_16x16x16_bf16 v[52:55], v[112:113], v[102:103], 0
    v_cvt_pk_bf16_f32 v80, v40, v41
    v_cndmask_b32 v80, 0, v80, s[72:73]
    v_cvt_pk_bf16_f32 v81, v42, v43
    v_cndmask_b32 v81, 0, v81, s[72:73]
    v_cvt_pk_bf16_f32 v82, v44, v45
    v_cndmask_b32 v82, 0, v82, s[72:73]
    v_cvt_pk_bf16_f32 v83, v46, v47
    v_cndmask_b32 v83, 0, v83, s[72:73]
    v_mfma_f32_16x16x16_bf16 v[56:59], v[80:81], v[100:101], 0
    s_nop 0
    v_mfma_f32_16x16x16_bf16 v[60:63], v[82:83], v[100:101], 0
    v_mfma_f32_16x16x16_bf16 v[64:67], v[80:81], v[102:103], 0
    v_mfma_f32_16x16x16_bf16 v[68:71], v[82:83], v[102:103], 0
    v_fma_f32 v48, v16, v104, v48
    v_rcp_f32 v48, v48
    v_fma_f32 v52, v20, v105, v52
    v_rcp_f32 v52, v52
    v_fma_f32 v56, v24, v104, v56
    v_fma_f32 v57, v25, v104, v57
    v_fma_f32 v58, v26, v104, v58
    v_fma_f32 v59, v27, v104, v59
    v_fma_f32 v60, v28, v104, v60
    v_fma_f32 v61, v29, v104, v61
    v_fma_f32 v62, v30, v104, v62
    v_fma_f32 v63, v31, v104, v63
    v_pk_mul_f32 v[56:57], v[56:57], v[48:49] op_sel_hi:[1,0]
    v_pk_mul_f32 v[58:59], v[58:59], v[48:49] op_sel_hi:[1,0]
    v_pk_mul_f32 v[60:61], v[60:61], v[48:49] op_sel_hi:[1,0]
    v_pk_mul_f32 v[62:63], v[62:63], v[48:49] op_sel_hi:[1,0]
    v_cvt_pk_bf16_f32 v72, v56, v60
    v_cvt_pk_bf16_f32 v73, v57, v61
    v_cvt_pk_bf16_f32 v74, v58, v62
    v_cvt_pk_bf16_f32 v75, v59, v63
    ds_write_b128 v9, v[72:75] offset:0
    v_fma_f32 v64, v32, v105, v64
    v_fma_f32 v65, v33, v105, v65
    v_fma_f32 v66, v34, v105, v66
    v_fma_f32 v67, v35, v105, v67
    v_fma_f32 v68, v36, v105, v68
    v_fma_f32 v69, v37, v105, v69
    v_fma_f32 v70, v38, v105, v70
    v_fma_f32 v71, v39, v105, v71
    v_pk_mul_f32 v[64:65], v[64:65], v[52:53] op_sel_hi:[1,0]
    v_pk_mul_f32 v[66:67], v[66:67], v[52:53] op_sel_hi:[1,0]
    v_pk_mul_f32 v[68:69], v[68:69], v[52:53] op_sel_hi:[1,0]
    v_pk_mul_f32 v[70:71], v[70:71], v[52:53] op_sel_hi:[1,0]
    v_cvt_pk_bf16_f32 v76, v64, v68
    v_cvt_pk_bf16_f32 v77, v65, v69
    v_cvt_pk_bf16_f32 v78, v66, v70
    v_cvt_pk_bf16_f32 v79, v67, v71
    ds_write_b128 v9, v[76:79] offset:4096
    s_waitcnt lgkmcnt(0)
    s_barrier
    ds_read_b128 v[16:19], v1 offset:0
    ds_read_b128 v[20:23], v1 offset:1024
    ds_read_b128 v[24:27], v1 offset:2048
    ds_read_b128 v[28:31], v1 offset:3072
    ds_read_b128 v[32:35], v1 offset:4096
    ds_read_b128 v[36:39], v1 offset:5120
    ds_read_b128 v[40:43], v1 offset:6144
    ds_read_b128 v[44:47], v1 offset:7168
    ds_read_b128 v[48:51], v7 offset:0
    ds_read_b128 v[52:55], v7 offset:1024
    ds_read_b128 v[56:59], v7 offset:2048
    s_lshl_b32 s36, s20, 10
    s_add_u32 s25, s26, s36
    s_waitcnt lgkmcnt(2)
    v_mfma_f32_16x16x32_bf16 v[64:67], v[16:19], v[48:51], 0
    ds_read_b128 v[60:63], v7 offset:3072
    s_waitcnt lgkmcnt(2)
    v_mfma_f32_16x16x32_bf16 v[68:71], v[16:19], v[52:55], 0
    ds_read_b128 v[48:51], v7 offset:4096
    s_waitcnt lgkmcnt(2)
    v_mfma_f32_16x16x32_bf16 v[72:75], v[16:19], v[56:59], 0
    ds_read_b128 v[52:55], v7 offset:5120
    s_waitcnt lgkmcnt(2)
    v_mfma_f32_16x16x32_bf16 v[76:79], v[16:19], v[60:63], 0
    ds_read_b128 v[56:59], v7 offset:6144
    s_waitcnt lgkmcnt(2)
    v_mfma_f32_16x16x32_bf16 v[80:83], v[16:19], v[48:51], 0
    ds_read_b128 v[60:63], v7 offset:7168
    s_waitcnt lgkmcnt(2)
    v_mfma_f32_16x16x32_bf16 v[84:87], v[16:19], v[52:55], 0
    ds_read_b128 v[48:51], v7 offset:8192
    s_waitcnt lgkmcnt(2)
    v_mfma_f32_16x16x32_bf16 v[88:91], v[16:19], v[56:59], 0
    ds_read_b128 v[52:55], v7 offset:9216
    s_waitcnt lgkmcnt(2)
    v_mfma_f32_16x16x32_bf16 v[92:95], v[16:19], v[60:63], 0
    ds_read_b128 v[56:59], v7 offset:10240
    s_waitcnt lgkmcnt(2)
    v_mfma_f32_16x16x32_bf16 v[64:67], v[20:23], v[48:51], v[64:67]
    ds_read_b128 v[60:63], v7 offset:11264
    s_waitcnt lgkmcnt(2)
    v_mfma_f32_16x16x32_bf16 v[68:71], v[20:23], v[52:55], v[68:71]
    ds_read_b128 v[48:51], v7 offset:12288
    s_waitcnt lgkmcnt(2)
    v_mfma_f32_16x16x32_bf16 v[72:75], v[20:23], v[56:59], v[72:75]
    ds_read_b128 v[52:55], v7 offset:13312
    s_waitcnt lgkmcnt(2)
    v_mfma_f32_16x16x32_bf16 v[76:79], v[20:23], v[60:63], v[76:79]
    ds_read_b128 v[56:59], v7 offset:14336
    s_waitcnt lgkmcnt(2)
    v_mfma_f32_16x16x32_bf16 v[80:83], v[20:23], v[48:51], v[80:83]
    ds_read_b128 v[60:63], v7 offset:15360
    s_waitcnt lgkmcnt(2)
    v_mfma_f32_16x16x32_bf16 v[84:87], v[20:23], v[52:55], v[84:87]
    ds_read_b128 v[48:51], v7 offset:16384
    s_waitcnt lgkmcnt(2)
    v_mfma_f32_16x16x32_bf16 v[88:91], v[20:23], v[56:59], v[88:91]
    ds_read_b128 v[52:55], v7 offset:17408
    s_waitcnt lgkmcnt(2)
    v_mfma_f32_16x16x32_bf16 v[92:95], v[20:23], v[60:63], v[92:95]
    ds_read_b128 v[56:59], v7 offset:18432
    s_waitcnt lgkmcnt(2)
    v_mfma_f32_16x16x32_bf16 v[64:67], v[24:27], v[48:51], v[64:67]
    ds_read_b128 v[60:63], v7 offset:19456
    s_waitcnt lgkmcnt(2)
    v_mfma_f32_16x16x32_bf16 v[68:71], v[24:27], v[52:55], v[68:71]
    ds_read_b128 v[48:51], v7 offset:20480
    s_waitcnt lgkmcnt(2)
    v_mfma_f32_16x16x32_bf16 v[72:75], v[24:27], v[56:59], v[72:75]
    ds_read_b128 v[52:55], v7 offset:21504
    s_waitcnt lgkmcnt(2)
    v_mfma_f32_16x16x32_bf16 v[76:79], v[24:27], v[60:63], v[76:79]
    ds_read_b128 v[56:59], v7 offset:22528
    s_waitcnt lgkmcnt(2)
    v_mfma_f32_16x16x32_bf16 v[80:83], v[24:27], v[48:51], v[80:83]
    ds_read_b128 v[60:63], v7 offset:23552
    s_waitcnt lgkmcnt(2)
    v_mfma_f32_16x16x32_bf16 v[84:87], v[24:27], v[52:55], v[84:87]
    ds_read_b128 v[48:51], v7 offset:24576
    s_waitcnt lgkmcnt(2)
    v_mfma_f32_16x16x32_bf16 v[88:91], v[24:27], v[56:59], v[88:91]
    ds_read_b128 v[52:55], v7 offset:25600
    s_waitcnt lgkmcnt(2)
    v_mfma_f32_16x16x32_bf16 v[92:95], v[24:27], v[60:63], v[92:95]
    ds_read_b128 v[56:59], v7 offset:26624
    s_waitcnt lgkmcnt(2)
    v_mfma_f32_16x16x32_bf16 v[64:67], v[28:31], v[48:51], v[64:67]
    ds_read_b128 v[60:63], v7 offset:27648
    s_waitcnt lgkmcnt(2)
    v_mfma_f32_16x16x32_bf16 v[68:71], v[28:31], v[52:55], v[68:71]
    ds_read_b128 v[48:51], v7 offset:28672
    s_waitcnt lgkmcnt(2)
    v_mfma_f32_16x16x32_bf16 v[72:75], v[28:31], v[56:59], v[72:75]
    ds_read_b128 v[52:55], v7 offset:29696
    s_waitcnt lgkmcnt(2)
    v_mfma_f32_16x16x32_bf16 v[76:79], v[28:31], v[60:63], v[76:79]
    ds_read_b128 v[56:59], v7 offset:30720
    s_waitcnt lgkmcnt(2)
    v_mfma_f32_16x16x32_bf16 v[80:83], v[28:31], v[48:51], v[80:83]
    ds_read_b128 v[60:63], v7 offset:31744
    s_waitcnt lgkmcnt(2)
    v_mfma_f32_16x16x32_bf16 v[84:87], v[28:31], v[52:55], v[84:87]
    ds_read_b128 v[48:51], v7 offset:0
    s_waitcnt lgkmcnt(2)
    v_mfma_f32_16x16x32_bf16 v[88:91], v[28:31], v[56:59], v[88:91]
    ds_read_b128 v[52:55], v7 offset:1024
    s_waitcnt lgkmcnt(2)
    v_mfma_f32_16x16x32_bf16 v[92:95], v[28:31], v[60:63], v[92:95]
    ds_read_b128 v[56:59], v7 offset:2048
    s_waitcnt lgkmcnt(2)
    v_mfma_f32_16x16x32_bf16 v[96:99], v[32:35], v[48:51], 0
    ds_read_b128 v[60:63], v7 offset:3072
    s_waitcnt lgkmcnt(2)
    v_mfma_f32_16x16x32_bf16 v[100:103], v[32:35], v[52:55], 0
    ds_read_b128 v[48:51], v7 offset:4096
    s_waitcnt lgkmcnt(2)
    v_mfma_f32_16x16x32_bf16 v[104:107], v[32:35], v[56:59], 0
    ds_read_b128 v[52:55], v7 offset:5120
    s_waitcnt lgkmcnt(2)
    v_mfma_f32_16x16x32_bf16 v[108:111], v[32:35], v[60:63], 0
    ds_read_b128 v[56:59], v7 offset:6144
    v_cvt_pk_bf16_f32 v16, v64, v68
    s_waitcnt lgkmcnt(2)
    v_mfma_f32_16x16x32_bf16 v[112:115], v[32:35], v[48:51], 0
    ds_read_b128 v[60:63], v7 offset:7168
    v_cvt_pk_bf16_f32 v17, v72, v76
    s_waitcnt lgkmcnt(2)
    v_mfma_f32_16x16x32_bf16 v[116:119], v[32:35], v[52:55], 0
    ds_read_b128 v[48:51], v7 offset:8192
    v_cvt_pk_bf16_f32 v18, v80, v84
    s_waitcnt lgkmcnt(2)
    v_mfma_f32_16x16x32_bf16 v[120:123], v[32:35], v[56:59], 0
    ds_read_b128 v[52:55], v7 offset:9216
    v_cvt_pk_bf16_f32 v19, v88, v92
    s_waitcnt lgkmcnt(2)
    v_mfma_f32_16x16x32_bf16 v[124:127], v[32:35], v[60:63], 0
    ds_read_b128 v[56:59], v7 offset:10240
    v_and_or_b32 v16, v16, -2, s27
    s_waitcnt lgkmcnt(2)
    v_mfma_f32_16x16x32_bf16 v[96:99], v[36:39], v[48:51], v[96:99]
    ds_read_b128 v[60:63], v7 offset:11264
    s_add_u32 s36, s25, 0x0
    s_waitcnt lgkmcnt(2)
    v_mfma_f32_16x16x32_bf16 v[100:103], v[36:39], v[52:55], v[100:103]
    ds_read_b128 v[48:51], v7 offset:12288
    buffer_store_dwordx4 v[16:19], v10, s[8:11], s36 offen sc1
    s_waitcnt lgkmcnt(2)
    v_mfma_f32_16x16x32_bf16 v[104:107], v[36:39], v[56:59], v[104:107]
    ds_read_b128 v[52:55], v7 offset:13312
    v_cvt_pk_bf16_f32 v20, v65, v69
    s_waitcnt lgkmcnt(2)
    v_mfma_f32_16x16x32_bf16 v[108:111], v[36:39], v[60:63], v[108:111]
    ds_read_b128 v[56:59], v7 offset:14336
    v_cvt_pk_bf16_f32 v21, v73, v77
    s_waitcnt lgkmcnt(2)
    v_mfma_f32_16x16x32_bf16 v[112:115], v[36:39], v[48:51], v[112:115]
    ds_read_b128 v[60:63], v7 offset:15360
    v_cvt_pk_bf16_f32 v22, v81, v85
    s_waitcnt lgkmcnt(2)
    v_mfma_f32_16x16x32_bf16 v[116:119], v[36:39], v[52:55], v[116:119]
    ds_read_b128 v[48:51], v7 offset:16384
    v_cvt_pk_bf16_f32 v23, v89, v93
    s_waitcnt lgkmcnt(2)
    v_mfma_f32_16x16x32_bf16 v[120:123], v[36:39], v[56:59], v[120:123]
    ds_read_b128 v[52:55], v7 offset:17408
    v_and_or_b32 v20, v20, -2, s27
    s_waitcnt lgkmcnt(2)
    v_mfma_f32_16x16x32_bf16 v[124:127], v[36:39], v[60:63], v[124:127]
    ds_read_b128 v[56:59], v7 offset:18432
    s_add_u32 s36, s25, 0x8000
    s_waitcnt lgkmcnt(2)
    v_mfma_f32_16x16x32_bf16 v[96:99], v[40:43], v[48:51], v[96:99]
    ds_read_b128 v[60:63], v7 offset:19456
    buffer_store_dwordx4 v[20:23], v10, s[8:11], s36 offen sc1
    s_waitcnt lgkmcnt(2)
    v_mfma_f32_16x16x32_bf16 v[100:103], v[40:43], v[52:55], v[100:103]
    ds_read_b128 v[48:51], v7 offset:20480
    v_cvt_pk_bf16_f32 v24, v66, v70
    s_waitcnt lgkmcnt(2)
    v_mfma_f32_16x16x32_bf16 v[104:107], v[40:43], v[56:59], v[104:107]
    ds_read_b128 v[52:55], v7 offset:21504
    v_cvt_pk_bf16_f32 v25, v74, v78
    s_waitcnt lgkmcnt(2)
    v_mfma_f32_16x16x32_bf16 v[108:111], v[40:43], v[60:63], v[108:111]
    ds_read_b128 v[56:59], v7 offset:22528
    v_cvt_pk_bf16_f32 v26, v82, v86
    s_waitcnt lgkmcnt(2)
    v_mfma_f32_16x16x32_bf16 v[112:115], v[40:43], v[48:51], v[112:115]
    ds_read_b128 v[60:63], v7 offset:23552
    v_cvt_pk_bf16_f32 v27, v90, v94
    s_waitcnt lgkmcnt(2)
    v_mfma_f32_16x16x32_bf16 v[116:119], v[40:43], v[52:55], v[116:119]
    ds_read_b128 v[48:51], v7 offset:24576
    v_and_or_b32 v24, v24, -2, s27
    s_waitcnt lgkmcnt(2)
    v_mfma_f32_16x16x32_bf16 v[120:123], v[40:43], v[56:59], v[120:123]
    ds_read_b128 v[52:55], v7 offset:25600
    s_add_u32 s36, s25, 0x10000
    s_waitcnt lgkmcnt(2)
    v_mfma_f32_16x16x32_bf16 v[124:127], v[40:43], v[60:63], v[124:127]
    ds_read_b128 v[56:59], v7 offset:26624
    buffer_store_dwordx4 v[24:27], v10, s[8:11], s36 offen sc1
    s_waitcnt lgkmcnt(2)
    v_mfma_f32_16x16x32_bf16 v[96:99], v[44:47], v[48:51], v[96:99]
    ds_read_b128 v[60:63], v7 offset:27648
    v_cvt_pk_bf16_f32 v28, v67, v71
    s_waitcnt lgkmcnt(2)
    v_mfma_f32_16x16x32_bf16 v[100:103], v[44:47], v[52:55], v[100:103]
    ds_read_b128 v[48:51], v7 offset:28672
    v_cvt_pk_bf16_f32 v29, v75, v79
    s_waitcnt lgkmcnt(2)
    v_mfma_f32_16x16x32_bf16 v[104:107], v[44:47], v[56:59], v[104:107]
    ds_read_b128 v[52:55], v7 offset:29696
    v_cvt_pk_bf16_f32 v30, v83, v87
    s_waitcnt lgkmcnt(2)
    v_mfma_f32_16x16x32_bf16 v[108:111], v[44:47], v[60:63], v[108:111]
    ds_read_b128 v[56:59], v7 offset:30720
    v_cvt_pk_bf16_f32 v31, v91, v95
    s_waitcnt lgkmcnt(2)
    v_mfma_f32_16x16x32_bf16 v[112:115], v[44:47], v[48:51], v[112:115]
    ds_read_b128 v[60:63], v7 offset:31744
    v_and_or_b32 v28, v28, -2, s27
    s_waitcnt lgkmcnt(2)
    v_mfma_f32_16x16x32_bf16 v[116:119], v[44:47], v[52:55], v[116:119]
    s_add_u32 s36, s25, 0x18000
    s_waitcnt lgkmcnt(1)
    v_mfma_f32_16x16x32_bf16 v[120:123], v[44:47], v[56:59], v[120:123]
    buffer_store_dwordx4 v[28:31], v10, s[8:11], s36 offen sc1
    s_waitcnt lgkmcnt(0)
    v_mfma_f32_16x16x32_bf16 v[124:127], v[44:47], v[60:63], v[124:127]
    v_cvt_pk_bf16_f32 v32, v96, v100
    v_cvt_pk_bf16_f32 v33, v104, v108
    v_cvt_pk_bf16_f32 v34, v112, v116
    s_nop 4
    v_cvt_pk_bf16_f32 v35, v120, v124
    v_and_or_b32 v32, v32, -2, s27
    s_add_u32 s36, s25, 0x80000
    buffer_store_dwordx4 v[32:35], v10, s[8:11], s36 offen sc1
    v_cvt_pk_bf16_f32 v36, v97, v101
    v_cvt_pk_bf16_f32 v37, v105, v109
    v_cvt_pk_bf16_f32 v38, v113, v117
    v_cvt_pk_bf16_f32 v39, v121, v125
    v_and_or_b32 v36, v36, -2, s27
    s_add_u32 s36, s25, 0x88000
    buffer_store_dwordx4 v[36:39], v10, s[8:11], s36 offen sc1
    v_cvt_pk_bf16_f32 v40, v98, v102
    v_cvt_pk_bf16_f32 v41, v106, v110
    v_cvt_pk_bf16_f32 v42, v114, v118
    v_cvt_pk_bf16_f32 v43, v122, v126
    v_and_or_b32 v40, v40, -2, s27
    s_add_u32 s36, s25, 0x90000
    buffer_store_dwordx4 v[40:43], v10, s[8:11], s36 offen sc1
    v_cvt_pk_bf16_f32 v44, v99, v103
    v_cvt_pk_bf16_f32 v45, v107, v111
    v_cvt_pk_bf16_f32 v46, v115, v119
    v_cvt_pk_bf16_f32 v47, v123, v127
    v_and_or_b32 v44, v44, -2, s27
    s_add_u32 s36, s25, 0x98000
    buffer_store_dwordx4 v[44:47], v10, s[8:11], s36 offen sc1
    s_add_u32 s38, s23, 6
    s_cmp_ge_u32 s38, 64
    s_cbranch_scc1 L_P2_last
    s_mul_i32 s24, s38, 0x82100
    s_lshl_b32 s36, s20, 14
    s_add_u32 s24, s24, s36
    s_add_u32 s24, s24, 0x1000000
    s_add_u32 s36, s24, 0
    s_add_u32 s37, s36, 0x7000000
    buffer_load_dwordx4 a[32:35], v1, s[8:11], s36 offen offset:0 sc1
    buffer_load_dwordx4 a[0:3], v1, s[8:11], s37 offen offset:0 sc1
    buffer_load_dwordx4 a[36:39], v1, s[8:11], s36 offen offset:1024 sc1
    buffer_load_dwordx4 a[4:7], v1, s[8:11], s37 offen offset:1024 sc1
    buffer_load_dwordx4 a[40:43], v1, s[8:11], s36 offen offset:2048 sc1
    buffer_load_dwordx4 a[8:11], v1, s[8:11], s37 offen offset:2048 sc1
    buffer_load_dwordx4 a[44:47], v1, s[8:11], s36 offen offset:3072 sc1
    buffer_load_dwordx4 a[12:15], v1, s[8:11], s37 offen offset:3072 sc1
    s_add_u32 s36, s24, 4096
    s_add_u32 s37, s36, 0x7000000
    buffer_load_dwordx4 a[48:51], v1, s[8:11], s36 offen offset:0 sc1
    buffer_load_dwordx4 a[16:19], v1, s[8:11], s37 offen offset:0 sc1
    buffer_load_dwordx4 a[52:55], v1, s[8:11], s36 offen offset:1024 sc1
    buffer_load_dwordx4 a[20:23], v1, s[8:11], s37 offen offset:1024 sc1
    buffer_load_dwordx4 a[56:59], v1, s[8:11], s36 offen offset:2048 sc1
    buffer_load_dwordx4 a[24:27], v1, s[8:11], s37 offen offset:2048 sc1
    buffer_load_dwordx4 a[60:63], v1, s[8:11], s36 offen offset:3072 sc1
    buffer_load_dwordx4 a[28:31], v1, s[8:11], s37 offen offset:3072 sc1
    s_lshr_b32 s36, s21, 1
    s_lshl_b32 s36, s36, 3
    s_xor_b32 s37, s36, 8
    s_add_u32 s24, s24, 8192
    s_add_u32 s36, s36, s24
    s_add_u32 s37, s37, s24
    buffer_load_dwordx2 a[64:65], v2, s[8:11], s36 offen offset:0 sc1
    buffer_load_dwordx2 a[66:67], v2, s[8:11], s37 offen offset:0 sc1
    buffer_load_dwordx2 a[68:69], v2, s[8:11], s36 offen offset:1024 sc1
    buffer_load_dwordx2 a[70:71], v2, s[8:11], s37 offen offset:1024 sc1
L_P2_last:
    s_lshl_b32 s24, s23, 5
    s_add_u32 s24, s24, s20
    s_lshl_b32 s24, s24, 10
    v_accvgpr_read_b32 v52, a72
    v_accvgpr_read_b32 v53, a73
    v_and_b32 v15, 15, v0
    v_mov_b32 v48, 0
    v_mov_b32 v14, 0x3f80
    v_cmp_eq_u32 vcc, 0, v15
    s_nop 1
    v_cndmask_b32 v48, v48, v14, vcc
    v_mov_b32 v14, 0x3f800000
    v_cmp_eq_u32 vcc, 1, v15
    s_nop 1
    v_cndmask_b32 v48, v48, v14, vcc
    v_mov_b32 v49, 0
    v_mov_b32 v14, 0x3f80
    v_cmp_eq_u32 vcc, 4, v15
    s_nop 1
    v_cndmask_b32 v49, v49, v14, vcc
    v_mov_b32 v14, 0x3f800000
    v_cmp_eq_u32 vcc, 5, v15
    s_nop 1
    v_cndmask_b32 v49, v49, v14, vcc
    v_mov_b32 v50, 0
    v_mov_b32 v14, 0x3f80
    v_cmp_eq_u32 vcc, 8, v15
    s_nop 1
    v_cndmask_b32 v50, v50, v14, vcc
    v_mov_b32 v14, 0x3f800000
    v_cmp_eq_u32 vcc, 9, v15
    s_nop 1
    v_cndmask_b32 v50, v50, v14, vcc
    v_mov_b32 v51, 0
    v_mov_b32 v14, 0x3f80
    v_cmp_eq_u32 vcc, 12, v15
    s_nop 1
    v_cndmask_b32 v51, v51, v14, vcc
    v_mov_b32 v14, 0x3f800000
    v_cmp_eq_u32 vcc, 13, v15
    s_nop 1
    v_cndmask_b32 v51, v51, v14, vcc
    s_lshl_b32 s25, s20, 15
    s_add_u32 s25, s25, s26
L_P3_poll:
    s_add_u32 s36, s25, 0
    buffer_load_dwordx4 v[80:83], v11, s[8:11], s36 offen sc1
    s_add_u32 s36, s25, 4096
    buffer_load_dwordx4 v[84:87], v11, s[8:11], s36 offen sc1
    s_add_u32 s36, s25, 8192
    buffer_load_dwordx4 v[88:91], v11, s[8:11], s36 offen sc1
    s_add_u32 s36, s25, 12288
    buffer_load_dwordx4 v[92:95], v11, s[8:11], s36 offen sc1
    s_add_u32 s36, s25, 16384
    buffer_load_dwordx4 v[96:99], v11, s[8:11], s36 offen sc1
    s_add_u32 s36, s25, 20480
    buffer_load_dwordx4 v[100:103], v11, s[8:11], s36 offen sc1
    s_add_u32 s36, s25, 24576
    buffer_load_dwordx4 v[104:107], v11, s[8:11], s36 offen sc1
    s_add_u32 s36, s25, 28672
    buffer_load_dwordx4 v[108:111], v11, s[8:11], s36 offen sc1
    s_mov_b64 exec, -1
    s_add_u32 s32, s32, 1
    s_cmp_gt_u32 s32, 200000
    s_waitcnt vmcnt(7)
    v_mfma_f32_16x16x32_bf16 v[56:59], v[48:51], v[80:83], 0
    s_waitcnt vmcnt(6)
    v_mfma_f32_16x16x32_bf16 v[56:59], v[48:51], v[84:87], v[56:59]
    v_bitop3_b32 v60, v80, v84, s27 bitop3:0x7e
    s_waitcnt vmcnt(5)
    v_mfma_f32_16x16x32_bf16 v[56:59], v[48:51], v[88:91], v[56:59]
    s_waitcnt vmcnt(4)
    v_mfma_f32_16x16x32_bf16 v[56:59], v[48:51], v[92:95], v[56:59]
    v_bitop3_b32 v61, v88, v92, s27 bitop3:0x7e
    s_waitcnt vmcnt(3)
    v_mfma_f32_16x16x32_bf16 v[56:59], v[48:51], v[96:99], v[56:59]
    s_waitcnt vmcnt(2)
    v_mfma_f32_16x16x32_bf16 v[56:59], v[48:51], v[100:103], v[56:59]
    v_bitop3_b32 v62, v96, v100, s27 bitop3:0x7e
    s_waitcnt vmcnt(1)
    v_mfma_f32_16x16x32_bf16 v[56:59], v[48:51], v[104:107], v[56:59]
    s_waitcnt vmcnt(0)
    v_mfma_f32_16x16x32_bf16 v[56:59], v[48:51], v[108:111], v[56:59]
    v_bitop3_b32 v63, v104, v108, s27 bitop3:0x7e
    v_or3_b32 v14, v60, v61, v62
    v_bitop3_b32 v14, v14, v63, 1 bitop3:0xa8
    s_cbranch_scc1 L_P3_got
    v_cmp_ne_u32 vcc, 0, v14
    s_cbranch_vccz L_P3_got
    s_mov_b64 exec, vcc
    s_branch L_P3_poll
L_P3_got:
    s_nop 4
    v_cvt_pk_bf16_f32 v62, v56, v57
    v_lshlrev_b32 v65, 16, v62
    v_and_b32 v66, 0xffff0000, v62
    v_lshlrev_b32 v60, 16, v52
    v_and_b32 v61, 0xffff0000, v52
    v_add_f32 v60, v60, v65
    v_add_f32 v61, v61, v66
    v_cvt_pk_bf16_f32 v62, v60, v61
    v_lshlrev_b32 v60, 16, v62
    v_and_b32 v61, 0xffff0000, v62
    v_add_f32 v63, v60, v61
    v_mul_f32 v64, v60, v60
    v_fmac_f32 v64, v61, v61
    v_add_f32_dpp v63, v63, v63 quad_perm:[1,0,3,2] row_mask:0xf bank_mask:0xf
    s_nop 0
    v_add_f32_dpp v64, v64, v64 quad_perm:[1,0,3,2] row_mask:0xf bank_mask:0xf
    v_add_f32_dpp v63, v63, v63 quad_perm:[2,3,0,1] row_mask:0xf bank_mask:0xf
    s_nop 0
    v_add_f32_dpp v64, v64, v64 quad_perm:[2,3,0,1] row_mask:0xf bank_mask:0xf
    v_add_f32_dpp v63, v63, v63 row_half_mirror row_mask:0xf bank_mask:0xf
    s_nop 0
    v_add_f32_dpp v64, v64, v64 row_half_mirror row_mask:0xf bank_mask:0xf
    v_add_f32_dpp v63, v63, v63 row_mirror row_mask:0xf bank_mask:0xf
    s_nop 0
    v_add_f32_dpp v64, v64, v64 row_mirror row_mask:0xf bank_mask:0xf
    v_mov_b32 v14, v63
    s_nop 1
    v_permlane16_swap_b32 v63, v14
    v_add_f32 v63, v63, v14
    v_mov_b32 v14, v64
    s_nop 1
    v_permlane16_swap_b32 v64, v14
    v_add_f32 v64, v64, v14
    v_mov_b32 v14, v63
    s_nop 1
    v_permlane32_swap_b32 v63, v14
    v_add_f32 v63, v63, v14
    v_mov_b32 v14, v64
    s_nop 1
    v_permlane32_swap_b32 v64, v14
    v_add_f32 v64, v64, v14
    v_mov_b32 v15, s21
    v_lshlrev_b32 v15, 3, v15
    v_add_u32 v15, 28672, v15
    ds_write2_b32 v15, v63, v64 offset0:0 offset1:1
    s_add_u32 s36, s24, 0x400000
    buffer_store_dword v62, v12, s[8:11], s36 offen sc1
    s_waitcnt lgkmcnt(0)
    s_barrier
    v_mov_b32 v15, 28672
    ds_read_b128 v[68:71], v15
    ds_read_b128 v[72:75], v15 offset:16
    s_waitcnt lgkmcnt(0)
    v_add_f32 v63, v68, v70
    v_add_f32 v63, v63, v72
    v_add_f32 v63, v63, v74
    v_mul_f32 v63, 0x3b000000, v63
    v_add_f32 v64, v69, v71
    v_add_f32 v64, v64, v73
    v_add_f32 v64, v64, v75
    v_mul_f32 v64, 0x3b000000, v64
    v_fma_f32 v64, -v63, v63, v64
    v_max_f32 v64, 0, v64
    v_cvt_pk_bf16_f32 v14, v63, v64
    v_lshlrev_b32 v63, 16, v14
    v_and_b32 v64, 0xffff0000, v14
    v_add_f32 v64, 0x3727c5ac, v64
    v_cvt_pk_bf16_f32 v14, v64, v64
    v_lshlrev_b32 v64, 16, v14
    v_sqrt_f32 v64, v64
    s_nop 0
    v_cvt_pk_bf16_f32 v14, v64, v64
    v_lshlrev_b32 v64, 16, v14
    v_rcp_f32 v64, v64
    v_sub_f32 v65, v60, v63
    v_sub_f32 v66, v61, v63
    v_cvt_pk_bf16_f32 v14, v65, v66
    v_lshlrev_b32 v65, 16, v14
    v_and_b32 v66, 0xffff0000, v14
    v_mul_f32 v65, v65, v64
    v_mul_f32 v66, v66, v64
    v_cvt_pk_bf16_f32 v67, v65, v66
    v_lshlrev_b32 v65, 16, v67
    v_and_b32 v66, 0xffff0000, v67
    v_lshlrev_b32 v68, 16, v53
    v_and_b32 v69, 0xffff0000, v53
    v_mul_f32 v63, v65, v68
    v_fmac_f32 v63, v66, v69
    s_nop 1
    v_add_f32_dpp v63, v63, v63 quad_perm:[1,0,3,2] row_mask:0xf bank_mask:0xf
    s_nop 1
    v_add_f32_dpp v63, v63, v63 quad_perm:[2,3,0,1] row_mask:0xf bank_mask:0xf
    s_nop 1
    v_add_f32_dpp v63, v63, v63 row_half_mirror row_mask:0xf bank_mask:0xf
    s_nop 1
    v_add_f32_dpp v63, v63, v63 row_mirror row_mask:0xf bank_mask:0xf
    v_mov_b32 v14, v63
    s_nop 1
    v_permlane16_swap_b32 v63, v14
    v_add_f32 v63, v63, v14
    v_mov_b32 v14, v63
    s_nop 1
    v_permlane32_swap_b32 v63, v14
    v_add_f32 v63, v63, v14
    s_lshr_b32 s25, s24, 6
    s_lshl_b32 s37, s21, 2
    s_add_u32 s25, s25, s37
    s_add_u32 s36, s25, 0x194000
    v_cmp_ne_u32 vcc, 0, v1
    v_mov_b32 v15, 0x40000000
    s_nop 0
    v_cndmask_b32 v15, v1, v15, vcc
    buffer_store_dword v63, v15, s[8:11], s36 offen sc1
    v_add_f32 v60, v60, v65
    v_add_f32 v61, v61, v66
    v_cvt_pk_bf16_f32 v62, v60, v61
    buffer_store_dword v62, v12, s[60:63], s24 offen sc1
    s_add_u32 s36, s24, 0x600000
    buffer_store_dword v67, v12, s[8:11], s36 offen sc1
    s_add_u32 s30, s25, 0x1b8000
    s_add_u32 s29, s29, 1
    s_barrier
    s_add_u32 s23, s23, 6
    s_cmp_lt_u32 s23, 64
    s_cbranch_scc1 L_P2
    s_waitcnt vmcnt(0)
    v_cmp_ne_u32 vcc, 0, v1
    v_mov_b32 v15, 0x40000000
    v_mov_b32 v14, 0
    v_cndmask_b32 v15, v1, v15, vcc
    buffer_store_dword v14, v15, s[8:11], s30 offen sc1
    s_branch L_end
L_mlp:
    s_mov_b32 s12, s44
    s_and_b32 s13, s45, 0xffff
    s_mov_b32 s14, 0x200000
    s_mov_b32 s15, 0x20000
    s_mov_b32 s60, s82
    s_and_b32 s61, s83, 0xffff
    s_mov_b32 s62, 0x200000
    s_mov_b32 s63, 0x20000
    s_mov_b32 s92, s80
    s_and_b32 s93, s81, 0xffff
    s_mov_b32 s94, 0x400
    s_mov_b32 s95, 0x20000
    v_mov_b32 v1, 0x0
    v_bfe_u32 v14, v0, 0, 1
    s_mov_b32 s38, 0x10
    v_mad_u32_u24 v1, v14, s38, v1
    v_bfe_u32 v14, v0, 1, 1
    s_mov_b32 s38, 0x20
    v_mad_u32_u24 v1, v14, s38, v1
    v_bfe_u32 v14, v0, 2, 1
    s_mov_b32 s38, 0x40
    v_mad_u32_u24 v1, v14, s38, v1
    v_bfe_u32 v14, v0, 3, 1
    s_mov_b32 s38, 0x80
    v_mad_u32_u24 v1, v14, s38, v1
    v_bfe_u32 v14, v0, 4, 1
    s_mov_b32 s38, 0x100
    v_mad_u32_u24 v1, v14, s38, v1
    v_bfe_u32 v14, v0, 5, 1
    s_mov_b32 s38, 0x200
    v_mad_u32_u24 v1, v14, s38, v1
    v_mov_b32 v2, 0x0
    v_bfe_u32 v14, v0, 0, 1
    s_mov_b32 s38, 0x10
    v_mad_u32_u24 v2, v14, s38, v2
    v_bfe_u32 v14, v0, 1, 1
    s_mov_b32 s38, 0x20
    v_mad_u32_u24 v2, v14, s38, v2
    v_bfe_u32 v14, v0, 2, 1
    s_mov_b32 s38, 0x40
    v_mad_u32_u24 v2, v14, s38, v2
    v_bfe_u32 v14, v0, 3, 1
    s_mov_b32 s38, 0x80
    v_mad_u32_u24 v2, v14, s38, v2
    v_bfe_u32 v14, v0, 4, 1
    s_mov_b32 s38, 0x100
    v_mad_u32_u24 v2, v14, s38, v2
    v_bfe_u32 v14, v0, 5, 1
    s_mov_b32 s38, 0x200
    v_mad_u32_u24 v2, v14, s38, v2
    v_bfe_u32 v14, v0, 6, 1
    s_mov_b32 s38, 0x800
    v_mad_u32_u24 v2, v14, s38, v2
    v_bfe_u32 v14, v0, 7, 1
    s_mov_b32 s38, 0x1000
    v_mad_u32_u24 v2, v14, s38, v2
    v_mov_b32 v9, 0x0
    v_bfe_u32 v14, v0, 0, 1
    s_mov_b32 s38, 0x10
    v_mad_u32_u24 v9, v14, s38, v9
    v_bfe_u32 v14, v0, 1, 1
    s_mov_b32 s38, 0x20
    v_mad_u32_u24 v9, v14, s38, v9
    v_bfe_u32 v14, v0, 2, 1
    s_mov_b32 s38, 0x40
    v_mad_u32_u24 v9, v14, s38, v9
    v_bfe_u32 v14, v0, 3, 1
    s_mov_b32 s38, 0x80
    v_mad_u32_u24 v9, v14, s38, v9
    v_bfe_u32 v14, v0, 4, 1
    s_mov_b32 s38, 0x100
    v_mad_u32_u24 v9, v14, s38, v9
    v_bfe_u32 v14, v0, 5, 1
    s_mov_b32 s38, 0x200
    v_mad_u32_u24 v9, v14, s38, v9
    v_bfe_u32 v14, v0, 6, 1
    s_mov_b32 s38, 0x400
    v_mad_u32_u24 v9, v14, s38, v9
    v_bfe_u32 v14, v0, 7, 1
    s_mov_b32 s38, 0x800
    v_mad_u32_u24 v9, v14, s38, v9
    v_mov_b32 v7, 0x8000
    v_bfe_u32 v14, v0, 0, 1
    s_mov_b32 s38, 0x10
    v_mad_u32_u24 v7, v14, s38, v7
    v_bfe_u32 v14, v0, 1, 1
    s_mov_b32 s38, 0x20
    v_mad_u32_u24 v7, v14, s38, v7
    v_bfe_u32 v14, v0, 2, 1
    s_mov_b32 s38, 0x40
    v_mad_u32_u24 v7, v14, s38, v7
    v_bfe_u32 v14, v0, 3, 1
    s_mov_b32 s38, 0x80
    v_mad_u32_u24 v7, v14, s38, v7
    v_bfe_u32 v14, v0, 4, 1
    s_mov_b32 s38, 0x100
    v_mad_u32_u24 v7, v14, s38, v7
    v_bfe_u32 v14, v0, 5, 1
    s_mov_b32 s38, 0x200
    v_mad_u32_u24 v7, v14, s38, v7
    v_bfe_u32 v14, v0, 6, 1
    s_mov_b32 s38, 0x8000
    v_mad_u32_u24 v7, v14, s38, v7
    v_bfe_u32 v14, v0, 7, 1
    s_mov_b32 s38, 0x10000
    v_mad_u32_u24 v7, v14, s38, v7
    v_mov_b32 v3, 0x0
    v_bfe_u32 v14, v0, 0, 1
    s_mov_b32 s38, 0x10
    v_mad_u32_u24 v3, v14, s38, v3
    v_bfe_u32 v14, v0, 1, 1
    s_mov_b32 s38, 0x20
    v_mad_u32_u24 v3, v14, s38, v3
    v_bfe_u32 v14, v0, 2, 1
    s_mov_b32 s38, 0x40
    v_mad_u32_u24 v3, v14, s38, v3
    v_bfe_u32 v14, v0, 3, 1
    s_mov_b32 s38, 0x400
    v_mad_u32_u24 v3, v14, s38, v3
    v_bfe_u32 v14, v0, 4, 1
    s_mov_b32 s38, 0x800
    v_mad_u32_u24 v3, v14, s38, v3
    v_bfe_u32 v14, v0, 5, 1
    s_mov_b32 s38, 0x1000
    v_mad_u32_u24 v3, v14, s38, v3
    v_bfe_u32 v14, v0, 6, 1
    s_mov_b32 s38, 0x2000
    v_mad_u32_u24 v3, v14, s38, v3
    v_bfe_u32 v14, v0, 7, 1
    s_mov_b32 s38, 0x4000
    v_mad_u32_u24 v3, v14, s38, v3
    v_mov_b32 v4, 0x0
    v_bfe_u32 v14, v0, 0, 1
    s_mov_b32 s38, 0x100
    v_mad_u32_u24 v4, v14, s38, v4
    v_bfe_u32 v14, v0, 1, 1
    s_mov_b32 s38, 0x200
    v_mad_u32_u24 v4, v14, s38, v4
    v_bfe_u32 v14, v0, 2, 1
    s_mov_b32 s38, 0x400
    v_mad_u32_u24 v4, v14, s38, v4
    v_bfe_u32 v14, v0, 6, 1
    s_mov_b32 s38, 0x80
    v_mad_u32_u24 v4, v14, s38, v4
    v_bfe_u32 v14, v0, 7, 1
    s_mov_b32 s38, 0x4000
    v_mad_u32_u24 v4, v14, s38, v4
    v_lshrrev_b32 v15, 3, v0
    v_xor_b32 v15, v15, v0
    v_and_b32 v15, 7, v15
    v_lshl_add_u32 v4, v15, 4, v4
    v_bfe_u32 v15, v0, 4, 2
    v_lshlrev_b32 v15, 4, v15
    v_xor_b32 v5, v15, v1
    v_xor_b32 v6, 64, v5
    v_mov_b32 v8, 0x5000
    v_bfe_u32 v14, v0, 0, 1
    s_mov_b32 s38, 0x10
    v_mad_u32_u24 v8, v14, s38, v8
    v_bfe_u32 v14, v0, 1, 1
    s_mov_b32 s38, 0x40
    v_mad_u32_u24 v8, v14, s38, v8
    v_bfe_u32 v14, v0, 2, 1
    s_mov_b32 s38, 0x80
    v_mad_u32_u24 v8, v14, s38, v8
    v_bfe_u32 v14, v0, 4, 1
    s_mov_b32 s38, 0x20
    v_mad_u32_u24 v8, v14, s38, v8
    v_bfe_u32 v14, v0, 5, 1
    s_mov_b32 s38, 0x100
    v_mad_u32_u24 v8, v14, s38, v8
    v_mov_b32 v10, 0x0
    v_bfe_u32 v14, v0, 0, 1
    s_mov_b32 s38, 0x10
    v_mad_u32_u24 v10, v14, s38, v10
    v_bfe_u32 v14, v0, 1, 1
    s_mov_b32 s38, 0x20
    v_mad_u32_u24 v10, v14, s38, v10
    v_bfe_u32 v14, v0, 2, 1
    s_mov_b32 s38, 0x40
    v_mad_u32_u24 v10, v14, s38, v10
    v_bfe_u32 v14, v0, 3, 1
    s_mov_b32 s38, 0x80
    v_mad_u32_u24 v10, v14, s38, v10
    v_bfe_u32 v14, v0, 4, 1
    s_mov_b32 s38, 0x20000
    v_mad_u32_u24 v10, v14, s38, v10
    v_bfe_u32 v14, v0, 5, 1
    s_mov_b32 s38, 0x40000
    v_mad_u32_u24 v10, v14, s38, v10
    v_bfe_u32 v14, v0, 6, 1
    s_mov_b32 s38, 0x100
    v_mad_u32_u24 v10, v14, s38, v10
    v_bfe_u32 v14, v0, 7, 1
    s_mov_b32 s38, 0x200
    v_mad_u32_u24 v10, v14, s38, v10
    v_mov_b32 v11, 0x0
    v_bfe_u32 v14, v0, 0, 1
    s_mov_b32 s38, 0x10
    v_mad_u32_u24 v11, v14, s38, v11
    v_bfe_u32 v14, v0, 1, 1
    s_mov_b32 s38, 0x20
    v_mad_u32_u24 v11, v14, s38, v11
    v_bfe_u32 v14, v0, 2, 1
    s_mov_b32 s38, 0x40
    v_mad_u32_u24 v11, v14, s38, v11
    v_bfe_u32 v14, v0, 3, 1
    s_mov_b32 s38, 0x80
    v_mad_u32_u24 v11, v14, s38, v11
    v_bfe_u32 v14, v0, 4, 1
    s_mov_b32 s38, 0x400
    v_mad_u32_u24 v11, v14, s38, v11
    v_bfe_u32 v14, v0, 5, 1
    s_mov_b32 s38, 0x800
    v_mad_u32_u24 v11, v14, s38, v11
    v_bfe_u32 v14, v0, 6, 1
    s_mov_b32 s38, 0x100
    v_mad_u32_u24 v11, v14, s38, v11
    v_bfe_u32 v14, v0, 7, 1
    s_mov_b32 s38, 0x200
    v_mad_u32_u24 v11, v14, s38, v11
    v_mov_b32 v12, 0x0
    v_bfe_u32 v14, v0, 0, 1
    s_mov_b32 s38, 0x10
    v_mad_u32_u24 v12, v14, s38, v12
    v_bfe_u32 v14, v0, 1, 1
    s_mov_b32 s38, 0x20
    v_mad_u32_u24 v12, v14, s38, v12
    v_bfe_u32 v14, v0, 2, 1
    s_mov_b32 s38, 0x40
    v_mad_u32_u24 v12, v14, s38, v12
    v_bfe_u32 v14, v0, 3, 1
    s_mov_b32 s38, 0x80
    v_mad_u32_u24 v12, v14, s38, v12
    v_bfe_u32 v14, v0, 4, 1
    s_mov_b32 s38, 0x4
    v_mad_u32_u24 v12, v14, s38, v12
    v_bfe_u32 v14, v0, 5, 1
    s_mov_b32 s38, 0x8
    v_mad_u32_u24 v12, v14, s38, v12
    v_bfe_u32 v14, v0, 6, 1
    s_mov_b32 s38, 0x100
    v_mad_u32_u24 v12, v14, s38, v12
    v_bfe_u32 v14, v0, 7, 1
    s_mov_b32 s38, 0x200
    v_mad_u32_u24 v12, v14, s38, v12
    v_mov_b32 v13, 0xf149f2ca
    v_and_b32 v14, 15, v0
    v_bfe_u32 v15, v0, 4, 2
    v_cmp_gt_u32 s[72:73], 2, v15
    v_lshlrev_b32 v15, 2, v15
    v_cmp_le_u32 s[64:65], v15, v14
    v_add_u32 v15, 1, v15
    v_cmp_le_u32 s[66:67], v15, v14
    v_add_u32 v15, 1, v15
    v_cmp_le_u32 s[68:69], v15, v14
    v_add_u32 v15, 1, v15
    v_cmp_le_u32 s[70:71], v15, v14
    v_add_u32 v15, 1, v15
    s_mov_b32 s34, 0x05040100
    s_mov_b32 s35, 0x07060302
    s_mov_b32 s33, 0x3e0293ee
    s_mov_b32 s32, 0
    s_mov_b32 s4, 0x3f803f80
    s_mov_b32 s5, 0x3f803f80
    s_lshr_b32 s20, s2, 3
    s_lshr_b32 s23, s2, 3
    s_lshl_b32 s23, s23, 1
    s_lshl_b32 s36, s23, 15
    buffer_load_dwordx4 v[96:99], v3, s[12:15], s36 offen offset:0
    buffer_load_dwordx4 v[100:103], v3, s[12:15], s36 offen offset:128
    buffer_load_dwordx4 v[104:107], v3, s[12:15], s36 offen offset:256
    buffer_load_dwordx4 v[108:111], v3, s[12:15], s36 offen offset:384
    buffer_load_dwordx4 v[112:115], v3, s[12:15], s36 offen offset:512
    buffer_load_dwordx4 v[116:119], v3, s[12:15], s36 offen offset:640
    buffer_load_dwordx4 v[120:123], v3, s[12:15], s36 offen offset:768
    buffer_load_dwordx4 v[124:127], v3, s[12:15], s36 offen offset:896
    s_add_u32 s36, s36, 0x8000
    buffer_load_dwordx4 v[128:131], v3, s[12:15], s36 offen offset:0
    buffer_load_dwordx4 v[132:135], v3, s[12:15], s36 offen offset:128
    buffer_load_dwordx4 v[136:139], v3, s[12:15], s36 offen offset:256
    buffer_load_dwordx4 v[140:143], v3, s[12:15], s36 offen offset:384
    buffer_load_dwordx4 v[144:147], v3, s[12:15], s36 offen offset:512
    buffer_load_dwordx4 v[148:151], v3, s[12:15], s36 offen offset:640
    buffer_load_dwordx4 v[152:155], v3, s[12:15], s36 offen offset:768
    buffer_load_dwordx4 v[156:159], v3, s[12:15], s36 offen offset:896
    s_mov_b32 s96, s46
    s_and_b32 s97, s47, 0xffff
    s_mov_b32 s98, 0x2000
    s_mov_b32 s99, 0x20000
    v_mov_b32 v68, 0x0
    v_bfe_u32 v14, v0, 0, 1
    s_mov_b32 s38, 0x8
    v_mad_u32_u24 v68, v14, s38, v68
    v_bfe_u32 v14, v0, 1, 1
    s_mov_b32 s38, 0x10
    v_mad_u32_u24 v68, v14, s38, v68
    v_bfe_u32 v14, v0, 2, 1
    s_mov_b32 s38, 0x10000
    v_mad_u32_u24 v68, v14, s38, v68
    v_bfe_u32 v14, v0, 3, 1
    s_mov_b32 s38, 0x10000
    v_mad_u32_u24 v68, v14, s38, v68
    v_bfe_u32 v14, v0, 4, 1
    s_mov_b32 s38, 0x400
    v_mad_u32_u24 v68, v14, s38, v68
    v_bfe_u32 v14, v0, 5, 1
    s_mov_b32 s38, 0x4
    v_mad_u32_u24 v68, v14, s38, v68
    v_bfe_u32 v14, v0, 6, 1
    s_mov_b32 s38, 0x40
    v_mad_u32_u24 v68, v14, s38, v68
    v_bfe_u32 v14, v0, 7, 1
    s_mov_b32 s38, 0x80
    v_mad_u32_u24 v68, v14, s38, v68
    v_mov_b32 v70, s20
    v_mov_b32 v69, 0x0
    v_bfe_u32 v14, v70, 0, 1
    s_mov_b32 s38, 0x20
    v_mad_u32_u24 v69, v14, s38, v69
    v_bfe_u32 v14, v70, 1, 1
    s_mov_b32 s38, 0x800
    v_mad_u32_u24 v69, v14, s38, v69
    v_bfe_u32 v14, v70, 2, 1
    s_mov_b32 s38, 0x1000
    v_mad_u32_u24 v69, v14, s38, v69
    v_bfe_u32 v14, v70, 3, 1
    s_mov_b32 s38, 0x100
    v_mad_u32_u24 v69, v14, s38, v69
    v_bfe_u32 v14, v70, 4, 1
    s_mov_b32 s38, 0x200
    v_mad_u32_u24 v69, v14, s38, v69
    v_add_u32 v68, v68, v69
    buffer_load_dword v72, v68, s[96:99], 0 offen
    v_mov_b32 v64, -1
    v_mov_b32 v65, -1
    v_mov_b32 v66, -1
    v_mov_b32 v67, -1
    s_lshl_b32 s36, s20, 13
    s_add_u32 s36, s36, 0x0
    buffer_store_dwordx4 v[64:67], v2, s[8:11], s36 offen sc1
    buffer_store_dwordx4 v[64:67], v2, s[8:11], s36 offen offset:1024 sc1
    s_lshl_b32 s36, s20, 14
    s_add_u32 s36, s36, 0x100000
    s_add_u32 s37, s36, 0x2000
    buffer_store_dwordx4 v[64:67], v2, s[8:11], s36 offen sc1
    buffer_store_dwordx4 v[64:67], v2, s[8:11], s36 offen offset:1024 sc1
    buffer_store_dwordx4 v[64:67], v2, s[8:11], s37 offen sc1
    buffer_store_dwordx4 v[64:67], v2, s[8:11], s37 offen offset:1024 sc1
    s_mul_i32 s36, s20, 0x104200
    s_add_u32 s36, s36, 0x1102100
    s_add_u32 s37, s36, 0x82100
    buffer_store_dwordx4 v[64:67], v2, s[8:11], s36 offen sc1
    buffer_store_dwordx4 v[64:67], v2, s[8:11], s36 offen offset:1024 sc1
    buffer_store_dwordx4 v[64:67], v2, s[8:11], s37 offen sc1
    buffer_store_dwordx4 v[64:67], v2, s[8:11], s37 offen offset:1024 sc1
    v_lshlrev_b32 v68, 2, v0
    s_lshl_b32 s36, s20, 10
    s_add_u32 s37, s36, 0x194000
    buffer_store_dword v64, v68, s[8:11], s37 offen sc1
    s_add_u32 s37, s36, 0x1b0000
    buffer_store_dword v64, v68, s[8:11], s37 offen sc1
    s_add_u32 s37, s36, 0x1b8000
    buffer_store_dword v64, v68, s[8:11], s37 offen sc1
    v_mov_b32 v69, 0x40000000
    v_cmp_lt_u32 vcc, 63, v0
    s_nop 1
    v_cndmask_b32 v68, v68, v69, vcc
    v_mov_b32 v73, 0
    s_lshl_b32 s36, s20, 8
    s_add_u32 s37, s36, 0x192000
    buffer_store_dword v73, v68, s[8:11], s37 offen sc1
    s_mul_i32 s36, s20, 0x104200
    s_add_u32 s36, s36, 0x1082000
    s_add_u32 s37, s36, 0x82100
    buffer_store_dword v73, v68, s[8:11], s36 offen sc1
    buffer_store_dword v73, v68, s[8:11], s37 offen sc1
    v_mov_b32 v71, 0x80000
    v_bfe_u32 v14, v0, 0, 1
    s_mov_b32 s38, 0x8
    v_mad_u32_u24 v71, v14, s38, v71
    v_bfe_u32 v14, v0, 1, 1
    s_mov_b32 s38, 0x20
    v_mad_u32_u24 v71, v14, s38, v71
    v_bfe_u32 v14, v0, 4, 1
    s_mov_b32 s38, 0x10
    v_mad_u32_u24 v71, v14, s38, v71
    v_bfe_u32 v14, v0, 5, 1
    s_mov_b32 s38, 0x4
    v_mad_u32_u24 v71, v14, s38, v71
    v_bfe_u32 v14, v0, 6, 1
    s_mov_b32 s38, 0x800
    v_mad_u32_u24 v71, v14, s38, v71
    v_bfe_u32 v14, v0, 7, 1
    s_mov_b32 s38, 0x1000
    v_mad_u32_u24 v71, v14, s38, v71
    v_mov_b32 v69, s20
    v_mov_b32 v68, 0x0
    v_bfe_u32 v14, v69, 0, 1
    s_mov_b32 s38, 0x100
    v_mad_u32_u24 v68, v14, s38, v68
    v_bfe_u32 v14, v69, 1, 1
    s_mov_b32 s38, 0x40
    v_mad_u32_u24 v68, v14, s38, v68
    v_bfe_u32 v14, v69, 2, 1
    s_mov_b32 s38, 0x80
    v_mad_u32_u24 v68, v14, s38, v68
    v_bfe_u32 v14, v69, 3, 1
    s_mov_b32 s38, 0x200
    v_mad_u32_u24 v68, v14, s38, v68
    v_bfe_u32 v14, v69, 4, 1
    s_mov_b32 s38, 0x400
    v_mad_u32_u24 v68, v14, s38, v68
    v_add_u32 v71, v68, v71
    v_and_b32 v68, 12, v0
    v_cmp_ne_u32 vcc, 0, v68
    v_mov_b32 v68, 0x40000000
    s_nop 0
    v_cndmask_b32 v71, v71, v68, vcc
    s_waitcnt vmcnt(16)
    s_mov_b32 s36, 0x1000000
    buffer_store_dword v72, v71, s[8:11], s36 offen sc1
L_XN:
    v_mov_b32 v88, 0
    v_mov_b32 v89, 0
    v_dot2_f32_bf16 v88, v96, s4, v88
    v_dot2_f32_bf16 v89, v96, v96, v89
    v_dot2_f32_bf16 v88, v97, s4, v88
    v_dot2_f32_bf16 v89, v97, v97, v89
    v_dot2_f32_bf16 v88, v98, s4, v88
    v_dot2_f32_bf16 v89, v98, v98, v89
    v_dot2_f32_bf16 v88, v99, s4, v88
    v_dot2_f32_bf16 v89, v99, v99, v89
    v_dot2_f32_bf16 v88, v100, s4, v88
    v_dot2_f32_bf16 v89, v100, v100, v89
    v_dot2_f32_bf16 v88, v101, s4, v88
    v_dot2_f32_bf16 v89, v101, v101, v89
    v_dot2_f32_bf16 v88, v102, s4, v88
    v_dot2_f32_bf16 v89, v102, v102, v89
    v_dot2_f32_bf16 v88, v103, s4, v88
    v_dot2_f32_bf16 v89, v103, v103, v89
    v_dot2_f32_bf16 v88, v104, s4, v88
    v_dot2_f32_bf16 v89, v104, v104, v89
    v_dot2_f32_bf16 v88, v105, s4, v88
    v_dot2_f32_bf16 v89, v105, v105, v89
    v_dot2_f32_bf16 v88, v106, s4, v88
    v_dot2_f32_bf16 v89, v106, v106, v89
    v_dot2_f32_bf16 v88, v107, s4, v88
    v_dot2_f32_bf16 v89, v107, v107, v89
    v_dot2_f32_bf16 v88, v108, s4, v88
    v_dot2_f32_bf16 v89, v108, v108, v89
    v_dot2_f32_bf16 v88, v109, s4, v88
    v_dot2_f32_bf16 v89, v109, v109, v89
    v_dot2_f32_bf16 v88, v110, s4, v88
    v_dot2_f32_bf16 v89, v110, v110, v89
    v_dot2_f32_bf16 v88, v111, s4, v88
    v_dot2_f32_bf16 v89, v111, v111, v89
    v_dot2_f32_bf16 v88, v112, s4, v88
    v_dot2_f32_bf16 v89, v112, v112, v89
    v_dot2_f32_bf16 v88, v113, s4, v88
    v_dot2_f32_bf16 v89, v113, v113, v89
    v_dot2_f32_bf16 v88, v114, s4, v88
    v_dot2_f32_bf16 v89, v114, v114, v89
    v_dot2_f32_bf16 v88, v115, s4, v88
    v_dot2_f32_bf16 v89, v115, v115, v89
    v_dot2_f32_bf16 v88, v116, s4, v88
    v_dot2_f32_bf16 v89, v116, v116, v89
    v_dot2_f32_bf16 v88, v117, s4, v88
    v_dot2_f32_bf16 v89, v117, v117, v89
    v_dot2_f32_bf16 v88, v118, s4, v88
    v_dot2_f32_bf16 v89, v118, v118, v89
    v_dot2_f32_bf16 v88, v119, s4, v88
    v_dot2_f32_bf16 v89, v119, v119, v89
    v_dot2_f32_bf16 v88, v120, s4, v88
    v_dot2_f32_bf16 v89, v120, v120, v89
    v_dot2_f32_bf16 v88, v121, s4, v88
    v_dot2_f32_bf16 v89, v121, v121, v89
    v_dot2_f32_bf16 v88, v122, s4, v88
    v_dot2_f32_bf16 v89, v122, v122, v89
    v_dot2_f32_bf16 v88, v123, s4, v88
    v_dot2_f32_bf16 v89, v123, v123, v89
    v_dot2_f32_bf16 v88, v124, s4, v88
    v_dot2_f32_bf16 v89, v124, v124, v89
    v_dot2_f32_bf16 v88, v125, s4, v88
    v_dot2_f32_bf16 v89, v125, v125, v89
    v_dot2_f32_bf16 v88, v126, s4, v88
    v_dot2_f32_bf16 v89, v126, v126, v89
    v_dot2_f32_bf16 v88, v127, s4, v88
    v_dot2_f32_bf16 v89, v127, v127, v89
    s_nop 3
    v_add_f32_dpp v88, v88, v88 quad_perm:[1,0,3,2] row_mask:0xf bank_mask:0xf
    v_add_f32_dpp v89, v89, v89 quad_perm:[1,0,3,2] row_mask:0xf bank_mask:0xf
    s_nop 0
    v_add_f32_dpp v88, v88, v88 quad_perm:[2,3,0,1] row_mask:0xf bank_mask:0xf
    v_add_f32_dpp v89, v89, v89 quad_perm:[2,3,0,1] row_mask:0xf bank_mask:0xf
    s_nop 0
    v_add_f32_dpp v88, v88, v88 row_half_mirror row_mask:0xf bank_mask:0xf
    v_add_f32_dpp v89, v89, v89 row_half_mirror row_mask:0xf bank_mask:0xf
    v_mul_f32 v88, 0x3b000000, v88
    v_mul_f32 v89, 0x3b000000, v89
    v_fma_f32 v89, -v88, v88, v89
    v_max_f32 v89, 0, v89
    v_cvt_pk_bf16_f32 v14, v88, v89
    v_lshlrev_b32 v88, 16, v14
    v_and_b32 v89, 0xffff0000, v14
    v_add_f32 v89, 0x3727c5ac, v89
    v_cvt_pk_bf16_f32 v14, v89, v89
    v_lshlrev_b32 v89, 16, v14
    v_sqrt_f32 v89, v89
    s_nop 0
    v_cvt_pk_bf16_f32 v14, v89, v89
    v_lshlrev_b32 v89, 16, v14
    v_rcp_f32 v89, v89
    v_lshlrev_b32 v90, 16, v96
    v_and_b32 v91, 0xffff0000, v96
    v_sub_f32 v90, v90, v88
    v_sub_f32 v91, v91, v88
    v_cvt_pk_bf16_f32 v96, v90, v91
    v_lshlrev_b32 v90, 16, v96
    v_and_b32 v91, 0xffff0000, v96
    v_mul_f32 v90, v90, v89
    v_mul_f32 v91, v91, v89
    v_cvt_pk_bf16_f32 v96, v90, v91
    v_lshlrev_b32 v90, 16, v97
    v_and_b32 v91, 0xffff0000, v97
    v_sub_f32 v90, v90, v88
    v_sub_f32 v91, v91, v88
    v_cvt_pk_bf16_f32 v97, v90, v91
    v_lshlrev_b32 v90, 16, v97
    v_and_b32 v91, 0xffff0000, v97
    v_mul_f32 v90, v90, v89
    v_mul_f32 v91, v91, v89
    v_cvt_pk_bf16_f32 v97, v90, v91
    v_lshlrev_b32 v90, 16, v98
    v_and_b32 v91, 0xffff0000, v98
    v_sub_f32 v90, v90, v88
    v_sub_f32 v91, v91, v88
    v_cvt_pk_bf16_f32 v98, v90, v91
    v_lshlrev_b32 v90, 16, v98
    v_and_b32 v91, 0xffff0000, v98
    v_mul_f32 v90, v90, v89
    v_mul_f32 v91, v91, v89
    v_cvt_pk_bf16_f32 v98, v90, v91
    v_lshlrev_b32 v90, 16, v99
    v_and_b32 v91, 0xffff0000, v99
    v_sub_f32 v90, v90, v88
    v_sub_f32 v91, v91, v88
    v_cvt_pk_bf16_f32 v99, v90, v91
    v_lshlrev_b32 v90, 16, v99
    v_and_b32 v91, 0xffff0000, v99
    v_mul_f32 v90, v90, v89
    v_mul_f32 v91, v91, v89
    v_cvt_pk_bf16_f32 v99, v90, v91
    ds_write_b128 v4, v[96:99] offset:0
    v_lshlrev_b32 v90, 16, v100
    v_and_b32 v91, 0xffff0000, v100
    v_sub_f32 v90, v90, v88
    v_sub_f32 v91, v91, v88
    v_cvt_pk_bf16_f32 v100, v90, v91
    v_lshlrev_b32 v90, 16, v100
    v_and_b32 v91, 0xffff0000, v100
    v_mul_f32 v90, v90, v89
    v_mul_f32 v91, v91, v89
    v_cvt_pk_bf16_f32 v100, v90, v91
    v_lshlrev_b32 v90, 16, v101
    v_and_b32 v91, 0xffff0000, v101
    v_sub_f32 v90, v90, v88
    v_sub_f32 v91, v91, v88
    v_cvt_pk_bf16_f32 v101, v90, v91
    v_lshlrev_b32 v90, 16, v101
    v_and_b32 v91, 0xffff0000, v101
    v_mul_f32 v90, v90, v89
    v_mul_f32 v91, v91, v89
    v_cvt_pk_bf16_f32 v101, v90, v91
    v_lshlrev_b32 v90, 16, v102
    v_and_b32 v91, 0xffff0000, v102
    v_sub_f32 v90, v90, v88
    v_sub_f32 v91, v91, v88
    v_cvt_pk_bf16_f32 v102, v90, v91
    v_lshlrev_b32 v90, 16, v102
    v_and_b32 v91, 0xffff0000, v102
    v_mul_f32 v90, v90, v89
    v_mul_f32 v91, v91, v89
    v_cvt_pk_bf16_f32 v102, v90, v91
    v_lshlrev_b32 v90, 16, v103
    v_and_b32 v91, 0xffff0000, v103
    v_sub_f32 v90, v90, v88
    v_sub_f32 v91, v91, v88
    v_cvt_pk_bf16_f32 v103, v90, v91
    v_lshlrev_b32 v90, 16, v103
    v_and_b32 v91, 0xffff0000, v103
    v_mul_f32 v90, v90, v89
    v_mul_f32 v91, v91, v89
    v_cvt_pk_bf16_f32 v103, v90, v91
    ds_write_b128 v4, v[100:103] offset:2048
    v_lshlrev_b32 v90, 16, v104
    v_and_b32 v91, 0xffff0000, v104
    v_sub_f32 v90, v90, v88
    v_sub_f32 v91, v91, v88
    v_cvt_pk_bf16_f32 v104, v90, v91
    v_lshlrev_b32 v90, 16, v104
    v_and_b32 v91, 0xffff0000, v104
    v_mul_f32 v90, v90, v89
    v_mul_f32 v91, v91, v89
    v_cvt_pk_bf16_f32 v104, v90, v91
    v_lshlrev_b32 v90, 16, v105
    v_and_b32 v91, 0xffff0000, v105
    v_sub_f32 v90, v90, v88
    v_sub_f32 v91, v91, v88
    v_cvt_pk_bf16_f32 v105, v90, v91
    v_lshlrev_b32 v90, 16, v105
    v_and_b32 v91, 0xffff0000, v105
    v_mul_f32 v90, v90, v89
    v_mul_f32 v91, v91, v89
    v_cvt_pk_bf16_f32 v105, v90, v91
    v_lshlrev_b32 v90, 16, v106
    v_and_b32 v91, 0xffff0000, v106
    v_sub_f32 v90, v90, v88
    v_sub_f32 v91, v91, v88
    v_cvt_pk_bf16_f32 v106, v90, v91
    v_lshlrev_b32 v90, 16, v106
    v_and_b32 v91, 0xffff0000, v106
    v_mul_f32 v90, v90, v89
    v_mul_f32 v91, v91, v89
    v_cvt_pk_bf16_f32 v106, v90, v91
    v_lshlrev_b32 v90, 16, v107
    v_and_b32 v91, 0xffff0000, v107
    v_sub_f32 v90, v90, v88
    v_sub_f32 v91, v91, v88
    v_cvt_pk_bf16_f32 v107, v90, v91
    v_lshlrev_b32 v90, 16, v107
    v_and_b32 v91, 0xffff0000, v107
    v_mul_f32 v90, v90, v89
    v_mul_f32 v91, v91, v89
    v_cvt_pk_bf16_f32 v107, v90, v91
    ds_write_b128 v4, v[104:107] offset:4096
    v_lshlrev_b32 v90, 16, v108
    v_and_b32 v91, 0xffff0000, v108
    v_sub_f32 v90, v90, v88
    v_sub_f32 v91, v91, v88
    v_cvt_pk_bf16_f32 v108, v90, v91
    v_lshlrev_b32 v90, 16, v108
    v_and_b32 v91, 0xffff0000, v108
    v_mul_f32 v90, v90, v89
    v_mul_f32 v91, v91, v89
    v_cvt_pk_bf16_f32 v108, v90, v91
    v_lshlrev_b32 v90, 16, v109
    v_and_b32 v91, 0xffff0000, v109
    v_sub_f32 v90, v90, v88
    v_sub_f32 v91, v91, v88
    v_cvt_pk_bf16_f32 v109, v90, v91
    v_lshlrev_b32 v90, 16, v109
    v_and_b32 v91, 0xffff0000, v109
    v_mul_f32 v90, v90, v89
    v_mul_f32 v91, v91, v89
    v_cvt_pk_bf16_f32 v109, v90, v91
    v_lshlrev_b32 v90, 16, v110
    v_and_b32 v91, 0xffff0000, v110
    v_sub_f32 v90, v90, v88
    v_sub_f32 v91, v91, v88
    v_cvt_pk_bf16_f32 v110, v90, v91
    v_lshlrev_b32 v90, 16, v110
    v_and_b32 v91, 0xffff0000, v110
    v_mul_f32 v90, v90, v89
    v_mul_f32 v91, v91, v89
    v_cvt_pk_bf16_f32 v110, v90, v91
    v_lshlrev_b32 v90, 16, v111
    v_and_b32 v91, 0xffff0000, v111
    v_sub_f32 v90, v90, v88
    v_sub_f32 v91, v91, v88
    v_cvt_pk_bf16_f32 v111, v90, v91
    v_lshlrev_b32 v90, 16, v111
    v_and_b32 v91, 0xffff0000, v111
    v_mul_f32 v90, v90, v89
    v_mul_f32 v91, v91, v89
    v_cvt_pk_bf16_f32 v111, v90, v91
    ds_write_b128 v4, v[108:111] offset:6144
    v_lshlrev_b32 v90, 16, v112
    v_and_b32 v91, 0xffff0000, v112
    v_sub_f32 v90, v90, v88
    v_sub_f32 v91, v91, v88
    v_cvt_pk_bf16_f32 v112, v90, v91
    v_lshlrev_b32 v90, 16, v112
    v_and_b32 v91, 0xffff0000, v112
    v_mul_f32 v90, v90, v89
    v_mul_f32 v91, v91, v89
    v_cvt_pk_bf16_f32 v112, v90, v91
    v_lshlrev_b32 v90, 16, v113
    v_and_b32 v91, 0xffff0000, v113
    v_sub_f32 v90, v90, v88
    v_sub_f32 v91, v91, v88
    v_cvt_pk_bf16_f32 v113, v90, v91
    v_lshlrev_b32 v90, 16, v113
    v_and_b32 v91, 0xffff0000, v113
    v_mul_f32 v90, v90, v89
    v_mul_f32 v91, v91, v89
    v_cvt_pk_bf16_f32 v113, v90, v91
    v_lshlrev_b32 v90, 16, v114
    v_and_b32 v91, 0xffff0000, v114
    v_sub_f32 v90, v90, v88
    v_sub_f32 v91, v91, v88
    v_cvt_pk_bf16_f32 v114, v90, v91
    v_lshlrev_b32 v90, 16, v114
    v_and_b32 v91, 0xffff0000, v114
    v_mul_f32 v90, v90, v89
    v_mul_f32 v91, v91, v89
    v_cvt_pk_bf16_f32 v114, v90, v91
    v_lshlrev_b32 v90, 16, v115
    v_and_b32 v91, 0xffff0000, v115
    v_sub_f32 v90, v90, v88
    v_sub_f32 v91, v91, v88
    v_cvt_pk_bf16_f32 v115, v90, v91
    v_lshlrev_b32 v90, 16, v115
    v_and_b32 v91, 0xffff0000, v115
    v_mul_f32 v90, v90, v89
    v_mul_f32 v91, v91, v89
    v_cvt_pk_bf16_f32 v115, v90, v91
    ds_write_b128 v4, v[112:115] offset:8192
    v_lshlrev_b32 v90, 16, v116
    v_and_b32 v91, 0xffff0000, v116
    v_sub_f32 v90, v90, v88
    v_sub_f32 v91, v91, v88
    v_cvt_pk_bf16_f32 v116, v90, v91
    v_lshlrev_b32 v90, 16, v116
    v_and_b32 v91, 0xffff0000, v116
    v_mul_f32 v90, v90, v89
    v_mul_f32 v91, v91, v89
    v_cvt_pk_bf16_f32 v116, v90, v91
    v_lshlrev_b32 v90, 16, v117
    v_and_b32 v91, 0xffff0000, v117
    v_sub_f32 v90, v90, v88
    v_sub_f32 v91, v91, v88
    v_cvt_pk_bf16_f32 v117, v90, v91
    v_lshlrev_b32 v90, 16, v117
    v_and_b32 v91, 0xffff0000, v117
    v_mul_f32 v90, v90, v89
    v_mul_f32 v91, v91, v89
    v_cvt_pk_bf16_f32 v117, v90, v91
    v_lshlrev_b32 v90, 16, v118
    v_and_b32 v91, 0xffff0000, v118
    v_sub_f32 v90, v90, v88
    v_sub_f32 v91, v91, v88
    v_cvt_pk_bf16_f32 v118, v90, v91
    v_lshlrev_b32 v90, 16, v118
    v_and_b32 v91, 0xffff0000, v118
    v_mul_f32 v90, v90, v89
    v_mul_f32 v91, v91, v89
    v_cvt_pk_bf16_f32 v118, v90, v91
    v_lshlrev_b32 v90, 16, v119
    v_and_b32 v91, 0xffff0000, v119
    v_sub_f32 v90, v90, v88
    v_sub_f32 v91, v91, v88
    v_cvt_pk_bf16_f32 v119, v90, v91
    v_lshlrev_b32 v90, 16, v119
    v_and_b32 v91, 0xffff0000, v119
    v_mul_f32 v90, v90, v89
    v_mul_f32 v91, v91, v89
    v_cvt_pk_bf16_f32 v119, v90, v91
    ds_write_b128 v4, v[116:119] offset:10240
    v_lshlrev_b32 v90, 16, v120
    v_and_b32 v91, 0xffff0000, v120
    v_sub_f32 v90, v90, v88
    v_sub_f32 v91, v91, v88
    v_cvt_pk_bf16_f32 v120, v90, v91
    v_lshlrev_b32 v90, 16, v120
    v_and_b32 v91, 0xffff0000, v120
    v_mul_f32 v90, v90, v89
    v_mul_f32 v91, v91, v89
    v_cvt_pk_bf16_f32 v120, v90, v91
    v_lshlrev_b32 v90, 16, v121
    v_and_b32 v91, 0xffff0000, v121
    v_sub_f32 v90, v90, v88
    v_sub_f32 v91, v91, v88
    v_cvt_pk_bf16_f32 v121, v90, v91
    v_lshlrev_b32 v90, 16, v121
    v_and_b32 v91, 0xffff0000, v121
    v_mul_f32 v90, v90, v89
    v_mul_f32 v91, v91, v89
    v_cvt_pk_bf16_f32 v121, v90, v91
    v_lshlrev_b32 v90, 16, v122
    v_and_b32 v91, 0xffff0000, v122
    v_sub_f32 v90, v90, v88
    v_sub_f32 v91, v91, v88
    v_cvt_pk_bf16_f32 v122, v90, v91
    v_lshlrev_b32 v90, 16, v122
    v_and_b32 v91, 0xffff0000, v122
    v_mul_f32 v90, v90, v89
    v_mul_f32 v91, v91, v89
    v_cvt_pk_bf16_f32 v122, v90, v91
    v_lshlrev_b32 v90, 16, v123
    v_and_b32 v91, 0xffff0000, v123
    v_sub_f32 v90, v90, v88
    v_sub_f32 v91, v91, v88
    v_cvt_pk_bf16_f32 v123, v90, v91
    v_lshlrev_b32 v90, 16, v123
    v_and_b32 v91, 0xffff0000, v123
    v_mul_f32 v90, v90, v89
    v_mul_f32 v91, v91, v89
    v_cvt_pk_bf16_f32 v123, v90, v91
    ds_write_b128 v4, v[120:123] offset:12288
    v_lshlrev_b32 v90, 16, v124
    v_and_b32 v91, 0xffff0000, v124
    v_sub_f32 v90, v90, v88
    v_sub_f32 v91, v91, v88
    v_cvt_pk_bf16_f32 v124, v90, v91
    v_lshlrev_b32 v90, 16, v124
    v_and_b32 v91, 0xffff0000, v124
    v_mul_f32 v90, v90, v89
    v_mul_f32 v91, v91, v89
    v_cvt_pk_bf16_f32 v124, v90, v91
    v_lshlrev_b32 v90, 16, v125
    v_and_b32 v91, 0xffff0000, v125
    v_sub_f32 v90, v90, v88
    v_sub_f32 v91, v91, v88
    v_cvt_pk_bf16_f32 v125, v90, v91
    v_lshlrev_b32 v90, 16, v125
    v_and_b32 v91, 0xffff0000, v125
    v_mul_f32 v90, v90, v89
    v_mul_f32 v91, v91, v89
    v_cvt_pk_bf16_f32 v125, v90, v91
    v_lshlrev_b32 v90, 16, v126
    v_and_b32 v91, 0xffff0000, v126
    v_sub_f32 v90, v90, v88
    v_sub_f32 v91, v91, v88
    v_cvt_pk_bf16_f32 v126, v90, v91
    v_lshlrev_b32 v90, 16, v126
    v_and_b32 v91, 0xffff0000, v126
    v_mul_f32 v90, v90, v89
    v_mul_f32 v91, v91, v89
    v_cvt_pk_bf16_f32 v126, v90, v91
    v_lshlrev_b32 v90, 16, v127
    v_and_b32 v91, 0xffff0000, v127
    v_sub_f32 v90, v90, v88
    v_sub_f32 v91, v91, v88
    v_cvt_pk_bf16_f32 v127, v90, v91
    v_lshlrev_b32 v90, 16, v127
    v_and_b32 v91, 0xffff0000, v127
    v_mul_f32 v90, v90, v89
    v_mul_f32 v91, v91, v89
    v_cvt_pk_bf16_f32 v127, v90, v91
    ds_write_b128 v4, v[124:127] offset:14336
    s_waitcnt lgkmcnt(0)
    s_barrier
    s_lshl_b32 s24, s23, 15
    s_add_u32 s24, s24, 0x800000
    ds_read_b128 v[24:27], v9 offset:0
    ds_read_b128 v[28:31], v9 offset:4096
    ds_read_b128 v[32:35], v9 offset:8192
    ds_read_b128 v[36:39], v9 offset:12288
    ds_read_b128 v[40:43], v9 offset:16384
    ds_read_b128 v[44:47], v9 offset:20480
    ds_read_b128 v[48:51], v9 offset:24576
    ds_read_b128 v[52:55], v9 offset:28672
    s_waitcnt lgkmcnt(7)
    s_add_u32 s36, s24, 0
    buffer_store_dwordx4 v[24:27], v9, s[8:11], s36 offen sc1
    s_waitcnt lgkmcnt(6)
    s_add_u32 s36, s24, 4096
    buffer_store_dwordx4 v[28:31], v9, s[8:11], s36 offen sc1
    s_waitcnt lgkmcnt(5)
    s_add_u32 s36, s24, 8192
    buffer_store_dwordx4 v[32:35], v9, s[8:11], s36 offen sc1
    s_waitcnt lgkmcnt(4)
    s_add_u32 s36, s24, 12288
    buffer_store_dwordx4 v[36:39], v9, s[8:11], s36 offen sc1
    s_waitcnt lgkmcnt(3)
    s_add_u32 s36, s24, 16384
    buffer_store_dwordx4 v[40:43], v9, s[8:11], s36 offen sc1
    s_waitcnt lgkmcnt(2)
    s_add_u32 s36, s24, 20480
    buffer_store_dwordx4 v[44:47], v9, s[8:11], s36 offen sc1
    s_waitcnt lgkmcnt(1)
    s_add_u32 s36, s24, 24576
    buffer_store_dwordx4 v[48:51], v9, s[8:11], s36 offen sc1
    s_waitcnt lgkmcnt(0)
    s_add_u32 s36, s24, 28672
    buffer_store_dwordx4 v[52:55], v9, s[8:11], s36 offen sc1
    s_barrier
    v_mov_b64 v[96:97], v[128:129]
    v_mov_b64 v[98:99], v[130:131]
    v_mov_b64 v[100:101], v[132:133]
    v_mov_b64 v[102:103], v[134:135]
    v_mov_b64 v[104:105], v[136:137]
    v_mov_b64 v[106:107], v[138:139]
    v_mov_b64 v[108:109], v[140:141]
    v_mov_b64 v[110:111], v[142:143]
    v_mov_b64 v[112:113], v[144:145]
    v_mov_b64 v[114:115], v[146:147]
    v_mov_b64 v[116:117], v[148:149]
    v_mov_b64 v[118:119], v[150:151]
    v_mov_b64 v[120:121], v[152:153]
    v_mov_b64 v[122:123], v[154:155]
    v_mov_b64 v[124:125], v[156:157]
    v_mov_b64 v[126:127], v[158:159]
    s_add_u32 s23, s23, 1
    s_bitcmp1_b32 s23, 0
    s_cbranch_scc1 L_XN
    s_waitcnt vmcnt(0)
    s_barrier
    v_mov_b32 v14, 1
    s_lshl_b32 s37, s20, 2
    v_lshlrev_b32 v15, 20, v0
    buffer_store_dword v14, v15, s[16:19], s37 offen sc1
    s_lshr_b32 s20, s2, 3
    s_mov_b32 s34, 0x05040100
    s_mov_b32 s35, 0x07060302
    s_mov_b32 s32, 0
    s_mov_b32 s64, s84
    s_and_b32 s65, s85, 0xffff
    s_mov_b32 s66, 0x1c0000
    s_mov_b32 s67, 0x20000
    s_mov_b32 s68, s86
    s_and_b32 s69, s87, 0xffff
    s_mov_b32 s70, 0x1c0000
    s_mov_b32 s71, 0x20000
    s_mov_b32 s76, s88
    s_and_b32 s77, s89, 0xffff
    s_mov_b32 s78, 0x1c0000
    s_mov_b32 s79, 0x20000
    v_and_b32 v3, 31, v0
    v_lshlrev_b32 v3, 2, v3
L_M_hs:
    buffer_load_dword v5, v3, s[16:19], 0 offen sc1
    s_add_u32 s32, s32, 1
    s_cmp_gt_u32 s32, 200000
    s_waitcnt vmcnt(0)
    s_cbranch_scc1 L_M_hs_ok
    v_cmp_eq_u32 vcc, 0, v5
    s_cbranch_vccz L_M_hs_ok
    s_sleep 16
    s_branch L_M_hs
L_M_hs_ok:
    v_lshlrev_b32 v3, 4, v0
L_M00_rp:
    s_mov_b32 s36, 0x194000
    buffer_load_dwordx4 v[16:19], v3, s[8:11], s36 offen sc1
    s_add_u32 s32, s32, 1
    v_mov_b32 v5, 0
    s_waitcnt vmcnt(0)
    v_max3_u32 v5, v5, v16, v17
    v_max3_u32 v5, v5, v18, v19
    s_cmp_gt_u32 s32, 200000
    s_cbranch_scc1 L_M00_rp_ok
    v_cmp_eq_u32 vcc, -1, v5
    s_cbranch_vccz L_M00_rp_ok
    s_sleep 64
    s_branch L_M00_rp
L_M00_rp_ok:
    v_add_f32 v16, v16, v17
    v_add_f32 v18, v18, v19
    v_add_f32 v16, v16, v18
    v_cvt_pk_bf16_f32 v5, v16, v16
    v_lshlrev_b32 v16, 16, v5
    v_ashrrev_i32 v5, 31, v16
    v_or_b32 v5, 0x80000000, v5
    v_xor_b32 v5, v5, v16
    v_and_b32 v5, 0xffff0000, v5
    v_sub_u32 v6, 2047, v0
    v_or_b32 v120, v5, v6
    v_lshrrev_b32 v1, 5, v0
    v_and_b32 v2, 31, v0
    s_mov_b32 s36, 229376
    v_mul_lo_u32 v4, v1, s36
    v_lshl_add_u32 v4, v2, 2, v4
    v_mov_b32 v5, 0x40000000
    v_cmp_lt_u32 vcc, 27, v2
    s_nop 1
    v_cndmask_b32 v4, v4, v5, vcc
    s_mul_i32 s23, s20, 112
    s_add_u32 s36, s23, 0
    buffer_load_dword v16, v4, s[64:67], s36 offen
    s_add_u32 s36, s23, 3584
    buffer_load_dword v17, v4, s[64:67], s36 offen
    s_add_u32 s36, s23, 7168
    buffer_load_dword v18, v4, s[64:67], s36 offen
    s_add_u32 s36, s23, 10752
    buffer_load_dword v19, v4, s[64:67], s36 offen
    s_add_u32 s36, s23, 14336
    buffer_load_dword v20, v4, s[64:67], s36 offen
    s_add_u32 s36, s23, 17920
    buffer_load_dword v21, v4, s[64:67], s36 offen
    s_add_u32 s36, s23, 21504
    buffer_load_dword v22, v4, s[64:67], s36 offen
    s_add_u32 s36, s23, 25088
    buffer_load_dword v23, v4, s[64:67], s36 offen
    s_add_u32 s36, s23, 28672
    buffer_load_dword v24, v4, s[64:67], s36 offen
    s_add_u32 s36, s23, 32256
    buffer_load_dword v25, v4, s[64:67], s36 offen
    s_add_u32 s36, s23, 35840
    buffer_load_dword v26, v4, s[64:67], s36 offen
    s_add_u32 s36, s23, 39424
    buffer_load_dword v27, v4, s[64:67], s36 offen
    s_add_u32 s36, s23, 43008
    buffer_load_dword v28, v4, s[64:67], s36 offen
    s_add_u32 s36, s23, 46592
    buffer_load_dword v29, v4, s[64:67], s36 offen
    s_add_u32 s36, s23, 50176
    buffer_load_dword v30, v4, s[64:67], s36 offen
    s_add_u32 s36, s23, 53760
    buffer_load_dword v31, v4, s[64:67], s36 offen
    s_add_u32 s36, s23, 57344
    buffer_load_dword v32, v4, s[64:67], s36 offen
    s_add_u32 s36, s23, 60928
    buffer_load_dword v33, v4, s[64:67], s36 offen
    s_add_u32 s36, s23, 64512
    buffer_load_dword v34, v4, s[64:67], s36 offen
    s_add_u32 s36, s23, 68096
    buffer_load_dword v35, v4, s[64:67], s36 offen
    s_add_u32 s36, s23, 71680
    buffer_load_dword v36, v4, s[64:67], s36 offen
    s_add_u32 s36, s23, 75264
    buffer_load_dword v37, v4, s[64:67], s36 offen
    s_add_u32 s36, s23, 78848
    buffer_load_dword v38, v4, s[64:67], s36 offen
    s_add_u32 s36, s23, 82432
    buffer_load_dword v39, v4, s[64:67], s36 offen
    s_add_u32 s36, s23, 86016
    buffer_load_dword v40, v4, s[64:67], s36 offen
    s_add_u32 s36, s23, 89600
    buffer_load_dword v41, v4, s[64:67], s36 offen
    s_add_u32 s36, s23, 93184
    buffer_load_dword v42, v4, s[64:67], s36 offen
    s_add_u32 s36, s23, 96768
    buffer_load_dword v43, v4, s[64:67], s36 offen
    s_add_u32 s36, s23, 100352
    buffer_load_dword v44, v4, s[64:67], s36 offen
    s_add_u32 s36, s23, 103936
    buffer_load_dword v45, v4, s[64:67], s36 offen
    s_add_u32 s36, s23, 107520
    buffer_load_dword v46, v4, s[64:67], s36 offen
    s_add_u32 s36, s23, 111104
    buffer_load_dword v47, v4, s[64:67], s36 offen
    s_waitcnt vmcnt(0)
    v_perm_b32 v128, v17, v16, s34
    v_perm_b32 v129, v19, v18, s34
    v_perm_b32 v130, v21, v20, s34
    v_perm_b32 v131, v23, v22, s34
    v_perm_b32 v132, v25, v24, s34
    v_perm_b32 v133, v27, v26, s34
    v_perm_b32 v134, v29, v28, s34
    v_perm_b32 v135, v31, v30, s34
    v_perm_b32 v136, v33, v32, s34
    v_perm_b32 v137, v35, v34, s34
    v_perm_b32 v138, v37, v36, s34
    v_perm_b32 v139, v39, v38, s34
    v_perm_b32 v140, v41, v40, s34
    v_perm_b32 v141, v43, v42, s34
    v_perm_b32 v142, v45, v44, s34
    v_perm_b32 v143, v47, v46, s34
    v_perm_b32 v160, v17, v16, s35
    v_perm_b32 v161, v19, v18, s35
    v_perm_b32 v162, v21, v20, s35
    v_perm_b32 v163, v23, v22, s35
    v_perm_b32 v164, v25, v24, s35
    v_perm_b32 v165, v27, v26, s35
    v_perm_b32 v166, v29, v28, s35
    v_perm_b32 v167, v31, v30, s35
    v_perm_b32 v168, v33, v32, s35
    v_perm_b32 v169, v35, v34, s35
    v_perm_b32 v170, v37, v36, s35
    v_perm_b32 v171, v39, v38, s35
    v_perm_b32 v172, v41, v40, s35
    v_perm_b32 v173, v43, v42, s35
    v_perm_b32 v174, v45, v44, s35
    v_perm_b32 v175, v47, v46, s35
    s_add_u32 s36, s23, 114688
    buffer_load_dword v16, v4, s[64:67], s36 offen
    s_add_u32 s36, s23, 118272
    buffer_load_dword v17, v4, s[64:67], s36 offen
    s_add_u32 s36, s23, 121856
    buffer_load_dword v18, v4, s[64:67], s36 offen
    s_add_u32 s36, s23, 125440
    buffer_load_dword v19, v4, s[64:67], s36 offen
    s_add_u32 s36, s23, 129024
    buffer_load_dword v20, v4, s[64:67], s36 offen
    s_add_u32 s36, s23, 132608
    buffer_load_dword v21, v4, s[64:67], s36 offen
    s_add_u32 s36, s23, 136192
    buffer_load_dword v22, v4, s[64:67], s36 offen
    s_add_u32 s36, s23, 139776
    buffer_load_dword v23, v4, s[64:67], s36 offen
    s_add_u32 s36, s23, 143360
    buffer_load_dword v24, v4, s[64:67], s36 offen
    s_add_u32 s36, s23, 146944
    buffer_load_dword v25, v4, s[64:67], s36 offen
    s_add_u32 s36, s23, 150528
    buffer_load_dword v26, v4, s[64:67], s36 offen
    s_add_u32 s36, s23, 154112
    buffer_load_dword v27, v4, s[64:67], s36 offen
    s_add_u32 s36, s23, 157696
    buffer_load_dword v28, v4, s[64:67], s36 offen
    s_add_u32 s36, s23, 161280
    buffer_load_dword v29, v4, s[64:67], s36 offen
    s_add_u32 s36, s23, 164864
    buffer_load_dword v30, v4, s[64:67], s36 offen
    s_add_u32 s36, s23, 168448
    buffer_load_dword v31, v4, s[64:67], s36 offen
    s_add_u32 s36, s23, 172032
    buffer_load_dword v32, v4, s[64:67], s36 offen
    s_add_u32 s36, s23, 175616
    buffer_load_dword v33, v4, s[64:67], s36 offen
    s_add_u32 s36, s23, 179200
    buffer_load_dword v34, v4, s[64:67], s36 offen
    s_add_u32 s36, s23, 182784
    buffer_load_dword v35, v4, s[64:67], s36 offen
    s_add_u32 s36, s23, 186368
    buffer_load_dword v36, v4, s[64:67], s36 offen
    s_add_u32 s36, s23, 189952
    buffer_load_dword v37, v4, s[64:67], s36 offen
    s_add_u32 s36, s23, 193536
    buffer_load_dword v38, v4, s[64:67], s36 offen
    s_add_u32 s36, s23, 197120
    buffer_load_dword v39, v4, s[64:67], s36 offen
    s_add_u32 s36, s23, 200704
    buffer_load_dword v40, v4, s[64:67], s36 offen
    s_add_u32 s36, s23, 204288
    buffer_load_dword v41, v4, s[64:67], s36 offen
    s_add_u32 s36, s23, 207872
    buffer_load_dword v42, v4, s[64:67], s36 offen
    s_add_u32 s36, s23, 211456
    buffer_load_dword v43, v4, s[64:67], s36 offen
    s_add_u32 s36, s23, 215040
    buffer_load_dword v44, v4, s[64:67], s36 offen
    s_add_u32 s36, s23, 218624
    buffer_load_dword v45, v4, s[64:67], s36 offen
    s_add_u32 s36, s23, 222208
    buffer_load_dword v46, v4, s[64:67], s36 offen
    s_add_u32 s36, s23, 225792
    buffer_load_dword v47, v4, s[64:67], s36 offen
    s_waitcnt vmcnt(0)
    v_perm_b32 v144, v17, v16, s34
    v_perm_b32 v145, v19, v18, s34
    v_perm_b32 v146, v21, v20, s34
    v_perm_b32 v147, v23, v22, s34
    v_perm_b32 v148, v25, v24, s34
    v_perm_b32 v149, v27, v26, s34
    v_perm_b32 v150, v29, v28, s34
    v_perm_b32 v151, v31, v30, s34
    v_perm_b32 v152, v33, v32, s34
    v_perm_b32 v153, v35, v34, s34
    v_perm_b32 v154, v37, v36, s34
    v_perm_b32 v155, v39, v38, s34
    v_perm_b32 v156, v41, v40, s34
    v_perm_b32 v157, v43, v42, s34
    v_perm_b32 v158, v45, v44, s34
    v_perm_b32 v159, v47, v46, s34
    v_perm_b32 v176, v17, v16, s35
    v_perm_b32 v177, v19, v18, s35
    v_perm_b32 v178, v21, v20, s35
    v_perm_b32 v179, v23, v22, s35
    v_perm_b32 v180, v25, v24, s35
    v_perm_b32 v181, v27, v26, s35
    v_perm_b32 v182, v29, v28, s35
    v_perm_b32 v183, v31, v30, s35
    v_perm_b32 v184, v33, v32, s35
    v_perm_b32 v185, v35, v34, s35
    v_perm_b32 v186, v37, v36, s35
    v_perm_b32 v187, v39, v38, s35
    v_perm_b32 v188, v41, v40, s35
    v_perm_b32 v189, v43, v42, s35
    v_perm_b32 v190, v45, v44, s35
    v_perm_b32 v191, v47, v46, s35
    s_add_u32 s36, s23, 0
    buffer_load_dword v16, v4, s[68:71], s36 offen
    s_add_u32 s36, s23, 3584
    buffer_load_dword v17, v4, s[68:71], s36 offen
    s_add_u32 s36, s23, 7168
    buffer_load_dword v18, v4, s[68:71], s36 offen
    s_add_u32 s36, s23, 10752
    buffer_load_dword v19, v4, s[68:71], s36 offen
    s_add_u32 s36, s23, 14336
    buffer_load_dword v20, v4, s[68:71], s36 offen
    s_add_u32 s36, s23, 17920
    buffer_load_dword v21, v4, s[68:71], s36 offen
    s_add_u32 s36, s23, 21504
    buffer_load_dword v22, v4, s[68:71], s36 offen
    s_add_u32 s36, s23, 25088
    buffer_load_dword v23, v4, s[68:71], s36 offen
    s_add_u32 s36, s23, 28672
    buffer_load_dword v24, v4, s[68:71], s36 offen
    s_add_u32 s36, s23, 32256
    buffer_load_dword v25, v4, s[68:71], s36 offen
    s_add_u32 s36, s23, 35840
    buffer_load_dword v26, v4, s[68:71], s36 offen
    s_add_u32 s36, s23, 39424
    buffer_load_dword v27, v4, s[68:71], s36 offen
    s_add_u32 s36, s23, 43008
    buffer_load_dword v28, v4, s[68:71], s36 offen
    s_add_u32 s36, s23, 46592
    buffer_load_dword v29, v4, s[68:71], s36 offen
    s_add_u32 s36, s23, 50176
    buffer_load_dword v30, v4, s[68:71], s36 offen
    s_add_u32 s36, s23, 53760
    buffer_load_dword v31, v4, s[68:71], s36 offen
    s_add_u32 s36, s23, 57344
    buffer_load_dword v32, v4, s[68:71], s36 offen
    s_add_u32 s36, s23, 60928
    buffer_load_dword v33, v4, s[68:71], s36 offen
    s_add_u32 s36, s23, 64512
    buffer_load_dword v34, v4, s[68:71], s36 offen
    s_add_u32 s36, s23, 68096
    buffer_load_dword v35, v4, s[68:71], s36 offen
    s_add_u32 s36, s23, 71680
    buffer_load_dword v36, v4, s[68:71], s36 offen
    s_add_u32 s36, s23, 75264
    buffer_load_dword v37, v4, s[68:71], s36 offen
    s_add_u32 s36, s23, 78848
    buffer_load_dword v38, v4, s[68:71], s36 offen
    s_add_u32 s36, s23, 82432
    buffer_load_dword v39, v4, s[68:71], s36 offen
    s_add_u32 s36, s23, 86016
    buffer_load_dword v40, v4, s[68:71], s36 offen
    s_add_u32 s36, s23, 89600
    buffer_load_dword v41, v4, s[68:71], s36 offen
    s_add_u32 s36, s23, 93184
    buffer_load_dword v42, v4, s[68:71], s36 offen
    s_add_u32 s36, s23, 96768
    buffer_load_dword v43, v4, s[68:71], s36 offen
    s_add_u32 s36, s23, 100352
    buffer_load_dword v44, v4, s[68:71], s36 offen
    s_add_u32 s36, s23, 103936
    buffer_load_dword v45, v4, s[68:71], s36 offen
    s_add_u32 s36, s23, 107520
    buffer_load_dword v46, v4, s[68:71], s36 offen
    s_add_u32 s36, s23, 111104
    buffer_load_dword v47, v4, s[68:71], s36 offen
    s_waitcnt vmcnt(0)
    v_perm_b32 v192, v17, v16, s34
    v_perm_b32 v193, v19, v18, s34
    v_perm_b32 v194, v21, v20, s34
    v_perm_b32 v195, v23, v22, s34
    v_perm_b32 v196, v25, v24, s34
    v_perm_b32 v197, v27, v26, s34
    v_perm_b32 v198, v29, v28, s34
    v_perm_b32 v199, v31, v30, s34
    v_perm_b32 v200, v33, v32, s34
    v_perm_b32 v201, v35, v34, s34
    v_perm_b32 v202, v37, v36, s34
    v_perm_b32 v203, v39, v38, s34
    v_perm_b32 v204, v41, v40, s34
    v_perm_b32 v205, v43, v42, s34
    v_perm_b32 v206, v45, v44, s34
    v_perm_b32 v207, v47, v46, s34
    v_perm_b32 v224, v17, v16, s35
    v_perm_b32 v225, v19, v18, s35
    v_perm_b32 v226, v21, v20, s35
    v_perm_b32 v227, v23, v22, s35
    v_perm_b32 v228, v25, v24, s35
    v_perm_b32 v229, v27, v26, s35
    v_perm_b32 v230, v29, v28, s35
    v_perm_b32 v231, v31, v30, s35
    v_perm_b32 v232, v33, v32, s35
    v_perm_b32 v233, v35, v34, s35
    v_perm_b32 v234, v37, v36, s35
    v_perm_b32 v235, v39, v38, s35
    v_perm_b32 v236, v41, v40, s35
    v_perm_b32 v237, v43, v42, s35
    v_perm_b32 v238, v45, v44, s35
    v_perm_b32 v239, v47, v46, s35
    s_add_u32 s36, s23, 114688
    buffer_load_dword v16, v4, s[68:71], s36 offen
    s_add_u32 s36, s23, 118272
    buffer_load_dword v17, v4, s[68:71], s36 offen
    s_add_u32 s36, s23, 121856
    buffer_load_dword v18, v4, s[68:71], s36 offen
    s_add_u32 s36, s23, 125440
    buffer_load_dword v19, v4, s[68:71], s36 offen
    s_add_u32 s36, s23, 129024
    buffer_load_dword v20, v4, s[68:71], s36 offen
    s_add_u32 s36, s23, 132608
    buffer_load_dword v21, v4, s[68:71], s36 offen
    s_add_u32 s36, s23, 136192
    buffer_load_dword v22, v4, s[68:71], s36 offen
    s_add_u32 s36, s23, 139776
    buffer_load_dword v23, v4, s[68:71], s36 offen
    s_add_u32 s36, s23, 143360
    buffer_load_dword v24, v4, s[68:71], s36 offen
    s_add_u32 s36, s23, 146944
    buffer_load_dword v25, v4, s[68:71], s36 offen
    s_add_u32 s36, s23, 150528
    buffer_load_dword v26, v4, s[68:71], s36 offen
    s_add_u32 s36, s23, 154112
    buffer_load_dword v27, v4, s[68:71], s36 offen
    s_add_u32 s36, s23, 157696
    buffer_load_dword v28, v4, s[68:71], s36 offen
    s_add_u32 s36, s23, 161280
    buffer_load_dword v29, v4, s[68:71], s36 offen
    s_add_u32 s36, s23, 164864
    buffer_load_dword v30, v4, s[68:71], s36 offen
    s_add_u32 s36, s23, 168448
    buffer_load_dword v31, v4, s[68:71], s36 offen
    s_add_u32 s36, s23, 172032
    buffer_load_dword v32, v4, s[68:71], s36 offen
    s_add_u32 s36, s23, 175616
    buffer_load_dword v33, v4, s[68:71], s36 offen
    s_add_u32 s36, s23, 179200
    buffer_load_dword v34, v4, s[68:71], s36 offen
    s_add_u32 s36, s23, 182784
    buffer_load_dword v35, v4, s[68:71], s36 offen
    s_add_u32 s36, s23, 186368
    buffer_load_dword v36, v4, s[68:71], s36 offen
    s_add_u32 s36, s23, 189952
    buffer_load_dword v37, v4, s[68:71], s36 offen
    s_add_u32 s36, s23, 193536
    buffer_load_dword v38, v4, s[68:71], s36 offen
    s_add_u32 s36, s23, 197120
    buffer_load_dword v39, v4, s[68:71], s36 offen
    s_add_u32 s36, s23, 200704
    buffer_load_dword v40, v4, s[68:71], s36 offen
    s_add_u32 s36, s23, 204288
    buffer_load_dword v41, v4, s[68:71], s36 offen
    s_add_u32 s36, s23, 207872
    buffer_load_dword v42, v4, s[68:71], s36 offen
    s_add_u32 s36, s23, 211456
    buffer_load_dword v43, v4, s[68:71], s36 offen
    s_add_u32 s36, s23, 215040
    buffer_load_dword v44, v4, s[68:71], s36 offen
    s_add_u32 s36, s23, 218624
    buffer_load_dword v45, v4, s[68:71], s36 offen
    s_add_u32 s36, s23, 222208
    buffer_load_dword v46, v4, s[68:71], s36 offen
    s_add_u32 s36, s23, 225792
    buffer_load_dword v47, v4, s[68:71], s36 offen
    s_waitcnt vmcnt(0)
    v_perm_b32 v208, v17, v16, s34
    v_perm_b32 v209, v19, v18, s34
    v_perm_b32 v210, v21, v20, s34
    v_perm_b32 v211, v23, v22, s34
    v_perm_b32 v212, v25, v24, s34
    v_perm_b32 v213, v27, v26, s34
    v_perm_b32 v214, v29, v28, s34
    v_perm_b32 v215, v31, v30, s34
    v_perm_b32 v216, v33, v32, s34
    v_perm_b32 v217, v35, v34, s34
    v_perm_b32 v218, v37, v36, s34
    v_perm_b32 v219, v39, v38, s34
    v_perm_b32 v220, v41, v40, s34
    v_perm_b32 v221, v43, v42, s34
    v_perm_b32 v222, v45, v44, s34
    v_perm_b32 v223, v47, v46, s34
    v_perm_b32 v240, v17, v16, s35
    v_perm_b32 v241, v19, v18, s35
    v_perm_b32 v242, v21, v20, s35
    v_perm_b32 v243, v23, v22, s35
    v_perm_b32 v244, v25, v24, s35
    v_perm_b32 v245, v27, v26, s35
    v_perm_b32 v246, v29, v28, s35
    v_perm_b32 v247, v31, v30, s35
    v_perm_b32 v248, v33, v32, s35
    v_perm_b32 v249, v35, v34, s35
    v_perm_b32 v250, v37, v36, s35
    v_perm_b32 v251, v39, v38, s35
    v_perm_b32 v252, v41, v40, s35
    v_perm_b32 v253, v43, v42, s35
    v_perm_b32 v254, v45, v44, s35
    v_perm_b32 v255, v47, v46, s35
    v_lshrrev_b32 v3, 3, v0
    v_mul_u32_u24 v4, 57344, v3
    v_and_b32 v3, 7, v0
    v_lshl_add_u32 v4, v3, 2, v4
    s_lshl_b32 s37, s20, 5
    s_add_u32 s36, s37, 0
    buffer_load_dword v16, v4, s[76:79], s36 offen
    s_add_u32 s36, s37, 1024
    buffer_load_dword v17, v4, s[76:79], s36 offen
    s_add_u32 s36, s37, 2048
    buffer_load_dword v18, v4, s[76:79], s36 offen
    s_add_u32 s36, s37, 3072
    buffer_load_dword v19, v4, s[76:79], s36 offen
    s_add_u32 s36, s37, 4096
    buffer_load_dword v20, v4, s[76:79], s36 offen
    s_add_u32 s36, s37, 5120
    buffer_load_dword v21, v4, s[76:79], s36 offen
    s_add_u32 s36, s37, 6144
    buffer_load_dword v22, v4, s[76:79], s36 offen
    s_add_u32 s36, s37, 7168
    buffer_load_dword v23, v4, s[76:79], s36 offen
    s_add_u32 s36, s37, 8192
    buffer_load_dword v24, v4, s[76:79], s36 offen
    s_add_u32 s36, s37, 9216
    buffer_load_dword v25, v4, s[76:79], s36 offen
    s_add_u32 s36, s37, 10240
    buffer_load_dword v26, v4, s[76:79], s36 offen
    s_add_u32 s36, s37, 11264
    buffer_load_dword v27, v4, s[76:79], s36 offen
    s_add_u32 s36, s37, 12288
    buffer_load_dword v28, v4, s[76:79], s36 offen
    s_add_u32 s36, s37, 13312
    buffer_load_dword v29, v4, s[76:79], s36 offen
    s_add_u32 s36, s37, 14336
    buffer_load_dword v30, v4, s[76:79], s36 offen
    s_add_u32 s36, s37, 15360
    buffer_load_dword v31, v4, s[76:79], s36 offen
    s_add_u32 s36, s37, 16384
    buffer_load_dword v32, v4, s[76:79], s36 offen
    s_add_u32 s36, s37, 17408
    buffer_load_dword v33, v4, s[76:79], s36 offen
    s_add_u32 s36, s37, 18432
    buffer_load_dword v34, v4, s[76:79], s36 offen
    s_add_u32 s36, s37, 19456
    buffer_load_dword v35, v4, s[76:79], s36 offen
    s_add_u32 s36, s37, 20480
    buffer_load_dword v36, v4, s[76:79], s36 offen
    s_add_u32 s36, s37, 21504
    buffer_load_dword v37, v4, s[76:79], s36 offen
    s_add_u32 s36, s37, 22528
    buffer_load_dword v38, v4, s[76:79], s36 offen
    s_add_u32 s36, s37, 23552
    buffer_load_dword v39, v4, s[76:79], s36 offen
    s_add_u32 s36, s37, 24576
    buffer_load_dword v40, v4, s[76:79], s36 offen
    s_add_u32 s36, s37, 25600
    buffer_load_dword v41, v4, s[76:79], s36 offen
    s_add_u32 s36, s37, 26624
    buffer_load_dword v42, v4, s[76:79], s36 offen
    s_add_u32 s36, s37, 27648
    buffer_load_dword v43, v4, s[76:79], s36 offen
    s_waitcnt vmcnt(0)
    v_perm_b32 v64, v17, v16, s34
    v_perm_b32 v65, v19, v18, s34
    v_perm_b32 v66, v21, v20, s34
    v_perm_b32 v67, v23, v22, s34
    v_perm_b32 v68, v25, v24, s34
    v_perm_b32 v69, v27, v26, s34
    v_perm_b32 v70, v29, v28, s34
    v_perm_b32 v71, v31, v30, s34
    v_perm_b32 v72, v33, v32, s34
    v_perm_b32 v73, v35, v34, s34
    v_perm_b32 v74, v37, v36, s34
    v_perm_b32 v75, v39, v38, s34
    v_perm_b32 v76, v41, v40, s34
    v_perm_b32 v77, v43, v42, s34
    v_perm_b32 v92, v17, v16, s35
    v_perm_b32 v93, v19, v18, s35
    v_perm_b32 v94, v21, v20, s35
    v_perm_b32 v95, v23, v22, s35
    v_perm_b32 v96, v25, v24, s35
    v_perm_b32 v97, v27, v26, s35
    v_perm_b32 v98, v29, v28, s35
    v_perm_b32 v99, v31, v30, s35
    v_perm_b32 v100, v33, v32, s35
    v_perm_b32 v101, v35, v34, s35
    v_perm_b32 v102, v37, v36, s35
    v_perm_b32 v103, v39, v38, s35
    v_perm_b32 v104, v41, v40, s35
    v_perm_b32 v105, v43, v42, s35
    s_add_u32 s36, s37, 28672
    buffer_load_dword v16, v4, s[76:79], s36 offen
    s_add_u32 s36, s37, 29696
    buffer_load_dword v17, v4, s[76:79], s36 offen
    s_add_u32 s36, s37, 30720
    buffer_load_dword v18, v4, s[76:79], s36 offen
    s_add_u32 s36, s37, 31744
    buffer_load_dword v19, v4, s[76:79], s36 offen
    s_add_u32 s36, s37, 32768
    buffer_load_dword v20, v4, s[76:79], s36 offen
    s_add_u32 s36, s37, 33792
    buffer_load_dword v21, v4, s[76:79], s36 offen
    s_add_u32 s36, s37, 34816
    buffer_load_dword v22, v4, s[76:79], s36 offen
    s_add_u32 s36, s37, 35840
    buffer_load_dword v23, v4, s[76:79], s36 offen
    s_add_u32 s36, s37, 36864
    buffer_load_dword v24, v4, s[76:79], s36 offen
    s_add_u32 s36, s37, 37888
    buffer_load_dword v25, v4, s[76:79], s36 offen
    s_add_u32 s36, s37, 38912
    buffer_load_dword v26, v4, s[76:79], s36 offen
    s_add_u32 s36, s37, 39936
    buffer_load_dword v27, v4, s[76:79], s36 offen
    s_add_u32 s36, s37, 40960
    buffer_load_dword v28, v4, s[76:79], s36 offen
    s_add_u32 s36, s37, 41984
    buffer_load_dword v29, v4, s[76:79], s36 offen
    s_add_u32 s36, s37, 43008
    buffer_load_dword v30, v4, s[76:79], s36 offen
    s_add_u32 s36, s37, 44032
    buffer_load_dword v31, v4, s[76:79], s36 offen
    s_add_u32 s36, s37, 45056
    buffer_load_dword v32, v4, s[76:79], s36 offen
    s_add_u32 s36, s37, 46080
    buffer_load_dword v33, v4, s[76:79], s36 offen
    s_add_u32 s36, s37, 47104
    buffer_load_dword v34, v4, s[76:79], s36 offen
    s_add_u32 s36, s37, 48128
    buffer_load_dword v35, v4, s[76:79], s36 offen
    s_add_u32 s36, s37, 49152
    buffer_load_dword v36, v4, s[76:79], s36 offen
    s_add_u32 s36, s37, 50176
    buffer_load_dword v37, v4, s[76:79], s36 offen
    s_add_u32 s36, s37, 51200
    buffer_load_dword v38, v4, s[76:79], s36 offen
    s_add_u32 s36, s37, 52224
    buffer_load_dword v39, v4, s[76:79], s36 offen
    s_add_u32 s36, s37, 53248
    buffer_load_dword v40, v4, s[76:79], s36 offen
    s_add_u32 s36, s37, 54272
    buffer_load_dword v41, v4, s[76:79], s36 offen
    s_add_u32 s36, s37, 55296
    buffer_load_dword v42, v4, s[76:79], s36 offen
    s_add_u32 s36, s37, 56320
    buffer_load_dword v43, v4, s[76:79], s36 offen
    s_waitcnt vmcnt(0)
    v_perm_b32 v78, v17, v16, s34
    v_perm_b32 v79, v19, v18, s34
    v_perm_b32 v80, v21, v20, s34
    v_perm_b32 v81, v23, v22, s34
    v_perm_b32 v82, v25, v24, s34
    v_perm_b32 v83, v27, v26, s34
    v_perm_b32 v84, v29, v28, s34
    v_perm_b32 v85, v31, v30, s34
    v_perm_b32 v86, v33, v32, s34
    v_perm_b32 v87, v35, v34, s34
    v_perm_b32 v88, v37, v36, s34
    v_perm_b32 v89, v39, v38, s34
    v_perm_b32 v90, v41, v40, s34
    v_perm_b32 v91, v43, v42, s34
    v_perm_b32 v106, v17, v16, s35
    v_perm_b32 v107, v19, v18, s35
    v_perm_b32 v108, v21, v20, s35
    v_perm_b32 v109, v23, v22, s35
    v_perm_b32 v110, v25, v24, s35
    v_perm_b32 v111, v27, v26, s35
    v_perm_b32 v112, v29, v28, s35
    v_perm_b32 v113, v31, v30, s35
    v_perm_b32 v114, v33, v32, s35
    v_perm_b32 v115, v35, v34, s35
    v_perm_b32 v116, v37, v36, s35
    v_perm_b32 v117, v39, v38, s35
    v_perm_b32 v118, v41, v40, s35
    v_perm_b32 v119, v43, v42, s35
    s_mov_b32 s42, 0xffff0000
    s_mov_b32 s24, 0
    s_mov_b64 s[28:29], 0
    v_mov_b32 v12, 0x40000000
    v_mov_b32 v13, 0
    v_lshlrev_b32 v3, 4, v0
L_M06_rp:
    s_mov_b32 s36, 0x19a000
    buffer_load_dwordx4 v[40:43], v3, s[8:11], s36 offen sc1
    s_add_u32 s32, s32, 1
    v_mov_b32 v5, 0
    s_waitcnt vmcnt(0)
    v_max3_u32 v5, v5, v40, v41
    v_max3_u32 v5, v5, v42, v43
    s_cmp_gt_u32 s32, 200000
    s_cbranch_scc1 L_M06_rp_ok
    v_cmp_eq_u32 vcc, -1, v5
    s_cbranch_vccz L_M06_rp_ok
    s_sleep 32
    s_branch L_M06_rp
L_M06_rp_ok:
    v_add_f32 v40, v40, v41
    v_add_f32 v42, v42, v43
    v_add_f32 v40, v40, v42
    v_cvt_pk_bf16_f32 v5, v40, v40
    v_lshlrev_b32 v40, 16, v5
    v_ashrrev_i32 v5, 31, v40
    v_or_b32 v5, 0x80000000, v5
    v_xor_b32 v5, v5, v40
    v_and_b32 v5, 0xffff0000, v5
    v_sub_u32 v6, 511, v0
    v_or_b32 v126, v5, v6
    v_lshlrev_b32 v3, 4, v0
L_M01_rp:
    s_mov_b32 s36, 0x195000
    buffer_load_dwordx4 v[20:23], v3, s[8:11], s36 offen sc1
    s_mov_b32 s36, 0x196000
    buffer_load_dwordx4 v[24:27], v3, s[8:11], s36 offen sc1
    s_mov_b32 s36, 0x197000
    buffer_load_dwordx4 v[28:31], v3, s[8:11], s36 offen sc1
    s_mov_b32 s36, 0x198000
    buffer_load_dwordx4 v[32:35], v3, s[8:11], s36 offen sc1
    s_mov_b32 s36, 0x199000
    buffer_load_dwordx4 v[36:39], v3, s[8:11], s36 offen sc1
    s_add_u32 s32, s32, 1
    v_mov_b32 v5, 0
    s_waitcnt vmcnt(0)
    v_max3_u32 v5, v5, v20, v21
    v_max3_u32 v5, v5, v22, v23
    v_max3_u32 v5, v5, v24, v25
    v_max3_u32 v5, v5, v26, v27
    v_max3_u32 v5, v5, v28, v29
    v_max3_u32 v5, v5, v30, v31
    v_max3_u32 v5, v5, v32, v33
    v_max3_u32 v5, v5, v34, v35
    v_max3_u32 v5, v5, v36, v37
    v_max3_u32 v5, v5, v38, v39
    s_cmp_gt_u32 s32, 200000
    s_cbranch_scc1 L_M01_rp_ok
    v_cmp_eq_u32 vcc, -1, v5
    s_cbranch_vccz L_M01_rp_ok
    s_sleep 8
    s_branch L_M01_rp
L_M01_rp_ok:
    v_add_f32 v20, v20, v21
    v_add_f32 v22, v22, v23
    v_add_f32 v20, v20, v22
    v_cvt_pk_bf16_f32 v5, v20, v20
    v_lshlrev_b32 v20, 16, v5
    v_ashrrev_i32 v5, 31, v20
    v_or_b32 v5, 0x80000000, v5
    v_xor_b32 v5, v5, v20
    v_and_b32 v5, 0xffff0000, v5
    v_sub_u32 v6, 1791, v0
    v_or_b32 v121, v5, v6
    v_add_f32 v24, v24, v25
    v_add_f32 v26, v26, v27
    v_add_f32 v24, v24, v26
    v_cvt_pk_bf16_f32 v5, v24, v24
    v_lshlrev_b32 v24, 16, v5
    v_ashrrev_i32 v5, 31, v24
    v_or_b32 v5, 0x80000000, v5
    v_xor_b32 v5, v5, v24
    v_and_b32 v5, 0xffff0000, v5
    v_sub_u32 v6, 1535, v0
    v_or_b32 v122, v5, v6
    v_add_f32 v28, v28, v29
    v_add_f32 v30, v30, v31
    v_add_f32 v28, v28, v30
    v_cvt_pk_bf16_f32 v5, v28, v28
    v_lshlrev_b32 v28, 16, v5
    v_ashrrev_i32 v5, 31, v28
    v_or_b32 v5, 0x80000000, v5
    v_xor_b32 v5, v5, v28
    v_and_b32 v5, 0xffff0000, v5
    v_sub_u32 v6, 1279, v0
    v_or_b32 v123, v5, v6
    v_add_f32 v32, v32, v33
    v_add_f32 v34, v34, v35
    v_add_f32 v32, v32, v34
    v_cvt_pk_bf16_f32 v5, v32, v32
    v_lshlrev_b32 v32, 16, v5
    v_ashrrev_i32 v5, 31, v32
    v_or_b32 v5, 0x80000000, v5
    v_xor_b32 v5, v5, v32
    v_and_b32 v5, 0xffff0000, v5
    v_sub_u32 v6, 1023, v0
    v_or_b32 v124, v5, v6
    v_add_f32 v36, v36, v37
    v_add_f32 v38, v38, v39
    v_add_f32 v36, v36, v38
    v_cvt_pk_bf16_f32 v5, v36, v36
    v_lshlrev_b32 v36, 16, v5
    v_ashrrev_i32 v5, 31, v36
    v_or_b32 v5, 0x80000000, v5
    v_xor_b32 v5, v5, v36
    v_and_b32 v5, 0xffff0000, v5
    v_sub_u32 v6, 767, v0
    v_or_b32 v125, v5, v6
    v_max_u32 v5, v120, v121
    v_min_u32 v6, v120, v121
    v_med3_u32 v6, v5, v6, v122
    v_max_u32 v5, v5, v122
    v_med3_u32 v6, v5, v6, v123
    v_max_u32 v5, v5, v123
    v_med3_u32 v6, v5, v6, v124
    v_max_u32 v5, v5, v124
    v_med3_u32 v6, v5, v6, v125
    v_max_u32 v5, v5, v125
    v_med3_u32 v6, v5, v6, v126
    v_max_u32 v5, v5, v126
    v_mov_b32 v120, v5
    v_mov_b32 v121, v6
    s_mov_b32 s25, 32
L_M_round:
    v_lshlrev_b32 v3, 4, v0
    v_cmp_gt_u32 s[74:75], s25, v0
L_M7_rp:
    s_mov_b32 s36, 0x19b000
    buffer_load_dwordx4 v[44:47], v3, s[8:11], s36 offen sc1
    s_add_u32 s32, s32, 1
    v_mov_b32 v5, 0
    s_waitcnt vmcnt(0)
    v_max3_u32 v5, v5, v44, v45
    v_max3_u32 v5, v5, v46, v47
    v_cndmask_b32 v5, 0, v5, s[74:75]
    s_cmp_gt_u32 s32, 200000
    s_cbranch_scc1 L_M7_rp_ok
    v_cmp_eq_u32 vcc, -1, v5
    s_cbranch_vccnz L_M7_rp
L_M7_rp_ok:
    v_add_f32 v44, v44, v45
    v_add_f32 v46, v46, v47
    v_add_f32 v44, v44, v46
    v_cvt_pk_bf16_f32 v5, v44, v44
    v_lshlrev_b32 v44, 16, v5
    v_ashrrev_i32 v5, 31, v44
    v_or_b32 v5, 0x80000000, v5
    v_xor_b32 v5, v5, v44
    v_and_b32 v5, 0xffff0000, v5
    v_sub_u32 v6, 255, v0
    v_or_b32 v127, v5, v6
    v_cndmask_b32 v127, 0, v127, s[74:75]
    v_max_u32 v5, v120, v127
    v_med3_u32 v6, v120, v121, v127
    s_nop 0
    v_mov_b32_dpp v7, v5 quad_perm:[1,0,3,2] row_mask:0xf bank_mask:0xf
    v_mov_b32_dpp v8, v6 quad_perm:[1,0,3,2] row_mask:0xf bank_mask:0xf
    v_min_u32 v9, v5, v7
    v_max_u32 v5, v5, v7
    v_max3_u32 v6, v6, v8, v9
    s_nop 0
    v_mov_b32_dpp v7, v5 quad_perm:[2,3,0,1] row_mask:0xf bank_mask:0xf
    v_mov_b32_dpp v8, v6 quad_perm:[2,3,0,1] row_mask:0xf bank_mask:0xf
    v_min_u32 v9, v5, v7
    v_max_u32 v5, v5, v7
    v_max3_u32 v6, v6, v8, v9
    s_nop 0
    v_mov_b32_dpp v7, v5 row_half_mirror row_mask:0xf bank_mask:0xf
    v_mov_b32_dpp v8, v6 row_half_mirror row_mask:0xf bank_mask:0xf
    v_min_u32 v9, v5, v7
    v_max_u32 v5, v5, v7
    v_max3_u32 v6, v6, v8, v9
    s_nop 0
    v_mov_b32_dpp v7, v5 row_mirror row_mask:0xf bank_mask:0xf
    v_mov_b32_dpp v8, v6 row_mirror row_mask:0xf bank_mask:0xf
    v_min_u32 v9, v5, v7
    v_max_u32 v5, v5, v7
    v_max3_u32 v6, v6, v8, v9
    v_lshrrev_b32 v9, 4, v0
    v_lshlrev_b32 v9, 3, v9
    s_barrier
    ds_write2_b32 v9, v5, v6 offset0:0 offset1:1
    v_and_b32 v9, 15, v0
    v_lshlrev_b32 v9, 3, v9
    s_waitcnt lgkmcnt(0)
    s_barrier
    ds_read2_b32 v[10:11], v9 offset0:0 offset1:1
    s_waitcnt lgkmcnt(0)
    v_mov_b32 v5, v10
    v_mov_b32 v6, v11
    s_nop 0
    v_mov_b32_dpp v7, v5 quad_perm:[1,0,3,2] row_mask:0xf bank_mask:0xf
    v_mov_b32_dpp v8, v6 quad_perm:[1,0,3,2] row_mask:0xf bank_mask:0xf
    v_min_u32 v9, v5, v7
    v_max_u32 v5, v5, v7
    v_max3_u32 v6, v6, v8, v9
    s_nop 0
    v_mov_b32_dpp v7, v5 quad_perm:[2,3,0,1] row_mask:0xf bank_mask:0xf
    v_mov_b32_dpp v8, v6 quad_perm:[2,3,0,1] row_mask:0xf bank_mask:0xf
    v_min_u32 v9, v5, v7
    v_max_u32 v5, v5, v7
    v_max3_u32 v6, v6, v8, v9
    s_nop 0
    v_mov_b32_dpp v7, v5 row_half_mirror row_mask:0xf bank_mask:0xf
    v_mov_b32_dpp v8, v6 row_half_mirror row_mask:0xf bank_mask:0xf
    v_min_u32 v9, v5, v7
    v_max_u32 v5, v5, v7
    v_max3_u32 v6, v6, v8, v9
    s_nop 0
    v_mov_b32_dpp v7, v5 row_mirror row_mask:0xf bank_mask:0xf
    v_mov_b32_dpp v8, v6 row_mirror row_mask:0xf bank_mask:0xf
    v_min_u32 v9, v5, v7
    v_max_u32 v5, v5, v7
    v_max3_u32 v6, v6, v8, v9
    v_readfirstlane_b32 s26, v5
    v_readfirstlane_b32 s27, v6
    s_nop 3
    s_cmp_eq_u64 s[26:27], s[28:29]
    s_cbranch_scc1 L_M_next
    s_mov_b64 s[28:29], s[26:27]
    buffer_store_dword v13, v12, s[60:63], 0 offen sc1
    s_and_b32 s36, s26, 0x7ff
    s_sub_u32 s30, 2047, s36
    s_and_b32 s36, s26, 0xffff0000
    s_xor_b32 s37, s36, 0x80000000
    s_xor_b32 s40, s36, 0xffff0000
    s_bitcmp1_b32 s36, 31
    s_cselect_b32 s40, s37, s40
    s_and_b32 s36, s27, 0x7ff
    s_sub_u32 s31, 2047, s36
    s_and_b32 s36, s27, 0xffff0000
    s_xor_b32 s37, s36, 0x80000000
    s_xor_b32 s41, s36, 0xffff0000
    s_bitcmp1_b32 s36, 31
    s_cselect_b32 s41, s37, s41
    v_mov_b32 v8, 0
L_M_rows:
    s_lshl_b32 s36, s30, 4
    s_add_u32 s36, s36, 0x1b8000
    buffer_load_dwordx4 v[16:19], v8, s[8:11], s36 offen sc1
    s_lshl_b32 s36, s31, 4
    s_add_u32 s36, s36, 0x1b8000
    buffer_load_dwordx4 v[20:23], v8, s[8:11], s36 offen sc1
    s_add_u32 s32, s32, 1
    s_cmp_gt_u32 s32, 200000
    s_waitcnt vmcnt(0)
    v_or3_b32 v5, v16, v17, v18
    v_or3_b32 v5, v5, v19, v20
    v_or3_b32 v5, v5, v21, v22
    v_or_b32 v5, v5, v23
    s_cbranch_scc1 L_M_rows_ok
    v_cmp_ne_u32 vcc, 0, v5
    s_cbranch_vccnz L_M_rows
L_M_rows_ok:
    v_bfe_u32 v9, v0, 6, 1
    v_cmp_ne_u32 vcc, 0, v9
    v_mov_b32 v5, s30
    v_mov_b32 v6, s31
    v_cndmask_b32 v7, v5, v6, vcc
    v_lshlrev_b32 v7, 10, v7
    v_and_b32 v8, 63, v0
    v_lshl_add_u32 v7, v8, 4, v7
    s_mov_b32 s37, 0x600000
    buffer_load_dwordx4 v[16:19], v7, s[8:11], s37 offen sc1
    v_bfe_u32 v9, v0, 3, 1
    v_cmp_ne_u32 vcc, 0, v9
    s_nop 1
    v_cndmask_b32 v12, v5, v6, vcc
    v_mov_b32 v5, s40
    v_mov_b32 v6, s41
    v_cndmask_b32 v11, v5, v6, vcc
    v_lshlrev_b32 v12, 10, v12
    v_and_b32 v3, 7, v0
    v_lshl_add_u32 v12, v3, 2, v12
    s_lshl_b32 s36, s20, 5
    v_add_u32 v12, s36, v12
    v_mov_b32 v7, 0x40000000
    v_cmp_lt_u32 vcc, 15, v0
    s_nop 1
    v_cndmask_b32 v12, v12, v7, vcc
    s_mov_b32 s36, 0x400000
    buffer_load_dword v14, v12, s[8:11], s36 offen sc1
    buffer_load_dword v15, v12, s[8:11], s37 offen sc1
    v_and_b32 v8, 127, v0
    v_lshlrev_b32 v8, 4, v8
    s_waitcnt vmcnt(2)
    ds_write_b128 v8, v[16:19] offset:4096
    s_waitcnt lgkmcnt(0)
    s_barrier
    v_mov_b64 v[48:49], 0
    v_mov_b64 v[50:51], 0
    v_mov_b64 v[52:53], 0
    v_mov_b64 v[54:55], 0
    v_lshlrev_b32 v8, 7, v1
    ds_read_b128 v[16:19], v8 offset:4096
    ds_read_b128 v[20:23], v8 offset:4112
    ds_read_b128 v[24:27], v8 offset:4128
    ds_read_b128 v[28:31], v8 offset:4144
    ds_read_b128 v[32:35], v8 offset:5120
    ds_read_b128 v[36:39], v8 offset:5136
    ds_read_b128 v[40:43], v8 offset:5152
    ds_read_b128 v[44:47], v8 offset:5168
    s_waitcnt lgkmcnt(0)
    v_dot2_f32_bf16 v48, v16, v128, v48
    v_dot2_f32_bf16 v49, v16, v160, v49
    v_dot2_f32_bf16 v50, v32, v128, v50
    v_dot2_f32_bf16 v51, v32, v160, v51
    v_dot2_f32_bf16 v52, v16, v192, v52
    v_dot2_f32_bf16 v53, v16, v224, v53
    v_dot2_f32_bf16 v54, v32, v192, v54
    v_dot2_f32_bf16 v55, v32, v224, v55
    v_dot2_f32_bf16 v48, v17, v129, v48
    v_dot2_f32_bf16 v49, v17, v161, v49
    v_dot2_f32_bf16 v50, v33, v129, v50
    v_dot2_f32_bf16 v51, v33, v161, v51
    v_dot2_f32_bf16 v52, v17, v193, v52
    v_dot2_f32_bf16 v53, v17, v225, v53
    v_dot2_f32_bf16 v54, v33, v193, v54
    v_dot2_f32_bf16 v55, v33, v225, v55
    v_dot2_f32_bf16 v48, v18, v130, v48
    v_dot2_f32_bf16 v49, v18, v162, v49
    v_dot2_f32_bf16 v50, v34, v130, v50
    v_dot2_f32_bf16 v51, v34, v162, v51
    v_dot2_f32_bf16 v52, v18, v194, v52
    v_dot2_f32_bf16 v53, v18, v226, v53
    v_dot2_f32_bf16 v54, v34, v194, v54
    v_dot2_f32_bf16 v55, v34, v226, v55
    v_dot2_f32_bf16 v48, v19, v131, v48
    v_dot2_f32_bf16 v49, v19, v163, v49
    v_dot2_f32_bf16 v50, v35, v131, v50
    v_dot2_f32_bf16 v51, v35, v163, v51
    v_dot2_f32_bf16 v52, v19, v195, v52
    v_dot2_f32_bf16 v53, v19, v227, v53
    v_dot2_f32_bf16 v54, v35, v195, v54
    v_dot2_f32_bf16 v55, v35, v227, v55
    v_dot2_f32_bf16 v48, v20, v132, v48
    v_dot2_f32_bf16 v49, v20, v164, v49
    v_dot2_f32_bf16 v50, v36, v132, v50
    v_dot2_f32_bf16 v51, v36, v164, v51
    v_dot2_f32_bf16 v52, v20, v196, v52
    v_dot2_f32_bf16 v53, v20, v228, v53
    v_dot2_f32_bf16 v54, v36, v196, v54
    v_dot2_f32_bf16 v55, v36, v228, v55
    v_dot2_f32_bf16 v48, v21, v133, v48
    v_dot2_f32_bf16 v49, v21, v165, v49
    v_dot2_f32_bf16 v50, v37, v133, v50
    v_dot2_f32_bf16 v51, v37, v165, v51
    v_dot2_f32_bf16 v52, v21, v197, v52
    v_dot2_f32_bf16 v53, v21, v229, v53
    v_dot2_f32_bf16 v54, v37, v197, v54
    v_dot2_f32_bf16 v55, v37, v229, v55
    v_dot2_f32_bf16 v48, v22, v134, v48
    v_dot2_f32_bf16 v49, v22, v166, v49
    v_dot2_f32_bf16 v50, v38, v134, v50
    v_dot2_f32_bf16 v51, v38, v166, v51
    v_dot2_f32_bf16 v52, v22, v198, v52
    v_dot2_f32_bf16 v53, v22, v230, v53
    v_dot2_f32_bf16 v54, v38, v198, v54
    v_dot2_f32_bf16 v55, v38, v230, v55
    v_dot2_f32_bf16 v48, v23, v135, v48
    v_dot2_f32_bf16 v49, v23, v167, v49
    v_dot2_f32_bf16 v50, v39, v135, v50
    v_dot2_f32_bf16 v51, v39, v167, v51
    v_dot2_f32_bf16 v52, v23, v199, v52
    v_dot2_f32_bf16 v53, v23, v231, v53
    v_dot2_f32_bf16 v54, v39, v199, v54
    v_dot2_f32_bf16 v55, v39, v231, v55
    v_dot2_f32_bf16 v48, v24, v136, v48
    v_dot2_f32_bf16 v49, v24, v168, v49
    v_dot2_f32_bf16 v50, v40, v136, v50
    v_dot2_f32_bf16 v51, v40, v168, v51
    v_dot2_f32_bf16 v52, v24, v200, v52
    v_dot2_f32_bf16 v53, v24, v232, v53
    v_dot2_f32_bf16 v54, v40, v200, v54
    v_dot2_f32_bf16 v55, v40, v232, v55
    v_dot2_f32_bf16 v48, v25, v137, v48
    v_dot2_f32_bf16 v49, v25, v169, v49
    v_dot2_f32_bf16 v50, v41, v137, v50
    v_dot2_f32_bf16 v51, v41, v169, v51
    v_dot2_f32_bf16 v52, v25, v201, v52
    v_dot2_f32_bf16 v53, v25, v233, v53
    v_dot2_f32_bf16 v54, v41, v201, v54
    v_dot2_f32_bf16 v55, v41, v233, v55
    v_dot2_f32_bf16 v48, v26, v138, v48
    v_dot2_f32_bf16 v49, v26, v170, v49
    v_dot2_f32_bf16 v50, v42, v138, v50
    v_dot2_f32_bf16 v51, v42, v170, v51
    v_dot2_f32_bf16 v52, v26, v202, v52
    v_dot2_f32_bf16 v53, v26, v234, v53
    v_dot2_f32_bf16 v54, v42, v202, v54
    v_dot2_f32_bf16 v55, v42, v234, v55
    v_dot2_f32_bf16 v48, v27, v139, v48
    v_dot2_f32_bf16 v49, v27, v171, v49
    v_dot2_f32_bf16 v50, v43, v139, v50
    v_dot2_f32_bf16 v51, v43, v171, v51
    v_dot2_f32_bf16 v52, v27, v203, v52
    v_dot2_f32_bf16 v53, v27, v235, v53
    v_dot2_f32_bf16 v54, v43, v203, v54
    v_dot2_f32_bf16 v55, v43, v235, v55
    v_dot2_f32_bf16 v48, v28, v140, v48
    v_dot2_f32_bf16 v49, v28, v172, v49
    v_dot2_f32_bf16 v50, v44, v140, v50
    v_dot2_f32_bf16 v51, v44, v172, v51
    v_dot2_f32_bf16 v52, v28, v204, v52
    v_dot2_f32_bf16 v53, v28, v236, v53
    v_dot2_f32_bf16 v54, v44, v204, v54
    v_dot2_f32_bf16 v55, v44, v236, v55
    v_dot2_f32_bf16 v48, v29, v141, v48
    v_dot2_f32_bf16 v49, v29, v173, v49
    v_dot2_f32_bf16 v50, v45, v141, v50
    v_dot2_f32_bf16 v51, v45, v173, v51
    v_dot2_f32_bf16 v52, v29, v205, v52
    v_dot2_f32_bf16 v53, v29, v237, v53
    v_dot2_f32_bf16 v54, v45, v205, v54
    v_dot2_f32_bf16 v55, v45, v237, v55
    v_dot2_f32_bf16 v48, v30, v142, v48
    v_dot2_f32_bf16 v49, v30, v174, v49
    v_dot2_f32_bf16 v50, v46, v142, v50
    v_dot2_f32_bf16 v51, v46, v174, v51
    v_dot2_f32_bf16 v52, v30, v206, v52
    v_dot2_f32_bf16 v53, v30, v238, v53
    v_dot2_f32_bf16 v54, v46, v206, v54
    v_dot2_f32_bf16 v55, v46, v238, v55
    v_dot2_f32_bf16 v48, v31, v143, v48
    v_dot2_f32_bf16 v49, v31, v175, v49
    v_dot2_f32_bf16 v50, v47, v143, v50
    v_dot2_f32_bf16 v51, v47, v175, v51
    v_dot2_f32_bf16 v52, v31, v207, v52
    v_dot2_f32_bf16 v53, v31, v239, v53
    v_dot2_f32_bf16 v54, v47, v207, v54
    v_dot2_f32_bf16 v55, v47, v239, v55
    ds_read_b128 v[16:19], v8 offset:4160
    ds_read_b128 v[20:23], v8 offset:4176
    ds_read_b128 v[24:27], v8 offset:4192
    ds_read_b128 v[28:31], v8 offset:4208
    ds_read_b128 v[32:35], v8 offset:5184
    ds_read_b128 v[36:39], v8 offset:5200
    ds_read_b128 v[40:43], v8 offset:5216
    ds_read_b128 v[44:47], v8 offset:5232
    s_waitcnt lgkmcnt(0)
    v_dot2_f32_bf16 v48, v16, v144, v48
    v_dot2_f32_bf16 v49, v16, v176, v49
    v_dot2_f32_bf16 v50, v32, v144, v50
    v_dot2_f32_bf16 v51, v32, v176, v51
    v_dot2_f32_bf16 v52, v16, v208, v52
    v_dot2_f32_bf16 v53, v16, v240, v53
    v_dot2_f32_bf16 v54, v32, v208, v54
    v_dot2_f32_bf16 v55, v32, v240, v55
    v_dot2_f32_bf16 v48, v17, v145, v48
    v_dot2_f32_bf16 v49, v17, v177, v49
    v_dot2_f32_bf16 v50, v33, v145, v50
    v_dot2_f32_bf16 v51, v33, v177, v51
    v_dot2_f32_bf16 v52, v17, v209, v52
    v_dot2_f32_bf16 v53, v17, v241, v53
    v_dot2_f32_bf16 v54, v33, v209, v54
    v_dot2_f32_bf16 v55, v33, v241, v55
    v_dot2_f32_bf16 v48, v18, v146, v48
    v_dot2_f32_bf16 v49, v18, v178, v49
    v_dot2_f32_bf16 v50, v34, v146, v50
    v_dot2_f32_bf16 v51, v34, v178, v51
    v_dot2_f32_bf16 v52, v18, v210, v52
    v_dot2_f32_bf16 v53, v18, v242, v53
    v_dot2_f32_bf16 v54, v34, v210, v54
    v_dot2_f32_bf16 v55, v34, v242, v55
    v_dot2_f32_bf16 v48, v19, v147, v48
    v_dot2_f32_bf16 v49, v19, v179, v49
    v_dot2_f32_bf16 v50, v35, v147, v50
    v_dot2_f32_bf16 v51, v35, v179, v51
    v_dot2_f32_bf16 v52, v19, v211, v52
    v_dot2_f32_bf16 v53, v19, v243, v53
    v_dot2_f32_bf16 v54, v35, v211, v54
    v_dot2_f32_bf16 v55, v35, v243, v55
    v_dot2_f32_bf16 v48, v20, v148, v48
    v_dot2_f32_bf16 v49, v20, v180, v49
    v_dot2_f32_bf16 v50, v36, v148, v50
    v_dot2_f32_bf16 v51, v36, v180, v51
    v_dot2_f32_bf16 v52, v20, v212, v52
    v_dot2_f32_bf16 v53, v20, v244, v53
    v_dot2_f32_bf16 v54, v36, v212, v54
    v_dot2_f32_bf16 v55, v36, v244, v55
    v_dot2_f32_bf16 v48, v21, v149, v48
    v_dot2_f32_bf16 v49, v21, v181, v49
    v_dot2_f32_bf16 v50, v37, v149, v50
    v_dot2_f32_bf16 v51, v37, v181, v51
    v_dot2_f32_bf16 v52, v21, v213, v52
    v_dot2_f32_bf16 v53, v21, v245, v53
    v_dot2_f32_bf16 v54, v37, v213, v54
    v_dot2_f32_bf16 v55, v37, v245, v55
    v_dot2_f32_bf16 v48, v22, v150, v48
    v_dot2_f32_bf16 v49, v22, v182, v49
    v_dot2_f32_bf16 v50, v38, v150, v50
    v_dot2_f32_bf16 v51, v38, v182, v51
    v_dot2_f32_bf16 v52, v22, v214, v52
    v_dot2_f32_bf16 v53, v22, v246, v53
    v_dot2_f32_bf16 v54, v38, v214, v54
    v_dot2_f32_bf16 v55, v38, v246, v55
    v_dot2_f32_bf16 v48, v23, v151, v48
    v_dot2_f32_bf16 v49, v23, v183, v49
    v_dot2_f32_bf16 v50, v39, v151, v50
    v_dot2_f32_bf16 v51, v39, v183, v51
    v_dot2_f32_bf16 v52, v23, v215, v52
    v_dot2_f32_bf16 v53, v23, v247, v53
    v_dot2_f32_bf16 v54, v39, v215, v54
    v_dot2_f32_bf16 v55, v39, v247, v55
    v_dot2_f32_bf16 v48, v24, v152, v48
    v_dot2_f32_bf16 v49, v24, v184, v49
    v_dot2_f32_bf16 v50, v40, v152, v50
    v_dot2_f32_bf16 v51, v40, v184, v51
    v_dot2_f32_bf16 v52, v24, v216, v52
    v_dot2_f32_bf16 v53, v24, v248, v53
    v_dot2_f32_bf16 v54, v40, v216, v54
    v_dot2_f32_bf16 v55, v40, v248, v55
    v_dot2_f32_bf16 v48, v25, v153, v48
    v_dot2_f32_bf16 v49, v25, v185, v49
    v_dot2_f32_bf16 v50, v41, v153, v50
    v_dot2_f32_bf16 v51, v41, v185, v51
    v_dot2_f32_bf16 v52, v25, v217, v52
    v_dot2_f32_bf16 v53, v25, v249, v53
    v_dot2_f32_bf16 v54, v41, v217, v54
    v_dot2_f32_bf16 v55, v41, v249, v55
    v_dot2_f32_bf16 v48, v26, v154, v48
    v_dot2_f32_bf16 v49, v26, v186, v49
    v_dot2_f32_bf16 v50, v42, v154, v50
    v_dot2_f32_bf16 v51, v42, v186, v51
    v_dot2_f32_bf16 v52, v26, v218, v52
    v_dot2_f32_bf16 v53, v26, v250, v53
    v_dot2_f32_bf16 v54, v42, v218, v54
    v_dot2_f32_bf16 v55, v42, v250, v55
    v_dot2_f32_bf16 v48, v27, v155, v48
    v_dot2_f32_bf16 v49, v27, v187, v49
    v_dot2_f32_bf16 v50, v43, v155, v50
    v_dot2_f32_bf16 v51, v43, v187, v51
    v_dot2_f32_bf16 v52, v27, v219, v52
    v_dot2_f32_bf16 v53, v27, v251, v53
    v_dot2_f32_bf16 v54, v43, v219, v54
    v_dot2_f32_bf16 v55, v43, v251, v55
    v_dot2_f32_bf16 v48, v28, v156, v48
    v_dot2_f32_bf16 v49, v28, v188, v49
    v_dot2_f32_bf16 v50, v44, v156, v50
    v_dot2_f32_bf16 v51, v44, v188, v51
    v_dot2_f32_bf16 v52, v28, v220, v52
    v_dot2_f32_bf16 v53, v28, v252, v53
    v_dot2_f32_bf16 v54, v44, v220, v54
    v_dot2_f32_bf16 v55, v44, v252, v55
    v_dot2_f32_bf16 v48, v29, v157, v48
    v_dot2_f32_bf16 v49, v29, v189, v49
    v_dot2_f32_bf16 v50, v45, v157, v50
    v_dot2_f32_bf16 v51, v45, v189, v51
    v_dot2_f32_bf16 v52, v29, v221, v52
    v_dot2_f32_bf16 v53, v29, v253, v53
    v_dot2_f32_bf16 v54, v45, v221, v54
    v_dot2_f32_bf16 v55, v45, v253, v55
    v_dot2_f32_bf16 v48, v30, v158, v48
    v_dot2_f32_bf16 v49, v30, v190, v49
    v_dot2_f32_bf16 v50, v46, v158, v50
    v_dot2_f32_bf16 v51, v46, v190, v51
    v_dot2_f32_bf16 v52, v30, v222, v52
    v_dot2_f32_bf16 v53, v30, v254, v53
    v_dot2_f32_bf16 v54, v46, v222, v54
    v_dot2_f32_bf16 v55, v46, v254, v55
    v_dot2_f32_bf16 v48, v31, v159, v48
    v_dot2_f32_bf16 v49, v31, v191, v49
    v_dot2_f32_bf16 v50, v47, v159, v50
    v_dot2_f32_bf16 v51, v47, v191, v51
    v_dot2_f32_bf16 v52, v31, v223, v52
    v_dot2_f32_bf16 v53, v31, v255, v53
    v_dot2_f32_bf16 v54, v47, v223, v54
    v_dot2_f32_bf16 v55, v47, v255, v55
    s_nop 3
    v_lshlrev_b32 v7, 5, v0
    ds_write_b128 v7, v[48:51] offset:8192
    ds_write_b128 v7, v[52:55] offset:8208
    s_waitcnt lgkmcnt(0)
    s_barrier
    v_lshlrev_b32 v7, 5, v2
    v_bfe_u32 v8, v0, 5, 1
    v_lshl_add_u32 v7, v8, 3, v7
    ds_read_b64 v[16:17], v7 offset:8192
    ds_read_b64 v[18:19], v7 offset:8208
    ds_read_b64 v[20:21], v7 offset:9216
    ds_read_b64 v[22:23], v7 offset:9232
    ds_read_b64 v[24:25], v7 offset:10240
    ds_read_b64 v[26:27], v7 offset:10256
    ds_read_b64 v[28:29], v7 offset:11264
    ds_read_b64 v[30:31], v7 offset:11280
    s_waitcnt lgkmcnt(0)
    ds_read_b64 v[32:33], v7 offset:12288
    ds_read_b64 v[34:35], v7 offset:12304
    ds_read_b64 v[36:37], v7 offset:13312
    ds_read_b64 v[38:39], v7 offset:13328
    ds_read_b64 v[40:41], v7 offset:14336
    ds_read_b64 v[42:43], v7 offset:14352
    ds_read_b64 v[44:45], v7 offset:15360
    ds_read_b64 v[46:47], v7 offset:15376
    s_waitcnt lgkmcnt(0)
    v_add_f32 v16, v16, v20
    v_add_f32 v16, v16, v24
    v_add_f32 v16, v16, v28
    v_add_f32 v16, v16, v32
    v_add_f32 v16, v16, v36
    v_add_f32 v16, v16, v40
    v_add_f32 v16, v16, v44
    v_cvt_pk_bf16_f32 v5, v16, v16
    v_lshlrev_b32 v16, 16, v5
    v_add_f32 v17, v17, v21
    v_add_f32 v17, v17, v25
    v_add_f32 v17, v17, v29
    v_add_f32 v17, v17, v33
    v_add_f32 v17, v17, v37
    v_add_f32 v17, v17, v41
    v_add_f32 v17, v17, v45
    v_cvt_pk_bf16_f32 v5, v17, v17
    v_lshlrev_b32 v17, 16, v5
    v_add_f32 v18, v18, v22
    v_add_f32 v18, v18, v26
    v_add_f32 v18, v18, v30
    v_add_f32 v18, v18, v34
    v_add_f32 v18, v18, v38
    v_add_f32 v18, v18, v42
    v_add_f32 v18, v18, v46
    v_cvt_pk_bf16_f32 v5, v18, v18
    v_lshlrev_b32 v18, 16, v5
    v_add_f32 v19, v19, v23
    v_add_f32 v19, v19, v27
    v_add_f32 v19, v19, v31
    v_add_f32 v19, v19, v35
    v_add_f32 v19, v19, v39
    v_add_f32 v19, v19, v43
    v_add_f32 v19, v19, v47
    v_cvt_pk_bf16_f32 v5, v19, v19
    v_lshlrev_b32 v19, 16, v5
    v_mul_f32 v6, 0xbfb8aa3b, v16
    v_exp_f32 v6, v6
    s_nop 0
    v_add_f32 v6, 1.0, v6
    v_rcp_f32 v6, v6
    s_nop 0
    v_mul_f32 v16, v16, v6
    v_cvt_pk_bf16_f32 v5, v16, v16
    v_lshlrev_b32 v16, 16, v5
    v_mul_f32 v16, v16, v18
    v_mul_f32 v6, 0xbfb8aa3b, v17
    v_exp_f32 v6, v6
    s_nop 0
    v_add_f32 v6, 1.0, v6
    v_rcp_f32 v6, v6
    s_nop 0
    v_mul_f32 v17, v17, v6
    v_cvt_pk_bf16_f32 v5, v17, v17
    v_lshlrev_b32 v17, 16, v5
    v_mul_f32 v17, v17, v19
    v_cvt_pk_bf16_f32 v16, v16, v17
    v_mul_u32_u24 v8, 3584, v8
    v_lshl_add_u32 v7, v2, 2, v8
    v_mov_b32 v6, 0x40000000
    v_cmp_lt_u32 vcc, 27, v2
    s_nop 1
    v_cndmask_b32 v7, v7, v6, vcc
    v_cmp_lt_u32 vcc, 63, v0
    s_nop 1
    v_cndmask_b32 v7, v7, v6, vcc
    s_mul_i32 s37, s24, 8192
    s_add_u32 s37, s37, 0x1b0000
    s_add_u32 s36, s37, s23
    buffer_store_dword v16, v7, s[8:11], s36 offen sc1
    v_lshlrev_b32 v7, 4, v0
    v_add_u32 v8, 4096, v7
    v_cmp_lt_u32 vcc, 191, v0
    s_nop 1
    v_cndmask_b32 v8, v8, v6, vcc
L_M_act:
    buffer_load_dwordx4 v[20:23], v7, s[8:11], s37 offen sc1
    buffer_load_dwordx4 v[24:27], v8, s[8:11], s37 offen sc1
    s_add_u32 s32, s32, 1
    s_cmp_gt_u32 s32, 200000
    s_waitcnt vmcnt(0)
    v_max3_u32 v5, v20, v21, v22
    v_max3_u32 v5, v5, v23, v24
    v_max3_u32 v5, v5, v25, v26
    v_max_u32 v5, v5, v27
    s_cbranch_scc1 L_M_act_ok
    v_cmp_eq_u32 vcc, -1, v5
    s_cbranch_vccnz L_M_act
L_M_act_ok:
    ds_write_b128 v7, v[20:23] offset:16384
    ds_write_b128 v7, v[24:27] offset:20480
    s_waitcnt lgkmcnt(0)
    s_barrier
    v_lshrrev_b32 v7, 3, v0
    v_mul_u32_u24 v7, 112, v7
    v_mov_b64 v[48:49], 0
    v_mov_b64 v[50:51], 0
    ds_read_b128 v[16:19], v7 offset:16384
    ds_read_b128 v[20:23], v7 offset:16400
    ds_read_b128 v[24:27], v7 offset:16416
    ds_read_b128 v[28:31], v7 offset:16432
    ds_read_b128 v[32:35], v7 offset:16448
    ds_read_b128 v[36:39], v7 offset:16464
    ds_read_b128 v[40:43], v7 offset:16480
    s_waitcnt lgkmcnt(0)
    v_dot2_f32_bf16 v48, v16, v64, v48
    v_dot2_f32_bf16 v49, v16, v92, v49
    v_dot2_f32_bf16 v48, v17, v65, v48
    v_dot2_f32_bf16 v49, v17, v93, v49
    v_dot2_f32_bf16 v48, v18, v66, v48
    v_dot2_f32_bf16 v49, v18, v94, v49
    v_dot2_f32_bf16 v48, v19, v67, v48
    v_dot2_f32_bf16 v49, v19, v95, v49
    v_dot2_f32_bf16 v48, v20, v68, v48
    v_dot2_f32_bf16 v49, v20, v96, v49
    v_dot2_f32_bf16 v48, v21, v69, v48
    v_dot2_f32_bf16 v49, v21, v97, v49
    v_dot2_f32_bf16 v48, v22, v70, v48
    v_dot2_f32_bf16 v49, v22, v98, v49
    v_dot2_f32_bf16 v48, v23, v71, v48
    v_dot2_f32_bf16 v49, v23, v99, v49
    v_dot2_f32_bf16 v48, v24, v72, v48
    v_dot2_f32_bf16 v49, v24, v100, v49
    v_dot2_f32_bf16 v48, v25, v73, v48
    v_dot2_f32_bf16 v49, v25, v101, v49
    v_dot2_f32_bf16 v48, v26, v74, v48
    v_dot2_f32_bf16 v49, v26, v102, v49
    v_dot2_f32_bf16 v48, v27, v75, v48
    v_dot2_f32_bf16 v49, v27, v103, v49
    v_dot2_f32_bf16 v48, v28, v76, v48
    v_dot2_f32_bf16 v49, v28, v104, v49
    v_dot2_f32_bf16 v48, v29, v77, v48
    v_dot2_f32_bf16 v49, v29, v105, v49
    v_dot2_f32_bf16 v48, v30, v78, v48
    v_dot2_f32_bf16 v49, v30, v106, v49
    v_dot2_f32_bf16 v48, v31, v79, v48
    v_dot2_f32_bf16 v49, v31, v107, v49
    v_dot2_f32_bf16 v48, v32, v80, v48
    v_dot2_f32_bf16 v49, v32, v108, v49
    v_dot2_f32_bf16 v48, v33, v81, v48
    v_dot2_f32_bf16 v49, v33, v109, v49
    v_dot2_f32_bf16 v48, v34, v82, v48
    v_dot2_f32_bf16 v49, v34, v110, v49
    v_dot2_f32_bf16 v48, v35, v83, v48
    v_dot2_f32_bf16 v49, v35, v111, v49
    v_dot2_f32_bf16 v48, v36, v84, v48
    v_dot2_f32_bf16 v49, v36, v112, v49
    v_dot2_f32_bf16 v48, v37, v85, v48
    v_dot2_f32_bf16 v49, v37, v113, v49
    v_dot2_f32_bf16 v48, v38, v86, v48
    v_dot2_f32_bf16 v49, v38, v114, v49
    v_dot2_f32_bf16 v48, v39, v87, v48
    v_dot2_f32_bf16 v49, v39, v115, v49
    v_dot2_f32_bf16 v48, v40, v88, v48
    v_dot2_f32_bf16 v49, v40, v116, v49
    v_dot2_f32_bf16 v48, v41, v89, v48
    v_dot2_f32_bf16 v49, v41, v117, v49
    v_dot2_f32_bf16 v48, v42, v90, v48
    v_dot2_f32_bf16 v49, v42, v118, v49
    v_dot2_f32_bf16 v48, v43, v91, v48
    v_dot2_f32_bf16 v49, v43, v119, v49
    ds_read_b128 v[16:19], v7 offset:19968
    ds_read_b128 v[20:23], v7 offset:19984
    ds_read_b128 v[24:27], v7 offset:20000
    ds_read_b128 v[28:31], v7 offset:20016
    ds_read_b128 v[32:35], v7 offset:20032
    ds_read_b128 v[36:39], v7 offset:20048
    ds_read_b128 v[40:43], v7 offset:20064
    s_waitcnt lgkmcnt(0)
    v_dot2_f32_bf16 v50, v16, v64, v50
    v_dot2_f32_bf16 v51, v16, v92, v51
    v_dot2_f32_bf16 v50, v17, v65, v50
    v_dot2_f32_bf16 v51, v17, v93, v51
    v_dot2_f32_bf16 v50, v18, v66, v50
    v_dot2_f32_bf16 v51, v18, v94, v51
    v_dot2_f32_bf16 v50, v19, v67, v50
    v_dot2_f32_bf16 v51, v19, v95, v51
    v_dot2_f32_bf16 v50, v20, v68, v50
    v_dot2_f32_bf16 v51, v20, v96, v51
    v_dot2_f32_bf16 v50, v21, v69, v50
    v_dot2_f32_bf16 v51, v21, v97, v51
    v_dot2_f32_bf16 v50, v22, v70, v50
    v_dot2_f32_bf16 v51, v22, v98, v51
    v_dot2_f32_bf16 v50, v23, v71, v50
    v_dot2_f32_bf16 v51, v23, v99, v51
    v_dot2_f32_bf16 v50, v24, v72, v50
    v_dot2_f32_bf16 v51, v24, v100, v51
    v_dot2_f32_bf16 v50, v25, v73, v50
    v_dot2_f32_bf16 v51, v25, v101, v51
    v_dot2_f32_bf16 v50, v26, v74, v50
    v_dot2_f32_bf16 v51, v26, v102, v51
    v_dot2_f32_bf16 v50, v27, v75, v50
    v_dot2_f32_bf16 v51, v27, v103, v51
    v_dot2_f32_bf16 v50, v28, v76, v50
    v_dot2_f32_bf16 v51, v28, v104, v51
    v_dot2_f32_bf16 v50, v29, v77, v50
    v_dot2_f32_bf16 v51, v29, v105, v51
    v_dot2_f32_bf16 v50, v30, v78, v50
    v_dot2_f32_bf16 v51, v30, v106, v51
    v_dot2_f32_bf16 v50, v31, v79, v50
    v_dot2_f32_bf16 v51, v31, v107, v51
    v_dot2_f32_bf16 v50, v32, v80, v50
    v_dot2_f32_bf16 v51, v32, v108, v51
    v_dot2_f32_bf16 v50, v33, v81, v50
    v_dot2_f32_bf16 v51, v33, v109, v51
    v_dot2_f32_bf16 v50, v34, v82, v50
    v_dot2_f32_bf16 v51, v34, v110, v51
    v_dot2_f32_bf16 v50, v35, v83, v50
    v_dot2_f32_bf16 v51, v35, v111, v51
    v_dot2_f32_bf16 v50, v36, v84, v50
    v_dot2_f32_bf16 v51, v36, v112, v51
    v_dot2_f32_bf16 v50, v37, v85, v50
    v_dot2_f32_bf16 v51, v37, v113, v51
    v_dot2_f32_bf16 v50, v38, v86, v50
    v_dot2_f32_bf16 v51, v38, v114, v51
    v_dot2_f32_bf16 v50, v39, v87, v50
    v_dot2_f32_bf16 v51, v39, v115, v51
    v_dot2_f32_bf16 v50, v40, v88, v50
    v_dot2_f32_bf16 v51, v40, v116, v51
    v_dot2_f32_bf16 v50, v41, v89, v50
    v_dot2_f32_bf16 v51, v41, v117, v51
    v_dot2_f32_bf16 v50, v42, v90, v50
    v_dot2_f32_bf16 v51, v42, v118, v51
    v_dot2_f32_bf16 v50, v43, v91, v50
    v_dot2_f32_bf16 v51, v43, v119, v51
    s_nop 3
    v_add_f32_dpp v48, v48, v48 row_ror:8 row_mask:0xf bank_mask:0xf
    v_add_f32_dpp v49, v49, v49 row_ror:8 row_mask:0xf bank_mask:0xf
    v_add_f32_dpp v50, v50, v50 row_ror:8 row_mask:0xf bank_mask:0xf
    v_add_f32_dpp v51, v51, v51 row_ror:8 row_mask:0xf bank_mask:0xf
    v_mov_b32 v5, v48
    s_nop 1
    v_permlane16_swap_b32 v48, v5
    v_add_f32 v48, v48, v5
    v_mov_b32 v5, v49
    s_nop 1
    v_permlane16_swap_b32 v49, v5
    v_add_f32 v49, v49, v5
    v_mov_b32 v5, v50
    s_nop 1
    v_permlane16_swap_b32 v50, v5
    v_add_f32 v50, v50, v5
    v_mov_b32 v5, v51
    s_nop 1
    v_permlane16_swap_b32 v51, v5
    v_add_f32 v51, v51, v5
    v_mov_b32 v5, v48
    s_nop 1
    v_permlane32_swap_b32 v48, v5
    v_add_f32 v48, v48, v5
    v_mov_b32 v5, v49
    s_nop 1
    v_permlane32_swap_b32 v49, v5
    v_add_f32 v49, v49, v5
    v_mov_b32 v5, v50
    s_nop 1
    v_permlane32_swap_b32 v50, v5
    v_add_f32 v50, v50, v5
    v_mov_b32 v5, v51
    s_nop 1
    v_permlane32_swap_b32 v51, v5
    v_add_f32 v51, v51, v5
    v_lshrrev_b32 v7, 6, v0
    v_lshlrev_b32 v7, 7, v7
    v_lshl_add_u32 v7, v3, 4, v7
    ds_write_b128 v7, v[48:51] offset:1024
    s_waitcnt lgkmcnt(0)
    s_barrier
    v_lshlrev_b32 v7, 4, v3
    v_lshl_add_u32 v7, v9, 3, v7
    ds_read_b64 v[16:17], v7 offset:1024
    ds_read_b64 v[18:19], v7 offset:1152
    ds_read_b64 v[20:21], v7 offset:1280
    ds_read_b64 v[22:23], v7 offset:1408
    v_mul_f32 v10, 0xbfb8aa3b, v11
    v_exp_f32 v10, v10
    s_nop 0
    v_add_f32 v10, 1.0, v10
    v_rcp_f32 v10, v10
    s_nop 0
    v_cvt_pk_bf16_f32 v5, v10, v10
    v_lshlrev_b32 v10, 16, v5
    s_waitcnt lgkmcnt(0)
    v_lshlrev_b32 v24, 16, v15
    v_and_b32 v25, 0xffff0000, v15
    v_lshlrev_b32 v26, 16, v14
    v_and_b32 v27, 0xffff0000, v14
    v_add_f32 v16, v16, v18
    v_add_f32 v20, v20, v22
    v_add_f32 v16, v16, v20
    v_cvt_pk_bf16_f32 v5, v16, v16
    v_lshlrev_b32 v16, 16, v5
    v_mul_f32 v16, v16, v10
    v_cvt_pk_bf16_f32 v5, v16, v16
    v_lshlrev_b32 v16, 16, v5
    v_add_f32 v16, v16, v24
    v_cvt_pk_bf16_f32 v5, v16, v16
    v_lshlrev_b32 v16, 16, v5
    v_add_f32 v16, v16, v26
    v_add_f32 v17, v17, v19
    v_add_f32 v21, v21, v23
    v_add_f32 v17, v17, v21
    v_cvt_pk_bf16_f32 v5, v17, v17
    v_lshlrev_b32 v17, 16, v5
    v_mul_f32 v17, v17, v10
    v_cvt_pk_bf16_f32 v5, v17, v17
    v_lshlrev_b32 v17, 16, v5
    v_add_f32 v17, v17, v25
    v_cvt_pk_bf16_f32 v5, v17, v17
    v_lshlrev_b32 v17, 16, v5
    v_add_f32 v17, v17, v27
    v_cvt_pk_bf16_f32 v16, v16, v17
    buffer_store_dword v16, v12, s[60:63], 0 offen sc1
    v_add_f32 v24, v24, v26
    v_add_f32 v25, v25, v27
    v_cvt_pk_bf16_f32 v13, v24, v25
L_M_next:
    s_add_u32 s24, s24, 1
    s_mov_b32 s25, 192
    s_cmp_eq_u32 s24, 1
    s_cbranch_scc1 L_M_round
    s_cmp_eq_u32 s24, 3
    s_cbranch_scc1 L_end
    s_mov_b32 s25, 256
    v_and_b32 v7, 63, v0
    v_lshlrev_b32 v3, 4, v7
    s_mov_b32 s36, 0x19bc00
    v_sub_u32 v7, 63, v7
L_M_fin:
    buffer_load_dwordx4 v[16:19], v3, s[8:11], s36 offen sc1
    s_add_u32 s32, s32, 1
    s_cmp_gt_u32 s32, 200000
    s_cselect_b32 s37, -1, -2
    s_waitcnt vmcnt(0)
    v_max3_u32 v5, v16, v17, v18
    v_max_u32 v5, v5, v19
    v_cmp_lt_u32 vcc, s37, v5
    s_cbranch_vccnz L_M_fin
    v_add_f32 v16, v16, v17
    v_add_f32 v18, v18, v19
    v_add_f32 v16, v16, v18
    v_cvt_pk_bf16_f32 v5, v16, v16
    v_lshlrev_b32 v16, 16, v5
    v_ashrrev_i32 v5, 31, v16
    v_or_b32 v5, 0x80000000, v5
    v_xor_b32 v5, v5, v16
    v_and_or_b32 v5, v5, s42, v7
    v_cmp_lt_u32 vcc, s29, v5
    s_cbranch_vccnz L_M_round
L_end:
    s_endpgm
.section .rodata,"a"
.p2align 6
.amdhsa_kernel sequential_preLN__memory_aug_recurrent_mem_tr__moe_arch_mod__prompt_kernel
  .amdhsa_next_free_vgpr 512
  .amdhsa_next_free_sgpr 102
  .amdhsa_accum_offset 256
  .amdhsa_group_segment_fixed_size 0
  .amdhsa_kernarg_size 120
  .amdhsa_user_sgpr_count 2
  .amdhsa_user_sgpr_kernarg_segment_ptr 1
  .amdhsa_system_sgpr_workgroup_id_x 1
.end_amdhsa_kernel
```

```asm
; @launch grid=(256,1,1) block=(256,1,1) lds=163840
.amdgcn_target "amdgcn-amd-amdhsa--gfx950"
.text
.globl sequential_preLN__memory_aug_recurrent_mem_tr__moe_arch_mod__prompt_kernel
.p2align 8
.type sequential_preLN__memory_aug_recurrent_mem_tr__moe_arch_mod__prompt_kernel,@function
sequential_preLN__memory_aug_recurrent_mem_tr__moe_arch_mod__prompt_kernel:
    s_cmp_ge_u32 s2, 256
    s_cbranch_scc1 L_end
    s_load_dwordx8 s[44:51], s[0:1], 0
    s_load_dwordx4 s[52:55], s[0:1], 32
    s_load_dwordx4 s[56:59], s[0:1], 104
    s_load_dwordx2 s[80:81], s[0:1], 64
    s_load_dwordx2 s[82:83], s[0:1], 96
    s_load_dwordx4 s[84:87], s[0:1], 72
    s_load_dwordx2 s[88:89], s[0:1], 88
    v_lshrrev_b32 v1, 6, v0
    s_nop 0
    v_readfirstlane_b32 s21, v1
    s_waitcnt lgkmcnt(0)
    s_mov_b32 s8, s58
    s_and_b32 s9, s59, 0xffff
    s_mov_b32 s10, 0x10000000
    s_mov_b32 s11, 0x20000
    s_mov_b32 s16, s56
    s_and_b32 s17, s57, 0xffff
    s_mov_b32 s18, 0x100
    s_mov_b32 s19, 0x20000
    s_and_b32 s3, s2, 7
    s_cmp_lg_u32 s3, 0
    s_cbranch_scc1 L_worker
    s_lshr_b32 s20, s2, 3
    v_lshrrev_b32 v28, 6, v0
    v_bfe_u32 v29, v0, 4, 2
    v_lshl_add_u32 v28, v28, 5, v29
    v_and_b32 v16, 15, v0
    v_lshlrev_b32 v16, 4, v16
    v_lshl_add_u32 v16, v28, 13, v16
    v_bfe_u32 v29, v0, 4, 1
    v_lshlrev_b32 v29, 5, v29
    v_xor_b32 v16, v16, v29
    v_xor_b32 v17, 64, v16
    v_xor_b32 v18, 128, v16
    v_xor_b32 v19, 192, v16
    s_add_u32 s28, s21, 1
    s_lshl_b32 s28, s28, 15
    s_lshl_b32 s3, s20, 8
    s_mov_b32 s60, s52
    s_and_b32 s61, s53, 0xffff
    s_mov_b32 s62, 0x400000
    s_mov_b32 s63, 0x20000
    s_add_u32 m0, s28, 0
    s_add_u32 s37, s3, 0x0
    buffer_load_dwordx4 v16, s[60:63], s37 offen lds
    s_add_u32 m0, s28, 1024
    s_add_u32 s37, s3, 0x8000
    buffer_load_dwordx4 v17, s[60:63], s37 offen lds
    s_add_u32 m0, s28, 2048
    s_add_u32 s37, s3, 0x10000
    buffer_load_dwordx4 v18, s[60:63], s37 offen lds
    s_add_u32 m0, s28, 3072
    s_add_u32 s37, s3, 0x18000
    buffer_load_dwordx4 v19, s[60:63], s37 offen lds
    s_add_u32 m0, s28, 4096
    s_add_u32 s37, s3, 0x20000
    buffer_load_dwordx4 v16, s[60:63], s37 offen lds
    s_add_u32 m0, s28, 5120
    s_add_u32 s37, s3, 0x28000
    buffer_load_dwordx4 v17, s[60:63], s37 offen lds
    s_add_u32 m0, s28, 6144
    s_add_u32 s37, s3, 0x30000
    buffer_load_dwordx4 v18, s[60:63], s37 offen lds
    s_add_u32 m0, s28, 7168
    s_add_u32 s37, s3, 0x38000
    buffer_load_dwordx4 v19, s[60:63], s37 offen lds
    s_add_u32 m0, s28, 8192
    s_add_u32 s37, s3, 0x100000
    buffer_load_dwordx4 v16, s[60:63], s37 offen lds
    s_add_u32 m0, s28, 9216
    s_add_u32 s37, s3, 0x108000
    buffer_load_dwordx4 v17, s[60:63], s37 offen lds
    s_add_u32 m0, s28, 10240
    s_add_u32 s37, s3, 0x110000
    buffer_load_dwordx4 v18, s[60:63], s37 offen lds
    s_add_u32 m0, s28, 11264
    s_add_u32 s37, s3, 0x118000
    buffer_load_dwordx4 v19, s[60:63], s37 offen lds
    s_add_u32 m0, s28, 12288
    s_add_u32 s37, s3, 0x120000
    buffer_load_dwordx4 v16, s[60:63], s37 offen lds
    s_add_u32 m0, s28, 13312
    s_add_u32 s37, s3, 0x128000
    buffer_load_dwordx4 v17, s[60:63], s37 offen lds
    s_add_u32 m0, s28, 14336
    s_add_u32 s37, s3, 0x130000
    buffer_load_dwordx4 v18, s[60:63], s37 offen lds
    s_add_u32 m0, s28, 15360
    s_add_u32 s37, s3, 0x138000
    buffer_load_dwordx4 v19, s[60:63], s37 offen lds
    s_add_u32 m0, s28, 16384
    s_add_u32 s37, s3, 0x200000
    buffer_load_dwordx4 v16, s[60:63], s37 offen lds
    s_add_u32 m0, s28, 17408
    s_add_u32 s37, s3, 0x208000
    buffer_load_dwordx4 v17, s[60:63], s37 offen lds
    s_add_u32 m0, s28, 18432
    s_add_u32 s37, s3, 0x210000
    buffer_load_dwordx4 v18, s[60:63], s37 offen lds
    s_add_u32 m0, s28, 19456
    s_add_u32 s37, s3, 0x218000
    buffer_load_dwordx4 v19, s[60:63], s37 offen lds
    s_add_u32 m0, s28, 20480
    s_add_u32 s37, s3, 0x220000
    buffer_load_dwordx4 v16, s[60:63], s37 offen lds
    s_add_u32 m0, s28, 21504
    s_add_u32 s37, s3, 0x228000
    buffer_load_dwordx4 v17, s[60:63], s37 offen lds
    s_add_u32 m0, s28, 22528
    s_add_u32 s37, s3, 0x230000
    buffer_load_dwordx4 v18, s[60:63], s37 offen lds
    s_add_u32 m0, s28, 23552
    s_add_u32 s37, s3, 0x238000
    buffer_load_dwordx4 v19, s[60:63], s37 offen lds
    v_mov_b32 v20, 0x0
    v_bfe_u32 v14, v0, 0, 1
    s_mov_b32 s38, 0x8
    v_mad_u32_u24 v20, v14, s38, v20
    v_bfe_u32 v14, v0, 1, 1
    s_mov_b32 s38, 0x10
    v_mad_u32_u24 v20, v14, s38, v20
    v_bfe_u32 v14, v0, 2, 1
    s_mov_b32 s38, 0x100
    v_mad_u32_u24 v20, v14, s38, v20
    v_bfe_u32 v14, v0, 3, 1
    s_mov_b32 s38, 0x800
    v_mad_u32_u24 v20, v14, s38, v20
    v_bfe_u32 v14, v0, 4, 1
    s_mov_b32 s38, 0x400
    v_mad_u32_u24 v20, v14, s38, v20
    v_bfe_u32 v14, v0, 5, 1
    s_mov_b32 s38, 0x1000
    v_mad_u32_u24 v20, v14, s38, v20
    v_mov_b32 v30, 0x0
    v_bfe_u32 v14, v0, 2, 1
    s_mov_b32 s38, 0x20
    v_mad_u32_u24 v30, v14, s38, v30
    v_bfe_u32 v14, v0, 3, 1
    s_mov_b32 s38, 0x80
    v_mad_u32_u24 v30, v14, s38, v30
    v_bfe_u32 v14, v0, 4, 1
    s_mov_b32 s38, 0x40
    v_mad_u32_u24 v30, v14, s38, v30
    v_mov_b32 v31, 0x0
    v_bfe_u32 v14, v0, 6, 1
    s_mov_b32 s38, 0x40
    v_mad_u32_u24 v31, v14, s38, v31
    v_bfe_u32 v14, v0, 7, 1
    s_mov_b32 s38, 0x80
    v_mad_u32_u24 v31, v14, s38, v31
    v_xor_b32 v30, v30, v31
    v_add_u32 v30, v30, v20
    s_xor_b32 s36, s21, 0
    s_add_u32 s36, s36, 1
    s_lshl_b32 s36, s36, 15
    v_add_u32 v20, s36, v30
    v_xor_b32 v21, 32, v20
    s_xor_b32 s36, s21, 1
    s_add_u32 s36, s36, 1
    s_lshl_b32 s36, s36, 15
    v_add_u32 v22, s36, v30
    v_xor_b32 v23, 32, v22
    s_xor_b32 s36, s21, 2
    s_add_u32 s36, s36, 1
    s_lshl_b32 s36, s36, 15
    v_add_u32 v24, s36, v30
    v_xor_b32 v25, 32, v24
    s_xor_b32 s36, s21, 3
    s_add_u32 s36, s36, 1
    s_lshl_b32 s36, s36, 15
    v_add_u32 v26, s36, v30
    v_xor_b32 v27, 32, v26
    v_mov_b32 v11, 0x0
    v_bfe_u32 v14, v0, 0, 1
    s_mov_b32 s38, 0x4
    v_mad_u32_u24 v11, v14, s38, v11
    v_bfe_u32 v14, v0, 1, 1
    s_mov_b32 s38, 0x8
    v_mad_u32_u24 v11, v14, s38, v11
    v_bfe_u32 v14, v0, 2, 1
    s_mov_b32 s38, 0x10
    v_mad_u32_u24 v11, v14, s38, v11
    v_bfe_u32 v14, v0, 3, 1
    s_mov_b32 s38, 0x20
    v_mad_u32_u24 v11, v14, s38, v11
    v_bfe_u32 v14, v0, 4, 1
    s_mov_b32 s38, 0x800
    v_mad_u32_u24 v11, v14, s38, v11
    v_bfe_u32 v14, v0, 5, 1
    s_mov_b32 s38, 0x1000
    v_mad_u32_u24 v11, v14, s38, v11
    v_bfe_u32 v14, v0, 6, 1
    s_mov_b32 s38, 0x100
    v_mad_u32_u24 v11, v14, s38, v11
    v_bfe_u32 v14, v0, 7, 1
    s_mov_b32 s38, 0x200
    v_mad_u32_u24 v11, v14, s38, v11
    s_mov_b32 s92, s54
    s_and_b32 s93, s55, 0xffff
    s_mov_b32 s94, 0x400000
    s_mov_b32 s95, 0x20000
    s_lshl_b32 s29, s20, 17
    s_xor_b32 s36, s21, 3
    s_lshl_b32 s36, s36, 15
    s_add_u32 s36, s36, s29
    s_add_u32 s37, s36, 0x80
    buffer_load_dword v32, v11, s[92:95], s37 offen
    s_add_u32 s37, s36, 0x4080
    buffer_load_dword v33, v11, s[92:95], s37 offen
    s_add_u32 s37, s36, 0x480
    buffer_load_dword v34, v11, s[92:95], s37 offen
    s_add_u32 s37, s36, 0x4480
    buffer_load_dword v35, v11, s[92:95], s37 offen
    s_add_u32 s37, s36, 0x2080
    buffer_load_dword v36, v11, s[92:95], s37 offen
    s_add_u32 s37, s36, 0x6080
    buffer_load_dword v37, v11, s[92:95], s37 offen
    s_add_u32 s37, s36, 0x2480
    buffer_load_dword v38, v11, s[92:95], s37 offen
    s_add_u32 s37, s36, 0x6480
    buffer_load_dword v39, v11, s[92:95], s37 offen
    s_add_u32 s37, s36, 0xc0
    buffer_load_dword v40, v11, s[92:95], s37 offen
    s_add_u32 s37, s36, 0x40c0
    buffer_load_dword v41, v11, s[92:95], s37 offen
    s_add_u32 s37, s36, 0x4c0
    buffer_load_dword v42, v11, s[92:95], s37 offen
    s_add_u32 s37, s36, 0x44c0
    buffer_load_dword v43, v11, s[92:95], s37 offen
    s_add_u32 s37, s36, 0x20c0
    buffer_load_dword v44, v11, s[92:95], s37 offen
    s_add_u32 s37, s36, 0x60c0
    buffer_load_dword v45, v11, s[92:95], s37 offen
    s_add_u32 s37, s36, 0x24c0
    buffer_load_dword v46, v11, s[92:95], s37 offen
    s_add_u32 s37, s36, 0x64c0
    buffer_load_dword v47, v11, s[92:95], s37 offen
    s_getreg_b32 s36, hwreg(HW_REG_XCC_ID)
    s_and_b32 s36, s36, 15
    s_or_b32 s36, s36, 0x100
    v_mov_b32 v30, s36
    s_lshl_b32 s37, s20, 2
    v_lshlrev_b32 v31, 20, v0
    buffer_store_dword v30, v31, s[16:19], s37 offen offset:128 sc1
    s_mov_b32 s12, s46
    s_and_b32 s13, s47, 0xffff
    s_mov_b32 s14, 0x2000
    s_mov_b32 s15, 0x20000
    v_mov_b32 v104, 0x0
    v_bfe_u32 v14, v0, 0, 1
    s_mov_b32 s38, 0x8
    v_mad_u32_u24 v104, v14, s38, v104
    v_bfe_u32 v14, v0, 1, 1
    s_mov_b32 s38, 0x10
    v_mad_u32_u24 v104, v14, s38, v104
    v_bfe_u32 v14, v0, 2, 1
    s_mov_b32 s38, 0x10000
    v_mad_u32_u24 v104, v14, s38, v104
    v_bfe_u32 v14, v0, 3, 1
    s_mov_b32 s38, 0x10000
    v_mad_u32_u24 v104, v14, s38, v104
    v_bfe_u32 v14, v0, 4, 1
    s_mov_b32 s38, 0x400
    v_mad_u32_u24 v104, v14, s38, v104
    v_bfe_u32 v14, v0, 5, 1
    s_mov_b32 s38, 0x4
    v_mad_u32_u24 v104, v14, s38, v104
    v_bfe_u32 v14, v0, 6, 1
    s_mov_b32 s38, 0x40
    v_mad_u32_u24 v104, v14, s38, v104
    v_bfe_u32 v14, v0, 7, 1
    s_mov_b32 s38, 0x80
    v_mad_u32_u24 v104, v14, s38, v104
    v_mov_b32 v106, s20
    v_mov_b32 v105, 0x0
    v_bfe_u32 v14, v106, 0, 1
    s_mov_b32 s38, 0x20
    v_mad_u32_u24 v105, v14, s38, v105
    v_bfe_u32 v14, v106, 1, 1
    s_mov_b32 s38, 0x800
    v_mad_u32_u24 v105, v14, s38, v105
    v_bfe_u32 v14, v106, 2, 1
    s_mov_b32 s38, 0x1000
    v_mad_u32_u24 v105, v14, s38, v105
    v_bfe_u32 v14, v106, 3, 1
    s_mov_b32 s38, 0x100
    v_mad_u32_u24 v105, v14, s38, v105
    v_bfe_u32 v14, v106, 4, 1
    s_mov_b32 s38, 0x200
    v_mad_u32_u24 v105, v14, s38, v105
    v_add_u32 v104, v104, v105
    buffer_load_dword v12, v104, s[12:15], 0 offen
    s_mov_b32 s36, 0x82100
    v_mul_lo_u32 v104, v0, s36
    v_mov_b32 v105, 0x40000000
    v_cmp_lt_u32 vcc, 1, v0
    s_nop 1
    v_cndmask_b32 v104, v104, v105, vcc
    s_mul_i32 s36, s20, 0x104200
    s_add_u32 s36, s36, 0x1082080
    buffer_load_dword v126, v104, s[8:11], s36 offen
    s_mov_b32 s36, 0xf0000
    buffer_load_dword v127, off, s[8:11], s36
    v_mov_b32 v1, 0x4444
    v_bfe_u32 v14, v0, 1, 1
    s_mov_b32 s38, 0xaaaa
    v_mad_u32_u24 v1, v14, s38, v1
    v_mov_b32 v3, 0x0
    v_bfe_u32 v14, v0, 0, 1
    s_mov_b32 s38, 0x10
    v_mad_u32_u24 v3, v14, s38, v3
    v_bfe_u32 v14, v0, 1, 1
    s_mov_b32 s38, 0x20
    v_mad_u32_u24 v3, v14, s38, v3
    v_bfe_u32 v14, v0, 2, 1
    s_mov_b32 s38, 0x40
    v_mad_u32_u24 v3, v14, s38, v3
    v_bfe_u32 v14, v0, 3, 1
    s_mov_b32 s38, 0x80
    v_mad_u32_u24 v3, v14, s38, v3
    v_bfe_u32 v14, v0, 4, 1
    s_mov_b32 s38, 0x100
    v_mad_u32_u24 v3, v14, s38, v3
    v_bfe_u32 v14, v0, 5, 1
    s_mov_b32 s38, 0x200
    v_mad_u32_u24 v3, v14, s38, v3
    v_mov_b32 v2, 0x0
    v_bfe_u32 v14, v0, 0, 1
    s_mov_b32 s38, 0x10
    v_mad_u32_u24 v2, v14, s38, v2
    v_bfe_u32 v14, v0, 1, 1
    s_mov_b32 s38, 0x20
    v_mad_u32_u24 v2, v14, s38, v2
    v_bfe_u32 v14, v0, 2, 1
    s_mov_b32 s38, 0x40
    v_mad_u32_u24 v2, v14, s38, v2
    v_bfe_u32 v14, v0, 3, 1
    s_mov_b32 s38, 0x80
    v_mad_u32_u24 v2, v14, s38, v2
    v_bfe_u32 v14, v0, 4, 1
    s_mov_b32 s38, 0x100
    v_mad_u32_u24 v2, v14, s38, v2
    v_bfe_u32 v14, v0, 5, 1
    s_mov_b32 s38, 0x200
    v_mad_u32_u24 v2, v14, s38, v2
    v_bfe_u32 v14, v0, 6, 1
    s_mov_b32 s38, 0x800
    v_mad_u32_u24 v2, v14, s38, v2
    v_bfe_u32 v14, v0, 7, 1
    s_mov_b32 s38, 0x1000
    v_mad_u32_u24 v2, v14, s38, v2
    v_mov_b32 v4, 0x8000
    v_bfe_u32 v14, v0, 0, 1
    s_mov_b32 s38, 0x10
    v_mad_u32_u24 v4, v14, s38, v4
    v_bfe_u32 v14, v0, 1, 1
    s_mov_b32 s38, 0x20
    v_mad_u32_u24 v4, v14, s38, v4
    v_bfe_u32 v14, v0, 2, 1
    s_mov_b32 s38, 0x40
    v_mad_u32_u24 v4, v14, s38, v4
    v_bfe_u32 v14, v0, 3, 1
    s_mov_b32 s38, 0x80
    v_mad_u32_u24 v4, v14, s38, v4
    v_bfe_u32 v14, v0, 4, 1
    s_mov_b32 s38, 0x100
    v_mad_u32_u24 v4, v14, s38, v4
    v_bfe_u32 v14, v0, 5, 1
    s_mov_b32 s38, 0x200
    v_mad_u32_u24 v4, v14, s38, v4
    v_bfe_u32 v14, v0, 6, 1
    s_mov_b32 s38, 0x8000
    v_mad_u32_u24 v4, v14, s38, v4
    v_bfe_u32 v14, v0, 7, 1
    s_mov_b32 s38, 0x10000
    v_mad_u32_u24 v4, v14, s38, v4
    v_mov_b32 v5, 0x4000
    v_bfe_u32 v14, v0, 0, 1
    s_mov_b32 s38, 0x4
    v_mad_u32_u24 v5, v14, s38, v5
    v_bfe_u32 v14, v0, 1, 1
    s_mov_b32 s38, 0x8
    v_mad_u32_u24 v5, v14, s38, v5
    v_bfe_u32 v14, v0, 2, 1
    s_mov_b32 s38, 0x10
    v_mad_u32_u24 v5, v14, s38, v5
    v_bfe_u32 v14, v0, 3, 1
    s_mov_b32 s38, 0x20
    v_mad_u32_u24 v5, v14, s38, v5
    v_bfe_u32 v14, v0, 4, 1
    s_mov_b32 s38, 0x240
    v_mad_u32_u24 v5, v14, s38, v5
    v_bfe_u32 v14, v0, 5, 1
    s_mov_b32 s38, 0x480
    v_mad_u32_u24 v5, v14, s38, v5
    v_bfe_u32 v14, v0, 6, 1
    s_mov_b32 s38, 0x40
    v_mad_u32_u24 v5, v14, s38, v5
    v_bfe_u32 v14, v0, 7, 1
    s_mov_b32 s38, 0x80
    v_mad_u32_u24 v5, v14, s38, v5
    v_mov_b32 v6, 0x4000
    v_bfe_u32 v14, v0, 0, 1
    s_mov_b32 s38, 0x120
    v_mad_u32_u24 v6, v14, s38, v6
    v_bfe_u32 v14, v0, 2, 1
    s_mov_b32 s38, 0x240
    v_mad_u32_u24 v6, v14, s38, v6
    v_bfe_u32 v14, v0, 3, 1
    s_mov_b32 s38, 0x480
    v_mad_u32_u24 v6, v14, s38, v6
    v_bfe_u32 v14, v0, 4, 1
    s_mov_b32 s38, 0x10
    v_mad_u32_u24 v6, v14, s38, v6
    v_bfe_u32 v14, v0, 5, 1
    s_mov_b32 s38, 0x20
    v_mad_u32_u24 v6, v14, s38, v6
    v_add_u32 v7, 2304, v5
    v_xor_b32 v8, 0x1000, v2
    v_mov_b32 v104, 0x0
    v_bfe_u32 v14, v0, 3, 1
    s_mov_b32 s38, 0x1
    v_mad_u32_u24 v104, v14, s38, v104
    v_bfe_u32 v14, v0, 4, 1
    s_mov_b32 s38, 0x2
    v_mad_u32_u24 v104, v14, s38, v104
    v_bfe_u32 v14, v0, 5, 1
    s_mov_b32 s38, 0x4
    v_mad_u32_u24 v104, v14, s38, v104
    v_bfe_u32 v14, v0, 6, 1
    s_mov_b32 s38, 0x8
    v_mad_u32_u24 v104, v14, s38, v104
    v_bfe_u32 v14, v0, 7, 1
    s_mov_b32 s38, 0x10
    v_mad_u32_u24 v104, v14, s38, v104
    v_add_u32 v104, s20, v104
    v_and_b32 v104, 31, v104
    v_lshlrev_b32 v104, 6, v104
    v_mov_b32 v9, 0x0
    v_bfe_u32 v14, v0, 0, 1
    s_mov_b32 s38, 0x8
    v_mad_u32_u24 v9, v14, s38, v9
    v_bfe_u32 v14, v0, 1, 1
    s_mov_b32 s38, 0x10
    v_mad_u32_u24 v9, v14, s38, v9
    v_bfe_u32 v14, v0, 2, 1
    s_mov_b32 s38, 0x20
    v_mad_u32_u24 v9, v14, s38, v9
    v_bfe_u32 v14, v0, 3, 1
    s_mov_b32 s38, 0x2000
    v_mad_u32_u24 v9, v14, s38, v9
    v_bfe_u32 v14, v0, 4, 1
    s_mov_b32 s38, 0x4000
    v_mad_u32_u24 v9, v14, s38, v9
    v_bfe_u32 v14, v0, 5, 1
    s_mov_b32 s38, 0x8000
    v_mad_u32_u24 v9, v14, s38, v9
    v_bfe_u32 v14, v0, 6, 1
    s_mov_b32 s38, 0x10000
    v_mad_u32_u24 v9, v14, s38, v9
    v_bfe_u32 v14, v0, 7, 1
    s_mov_b32 s38, 0x20000
    v_mad_u32_u24 v9, v14, s38, v9
    v_add_u32 v9, v9, v104
    v_mov_b32 v10, 0x80000
    v_bfe_u32 v14, v0, 0, 1
    s_mov_b32 s38, 0x8
    v_mad_u32_u24 v10, v14, s38, v10
    v_bfe_u32 v14, v0, 1, 1
    s_mov_b32 s38, 0x20
    v_mad_u32_u24 v10, v14, s38, v10
    v_bfe_u32 v14, v0, 4, 1
    s_mov_b32 s38, 0x10
    v_mad_u32_u24 v10, v14, s38, v10
    v_bfe_u32 v14, v0, 5, 1
    s_mov_b32 s38, 0x4
    v_mad_u32_u24 v10, v14, s38, v10
    v_bfe_u32 v14, v0, 6, 1
    s_mov_b32 s38, 0x800
    v_mad_u32_u24 v10, v14, s38, v10
    v_bfe_u32 v14, v0, 7, 1
    s_mov_b32 s38, 0x1000
    v_mad_u32_u24 v10, v14, s38, v10
    v_mov_b32 v105, s20
    v_mov_b32 v104, 0x0
    v_bfe_u32 v14, v105, 0, 1
    s_mov_b32 s38, 0x100
    v_mad_u32_u24 v104, v14, s38, v104
    v_bfe_u32 v14, v105, 1, 1
    s_mov_b32 s38, 0x40
    v_mad_u32_u24 v104, v14, s38, v104
    v_bfe_u32 v14, v105, 2, 1
    s_mov_b32 s38, 0x80
    v_mad_u32_u24 v104, v14, s38, v104
    v_bfe_u32 v14, v105, 3, 1
    s_mov_b32 s38, 0x200
    v_mad_u32_u24 v104, v14, s38, v104
    v_bfe_u32 v14, v105, 4, 1
    s_mov_b32 s38, 0x400
    v_mad_u32_u24 v104, v14, s38, v104
    v_add_u32 v10, v104, v10
    v_and_b32 v104, 12, v0
    v_cmp_ne_u32 vcc, 0, v104
    v_mov_b32 v104, 0x40000000
    s_nop 0
    v_cndmask_b32 v10, v10, v104, vcc
    v_mov_b32 v13, 0x0
    v_bfe_u32 v14, v0, 0, 1
    s_mov_b32 s38, 0x10
    v_mad_u32_u24 v13, v14, s38, v13
    v_bfe_u32 v14, v0, 1, 1
    s_mov_b32 s38, 0x8
    v_mad_u32_u24 v13, v14, s38, v13
    v_bfe_u32 v14, v0, 2, 1
    s_mov_b32 s38, 0x20
    v_mad_u32_u24 v13, v14, s38, v13
    v_bfe_u32 v14, v0, 3, 1
    s_mov_b32 s38, 0x40
    v_mad_u32_u24 v13, v14, s38, v13
    v_bfe_u32 v14, v0, 4, 1
    s_mov_b32 s38, 0x80
    v_mad_u32_u24 v13, v14, s38, v13
    v_bfe_u32 v14, v0, 5, 1
    s_mov_b32 s38, 0x100
    v_mad_u32_u24 v13, v14, s38, v13
    v_bfe_u32 v14, v0, 6, 1
    s_mov_b32 s38, 0x800
    v_mad_u32_u24 v13, v14, s38, v13
    v_bfe_u32 v14, v0, 7, 1
    s_mov_b32 s38, 0x1000
    v_mad_u32_u24 v13, v14, s38, v13
    s_lshl_b32 s6, s20, 13
    s_add_u32 s6, s6, 0x0
    s_mov_b32 s26, 4096
    v_and_b32 v104, 15, v0
    v_mov_b32 v100, 0
    v_mov_b32 v105, 0x3f80
    v_cmp_eq_u32 vcc, 0, v104
    s_nop 1
    v_cndmask_b32 v100, v100, v105, vcc
    v_mov_b32 v105, 0x3f800000
    v_cmp_eq_u32 vcc, 1, v104
    s_nop 1
    v_cndmask_b32 v100, v100, v105, vcc
    v_mov_b32 v101, 0
    v_mov_b32 v105, 0x3f80
    v_cmp_eq_u32 vcc, 4, v104
    s_nop 1
    v_cndmask_b32 v101, v101, v105, vcc
    v_mov_b32 v105, 0x3f800000
    v_cmp_eq_u32 vcc, 5, v104
    s_nop 1
    v_cndmask_b32 v101, v101, v105, vcc
    v_mov_b32 v102, 0
    v_mov_b32 v105, 0x3f80
    v_cmp_eq_u32 vcc, 8, v104
    s_nop 1
    v_cndmask_b32 v102, v102, v105, vcc
    v_mov_b32 v105, 0x3f800000
    v_cmp_eq_u32 vcc, 9, v104
    s_nop 1
    v_cndmask_b32 v102, v102, v105, vcc
    v_mov_b32 v103, 0
    v_mov_b32 v105, 0x3f80
    v_cmp_eq_u32 vcc, 12, v104
    s_nop 1
    v_cndmask_b32 v103, v103, v105, vcc
    v_mov_b32 v105, 0x3f800000
    v_cmp_eq_u32 vcc, 13, v104
    s_nop 1
    v_cndmask_b32 v103, v103, v105, vcc
    ds_write_b128 v3, v[100:103] offset:23040
    s_mov_b32 s34, 0x05040100
    s_mov_b32 s35, 0x07060302
    s_mov_b32 s33, 0x3e0293ee
    s_mov_b32 s40, 0x4e800000
    s_mov_b32 s32, 0
    s_mov_b32 s4, 0x3f803f80
    s_mov_b32 s5, 0x3f803f80
    s_lshl_b32 s36, s20, 14
    s_lshr_b32 s37, s21, 1
    s_lshl_b32 s37, s37, 12
    s_add_u32 s25, s36, s37
    s_lshl_b32 s37, s21, 11
    s_add_u32 s39, s36, s37
    s_add_u32 s39, s39, 8192
    v_mov_b32 v104, 0x0
    v_bfe_u32 v14, v0, 0, 1
    s_mov_b32 s38, 0x80
    v_mad_u32_u24 v104, v14, s38, v104
    v_bfe_u32 v14, v0, 1, 1
    s_mov_b32 s38, 0x100
    v_mad_u32_u24 v104, v14, s38, v104
    v_bfe_u32 v14, v0, 2, 1
    s_mov_b32 s38, 0x200
    v_mad_u32_u24 v104, v14, s38, v104
    v_bfe_u32 v14, v0, 3, 1
    s_mov_b32 s38, 0x400
    v_mad_u32_u24 v104, v14, s38, v104
    v_bfe_u32 v14, v0, 4, 1
    s_mov_b32 s38, 0x800
    v_mad_u32_u24 v104, v14, s38, v104
    v_bfe_u32 v14, v0, 6, 1
    s_mov_b32 s38, 0x1000
    v_mad_u32_u24 v104, v14, s38, v104
    v_bfe_u32 v14, v0, 7, 1
    s_mov_b32 s38, 0x2000
    v_mad_u32_u24 v104, v14, s38, v104
    s_lshl_b32 s36, s20, 14
    v_add_u32 v104, s36, v104
    s_lshl_b32 s36, s20, 8
    s_lshr_b32 s37, s21, 1
    s_lshl_b32 s37, s37, 7
    s_add_u32 s36, s36, s37
    s_add_u32 s36, s36, 0x102100
    v_and_b32 v14, 63, v0
    v_mov_b32 v105, 0x40000000
    v_cmp_lt_u32 vcc, 32, v14
    s_nop 1
    v_cndmask_b32 v104, v104, v105, vcc
    v_mov_b32 v105, s36
    v_cmp_eq_u32 vcc, 32, v14
    s_nop 1
    v_cndmask_b32 v104, v104, v105, vcc
    s_lshl_b32 s36, s20, 2
    s_add_u32 s36, s36, 0x104100
    v_mov_b32 v105, s36
    v_cmp_eq_u32 vcc, 33, v14
    s_nop 1
    v_cndmask_b32 v0, v104, v105, vcc
    s_waitcnt vmcnt(36)
    s_barrier
    ds_read_b64_tr_b16 a[160:161], v20 offset:0
    ds_read_b64_tr_b16 a[162:163], v20 offset:512
    ds_read_b64_tr_b16 a[168:169], v21 offset:0
    ds_read_b64_tr_b16 a[170:171], v21 offset:512
    ds_read_b64_tr_b16 a[192:193], v22 offset:0
    ds_read_b64_tr_b16 a[194:195], v22 offset:512
    ds_read_b64_tr_b16 a[200:201], v23 offset:0
    ds_read_b64_tr_b16 a[202:203], v23 offset:512
    ds_read_b64_tr_b16 a[224:225], v24 offset:0
    ds_read_b64_tr_b16 a[226:227], v24 offset:512
    ds_read_b64_tr_b16 a[232:233], v25 offset:0
    ds_read_b64_tr_b16 a[234:235], v25 offset:512
    s_waitcnt lgkmcnt(4)
    ds_read_b64_tr_b16 v[128:129], v26 offset:0
    ds_read_b64_tr_b16 v[130:131], v26 offset:512
    ds_read_b64_tr_b16 v[136:137], v27 offset:0
    ds_read_b64_tr_b16 v[138:139], v27 offset:512
    s_waitcnt lgkmcnt(0)
    s_barrier
    s_add_u32 m0, s28, 0
    s_add_u32 s37, s3, 0x300000
    buffer_load_dwordx4 v16, s[60:63], s37 offen lds
    s_add_u32 m0, s28, 1024
    s_add_u32 s37, s3, 0x308000
    buffer_load_dwordx4 v17, s[60:63], s37 offen lds
    s_add_u32 m0, s28, 2048
    s_add_u32 s37, s3, 0x310000
    buffer_load_dwordx4 v18, s[60:63], s37 offen lds
    s_add_u32 m0, s28, 3072
    s_add_u32 s37, s3, 0x318000
    buffer_load_dwordx4 v19, s[60:63], s37 offen lds
    s_add_u32 m0, s28, 4096
    s_add_u32 s37, s3, 0x320000
    buffer_load_dwordx4 v16, s[60:63], s37 offen lds
    s_add_u32 m0, s28, 5120
    s_add_u32 s37, s3, 0x328000
    buffer_load_dwordx4 v17, s[60:63], s37 offen lds
    s_add_u32 m0, s28, 6144
    s_add_u32 s37, s3, 0x330000
    buffer_load_dwordx4 v18, s[60:63], s37 offen lds
    s_add_u32 m0, s28, 7168
    s_add_u32 s37, s3, 0x338000
    buffer_load_dwordx4 v19, s[60:63], s37 offen lds
    s_xor_b32 s36, s21, 2
    s_lshl_b32 s36, s36, 15
    s_add_u32 s36, s36, s29
    s_add_u32 s37, s36, 0x80
    buffer_load_dword v48, v11, s[92:95], s37 offen
    s_add_u32 s37, s36, 0x4080
    buffer_load_dword v49, v11, s[92:95], s37 offen
    s_add_u32 s37, s36, 0x480
    buffer_load_dword v50, v11, s[92:95], s37 offen
    s_add_u32 s37, s36, 0x4480
    buffer_load_dword v51, v11, s[92:95], s37 offen
    s_add_u32 s37, s36, 0x2080
    buffer_load_dword v52, v11, s[92:95], s37 offen
    s_add_u32 s37, s36, 0x6080
    buffer_load_dword v53, v11, s[92:95], s37 offen
    s_add_u32 s37, s36, 0x2480
    buffer_load_dword v54, v11, s[92:95], s37 offen
    s_add_u32 s37, s36, 0x6480
    buffer_load_dword v55, v11, s[92:95], s37 offen
    s_add_u32 s37, s36, 0xc0
    buffer_load_dword v56, v11, s[92:95], s37 offen
    s_add_u32 s37, s36, 0x40c0
    buffer_load_dword v57, v11, s[92:95], s37 offen
    s_add_u32 s37, s36, 0x4c0
    buffer_load_dword v58, v11, s[92:95], s37 offen
    s_add_u32 s37, s36, 0x44c0
    buffer_load_dword v59, v11, s[92:95], s37 offen
    s_add_u32 s37, s36, 0x20c0
    buffer_load_dword v60, v11, s[92:95], s37 offen
    s_add_u32 s37, s36, 0x60c0
    buffer_load_dword v61, v11, s[92:95], s37 offen
    s_add_u32 s37, s36, 0x24c0
    buffer_load_dword v62, v11, s[92:95], s37 offen
    s_add_u32 s37, s36, 0x64c0
    buffer_load_dword v63, v11, s[92:95], s37 offen
    s_waitcnt vmcnt(52)
    s_barrier
    ds_read_b64_tr_b16 a[164:165], v20 offset:8192
    ds_read_b64_tr_b16 a[166:167], v20 offset:8704
    ds_read_b64_tr_b16 a[172:173], v21 offset:8192
    ds_read_b64_tr_b16 a[174:175], v21 offset:8704
    ds_read_b64_tr_b16 a[196:197], v22 offset:8192
    ds_read_b64_tr_b16 a[198:199], v22 offset:8704
    ds_read_b64_tr_b16 a[204:205], v23 offset:8192
    ds_read_b64_tr_b16 a[206:207], v23 offset:8704
    ds_read_b64_tr_b16 a[228:229], v24 offset:8192
    ds_read_b64_tr_b16 a[230:231], v24 offset:8704
    ds_read_b64_tr_b16 a[236:237], v25 offset:8192
    ds_read_b64_tr_b16 a[238:239], v25 offset:8704
    s_waitcnt lgkmcnt(4)
    ds_read_b64_tr_b16 v[132:133], v26 offset:8192
    ds_read_b64_tr_b16 v[134:135], v26 offset:8704
    ds_read_b64_tr_b16 v[140:141], v27 offset:8192
    ds_read_b64_tr_b16 v[142:143], v27 offset:8704
    s_waitcnt lgkmcnt(0)
    s_barrier
    s_mov_b32 s88, s50
    s_and_b32 s89, s51, 0xffff
    s_mov_b32 s90, 0x400000
    s_mov_b32 s91, 0x20000
    s_add_u32 m0, s28, 8192
    s_add_u32 s37, s3, 0x0
    buffer_load_dwordx4 v16, s[88:91], s37 offen lds
    s_add_u32 m0, s28, 9216
    s_add_u32 s37, s3, 0x8000
    buffer_load_dwordx4 v17, s[88:91], s37 offen lds
    s_add_u32 m0, s28, 10240
    s_add_u32 s37, s3, 0x10000
    buffer_load_dwordx4 v18, s[88:91], s37 offen lds
    s_add_u32 m0, s28, 11264
    s_add_u32 s37, s3, 0x18000
    buffer_load_dwordx4 v19, s[88:91], s37 offen lds
    s_add_u32 m0, s28, 12288
    s_add_u32 s37, s3, 0x20000
    buffer_load_dwordx4 v16, s[88:91], s37 offen lds
    s_add_u32 m0, s28, 13312
    s_add_u32 s37, s3, 0x28000
    buffer_load_dwordx4 v17, s[88:91], s37 offen lds
    s_add_u32 m0, s28, 14336
    s_add_u32 s37, s3, 0x30000
    buffer_load_dwordx4 v18, s[88:91], s37 offen lds
    s_add_u32 m0, s28, 15360
    s_add_u32 s37, s3, 0x38000
    buffer_load_dwordx4 v19, s[88:91], s37 offen lds
    s_waitcnt vmcnt(36)
    v_perm_b32 v120, v33, v32, s34
    v_perm_b32 v121, v33, v32, s35
    v_perm_b32 v122, v35, v34, s34
    v_perm_b32 v123, v35, v34, s35
    v_perm_b32 v124, v37, v36, s34
    v_perm_b32 v125, v37, v36, s35
    v_perm_b32 v126, v39, v38, s34
    v_perm_b32 v127, v39, v38, s35
    ds_write_b128 v4, v[120:123] offset:24576
    ds_write_b128 v4, v[124:127] offset:25600
    s_waitcnt lgkmcnt(0)
    v_perm_b32 v120, v41, v40, s34
    v_perm_b32 v121, v41, v40, s35
    v_perm_b32 v122, v43, v42, s34
    v_perm_b32 v123, v43, v42, s35
    v_perm_b32 v124, v45, v44, s34
    v_perm_b32 v125, v45, v44, s35
    v_perm_b32 v126, v47, v46, s34
    v_perm_b32 v127, v47, v46, s35
    ds_write_b128 v4, v[120:123] offset:30720
    ds_write_b128 v4, v[124:127] offset:31744
    s_waitcnt lgkmcnt(0)
    s_xor_b32 s36, s21, 1
    s_lshl_b32 s36, s36, 15
    s_add_u32 s36, s36, s29
    s_add_u32 s37, s36, 0x80
    buffer_load_dword v80, v11, s[92:95], s37 offen
    s_add_u32 s37, s36, 0x4080
    buffer_load_dword v81, v11, s[92:95], s37 offen
    s_add_u32 s37, s36, 0x480
    buffer_load_dword v82, v11, s[92:95], s37 offen
    s_add_u32 s37, s36, 0x4480
    buffer_load_dword v83, v11, s[92:95], s37 offen
    s_add_u32 s37, s36, 0x2080
    buffer_load_dword v84, v11, s[92:95], s37 offen
    s_add_u32 s37, s36, 0x6080
    buffer_load_dword v85, v11, s[92:95], s37 offen
    s_add_u32 s37, s36, 0x2480
    buffer_load_dword v86, v11, s[92:95], s37 offen
    s_add_u32 s37, s36, 0x6480
    buffer_load_dword v87, v11, s[92:95], s37 offen
    s_add_u32 s37, s36, 0xc0
    buffer_load_dword v88, v11, s[92:95], s37 offen
    s_add_u32 s37, s36, 0x40c0
    buffer_load_dword v89, v11, s[92:95], s37 offen
    s_add_u32 s37, s36, 0x4c0
    buffer_load_dword v90, v11, s[92:95], s37 offen
    s_add_u32 s37, s36, 0x44c0
    buffer_load_dword v91, v11, s[92:95], s37 offen
    s_add_u32 s37, s36, 0x20c0
    buffer_load_dword v92, v11, s[92:95], s37 offen
    s_add_u32 s37, s36, 0x60c0
    buffer_load_dword v93, v11, s[92:95], s37 offen
    s_add_u32 s37, s36, 0x24c0
    buffer_load_dword v94, v11, s[92:95], s37 offen
    s_add_u32 s37, s36, 0x64c0
    buffer_load_dword v95, v11, s[92:95], s37 offen
    s_barrier
    ds_read_b64_tr_b16 a[176:177], v20 offset:16384
    ds_read_b64_tr_b16 a[178:179], v20 offset:16896
    ds_read_b64_tr_b16 a[184:185], v21 offset:16384
    ds_read_b64_tr_b16 a[186:187], v21 offset:16896
    ds_read_b64_tr_b16 a[208:209], v22 offset:16384
    ds_read_b64_tr_b16 a[210:211], v22 offset:16896
    ds_read_b64_tr_b16 a[216:217], v23 offset:16384
    ds_read_b64_tr_b16 a[218:219], v23 offset:16896
    ds_read_b64_tr_b16 a[240:241], v24 offset:16384
    ds_read_b64_tr_b16 a[242:243], v24 offset:16896
    ds_read_b64_tr_b16 a[248:249], v25 offset:16384
    ds_read_b64_tr_b16 a[250:251], v25 offset:16896
    s_waitcnt lgkmcnt(4)
    ds_read_b64_tr_b16 v[144:145], v26 offset:16384
    ds_read_b64_tr_b16 v[146:147], v26 offset:16896
    ds_read_b64_tr_b16 v[152:153], v27 offset:16384
    ds_read_b64_tr_b16 v[154:155], v27 offset:16896
    s_waitcnt lgkmcnt(0)
    s_barrier
    s_add_u32 m0, s28, 16384
    s_add_u32 s37, s3, 0x100000
    buffer_load_dwordx4 v16, s[88:91], s37 offen lds
    s_add_u32 m0, s28, 17408
    s_add_u32 s37, s3, 0x108000
    buffer_load_dwordx4 v17, s[88:91], s37 offen lds
    s_add_u32 m0, s28, 18432
    s_add_u32 s37, s3, 0x110000
    buffer_load_dwordx4 v18, s[88:91], s37 offen lds
    s_add_u32 m0, s28, 19456
    s_add_u32 s37, s3, 0x118000
    buffer_load_dwordx4 v19, s[88:91], s37 offen lds
    s_add_u32 m0, s28, 20480
    s_add_u32 s37, s3, 0x120000
    buffer_load_dwordx4 v16, s[88:91], s37 offen lds
    s_add_u32 m0, s28, 21504
    s_add_u32 s37, s3, 0x128000
    buffer_load_dwordx4 v17, s[88:91], s37 offen lds
    s_add_u32 m0, s28, 22528
    s_add_u32 s37, s3, 0x130000
    buffer_load_dwordx4 v18, s[88:91], s37 offen lds
    s_add_u32 m0, s28, 23552
    s_add_u32 s37, s3, 0x138000
    buffer_load_dwordx4 v19, s[88:91], s37 offen lds
    s_waitcnt vmcnt(32)
    v_perm_b32 v232, v49, v48, s34
    v_perm_b32 v233, v49, v48, s35
    v_perm_b32 v234, v51, v50, s34
    v_perm_b32 v235, v51, v50, s35
    v_perm_b32 v236, v53, v52, s34
    v_perm_b32 v237, v53, v52, s35
    v_perm_b32 v238, v55, v54, s34
    v_perm_b32 v239, v55, v54, s35
    v_perm_b32 v120, v57, v56, s34
    v_perm_b32 v121, v57, v56, s35
    v_perm_b32 v122, v59, v58, s34
    v_perm_b32 v123, v59, v58, s35
    v_perm_b32 v124, v61, v60, s34
    v_perm_b32 v125, v61, v60, s35
    v_perm_b32 v126, v63, v62, s34
    v_perm_b32 v127, v63, v62, s35
    ds_write_b128 v4, v[120:123] offset:28672
    ds_write_b128 v4, v[124:127] offset:29696
    s_waitcnt lgkmcnt(0)
    s_xor_b32 s36, s21, 3
    s_lshl_b32 s36, s36, 15
    s_add_u32 s36, s36, s29
    s_add_u32 s37, s36, 0x0
    buffer_load_dword v32, v11, s[92:95], s37 offen
    s_add_u32 s37, s36, 0x4000
    buffer_load_dword v33, v11, s[92:95], s37 offen
    s_add_u32 s37, s36, 0x400
    buffer_load_dword v34, v11, s[92:95], s37 offen
    s_add_u32 s37, s36, 0x4400
    buffer_load_dword v35, v11, s[92:95], s37 offen
    s_add_u32 s37, s36, 0x2000
    buffer_load_dword v36, v11, s[92:95], s37 offen
    s_add_u32 s37, s36, 0x6000
    buffer_load_dword v37, v11, s[92:95], s37 offen
    s_add_u32 s37, s36, 0x2400
    buffer_load_dword v38, v11, s[92:95], s37 offen
    s_add_u32 s37, s36, 0x6400
    buffer_load_dword v39, v11, s[92:95], s37 offen
    s_add_u32 s37, s36, 0x40
    buffer_load_dword v40, v11, s[92:95], s37 offen
    s_add_u32 s37, s36, 0x4040
    buffer_load_dword v41, v11, s[92:95], s37 offen
    s_add_u32 s37, s36, 0x440
    buffer_load_dword v42, v11, s[92:95], s37 offen
    s_add_u32 s37, s36, 0x4440
    buffer_load_dword v43, v11, s[92:95], s37 offen
    s_add_u32 s37, s36, 0x2040
    buffer_load_dword v44, v11, s[92:95], s37 offen
    s_add_u32 s37, s36, 0x6040
    buffer_load_dword v45, v11, s[92:95], s37 offen
    s_add_u32 s37, s36, 0x2440
    buffer_load_dword v46, v11, s[92:95], s37 offen
    s_add_u32 s37, s36, 0x6440
    buffer_load_dword v47, v11, s[92:95], s37 offen
    s_barrier
    ds_read_b64_tr_b16 a[180:181], v20 offset:0
    ds_read_b64_tr_b16 a[182:183], v20 offset:512
    ds_read_b64_tr_b16 a[188:189], v21 offset:0
    ds_read_b64_tr_b16 a[190:191], v21 offset:512
    ds_read_b64_tr_b16 a[212:213], v22 offset:0
    ds_read_b64_tr_b16 a[214:215], v22 offset:512
    ds_read_b64_tr_b16 a[220:221], v23 offset:0
    ds_read_b64_tr_b16 a[222:223], v23 offset:512
    ds_read_b64_tr_b16 a[244:245], v24 offset:0
    ds_read_b64_tr_b16 a[246:247], v24 offset:512
    ds_read_b64_tr_b16 a[252:253], v25 offset:0
    ds_read_b64_tr_b16 a[254:255], v25 offset:512
    s_waitcnt lgkmcnt(4)
    ds_read_b64_tr_b16 v[148:149], v26 offset:0
    ds_read_b64_tr_b16 v[150:151], v26 offset:512
    ds_read_b64_tr_b16 v[156:157], v27 offset:0
    ds_read_b64_tr_b16 v[158:159], v27 offset:512
    s_waitcnt lgkmcnt(0)
    s_barrier
    s_add_u32 m0, s28, 0
    s_add_u32 s37, s3, 0x200000
    buffer_load_dwordx4 v16, s[88:91], s37 offen lds
    s_add_u32 m0, s28, 1024
    s_add_u32 s37, s3, 0x208000
    buffer_load_dwordx4 v17, s[88:91], s37 offen lds
    s_add_u32 m0, s28, 2048
    s_add_u32 s37, s3, 0x210000
    buffer_load_dwordx4 v18, s[88:91], s37 offen lds
    s_add_u32 m0, s28, 3072
    s_add_u32 s37, s3, 0x218000
    buffer_load_dwordx4 v19, s[88:91], s37 offen lds
    s_add_u32 m0, s28, 4096
    s_add_u32 s37, s3, 0x220000
    buffer_load_dwordx4 v16, s[88:91], s37 offen lds
    s_add_u32 m0, s28, 5120
    s_add_u32 s37, s3, 0x228000
    buffer_load_dwordx4 v17, s[88:91], s37 offen lds
    s_add_u32 m0, s28, 6144
    s_add_u32 s37, s3, 0x230000
    buffer_load_dwordx4 v18, s[88:91], s37 offen lds
    s_add_u32 m0, s28, 7168
    s_add_u32 s37, s3, 0x238000
    buffer_load_dwordx4 v19, s[88:91], s37 offen lds
    s_waitcnt vmcnt(32)
    v_perm_b32 v208, v81, v80, s34
    v_perm_b32 v209, v81, v80, s35
    v_perm_b32 v210, v83, v82, s34
    v_perm_b32 v211, v83, v82, s35
    v_perm_b32 v212, v85, v84, s34
    v_perm_b32 v213, v85, v84, s35
    v_perm_b32 v214, v87, v86, s34
    v_perm_b32 v215, v87, v86, s35
    v_perm_b32 v120, v89, v88, s34
    v_perm_b32 v121, v89, v88, s35
    v_perm_b32 v122, v91, v90, s34
    v_perm_b32 v123, v91, v90, s35
    v_perm_b32 v124, v93, v92, s34
    v_perm_b32 v125, v93, v92, s35
    v_perm_b32 v126, v95, v94, s34
    v_perm_b32 v127, v95, v94, s35
    ds_write_b128 v4, v[120:123] offset:26624
    ds_write_b128 v4, v[124:127] offset:27648
    s_waitcnt lgkmcnt(0)
    s_xor_b32 s36, s21, 2
    s_lshl_b32 s36, s36, 15
    s_add_u32 s36, s36, s29
    s_add_u32 s37, s36, 0x0
    buffer_load_dword v48, v11, s[92:95], s37 offen
    s_add_u32 s37, s36, 0x4000
    buffer_load_dword v49, v11, s[92:95], s37 offen
    s_add_u32 s37, s36, 0x400
    buffer_load_dword v50, v11, s[92:95], s37 offen
    s_add_u32 s37, s36, 0x4400
    buffer_load_dword v51, v11, s[92:95], s37 offen
    s_add_u32 s37, s36, 0x2000
    buffer_load_dword v52, v11, s[92:95], s37 offen
    s_add_u32 s37, s36, 0x6000
    buffer_load_dword v53, v11, s[92:95], s37 offen
    s_add_u32 s37, s36, 0x2400
    buffer_load_dword v54, v11, s[92:95], s37 offen
    s_add_u32 s37, s36, 0x6400
    buffer_load_dword v55, v11, s[92:95], s37 offen
    s_add_u32 s37, s36, 0x40
    buffer_load_dword v56, v11, s[92:95], s37 offen
    s_add_u32 s37, s36, 0x4040
    buffer_load_dword v57, v11, s[92:95], s37 offen
    s_add_u32 s37, s36, 0x440
    buffer_load_dword v58, v11, s[92:95], s37 offen
    s_add_u32 s37, s36, 0x4440
    buffer_load_dword v59, v11, s[92:95], s37 offen
    s_add_u32 s37, s36, 0x2040
    buffer_load_dword v60, v11, s[92:95], s37 offen
    s_add_u32 s37, s36, 0x6040
    buffer_load_dword v61, v11, s[92:95], s37 offen
    s_add_u32 s37, s36, 0x2440
    buffer_load_dword v62, v11, s[92:95], s37 offen
    s_add_u32 s37, s36, 0x6440
    buffer_load_dword v63, v11, s[92:95], s37 offen
    s_barrier
    ds_read_b64_tr_b16 v[64:65], v20 offset:8192
    ds_read_b64_tr_b16 v[66:67], v20 offset:8704
    ds_read_b64_tr_b16 v[72:73], v21 offset:8192
    ds_read_b64_tr_b16 v[74:75], v21 offset:8704
    ds_read_b64_tr_b16 v[96:97], v22 offset:8192
    ds_read_b64_tr_b16 v[98:99], v22 offset:8704
    ds_read_b64_tr_b16 v[104:105], v23 offset:8192
    ds_read_b64_tr_b16 v[106:107], v23 offset:8704
    ds_read_b64_tr_b16 a[112:113], v24 offset:8192
    ds_read_b64_tr_b16 a[114:115], v24 offset:8704
    ds_read_b64_tr_b16 a[120:121], v25 offset:8192
    ds_read_b64_tr_b16 a[122:123], v25 offset:8704
    s_waitcnt lgkmcnt(4)
    ds_read_b64_tr_b16 a[144:145], v26 offset:8192
    ds_read_b64_tr_b16 a[146:147], v26 offset:8704
    ds_read_b64_tr_b16 a[152:153], v27 offset:8192
    ds_read_b64_tr_b16 a[154:155], v27 offset:8704
    s_waitcnt lgkmcnt(0)
    s_barrier
    s_add_u32 m0, s28, 8192
    s_add_u32 s37, s3, 0x300000
    buffer_load_dwordx4 v16, s[88:91], s37 offen lds
    s_add_u32 m0, s28, 9216
    s_add_u32 s37, s3, 0x308000
    buffer_load_dwordx4 v17, s[88:91], s37 offen lds
    s_add_u32 m0, s28, 10240
    s_add_u32 s37, s3, 0x310000
    buffer_load_dwordx4 v18, s[88:91], s37 offen lds
    s_add_u32 m0, s28, 11264
    s_add_u32 s37, s3, 0x318000
    buffer_load_dwordx4 v19, s[88:91], s37 offen lds
    s_add_u32 m0, s28, 12288
    s_add_u32 s37, s3, 0x320000
    buffer_load_dwordx4 v16, s[88:91], s37 offen lds
    s_add_u32 m0, s28, 13312
    s_add_u32 s37, s3, 0x328000
    buffer_load_dwordx4 v17, s[88:91], s37 offen lds
    s_add_u32 m0, s28, 14336
    s_add_u32 s37, s3, 0x330000
    buffer_load_dwordx4 v18, s[88:91], s37 offen lds
    s_add_u32 m0, s28, 15360
    s_add_u32 s37, s3, 0x338000
    buffer_load_dwordx4 v19, s[88:91], s37 offen lds
    s_waitcnt vmcnt(32)
    v_perm_b32 v240, v33, v32, s34
    v_perm_b32 v241, v33, v32, s35
    v_perm_b32 v242, v35, v34, s34
    v_perm_b32 v243, v35, v34, s35
    v_perm_b32 v244, v37, v36, s34
    v_perm_b32 v245, v37, v36, s35
    v_perm_b32 v246, v39, v38, s34
    v_perm_b32 v247, v39, v38, s35
    v_perm_b32 v248, v41, v40, s34
    v_perm_b32 v249, v41, v40, s35
    v_perm_b32 v250, v43, v42, s34
    v_perm_b32 v251, v43, v42, s35
    v_perm_b32 v252, v45, v44, s34
    v_perm_b32 v253, v45, v44, s35
    v_perm_b32 v254, v47, v46, s34
    v_perm_b32 v255, v47, v46, s35
    s_xor_b32 s36, s21, 1
    s_lshl_b32 s36, s36, 15
    s_add_u32 s36, s36, s29
    s_add_u32 s37, s36, 0x0
    buffer_load_dword v80, v11, s[92:95], s37 offen
    s_add_u32 s37, s36, 0x4000
    buffer_load_dword v81, v11, s[92:95], s37 offen
    s_add_u32 s37, s36, 0x400
    buffer_load_dword v82, v11, s[92:95], s37 offen
    s_add_u32 s37, s36, 0x4400
    buffer_load_dword v83, v11, s[92:95], s37 offen
    s_add_u32 s37, s36, 0x2000
    buffer_load_dword v84, v11, s[92:95], s37 offen
    s_add_u32 s37, s36, 0x6000
    buffer_load_dword v85, v11, s[92:95], s37 offen
    s_add_u32 s37, s36, 0x2400
    buffer_load_dword v86, v11, s[92:95], s37 offen
    s_add_u32 s37, s36, 0x6400
    buffer_load_dword v87, v11, s[92:95], s37 offen
    s_add_u32 s37, s36, 0x40
    buffer_load_dword v88, v11, s[92:95], s37 offen
    s_add_u32 s37, s36, 0x4040
    buffer_load_dword v89, v11, s[92:95], s37 offen
    s_add_u32 s37, s36, 0x440
    buffer_load_dword v90, v11, s[92:95], s37 offen
    s_add_u32 s37, s36, 0x4440
    buffer_load_dword v91, v11, s[92:95], s37 offen
    s_add_u32 s37, s36, 0x2040
    buffer_load_dword v92, v11, s[92:95], s37 offen
    s_add_u32 s37, s36, 0x6040
    buffer_load_dword v93, v11, s[92:95], s37 offen
    s_add_u32 s37, s36, 0x2440
    buffer_load_dword v94, v11, s[92:95], s37 offen
    s_add_u32 s37, s36, 0x6440
    buffer_load_dword v95, v11, s[92:95], s37 offen
    s_barrier
    ds_read_b64_tr_b16 v[68:69], v20 offset:16384
    ds_read_b64_tr_b16 v[70:71], v20 offset:16896
    ds_read_b64_tr_b16 v[76:77], v21 offset:16384
    ds_read_b64_tr_b16 v[78:79], v21 offset:16896
    ds_read_b64_tr_b16 v[100:101], v22 offset:16384
    ds_read_b64_tr_b16 v[102:103], v22 offset:16896
    ds_read_b64_tr_b16 v[108:109], v23 offset:16384
    ds_read_b64_tr_b16 v[110:111], v23 offset:16896
    ds_read_b64_tr_b16 a[116:117], v24 offset:16384
    ds_read_b64_tr_b16 a[118:119], v24 offset:16896
    ds_read_b64_tr_b16 a[124:125], v25 offset:16384
    ds_read_b64_tr_b16 a[126:127], v25 offset:16896
    s_waitcnt lgkmcnt(4)
    ds_read_b64_tr_b16 a[148:149], v26 offset:16384
    ds_read_b64_tr_b16 a[150:151], v26 offset:16896
    ds_read_b64_tr_b16 a[156:157], v27 offset:16384
    ds_read_b64_tr_b16 a[158:159], v27 offset:16896
    s_waitcnt lgkmcnt(0)
    s_barrier
    s_mov_b32 s96, s48
    s_and_b32 s97, s49, 0xffff
    s_mov_b32 s98, 0x400000
    s_mov_b32 s99, 0x20000
    s_add_u32 m0, s28, 16384
    s_add_u32 s37, s3, 0x0
    buffer_load_dwordx4 v16, s[96:99], s37 offen lds
    s_add_u32 m0, s28, 17408
    s_add_u32 s37, s3, 0x8000
    buffer_load_dwordx4 v17, s[96:99], s37 offen lds
    s_add_u32 m0, s28, 18432
    s_add_u32 s37, s3, 0x10000
    buffer_load_dwordx4 v18, s[96:99], s37 offen lds
    s_add_u32 m0, s28, 19456
    s_add_u32 s37, s3, 0x18000
    buffer_load_dwordx4 v19, s[96:99], s37 offen lds
    s_add_u32 m0, s28, 20480
    s_add_u32 s37, s3, 0x20000
    buffer_load_dwordx4 v16, s[96:99], s37 offen lds
    s_add_u32 m0, s28, 21504
    s_add_u32 s37, s3, 0x28000
    buffer_load_dwordx4 v17, s[96:99], s37 offen lds
    s_add_u32 m0, s28, 22528
    s_add_u32 s37, s3, 0x30000
    buffer_load_dwordx4 v18, s[96:99], s37 offen lds
    s_add_u32 m0, s28, 23552
    s_add_u32 s37, s3, 0x38000
    buffer_load_dwordx4 v19, s[96:99], s37 offen lds
    s_waitcnt vmcnt(32)
    v_perm_b32 v216, v49, v48, s34
    v_perm_b32 v217, v49, v48, s35
    v_perm_b32 v218, v51, v50, s34
    v_perm_b32 v219, v51, v50, s35
    v_perm_b32 v220, v53, v52, s34
    v_perm_b32 v221, v53, v52, s35
    v_perm_b32 v222, v55, v54, s34
    v_perm_b32 v223, v55, v54, s35
    v_perm_b32 v224, v57, v56, s34
    v_perm_b32 v225, v57, v56, s35
    v_perm_b32 v226, v59, v58, s34
    v_perm_b32 v227, v59, v58, s35
    v_perm_b32 v228, v61, v60, s34
    v_perm_b32 v229, v61, v60, s35
    v_perm_b32 v230, v63, v62, s34
    v_perm_b32 v231, v63, v62, s35
    s_xor_b32 s36, s21, 0
    s_lshl_b32 s36, s36, 15
    s_add_u32 s36, s36, s29
    s_add_u32 s37, s36, 0x80
    buffer_load_dword v32, v11, s[92:95], s37 offen
    s_add_u32 s37, s36, 0x4080
    buffer_load_dword v33, v11, s[92:95], s37 offen
    s_add_u32 s37, s36, 0x480
    buffer_load_dword v34, v11, s[92:95], s37 offen
    s_add_u32 s37, s36, 0x4480
    buffer_load_dword v35, v11, s[92:95], s37 offen
    s_add_u32 s37, s36, 0x2080
    buffer_load_dword v36, v11, s[92:95], s37 offen
    s_add_u32 s37, s36, 0x6080
    buffer_load_dword v37, v11, s[92:95], s37 offen
    s_add_u32 s37, s36, 0x2480
    buffer_load_dword v38, v11, s[92:95], s37 offen
    s_add_u32 s37, s36, 0x6480
    buffer_load_dword v39, v11, s[92:95], s37 offen
    s_add_u32 s37, s36, 0xc0
    buffer_load_dword v40, v11, s[92:95], s37 offen
    s_add_u32 s37, s36, 0x40c0
    buffer_load_dword v41, v11, s[92:95], s37 offen
    s_add_u32 s37, s36, 0x4c0
    buffer_load_dword v42, v11, s[92:95], s37 offen
    s_add_u32 s37, s36, 0x44c0
    buffer_load_dword v43, v11, s[92:95], s37 offen
    s_add_u32 s37, s36, 0x20c0
    buffer_load_dword v44, v11, s[92:95], s37 offen
    s_add_u32 s37, s36, 0x60c0
    buffer_load_dword v45, v11, s[92:95], s37 offen
    s_add_u32 s37, s36, 0x24c0
    buffer_load_dword v46, v11, s[92:95], s37 offen
    s_add_u32 s37, s36, 0x64c0
    buffer_load_dword v47, v11, s[92:95], s37 offen
    s_barrier
    ds_read_b64_tr_b16 a[80:81], v20 offset:0
    ds_read_b64_tr_b16 a[82:83], v20 offset:512
    ds_read_b64_tr_b16 a[88:89], v21 offset:0
    ds_read_b64_tr_b16 a[90:91], v21 offset:512
    ds_read_b64_tr_b16 a[96:97], v22 offset:0
    ds_read_b64_tr_b16 a[98:99], v22 offset:512
    ds_read_b64_tr_b16 a[104:105], v23 offset:0
    ds_read_b64_tr_b16 a[106:107], v23 offset:512
    ds_read_b64_tr_b16 a[128:129], v24 offset:0
    ds_read_b64_tr_b16 a[130:131], v24 offset:512
    ds_read_b64_tr_b16 a[136:137], v25 offset:0
    ds_read_b64_tr_b16 a[138:139], v25 offset:512
    s_waitcnt lgkmcnt(4)
    ds_read_b64_tr_b16 v[112:113], v26 offset:0
    ds_read_b64_tr_b16 v[114:115], v26 offset:512
    ds_read_b64_tr_b16 v[120:121], v27 offset:0
    ds_read_b64_tr_b16 v[122:123], v27 offset:512
    s_waitcnt lgkmcnt(0)
    s_barrier
    s_add_u32 m0, s28, 0
    s_add_u32 s37, s3, 0x100000
    buffer_load_dwordx4 v16, s[96:99], s37 offen lds
    s_add_u32 m0, s28, 1024
    s_add_u32 s37, s3, 0x108000
    buffer_load_dwordx4 v17, s[96:99], s37 offen lds
    s_add_u32 m0, s28, 2048
    s_add_u32 s37, s3, 0x110000
    buffer_load_dwordx4 v18, s[96:99], s37 offen lds
    s_add_u32 m0, s28, 3072
    s_add_u32 s37, s3, 0x118000
    buffer_load_dwordx4 v19, s[96:99], s37 offen lds
    s_add_u32 m0, s28, 4096
    s_add_u32 s37, s3, 0x120000
    buffer_load_dwordx4 v16, s[96:99], s37 offen lds
    s_add_u32 m0, s28, 5120
    s_add_u32 s37, s3, 0x128000
    buffer_load_dwordx4 v17, s[96:99], s37 offen lds
    s_add_u32 m0, s28, 6144
    s_add_u32 s37, s3, 0x130000
    buffer_load_dwordx4 v18, s[96:99], s37 offen lds
    s_add_u32 m0, s28, 7168
    s_add_u32 s37, s3, 0x138000
    buffer_load_dwordx4 v19, s[96:99], s37 offen lds
    s_waitcnt vmcnt(32)
    v_perm_b32 v192, v81, v80, s34
    v_perm_b32 v193, v81, v80, s35
    v_perm_b32 v194, v83, v82, s34
    v_perm_b32 v195, v83, v82, s35
    v_perm_b32 v196, v85, v84, s34
    v_perm_b32 v197, v85, v84, s35
    v_perm_b32 v198, v87, v86, s34
    v_perm_b32 v199, v87, v86, s35
    v_perm_b32 v200, v89, v88, s34
    v_perm_b32 v201, v89, v88, s35
    v_perm_b32 v202, v91, v90, s34
    v_perm_b32 v203, v91, v90, s35
    v_perm_b32 v204, v93, v92, s34
    v_perm_b32 v205, v93, v92, s35
    v_perm_b32 v206, v95, v94, s34
    v_perm_b32 v207, v95, v94, s35
    s_xor_b32 s36, s21, 0
    s_lshl_b32 s36, s36, 15
    s_add_u32 s36, s36, s29
    s_add_u32 s37, s36, 0x0
    buffer_load_dword v48, v11, s[92:95], s37 offen
    s_add_u32 s37, s36, 0x4000
    buffer_load_dword v49, v11, s[92:95], s37 offen
    s_add_u32 s37, s36, 0x400
    buffer_load_dword v50, v11, s[92:95], s37 offen
    s_add_u32 s37, s36, 0x4400
    buffer_load_dword v51, v11, s[92:95], s37 offen
    s_add_u32 s37, s36, 0x2000
    buffer_load_dword v52, v11, s[92:95], s37 offen
    s_add_u32 s37, s36, 0x6000
    buffer_load_dword v53, v11, s[92:95], s37 offen
    s_add_u32 s37, s36, 0x2400
    buffer_load_dword v54, v11, s[92:95], s37 offen
    s_add_u32 s37, s36, 0x6400
    buffer_load_dword v55, v11, s[92:95], s37 offen
    s_add_u32 s37, s36, 0x40
    buffer_load_dword v56, v11, s[92:95], s37 offen
    s_add_u32 s37, s36, 0x4040
    buffer_load_dword v57, v11, s[92:95], s37 offen
    s_add_u32 s37, s36, 0x440
    buffer_load_dword v58, v11, s[92:95], s37 offen
    s_add_u32 s37, s36, 0x4440
    buffer_load_dword v59, v11, s[92:95], s37 offen
    s_add_u32 s37, s36, 0x2040
    buffer_load_dword v60, v11, s[92:95], s37 offen
    s_add_u32 s37, s36, 0x6040
    buffer_load_dword v61, v11, s[92:95], s37 offen
    s_add_u32 s37, s36, 0x2440
    buffer_load_dword v62, v11, s[92:95], s37 offen
    s_add_u32 s37, s36, 0x6440
    buffer_load_dword v63, v11, s[92:95], s37 offen
    s_barrier
    ds_read_b64_tr_b16 a[84:85], v20 offset:8192
    ds_read_b64_tr_b16 a[86:87], v20 offset:8704
    ds_read_b64_tr_b16 a[92:93], v21 offset:8192
    ds_read_b64_tr_b16 a[94:95], v21 offset:8704
    ds_read_b64_tr_b16 a[100:101], v22 offset:8192
    ds_read_b64_tr_b16 a[102:103], v22 offset:8704
    ds_read_b64_tr_b16 a[108:109], v23 offset:8192
    ds_read_b64_tr_b16 a[110:111], v23 offset:8704
    ds_read_b64_tr_b16 a[132:133], v24 offset:8192
    ds_read_b64_tr_b16 a[134:135], v24 offset:8704
    ds_read_b64_tr_b16 a[140:141], v25 offset:8192
    ds_read_b64_tr_b16 a[142:143], v25 offset:8704
    s_waitcnt lgkmcnt(4)
    ds_read_b64_tr_b16 v[116:117], v26 offset:8192
    ds_read_b64_tr_b16 v[118:119], v26 offset:8704
    ds_read_b64_tr_b16 v[124:125], v27 offset:8192
    ds_read_b64_tr_b16 v[126:127], v27 offset:8704
    s_waitcnt lgkmcnt(0)
    s_barrier
    s_add_u32 m0, s28, 8192
    s_add_u32 s37, s3, 0x200000
    buffer_load_dwordx4 v16, s[96:99], s37 offen lds
    s_add_u32 m0, s28, 9216
    s_add_u32 s37, s3, 0x208000
    buffer_load_dwordx4 v17, s[96:99], s37 offen lds
    s_add_u32 m0, s28, 10240
    s_add_u32 s37, s3, 0x210000
    buffer_load_dwordx4 v18, s[96:99], s37 offen lds
    s_add_u32 m0, s28, 11264
    s_add_u32 s37, s3, 0x218000
    buffer_load_dwordx4 v19, s[96:99], s37 offen lds
    s_add_u32 m0, s28, 12288
    s_add_u32 s37, s3, 0x220000
    buffer_load_dwordx4 v16, s[96:99], s37 offen lds
    s_add_u32 m0, s28, 13312
    s_add_u32 s37, s3, 0x228000
    buffer_load_dwordx4 v17, s[96:99], s37 offen lds
    s_add_u32 m0, s28, 14336
    s_add_u32 s37, s3, 0x230000
    buffer_load_dwordx4 v18, s[96:99], s37 offen lds
    s_add_u32 m0, s28, 15360
    s_add_u32 s37, s3, 0x238000
    buffer_load_dwordx4 v19, s[96:99], s37 offen lds
    s_waitcnt vmcnt(32)
    v_perm_b32 v176, v33, v32, s34
    v_perm_b32 v177, v33, v32, s35
    v_perm_b32 v178, v35, v34, s34
    v_perm_b32 v179, v35, v34, s35
    v_perm_b32 v180, v37, v36, s34
    v_perm_b32 v181, v37, v36, s35
    v_perm_b32 v182, v39, v38, s34
    v_perm_b32 v183, v39, v38, s35
    v_perm_b32 v184, v41, v40, s34
    v_perm_b32 v185, v41, v40, s35
    v_perm_b32 v186, v43, v42, s34
    v_perm_b32 v187, v43, v42, s35
    v_perm_b32 v188, v45, v44, s34
    v_perm_b32 v189, v45, v44, s35
    v_perm_b32 v190, v47, v46, s34
    v_perm_b32 v191, v47, v46, s35
    v_lshrrev_b32 v31, 2, v3
    buffer_load_dword v30, v31, s[16:19], 0 offen sc1
    s_barrier
    ds_read_b64_tr_b16 v[32:33], v20 offset:16384
    ds_read_b64_tr_b16 v[34:35], v20 offset:16896
    ds_read_b64_tr_b16 v[40:41], v21 offset:16384
    ds_read_b64_tr_b16 v[42:43], v21 offset:16896
    ds_read_b64_tr_b16 a[0:1], v22 offset:16384
    ds_read_b64_tr_b16 a[2:3], v22 offset:16896
    ds_read_b64_tr_b16 a[8:9], v23 offset:16384
    ds_read_b64_tr_b16 a[10:11], v23 offset:16896
    ds_read_b64_tr_b16 a[32:33], v24 offset:16384
    ds_read_b64_tr_b16 a[34:35], v24 offset:16896
    ds_read_b64_tr_b16 a[40:41], v25 offset:16384
    ds_read_b64_tr_b16 a[42:43], v25 offset:16896
    s_waitcnt lgkmcnt(4)
    ds_read_b64_tr_b16 a[64:65], v26 offset:16384
    ds_read_b64_tr_b16 a[66:67], v26 offset:16896
    ds_read_b64_tr_b16 a[72:73], v27 offset:16384
    ds_read_b64_tr_b16 a[74:75], v27 offset:16896
    s_waitcnt lgkmcnt(0)
    s_barrier
    s_add_u32 m0, s28, 16384
    s_add_u32 s37, s3, 0x300000
    buffer_load_dwordx4 v16, s[96:99], s37 offen lds
    s_add_u32 m0, s28, 17408
    s_add_u32 s37, s3, 0x308000
    buffer_load_dwordx4 v17, s[96:99], s37 offen lds
    s_add_u32 m0, s28, 18432
    s_add_u32 s37, s3, 0x310000
    buffer_load_dwordx4 v18, s[96:99], s37 offen lds
    s_add_u32 m0, s28, 19456
    s_add_u32 s37, s3, 0x318000
    buffer_load_dwordx4 v19, s[96:99], s37 offen lds
    s_add_u32 m0, s28, 20480
    s_add_u32 s37, s3, 0x320000
    buffer_load_dwordx4 v16, s[96:99], s37 offen lds
    s_add_u32 m0, s28, 21504
    s_add_u32 s37, s3, 0x328000
    buffer_load_dwordx4 v17, s[96:99], s37 offen lds
    s_add_u32 m0, s28, 22528
    s_add_u32 s37, s3, 0x330000
    buffer_load_dwordx4 v18, s[96:99], s37 offen lds
    s_add_u32 m0, s28, 23552
    s_add_u32 s37, s3, 0x338000
    buffer_load_dwordx4 v19, s[96:99], s37 offen lds
    s_waitcnt vmcnt(17)
    v_perm_b32 v160, v49, v48, s34
    v_perm_b32 v161, v49, v48, s35
    v_perm_b32 v162, v51, v50, s34
    v_perm_b32 v163, v51, v50, s35
    v_perm_b32 v164, v53, v52, s34
    v_perm_b32 v165, v53, v52, s35
    v_perm_b32 v166, v55, v54, s34
    v_perm_b32 v167, v55, v54, s35
    v_perm_b32 v168, v57, v56, s34
    v_perm_b32 v169, v57, v56, s35
    v_perm_b32 v170, v59, v58, s34
    v_perm_b32 v171, v59, v58, s35
    v_perm_b32 v172, v61, v60, s34
    v_perm_b32 v173, v61, v60, s35
    v_perm_b32 v174, v63, v62, s34
    v_perm_b32 v175, v63, v62, s35
    s_waitcnt vmcnt(8)
    s_mov_b32 s41, 1
L_HS:
    v_cmp_eq_u32 vcc, 0, v30
    s_cbranch_vccz L_HS_ok
    buffer_load_dword v30, v31, s[16:19], 0 offen sc1
    s_add_u32 s32, s32, 1
    s_cmp_gt_u32 s32, 200000
    s_waitcnt vmcnt(0)
    s_cbranch_scc0 L_HS
    s_branch L_HS_done
L_HS_ok:
    v_readlane_b32 s36, v30, 63
    s_nop 1
    v_cmp_ne_u32 vcc, s36, v30
    s_nop 1
    s_cmp_lg_u32 vcc_hi, 0
    s_cselect_b32 s41, 1, 0
L_HS_done:
    s_mov_b32 s7, 0xf7df00
    buffer_load_dword v15, v0, s[8:11], s7 offen sc1
    s_barrier
    ds_read_b64_tr_b16 v[36:37], v20 offset:0
    ds_read_b64_tr_b16 v[38:39], v20 offset:512
    ds_read_b64_tr_b16 v[44:45], v21 offset:0
    ds_read_b64_tr_b16 v[46:47], v21 offset:512
    ds_read_b64_tr_b16 a[4:5], v22 offset:0
    ds_read_b64_tr_b16 a[6:7], v22 offset:512
    ds_read_b64_tr_b16 a[12:13], v23 offset:0
    ds_read_b64_tr_b16 a[14:15], v23 offset:512
    ds_read_b64_tr_b16 a[36:37], v24 offset:0
    ds_read_b64_tr_b16 a[38:39], v24 offset:512
    ds_read_b64_tr_b16 a[44:45], v25 offset:0
    ds_read_b64_tr_b16 a[46:47], v25 offset:512
    s_waitcnt lgkmcnt(4)
    ds_read_b64_tr_b16 a[68:69], v26 offset:0
    ds_read_b64_tr_b16 a[70:71], v26 offset:512
    ds_read_b64_tr_b16 a[76:77], v27 offset:0
    ds_read_b64_tr_b16 a[78:79], v27 offset:512
    s_waitcnt lgkmcnt(0)
    s_barrier
    s_barrier
    ds_read_b64_tr_b16 v[48:49], v20 offset:8192
    ds_read_b64_tr_b16 v[50:51], v20 offset:8704
    ds_read_b64_tr_b16 v[56:57], v21 offset:8192
    ds_read_b64_tr_b16 v[58:59], v21 offset:8704
    ds_read_b64_tr_b16 a[16:17], v22 offset:8192
    ds_read_b64_tr_b16 a[18:19], v22 offset:8704
    ds_read_b64_tr_b16 a[24:25], v23 offset:8192
    ds_read_b64_tr_b16 a[26:27], v23 offset:8704
    ds_read_b64_tr_b16 a[48:49], v24 offset:8192
    ds_read_b64_tr_b16 a[50:51], v24 offset:8704
    ds_read_b64_tr_b16 a[56:57], v25 offset:8192
    ds_read_b64_tr_b16 a[58:59], v25 offset:8704
    s_waitcnt lgkmcnt(4)
    ds_read_b64_tr_b16 v[80:81], v26 offset:8192
    ds_read_b64_tr_b16 v[82:83], v26 offset:8704
    ds_read_b64_tr_b16 v[88:89], v27 offset:8192
    ds_read_b64_tr_b16 v[90:91], v27 offset:8704
    s_waitcnt lgkmcnt(0)
    s_barrier
    s_waitcnt vmcnt(0)
L_F0:
    v_readlane_b32 s36, v15, 33
    s_nop 1
    s_cmp_lg_u32 s36, 0
    s_cbranch_scc1 L_F0_ok
    buffer_load_dword v15, v0, s[8:11], s7 offen sc1
    s_add_u32 s32, s32, 1
    s_cmp_gt_u32 s32, 200000
    s_waitcnt vmcnt(0)
    s_cbranch_scc0 L_F0
L_F0_ok:
    s_mov_b32 s7, 0x1000000
    buffer_load_dword v15, v0, s[8:11], s7 offen sc1
    s_barrier
    ds_read_b64_tr_b16 v[52:53], v20 offset:16384
    ds_read_b64_tr_b16 v[54:55], v20 offset:16896
    ds_read_b64_tr_b16 v[60:61], v21 offset:16384
    ds_read_b64_tr_b16 v[62:63], v21 offset:16896
    ds_read_b64_tr_b16 a[20:21], v22 offset:16384
    ds_read_b64_tr_b16 a[22:23], v22 offset:16896
    ds_read_b64_tr_b16 a[28:29], v23 offset:16384
    ds_read_b64_tr_b16 a[30:31], v23 offset:16896
    ds_read_b64_tr_b16 a[52:53], v24 offset:16384
    ds_read_b64_tr_b16 a[54:55], v24 offset:16896
    ds_read_b64_tr_b16 a[60:61], v25 offset:16384
    ds_read_b64_tr_b16 a[62:63], v25 offset:16896
    s_waitcnt lgkmcnt(4)
    ds_read_b64_tr_b16 v[84:85], v26 offset:16384
    ds_read_b64_tr_b16 v[86:87], v26 offset:16896
    ds_read_b64_tr_b16 v[92:93], v27 offset:16384
    ds_read_b64_tr_b16 v[94:95], v27 offset:16896
    s_waitcnt lgkmcnt(0)
    s_barrier
    ds_write_b128 v4, v[32:35] offset:0
    ds_write_b128 v4, v[36:39] offset:1024
    ds_write_b128 v4, v[40:43] offset:2048
    ds_write_b128 v4, v[44:47] offset:3072
    ds_write_b128 v4, v[48:51] offset:4096
    ds_write_b128 v4, v[52:55] offset:5120
    ds_write_b128 v4, v[56:59] offset:6144
    ds_write_b128 v4, v[60:63] offset:7168
    s_waitcnt lgkmcnt(0)
    ds_write_b128 v4, v[64:67] offset:8192
    ds_write_b128 v4, v[68:71] offset:9216
    ds_write_b128 v4, v[72:75] offset:10240
    ds_write_b128 v4, v[76:79] offset:11264
    ds_write_b128 v4, v[80:83] offset:12288
    ds_write_b128 v4, v[84:87] offset:13312
    ds_write_b128 v4, v[88:91] offset:14336
    ds_write_b128 v4, v[92:95] offset:15360
    s_waitcnt lgkmcnt(0)
    ds_write_b128 v4, v[96:99] offset:16384
    ds_write_b128 v4, v[100:103] offset:17408
    ds_write_b128 v4, v[104:107] offset:18432
    ds_write_b128 v4, v[108:111] offset:19456
    ds_write_b128 v4, v[112:115] offset:20480
    ds_write_b128 v4, v[116:119] offset:21504
    ds_write_b128 v4, v[120:123] offset:22528
    ds_write_b128 v4, v[124:127] offset:23552
    s_waitcnt lgkmcnt(0)
    s_waitcnt lgkmcnt(0)
    s_cmp_lg_u32 s41, 0
    s_cbranch_scc1 L_slow_start
L_fast_start:
    s_mov_b32 s22, 0
    s_mov_b32 s23, 0x1000000
    s_mov_b32 s27, 0
    s_mov_b32 s31, 0x80000
    s_mov_b32 s61, 0x40000000
    s_mov_b32 s96, 0x800
    s_mov_b32 s97, 0x1000
    s_mov_b32 s98, 0x1800
    s_mov_b32 s92, 0xcccccccc
    s_mov_b32 s93, 0xcccccccc
    s_mov_b32 s91, 0
    ds_read_b128 v[104:107], v4 offset:0
    ds_read_b128 v[108:111], v4 offset:1024
    ds_read_b128 v[112:115], v4 offset:2048
    ds_read_b128 v[116:119], v4 offset:3072
    ds_read_b128 v[88:91], v4 offset:4096
    ds_read_b128 v[92:95], v4 offset:5120
    ds_read_b128 v[96:99], v4 offset:6144
    ds_read_b128 v[100:103], v4 offset:7168
    ds_read_b128 v[72:75], v4 offset:8192
    ds_read_b128 v[76:79], v4 offset:9216
    ds_read_b128 v[80:83], v4 offset:10240
    ds_read_b128 v[84:87], v4 offset:11264
    v_mov_b64 v[48:49], 0
    v_mov_b64 v[50:51], 0
    v_mov_b64 v[52:53], 0
    v_mov_b64 v[54:55], 0
    v_mov_b64 v[56:57], 0
    v_mov_b64 v[58:59], 0
    v_mov_b64 v[60:61], 0
    v_mov_b64 v[62:63], 0
    v_mov_b64 v[64:65], 0
    v_mov_b64 v[66:67], 0
    v_mov_b64 v[68:69], 0
    v_mov_b64 v[70:71], 0
    s_add_u32 s7, s23, 0x80000
    buffer_load_dwordx4 v[16:19], v2, s[8:11], s7 offen sc1
    buffer_load_dwordx4 v[20:23], v2, s[8:11], s7 offen offset:1024 sc1
    s_waitcnt vmcnt(2)
L_fast_step:
    v_readlane_b32 s36, v15, 33
    s_add_u32 s24, s23, 0x82100
    s_cmp_eq_u32 s36, 0
    s_cbranch_scc1 L_fast_refresh
L_fast_fresh:
    s_add_u32 s29, s23, s25
    s_add_u32 s30, s23, s39
    s_xor_b32 s28, s27, 1
    s_add_u32 s90, s22, 1
    s_nop 15
L_fast_retrym:
    buffer_load_dwordx4 v[16:19], v2, s[8:11], s7 offen sc1
    buffer_load_dwordx4 v[20:23], v2, s[8:11], s7 offen offset:1024 sc1
L_fast_prem:
    s_add_u32 s32, s32, 1
    s_cmp_gt_u32 s32, 200000
    s_cselect_b32 s94, -1, -2
    v_xor_b32 v28, 0x800, v2
    v_xor_b32 v44, 0x1800, v2
    v_mov_b64 v[48:49], 0
    v_mov_b64 v[50:51], 0
    v_mov_b64 v[52:53], 0
    v_mov_b64 v[54:55], 0
L_fast_waitm:
    s_waitcnt vmcnt(3) lgkmcnt(0)
L_fast_gotm:
    v_max3_u32 v14, v16, v17, v18
    v_max_u32 v14, v14, v19
    v_smfmac_f32_16x16x64_bf16 v[48:51], v[16:19], v[104:111], v1
    s_waitcnt vmcnt(2)
    v_max3_u32 v14, v14, v20, v21
    v_smfmac_f32_16x16x64_bf16 v[52:55], v[16:19], v[112:119], v1
    v_max3_u32 v14, v14, v22, v23
    v_cmp_lt_u32 vcc, s94, v14
    v_smfmac_f32_16x16x64_bf16 v[48:51], v[20:23], v[88:95], v1
    ds_write_b128 v2, v[16:19] offset:0
    s_cbranch_vccnz L_fast_retrym
    v_smfmac_f32_16x16x64_bf16 v[52:55], v[20:23], v[96:103], v1
    ds_write_b128 v2, v[20:23] offset:1024
    v_smfmac_f32_16x16x64_bf16 v[56:59], v[16:19], v[72:79], v1
    buffer_load_dwordx4 v[104:107], v3, s[8:11], s29 offen offset:0 sc1
    buffer_load_dwordx4 v[120:123], v3, s[8:11], s30 offen offset:0 sc1
    v_smfmac_f32_16x16x64_bf16 v[60:63], v[16:19], v[80:87], v1
    buffer_load_dwordx4 v[108:111], v3, s[8:11], s29 offen offset:1024 sc1
    buffer_load_dwordx4 v[124:127], v3, s[8:11], s30 offen offset:1024 sc1
    v_smfmac_f32_16x16x64_bf16 v[56:59], v[20:23], a[80:87], v1
    buffer_load_dwordx4 v[112:115], v3, s[8:11], s29 offen offset:2048 sc1
    buffer_load_dwordx4 v[116:119], v3, s[8:11], s29 offen offset:3072 sc1
    v_smfmac_f32_16x16x64_bf16 v[60:63], v[20:23], a[88:95], v1
    s_waitcnt lgkmcnt(0)
    s_barrier
    ds_read_b128 v[24:27], v28 offset:0
    v_smfmac_f32_16x16x64_bf16 v[64:67], v[16:19], a[160:167], v1
    ds_read_b128 v[28:31], v28 offset:1024
    v_smfmac_f32_16x16x64_bf16 v[68:71], v[16:19], a[168:175], v1
    buffer_load_dword v15, v0, s[8:11], s24 offen sc1
    v_smfmac_f32_16x16x64_bf16 v[64:67], v[20:23], a[176:183], v1
    ds_read_b128 v[32:35], v8 offset:0
    v_smfmac_f32_16x16x64_bf16 v[68:71], v[20:23], a[184:191], v1
    ds_read_b128 v[36:39], v8 offset:1024
    s_waitcnt lgkmcnt(3)
    v_smfmac_f32_16x16x64_bf16 v[48:51], v[24:27], a[0:7], v1
    ds_read_b128 v[40:43], v44 offset:0
    v_smfmac_f32_16x16x64_bf16 v[52:55], v[24:27], a[8:15], v1
    ds_read_b128 v[44:47], v44 offset:1024
    s_waitcnt lgkmcnt(4)
    v_smfmac_f32_16x16x64_bf16 v[48:51], v[28:31], a[16:23], v1
    ds_read_b128 v[88:91], v4 offset:12288
    v_smfmac_f32_16x16x64_bf16 v[52:55], v[28:31], a[24:31], v1
    ds_read_b128 v[92:95], v4 offset:13312
    s_waitcnt lgkmcnt(4)
    v_smfmac_f32_16x16x64_bf16 v[48:51], v[32:35], a[32:39], v1
    ds_read_b128 v[96:99], v4 offset:14336
    v_smfmac_f32_16x16x64_bf16 v[52:55], v[32:35], a[40:47], v1
    ds_read_b128 v[100:103], v4 offset:15360
    s_waitcnt lgkmcnt(4)
    v_smfmac_f32_16x16x64_bf16 v[48:51], v[36:39], a[48:55], v1
    v_smfmac_f32_16x16x64_bf16 v[52:55], v[36:39], a[56:63], v1
    ds_read_b128 v[72:75], v4 offset:16384
    v_smfmac_f32_16x16x64_bf16 v[48:51], v[40:43], a[64:71], v1
    v_smfmac_f32_16x16x64_bf16 v[52:55], v[40:43], a[72:79], v1
    ds_read_b128 v[76:79], v4 offset:17408
    s_waitcnt lgkmcnt(2)
    v_smfmac_f32_16x16x64_bf16 v[48:51], v[44:47], v[88:95], v1
    ds_read_b128 v[80:83], v4 offset:18432
    v_smfmac_f32_16x16x64_bf16 v[52:55], v[44:47], v[96:103], v1
    ds_read_b128 v[84:87], v4 offset:19456
    v_smfmac_f32_16x16x64_bf16 v[56:59], v[28:31], a[96:103], v1
    ds_read_b128 v[88:91], v4 offset:20480
    v_smfmac_f32_16x16x64_bf16 v[60:63], v[28:31], a[104:111], v1
    ds_read_b128 v[92:95], v4 offset:21504
    v_smfmac_f32_16x16x64_bf16 v[56:59], v[32:35], a[112:119], v1
    ds_read_b128 v[96:99], v4 offset:22528
    v_add_f32 v48, v48, v50
    v_add_f32 v49, v49, v51
    v_smfmac_f32_16x16x64_bf16 v[60:63], v[32:35], a[120:127], v1
    ds_read_b128 v[100:103], v4 offset:23552
    v_add_f32 v52, v52, v54
    v_add_f32 v53, v53, v55
    v_smfmac_f32_16x16x64_bf16 v[56:59], v[36:39], a[128:135], v1
    s_waitcnt lgkmcnt(4)
    v_cvt_pk_bf16_f32 v50, v48, v52
    v_cvt_pk_bf16_f32 v51, v49, v53
    v_smfmac_f32_16x16x64_bf16 v[56:59], v[24:27], v[72:79], v1
    ds_write2_b32 v5, v50, v51 offset0:0 offset1:72
    v_smfmac_f32_16x16x64_bf16 v[60:63], v[24:27], v[80:87], v1
    v_smfmac_f32_16x16x64_bf16 v[60:63], v[36:39], a[136:143], v1
    v_smfmac_f32_16x16x64_bf16 v[56:59], v[40:43], a[144:151], v1
    buffer_store_dword v12, v10, s[8:11], s31 offen sc1
    v_smfmac_f32_16x16x64_bf16 v[60:63], v[40:43], a[152:159], v1
    s_waitcnt lgkmcnt(0)
    s_barrier
    v_smfmac_f32_16x16x64_bf16 v[56:59], v[44:47], v[88:95], v1
    ds_read_b128 v[72:75], v6 offset:0
    v_smfmac_f32_16x16x64_bf16 v[60:63], v[44:47], v[96:103], v1
    ds_read_b128 v[76:79], v6 offset:64
    v_smfmac_f32_16x16x64_bf16 v[64:67], v[24:27], a[192:199], v1
    ds_read_b128 v[80:83], v6 offset:128
    v_smfmac_f32_16x16x64_bf16 v[68:71], v[24:27], a[200:207], v1
    ds_read_b128 v[84:87], v6 offset:192
    s_waitcnt vmcnt(2) lgkmcnt(3)
    v_mfma_f32_16x16x32_bf16 v[48:51], v[104:107], v[72:75], 0
    s_waitcnt lgkmcnt(2)
    v_add_f32 v56, v56, v58
    v_add_f32 v57, v57, v59
    v_mfma_f32_16x16x32_bf16 v[48:51], v[108:111], v[76:79], v[48:51]
    s_waitcnt lgkmcnt(1)
    v_add_f32 v60, v60, v62
    v_add_f32 v61, v61, v63
    v_mfma_f32_16x16x32_bf16 v[48:51], v[112:115], v[80:83], v[48:51]
    s_waitcnt lgkmcnt(0)
    v_cvt_pk_bf16_f32 v58, v56, v60
    v_cvt_pk_bf16_f32 v59, v57, v61
    v_mfma_f32_16x16x32_bf16 v[48:51], v[116:119], v[84:87], v[48:51]
    ds_write2_b32 v7, v58, v59 offset0:0 offset1:72
    v_smfmac_f32_16x16x64_bf16 v[64:67], v[28:31], a[208:215], v1
    v_mov_b64 v[104:105], s[4:5]
    v_smfmac_f32_16x16x64_bf16 v[68:71], v[28:31], a[216:223], v1
    s_nop 1
    v_mov_b64 v[106:107], s[4:5]
    v_smfmac_f32_16x16x64_bf16 v[64:67], v[32:35], a[224:231], v1
    v_exp_f32 v48, v48
    v_smfmac_f32_16x16x64_bf16 v[68:71], v[32:35], a[232:239], v1
    s_waitcnt lgkmcnt(0)
    s_barrier
    v_exp_f32 v49, v49
    v_smfmac_f32_16x16x64_bf16 v[64:67], v[36:39], a[240:247], v1
    ds_read_b128 v[88:91], v6 offset:2304
    v_exp_f32 v50, v50
    v_smfmac_f32_16x16x64_bf16 v[68:71], v[36:39], a[248:255], v1
    ds_read_b128 v[92:95], v6 offset:2368
    v_exp_f32 v51, v51
    v_smfmac_f32_16x16x64_bf16 v[64:67], v[40:43], v[128:135], v1
    ds_read_b128 v[96:99], v6 offset:2432
    v_cvt_pk_bf16_f32 v108, v48, v49
    v_cvt_pk_bf16_f32 v109, v50, v51
    v_smfmac_f32_16x16x64_bf16 v[68:71], v[40:43], v[136:143], v1
    ds_read_b128 v[100:103], v6 offset:2496
    ds_write_b64 v2, v[108:109] offset:8192
    s_waitcnt lgkmcnt(4)
    v_mfma_f32_16x16x32_bf16 v[52:55], v[88:91], v[72:75], 0
    s_waitcnt lgkmcnt(3)
    v_mov_b32 v113, 0
    v_mov_b32 v115, 0
    v_mfma_f32_16x16x32_bf16 v[52:55], v[92:95], v[76:79], v[52:55]
    s_waitcnt lgkmcnt(2)
    v_mov_b32 v117, 0
    v_mov_b64 v[16:17], 0
    v_mfma_f32_16x16x32_bf16 v[52:55], v[96:99], v[80:83], v[52:55]
    s_waitcnt lgkmcnt(1)
    v_mov_b64 v[18:19], 0
    v_mov_b64 v[20:21], 0
    v_mfma_f32_16x16x32_bf16 v[52:55], v[100:103], v[84:87], v[52:55]
    s_waitcnt lgkmcnt(0)
    s_barrier
    v_smfmac_f32_16x16x64_bf16 v[64:67], v[44:47], v[144:151], v1
    ds_read_b64 v[110:111], v8 offset:8192
    v_mov_b64 v[22:23], 0
    v_smfmac_f32_16x16x64_bf16 v[68:71], v[44:47], v[152:159], v1
    v_mov_b64 v[24:25], 0
    v_mov_b64 v[26:27], 0
    v_mul_f32 v52, s33, v52
    v_mul_f32 v53, s33, v53
    v_exp_f32 v52, v52
    s_waitcnt lgkmcnt(0)
    v_mfma_f32_16x16x32_bf16 v[48:51], v[104:107], v[108:111], 0
    v_exp_f32 v53, v53
    v_add_f32 v64, v64, v66
    v_mfma_f32_16x16x32_bf16 v[56:59], v[120:123], v[108:111], 0
    v_cvt_pk_bf16_f32 v112, v52, v53
    v_add_f32 v65, v65, v67
    v_mfma_f32_16x16x32_bf16 v[60:63], v[124:127], v[108:111], 0
    v_cvt_pk_bf16_f32 v114, v64, v65
    v_add_f32 v68, v68, v70
    v_mfma_f32_16x16x16_bf16 v[48:51], v[104:105], v[112:113], v[48:51]
    v_add_f32 v69, v69, v71
    v_cvt_pk_bf16_f32 v116, v68, v69
    v_mfma_f32_16x16x16_bf16 v[56:59], v[114:115], v[112:113], v[56:59]
    v_mov_b64 v[28:29], 0
    v_mov_b64 v[30:31], 0
    v_mfma_f32_16x16x16_bf16 v[60:63], v[116:117], v[112:113], v[60:63]
    v_bitop3_b32 v32, v13, s96, -9 bitop3:0x28
    v_bitop3_b32 v36, v13, s97, -9 bitop3:0x28
    v_rcp_f32 v118, v48
    v_bitop3_b32 v40, v13, s98, -9 bitop3:0x28
    v_max_f32 v14, v118, v48
    v_cmp_nge_f32 vcc, s40, v14
    v_pk_mul_f32 v[56:57], v[56:57], v[118:119] op_sel_hi:[1,0]
    v_pk_mul_f32 v[58:59], v[58:59], v[118:119] op_sel_hi:[1,0]
    v_pk_mul_f32 v[60:61], v[60:61], v[118:119] op_sel_hi:[1,0]
    v_pk_mul_f32 v[62:63], v[62:63], v[118:119] op_sel_hi:[1,0]
    v_cvt_pk_bf16_f32 v52, v56, v60
    v_cvt_pk_bf16_f32 v54, v58, v62
    v_cvt_pk_bf16_f32 v53, v57, v61
    v_cvt_pk_bf16_f32 v55, v59, v63
L_fast_rejoin:
    v_cndmask_b32 v50, v52, v54, s[92:93]
    v_cndmask_b32 v51, v53, v55, s[92:93]
    ds_write_b64 v13, v[50:51] offset:9216
    v_smfmac_f32_16x16x64_bf16 v[16:19], v[52:55], v[160:167], v1
    v_smfmac_f32_16x16x64_bf16 v[20:23], v[52:55], v[168:175], v1
    s_waitcnt lgkmcnt(0)
    s_barrier
    ds_read_b128 v[32:35], v32 offset:9216
    ds_read_b128 v[36:39], v36 offset:9216
    v_smfmac_f32_16x16x64_bf16 v[24:27], v[52:55], v[176:183], v1
    ds_read_b128 v[40:43], v40 offset:9216
    v_smfmac_f32_16x16x64_bf16 v[28:31], v[52:55], v[184:191], v1
    ds_read_b128 v[88:91], v4 offset:24576
    ds_read_b128 v[92:95], v4 offset:25600
    s_waitcnt lgkmcnt(4)
    v_smfmac_f32_16x16x64_bf16 v[16:19], v[32:35], v[192:199], v1
    ds_read_b128 v[96:99], v4 offset:26624
    s_waitcnt lgkmcnt(4)
    v_smfmac_f32_16x16x64_bf16 v[16:19], v[36:39], v[216:223], v1
    ds_read_b128 v[100:103], v4 offset:27648
    s_waitcnt lgkmcnt(4)
    v_smfmac_f32_16x16x64_bf16 v[16:19], v[40:43], v[240:247], v1
    ds_read_b128 v[72:75], v4 offset:28672
    s_cmp_lg_u64 vcc, 0
    v_smfmac_f32_16x16x64_bf16 v[20:23], v[32:35], v[200:207], v1
    ds_read_b128 v[76:79], v4 offset:29696
    s_cselect_b32 s60, s28, s27
    v_smfmac_f32_16x16x64_bf16 v[20:23], v[36:39], v[224:231], v1
    ds_read_b128 v[80:83], v4 offset:30720
    s_nop 0
    v_cvt_pk_bf16_f32 v56, v16, v18
    v_smfmac_f32_16x16x64_bf16 v[20:23], v[40:43], v[248:255], v1
    ds_read_b128 v[84:87], v4 offset:31744
    v_cvt_pk_bf16_f32 v57, v17, v19
    v_and_or_b32 v56, v56, -2, s60
    v_smfmac_f32_16x16x64_bf16 v[24:27], v[32:35], v[208:215], v1
    buffer_store_dwordx2 v[56:57], v9, s[8:11], 0 offen offset:0
    v_smfmac_f32_16x16x64_bf16 v[24:27], v[36:39], v[232:239], v1
    s_waitcnt lgkmcnt(4)
    s_nop 0
    v_cvt_pk_bf16_f32 v58, v20, v22
    v_smfmac_f32_16x16x64_bf16 v[24:27], v[40:43], v[88:95], v1
    ds_read_b128 v[64:67], v3 offset:23040
    v_cvt_pk_bf16_f32 v59, v21, v23
    v_and_or_b32 v58, v58, -2, s60
    v_smfmac_f32_16x16x64_bf16 v[28:31], v[32:35], v[96:103], v1
    buffer_store_dwordx2 v[58:59], v9, s[8:11], 0 offen offset:2048
    s_waitcnt lgkmcnt(1)
    v_smfmac_f32_16x16x64_bf16 v[28:31], v[36:39], v[72:79], v1
    s_nop 1
    v_cvt_pk_bf16_f32 v60, v24, v26
    v_smfmac_f32_16x16x64_bf16 v[28:31], v[40:43], v[80:87], v1
    s_nop 2
    v_cvt_pk_bf16_f32 v61, v25, v27
    v_and_or_b32 v60, v60, -2, s60
    buffer_store_dwordx2 v[60:61], v9, s[8:11], s26 offen offset:0
    s_nop 1
    v_cvt_pk_bf16_f32 v62, v28, v30
    v_cvt_pk_bf16_f32 v63, v29, v31
    v_and_or_b32 v62, v62, -2, s60
    buffer_store_dwordx2 v[62:63], v9, s[8:11], s26 offen offset:2048
L_fast_stored:
    s_cmp_lg_u32 s60, s27
    s_cbranch_scc1 L_fast_safe
    ds_read_b128 v[104:107], v4 offset:0
    ds_read_b128 v[108:111], v4 offset:1024
    ds_read_b128 v[112:115], v4 offset:2048
    ds_read_b128 v[116:119], v4 offset:3072
    ds_read_b128 v[88:91], v4 offset:4096
    ds_read_b128 v[92:95], v4 offset:5120
    ds_read_b128 v[96:99], v4 offset:6144
    ds_read_b128 v[100:103], v4 offset:7168
    ds_read_b128 v[72:75], v4 offset:8192
    ds_read_b128 v[76:79], v4 offset:9216
    ds_read_b128 v[80:83], v4 offset:10240
    ds_read_b128 v[84:87], v4 offset:11264
    s_cmp_lt_u32 s21, 1
    s_cbranch_scc1 L_fast_pollp
    s_nop 13
    s_cmp_lt_u32 s21, 2
    s_cbranch_scc1 L_fast_pollp
    s_nop 13
    s_cmp_lt_u32 s21, 3
    s_cbranch_scc1 L_fast_pollp
    s_nop 13
L_fast_pollp:
    buffer_load_dwordx4 v[120:123], v2, s[8:11], s6 offen sc1
    buffer_load_dwordx4 v[124:127], v2, s[8:11], s6 offen offset:1024 sc1
    v_mov_b64 v[56:57], 0
    v_mov_b64 v[58:59], 0
    v_mov_b64 v[60:61], 0
    v_mov_b64 v[62:63], 0
    s_nop 15
    s_nop 15
    buffer_load_dwordx4 v[32:35], v2, s[8:11], s6 offen sc1
    buffer_load_dwordx4 v[36:39], v2, s[8:11], s6 offen offset:1024 sc1
L_fast_prep:
    s_add_u32 s7, s24, 0x80000
    s_waitcnt vmcnt(3) lgkmcnt(0)
    v_mfma_f32_16x16x32_bf16 v[68:71], v[64:67], v[120:123], 0
    v_bitop3_b32 v14, v120, v122, s27 bitop3:0x7e
    s_waitcnt vmcnt(2)
    v_mfma_f32_16x16x32_bf16 v[68:71], v[64:67], v[124:127], v[68:71]
    v_bitop3_b32 v11, v124, v126, s27 bitop3:0x7e
    v_bitop3_b32 v14, v14, v11, 1 bitop3:0xa8
    v_cmp_ne_u32 vcc, 0, v14
    s_nop 2
    s_cmp_eq_u64 vcc, 0
    s_cselect_b32 s36, s24, s61
    v_add_f32_dpp v68, v68, v68 row_ror:8 row_mask:0xf bank_mask:0xf
    v_add_f32_dpp v69, v69, v69 row_ror:8 row_mask:0xf bank_mask:0xf
    s_nop 0
    v_add_f32_dpp v68, v68, v68 row_ror:4 row_mask:0xf bank_mask:0xf
    v_add_f32_dpp v69, v69, v69 row_ror:4 row_mask:0xf bank_mask:0xf
    v_cvt_pk_bf16_f32 v12, v68, v69
    buffer_store_dword v12, v10, s[8:11], s36 offen
    s_cbranch_scc1 L_fast_gotp
L_fast_retryp:
    buffer_load_dwordx4 v[120:123], v2, s[8:11], s6 offen sc1
    buffer_load_dwordx4 v[124:127], v2, s[8:11], s6 offen offset:1024 sc1
    s_waitcnt vmcnt(4) lgkmcnt(0)
    v_mfma_f32_16x16x32_bf16 v[68:71], v[64:67], v[32:35], 0
    v_bitop3_b32 v14, v32, v34, s27 bitop3:0x7e
    s_waitcnt vmcnt(3)
    v_mfma_f32_16x16x32_bf16 v[68:71], v[64:67], v[36:39], v[68:71]
    v_bitop3_b32 v11, v36, v38, s27 bitop3:0x7e
    v_bitop3_b32 v14, v14, v11, 1 bitop3:0xa8
    v_cmp_ne_u32 vcc, 0, v14
    s_nop 2
    s_cmp_eq_u64 vcc, 0
    s_cselect_b32 s36, s24, s61
    v_add_f32_dpp v68, v68, v68 row_ror:8 row_mask:0xf bank_mask:0xf
    v_add_f32_dpp v69, v69, v69 row_ror:8 row_mask:0xf bank_mask:0xf
    s_nop 0
    v_add_f32_dpp v68, v68, v68 row_ror:4 row_mask:0xf bank_mask:0xf
    v_add_f32_dpp v69, v69, v69 row_ror:4 row_mask:0xf bank_mask:0xf
    v_cvt_pk_bf16_f32 v12, v68, v69
    buffer_store_dword v12, v10, s[8:11], s36 offen
    s_cbranch_scc1 L_fast_gotp
    buffer_load_dwordx4 v[32:35], v2, s[8:11], s6 offen sc1
    buffer_load_dwordx4 v[36:39], v2, s[8:11], s6 offen offset:1024 sc1
    s_waitcnt vmcnt(4) lgkmcnt(0)
    v_mfma_f32_16x16x32_bf16 v[68:71], v[64:67], v[120:123], 0
    v_bitop3_b32 v14, v120, v122, s27 bitop3:0x7e
    s_waitcnt vmcnt(3)
    v_mfma_f32_16x16x32_bf16 v[68:71], v[64:67], v[124:127], v[68:71]
    v_bitop3_b32 v11, v124, v126, s27 bitop3:0x7e
    v_bitop3_b32 v14, v14, v11, 1 bitop3:0xa8
    v_cmp_ne_u32 vcc, 0, v14
    s_nop 2
    s_cmp_eq_u64 vcc, 0
    s_cselect_b32 s36, s24, s61
    v_add_f32_dpp v68, v68, v68 row_ror:8 row_mask:0xf bank_mask:0xf
    v_add_f32_dpp v69, v69, v69 row_ror:8 row_mask:0xf bank_mask:0xf
    s_nop 0
    v_add_f32_dpp v68, v68, v68 row_ror:4 row_mask:0xf bank_mask:0xf
    v_add_f32_dpp v69, v69, v69 row_ror:4 row_mask:0xf bank_mask:0xf
    v_cvt_pk_bf16_f32 v12, v68, v69
    buffer_store_dword v12, v10, s[8:11], s36 offen
    s_cbranch_scc1 L_fast_gotp
    s_add_u32 s32, s32, 1
    s_cmp_le_u32 s32, 200000
    s_cbranch_scc1 L_fast_retryp
    s_mov_b32 s36, s24
    buffer_store_dword v12, v10, s[8:11], s36 offen
L_fast_gotp:
    s_add_u32 s31, s31, 0x2000
    s_cmp_ge_u32 s90, 63
    s_cbranch_scc1 L_fast_last
    s_mov_b32 s23, s24
    s_mov_b32 s22, s90
    s_mov_b32 s27, s28
    v_mov_b64 v[64:65], 0
    v_mov_b64 v[66:67], 0
    v_mov_b64 v[68:69], 0
    v_mov_b64 v[70:71], 0
    s_nop 15
    s_nop 11
    buffer_load_dwordx4 v[16:19], v2, s[8:11], s7 offen sc1
    buffer_load_dwordx4 v[20:23], v2, s[8:11], s7 offen offset:1024 sc1
    s_branch L_fast_step
L_fast_last:
    buffer_store_dword v12, v10, s[8:11], s31 offen sc1
    s_branch L_fast_done
L_fast_refresh:
    buffer_load_dword v15, v0, s[8:11], s23 offen sc1
    s_add_u32 s32, s32, 1
    s_cmp_le_u32 s32, 200000
    s_waitcnt vmcnt(0)
    s_cbranch_scc1 L_fast_step
    s_branch L_fast_fresh
L_fast_safe:
    s_nop 11
    s_waitcnt vmcnt(0) lgkmcnt(0)
    s_barrier
    ds_read_b128 v[72:75], v6 offset:0
    ds_read_b128 v[88:91], v6 offset:2304
    ds_read_b128 v[76:79], v6 offset:64
    ds_read_b128 v[92:95], v6 offset:2368
    ds_read_b128 v[80:83], v6 offset:128
    ds_read_b128 v[96:99], v6 offset:2432
    ds_read_b128 v[84:87], v6 offset:192
    ds_read_b128 v[100:103], v6 offset:2496
    s_xor_b32 s36, s25, 0x1000
    s_add_u32 s36, s36, s23
    buffer_load_dwordx4 v[16:19], v3, s[8:11], s29 offen offset:0 sc1
    buffer_load_dwordx4 v[32:35], v3, s[8:11], s36 offen offset:0 sc1
    buffer_load_dwordx4 v[20:23], v3, s[8:11], s29 offen offset:1024 sc1
    buffer_load_dwordx4 v[36:39], v3, s[8:11], s36 offen offset:1024 sc1
    buffer_load_dwordx4 v[24:27], v3, s[8:11], s29 offen offset:2048 sc1
    buffer_load_dwordx4 v[40:43], v3, s[8:11], s36 offen offset:2048 sc1
    buffer_load_dwordx4 v[28:31], v3, s[8:11], s29 offen offset:3072 sc1
    buffer_load_dwordx4 v[44:47], v3, s[8:11], s36 offen offset:3072 sc1
    s_waitcnt vmcnt(0) lgkmcnt(0)
    v_mfma_f32_16x16x32_bf16 v[48:51], v[16:19], v[72:75], 0
    v_mfma_f32_16x16x32_bf16 v[48:51], v[20:23], v[76:79], v[48:51]
    v_mfma_f32_16x16x32_bf16 v[48:51], v[24:27], v[80:83], v[48:51]
    v_mfma_f32_16x16x32_bf16 v[48:51], v[28:31], v[84:87], v[48:51]
    v_mfma_f32_16x16x32_bf16 v[52:55], v[32:35], v[72:75], 0
    v_mfma_f32_16x16x32_bf16 v[52:55], v[36:39], v[76:79], v[52:55]
    v_mfma_f32_16x16x32_bf16 v[52:55], v[40:43], v[80:83], v[52:55]
    v_mfma_f32_16x16x32_bf16 v[52:55], v[44:47], v[84:87], v[52:55]
    v_mfma_f32_16x16x32_bf16 v[56:59], v[88:91], v[72:75], 0
    v_mfma_f32_16x16x32_bf16 v[56:59], v[92:95], v[76:79], v[56:59]
    v_mfma_f32_16x16x32_bf16 v[56:59], v[96:99], v[80:83], v[56:59]
    v_mfma_f32_16x16x32_bf16 v[56:59], v[100:103], v[84:87], v[56:59]
    s_nop 7
    v_mul_f32 v56, s33, v56
    v_mul_f32 v57, s33, v57
    v_max3_f32 v16, v48, v49, v50
    v_max3_f32 v16, v16, v51, v52
    v_max3_f32 v16, v16, v53, v54
    v_max3_f32 v16, v16, v55, v56
    v_max_f32 v16, v16, v57
    v_mov_b32 v17, v16
    s_nop 1
    v_permlane16_swap_b32 v16, v17
    v_max_f32 v16, v16, v17
    v_mov_b32 v17, v16
    s_nop 1
    v_permlane32_swap_b32 v16, v17
    v_max_f32 v16, v16, v17
    v_sub_f32 v48, v48, v16
    v_exp_f32 v48, v48
    v_sub_f32 v49, v49, v16
    v_exp_f32 v49, v49
    v_sub_f32 v50, v50, v16
    v_exp_f32 v50, v50
    v_sub_f32 v51, v51, v16
    v_exp_f32 v51, v51
    v_sub_f32 v52, v52, v16
    v_exp_f32 v52, v52
    v_sub_f32 v53, v53, v16
    v_exp_f32 v53, v53
    v_sub_f32 v54, v54, v16
    v_exp_f32 v54, v54
    v_sub_f32 v55, v55, v16
    v_exp_f32 v55, v55
    v_sub_f32 v56, v56, v16
    v_exp_f32 v56, v56
    v_sub_f32 v57, v57, v16
    v_exp_f32 v57, v57
    v_cvt_pk_bf16_f32 v108, v48, v49
    v_cvt_pk_bf16_f32 v109, v50, v51
    v_cvt_pk_bf16_f32 v110, v52, v53
    v_cvt_pk_bf16_f32 v111, v54, v55
    v_cvt_pk_bf16_f32 v112, v56, v57
    s_nop 0
    v_mfma_f32_16x16x32_bf16 v[48:51], v[104:107], v[108:111], 0
    v_mfma_f32_16x16x32_bf16 v[56:59], v[120:123], v[108:111], 0
    v_mfma_f32_16x16x32_bf16 v[60:63], v[124:127], v[108:111], 0
    s_nop 3
    v_mfma_f32_16x16x16_bf16 v[48:51], v[104:105], v[112:113], v[48:51]
    v_mfma_f32_16x16x16_bf16 v[56:59], v[114:115], v[112:113], v[56:59]
    v_mfma_f32_16x16x16_bf16 v[60:63], v[116:117], v[112:113], v[60:63]
    s_nop 5
    v_rcp_f32 v118, v48
    s_nop 0
    v_mul_f32 v56, v56, v118
    v_mul_f32 v57, v57, v118
    v_mul_f32 v58, v58, v118
    v_mul_f32 v59, v59, v118
    v_mul_f32 v60, v60, v118
    v_mul_f32 v61, v61, v118
    v_mul_f32 v62, v62, v118
    v_mul_f32 v63, v63, v118
    v_cvt_pk_bf16_f32 v52, v56, v60
    v_cvt_pk_bf16_f32 v53, v57, v61
    v_cvt_pk_bf16_f32 v54, v58, v62
    v_cvt_pk_bf16_f32 v55, v59, v63
    v_mov_b32 v16, 0
    v_mov_b32 v17, 0
    v_mov_b32 v18, 0
    v_mov_b32 v19, 0
    v_mov_b32 v20, 0
    v_mov_b32 v21, 0
    v_mov_b32 v22, 0
    v_mov_b32 v23, 0
    v_mov_b32 v24, 0
    v_mov_b32 v25, 0
    v_mov_b32 v26, 0
    v_mov_b32 v27, 0
    v_mov_b32 v28, 0
    v_mov_b32 v29, 0
    v_mov_b32 v30, 0
    v_mov_b32 v31, 0
    v_bitop3_b32 v32, v13, s96, -9 bitop3:0x28
    v_bitop3_b32 v36, v13, s97, -9 bitop3:0x28
    v_bitop3_b32 v40, v13, s98, -9 bitop3:0x28
    s_mov_b64 vcc, 0
    s_branch L_fast_rejoin
L_fast_done:
    s_branch L_end
L_slow_start:
    s_mov_b32 s22, 0
    s_mov_b32 s23, 0x1000000
    s_mov_b32 s27, 0
    s_mov_b32 s31, 0x80000
    s_mov_b32 s61, 0x40000000
    s_mov_b32 s96, 0x800
    s_mov_b32 s97, 0x1000
    s_mov_b32 s98, 0x1800
    s_mov_b32 s92, 0xcccccccc
    s_mov_b32 s93, 0xcccccccc
    s_mov_b32 s91, 0
    ds_read_b128 v[104:107], v4 offset:0
    ds_read_b128 v[108:111], v4 offset:1024
    ds_read_b128 v[112:115], v4 offset:2048
    ds_read_b128 v[116:119], v4 offset:3072
    ds_read_b128 v[88:91], v4 offset:4096
    ds_read_b128 v[92:95], v4 offset:5120
    ds_read_b128 v[96:99], v4 offset:6144
    ds_read_b128 v[100:103], v4 offset:7168
    ds_read_b128 v[72:75], v4 offset:8192
    ds_read_b128 v[76:79], v4 offset:9216
    ds_read_b128 v[80:83], v4 offset:10240
    ds_read_b128 v[84:87], v4 offset:11264
    v_mov_b64 v[48:49], 0
    v_mov_b64 v[50:51], 0
    v_mov_b64 v[52:53], 0
    v_mov_b64 v[54:55], 0
    v_mov_b64 v[56:57], 0
    v_mov_b64 v[58:59], 0
    v_mov_b64 v[60:61], 0
    v_mov_b64 v[62:63], 0
    v_mov_b64 v[64:65], 0
    v_mov_b64 v[66:67], 0
    v_mov_b64 v[68:69], 0
    v_mov_b64 v[70:71], 0
    s_add_u32 s7, s23, 0x80000
    buffer_load_dwordx4 v[16:19], v2, s[8:11], s7 offen sc1
    buffer_load_dwordx4 v[20:23], v2, s[8:11], s7 offen offset:1024 sc1
    s_waitcnt vmcnt(2)
L_slow_step:
    v_readlane_b32 s36, v15, 33
    s_add_u32 s24, s23, 0x82100
    s_cmp_eq_u32 s36, 0
    s_cbranch_scc1 L_slow_refresh
L_slow_fresh:
    s_add_u32 s29, s23, s25
    s_add_u32 s30, s23, s39
    s_xor_b32 s28, s27, 1
    s_add_u32 s90, s22, 1
    s_nop 15
L_slow_retrym:
    buffer_load_dwordx4 v[16:19], v2, s[8:11], s7 offen sc1
    buffer_load_dwordx4 v[20:23], v2, s[8:11], s7 offen offset:1024 sc1
L_slow_prem:
    s_add_u32 s32, s32, 1
    s_cmp_gt_u32 s32, 200000
    s_cselect_b32 s94, -1, -2
    v_xor_b32 v28, 0x800, v2
    v_xor_b32 v44, 0x1800, v2
    v_mov_b64 v[48:49], 0
    v_mov_b64 v[50:51], 0
    v_mov_b64 v[52:53], 0
    v_mov_b64 v[54:55], 0
L_slow_waitm:
    s_waitcnt vmcnt(3) lgkmcnt(0)
L_slow_gotm:
    v_max3_u32 v14, v16, v17, v18
    v_max_u32 v14, v14, v19
    v_smfmac_f32_16x16x64_bf16 v[48:51], v[16:19], v[104:111], v1
    s_waitcnt vmcnt(2)
    v_max3_u32 v14, v14, v20, v21
    v_smfmac_f32_16x16x64_bf16 v[52:55], v[16:19], v[112:119], v1
    v_max3_u32 v14, v14, v22, v23
    v_cmp_lt_u32 vcc, s94, v14
    v_smfmac_f32_16x16x64_bf16 v[48:51], v[20:23], v[88:95], v1
    ds_write_b128 v2, v[16:19] offset:0
    s_cbranch_vccnz L_slow_retrym
    v_smfmac_f32_16x16x64_bf16 v[52:55], v[20:23], v[96:103], v1
    ds_write_b128 v2, v[20:23] offset:1024
    v_smfmac_f32_16x16x64_bf16 v[56:59], v[16:19], v[72:79], v1
    buffer_load_dwordx4 v[104:107], v3, s[8:11], s29 offen offset:0 sc1
    buffer_load_dwordx4 v[120:123], v3, s[8:11], s30 offen offset:0 sc1
    v_smfmac_f32_16x16x64_bf16 v[60:63], v[16:19], v[80:87], v1
    buffer_load_dwordx4 v[108:111], v3, s[8:11], s29 offen offset:1024 sc1
    buffer_load_dwordx4 v[124:127], v3, s[8:11], s30 offen offset:1024 sc1
    v_smfmac_f32_16x16x64_bf16 v[56:59], v[20:23], a[80:87], v1
    buffer_load_dwordx4 v[112:115], v3, s[8:11], s29 offen offset:2048 sc1
    buffer_load_dwordx4 v[116:119], v3, s[8:11], s29 offen offset:3072 sc1
    v_smfmac_f32_16x16x64_bf16 v[60:63], v[20:23], a[88:95], v1
    s_waitcnt lgkmcnt(0)
    s_barrier
    ds_read_b128 v[24:27], v28 offset:0
    v_smfmac_f32_16x16x64_bf16 v[64:67], v[16:19], a[160:167], v1
    ds_read_b128 v[28:31], v28 offset:1024
    v_smfmac_f32_16x16x64_bf16 v[68:71], v[16:19], a[168:175], v1
    buffer_load_dword v15, v0, s[8:11], s24 offen sc1
    v_smfmac_f32_16x16x64_bf16 v[64:67], v[20:23], a[176:183], v1
    ds_read_b128 v[32:35], v8 offset:0
    v_smfmac_f32_16x16x64_bf16 v[68:71], v[20:23], a[184:191], v1
    ds_read_b128 v[36:39], v8 offset:1024
    s_waitcnt lgkmcnt(3)
    v_smfmac_f32_16x16x64_bf16 v[48:51], v[24:27], a[0:7], v1
    ds_read_b128 v[40:43], v44 offset:0
    v_smfmac_f32_16x16x64_bf16 v[52:55], v[24:27], a[8:15], v1
    ds_read_b128 v[44:47], v44 offset:1024
    s_waitcnt lgkmcnt(4)
    v_smfmac_f32_16x16x64_bf16 v[48:51], v[28:31], a[16:23], v1
    ds_read_b128 v[88:91], v4 offset:12288
    v_smfmac_f32_16x16x64_bf16 v[52:55], v[28:31], a[24:31], v1
    ds_read_b128 v[92:95], v4 offset:13312
    s_waitcnt lgkmcnt(4)
    v_smfmac_f32_16x16x64_bf16 v[48:51], v[32:35], a[32:39], v1
    ds_read_b128 v[96:99], v4 offset:14336
    v_smfmac_f32_16x16x64_bf16 v[52:55], v[32:35], a[40:47], v1
    ds_read_b128 v[100:103], v4 offset:15360
    s_waitcnt lgkmcnt(4)
    v_smfmac_f32_16x16x64_bf16 v[48:51], v[36:39], a[48:55], v1
    v_smfmac_f32_16x16x64_bf16 v[52:55], v[36:39], a[56:63], v1
    ds_read_b128 v[72:75], v4 offset:16384
    v_smfmac_f32_16x16x64_bf16 v[48:51], v[40:43], a[64:71], v1
    v_smfmac_f32_16x16x64_bf16 v[52:55], v[40:43], a[72:79], v1
    ds_read_b128 v[76:79], v4 offset:17408
    s_waitcnt lgkmcnt(2)
    v_smfmac_f32_16x16x64_bf16 v[48:51], v[44:47], v[88:95], v1
    ds_read_b128 v[80:83], v4 offset:18432
    v_smfmac_f32_16x16x64_bf16 v[52:55], v[44:47], v[96:103], v1
    ds_read_b128 v[84:87], v4 offset:19456
    v_smfmac_f32_16x16x64_bf16 v[56:59], v[28:31], a[96:103], v1
    ds_read_b128 v[88:91], v4 offset:20480
    v_smfmac_f32_16x16x64_bf16 v[60:63], v[28:31], a[104:111], v1
    ds_read_b128 v[92:95], v4 offset:21504
    v_smfmac_f32_16x16x64_bf16 v[56:59], v[32:35], a[112:119], v1
    ds_read_b128 v[96:99], v4 offset:22528
    v_add_f32 v48, v48, v50
    v_add_f32 v49, v49, v51
    v_smfmac_f32_16x16x64_bf16 v[60:63], v[32:35], a[120:127], v1
    ds_read_b128 v[100:103], v4 offset:23552
    v_add_f32 v52, v52, v54
    v_add_f32 v53, v53, v55
    v_smfmac_f32_16x16x64_bf16 v[56:59], v[36:39], a[128:135], v1
    s_waitcnt lgkmcnt(4)
    v_cvt_pk_bf16_f32 v50, v48, v52
    v_cvt_pk_bf16_f32 v51, v49, v53
    v_smfmac_f32_16x16x64_bf16 v[56:59], v[24:27], v[72:79], v1
    ds_write2_b32 v5, v50, v51 offset0:0 offset1:72
    v_smfmac_f32_16x16x64_bf16 v[60:63], v[24:27], v[80:87], v1
    v_smfmac_f32_16x16x64_bf16 v[60:63], v[36:39], a[136:143], v1
    v_smfmac_f32_16x16x64_bf16 v[56:59], v[40:43], a[144:151], v1
    buffer_store_dword v12, v10, s[8:11], s31 offen sc1
    v_smfmac_f32_16x16x64_bf16 v[60:63], v[40:43], a[152:159], v1
    s_waitcnt lgkmcnt(0)
    s_barrier
    v_smfmac_f32_16x16x64_bf16 v[56:59], v[44:47], v[88:95], v1
    ds_read_b128 v[72:75], v6 offset:0
    v_smfmac_f32_16x16x64_bf16 v[60:63], v[44:47], v[96:103], v1
    ds_read_b128 v[76:79], v6 offset:64
    v_smfmac_f32_16x16x64_bf16 v[64:67], v[24:27], a[192:199], v1
    ds_read_b128 v[80:83], v6 offset:128
    v_smfmac_f32_16x16x64_bf16 v[68:71], v[24:27], a[200:207], v1
    ds_read_b128 v[84:87], v6 offset:192
    s_waitcnt vmcnt(2) lgkmcnt(3)
    v_mfma_f32_16x16x32_bf16 v[48:51], v[104:107], v[72:75], 0
    s_waitcnt lgkmcnt(2)
    v_add_f32 v56, v56, v58
    v_add_f32 v57, v57, v59
    v_mfma_f32_16x16x32_bf16 v[48:51], v[108:111], v[76:79], v[48:51]
    s_waitcnt lgkmcnt(1)
    v_add_f32 v60, v60, v62
    v_add_f32 v61, v61, v63
    v_mfma_f32_16x16x32_bf16 v[48:51], v[112:115], v[80:83], v[48:51]
    s_waitcnt lgkmcnt(0)
    v_cvt_pk_bf16_f32 v58, v56, v60
    v_cvt_pk_bf16_f32 v59, v57, v61
    v_mfma_f32_16x16x32_bf16 v[48:51], v[116:119], v[84:87], v[48:51]
    ds_write2_b32 v7, v58, v59 offset0:0 offset1:72
    v_smfmac_f32_16x16x64_bf16 v[64:67], v[28:31], a[208:215], v1
    v_mov_b64 v[104:105], s[4:5]
    v_smfmac_f32_16x16x64_bf16 v[68:71], v[28:31], a[216:223], v1
    s_nop 1
    v_mov_b64 v[106:107], s[4:5]
    v_smfmac_f32_16x16x64_bf16 v[64:67], v[32:35], a[224:231], v1
    v_exp_f32 v48, v48
    v_smfmac_f32_16x16x64_bf16 v[68:71], v[32:35], a[232:239], v1
    s_waitcnt lgkmcnt(0)
    s_barrier
    v_exp_f32 v49, v49
    v_smfmac_f32_16x16x64_bf16 v[64:67], v[36:39], a[240:247], v1
    ds_read_b128 v[88:91], v6 offset:2304
    v_exp_f32 v50, v50
    v_smfmac_f32_16x16x64_bf16 v[68:71], v[36:39], a[248:255], v1
    ds_read_b128 v[92:95], v6 offset:2368
    v_exp_f32 v51, v51
    v_smfmac_f32_16x16x64_bf16 v[64:67], v[40:43], v[128:135], v1
    ds_read_b128 v[96:99], v6 offset:2432
    v_cvt_pk_bf16_f32 v108, v48, v49
    v_cvt_pk_bf16_f32 v109, v50, v51
    v_smfmac_f32_16x16x64_bf16 v[68:71], v[40:43], v[136:143], v1
    ds_read_b128 v[100:103], v6 offset:2496
    ds_write_b64 v2, v[108:109] offset:8192
    s_waitcnt lgkmcnt(4)
    v_mfma_f32_16x16x32_bf16 v[52:55], v[88:91], v[72:75], 0
    s_waitcnt lgkmcnt(3)
    v_mov_b32 v113, 0
    v_mov_b32 v115, 0
    v_mfma_f32_16x16x32_bf16 v[52:55], v[92:95], v[76:79], v[52:55]
    s_waitcnt lgkmcnt(2)
    v_mov_b32 v117, 0
    v_mov_b64 v[16:17], 0
    v_mfma_f32_16x16x32_bf16 v[52:55], v[96:99], v[80:83], v[52:55]
    s_waitcnt lgkmcnt(1)
    v_mov_b64 v[18:19], 0
    v_mov_b64 v[20:21], 0
    v_mfma_f32_16x16x32_bf16 v[52:55], v[100:103], v[84:87], v[52:55]
    s_waitcnt lgkmcnt(0)
    s_barrier
    v_smfmac_f32_16x16x64_bf16 v[64:67], v[44:47], v[144:151], v1
    ds_read_b64 v[110:111], v8 offset:8192
    v_mov_b64 v[22:23], 0
    v_smfmac_f32_16x16x64_bf16 v[68:71], v[44:47], v[152:159], v1
    v_mov_b64 v[24:25], 0
    v_mov_b64 v[26:27], 0
    v_mul_f32 v52, s33, v52
    v_mul_f32 v53, s33, v53
    v_exp_f32 v52, v52
    s_waitcnt lgkmcnt(0)
    v_mfma_f32_16x16x32_bf16 v[48:51], v[104:107], v[108:111], 0
    v_exp_f32 v53, v53
    v_add_f32 v64, v64, v66
    v_mfma_f32_16x16x32_bf16 v[56:59], v[120:123], v[108:111], 0
    v_cvt_pk_bf16_f32 v112, v52, v53
    v_add_f32 v65, v65, v67
    v_mfma_f32_16x16x32_bf16 v[60:63], v[124:127], v[108:111], 0
    v_cvt_pk_bf16_f32 v114, v64, v65
    v_add_f32 v68, v68, v70
    v_mfma_f32_16x16x16_bf16 v[48:51], v[104:105], v[112:113], v[48:51]
    v_add_f32 v69, v69, v71
    v_cvt_pk_bf16_f32 v116, v68, v69
    v_mfma_f32_16x16x16_bf16 v[56:59], v[114:115], v[112:113], v[56:59]
    v_mov_b64 v[28:29], 0
    v_mov_b64 v[30:31], 0
    v_mfma_f32_16x16x16_bf16 v[60:63], v[116:117], v[112:113], v[60:63]
    v_bitop3_b32 v32, v13, s96, -9 bitop3:0x28
    v_bitop3_b32 v36, v13, s97, -9 bitop3:0x28
    v_rcp_f32 v118, v48
    v_bitop3_b32 v40, v13, s98, -9 bitop3:0x28
    v_max_f32 v14, v118, v48
    v_cmp_nge_f32 vcc, s40, v14
    v_pk_mul_f32 v[56:57], v[56:57], v[118:119] op_sel_hi:[1,0]
    v_pk_mul_f32 v[58:59], v[58:59], v[118:119] op_sel_hi:[1,0]
    v_pk_mul_f32 v[60:61], v[60:61], v[118:119] op_sel_hi:[1,0]
    v_pk_mul_f32 v[62:63], v[62:63], v[118:119] op_sel_hi:[1,0]
    v_cvt_pk_bf16_f32 v52, v56, v60
    v_cvt_pk_bf16_f32 v54, v58, v62
    v_cvt_pk_bf16_f32 v53, v57, v61
    v_cvt_pk_bf16_f32 v55, v59, v63
L_slow_rejoin:
    v_cndmask_b32 v50, v52, v54, s[92:93]
    v_cndmask_b32 v51, v53, v55, s[92:93]
    ds_write_b64 v13, v[50:51] offset:9216
    v_smfmac_f32_16x16x64_bf16 v[16:19], v[52:55], v[160:167], v1
    v_smfmac_f32_16x16x64_bf16 v[20:23], v[52:55], v[168:175], v1
    s_waitcnt lgkmcnt(0)
    s_barrier
    ds_read_b128 v[32:35], v32 offset:9216
    ds_read_b128 v[36:39], v36 offset:9216
    v_smfmac_f32_16x16x64_bf16 v[24:27], v[52:55], v[176:183], v1
    ds_read_b128 v[40:43], v40 offset:9216
    v_smfmac_f32_16x16x64_bf16 v[28:31], v[52:55], v[184:191], v1
    ds_read_b128 v[88:91], v4 offset:24576
    ds_read_b128 v[92:95], v4 offset:25600
    s_waitcnt lgkmcnt(4)
    v_smfmac_f32_16x16x64_bf16 v[16:19], v[32:35], v[192:199], v1
    ds_read_b128 v[96:99], v4 offset:26624
    s_waitcnt lgkmcnt(4)
    v_smfmac_f32_16x16x64_bf16 v[16:19], v[36:39], v[216:223], v1
    ds_read_b128 v[100:103], v4 offset:27648
    s_waitcnt lgkmcnt(4)
    v_smfmac_f32_16x16x64_bf16 v[16:19], v[40:43], v[240:247], v1
    ds_read_b128 v[72:75], v4 offset:28672
    s_cmp_lg_u64 vcc, 0
    v_smfmac_f32_16x16x64_bf16 v[20:23], v[32:35], v[200:207], v1
    ds_read_b128 v[76:79], v4 offset:29696
    s_cselect_b32 s60, s28, s27
    v_smfmac_f32_16x16x64_bf16 v[20:23], v[36:39], v[224:231], v1
    ds_read_b128 v[80:83], v4 offset:30720
    s_nop 0
    v_cvt_pk_bf16_f32 v56, v16, v18
    v_smfmac_f32_16x16x64_bf16 v[20:23], v[40:43], v[248:255], v1
    ds_read_b128 v[84:87], v4 offset:31744
    v_cvt_pk_bf16_f32 v57, v17, v19
    v_and_or_b32 v56, v56, -2, s60
    v_smfmac_f32_16x16x64_bf16 v[24:27], v[32:35], v[208:215], v1
    buffer_store_dwordx2 v[56:57], v9, s[8:11], 0 offen offset:0 sc1
    v_smfmac_f32_16x16x64_bf16 v[24:27], v[36:39], v[232:239], v1
    s_waitcnt lgkmcnt(4)
    s_nop 0
    v_cvt_pk_bf16_f32 v58, v20, v22
    v_smfmac_f32_16x16x64_bf16 v[24:27], v[40:43], v[88:95], v1
    ds_read_b128 v[64:67], v3 offset:23040
    v_cvt_pk_bf16_f32 v59, v21, v23
    v_and_or_b32 v58, v58, -2, s60
    v_smfmac_f32_16x16x64_bf16 v[28:31], v[32:35], v[96:103], v1
    buffer_store_dwordx2 v[58:59], v9, s[8:11], 0 offen offset:2048 sc1
    s_waitcnt lgkmcnt(1)
    v_smfmac_f32_16x16x64_bf16 v[28:31], v[36:39], v[72:79], v1
    s_nop 1
    v_cvt_pk_bf16_f32 v60, v24, v26
    v_smfmac_f32_16x16x64_bf16 v[28:31], v[40:43], v[80:87], v1
    s_nop 2
    v_cvt_pk_bf16_f32 v61, v25, v27
    v_and_or_b32 v60, v60, -2, s60
    buffer_store_dwordx2 v[60:61], v9, s[8:11], s26 offen offset:0 sc1
    s_nop 1
    v_cvt_pk_bf16_f32 v62, v28, v30
    v_cvt_pk_bf16_f32 v63, v29, v31
    v_and_or_b32 v62, v62, -2, s60
    buffer_store_dwordx2 v[62:63], v9, s[8:11], s26 offen offset:2048 sc1
L_slow_stored:
    s_cmp_lg_u32 s60, s27
    s_cbranch_scc1 L_slow_safe
    ds_read_b128 v[104:107], v4 offset:0
    ds_read_b128 v[108:111], v4 offset:1024
    ds_read_b128 v[112:115], v4 offset:2048
    ds_read_b128 v[116:119], v4 offset:3072
    ds_read_b128 v[88:91], v4 offset:4096
    ds_read_b128 v[92:95], v4 offset:5120
    ds_read_b128 v[96:99], v4 offset:6144
    ds_read_b128 v[100:103], v4 offset:7168
    ds_read_b128 v[72:75], v4 offset:8192
    ds_read_b128 v[76:79], v4 offset:9216
    ds_read_b128 v[80:83], v4 offset:10240
    ds_read_b128 v[84:87], v4 offset:11264
    s_cmp_lt_u32 s21, 1
    s_cbranch_scc1 L_slow_pollp
    s_nop 13
    s_cmp_lt_u32 s21, 2
    s_cbranch_scc1 L_slow_pollp
    s_nop 13
    s_cmp_lt_u32 s21, 3
    s_cbranch_scc1 L_slow_pollp
    s_nop 13
L_slow_pollp:
    buffer_load_dwordx4 v[120:123], v2, s[8:11], s6 offen sc1
    buffer_load_dwordx4 v[124:127], v2, s[8:11], s6 offen offset:1024 sc1
    v_mov_b64 v[56:57], 0
    v_mov_b64 v[58:59], 0
    v_mov_b64 v[60:61], 0
    v_mov_b64 v[62:63], 0
    s_nop 15
    s_nop 15
    buffer_load_dwordx4 v[32:35], v2, s[8:11], s6 offen sc1
    buffer_load_dwordx4 v[36:39], v2, s[8:11], s6 offen offset:1024 sc1
L_slow_prep:
    s_add_u32 s7, s24, 0x80000
    s_waitcnt vmcnt(3) lgkmcnt(0)
    v_mfma_f32_16x16x32_bf16 v[68:71], v[64:67], v[120:123], 0
    v_bitop3_b32 v14, v120, v122, s27 bitop3:0x7e
    s_waitcnt vmcnt(2)
    v_mfma_f32_16x16x32_bf16 v[68:71], v[64:67], v[124:127], v[68:71]
    v_bitop3_b32 v11, v124, v126, s27 bitop3:0x7e
    v_bitop3_b32 v14, v14, v11, 1 bitop3:0xa8
    v_cmp_ne_u32 vcc, 0, v14
    s_nop 2
    s_cmp_eq_u64 vcc, 0
    s_cselect_b32 s36, s24, s61
    v_add_f32_dpp v68, v68, v68 row_ror:8 row_mask:0xf bank_mask:0xf
    v_add_f32_dpp v69, v69, v69 row_ror:8 row_mask:0xf bank_mask:0xf
    s_nop 0
    v_add_f32_dpp v68, v68, v68 row_ror:4 row_mask:0xf bank_mask:0xf
    v_add_f32_dpp v69, v69, v69 row_ror:4 row_mask:0xf bank_mask:0xf
    v_cvt_pk_bf16_f32 v12, v68, v69
    buffer_store_dword v12, v10, s[8:11], s36 offen sc1
    s_cbranch_scc1 L_slow_gotp
L_slow_retryp:
    buffer_load_dwordx4 v[120:123], v2, s[8:11], s6 offen sc1
    buffer_load_dwordx4 v[124:127], v2, s[8:11], s6 offen offset:1024 sc1
    s_waitcnt vmcnt(4) lgkmcnt(0)
    v_mfma_f32_16x16x32_bf16 v[68:71], v[64:67], v[32:35], 0
    v_bitop3_b32 v14, v32, v34, s27 bitop3:0x7e
    s_waitcnt vmcnt(3)
    v_mfma_f32_16x16x32_bf16 v[68:71], v[64:67], v[36:39], v[68:71]
    v_bitop3_b32 v11, v36, v38, s27 bitop3:0x7e
    v_bitop3_b32 v14, v14, v11, 1 bitop3:0xa8
    v_cmp_ne_u32 vcc, 0, v14
    s_nop 2
    s_cmp_eq_u64 vcc, 0
    s_cselect_b32 s36, s24, s61
    v_add_f32_dpp v68, v68, v68 row_ror:8 row_mask:0xf bank_mask:0xf
    v_add_f32_dpp v69, v69, v69 row_ror:8 row_mask:0xf bank_mask:0xf
    s_nop 0
    v_add_f32_dpp v68, v68, v68 row_ror:4 row_mask:0xf bank_mask:0xf
    v_add_f32_dpp v69, v69, v69 row_ror:4 row_mask:0xf bank_mask:0xf
    v_cvt_pk_bf16_f32 v12, v68, v69
    buffer_store_dword v12, v10, s[8:11], s36 offen sc1
    s_cbranch_scc1 L_slow_gotp
    buffer_load_dwordx4 v[32:35], v2, s[8:11], s6 offen sc1
    buffer_load_dwordx4 v[36:39], v2, s[8:11], s6 offen offset:1024 sc1
    s_waitcnt vmcnt(4) lgkmcnt(0)
    v_mfma_f32_16x16x32_bf16 v[68:71], v[64:67], v[120:123], 0
    v_bitop3_b32 v14, v120, v122, s27 bitop3:0x7e
    s_waitcnt vmcnt(3)
    v_mfma_f32_16x16x32_bf16 v[68:71], v[64:67], v[124:127], v[68:71]
    v_bitop3_b32 v11, v124, v126, s27 bitop3:0x7e
    v_bitop3_b32 v14, v14, v11, 1 bitop3:0xa8
    v_cmp_ne_u32 vcc, 0, v14
    s_nop 2
    s_cmp_eq_u64 vcc, 0
    s_cselect_b32 s36, s24, s61
    v_add_f32_dpp v68, v68, v68 row_ror:8 row_mask:0xf bank_mask:0xf
    v_add_f32_dpp v69, v69, v69 row_ror:8 row_mask:0xf bank_mask:0xf
    s_nop 0
    v_add_f32_dpp v68, v68, v68 row_ror:4 row_mask:0xf bank_mask:0xf
    v_add_f32_dpp v69, v69, v69 row_ror:4 row_mask:0xf bank_mask:0xf
    v_cvt_pk_bf16_f32 v12, v68, v69
    buffer_store_dword v12, v10, s[8:11], s36 offen sc1
    s_cbranch_scc1 L_slow_gotp
    s_add_u32 s32, s32, 1
    s_cmp_le_u32 s32, 200000
    s_cbranch_scc1 L_slow_retryp
    s_mov_b32 s36, s24
    buffer_store_dword v12, v10, s[8:11], s36 offen sc1
L_slow_gotp:
    s_add_u32 s31, s31, 0x2000
    s_cmp_ge_u32 s90, 63
    s_cbranch_scc1 L_slow_last
    s_mov_b32 s23, s24
    s_mov_b32 s22, s90
    s_mov_b32 s27, s28
    v_mov_b64 v[64:65], 0
    v_mov_b64 v[66:67], 0
    v_mov_b64 v[68:69], 0
    v_mov_b64 v[70:71], 0
    s_nop 15
    s_nop 11
    buffer_load_dwordx4 v[16:19], v2, s[8:11], s7 offen sc1
    buffer_load_dwordx4 v[20:23], v2, s[8:11], s7 offen offset:1024 sc1
    s_branch L_slow_step
L_slow_last:
    buffer_store_dword v12, v10, s[8:11], s31 offen sc1
    s_branch L_slow_done
L_slow_refresh:
    buffer_load_dword v15, v0, s[8:11], s23 offen sc1
    s_add_u32 s32, s32, 1
    s_cmp_le_u32 s32, 200000
    s_waitcnt vmcnt(0)
    s_cbranch_scc1 L_slow_step
    s_branch L_slow_fresh
L_slow_safe:
    s_nop 11
    s_waitcnt vmcnt(0) lgkmcnt(0)
    s_barrier
    ds_read_b128 v[72:75], v6 offset:0
    ds_read_b128 v[88:91], v6 offset:2304
    ds_read_b128 v[76:79], v6 offset:64
    ds_read_b128 v[92:95], v6 offset:2368
    ds_read_b128 v[80:83], v6 offset:128
    ds_read_b128 v[96:99], v6 offset:2432
    ds_read_b128 v[84:87], v6 offset:192
    ds_read_b128 v[100:103], v6 offset:2496
    s_xor_b32 s36, s25, 0x1000
    s_add_u32 s36, s36, s23
    buffer_load_dwordx4 v[16:19], v3, s[8:11], s29 offen offset:0 sc1
    buffer_load_dwordx4 v[32:35], v3, s[8:11], s36 offen offset:0 sc1
    buffer_load_dwordx4 v[20:23], v3, s[8:11], s29 offen offset:1024 sc1
    buffer_load_dwordx4 v[36:39], v3, s[8:11], s36 offen offset:1024 sc1
    buffer_load_dwordx4 v[24:27], v3, s[8:11], s29 offen offset:2048 sc1
    buffer_load_dwordx4 v[40:43], v3, s[8:11], s36 offen offset:2048 sc1
    buffer_load_dwordx4 v[28:31], v3, s[8:11], s29 offen offset:3072 sc1
    buffer_load_dwordx4 v[44:47], v3, s[8:11], s36 offen offset:3072 sc1
    s_waitcnt vmcnt(0) lgkmcnt(0)
    v_mfma_f32_16x16x32_bf16 v[48:51], v[16:19], v[72:75], 0
    v_mfma_f32_16x16x32_bf16 v[48:51], v[20:23], v[76:79], v[48:51]
    v_mfma_f32_16x16x32_bf16 v[48:51], v[24:27], v[80:83], v[48:51]
    v_mfma_f32_16x16x32_bf16 v[48:51], v[28:31], v[84:87], v[48:51]
    v_mfma_f32_16x16x32_bf16 v[52:55], v[32:35], v[72:75], 0
    v_mfma_f32_16x16x32_bf16 v[52:55], v[36:39], v[76:79], v[52:55]
    v_mfma_f32_16x16x32_bf16 v[52:55], v[40:43], v[80:83], v[52:55]
    v_mfma_f32_16x16x32_bf16 v[52:55], v[44:47], v[84:87], v[52:55]
    v_mfma_f32_16x16x32_bf16 v[56:59], v[88:91], v[72:75], 0
    v_mfma_f32_16x16x32_bf16 v[56:59], v[92:95], v[76:79], v[56:59]
    v_mfma_f32_16x16x32_bf16 v[56:59], v[96:99], v[80:83], v[56:59]
    v_mfma_f32_16x16x32_bf16 v[56:59], v[100:103], v[84:87], v[56:59]
    s_nop 7
    v_mul_f32 v56, s33, v56
    v_mul_f32 v57, s33, v57
    v_max3_f32 v16, v48, v49, v50
    v_max3_f32 v16, v16, v51, v52
    v_max3_f32 v16, v16, v53, v54
    v_max3_f32 v16, v16, v55, v56
    v_max_f32 v16, v16, v57
    v_mov_b32 v17, v16
    s_nop 1
    v_permlane16_swap_b32 v16, v17
    v_max_f32 v16, v16, v17
    v_mov_b32 v17, v16
    s_nop 1
    v_permlane32_swap_b32 v16, v17
    v_max_f32 v16, v16, v17
    v_sub_f32 v48, v48, v16
    v_exp_f32 v48, v48
    v_sub_f32 v49, v49, v16
    v_exp_f32 v49, v49
    v_sub_f32 v50, v50, v16
    v_exp_f32 v50, v50
    v_sub_f32 v51, v51, v16
    v_exp_f32 v51, v51
    v_sub_f32 v52, v52, v16
    v_exp_f32 v52, v52
    v_sub_f32 v53, v53, v16
    v_exp_f32 v53, v53
    v_sub_f32 v54, v54, v16
    v_exp_f32 v54, v54
    v_sub_f32 v55, v55, v16
    v_exp_f32 v55, v55
    v_sub_f32 v56, v56, v16
    v_exp_f32 v56, v56
    v_sub_f32 v57, v57, v16
    v_exp_f32 v57, v57
    v_cvt_pk_bf16_f32 v108, v48, v49
    v_cvt_pk_bf16_f32 v109, v50, v51
    v_cvt_pk_bf16_f32 v110, v52, v53
    v_cvt_pk_bf16_f32 v111, v54, v55
    v_cvt_pk_bf16_f32 v112, v56, v57
    s_nop 0
    v_mfma_f32_16x16x32_bf16 v[48:51], v[104:107], v[108:111], 0
    v_mfma_f32_16x16x32_bf16 v[56:59], v[120:123], v[108:111], 0
    v_mfma_f32_16x16x32_bf16 v[60:63], v[124:127], v[108:111], 0
    s_nop 3
    v_mfma_f32_16x16x16_bf16 v[48:51], v[104:105], v[112:113], v[48:51]
    v_mfma_f32_16x16x16_bf16 v[56:59], v[114:115], v[112:113], v[56:59]
    v_mfma_f32_16x16x16_bf16 v[60:63], v[116:117], v[112:113], v[60:63]
    s_nop 5
    v_rcp_f32 v118, v48
    s_nop 0
    v_mul_f32 v56, v56, v118
    v_mul_f32 v57, v57, v118
    v_mul_f32 v58, v58, v118
    v_mul_f32 v59, v59, v118
    v_mul_f32 v60, v60, v118
    v_mul_f32 v61, v61, v118
    v_mul_f32 v62, v62, v118
    v_mul_f32 v63, v63, v118
    v_cvt_pk_bf16_f32 v52, v56, v60
    v_cvt_pk_bf16_f32 v53, v57, v61
    v_cvt_pk_bf16_f32 v54, v58, v62
    v_cvt_pk_bf16_f32 v55, v59, v63
    v_mov_b32 v16, 0
    v_mov_b32 v17, 0
    v_mov_b32 v18, 0
    v_mov_b32 v19, 0
    v_mov_b32 v20, 0
    v_mov_b32 v21, 0
    v_mov_b32 v22, 0
    v_mov_b32 v23, 0
    v_mov_b32 v24, 0
    v_mov_b32 v25, 0
    v_mov_b32 v26, 0
    v_mov_b32 v27, 0
    v_mov_b32 v28, 0
    v_mov_b32 v29, 0
    v_mov_b32 v30, 0
    v_mov_b32 v31, 0
    v_bitop3_b32 v32, v13, s96, -9 bitop3:0x28
    v_bitop3_b32 v36, v13, s97, -9 bitop3:0x28
    v_bitop3_b32 v40, v13, s98, -9 bitop3:0x28
    s_mov_b64 vcc, 0
    s_branch L_slow_rejoin
L_slow_done:
    s_branch L_end
L_worker:
    s_cmp_eq_u32 s3, 7
    s_cbranch_scc1 L_mlp
    s_and_b32 s36, s2, 7
    s_sub_u32 s36, s36, 1
    s_lshl_b32 s36, s36, 5
    s_lshr_b32 s37, s2, 3
    s_add_u32 s36, s36, s37
    s_mul_i32 s20, s36, 10923
    s_lshr_b32 s20, s20, 16
    s_mul_i32 s37, s20, 6
    s_sub_u32 s22, s36, s37
    v_lshrrev_b32 v28, 6, v0
    v_bfe_u32 v29, v0, 4, 2
    v_lshl_add_u32 v28, v28, 5, v29
    v_and_b32 v16, 15, v0
    v_lshlrev_b32 v16, 4, v16
    v_lshl_add_u32 v16, v28, 13, v16
    v_bfe_u32 v29, v0, 4, 2
    v_lshlrev_b32 v29, 5, v29
    v_xor_b32 v16, v16, v29
    v_xor_b32 v17, 0, v16
    v_xor_b32 v18, 128, v16
    v_xor_b32 v19, 128, v16
    s_add_u32 s28, s21, 1
    s_lshl_b32 s28, s28, 15
    s_lshl_b32 s3, s20, 8
    s_mov_b32 s76, s52
    s_and_b32 s77, s53, 0xffff
    s_mov_b32 s78, 0x400000
    s_mov_b32 s79, 0x20000
    s_add_u32 m0, s28, 0
    s_add_u32 s37, s3, 0x0
    buffer_load_dwordx4 v16, s[76:79], s37 offen lds
    s_add_u32 m0, s28, 1024
    s_add_u32 s37, s3, 0x8000
    buffer_load_dwordx4 v17, s[76:79], s37 offen lds
    s_add_u32 m0, s28, 2048
    s_add_u32 s37, s3, 0x10000
    buffer_load_dwordx4 v18, s[76:79], s37 offen lds
    s_add_u32 m0, s28, 3072
    s_add_u32 s37, s3, 0x18000
    buffer_load_dwordx4 v19, s[76:79], s37 offen lds
    s_add_u32 m0, s28, 4096
    s_add_u32 s37, s3, 0x20000
    buffer_load_dwordx4 v16, s[76:79], s37 offen lds
    s_add_u32 m0, s28, 5120
    s_add_u32 s37, s3, 0x28000
    buffer_load_dwordx4 v17, s[76:79], s37 offen lds
    s_add_u32 m0, s28, 6144
    s_add_u32 s37, s3, 0x30000
    buffer_load_dwordx4 v18, s[76:79], s37 offen lds
    s_add_u32 m0, s28, 7168
    s_add_u32 s37, s3, 0x38000
    buffer_load_dwordx4 v19, s[76:79], s37 offen lds
    s_add_u32 m0, s28, 8192
    s_add_u32 s37, s3, 0x100000
    buffer_load_dwordx4 v16, s[76:79], s37 offen lds
    s_add_u32 m0, s28, 9216
    s_add_u32 s37, s3, 0x108000
    buffer_load_dwordx4 v17, s[76:79], s37 offen lds
    s_add_u32 m0, s28, 10240
    s_add_u32 s37, s3, 0x110000
    buffer_load_dwordx4 v18, s[76:79], s37 offen lds
    s_add_u32 m0, s28, 11264
    s_add_u32 s37, s3, 0x118000
    buffer_load_dwordx4 v19, s[76:79], s37 offen lds
    s_add_u32 m0, s28, 12288
    s_add_u32 s37, s3, 0x120000
    buffer_load_dwordx4 v16, s[76:79], s37 offen lds
    s_add_u32 m0, s28, 13312
    s_add_u32 s37, s3, 0x128000
    buffer_load_dwordx4 v17, s[76:79], s37 offen lds
    s_add_u32 m0, s28, 14336
    s_add_u32 s37, s3, 0x130000
    buffer_load_dwordx4 v18, s[76:79], s37 offen lds
    s_add_u32 m0, s28, 15360
    s_add_u32 s37, s3, 0x138000
    buffer_load_dwordx4 v19, s[76:79], s37 offen lds
    s_add_u32 m0, s28, 16384
    s_add_u32 s37, s3, 0x200000
    buffer_load_dwordx4 v16, s[76:79], s37 offen lds
    s_add_u32 m0, s28, 17408
    s_add_u32 s37, s3, 0x208000
    buffer_load_dwordx4 v17, s[76:79], s37 offen lds
    s_add_u32 m0, s28, 18432
    s_add_u32 s37, s3, 0x210000
    buffer_load_dwordx4 v18, s[76:79], s37 offen lds
    s_add_u32 m0, s28, 19456
    s_add_u32 s37, s3, 0x218000
    buffer_load_dwordx4 v19, s[76:79], s37 offen lds
    s_add_u32 m0, s28, 20480
    s_add_u32 s37, s3, 0x220000
    buffer_load_dwordx4 v16, s[76:79], s37 offen lds
    s_add_u32 m0, s28, 21504
    s_add_u32 s37, s3, 0x228000
    buffer_load_dwordx4 v17, s[76:79], s37 offen lds
    s_add_u32 m0, s28, 22528
    s_add_u32 s37, s3, 0x230000
    buffer_load_dwordx4 v18, s[76:79], s37 offen lds
    s_add_u32 m0, s28, 23552
    s_add_u32 s37, s3, 0x238000
    buffer_load_dwordx4 v19, s[76:79], s37 offen lds
    s_add_u32 m0, s28, 24576
    s_add_u32 s37, s3, 0x300000
    buffer_load_dwordx4 v16, s[76:79], s37 offen lds
    s_add_u32 m0, s28, 25600
    s_add_u32 s37, s3, 0x308000
    buffer_load_dwordx4 v17, s[76:79], s37 offen lds
    s_add_u32 m0, s28, 26624
    s_add_u32 s37, s3, 0x310000
    buffer_load_dwordx4 v18, s[76:79], s37 offen lds
    s_add_u32 m0, s28, 27648
    s_add_u32 s37, s3, 0x318000
    buffer_load_dwordx4 v19, s[76:79], s37 offen lds
    s_add_u32 m0, s28, 28672
    s_add_u32 s37, s3, 0x320000
    buffer_load_dwordx4 v16, s[76:79], s37 offen lds
    s_add_u32 m0, s28, 29696
    s_add_u32 s37, s3, 0x328000
    buffer_load_dwordx4 v17, s[76:79], s37 offen lds
    s_add_u32 m0, s28, 30720
    s_add_u32 s37, s3, 0x330000
    buffer_load_dwordx4 v18, s[76:79], s37 offen lds
    s_add_u32 m0, s28, 31744
    s_add_u32 s37, s3, 0x338000
    buffer_load_dwordx4 v19, s[76:79], s37 offen lds
    v_mov_b32 v20, 0x0
    v_bfe_u32 v14, v0, 0, 1
    s_mov_b32 s38, 0x8
    v_mad_u32_u24 v20, v14, s38, v20
    v_bfe_u32 v14, v0, 1, 1
    s_mov_b32 s38, 0x10
    v_mad_u32_u24 v20, v14, s38, v20
    v_bfe_u32 v14, v0, 2, 1
    s_mov_b32 s38, 0x100
    v_mad_u32_u24 v20, v14, s38, v20
    v_bfe_u32 v14, v0, 3, 1
    s_mov_b32 s38, 0x200
    v_mad_u32_u24 v20, v14, s38, v20
    v_bfe_u32 v14, v0, 4, 1
    s_mov_b32 s38, 0x800
    v_mad_u32_u24 v20, v14, s38, v20
    v_bfe_u32 v14, v0, 5, 1
    s_mov_b32 s38, 0x1000
    v_mad_u32_u24 v20, v14, s38, v20
    v_mov_b32 v30, 0x0
    v_bfe_u32 v14, v0, 2, 1
    s_mov_b32 s38, 0x20
    v_mad_u32_u24 v30, v14, s38, v30
    v_bfe_u32 v14, v0, 3, 1
    s_mov_b32 s38, 0x40
    v_mad_u32_u24 v30, v14, s38, v30
    v_bfe_u32 v14, v0, 4, 1
    s_mov_b32 s38, 0x80
    v_mad_u32_u24 v30, v14, s38, v30
    v_mov_b32 v31, 0x0
    v_bfe_u32 v14, v0, 6, 1
    s_mov_b32 s38, 0x40
    v_mad_u32_u24 v31, v14, s38, v31
    v_bfe_u32 v14, v0, 7, 1
    s_mov_b32 s38, 0x80
    v_mad_u32_u24 v31, v14, s38, v31
    v_xor_b32 v30, v30, v31
    v_add_u32 v30, v30, v20
    v_add_u32 v20, 0x8000, v30
    v_xor_b32 v21, 32, v20
    v_add_u32 v22, 0x10000, v30
    v_xor_b32 v23, 32, v22
    v_add_u32 v24, 0x18000, v30
    v_xor_b32 v25, 32, v24
    v_add_u32 v26, 0x20000, v30
    v_xor_b32 v27, 32, v26
    s_mov_b32 s12, s54
    s_and_b32 s13, s55, 0xffff
    s_mov_b32 s14, 0x400000
    s_mov_b32 s15, 0x20000
    s_lshl_b32 s24, s20, 17
    s_and_b32 s25, s22, 3
    s_lshl_b32 s25, s25, 15
    s_add_u32 s24, s24, s25
    v_lshlrev_b32 v30, 7, v0
    buffer_load_dword v31, v30, s[12:15], s24 offen
    s_mov_b32 s12, s44
    s_and_b32 s13, s45, 0xffff
    s_mov_b32 s14, 0x200000
    s_mov_b32 s15, 0x20000
    s_mov_b32 s60, s82
    s_and_b32 s61, s83, 0xffff
    s_mov_b32 s62, 0x200000
    s_mov_b32 s63, 0x20000
    s_mov_b32 s92, s80
    s_and_b32 s93, s81, 0xffff
    s_mov_b32 s94, 0x400
    s_mov_b32 s95, 0x20000
    v_mov_b32 v1, 0x0
    v_bfe_u32 v14, v0, 0, 1
    s_mov_b32 s38, 0x10
    v_mad_u32_u24 v1, v14, s38, v1
    v_bfe_u32 v14, v0, 1, 1
    s_mov_b32 s38, 0x20
    v_mad_u32_u24 v1, v14, s38, v1
    v_bfe_u32 v14, v0, 2, 1
    s_mov_b32 s38, 0x40
    v_mad_u32_u24 v1, v14, s38, v1
    v_bfe_u32 v14, v0, 3, 1
    s_mov_b32 s38, 0x80
    v_mad_u32_u24 v1, v14, s38, v1
    v_bfe_u32 v14, v0, 4, 1
    s_mov_b32 s38, 0x100
    v_mad_u32_u24 v1, v14, s38, v1
    v_bfe_u32 v14, v0, 5, 1
    s_mov_b32 s38, 0x200
    v_mad_u32_u24 v1, v14, s38, v1
    v_mov_b32 v2, 0x0
    v_bfe_u32 v14, v0, 0, 1
    s_mov_b32 s38, 0x10
    v_mad_u32_u24 v2, v14, s38, v2
    v_bfe_u32 v14, v0, 1, 1
    s_mov_b32 s38, 0x20
    v_mad_u32_u24 v2, v14, s38, v2
    v_bfe_u32 v14, v0, 2, 1
    s_mov_b32 s38, 0x40
    v_mad_u32_u24 v2, v14, s38, v2
    v_bfe_u32 v14, v0, 3, 1
    s_mov_b32 s38, 0x80
    v_mad_u32_u24 v2, v14, s38, v2
    v_bfe_u32 v14, v0, 4, 1
    s_mov_b32 s38, 0x100
    v_mad_u32_u24 v2, v14, s38, v2
    v_bfe_u32 v14, v0, 5, 1
    s_mov_b32 s38, 0x200
    v_mad_u32_u24 v2, v14, s38, v2
    v_bfe_u32 v14, v0, 6, 1
    s_mov_b32 s38, 0x800
    v_mad_u32_u24 v2, v14, s38, v2
    v_bfe_u32 v14, v0, 7, 1
    s_mov_b32 s38, 0x1000
    v_mad_u32_u24 v2, v14, s38, v2
    v_mov_b32 v9, 0x0
    v_bfe_u32 v14, v0, 0, 1
    s_mov_b32 s38, 0x10
    v_mad_u32_u24 v9, v14, s38, v9
    v_bfe_u32 v14, v0, 1, 1
    s_mov_b32 s38, 0x20
    v_mad_u32_u24 v9, v14, s38, v9
    v_bfe_u32 v14, v0, 2, 1
    s_mov_b32 s38, 0x40
    v_mad_u32_u24 v9, v14, s38, v9
    v_bfe_u32 v14, v0, 3, 1
    s_mov_b32 s38, 0x80
    v_mad_u32_u24 v9, v14, s38, v9
    v_bfe_u32 v14, v0, 4, 1
    s_mov_b32 s38, 0x100
    v_mad_u32_u24 v9, v14, s38, v9
    v_bfe_u32 v14, v0, 5, 1
    s_mov_b32 s38, 0x200
    v_mad_u32_u24 v9, v14, s38, v9
    v_bfe_u32 v14, v0, 6, 1
    s_mov_b32 s38, 0x400
    v_mad_u32_u24 v9, v14, s38, v9
    v_bfe_u32 v14, v0, 7, 1
    s_mov_b32 s38, 0x800
    v_mad_u32_u24 v9, v14, s38, v9
    v_mov_b32 v7, 0x8000
    v_bfe_u32 v14, v0, 0, 1
    s_mov_b32 s38, 0x10
    v_mad_u32_u24 v7, v14, s38, v7
    v_bfe_u32 v14, v0, 1, 1
    s_mov_b32 s38, 0x20
    v_mad_u32_u24 v7, v14, s38, v7
    v_bfe_u32 v14, v0, 2, 1
    s_mov_b32 s38, 0x40
    v_mad_u32_u24 v7, v14, s38, v7
    v_bfe_u32 v14, v0, 3, 1
    s_mov_b32 s38, 0x80
    v_mad_u32_u24 v7, v14, s38, v7
    v_bfe_u32 v14, v0, 4, 1
    s_mov_b32 s38, 0x100
    v_mad_u32_u24 v7, v14, s38, v7
    v_bfe_u32 v14, v0, 5, 1
    s_mov_b32 s38, 0x200
    v_mad_u32_u24 v7, v14, s38, v7
    v_bfe_u32 v14, v0, 6, 1
    s_mov_b32 s38, 0x8000
    v_mad_u32_u24 v7, v14, s38, v7
    v_bfe_u32 v14, v0, 7, 1
    s_mov_b32 s38, 0x10000
    v_mad_u32_u24 v7, v14, s38, v7
    v_mov_b32 v3, 0x0
    v_bfe_u32 v14, v0, 0, 1
    s_mov_b32 s38, 0x10
    v_mad_u32_u24 v3, v14, s38, v3
    v_bfe_u32 v14, v0, 1, 1
    s_mov_b32 s38, 0x20
    v_mad_u32_u24 v3, v14, s38, v3
    v_bfe_u32 v14, v0, 2, 1
    s_mov_b32 s38, 0x40
    v_mad_u32_u24 v3, v14, s38, v3
    v_bfe_u32 v14, v0, 3, 1
    s_mov_b32 s38, 0x400
    v_mad_u32_u24 v3, v14, s38, v3
    v_bfe_u32 v14, v0, 4, 1
    s_mov_b32 s38, 0x800
    v_mad_u32_u24 v3, v14, s38, v3
    v_bfe_u32 v14, v0, 5, 1
    s_mov_b32 s38, 0x1000
    v_mad_u32_u24 v3, v14, s38, v3
    v_bfe_u32 v14, v0, 6, 1
    s_mov_b32 s38, 0x2000
    v_mad_u32_u24 v3, v14, s38, v3
    v_bfe_u32 v14, v0, 7, 1
    s_mov_b32 s38, 0x4000
    v_mad_u32_u24 v3, v14, s38, v3
    v_mov_b32 v4, 0x0
    v_bfe_u32 v14, v0, 0, 1
    s_mov_b32 s38, 0x100
    v_mad_u32_u24 v4, v14, s38, v4
    v_bfe_u32 v14, v0, 1, 1
    s_mov_b32 s38, 0x200
    v_mad_u32_u24 v4, v14, s38, v4
    v_bfe_u32 v14, v0, 2, 1
    s_mov_b32 s38, 0x400
    v_mad_u32_u24 v4, v14, s38, v4
    v_bfe_u32 v14, v0, 6, 1
    s_mov_b32 s38, 0x80
    v_mad_u32_u24 v4, v14, s38, v4
    v_bfe_u32 v14, v0, 7, 1
    s_mov_b32 s38, 0x4000
    v_mad_u32_u24 v4, v14, s38, v4
    v_lshrrev_b32 v15, 3, v0
    v_xor_b32 v15, v15, v0
    v_and_b32 v15, 7, v15
    v_lshl_add_u32 v4, v15, 4, v4
    v_bfe_u32 v15, v0, 4, 2
    v_lshlrev_b32 v15, 4, v15
    v_xor_b32 v5, v15, v1
    v_xor_b32 v6, 64, v5
    v_mov_b32 v8, 0x5000
    v_bfe_u32 v14, v0, 0, 1
    s_mov_b32 s38, 0x10
    v_mad_u32_u24 v8, v14, s38, v8
    v_bfe_u32 v14, v0, 1, 1
    s_mov_b32 s38, 0x40
    v_mad_u32_u24 v8, v14, s38, v8
    v_bfe_u32 v14, v0, 2, 1
    s_mov_b32 s38, 0x80
    v_mad_u32_u24 v8, v14, s38, v8
    v_bfe_u32 v14, v0, 4, 1
    s_mov_b32 s38, 0x20
    v_mad_u32_u24 v8, v14, s38, v8
    v_bfe_u32 v14, v0, 5, 1
    s_mov_b32 s38, 0x100
    v_mad_u32_u24 v8, v14, s38, v8
    v_mov_b32 v10, 0x0
    v_bfe_u32 v14, v0, 0, 1
    s_mov_b32 s38, 0x10
    v_mad_u32_u24 v10, v14, s38, v10
    v_bfe_u32 v14, v0, 1, 1
    s_mov_b32 s38, 0x20
    v_mad_u32_u24 v10, v14, s38, v10
    v_bfe_u32 v14, v0, 2, 1
    s_mov_b32 s38, 0x40
    v_mad_u32_u24 v10, v14, s38, v10
    v_bfe_u32 v14, v0, 3, 1
    s_mov_b32 s38, 0x80
    v_mad_u32_u24 v10, v14, s38, v10
    v_bfe_u32 v14, v0, 4, 1
    s_mov_b32 s38, 0x20000
    v_mad_u32_u24 v10, v14, s38, v10
    v_bfe_u32 v14, v0, 5, 1
    s_mov_b32 s38, 0x40000
    v_mad_u32_u24 v10, v14, s38, v10
    v_bfe_u32 v14, v0, 6, 1
    s_mov_b32 s38, 0x100
    v_mad_u32_u24 v10, v14, s38, v10
    v_bfe_u32 v14, v0, 7, 1
    s_mov_b32 s38, 0x200
    v_mad_u32_u24 v10, v14, s38, v10
    v_mov_b32 v11, 0x0
    v_bfe_u32 v14, v0, 0, 1
    s_mov_b32 s38, 0x10
    v_mad_u32_u24 v11, v14, s38, v11
    v_bfe_u32 v14, v0, 1, 1
    s_mov_b32 s38, 0x20
    v_mad_u32_u24 v11, v14, s38, v11
    v_bfe_u32 v14, v0, 2, 1
    s_mov_b32 s38, 0x40
    v_mad_u32_u24 v11, v14, s38, v11
    v_bfe_u32 v14, v0, 3, 1
    s_mov_b32 s38, 0x80
    v_mad_u32_u24 v11, v14, s38, v11
    v_bfe_u32 v14, v0, 4, 1
    s_mov_b32 s38, 0x400
    v_mad_u32_u24 v11, v14, s38, v11
    v_bfe_u32 v14, v0, 5, 1
    s_mov_b32 s38, 0x800
    v_mad_u32_u24 v11, v14, s38, v11
    v_bfe_u32 v14, v0, 6, 1
    s_mov_b32 s38, 0x100
    v_mad_u32_u24 v11, v14, s38, v11
    v_bfe_u32 v14, v0, 7, 1
    s_mov_b32 s38, 0x200
    v_mad_u32_u24 v11, v14, s38, v11
    v_mov_b32 v12, 0x0
    v_bfe_u32 v14, v0, 0, 1
    s_mov_b32 s38, 0x10
    v_mad_u32_u24 v12, v14, s38, v12
    v_bfe_u32 v14, v0, 1, 1
    s_mov_b32 s38, 0x20
    v_mad_u32_u24 v12, v14, s38, v12
    v_bfe_u32 v14, v0, 2, 1
    s_mov_b32 s38, 0x40
    v_mad_u32_u24 v12, v14, s38, v12
    v_bfe_u32 v14, v0, 3, 1
    s_mov_b32 s38, 0x80
    v_mad_u32_u24 v12, v14, s38, v12
    v_bfe_u32 v14, v0, 4, 1
    s_mov_b32 s38, 0x4
    v_mad_u32_u24 v12, v14, s38, v12
    v_bfe_u32 v14, v0, 5, 1
    s_mov_b32 s38, 0x8
    v_mad_u32_u24 v12, v14, s38, v12
    v_bfe_u32 v14, v0, 6, 1
    s_mov_b32 s38, 0x100
    v_mad_u32_u24 v12, v14, s38, v12
    v_bfe_u32 v14, v0, 7, 1
    s_mov_b32 s38, 0x200
    v_mad_u32_u24 v12, v14, s38, v12
    v_mov_b32 v13, 0xf149f2ca
    v_and_b32 v14, 15, v0
    v_bfe_u32 v15, v0, 4, 2
    v_cmp_gt_u32 s[72:73], 2, v15
    v_lshlrev_b32 v15, 2, v15
    v_cmp_le_u32 s[64:65], v15, v14
    v_add_u32 v15, 1, v15
    v_cmp_le_u32 s[66:67], v15, v14
    v_add_u32 v15, 1, v15
    v_cmp_le_u32 s[68:69], v15, v14
    v_add_u32 v15, 1, v15
    v_cmp_le_u32 s[70:71], v15, v14
    v_add_u32 v15, 1, v15
    s_mov_b32 s34, 0x05040100
    s_mov_b32 s35, 0x07060302
    s_mov_b32 s33, 0x3e0293ee
    s_mov_b32 s32, 0
    s_mov_b32 s4, 0x3f803f80
    s_mov_b32 s5, 0x3f803f80
    s_mov_b32 s23, s22
    s_lshl_b32 s36, s23, 15
    buffer_load_dwordx4 v[96:99], v3, s[12:15], s36 offen offset:0
    buffer_load_dwordx4 v[100:103], v3, s[12:15], s36 offen offset:128
    buffer_load_dwordx4 v[104:107], v3, s[12:15], s36 offen offset:256
    buffer_load_dwordx4 v[108:111], v3, s[12:15], s36 offen offset:384
    buffer_load_dwordx4 v[112:115], v3, s[12:15], s36 offen offset:512
    buffer_load_dwordx4 v[116:119], v3, s[12:15], s36 offen offset:640
    buffer_load_dwordx4 v[120:123], v3, s[12:15], s36 offen offset:768
    buffer_load_dwordx4 v[124:127], v3, s[12:15], s36 offen offset:896
    s_waitcnt vmcnt(33)
    s_barrier
    ds_read_b64_tr_b16 v[128:129], v20 offset:0
    ds_read_b64_tr_b16 v[130:131], v20 offset:1024
    ds_read_b64_tr_b16 v[132:133], v21 offset:0
    ds_read_b64_tr_b16 v[134:135], v21 offset:1024
    ds_read_b64_tr_b16 v[136:137], v22 offset:0
    ds_read_b64_tr_b16 v[138:139], v22 offset:1024
    ds_read_b64_tr_b16 v[140:141], v23 offset:0
    ds_read_b64_tr_b16 v[142:143], v23 offset:1024
    ds_read_b64_tr_b16 v[144:145], v24 offset:0
    ds_read_b64_tr_b16 v[146:147], v24 offset:1024
    ds_read_b64_tr_b16 v[148:149], v25 offset:0
    ds_read_b64_tr_b16 v[150:151], v25 offset:1024
    s_waitcnt lgkmcnt(4)
    ds_read_b64_tr_b16 v[152:153], v26 offset:0
    ds_read_b64_tr_b16 v[154:155], v26 offset:1024
    ds_read_b64_tr_b16 v[156:157], v27 offset:0
    ds_read_b64_tr_b16 v[158:159], v27 offset:1024
    s_waitcnt lgkmcnt(0)
    s_barrier
    s_mov_b32 s40, s50
    s_and_b32 s41, s51, 0xffff
    s_mov_b32 s42, 0x400000
    s_mov_b32 s43, 0x20000
    s_add_u32 m0, s28, 0
    s_add_u32 s37, s3, 0x0
    buffer_load_dwordx4 v16, s[40:43], s37 offen lds
    s_add_u32 m0, s28, 1024
    s_add_u32 s37, s3, 0x8000
    buffer_load_dwordx4 v17, s[40:43], s37 offen lds
    s_add_u32 m0, s28, 2048
    s_add_u32 s37, s3, 0x10000
    buffer_load_dwordx4 v18, s[40:43], s37 offen lds
    s_add_u32 m0, s28, 3072
    s_add_u32 s37, s3, 0x18000
    buffer_load_dwordx4 v19, s[40:43], s37 offen lds
    s_add_u32 m0, s28, 4096
    s_add_u32 s37, s3, 0x20000
    buffer_load_dwordx4 v16, s[40:43], s37 offen lds
    s_add_u32 m0, s28, 5120
    s_add_u32 s37, s3, 0x28000
    buffer_load_dwordx4 v17, s[40:43], s37 offen lds
    s_add_u32 m0, s28, 6144
    s_add_u32 s37, s3, 0x30000
    buffer_load_dwordx4 v18, s[40:43], s37 offen lds
    s_add_u32 m0, s28, 7168
    s_add_u32 s37, s3, 0x38000
    buffer_load_dwordx4 v19, s[40:43], s37 offen lds
    s_waitcnt vmcnt(33)
    s_barrier
    ds_read_b64_tr_b16 v[160:161], v20 offset:8192
    ds_read_b64_tr_b16 v[162:163], v20 offset:9216
    ds_read_b64_tr_b16 v[164:165], v21 offset:8192
    ds_read_b64_tr_b16 v[166:167], v21 offset:9216
    ds_read_b64_tr_b16 v[168:169], v22 offset:8192
    ds_read_b64_tr_b16 v[170:171], v22 offset:9216
    ds_read_b64_tr_b16 v[172:173], v23 offset:8192
    ds_read_b64_tr_b16 v[174:175], v23 offset:9216
    ds_read_b64_tr_b16 v[176:177], v24 offset:8192
    ds_read_b64_tr_b16 v[178:179], v24 offset:9216
    ds_read_b64_tr_b16 v[180:181], v25 offset:8192
    ds_read_b64_tr_b16 v[182:183], v25 offset:9216
    s_waitcnt lgkmcnt(4)
    ds_read_b64_tr_b16 v[184:185], v26 offset:8192
    ds_read_b64_tr_b16 v[186:187], v26 offset:9216
    ds_read_b64_tr_b16 v[188:189], v27 offset:8192
    ds_read_b64_tr_b16 v[190:191], v27 offset:9216
    s_waitcnt lgkmcnt(0)
    s_barrier
    s_add_u32 m0, s28, 8192
    s_add_u32 s37, s3, 0x100000
    buffer_load_dwordx4 v16, s[40:43], s37 offen lds
    s_add_u32 m0, s28, 9216
    s_add_u32 s37, s3, 0x108000
    buffer_load_dwordx4 v17, s[40:43], s37 offen lds
    s_add_u32 m0, s28, 10240
    s_add_u32 s37, s3, 0x110000
    buffer_load_dwordx4 v18, s[40:43], s37 offen lds
    s_add_u32 m0, s28, 11264
    s_add_u32 s37, s3, 0x118000
    buffer_load_dwordx4 v19, s[40:43], s37 offen lds
    s_add_u32 m0, s28, 12288
    s_add_u32 s37, s3, 0x120000
    buffer_load_dwordx4 v16, s[40:43], s37 offen lds
    s_add_u32 m0, s28, 13312
    s_add_u32 s37, s3, 0x128000
    buffer_load_dwordx4 v17, s[40:43], s37 offen lds
    s_add_u32 m0, s28, 14336
    s_add_u32 s37, s3, 0x130000
    buffer_load_dwordx4 v18, s[40:43], s37 offen lds
    s_add_u32 m0, s28, 15360
    s_add_u32 s37, s3, 0x138000
    buffer_load_dwordx4 v19, s[40:43], s37 offen lds
    s_waitcnt vmcnt(33)
    s_barrier
    ds_read_b64_tr_b16 v[192:193], v20 offset:16384
    ds_read_b64_tr_b16 v[194:195], v20 offset:17408
    ds_read_b64_tr_b16 v[196:197], v21 offset:16384
    ds_read_b64_tr_b16 v[198:199], v21 offset:17408
    ds_read_b64_tr_b16 v[200:201], v22 offset:16384
    ds_read_b64_tr_b16 v[202:203], v22 offset:17408
    ds_read_b64_tr_b16 v[204:205], v23 offset:16384
    ds_read_b64_tr_b16 v[206:207], v23 offset:17408
    ds_read_b64_tr_b16 v[208:209], v24 offset:16384
    ds_read_b64_tr_b16 v[210:211], v24 offset:17408
    ds_read_b64_tr_b16 v[212:213], v25 offset:16384
    ds_read_b64_tr_b16 v[214:215], v25 offset:17408
    s_waitcnt lgkmcnt(4)
    ds_read_b64_tr_b16 v[216:217], v26 offset:16384
    ds_read_b64_tr_b16 v[218:219], v26 offset:17408
    ds_read_b64_tr_b16 v[220:221], v27 offset:16384
    ds_read_b64_tr_b16 v[222:223], v27 offset:17408
    s_waitcnt lgkmcnt(0)
    s_barrier
    s_add_u32 m0, s28, 16384
    s_add_u32 s37, s3, 0x200000
    buffer_load_dwordx4 v16, s[40:43], s37 offen lds
    s_add_u32 m0, s28, 17408
    s_add_u32 s37, s3, 0x208000
    buffer_load_dwordx4 v17, s[40:43], s37 offen lds
    s_add_u32 m0, s28, 18432
    s_add_u32 s37, s3, 0x210000
    buffer_load_dwordx4 v18, s[40:43], s37 offen lds
    s_add_u32 m0, s28, 19456
    s_add_u32 s37, s3, 0x218000
    buffer_load_dwordx4 v19, s[40:43], s37 offen lds
    s_add_u32 m0, s28, 20480
    s_add_u32 s37, s3, 0x220000
    buffer_load_dwordx4 v16, s[40:43], s37 offen lds
    s_add_u32 m0, s28, 21504
    s_add_u32 s37, s3, 0x228000
    buffer_load_dwordx4 v17, s[40:43], s37 offen lds
    s_add_u32 m0, s28, 22528
    s_add_u32 s37, s3, 0x230000
    buffer_load_dwordx4 v18, s[40:43], s37 offen lds
    s_add_u32 m0, s28, 23552
    s_add_u32 s37, s3, 0x238000
    buffer_load_dwordx4 v19, s[40:43], s37 offen lds
    s_waitcnt vmcnt(33)
    s_barrier
    ds_read_b64_tr_b16 v[224:225], v20 offset:24576
    ds_read_b64_tr_b16 v[226:227], v20 offset:25600
    ds_read_b64_tr_b16 v[228:229], v21 offset:24576
    ds_read_b64_tr_b16 v[230:231], v21 offset:25600
    ds_read_b64_tr_b16 v[232:233], v22 offset:24576
    ds_read_b64_tr_b16 v[234:235], v22 offset:25600
    ds_read_b64_tr_b16 v[236:237], v23 offset:24576
    ds_read_b64_tr_b16 v[238:239], v23 offset:25600
    ds_read_b64_tr_b16 v[240:241], v24 offset:24576
    ds_read_b64_tr_b16 v[242:243], v24 offset:25600
    ds_read_b64_tr_b16 v[244:245], v25 offset:24576
    ds_read_b64_tr_b16 v[246:247], v25 offset:25600
    s_waitcnt lgkmcnt(4)
    ds_read_b64_tr_b16 v[248:249], v26 offset:24576
    ds_read_b64_tr_b16 v[250:251], v26 offset:25600
    ds_read_b64_tr_b16 v[252:253], v27 offset:24576
    ds_read_b64_tr_b16 v[254:255], v27 offset:25600
    s_waitcnt lgkmcnt(0)
    s_barrier
    s_add_u32 m0, s28, 24576
    s_add_u32 s37, s3, 0x300000
    buffer_load_dwordx4 v16, s[40:43], s37 offen lds
    s_add_u32 m0, s28, 25600
    s_add_u32 s37, s3, 0x308000
    buffer_load_dwordx4 v17, s[40:43], s37 offen lds
    s_add_u32 m0, s28, 26624
    s_add_u32 s37, s3, 0x310000
    buffer_load_dwordx4 v18, s[40:43], s37 offen lds
    s_add_u32 m0, s28, 27648
    s_add_u32 s37, s3, 0x318000
    buffer_load_dwordx4 v19, s[40:43], s37 offen lds
    s_add_u32 m0, s28, 28672
    s_add_u32 s37, s3, 0x320000
    buffer_load_dwordx4 v16, s[40:43], s37 offen lds
    s_add_u32 m0, s28, 29696
    s_add_u32 s37, s3, 0x328000
    buffer_load_dwordx4 v17, s[40:43], s37 offen lds
    s_add_u32 m0, s28, 30720
    s_add_u32 s37, s3, 0x330000
    buffer_load_dwordx4 v18, s[40:43], s37 offen lds
    s_add_u32 m0, s28, 31744
    s_add_u32 s37, s3, 0x338000
    buffer_load_dwordx4 v19, s[40:43], s37 offen lds
    s_waitcnt vmcnt(32)
    v_mov_b32 v88, 0
    v_mov_b32 v89, 0
    v_dot2_f32_bf16 v88, v96, s4, v88
    v_dot2_f32_bf16 v89, v96, v96, v89
    v_dot2_f32_bf16 v88, v97, s4, v88
    v_dot2_f32_bf16 v89, v97, v97, v89
    v_dot2_f32_bf16 v88, v98, s4, v88
    v_dot2_f32_bf16 v89, v98, v98, v89
    v_dot2_f32_bf16 v88, v99, s4, v88
    v_dot2_f32_bf16 v89, v99, v99, v89
    v_dot2_f32_bf16 v88, v100, s4, v88
    v_dot2_f32_bf16 v89, v100, v100, v89
    v_dot2_f32_bf16 v88, v101, s4, v88
    v_dot2_f32_bf16 v89, v101, v101, v89
    v_dot2_f32_bf16 v88, v102, s4, v88
    v_dot2_f32_bf16 v89, v102, v102, v89
    v_dot2_f32_bf16 v88, v103, s4, v88
    v_dot2_f32_bf16 v89, v103, v103, v89
    v_dot2_f32_bf16 v88, v104, s4, v88
    v_dot2_f32_bf16 v89, v104, v104, v89
    v_dot2_f32_bf16 v88, v105, s4, v88
    v_dot2_f32_bf16 v89, v105, v105, v89
    v_dot2_f32_bf16 v88, v106, s4, v88
    v_dot2_f32_bf16 v89, v106, v106, v89
    v_dot2_f32_bf16 v88, v107, s4, v88
    v_dot2_f32_bf16 v89, v107, v107, v89
    v_dot2_f32_bf16 v88, v108, s4, v88
    v_dot2_f32_bf16 v89, v108, v108, v89
    v_dot2_f32_bf16 v88, v109, s4, v88
    v_dot2_f32_bf16 v89, v109, v109, v89
    v_dot2_f32_bf16 v88, v110, s4, v88
    v_dot2_f32_bf16 v89, v110, v110, v89
    v_dot2_f32_bf16 v88, v111, s4, v88
    v_dot2_f32_bf16 v89, v111, v111, v89
    v_dot2_f32_bf16 v88, v112, s4, v88
    v_dot2_f32_bf16 v89, v112, v112, v89
    v_dot2_f32_bf16 v88, v113, s4, v88
    v_dot2_f32_bf16 v89, v113, v113, v89
    v_dot2_f32_bf16 v88, v114, s4, v88
    v_dot2_f32_bf16 v89, v114, v114, v89
    v_dot2_f32_bf16 v88, v115, s4, v88
    v_dot2_f32_bf16 v89, v115, v115, v89
    v_dot2_f32_bf16 v88, v116, s4, v88
    v_dot2_f32_bf16 v89, v116, v116, v89
    v_dot2_f32_bf16 v88, v117, s4, v88
    v_dot2_f32_bf16 v89, v117, v117, v89
    v_dot2_f32_bf16 v88, v118, s4, v88
    v_dot2_f32_bf16 v89, v118, v118, v89
    v_dot2_f32_bf16 v88, v119, s4, v88
    v_dot2_f32_bf16 v89, v119, v119, v89
    v_dot2_f32_bf16 v88, v120, s4, v88
    v_dot2_f32_bf16 v89, v120, v120, v89
    v_dot2_f32_bf16 v88, v121, s4, v88
    v_dot2_f32_bf16 v89, v121, v121, v89
    v_dot2_f32_bf16 v88, v122, s4, v88
    v_dot2_f32_bf16 v89, v122, v122, v89
    v_dot2_f32_bf16 v88, v123, s4, v88
    v_dot2_f32_bf16 v89, v123, v123, v89
    v_dot2_f32_bf16 v88, v124, s4, v88
    v_dot2_f32_bf16 v89, v124, v124, v89
    v_dot2_f32_bf16 v88, v125, s4, v88
    v_dot2_f32_bf16 v89, v125, v125, v89
    v_dot2_f32_bf16 v88, v126, s4, v88
    v_dot2_f32_bf16 v89, v126, v126, v89
    v_dot2_f32_bf16 v88, v127, s4, v88
    v_dot2_f32_bf16 v89, v127, v127, v89
    s_nop 3
    v_add_f32_dpp v88, v88, v88 quad_perm:[1,0,3,2] row_mask:0xf bank_mask:0xf
    v_add_f32_dpp v89, v89, v89 quad_perm:[1,0,3,2] row_mask:0xf bank_mask:0xf
    s_nop 0
    v_add_f32_dpp v88, v88, v88 quad_perm:[2,3,0,1] row_mask:0xf bank_mask:0xf
    v_add_f32_dpp v89, v89, v89 quad_perm:[2,3,0,1] row_mask:0xf bank_mask:0xf
    s_nop 0
    v_add_f32_dpp v88, v88, v88 row_half_mirror row_mask:0xf bank_mask:0xf
    v_add_f32_dpp v89, v89, v89 row_half_mirror row_mask:0xf bank_mask:0xf
    v_mul_f32 v88, 0x3b000000, v88
    v_mul_f32 v89, 0x3b000000, v89
    v_fma_f32 v89, -v88, v88, v89
    v_max_f32 v89, 0, v89
    v_cvt_pk_bf16_f32 v14, v88, v89
    v_lshlrev_b32 v88, 16, v14
    v_and_b32 v89, 0xffff0000, v14
    v_add_f32 v89, 0x3727c5ac, v89
    v_cvt_pk_bf16_f32 v14, v89, v89
    v_lshlrev_b32 v89, 16, v14
    v_sqrt_f32 v89, v89
    s_nop 0
    v_cvt_pk_bf16_f32 v14, v89, v89
    v_lshlrev_b32 v89, 16, v14
    v_rcp_f32 v89, v89
    v_lshlrev_b32 v90, 16, v96
    v_and_b32 v91, 0xffff0000, v96
    v_sub_f32 v90, v90, v88
    v_sub_f32 v91, v91, v88
    v_cvt_pk_bf16_f32 v96, v90, v91
    v_lshlrev_b32 v90, 16, v96
    v_and_b32 v91, 0xffff0000, v96
    v_mul_f32 v90, v90, v89
    v_mul_f32 v91, v91, v89
    v_cvt_pk_bf16_f32 v96, v90, v91
    v_lshlrev_b32 v90, 16, v97
    v_and_b32 v91, 0xffff0000, v97
    v_sub_f32 v90, v90, v88
    v_sub_f32 v91, v91, v88
    v_cvt_pk_bf16_f32 v97, v90, v91
    v_lshlrev_b32 v90, 16, v97
    v_and_b32 v91, 0xffff0000, v97
    v_mul_f32 v90, v90, v89
    v_mul_f32 v91, v91, v89
    v_cvt_pk_bf16_f32 v97, v90, v91
    v_lshlrev_b32 v90, 16, v98
    v_and_b32 v91, 0xffff0000, v98
    v_sub_f32 v90, v90, v88
    v_sub_f32 v91, v91, v88
    v_cvt_pk_bf16_f32 v98, v90, v91
    v_lshlrev_b32 v90, 16, v98
    v_and_b32 v91, 0xffff0000, v98
    v_mul_f32 v90, v90, v89
    v_mul_f32 v91, v91, v89
    v_cvt_pk_bf16_f32 v98, v90, v91
    v_lshlrev_b32 v90, 16, v99
    v_and_b32 v91, 0xffff0000, v99
    v_sub_f32 v90, v90, v88
    v_sub_f32 v91, v91, v88
    v_cvt_pk_bf16_f32 v99, v90, v91
    v_lshlrev_b32 v90, 16, v99
    v_and_b32 v91, 0xffff0000, v99
    v_mul_f32 v90, v90, v89
    v_mul_f32 v91, v91, v89
    v_cvt_pk_bf16_f32 v99, v90, v91
    ds_write_b128 v4, v[96:99] offset:0
    v_lshlrev_b32 v90, 16, v100
    v_and_b32 v91, 0xffff0000, v100
    v_sub_f32 v90, v90, v88
    v_sub_f32 v91, v91, v88
    v_cvt_pk_bf16_f32 v100, v90, v91
    v_lshlrev_b32 v90, 16, v100
    v_and_b32 v91, 0xffff0000, v100
    v_mul_f32 v90, v90, v89
    v_mul_f32 v91, v91, v89
    v_cvt_pk_bf16_f32 v100, v90, v91
    v_lshlrev_b32 v90, 16, v101
    v_and_b32 v91, 0xffff0000, v101
    v_sub_f32 v90, v90, v88
    v_sub_f32 v91, v91, v88
    v_cvt_pk_bf16_f32 v101, v90, v91
    v_lshlrev_b32 v90, 16, v101
    v_and_b32 v91, 0xffff0000, v101
    v_mul_f32 v90, v90, v89
    v_mul_f32 v91, v91, v89
    v_cvt_pk_bf16_f32 v101, v90, v91
    v_lshlrev_b32 v90, 16, v102
    v_and_b32 v91, 0xffff0000, v102
    v_sub_f32 v90, v90, v88
    v_sub_f32 v91, v91, v88
    v_cvt_pk_bf16_f32 v102, v90, v91
    v_lshlrev_b32 v90, 16, v102
    v_and_b32 v91, 0xffff0000, v102
    v_mul_f32 v90, v90, v89
    v_mul_f32 v91, v91, v89
    v_cvt_pk_bf16_f32 v102, v90, v91
    v_lshlrev_b32 v90, 16, v103
    v_and_b32 v91, 0xffff0000, v103
    v_sub_f32 v90, v90, v88
    v_sub_f32 v91, v91, v88
    v_cvt_pk_bf16_f32 v103, v90, v91
    v_lshlrev_b32 v90, 16, v103
    v_and_b32 v91, 0xffff0000, v103
    v_mul_f32 v90, v90, v89
    v_mul_f32 v91, v91, v89
    v_cvt_pk_bf16_f32 v103, v90, v91
    ds_write_b128 v4, v[100:103] offset:2048
    v_lshlrev_b32 v90, 16, v104
    v_and_b32 v91, 0xffff0000, v104
    v_sub_f32 v90, v90, v88
    v_sub_f32 v91, v91, v88
    v_cvt_pk_bf16_f32 v104, v90, v91
    v_lshlrev_b32 v90, 16, v104
    v_and_b32 v91, 0xffff0000, v104
    v_mul_f32 v90, v90, v89
    v_mul_f32 v91, v91, v89
    v_cvt_pk_bf16_f32 v104, v90, v91
    v_lshlrev_b32 v90, 16, v105
    v_and_b32 v91, 0xffff0000, v105
    v_sub_f32 v90, v90, v88
    v_sub_f32 v91, v91, v88
    v_cvt_pk_bf16_f32 v105, v90, v91
    v_lshlrev_b32 v90, 16, v105
    v_and_b32 v91, 0xffff0000, v105
    v_mul_f32 v90, v90, v89
    v_mul_f32 v91, v91, v89
    v_cvt_pk_bf16_f32 v105, v90, v91
    v_lshlrev_b32 v90, 16, v106
    v_and_b32 v91, 0xffff0000, v106
    v_sub_f32 v90, v90, v88
    v_sub_f32 v91, v91, v88
    v_cvt_pk_bf16_f32 v106, v90, v91
    v_lshlrev_b32 v90, 16, v106
    v_and_b32 v91, 0xffff0000, v106
    v_mul_f32 v90, v90, v89
    v_mul_f32 v91, v91, v89
    v_cvt_pk_bf16_f32 v106, v90, v91
    v_lshlrev_b32 v90, 16, v107
    v_and_b32 v91, 0xffff0000, v107
    v_sub_f32 v90, v90, v88
    v_sub_f32 v91, v91, v88
    v_cvt_pk_bf16_f32 v107, v90, v91
    v_lshlrev_b32 v90, 16, v107
    v_and_b32 v91, 0xffff0000, v107
    v_mul_f32 v90, v90, v89
    v_mul_f32 v91, v91, v89
    v_cvt_pk_bf16_f32 v107, v90, v91
    ds_write_b128 v4, v[104:107] offset:4096
    v_lshlrev_b32 v90, 16, v108
    v_and_b32 v91, 0xffff0000, v108
    v_sub_f32 v90, v90, v88
    v_sub_f32 v91, v91, v88
    v_cvt_pk_bf16_f32 v108, v90, v91
    v_lshlrev_b32 v90, 16, v108
    v_and_b32 v91, 0xffff0000, v108
    v_mul_f32 v90, v90, v89
    v_mul_f32 v91, v91, v89
    v_cvt_pk_bf16_f32 v108, v90, v91
    v_lshlrev_b32 v90, 16, v109
    v_and_b32 v91, 0xffff0000, v109
    v_sub_f32 v90, v90, v88
    v_sub_f32 v91, v91, v88
    v_cvt_pk_bf16_f32 v109, v90, v91
    v_lshlrev_b32 v90, 16, v109
    v_and_b32 v91, 0xffff0000, v109
    v_mul_f32 v90, v90, v89
    v_mul_f32 v91, v91, v89
    v_cvt_pk_bf16_f32 v109, v90, v91
    v_lshlrev_b32 v90, 16, v110
    v_and_b32 v91, 0xffff0000, v110
    v_sub_f32 v90, v90, v88
    v_sub_f32 v91, v91, v88
    v_cvt_pk_bf16_f32 v110, v90, v91
    v_lshlrev_b32 v90, 16, v110
    v_and_b32 v91, 0xffff0000, v110
    v_mul_f32 v90, v90, v89
    v_mul_f32 v91, v91, v89
    v_cvt_pk_bf16_f32 v110, v90, v91
    v_lshlrev_b32 v90, 16, v111
    v_and_b32 v91, 0xffff0000, v111
    v_sub_f32 v90, v90, v88
    v_sub_f32 v91, v91, v88
    v_cvt_pk_bf16_f32 v111, v90, v91
    v_lshlrev_b32 v90, 16, v111
    v_and_b32 v91, 0xffff0000, v111
    v_mul_f32 v90, v90, v89
    v_mul_f32 v91, v91, v89
    v_cvt_pk_bf16_f32 v111, v90, v91
    ds_write_b128 v4, v[108:111] offset:6144
    v_lshlrev_b32 v90, 16, v112
    v_and_b32 v91, 0xffff0000, v112
    v_sub_f32 v90, v90, v88
    v_sub_f32 v91, v91, v88
    v_cvt_pk_bf16_f32 v112, v90, v91
    v_lshlrev_b32 v90, 16, v112
    v_and_b32 v91, 0xffff0000, v112
    v_mul_f32 v90, v90, v89
    v_mul_f32 v91, v91, v89
    v_cvt_pk_bf16_f32 v112, v90, v91
    v_lshlrev_b32 v90, 16, v113
    v_and_b32 v91, 0xffff0000, v113
    v_sub_f32 v90, v90, v88
    v_sub_f32 v91, v91, v88
    v_cvt_pk_bf16_f32 v113, v90, v91
    v_lshlrev_b32 v90, 16, v113
    v_and_b32 v91, 0xffff0000, v113
    v_mul_f32 v90, v90, v89
    v_mul_f32 v91, v91, v89
    v_cvt_pk_bf16_f32 v113, v90, v91
    v_lshlrev_b32 v90, 16, v114
    v_and_b32 v91, 0xffff0000, v114
    v_sub_f32 v90, v90, v88
    v_sub_f32 v91, v91, v88
    v_cvt_pk_bf16_f32 v114, v90, v91
    v_lshlrev_b32 v90, 16, v114
    v_and_b32 v91, 0xffff0000, v114
    v_mul_f32 v90, v90, v89
    v_mul_f32 v91, v91, v89
    v_cvt_pk_bf16_f32 v114, v90, v91
    v_lshlrev_b32 v90, 16, v115
    v_and_b32 v91, 0xffff0000, v115
    v_sub_f32 v90, v90, v88
    v_sub_f32 v91, v91, v88
    v_cvt_pk_bf16_f32 v115, v90, v91
    v_lshlrev_b32 v90, 16, v115
    v_and_b32 v91, 0xffff0000, v115
    v_mul_f32 v90, v90, v89
    v_mul_f32 v91, v91, v89
    v_cvt_pk_bf16_f32 v115, v90, v91
    ds_write_b128 v4, v[112:115] offset:8192
    v_lshlrev_b32 v90, 16, v116
    v_and_b32 v91, 0xffff0000, v116
    v_sub_f32 v90, v90, v88
    v_sub_f32 v91, v91, v88
    v_cvt_pk_bf16_f32 v116, v90, v91
    v_lshlrev_b32 v90, 16, v116
    v_and_b32 v91, 0xffff0000, v116
    v_mul_f32 v90, v90, v89
    v_mul_f32 v91, v91, v89
    v_cvt_pk_bf16_f32 v116, v90, v91
    v_lshlrev_b32 v90, 16, v117
    v_and_b32 v91, 0xffff0000, v117
    v_sub_f32 v90, v90, v88
    v_sub_f32 v91, v91, v88
    v_cvt_pk_bf16_f32 v117, v90, v91
    v_lshlrev_b32 v90, 16, v117
    v_and_b32 v91, 0xffff0000, v117
    v_mul_f32 v90, v90, v89
    v_mul_f32 v91, v91, v89
    v_cvt_pk_bf16_f32 v117, v90, v91
    v_lshlrev_b32 v90, 16, v118
    v_and_b32 v91, 0xffff0000, v118
    v_sub_f32 v90, v90, v88
    v_sub_f32 v91, v91, v88
    v_cvt_pk_bf16_f32 v118, v90, v91
    v_lshlrev_b32 v90, 16, v118
    v_and_b32 v91, 0xffff0000, v118
    v_mul_f32 v90, v90, v89
    v_mul_f32 v91, v91, v89
    v_cvt_pk_bf16_f32 v118, v90, v91
    v_lshlrev_b32 v90, 16, v119
    v_and_b32 v91, 0xffff0000, v119
    v_sub_f32 v90, v90, v88
    v_sub_f32 v91, v91, v88
    v_cvt_pk_bf16_f32 v119, v90, v91
    v_lshlrev_b32 v90, 16, v119
    v_and_b32 v91, 0xffff0000, v119
    v_mul_f32 v90, v90, v89
    v_mul_f32 v91, v91, v89
    v_cvt_pk_bf16_f32 v119, v90, v91
    ds_write_b128 v4, v[116:119] offset:10240
    v_lshlrev_b32 v90, 16, v120
    v_and_b32 v91, 0xffff0000, v120
    v_sub_f32 v90, v90, v88
    v_sub_f32 v91, v91, v88
    v_cvt_pk_bf16_f32 v120, v90, v91
    v_lshlrev_b32 v90, 16, v120
    v_and_b32 v91, 0xffff0000, v120
    v_mul_f32 v90, v90, v89
    v_mul_f32 v91, v91, v89
    v_cvt_pk_bf16_f32 v120, v90, v91
    v_lshlrev_b32 v90, 16, v121
    v_and_b32 v91, 0xffff0000, v121
    v_sub_f32 v90, v90, v88
    v_sub_f32 v91, v91, v88
    v_cvt_pk_bf16_f32 v121, v90, v91
    v_lshlrev_b32 v90, 16, v121
    v_and_b32 v91, 0xffff0000, v121
    v_mul_f32 v90, v90, v89
    v_mul_f32 v91, v91, v89
    v_cvt_pk_bf16_f32 v121, v90, v91
    v_lshlrev_b32 v90, 16, v122
    v_and_b32 v91, 0xffff0000, v122
    v_sub_f32 v90, v90, v88
    v_sub_f32 v91, v91, v88
    v_cvt_pk_bf16_f32 v122, v90, v91
    v_lshlrev_b32 v90, 16, v122
    v_and_b32 v91, 0xffff0000, v122
    v_mul_f32 v90, v90, v89
    v_mul_f32 v91, v91, v89
    v_cvt_pk_bf16_f32 v122, v90, v91
    v_lshlrev_b32 v90, 16, v123
    v_and_b32 v91, 0xffff0000, v123
    v_sub_f32 v90, v90, v88
    v_sub_f32 v91, v91, v88
    v_cvt_pk_bf16_f32 v123, v90, v91
    v_lshlrev_b32 v90, 16, v123
    v_and_b32 v91, 0xffff0000, v123
    v_mul_f32 v90, v90, v89
    v_mul_f32 v91, v91, v89
    v_cvt_pk_bf16_f32 v123, v90, v91
    ds_write_b128 v4, v[120:123] offset:12288
    v_lshlrev_b32 v90, 16, v124
    v_and_b32 v91, 0xffff0000, v124
    v_sub_f32 v90, v90, v88
    v_sub_f32 v91, v91, v88
    v_cvt_pk_bf16_f32 v124, v90, v91
    v_lshlrev_b32 v90, 16, v124
    v_and_b32 v91, 0xffff0000, v124
    v_mul_f32 v90, v90, v89
    v_mul_f32 v91, v91, v89
    v_cvt_pk_bf16_f32 v124, v90, v91
    v_lshlrev_b32 v90, 16, v125
    v_and_b32 v91, 0xffff0000, v125
    v_sub_f32 v90, v90, v88
    v_sub_f32 v91, v91, v88
    v_cvt_pk_bf16_f32 v125, v90, v91
    v_lshlrev_b32 v90, 16, v125
    v_and_b32 v91, 0xffff0000, v125
    v_mul_f32 v90, v90, v89
    v_mul_f32 v91, v91, v89
    v_cvt_pk_bf16_f32 v125, v90, v91
    v_lshlrev_b32 v90, 16, v126
    v_and_b32 v91, 0xffff0000, v126
    v_sub_f32 v90, v90, v88
    v_sub_f32 v91, v91, v88
    v_cvt_pk_bf16_f32 v126, v90, v91
    v_lshlrev_b32 v90, 16, v126
    v_and_b32 v91, 0xffff0000, v126
    v_mul_f32 v90, v90, v89
    v_mul_f32 v91, v91, v89
    v_cvt_pk_bf16_f32 v126, v90, v91
    v_lshlrev_b32 v90, 16, v127
    v_and_b32 v91, 0xffff0000, v127
    v_sub_f32 v90, v90, v88
    v_sub_f32 v91, v91, v88
    v_cvt_pk_bf16_f32 v127, v90, v91
    v_lshlrev_b32 v90, 16, v127
    v_and_b32 v91, 0xffff0000, v127
    v_mul_f32 v90, v90, v89
    v_mul_f32 v91, v91, v89
    v_cvt_pk_bf16_f32 v127, v90, v91
    ds_write_b128 v4, v[124:127] offset:14336
    s_lshr_b32 s36, s21, 1
    s_lshl_b32 s36, s36, 14
    s_xor_b32 s37, s36, 16384
    v_add_u32 v80, s36, v5
    v_add_u32 v81, s37, v5
    v_add_u32 v82, s36, v6
    v_add_u32 v83, s37, v6
    s_mov_b32 s31, 0
    s_waitcnt vmcnt(24)
    s_barrier
    ds_read_b64_tr_b16 a[128:129], v20 offset:0
    ds_read_b64_tr_b16 a[130:131], v20 offset:1024
    ds_read_b64_tr_b16 a[132:133], v21 offset:0
    ds_read_b64_tr_b16 a[134:135], v21 offset:1024
    ds_read_b64_tr_b16 a[136:137], v22 offset:0
    ds_read_b64_tr_b16 a[138:139], v22 offset:1024
    ds_read_b64_tr_b16 a[140:141], v23 offset:0
    ds_read_b64_tr_b16 a[142:143], v23 offset:1024
    ds_read_b64_tr_b16 a[144:145], v24 offset:0
    ds_read_b64_tr_b16 a[146:147], v24 offset:1024
    ds_read_b64_tr_b16 a[148:149], v25 offset:0
    ds_read_b64_tr_b16 a[150:151], v25 offset:1024
    s_waitcnt lgkmcnt(4)
    ds_read_b64_tr_b16 a[152:153], v26 offset:0
    ds_read_b64_tr_b16 a[154:155], v26 offset:1024
    ds_read_b64_tr_b16 a[156:157], v27 offset:0
    ds_read_b64_tr_b16 a[158:159], v27 offset:1024
    s_waitcnt lgkmcnt(0)
    s_barrier
    s_mov_b32 s96, s48
    s_and_b32 s97, s49, 0xffff
    s_mov_b32 s98, 0x400000
    s_mov_b32 s99, 0x20000
    s_add_u32 m0, s28, 0
    s_add_u32 s37, s3, 0x0
    buffer_load_dwordx4 v16, s[96:99], s37 offen lds
    s_add_u32 m0, s28, 1024
    s_add_u32 s37, s3, 0x8000
    buffer_load_dwordx4 v17, s[96:99], s37 offen lds
    s_add_u32 m0, s28, 2048
    s_add_u32 s37, s3, 0x10000
    buffer_load_dwordx4 v18, s[96:99], s37 offen lds
    s_add_u32 m0, s28, 3072
    s_add_u32 s37, s3, 0x18000
    buffer_load_dwordx4 v19, s[96:99], s37 offen lds
    s_add_u32 m0, s28, 4096
    s_add_u32 s37, s3, 0x20000
    buffer_load_dwordx4 v16, s[96:99], s37 offen lds
    s_add_u32 m0, s28, 5120
    s_add_u32 s37, s3, 0x28000
    buffer_load_dwordx4 v17, s[96:99], s37 offen lds
    s_add_u32 m0, s28, 6144
    s_add_u32 s37, s3, 0x30000
    buffer_load_dwordx4 v18, s[96:99], s37 offen lds
    s_add_u32 m0, s28, 7168
    s_add_u32 s37, s3, 0x38000
    buffer_load_dwordx4 v19, s[96:99], s37 offen lds
    s_waitcnt vmcnt(24)
    s_barrier
    ds_read_b64_tr_b16 a[160:161], v20 offset:8192
    ds_read_b64_tr_b16 a[162:163], v20 offset:9216
    ds_read_b64_tr_b16 a[164:165], v21 offset:8192
    ds_read_b64_tr_b16 a[166:167], v21 offset:9216
    ds_read_b64_tr_b16 a[168:169], v22 offset:8192
    ds_read_b64_tr_b16 a[170:171], v22 offset:9216
    ds_read_b64_tr_b16 a[172:173], v23 offset:8192
    ds_read_b64_tr_b16 a[174:175], v23 offset:9216
    ds_read_b64_tr_b16 a[176:177], v24 offset:8192
    ds_read_b64_tr_b16 a[178:179], v24 offset:9216
    ds_read_b64_tr_b16 a[180:181], v25 offset:8192
    ds_read_b64_tr_b16 a[182:183], v25 offset:9216
    s_waitcnt lgkmcnt(4)
    ds_read_b64_tr_b16 a[184:185], v26 offset:8192
    ds_read_b64_tr_b16 a[186:187], v26 offset:9216
    ds_read_b64_tr_b16 a[188:189], v27 offset:8192
    ds_read_b64_tr_b16 a[190:191], v27 offset:9216
    s_waitcnt lgkmcnt(0)
    s_barrier
    s_add_u32 m0, s28, 8192
    s_add_u32 s37, s3, 0x100000
    buffer_load_dwordx4 v16, s[96:99], s37 offen lds
    s_add_u32 m0, s28, 9216
    s_add_u32 s37, s3, 0x108000
    buffer_load_dwordx4 v17, s[96:99], s37 offen lds
    s_add_u32 m0, s28, 10240
    s_add_u32 s37, s3, 0x110000
    buffer_load_dwordx4 v18, s[96:99], s37 offen lds
    s_add_u32 m0, s28, 11264
    s_add_u32 s37, s3, 0x118000
    buffer_load_dwordx4 v19, s[96:99], s37 offen lds
    s_add_u32 m0, s28, 12288
    s_add_u32 s37, s3, 0x120000
    buffer_load_dwordx4 v16, s[96:99], s37 offen lds
    s_add_u32 m0, s28, 13312
    s_add_u32 s37, s3, 0x128000
    buffer_load_dwordx4 v17, s[96:99], s37 offen lds
    s_add_u32 m0, s28, 14336
    s_add_u32 s37, s3, 0x130000
    buffer_load_dwordx4 v18, s[96:99], s37 offen lds
    s_add_u32 m0, s28, 15360
    s_add_u32 s37, s3, 0x138000
    buffer_load_dwordx4 v19, s[96:99], s37 offen lds
    s_waitcnt vmcnt(24)
    s_barrier
    ds_read_b64_tr_b16 a[192:193], v20 offset:16384
    ds_read_b64_tr_b16 a[194:195], v20 offset:17408
    ds_read_b64_tr_b16 a[196:197], v21 offset:16384
    ds_read_b64_tr_b16 a[198:199], v21 offset:17408
    ds_read_b64_tr_b16 a[200:201], v22 offset:16384
    ds_read_b64_tr_b16 a[202:203], v22 offset:17408
    ds_read_b64_tr_b16 a[204:205], v23 offset:16384
    ds_read_b64_tr_b16 a[206:207], v23 offset:17408
    ds_read_b64_tr_b16 a[208:209], v24 offset:16384
    ds_read_b64_tr_b16 a[210:211], v24 offset:17408
    ds_read_b64_tr_b16 a[212:213], v25 offset:16384
    ds_read_b64_tr_b16 a[214:215], v25 offset:17408
    s_waitcnt lgkmcnt(4)
    ds_read_b64_tr_b16 a[216:217], v26 offset:16384
    ds_read_b64_tr_b16 a[218:219], v26 offset:17408
    ds_read_b64_tr_b16 a[220:221], v27 offset:16384
    ds_read_b64_tr_b16 a[222:223], v27 offset:17408
    s_waitcnt lgkmcnt(0)
    s_barrier
    s_add_u32 m0, s28, 16384
    s_add_u32 s37, s3, 0x200000
    buffer_load_dwordx4 v16, s[96:99], s37 offen lds
    s_add_u32 m0, s28, 17408
    s_add_u32 s37, s3, 0x208000
    buffer_load_dwordx4 v17, s[96:99], s37 offen lds
    s_add_u32 m0, s28, 18432
    s_add_u32 s37, s3, 0x210000
    buffer_load_dwordx4 v18, s[96:99], s37 offen lds
    s_add_u32 m0, s28, 19456
    s_add_u32 s37, s3, 0x218000
    buffer_load_dwordx4 v19, s[96:99], s37 offen lds
    s_add_u32 m0, s28, 20480
    s_add_u32 s37, s3, 0x220000
    buffer_load_dwordx4 v16, s[96:99], s37 offen lds
    s_add_u32 m0, s28, 21504
    s_add_u32 s37, s3, 0x228000
    buffer_load_dwordx4 v17, s[96:99], s37 offen lds
    s_add_u32 m0, s28, 22528
    s_add_u32 s37, s3, 0x230000
    buffer_load_dwordx4 v18, s[96:99], s37 offen lds
    s_add_u32 m0, s28, 23552
    s_add_u32 s37, s3, 0x238000
    buffer_load_dwordx4 v19, s[96:99], s37 offen lds
    s_waitcnt vmcnt(24)
    s_barrier
    ds_read_b64_tr_b16 a[224:225], v20 offset:24576
    ds_read_b64_tr_b16 a[226:227], v20 offset:25600
    ds_read_b64_tr_b16 a[228:229], v21 offset:24576
    ds_read_b64_tr_b16 a[230:231], v21 offset:25600
    ds_read_b64_tr_b16 a[232:233], v22 offset:24576
    ds_read_b64_tr_b16 a[234:235], v22 offset:25600
    ds_read_b64_tr_b16 a[236:237], v23 offset:24576
    ds_read_b64_tr_b16 a[238:239], v23 offset:25600
    ds_read_b64_tr_b16 a[240:241], v24 offset:24576
    ds_read_b64_tr_b16 a[242:243], v24 offset:25600
    ds_read_b64_tr_b16 a[244:245], v25 offset:24576
    ds_read_b64_tr_b16 a[246:247], v25 offset:25600
    s_waitcnt lgkmcnt(4)
    ds_read_b64_tr_b16 a[248:249], v26 offset:24576
    ds_read_b64_tr_b16 a[250:251], v26 offset:25600
    ds_read_b64_tr_b16 a[252:253], v27 offset:24576
    ds_read_b64_tr_b16 a[254:255], v27 offset:25600
    s_waitcnt lgkmcnt(0)
    s_barrier
    s_add_u32 m0, s28, 24576
    s_add_u32 s37, s3, 0x300000
    buffer_load_dwordx4 v16, s[96:99], s37 offen lds
    s_add_u32 m0, s28, 25600
    s_add_u32 s37, s3, 0x308000
    buffer_load_dwordx4 v17, s[96:99], s37 offen lds
    s_add_u32 m0, s28, 26624
    s_add_u32 s37, s3, 0x310000
    buffer_load_dwordx4 v18, s[96:99], s37 offen lds
    s_add_u32 m0, s28, 27648
    s_add_u32 s37, s3, 0x318000
    buffer_load_dwordx4 v19, s[96:99], s37 offen lds
    s_add_u32 m0, s28, 28672
    s_add_u32 s37, s3, 0x320000
    buffer_load_dwordx4 v16, s[96:99], s37 offen lds
    s_add_u32 m0, s28, 29696
    s_add_u32 s37, s3, 0x328000
    buffer_load_dwordx4 v17, s[96:99], s37 offen lds
    s_add_u32 m0, s28, 30720
    s_add_u32 s37, s3, 0x330000
    buffer_load_dwordx4 v18, s[96:99], s37 offen lds
    s_add_u32 m0, s28, 31744
    s_add_u32 s37, s3, 0x338000
    buffer_load_dwordx4 v19, s[96:99], s37 offen lds
    ds_read_b128 v[64:67], v80 offset:0
    ds_read_b128 v[68:71], v81 offset:0
    ds_read_b128 v[72:75], v82 offset:1024
    ds_read_b128 v[76:79], v83 offset:1024
    s_waitcnt lgkmcnt(2)
    v_mfma_f32_16x16x32_bf16 v[32:35], a[128:131], v[64:67], 0
    v_mfma_f32_16x16x32_bf16 v[36:39], a[128:131], v[68:71], 0
    v_mfma_f32_16x16x32_bf16 v[40:43], a[132:135], v[64:67], 0
    v_mfma_f32_16x16x32_bf16 v[44:47], a[132:135], v[68:71], 0
    v_mfma_f32_16x16x32_bf16 v[48:51], v[64:67], v[128:131], 0
    v_mfma_f32_16x16x32_bf16 v[56:59], v[68:71], v[128:131], 0
    v_mfma_f32_16x16x32_bf16 v[52:55], v[64:67], v[132:135], 0
    v_mfma_f32_16x16x32_bf16 v[60:63], v[68:71], v[132:135], 0
    ds_read_b128 v[64:67], v80 offset:2048
    ds_read_b128 v[68:71], v81 offset:2048
    s_waitcnt lgkmcnt(2)
    v_mfma_f32_16x16x32_bf16 v[32:35], a[136:139], v[72:75], v[32:35]
    v_mfma_f32_16x16x32_bf16 v[36:39], a[136:139], v[76:79], v[36:39]
    v_mfma_f32_16x16x32_bf16 v[40:43], a[140:143], v[72:75], v[40:43]
    v_mfma_f32_16x16x32_bf16 v[44:47], a[140:143], v[76:79], v[44:47]
    v_mfma_f32_16x16x32_bf16 v[48:51], v[72:75], v[136:139], v[48:51]
    v_mfma_f32_16x16x32_bf16 v[56:59], v[76:79], v[136:139], v[56:59]
    v_mfma_f32_16x16x32_bf16 v[52:55], v[72:75], v[140:143], v[52:55]
    v_mfma_f32_16x16x32_bf16 v[60:63], v[76:79], v[140:143], v[60:63]
    ds_read_b128 v[72:75], v82 offset:3072
    ds_read_b128 v[76:79], v83 offset:3072
    s_waitcnt lgkmcnt(2)
    v_mfma_f32_16x16x32_bf16 v[32:35], a[144:147], v[64:67], v[32:35]
    v_mfma_f32_16x16x32_bf16 v[36:39], a[144:147], v[68:71], v[36:39]
    v_mfma_f32_16x16x32_bf16 v[40:43], a[148:151], v[64:67], v[40:43]
    v_mfma_f32_16x16x32_bf16 v[44:47], a[148:151], v[68:71], v[44:47]
    v_mfma_f32_16x16x32_bf16 v[48:51], v[64:67], v[144:147], v[48:51]
    v_mfma_f32_16x16x32_bf16 v[56:59], v[68:71], v[144:147], v[56:59]
    v_mfma_f32_16x16x32_bf16 v[52:55], v[64:67], v[148:151], v[52:55]
    v_mfma_f32_16x16x32_bf16 v[60:63], v[68:71], v[148:151], v[60:63]
    ds_read_b128 v[64:67], v80 offset:4096
    ds_read_b128 v[68:71], v81 offset:4096
    s_waitcnt lgkmcnt(2)
    v_mfma_f32_16x16x32_bf16 v[32:35], a[152:155], v[72:75], v[32:35]
    v_mfma_f32_16x16x32_bf16 v[36:39], a[152:155], v[76:79], v[36:39]
    v_mfma_f32_16x16x32_bf16 v[40:43], a[156:159], v[72:75], v[40:43]
    v_mfma_f32_16x16x32_bf16 v[44:47], a[156:159], v[76:79], v[44:47]
    v_mfma_f32_16x16x32_bf16 v[48:51], v[72:75], v[152:155], v[48:51]
    v_mfma_f32_16x16x32_bf16 v[56:59], v[76:79], v[152:155], v[56:59]
    v_mfma_f32_16x16x32_bf16 v[52:55], v[72:75], v[156:159], v[52:55]
    v_mfma_f32_16x16x32_bf16 v[60:63], v[76:79], v[156:159], v[60:63]
    ds_read_b128 v[72:75], v82 offset:5120
    ds_read_b128 v[76:79], v83 offset:5120
    s_waitcnt lgkmcnt(2)
    v_mfma_f32_16x16x32_bf16 v[32:35], a[160:163], v[64:67], v[32:35]
    v_mfma_f32_16x16x32_bf16 v[36:39], a[160:163], v[68:71], v[36:39]
    v_mfma_f32_16x16x32_bf16 v[40:43], a[164:167], v[64:67], v[40:43]
    v_mfma_f32_16x16x32_bf16 v[44:47], a[164:167], v[68:71], v[44:47]
    v_mfma_f32_16x16x32_bf16 v[48:51], v[64:67], v[160:163], v[48:51]
    v_mfma_f32_16x16x32_bf16 v[56:59], v[68:71], v[160:163], v[56:59]
    v_mfma_f32_16x16x32_bf16 v[52:55], v[64:67], v[164:167], v[52:55]
    v_mfma_f32_16x16x32_bf16 v[60:63], v[68:71], v[164:167], v[60:63]
    ds_read_b128 v[64:67], v80 offset:6144
    ds_read_b128 v[68:71], v81 offset:6144
    s_waitcnt lgkmcnt(2)
    v_mfma_f32_16x16x32_bf16 v[32:35], a[168:171], v[72:75], v[32:35]
    v_mfma_f32_16x16x32_bf16 v[36:39], a[168:171], v[76:79], v[36:39]
    v_mfma_f32_16x16x32_bf16 v[40:43], a[172:175], v[72:75], v[40:43]
    v_mfma_f32_16x16x32_bf16 v[44:47], a[172:175], v[76:79], v[44:47]
    v_mfma_f32_16x16x32_bf16 v[48:51], v[72:75], v[168:171], v[48:51]
    v_mfma_f32_16x16x32_bf16 v[56:59], v[76:79], v[168:171], v[56:59]
    v_mfma_f32_16x16x32_bf16 v[52:55], v[72:75], v[172:175], v[52:55]
    v_mfma_f32_16x16x32_bf16 v[60:63], v[76:79], v[172:175], v[60:63]
    ds_read_b128 v[72:75], v82 offset:7168
    ds_read_b128 v[76:79], v83 offset:7168
    s_waitcnt lgkmcnt(2)
    v_mfma_f32_16x16x32_bf16 v[32:35], a[176:179], v[64:67], v[32:35]
    v_mfma_f32_16x16x32_bf16 v[36:39], a[176:179], v[68:71], v[36:39]
    v_mfma_f32_16x16x32_bf16 v[40:43], a[180:183], v[64:67], v[40:43]
    v_mfma_f32_16x16x32_bf16 v[44:47], a[180:183], v[68:71], v[44:47]
    v_mfma_f32_16x16x32_bf16 v[48:51], v[64:67], v[176:179], v[48:51]
    v_mfma_f32_16x16x32_bf16 v[56:59], v[68:71], v[176:179], v[56:59]
    v_mfma_f32_16x16x32_bf16 v[52:55], v[64:67], v[180:183], v[52:55]
    v_mfma_f32_16x16x32_bf16 v[60:63], v[68:71], v[180:183], v[60:63]
    ds_read_b128 v[64:67], v80 offset:8192
    ds_read_b128 v[68:71], v81 offset:8192
    s_waitcnt lgkmcnt(2)
    v_mfma_f32_16x16x32_bf16 v[32:35], a[184:187], v[72:75], v[32:35]
    v_mfma_f32_16x16x32_bf16 v[36:39], a[184:187], v[76:79], v[36:39]
    v_mfma_f32_16x16x32_bf16 v[40:43], a[188:191], v[72:75], v[40:43]
    v_mfma_f32_16x16x32_bf16 v[44:47], a[188:191], v[76:79], v[44:47]
    v_mfma_f32_16x16x32_bf16 v[48:51], v[72:75], v[184:187], v[48:51]
    v_mfma_f32_16x16x32_bf16 v[56:59], v[76:79], v[184:187], v[56:59]
    v_mfma_f32_16x16x32_bf16 v[52:55], v[72:75], v[188:191], v[52:55]
    v_mfma_f32_16x16x32_bf16 v[60:63], v[76:79], v[188:191], v[60:63]
    ds_read_b128 v[72:75], v82 offset:9216
    ds_read_b128 v[76:79], v83 offset:9216
    s_waitcnt lgkmcnt(2)
    v_mfma_f32_16x16x32_bf16 v[32:35], a[192:195], v[64:67], v[32:35]
    v_mfma_f32_16x16x32_bf16 v[36:39], a[192:195], v[68:71], v[36:39]
    v_mfma_f32_16x16x32_bf16 v[40:43], a[196:199], v[64:67], v[40:43]
    v_mfma_f32_16x16x32_bf16 v[44:47], a[196:199], v[68:71], v[44:47]
    v_mfma_f32_16x16x32_bf16 v[48:51], v[64:67], v[192:195], v[48:51]
    v_mfma_f32_16x16x32_bf16 v[56:59], v[68:71], v[192:195], v[56:59]
    v_mfma_f32_16x16x32_bf16 v[52:55], v[64:67], v[196:199], v[52:55]
    v_mfma_f32_16x16x32_bf16 v[60:63], v[68:71], v[196:199], v[60:63]
    ds_read_b128 v[64:67], v80 offset:10240
    ds_read_b128 v[68:71], v81 offset:10240
    s_waitcnt lgkmcnt(2)
    v_mfma_f32_16x16x32_bf16 v[32:35], a[200:203], v[72:75], v[32:35]
    v_mfma_f32_16x16x32_bf16 v[36:39], a[200:203], v[76:79], v[36:39]
    v_mfma_f32_16x16x32_bf16 v[40:43], a[204:207], v[72:75], v[40:43]
    v_mfma_f32_16x16x32_bf16 v[44:47], a[204:207], v[76:79], v[44:47]
    v_mfma_f32_16x16x32_bf16 v[48:51], v[72:75], v[200:203], v[48:51]
    v_mfma_f32_16x16x32_bf16 v[56:59], v[76:79], v[200:203], v[56:59]
    v_mfma_f32_16x16x32_bf16 v[52:55], v[72:75], v[204:207], v[52:55]
    v_mfma_f32_16x16x32_bf16 v[60:63], v[76:79], v[204:207], v[60:63]
    ds_read_b128 v[72:75], v82 offset:11264
    ds_read_b128 v[76:79], v83 offset:11264
    s_waitcnt lgkmcnt(2)
    v_mfma_f32_16x16x32_bf16 v[32:35], a[208:211], v[64:67], v[32:35]
    v_mfma_f32_16x16x32_bf16 v[36:39], a[208:211], v[68:71], v[36:39]
    v_mfma_f32_16x16x32_bf16 v[40:43], a[212:215], v[64:67], v[40:43]
    v_mfma_f32_16x16x32_bf16 v[44:47], a[212:215], v[68:71], v[44:47]
    v_mfma_f32_16x16x32_bf16 v[48:51], v[64:67], v[208:211], v[48:51]
    v_mfma_f32_16x16x32_bf16 v[56:59], v[68:71], v[208:211], v[56:59]
    v_mfma_f32_16x16x32_bf16 v[52:55], v[64:67], v[212:215], v[52:55]
    v_mfma_f32_16x16x32_bf16 v[60:63], v[68:71], v[212:215], v[60:63]
    ds_read_b128 v[64:67], v80 offset:12288
    ds_read_b128 v[68:71], v81 offset:12288
    s_waitcnt lgkmcnt(2)
    v_mfma_f32_16x16x32_bf16 v[32:35], a[216:219], v[72:75], v[32:35]
    v_mfma_f32_16x16x32_bf16 v[36:39], a[216:219], v[76:79], v[36:39]
    v_mfma_f32_16x16x32_bf16 v[40:43], a[220:223], v[72:75], v[40:43]
    v_mfma_f32_16x16x32_bf16 v[44:47], a[220:223], v[76:79], v[44:47]
    v_mfma_f32_16x16x32_bf16 v[48:51], v[72:75], v[216:219], v[48:51]
    v_mfma_f32_16x16x32_bf16 v[56:59], v[76:79], v[216:219], v[56:59]
    v_mfma_f32_16x16x32_bf16 v[52:55], v[72:75], v[220:223], v[52:55]
    v_mfma_f32_16x16x32_bf16 v[60:63], v[76:79], v[220:223], v[60:63]
    ds_read_b128 v[72:75], v82 offset:13312
    ds_read_b128 v[76:79], v83 offset:13312
    s_waitcnt lgkmcnt(2)
    v_mfma_f32_16x16x32_bf16 v[32:35], a[224:227], v[64:67], v[32:35]
    v_mfma_f32_16x16x32_bf16 v[36:39], a[224:227], v[68:71], v[36:39]
    v_mfma_f32_16x16x32_bf16 v[40:43], a[228:231], v[64:67], v[40:43]
    v_mfma_f32_16x16x32_bf16 v[44:47], a[228:231], v[68:71], v[44:47]
    v_mfma_f32_16x16x32_bf16 v[48:51], v[64:67], v[224:227], v[48:51]
    v_mfma_f32_16x16x32_bf16 v[56:59], v[68:71], v[224:227], v[56:59]
    v_mfma_f32_16x16x32_bf16 v[52:55], v[64:67], v[228:231], v[52:55]
    v_mfma_f32_16x16x32_bf16 v[60:63], v[68:71], v[228:231], v[60:63]
    ds_read_b128 v[64:67], v80 offset:14336
    ds_read_b128 v[68:71], v81 offset:14336
    s_waitcnt lgkmcnt(2)
    v_mfma_f32_16x16x32_bf16 v[32:35], a[232:235], v[72:75], v[32:35]
    v_mfma_f32_16x16x32_bf16 v[36:39], a[232:235], v[76:79], v[36:39]
    v_mfma_f32_16x16x32_bf16 v[40:43], a[236:239], v[72:75], v[40:43]
    v_mfma_f32_16x16x32_bf16 v[44:47], a[236:239], v[76:79], v[44:47]
    v_mfma_f32_16x16x32_bf16 v[48:51], v[72:75], v[232:235], v[48:51]
    v_mfma_f32_16x16x32_bf16 v[56:59], v[76:79], v[232:235], v[56:59]
    v_mfma_f32_16x16x32_bf16 v[52:55], v[72:75], v[236:239], v[52:55]
    v_mfma_f32_16x16x32_bf16 v[60:63], v[76:79], v[236:239], v[60:63]
    ds_read_b128 v[72:75], v82 offset:15360
    ds_read_b128 v[76:79], v83 offset:15360
    s_waitcnt lgkmcnt(2)
    v_mfma_f32_16x16x32_bf16 v[32:35], a[240:243], v[64:67], v[32:35]
    v_mfma_f32_16x16x32_bf16 v[36:39], a[240:243], v[68:71], v[36:39]
    v_mfma_f32_16x16x32_bf16 v[40:43], a[244:247], v[64:67], v[40:43]
    v_mfma_f32_16x16x32_bf16 v[44:47], a[244:247], v[68:71], v[44:47]
    v_mfma_f32_16x16x32_bf16 v[48:51], v[64:67], v[240:243], v[48:51]
    v_mfma_f32_16x16x32_bf16 v[56:59], v[68:71], v[240:243], v[56:59]
    v_mfma_f32_16x16x32_bf16 v[52:55], v[64:67], v[244:247], v[52:55]
    v_mfma_f32_16x16x32_bf16 v[60:63], v[68:71], v[244:247], v[60:63]
    s_waitcnt lgkmcnt(0)
    v_mfma_f32_16x16x32_bf16 v[32:35], a[248:251], v[72:75], v[32:35]
    v_mfma_f32_16x16x32_bf16 v[36:39], a[248:251], v[76:79], v[36:39]
    v_mfma_f32_16x16x32_bf16 v[40:43], a[252:255], v[72:75], v[40:43]
    v_mfma_f32_16x16x32_bf16 v[44:47], a[252:255], v[76:79], v[44:47]
    v_mfma_f32_16x16x32_bf16 v[48:51], v[72:75], v[248:251], v[48:51]
    v_mfma_f32_16x16x32_bf16 v[56:59], v[76:79], v[248:251], v[56:59]
    v_mfma_f32_16x16x32_bf16 v[52:55], v[72:75], v[252:255], v[52:55]
    v_mfma_f32_16x16x32_bf16 v[60:63], v[76:79], v[252:255], v[60:63]
    s_nop 0
    v_mul_f32 v32, s33, v32
    v_mul_f32 v33, s33, v33
    v_mul_f32 v34, s33, v34
    v_mul_f32 v35, s33, v35
    v_mul_f32 v36, s33, v36
    v_mul_f32 v37, s33, v37
    v_mul_f32 v38, s33, v38
    v_mul_f32 v39, s33, v39
    v_mul_f32 v40, s33, v40
    v_mul_f32 v41, s33, v41
    v_mul_f32 v42, s33, v42
    v_mul_f32 v43, s33, v43
    v_mul_f32 v44, s33, v44
    v_mul_f32 v45, s33, v45
    v_mul_f32 v46, s33, v46
    v_mul_f32 v47, s33, v47
    v_cvt_pk_bf16_f32 v88, v32, v40
    v_cvt_pk_bf16_f32 v89, v33, v41
    v_cvt_pk_bf16_f32 v90, v34, v42
    v_cvt_pk_bf16_f32 v91, v35, v43
    v_cvt_pk_bf16_f32 v92, v36, v44
    v_cvt_pk_bf16_f32 v93, v37, v45
    v_cvt_pk_bf16_f32 v94, v38, v46
    v_cvt_pk_bf16_f32 v95, v39, v47
    v_cvt_pk_bf16_f32 v96, v48, v49
    v_cvt_pk_bf16_f32 v97, v50, v51
    v_cvt_pk_bf16_f32 v98, v56, v57
    v_cvt_pk_bf16_f32 v99, v58, v59
    v_cvt_pk_bf16_f32 v100, v52, v53
    v_cvt_pk_bf16_f32 v101, v54, v55
    v_cvt_pk_bf16_f32 v102, v60, v61
    v_cvt_pk_bf16_f32 v103, v62, v63
    s_mul_i32 s24, s23, 0x82100
    s_lshl_b32 s36, s20, 14
    s_add_u32 s24, s24, s36
    s_add_u32 s24, s24, 0x1000000
    s_mov_b32 s30, s24
    s_lshr_b32 s36, s21, 1
    s_lshl_b32 s36, s36, 12
    s_xor_b32 s37, s36, 4096
    s_add_u32 s36, s36, s24
    s_add_u32 s37, s37, s24
    buffer_store_dwordx4 v[88:91], v9, s[8:11], s36 offen sc1
    buffer_store_dwordx4 v[92:95], v9, s[8:11], s37 offen sc1
    s_add_u32 s24, s24, 8192
    buffer_store_dwordx4 v[96:99], v2, s[8:11], s24 offen sc1
    buffer_store_dwordx4 v[100:103], v2, s[8:11], s24 offen offset:1024 sc1
    s_mul_i32 s25, s23, 0x82100
    s_lshl_b32 s36, s20, 2
    s_add_u32 s25, s25, s36
    s_add_u32 s25, s25, 0x1082000
    v_lshrrev_b32 v15, 2, v1
    v_and_b32 v15, 127, v15
L_WHS:
    buffer_load_dword v14, v15, s[16:19], 0 offen sc1
    s_add_u32 s32, s32, 1
    s_cmp_gt_u32 s32, 200000
    s_cbranch_scc1 L_WHS_done
    s_waitcnt vmcnt(0)
    v_cmp_eq_u32 vcc, 0, v14
    s_cbranch_vccnz L_WHS
L_WHS_done:
    s_waitcnt vmcnt(0)
    s_barrier
    v_cmp_ne_u32 vcc, 0, v0
    v_mov_b32 v15, 0x40000000
    v_mov_b32 v14, 1
    v_cndmask_b32 v15, v0, v15, vcc
    buffer_store_dword v14, v15, s[8:11], s25 offen sc1
    s_barrier
    ds_read_b64_tr_b16 a[0:1], v20 offset:0
    ds_read_b64_tr_b16 a[2:3], v20 offset:1024
    ds_read_b64_tr_b16 a[4:5], v21 offset:0
    ds_read_b64_tr_b16 a[6:7], v21 offset:1024
    ds_read_b64_tr_b16 a[8:9], v22 offset:0
    ds_read_b64_tr_b16 a[10:11], v22 offset:1024
    ds_read_b64_tr_b16 a[12:13], v23 offset:0
    ds_read_b64_tr_b16 a[14:15], v23 offset:1024
    ds_read_b64_tr_b16 a[16:17], v24 offset:0
    ds_read_b64_tr_b16 a[18:19], v24 offset:1024
    ds_read_b64_tr_b16 a[20:21], v25 offset:0
    ds_read_b64_tr_b16 a[22:23], v25 offset:1024
    s_waitcnt lgkmcnt(4)
    ds_read_b64_tr_b16 a[24:25], v26 offset:0
    ds_read_b64_tr_b16 a[26:27], v26 offset:1024
    ds_read_b64_tr_b16 a[28:29], v27 offset:0
    ds_read_b64_tr_b16 a[30:31], v27 offset:1024
    s_waitcnt lgkmcnt(0)
    s_barrier
    s_barrier
    ds_read_b64_tr_b16 a[32:33], v20 offset:8192
    ds_read_b64_tr_b16 a[34:35], v20 offset:9216
    ds_read_b64_tr_b16 a[36:37], v21 offset:8192
    ds_read_b64_tr_b16 a[38:39], v21 offset:9216
    ds_read_b64_tr_b16 a[40:41], v22 offset:8192
    ds_read_b64_tr_b16 a[42:43], v22 offset:9216
    ds_read_b64_tr_b16 a[44:45], v23 offset:8192
    ds_read_b64_tr_b16 a[46:47], v23 offset:9216
    ds_read_b64_tr_b16 a[48:49], v24 offset:8192
    ds_read_b64_tr_b16 a[50:51], v24 offset:9216
    ds_read_b64_tr_b16 a[52:53], v25 offset:8192
    ds_read_b64_tr_b16 a[54:55], v25 offset:9216
    s_waitcnt lgkmcnt(4)
    ds_read_b64_tr_b16 a[56:57], v26 offset:8192
    ds_read_b64_tr_b16 a[58:59], v26 offset:9216
    ds_read_b64_tr_b16 a[60:61], v27 offset:8192
    ds_read_b64_tr_b16 a[62:63], v27 offset:9216
    s_waitcnt lgkmcnt(0)
    s_barrier
    s_barrier
    ds_read_b64_tr_b16 a[64:65], v20 offset:16384
    ds_read_b64_tr_b16 a[66:67], v20 offset:17408
    ds_read_b64_tr_b16 a[68:69], v21 offset:16384
    ds_read_b64_tr_b16 a[70:71], v21 offset:17408
    ds_read_b64_tr_b16 a[72:73], v22 offset:16384
    ds_read_b64_tr_b16 a[74:75], v22 offset:17408
    ds_read_b64_tr_b16 a[76:77], v23 offset:16384
    ds_read_b64_tr_b16 a[78:79], v23 offset:17408
    ds_read_b64_tr_b16 a[80:81], v24 offset:16384
    ds_read_b64_tr_b16 a[82:83], v24 offset:17408
    ds_read_b64_tr_b16 a[84:85], v25 offset:16384
    ds_read_b64_tr_b16 a[86:87], v25 offset:17408
    s_waitcnt lgkmcnt(4)
    ds_read_b64_tr_b16 a[88:89], v26 offset:16384
    ds_read_b64_tr_b16 a[90:91], v26 offset:17408
    ds_read_b64_tr_b16 a[92:93], v27 offset:16384
    ds_read_b64_tr_b16 a[94:95], v27 offset:17408
    s_waitcnt lgkmcnt(0)
    s_barrier
    s_barrier
    ds_read_b64_tr_b16 a[96:97], v20 offset:24576
    ds_read_b64_tr_b16 a[98:99], v20 offset:25600
    ds_read_b64_tr_b16 a[100:101], v21 offset:24576
    ds_read_b64_tr_b16 a[102:103], v21 offset:25600
    ds_read_b64_tr_b16 a[104:105], v22 offset:24576
    ds_read_b64_tr_b16 a[106:107], v22 offset:25600
    ds_read_b64_tr_b16 a[108:109], v23 offset:24576
    ds_read_b64_tr_b16 a[110:111], v23 offset:25600
    ds_read_b64_tr_b16 a[112:113], v24 offset:24576
    ds_read_b64_tr_b16 a[114:115], v24 offset:25600
    ds_read_b64_tr_b16 a[116:117], v25 offset:24576
    ds_read_b64_tr_b16 a[118:119], v25 offset:25600
    s_waitcnt lgkmcnt(4)
    ds_read_b64_tr_b16 a[120:121], v26 offset:24576
    ds_read_b64_tr_b16 a[122:123], v26 offset:25600
    ds_read_b64_tr_b16 a[124:125], v27 offset:24576
    ds_read_b64_tr_b16 a[126:127], v27 offset:25600
    s_waitcnt lgkmcnt(0)
    s_barrier
L_P1:
    s_waitcnt vmcnt(6)
    s_barrier
    s_xor_b32 s31, s31, 32768
    s_add_u32 s24, s23, 6
    s_min_u32 s24, s24, 63
    s_lshl_b32 s36, s24, 15
    s_add_u32 s36, s36, 0x800000
    s_lshl_b32 s37, s21, 10
    s_add_u32 s37, s37, s31
    s_add_u32 m0, s37, 0
    s_add_u32 s38, s36, 0
    buffer_load_dwordx4 v9, s[8:11], s38 offen sc1 lds
    s_add_u32 m0, s37, 4096
    s_add_u32 s38, s36, 4096
    buffer_load_dwordx4 v9, s[8:11], s38 offen sc1 lds
    s_add_u32 m0, s37, 8192
    s_add_u32 s38, s36, 8192
    buffer_load_dwordx4 v9, s[8:11], s38 offen sc1 lds
    s_add_u32 m0, s37, 12288
    s_add_u32 s38, s36, 12288
    buffer_load_dwordx4 v9, s[8:11], s38 offen sc1 lds
    s_add_u32 m0, s37, 16384
    s_add_u32 s38, s36, 16384
    buffer_load_dwordx4 v9, s[8:11], s38 offen sc1 lds
    s_add_u32 m0, s37, 20480
    s_add_u32 s38, s36, 20480
    buffer_load_dwordx4 v9, s[8:11], s38 offen sc1 lds
    s_add_u32 m0, s37, 24576
    s_add_u32 s38, s36, 24576
    buffer_load_dwordx4 v9, s[8:11], s38 offen sc1 lds
    s_add_u32 m0, s37, 28672
    s_add_u32 s38, s36, 28672
    buffer_load_dwordx4 v9, s[8:11], s38 offen sc1 lds
    ds_read_b128 v[64:67], v80 offset:0
    ds_read_b128 v[68:71], v81 offset:0
    ds_read_b128 v[72:75], v82 offset:1024
    ds_read_b128 v[76:79], v83 offset:1024
    s_waitcnt lgkmcnt(2)
    v_mfma_f32_16x16x32_bf16 v[32:35], a[128:131], v[64:67], 0
    v_mfma_f32_16x16x32_bf16 v[36:39], a[128:131], v[68:71], 0
    v_mfma_f32_16x16x32_bf16 v[40:43], a[132:135], v[64:67], 0
    v_mfma_f32_16x16x32_bf16 v[44:47], a[132:135], v[68:71], 0
    v_mfma_f32_16x16x32_bf16 v[48:51], v[64:67], v[128:131], 0
    v_mfma_f32_16x16x32_bf16 v[56:59], v[68:71], v[128:131], 0
    v_mfma_f32_16x16x32_bf16 v[52:55], v[64:67], v[132:135], 0
    v_mfma_f32_16x16x32_bf16 v[60:63], v[68:71], v[132:135], 0
    v_mfma_f32_16x16x32_bf16 v[16:19], a[0:3], v[64:67], 0
    v_mfma_f32_16x16x32_bf16 v[20:23], a[0:3], v[68:71], 0
    v_mfma_f32_16x16x32_bf16 v[24:27], a[4:7], v[64:67], 0
    v_mfma_f32_16x16x32_bf16 v[28:31], a[4:7], v[68:71], 0
    ds_read_b128 v[64:67], v80 offset:2048
    ds_read_b128 v[68:71], v81 offset:2048
    s_waitcnt lgkmcnt(2)
    v_mfma_f32_16x16x32_bf16 v[32:35], a[136:139], v[72:75], v[32:35]
    v_mfma_f32_16x16x32_bf16 v[36:39], a[136:139], v[76:79], v[36:39]
    v_mfma_f32_16x16x32_bf16 v[40:43], a[140:143], v[72:75], v[40:43]
    v_mfma_f32_16x16x32_bf16 v[44:47], a[140:143], v[76:79], v[44:47]
    v_mfma_f32_16x16x32_bf16 v[48:51], v[72:75], v[136:139], v[48:51]
    v_mfma_f32_16x16x32_bf16 v[56:59], v[76:79], v[136:139], v[56:59]
    v_mfma_f32_16x16x32_bf16 v[52:55], v[72:75], v[140:143], v[52:55]
    v_mfma_f32_16x16x32_bf16 v[60:63], v[76:79], v[140:143], v[60:63]
    v_mfma_f32_16x16x32_bf16 v[16:19], a[8:11], v[72:75], v[16:19]
    v_mfma_f32_16x16x32_bf16 v[20:23], a[8:11], v[76:79], v[20:23]
    v_mfma_f32_16x16x32_bf16 v[24:27], a[12:15], v[72:75], v[24:27]
    v_mfma_f32_16x16x32_bf16 v[28:31], a[12:15], v[76:79], v[28:31]
    ds_read_b128 v[72:75], v82 offset:3072
    ds_read_b128 v[76:79], v83 offset:3072
    s_waitcnt lgkmcnt(2)
    v_mfma_f32_16x16x32_bf16 v[32:35], a[144:147], v[64:67], v[32:35]
    v_mfma_f32_16x16x32_bf16 v[36:39], a[144:147], v[68:71], v[36:39]
    v_mfma_f32_16x16x32_bf16 v[40:43], a[148:151], v[64:67], v[40:43]
    v_mfma_f32_16x16x32_bf16 v[44:47], a[148:151], v[68:71], v[44:47]
    v_mfma_f32_16x16x32_bf16 v[48:51], v[64:67], v[144:147], v[48:51]
    v_mfma_f32_16x16x32_bf16 v[56:59], v[68:71], v[144:147], v[56:59]
    v_mfma_f32_16x16x32_bf16 v[52:55], v[64:67], v[148:151], v[52:55]
    v_mfma_f32_16x16x32_bf16 v[60:63], v[68:71], v[148:151], v[60:63]
    v_mfma_f32_16x16x32_bf16 v[16:19], a[16:19], v[64:67], v[16:19]
    v_mfma_f32_16x16x32_bf16 v[20:23], a[16:19], v[68:71], v[20:23]
    v_mfma_f32_16x16x32_bf16 v[24:27], a[20:23], v[64:67], v[24:27]
    v_mfma_f32_16x16x32_bf16 v[28:31], a[20:23], v[68:71], v[28:31]
    ds_read_b128 v[64:67], v80 offset:4096
    ds_read_b128 v[68:71], v81 offset:4096
    s_waitcnt lgkmcnt(2)
    v_mfma_f32_16x16x32_bf16 v[32:35], a[152:155], v[72:75], v[32:35]
    v_mfma_f32_16x16x32_bf16 v[36:39], a[152:155], v[76:79], v[36:39]
    v_mfma_f32_16x16x32_bf16 v[40:43], a[156:159], v[72:75], v[40:43]
    v_mfma_f32_16x16x32_bf16 v[44:47], a[156:159], v[76:79], v[44:47]
    v_mfma_f32_16x16x32_bf16 v[48:51], v[72:75], v[152:155], v[48:51]
    v_mfma_f32_16x16x32_bf16 v[56:59], v[76:79], v[152:155], v[56:59]
    v_mfma_f32_16x16x32_bf16 v[52:55], v[72:75], v[156:159], v[52:55]
    v_mfma_f32_16x16x32_bf16 v[60:63], v[76:79], v[156:159], v[60:63]
    v_mfma_f32_16x16x32_bf16 v[16:19], a[24:27], v[72:75], v[16:19]
    v_mfma_f32_16x16x32_bf16 v[20:23], a[24:27], v[76:79], v[20:23]
    v_mfma_f32_16x16x32_bf16 v[24:27], a[28:31], v[72:75], v[24:27]
    v_mfma_f32_16x16x32_bf16 v[28:31], a[28:31], v[76:79], v[28:31]
    ds_read_b128 v[72:75], v82 offset:5120
    ds_read_b128 v[76:79], v83 offset:5120
    s_waitcnt lgkmcnt(2)
    v_mfma_f32_16x16x32_bf16 v[32:35], a[160:163], v[64:67], v[32:35]
    v_mfma_f32_16x16x32_bf16 v[36:39], a[160:163], v[68:71], v[36:39]
    v_mfma_f32_16x16x32_bf16 v[40:43], a[164:167], v[64:67], v[40:43]
    v_mfma_f32_16x16x32_bf16 v[44:47], a[164:167], v[68:71], v[44:47]
    v_mfma_f32_16x16x32_bf16 v[48:51], v[64:67], v[160:163], v[48:51]
    v_mfma_f32_16x16x32_bf16 v[56:59], v[68:71], v[160:163], v[56:59]
    v_mfma_f32_16x16x32_bf16 v[52:55], v[64:67], v[164:167], v[52:55]
    v_mfma_f32_16x16x32_bf16 v[60:63], v[68:71], v[164:167], v[60:63]
    v_mfma_f32_16x16x32_bf16 v[16:19], a[32:35], v[64:67], v[16:19]
    v_mfma_f32_16x16x32_bf16 v[20:23], a[32:35], v[68:71], v[20:23]
    v_mfma_f32_16x16x32_bf16 v[24:27], a[36:39], v[64:67], v[24:27]
    v_mfma_f32_16x16x32_bf16 v[28:31], a[36:39], v[68:71], v[28:31]
    ds_read_b128 v[64:67], v80 offset:6144
    ds_read_b128 v[68:71], v81 offset:6144
    s_waitcnt lgkmcnt(2)
    v_mfma_f32_16x16x32_bf16 v[32:35], a[168:171], v[72:75], v[32:35]
    v_mfma_f32_16x16x32_bf16 v[36:39], a[168:171], v[76:79], v[36:39]
    v_mfma_f32_16x16x32_bf16 v[40:43], a[172:175], v[72:75], v[40:43]
    v_mfma_f32_16x16x32_bf16 v[44:47], a[172:175], v[76:79], v[44:47]
    v_mfma_f32_16x16x32_bf16 v[48:51], v[72:75], v[168:171], v[48:51]
    v_mfma_f32_16x16x32_bf16 v[56:59], v[76:79], v[168:171], v[56:59]
    v_mfma_f32_16x16x32_bf16 v[52:55], v[72:75], v[172:175], v[52:55]
    v_mfma_f32_16x16x32_bf16 v[60:63], v[76:79], v[172:175], v[60:63]
    v_mfma_f32_16x16x32_bf16 v[16:19], a[40:43], v[72:75], v[16:19]
    v_mfma_f32_16x16x32_bf16 v[20:23], a[40:43], v[76:79], v[20:23]
    v_mfma_f32_16x16x32_bf16 v[24:27], a[44:47], v[72:75], v[24:27]
    v_mfma_f32_16x16x32_bf16 v[28:31], a[44:47], v[76:79], v[28:31]
    ds_read_b128 v[72:75], v82 offset:7168
    ds_read_b128 v[76:79], v83 offset:7168
    s_waitcnt lgkmcnt(2)
    s_waitcnt vmcnt(8)
    s_barrier
    v_cmp_ne_u32 vcc, 0, v0
    v_mov_b32 v15, 0x40000000
    v_mov_b32 v14, 1
    v_cndmask_b32 v15, v0, v15, vcc
    buffer_store_dword v14, v15, s[8:11], s25 offen sc1
    v_mfma_f32_16x16x32_bf16 v[32:35], a[176:179], v[64:67], v[32:35]
    v_mfma_f32_16x16x32_bf16 v[36:39], a[176:179], v[68:71], v[36:39]
    v_mfma_f32_16x16x32_bf16 v[40:43], a[180:183], v[64:67], v[40:43]
    v_mfma_f32_16x16x32_bf16 v[44:47], a[180:183], v[68:71], v[44:47]
    v_mfma_f32_16x16x32_bf16 v[48:51], v[64:67], v[176:179], v[48:51]
    v_mfma_f32_16x16x32_bf16 v[56:59], v[68:71], v[176:179], v[56:59]
    v_mfma_f32_16x16x32_bf16 v[52:55], v[64:67], v[180:183], v[52:55]
    v_mfma_f32_16x16x32_bf16 v[60:63], v[68:71], v[180:183], v[60:63]
    v_mfma_f32_16x16x32_bf16 v[16:19], a[48:51], v[64:67], v[16:19]
    v_mfma_f32_16x16x32_bf16 v[20:23], a[48:51], v[68:71], v[20:23]
    v_mfma_f32_16x16x32_bf16 v[24:27], a[52:55], v[64:67], v[24:27]
    v_mfma_f32_16x16x32_bf16 v[28:31], a[52:55], v[68:71], v[28:31]
    ds_read_b128 v[64:67], v80 offset:8192
    ds_read_b128 v[68:71], v81 offset:8192
    s_waitcnt lgkmcnt(2)
    v_mfma_f32_16x16x32_bf16 v[32:35], a[184:187], v[72:75], v[32:35]
    v_mfma_f32_16x16x32_bf16 v[36:39], a[184:187], v[76:79], v[36:39]
    v_mfma_f32_16x16x32_bf16 v[40:43], a[188:191], v[72:75], v[40:43]
    v_mfma_f32_16x16x32_bf16 v[44:47], a[188:191], v[76:79], v[44:47]
    v_mfma_f32_16x16x32_bf16 v[48:51], v[72:75], v[184:187], v[48:51]
    v_mfma_f32_16x16x32_bf16 v[56:59], v[76:79], v[184:187], v[56:59]
    v_mfma_f32_16x16x32_bf16 v[52:55], v[72:75], v[188:191], v[52:55]
    v_mfma_f32_16x16x32_bf16 v[60:63], v[76:79], v[188:191], v[60:63]
    v_mfma_f32_16x16x32_bf16 v[16:19], a[56:59], v[72:75], v[16:19]
    v_mfma_f32_16x16x32_bf16 v[20:23], a[56:59], v[76:79], v[20:23]
    v_mfma_f32_16x16x32_bf16 v[24:27], a[60:63], v[72:75], v[24:27]
    v_mfma_f32_16x16x32_bf16 v[28:31], a[60:63], v[76:79], v[28:31]
    ds_read_b128 v[72:75], v82 offset:9216
    ds_read_b128 v[76:79], v83 offset:9216
    s_waitcnt lgkmcnt(2)
    v_mfma_f32_16x16x32_bf16 v[32:35], a[192:195], v[64:67], v[32:35]
    v_mfma_f32_16x16x32_bf16 v[36:39], a[192:195], v[68:71], v[36:39]
    v_mfma_f32_16x16x32_bf16 v[40:43], a[196:199], v[64:67], v[40:43]
    v_mfma_f32_16x16x32_bf16 v[44:47], a[196:199], v[68:71], v[44:47]
    v_mfma_f32_16x16x32_bf16 v[48:51], v[64:67], v[192:195], v[48:51]
    v_mfma_f32_16x16x32_bf16 v[56:59], v[68:71], v[192:195], v[56:59]
    v_mfma_f32_16x16x32_bf16 v[52:55], v[64:67], v[196:199], v[52:55]
    v_mfma_f32_16x16x32_bf16 v[60:63], v[68:71], v[196:199], v[60:63]
    v_mfma_f32_16x16x32_bf16 v[16:19], a[64:67], v[64:67], v[16:19]
    v_mfma_f32_16x16x32_bf16 v[20:23], a[64:67], v[68:71], v[20:23]
    v_mfma_f32_16x16x32_bf16 v[24:27], a[68:71], v[64:67], v[24:27]
    v_mfma_f32_16x16x32_bf16 v[28:31], a[68:71], v[68:71], v[28:31]
    ds_read_b128 v[64:67], v80 offset:10240
    ds_read_b128 v[68:71], v81 offset:10240
    s_waitcnt lgkmcnt(2)
    v_mfma_f32_16x16x32_bf16 v[32:35], a[200:203], v[72:75], v[32:35]
    v_mfma_f32_16x16x32_bf16 v[36:39], a[200:203], v[76:79], v[36:39]
    v_mfma_f32_16x16x32_bf16 v[40:43], a[204:207], v[72:75], v[40:43]
    v_mfma_f32_16x16x32_bf16 v[44:47], a[204:207], v[76:79], v[44:47]
    v_mfma_f32_16x16x32_bf16 v[48:51], v[72:75], v[200:203], v[48:51]
    v_mfma_f32_16x16x32_bf16 v[56:59], v[76:79], v[200:203], v[56:59]
    v_mfma_f32_16x16x32_bf16 v[52:55], v[72:75], v[204:207], v[52:55]
    v_mfma_f32_16x16x32_bf16 v[60:63], v[76:79], v[204:207], v[60:63]
    v_mfma_f32_16x16x32_bf16 v[16:19], a[72:75], v[72:75], v[16:19]
    v_mfma_f32_16x16x32_bf16 v[20:23], a[72:75], v[76:79], v[20:23]
    v_mfma_f32_16x16x32_bf16 v[24:27], a[76:79], v[72:75], v[24:27]
    v_mfma_f32_16x16x32_bf16 v[28:31], a[76:79], v[76:79], v[28:31]
    ds_read_b128 v[72:75], v82 offset:11264
    ds_read_b128 v[76:79], v83 offset:11264
    s_waitcnt lgkmcnt(2)
    v_mfma_f32_16x16x32_bf16 v[32:35], a[208:211], v[64:67], v[32:35]
    v_mfma_f32_16x16x32_bf16 v[36:39], a[208:211], v[68:71], v[36:39]
    v_mfma_f32_16x16x32_bf16 v[40:43], a[212:215], v[64:67], v[40:43]
    v_mfma_f32_16x16x32_bf16 v[44:47], a[212:215], v[68:71], v[44:47]
    v_mfma_f32_16x16x32_bf16 v[48:51], v[64:67], v[208:211], v[48:51]
    v_mfma_f32_16x16x32_bf16 v[56:59], v[68:71], v[208:211], v[56:59]
    v_mfma_f32_16x16x32_bf16 v[52:55], v[64:67], v[212:215], v[52:55]
    v_mfma_f32_16x16x32_bf16 v[60:63], v[68:71], v[212:215], v[60:63]
    v_mfma_f32_16x16x32_bf16 v[16:19], a[80:83], v[64:67], v[16:19]
    v_mfma_f32_16x16x32_bf16 v[20:23], a[80:83], v[68:71], v[20:23]
    v_mfma_f32_16x16x32_bf16 v[24:27], a[84:87], v[64:67], v[24:27]
    v_mfma_f32_16x16x32_bf16 v[28:31], a[84:87], v[68:71], v[28:31]
    ds_read_b128 v[64:67], v80 offset:12288
    ds_read_b128 v[68:71], v81 offset:12288
    s_waitcnt lgkmcnt(2)
    v_mfma_f32_16x16x32_bf16 v[32:35], a[216:219], v[72:75], v[32:35]
    v_mfma_f32_16x16x32_bf16 v[36:39], a[216:219], v[76:79], v[36:39]
    v_mfma_f32_16x16x32_bf16 v[40:43], a[220:223], v[72:75], v[40:43]
    v_mfma_f32_16x16x32_bf16 v[44:47], a[220:223], v[76:79], v[44:47]
    v_mfma_f32_16x16x32_bf16 v[48:51], v[72:75], v[216:219], v[48:51]
    v_mfma_f32_16x16x32_bf16 v[56:59], v[76:79], v[216:219], v[56:59]
    v_mfma_f32_16x16x32_bf16 v[52:55], v[72:75], v[220:223], v[52:55]
    v_mfma_f32_16x16x32_bf16 v[60:63], v[76:79], v[220:223], v[60:63]
    v_mfma_f32_16x16x32_bf16 v[16:19], a[88:91], v[72:75], v[16:19]
    v_mfma_f32_16x16x32_bf16 v[20:23], a[88:91], v[76:79], v[20:23]
    v_mfma_f32_16x16x32_bf16 v[24:27], a[92:95], v[72:75], v[24:27]
    v_mfma_f32_16x16x32_bf16 v[28:31], a[92:95], v[76:79], v[28:31]
    ds_read_b128 v[72:75], v82 offset:13312
    ds_read_b128 v[76:79], v83 offset:13312
    s_waitcnt lgkmcnt(2)
    v_mfma_f32_16x16x32_bf16 v[32:35], a[224:227], v[64:67], v[32:35]
    v_mfma_f32_16x16x32_bf16 v[36:39], a[224:227], v[68:71], v[36:39]
    v_mfma_f32_16x16x32_bf16 v[40:43], a[228:231], v[64:67], v[40:43]
    v_mfma_f32_16x16x32_bf16 v[44:47], a[228:231], v[68:71], v[44:47]
    v_mfma_f32_16x16x32_bf16 v[48:51], v[64:67], v[224:227], v[48:51]
    v_mfma_f32_16x16x32_bf16 v[56:59], v[68:71], v[224:227], v[56:59]
    v_mfma_f32_16x16x32_bf16 v[52:55], v[64:67], v[228:231], v[52:55]
    v_mfma_f32_16x16x32_bf16 v[60:63], v[68:71], v[228:231], v[60:63]
    v_mfma_f32_16x16x32_bf16 v[16:19], a[96:99], v[64:67], v[16:19]
    v_mfma_f32_16x16x32_bf16 v[20:23], a[96:99], v[68:71], v[20:23]
    v_mfma_f32_16x16x32_bf16 v[24:27], a[100:103], v[64:67], v[24:27]
    v_mfma_f32_16x16x32_bf16 v[28:31], a[100:103], v[68:71], v[28:31]
    ds_read_b128 v[64:67], v80 offset:14336
    ds_read_b128 v[68:71], v81 offset:14336
    s_waitcnt lgkmcnt(2)
    v_mfma_f32_16x16x32_bf16 v[32:35], a[232:235], v[72:75], v[32:35]
    v_mfma_f32_16x16x32_bf16 v[36:39], a[232:235], v[76:79], v[36:39]
    v_mfma_f32_16x16x32_bf16 v[40:43], a[236:239], v[72:75], v[40:43]
    v_mfma_f32_16x16x32_bf16 v[44:47], a[236:239], v[76:79], v[44:47]
    v_mfma_f32_16x16x32_bf16 v[48:51], v[72:75], v[232:235], v[48:51]
    v_mfma_f32_16x16x32_bf16 v[56:59], v[76:79], v[232:235], v[56:59]
    v_mfma_f32_16x16x32_bf16 v[52:55], v[72:75], v[236:239], v[52:55]
    v_mfma_f32_16x16x32_bf16 v[60:63], v[76:79], v[236:239], v[60:63]
    v_mfma_f32_16x16x32_bf16 v[16:19], a[104:107], v[72:75], v[16:19]
    v_mfma_f32_16x16x32_bf16 v[20:23], a[104:107], v[76:79], v[20:23]
    v_mfma_f32_16x16x32_bf16 v[24:27], a[108:111], v[72:75], v[24:27]
    v_mfma_f32_16x16x32_bf16 v[28:31], a[108:111], v[76:79], v[28:31]
    ds_read_b128 v[72:75], v82 offset:15360
    ds_read_b128 v[76:79], v83 offset:15360
    s_waitcnt lgkmcnt(2)
    v_mfma_f32_16x16x32_bf16 v[32:35], a[240:243], v[64:67], v[32:35]
    v_mfma_f32_16x16x32_bf16 v[36:39], a[240:243], v[68:71], v[36:39]
    v_mfma_f32_16x16x32_bf16 v[40:43], a[244:247], v[64:67], v[40:43]
    v_mfma_f32_16x16x32_bf16 v[44:47], a[244:247], v[68:71], v[44:47]
    v_mfma_f32_16x16x32_bf16 v[48:51], v[64:67], v[240:243], v[48:51]
    v_mfma_f32_16x16x32_bf16 v[56:59], v[68:71], v[240:243], v[56:59]
    v_mfma_f32_16x16x32_bf16 v[52:55], v[64:67], v[244:247], v[52:55]
    v_mfma_f32_16x16x32_bf16 v[60:63], v[68:71], v[244:247], v[60:63]
    v_mfma_f32_16x16x32_bf16 v[16:19], a[112:115], v[64:67], v[16:19]
    v_mfma_f32_16x16x32_bf16 v[20:23], a[112:115], v[68:71], v[20:23]
    v_mfma_f32_16x16x32_bf16 v[24:27], a[116:119], v[64:67], v[24:27]
    v_mfma_f32_16x16x32_bf16 v[28:31], a[116:119], v[68:71], v[28:31]
    s_waitcnt lgkmcnt(0)
    v_mfma_f32_16x16x32_bf16 v[32:35], a[248:251], v[72:75], v[32:35]
    v_mfma_f32_16x16x32_bf16 v[36:39], a[248:251], v[76:79], v[36:39]
    v_mfma_f32_16x16x32_bf16 v[40:43], a[252:255], v[72:75], v[40:43]
    v_mfma_f32_16x16x32_bf16 v[44:47], a[252:255], v[76:79], v[44:47]
    v_mfma_f32_16x16x32_bf16 v[48:51], v[72:75], v[248:251], v[48:51]
    v_mfma_f32_16x16x32_bf16 v[56:59], v[76:79], v[248:251], v[56:59]
    v_mfma_f32_16x16x32_bf16 v[52:55], v[72:75], v[252:255], v[52:55]
    v_mfma_f32_16x16x32_bf16 v[60:63], v[76:79], v[252:255], v[60:63]
    v_mfma_f32_16x16x32_bf16 v[16:19], a[120:123], v[72:75], v[16:19]
    v_mfma_f32_16x16x32_bf16 v[20:23], a[120:123], v[76:79], v[20:23]
    v_mfma_f32_16x16x32_bf16 v[24:27], a[124:127], v[72:75], v[24:27]
    v_mfma_f32_16x16x32_bf16 v[28:31], a[124:127], v[76:79], v[28:31]
    v_xor_b32 v80, 0x8000, v80
    v_xor_b32 v81, 0x8000, v81
    v_xor_b32 v82, 0x8000, v82
    v_xor_b32 v83, 0x8000, v83
    v_mul_f32 v32, s33, v32
    v_mul_f32 v33, s33, v33
    v_mul_f32 v34, s33, v34
    v_mul_f32 v35, s33, v35
    v_mul_f32 v36, s33, v36
    v_mul_f32 v37, s33, v37
    v_mul_f32 v38, s33, v38
    v_mul_f32 v39, s33, v39
    v_mul_f32 v40, s33, v40
    v_mul_f32 v41, s33, v41
    v_mul_f32 v42, s33, v42
    v_mul_f32 v43, s33, v43
    v_mul_f32 v44, s33, v44
    v_mul_f32 v45, s33, v45
    v_mul_f32 v46, s33, v46
    v_mul_f32 v47, s33, v47
    v_cvt_pk_bf16_f32 v88, v32, v40
    v_cvt_pk_bf16_f32 v89, v33, v41
    v_cvt_pk_bf16_f32 v90, v34, v42
    v_cvt_pk_bf16_f32 v91, v35, v43
    v_cvt_pk_bf16_f32 v92, v36, v44
    v_cvt_pk_bf16_f32 v93, v37, v45
    v_cvt_pk_bf16_f32 v94, v38, v46
    v_cvt_pk_bf16_f32 v95, v39, v47
    v_cvt_pk_bf16_f32 v96, v48, v49
    v_cvt_pk_bf16_f32 v97, v50, v51
    v_cvt_pk_bf16_f32 v98, v56, v57
    v_cvt_pk_bf16_f32 v99, v58, v59
    v_cvt_pk_bf16_f32 v100, v52, v53
    v_cvt_pk_bf16_f32 v101, v54, v55
    v_cvt_pk_bf16_f32 v102, v60, v61
    v_cvt_pk_bf16_f32 v103, v62, v63
    v_cvt_pk_bf16_f32 v104, v16, v24
    v_cvt_pk_bf16_f32 v105, v17, v25
    v_cvt_pk_bf16_f32 v106, v18, v26
    v_cvt_pk_bf16_f32 v107, v19, v27
    v_cvt_pk_bf16_f32 v108, v20, v28
    v_cvt_pk_bf16_f32 v109, v21, v29
    v_cvt_pk_bf16_f32 v110, v22, v30
    v_cvt_pk_bf16_f32 v111, v23, v31
    s_mul_i32 s24, s23, 0x82100
    s_lshl_b32 s36, s20, 14
    s_add_u32 s24, s24, s36
    s_add_u32 s24, s24, 0x1000000
    s_mov_b32 s30, s24
    s_lshr_b32 s36, s21, 1
    s_lshl_b32 s36, s36, 12
    s_xor_b32 s37, s36, 4096
    s_add_u32 s36, s36, s24
    s_add_u32 s37, s37, s24
    buffer_store_dwordx4 v[88:91], v9, s[8:11], s36 offen sc1
    buffer_store_dwordx4 v[92:95], v9, s[8:11], s37 offen sc1
    s_add_u32 s24, s24, 8192
    buffer_store_dwordx4 v[96:99], v2, s[8:11], s24 offen sc1
    buffer_store_dwordx4 v[100:103], v2, s[8:11], s24 offen offset:1024 sc1
    s_add_u32 s36, s36, 0x7000000
    s_add_u32 s37, s37, 0x7000000
    buffer_store_dwordx4 v[104:107], v9, s[8:11], s36 offen sc1
    buffer_store_dwordx4 v[108:111], v9, s[8:11], s37 offen sc1
    s_mul_i32 s25, s23, 0x82100
    s_lshl_b32 s36, s20, 2
    s_add_u32 s25, s25, s36
    s_add_u32 s25, s25, 0x1082000
    s_add_u32 s23, s23, 6
    s_cmp_lt_u32 s23, 64
    s_cbranch_scc1 L_P1
    v_mov_b32 v20, -1
    v_mov_b32 v21, -1
    v_mov_b32 v22, -1
    v_mov_b32 v23, -1
    s_lshl_b32 s24, s22, 21
    s_lshl_b32 s36, s20, 15
    s_add_u32 s24, s24, s36
    s_add_u32 s36, s24, 0x4000000
    buffer_store_dwordx4 v[20:23], v11, s[8:11], s36 offen sc1
    s_add_u32 s36, s24, 0x4001000
    buffer_store_dwordx4 v[20:23], v11, s[8:11], s36 offen sc1
    s_add_u32 s36, s24, 0x4002000
    buffer_store_dwordx4 v[20:23], v11, s[8:11], s36 offen sc1
    s_add_u32 s36, s24, 0x4003000
    buffer_store_dwordx4 v[20:23], v11, s[8:11], s36 offen sc1
    s_add_u32 s36, s24, 0x4004000
    buffer_store_dwordx4 v[20:23], v11, s[8:11], s36 offen sc1
    s_add_u32 s36, s24, 0x4005000
    buffer_store_dwordx4 v[20:23], v11, s[8:11], s36 offen sc1
    s_add_u32 s36, s24, 0x4006000
    buffer_store_dwordx4 v[20:23], v11, s[8:11], s36 offen sc1
    s_add_u32 s36, s24, 0x4007000
    buffer_store_dwordx4 v[20:23], v11, s[8:11], s36 offen sc1
    s_add_u32 s36, s24, 0x4100000
    buffer_store_dwordx4 v[20:23], v11, s[8:11], s36 offen sc1
    s_add_u32 s36, s24, 0x4101000
    buffer_store_dwordx4 v[20:23], v11, s[8:11], s36 offen sc1
    s_add_u32 s36, s24, 0x4102000
    buffer_store_dwordx4 v[20:23], v11, s[8:11], s36 offen sc1
    s_add_u32 s36, s24, 0x4103000
    buffer_store_dwordx4 v[20:23], v11, s[8:11], s36 offen sc1
    s_add_u32 s36, s24, 0x4104000
    buffer_store_dwordx4 v[20:23], v11, s[8:11], s36 offen sc1
    s_add_u32 s36, s24, 0x4105000
    buffer_store_dwordx4 v[20:23], v11, s[8:11], s36 offen sc1
    s_add_u32 s36, s24, 0x4106000
    buffer_store_dwordx4 v[20:23], v11, s[8:11], s36 offen sc1
    s_add_u32 s36, s24, 0x4107000
    buffer_store_dwordx4 v[20:23], v11, s[8:11], s36 offen sc1
    s_waitcnt vmcnt(0)
    s_barrier
    v_cmp_ne_u32 vcc, 0, v0
    v_mov_b32 v15, 0x40000000
    v_mov_b32 v14, 1
    v_cndmask_b32 v15, v0, v15, vcc
    buffer_store_dword v14, v15, s[8:11], s25 offen sc1
    s_lshl_b32 s25, s22, 7
    s_lshl_b32 s36, s20, 2
    s_add_u32 s36, s36, s25
    s_add_u32 s36, s36, 0x192000
    v_cmp_ne_u32 vcc, 0, v0
    v_mov_b32 v15, 0x40000000
    v_mov_b32 v14, 1
    v_cndmask_b32 v15, v0, v15, vcc
    buffer_store_dword v14, v15, s[8:11], s36 offen sc1
    s_mov_b32 s96, s54
    s_and_b32 s97, s55, 0xffff
    s_mov_b32 s98, 0x400000
    s_mov_b32 s99, 0x20000
    v_mov_b32 v15, 0x0
    v_bfe_u32 v14, v0, 0, 1
    s_mov_b32 s38, 0x10
    v_mad_u32_u24 v15, v14, s38, v15
    v_bfe_u32 v14, v0, 1, 1
    s_mov_b32 s38, 0x20
    v_mad_u32_u24 v15, v14, s38, v15
    v_bfe_u32 v14, v0, 2, 1
    s_mov_b32 s38, 0x40
    v_mad_u32_u24 v15, v14, s38, v15
    v_bfe_u32 v14, v0, 3, 1
    s_mov_b32 s38, 0x80
    v_mad_u32_u24 v15, v14, s38, v15
    v_bfe_u32 v14, v0, 4, 1
    s_mov_b32 s38, 0x1000
    v_mad_u32_u24 v15, v14, s38, v15
    v_bfe_u32 v14, v0, 5, 1
    s_mov_b32 s38, 0x2000
    v_mad_u32_u24 v15, v14, s38, v15
    v_bfe_u32 v14, v0, 6, 1
    s_mov_b32 s38, 0x100
    v_mad_u32_u24 v15, v14, s38, v15
    v_bfe_u32 v14, v0, 7, 1
    s_mov_b32 s38, 0x200
    v_mad_u32_u24 v15, v14, s38, v15
    s_lshl_b32 s36, s20, 17
    s_add_u32 s37, s36, 0x0
    buffer_load_dwordx4 v[16:19], v15, s[96:99], s37 offen
    s_add_u32 s37, s36, 0x4000
    buffer_load_dwordx4 v[20:23], v15, s[96:99], s37 offen
    s_add_u32 s37, s36, 0x400
    buffer_load_dwordx4 v[24:27], v15, s[96:99], s37 offen
    s_add_u32 s37, s36, 0x4400
    buffer_load_dwordx4 v[28:31], v15, s[96:99], s37 offen
    s_add_u32 s37, s36, 0x800
    buffer_load_dwordx4 v[32:35], v15, s[96:99], s37 offen
    s_add_u32 s37, s36, 0x4800
    buffer_load_dwordx4 v[36:39], v15, s[96:99], s37 offen
    s_add_u32 s37, s36, 0xc00
    buffer_load_dwordx4 v[40:43], v15, s[96:99], s37 offen
    s_add_u32 s37, s36, 0x4c00
    buffer_load_dwordx4 v[44:47], v15, s[96:99], s37 offen
    s_add_u32 s37, s36, 0x8000
    buffer_load_dwordx4 v[48:51], v15, s[96:99], s37 offen
    s_add_u32 s37, s36, 0xc000
    buffer_load_dwordx4 v[52:55], v15, s[96:99], s37 offen
    s_add_u32 s37, s36, 0x8400
    buffer_load_dwordx4 v[56:59], v15, s[96:99], s37 offen
    s_add_u32 s37, s36, 0xc400
    buffer_load_dwordx4 v[60:63], v15, s[96:99], s37 offen
    s_add_u32 s37, s36, 0x8800
    buffer_load_dwordx4 v[64:67], v15, s[96:99], s37 offen
    s_add_u32 s37, s36, 0xc800
    buffer_load_dwordx4 v[68:71], v15, s[96:99], s37 offen
    s_add_u32 s37, s36, 0x8c00
    buffer_load_dwordx4 v[72:75], v15, s[96:99], s37 offen
    s_add_u32 s37, s36, 0xcc00
    buffer_load_dwordx4 v[76:79], v15, s[96:99], s37 offen
    s_add_u32 s37, s36, 0x10000
    buffer_load_dwordx4 v[80:83], v15, s[96:99], s37 offen
    s_add_u32 s37, s36, 0x14000
    buffer_load_dwordx4 v[84:87], v15, s[96:99], s37 offen
    s_add_u32 s37, s36, 0x10400
    buffer_load_dwordx4 v[88:91], v15, s[96:99], s37 offen
    s_add_u32 s37, s36, 0x14400
    buffer_load_dwordx4 v[92:95], v15, s[96:99], s37 offen
    s_add_u32 s37, s36, 0x10800
    buffer_load_dwordx4 v[96:99], v15, s[96:99], s37 offen
    s_add_u32 s37, s36, 0x14800
    buffer_load_dwordx4 v[100:103], v15, s[96:99], s37 offen
    s_add_u32 s37, s36, 0x10c00
    buffer_load_dwordx4 v[104:107], v15, s[96:99], s37 offen
    s_add_u32 s37, s36, 0x14c00
    buffer_load_dwordx4 v[108:111], v15, s[96:99], s37 offen
    s_waitcnt vmcnt(16)
    v_perm_b32 v112, v20, v16, s34
    v_perm_b32 v113, v28, v24, s34
    v_perm_b32 v114, v36, v32, s34
    v_perm_b32 v115, v44, v40, s34
    ds_write_b128 v7, v[112:115] offset:0
    v_perm_b32 v116, v20, v16, s35
    v_perm_b32 v117, v28, v24, s35
    v_perm_b32 v118, v36, v32, s35
    v_perm_b32 v119, v44, v40, s35
    ds_write_b128 v7, v[116:119] offset:1024
    v_perm_b32 v120, v21, v17, s34
    v_perm_b32 v121, v29, v25, s34
    v_perm_b32 v122, v37, v33, s34
    v_perm_b32 v123, v45, v41, s34
    ds_write_b128 v7, v[120:123] offset:2048
    v_perm_b32 v124, v21, v17, s35
    v_perm_b32 v125, v29, v25, s35
    v_perm_b32 v126, v37, v33, s35
    v_perm_b32 v127, v45, v41, s35
    ds_write_b128 v7, v[124:127] offset:3072
    s_waitcnt lgkmcnt(0)
    v_perm_b32 v112, v22, v18, s34
    v_perm_b32 v113, v30, v26, s34
    v_perm_b32 v114, v38, v34, s34
    v_perm_b32 v115, v46, v42, s34
    ds_write_b128 v7, v[112:115] offset:4096
    v_perm_b32 v116, v22, v18, s35
    v_perm_b32 v117, v30, v26, s35
    v_perm_b32 v118, v38, v34, s35
    v_perm_b32 v119, v46, v42, s35
    ds_write_b128 v7, v[116:119] offset:5120
    v_perm_b32 v120, v23, v19, s34
    v_perm_b32 v121, v31, v27, s34
    v_perm_b32 v122, v39, v35, s34
    v_perm_b32 v123, v47, v43, s34
    ds_write_b128 v7, v[120:123] offset:6144
    v_perm_b32 v124, v23, v19, s35
    v_perm_b32 v125, v31, v27, s35
    v_perm_b32 v126, v39, v35, s35
    v_perm_b32 v127, v47, v43, s35
    ds_write_b128 v7, v[124:127] offset:7168
    s_waitcnt lgkmcnt(0)
    s_add_u32 s37, s36, 0x18000
    buffer_load_dwordx4 v[16:19], v15, s[96:99], s37 offen
    s_add_u32 s37, s36, 0x1c000
    buffer_load_dwordx4 v[20:23], v15, s[96:99], s37 offen
    s_add_u32 s37, s36, 0x18400
    buffer_load_dwordx4 v[24:27], v15, s[96:99], s37 offen
    s_add_u32 s37, s36, 0x1c400
    buffer_load_dwordx4 v[28:31], v15, s[96:99], s37 offen
    s_add_u32 s37, s36, 0x18800
    buffer_load_dwordx4 v[32:35], v15, s[96:99], s37 offen
    s_add_u32 s37, s36, 0x1c800
    buffer_load_dwordx4 v[36:39], v15, s[96:99], s37 offen
    s_add_u32 s37, s36, 0x18c00
    buffer_load_dwordx4 v[40:43], v15, s[96:99], s37 offen
    s_add_u32 s37, s36, 0x1cc00
    buffer_load_dwordx4 v[44:47], v15, s[96:99], s37 offen
    s_waitcnt vmcnt(16)
    v_perm_b32 v112, v52, v48, s34
    v_perm_b32 v113, v60, v56, s34
    v_perm_b32 v114, v68, v64, s34
    v_perm_b32 v115, v76, v72, s34
    ds_write_b128 v7, v[112:115] offset:8192
    v_perm_b32 v116, v52, v48, s35
    v_perm_b32 v117, v60, v56, s35
    v_perm_b32 v118, v68, v64, s35
    v_perm_b32 v119, v76, v72, s35
    ds_write_b128 v7, v[116:119] offset:9216
    v_perm_b32 v120, v53, v49, s34
    v_perm_b32 v121, v61, v57, s34
    v_perm_b32 v122, v69, v65, s34
    v_perm_b32 v123, v77, v73, s34
    ds_write_b128 v7, v[120:123] offset:10240
    v_perm_b32 v124, v53, v49, s35
    v_perm_b32 v125, v61, v57, s35
    v_perm_b32 v126, v69, v65, s35
    v_perm_b32 v127, v77, v73, s35
    ds_write_b128 v7, v[124:127] offset:11264
    s_waitcnt lgkmcnt(0)
    v_perm_b32 v112, v54, v50, s34
    v_perm_b32 v113, v62, v58, s34
    v_perm_b32 v114, v70, v66, s34
    v_perm_b32 v115, v78, v74, s34
    ds_write_b128 v7, v[112:115] offset:12288
    v_perm_b32 v116, v54, v50, s35
    v_perm_b32 v117, v62, v58, s35
    v_perm_b32 v118, v70, v66, s35
    v_perm_b32 v119, v78, v74, s35
    ds_write_b128 v7, v[116:119] offset:13312
    v_perm_b32 v120, v55, v51, s34
    v_perm_b32 v121, v63, v59, s34
    v_perm_b32 v122, v71, v67, s34
    v_perm_b32 v123, v79, v75, s34
    ds_write_b128 v7, v[120:123] offset:14336
    v_perm_b32 v124, v55, v51, s35
    v_perm_b32 v125, v63, v59, s35
    v_perm_b32 v126, v71, v67, s35
    v_perm_b32 v127, v79, v75, s35
    ds_write_b128 v7, v[124:127] offset:15360
    s_waitcnt lgkmcnt(0)
    s_waitcnt vmcnt(8)
    v_perm_b32 v112, v84, v80, s34
    v_perm_b32 v113, v92, v88, s34
    v_perm_b32 v114, v100, v96, s34
    v_perm_b32 v115, v108, v104, s34
    ds_write_b128 v7, v[112:115] offset:16384
    v_perm_b32 v116, v84, v80, s35
    v_perm_b32 v117, v92, v88, s35
    v_perm_b32 v118, v100, v96, s35
    v_perm_b32 v119, v108, v104, s35
    ds_write_b128 v7, v[116:119] offset:17408
    v_perm_b32 v120, v85, v81, s34
    v_perm_b32 v121, v93, v89, s34
    v_perm_b32 v122, v101, v97, s34
    v_perm_b32 v123, v109, v105, s34
    ds_write_b128 v7, v[120:123] offset:18432
    v_perm_b32 v124, v85, v81, s35
    v_perm_b32 v125, v93, v89, s35
    v_perm_b32 v126, v101, v97, s35
    v_perm_b32 v127, v109, v105, s35
    ds_write_b128 v7, v[124:127] offset:19456
    s_waitcnt lgkmcnt(0)
    v_perm_b32 v112, v86, v82, s34
    v_perm_b32 v113, v94, v90, s34
    v_perm_b32 v114, v102, v98, s34
    v_perm_b32 v115, v110, v106, s34
    ds_write_b128 v7, v[112:115] offset:20480
    v_perm_b32 v116, v86, v82, s35
    v_perm_b32 v117, v94, v90, s35
    v_perm_b32 v118, v102, v98, s35
    v_perm_b32 v119, v110, v106, s35
    ds_write_b128 v7, v[116:119] offset:21504
    v_perm_b32 v120, v87, v83, s34
    v_perm_b32 v121, v95, v91, s34
    v_perm_b32 v122, v103, v99, s34
    v_perm_b32 v123, v111, v107, s34
    ds_write_b128 v7, v[120:123] offset:22528
    v_perm_b32 v124, v87, v83, s35
    v_perm_b32 v125, v95, v91, s35
    v_perm_b32 v126, v103, v99, s35
    v_perm_b32 v127, v111, v107, s35
    ds_write_b128 v7, v[124:127] offset:23552
    s_waitcnt lgkmcnt(0)
    s_waitcnt vmcnt(0)
    v_perm_b32 v112, v20, v16, s34
    v_perm_b32 v113, v28, v24, s34
    v_perm_b32 v114, v36, v32, s34
    v_perm_b32 v115, v44, v40, s34
    ds_write_b128 v7, v[112:115] offset:24576
    v_perm_b32 v116, v20, v16, s35
    v_perm_b32 v117, v28, v24, s35
    v_perm_b32 v118, v36, v32, s35
    v_perm_b32 v119, v44, v40, s35
    ds_write_b128 v7, v[116:119] offset:25600
    v_perm_b32 v120, v21, v17, s34
    v_perm_b32 v121, v29, v25, s34
    v_perm_b32 v122, v37, v33, s34
    v_perm_b32 v123, v45, v41, s34
    ds_write_b128 v7, v[120:123] offset:26624
    v_perm_b32 v124, v21, v17, s35
    v_perm_b32 v125, v29, v25, s35
    v_perm_b32 v126, v37, v33, s35
    v_perm_b32 v127, v45, v41, s35
    ds_write_b128 v7, v[124:127] offset:27648
    s_waitcnt lgkmcnt(0)
    v_perm_b32 v112, v22, v18, s34
    v_perm_b32 v113, v30, v26, s34
    v_perm_b32 v114, v38, v34, s34
    v_perm_b32 v115, v46, v42, s34
    ds_write_b128 v7, v[112:115] offset:28672
    v_perm_b32 v116, v22, v18, s35
    v_perm_b32 v117, v30, v26, s35
    v_perm_b32 v118, v38, v34, s35
    v_perm_b32 v119, v46, v42, s35
    ds_write_b128 v7, v[116:119] offset:29696
    v_perm_b32 v120, v23, v19, s34
    v_perm_b32 v121, v31, v27, s34
    v_perm_b32 v122, v39, v35, s34
    v_perm_b32 v123, v47, v43, s34
    ds_write_b128 v7, v[120:123] offset:30720
    v_perm_b32 v124, v23, v19, s35
    v_perm_b32 v125, v31, v27, s35
    v_perm_b32 v126, v39, v35, s35
    v_perm_b32 v127, v47, v43, s35
    ds_write_b128 v7, v[124:127] offset:31744
    s_waitcnt lgkmcnt(0)
    s_lshl_b32 s25, s22, 7
    s_add_u32 s25, s25, 0x192000
    v_lshrrev_b32 v15, 2, v1
    v_and_b32 v15, 127, v15
L_TPI:
    buffer_load_dword v14, v15, s[8:11], s25 offen sc1
    s_add_u32 s32, s32, 1
    s_cmp_gt_u32 s32, 200000
    s_waitcnt vmcnt(0)
    s_cbranch_scc1 L_TPI_ok
    v_cmp_eq_u32 vcc, 0, v14
    s_cbranch_vccz L_TPI_ok
    s_sleep 8
    s_branch L_TPI
L_TPI_ok:
    s_mov_b32 s23, s22
    s_mov_b32 s29, 0
    s_mov_b32 s30, 0x40000000
    s_mul_i32 s24, s23, 0x82100
    s_lshl_b32 s36, s20, 14
    s_add_u32 s24, s24, s36
    s_add_u32 s24, s24, 0x1000000
    s_add_u32 s36, s24, 0
    s_add_u32 s37, s36, 0x7000000
    buffer_load_dwordx4 a[32:35], v1, s[8:11], s36 offen offset:0 sc1
    buffer_load_dwordx4 a[0:3], v1, s[8:11], s37 offen offset:0 sc1
    buffer_load_dwordx4 a[36:39], v1, s[8:11], s36 offen offset:1024 sc1
    buffer_load_dwordx4 a[4:7], v1, s[8:11], s37 offen offset:1024 sc1
    buffer_load_dwordx4 a[40:43], v1, s[8:11], s36 offen offset:2048 sc1
    buffer_load_dwordx4 a[8:11], v1, s[8:11], s37 offen offset:2048 sc1
    buffer_load_dwordx4 a[44:47], v1, s[8:11], s36 offen offset:3072 sc1
    buffer_load_dwordx4 a[12:15], v1, s[8:11], s37 offen offset:3072 sc1
    s_add_u32 s36, s24, 4096
    s_add_u32 s37, s36, 0x7000000
    buffer_load_dwordx4 a[48:51], v1, s[8:11], s36 offen offset:0 sc1
    buffer_load_dwordx4 a[16:19], v1, s[8:11], s37 offen offset:0 sc1
    buffer_load_dwordx4 a[52:55], v1, s[8:11], s36 offen offset:1024 sc1
    buffer_load_dwordx4 a[20:23], v1, s[8:11], s37 offen offset:1024 sc1
    buffer_load_dwordx4 a[56:59], v1, s[8:11], s36 offen offset:2048 sc1
    buffer_load_dwordx4 a[24:27], v1, s[8:11], s37 offen offset:2048 sc1
    buffer_load_dwordx4 a[60:63], v1, s[8:11], s36 offen offset:3072 sc1
    buffer_load_dwordx4 a[28:31], v1, s[8:11], s37 offen offset:3072 sc1
    s_lshr_b32 s36, s21, 1
    s_lshl_b32 s36, s36, 3
    s_xor_b32 s37, s36, 8
    s_add_u32 s24, s24, 8192
    s_add_u32 s36, s36, s24
    s_add_u32 s37, s37, s24
    buffer_load_dwordx2 a[64:65], v2, s[8:11], s36 offen offset:0 sc1
    buffer_load_dwordx2 a[66:67], v2, s[8:11], s37 offen offset:0 sc1
    buffer_load_dwordx2 a[68:69], v2, s[8:11], s36 offen offset:1024 sc1
    buffer_load_dwordx2 a[70:71], v2, s[8:11], s37 offen offset:1024 sc1
L_P2:
    s_and_b32 s36, s29, 1
    s_lshl_b32 s36, s36, 20
    s_lshl_b32 s26, s22, 21
    s_add_u32 s26, s26, s36
    s_add_u32 s26, s26, 0x4000000
    s_bfe_u32 s27, s29, 0x10001
    s_lshl_b32 s24, s23, 13
    s_add_u32 s24, s24, 0x100000
    s_max_u32 s25, s23, 1
    s_lshl_b32 s25, s25, 13
    s_add_u32 s25, s25, 0xfe000
    buffer_load_dwordx4 v[48:51], v2, s[8:11], s24 offen sc1
    buffer_load_dwordx4 v[52:55], v2, s[8:11], s24 offen offset:1024 sc1
    s_lshl_b32 s36, s23, 5
    s_add_u32 s36, s36, s20
    s_lshl_b32 s36, s36, 10
    buffer_load_dword a72, v12, s[12:15], s36 offen
    buffer_load_dword a73, v12, s[92:95], 0 offen
    s_waitcnt vmcnt(4)
    v_cmp_ne_u32 vcc, 0, v1
    v_mov_b32 v15, 0x40000000
    v_mov_b32 v14, 0
    v_cndmask_b32 v15, v1, v15, vcc
    buffer_store_dword v14, v15, s[8:11], s30 offen sc1
    v_mfma_f32_16x16x32_bf16 v[80:83], a[32:35], a[0:3], 0
    v_mfma_f32_16x16x32_bf16 v[80:83], a[36:39], a[4:7], v[80:83]
    v_mfma_f32_16x16x32_bf16 v[80:83], a[40:43], a[8:11], v[80:83]
    v_mfma_f32_16x16x32_bf16 v[80:83], a[44:47], a[12:15], v[80:83]
    v_mfma_f32_16x16x32_bf16 v[88:91], a[48:51], a[16:19], 0
    v_mfma_f32_16x16x32_bf16 v[88:91], a[52:55], a[20:23], v[88:91]
    v_mfma_f32_16x16x32_bf16 v[88:91], a[56:59], a[24:27], v[88:91]
    v_mfma_f32_16x16x32_bf16 v[88:91], a[60:63], a[28:31], v[88:91]
    v_mfma_f32_16x16x32_bf16 v[84:87], a[32:35], a[16:19], 0
    v_mfma_f32_16x16x32_bf16 v[84:87], a[36:39], a[20:23], v[84:87]
    v_mfma_f32_16x16x32_bf16 v[84:87], a[40:43], a[24:27], v[84:87]
    v_mfma_f32_16x16x32_bf16 v[84:87], a[44:47], a[28:31], v[84:87]
    v_cndmask_b32 v80, v13, v80, s[64:65]
    v_cndmask_b32 v81, v13, v81, s[66:67]
    v_cndmask_b32 v82, v13, v82, s[68:69]
    v_cndmask_b32 v83, v13, v83, s[70:71]
    v_cndmask_b32 v88, v13, v88, s[64:65]
    v_cndmask_b32 v89, v13, v89, s[66:67]
    v_cndmask_b32 v90, v13, v90, s[68:69]
    v_cndmask_b32 v91, v13, v91, s[70:71]
    v_max_f32 v116, v80, v81
    v_max3_f32 v116, v116, v82, v83
    v_max_f32 v117, v84, v85
    v_max3_f32 v117, v117, v86, v87
    v_max3_f32 v117, v117, v88, v89
    v_max3_f32 v117, v117, v90, v91
    v_mov_b32 v14, v116
    s_nop 1
    v_permlane16_swap_b32 v116, v14
    v_max_f32 v116, v116, v14
    v_mov_b32 v14, v117
    s_nop 1
    v_permlane16_swap_b32 v117, v14
    v_max_f32 v117, v117, v14
    v_mov_b32 v14, v116
    s_nop 1
    v_permlane32_swap_b32 v116, v14
    v_max_f32 v116, v116, v14
    v_mov_b32 v14, v117
    s_nop 1
    v_permlane32_swap_b32 v117, v14
    v_max_f32 v117, v117, v14
    v_sub_f32 v80, v80, v116
    v_exp_f32 v80, v80
    v_sub_f32 v81, v81, v116
    v_exp_f32 v81, v81
    v_sub_f32 v82, v82, v116
    v_exp_f32 v82, v82
    v_sub_f32 v83, v83, v116
    v_exp_f32 v83, v83
    v_sub_f32 v84, v84, v117
    v_exp_f32 v84, v84
    v_sub_f32 v85, v85, v117
    v_exp_f32 v85, v85
    v_sub_f32 v86, v86, v117
    v_exp_f32 v86, v86
    v_sub_f32 v87, v87, v117
    v_exp_f32 v87, v87
    v_sub_f32 v88, v88, v117
    v_exp_f32 v88, v88
    v_sub_f32 v89, v89, v117
    v_exp_f32 v89, v89
    v_sub_f32 v90, v90, v117
    v_exp_f32 v90, v90
    v_sub_f32 v91, v91, v117
    v_exp_f32 v91, v91
    v_cvt_pk_bf16_f32 v100, v80, v81
    v_cvt_pk_bf16_f32 v101, v82, v83
    v_mov_b64 v[102:103], 0
    v_cvt_pk_bf16_f32 v104, v84, v85
    v_cvt_pk_bf16_f32 v105, v86, v87
    v_cvt_pk_bf16_f32 v106, v88, v89
    v_cvt_pk_bf16_f32 v107, v90, v91
    v_mov_b64 v[108:109], s[4:5]
    v_mov_b64 v[110:111], s[4:5]
    v_cndmask_b32 v112, 0, v108, s[72:73]
    v_cndmask_b32 v113, 0, v108, s[72:73]
    v_mfma_f32_16x16x32_bf16 v[16:19], v[108:111], v[100:103], 0
    v_mfma_f32_16x16x32_bf16 v[24:27], a[64:67], v[100:103], 0
    v_mfma_f32_16x16x32_bf16 v[28:31], a[68:71], v[100:103], 0
    v_mfma_f32_16x16x32_bf16 v[20:23], v[108:111], v[104:107], 0
    v_mfma_f32_16x16x32_bf16 v[32:35], a[64:67], v[104:107], 0
    v_mfma_f32_16x16x32_bf16 v[36:39], a[68:71], v[104:107], 0
    s_branch L_P2_chk
L_P2_far:
    buffer_load_dword v14, v2, s[8:11], s25 offen sc1
    s_add_u32 s32, s32, 1
    s_cmp_gt_u32 s32, 200000
    s_waitcnt vmcnt(0)
    s_cbranch_scc1 L_P2_poll
    v_cmp_eq_u32 vcc, -1, v14
    s_cbranch_vccz L_P2_near
    s_sleep 12
    s_branch L_P2_far
L_P2_near:
    s_mov_b32 s25, 0x40000000
L_P2_poll:
    buffer_load_dwordx4 v[48:51], v2, s[8:11], s24 offen sc1
    buffer_load_dwordx4 v[52:55], v2, s[8:11], s24 offen offset:1024 sc1
L_P2_chk:
    s_add_u32 s32, s32, 1
    s_waitcnt vmcnt(0)
    ds_write_b128 v2, v[48:51] offset:20480
    ds_write_b128 v2, v[52:55] offset:21504
    v_max3_u32 v14, v48, v49, v50
    v_max3_u32 v15, v51, v52, v53
    v_max3_u32 v14, v14, v54, v55
    v_max_u32 v14, v14, v15
    v_cmp_eq_u32 vcc, -1, v14
    s_cbranch_vccz L_P2_got
    s_cmp_gt_u32 s32, 200000
    s_cbranch_scc1 L_P2_got
    s_cmp_eq_u32 s25, 0x40000000
    s_cbranch_scc1 L_P2_poll
    s_branch L_P2_far
L_P2_got:
    s_waitcnt lgkmcnt(0)
    s_barrier
    ds_read_b128 v[48:51], v8 offset:0
    ds_read_b128 v[52:55], v8 offset:2048
    ds_read_b128 v[56:59], v8 offset:4096
    ds_read_b128 v[60:63], v8 offset:6144
    s_waitcnt lgkmcnt(3)
    v_mfma_f32_16x16x32_bf16 v[80:83], a[128:131], v[48:51], 0
    v_mfma_f32_16x16x32_bf16 v[84:87], a[132:135], v[48:51], 0
    ds_read_b128 v[48:51], v8 offset:512
    s_waitcnt lgkmcnt(3)
    v_mfma_f32_16x16x32_bf16 v[80:83], a[136:139], v[52:55], v[80:83]
    v_mfma_f32_16x16x32_bf16 v[84:87], a[140:143], v[52:55], v[84:87]
    ds_read_b128 v[52:55], v8 offset:2560
    s_waitcnt lgkmcnt(3)
    v_mfma_f32_16x16x32_bf16 v[80:83], a[144:147], v[56:59], v[80:83]
    v_mfma_f32_16x16x32_bf16 v[84:87], a[148:151], v[56:59], v[84:87]
    ds_read_b128 v[56:59], v8 offset:4608
    s_waitcnt lgkmcnt(3)
    v_mfma_f32_16x16x32_bf16 v[80:83], a[152:155], v[60:63], v[80:83]
    v_mfma_f32_16x16x32_bf16 v[84:87], a[156:159], v[60:63], v[84:87]
    ds_read_b128 v[60:63], v8 offset:6656
    s_waitcnt lgkmcnt(3)
    v_mfma_f32_16x16x32_bf16 v[80:83], a[160:163], v[48:51], v[80:83]
    v_mfma_f32_16x16x32_bf16 v[84:87], a[164:167], v[48:51], v[84:87]
    ds_read_b128 v[48:51], v8 offset:1024
    s_waitcnt lgkmcnt(3)
    v_mfma_f32_16x16x32_bf16 v[80:83], a[168:171], v[52:55], v[80:83]
    v_mfma_f32_16x16x32_bf16 v[84:87], a[172:175], v[52:55], v[84:87]
    ds_read_b128 v[52:55], v8 offset:3072
    s_waitcnt lgkmcnt(3)
    v_mfma_f32_16x16x32_bf16 v[80:83], a[176:179], v[56:59], v[80:83]
    v_mfma_f32_16x16x32_bf16 v[84:87], a[180:183], v[56:59], v[84:87]
    ds_read_b128 v[56:59], v8 offset:5120
    s_waitcnt lgkmcnt(3)
    v_mfma_f32_16x16x32_bf16 v[80:83], a[184:187], v[60:63], v[80:83]
    v_mfma_f32_16x16x32_bf16 v[84:87], a[188:191], v[60:63], v[84:87]
    ds_read_b128 v[60:63], v8 offset:7168
    s_waitcnt lgkmcnt(3)
    v_mfma_f32_16x16x32_bf16 v[80:83], a[192:195], v[48:51], v[80:83]
    v_mfma_f32_16x16x32_bf16 v[84:87], a[196:199], v[48:51], v[84:87]
    ds_read_b128 v[48:51], v8 offset:1536
    s_waitcnt lgkmcnt(3)
    v_mfma_f32_16x16x32_bf16 v[80:83], a[200:203], v[52:55], v[80:83]
    v_mfma_f32_16x16x32_bf16 v[84:87], a[204:207], v[52:55], v[84:87]
    ds_read_b128 v[52:55], v8 offset:3584
    s_waitcnt lgkmcnt(3)
    v_mfma_f32_16x16x32_bf16 v[80:83], a[208:211], v[56:59], v[80:83]
    v_mfma_f32_16x16x32_bf16 v[84:87], a[212:215], v[56:59], v[84:87]
    ds_read_b128 v[56:59], v8 offset:5632
    s_waitcnt lgkmcnt(3)
    v_mfma_f32_16x16x32_bf16 v[80:83], a[216:219], v[60:63], v[80:83]
    v_mfma_f32_16x16x32_bf16 v[84:87], a[220:223], v[60:63], v[84:87]
    ds_read_b128 v[60:63], v8 offset:7680
    s_waitcnt lgkmcnt(3)
    v_mfma_f32_16x16x32_bf16 v[80:83], a[224:227], v[48:51], v[80:83]
    v_mfma_f32_16x16x32_bf16 v[84:87], a[228:231], v[48:51], v[84:87]
    ds_read_b128 v[48:51], v8 offset:0
    s_waitcnt lgkmcnt(3)
    v_mfma_f32_16x16x32_bf16 v[80:83], a[232:235], v[52:55], v[80:83]
    v_mfma_f32_16x16x32_bf16 v[84:87], a[236:239], v[52:55], v[84:87]
    ds_read_b128 v[52:55], v8 offset:2048
    s_waitcnt lgkmcnt(3)
    v_mfma_f32_16x16x32_bf16 v[80:83], a[240:243], v[56:59], v[80:83]
    v_mfma_f32_16x16x32_bf16 v[84:87], a[244:247], v[56:59], v[84:87]
    ds_read_b128 v[56:59], v8 offset:4096
    s_waitcnt lgkmcnt(3)
    v_mfma_f32_16x16x32_bf16 v[80:83], a[248:251], v[60:63], v[80:83]
    v_mfma_f32_16x16x32_bf16 v[84:87], a[252:255], v[60:63], v[84:87]
    ds_read_b128 v[60:63], v8 offset:6144
    s_waitcnt lgkmcnt(3)
    v_mfma_f32_16x16x32_bf16 v[40:43], v[48:51], v[128:131], 0
    v_mfma_f32_16x16x32_bf16 v[44:47], v[48:51], v[132:135], 0
    ds_read_b128 v[48:51], v8 offset:512
    s_waitcnt lgkmcnt(3)
    v_mfma_f32_16x16x32_bf16 v[40:43], v[52:55], v[136:139], v[40:43]
    v_mfma_f32_16x16x32_bf16 v[44:47], v[52:55], v[140:143], v[44:47]
    ds_read_b128 v[52:55], v8 offset:2560
    s_waitcnt lgkmcnt(3)
    v_mfma_f32_16x16x32_bf16 v[40:43], v[56:59], v[144:147], v[40:43]
    v_mfma_f32_16x16x32_bf16 v[44:47], v[56:59], v[148:151], v[44:47]
    v_mul_f32 v80, s33, v80
    v_mul_f32 v81, s33, v81
    v_mul_f32 v82, s33, v82
    v_mul_f32 v83, s33, v83
    ds_read_b128 v[56:59], v8 offset:4608
    s_waitcnt lgkmcnt(3)
    v_mfma_f32_16x16x32_bf16 v[40:43], v[60:63], v[152:155], v[40:43]
    v_mfma_f32_16x16x32_bf16 v[44:47], v[60:63], v[156:159], v[44:47]
    v_mul_f32 v84, s33, v84
    v_mul_f32 v85, s33, v85
    v_mul_f32 v86, s33, v86
    v_mul_f32 v87, s33, v87
    ds_read_b128 v[60:63], v8 offset:6656
    s_waitcnt lgkmcnt(3)
    v_mfma_f32_16x16x32_bf16 v[40:43], v[48:51], v[160:163], v[40:43]
    v_mfma_f32_16x16x32_bf16 v[44:47], v[48:51], v[164:167], v[44:47]
    v_cvt_pk_bf16_f32 v88, v80, v84
    v_cvt_pk_bf16_f32 v89, v81, v85
    v_cvt_pk_bf16_f32 v90, v82, v86
    v_cvt_pk_bf16_f32 v91, v83, v87
    ds_write_b128 v9, v[88:91] offset:16384
    ds_read_b128 v[48:51], v8 offset:1024
    s_waitcnt lgkmcnt(4)
    v_mfma_f32_16x16x32_bf16 v[40:43], v[52:55], v[168:171], v[40:43]
    v_mfma_f32_16x16x32_bf16 v[44:47], v[52:55], v[172:175], v[44:47]
    ds_read_b128 v[52:55], v8 offset:3072
    s_waitcnt lgkmcnt(4)
    v_mfma_f32_16x16x32_bf16 v[40:43], v[56:59], v[176:179], v[40:43]
    v_mfma_f32_16x16x32_bf16 v[44:47], v[56:59], v[180:183], v[44:47]
    ds_read_b128 v[56:59], v8 offset:5120
    s_waitcnt lgkmcnt(4)
    v_mfma_f32_16x16x32_bf16 v[40:43], v[60:63], v[184:187], v[40:43]
    v_mfma_f32_16x16x32_bf16 v[44:47], v[60:63], v[188:191], v[44:47]
    s_waitcnt lgkmcnt(3)
    s_barrier
    ds_read_b128 v[64:67], v1 offset:16384
    ds_read_b128 v[68:71], v1 offset:17408
    ds_read_b128 v[72:75], v1 offset:18432
    ds_read_b128 v[76:79], v1 offset:19456
    ds_read_b128 v[60:63], v8 offset:7168
    s_waitcnt lgkmcnt(7)
    v_mfma_f32_16x16x32_bf16 v[40:43], v[48:51], v[192:195], v[40:43]
    v_mfma_f32_16x16x32_bf16 v[44:47], v[48:51], v[196:199], v[44:47]
    ds_read_b128 v[48:51], v8 offset:1536
    s_waitcnt lgkmcnt(7)
    v_mfma_f32_16x16x32_bf16 v[40:43], v[52:55], v[200:203], v[40:43]
    v_mfma_f32_16x16x32_bf16 v[44:47], v[52:55], v[204:207], v[44:47]
    s_waitcnt lgkmcnt(2)
    v_mfma_f32_16x16x32_bf16 v[92:95], v[64:67], a[0:3], 0
    v_mfma_f32_16x16x32_bf16 v[96:99], v[64:67], a[16:19], 0
    v_mfma_f32_16x16x32_bf16 v[92:95], v[68:71], a[4:7], v[92:95]
    v_mfma_f32_16x16x32_bf16 v[96:99], v[68:71], a[20:23], v[96:99]
    v_mfma_f32_16x16x32_bf16 v[92:95], v[72:75], a[8:11], v[92:95]
    v_mfma_f32_16x16x32_bf16 v[96:99], v[72:75], a[24:27], v[96:99]
    v_mfma_f32_16x16x32_bf16 v[92:95], v[76:79], a[12:15], v[92:95]
    v_mfma_f32_16x16x32_bf16 v[96:99], v[76:79], a[28:31], v[96:99]
    ds_read_b128 v[52:55], v8 offset:3584
    s_waitcnt lgkmcnt(3)
    v_mfma_f32_16x16x32_bf16 v[40:43], v[56:59], v[208:211], v[40:43]
    v_mfma_f32_16x16x32_bf16 v[44:47], v[56:59], v[212:215], v[44:47]
    ds_read_b128 v[56:59], v8 offset:5632
    s_waitcnt lgkmcnt(3)
    v_mfma_f32_16x16x32_bf16 v[40:43], v[60:63], v[216:219], v[40:43]
    v_mfma_f32_16x16x32_bf16 v[44:47], v[60:63], v[220:223], v[44:47]
    v_max3_f32 v118, v92, v93, v94
    v_max3_f32 v118, v118, v95, v116
    v_max3_f32 v119, v96, v97, v98
    v_max3_f32 v119, v119, v99, v117
    v_mov_b32 v14, v118
    v_mov_b32 v15, v119
    ds_read_b128 v[60:63], v8 offset:7680
    s_waitcnt lgkmcnt(3)
    v_mfma_f32_16x16x32_bf16 v[40:43], v[48:51], v[224:227], v[40:43]
    v_mfma_f32_16x16x32_bf16 v[44:47], v[48:51], v[228:231], v[44:47]
    v_permlane16_swap_b32 v118, v14
    v_permlane16_swap_b32 v119, v15
    v_max_f32 v118, v118, v14
    v_max_f32 v119, v119, v15
    v_sub_f32 v92, v92, v118
    v_exp_f32 v92, v92
    s_waitcnt lgkmcnt(2)
    v_mfma_f32_16x16x32_bf16 v[40:43], v[52:55], v[232:235], v[40:43]
    v_mfma_f32_16x16x32_bf16 v[44:47], v[52:55], v[236:239], v[44:47]
    v_sub_f32 v93, v93, v118
    v_exp_f32 v93, v93
    v_sub_f32 v94, v94, v118
    v_exp_f32 v94, v94
    v_sub_f32 v95, v95, v118
    v_exp_f32 v95, v95
    s_waitcnt lgkmcnt(1)
    v_mfma_f32_16x16x32_bf16 v[40:43], v[56:59], v[240:243], v[40:43]
    v_mfma_f32_16x16x32_bf16 v[44:47], v[56:59], v[244:247], v[44:47]
    v_sub_f32 v104, v116, v118
    v_exp_f32 v104, v104
    v_cvt_pk_bf16_f32 v100, v92, v93
    v_cvt_pk_bf16_f32 v101, v94, v95
    v_sub_f32 v96, v96, v119
    v_exp_f32 v96, v96
    s_waitcnt lgkmcnt(0)
    v_mfma_f32_16x16x32_bf16 v[40:43], v[60:63], v[248:251], v[40:43]
    v_mfma_f32_16x16x32_bf16 v[44:47], v[60:63], v[252:255], v[44:47]
    v_sub_f32 v97, v97, v119
    v_exp_f32 v97, v97
    v_sub_f32 v98, v98, v119
    v_exp_f32 v98, v98
    v_sub_f32 v99, v99, v119
    v_exp_f32 v99, v99
    v_sub_f32 v105, v117, v119
    v_exp_f32 v105, v105
    v_cvt_pk_bf16_f32 v102, v96, v97
    v_cvt_pk_bf16_f32 v103, v98, v99
    v_mfma_f32_16x16x16_bf16 v[48:51], v[112:113], v[100:101], 0
    s_nop 0
    v_mfma_f32_16x16x16_bf16 v[52:55], v[112:113], v[102:103], 0
    v_cvt_pk_bf16_f32 v80, v40, v41
    v_cndmask_b32 v80, 0, v80, s[72:73]
    v_cvt_pk_bf16_f32 v81, v42, v43
    v_cndmask_b32 v81, 0, v81, s[72:73]
    v_cvt_pk_bf16_f32 v82, v44, v45
    v_cndmask_b32 v82, 0, v82, s[72:73]
    v_cvt_pk_bf16_f32 v83, v46, v47
    v_cndmask_b32 v83, 0, v83, s[72:73]
    v_mfma_f32_16x16x16_bf16 v[56:59], v[80:81], v[100:101], 0
    s_nop 0
    v_mfma_f32_16x16x16_bf16 v[60:63], v[82:83], v[100:101], 0
    v_mfma_f32_16x16x16_bf16 v[64:67], v[80:81], v[102:103], 0
    v_mfma_f32_16x16x16_bf16 v[68:71], v[82:83], v[102:103], 0
    v_fma_f32 v48, v16, v104, v48
    v_rcp_f32 v48, v48
    v_fma_f32 v52, v20, v105, v52
    v_rcp_f32 v52, v52
    v_fma_f32 v56, v24, v104, v56
    v_fma_f32 v57, v25, v104, v57
    v_fma_f32 v58, v26, v104, v58
    v_fma_f32 v59, v27, v104, v59
    v_fma_f32 v60, v28, v104, v60
    v_fma_f32 v61, v29, v104, v61
    v_fma_f32 v62, v30, v104, v62
    v_fma_f32 v63, v31, v104, v63
    v_pk_mul_f32 v[56:57], v[56:57], v[48:49] op_sel_hi:[1,0]
    v_pk_mul_f32 v[58:59], v[58:59], v[48:49] op_sel_hi:[1,0]
    v_pk_mul_f32 v[60:61], v[60:61], v[48:49] op_sel_hi:[1,0]
    v_pk_mul_f32 v[62:63], v[62:63], v[48:49] op_sel_hi:[1,0]
    v_cvt_pk_bf16_f32 v72, v56, v60
    v_cvt_pk_bf16_f32 v73, v57, v61
    v_cvt_pk_bf16_f32 v74, v58, v62
    v_cvt_pk_bf16_f32 v75, v59, v63
    ds_write_b128 v9, v[72:75] offset:0
    v_fma_f32 v64, v32, v105, v64
    v_fma_f32 v65, v33, v105, v65
    v_fma_f32 v66, v34, v105, v66
    v_fma_f32 v67, v35, v105, v67
    v_fma_f32 v68, v36, v105, v68
    v_fma_f32 v69, v37, v105, v69
    v_fma_f32 v70, v38, v105, v70
    v_fma_f32 v71, v39, v105, v71
    v_pk_mul_f32 v[64:65], v[64:65], v[52:53] op_sel_hi:[1,0]
    v_pk_mul_f32 v[66:67], v[66:67], v[52:53] op_sel_hi:[1,0]
    v_pk_mul_f32 v[68:69], v[68:69], v[52:53] op_sel_hi:[1,0]
    v_pk_mul_f32 v[70:71], v[70:71], v[52:53] op_sel_hi:[1,0]
    v_cvt_pk_bf16_f32 v76, v64, v68
    v_cvt_pk_bf16_f32 v77, v65, v69
    v_cvt_pk_bf16_f32 v78, v66, v70
    v_cvt_pk_bf16_f32 v79, v67, v71
    ds_write_b128 v9, v[76:79] offset:4096
    s_waitcnt lgkmcnt(0)
    s_barrier
    ds_read_b128 v[16:19], v1 offset:0
    ds_read_b128 v[20:23], v1 offset:1024
    ds_read_b128 v[24:27], v1 offset:2048
    ds_read_b128 v[28:31], v1 offset:3072
    ds_read_b128 v[32:35], v1 offset:4096
    ds_read_b128 v[36:39], v1 offset:5120
    ds_read_b128 v[40:43], v1 offset:6144
    ds_read_b128 v[44:47], v1 offset:7168
    ds_read_b128 v[48:51], v7 offset:0
    ds_read_b128 v[52:55], v7 offset:1024
    ds_read_b128 v[56:59], v7 offset:2048
    s_lshl_b32 s36, s20, 10
    s_add_u32 s25, s26, s36
    s_waitcnt lgkmcnt(2)
    v_mfma_f32_16x16x32_bf16 v[64:67], v[16:19], v[48:51], 0
    ds_read_b128 v[60:63], v7 offset:3072
    s_waitcnt lgkmcnt(2)
    v_mfma_f32_16x16x32_bf16 v[68:71], v[16:19], v[52:55], 0
    ds_read_b128 v[48:51], v7 offset:4096
    s_waitcnt lgkmcnt(2)
    v_mfma_f32_16x16x32_bf16 v[72:75], v[16:19], v[56:59], 0
    ds_read_b128 v[52:55], v7 offset:5120
    s_waitcnt lgkmcnt(2)
    v_mfma_f32_16x16x32_bf16 v[76:79], v[16:19], v[60:63], 0
    ds_read_b128 v[56:59], v7 offset:6144
    s_waitcnt lgkmcnt(2)
    v_mfma_f32_16x16x32_bf16 v[80:83], v[16:19], v[48:51], 0
    ds_read_b128 v[60:63], v7 offset:7168
    s_waitcnt lgkmcnt(2)
    v_mfma_f32_16x16x32_bf16 v[84:87], v[16:19], v[52:55], 0
    ds_read_b128 v[48:51], v7 offset:8192
    s_waitcnt lgkmcnt(2)
    v_mfma_f32_16x16x32_bf16 v[88:91], v[16:19], v[56:59], 0
    ds_read_b128 v[52:55], v7 offset:9216
    s_waitcnt lgkmcnt(2)
    v_mfma_f32_16x16x32_bf16 v[92:95], v[16:19], v[60:63], 0
    ds_read_b128 v[56:59], v7 offset:10240
    s_waitcnt lgkmcnt(2)
    v_mfma_f32_16x16x32_bf16 v[64:67], v[20:23], v[48:51], v[64:67]
    ds_read_b128 v[60:63], v7 offset:11264
    s_waitcnt lgkmcnt(2)
    v_mfma_f32_16x16x32_bf16 v[68:71], v[20:23], v[52:55], v[68:71]
    ds_read_b128 v[48:51], v7 offset:12288
    s_waitcnt lgkmcnt(2)
    v_mfma_f32_16x16x32_bf16 v[72:75], v[20:23], v[56:59], v[72:75]
    ds_read_b128 v[52:55], v7 offset:13312
    s_waitcnt lgkmcnt(2)
    v_mfma_f32_16x16x32_bf16 v[76:79], v[20:23], v[60:63], v[76:79]
    ds_read_b128 v[56:59], v7 offset:14336
    s_waitcnt lgkmcnt(2)
    v_mfma_f32_16x16x32_bf16 v[80:83], v[20:23], v[48:51], v[80:83]
    ds_read_b128 v[60:63], v7 offset:15360
    s_waitcnt lgkmcnt(2)
    v_mfma_f32_16x16x32_bf16 v[84:87], v[20:23], v[52:55], v[84:87]
    ds_read_b128 v[48:51], v7 offset:16384
    s_waitcnt lgkmcnt(2)
    v_mfma_f32_16x16x32_bf16 v[88:91], v[20:23], v[56:59], v[88:91]
    ds_read_b128 v[52:55], v7 offset:17408
    s_waitcnt lgkmcnt(2)
    v_mfma_f32_16x16x32_bf16 v[92:95], v[20:23], v[60:63], v[92:95]
    ds_read_b128 v[56:59], v7 offset:18432
    s_waitcnt lgkmcnt(2)
    v_mfma_f32_16x16x32_bf16 v[64:67], v[24:27], v[48:51], v[64:67]
    ds_read_b128 v[60:63], v7 offset:19456
    s_waitcnt lgkmcnt(2)
    v_mfma_f32_16x16x32_bf16 v[68:71], v[24:27], v[52:55], v[68:71]
    ds_read_b128 v[48:51], v7 offset:20480
    s_waitcnt lgkmcnt(2)
    v_mfma_f32_16x16x32_bf16 v[72:75], v[24:27], v[56:59], v[72:75]
    ds_read_b128 v[52:55], v7 offset:21504
    s_waitcnt lgkmcnt(2)
    v_mfma_f32_16x16x32_bf16 v[76:79], v[24:27], v[60:63], v[76:79]
    ds_read_b128 v[56:59], v7 offset:22528
    s_waitcnt lgkmcnt(2)
    v_mfma_f32_16x16x32_bf16 v[80:83], v[24:27], v[48:51], v[80:83]
    ds_read_b128 v[60:63], v7 offset:23552
    s_waitcnt lgkmcnt(2)
    v_mfma_f32_16x16x32_bf16 v[84:87], v[24:27], v[52:55], v[84:87]
    ds_read_b128 v[48:51], v7 offset:24576
    s_waitcnt lgkmcnt(2)
    v_mfma_f32_16x16x32_bf16 v[88:91], v[24:27], v[56:59], v[88:91]
    ds_read_b128 v[52:55], v7 offset:25600
    s_waitcnt lgkmcnt(2)
    v_mfma_f32_16x16x32_bf16 v[92:95], v[24:27], v[60:63], v[92:95]
    ds_read_b128 v[56:59], v7 offset:26624
    s_waitcnt lgkmcnt(2)
    v_mfma_f32_16x16x32_bf16 v[64:67], v[28:31], v[48:51], v[64:67]
    ds_read_b128 v[60:63], v7 offset:27648
    s_waitcnt lgkmcnt(2)
    v_mfma_f32_16x16x32_bf16 v[68:71], v[28:31], v[52:55], v[68:71]
    ds_read_b128 v[48:51], v7 offset:28672
    s_waitcnt lgkmcnt(2)
    v_mfma_f32_16x16x32_bf16 v[72:75], v[28:31], v[56:59], v[72:75]
    ds_read_b128 v[52:55], v7 offset:29696
    s_waitcnt lgkmcnt(2)
    v_mfma_f32_16x16x32_bf16 v[76:79], v[28:31], v[60:63], v[76:79]
    ds_read_b128 v[56:59], v7 offset:30720
    s_waitcnt lgkmcnt(2)
    v_mfma_f32_16x16x32_bf16 v[80:83], v[28:31], v[48:51], v[80:83]
    ds_read_b128 v[60:63], v7 offset:31744
    s_waitcnt lgkmcnt(2)
    v_mfma_f32_16x16x32_bf16 v[84:87], v[28:31], v[52:55], v[84:87]
    ds_read_b128 v[48:51], v7 offset:0
    s_waitcnt lgkmcnt(2)
    v_mfma_f32_16x16x32_bf16 v[88:91], v[28:31], v[56:59], v[88:91]
    ds_read_b128 v[52:55], v7 offset:1024
    s_waitcnt lgkmcnt(2)
    v_mfma_f32_16x16x32_bf16 v[92:95], v[28:31], v[60:63], v[92:95]
    ds_read_b128 v[56:59], v7 offset:2048
    s_waitcnt lgkmcnt(2)
    v_mfma_f32_16x16x32_bf16 v[96:99], v[32:35], v[48:51], 0
    ds_read_b128 v[60:63], v7 offset:3072
    s_waitcnt lgkmcnt(2)
    v_mfma_f32_16x16x32_bf16 v[100:103], v[32:35], v[52:55], 0
    ds_read_b128 v[48:51], v7 offset:4096
    s_waitcnt lgkmcnt(2)
    v_mfma_f32_16x16x32_bf16 v[104:107], v[32:35], v[56:59], 0
    ds_read_b128 v[52:55], v7 offset:5120
    s_waitcnt lgkmcnt(2)
    v_mfma_f32_16x16x32_bf16 v[108:111], v[32:35], v[60:63], 0
    ds_read_b128 v[56:59], v7 offset:6144
    v_cvt_pk_bf16_f32 v16, v64, v68
    s_waitcnt lgkmcnt(2)
    v_mfma_f32_16x16x32_bf16 v[112:115], v[32:35], v[48:51], 0
    ds_read_b128 v[60:63], v7 offset:7168
    v_cvt_pk_bf16_f32 v17, v72, v76
    s_waitcnt lgkmcnt(2)
    v_mfma_f32_16x16x32_bf16 v[116:119], v[32:35], v[52:55], 0
    ds_read_b128 v[48:51], v7 offset:8192
    v_cvt_pk_bf16_f32 v18, v80, v84
    s_waitcnt lgkmcnt(2)
    v_mfma_f32_16x16x32_bf16 v[120:123], v[32:35], v[56:59], 0
    ds_read_b128 v[52:55], v7 offset:9216
    v_cvt_pk_bf16_f32 v19, v88, v92
    s_waitcnt lgkmcnt(2)
    v_mfma_f32_16x16x32_bf16 v[124:127], v[32:35], v[60:63], 0
    ds_read_b128 v[56:59], v7 offset:10240
    v_and_or_b32 v16, v16, -2, s27
    s_waitcnt lgkmcnt(2)
    v_mfma_f32_16x16x32_bf16 v[96:99], v[36:39], v[48:51], v[96:99]
    ds_read_b128 v[60:63], v7 offset:11264
    s_add_u32 s36, s25, 0x0
    s_waitcnt lgkmcnt(2)
    v_mfma_f32_16x16x32_bf16 v[100:103], v[36:39], v[52:55], v[100:103]
    ds_read_b128 v[48:51], v7 offset:12288
    buffer_store_dwordx4 v[16:19], v10, s[8:11], s36 offen sc1
    s_waitcnt lgkmcnt(2)
    v_mfma_f32_16x16x32_bf16 v[104:107], v[36:39], v[56:59], v[104:107]
    ds_read_b128 v[52:55], v7 offset:13312
    v_cvt_pk_bf16_f32 v20, v65, v69
    s_waitcnt lgkmcnt(2)
    v_mfma_f32_16x16x32_bf16 v[108:111], v[36:39], v[60:63], v[108:111]
    ds_read_b128 v[56:59], v7 offset:14336
    v_cvt_pk_bf16_f32 v21, v73, v77
    s_waitcnt lgkmcnt(2)
    v_mfma_f32_16x16x32_bf16 v[112:115], v[36:39], v[48:51], v[112:115]
    ds_read_b128 v[60:63], v7 offset:15360
    v_cvt_pk_bf16_f32 v22, v81, v85
    s_waitcnt lgkmcnt(2)
    v_mfma_f32_16x16x32_bf16 v[116:119], v[36:39], v[52:55], v[116:119]
    ds_read_b128 v[48:51], v7 offset:16384
    v_cvt_pk_bf16_f32 v23, v89, v93
    s_waitcnt lgkmcnt(2)
    v_mfma_f32_16x16x32_bf16 v[120:123], v[36:39], v[56:59], v[120:123]
    ds_read_b128 v[52:55], v7 offset:17408
    v_and_or_b32 v20, v20, -2, s27
    s_waitcnt lgkmcnt(2)
    v_mfma_f32_16x16x32_bf16 v[124:127], v[36:39], v[60:63], v[124:127]
    ds_read_b128 v[56:59], v7 offset:18432
    s_add_u32 s36, s25, 0x8000
    s_waitcnt lgkmcnt(2)
    v_mfma_f32_16x16x32_bf16 v[96:99], v[40:43], v[48:51], v[96:99]
    ds_read_b128 v[60:63], v7 offset:19456
    buffer_store_dwordx4 v[20:23], v10, s[8:11], s36 offen sc1
    s_waitcnt lgkmcnt(2)
    v_mfma_f32_16x16x32_bf16 v[100:103], v[40:43], v[52:55], v[100:103]
    ds_read_b128 v[48:51], v7 offset:20480
    v_cvt_pk_bf16_f32 v24, v66, v70
    s_waitcnt lgkmcnt(2)
    v_mfma_f32_16x16x32_bf16 v[104:107], v[40:43], v[56:59], v[104:107]
    ds_read_b128 v[52:55], v7 offset:21504
    v_cvt_pk_bf16_f32 v25, v74, v78
    s_waitcnt lgkmcnt(2)
    v_mfma_f32_16x16x32_bf16 v[108:111], v[40:43], v[60:63], v[108:111]
    ds_read_b128 v[56:59], v7 offset:22528
    v_cvt_pk_bf16_f32 v26, v82, v86
    s_waitcnt lgkmcnt(2)
    v_mfma_f32_16x16x32_bf16 v[112:115], v[40:43], v[48:51], v[112:115]
    ds_read_b128 v[60:63], v7 offset:23552
    v_cvt_pk_bf16_f32 v27, v90, v94
    s_waitcnt lgkmcnt(2)
    v_mfma_f32_16x16x32_bf16 v[116:119], v[40:43], v[52:55], v[116:119]
    ds_read_b128 v[48:51], v7 offset:24576
    v_and_or_b32 v24, v24, -2, s27
    s_waitcnt lgkmcnt(2)
    v_mfma_f32_16x16x32_bf16 v[120:123], v[40:43], v[56:59], v[120:123]
    ds_read_b128 v[52:55], v7 offset:25600
    s_add_u32 s36, s25, 0x10000
    s_waitcnt lgkmcnt(2)
    v_mfma_f32_16x16x32_bf16 v[124:127], v[40:43], v[60:63], v[124:127]
    ds_read_b128 v[56:59], v7 offset:26624
    buffer_store_dwordx4 v[24:27], v10, s[8:11], s36 offen sc1
    s_waitcnt lgkmcnt(2)
    v_mfma_f32_16x16x32_bf16 v[96:99], v[44:47], v[48:51], v[96:99]
    ds_read_b128 v[60:63], v7 offset:27648
    v_cvt_pk_bf16_f32 v28, v67, v71
    s_waitcnt lgkmcnt(2)
    v_mfma_f32_16x16x32_bf16 v[100:103], v[44:47], v[52:55], v[100:103]
    ds_read_b128 v[48:51], v7 offset:28672
    v_cvt_pk_bf16_f32 v29, v75, v79
    s_waitcnt lgkmcnt(2)
    v_mfma_f32_16x16x32_bf16 v[104:107], v[44:47], v[56:59], v[104:107]
    ds_read_b128 v[52:55], v7 offset:29696
    v_cvt_pk_bf16_f32 v30, v83, v87
    s_waitcnt lgkmcnt(2)
    v_mfma_f32_16x16x32_bf16 v[108:111], v[44:47], v[60:63], v[108:111]
    ds_read_b128 v[56:59], v7 offset:30720
    v_cvt_pk_bf16_f32 v31, v91, v95
    s_waitcnt lgkmcnt(2)
    v_mfma_f32_16x16x32_bf16 v[112:115], v[44:47], v[48:51], v[112:115]
    ds_read_b128 v[60:63], v7 offset:31744
    v_and_or_b32 v28, v28, -2, s27
    s_waitcnt lgkmcnt(2)
    v_mfma_f32_16x16x32_bf16 v[116:119], v[44:47], v[52:55], v[116:119]
    s_add_u32 s36, s25, 0x18000
    s_waitcnt lgkmcnt(1)
    v_mfma_f32_16x16x32_bf16 v[120:123], v[44:47], v[56:59], v[120:123]
    buffer_store_dwordx4 v[28:31], v10, s[8:11], s36 offen sc1
    s_waitcnt lgkmcnt(0)
    v_mfma_f32_16x16x32_bf16 v[124:127], v[44:47], v[60:63], v[124:127]
    v_cvt_pk_bf16_f32 v32, v96, v100
    v_cvt_pk_bf16_f32 v33, v104, v108
    v_cvt_pk_bf16_f32 v34, v112, v116
    s_nop 4
    v_cvt_pk_bf16_f32 v35, v120, v124
    v_and_or_b32 v32, v32, -2, s27
    s_add_u32 s36, s25, 0x80000
    buffer_store_dwordx4 v[32:35], v10, s[8:11], s36 offen sc1
    v_cvt_pk_bf16_f32 v36, v97, v101
    v_cvt_pk_bf16_f32 v37, v105, v109
    v_cvt_pk_bf16_f32 v38, v113, v117
    v_cvt_pk_bf16_f32 v39, v121, v125
    v_and_or_b32 v36, v36, -2, s27
    s_add_u32 s36, s25, 0x88000
    buffer_store_dwordx4 v[36:39], v10, s[8:11], s36 offen sc1
    v_cvt_pk_bf16_f32 v40, v98, v102
    v_cvt_pk_bf16_f32 v41, v106, v110
    v_cvt_pk_bf16_f32 v42, v114, v118
    v_cvt_pk_bf16_f32 v43, v122, v126
    v_and_or_b32 v40, v40, -2, s27
    s_add_u32 s36, s25, 0x90000
    buffer_store_dwordx4 v[40:43], v10, s[8:11], s36 offen sc1
    v_cvt_pk_bf16_f32 v44, v99, v103
    v_cvt_pk_bf16_f32 v45, v107, v111
    v_cvt_pk_bf16_f32 v46, v115, v119
    v_cvt_pk_bf16_f32 v47, v123, v127
    v_and_or_b32 v44, v44, -2, s27
    s_add_u32 s36, s25, 0x98000
    buffer_store_dwordx4 v[44:47], v10, s[8:11], s36 offen sc1
    s_add_u32 s38, s23, 6
    s_cmp_ge_u32 s38, 64
    s_cbranch_scc1 L_P2_last
    s_mul_i32 s24, s38, 0x82100
    s_lshl_b32 s36, s20, 14
    s_add_u32 s24, s24, s36
    s_add_u32 s24, s24, 0x1000000
    s_add_u32 s36, s24, 0
    s_add_u32 s37, s36, 0x7000000
    buffer_load_dwordx4 a[32:35], v1, s[8:11], s36 offen offset:0 sc1
    buffer_load_dwordx4 a[0:3], v1, s[8:11], s37 offen offset:0 sc1
    buffer_load_dwordx4 a[36:39], v1, s[8:11], s36 offen offset:1024 sc1
    buffer_load_dwordx4 a[4:7], v1, s[8:11], s37 offen offset:1024 sc1
    buffer_load_dwordx4 a[40:43], v1, s[8:11], s36 offen offset:2048 sc1
    buffer_load_dwordx4 a[8:11], v1, s[8:11], s37 offen offset:2048 sc1
    buffer_load_dwordx4 a[44:47], v1, s[8:11], s36 offen offset:3072 sc1
    buffer_load_dwordx4 a[12:15], v1, s[8:11], s37 offen offset:3072 sc1
    s_add_u32 s36, s24, 4096
    s_add_u32 s37, s36, 0x7000000
    buffer_load_dwordx4 a[48:51], v1, s[8:11], s36 offen offset:0 sc1
    buffer_load_dwordx4 a[16:19], v1, s[8:11], s37 offen offset:0 sc1
    buffer_load_dwordx4 a[52:55], v1, s[8:11], s36 offen offset:1024 sc1
    buffer_load_dwordx4 a[20:23], v1, s[8:11], s37 offen offset:1024 sc1
    buffer_load_dwordx4 a[56:59], v1, s[8:11], s36 offen offset:2048 sc1
    buffer_load_dwordx4 a[24:27], v1, s[8:11], s37 offen offset:2048 sc1
    buffer_load_dwordx4 a[60:63], v1, s[8:11], s36 offen offset:3072 sc1
    buffer_load_dwordx4 a[28:31], v1, s[8:11], s37 offen offset:3072 sc1
    s_lshr_b32 s36, s21, 1
    s_lshl_b32 s36, s36, 3
    s_xor_b32 s37, s36, 8
    s_add_u32 s24, s24, 8192
    s_add_u32 s36, s36, s24
    s_add_u32 s37, s37, s24
    buffer_load_dwordx2 a[64:65], v2, s[8:11], s36 offen offset:0 sc1
    buffer_load_dwordx2 a[66:67], v2, s[8:11], s37 offen offset:0 sc1
    buffer_load_dwordx2 a[68:69], v2, s[8:11], s36 offen offset:1024 sc1
    buffer_load_dwordx2 a[70:71], v2, s[8:11], s37 offen offset:1024 sc1
L_P2_last:
    s_lshl_b32 s24, s23, 5
    s_add_u32 s24, s24, s20
    s_lshl_b32 s24, s24, 10
    v_accvgpr_read_b32 v52, a72
    v_accvgpr_read_b32 v53, a73
    v_and_b32 v15, 15, v0
    v_mov_b32 v48, 0
    v_mov_b32 v14, 0x3f80
    v_cmp_eq_u32 vcc, 0, v15
    s_nop 1
    v_cndmask_b32 v48, v48, v14, vcc
    v_mov_b32 v14, 0x3f800000
    v_cmp_eq_u32 vcc, 1, v15
    s_nop 1
    v_cndmask_b32 v48, v48, v14, vcc
    v_mov_b32 v49, 0
    v_mov_b32 v14, 0x3f80
    v_cmp_eq_u32 vcc, 4, v15
    s_nop 1
    v_cndmask_b32 v49, v49, v14, vcc
    v_mov_b32 v14, 0x3f800000
    v_cmp_eq_u32 vcc, 5, v15
    s_nop 1
    v_cndmask_b32 v49, v49, v14, vcc
    v_mov_b32 v50, 0
    v_mov_b32 v14, 0x3f80
    v_cmp_eq_u32 vcc, 8, v15
    s_nop 1
    v_cndmask_b32 v50, v50, v14, vcc
    v_mov_b32 v14, 0x3f800000
    v_cmp_eq_u32 vcc, 9, v15
    s_nop 1
    v_cndmask_b32 v50, v50, v14, vcc
    v_mov_b32 v51, 0
    v_mov_b32 v14, 0x3f80
    v_cmp_eq_u32 vcc, 12, v15
    s_nop 1
    v_cndmask_b32 v51, v51, v14, vcc
    v_mov_b32 v14, 0x3f800000
    v_cmp_eq_u32 vcc, 13, v15
    s_nop 1
    v_cndmask_b32 v51, v51, v14, vcc
    s_lshl_b32 s25, s20, 15
    s_add_u32 s25, s25, s26
L_P3_poll:
    s_add_u32 s36, s25, 0
    buffer_load_dwordx4 v[80:83], v11, s[8:11], s36 offen sc1
    s_add_u32 s36, s25, 4096
    buffer_load_dwordx4 v[84:87], v11, s[8:11], s36 offen sc1
    s_add_u32 s36, s25, 8192
    buffer_load_dwordx4 v[88:91], v11, s[8:11], s36 offen sc1
    s_add_u32 s36, s25, 12288
    buffer_load_dwordx4 v[92:95], v11, s[8:11], s36 offen sc1
    s_add_u32 s36, s25, 16384
    buffer_load_dwordx4 v[96:99], v11, s[8:11], s36 offen sc1
    s_add_u32 s36, s25, 20480
    buffer_load_dwordx4 v[100:103], v11, s[8:11], s36 offen sc1
    s_add_u32 s36, s25, 24576
    buffer_load_dwordx4 v[104:107], v11, s[8:11], s36 offen sc1
    s_add_u32 s36, s25, 28672
    buffer_load_dwordx4 v[108:111], v11, s[8:11], s36 offen sc1
    s_mov_b64 exec, -1
    s_add_u32 s32, s32, 1
    s_cmp_gt_u32 s32, 200000
    s_waitcnt vmcnt(7)
    v_mfma_f32_16x16x32_bf16 v[56:59], v[48:51], v[80:83], 0
    s_waitcnt vmcnt(6)
    v_mfma_f32_16x16x32_bf16 v[56:59], v[48:51], v[84:87], v[56:59]
    v_bitop3_b32 v60, v80, v84, s27 bitop3:0x7e
    s_waitcnt vmcnt(5)
    v_mfma_f32_16x16x32_bf16 v[56:59], v[48:51], v[88:91], v[56:59]
    s_waitcnt vmcnt(4)
    v_mfma_f32_16x16x32_bf16 v[56:59], v[48:51], v[92:95], v[56:59]
    v_bitop3_b32 v61, v88, v92, s27 bitop3:0x7e
    s_waitcnt vmcnt(3)
    v_mfma_f32_16x16x32_bf16 v[56:59], v[48:51], v[96:99], v[56:59]
    s_waitcnt vmcnt(2)
    v_mfma_f32_16x16x32_bf16 v[56:59], v[48:51], v[100:103], v[56:59]
    v_bitop3_b32 v62, v96, v100, s27 bitop3:0x7e
    s_waitcnt vmcnt(1)
    v_mfma_f32_16x16x32_bf16 v[56:59], v[48:51], v[104:107], v[56:59]
    s_waitcnt vmcnt(0)
    v_mfma_f32_16x16x32_bf16 v[56:59], v[48:51], v[108:111], v[56:59]
    v_bitop3_b32 v63, v104, v108, s27 bitop3:0x7e
    v_or3_b32 v14, v60, v61, v62
    v_bitop3_b32 v14, v14, v63, 1 bitop3:0xa8
    s_cbranch_scc1 L_P3_got
    v_cmp_ne_u32 vcc, 0, v14
    s_cbranch_vccz L_P3_got
    s_mov_b64 exec, vcc
    s_branch L_P3_poll
L_P3_got:
    s_nop 4
    v_cvt_pk_bf16_f32 v62, v56, v57
    v_lshlrev_b32 v65, 16, v62
    v_and_b32 v66, 0xffff0000, v62
    v_lshlrev_b32 v60, 16, v52
    v_and_b32 v61, 0xffff0000, v52
    v_add_f32 v60, v60, v65
    v_add_f32 v61, v61, v66
    v_cvt_pk_bf16_f32 v62, v60, v61
    v_lshlrev_b32 v60, 16, v62
    v_and_b32 v61, 0xffff0000, v62
    v_add_f32 v63, v60, v61
    v_mul_f32 v64, v60, v60
    v_fmac_f32 v64, v61, v61
    v_add_f32_dpp v63, v63, v63 quad_perm:[1,0,3,2] row_mask:0xf bank_mask:0xf
    s_nop 0
    v_add_f32_dpp v64, v64, v64 quad_perm:[1,0,3,2] row_mask:0xf bank_mask:0xf
    v_add_f32_dpp v63, v63, v63 quad_perm:[2,3,0,1] row_mask:0xf bank_mask:0xf
    s_nop 0
    v_add_f32_dpp v64, v64, v64 quad_perm:[2,3,0,1] row_mask:0xf bank_mask:0xf
    v_add_f32_dpp v63, v63, v63 row_half_mirror row_mask:0xf bank_mask:0xf
    s_nop 0
    v_add_f32_dpp v64, v64, v64 row_half_mirror row_mask:0xf bank_mask:0xf
    v_add_f32_dpp v63, v63, v63 row_mirror row_mask:0xf bank_mask:0xf
    s_nop 0
    v_add_f32_dpp v64, v64, v64 row_mirror row_mask:0xf bank_mask:0xf
    v_mov_b32 v14, v63
    s_nop 1
    v_permlane16_swap_b32 v63, v14
    v_add_f32 v63, v63, v14
    v_mov_b32 v14, v64
    s_nop 1
    v_permlane16_swap_b32 v64, v14
    v_add_f32 v64, v64, v14
    v_mov_b32 v14, v63
    s_nop 1
    v_permlane32_swap_b32 v63, v14
    v_add_f32 v63, v63, v14
    v_mov_b32 v14, v64
    s_nop 1
    v_permlane32_swap_b32 v64, v14
    v_add_f32 v64, v64, v14
    v_mov_b32 v15, s21
    v_lshlrev_b32 v15, 3, v15
    v_add_u32 v15, 28672, v15
    ds_write2_b32 v15, v63, v64 offset0:0 offset1:1
    s_add_u32 s36, s24, 0x400000
    buffer_store_dword v62, v12, s[8:11], s36 offen sc1
    s_waitcnt lgkmcnt(0)
    s_barrier
    v_mov_b32 v15, 28672
    ds_read_b128 v[68:71], v15
    ds_read_b128 v[72:75], v15 offset:16
    s_waitcnt lgkmcnt(0)
    v_add_f32 v63, v68, v70
    v_add_f32 v63, v63, v72
    v_add_f32 v63, v63, v74
    v_mul_f32 v63, 0x3b000000, v63
    v_add_f32 v64, v69, v71
    v_add_f32 v64, v64, v73
    v_add_f32 v64, v64, v75
    v_mul_f32 v64, 0x3b000000, v64
    v_fma_f32 v64, -v63, v63, v64
    v_max_f32 v64, 0, v64
    v_cvt_pk_bf16_f32 v14, v63, v64
    v_lshlrev_b32 v63, 16, v14
    v_and_b32 v64, 0xffff0000, v14
    v_add_f32 v64, 0x3727c5ac, v64
    v_cvt_pk_bf16_f32 v14, v64, v64
    v_lshlrev_b32 v64, 16, v14
    v_sqrt_f32 v64, v64
    s_nop 0
    v_cvt_pk_bf16_f32 v14, v64, v64
    v_lshlrev_b32 v64, 16, v14
    v_rcp_f32 v64, v64
    v_sub_f32 v65, v60, v63
    v_sub_f32 v66, v61, v63
    v_cvt_pk_bf16_f32 v14, v65, v66
    v_lshlrev_b32 v65, 16, v14
    v_and_b32 v66, 0xffff0000, v14
    v_mul_f32 v65, v65, v64
    v_mul_f32 v66, v66, v64
    v_cvt_pk_bf16_f32 v67, v65, v66
    v_lshlrev_b32 v65, 16, v67
    v_and_b32 v66, 0xffff0000, v67
    v_lshlrev_b32 v68, 16, v53
    v_and_b32 v69, 0xffff0000, v53
    v_mul_f32 v63, v65, v68
    v_fmac_f32 v63, v66, v69
    s_nop 1
    v_add_f32_dpp v63, v63, v63 quad_perm:[1,0,3,2] row_mask:0xf bank_mask:0xf
    s_nop 1
    v_add_f32_dpp v63, v63, v63 quad_perm:[2,3,0,1] row_mask:0xf bank_mask:0xf
    s_nop 1
    v_add_f32_dpp v63, v63, v63 row_half_mirror row_mask:0xf bank_mask:0xf
    s_nop 1
    v_add_f32_dpp v63, v63, v63 row_mirror row_mask:0xf bank_mask:0xf
    v_mov_b32 v14, v63
    s_nop 1
    v_permlane16_swap_b32 v63, v14
    v_add_f32 v63, v63, v14
    v_mov_b32 v14, v63
    s_nop 1
    v_permlane32_swap_b32 v63, v14
    v_add_f32 v63, v63, v14
    s_lshr_b32 s25, s24, 6
    s_lshl_b32 s37, s21, 2
    s_add_u32 s25, s25, s37
    s_add_u32 s36, s25, 0x194000
    v_cmp_ne_u32 vcc, 0, v1
    v_mov_b32 v15, 0x40000000
    s_nop 0
    v_cndmask_b32 v15, v1, v15, vcc
    buffer_store_dword v63, v15, s[8:11], s36 offen sc1
    v_add_f32 v60, v60, v65
    v_add_f32 v61, v61, v66
    v_cvt_pk_bf16_f32 v62, v60, v61
    buffer_store_dword v62, v12, s[60:63], s24 offen sc1
    s_add_u32 s36, s24, 0x600000
    buffer_store_dword v67, v12, s[8:11], s36 offen sc1
    s_add_u32 s30, s25, 0x1b8000
    s_add_u32 s29, s29, 1
    s_barrier
    s_add_u32 s23, s23, 6
    s_cmp_lt_u32 s23, 64
    s_cbranch_scc1 L_P2
    s_waitcnt vmcnt(0)
    v_cmp_ne_u32 vcc, 0, v1
    v_mov_b32 v15, 0x40000000
    v_mov_b32 v14, 0
    v_cndmask_b32 v15, v1, v15, vcc
    buffer_store_dword v14, v15, s[8:11], s30 offen sc1
    s_branch L_end
L_mlp:
    s_mov_b32 s12, s44
    s_and_b32 s13, s45, 0xffff
    s_mov_b32 s14, 0x200000
    s_mov_b32 s15, 0x20000
    s_mov_b32 s60, s82
    s_and_b32 s61, s83, 0xffff
    s_mov_b32 s62, 0x200000
    s_mov_b32 s63, 0x20000
    s_mov_b32 s92, s80
    s_and_b32 s93, s81, 0xffff
    s_mov_b32 s94, 0x400
    s_mov_b32 s95, 0x20000
    v_mov_b32 v1, 0x0
    v_bfe_u32 v14, v0, 0, 1
    s_mov_b32 s38, 0x10
    v_mad_u32_u24 v1, v14, s38, v1
    v_bfe_u32 v14, v0, 1, 1
    s_mov_b32 s38, 0x20
    v_mad_u32_u24 v1, v14, s38, v1
    v_bfe_u32 v14, v0, 2, 1
    s_mov_b32 s38, 0x40
    v_mad_u32_u24 v1, v14, s38, v1
    v_bfe_u32 v14, v0, 3, 1
    s_mov_b32 s38, 0x80
    v_mad_u32_u24 v1, v14, s38, v1
    v_bfe_u32 v14, v0, 4, 1
    s_mov_b32 s38, 0x100
    v_mad_u32_u24 v1, v14, s38, v1
    v_bfe_u32 v14, v0, 5, 1
    s_mov_b32 s38, 0x200
    v_mad_u32_u24 v1, v14, s38, v1
    v_mov_b32 v2, 0x0
    v_bfe_u32 v14, v0, 0, 1
    s_mov_b32 s38, 0x10
    v_mad_u32_u24 v2, v14, s38, v2
    v_bfe_u32 v14, v0, 1, 1
    s_mov_b32 s38, 0x20
    v_mad_u32_u24 v2, v14, s38, v2
    v_bfe_u32 v14, v0, 2, 1
    s_mov_b32 s38, 0x40
    v_mad_u32_u24 v2, v14, s38, v2
    v_bfe_u32 v14, v0, 3, 1
    s_mov_b32 s38, 0x80
    v_mad_u32_u24 v2, v14, s38, v2
    v_bfe_u32 v14, v0, 4, 1
    s_mov_b32 s38, 0x100
    v_mad_u32_u24 v2, v14, s38, v2
    v_bfe_u32 v14, v0, 5, 1
    s_mov_b32 s38, 0x200
    v_mad_u32_u24 v2, v14, s38, v2
    v_bfe_u32 v14, v0, 6, 1
    s_mov_b32 s38, 0x800
    v_mad_u32_u24 v2, v14, s38, v2
    v_bfe_u32 v14, v0, 7, 1
    s_mov_b32 s38, 0x1000
    v_mad_u32_u24 v2, v14, s38, v2
    v_mov_b32 v9, 0x0
    v_bfe_u32 v14, v0, 0, 1
    s_mov_b32 s38, 0x10
    v_mad_u32_u24 v9, v14, s38, v9
    v_bfe_u32 v14, v0, 1, 1
    s_mov_b32 s38, 0x20
    v_mad_u32_u24 v9, v14, s38, v9
    v_bfe_u32 v14, v0, 2, 1
    s_mov_b32 s38, 0x40
    v_mad_u32_u24 v9, v14, s38, v9
    v_bfe_u32 v14, v0, 3, 1
    s_mov_b32 s38, 0x80
    v_mad_u32_u24 v9, v14, s38, v9
    v_bfe_u32 v14, v0, 4, 1
    s_mov_b32 s38, 0x100
    v_mad_u32_u24 v9, v14, s38, v9
    v_bfe_u32 v14, v0, 5, 1
    s_mov_b32 s38, 0x200
    v_mad_u32_u24 v9, v14, s38, v9
    v_bfe_u32 v14, v0, 6, 1
    s_mov_b32 s38, 0x400
    v_mad_u32_u24 v9, v14, s38, v9
    v_bfe_u32 v14, v0, 7, 1
    s_mov_b32 s38, 0x800
    v_mad_u32_u24 v9, v14, s38, v9
    v_mov_b32 v7, 0x8000
    v_bfe_u32 v14, v0, 0, 1
    s_mov_b32 s38, 0x10
    v_mad_u32_u24 v7, v14, s38, v7
    v_bfe_u32 v14, v0, 1, 1
    s_mov_b32 s38, 0x20
    v_mad_u32_u24 v7, v14, s38, v7
    v_bfe_u32 v14, v0, 2, 1
    s_mov_b32 s38, 0x40
    v_mad_u32_u24 v7, v14, s38, v7
    v_bfe_u32 v14, v0, 3, 1
    s_mov_b32 s38, 0x80
    v_mad_u32_u24 v7, v14, s38, v7
    v_bfe_u32 v14, v0, 4, 1
    s_mov_b32 s38, 0x100
    v_mad_u32_u24 v7, v14, s38, v7
    v_bfe_u32 v14, v0, 5, 1
    s_mov_b32 s38, 0x200
    v_mad_u32_u24 v7, v14, s38, v7
    v_bfe_u32 v14, v0, 6, 1
    s_mov_b32 s38, 0x8000
    v_mad_u32_u24 v7, v14, s38, v7
    v_bfe_u32 v14, v0, 7, 1
    s_mov_b32 s38, 0x10000
    v_mad_u32_u24 v7, v14, s38, v7
    v_mov_b32 v3, 0x0
    v_bfe_u32 v14, v0, 0, 1
    s_mov_b32 s38, 0x10
    v_mad_u32_u24 v3, v14, s38, v3
    v_bfe_u32 v14, v0, 1, 1
    s_mov_b32 s38, 0x20
    v_mad_u32_u24 v3, v14, s38, v3
    v_bfe_u32 v14, v0, 2, 1
    s_mov_b32 s38, 0x40
    v_mad_u32_u24 v3, v14, s38, v3
    v_bfe_u32 v14, v0, 3, 1
    s_mov_b32 s38, 0x400
    v_mad_u32_u24 v3, v14, s38, v3
    v_bfe_u32 v14, v0, 4, 1
    s_mov_b32 s38, 0x800
    v_mad_u32_u24 v3, v14, s38, v3
    v_bfe_u32 v14, v0, 5, 1
    s_mov_b32 s38, 0x1000
    v_mad_u32_u24 v3, v14, s38, v3
    v_bfe_u32 v14, v0, 6, 1
    s_mov_b32 s38, 0x2000
    v_mad_u32_u24 v3, v14, s38, v3
    v_bfe_u32 v14, v0, 7, 1
    s_mov_b32 s38, 0x4000
    v_mad_u32_u24 v3, v14, s38, v3
    v_mov_b32 v4, 0x0
    v_bfe_u32 v14, v0, 0, 1
    s_mov_b32 s38, 0x100
    v_mad_u32_u24 v4, v14, s38, v4
    v_bfe_u32 v14, v0, 1, 1
    s_mov_b32 s38, 0x200
    v_mad_u32_u24 v4, v14, s38, v4
    v_bfe_u32 v14, v0, 2, 1
    s_mov_b32 s38, 0x400
    v_mad_u32_u24 v4, v14, s38, v4
    v_bfe_u32 v14, v0, 6, 1
    s_mov_b32 s38, 0x80
    v_mad_u32_u24 v4, v14, s38, v4
    v_bfe_u32 v14, v0, 7, 1
    s_mov_b32 s38, 0x4000
    v_mad_u32_u24 v4, v14, s38, v4
    v_lshrrev_b32 v15, 3, v0
    v_xor_b32 v15, v15, v0
    v_and_b32 v15, 7, v15
    v_lshl_add_u32 v4, v15, 4, v4
    v_bfe_u32 v15, v0, 4, 2
    v_lshlrev_b32 v15, 4, v15
    v_xor_b32 v5, v15, v1
    v_xor_b32 v6, 64, v5
    v_mov_b32 v8, 0x5000
    v_bfe_u32 v14, v0, 0, 1
    s_mov_b32 s38, 0x10
    v_mad_u32_u24 v8, v14, s38, v8
    v_bfe_u32 v14, v0, 1, 1
    s_mov_b32 s38, 0x40
    v_mad_u32_u24 v8, v14, s38, v8
    v_bfe_u32 v14, v0, 2, 1
    s_mov_b32 s38, 0x80
    v_mad_u32_u24 v8, v14, s38, v8
    v_bfe_u32 v14, v0, 4, 1
    s_mov_b32 s38, 0x20
    v_mad_u32_u24 v8, v14, s38, v8
    v_bfe_u32 v14, v0, 5, 1
    s_mov_b32 s38, 0x100
    v_mad_u32_u24 v8, v14, s38, v8
    v_mov_b32 v10, 0x0
    v_bfe_u32 v14, v0, 0, 1
    s_mov_b32 s38, 0x10
    v_mad_u32_u24 v10, v14, s38, v10
    v_bfe_u32 v14, v0, 1, 1
    s_mov_b32 s38, 0x20
    v_mad_u32_u24 v10, v14, s38, v10
    v_bfe_u32 v14, v0, 2, 1
    s_mov_b32 s38, 0x40
    v_mad_u32_u24 v10, v14, s38, v10
    v_bfe_u32 v14, v0, 3, 1
    s_mov_b32 s38, 0x80
    v_mad_u32_u24 v10, v14, s38, v10
    v_bfe_u32 v14, v0, 4, 1
    s_mov_b32 s38, 0x20000
    v_mad_u32_u24 v10, v14, s38, v10
    v_bfe_u32 v14, v0, 5, 1
    s_mov_b32 s38, 0x40000
    v_mad_u32_u24 v10, v14, s38, v10
    v_bfe_u32 v14, v0, 6, 1
    s_mov_b32 s38, 0x100
    v_mad_u32_u24 v10, v14, s38, v10
    v_bfe_u32 v14, v0, 7, 1
    s_mov_b32 s38, 0x200
    v_mad_u32_u24 v10, v14, s38, v10
    v_mov_b32 v11, 0x0
    v_bfe_u32 v14, v0, 0, 1
    s_mov_b32 s38, 0x10
    v_mad_u32_u24 v11, v14, s38, v11
    v_bfe_u32 v14, v0, 1, 1
    s_mov_b32 s38, 0x20
    v_mad_u32_u24 v11, v14, s38, v11
    v_bfe_u32 v14, v0, 2, 1
    s_mov_b32 s38, 0x40
    v_mad_u32_u24 v11, v14, s38, v11
    v_bfe_u32 v14, v0, 3, 1
    s_mov_b32 s38, 0x80
    v_mad_u32_u24 v11, v14, s38, v11
    v_bfe_u32 v14, v0, 4, 1
    s_mov_b32 s38, 0x400
    v_mad_u32_u24 v11, v14, s38, v11
    v_bfe_u32 v14, v0, 5, 1
    s_mov_b32 s38, 0x800
    v_mad_u32_u24 v11, v14, s38, v11
    v_bfe_u32 v14, v0, 6, 1
    s_mov_b32 s38, 0x100
    v_mad_u32_u24 v11, v14, s38, v11
    v_bfe_u32 v14, v0, 7, 1
    s_mov_b32 s38, 0x200
    v_mad_u32_u24 v11, v14, s38, v11
    v_mov_b32 v12, 0x0
    v_bfe_u32 v14, v0, 0, 1
    s_mov_b32 s38, 0x10
    v_mad_u32_u24 v12, v14, s38, v12
    v_bfe_u32 v14, v0, 1, 1
    s_mov_b32 s38, 0x20
    v_mad_u32_u24 v12, v14, s38, v12
    v_bfe_u32 v14, v0, 2, 1
    s_mov_b32 s38, 0x40
    v_mad_u32_u24 v12, v14, s38, v12
    v_bfe_u32 v14, v0, 3, 1
    s_mov_b32 s38, 0x80
    v_mad_u32_u24 v12, v14, s38, v12
    v_bfe_u32 v14, v0, 4, 1
    s_mov_b32 s38, 0x4
    v_mad_u32_u24 v12, v14, s38, v12
    v_bfe_u32 v14, v0, 5, 1
    s_mov_b32 s38, 0x8
    v_mad_u32_u24 v12, v14, s38, v12
    v_bfe_u32 v14, v0, 6, 1
    s_mov_b32 s38, 0x100
    v_mad_u32_u24 v12, v14, s38, v12
    v_bfe_u32 v14, v0, 7, 1
    s_mov_b32 s38, 0x200
    v_mad_u32_u24 v12, v14, s38, v12
    v_mov_b32 v13, 0xf149f2ca
    v_and_b32 v14, 15, v0
    v_bfe_u32 v15, v0, 4, 2
    v_cmp_gt_u32 s[72:73], 2, v15
    v_lshlrev_b32 v15, 2, v15
    v_cmp_le_u32 s[64:65], v15, v14
    v_add_u32 v15, 1, v15
    v_cmp_le_u32 s[66:67], v15, v14
    v_add_u32 v15, 1, v15
    v_cmp_le_u32 s[68:69], v15, v14
    v_add_u32 v15, 1, v15
    v_cmp_le_u32 s[70:71], v15, v14
    v_add_u32 v15, 1, v15
    s_mov_b32 s34, 0x05040100
    s_mov_b32 s35, 0x07060302
    s_mov_b32 s33, 0x3e0293ee
    s_mov_b32 s32, 0
    s_mov_b32 s4, 0x3f803f80
    s_mov_b32 s5, 0x3f803f80
    s_lshr_b32 s20, s2, 3
    s_lshr_b32 s23, s2, 3
    s_lshl_b32 s23, s23, 1
    s_lshl_b32 s36, s23, 15
    buffer_load_dwordx4 v[96:99], v3, s[12:15], s36 offen offset:0
    buffer_load_dwordx4 v[100:103], v3, s[12:15], s36 offen offset:128
    buffer_load_dwordx4 v[104:107], v3, s[12:15], s36 offen offset:256
    buffer_load_dwordx4 v[108:111], v3, s[12:15], s36 offen offset:384
    buffer_load_dwordx4 v[112:115], v3, s[12:15], s36 offen offset:512
    buffer_load_dwordx4 v[116:119], v3, s[12:15], s36 offen offset:640
    buffer_load_dwordx4 v[120:123], v3, s[12:15], s36 offen offset:768
    buffer_load_dwordx4 v[124:127], v3, s[12:15], s36 offen offset:896
    s_add_u32 s36, s36, 0x8000
    buffer_load_dwordx4 v[128:131], v3, s[12:15], s36 offen offset:0
    buffer_load_dwordx4 v[132:135], v3, s[12:15], s36 offen offset:128
    buffer_load_dwordx4 v[136:139], v3, s[12:15], s36 offen offset:256
    buffer_load_dwordx4 v[140:143], v3, s[12:15], s36 offen offset:384
    buffer_load_dwordx4 v[144:147], v3, s[12:15], s36 offen offset:512
    buffer_load_dwordx4 v[148:151], v3, s[12:15], s36 offen offset:640
    buffer_load_dwordx4 v[152:155], v3, s[12:15], s36 offen offset:768
    buffer_load_dwordx4 v[156:159], v3, s[12:15], s36 offen offset:896
    s_mov_b32 s96, s46
    s_and_b32 s97, s47, 0xffff
    s_mov_b32 s98, 0x2000
    s_mov_b32 s99, 0x20000
    v_mov_b32 v68, 0x0
    v_bfe_u32 v14, v0, 0, 1
    s_mov_b32 s38, 0x8
    v_mad_u32_u24 v68, v14, s38, v68
    v_bfe_u32 v14, v0, 1, 1
    s_mov_b32 s38, 0x10
    v_mad_u32_u24 v68, v14, s38, v68
    v_bfe_u32 v14, v0, 2, 1
    s_mov_b32 s38, 0x10000
    v_mad_u32_u24 v68, v14, s38, v68
    v_bfe_u32 v14, v0, 3, 1
    s_mov_b32 s38, 0x10000
    v_mad_u32_u24 v68, v14, s38, v68
    v_bfe_u32 v14, v0, 4, 1
    s_mov_b32 s38, 0x400
    v_mad_u32_u24 v68, v14, s38, v68
    v_bfe_u32 v14, v0, 5, 1
    s_mov_b32 s38, 0x4
    v_mad_u32_u24 v68, v14, s38, v68
    v_bfe_u32 v14, v0, 6, 1
    s_mov_b32 s38, 0x40
    v_mad_u32_u24 v68, v14, s38, v68
    v_bfe_u32 v14, v0, 7, 1
    s_mov_b32 s38, 0x80
    v_mad_u32_u24 v68, v14, s38, v68
    v_mov_b32 v70, s20
    v_mov_b32 v69, 0x0
    v_bfe_u32 v14, v70, 0, 1
    s_mov_b32 s38, 0x20
    v_mad_u32_u24 v69, v14, s38, v69
    v_bfe_u32 v14, v70, 1, 1
    s_mov_b32 s38, 0x800
    v_mad_u32_u24 v69, v14, s38, v69
    v_bfe_u32 v14, v70, 2, 1
    s_mov_b32 s38, 0x1000
    v_mad_u32_u24 v69, v14, s38, v69
    v_bfe_u32 v14, v70, 3, 1
    s_mov_b32 s38, 0x100
    v_mad_u32_u24 v69, v14, s38, v69
    v_bfe_u32 v14, v70, 4, 1
    s_mov_b32 s38, 0x200
    v_mad_u32_u24 v69, v14, s38, v69
    v_add_u32 v68, v68, v69
    buffer_load_dword v72, v68, s[96:99], 0 offen
    v_mov_b32 v64, -1
    v_mov_b32 v65, -1
    v_mov_b32 v66, -1
    v_mov_b32 v67, -1
    s_lshl_b32 s36, s20, 13
    s_add_u32 s36, s36, 0x0
    buffer_store_dwordx4 v[64:67], v2, s[8:11], s36 offen sc1
    buffer_store_dwordx4 v[64:67], v2, s[8:11], s36 offen offset:1024 sc1
    s_lshl_b32 s36, s20, 14
    s_add_u32 s36, s36, 0x100000
    s_add_u32 s37, s36, 0x2000
    buffer_store_dwordx4 v[64:67], v2, s[8:11], s36 offen sc1
    buffer_store_dwordx4 v[64:67], v2, s[8:11], s36 offen offset:1024 sc1
    buffer_store_dwordx4 v[64:67], v2, s[8:11], s37 offen sc1
    buffer_store_dwordx4 v[64:67], v2, s[8:11], s37 offen offset:1024 sc1
    s_mul_i32 s36, s20, 0x104200
    s_add_u32 s36, s36, 0x1102100
    s_add_u32 s37, s36, 0x82100
    buffer_store_dwordx4 v[64:67], v2, s[8:11], s36 offen sc1
    buffer_store_dwordx4 v[64:67], v2, s[8:11], s36 offen offset:1024 sc1
    buffer_store_dwordx4 v[64:67], v2, s[8:11], s37 offen sc1
    buffer_store_dwordx4 v[64:67], v2, s[8:11], s37 offen offset:1024 sc1
    v_lshlrev_b32 v68, 2, v0
    s_lshl_b32 s36, s20, 10
    s_add_u32 s37, s36, 0x194000
    buffer_store_dword v64, v68, s[8:11], s37 offen sc1
    s_add_u32 s37, s36, 0x1b0000
    buffer_store_dword v64, v68, s[8:11], s37 offen sc1
    s_add_u32 s37, s36, 0x1b8000
    buffer_store_dword v64, v68, s[8:11], s37 offen sc1
    v_mov_b32 v69, 0x40000000
    v_cmp_lt_u32 vcc, 63, v0
    s_nop 1
    v_cndmask_b32 v68, v68, v69, vcc
    v_mov_b32 v73, 0
    s_lshl_b32 s36, s20, 8
    s_add_u32 s37, s36, 0x192000
    buffer_store_dword v73, v68, s[8:11], s37 offen sc1
    s_mul_i32 s36, s20, 0x104200
    s_add_u32 s36, s36, 0x1082000
    s_add_u32 s37, s36, 0x82100
    buffer_store_dword v73, v68, s[8:11], s36 offen sc1
    buffer_store_dword v73, v68, s[8:11], s37 offen sc1
    v_mov_b32 v71, 0x80000
    v_bfe_u32 v14, v0, 0, 1
    s_mov_b32 s38, 0x8
    v_mad_u32_u24 v71, v14, s38, v71
    v_bfe_u32 v14, v0, 1, 1
    s_mov_b32 s38, 0x20
    v_mad_u32_u24 v71, v14, s38, v71
    v_bfe_u32 v14, v0, 4, 1
    s_mov_b32 s38, 0x10
    v_mad_u32_u24 v71, v14, s38, v71
    v_bfe_u32 v14, v0, 5, 1
    s_mov_b32 s38, 0x4
    v_mad_u32_u24 v71, v14, s38, v71
    v_bfe_u32 v14, v0, 6, 1
    s_mov_b32 s38, 0x800
    v_mad_u32_u24 v71, v14, s38, v71
    v_bfe_u32 v14, v0, 7, 1
    s_mov_b32 s38, 0x1000
    v_mad_u32_u24 v71, v14, s38, v71
    v_mov_b32 v69, s20
    v_mov_b32 v68, 0x0
    v_bfe_u32 v14, v69, 0, 1
    s_mov_b32 s38, 0x100
    v_mad_u32_u24 v68, v14, s38, v68
    v_bfe_u32 v14, v69, 1, 1
    s_mov_b32 s38, 0x40
    v_mad_u32_u24 v68, v14, s38, v68
    v_bfe_u32 v14, v69, 2, 1
    s_mov_b32 s38, 0x80
    v_mad_u32_u24 v68, v14, s38, v68
    v_bfe_u32 v14, v69, 3, 1
    s_mov_b32 s38, 0x200
    v_mad_u32_u24 v68, v14, s38, v68
    v_bfe_u32 v14, v69, 4, 1
    s_mov_b32 s38, 0x400
    v_mad_u32_u24 v68, v14, s38, v68
    v_add_u32 v71, v68, v71
    v_and_b32 v68, 12, v0
    v_cmp_ne_u32 vcc, 0, v68
    v_mov_b32 v68, 0x40000000
    s_nop 0
    v_cndmask_b32 v71, v71, v68, vcc
    s_waitcnt vmcnt(16)
    s_mov_b32 s36, 0x1000000
    buffer_store_dword v72, v71, s[8:11], s36 offen sc1
L_XN:
    v_mov_b32 v88, 0
    v_mov_b32 v89, 0
    v_dot2_f32_bf16 v88, v96, s4, v88
    v_dot2_f32_bf16 v89, v96, v96, v89
    v_dot2_f32_bf16 v88, v97, s4, v88
    v_dot2_f32_bf16 v89, v97, v97, v89
    v_dot2_f32_bf16 v88, v98, s4, v88
    v_dot2_f32_bf16 v89, v98, v98, v89
    v_dot2_f32_bf16 v88, v99, s4, v88
    v_dot2_f32_bf16 v89, v99, v99, v89
    v_dot2_f32_bf16 v88, v100, s4, v88
    v_dot2_f32_bf16 v89, v100, v100, v89
    v_dot2_f32_bf16 v88, v101, s4, v88
    v_dot2_f32_bf16 v89, v101, v101, v89
    v_dot2_f32_bf16 v88, v102, s4, v88
    v_dot2_f32_bf16 v89, v102, v102, v89
    v_dot2_f32_bf16 v88, v103, s4, v88
    v_dot2_f32_bf16 v89, v103, v103, v89
    v_dot2_f32_bf16 v88, v104, s4, v88
    v_dot2_f32_bf16 v89, v104, v104, v89
    v_dot2_f32_bf16 v88, v105, s4, v88
    v_dot2_f32_bf16 v89, v105, v105, v89
    v_dot2_f32_bf16 v88, v106, s4, v88
    v_dot2_f32_bf16 v89, v106, v106, v89
    v_dot2_f32_bf16 v88, v107, s4, v88
    v_dot2_f32_bf16 v89, v107, v107, v89
    v_dot2_f32_bf16 v88, v108, s4, v88
    v_dot2_f32_bf16 v89, v108, v108, v89
    v_dot2_f32_bf16 v88, v109, s4, v88
    v_dot2_f32_bf16 v89, v109, v109, v89
    v_dot2_f32_bf16 v88, v110, s4, v88
    v_dot2_f32_bf16 v89, v110, v110, v89
    v_dot2_f32_bf16 v88, v111, s4, v88
    v_dot2_f32_bf16 v89, v111, v111, v89
    v_dot2_f32_bf16 v88, v112, s4, v88
    v_dot2_f32_bf16 v89, v112, v112, v89
    v_dot2_f32_bf16 v88, v113, s4, v88
    v_dot2_f32_bf16 v89, v113, v113, v89
    v_dot2_f32_bf16 v88, v114, s4, v88
    v_dot2_f32_bf16 v89, v114, v114, v89
    v_dot2_f32_bf16 v88, v115, s4, v88
    v_dot2_f32_bf16 v89, v115, v115, v89
    v_dot2_f32_bf16 v88, v116, s4, v88
    v_dot2_f32_bf16 v89, v116, v116, v89
    v_dot2_f32_bf16 v88, v117, s4, v88
    v_dot2_f32_bf16 v89, v117, v117, v89
    v_dot2_f32_bf16 v88, v118, s4, v88
    v_dot2_f32_bf16 v89, v118, v118, v89
    v_dot2_f32_bf16 v88, v119, s4, v88
    v_dot2_f32_bf16 v89, v119, v119, v89
    v_dot2_f32_bf16 v88, v120, s4, v88
    v_dot2_f32_bf16 v89, v120, v120, v89
    v_dot2_f32_bf16 v88, v121, s4, v88
    v_dot2_f32_bf16 v89, v121, v121, v89
    v_dot2_f32_bf16 v88, v122, s4, v88
    v_dot2_f32_bf16 v89, v122, v122, v89
    v_dot2_f32_bf16 v88, v123, s4, v88
    v_dot2_f32_bf16 v89, v123, v123, v89
    v_dot2_f32_bf16 v88, v124, s4, v88
    v_dot2_f32_bf16 v89, v124, v124, v89
    v_dot2_f32_bf16 v88, v125, s4, v88
    v_dot2_f32_bf16 v89, v125, v125, v89
    v_dot2_f32_bf16 v88, v126, s4, v88
    v_dot2_f32_bf16 v89, v126, v126, v89
    v_dot2_f32_bf16 v88, v127, s4, v88
    v_dot2_f32_bf16 v89, v127, v127, v89
    s_nop 3
    v_add_f32_dpp v88, v88, v88 quad_perm:[1,0,3,2] row_mask:0xf bank_mask:0xf
    v_add_f32_dpp v89, v89, v89 quad_perm:[1,0,3,2] row_mask:0xf bank_mask:0xf
    s_nop 0
    v_add_f32_dpp v88, v88, v88 quad_perm:[2,3,0,1] row_mask:0xf bank_mask:0xf
    v_add_f32_dpp v89, v89, v89 quad_perm:[2,3,0,1] row_mask:0xf bank_mask:0xf
    s_nop 0
    v_add_f32_dpp v88, v88, v88 row_half_mirror row_mask:0xf bank_mask:0xf
    v_add_f32_dpp v89, v89, v89 row_half_mirror row_mask:0xf bank_mask:0xf
    v_mul_f32 v88, 0x3b000000, v88
    v_mul_f32 v89, 0x3b000000, v89
    v_fma_f32 v89, -v88, v88, v89
    v_max_f32 v89, 0, v89
    v_cvt_pk_bf16_f32 v14, v88, v89
    v_lshlrev_b32 v88, 16, v14
    v_and_b32 v89, 0xffff0000, v14
    v_add_f32 v89, 0x3727c5ac, v89
    v_cvt_pk_bf16_f32 v14, v89, v89
    v_lshlrev_b32 v89, 16, v14
    v_sqrt_f32 v89, v89
    s_nop 0
    v_cvt_pk_bf16_f32 v14, v89, v89
    v_lshlrev_b32 v89, 16, v14
    v_rcp_f32 v89, v89
    v_lshlrev_b32 v90, 16, v96
    v_and_b32 v91, 0xffff0000, v96
    v_sub_f32 v90, v90, v88
    v_sub_f32 v91, v91, v88
    v_cvt_pk_bf16_f32 v96, v90, v91
    v_lshlrev_b32 v90, 16, v96
    v_and_b32 v91, 0xffff0000, v96
    v_mul_f32 v90, v90, v89
    v_mul_f32 v91, v91, v89
    v_cvt_pk_bf16_f32 v96, v90, v91
    v_lshlrev_b32 v90, 16, v97
    v_and_b32 v91, 0xffff0000, v97
    v_sub_f32 v90, v90, v88
    v_sub_f32 v91, v91, v88
    v_cvt_pk_bf16_f32 v97, v90, v91
    v_lshlrev_b32 v90, 16, v97
    v_and_b32 v91, 0xffff0000, v97
    v_mul_f32 v90, v90, v89
    v_mul_f32 v91, v91, v89
    v_cvt_pk_bf16_f32 v97, v90, v91
    v_lshlrev_b32 v90, 16, v98
    v_and_b32 v91, 0xffff0000, v98
    v_sub_f32 v90, v90, v88
    v_sub_f32 v91, v91, v88
    v_cvt_pk_bf16_f32 v98, v90, v91
    v_lshlrev_b32 v90, 16, v98
    v_and_b32 v91, 0xffff0000, v98
    v_mul_f32 v90, v90, v89
    v_mul_f32 v91, v91, v89
    v_cvt_pk_bf16_f32 v98, v90, v91
    v_lshlrev_b32 v90, 16, v99
    v_and_b32 v91, 0xffff0000, v99
    v_sub_f32 v90, v90, v88
    v_sub_f32 v91, v91, v88
    v_cvt_pk_bf16_f32 v99, v90, v91
    v_lshlrev_b32 v90, 16, v99
    v_and_b32 v91, 0xffff0000, v99
    v_mul_f32 v90, v90, v89
    v_mul_f32 v91, v91, v89
    v_cvt_pk_bf16_f32 v99, v90, v91
    ds_write_b128 v4, v[96:99] offset:0
    v_lshlrev_b32 v90, 16, v100
    v_and_b32 v91, 0xffff0000, v100
    v_sub_f32 v90, v90, v88
    v_sub_f32 v91, v91, v88
    v_cvt_pk_bf16_f32 v100, v90, v91
    v_lshlrev_b32 v90, 16, v100
    v_and_b32 v91, 0xffff0000, v100
    v_mul_f32 v90, v90, v89
    v_mul_f32 v91, v91, v89
    v_cvt_pk_bf16_f32 v100, v90, v91
    v_lshlrev_b32 v90, 16, v101
    v_and_b32 v91, 0xffff0000, v101
    v_sub_f32 v90, v90, v88
    v_sub_f32 v91, v91, v88
    v_cvt_pk_bf16_f32 v101, v90, v91
    v_lshlrev_b32 v90, 16, v101
    v_and_b32 v91, 0xffff0000, v101
    v_mul_f32 v90, v90, v89
    v_mul_f32 v91, v91, v89
    v_cvt_pk_bf16_f32 v101, v90, v91
    v_lshlrev_b32 v90, 16, v102
    v_and_b32 v91, 0xffff0000, v102
    v_sub_f32 v90, v90, v88
    v_sub_f32 v91, v91, v88
    v_cvt_pk_bf16_f32 v102, v90, v91
    v_lshlrev_b32 v90, 16, v102
    v_and_b32 v91, 0xffff0000, v102
    v_mul_f32 v90, v90, v89
    v_mul_f32 v91, v91, v89
    v_cvt_pk_bf16_f32 v102, v90, v91
    v_lshlrev_b32 v90, 16, v103
    v_and_b32 v91, 0xffff0000, v103
    v_sub_f32 v90, v90, v88
    v_sub_f32 v91, v91, v88
    v_cvt_pk_bf16_f32 v103, v90, v91
    v_lshlrev_b32 v90, 16, v103
    v_and_b32 v91, 0xffff0000, v103
    v_mul_f32 v90, v90, v89
    v_mul_f32 v91, v91, v89
    v_cvt_pk_bf16_f32 v103, v90, v91
    ds_write_b128 v4, v[100:103] offset:2048
    v_lshlrev_b32 v90, 16, v104
    v_and_b32 v91, 0xffff0000, v104
    v_sub_f32 v90, v90, v88
    v_sub_f32 v91, v91, v88
    v_cvt_pk_bf16_f32 v104, v90, v91
    v_lshlrev_b32 v90, 16, v104
    v_and_b32 v91, 0xffff0000, v104
    v_mul_f32 v90, v90, v89
    v_mul_f32 v91, v91, v89
    v_cvt_pk_bf16_f32 v104, v90, v91
    v_lshlrev_b32 v90, 16, v105
    v_and_b32 v91, 0xffff0000, v105
    v_sub_f32 v90, v90, v88
    v_sub_f32 v91, v91, v88
    v_cvt_pk_bf16_f32 v105, v90, v91
    v_lshlrev_b32 v90, 16, v105
    v_and_b32 v91, 0xffff0000, v105
    v_mul_f32 v90, v90, v89
    v_mul_f32 v91, v91, v89
    v_cvt_pk_bf16_f32 v105, v90, v91
    v_lshlrev_b32 v90, 16, v106
    v_and_b32 v91, 0xffff0000, v106
    v_sub_f32 v90, v90, v88
    v_sub_f32 v91, v91, v88
    v_cvt_pk_bf16_f32 v106, v90, v91
    v_lshlrev_b32 v90, 16, v106
    v_and_b32 v91, 0xffff0000, v106
    v_mul_f32 v90, v90, v89
    v_mul_f32 v91, v91, v89
    v_cvt_pk_bf16_f32 v106, v90, v91
    v_lshlrev_b32 v90, 16, v107
    v_and_b32 v91, 0xffff0000, v107
    v_sub_f32 v90, v90, v88
    v_sub_f32 v91, v91, v88
    v_cvt_pk_bf16_f32 v107, v90, v91
    v_lshlrev_b32 v90, 16, v107
    v_and_b32 v91, 0xffff0000, v107
    v_mul_f32 v90, v90, v89
    v_mul_f32 v91, v91, v89
    v_cvt_pk_bf16_f32 v107, v90, v91
    ds_write_b128 v4, v[104:107] offset:4096
    v_lshlrev_b32 v90, 16, v108
    v_and_b32 v91, 0xffff0000, v108
    v_sub_f32 v90, v90, v88
    v_sub_f32 v91, v91, v88
    v_cvt_pk_bf16_f32 v108, v90, v91
    v_lshlrev_b32 v90, 16, v108
    v_and_b32 v91, 0xffff0000, v108
    v_mul_f32 v90, v90, v89
    v_mul_f32 v91, v91, v89
    v_cvt_pk_bf16_f32 v108, v90, v91
    v_lshlrev_b32 v90, 16, v109
    v_and_b32 v91, 0xffff0000, v109
    v_sub_f32 v90, v90, v88
    v_sub_f32 v91, v91, v88
    v_cvt_pk_bf16_f32 v109, v90, v91
    v_lshlrev_b32 v90, 16, v109
    v_and_b32 v91, 0xffff0000, v109
    v_mul_f32 v90, v90, v89
    v_mul_f32 v91, v91, v89
    v_cvt_pk_bf16_f32 v109, v90, v91
    v_lshlrev_b32 v90, 16, v110
    v_and_b32 v91, 0xffff0000, v110
    v_sub_f32 v90, v90, v88
    v_sub_f32 v91, v91, v88
    v_cvt_pk_bf16_f32 v110, v90, v91
    v_lshlrev_b32 v90, 16, v110
    v_and_b32 v91, 0xffff0000, v110
    v_mul_f32 v90, v90, v89
    v_mul_f32 v91, v91, v89
    v_cvt_pk_bf16_f32 v110, v90, v91
    v_lshlrev_b32 v90, 16, v111
    v_and_b32 v91, 0xffff0000, v111
    v_sub_f32 v90, v90, v88
    v_sub_f32 v91, v91, v88
    v_cvt_pk_bf16_f32 v111, v90, v91
    v_lshlrev_b32 v90, 16, v111
    v_and_b32 v91, 0xffff0000, v111
    v_mul_f32 v90, v90, v89
    v_mul_f32 v91, v91, v89
    v_cvt_pk_bf16_f32 v111, v90, v91
    ds_write_b128 v4, v[108:111] offset:6144
    v_lshlrev_b32 v90, 16, v112
    v_and_b32 v91, 0xffff0000, v112
    v_sub_f32 v90, v90, v88
    v_sub_f32 v91, v91, v88
    v_cvt_pk_bf16_f32 v112, v90, v91
    v_lshlrev_b32 v90, 16, v112
    v_and_b32 v91, 0xffff0000, v112
    v_mul_f32 v90, v90, v89
    v_mul_f32 v91, v91, v89
    v_cvt_pk_bf16_f32 v112, v90, v91
    v_lshlrev_b32 v90, 16, v113
    v_and_b32 v91, 0xffff0000, v113
    v_sub_f32 v90, v90, v88
    v_sub_f32 v91, v91, v88
    v_cvt_pk_bf16_f32 v113, v90, v91
    v_lshlrev_b32 v90, 16, v113
    v_and_b32 v91, 0xffff0000, v113
    v_mul_f32 v90, v90, v89
    v_mul_f32 v91, v91, v89
    v_cvt_pk_bf16_f32 v113, v90, v91
    v_lshlrev_b32 v90, 16, v114
    v_and_b32 v91, 0xffff0000, v114
    v_sub_f32 v90, v90, v88
    v_sub_f32 v91, v91, v88
    v_cvt_pk_bf16_f32 v114, v90, v91
    v_lshlrev_b32 v90, 16, v114
    v_and_b32 v91, 0xffff0000, v114
    v_mul_f32 v90, v90, v89
    v_mul_f32 v91, v91, v89
    v_cvt_pk_bf16_f32 v114, v90, v91
    v_lshlrev_b32 v90, 16, v115
    v_and_b32 v91, 0xffff0000, v115
    v_sub_f32 v90, v90, v88
    v_sub_f32 v91, v91, v88
    v_cvt_pk_bf16_f32 v115, v90, v91
    v_lshlrev_b32 v90, 16, v115
    v_and_b32 v91, 0xffff0000, v115
    v_mul_f32 v90, v90, v89
    v_mul_f32 v91, v91, v89
    v_cvt_pk_bf16_f32 v115, v90, v91
    ds_write_b128 v4, v[112:115] offset:8192
    v_lshlrev_b32 v90, 16, v116
    v_and_b32 v91, 0xffff0000, v116
    v_sub_f32 v90, v90, v88
    v_sub_f32 v91, v91, v88
    v_cvt_pk_bf16_f32 v116, v90, v91
    v_lshlrev_b32 v90, 16, v116
    v_and_b32 v91, 0xffff0000, v116
    v_mul_f32 v90, v90, v89
    v_mul_f32 v91, v91, v89
    v_cvt_pk_bf16_f32 v116, v90, v91
    v_lshlrev_b32 v90, 16, v117
    v_and_b32 v91, 0xffff0000, v117
    v_sub_f32 v90, v90, v88
    v_sub_f32 v91, v91, v88
    v_cvt_pk_bf16_f32 v117, v90, v91
    v_lshlrev_b32 v90, 16, v117
    v_and_b32 v91, 0xffff0000, v117
    v_mul_f32 v90, v90, v89
    v_mul_f32 v91, v91, v89
    v_cvt_pk_bf16_f32 v117, v90, v91
    v_lshlrev_b32 v90, 16, v118
    v_and_b32 v91, 0xffff0000, v118
    v_sub_f32 v90, v90, v88
    v_sub_f32 v91, v91, v88
    v_cvt_pk_bf16_f32 v118, v90, v91
    v_lshlrev_b32 v90, 16, v118
    v_and_b32 v91, 0xffff0000, v118
    v_mul_f32 v90, v90, v89
    v_mul_f32 v91, v91, v89
    v_cvt_pk_bf16_f32 v118, v90, v91
    v_lshlrev_b32 v90, 16, v119
    v_and_b32 v91, 0xffff0000, v119
    v_sub_f32 v90, v90, v88
    v_sub_f32 v91, v91, v88
    v_cvt_pk_bf16_f32 v119, v90, v91
    v_lshlrev_b32 v90, 16, v119
    v_and_b32 v91, 0xffff0000, v119
    v_mul_f32 v90, v90, v89
    v_mul_f32 v91, v91, v89
    v_cvt_pk_bf16_f32 v119, v90, v91
    ds_write_b128 v4, v[116:119] offset:10240
    v_lshlrev_b32 v90, 16, v120
    v_and_b32 v91, 0xffff0000, v120
    v_sub_f32 v90, v90, v88
    v_sub_f32 v91, v91, v88
    v_cvt_pk_bf16_f32 v120, v90, v91
    v_lshlrev_b32 v90, 16, v120
    v_and_b32 v91, 0xffff0000, v120
    v_mul_f32 v90, v90, v89
    v_mul_f32 v91, v91, v89
    v_cvt_pk_bf16_f32 v120, v90, v91
    v_lshlrev_b32 v90, 16, v121
    v_and_b32 v91, 0xffff0000, v121
    v_sub_f32 v90, v90, v88
    v_sub_f32 v91, v91, v88
    v_cvt_pk_bf16_f32 v121, v90, v91
    v_lshlrev_b32 v90, 16, v121
    v_and_b32 v91, 0xffff0000, v121
    v_mul_f32 v90, v90, v89
    v_mul_f32 v91, v91, v89
    v_cvt_pk_bf16_f32 v121, v90, v91
    v_lshlrev_b32 v90, 16, v122
    v_and_b32 v91, 0xffff0000, v122
    v_sub_f32 v90, v90, v88
    v_sub_f32 v91, v91, v88
    v_cvt_pk_bf16_f32 v122, v90, v91
    v_lshlrev_b32 v90, 16, v122
    v_and_b32 v91, 0xffff0000, v122
    v_mul_f32 v90, v90, v89
    v_mul_f32 v91, v91, v89
    v_cvt_pk_bf16_f32 v122, v90, v91
    v_lshlrev_b32 v90, 16, v123
    v_and_b32 v91, 0xffff0000, v123
    v_sub_f32 v90, v90, v88
    v_sub_f32 v91, v91, v88
    v_cvt_pk_bf16_f32 v123, v90, v91
    v_lshlrev_b32 v90, 16, v123
    v_and_b32 v91, 0xffff0000, v123
    v_mul_f32 v90, v90, v89
    v_mul_f32 v91, v91, v89
    v_cvt_pk_bf16_f32 v123, v90, v91
    ds_write_b128 v4, v[120:123] offset:12288
    v_lshlrev_b32 v90, 16, v124
    v_and_b32 v91, 0xffff0000, v124
    v_sub_f32 v90, v90, v88
    v_sub_f32 v91, v91, v88
    v_cvt_pk_bf16_f32 v124, v90, v91
    v_lshlrev_b32 v90, 16, v124
    v_and_b32 v91, 0xffff0000, v124
    v_mul_f32 v90, v90, v89
    v_mul_f32 v91, v91, v89
    v_cvt_pk_bf16_f32 v124, v90, v91
    v_lshlrev_b32 v90, 16, v125
    v_and_b32 v91, 0xffff0000, v125
    v_sub_f32 v90, v90, v88
    v_sub_f32 v91, v91, v88
    v_cvt_pk_bf16_f32 v125, v90, v91
    v_lshlrev_b32 v90, 16, v125
    v_and_b32 v91, 0xffff0000, v125
    v_mul_f32 v90, v90, v89
    v_mul_f32 v91, v91, v89
    v_cvt_pk_bf16_f32 v125, v90, v91
    v_lshlrev_b32 v90, 16, v126
    v_and_b32 v91, 0xffff0000, v126
    v_sub_f32 v90, v90, v88
    v_sub_f32 v91, v91, v88
    v_cvt_pk_bf16_f32 v126, v90, v91
    v_lshlrev_b32 v90, 16, v126
    v_and_b32 v91, 0xffff0000, v126
    v_mul_f32 v90, v90, v89
    v_mul_f32 v91, v91, v89
    v_cvt_pk_bf16_f32 v126, v90, v91
    v_lshlrev_b32 v90, 16, v127
    v_and_b32 v91, 0xffff0000, v127
    v_sub_f32 v90, v90, v88
    v_sub_f32 v91, v91, v88
    v_cvt_pk_bf16_f32 v127, v90, v91
    v_lshlrev_b32 v90, 16, v127
    v_and_b32 v91, 0xffff0000, v127
    v_mul_f32 v90, v90, v89
    v_mul_f32 v91, v91, v89
    v_cvt_pk_bf16_f32 v127, v90, v91
    ds_write_b128 v4, v[124:127] offset:14336
    s_waitcnt lgkmcnt(0)
    s_barrier
    s_lshl_b32 s24, s23, 15
    s_add_u32 s24, s24, 0x800000
    ds_read_b128 v[24:27], v9 offset:0
    ds_read_b128 v[28:31], v9 offset:4096
    ds_read_b128 v[32:35], v9 offset:8192
    ds_read_b128 v[36:39], v9 offset:12288
    ds_read_b128 v[40:43], v9 offset:16384
    ds_read_b128 v[44:47], v9 offset:20480
    ds_read_b128 v[48:51], v9 offset:24576
    ds_read_b128 v[52:55], v9 offset:28672
    s_waitcnt lgkmcnt(7)
    s_add_u32 s36, s24, 0
    buffer_store_dwordx4 v[24:27], v9, s[8:11], s36 offen sc1
    s_waitcnt lgkmcnt(6)
    s_add_u32 s36, s24, 4096
    buffer_store_dwordx4 v[28:31], v9, s[8:11], s36 offen sc1
    s_waitcnt lgkmcnt(5)
    s_add_u32 s36, s24, 8192
    buffer_store_dwordx4 v[32:35], v9, s[8:11], s36 offen sc1
    s_waitcnt lgkmcnt(4)
    s_add_u32 s36, s24, 12288
    buffer_store_dwordx4 v[36:39], v9, s[8:11], s36 offen sc1
    s_waitcnt lgkmcnt(3)
    s_add_u32 s36, s24, 16384
    buffer_store_dwordx4 v[40:43], v9, s[8:11], s36 offen sc1
    s_waitcnt lgkmcnt(2)
    s_add_u32 s36, s24, 20480
    buffer_store_dwordx4 v[44:47], v9, s[8:11], s36 offen sc1
    s_waitcnt lgkmcnt(1)
    s_add_u32 s36, s24, 24576
    buffer_store_dwordx4 v[48:51], v9, s[8:11], s36 offen sc1
    s_waitcnt lgkmcnt(0)
    s_add_u32 s36, s24, 28672
    buffer_store_dwordx4 v[52:55], v9, s[8:11], s36 offen sc1
    s_barrier
    v_mov_b64 v[96:97], v[128:129]
    v_mov_b64 v[98:99], v[130:131]
    v_mov_b64 v[100:101], v[132:133]
    v_mov_b64 v[102:103], v[134:135]
    v_mov_b64 v[104:105], v[136:137]
    v_mov_b64 v[106:107], v[138:139]
    v_mov_b64 v[108:109], v[140:141]
    v_mov_b64 v[110:111], v[142:143]
    v_mov_b64 v[112:113], v[144:145]
    v_mov_b64 v[114:115], v[146:147]
    v_mov_b64 v[116:117], v[148:149]
    v_mov_b64 v[118:119], v[150:151]
    v_mov_b64 v[120:121], v[152:153]
    v_mov_b64 v[122:123], v[154:155]
    v_mov_b64 v[124:125], v[156:157]
    v_mov_b64 v[126:127], v[158:159]
    s_add_u32 s23, s23, 1
    s_bitcmp1_b32 s23, 0
    s_cbranch_scc1 L_XN
    s_waitcnt vmcnt(0)
    s_barrier
    v_mov_b32 v14, 1
    s_lshl_b32 s37, s20, 2
    v_lshlrev_b32 v15, 20, v0
    buffer_store_dword v14, v15, s[16:19], s37 offen sc1
    s_lshr_b32 s20, s2, 3
    s_mov_b32 s34, 0x05040100
    s_mov_b32 s35, 0x07060302
    s_mov_b32 s32, 0
    s_mov_b32 s64, s84
    s_and_b32 s65, s85, 0xffff
    s_mov_b32 s66, 0x1c0000
    s_mov_b32 s67, 0x20000
    s_mov_b32 s68, s86
    s_and_b32 s69, s87, 0xffff
    s_mov_b32 s70, 0x1c0000
    s_mov_b32 s71, 0x20000
    s_mov_b32 s76, s88
    s_and_b32 s77, s89, 0xffff
    s_mov_b32 s78, 0x1c0000
    s_mov_b32 s79, 0x20000
    v_and_b32 v3, 31, v0
    v_lshlrev_b32 v3, 2, v3
L_M_hs:
    buffer_load_dword v5, v3, s[16:19], 0 offen sc1
    s_add_u32 s32, s32, 1
    s_cmp_gt_u32 s32, 200000
    s_waitcnt vmcnt(0)
    s_cbranch_scc1 L_M_hs_ok
    v_cmp_eq_u32 vcc, 0, v5
    s_cbranch_vccz L_M_hs_ok
    s_sleep 16
    s_branch L_M_hs
L_M_hs_ok:
    v_lshlrev_b32 v3, 4, v0
L_M00_rp:
    s_mov_b32 s36, 0x194000
    buffer_load_dwordx4 v[16:19], v3, s[8:11], s36 offen sc1
    s_add_u32 s32, s32, 1
    v_mov_b32 v5, 0
    s_waitcnt vmcnt(0)
    v_max3_u32 v5, v5, v16, v17
    v_max3_u32 v5, v5, v18, v19
    s_cmp_gt_u32 s32, 200000
    s_cbranch_scc1 L_M00_rp_ok
    v_cmp_eq_u32 vcc, -1, v5
    s_cbranch_vccz L_M00_rp_ok
    s_sleep 64
    s_branch L_M00_rp
L_M00_rp_ok:
    v_add_f32 v16, v16, v17
    v_add_f32 v18, v18, v19
    v_add_f32 v16, v16, v18
    v_cvt_pk_bf16_f32 v5, v16, v16
    v_lshlrev_b32 v16, 16, v5
    v_ashrrev_i32 v5, 31, v16
    v_or_b32 v5, 0x80000000, v5
    v_xor_b32 v5, v5, v16
    v_and_b32 v5, 0xffff0000, v5
    v_sub_u32 v6, 2047, v0
    v_or_b32 v120, v5, v6
    v_lshrrev_b32 v1, 5, v0
    v_and_b32 v2, 31, v0
    s_mov_b32 s36, 229376
    v_mul_lo_u32 v4, v1, s36
    v_lshl_add_u32 v4, v2, 2, v4
    v_mov_b32 v5, 0x40000000
    v_cmp_lt_u32 vcc, 27, v2
    s_nop 1
    v_cndmask_b32 v4, v4, v5, vcc
    s_mul_i32 s23, s20, 112
    s_add_u32 s36, s23, 0
    buffer_load_dword v16, v4, s[64:67], s36 offen
    s_add_u32 s36, s23, 3584
    buffer_load_dword v17, v4, s[64:67], s36 offen
    s_add_u32 s36, s23, 7168
    buffer_load_dword v18, v4, s[64:67], s36 offen
    s_add_u32 s36, s23, 10752
    buffer_load_dword v19, v4, s[64:67], s36 offen
    s_add_u32 s36, s23, 14336
    buffer_load_dword v20, v4, s[64:67], s36 offen
    s_add_u32 s36, s23, 17920
    buffer_load_dword v21, v4, s[64:67], s36 offen
    s_add_u32 s36, s23, 21504
    buffer_load_dword v22, v4, s[64:67], s36 offen
    s_add_u32 s36, s23, 25088
    buffer_load_dword v23, v4, s[64:67], s36 offen
    s_add_u32 s36, s23, 28672
    buffer_load_dword v24, v4, s[64:67], s36 offen
    s_add_u32 s36, s23, 32256
    buffer_load_dword v25, v4, s[64:67], s36 offen
    s_add_u32 s36, s23, 35840
    buffer_load_dword v26, v4, s[64:67], s36 offen
    s_add_u32 s36, s23, 39424
    buffer_load_dword v27, v4, s[64:67], s36 offen
    s_add_u32 s36, s23, 43008
    buffer_load_dword v28, v4, s[64:67], s36 offen
    s_add_u32 s36, s23, 46592
    buffer_load_dword v29, v4, s[64:67], s36 offen
    s_add_u32 s36, s23, 50176
    buffer_load_dword v30, v4, s[64:67], s36 offen
    s_add_u32 s36, s23, 53760
    buffer_load_dword v31, v4, s[64:67], s36 offen
    s_add_u32 s36, s23, 57344
    buffer_load_dword v32, v4, s[64:67], s36 offen
    s_add_u32 s36, s23, 60928
    buffer_load_dword v33, v4, s[64:67], s36 offen
    s_add_u32 s36, s23, 64512
    buffer_load_dword v34, v4, s[64:67], s36 offen
    s_add_u32 s36, s23, 68096
    buffer_load_dword v35, v4, s[64:67], s36 offen
    s_add_u32 s36, s23, 71680
    buffer_load_dword v36, v4, s[64:67], s36 offen
    s_add_u32 s36, s23, 75264
    buffer_load_dword v37, v4, s[64:67], s36 offen
    s_add_u32 s36, s23, 78848
    buffer_load_dword v38, v4, s[64:67], s36 offen
    s_add_u32 s36, s23, 82432
    buffer_load_dword v39, v4, s[64:67], s36 offen
    s_add_u32 s36, s23, 86016
    buffer_load_dword v40, v4, s[64:67], s36 offen
    s_add_u32 s36, s23, 89600
    buffer_load_dword v41, v4, s[64:67], s36 offen
    s_add_u32 s36, s23, 93184
    buffer_load_dword v42, v4, s[64:67], s36 offen
    s_add_u32 s36, s23, 96768
    buffer_load_dword v43, v4, s[64:67], s36 offen
    s_add_u32 s36, s23, 100352
    buffer_load_dword v44, v4, s[64:67], s36 offen
    s_add_u32 s36, s23, 103936
    buffer_load_dword v45, v4, s[64:67], s36 offen
    s_add_u32 s36, s23, 107520
    buffer_load_dword v46, v4, s[64:67], s36 offen
    s_add_u32 s36, s23, 111104
    buffer_load_dword v47, v4, s[64:67], s36 offen
    s_waitcnt vmcnt(0)
    v_perm_b32 v128, v17, v16, s34
    v_perm_b32 v129, v19, v18, s34
    v_perm_b32 v130, v21, v20, s34
    v_perm_b32 v131, v23, v22, s34
    v_perm_b32 v132, v25, v24, s34
    v_perm_b32 v133, v27, v26, s34
    v_perm_b32 v134, v29, v28, s34
    v_perm_b32 v135, v31, v30, s34
    v_perm_b32 v136, v33, v32, s34
    v_perm_b32 v137, v35, v34, s34
    v_perm_b32 v138, v37, v36, s34
    v_perm_b32 v139, v39, v38, s34
    v_perm_b32 v140, v41, v40, s34
    v_perm_b32 v141, v43, v42, s34
    v_perm_b32 v142, v45, v44, s34
    v_perm_b32 v143, v47, v46, s34
    v_perm_b32 v160, v17, v16, s35
    v_perm_b32 v161, v19, v18, s35
    v_perm_b32 v162, v21, v20, s35
    v_perm_b32 v163, v23, v22, s35
    v_perm_b32 v164, v25, v24, s35
    v_perm_b32 v165, v27, v26, s35
    v_perm_b32 v166, v29, v28, s35
    v_perm_b32 v167, v31, v30, s35
    v_perm_b32 v168, v33, v32, s35
    v_perm_b32 v169, v35, v34, s35
    v_perm_b32 v170, v37, v36, s35
    v_perm_b32 v171, v39, v38, s35
    v_perm_b32 v172, v41, v40, s35
    v_perm_b32 v173, v43, v42, s35
    v_perm_b32 v174, v45, v44, s35
    v_perm_b32 v175, v47, v46, s35
    s_add_u32 s36, s23, 114688
    buffer_load_dword v16, v4, s[64:67], s36 offen
    s_add_u32 s36, s23, 118272
    buffer_load_dword v17, v4, s[64:67], s36 offen
    s_add_u32 s36, s23, 121856
    buffer_load_dword v18, v4, s[64:67], s36 offen
    s_add_u32 s36, s23, 125440
    buffer_load_dword v19, v4, s[64:67], s36 offen
    s_add_u32 s36, s23, 129024
    buffer_load_dword v20, v4, s[64:67], s36 offen
    s_add_u32 s36, s23, 132608
    buffer_load_dword v21, v4, s[64:67], s36 offen
    s_add_u32 s36, s23, 136192
    buffer_load_dword v22, v4, s[64:67], s36 offen
    s_add_u32 s36, s23, 139776
    buffer_load_dword v23, v4, s[64:67], s36 offen
    s_add_u32 s36, s23, 143360
    buffer_load_dword v24, v4, s[64:67], s36 offen
    s_add_u32 s36, s23, 146944
    buffer_load_dword v25, v4, s[64:67], s36 offen
    s_add_u32 s36, s23, 150528
    buffer_load_dword v26, v4, s[64:67], s36 offen
    s_add_u32 s36, s23, 154112
    buffer_load_dword v27, v4, s[64:67], s36 offen
    s_add_u32 s36, s23, 157696
    buffer_load_dword v28, v4, s[64:67], s36 offen
    s_add_u32 s36, s23, 161280
    buffer_load_dword v29, v4, s[64:67], s36 offen
    s_add_u32 s36, s23, 164864
    buffer_load_dword v30, v4, s[64:67], s36 offen
    s_add_u32 s36, s23, 168448
    buffer_load_dword v31, v4, s[64:67], s36 offen
    s_add_u32 s36, s23, 172032
    buffer_load_dword v32, v4, s[64:67], s36 offen
    s_add_u32 s36, s23, 175616
    buffer_load_dword v33, v4, s[64:67], s36 offen
    s_add_u32 s36, s23, 179200
    buffer_load_dword v34, v4, s[64:67], s36 offen
    s_add_u32 s36, s23, 182784
    buffer_load_dword v35, v4, s[64:67], s36 offen
    s_add_u32 s36, s23, 186368
    buffer_load_dword v36, v4, s[64:67], s36 offen
    s_add_u32 s36, s23, 189952
    buffer_load_dword v37, v4, s[64:67], s36 offen
    s_add_u32 s36, s23, 193536
    buffer_load_dword v38, v4, s[64:67], s36 offen
    s_add_u32 s36, s23, 197120
    buffer_load_dword v39, v4, s[64:67], s36 offen
    s_add_u32 s36, s23, 200704
    buffer_load_dword v40, v4, s[64:67], s36 offen
    s_add_u32 s36, s23, 204288
    buffer_load_dword v41, v4, s[64:67], s36 offen
    s_add_u32 s36, s23, 207872
    buffer_load_dword v42, v4, s[64:67], s36 offen
    s_add_u32 s36, s23, 211456
    buffer_load_dword v43, v4, s[64:67], s36 offen
    s_add_u32 s36, s23, 215040
    buffer_load_dword v44, v4, s[64:67], s36 offen
    s_add_u32 s36, s23, 218624
    buffer_load_dword v45, v4, s[64:67], s36 offen
    s_add_u32 s36, s23, 222208
    buffer_load_dword v46, v4, s[64:67], s36 offen
    s_add_u32 s36, s23, 225792
    buffer_load_dword v47, v4, s[64:67], s36 offen
    s_waitcnt vmcnt(0)
    v_perm_b32 v144, v17, v16, s34
    v_perm_b32 v145, v19, v18, s34
    v_perm_b32 v146, v21, v20, s34
    v_perm_b32 v147, v23, v22, s34
    v_perm_b32 v148, v25, v24, s34
    v_perm_b32 v149, v27, v26, s34
    v_perm_b32 v150, v29, v28, s34
    v_perm_b32 v151, v31, v30, s34
    v_perm_b32 v152, v33, v32, s34
    v_perm_b32 v153, v35, v34, s34
    v_perm_b32 v154, v37, v36, s34
    v_perm_b32 v155, v39, v38, s34
    v_perm_b32 v156, v41, v40, s34
    v_perm_b32 v157, v43, v42, s34
    v_perm_b32 v158, v45, v44, s34
    v_perm_b32 v159, v47, v46, s34
    v_perm_b32 v176, v17, v16, s35
    v_perm_b32 v177, v19, v18, s35
    v_perm_b32 v178, v21, v20, s35
    v_perm_b32 v179, v23, v22, s35
    v_perm_b32 v180, v25, v24, s35
    v_perm_b32 v181, v27, v26, s35
    v_perm_b32 v182, v29, v28, s35
    v_perm_b32 v183, v31, v30, s35
    v_perm_b32 v184, v33, v32, s35
    v_perm_b32 v185, v35, v34, s35
    v_perm_b32 v186, v37, v36, s35
    v_perm_b32 v187, v39, v38, s35
    v_perm_b32 v188, v41, v40, s35
    v_perm_b32 v189, v43, v42, s35
    v_perm_b32 v190, v45, v44, s35
    v_perm_b32 v191, v47, v46, s35
    s_add_u32 s36, s23, 0
    buffer_load_dword v16, v4, s[68:71], s36 offen
    s_add_u32 s36, s23, 3584
    buffer_load_dword v17, v4, s[68:71], s36 offen
    s_add_u32 s36, s23, 7168
    buffer_load_dword v18, v4, s[68:71], s36 offen
    s_add_u32 s36, s23, 10752
    buffer_load_dword v19, v4, s[68:71], s36 offen
    s_add_u32 s36, s23, 14336
    buffer_load_dword v20, v4, s[68:71], s36 offen
    s_add_u32 s36, s23, 17920
    buffer_load_dword v21, v4, s[68:71], s36 offen
    s_add_u32 s36, s23, 21504
    buffer_load_dword v22, v4, s[68:71], s36 offen
    s_add_u32 s36, s23, 25088
    buffer_load_dword v23, v4, s[68:71], s36 offen
    s_add_u32 s36, s23, 28672
    buffer_load_dword v24, v4, s[68:71], s36 offen
    s_add_u32 s36, s23, 32256
    buffer_load_dword v25, v4, s[68:71], s36 offen
    s_add_u32 s36, s23, 35840
    buffer_load_dword v26, v4, s[68:71], s36 offen
    s_add_u32 s36, s23, 39424
    buffer_load_dword v27, v4, s[68:71], s36 offen
    s_add_u32 s36, s23, 43008
    buffer_load_dword v28, v4, s[68:71], s36 offen
    s_add_u32 s36, s23, 46592
    buffer_load_dword v29, v4, s[68:71], s36 offen
    s_add_u32 s36, s23, 50176
    buffer_load_dword v30, v4, s[68:71], s36 offen
    s_add_u32 s36, s23, 53760
    buffer_load_dword v31, v4, s[68:71], s36 offen
    s_add_u32 s36, s23, 57344
    buffer_load_dword v32, v4, s[68:71], s36 offen
    s_add_u32 s36, s23, 60928
    buffer_load_dword v33, v4, s[68:71], s36 offen
    s_add_u32 s36, s23, 64512
    buffer_load_dword v34, v4, s[68:71], s36 offen
    s_add_u32 s36, s23, 68096
    buffer_load_dword v35, v4, s[68:71], s36 offen
    s_add_u32 s36, s23, 71680
    buffer_load_dword v36, v4, s[68:71], s36 offen
    s_add_u32 s36, s23, 75264
    buffer_load_dword v37, v4, s[68:71], s36 offen
    s_add_u32 s36, s23, 78848
    buffer_load_dword v38, v4, s[68:71], s36 offen
    s_add_u32 s36, s23, 82432
    buffer_load_dword v39, v4, s[68:71], s36 offen
    s_add_u32 s36, s23, 86016
    buffer_load_dword v40, v4, s[68:71], s36 offen
    s_add_u32 s36, s23, 89600
    buffer_load_dword v41, v4, s[68:71], s36 offen
    s_add_u32 s36, s23, 93184
    buffer_load_dword v42, v4, s[68:71], s36 offen
    s_add_u32 s36, s23, 96768
    buffer_load_dword v43, v4, s[68:71], s36 offen
    s_add_u32 s36, s23, 100352
    buffer_load_dword v44, v4, s[68:71], s36 offen
    s_add_u32 s36, s23, 103936
    buffer_load_dword v45, v4, s[68:71], s36 offen
    s_add_u32 s36, s23, 107520
    buffer_load_dword v46, v4, s[68:71], s36 offen
    s_add_u32 s36, s23, 111104
    buffer_load_dword v47, v4, s[68:71], s36 offen
    s_waitcnt vmcnt(0)
    v_perm_b32 v192, v17, v16, s34
    v_perm_b32 v193, v19, v18, s34
    v_perm_b32 v194, v21, v20, s34
    v_perm_b32 v195, v23, v22, s34
    v_perm_b32 v196, v25, v24, s34
    v_perm_b32 v197, v27, v26, s34
    v_perm_b32 v198, v29, v28, s34
    v_perm_b32 v199, v31, v30, s34
    v_perm_b32 v200, v33, v32, s34
    v_perm_b32 v201, v35, v34, s34
    v_perm_b32 v202, v37, v36, s34
    v_perm_b32 v203, v39, v38, s34
    v_perm_b32 v204, v41, v40, s34
    v_perm_b32 v205, v43, v42, s34
    v_perm_b32 v206, v45, v44, s34
    v_perm_b32 v207, v47, v46, s34
    v_perm_b32 v224, v17, v16, s35
    v_perm_b32 v225, v19, v18, s35
    v_perm_b32 v226, v21, v20, s35
    v_perm_b32 v227, v23, v22, s35
    v_perm_b32 v228, v25, v24, s35
    v_perm_b32 v229, v27, v26, s35
    v_perm_b32 v230, v29, v28, s35
    v_perm_b32 v231, v31, v30, s35
    v_perm_b32 v232, v33, v32, s35
    v_perm_b32 v233, v35, v34, s35
    v_perm_b32 v234, v37, v36, s35
    v_perm_b32 v235, v39, v38, s35
    v_perm_b32 v236, v41, v40, s35
    v_perm_b32 v237, v43, v42, s35
    v_perm_b32 v238, v45, v44, s35
    v_perm_b32 v239, v47, v46, s35
    s_add_u32 s36, s23, 114688
    buffer_load_dword v16, v4, s[68:71], s36 offen
    s_add_u32 s36, s23, 118272
    buffer_load_dword v17, v4, s[68:71], s36 offen
    s_add_u32 s36, s23, 121856
    buffer_load_dword v18, v4, s[68:71], s36 offen
    s_add_u32 s36, s23, 125440
    buffer_load_dword v19, v4, s[68:71], s36 offen
    s_add_u32 s36, s23, 129024
    buffer_load_dword v20, v4, s[68:71], s36 offen
    s_add_u32 s36, s23, 132608
    buffer_load_dword v21, v4, s[68:71], s36 offen
    s_add_u32 s36, s23, 136192
    buffer_load_dword v22, v4, s[68:71], s36 offen
    s_add_u32 s36, s23, 139776
    buffer_load_dword v23, v4, s[68:71], s36 offen
    s_add_u32 s36, s23, 143360
    buffer_load_dword v24, v4, s[68:71], s36 offen
    s_add_u32 s36, s23, 146944
    buffer_load_dword v25, v4, s[68:71], s36 offen
    s_add_u32 s36, s23, 150528
    buffer_load_dword v26, v4, s[68:71], s36 offen
    s_add_u32 s36, s23, 154112
    buffer_load_dword v27, v4, s[68:71], s36 offen
    s_add_u32 s36, s23, 157696
    buffer_load_dword v28, v4, s[68:71], s36 offen
    s_add_u32 s36, s23, 161280
    buffer_load_dword v29, v4, s[68:71], s36 offen
    s_add_u32 s36, s23, 164864
    buffer_load_dword v30, v4, s[68:71], s36 offen
    s_add_u32 s36, s23, 168448
    buffer_load_dword v31, v4, s[68:71], s36 offen
    s_add_u32 s36, s23, 172032
    buffer_load_dword v32, v4, s[68:71], s36 offen
    s_add_u32 s36, s23, 175616
    buffer_load_dword v33, v4, s[68:71], s36 offen
    s_add_u32 s36, s23, 179200
    buffer_load_dword v34, v4, s[68:71], s36 offen
    s_add_u32 s36, s23, 182784
    buffer_load_dword v35, v4, s[68:71], s36 offen
    s_add_u32 s36, s23, 186368
    buffer_load_dword v36, v4, s[68:71], s36 offen
    s_add_u32 s36, s23, 189952
    buffer_load_dword v37, v4, s[68:71], s36 offen
    s_add_u32 s36, s23, 193536
    buffer_load_dword v38, v4, s[68:71], s36 offen
    s_add_u32 s36, s23, 197120
    buffer_load_dword v39, v4, s[68:71], s36 offen
    s_add_u32 s36, s23, 200704
    buffer_load_dword v40, v4, s[68:71], s36 offen
    s_add_u32 s36, s23, 204288
    buffer_load_dword v41, v4, s[68:71], s36 offen
    s_add_u32 s36, s23, 207872
    buffer_load_dword v42, v4, s[68:71], s36 offen
    s_add_u32 s36, s23, 211456
    buffer_load_dword v43, v4, s[68:71], s36 offen
    s_add_u32 s36, s23, 215040
    buffer_load_dword v44, v4, s[68:71], s36 offen
    s_add_u32 s36, s23, 218624
    buffer_load_dword v45, v4, s[68:71], s36 offen
    s_add_u32 s36, s23, 222208
    buffer_load_dword v46, v4, s[68:71], s36 offen
    s_add_u32 s36, s23, 225792
    buffer_load_dword v47, v4, s[68:71], s36 offen
    s_waitcnt vmcnt(0)
    v_perm_b32 v208, v17, v16, s34
    v_perm_b32 v209, v19, v18, s34
    v_perm_b32 v210, v21, v20, s34
    v_perm_b32 v211, v23, v22, s34
    v_perm_b32 v212, v25, v24, s34
    v_perm_b32 v213, v27, v26, s34
    v_perm_b32 v214, v29, v28, s34
    v_perm_b32 v215, v31, v30, s34
    v_perm_b32 v216, v33, v32, s34
    v_perm_b32 v217, v35, v34, s34
    v_perm_b32 v218, v37, v36, s34
    v_perm_b32 v219, v39, v38, s34
    v_perm_b32 v220, v41, v40, s34
    v_perm_b32 v221, v43, v42, s34
    v_perm_b32 v222, v45, v44, s34
    v_perm_b32 v223, v47, v46, s34
    v_perm_b32 v240, v17, v16, s35
    v_perm_b32 v241, v19, v18, s35
    v_perm_b32 v242, v21, v20, s35
    v_perm_b32 v243, v23, v22, s35
    v_perm_b32 v244, v25, v24, s35
    v_perm_b32 v245, v27, v26, s35
    v_perm_b32 v246, v29, v28, s35
    v_perm_b32 v247, v31, v30, s35
    v_perm_b32 v248, v33, v32, s35
    v_perm_b32 v249, v35, v34, s35
    v_perm_b32 v250, v37, v36, s35
    v_perm_b32 v251, v39, v38, s35
    v_perm_b32 v252, v41, v40, s35
    v_perm_b32 v253, v43, v42, s35
    v_perm_b32 v254, v45, v44, s35
    v_perm_b32 v255, v47, v46, s35
    v_lshrrev_b32 v3, 3, v0
    v_mul_u32_u24 v4, 57344, v3
    v_and_b32 v3, 7, v0
    v_lshl_add_u32 v4, v3, 2, v4
    s_lshl_b32 s37, s20, 5
    s_add_u32 s36, s37, 0
    buffer_load_dword v16, v4, s[76:79], s36 offen
    s_add_u32 s36, s37, 1024
    buffer_load_dword v17, v4, s[76:79], s36 offen
    s_add_u32 s36, s37, 2048
    buffer_load_dword v18, v4, s[76:79], s36 offen
    s_add_u32 s36, s37, 3072
    buffer_load_dword v19, v4, s[76:79], s36 offen
    s_add_u32 s36, s37, 4096
    buffer_load_dword v20, v4, s[76:79], s36 offen
    s_add_u32 s36, s37, 5120
    buffer_load_dword v21, v4, s[76:79], s36 offen
    s_add_u32 s36, s37, 6144
    buffer_load_dword v22, v4, s[76:79], s36 offen
    s_add_u32 s36, s37, 7168
    buffer_load_dword v23, v4, s[76:79], s36 offen
    s_add_u32 s36, s37, 8192
    buffer_load_dword v24, v4, s[76:79], s36 offen
    s_add_u32 s36, s37, 9216
    buffer_load_dword v25, v4, s[76:79], s36 offen
    s_add_u32 s36, s37, 10240
    buffer_load_dword v26, v4, s[76:79], s36 offen
    s_add_u32 s36, s37, 11264
    buffer_load_dword v27, v4, s[76:79], s36 offen
    s_add_u32 s36, s37, 12288
    buffer_load_dword v28, v4, s[76:79], s36 offen
    s_add_u32 s36, s37, 13312
    buffer_load_dword v29, v4, s[76:79], s36 offen
    s_add_u32 s36, s37, 14336
    buffer_load_dword v30, v4, s[76:79], s36 offen
    s_add_u32 s36, s37, 15360
    buffer_load_dword v31, v4, s[76:79], s36 offen
    s_add_u32 s36, s37, 16384
    buffer_load_dword v32, v4, s[76:79], s36 offen
    s_add_u32 s36, s37, 17408
    buffer_load_dword v33, v4, s[76:79], s36 offen
    s_add_u32 s36, s37, 18432
    buffer_load_dword v34, v4, s[76:79], s36 offen
    s_add_u32 s36, s37, 19456
    buffer_load_dword v35, v4, s[76:79], s36 offen
    s_add_u32 s36, s37, 20480
    buffer_load_dword v36, v4, s[76:79], s36 offen
    s_add_u32 s36, s37, 21504
    buffer_load_dword v37, v4, s[76:79], s36 offen
    s_add_u32 s36, s37, 22528
    buffer_load_dword v38, v4, s[76:79], s36 offen
    s_add_u32 s36, s37, 23552
    buffer_load_dword v39, v4, s[76:79], s36 offen
    s_add_u32 s36, s37, 24576
    buffer_load_dword v40, v4, s[76:79], s36 offen
    s_add_u32 s36, s37, 25600
    buffer_load_dword v41, v4, s[76:79], s36 offen
    s_add_u32 s36, s37, 26624
    buffer_load_dword v42, v4, s[76:79], s36 offen
    s_add_u32 s36, s37, 27648
    buffer_load_dword v43, v4, s[76:79], s36 offen
    s_waitcnt vmcnt(0)
    v_perm_b32 v64, v17, v16, s34
    v_perm_b32 v65, v19, v18, s34
    v_perm_b32 v66, v21, v20, s34
    v_perm_b32 v67, v23, v22, s34
    v_perm_b32 v68, v25, v24, s34
    v_perm_b32 v69, v27, v26, s34
    v_perm_b32 v70, v29, v28, s34
    v_perm_b32 v71, v31, v30, s34
    v_perm_b32 v72, v33, v32, s34
    v_perm_b32 v73, v35, v34, s34
    v_perm_b32 v74, v37, v36, s34
    v_perm_b32 v75, v39, v38, s34
    v_perm_b32 v76, v41, v40, s34
    v_perm_b32 v77, v43, v42, s34
    v_perm_b32 v92, v17, v16, s35
    v_perm_b32 v93, v19, v18, s35
    v_perm_b32 v94, v21, v20, s35
    v_perm_b32 v95, v23, v22, s35
    v_perm_b32 v96, v25, v24, s35
    v_perm_b32 v97, v27, v26, s35
    v_perm_b32 v98, v29, v28, s35
    v_perm_b32 v99, v31, v30, s35
    v_perm_b32 v100, v33, v32, s35
    v_perm_b32 v101, v35, v34, s35
    v_perm_b32 v102, v37, v36, s35
    v_perm_b32 v103, v39, v38, s35
    v_perm_b32 v104, v41, v40, s35
    v_perm_b32 v105, v43, v42, s35
    s_add_u32 s36, s37, 28672
    buffer_load_dword v16, v4, s[76:79], s36 offen
    s_add_u32 s36, s37, 29696
    buffer_load_dword v17, v4, s[76:79], s36 offen
    s_add_u32 s36, s37, 30720
    buffer_load_dword v18, v4, s[76:79], s36 offen
    s_add_u32 s36, s37, 31744
    buffer_load_dword v19, v4, s[76:79], s36 offen
    s_add_u32 s36, s37, 32768
    buffer_load_dword v20, v4, s[76:79], s36 offen
    s_add_u32 s36, s37, 33792
    buffer_load_dword v21, v4, s[76:79], s36 offen
    s_add_u32 s36, s37, 34816
    buffer_load_dword v22, v4, s[76:79], s36 offen
    s_add_u32 s36, s37, 35840
    buffer_load_dword v23, v4, s[76:79], s36 offen
    s_add_u32 s36, s37, 36864
    buffer_load_dword v24, v4, s[76:79], s36 offen
    s_add_u32 s36, s37, 37888
    buffer_load_dword v25, v4, s[76:79], s36 offen
    s_add_u32 s36, s37, 38912
    buffer_load_dword v26, v4, s[76:79], s36 offen
    s_add_u32 s36, s37, 39936
    buffer_load_dword v27, v4, s[76:79], s36 offen
    s_add_u32 s36, s37, 40960
    buffer_load_dword v28, v4, s[76:79], s36 offen
    s_add_u32 s36, s37, 41984
    buffer_load_dword v29, v4, s[76:79], s36 offen
    s_add_u32 s36, s37, 43008
    buffer_load_dword v30, v4, s[76:79], s36 offen
    s_add_u32 s36, s37, 44032
    buffer_load_dword v31, v4, s[76:79], s36 offen
    s_add_u32 s36, s37, 45056
    buffer_load_dword v32, v4, s[76:79], s36 offen
    s_add_u32 s36, s37, 46080
    buffer_load_dword v33, v4, s[76:79], s36 offen
    s_add_u32 s36, s37, 47104
    buffer_load_dword v34, v4, s[76:79], s36 offen
    s_add_u32 s36, s37, 48128
    buffer_load_dword v35, v4, s[76:79], s36 offen
    s_add_u32 s36, s37, 49152
    buffer_load_dword v36, v4, s[76:79], s36 offen
    s_add_u32 s36, s37, 50176
    buffer_load_dword v37, v4, s[76:79], s36 offen
    s_add_u32 s36, s37, 51200
    buffer_load_dword v38, v4, s[76:79], s36 offen
    s_add_u32 s36, s37, 52224
    buffer_load_dword v39, v4, s[76:79], s36 offen
    s_add_u32 s36, s37, 53248
    buffer_load_dword v40, v4, s[76:79], s36 offen
    s_add_u32 s36, s37, 54272
    buffer_load_dword v41, v4, s[76:79], s36 offen
    s_add_u32 s36, s37, 55296
    buffer_load_dword v42, v4, s[76:79], s36 offen
    s_add_u32 s36, s37, 56320
    buffer_load_dword v43, v4, s[76:79], s36 offen
    s_waitcnt vmcnt(0)
    v_perm_b32 v78, v17, v16, s34
    v_perm_b32 v79, v19, v18, s34
    v_perm_b32 v80, v21, v20, s34
    v_perm_b32 v81, v23, v22, s34
    v_perm_b32 v82, v25, v24, s34
    v_perm_b32 v83, v27, v26, s34
    v_perm_b32 v84, v29, v28, s34
    v_perm_b32 v85, v31, v30, s34
    v_perm_b32 v86, v33, v32, s34
    v_perm_b32 v87, v35, v34, s34
    v_perm_b32 v88, v37, v36, s34
    v_perm_b32 v89, v39, v38, s34
    v_perm_b32 v90, v41, v40, s34
    v_perm_b32 v91, v43, v42, s34
    v_perm_b32 v106, v17, v16, s35
    v_perm_b32 v107, v19, v18, s35
    v_perm_b32 v108, v21, v20, s35
    v_perm_b32 v109, v23, v22, s35
    v_perm_b32 v110, v25, v24, s35
    v_perm_b32 v111, v27, v26, s35
    v_perm_b32 v112, v29, v28, s35
    v_perm_b32 v113, v31, v30, s35
    v_perm_b32 v114, v33, v32, s35
    v_perm_b32 v115, v35, v34, s35
    v_perm_b32 v116, v37, v36, s35
    v_perm_b32 v117, v39, v38, s35
    v_perm_b32 v118, v41, v40, s35
    v_perm_b32 v119, v43, v42, s35
    s_mov_b32 s42, 0xffff0000
    s_mov_b32 s24, 0
    s_mov_b64 s[28:29], 0
    v_mov_b32 v12, 0x40000000
    v_mov_b32 v13, 0
    v_lshlrev_b32 v3, 4, v0
L_M06_rp:
    s_mov_b32 s36, 0x19a000
    buffer_load_dwordx4 v[40:43], v3, s[8:11], s36 offen sc1
    s_add_u32 s32, s32, 1
    v_mov_b32 v5, 0
    s_waitcnt vmcnt(0)
    v_max3_u32 v5, v5, v40, v41
    v_max3_u32 v5, v5, v42, v43
    s_cmp_gt_u32 s32, 200000
    s_cbranch_scc1 L_M06_rp_ok
    v_cmp_eq_u32 vcc, -1, v5
    s_cbranch_vccz L_M06_rp_ok
    s_sleep 32
    s_branch L_M06_rp
L_M06_rp_ok:
    v_add_f32 v40, v40, v41
    v_add_f32 v42, v42, v43
    v_add_f32 v40, v40, v42
    v_cvt_pk_bf16_f32 v5, v40, v40
    v_lshlrev_b32 v40, 16, v5
    v_ashrrev_i32 v5, 31, v40
    v_or_b32 v5, 0x80000000, v5
    v_xor_b32 v5, v5, v40
    v_and_b32 v5, 0xffff0000, v5
    v_sub_u32 v6, 511, v0
    v_or_b32 v126, v5, v6
    v_lshlrev_b32 v3, 4, v0
L_M01_rp:
    s_mov_b32 s36, 0x195000
    buffer_load_dwordx4 v[20:23], v3, s[8:11], s36 offen sc1
    s_mov_b32 s36, 0x196000
    buffer_load_dwordx4 v[24:27], v3, s[8:11], s36 offen sc1
    s_mov_b32 s36, 0x197000
    buffer_load_dwordx4 v[28:31], v3, s[8:11], s36 offen sc1
    s_mov_b32 s36, 0x198000
    buffer_load_dwordx4 v[32:35], v3, s[8:11], s36 offen sc1
    s_mov_b32 s36, 0x199000
    buffer_load_dwordx4 v[36:39], v3, s[8:11], s36 offen sc1
    s_add_u32 s32, s32, 1
    v_mov_b32 v5, 0
    s_waitcnt vmcnt(0)
    v_max3_u32 v5, v5, v20, v21
    v_max3_u32 v5, v5, v22, v23
    v_max3_u32 v5, v5, v24, v25
    v_max3_u32 v5, v5, v26, v27
    v_max3_u32 v5, v5, v28, v29
    v_max3_u32 v5, v5, v30, v31
    v_max3_u32 v5, v5, v32, v33
    v_max3_u32 v5, v5, v34, v35
    v_max3_u32 v5, v5, v36, v37
    v_max3_u32 v5, v5, v38, v39
    s_cmp_gt_u32 s32, 200000
    s_cbranch_scc1 L_M01_rp_ok
    v_cmp_eq_u32 vcc, -1, v5
    s_cbranch_vccz L_M01_rp_ok
    s_sleep 8
    s_branch L_M01_rp
L_M01_rp_ok:
    v_add_f32 v20, v20, v21
    v_add_f32 v22, v22, v23
    v_add_f32 v20, v20, v22
    v_cvt_pk_bf16_f32 v5, v20, v20
    v_lshlrev_b32 v20, 16, v5
    v_ashrrev_i32 v5, 31, v20
    v_or_b32 v5, 0x80000000, v5
    v_xor_b32 v5, v5, v20
    v_and_b32 v5, 0xffff0000, v5
    v_sub_u32 v6, 1791, v0
    v_or_b32 v121, v5, v6
    v_add_f32 v24, v24, v25
    v_add_f32 v26, v26, v27
    v_add_f32 v24, v24, v26
    v_cvt_pk_bf16_f32 v5, v24, v24
    v_lshlrev_b32 v24, 16, v5
    v_ashrrev_i32 v5, 31, v24
    v_or_b32 v5, 0x80000000, v5
    v_xor_b32 v5, v5, v24
    v_and_b32 v5, 0xffff0000, v5
    v_sub_u32 v6, 1535, v0
    v_or_b32 v122, v5, v6
    v_add_f32 v28, v28, v29
    v_add_f32 v30, v30, v31
    v_add_f32 v28, v28, v30
    v_cvt_pk_bf16_f32 v5, v28, v28
    v_lshlrev_b32 v28, 16, v5
    v_ashrrev_i32 v5, 31, v28
    v_or_b32 v5, 0x80000000, v5
    v_xor_b32 v5, v5, v28
    v_and_b32 v5, 0xffff0000, v5
    v_sub_u32 v6, 1279, v0
    v_or_b32 v123, v5, v6
    v_add_f32 v32, v32, v33
    v_add_f32 v34, v34, v35
    v_add_f32 v32, v32, v34
    v_cvt_pk_bf16_f32 v5, v32, v32
    v_lshlrev_b32 v32, 16, v5
    v_ashrrev_i32 v5, 31, v32
    v_or_b32 v5, 0x80000000, v5
    v_xor_b32 v5, v5, v32
    v_and_b32 v5, 0xffff0000, v5
    v_sub_u32 v6, 1023, v0
    v_or_b32 v124, v5, v6
    v_add_f32 v36, v36, v37
    v_add_f32 v38, v38, v39
    v_add_f32 v36, v36, v38
    v_cvt_pk_bf16_f32 v5, v36, v36
    v_lshlrev_b32 v36, 16, v5
    v_ashrrev_i32 v5, 31, v36
    v_or_b32 v5, 0x80000000, v5
    v_xor_b32 v5, v5, v36
    v_and_b32 v5, 0xffff0000, v5
    v_sub_u32 v6, 767, v0
    v_or_b32 v125, v5, v6
    v_max_u32 v5, v120, v121
    v_min_u32 v6, v120, v121
    v_med3_u32 v6, v5, v6, v122
    v_max_u32 v5, v5, v122
    v_med3_u32 v6, v5, v6, v123
    v_max_u32 v5, v5, v123
    v_med3_u32 v6, v5, v6, v124
    v_max_u32 v5, v5, v124
    v_med3_u32 v6, v5, v6, v125
    v_max_u32 v5, v5, v125
    v_med3_u32 v6, v5, v6, v126
    v_max_u32 v5, v5, v126
    v_mov_b32 v120, v5
    v_mov_b32 v121, v6
    s_mov_b32 s25, 32
L_M_round:
    v_lshlrev_b32 v3, 4, v0
    v_cmp_gt_u32 s[74:75], s25, v0
L_M7_rp:
    s_mov_b32 s36, 0x19b000
    buffer_load_dwordx4 v[44:47], v3, s[8:11], s36 offen sc1
    s_add_u32 s32, s32, 1
    v_mov_b32 v5, 0
    s_waitcnt vmcnt(0)
    v_max3_u32 v5, v5, v44, v45
    v_max3_u32 v5, v5, v46, v47
    v_cndmask_b32 v5, 0, v5, s[74:75]
    s_cmp_gt_u32 s32, 200000
    s_cbranch_scc1 L_M7_rp_ok
    v_cmp_eq_u32 vcc, -1, v5
    s_cbranch_vccnz L_M7_rp
L_M7_rp_ok:
    v_add_f32 v44, v44, v45
    v_add_f32 v46, v46, v47
    v_add_f32 v44, v44, v46
    v_cvt_pk_bf16_f32 v5, v44, v44
    v_lshlrev_b32 v44, 16, v5
    v_ashrrev_i32 v5, 31, v44
    v_or_b32 v5, 0x80000000, v5
    v_xor_b32 v5, v5, v44
    v_and_b32 v5, 0xffff0000, v5
    v_sub_u32 v6, 255, v0
    v_or_b32 v127, v5, v6
    v_cndmask_b32 v127, 0, v127, s[74:75]
    v_max_u32 v5, v120, v127
    v_med3_u32 v6, v120, v121, v127
    s_nop 0
    v_mov_b32_dpp v7, v5 quad_perm:[1,0,3,2] row_mask:0xf bank_mask:0xf
    v_mov_b32_dpp v8, v6 quad_perm:[1,0,3,2] row_mask:0xf bank_mask:0xf
    v_min_u32 v9, v5, v7
    v_max_u32 v5, v5, v7
    v_max3_u32 v6, v6, v8, v9
    s_nop 0
    v_mov_b32_dpp v7, v5 quad_perm:[2,3,0,1] row_mask:0xf bank_mask:0xf
    v_mov_b32_dpp v8, v6 quad_perm:[2,3,0,1] row_mask:0xf bank_mask:0xf
    v_min_u32 v9, v5, v7
    v_max_u32 v5, v5, v7
    v_max3_u32 v6, v6, v8, v9
    s_nop 0
    v_mov_b32_dpp v7, v5 row_half_mirror row_mask:0xf bank_mask:0xf
    v_mov_b32_dpp v8, v6 row_half_mirror row_mask:0xf bank_mask:0xf
    v_min_u32 v9, v5, v7
    v_max_u32 v5, v5, v7
    v_max3_u32 v6, v6, v8, v9
    s_nop 0
    v_mov_b32_dpp v7, v5 row_mirror row_mask:0xf bank_mask:0xf
    v_mov_b32_dpp v8, v6 row_mirror row_mask:0xf bank_mask:0xf
    v_min_u32 v9, v5, v7
    v_max_u32 v5, v5, v7
    v_max3_u32 v6, v6, v8, v9
    v_lshrrev_b32 v9, 4, v0
    v_lshlrev_b32 v9, 3, v9
    s_barrier
    ds_write2_b32 v9, v5, v6 offset0:0 offset1:1
    v_and_b32 v9, 15, v0
    v_lshlrev_b32 v9, 3, v9
    s_waitcnt lgkmcnt(0)
    s_barrier
    ds_read2_b32 v[10:11], v9 offset0:0 offset1:1
    s_waitcnt lgkmcnt(0)
    v_mov_b32 v5, v10
    v_mov_b32 v6, v11
    s_nop 0
    v_mov_b32_dpp v7, v5 quad_perm:[1,0,3,2] row_mask:0xf bank_mask:0xf
    v_mov_b32_dpp v8, v6 quad_perm:[1,0,3,2] row_mask:0xf bank_mask:0xf
    v_min_u32 v9, v5, v7
    v_max_u32 v5, v5, v7
    v_max3_u32 v6, v6, v8, v9
    s_nop 0
    v_mov_b32_dpp v7, v5 quad_perm:[2,3,0,1] row_mask:0xf bank_mask:0xf
    v_mov_b32_dpp v8, v6 quad_perm:[2,3,0,1] row_mask:0xf bank_mask:0xf
    v_min_u32 v9, v5, v7
    v_max_u32 v5, v5, v7
    v_max3_u32 v6, v6, v8, v9
    s_nop 0
    v_mov_b32_dpp v7, v5 row_half_mirror row_mask:0xf bank_mask:0xf
    v_mov_b32_dpp v8, v6 row_half_mirror row_mask:0xf bank_mask:0xf
    v_min_u32 v9, v5, v7
    v_max_u32 v5, v5, v7
    v_max3_u32 v6, v6, v8, v9
    s_nop 0
    v_mov_b32_dpp v7, v5 row_mirror row_mask:0xf bank_mask:0xf
    v_mov_b32_dpp v8, v6 row_mirror row_mask:0xf bank_mask:0xf
    v_min_u32 v9, v5, v7
    v_max_u32 v5, v5, v7
    v_max3_u32 v6, v6, v8, v9
    v_readfirstlane_b32 s26, v5
    v_readfirstlane_b32 s27, v6
    s_nop 3
    s_cmp_eq_u64 s[26:27], s[28:29]
    s_cbranch_scc1 L_M_next
    s_mov_b64 s[28:29], s[26:27]
    buffer_store_dword v13, v12, s[60:63], 0 offen sc1
    s_and_b32 s36, s26, 0x7ff
    s_sub_u32 s30, 2047, s36
    s_and_b32 s36, s26, 0xffff0000
    s_xor_b32 s37, s36, 0x80000000
    s_xor_b32 s40, s36, 0xffff0000
    s_bitcmp1_b32 s36, 31
    s_cselect_b32 s40, s37, s40
    s_and_b32 s36, s27, 0x7ff
    s_sub_u32 s31, 2047, s36
    s_and_b32 s36, s27, 0xffff0000
    s_xor_b32 s37, s36, 0x80000000
    s_xor_b32 s41, s36, 0xffff0000
    s_bitcmp1_b32 s36, 31
    s_cselect_b32 s41, s37, s41
    v_mov_b32 v8, 0
L_M_rows:
    s_lshl_b32 s36, s30, 4
    s_add_u32 s36, s36, 0x1b8000
    buffer_load_dwordx4 v[16:19], v8, s[8:11], s36 offen sc1
    s_lshl_b32 s36, s31, 4
    s_add_u32 s36, s36, 0x1b8000
    buffer_load_dwordx4 v[20:23], v8, s[8:11], s36 offen sc1
    s_add_u32 s32, s32, 1
    s_cmp_gt_u32 s32, 200000
    s_waitcnt vmcnt(0)
    v_or3_b32 v5, v16, v17, v18
    v_or3_b32 v5, v5, v19, v20
    v_or3_b32 v5, v5, v21, v22
    v_or_b32 v5, v5, v23
    s_cbranch_scc1 L_M_rows_ok
    v_cmp_ne_u32 vcc, 0, v5
    s_cbranch_vccnz L_M_rows
L_M_rows_ok:
    v_bfe_u32 v9, v0, 6, 1
    v_cmp_ne_u32 vcc, 0, v9
    v_mov_b32 v5, s30
    v_mov_b32 v6, s31
    v_cndmask_b32 v7, v5, v6, vcc
    v_lshlrev_b32 v7, 10, v7
    v_and_b32 v8, 63, v0
    v_lshl_add_u32 v7, v8, 4, v7
    s_mov_b32 s37, 0x600000
    buffer_load_dwordx4 v[16:19], v7, s[8:11], s37 offen sc1
    v_bfe_u32 v9, v0, 3, 1
    v_cmp_ne_u32 vcc, 0, v9
    s_nop 1
    v_cndmask_b32 v12, v5, v6, vcc
    v_mov_b32 v5, s40
    v_mov_b32 v6, s41
    v_cndmask_b32 v11, v5, v6, vcc
    v_lshlrev_b32 v12, 10, v12
    v_and_b32 v3, 7, v0
    v_lshl_add_u32 v12, v3, 2, v12
    s_lshl_b32 s36, s20, 5
    v_add_u32 v12, s36, v12
    v_mov_b32 v7, 0x40000000
    v_cmp_lt_u32 vcc, 15, v0
    s_nop 1
    v_cndmask_b32 v12, v12, v7, vcc
    s_mov_b32 s36, 0x400000
    buffer_load_dword v14, v12, s[8:11], s36 offen sc1
    buffer_load_dword v15, v12, s[8:11], s37 offen sc1
    v_and_b32 v8, 127, v0
    v_lshlrev_b32 v8, 4, v8
    s_waitcnt vmcnt(2)
    ds_write_b128 v8, v[16:19] offset:4096
    s_waitcnt lgkmcnt(0)
    s_barrier
    v_mov_b64 v[48:49], 0
    v_mov_b64 v[50:51], 0
    v_mov_b64 v[52:53], 0
    v_mov_b64 v[54:55], 0
    v_lshlrev_b32 v8, 7, v1
    ds_read_b128 v[16:19], v8 offset:4096
    ds_read_b128 v[20:23], v8 offset:4112
    ds_read_b128 v[24:27], v8 offset:4128
    ds_read_b128 v[28:31], v8 offset:4144
    ds_read_b128 v[32:35], v8 offset:5120
    ds_read_b128 v[36:39], v8 offset:5136
    ds_read_b128 v[40:43], v8 offset:5152
    ds_read_b128 v[44:47], v8 offset:5168
    s_waitcnt lgkmcnt(0)
    v_dot2_f32_bf16 v48, v16, v128, v48
    v_dot2_f32_bf16 v49, v16, v160, v49
    v_dot2_f32_bf16 v50, v32, v128, v50
    v_dot2_f32_bf16 v51, v32, v160, v51
    v_dot2_f32_bf16 v52, v16, v192, v52
    v_dot2_f32_bf16 v53, v16, v224, v53
    v_dot2_f32_bf16 v54, v32, v192, v54
    v_dot2_f32_bf16 v55, v32, v224, v55
    v_dot2_f32_bf16 v48, v17, v129, v48
    v_dot2_f32_bf16 v49, v17, v161, v49
    v_dot2_f32_bf16 v50, v33, v129, v50
    v_dot2_f32_bf16 v51, v33, v161, v51
    v_dot2_f32_bf16 v52, v17, v193, v52
    v_dot2_f32_bf16 v53, v17, v225, v53
    v_dot2_f32_bf16 v54, v33, v193, v54
    v_dot2_f32_bf16 v55, v33, v225, v55
    v_dot2_f32_bf16 v48, v18, v130, v48
    v_dot2_f32_bf16 v49, v18, v162, v49
    v_dot2_f32_bf16 v50, v34, v130, v50
    v_dot2_f32_bf16 v51, v34, v162, v51
    v_dot2_f32_bf16 v52, v18, v194, v52
    v_dot2_f32_bf16 v53, v18, v226, v53
    v_dot2_f32_bf16 v54, v34, v194, v54
    v_dot2_f32_bf16 v55, v34, v226, v55
    v_dot2_f32_bf16 v48, v19, v131, v48
    v_dot2_f32_bf16 v49, v19, v163, v49
    v_dot2_f32_bf16 v50, v35, v131, v50
    v_dot2_f32_bf16 v51, v35, v163, v51
    v_dot2_f32_bf16 v52, v19, v195, v52
    v_dot2_f32_bf16 v53, v19, v227, v53
    v_dot2_f32_bf16 v54, v35, v195, v54
    v_dot2_f32_bf16 v55, v35, v227, v55
    v_dot2_f32_bf16 v48, v20, v132, v48
    v_dot2_f32_bf16 v49, v20, v164, v49
    v_dot2_f32_bf16 v50, v36, v132, v50
    v_dot2_f32_bf16 v51, v36, v164, v51
    v_dot2_f32_bf16 v52, v20, v196, v52
    v_dot2_f32_bf16 v53, v20, v228, v53
    v_dot2_f32_bf16 v54, v36, v196, v54
    v_dot2_f32_bf16 v55, v36, v228, v55
    v_dot2_f32_bf16 v48, v21, v133, v48
    v_dot2_f32_bf16 v49, v21, v165, v49
    v_dot2_f32_bf16 v50, v37, v133, v50
    v_dot2_f32_bf16 v51, v37, v165, v51
    v_dot2_f32_bf16 v52, v21, v197, v52
    v_dot2_f32_bf16 v53, v21, v229, v53
    v_dot2_f32_bf16 v54, v37, v197, v54
    v_dot2_f32_bf16 v55, v37, v229, v55
    v_dot2_f32_bf16 v48, v22, v134, v48
    v_dot2_f32_bf16 v49, v22, v166, v49
    v_dot2_f32_bf16 v50, v38, v134, v50
    v_dot2_f32_bf16 v51, v38, v166, v51
    v_dot2_f32_bf16 v52, v22, v198, v52
    v_dot2_f32_bf16 v53, v22, v230, v53
    v_dot2_f32_bf16 v54, v38, v198, v54
    v_dot2_f32_bf16 v55, v38, v230, v55
    v_dot2_f32_bf16 v48, v23, v135, v48
    v_dot2_f32_bf16 v49, v23, v167, v49
    v_dot2_f32_bf16 v50, v39, v135, v50
    v_dot2_f32_bf16 v51, v39, v167, v51
    v_dot2_f32_bf16 v52, v23, v199, v52
    v_dot2_f32_bf16 v53, v23, v231, v53
    v_dot2_f32_bf16 v54, v39, v199, v54
    v_dot2_f32_bf16 v55, v39, v231, v55
    v_dot2_f32_bf16 v48, v24, v136, v48
    v_dot2_f32_bf16 v49, v24, v168, v49
    v_dot2_f32_bf16 v50, v40, v136, v50
    v_dot2_f32_bf16 v51, v40, v168, v51
    v_dot2_f32_bf16 v52, v24, v200, v52
    v_dot2_f32_bf16 v53, v24, v232, v53
    v_dot2_f32_bf16 v54, v40, v200, v54
    v_dot2_f32_bf16 v55, v40, v232, v55
    v_dot2_f32_bf16 v48, v25, v137, v48
    v_dot2_f32_bf16 v49, v25, v169, v49
    v_dot2_f32_bf16 v50, v41, v137, v50
    v_dot2_f32_bf16 v51, v41, v169, v51
    v_dot2_f32_bf16 v52, v25, v201, v52
    v_dot2_f32_bf16 v53, v25, v233, v53
    v_dot2_f32_bf16 v54, v41, v201, v54
    v_dot2_f32_bf16 v55, v41, v233, v55
    v_dot2_f32_bf16 v48, v26, v138, v48
    v_dot2_f32_bf16 v49, v26, v170, v49
    v_dot2_f32_bf16 v50, v42, v138, v50
    v_dot2_f32_bf16 v51, v42, v170, v51
    v_dot2_f32_bf16 v52, v26, v202, v52
    v_dot2_f32_bf16 v53, v26, v234, v53
    v_dot2_f32_bf16 v54, v42, v202, v54
    v_dot2_f32_bf16 v55, v42, v234, v55
    v_dot2_f32_bf16 v48, v27, v139, v48
    v_dot2_f32_bf16 v49, v27, v171, v49
    v_dot2_f32_bf16 v50, v43, v139, v50
    v_dot2_f32_bf16 v51, v43, v171, v51
    v_dot2_f32_bf16 v52, v27, v203, v52
    v_dot2_f32_bf16 v53, v27, v235, v53
    v_dot2_f32_bf16 v54, v43, v203, v54
    v_dot2_f32_bf16 v55, v43, v235, v55
    v_dot2_f32_bf16 v48, v28, v140, v48
    v_dot2_f32_bf16 v49, v28, v172, v49
    v_dot2_f32_bf16 v50, v44, v140, v50
    v_dot2_f32_bf16 v51, v44, v172, v51
    v_dot2_f32_bf16 v52, v28, v204, v52
    v_dot2_f32_bf16 v53, v28, v236, v53
    v_dot2_f32_bf16 v54, v44, v204, v54
    v_dot2_f32_bf16 v55, v44, v236, v55
    v_dot2_f32_bf16 v48, v29, v141, v48
    v_dot2_f32_bf16 v49, v29, v173, v49
    v_dot2_f32_bf16 v50, v45, v141, v50
    v_dot2_f32_bf16 v51, v45, v173, v51
    v_dot2_f32_bf16 v52, v29, v205, v52
    v_dot2_f32_bf16 v53, v29, v237, v53
    v_dot2_f32_bf16 v54, v45, v205, v54
    v_dot2_f32_bf16 v55, v45, v237, v55
    v_dot2_f32_bf16 v48, v30, v142, v48
    v_dot2_f32_bf16 v49, v30, v174, v49
    v_dot2_f32_bf16 v50, v46, v142, v50
    v_dot2_f32_bf16 v51, v46, v174, v51
    v_dot2_f32_bf16 v52, v30, v206, v52
    v_dot2_f32_bf16 v53, v30, v238, v53
    v_dot2_f32_bf16 v54, v46, v206, v54
    v_dot2_f32_bf16 v55, v46, v238, v55
    v_dot2_f32_bf16 v48, v31, v143, v48
    v_dot2_f32_bf16 v49, v31, v175, v49
    v_dot2_f32_bf16 v50, v47, v143, v50
    v_dot2_f32_bf16 v51, v47, v175, v51
    v_dot2_f32_bf16 v52, v31, v207, v52
    v_dot2_f32_bf16 v53, v31, v239, v53
    v_dot2_f32_bf16 v54, v47, v207, v54
    v_dot2_f32_bf16 v55, v47, v239, v55
    ds_read_b128 v[16:19], v8 offset:4160
    ds_read_b128 v[20:23], v8 offset:4176
    ds_read_b128 v[24:27], v8 offset:4192
    ds_read_b128 v[28:31], v8 offset:4208
    ds_read_b128 v[32:35], v8 offset:5184
    ds_read_b128 v[36:39], v8 offset:5200
    ds_read_b128 v[40:43], v8 offset:5216
    ds_read_b128 v[44:47], v8 offset:5232
    s_waitcnt lgkmcnt(0)
    v_dot2_f32_bf16 v48, v16, v144, v48
    v_dot2_f32_bf16 v49, v16, v176, v49
    v_dot2_f32_bf16 v50, v32, v144, v50
    v_dot2_f32_bf16 v51, v32, v176, v51
    v_dot2_f32_bf16 v52, v16, v208, v52
    v_dot2_f32_bf16 v53, v16, v240, v53
    v_dot2_f32_bf16 v54, v32, v208, v54
    v_dot2_f32_bf16 v55, v32, v240, v55
    v_dot2_f32_bf16 v48, v17, v145, v48
    v_dot2_f32_bf16 v49, v17, v177, v49
    v_dot2_f32_bf16 v50, v33, v145, v50
    v_dot2_f32_bf16 v51, v33, v177, v51
    v_dot2_f32_bf16 v52, v17, v209, v52
    v_dot2_f32_bf16 v53, v17, v241, v53
    v_dot2_f32_bf16 v54, v33, v209, v54
    v_dot2_f32_bf16 v55, v33, v241, v55
    v_dot2_f32_bf16 v48, v18, v146, v48
    v_dot2_f32_bf16 v49, v18, v178, v49
    v_dot2_f32_bf16 v50, v34, v146, v50
    v_dot2_f32_bf16 v51, v34, v178, v51
    v_dot2_f32_bf16 v52, v18, v210, v52
    v_dot2_f32_bf16 v53, v18, v242, v53
    v_dot2_f32_bf16 v54, v34, v210, v54
    v_dot2_f32_bf16 v55, v34, v242, v55
    v_dot2_f32_bf16 v48, v19, v147, v48
    v_dot2_f32_bf16 v49, v19, v179, v49
    v_dot2_f32_bf16 v50, v35, v147, v50
    v_dot2_f32_bf16 v51, v35, v179, v51
    v_dot2_f32_bf16 v52, v19, v211, v52
    v_dot2_f32_bf16 v53, v19, v243, v53
    v_dot2_f32_bf16 v54, v35, v211, v54
    v_dot2_f32_bf16 v55, v35, v243, v55
    v_dot2_f32_bf16 v48, v20, v148, v48
    v_dot2_f32_bf16 v49, v20, v180, v49
    v_dot2_f32_bf16 v50, v36, v148, v50
    v_dot2_f32_bf16 v51, v36, v180, v51
    v_dot2_f32_bf16 v52, v20, v212, v52
    v_dot2_f32_bf16 v53, v20, v244, v53
    v_dot2_f32_bf16 v54, v36, v212, v54
    v_dot2_f32_bf16 v55, v36, v244, v55
    v_dot2_f32_bf16 v48, v21, v149, v48
    v_dot2_f32_bf16 v49, v21, v181, v49
    v_dot2_f32_bf16 v50, v37, v149, v50
    v_dot2_f32_bf16 v51, v37, v181, v51
    v_dot2_f32_bf16 v52, v21, v213, v52
    v_dot2_f32_bf16 v53, v21, v245, v53
    v_dot2_f32_bf16 v54, v37, v213, v54
    v_dot2_f32_bf16 v55, v37, v245, v55
    v_dot2_f32_bf16 v48, v22, v150, v48
    v_dot2_f32_bf16 v49, v22, v182, v49
    v_dot2_f32_bf16 v50, v38, v150, v50
    v_dot2_f32_bf16 v51, v38, v182, v51
    v_dot2_f32_bf16 v52, v22, v214, v52
    v_dot2_f32_bf16 v53, v22, v246, v53
    v_dot2_f32_bf16 v54, v38, v214, v54
    v_dot2_f32_bf16 v55, v38, v246, v55
    v_dot2_f32_bf16 v48, v23, v151, v48
    v_dot2_f32_bf16 v49, v23, v183, v49
    v_dot2_f32_bf16 v50, v39, v151, v50
    v_dot2_f32_bf16 v51, v39, v183, v51
    v_dot2_f32_bf16 v52, v23, v215, v52
    v_dot2_f32_bf16 v53, v23, v247, v53
    v_dot2_f32_bf16 v54, v39, v215, v54
    v_dot2_f32_bf16 v55, v39, v247, v55
    v_dot2_f32_bf16 v48, v24, v152, v48
    v_dot2_f32_bf16 v49, v24, v184, v49
    v_dot2_f32_bf16 v50, v40, v152, v50
    v_dot2_f32_bf16 v51, v40, v184, v51
    v_dot2_f32_bf16 v52, v24, v216, v52
    v_dot2_f32_bf16 v53, v24, v248, v53
    v_dot2_f32_bf16 v54, v40, v216, v54
    v_dot2_f32_bf16 v55, v40, v248, v55
    v_dot2_f32_bf16 v48, v25, v153, v48
    v_dot2_f32_bf16 v49, v25, v185, v49
    v_dot2_f32_bf16 v50, v41, v153, v50
    v_dot2_f32_bf16 v51, v41, v185, v51
    v_dot2_f32_bf16 v52, v25, v217, v52
    v_dot2_f32_bf16 v53, v25, v249, v53
    v_dot2_f32_bf16 v54, v41, v217, v54
    v_dot2_f32_bf16 v55, v41, v249, v55
    v_dot2_f32_bf16 v48, v26, v154, v48
    v_dot2_f32_bf16 v49, v26, v186, v49
    v_dot2_f32_bf16 v50, v42, v154, v50
    v_dot2_f32_bf16 v51, v42, v186, v51
    v_dot2_f32_bf16 v52, v26, v218, v52
    v_dot2_f32_bf16 v53, v26, v250, v53
    v_dot2_f32_bf16 v54, v42, v218, v54
    v_dot2_f32_bf16 v55, v42, v250, v55
    v_dot2_f32_bf16 v48, v27, v155, v48
    v_dot2_f32_bf16 v49, v27, v187, v49
    v_dot2_f32_bf16 v50, v43, v155, v50
    v_dot2_f32_bf16 v51, v43, v187, v51
    v_dot2_f32_bf16 v52, v27, v219, v52
    v_dot2_f32_bf16 v53, v27, v251, v53
    v_dot2_f32_bf16 v54, v43, v219, v54
    v_dot2_f32_bf16 v55, v43, v251, v55
    v_dot2_f32_bf16 v48, v28, v156, v48
    v_dot2_f32_bf16 v49, v28, v188, v49
    v_dot2_f32_bf16 v50, v44, v156, v50
    v_dot2_f32_bf16 v51, v44, v188, v51
    v_dot2_f32_bf16 v52, v28, v220, v52
    v_dot2_f32_bf16 v53, v28, v252, v53
    v_dot2_f32_bf16 v54, v44, v220, v54
    v_dot2_f32_bf16 v55, v44, v252, v55
    v_dot2_f32_bf16 v48, v29, v157, v48
    v_dot2_f32_bf16 v49, v29, v189, v49
    v_dot2_f32_bf16 v50, v45, v157, v50
    v_dot2_f32_bf16 v51, v45, v189, v51
    v_dot2_f32_bf16 v52, v29, v221, v52
    v_dot2_f32_bf16 v53, v29, v253, v53
    v_dot2_f32_bf16 v54, v45, v221, v54
    v_dot2_f32_bf16 v55, v45, v253, v55
    v_dot2_f32_bf16 v48, v30, v158, v48
    v_dot2_f32_bf16 v49, v30, v190, v49
    v_dot2_f32_bf16 v50, v46, v158, v50
    v_dot2_f32_bf16 v51, v46, v190, v51
    v_dot2_f32_bf16 v52, v30, v222, v52
    v_dot2_f32_bf16 v53, v30, v254, v53
    v_dot2_f32_bf16 v54, v46, v222, v54
    v_dot2_f32_bf16 v55, v46, v254, v55
    v_dot2_f32_bf16 v48, v31, v159, v48
    v_dot2_f32_bf16 v49, v31, v191, v49
    v_dot2_f32_bf16 v50, v47, v159, v50
    v_dot2_f32_bf16 v51, v47, v191, v51
    v_dot2_f32_bf16 v52, v31, v223, v52
    v_dot2_f32_bf16 v53, v31, v255, v53
    v_dot2_f32_bf16 v54, v47, v223, v54
    v_dot2_f32_bf16 v55, v47, v255, v55
    s_nop 3
    v_lshlrev_b32 v7, 5, v0
    ds_write_b128 v7, v[48:51] offset:8192
    ds_write_b128 v7, v[52:55] offset:8208
    s_waitcnt lgkmcnt(0)
    s_barrier
    v_lshlrev_b32 v7, 5, v2
    v_bfe_u32 v8, v0, 5, 1
    v_lshl_add_u32 v7, v8, 3, v7
    ds_read_b64 v[16:17], v7 offset:8192
    ds_read_b64 v[18:19], v7 offset:8208
    ds_read_b64 v[20:21], v7 offset:9216
    ds_read_b64 v[22:23], v7 offset:9232
    ds_read_b64 v[24:25], v7 offset:10240
    ds_read_b64 v[26:27], v7 offset:10256
    ds_read_b64 v[28:29], v7 offset:11264
    ds_read_b64 v[30:31], v7 offset:11280
    s_waitcnt lgkmcnt(0)
    ds_read_b64 v[32:33], v7 offset:12288
    ds_read_b64 v[34:35], v7 offset:12304
    ds_read_b64 v[36:37], v7 offset:13312
    ds_read_b64 v[38:39], v7 offset:13328
    ds_read_b64 v[40:41], v7 offset:14336
    ds_read_b64 v[42:43], v7 offset:14352
    ds_read_b64 v[44:45], v7 offset:15360
    ds_read_b64 v[46:47], v7 offset:15376
    s_waitcnt lgkmcnt(0)
    v_add_f32 v16, v16, v20
    v_add_f32 v16, v16, v24
    v_add_f32 v16, v16, v28
    v_add_f32 v16, v16, v32
    v_add_f32 v16, v16, v36
    v_add_f32 v16, v16, v40
    v_add_f32 v16, v16, v44
    v_cvt_pk_bf16_f32 v5, v16, v16
    v_lshlrev_b32 v16, 16, v5
    v_add_f32 v17, v17, v21
    v_add_f32 v17, v17, v25
    v_add_f32 v17, v17, v29
    v_add_f32 v17, v17, v33
    v_add_f32 v17, v17, v37
    v_add_f32 v17, v17, v41
    v_add_f32 v17, v17, v45
    v_cvt_pk_bf16_f32 v5, v17, v17
    v_lshlrev_b32 v17, 16, v5
    v_add_f32 v18, v18, v22
    v_add_f32 v18, v18, v26
    v_add_f32 v18, v18, v30
    v_add_f32 v18, v18, v34
    v_add_f32 v18, v18, v38
    v_add_f32 v18, v18, v42
    v_add_f32 v18, v18, v46
    v_cvt_pk_bf16_f32 v5, v18, v18
    v_lshlrev_b32 v18, 16, v5
    v_add_f32 v19, v19, v23
    v_add_f32 v19, v19, v27
    v_add_f32 v19, v19, v31
    v_add_f32 v19, v19, v35
    v_add_f32 v19, v19, v39
    v_add_f32 v19, v19, v43
    v_add_f32 v19, v19, v47
    v_cvt_pk_bf16_f32 v5, v19, v19
    v_lshlrev_b32 v19, 16, v5
    v_mul_f32 v6, 0xbfb8aa3b, v16
    v_exp_f32 v6, v6
    s_nop 0
    v_add_f32 v6, 1.0, v6
    v_rcp_f32 v6, v6
    s_nop 0
    v_mul_f32 v16, v16, v6
    v_cvt_pk_bf16_f32 v5, v16, v16
    v_lshlrev_b32 v16, 16, v5
    v_mul_f32 v16, v16, v18
    v_mul_f32 v6, 0xbfb8aa3b, v17
    v_exp_f32 v6, v6
    s_nop 0
    v_add_f32 v6, 1.0, v6
    v_rcp_f32 v6, v6
    s_nop 0
    v_mul_f32 v17, v17, v6
    v_cvt_pk_bf16_f32 v5, v17, v17
    v_lshlrev_b32 v17, 16, v5
    v_mul_f32 v17, v17, v19
    v_cvt_pk_bf16_f32 v16, v16, v17
    v_mul_u32_u24 v8, 3584, v8
    v_lshl_add_u32 v7, v2, 2, v8
    v_mov_b32 v6, 0x40000000
    v_cmp_lt_u32 vcc, 27, v2
    s_nop 1
    v_cndmask_b32 v7, v7, v6, vcc
    v_cmp_lt_u32 vcc, 63, v0
    s_nop 1
    v_cndmask_b32 v7, v7, v6, vcc
    s_mul_i32 s37, s24, 8192
    s_add_u32 s37, s37, 0x1b0000
    s_add_u32 s36, s37, s23
    buffer_store_dword v16, v7, s[8:11], s36 offen sc1
    v_lshlrev_b32 v7, 4, v0
    v_add_u32 v8, 4096, v7
    v_cmp_lt_u32 vcc, 191, v0
    s_nop 1
    v_cndmask_b32 v8, v8, v6, vcc
L_M_act:
    buffer_load_dwordx4 v[20:23], v7, s[8:11], s37 offen sc1
    buffer_load_dwordx4 v[24:27], v8, s[8:11], s37 offen sc1
    s_add_u32 s32, s32, 1
    s_cmp_gt_u32 s32, 200000
    s_waitcnt vmcnt(0)
    v_max3_u32 v5, v20, v21, v22
    v_max3_u32 v5, v5, v23, v24
    v_max3_u32 v5, v5, v25, v26
    v_max_u32 v5, v5, v27
    s_cbranch_scc1 L_M_act_ok
    v_cmp_eq_u32 vcc, -1, v5
    s_cbranch_vccnz L_M_act
L_M_act_ok:
    ds_write_b128 v7, v[20:23] offset:16384
    ds_write_b128 v7, v[24:27] offset:20480
    s_waitcnt lgkmcnt(0)
    s_barrier
    v_lshrrev_b32 v7, 3, v0
    v_mul_u32_u24 v7, 112, v7
    v_mov_b64 v[48:49], 0
    v_mov_b64 v[50:51], 0
    ds_read_b128 v[16:19], v7 offset:16384
    ds_read_b128 v[20:23], v7 offset:16400
    ds_read_b128 v[24:27], v7 offset:16416
    ds_read_b128 v[28:31], v7 offset:16432
    ds_read_b128 v[32:35], v7 offset:16448
    ds_read_b128 v[36:39], v7 offset:16464
    ds_read_b128 v[40:43], v7 offset:16480
    s_waitcnt lgkmcnt(0)
    v_dot2_f32_bf16 v48, v16, v64, v48
    v_dot2_f32_bf16 v49, v16, v92, v49
    v_dot2_f32_bf16 v48, v17, v65, v48
    v_dot2_f32_bf16 v49, v17, v93, v49
    v_dot2_f32_bf16 v48, v18, v66, v48
    v_dot2_f32_bf16 v49, v18, v94, v49
    v_dot2_f32_bf16 v48, v19, v67, v48
    v_dot2_f32_bf16 v49, v19, v95, v49
    v_dot2_f32_bf16 v48, v20, v68, v48
    v_dot2_f32_bf16 v49, v20, v96, v49
    v_dot2_f32_bf16 v48, v21, v69, v48
    v_dot2_f32_bf16 v49, v21, v97, v49
    v_dot2_f32_bf16 v48, v22, v70, v48
    v_dot2_f32_bf16 v49, v22, v98, v49
    v_dot2_f32_bf16 v48, v23, v71, v48
    v_dot2_f32_bf16 v49, v23, v99, v49
    v_dot2_f32_bf16 v48, v24, v72, v48
    v_dot2_f32_bf16 v49, v24, v100, v49
    v_dot2_f32_bf16 v48, v25, v73, v48
    v_dot2_f32_bf16 v49, v25, v101, v49
    v_dot2_f32_bf16 v48, v26, v74, v48
    v_dot2_f32_bf16 v49, v26, v102, v49
    v_dot2_f32_bf16 v48, v27, v75, v48
    v_dot2_f32_bf16 v49, v27, v103, v49
    v_dot2_f32_bf16 v48, v28, v76, v48
    v_dot2_f32_bf16 v49, v28, v104, v49
    v_dot2_f32_bf16 v48, v29, v77, v48
    v_dot2_f32_bf16 v49, v29, v105, v49
    v_dot2_f32_bf16 v48, v30, v78, v48
    v_dot2_f32_bf16 v49, v30, v106, v49
    v_dot2_f32_bf16 v48, v31, v79, v48
    v_dot2_f32_bf16 v49, v31, v107, v49
    v_dot2_f32_bf16 v48, v32, v80, v48
    v_dot2_f32_bf16 v49, v32, v108, v49
    v_dot2_f32_bf16 v48, v33, v81, v48
    v_dot2_f32_bf16 v49, v33, v109, v49
    v_dot2_f32_bf16 v48, v34, v82, v48
    v_dot2_f32_bf16 v49, v34, v110, v49
    v_dot2_f32_bf16 v48, v35, v83, v48
    v_dot2_f32_bf16 v49, v35, v111, v49
    v_dot2_f32_bf16 v48, v36, v84, v48
    v_dot2_f32_bf16 v49, v36, v112, v49
    v_dot2_f32_bf16 v48, v37, v85, v48
    v_dot2_f32_bf16 v49, v37, v113, v49
    v_dot2_f32_bf16 v48, v38, v86, v48
    v_dot2_f32_bf16 v49, v38, v114, v49
    v_dot2_f32_bf16 v48, v39, v87, v48
    v_dot2_f32_bf16 v49, v39, v115, v49
    v_dot2_f32_bf16 v48, v40, v88, v48
    v_dot2_f32_bf16 v49, v40, v116, v49
    v_dot2_f32_bf16 v48, v41, v89, v48
    v_dot2_f32_bf16 v49, v41, v117, v49
    v_dot2_f32_bf16 v48, v42, v90, v48
    v_dot2_f32_bf16 v49, v42, v118, v49
    v_dot2_f32_bf16 v48, v43, v91, v48
    v_dot2_f32_bf16 v49, v43, v119, v49
    ds_read_b128 v[16:19], v7 offset:19968
    ds_read_b128 v[20:23], v7 offset:19984
    ds_read_b128 v[24:27], v7 offset:20000
    ds_read_b128 v[28:31], v7 offset:20016
    ds_read_b128 v[32:35], v7 offset:20032
    ds_read_b128 v[36:39], v7 offset:20048
    ds_read_b128 v[40:43], v7 offset:20064
    s_waitcnt lgkmcnt(0)
    v_dot2_f32_bf16 v50, v16, v64, v50
    v_dot2_f32_bf16 v51, v16, v92, v51
    v_dot2_f32_bf16 v50, v17, v65, v50
    v_dot2_f32_bf16 v51, v17, v93, v51
    v_dot2_f32_bf16 v50, v18, v66, v50
    v_dot2_f32_bf16 v51, v18, v94, v51
    v_dot2_f32_bf16 v50, v19, v67, v50
    v_dot2_f32_bf16 v51, v19, v95, v51
    v_dot2_f32_bf16 v50, v20, v68, v50
    v_dot2_f32_bf16 v51, v20, v96, v51
    v_dot2_f32_bf16 v50, v21, v69, v50
    v_dot2_f32_bf16 v51, v21, v97, v51
    v_dot2_f32_bf16 v50, v22, v70, v50
    v_dot2_f32_bf16 v51, v22, v98, v51
    v_dot2_f32_bf16 v50, v23, v71, v50
    v_dot2_f32_bf16 v51, v23, v99, v51
    v_dot2_f32_bf16 v50, v24, v72, v50
    v_dot2_f32_bf16 v51, v24, v100, v51
    v_dot2_f32_bf16 v50, v25, v73, v50
    v_dot2_f32_bf16 v51, v25, v101, v51
    v_dot2_f32_bf16 v50, v26, v74, v50
    v_dot2_f32_bf16 v51, v26, v102, v51
    v_dot2_f32_bf16 v50, v27, v75, v50
    v_dot2_f32_bf16 v51, v27, v103, v51
    v_dot2_f32_bf16 v50, v28, v76, v50
    v_dot2_f32_bf16 v51, v28, v104, v51
    v_dot2_f32_bf16 v50, v29, v77, v50
    v_dot2_f32_bf16 v51, v29, v105, v51
    v_dot2_f32_bf16 v50, v30, v78, v50
    v_dot2_f32_bf16 v51, v30, v106, v51
    v_dot2_f32_bf16 v50, v31, v79, v50
    v_dot2_f32_bf16 v51, v31, v107, v51
    v_dot2_f32_bf16 v50, v32, v80, v50
    v_dot2_f32_bf16 v51, v32, v108, v51
    v_dot2_f32_bf16 v50, v33, v81, v50
    v_dot2_f32_bf16 v51, v33, v109, v51
    v_dot2_f32_bf16 v50, v34, v82, v50
    v_dot2_f32_bf16 v51, v34, v110, v51
    v_dot2_f32_bf16 v50, v35, v83, v50
    v_dot2_f32_bf16 v51, v35, v111, v51
    v_dot2_f32_bf16 v50, v36, v84, v50
    v_dot2_f32_bf16 v51, v36, v112, v51
    v_dot2_f32_bf16 v50, v37, v85, v50
    v_dot2_f32_bf16 v51, v37, v113, v51
    v_dot2_f32_bf16 v50, v38, v86, v50
    v_dot2_f32_bf16 v51, v38, v114, v51
    v_dot2_f32_bf16 v50, v39, v87, v50
    v_dot2_f32_bf16 v51, v39, v115, v51
    v_dot2_f32_bf16 v50, v40, v88, v50
    v_dot2_f32_bf16 v51, v40, v116, v51
    v_dot2_f32_bf16 v50, v41, v89, v50
    v_dot2_f32_bf16 v51, v41, v117, v51
    v_dot2_f32_bf16 v50, v42, v90, v50
    v_dot2_f32_bf16 v51, v42, v118, v51
    v_dot2_f32_bf16 v50, v43, v91, v50
    v_dot2_f32_bf16 v51, v43, v119, v51
    s_nop 3
    v_add_f32_dpp v48, v48, v48 row_ror:8 row_mask:0xf bank_mask:0xf
    v_add_f32_dpp v49, v49, v49 row_ror:8 row_mask:0xf bank_mask:0xf
    v_add_f32_dpp v50, v50, v50 row_ror:8 row_mask:0xf bank_mask:0xf
    v_add_f32_dpp v51, v51, v51 row_ror:8 row_mask:0xf bank_mask:0xf
    v_mov_b32 v5, v48
    s_nop 1
    v_permlane16_swap_b32 v48, v5
    v_add_f32 v48, v48, v5
    v_mov_b32 v5, v49
    s_nop 1
    v_permlane16_swap_b32 v49, v5
    v_add_f32 v49, v49, v5
    v_mov_b32 v5, v50
    s_nop 1
    v_permlane16_swap_b32 v50, v5
    v_add_f32 v50, v50, v5
    v_mov_b32 v5, v51
    s_nop 1
    v_permlane16_swap_b32 v51, v5
    v_add_f32 v51, v51, v5
    v_mov_b32 v5, v48
    s_nop 1
    v_permlane32_swap_b32 v48, v5
    v_add_f32 v48, v48, v5
    v_mov_b32 v5, v49
    s_nop 1
    v_permlane32_swap_b32 v49, v5
    v_add_f32 v49, v49, v5
    v_mov_b32 v5, v50
    s_nop 1
    v_permlane32_swap_b32 v50, v5
    v_add_f32 v50, v50, v5
    v_mov_b32 v5, v51
    s_nop 1
    v_permlane32_swap_b32 v51, v5
    v_add_f32 v51, v51, v5
    v_lshrrev_b32 v7, 6, v0
    v_lshlrev_b32 v7, 7, v7
    v_lshl_add_u32 v7, v3, 4, v7
    ds_write_b128 v7, v[48:51] offset:1024
    s_waitcnt lgkmcnt(0)
    s_barrier
    v_lshlrev_b32 v7, 4, v3
    v_lshl_add_u32 v7, v9, 3, v7
    ds_read_b64 v[16:17], v7 offset:1024
    ds_read_b64 v[18:19], v7 offset:1152
    ds_read_b64 v[20:21], v7 offset:1280
    ds_read_b64 v[22:23], v7 offset:1408
    v_mul_f32 v10, 0xbfb8aa3b, v11
    v_exp_f32 v10, v10
    s_nop 0
    v_add_f32 v10, 1.0, v10
    v_rcp_f32 v10, v10
    s_nop 0
    v_cvt_pk_bf16_f32 v5, v10, v10
    v_lshlrev_b32 v10, 16, v5
    s_waitcnt lgkmcnt(0)
    v_lshlrev_b32 v24, 16, v15
    v_and_b32 v25, 0xffff0000, v15
    v_lshlrev_b32 v26, 16, v14
    v_and_b32 v27, 0xffff0000, v14
    v_add_f32 v16, v16, v18
    v_add_f32 v20, v20, v22
    v_add_f32 v16, v16, v20
    v_cvt_pk_bf16_f32 v5, v16, v16
    v_lshlrev_b32 v16, 16, v5
    v_mul_f32 v16, v16, v10
    v_cvt_pk_bf16_f32 v5, v16, v16
    v_lshlrev_b32 v16, 16, v5
    v_add_f32 v16, v16, v24
    v_cvt_pk_bf16_f32 v5, v16, v16
    v_lshlrev_b32 v16, 16, v5
    v_add_f32 v16, v16, v26
    v_add_f32 v17, v17, v19
    v_add_f32 v21, v21, v23
    v_add_f32 v17, v17, v21
    v_cvt_pk_bf16_f32 v5, v17, v17
    v_lshlrev_b32 v17, 16, v5
    v_mul_f32 v17, v17, v10
    v_cvt_pk_bf16_f32 v5, v17, v17
    v_lshlrev_b32 v17, 16, v5
    v_add_f32 v17, v17, v25
    v_cvt_pk_bf16_f32 v5, v17, v17
    v_lshlrev_b32 v17, 16, v5
    v_add_f32 v17, v17, v27
    v_cvt_pk_bf16_f32 v16, v16, v17
    buffer_store_dword v16, v12, s[60:63], 0 offen sc1
    v_add_f32 v24, v24, v26
    v_add_f32 v25, v25, v27
    v_cvt_pk_bf16_f32 v13, v24, v25
L_M_next:
    s_add_u32 s24, s24, 1
    s_mov_b32 s25, 192
    s_cmp_eq_u32 s24, 1
    s_cbranch_scc1 L_M_round
    s_cmp_eq_u32 s24, 3
    s_cbranch_scc1 L_end
    s_mov_b32 s25, 256
    v_and_b32 v7, 63, v0
    v_lshlrev_b32 v3, 4, v7
    s_mov_b32 s36, 0x19bc00
    v_sub_u32 v7, 63, v7
L_M_fin:
    buffer_load_dwordx4 v[16:19], v3, s[8:11], s36 offen sc1
    s_add_u32 s32, s32, 1
    s_cmp_gt_u32 s32, 200000
    s_cselect_b32 s37, -1, -2
    s_waitcnt vmcnt(0)
    v_max3_u32 v5, v16, v17, v18
    v_max_u32 v5, v5, v19
    v_cmp_lt_u32 vcc, s37, v5
    s_cbranch_vccnz L_M_fin
    v_add_f32 v16, v16, v17
    v_add_f32 v18, v18, v19
    v_add_f32 v16, v16, v18
    v_cvt_pk_bf16_f32 v5, v16, v16
    v_lshlrev_b32 v16, 16, v5
    v_ashrrev_i32 v5, 31, v16
    v_or_b32 v5, 0x80000000, v5
    v_xor_b32 v5, v5, v16
    v_and_or_b32 v5, v5, s42, v7
    v_cmp_lt_u32 vcc, s29, v5
    s_cbranch_vccnz L_M_round
L_end:
    s_endpgm
.section .rodata,"a"
.p2align 6
.amdhsa_kernel sequential_preLN__memory_aug_recurrent_mem_tr__moe_arch_mod__prompt_kernel
  .amdhsa_next_free_vgpr 512
  .amdhsa_next_free_sgpr 102
  .amdhsa_accum_offset 256
  .amdhsa_group_segment_fixed_size 0
  .amdhsa_kernarg_size 120
  .amdhsa_user_sgpr_count 2
  .amdhsa_user_sgpr_kernarg_segment_ptr 1
  .amdhsa_system_sgpr_workgroup_id_x 1
.end_amdhsa_kernel
```

```asm
; @launch grid=(256,1,1) block=(256,1,1) lds=163840
.amdgcn_target "amdgcn-amd-amdhsa--gfx950"
.text
.globl sequential_preLN__memory_aug_recurrent_mem_tr__moe_arch_mod__prompt_kernel
.p2align 8
.type sequential_preLN__memory_aug_recurrent_mem_tr__moe_arch_mod__prompt_kernel,@function
sequential_preLN__memory_aug_recurrent_mem_tr__moe_arch_mod__prompt_kernel:
    s_cmp_ge_u32 s2, 256
    s_cbranch_scc1 L_end
    s_load_dwordx8 s[44:51], s[0:1], 0
    s_load_dwordx4 s[52:55], s[0:1], 32
    s_load_dwordx4 s[56:59], s[0:1], 104
    s_load_dwordx2 s[80:81], s[0:1], 64
    s_load_dwordx2 s[82:83], s[0:1], 96
    s_load_dwordx4 s[84:87], s[0:1], 72
    s_load_dwordx2 s[88:89], s[0:1], 88
    v_lshrrev_b32 v1, 6, v0
    s_nop 0
    v_readfirstlane_b32 s21, v1
    s_waitcnt lgkmcnt(0)
    s_mov_b32 s8, s58
    s_and_b32 s9, s59, 0xffff
    s_mov_b32 s10, 0x10000000
    s_mov_b32 s11, 0x20000
    s_mov_b32 s16, s56
    s_and_b32 s17, s57, 0xffff
    s_mov_b32 s18, 0x100
    s_mov_b32 s19, 0x20000
    s_and_b32 s3, s2, 7
    s_cmp_lg_u32 s3, 0
    s_cbranch_scc1 L_worker
    s_lshr_b32 s20, s2, 3
    v_lshrrev_b32 v28, 6, v0
    v_bfe_u32 v29, v0, 4, 2
    v_lshl_add_u32 v28, v28, 5, v29
    v_and_b32 v16, 15, v0
    v_lshlrev_b32 v16, 4, v16
    v_lshl_add_u32 v16, v28, 13, v16
    v_bfe_u32 v29, v0, 4, 1
    v_lshlrev_b32 v29, 5, v29
    v_xor_b32 v16, v16, v29
    v_xor_b32 v17, 64, v16
    v_xor_b32 v18, 128, v16
    v_xor_b32 v19, 192, v16
    s_add_u32 s28, s21, 1
    s_lshl_b32 s28, s28, 15
    s_lshl_b32 s3, s20, 8
    s_mov_b32 s60, s52
    s_and_b32 s61, s53, 0xffff
    s_mov_b32 s62, 0x400000
    s_mov_b32 s63, 0x20000
    s_add_u32 m0, s28, 0
    s_add_u32 s37, s3, 0x0
    buffer_load_dwordx4 v16, s[60:63], s37 offen lds
    s_add_u32 m0, s28, 1024
    s_add_u32 s37, s3, 0x8000
    buffer_load_dwordx4 v17, s[60:63], s37 offen lds
    s_add_u32 m0, s28, 2048
    s_add_u32 s37, s3, 0x10000
    buffer_load_dwordx4 v18, s[60:63], s37 offen lds
    s_add_u32 m0, s28, 3072
    s_add_u32 s37, s3, 0x18000
    buffer_load_dwordx4 v19, s[60:63], s37 offen lds
    s_add_u32 m0, s28, 4096
    s_add_u32 s37, s3, 0x20000
    buffer_load_dwordx4 v16, s[60:63], s37 offen lds
    s_add_u32 m0, s28, 5120
    s_add_u32 s37, s3, 0x28000
    buffer_load_dwordx4 v17, s[60:63], s37 offen lds
    s_add_u32 m0, s28, 6144
    s_add_u32 s37, s3, 0x30000
    buffer_load_dwordx4 v18, s[60:63], s37 offen lds
    s_add_u32 m0, s28, 7168
    s_add_u32 s37, s3, 0x38000
    buffer_load_dwordx4 v19, s[60:63], s37 offen lds
    s_add_u32 m0, s28, 8192
    s_add_u32 s37, s3, 0x100000
    buffer_load_dwordx4 v16, s[60:63], s37 offen lds
    s_add_u32 m0, s28, 9216
    s_add_u32 s37, s3, 0x108000
    buffer_load_dwordx4 v17, s[60:63], s37 offen lds
    s_add_u32 m0, s28, 10240
    s_add_u32 s37, s3, 0x110000
    buffer_load_dwordx4 v18, s[60:63], s37 offen lds
    s_add_u32 m0, s28, 11264
    s_add_u32 s37, s3, 0x118000
    buffer_load_dwordx4 v19, s[60:63], s37 offen lds
    s_add_u32 m0, s28, 12288
    s_add_u32 s37, s3, 0x120000
    buffer_load_dwordx4 v16, s[60:63], s37 offen lds
    s_add_u32 m0, s28, 13312
    s_add_u32 s37, s3, 0x128000
    buffer_load_dwordx4 v17, s[60:63], s37 offen lds
    s_add_u32 m0, s28, 14336
    s_add_u32 s37, s3, 0x130000
    buffer_load_dwordx4 v18, s[60:63], s37 offen lds
    s_add_u32 m0, s28, 15360
    s_add_u32 s37, s3, 0x138000
    buffer_load_dwordx4 v19, s[60:63], s37 offen lds
    s_add_u32 m0, s28, 16384
    s_add_u32 s37, s3, 0x200000
    buffer_load_dwordx4 v16, s[60:63], s37 offen lds
    s_add_u32 m0, s28, 17408
    s_add_u32 s37, s3, 0x208000
    buffer_load_dwordx4 v17, s[60:63], s37 offen lds
    s_add_u32 m0, s28, 18432
    s_add_u32 s37, s3, 0x210000
    buffer_load_dwordx4 v18, s[60:63], s37 offen lds
    s_add_u32 m0, s28, 19456
    s_add_u32 s37, s3, 0x218000
    buffer_load_dwordx4 v19, s[60:63], s37 offen lds
    s_add_u32 m0, s28, 20480
    s_add_u32 s37, s3, 0x220000
    buffer_load_dwordx4 v16, s[60:63], s37 offen lds
    s_add_u32 m0, s28, 21504
    s_add_u32 s37, s3, 0x228000
    buffer_load_dwordx4 v17, s[60:63], s37 offen lds
    s_add_u32 m0, s28, 22528
    s_add_u32 s37, s3, 0x230000
    buffer_load_dwordx4 v18, s[60:63], s37 offen lds
    s_add_u32 m0, s28, 23552
    s_add_u32 s37, s3, 0x238000
    buffer_load_dwordx4 v19, s[60:63], s37 offen lds
    v_mov_b32 v20, 0x0
    v_bfe_u32 v14, v0, 0, 1
    s_mov_b32 s38, 0x8
    v_mad_u32_u24 v20, v14, s38, v20
    v_bfe_u32 v14, v0, 1, 1
    s_mov_b32 s38, 0x10
    v_mad_u32_u24 v20, v14, s38, v20
    v_bfe_u32 v14, v0, 2, 1
    s_mov_b32 s38, 0x100
    v_mad_u32_u24 v20, v14, s38, v20
    v_bfe_u32 v14, v0, 3, 1
    s_mov_b32 s38, 0x800
    v_mad_u32_u24 v20, v14, s38, v20
    v_bfe_u32 v14, v0, 4, 1
    s_mov_b32 s38, 0x400
    v_mad_u32_u24 v20, v14, s38, v20
    v_bfe_u32 v14, v0, 5, 1
    s_mov_b32 s38, 0x1000
    v_mad_u32_u24 v20, v14, s38, v20
    v_mov_b32 v30, 0x0
    v_bfe_u32 v14, v0, 2, 1
    s_mov_b32 s38, 0x20
    v_mad_u32_u24 v30, v14, s38, v30
    v_bfe_u32 v14, v0, 3, 1
    s_mov_b32 s38, 0x80
    v_mad_u32_u24 v30, v14, s38, v30
    v_bfe_u32 v14, v0, 4, 1
    s_mov_b32 s38, 0x40
    v_mad_u32_u24 v30, v14, s38, v30
    v_mov_b32 v31, 0x0
    v_bfe_u32 v14, v0, 6, 1
    s_mov_b32 s38, 0x40
    v_mad_u32_u24 v31, v14, s38, v31
    v_bfe_u32 v14, v0, 7, 1
    s_mov_b32 s38, 0x80
    v_mad_u32_u24 v31, v14, s38, v31
    v_xor_b32 v30, v30, v31
    v_add_u32 v30, v30, v20
    s_xor_b32 s36, s21, 0
    s_add_u32 s36, s36, 1
    s_lshl_b32 s36, s36, 15
    v_add_u32 v20, s36, v30
    v_xor_b32 v21, 32, v20
    s_xor_b32 s36, s21, 1
    s_add_u32 s36, s36, 1
    s_lshl_b32 s36, s36, 15
    v_add_u32 v22, s36, v30
    v_xor_b32 v23, 32, v22
    s_xor_b32 s36, s21, 2
    s_add_u32 s36, s36, 1
    s_lshl_b32 s36, s36, 15
    v_add_u32 v24, s36, v30
    v_xor_b32 v25, 32, v24
    s_xor_b32 s36, s21, 3
    s_add_u32 s36, s36, 1
    s_lshl_b32 s36, s36, 15
    v_add_u32 v26, s36, v30
    v_xor_b32 v27, 32, v26
    v_mov_b32 v11, 0x0
    v_bfe_u32 v14, v0, 0, 1
    s_mov_b32 s38, 0x4
    v_mad_u32_u24 v11, v14, s38, v11
    v_bfe_u32 v14, v0, 1, 1
    s_mov_b32 s38, 0x8
    v_mad_u32_u24 v11, v14, s38, v11
    v_bfe_u32 v14, v0, 2, 1
    s_mov_b32 s38, 0x10
    v_mad_u32_u24 v11, v14, s38, v11
    v_bfe_u32 v14, v0, 3, 1
    s_mov_b32 s38, 0x20
    v_mad_u32_u24 v11, v14, s38, v11
    v_bfe_u32 v14, v0, 4, 1
    s_mov_b32 s38, 0x800
    v_mad_u32_u24 v11, v14, s38, v11
    v_bfe_u32 v14, v0, 5, 1
    s_mov_b32 s38, 0x1000
    v_mad_u32_u24 v11, v14, s38, v11
    v_bfe_u32 v14, v0, 6, 1
    s_mov_b32 s38, 0x100
    v_mad_u32_u24 v11, v14, s38, v11
    v_bfe_u32 v14, v0, 7, 1
    s_mov_b32 s38, 0x200
    v_mad_u32_u24 v11, v14, s38, v11
    s_mov_b32 s92, s54
    s_and_b32 s93, s55, 0xffff
    s_mov_b32 s94, 0x400000
    s_mov_b32 s95, 0x20000
    s_lshl_b32 s29, s20, 17
    s_xor_b32 s36, s21, 3
    s_lshl_b32 s36, s36, 15
    s_add_u32 s36, s36, s29
    s_add_u32 s37, s36, 0x80
    buffer_load_dword v32, v11, s[92:95], s37 offen
    s_add_u32 s37, s36, 0x4080
    buffer_load_dword v33, v11, s[92:95], s37 offen
    s_add_u32 s37, s36, 0x480
    buffer_load_dword v34, v11, s[92:95], s37 offen
    s_add_u32 s37, s36, 0x4480
    buffer_load_dword v35, v11, s[92:95], s37 offen
    s_add_u32 s37, s36, 0x2080
    buffer_load_dword v36, v11, s[92:95], s37 offen
    s_add_u32 s37, s36, 0x6080
    buffer_load_dword v37, v11, s[92:95], s37 offen
    s_add_u32 s37, s36, 0x2480
    buffer_load_dword v38, v11, s[92:95], s37 offen
    s_add_u32 s37, s36, 0x6480
    buffer_load_dword v39, v11, s[92:95], s37 offen
    s_add_u32 s37, s36, 0xc0
    buffer_load_dword v40, v11, s[92:95], s37 offen
    s_add_u32 s37, s36, 0x40c0
    buffer_load_dword v41, v11, s[92:95], s37 offen
    s_add_u32 s37, s36, 0x4c0
    buffer_load_dword v42, v11, s[92:95], s37 offen
    s_add_u32 s37, s36, 0x44c0
    buffer_load_dword v43, v11, s[92:95], s37 offen
    s_add_u32 s37, s36, 0x20c0
    buffer_load_dword v44, v11, s[92:95], s37 offen
    s_add_u32 s37, s36, 0x60c0
    buffer_load_dword v45, v11, s[92:95], s37 offen
    s_add_u32 s37, s36, 0x24c0
    buffer_load_dword v46, v11, s[92:95], s37 offen
    s_add_u32 s37, s36, 0x64c0
    buffer_load_dword v47, v11, s[92:95], s37 offen
    s_getreg_b32 s36, hwreg(HW_REG_XCC_ID)
    s_and_b32 s36, s36, 15
    s_or_b32 s36, s36, 0x100
    v_mov_b32 v30, s36
    s_lshl_b32 s37, s20, 2
    v_lshlrev_b32 v31, 20, v0
    buffer_store_dword v30, v31, s[16:19], s37 offen offset:128 sc1
    s_mov_b32 s12, s46
    s_and_b32 s13, s47, 0xffff
    s_mov_b32 s14, 0x2000
    s_mov_b32 s15, 0x20000
    v_mov_b32 v104, 0x0
    v_bfe_u32 v14, v0, 0, 1
    s_mov_b32 s38, 0x8
    v_mad_u32_u24 v104, v14, s38, v104
    v_bfe_u32 v14, v0, 1, 1
    s_mov_b32 s38, 0x10
    v_mad_u32_u24 v104, v14, s38, v104
    v_bfe_u32 v14, v0, 2, 1
    s_mov_b32 s38, 0x10000
    v_mad_u32_u24 v104, v14, s38, v104
    v_bfe_u32 v14, v0, 3, 1
    s_mov_b32 s38, 0x10000
    v_mad_u32_u24 v104, v14, s38, v104
    v_bfe_u32 v14, v0, 4, 1
    s_mov_b32 s38, 0x400
    v_mad_u32_u24 v104, v14, s38, v104
    v_bfe_u32 v14, v0, 5, 1
    s_mov_b32 s38, 0x4
    v_mad_u32_u24 v104, v14, s38, v104
    v_bfe_u32 v14, v0, 6, 1
    s_mov_b32 s38, 0x40
    v_mad_u32_u24 v104, v14, s38, v104
    v_bfe_u32 v14, v0, 7, 1
    s_mov_b32 s38, 0x80
    v_mad_u32_u24 v104, v14, s38, v104
    v_mov_b32 v106, s20
    v_mov_b32 v105, 0x0
    v_bfe_u32 v14, v106, 0, 1
    s_mov_b32 s38, 0x20
    v_mad_u32_u24 v105, v14, s38, v105
    v_bfe_u32 v14, v106, 1, 1
    s_mov_b32 s38, 0x800
    v_mad_u32_u24 v105, v14, s38, v105
    v_bfe_u32 v14, v106, 2, 1
    s_mov_b32 s38, 0x1000
    v_mad_u32_u24 v105, v14, s38, v105
    v_bfe_u32 v14, v106, 3, 1
    s_mov_b32 s38, 0x100
    v_mad_u32_u24 v105, v14, s38, v105
    v_bfe_u32 v14, v106, 4, 1
    s_mov_b32 s38, 0x200
    v_mad_u32_u24 v105, v14, s38, v105
    v_add_u32 v104, v104, v105
    buffer_load_dword v12, v104, s[12:15], 0 offen
    v_mov_b32 v1, 0x4444
    v_bfe_u32 v14, v0, 1, 1
    s_mov_b32 s38, 0xaaaa
    v_mad_u32_u24 v1, v14, s38, v1
    v_mov_b32 v3, 0x0
    v_bfe_u32 v14, v0, 0, 1
    s_mov_b32 s38, 0x10
    v_mad_u32_u24 v3, v14, s38, v3
    v_bfe_u32 v14, v0, 1, 1
    s_mov_b32 s38, 0x20
    v_mad_u32_u24 v3, v14, s38, v3
    v_bfe_u32 v14, v0, 2, 1
    s_mov_b32 s38, 0x40
    v_mad_u32_u24 v3, v14, s38, v3
    v_bfe_u32 v14, v0, 3, 1
    s_mov_b32 s38, 0x80
    v_mad_u32_u24 v3, v14, s38, v3
    v_bfe_u32 v14, v0, 4, 1
    s_mov_b32 s38, 0x100
    v_mad_u32_u24 v3, v14, s38, v3
    v_bfe_u32 v14, v0, 5, 1
    s_mov_b32 s38, 0x200
    v_mad_u32_u24 v3, v14, s38, v3
    v_mov_b32 v2, 0x0
    v_bfe_u32 v14, v0, 0, 1
    s_mov_b32 s38, 0x10
    v_mad_u32_u24 v2, v14, s38, v2
    v_bfe_u32 v14, v0, 1, 1
    s_mov_b32 s38, 0x20
    v_mad_u32_u24 v2, v14, s38, v2
    v_bfe_u32 v14, v0, 2, 1
    s_mov_b32 s38, 0x40
    v_mad_u32_u24 v2, v14, s38, v2
    v_bfe_u32 v14, v0, 3, 1
    s_mov_b32 s38, 0x80
    v_mad_u32_u24 v2, v14, s38, v2
    v_bfe_u32 v14, v0, 4, 1
    s_mov_b32 s38, 0x100
    v_mad_u32_u24 v2, v14, s38, v2
    v_bfe_u32 v14, v0, 5, 1
    s_mov_b32 s38, 0x200
    v_mad_u32_u24 v2, v14, s38, v2
    v_bfe_u32 v14, v0, 6, 1
    s_mov_b32 s38, 0x800
    v_mad_u32_u24 v2, v14, s38, v2
    v_bfe_u32 v14, v0, 7, 1
    s_mov_b32 s38, 0x1000
    v_mad_u32_u24 v2, v14, s38, v2
    v_mov_b32 v4, 0x8000
    v_bfe_u32 v14, v0, 0, 1
    s_mov_b32 s38, 0x10
    v_mad_u32_u24 v4, v14, s38, v4
    v_bfe_u32 v14, v0, 1, 1
    s_mov_b32 s38, 0x20
    v_mad_u32_u24 v4, v14, s38, v4
    v_bfe_u32 v14, v0, 2, 1
    s_mov_b32 s38, 0x40
    v_mad_u32_u24 v4, v14, s38, v4
    v_bfe_u32 v14, v0, 3, 1
    s_mov_b32 s38, 0x80
    v_mad_u32_u24 v4, v14, s38, v4
    v_bfe_u32 v14, v0, 4, 1
    s_mov_b32 s38, 0x100
    v_mad_u32_u24 v4, v14, s38, v4
    v_bfe_u32 v14, v0, 5, 1
    s_mov_b32 s38, 0x200
    v_mad_u32_u24 v4, v14, s38, v4
    v_bfe_u32 v14, v0, 6, 1
    s_mov_b32 s38, 0x8000
    v_mad_u32_u24 v4, v14, s38, v4
    v_bfe_u32 v14, v0, 7, 1
    s_mov_b32 s38, 0x10000
    v_mad_u32_u24 v4, v14, s38, v4
    v_mov_b32 v5, 0x4000
    v_bfe_u32 v14, v0, 0, 1
    s_mov_b32 s38, 0x4
    v_mad_u32_u24 v5, v14, s38, v5
    v_bfe_u32 v14, v0, 1, 1
    s_mov_b32 s38, 0x8
    v_mad_u32_u24 v5, v14, s38, v5
    v_bfe_u32 v14, v0, 2, 1
    s_mov_b32 s38, 0x10
    v_mad_u32_u24 v5, v14, s38, v5
    v_bfe_u32 v14, v0, 3, 1
    s_mov_b32 s38, 0x20
    v_mad_u32_u24 v5, v14, s38, v5
    v_bfe_u32 v14, v0, 4, 1
    s_mov_b32 s38, 0x240
    v_mad_u32_u24 v5, v14, s38, v5
    v_bfe_u32 v14, v0, 5, 1
    s_mov_b32 s38, 0x480
    v_mad_u32_u24 v5, v14, s38, v5
    v_bfe_u32 v14, v0, 6, 1
    s_mov_b32 s38, 0x40
    v_mad_u32_u24 v5, v14, s38, v5
    v_bfe_u32 v14, v0, 7, 1
    s_mov_b32 s38, 0x80
    v_mad_u32_u24 v5, v14, s38, v5
    v_mov_b32 v6, 0x4000
    v_bfe_u32 v14, v0, 0, 1
    s_mov_b32 s38, 0x120
    v_mad_u32_u24 v6, v14, s38, v6
    v_bfe_u32 v14, v0, 2, 1
    s_mov_b32 s38, 0x240
    v_mad_u32_u24 v6, v14, s38, v6
    v_bfe_u32 v14, v0, 3, 1
    s_mov_b32 s38, 0x480
    v_mad_u32_u24 v6, v14, s38, v6
    v_bfe_u32 v14, v0, 4, 1
    s_mov_b32 s38, 0x10
    v_mad_u32_u24 v6, v14, s38, v6
    v_bfe_u32 v14, v0, 5, 1
    s_mov_b32 s38, 0x20
    v_mad_u32_u24 v6, v14, s38, v6
    v_add_u32 v7, 2304, v5
    v_xor_b32 v8, 0x1000, v2
    v_mov_b32 v104, 0x0
    v_bfe_u32 v14, v0, 3, 1
    s_mov_b32 s38, 0x1
    v_mad_u32_u24 v104, v14, s38, v104
    v_bfe_u32 v14, v0, 4, 1
    s_mov_b32 s38, 0x2
    v_mad_u32_u24 v104, v14, s38, v104
    v_bfe_u32 v14, v0, 5, 1
    s_mov_b32 s38, 0x4
    v_mad_u32_u24 v104, v14, s38, v104
    v_bfe_u32 v14, v0, 6, 1
    s_mov_b32 s38, 0x8
    v_mad_u32_u24 v104, v14, s38, v104
    v_bfe_u32 v14, v0, 7, 1
    s_mov_b32 s38, 0x10
    v_mad_u32_u24 v104, v14, s38, v104
    v_add_u32 v104, s20, v104
    v_and_b32 v104, 31, v104
    v_lshlrev_b32 v104, 6, v104
    v_mov_b32 v9, 0x0
    v_bfe_u32 v14, v0, 0, 1
    s_mov_b32 s38, 0x8
    v_mad_u32_u24 v9, v14, s38, v9
    v_bfe_u32 v14, v0, 1, 1
    s_mov_b32 s38, 0x10
    v_mad_u32_u24 v9, v14, s38, v9
    v_bfe_u32 v14, v0, 2, 1
    s_mov_b32 s38, 0x20
    v_mad_u32_u24 v9, v14, s38, v9
    v_bfe_u32 v14, v0, 3, 1
    s_mov_b32 s38, 0x2000
    v_mad_u32_u24 v9, v14, s38, v9
    v_bfe_u32 v14, v0, 4, 1
    s_mov_b32 s38, 0x4000
    v_mad_u32_u24 v9, v14, s38, v9
    v_bfe_u32 v14, v0, 5, 1
    s_mov_b32 s38, 0x8000
    v_mad_u32_u24 v9, v14, s38, v9
    v_bfe_u32 v14, v0, 6, 1
    s_mov_b32 s38, 0x10000
    v_mad_u32_u24 v9, v14, s38, v9
    v_bfe_u32 v14, v0, 7, 1
    s_mov_b32 s38, 0x20000
    v_mad_u32_u24 v9, v14, s38, v9
    v_add_u32 v9, v9, v104
    v_mov_b32 v10, 0x80000
    v_bfe_u32 v14, v0, 0, 1
    s_mov_b32 s38, 0x8
    v_mad_u32_u24 v10, v14, s38, v10
    v_bfe_u32 v14, v0, 1, 1
    s_mov_b32 s38, 0x20
    v_mad_u32_u24 v10, v14, s38, v10
    v_bfe_u32 v14, v0, 4, 1
    s_mov_b32 s38, 0x10
    v_mad_u32_u24 v10, v14, s38, v10
    v_bfe_u32 v14, v0, 5, 1
    s_mov_b32 s38, 0x4
    v_mad_u32_u24 v10, v14, s38, v10
    v_bfe_u32 v14, v0, 6, 1
    s_mov_b32 s38, 0x800
    v_mad_u32_u24 v10, v14, s38, v10
    v_bfe_u32 v14, v0, 7, 1
    s_mov_b32 s38, 0x1000
    v_mad_u32_u24 v10, v14, s38, v10
    v_mov_b32 v105, s20
    v_mov_b32 v104, 0x0
    v_bfe_u32 v14, v105, 0, 1
    s_mov_b32 s38, 0x100
    v_mad_u32_u24 v104, v14, s38, v104
    v_bfe_u32 v14, v105, 1, 1
    s_mov_b32 s38, 0x40
    v_mad_u32_u24 v104, v14, s38, v104
    v_bfe_u32 v14, v105, 2, 1
    s_mov_b32 s38, 0x80
    v_mad_u32_u24 v104, v14, s38, v104
    v_bfe_u32 v14, v105, 3, 1
    s_mov_b32 s38, 0x200
    v_mad_u32_u24 v104, v14, s38, v104
    v_bfe_u32 v14, v105, 4, 1
    s_mov_b32 s38, 0x400
    v_mad_u32_u24 v104, v14, s38, v104
    v_add_u32 v10, v104, v10
    v_and_b32 v104, 12, v0
    v_cmp_ne_u32 vcc, 0, v104
    v_mov_b32 v104, 0x40000000
    s_nop 0
    v_cndmask_b32 v10, v10, v104, vcc
    v_mov_b32 v13, 0x0
    v_bfe_u32 v14, v0, 0, 1
    s_mov_b32 s38, 0x10
    v_mad_u32_u24 v13, v14, s38, v13
    v_bfe_u32 v14, v0, 1, 1
    s_mov_b32 s38, 0x8
    v_mad_u32_u24 v13, v14, s38, v13
    v_bfe_u32 v14, v0, 2, 1
    s_mov_b32 s38, 0x20
    v_mad_u32_u24 v13, v14, s38, v13
    v_bfe_u32 v14, v0, 3, 1
    s_mov_b32 s38, 0x40
    v_mad_u32_u24 v13, v14, s38, v13
    v_bfe_u32 v14, v0, 4, 1
    s_mov_b32 s38, 0x80
    v_mad_u32_u24 v13, v14, s38, v13
    v_bfe_u32 v14, v0, 5, 1
    s_mov_b32 s38, 0x100
    v_mad_u32_u24 v13, v14, s38, v13
    v_bfe_u32 v14, v0, 6, 1
    s_mov_b32 s38, 0x800
    v_mad_u32_u24 v13, v14, s38, v13
    v_bfe_u32 v14, v0, 7, 1
    s_mov_b32 s38, 0x1000
    v_mad_u32_u24 v13, v14, s38, v13
    s_lshl_b32 s6, s20, 13
    s_add_u32 s6, s6, 0x0
    s_mov_b32 s26, 4096
    v_and_b32 v104, 15, v0
    v_mov_b32 v100, 0
    v_mov_b32 v105, 0x3f80
    v_cmp_eq_u32 vcc, 0, v104
    s_nop 1
    v_cndmask_b32 v100, v100, v105, vcc
    v_mov_b32 v105, 0x3f800000
    v_cmp_eq_u32 vcc, 1, v104
    s_nop 1
    v_cndmask_b32 v100, v100, v105, vcc
    v_mov_b32 v101, 0
    v_mov_b32 v105, 0x3f80
    v_cmp_eq_u32 vcc, 4, v104
    s_nop 1
    v_cndmask_b32 v101, v101, v105, vcc
    v_mov_b32 v105, 0x3f800000
    v_cmp_eq_u32 vcc, 5, v104
    s_nop 1
    v_cndmask_b32 v101, v101, v105, vcc
    v_mov_b32 v102, 0
    v_mov_b32 v105, 0x3f80
    v_cmp_eq_u32 vcc, 8, v104
    s_nop 1
    v_cndmask_b32 v102, v102, v105, vcc
    v_mov_b32 v105, 0x3f800000
    v_cmp_eq_u32 vcc, 9, v104
    s_nop 1
    v_cndmask_b32 v102, v102, v105, vcc
    v_mov_b32 v103, 0
    v_mov_b32 v105, 0x3f80
    v_cmp_eq_u32 vcc, 12, v104
    s_nop 1
    v_cndmask_b32 v103, v103, v105, vcc
    v_mov_b32 v105, 0x3f800000
    v_cmp_eq_u32 vcc, 13, v104
    s_nop 1
    v_cndmask_b32 v103, v103, v105, vcc
    ds_write_b128 v3, v[100:103] offset:23040
    s_mov_b32 s34, 0x05040100
    s_mov_b32 s35, 0x07060302
    s_mov_b32 s33, 0x3e0293ee
    s_mov_b32 s40, 0x4e800000
    s_mov_b32 s32, 0
    s_mov_b32 s4, 0x3f803f80
    s_mov_b32 s5, 0x3f803f80
    s_lshl_b32 s36, s20, 14
    s_lshr_b32 s37, s21, 1
    s_lshl_b32 s37, s37, 12
    s_add_u32 s25, s36, s37
    s_lshl_b32 s37, s21, 11
    s_add_u32 s39, s36, s37
    s_add_u32 s39, s39, 8192
    v_mov_b32 v104, 0x0
    v_bfe_u32 v14, v0, 0, 1
    s_mov_b32 s38, 0x80
    v_mad_u32_u24 v104, v14, s38, v104
    v_bfe_u32 v14, v0, 1, 1
    s_mov_b32 s38, 0x100
    v_mad_u32_u24 v104, v14, s38, v104
    v_bfe_u32 v14, v0, 2, 1
    s_mov_b32 s38, 0x200
    v_mad_u32_u24 v104, v14, s38, v104
    v_bfe_u32 v14, v0, 3, 1
    s_mov_b32 s38, 0x400
    v_mad_u32_u24 v104, v14, s38, v104
    v_bfe_u32 v14, v0, 4, 1
    s_mov_b32 s38, 0x800
    v_mad_u32_u24 v104, v14, s38, v104
    v_bfe_u32 v14, v0, 6, 1
    s_mov_b32 s38, 0x1000
    v_mad_u32_u24 v104, v14, s38, v104
    v_bfe_u32 v14, v0, 7, 1
    s_mov_b32 s38, 0x2000
    v_mad_u32_u24 v104, v14, s38, v104
    s_lshl_b32 s36, s20, 14
    v_add_u32 v104, s36, v104
    s_lshl_b32 s36, s20, 8
    s_lshr_b32 s37, s21, 1
    s_lshl_b32 s37, s37, 7
    s_add_u32 s36, s36, s37
    s_add_u32 s36, s36, 0x102100
    v_and_b32 v14, 63, v0
    v_mov_b32 v105, 0x40000000
    v_cmp_lt_u32 vcc, 32, v14
    s_nop 1
    v_cndmask_b32 v104, v104, v105, vcc
    v_mov_b32 v105, s36
    v_cmp_eq_u32 vcc, 32, v14
    s_nop 1
    v_cndmask_b32 v104, v104, v105, vcc
    s_lshl_b32 s36, s20, 2
    s_add_u32 s36, s36, 0x104100
    v_mov_b32 v105, s36
    v_cmp_eq_u32 vcc, 33, v14
    s_nop 1
    v_cndmask_b32 v0, v104, v105, vcc
    s_waitcnt vmcnt(34)
    s_barrier
    ds_read_b64_tr_b16 a[160:161], v20 offset:0
    ds_read_b64_tr_b16 a[162:163], v20 offset:512
    ds_read_b64_tr_b16 a[168:169], v21 offset:0
    ds_read_b64_tr_b16 a[170:171], v21 offset:512
    ds_read_b64_tr_b16 a[192:193], v22 offset:0
    ds_read_b64_tr_b16 a[194:195], v22 offset:512
    ds_read_b64_tr_b16 a[200:201], v23 offset:0
    ds_read_b64_tr_b16 a[202:203], v23 offset:512
    ds_read_b64_tr_b16 a[224:225], v24 offset:0
    ds_read_b64_tr_b16 a[226:227], v24 offset:512
    ds_read_b64_tr_b16 a[232:233], v25 offset:0
    ds_read_b64_tr_b16 a[234:235], v25 offset:512
    s_waitcnt lgkmcnt(4)
    ds_read_b64_tr_b16 v[128:129], v26 offset:0
    ds_read_b64_tr_b16 v[130:131], v26 offset:512
    ds_read_b64_tr_b16 v[136:137], v27 offset:0
    ds_read_b64_tr_b16 v[138:139], v27 offset:512
    s_waitcnt lgkmcnt(0)
    s_barrier
    s_add_u32 m0, s28, 0
    s_add_u32 s37, s3, 0x300000
    buffer_load_dwordx4 v16, s[60:63], s37 offen lds
    s_add_u32 m0, s28, 1024
    s_add_u32 s37, s3, 0x308000
    buffer_load_dwordx4 v17, s[60:63], s37 offen lds
    s_add_u32 m0, s28, 2048
    s_add_u32 s37, s3, 0x310000
    buffer_load_dwordx4 v18, s[60:63], s37 offen lds
    s_add_u32 m0, s28, 3072
    s_add_u32 s37, s3, 0x318000
    buffer_load_dwordx4 v19, s[60:63], s37 offen lds
    s_add_u32 m0, s28, 4096
    s_add_u32 s37, s3, 0x320000
    buffer_load_dwordx4 v16, s[60:63], s37 offen lds
    s_add_u32 m0, s28, 5120
    s_add_u32 s37, s3, 0x328000
    buffer_load_dwordx4 v17, s[60:63], s37 offen lds
    s_add_u32 m0, s28, 6144
    s_add_u32 s37, s3, 0x330000
    buffer_load_dwordx4 v18, s[60:63], s37 offen lds
    s_add_u32 m0, s28, 7168
    s_add_u32 s37, s3, 0x338000
    buffer_load_dwordx4 v19, s[60:63], s37 offen lds
    s_xor_b32 s36, s21, 2
    s_lshl_b32 s36, s36, 15
    s_add_u32 s36, s36, s29
    s_add_u32 s37, s36, 0x80
    buffer_load_dword v48, v11, s[92:95], s37 offen
    s_add_u32 s37, s36, 0x4080
    buffer_load_dword v49, v11, s[92:95], s37 offen
    s_add_u32 s37, s36, 0x480
    buffer_load_dword v50, v11, s[92:95], s37 offen
    s_add_u32 s37, s36, 0x4480
    buffer_load_dword v51, v11, s[92:95], s37 offen
    s_add_u32 s37, s36, 0x2080
    buffer_load_dword v52, v11, s[92:95], s37 offen
    s_add_u32 s37, s36, 0x6080
    buffer_load_dword v53, v11, s[92:95], s37 offen
    s_add_u32 s37, s36, 0x2480
    buffer_load_dword v54, v11, s[92:95], s37 offen
    s_add_u32 s37, s36, 0x6480
    buffer_load_dword v55, v11, s[92:95], s37 offen
    s_add_u32 s37, s36, 0xc0
    buffer_load_dword v56, v11, s[92:95], s37 offen
    s_add_u32 s37, s36, 0x40c0
    buffer_load_dword v57, v11, s[92:95], s37 offen
    s_add_u32 s37, s36, 0x4c0
    buffer_load_dword v58, v11, s[92:95], s37 offen
    s_add_u32 s37, s36, 0x44c0
    buffer_load_dword v59, v11, s[92:95], s37 offen
    s_add_u32 s37, s36, 0x20c0
    buffer_load_dword v60, v11, s[92:95], s37 offen
    s_add_u32 s37, s36, 0x60c0
    buffer_load_dword v61, v11, s[92:95], s37 offen
    s_add_u32 s37, s36, 0x24c0
    buffer_load_dword v62, v11, s[92:95], s37 offen
    s_add_u32 s37, s36, 0x64c0
    buffer_load_dword v63, v11, s[92:95], s37 offen
    s_waitcnt vmcnt(50)
    s_barrier
    ds_read_b64_tr_b16 a[164:165], v20 offset:8192
    ds_read_b64_tr_b16 a[166:167], v20 offset:8704
    ds_read_b64_tr_b16 a[172:173], v21 offset:8192
    ds_read_b64_tr_b16 a[174:175], v21 offset:8704
    ds_read_b64_tr_b16 a[196:197], v22 offset:8192
    ds_read_b64_tr_b16 a[198:199], v22 offset:8704
    ds_read_b64_tr_b16 a[204:205], v23 offset:8192
    ds_read_b64_tr_b16 a[206:207], v23 offset:8704
    ds_read_b64_tr_b16 a[228:229], v24 offset:8192
    ds_read_b64_tr_b16 a[230:231], v24 offset:8704
    ds_read_b64_tr_b16 a[236:237], v25 offset:8192
    ds_read_b64_tr_b16 a[238:239], v25 offset:8704
    s_waitcnt lgkmcnt(4)
    ds_read_b64_tr_b16 v[132:133], v26 offset:8192
    ds_read_b64_tr_b16 v[134:135], v26 offset:8704
    ds_read_b64_tr_b16 v[140:141], v27 offset:8192
    ds_read_b64_tr_b16 v[142:143], v27 offset:8704
    s_waitcnt lgkmcnt(0)
    s_barrier
    s_mov_b32 s88, s50
    s_and_b32 s89, s51, 0xffff
    s_mov_b32 s90, 0x400000
    s_mov_b32 s91, 0x20000
    s_add_u32 m0, s28, 8192
    s_add_u32 s37, s3, 0x0
    buffer_load_dwordx4 v16, s[88:91], s37 offen lds
    s_add_u32 m0, s28, 9216
    s_add_u32 s37, s3, 0x8000
    buffer_load_dwordx4 v17, s[88:91], s37 offen lds
    s_add_u32 m0, s28, 10240
    s_add_u32 s37, s3, 0x10000
    buffer_load_dwordx4 v18, s[88:91], s37 offen lds
    s_add_u32 m0, s28, 11264
    s_add_u32 s37, s3, 0x18000
    buffer_load_dwordx4 v19, s[88:91], s37 offen lds
    s_add_u32 m0, s28, 12288
    s_add_u32 s37, s3, 0x20000
    buffer_load_dwordx4 v16, s[88:91], s37 offen lds
    s_add_u32 m0, s28, 13312
    s_add_u32 s37, s3, 0x28000
    buffer_load_dwordx4 v17, s[88:91], s37 offen lds
    s_add_u32 m0, s28, 14336
    s_add_u32 s37, s3, 0x30000
    buffer_load_dwordx4 v18, s[88:91], s37 offen lds
    s_add_u32 m0, s28, 15360
    s_add_u32 s37, s3, 0x38000
    buffer_load_dwordx4 v19, s[88:91], s37 offen lds
    s_waitcnt vmcnt(34)
    v_perm_b32 v120, v33, v32, s34
    v_perm_b32 v121, v33, v32, s35
    v_perm_b32 v122, v35, v34, s34
    v_perm_b32 v123, v35, v34, s35
    v_perm_b32 v124, v37, v36, s34
    v_perm_b32 v125, v37, v36, s35
    v_perm_b32 v126, v39, v38, s34
    v_perm_b32 v127, v39, v38, s35
    ds_write_b128 v4, v[120:123] offset:24576
    ds_write_b128 v4, v[124:127] offset:25600
    s_waitcnt lgkmcnt(0)
    v_perm_b32 v120, v41, v40, s34
    v_perm_b32 v121, v41, v40, s35
    v_perm_b32 v122, v43, v42, s34
    v_perm_b32 v123, v43, v42, s35
    v_perm_b32 v124, v45, v44, s34
    v_perm_b32 v125, v45, v44, s35
    v_perm_b32 v126, v47, v46, s34
    v_perm_b32 v127, v47, v46, s35
    ds_write_b128 v4, v[120:123] offset:30720
    ds_write_b128 v4, v[124:127] offset:31744
    s_waitcnt lgkmcnt(0)
    s_xor_b32 s36, s21, 1
    s_lshl_b32 s36, s36, 15
    s_add_u32 s36, s36, s29
    s_add_u32 s37, s36, 0x80
    buffer_load_dword v80, v11, s[92:95], s37 offen
    s_add_u32 s37, s36, 0x4080
    buffer_load_dword v81, v11, s[92:95], s37 offen
    s_add_u32 s37, s36, 0x480
    buffer_load_dword v82, v11, s[92:95], s37 offen
    s_add_u32 s37, s36, 0x4480
    buffer_load_dword v83, v11, s[92:95], s37 offen
    s_add_u32 s37, s36, 0x2080
    buffer_load_dword v84, v11, s[92:95], s37 offen
    s_add_u32 s37, s36, 0x6080
    buffer_load_dword v85, v11, s[92:95], s37 offen
    s_add_u32 s37, s36, 0x2480
    buffer_load_dword v86, v11, s[92:95], s37 offen
    s_add_u32 s37, s36, 0x6480
    buffer_load_dword v87, v11, s[92:95], s37 offen
    s_add_u32 s37, s36, 0xc0
    buffer_load_dword v88, v11, s[92:95], s37 offen
    s_add_u32 s37, s36, 0x40c0
    buffer_load_dword v89, v11, s[92:95], s37 offen
    s_add_u32 s37, s36, 0x4c0
    buffer_load_dword v90, v11, s[92:95], s37 offen
    s_add_u32 s37, s36, 0x44c0
    buffer_load_dword v91, v11, s[92:95], s37 offen
    s_add_u32 s37, s36, 0x20c0
    buffer_load_dword v92, v11, s[92:95], s37 offen
    s_add_u32 s37, s36, 0x60c0
    buffer_load_dword v93, v11, s[92:95], s37 offen
    s_add_u32 s37, s36, 0x24c0
    buffer_load_dword v94, v11, s[92:95], s37 offen
    s_add_u32 s37, s36, 0x64c0
    buffer_load_dword v95, v11, s[92:95], s37 offen
    s_barrier
    ds_read_b64_tr_b16 a[176:177], v20 offset:16384
    ds_read_b64_tr_b16 a[178:179], v20 offset:16896
    ds_read_b64_tr_b16 a[184:185], v21 offset:16384
    ds_read_b64_tr_b16 a[186:187], v21 offset:16896
    ds_read_b64_tr_b16 a[208:209], v22 offset:16384
    ds_read_b64_tr_b16 a[210:211], v22 offset:16896
    ds_read_b64_tr_b16 a[216:217], v23 offset:16384
    ds_read_b64_tr_b16 a[218:219], v23 offset:16896
    ds_read_b64_tr_b16 a[240:241], v24 offset:16384
    ds_read_b64_tr_b16 a[242:243], v24 offset:16896
    ds_read_b64_tr_b16 a[248:249], v25 offset:16384
    ds_read_b64_tr_b16 a[250:251], v25 offset:16896
    s_waitcnt lgkmcnt(4)
    ds_read_b64_tr_b16 v[144:145], v26 offset:16384
    ds_read_b64_tr_b16 v[146:147], v26 offset:16896
    ds_read_b64_tr_b16 v[152:153], v27 offset:16384
    ds_read_b64_tr_b16 v[154:155], v27 offset:16896
    s_waitcnt lgkmcnt(0)
    s_barrier
    s_add_u32 m0, s28, 16384
    s_add_u32 s37, s3, 0x100000
    buffer_load_dwordx4 v16, s[88:91], s37 offen lds
    s_add_u32 m0, s28, 17408
    s_add_u32 s37, s3, 0x108000
    buffer_load_dwordx4 v17, s[88:91], s37 offen lds
    s_add_u32 m0, s28, 18432
    s_add_u32 s37, s3, 0x110000
    buffer_load_dwordx4 v18, s[88:91], s37 offen lds
    s_add_u32 m0, s28, 19456
    s_add_u32 s37, s3, 0x118000
    buffer_load_dwordx4 v19, s[88:91], s37 offen lds
    s_add_u32 m0, s28, 20480
    s_add_u32 s37, s3, 0x120000
    buffer_load_dwordx4 v16, s[88:91], s37 offen lds
    s_add_u32 m0, s28, 21504
    s_add_u32 s37, s3, 0x128000
    buffer_load_dwordx4 v17, s[88:91], s37 offen lds
    s_add_u32 m0, s28, 22528
    s_add_u32 s37, s3, 0x130000
    buffer_load_dwordx4 v18, s[88:91], s37 offen lds
    s_add_u32 m0, s28, 23552
    s_add_u32 s37, s3, 0x138000
    buffer_load_dwordx4 v19, s[88:91], s37 offen lds
    s_waitcnt vmcnt(32)
    v_perm_b32 v232, v49, v48, s34
    v_perm_b32 v233, v49, v48, s35
    v_perm_b32 v234, v51, v50, s34
    v_perm_b32 v235, v51, v50, s35
    v_perm_b32 v236, v53, v52, s34
    v_perm_b32 v237, v53, v52, s35
    v_perm_b32 v238, v55, v54, s34
    v_perm_b32 v239, v55, v54, s35
    v_perm_b32 v120, v57, v56, s34
    v_perm_b32 v121, v57, v56, s35
    v_perm_b32 v122, v59, v58, s34
    v_perm_b32 v123, v59, v58, s35
    v_perm_b32 v124, v61, v60, s34
    v_perm_b32 v125, v61, v60, s35
    v_perm_b32 v126, v63, v62, s34
    v_perm_b32 v127, v63, v62, s35
    ds_write_b128 v4, v[120:123] offset:28672
    ds_write_b128 v4, v[124:127] offset:29696
    s_waitcnt lgkmcnt(0)
    s_xor_b32 s36, s21, 3
    s_lshl_b32 s36, s36, 15
    s_add_u32 s36, s36, s29
    s_add_u32 s37, s36, 0x0
    buffer_load_dword v32, v11, s[92:95], s37 offen
    s_add_u32 s37, s36, 0x4000
    buffer_load_dword v33, v11, s[92:95], s37 offen
    s_add_u32 s37, s36, 0x400
    buffer_load_dword v34, v11, s[92:95], s37 offen
    s_add_u32 s37, s36, 0x4400
    buffer_load_dword v35, v11, s[92:95], s37 offen
    s_add_u32 s37, s36, 0x2000
    buffer_load_dword v36, v11, s[92:95], s37 offen
    s_add_u32 s37, s36, 0x6000
    buffer_load_dword v37, v11, s[92:95], s37 offen
    s_add_u32 s37, s36, 0x2400
    buffer_load_dword v38, v11, s[92:95], s37 offen
    s_add_u32 s37, s36, 0x6400
    buffer_load_dword v39, v11, s[92:95], s37 offen
    s_add_u32 s37, s36, 0x40
    buffer_load_dword v40, v11, s[92:95], s37 offen
    s_add_u32 s37, s36, 0x4040
    buffer_load_dword v41, v11, s[92:95], s37 offen
    s_add_u32 s37, s36, 0x440
    buffer_load_dword v42, v11, s[92:95], s37 offen
    s_add_u32 s37, s36, 0x4440
    buffer_load_dword v43, v11, s[92:95], s37 offen
    s_add_u32 s37, s36, 0x2040
    buffer_load_dword v44, v11, s[92:95], s37 offen
    s_add_u32 s37, s36, 0x6040
    buffer_load_dword v45, v11, s[92:95], s37 offen
    s_add_u32 s37, s36, 0x2440
    buffer_load_dword v46, v11, s[92:95], s37 offen
    s_add_u32 s37, s36, 0x6440
    buffer_load_dword v47, v11, s[92:95], s37 offen
    s_barrier
    ds_read_b64_tr_b16 a[180:181], v20 offset:0
    ds_read_b64_tr_b16 a[182:183], v20 offset:512
    ds_read_b64_tr_b16 a[188:189], v21 offset:0
    ds_read_b64_tr_b16 a[190:191], v21 offset:512
    ds_read_b64_tr_b16 a[212:213], v22 offset:0
    ds_read_b64_tr_b16 a[214:215], v22 offset:512
    ds_read_b64_tr_b16 a[220:221], v23 offset:0
    ds_read_b64_tr_b16 a[222:223], v23 offset:512
    ds_read_b64_tr_b16 a[244:245], v24 offset:0
    ds_read_b64_tr_b16 a[246:247], v24 offset:512
    ds_read_b64_tr_b16 a[252:253], v25 offset:0
    ds_read_b64_tr_b16 a[254:255], v25 offset:512
    s_waitcnt lgkmcnt(4)
    ds_read_b64_tr_b16 v[148:149], v26 offset:0
    ds_read_b64_tr_b16 v[150:151], v26 offset:512
    ds_read_b64_tr_b16 v[156:157], v27 offset:0
    ds_read_b64_tr_b16 v[158:159], v27 offset:512
    s_waitcnt lgkmcnt(0)
    s_barrier
    s_add_u32 m0, s28, 0
    s_add_u32 s37, s3, 0x200000
    buffer_load_dwordx4 v16, s[88:91], s37 offen lds
    s_add_u32 m0, s28, 1024
    s_add_u32 s37, s3, 0x208000
    buffer_load_dwordx4 v17, s[88:91], s37 offen lds
    s_add_u32 m0, s28, 2048
    s_add_u32 s37, s3, 0x210000
    buffer_load_dwordx4 v18, s[88:91], s37 offen lds
    s_add_u32 m0, s28, 3072
    s_add_u32 s37, s3, 0x218000
    buffer_load_dwordx4 v19, s[88:91], s37 offen lds
    s_add_u32 m0, s28, 4096
    s_add_u32 s37, s3, 0x220000
    buffer_load_dwordx4 v16, s[88:91], s37 offen lds
    s_add_u32 m0, s28, 5120
    s_add_u32 s37, s3, 0x228000
    buffer_load_dwordx4 v17, s[88:91], s37 offen lds
    s_add_u32 m0, s28, 6144
    s_add_u32 s37, s3, 0x230000
    buffer_load_dwordx4 v18, s[88:91], s37 offen lds
    s_add_u32 m0, s28, 7168
    s_add_u32 s37, s3, 0x238000
    buffer_load_dwordx4 v19, s[88:91], s37 offen lds
    s_waitcnt vmcnt(32)
    v_perm_b32 v208, v81, v80, s34
    v_perm_b32 v209, v81, v80, s35
    v_perm_b32 v210, v83, v82, s34
    v_perm_b32 v211, v83, v82, s35
    v_perm_b32 v212, v85, v84, s34
    v_perm_b32 v213, v85, v84, s35
    v_perm_b32 v214, v87, v86, s34
    v_perm_b32 v215, v87, v86, s35
    v_perm_b32 v120, v89, v88, s34
    v_perm_b32 v121, v89, v88, s35
    v_perm_b32 v122, v91, v90, s34
    v_perm_b32 v123, v91, v90, s35
    v_perm_b32 v124, v93, v92, s34
    v_perm_b32 v125, v93, v92, s35
    v_perm_b32 v126, v95, v94, s34
    v_perm_b32 v127, v95, v94, s35
    ds_write_b128 v4, v[120:123] offset:26624
    ds_write_b128 v4, v[124:127] offset:27648
    s_waitcnt lgkmcnt(0)
    s_xor_b32 s36, s21, 2
    s_lshl_b32 s36, s36, 15
    s_add_u32 s36, s36, s29
    s_add_u32 s37, s36, 0x0
    buffer_load_dword v48, v11, s[92:95], s37 offen
    s_add_u32 s37, s36, 0x4000
    buffer_load_dword v49, v11, s[92:95], s37 offen
    s_add_u32 s37, s36, 0x400
    buffer_load_dword v50, v11, s[92:95], s37 offen
    s_add_u32 s37, s36, 0x4400
    buffer_load_dword v51, v11, s[92:95], s37 offen
    s_add_u32 s37, s36, 0x2000
    buffer_load_dword v52, v11, s[92:95], s37 offen
    s_add_u32 s37, s36, 0x6000
    buffer_load_dword v53, v11, s[92:95], s37 offen
    s_add_u32 s37, s36, 0x2400
    buffer_load_dword v54, v11, s[92:95], s37 offen
    s_add_u32 s37, s36, 0x6400
    buffer_load_dword v55, v11, s[92:95], s37 offen
    s_add_u32 s37, s36, 0x40
    buffer_load_dword v56, v11, s[92:95], s37 offen
    s_add_u32 s37, s36, 0x4040
    buffer_load_dword v57, v11, s[92:95], s37 offen
    s_add_u32 s37, s36, 0x440
    buffer_load_dword v58, v11, s[92:95], s37 offen
    s_add_u32 s37, s36, 0x4440
    buffer_load_dword v59, v11, s[92:95], s37 offen
    s_add_u32 s37, s36, 0x2040
    buffer_load_dword v60, v11, s[92:95], s37 offen
    s_add_u32 s37, s36, 0x6040
    buffer_load_dword v61, v11, s[92:95], s37 offen
    s_add_u32 s37, s36, 0x2440
    buffer_load_dword v62, v11, s[92:95], s37 offen
    s_add_u32 s37, s36, 0x6440
    buffer_load_dword v63, v11, s[92:95], s37 offen
    s_barrier
    ds_read_b64_tr_b16 v[64:65], v20 offset:8192
    ds_read_b64_tr_b16 v[66:67], v20 offset:8704
    ds_read_b64_tr_b16 v[72:73], v21 offset:8192
    ds_read_b64_tr_b16 v[74:75], v21 offset:8704
    ds_read_b64_tr_b16 v[96:97], v22 offset:8192
    ds_read_b64_tr_b16 v[98:99], v22 offset:8704
    ds_read_b64_tr_b16 v[104:105], v23 offset:8192
    ds_read_b64_tr_b16 v[106:107], v23 offset:8704
    ds_read_b64_tr_b16 a[112:113], v24 offset:8192
    ds_read_b64_tr_b16 a[114:115], v24 offset:8704
    ds_read_b64_tr_b16 a[120:121], v25 offset:8192
    ds_read_b64_tr_b16 a[122:123], v25 offset:8704
    s_waitcnt lgkmcnt(4)
    ds_read_b64_tr_b16 a[144:145], v26 offset:8192
    ds_read_b64_tr_b16 a[146:147], v26 offset:8704
    ds_read_b64_tr_b16 a[152:153], v27 offset:8192
    ds_read_b64_tr_b16 a[154:155], v27 offset:8704
    s_waitcnt lgkmcnt(0)
    s_barrier
    s_add_u32 m0, s28, 8192
    s_add_u32 s37, s3, 0x300000
    buffer_load_dwordx4 v16, s[88:91], s37 offen lds
    s_add_u32 m0, s28, 9216
    s_add_u32 s37, s3, 0x308000
    buffer_load_dwordx4 v17, s[88:91], s37 offen lds
    s_add_u32 m0, s28, 10240
    s_add_u32 s37, s3, 0x310000
    buffer_load_dwordx4 v18, s[88:91], s37 offen lds
    s_add_u32 m0, s28, 11264
    s_add_u32 s37, s3, 0x318000
    buffer_load_dwordx4 v19, s[88:91], s37 offen lds
    s_add_u32 m0, s28, 12288
    s_add_u32 s37, s3, 0x320000
    buffer_load_dwordx4 v16, s[88:91], s37 offen lds
    s_add_u32 m0, s28, 13312
    s_add_u32 s37, s3, 0x328000
    buffer_load_dwordx4 v17, s[88:91], s37 offen lds
    s_add_u32 m0, s28, 14336
    s_add_u32 s37, s3, 0x330000
    buffer_load_dwordx4 v18, s[88:91], s37 offen lds
    s_add_u32 m0, s28, 15360
    s_add_u32 s37, s3, 0x338000
    buffer_load_dwordx4 v19, s[88:91], s37 offen lds
    s_waitcnt vmcnt(32)
    v_perm_b32 v240, v33, v32, s34
    v_perm_b32 v241, v33, v32, s35
    v_perm_b32 v242, v35, v34, s34
    v_perm_b32 v243, v35, v34, s35
    v_perm_b32 v244, v37, v36, s34
    v_perm_b32 v245, v37, v36, s35
    v_perm_b32 v246, v39, v38, s34
    v_perm_b32 v247, v39, v38, s35
    v_perm_b32 v248, v41, v40, s34
    v_perm_b32 v249, v41, v40, s35
    v_perm_b32 v250, v43, v42, s34
    v_perm_b32 v251, v43, v42, s35
    v_perm_b32 v252, v45, v44, s34
    v_perm_b32 v253, v45, v44, s35
    v_perm_b32 v254, v47, v46, s34
    v_perm_b32 v255, v47, v46, s35
    s_xor_b32 s36, s21, 1
    s_lshl_b32 s36, s36, 15
    s_add_u32 s36, s36, s29
    s_add_u32 s37, s36, 0x0
    buffer_load_dword v80, v11, s[92:95], s37 offen
    s_add_u32 s37, s36, 0x4000
    buffer_load_dword v81, v11, s[92:95], s37 offen
    s_add_u32 s37, s36, 0x400
    buffer_load_dword v82, v11, s[92:95], s37 offen
    s_add_u32 s37, s36, 0x4400
    buffer_load_dword v83, v11, s[92:95], s37 offen
    s_add_u32 s37, s36, 0x2000
    buffer_load_dword v84, v11, s[92:95], s37 offen
    s_add_u32 s37, s36, 0x6000
    buffer_load_dword v85, v11, s[92:95], s37 offen
    s_add_u32 s37, s36, 0x2400
    buffer_load_dword v86, v11, s[92:95], s37 offen
    s_add_u32 s37, s36, 0x6400
    buffer_load_dword v87, v11, s[92:95], s37 offen
    s_add_u32 s37, s36, 0x40
    buffer_load_dword v88, v11, s[92:95], s37 offen
    s_add_u32 s37, s36, 0x4040
    buffer_load_dword v89, v11, s[92:95], s37 offen
    s_add_u32 s37, s36, 0x440
    buffer_load_dword v90, v11, s[92:95], s37 offen
    s_add_u32 s37, s36, 0x4440
    buffer_load_dword v91, v11, s[92:95], s37 offen
    s_add_u32 s37, s36, 0x2040
    buffer_load_dword v92, v11, s[92:95], s37 offen
    s_add_u32 s37, s36, 0x6040
    buffer_load_dword v93, v11, s[92:95], s37 offen
    s_add_u32 s37, s36, 0x2440
    buffer_load_dword v94, v11, s[92:95], s37 offen
    s_add_u32 s37, s36, 0x6440
    buffer_load_dword v95, v11, s[92:95], s37 offen
    s_barrier
    ds_read_b64_tr_b16 v[68:69], v20 offset:16384
    ds_read_b64_tr_b16 v[70:71], v20 offset:16896
    ds_read_b64_tr_b16 v[76:77], v21 offset:16384
    ds_read_b64_tr_b16 v[78:79], v21 offset:16896
    ds_read_b64_tr_b16 v[100:101], v22 offset:16384
    ds_read_b64_tr_b16 v[102:103], v22 offset:16896
    ds_read_b64_tr_b16 v[108:109], v23 offset:16384
    ds_read_b64_tr_b16 v[110:111], v23 offset:16896
    ds_read_b64_tr_b16 a[116:117], v24 offset:16384
    ds_read_b64_tr_b16 a[118:119], v24 offset:16896
    ds_read_b64_tr_b16 a[124:125], v25 offset:16384
    ds_read_b64_tr_b16 a[126:127], v25 offset:16896
    s_waitcnt lgkmcnt(4)
    ds_read_b64_tr_b16 a[148:149], v26 offset:16384
    ds_read_b64_tr_b16 a[150:151], v26 offset:16896
    ds_read_b64_tr_b16 a[156:157], v27 offset:16384
    ds_read_b64_tr_b16 a[158:159], v27 offset:16896
    s_waitcnt lgkmcnt(0)
    s_barrier
    s_mov_b32 s96, s48
    s_and_b32 s97, s49, 0xffff
    s_mov_b32 s98, 0x400000
    s_mov_b32 s99, 0x20000
    s_add_u32 m0, s28, 16384
    s_add_u32 s37, s3, 0x0
    buffer_load_dwordx4 v16, s[96:99], s37 offen lds
    s_add_u32 m0, s28, 17408
    s_add_u32 s37, s3, 0x8000
    buffer_load_dwordx4 v17, s[96:99], s37 offen lds
    s_add_u32 m0, s28, 18432
    s_add_u32 s37, s3, 0x10000
    buffer_load_dwordx4 v18, s[96:99], s37 offen lds
    s_add_u32 m0, s28, 19456
    s_add_u32 s37, s3, 0x18000
    buffer_load_dwordx4 v19, s[96:99], s37 offen lds
    s_add_u32 m0, s28, 20480
    s_add_u32 s37, s3, 0x20000
    buffer_load_dwordx4 v16, s[96:99], s37 offen lds
    s_add_u32 m0, s28, 21504
    s_add_u32 s37, s3, 0x28000
    buffer_load_dwordx4 v17, s[96:99], s37 offen lds
    s_add_u32 m0, s28, 22528
    s_add_u32 s37, s3, 0x30000
    buffer_load_dwordx4 v18, s[96:99], s37 offen lds
    s_add_u32 m0, s28, 23552
    s_add_u32 s37, s3, 0x38000
    buffer_load_dwordx4 v19, s[96:99], s37 offen lds
    s_waitcnt vmcnt(32)
    v_perm_b32 v216, v49, v48, s34
    v_perm_b32 v217, v49, v48, s35
    v_perm_b32 v218, v51, v50, s34
    v_perm_b32 v219, v51, v50, s35
    v_perm_b32 v220, v53, v52, s34
    v_perm_b32 v221, v53, v52, s35
    v_perm_b32 v222, v55, v54, s34
    v_perm_b32 v223, v55, v54, s35
    v_perm_b32 v224, v57, v56, s34
    v_perm_b32 v225, v57, v56, s35
    v_perm_b32 v226, v59, v58, s34
    v_perm_b32 v227, v59, v58, s35
    v_perm_b32 v228, v61, v60, s34
    v_perm_b32 v229, v61, v60, s35
    v_perm_b32 v230, v63, v62, s34
    v_perm_b32 v231, v63, v62, s35
    s_xor_b32 s36, s21, 0
    s_lshl_b32 s36, s36, 15
    s_add_u32 s36, s36, s29
    s_add_u32 s37, s36, 0x80
    buffer_load_dword v32, v11, s[92:95], s37 offen
    s_add_u32 s37, s36, 0x4080
    buffer_load_dword v33, v11, s[92:95], s37 offen
    s_add_u32 s37, s36, 0x480
    buffer_load_dword v34, v11, s[92:95], s37 offen
    s_add_u32 s37, s36, 0x4480
    buffer_load_dword v35, v11, s[92:95], s37 offen
    s_add_u32 s37, s36, 0x2080
    buffer_load_dword v36, v11, s[92:95], s37 offen
    s_add_u32 s37, s36, 0x6080
    buffer_load_dword v37, v11, s[92:95], s37 offen
    s_add_u32 s37, s36, 0x2480
    buffer_load_dword v38, v11, s[92:95], s37 offen
    s_add_u32 s37, s36, 0x6480
    buffer_load_dword v39, v11, s[92:95], s37 offen
    s_add_u32 s37, s36, 0xc0
    buffer_load_dword v40, v11, s[92:95], s37 offen
    s_add_u32 s37, s36, 0x40c0
    buffer_load_dword v41, v11, s[92:95], s37 offen
    s_add_u32 s37, s36, 0x4c0
    buffer_load_dword v42, v11, s[92:95], s37 offen
    s_add_u32 s37, s36, 0x44c0
    buffer_load_dword v43, v11, s[92:95], s37 offen
    s_add_u32 s37, s36, 0x20c0
    buffer_load_dword v44, v11, s[92:95], s37 offen
    s_add_u32 s37, s36, 0x60c0
    buffer_load_dword v45, v11, s[92:95], s37 offen
    s_add_u32 s37, s36, 0x24c0
    buffer_load_dword v46, v11, s[92:95], s37 offen
    s_add_u32 s37, s36, 0x64c0
    buffer_load_dword v47, v11, s[92:95], s37 offen
    s_barrier
    ds_read_b64_tr_b16 a[80:81], v20 offset:0
    ds_read_b64_tr_b16 a[82:83], v20 offset:512
    ds_read_b64_tr_b16 a[88:89], v21 offset:0
    ds_read_b64_tr_b16 a[90:91], v21 offset:512
    ds_read_b64_tr_b16 a[96:97], v22 offset:0
    ds_read_b64_tr_b16 a[98:99], v22 offset:512
    ds_read_b64_tr_b16 a[104:105], v23 offset:0
    ds_read_b64_tr_b16 a[106:107], v23 offset:512
    ds_read_b64_tr_b16 a[128:129], v24 offset:0
    ds_read_b64_tr_b16 a[130:131], v24 offset:512
    ds_read_b64_tr_b16 a[136:137], v25 offset:0
    ds_read_b64_tr_b16 a[138:139], v25 offset:512
    s_waitcnt lgkmcnt(4)
    ds_read_b64_tr_b16 v[112:113], v26 offset:0
    ds_read_b64_tr_b16 v[114:115], v26 offset:512
    ds_read_b64_tr_b16 v[120:121], v27 offset:0
    ds_read_b64_tr_b16 v[122:123], v27 offset:512
    s_waitcnt lgkmcnt(0)
    s_barrier
    s_add_u32 m0, s28, 0
    s_add_u32 s37, s3, 0x100000
    buffer_load_dwordx4 v16, s[96:99], s37 offen lds
    s_add_u32 m0, s28, 1024
    s_add_u32 s37, s3, 0x108000
    buffer_load_dwordx4 v17, s[96:99], s37 offen lds
    s_add_u32 m0, s28, 2048
    s_add_u32 s37, s3, 0x110000
    buffer_load_dwordx4 v18, s[96:99], s37 offen lds
    s_add_u32 m0, s28, 3072
    s_add_u32 s37, s3, 0x118000
    buffer_load_dwordx4 v19, s[96:99], s37 offen lds
    s_add_u32 m0, s28, 4096
    s_add_u32 s37, s3, 0x120000
    buffer_load_dwordx4 v16, s[96:99], s37 offen lds
    s_add_u32 m0, s28, 5120
    s_add_u32 s37, s3, 0x128000
    buffer_load_dwordx4 v17, s[96:99], s37 offen lds
    s_add_u32 m0, s28, 6144
    s_add_u32 s37, s3, 0x130000
    buffer_load_dwordx4 v18, s[96:99], s37 offen lds
    s_add_u32 m0, s28, 7168
    s_add_u32 s37, s3, 0x138000
    buffer_load_dwordx4 v19, s[96:99], s37 offen lds
    s_waitcnt vmcnt(32)
    v_perm_b32 v192, v81, v80, s34
    v_perm_b32 v193, v81, v80, s35
    v_perm_b32 v194, v83, v82, s34
    v_perm_b32 v195, v83, v82, s35
    v_perm_b32 v196, v85, v84, s34
    v_perm_b32 v197, v85, v84, s35
    v_perm_b32 v198, v87, v86, s34
    v_perm_b32 v199, v87, v86, s35
    v_perm_b32 v200, v89, v88, s34
    v_perm_b32 v201, v89, v88, s35
    v_perm_b32 v202, v91, v90, s34
    v_perm_b32 v203, v91, v90, s35
    v_perm_b32 v204, v93, v92, s34
    v_perm_b32 v205, v93, v92, s35
    v_perm_b32 v206, v95, v94, s34
    v_perm_b32 v207, v95, v94, s35
    s_xor_b32 s36, s21, 0
    s_lshl_b32 s36, s36, 15
    s_add_u32 s36, s36, s29
    s_add_u32 s37, s36, 0x0
    buffer_load_dword v48, v11, s[92:95], s37 offen
    s_add_u32 s37, s36, 0x4000
    buffer_load_dword v49, v11, s[92:95], s37 offen
    s_add_u32 s37, s36, 0x400
    buffer_load_dword v50, v11, s[92:95], s37 offen
    s_add_u32 s37, s36, 0x4400
    buffer_load_dword v51, v11, s[92:95], s37 offen
    s_add_u32 s37, s36, 0x2000
    buffer_load_dword v52, v11, s[92:95], s37 offen
    s_add_u32 s37, s36, 0x6000
    buffer_load_dword v53, v11, s[92:95], s37 offen
    s_add_u32 s37, s36, 0x2400
    buffer_load_dword v54, v11, s[92:95], s37 offen
    s_add_u32 s37, s36, 0x6400
    buffer_load_dword v55, v11, s[92:95], s37 offen
    s_add_u32 s37, s36, 0x40
    buffer_load_dword v56, v11, s[92:95], s37 offen
    s_add_u32 s37, s36, 0x4040
    buffer_load_dword v57, v11, s[92:95], s37 offen
    s_add_u32 s37, s36, 0x440
    buffer_load_dword v58, v11, s[92:95], s37 offen
    s_add_u32 s37, s36, 0x4440
    buffer_load_dword v59, v11, s[92:95], s37 offen
    s_add_u32 s37, s36, 0x2040
    buffer_load_dword v60, v11, s[92:95], s37 offen
    s_add_u32 s37, s36, 0x6040
    buffer_load_dword v61, v11, s[92:95], s37 offen
    s_add_u32 s37, s36, 0x2440
    buffer_load_dword v62, v11, s[92:95], s37 offen
    s_add_u32 s37, s36, 0x6440
    buffer_load_dword v63, v11, s[92:95], s37 offen
    s_barrier
    ds_read_b64_tr_b16 a[84:85], v20 offset:8192
    ds_read_b64_tr_b16 a[86:87], v20 offset:8704
    ds_read_b64_tr_b16 a[92:93], v21 offset:8192
    ds_read_b64_tr_b16 a[94:95], v21 offset:8704
    ds_read_b64_tr_b16 a[100:101], v22 offset:8192
    ds_read_b64_tr_b16 a[102:103], v22 offset:8704
    ds_read_b64_tr_b16 a[108:109], v23 offset:8192
    ds_read_b64_tr_b16 a[110:111], v23 offset:8704
    ds_read_b64_tr_b16 a[132:133], v24 offset:8192
    ds_read_b64_tr_b16 a[134:135], v24 offset:8704
    ds_read_b64_tr_b16 a[140:141], v25 offset:8192
    ds_read_b64_tr_b16 a[142:143], v25 offset:8704
    s_waitcnt lgkmcnt(4)
    ds_read_b64_tr_b16 v[116:117], v26 offset:8192
    ds_read_b64_tr_b16 v[118:119], v26 offset:8704
    ds_read_b64_tr_b16 v[124:125], v27 offset:8192
    ds_read_b64_tr_b16 v[126:127], v27 offset:8704
    s_waitcnt lgkmcnt(0)
    s_barrier
    s_add_u32 m0, s28, 8192
    s_add_u32 s37, s3, 0x200000
    buffer_load_dwordx4 v16, s[96:99], s37 offen lds
    s_add_u32 m0, s28, 9216
    s_add_u32 s37, s3, 0x208000
    buffer_load_dwordx4 v17, s[96:99], s37 offen lds
    s_add_u32 m0, s28, 10240
    s_add_u32 s37, s3, 0x210000
    buffer_load_dwordx4 v18, s[96:99], s37 offen lds
    s_add_u32 m0, s28, 11264
    s_add_u32 s37, s3, 0x218000
    buffer_load_dwordx4 v19, s[96:99], s37 offen lds
    s_add_u32 m0, s28, 12288
    s_add_u32 s37, s3, 0x220000
    buffer_load_dwordx4 v16, s[96:99], s37 offen lds
    s_add_u32 m0, s28, 13312
    s_add_u32 s37, s3, 0x228000
    buffer_load_dwordx4 v17, s[96:99], s37 offen lds
    s_add_u32 m0, s28, 14336
    s_add_u32 s37, s3, 0x230000
    buffer_load_dwordx4 v18, s[96:99], s37 offen lds
    s_add_u32 m0, s28, 15360
    s_add_u32 s37, s3, 0x238000
    buffer_load_dwordx4 v19, s[96:99], s37 offen lds
    s_waitcnt vmcnt(32)
    v_perm_b32 v176, v33, v32, s34
    v_perm_b32 v177, v33, v32, s35
    v_perm_b32 v178, v35, v34, s34
    v_perm_b32 v179, v35, v34, s35
    v_perm_b32 v180, v37, v36, s34
    v_perm_b32 v181, v37, v36, s35
    v_perm_b32 v182, v39, v38, s34
    v_perm_b32 v183, v39, v38, s35
    v_perm_b32 v184, v41, v40, s34
    v_perm_b32 v185, v41, v40, s35
    v_perm_b32 v186, v43, v42, s34
    v_perm_b32 v187, v43, v42, s35
    v_perm_b32 v188, v45, v44, s34
    v_perm_b32 v189, v45, v44, s35
    v_perm_b32 v190, v47, v46, s34
    v_perm_b32 v191, v47, v46, s35
    v_lshrrev_b32 v31, 2, v3
    buffer_load_dword v30, v31, s[16:19], 0 offen sc1
    s_barrier
    ds_read_b64_tr_b16 v[32:33], v20 offset:16384
    ds_read_b64_tr_b16 v[34:35], v20 offset:16896
    ds_read_b64_tr_b16 v[40:41], v21 offset:16384
    ds_read_b64_tr_b16 v[42:43], v21 offset:16896
    ds_read_b64_tr_b16 a[0:1], v22 offset:16384
    ds_read_b64_tr_b16 a[2:3], v22 offset:16896
    ds_read_b64_tr_b16 a[8:9], v23 offset:16384
    ds_read_b64_tr_b16 a[10:11], v23 offset:16896
    ds_read_b64_tr_b16 a[32:33], v24 offset:16384
    ds_read_b64_tr_b16 a[34:35], v24 offset:16896
    ds_read_b64_tr_b16 a[40:41], v25 offset:16384
    ds_read_b64_tr_b16 a[42:43], v25 offset:16896
    s_waitcnt lgkmcnt(4)
    ds_read_b64_tr_b16 a[64:65], v26 offset:16384
    ds_read_b64_tr_b16 a[66:67], v26 offset:16896
    ds_read_b64_tr_b16 a[72:73], v27 offset:16384
    ds_read_b64_tr_b16 a[74:75], v27 offset:16896
    s_waitcnt lgkmcnt(0)
    s_barrier
    s_add_u32 m0, s28, 16384
    s_add_u32 s37, s3, 0x300000
    buffer_load_dwordx4 v16, s[96:99], s37 offen lds
    s_add_u32 m0, s28, 17408
    s_add_u32 s37, s3, 0x308000
    buffer_load_dwordx4 v17, s[96:99], s37 offen lds
    s_add_u32 m0, s28, 18432
    s_add_u32 s37, s3, 0x310000
    buffer_load_dwordx4 v18, s[96:99], s37 offen lds
    s_add_u32 m0, s28, 19456
    s_add_u32 s37, s3, 0x318000
    buffer_load_dwordx4 v19, s[96:99], s37 offen lds
    s_add_u32 m0, s28, 20480
    s_add_u32 s37, s3, 0x320000
    buffer_load_dwordx4 v16, s[96:99], s37 offen lds
    s_add_u32 m0, s28, 21504
    s_add_u32 s37, s3, 0x328000
    buffer_load_dwordx4 v17, s[96:99], s37 offen lds
    s_add_u32 m0, s28, 22528
    s_add_u32 s37, s3, 0x330000
    buffer_load_dwordx4 v18, s[96:99], s37 offen lds
    s_add_u32 m0, s28, 23552
    s_add_u32 s37, s3, 0x338000
    buffer_load_dwordx4 v19, s[96:99], s37 offen lds
    s_waitcnt vmcnt(17)
    v_perm_b32 v160, v49, v48, s34
    v_perm_b32 v161, v49, v48, s35
    v_perm_b32 v162, v51, v50, s34
    v_perm_b32 v163, v51, v50, s35
    v_perm_b32 v164, v53, v52, s34
    v_perm_b32 v165, v53, v52, s35
    v_perm_b32 v166, v55, v54, s34
    v_perm_b32 v167, v55, v54, s35
    v_perm_b32 v168, v57, v56, s34
    v_perm_b32 v169, v57, v56, s35
    v_perm_b32 v170, v59, v58, s34
    v_perm_b32 v171, v59, v58, s35
    v_perm_b32 v172, v61, v60, s34
    v_perm_b32 v173, v61, v60, s35
    v_perm_b32 v174, v63, v62, s34
    v_perm_b32 v175, v63, v62, s35
    s_waitcnt vmcnt(8)
    s_mov_b32 s41, 1
L_HS:
    v_cmp_eq_u32 vcc, 0, v30
    s_cbranch_vccz L_HS_ok
    buffer_load_dword v30, v31, s[16:19], 0 offen sc1
    s_add_u32 s32, s32, 1
    s_cmp_gt_u32 s32, 200000
    s_waitcnt vmcnt(0)
    s_cbranch_scc0 L_HS
    s_branch L_HS_done
L_HS_ok:
    v_readlane_b32 s36, v30, 63
    s_nop 1
    v_cmp_ne_u32 vcc, s36, v30
    s_nop 1
    s_cmp_lg_u32 vcc_hi, 0
    s_cselect_b32 s41, 1, 0
L_HS_done:
    s_mov_b32 s7, 0xf7df00
    buffer_load_dword v15, v0, s[8:11], s7 offen sc1
    s_barrier
    ds_read_b64_tr_b16 v[36:37], v20 offset:0
    ds_read_b64_tr_b16 v[38:39], v20 offset:512
    ds_read_b64_tr_b16 v[44:45], v21 offset:0
    ds_read_b64_tr_b16 v[46:47], v21 offset:512
    ds_read_b64_tr_b16 a[4:5], v22 offset:0
    ds_read_b64_tr_b16 a[6:7], v22 offset:512
    ds_read_b64_tr_b16 a[12:13], v23 offset:0
    ds_read_b64_tr_b16 a[14:15], v23 offset:512
    ds_read_b64_tr_b16 a[36:37], v24 offset:0
    ds_read_b64_tr_b16 a[38:39], v24 offset:512
    ds_read_b64_tr_b16 a[44:45], v25 offset:0
    ds_read_b64_tr_b16 a[46:47], v25 offset:512
    s_waitcnt lgkmcnt(4)
    ds_read_b64_tr_b16 a[68:69], v26 offset:0
    ds_read_b64_tr_b16 a[70:71], v26 offset:512
    ds_read_b64_tr_b16 a[76:77], v27 offset:0
    ds_read_b64_tr_b16 a[78:79], v27 offset:512
    s_waitcnt lgkmcnt(0)
    s_barrier
    s_barrier
    ds_read_b64_tr_b16 v[48:49], v20 offset:8192
    ds_read_b64_tr_b16 v[50:51], v20 offset:8704
    ds_read_b64_tr_b16 v[56:57], v21 offset:8192
    ds_read_b64_tr_b16 v[58:59], v21 offset:8704
    ds_read_b64_tr_b16 a[16:17], v22 offset:8192
    ds_read_b64_tr_b16 a[18:19], v22 offset:8704
    ds_read_b64_tr_b16 a[24:25], v23 offset:8192
    ds_read_b64_tr_b16 a[26:27], v23 offset:8704
    ds_read_b64_tr_b16 a[48:49], v24 offset:8192
    ds_read_b64_tr_b16 a[50:51], v24 offset:8704
    ds_read_b64_tr_b16 a[56:57], v25 offset:8192
    ds_read_b64_tr_b16 a[58:59], v25 offset:8704
    s_waitcnt lgkmcnt(4)
    ds_read_b64_tr_b16 v[80:81], v26 offset:8192
    ds_read_b64_tr_b16 v[82:83], v26 offset:8704
    ds_read_b64_tr_b16 v[88:89], v27 offset:8192
    ds_read_b64_tr_b16 v[90:91], v27 offset:8704
    s_waitcnt lgkmcnt(0)
    s_barrier
    s_waitcnt vmcnt(0)
L_F0:
    v_readlane_b32 s36, v15, 33
    s_nop 1
    s_cmp_lg_u32 s36, 0
    s_cbranch_scc1 L_F0_ok
    buffer_load_dword v15, v0, s[8:11], s7 offen sc1
    s_add_u32 s32, s32, 1
    s_cmp_gt_u32 s32, 200000
    s_waitcnt vmcnt(0)
    s_cbranch_scc0 L_F0
L_F0_ok:
    s_mov_b32 s7, 0x1000000
    buffer_load_dword v15, v0, s[8:11], s7 offen sc1
    s_barrier
    ds_read_b64_tr_b16 v[52:53], v20 offset:16384
    ds_read_b64_tr_b16 v[54:55], v20 offset:16896
    ds_read_b64_tr_b16 v[60:61], v21 offset:16384
    ds_read_b64_tr_b16 v[62:63], v21 offset:16896
    ds_read_b64_tr_b16 a[20:21], v22 offset:16384
    ds_read_b64_tr_b16 a[22:23], v22 offset:16896
    ds_read_b64_tr_b16 a[28:29], v23 offset:16384
    ds_read_b64_tr_b16 a[30:31], v23 offset:16896
    ds_read_b64_tr_b16 a[52:53], v24 offset:16384
    ds_read_b64_tr_b16 a[54:55], v24 offset:16896
    ds_read_b64_tr_b16 a[60:61], v25 offset:16384
    ds_read_b64_tr_b16 a[62:63], v25 offset:16896
    s_waitcnt lgkmcnt(4)
    ds_read_b64_tr_b16 v[84:85], v26 offset:16384
    ds_read_b64_tr_b16 v[86:87], v26 offset:16896
    ds_read_b64_tr_b16 v[92:93], v27 offset:16384
    ds_read_b64_tr_b16 v[94:95], v27 offset:16896
    s_waitcnt lgkmcnt(0)
    s_barrier
    ds_write_b128 v4, v[32:35] offset:0
    ds_write_b128 v4, v[36:39] offset:1024
    ds_write_b128 v4, v[40:43] offset:2048
    ds_write_b128 v4, v[44:47] offset:3072
    ds_write_b128 v4, v[48:51] offset:4096
    ds_write_b128 v4, v[52:55] offset:5120
    ds_write_b128 v4, v[56:59] offset:6144
    ds_write_b128 v4, v[60:63] offset:7168
    s_waitcnt lgkmcnt(0)
    ds_write_b128 v4, v[64:67] offset:8192
    ds_write_b128 v4, v[68:71] offset:9216
    ds_write_b128 v4, v[72:75] offset:10240
    ds_write_b128 v4, v[76:79] offset:11264
    ds_write_b128 v4, v[80:83] offset:12288
    ds_write_b128 v4, v[84:87] offset:13312
    ds_write_b128 v4, v[88:91] offset:14336
    ds_write_b128 v4, v[92:95] offset:15360
    s_waitcnt lgkmcnt(0)
    ds_write_b128 v4, v[96:99] offset:16384
    ds_write_b128 v4, v[100:103] offset:17408
    ds_write_b128 v4, v[104:107] offset:18432
    ds_write_b128 v4, v[108:111] offset:19456
    ds_write_b128 v4, v[112:115] offset:20480
    ds_write_b128 v4, v[116:119] offset:21504
    ds_write_b128 v4, v[120:123] offset:22528
    ds_write_b128 v4, v[124:127] offset:23552
    s_waitcnt lgkmcnt(0)
    s_waitcnt lgkmcnt(0)
    s_cmp_lg_u32 s41, 0
    s_cbranch_scc1 L_slow_start
L_fast_start:
    s_mov_b32 s22, 0
    s_mov_b32 s23, 0x1000000
    s_mov_b32 s27, 0
    s_mov_b32 s31, 0x80000
    s_mov_b32 s61, 0x40000000
    s_mov_b32 s96, 0x800
    s_mov_b32 s97, 0x1000
    s_mov_b32 s98, 0x1800
    s_mov_b32 s92, 0xcccccccc
    s_mov_b32 s93, 0xcccccccc
    s_mov_b32 s91, 0
    ds_read_b128 v[104:107], v4 offset:0
    ds_read_b128 v[108:111], v4 offset:1024
    ds_read_b128 v[112:115], v4 offset:2048
    ds_read_b128 v[116:119], v4 offset:3072
    ds_read_b128 v[88:91], v4 offset:4096
    ds_read_b128 v[92:95], v4 offset:5120
    ds_read_b128 v[96:99], v4 offset:6144
    ds_read_b128 v[100:103], v4 offset:7168
    ds_read_b128 v[72:75], v4 offset:8192
    ds_read_b128 v[76:79], v4 offset:9216
    ds_read_b128 v[80:83], v4 offset:10240
    ds_read_b128 v[84:87], v4 offset:11264
    v_mov_b64 v[48:49], 0
    v_mov_b64 v[50:51], 0
    v_mov_b64 v[52:53], 0
    v_mov_b64 v[54:55], 0
    v_mov_b64 v[56:57], 0
    v_mov_b64 v[58:59], 0
    v_mov_b64 v[60:61], 0
    v_mov_b64 v[62:63], 0
    v_mov_b64 v[64:65], 0
    v_mov_b64 v[66:67], 0
    v_mov_b64 v[68:69], 0
    v_mov_b64 v[70:71], 0
    s_add_u32 s7, s23, 0x80000
    buffer_load_dwordx4 v[16:19], v2, s[8:11], s7 offen sc1
    buffer_load_dwordx4 v[20:23], v2, s[8:11], s7 offen offset:1024 sc1
    s_waitcnt vmcnt(2)
L_fast_step:
    v_readlane_b32 s36, v15, 33
    s_add_u32 s24, s23, 0x82100
    s_cmp_eq_u32 s36, 0
    s_cbranch_scc1 L_fast_refresh
L_fast_fresh:
    s_add_u32 s29, s23, s25
    s_add_u32 s30, s23, s39
    s_xor_b32 s28, s27, 1
    s_add_u32 s90, s22, 1
    s_nop 15
L_fast_retrym:
    buffer_load_dwordx4 v[16:19], v2, s[8:11], s7 offen sc1
    buffer_load_dwordx4 v[20:23], v2, s[8:11], s7 offen offset:1024 sc1
L_fast_prem:
    s_add_u32 s32, s32, 1
    s_cmp_gt_u32 s32, 200000
    s_cselect_b32 s94, -1, -2
    v_xor_b32 v28, 0x800, v2
    v_xor_b32 v44, 0x1800, v2
    v_mov_b64 v[48:49], 0
    v_mov_b64 v[50:51], 0
    v_mov_b64 v[52:53], 0
    v_mov_b64 v[54:55], 0
L_fast_waitm:
    s_waitcnt vmcnt(3) lgkmcnt(0)
L_fast_gotm:
    v_max3_u32 v14, v16, v17, v18
    v_max_u32 v14, v14, v19
    v_smfmac_f32_16x16x64_bf16 v[48:51], v[16:19], v[104:111], v1
    s_waitcnt vmcnt(2)
    v_max3_u32 v14, v14, v20, v21
    v_smfmac_f32_16x16x64_bf16 v[52:55], v[16:19], v[112:119], v1
    v_max3_u32 v14, v14, v22, v23
    v_cmp_lt_u32 vcc, s94, v14
    v_smfmac_f32_16x16x64_bf16 v[48:51], v[20:23], v[88:95], v1
    ds_write_b128 v2, v[16:19] offset:0
    s_cbranch_vccnz L_fast_retrym
    v_smfmac_f32_16x16x64_bf16 v[52:55], v[20:23], v[96:103], v1
    ds_write_b128 v2, v[20:23] offset:1024
    v_smfmac_f32_16x16x64_bf16 v[56:59], v[16:19], v[72:79], v1
    buffer_load_dwordx4 v[104:107], v3, s[8:11], s29 offen offset:0 sc1
    buffer_load_dwordx4 v[120:123], v3, s[8:11], s30 offen offset:0 sc1
    v_smfmac_f32_16x16x64_bf16 v[60:63], v[16:19], v[80:87], v1
    buffer_load_dwordx4 v[108:111], v3, s[8:11], s29 offen offset:1024 sc1
    buffer_load_dwordx4 v[124:127], v3, s[8:11], s30 offen offset:1024 sc1
    v_smfmac_f32_16x16x64_bf16 v[56:59], v[20:23], a[80:87], v1
    buffer_load_dwordx4 v[112:115], v3, s[8:11], s29 offen offset:2048 sc1
    buffer_load_dwordx4 v[116:119], v3, s[8:11], s29 offen offset:3072 sc1
    v_smfmac_f32_16x16x64_bf16 v[60:63], v[20:23], a[88:95], v1
    s_waitcnt lgkmcnt(0)
    s_barrier
    ds_read_b128 v[24:27], v28 offset:0
    v_smfmac_f32_16x16x64_bf16 v[64:67], v[16:19], a[160:167], v1
    ds_read_b128 v[28:31], v28 offset:1024
    v_smfmac_f32_16x16x64_bf16 v[68:71], v[16:19], a[168:175], v1
    buffer_load_dword v15, v0, s[8:11], s24 offen sc1
    v_smfmac_f32_16x16x64_bf16 v[64:67], v[20:23], a[176:183], v1
    ds_read_b128 v[32:35], v8 offset:0
    v_smfmac_f32_16x16x64_bf16 v[68:71], v[20:23], a[184:191], v1
    ds_read_b128 v[36:39], v8 offset:1024
    s_waitcnt lgkmcnt(3)
    v_smfmac_f32_16x16x64_bf16 v[48:51], v[24:27], a[0:7], v1
    ds_read_b128 v[40:43], v44 offset:0
    v_smfmac_f32_16x16x64_bf16 v[52:55], v[24:27], a[8:15], v1
    ds_read_b128 v[44:47], v44 offset:1024
    s_waitcnt lgkmcnt(4)
    v_smfmac_f32_16x16x64_bf16 v[48:51], v[28:31], a[16:23], v1
    ds_read_b128 v[88:91], v4 offset:12288
    v_smfmac_f32_16x16x64_bf16 v[52:55], v[28:31], a[24:31], v1
    ds_read_b128 v[92:95], v4 offset:13312
    s_waitcnt lgkmcnt(4)
    v_smfmac_f32_16x16x64_bf16 v[48:51], v[32:35], a[32:39], v1
    ds_read_b128 v[96:99], v4 offset:14336
    v_smfmac_f32_16x16x64_bf16 v[52:55], v[32:35], a[40:47], v1
    ds_read_b128 v[100:103], v4 offset:15360
    s_waitcnt lgkmcnt(4)
    v_smfmac_f32_16x16x64_bf16 v[48:51], v[36:39], a[48:55], v1
    v_smfmac_f32_16x16x64_bf16 v[52:55], v[36:39], a[56:63], v1
    ds_read_b128 v[72:75], v4 offset:16384
    v_smfmac_f32_16x16x64_bf16 v[48:51], v[40:43], a[64:71], v1
    v_smfmac_f32_16x16x64_bf16 v[52:55], v[40:43], a[72:79], v1
    ds_read_b128 v[76:79], v4 offset:17408
    s_waitcnt lgkmcnt(2)
    v_smfmac_f32_16x16x64_bf16 v[48:51], v[44:47], v[88:95], v1
    ds_read_b128 v[80:83], v4 offset:18432
    v_smfmac_f32_16x16x64_bf16 v[52:55], v[44:47], v[96:103], v1
    ds_read_b128 v[84:87], v4 offset:19456
    v_smfmac_f32_16x16x64_bf16 v[56:59], v[28:31], a[96:103], v1
    ds_read_b128 v[88:91], v4 offset:20480
    v_smfmac_f32_16x16x64_bf16 v[60:63], v[28:31], a[104:111], v1
    ds_read_b128 v[92:95], v4 offset:21504
    v_smfmac_f32_16x16x64_bf16 v[56:59], v[32:35], a[112:119], v1
    ds_read_b128 v[96:99], v4 offset:22528
    v_add_f32 v48, v48, v50
    v_add_f32 v49, v49, v51
    v_smfmac_f32_16x16x64_bf16 v[60:63], v[32:35], a[120:127], v1
    ds_read_b128 v[100:103], v4 offset:23552
    v_add_f32 v52, v52, v54
    v_add_f32 v53, v53, v55
    v_smfmac_f32_16x16x64_bf16 v[56:59], v[36:39], a[128:135], v1
    s_waitcnt lgkmcnt(4)
    v_cvt_pk_bf16_f32 v50, v48, v52
    v_cvt_pk_bf16_f32 v51, v49, v53
    v_smfmac_f32_16x16x64_bf16 v[56:59], v[24:27], v[72:79], v1
    ds_write2_b32 v5, v50, v51 offset0:0 offset1:72
    v_smfmac_f32_16x16x64_bf16 v[60:63], v[24:27], v[80:87], v1
    v_smfmac_f32_16x16x64_bf16 v[60:63], v[36:39], a[136:143], v1
    v_smfmac_f32_16x16x64_bf16 v[56:59], v[40:43], a[144:151], v1
    buffer_store_dword v12, v10, s[8:11], s31 offen sc1
    v_smfmac_f32_16x16x64_bf16 v[60:63], v[40:43], a[152:159], v1
    s_waitcnt lgkmcnt(0)
    s_barrier
    v_smfmac_f32_16x16x64_bf16 v[56:59], v[44:47], v[88:95], v1
    ds_read_b128 v[72:75], v6 offset:0
    v_smfmac_f32_16x16x64_bf16 v[60:63], v[44:47], v[96:103], v1
    ds_read_b128 v[76:79], v6 offset:64
    v_smfmac_f32_16x16x64_bf16 v[64:67], v[24:27], a[192:199], v1
    ds_read_b128 v[80:83], v6 offset:128
    v_smfmac_f32_16x16x64_bf16 v[68:71], v[24:27], a[200:207], v1
    ds_read_b128 v[84:87], v6 offset:192
    s_waitcnt vmcnt(2) lgkmcnt(3)
    v_mfma_f32_16x16x32_bf16 v[48:51], v[104:107], v[72:75], 0
    s_waitcnt lgkmcnt(2)
    v_add_f32 v56, v56, v58
    v_add_f32 v57, v57, v59
    v_mfma_f32_16x16x32_bf16 v[48:51], v[108:111], v[76:79], v[48:51]
    s_waitcnt lgkmcnt(1)
    v_add_f32 v60, v60, v62
    v_add_f32 v61, v61, v63
    v_mfma_f32_16x16x32_bf16 v[48:51], v[112:115], v[80:83], v[48:51]
    s_waitcnt lgkmcnt(0)
    v_cvt_pk_bf16_f32 v58, v56, v60
    v_cvt_pk_bf16_f32 v59, v57, v61
    v_mfma_f32_16x16x32_bf16 v[48:51], v[116:119], v[84:87], v[48:51]
    ds_write2_b32 v7, v58, v59 offset0:0 offset1:72
    v_smfmac_f32_16x16x64_bf16 v[64:67], v[28:31], a[208:215], v1
    v_mov_b64 v[104:105], s[4:5]
    v_smfmac_f32_16x16x64_bf16 v[68:71], v[28:31], a[216:223], v1
    s_nop 1
    v_mov_b64 v[106:107], s[4:5]
    v_smfmac_f32_16x16x64_bf16 v[64:67], v[32:35], a[224:231], v1
    v_exp_f32 v48, v48
    v_smfmac_f32_16x16x64_bf16 v[68:71], v[32:35], a[232:239], v1
    s_waitcnt lgkmcnt(0)
    s_barrier
    v_exp_f32 v49, v49
    v_smfmac_f32_16x16x64_bf16 v[64:67], v[36:39], a[240:247], v1
    ds_read_b128 v[88:91], v6 offset:2304
    v_exp_f32 v50, v50
    v_smfmac_f32_16x16x64_bf16 v[68:71], v[36:39], a[248:255], v1
    ds_read_b128 v[92:95], v6 offset:2368
    v_exp_f32 v51, v51
    v_smfmac_f32_16x16x64_bf16 v[64:67], v[40:43], v[128:135], v1
    ds_read_b128 v[96:99], v6 offset:2432
    v_cvt_pk_bf16_f32 v108, v48, v49
    v_cvt_pk_bf16_f32 v109, v50, v51
    v_smfmac_f32_16x16x64_bf16 v[68:71], v[40:43], v[136:143], v1
    ds_read_b128 v[100:103], v6 offset:2496
    ds_write_b64 v2, v[108:109] offset:8192
    s_waitcnt lgkmcnt(4)
    v_mfma_f32_16x16x32_bf16 v[52:55], v[88:91], v[72:75], 0
    s_waitcnt lgkmcnt(3)
    v_mov_b32 v113, 0
    v_mov_b32 v115, 0
    v_mfma_f32_16x16x32_bf16 v[52:55], v[92:95], v[76:79], v[52:55]
    s_waitcnt lgkmcnt(2)
    v_mov_b32 v117, 0
    v_mov_b64 v[16:17], 0
    v_mfma_f32_16x16x32_bf16 v[52:55], v[96:99], v[80:83], v[52:55]
    s_waitcnt lgkmcnt(1)
    v_mov_b64 v[18:19], 0
    v_mov_b64 v[20:21], 0
    v_mfma_f32_16x16x32_bf16 v[52:55], v[100:103], v[84:87], v[52:55]
    s_waitcnt lgkmcnt(0)
    s_barrier
    v_smfmac_f32_16x16x64_bf16 v[64:67], v[44:47], v[144:151], v1
    ds_read_b64 v[110:111], v8 offset:8192
    v_mov_b64 v[22:23], 0
    v_smfmac_f32_16x16x64_bf16 v[68:71], v[44:47], v[152:159], v1
    v_mov_b64 v[24:25], 0
    v_mov_b64 v[26:27], 0
    v_mul_f32 v52, s33, v52
    v_mul_f32 v53, s33, v53
    v_exp_f32 v52, v52
    s_waitcnt lgkmcnt(0)
    v_mfma_f32_16x16x32_bf16 v[48:51], v[104:107], v[108:111], 0
    v_exp_f32 v53, v53
    v_add_f32 v64, v64, v66
    v_mfma_f32_16x16x32_bf16 v[56:59], v[120:123], v[108:111], 0
    v_cvt_pk_bf16_f32 v112, v52, v53
    v_add_f32 v65, v65, v67
    v_mfma_f32_16x16x32_bf16 v[60:63], v[124:127], v[108:111], 0
    v_cvt_pk_bf16_f32 v114, v64, v65
    v_add_f32 v68, v68, v70
    v_mfma_f32_16x16x16_bf16 v[48:51], v[104:105], v[112:113], v[48:51]
    v_add_f32 v69, v69, v71
    v_cvt_pk_bf16_f32 v116, v68, v69
    v_mfma_f32_16x16x16_bf16 v[56:59], v[114:115], v[112:113], v[56:59]
    v_mov_b64 v[28:29], 0
    v_mov_b64 v[30:31], 0
    v_mfma_f32_16x16x16_bf16 v[60:63], v[116:117], v[112:113], v[60:63]
    v_bitop3_b32 v32, v13, s96, -9 bitop3:0x28
    v_bitop3_b32 v36, v13, s97, -9 bitop3:0x28
    v_rcp_f32 v118, v48
    v_bitop3_b32 v40, v13, s98, -9 bitop3:0x28
    v_max_f32 v14, v118, v48
    v_cmp_nge_f32 vcc, s40, v14
    v_pk_mul_f32 v[56:57], v[56:57], v[118:119] op_sel_hi:[1,0]
    v_pk_mul_f32 v[58:59], v[58:59], v[118:119] op_sel_hi:[1,0]
    v_pk_mul_f32 v[60:61], v[60:61], v[118:119] op_sel_hi:[1,0]
    v_pk_mul_f32 v[62:63], v[62:63], v[118:119] op_sel_hi:[1,0]
    v_cvt_pk_bf16_f32 v52, v56, v60
    v_cvt_pk_bf16_f32 v54, v58, v62
    v_cvt_pk_bf16_f32 v53, v57, v61
    v_cvt_pk_bf16_f32 v55, v59, v63
L_fast_rejoin:
    v_cndmask_b32 v50, v52, v54, s[92:93]
    v_cndmask_b32 v51, v53, v55, s[92:93]
    ds_write_b64 v13, v[50:51] offset:9216
    v_smfmac_f32_16x16x64_bf16 v[16:19], v[52:55], v[160:167], v1
    v_smfmac_f32_16x16x64_bf16 v[20:23], v[52:55], v[168:175], v1
    s_waitcnt lgkmcnt(0)
    s_barrier
    ds_read_b128 v[32:35], v32 offset:9216
    ds_read_b128 v[36:39], v36 offset:9216
    v_smfmac_f32_16x16x64_bf16 v[24:27], v[52:55], v[176:183], v1
    ds_read_b128 v[40:43], v40 offset:9216
    v_smfmac_f32_16x16x64_bf16 v[28:31], v[52:55], v[184:191], v1
    ds_read_b128 v[88:91], v4 offset:24576
    ds_read_b128 v[92:95], v4 offset:25600
    s_waitcnt lgkmcnt(4)
    v_smfmac_f32_16x16x64_bf16 v[16:19], v[32:35], v[192:199], v1
    ds_read_b128 v[96:99], v4 offset:26624
    s_waitcnt lgkmcnt(4)
    v_smfmac_f32_16x16x64_bf16 v[16:19], v[36:39], v[216:223], v1
    ds_read_b128 v[100:103], v4 offset:27648
    s_waitcnt lgkmcnt(4)
    v_smfmac_f32_16x16x64_bf16 v[16:19], v[40:43], v[240:247], v1
    ds_read_b128 v[72:75], v4 offset:28672
    s_cmp_lg_u64 vcc, 0
    v_smfmac_f32_16x16x64_bf16 v[20:23], v[32:35], v[200:207], v1
    ds_read_b128 v[76:79], v4 offset:29696
    s_cselect_b32 s60, s28, s27
    v_smfmac_f32_16x16x64_bf16 v[20:23], v[36:39], v[224:231], v1
    ds_read_b128 v[80:83], v4 offset:30720
    s_nop 0
    v_cvt_pk_bf16_f32 v56, v16, v18
    v_smfmac_f32_16x16x64_bf16 v[20:23], v[40:43], v[248:255], v1
    ds_read_b128 v[84:87], v4 offset:31744
    v_cvt_pk_bf16_f32 v57, v17, v19
    v_and_or_b32 v56, v56, -2, s60
    v_smfmac_f32_16x16x64_bf16 v[24:27], v[32:35], v[208:215], v1
    buffer_store_dwordx2 v[56:57], v9, s[8:11], 0 offen offset:0
    v_smfmac_f32_16x16x64_bf16 v[24:27], v[36:39], v[232:239], v1
    s_waitcnt lgkmcnt(4)
    s_nop 0
    v_cvt_pk_bf16_f32 v58, v20, v22
    v_smfmac_f32_16x16x64_bf16 v[24:27], v[40:43], v[88:95], v1
    ds_read_b128 v[64:67], v3 offset:23040
    v_cvt_pk_bf16_f32 v59, v21, v23
    v_and_or_b32 v58, v58, -2, s60
    v_smfmac_f32_16x16x64_bf16 v[28:31], v[32:35], v[96:103], v1
    buffer_store_dwordx2 v[58:59], v9, s[8:11], 0 offen offset:2048
    s_waitcnt lgkmcnt(1)
    v_smfmac_f32_16x16x64_bf16 v[28:31], v[36:39], v[72:79], v1
    s_nop 1
    v_cvt_pk_bf16_f32 v60, v24, v26
    v_smfmac_f32_16x16x64_bf16 v[28:31], v[40:43], v[80:87], v1
    s_nop 2
    v_cvt_pk_bf16_f32 v61, v25, v27
    v_and_or_b32 v60, v60, -2, s60
    buffer_store_dwordx2 v[60:61], v9, s[8:11], s26 offen offset:0
    s_nop 1
    v_cvt_pk_bf16_f32 v62, v28, v30
    v_cvt_pk_bf16_f32 v63, v29, v31
    v_and_or_b32 v62, v62, -2, s60
    buffer_store_dwordx2 v[62:63], v9, s[8:11], s26 offen offset:2048
L_fast_stored:
    s_cmp_lg_u32 s60, s27
    s_cbranch_scc1 L_fast_safe
    ds_read_b128 v[104:107], v4 offset:0
    ds_read_b128 v[108:111], v4 offset:1024
    ds_read_b128 v[112:115], v4 offset:2048
    ds_read_b128 v[116:119], v4 offset:3072
    ds_read_b128 v[88:91], v4 offset:4096
    ds_read_b128 v[92:95], v4 offset:5120
    ds_read_b128 v[96:99], v4 offset:6144
    ds_read_b128 v[100:103], v4 offset:7168
    ds_read_b128 v[72:75], v4 offset:8192
    ds_read_b128 v[76:79], v4 offset:9216
    ds_read_b128 v[80:83], v4 offset:10240
    ds_read_b128 v[84:87], v4 offset:11264
    s_cmp_lt_u32 s21, 1
    s_cbranch_scc1 L_fast_pollp
    s_nop 13
    s_cmp_lt_u32 s21, 2
    s_cbranch_scc1 L_fast_pollp
    s_nop 13
    s_cmp_lt_u32 s21, 3
    s_cbranch_scc1 L_fast_pollp
    s_nop 13
L_fast_pollp:
    buffer_load_dwordx4 v[120:123], v2, s[8:11], s6 offen sc1
    buffer_load_dwordx4 v[124:127], v2, s[8:11], s6 offen offset:1024 sc1
    v_mov_b64 v[56:57], 0
    v_mov_b64 v[58:59], 0
    v_mov_b64 v[60:61], 0
    v_mov_b64 v[62:63], 0
    s_nop 15
    s_nop 15
    buffer_load_dwordx4 v[32:35], v2, s[8:11], s6 offen sc1
    buffer_load_dwordx4 v[36:39], v2, s[8:11], s6 offen offset:1024 sc1
L_fast_prep:
    s_add_u32 s7, s24, 0x80000
    s_waitcnt vmcnt(3) lgkmcnt(0)
    v_mfma_f32_16x16x32_bf16 v[68:71], v[64:67], v[120:123], 0
    v_bitop3_b32 v14, v120, v122, s27 bitop3:0x7e
    s_waitcnt vmcnt(2)
    v_mfma_f32_16x16x32_bf16 v[68:71], v[64:67], v[124:127], v[68:71]
    v_bitop3_b32 v11, v124, v126, s27 bitop3:0x7e
    v_bitop3_b32 v14, v14, v11, 1 bitop3:0xa8
    v_cmp_ne_u32 vcc, 0, v14
    s_nop 2
    s_cmp_eq_u64 vcc, 0
    s_cselect_b32 s36, s24, s61
    v_add_f32_dpp v68, v68, v68 row_ror:8 row_mask:0xf bank_mask:0xf
    v_add_f32_dpp v69, v69, v69 row_ror:8 row_mask:0xf bank_mask:0xf
    s_nop 0
    v_add_f32_dpp v68, v68, v68 row_ror:4 row_mask:0xf bank_mask:0xf
    v_add_f32_dpp v69, v69, v69 row_ror:4 row_mask:0xf bank_mask:0xf
    v_cvt_pk_bf16_f32 v12, v68, v69
    buffer_store_dword v12, v10, s[8:11], s36 offen
    s_cbranch_scc1 L_fast_gotp
L_fast_retryp:
    buffer_load_dwordx4 v[120:123], v2, s[8:11], s6 offen sc1
    buffer_load_dwordx4 v[124:127], v2, s[8:11], s6 offen offset:1024 sc1
    s_waitcnt vmcnt(4) lgkmcnt(0)
    v_mfma_f32_16x16x32_bf16 v[68:71], v[64:67], v[32:35], 0
    v_bitop3_b32 v14, v32, v34, s27 bitop3:0x7e
    s_waitcnt vmcnt(3)
    v_mfma_f32_16x16x32_bf16 v[68:71], v[64:67], v[36:39], v[68:71]
    v_bitop3_b32 v11, v36, v38, s27 bitop3:0x7e
    v_bitop3_b32 v14, v14, v11, 1 bitop3:0xa8
    v_cmp_ne_u32 vcc, 0, v14
    s_nop 2
    s_cmp_eq_u64 vcc, 0
    s_cselect_b32 s36, s24, s61
    v_add_f32_dpp v68, v68, v68 row_ror:8 row_mask:0xf bank_mask:0xf
    v_add_f32_dpp v69, v69, v69 row_ror:8 row_mask:0xf bank_mask:0xf
    s_nop 0
    v_add_f32_dpp v68, v68, v68 row_ror:4 row_mask:0xf bank_mask:0xf
    v_add_f32_dpp v69, v69, v69 row_ror:4 row_mask:0xf bank_mask:0xf
    v_cvt_pk_bf16_f32 v12, v68, v69
    buffer_store_dword v12, v10, s[8:11], s36 offen
    s_cbranch_scc1 L_fast_gotp
    buffer_load_dwordx4 v[32:35], v2, s[8:11], s6 offen sc1
    buffer_load_dwordx4 v[36:39], v2, s[8:11], s6 offen offset:1024 sc1
    s_waitcnt vmcnt(4) lgkmcnt(0)
    v_mfma_f32_16x16x32_bf16 v[68:71], v[64:67], v[120:123], 0
    v_bitop3_b32 v14, v120, v122, s27 bitop3:0x7e
    s_waitcnt vmcnt(3)
    v_mfma_f32_16x16x32_bf16 v[68:71], v[64:67], v[124:127], v[68:71]
    v_bitop3_b32 v11, v124, v126, s27 bitop3:0x7e
    v_bitop3_b32 v14, v14, v11, 1 bitop3:0xa8
    v_cmp_ne_u32 vcc, 0, v14
    s_nop 2
    s_cmp_eq_u64 vcc, 0
    s_cselect_b32 s36, s24, s61
    v_add_f32_dpp v68, v68, v68 row_ror:8 row_mask:0xf bank_mask:0xf
    v_add_f32_dpp v69, v69, v69 row_ror:8 row_mask:0xf bank_mask:0xf
    s_nop 0
    v_add_f32_dpp v68, v68, v68 row_ror:4 row_mask:0xf bank_mask:0xf
    v_add_f32_dpp v69, v69, v69 row_ror:4 row_mask:0xf bank_mask:0xf
    v_cvt_pk_bf16_f32 v12, v68, v69
    buffer_store_dword v12, v10, s[8:11], s36 offen
    s_cbranch_scc1 L_fast_gotp
    s_add_u32 s32, s32, 1
    s_cmp_le_u32 s32, 200000
    s_cbranch_scc1 L_fast_retryp
    s_mov_b32 s36, s24
    buffer_store_dword v12, v10, s[8:11], s36 offen
L_fast_gotp:
    s_add_u32 s31, s31, 0x2000
    s_cmp_ge_u32 s90, 63
    s_cbranch_scc1 L_fast_last
    s_mov_b32 s23, s24
    s_mov_b32 s22, s90
    s_mov_b32 s27, s28
    v_mov_b64 v[64:65], 0
    v_mov_b64 v[66:67], 0
    v_mov_b64 v[68:69], 0
    v_mov_b64 v[70:71], 0
    s_nop 15
    s_nop 11
    buffer_load_dwordx4 v[16:19], v2, s[8:11], s7 offen sc1
    buffer_load_dwordx4 v[20:23], v2, s[8:11], s7 offen offset:1024 sc1
    s_branch L_fast_step
L_fast_last:
    buffer_store_dword v12, v10, s[8:11], s31 offen sc1
    s_branch L_fast_done
L_fast_refresh:
    buffer_load_dword v15, v0, s[8:11], s23 offen sc1
    s_add_u32 s32, s32, 1
    s_cmp_le_u32 s32, 200000
    s_waitcnt vmcnt(0)
    s_cbranch_scc1 L_fast_step
    s_branch L_fast_fresh
L_fast_safe:
    s_nop 11
    s_waitcnt vmcnt(0) lgkmcnt(0)
    s_barrier
    ds_read_b128 v[72:75], v6 offset:0
    ds_read_b128 v[88:91], v6 offset:2304
    ds_read_b128 v[76:79], v6 offset:64
    ds_read_b128 v[92:95], v6 offset:2368
    ds_read_b128 v[80:83], v6 offset:128
    ds_read_b128 v[96:99], v6 offset:2432
    ds_read_b128 v[84:87], v6 offset:192
    ds_read_b128 v[100:103], v6 offset:2496
    s_xor_b32 s36, s25, 0x1000
    s_add_u32 s36, s36, s23
    buffer_load_dwordx4 v[16:19], v3, s[8:11], s29 offen offset:0 sc1
    buffer_load_dwordx4 v[32:35], v3, s[8:11], s36 offen offset:0 sc1
    buffer_load_dwordx4 v[20:23], v3, s[8:11], s29 offen offset:1024 sc1
    buffer_load_dwordx4 v[36:39], v3, s[8:11], s36 offen offset:1024 sc1
    buffer_load_dwordx4 v[24:27], v3, s[8:11], s29 offen offset:2048 sc1
    buffer_load_dwordx4 v[40:43], v3, s[8:11], s36 offen offset:2048 sc1
    buffer_load_dwordx4 v[28:31], v3, s[8:11], s29 offen offset:3072 sc1
    buffer_load_dwordx4 v[44:47], v3, s[8:11], s36 offen offset:3072 sc1
    s_waitcnt vmcnt(0) lgkmcnt(0)
    v_mfma_f32_16x16x32_bf16 v[48:51], v[16:19], v[72:75], 0
    v_mfma_f32_16x16x32_bf16 v[48:51], v[20:23], v[76:79], v[48:51]
    v_mfma_f32_16x16x32_bf16 v[48:51], v[24:27], v[80:83], v[48:51]
    v_mfma_f32_16x16x32_bf16 v[48:51], v[28:31], v[84:87], v[48:51]
    v_mfma_f32_16x16x32_bf16 v[52:55], v[32:35], v[72:75], 0
    v_mfma_f32_16x16x32_bf16 v[52:55], v[36:39], v[76:79], v[52:55]
    v_mfma_f32_16x16x32_bf16 v[52:55], v[40:43], v[80:83], v[52:55]
    v_mfma_f32_16x16x32_bf16 v[52:55], v[44:47], v[84:87], v[52:55]
    v_mfma_f32_16x16x32_bf16 v[56:59], v[88:91], v[72:75], 0
    v_mfma_f32_16x16x32_bf16 v[56:59], v[92:95], v[76:79], v[56:59]
    v_mfma_f32_16x16x32_bf16 v[56:59], v[96:99], v[80:83], v[56:59]
    v_mfma_f32_16x16x32_bf16 v[56:59], v[100:103], v[84:87], v[56:59]
    s_nop 7
    v_mul_f32 v56, s33, v56
    v_mul_f32 v57, s33, v57
    v_max3_f32 v16, v48, v49, v50
    v_max3_f32 v16, v16, v51, v52
    v_max3_f32 v16, v16, v53, v54
    v_max3_f32 v16, v16, v55, v56
    v_max_f32 v16, v16, v57
    v_mov_b32 v17, v16
    s_nop 1
    v_permlane16_swap_b32 v16, v17
    v_max_f32 v16, v16, v17
    v_mov_b32 v17, v16
    s_nop 1
    v_permlane32_swap_b32 v16, v17
    v_max_f32 v16, v16, v17
    v_sub_f32 v48, v48, v16
    v_exp_f32 v48, v48
    v_sub_f32 v49, v49, v16
    v_exp_f32 v49, v49
    v_sub_f32 v50, v50, v16
    v_exp_f32 v50, v50
    v_sub_f32 v51, v51, v16
    v_exp_f32 v51, v51
    v_sub_f32 v52, v52, v16
    v_exp_f32 v52, v52
    v_sub_f32 v53, v53, v16
    v_exp_f32 v53, v53
    v_sub_f32 v54, v54, v16
    v_exp_f32 v54, v54
    v_sub_f32 v55, v55, v16
    v_exp_f32 v55, v55
    v_sub_f32 v56, v56, v16
    v_exp_f32 v56, v56
    v_sub_f32 v57, v57, v16
    v_exp_f32 v57, v57
    v_cvt_pk_bf16_f32 v108, v48, v49
    v_cvt_pk_bf16_f32 v109, v50, v51
    v_cvt_pk_bf16_f32 v110, v52, v53
    v_cvt_pk_bf16_f32 v111, v54, v55
    v_cvt_pk_bf16_f32 v112, v56, v57
    s_nop 0
    v_mfma_f32_16x16x32_bf16 v[48:51], v[104:107], v[108:111], 0
    v_mfma_f32_16x16x32_bf16 v[56:59], v[120:123], v[108:111], 0
    v_mfma_f32_16x16x32_bf16 v[60:63], v[124:127], v[108:111], 0
    s_nop 3
    v_mfma_f32_16x16x16_bf16 v[48:51], v[104:105], v[112:113], v[48:51]
    v_mfma_f32_16x16x16_bf16 v[56:59], v[114:115], v[112:113], v[56:59]
    v_mfma_f32_16x16x16_bf16 v[60:63], v[116:117], v[112:113], v[60:63]
    s_nop 5
    v_rcp_f32 v118, v48
    s_nop 0
    v_mul_f32 v56, v56, v118
    v_mul_f32 v57, v57, v118
    v_mul_f32 v58, v58, v118
    v_mul_f32 v59, v59, v118
    v_mul_f32 v60, v60, v118
    v_mul_f32 v61, v61, v118
    v_mul_f32 v62, v62, v118
    v_mul_f32 v63, v63, v118
    v_cvt_pk_bf16_f32 v52, v56, v60
    v_cvt_pk_bf16_f32 v53, v57, v61
    v_cvt_pk_bf16_f32 v54, v58, v62
    v_cvt_pk_bf16_f32 v55, v59, v63
    v_mov_b32 v16, 0
    v_mov_b32 v17, 0
    v_mov_b32 v18, 0
    v_mov_b32 v19, 0
    v_mov_b32 v20, 0
    v_mov_b32 v21, 0
    v_mov_b32 v22, 0
    v_mov_b32 v23, 0
    v_mov_b32 v24, 0
    v_mov_b32 v25, 0
    v_mov_b32 v26, 0
    v_mov_b32 v27, 0
    v_mov_b32 v28, 0
    v_mov_b32 v29, 0
    v_mov_b32 v30, 0
    v_mov_b32 v31, 0
    v_bitop3_b32 v32, v13, s96, -9 bitop3:0x28
    v_bitop3_b32 v36, v13, s97, -9 bitop3:0x28
    v_bitop3_b32 v40, v13, s98, -9 bitop3:0x28
    s_mov_b64 vcc, 0
    s_branch L_fast_rejoin
L_fast_done:
    s_branch L_end
L_slow_start:
    s_mov_b32 s22, 0
    s_mov_b32 s23, 0x1000000
    s_mov_b32 s27, 0
    s_mov_b32 s31, 0x80000
    s_mov_b32 s61, 0x40000000
    s_mov_b32 s96, 0x800
    s_mov_b32 s97, 0x1000
    s_mov_b32 s98, 0x1800
    s_mov_b32 s92, 0xcccccccc
    s_mov_b32 s93, 0xcccccccc
    s_mov_b32 s91, 0
    ds_read_b128 v[104:107], v4 offset:0
    ds_read_b128 v[108:111], v4 offset:1024
    ds_read_b128 v[112:115], v4 offset:2048
    ds_read_b128 v[116:119], v4 offset:3072
    ds_read_b128 v[88:91], v4 offset:4096
    ds_read_b128 v[92:95], v4 offset:5120
    ds_read_b128 v[96:99], v4 offset:6144
    ds_read_b128 v[100:103], v4 offset:7168
    ds_read_b128 v[72:75], v4 offset:8192
    ds_read_b128 v[76:79], v4 offset:9216
    ds_read_b128 v[80:83], v4 offset:10240
    ds_read_b128 v[84:87], v4 offset:11264
    v_mov_b64 v[48:49], 0
    v_mov_b64 v[50:51], 0
    v_mov_b64 v[52:53], 0
    v_mov_b64 v[54:55], 0
    v_mov_b64 v[56:57], 0
    v_mov_b64 v[58:59], 0
    v_mov_b64 v[60:61], 0
    v_mov_b64 v[62:63], 0
    v_mov_b64 v[64:65], 0
    v_mov_b64 v[66:67], 0
    v_mov_b64 v[68:69], 0
    v_mov_b64 v[70:71], 0
    s_add_u32 s7, s23, 0x80000
    buffer_load_dwordx4 v[16:19], v2, s[8:11], s7 offen sc1
    buffer_load_dwordx4 v[20:23], v2, s[8:11], s7 offen offset:1024 sc1
    s_waitcnt vmcnt(2)
L_slow_step:
    v_readlane_b32 s36, v15, 33
    s_add_u32 s24, s23, 0x82100
    s_cmp_eq_u32 s36, 0
    s_cbranch_scc1 L_slow_refresh
L_slow_fresh:
    s_add_u32 s29, s23, s25
    s_add_u32 s30, s23, s39
    s_xor_b32 s28, s27, 1
    s_add_u32 s90, s22, 1
    s_nop 15
L_slow_retrym:
    buffer_load_dwordx4 v[16:19], v2, s[8:11], s7 offen sc1
    buffer_load_dwordx4 v[20:23], v2, s[8:11], s7 offen offset:1024 sc1
L_slow_prem:
    s_add_u32 s32, s32, 1
    s_cmp_gt_u32 s32, 200000
    s_cselect_b32 s94, -1, -2
    v_xor_b32 v28, 0x800, v2
    v_xor_b32 v44, 0x1800, v2
    v_mov_b64 v[48:49], 0
    v_mov_b64 v[50:51], 0
    v_mov_b64 v[52:53], 0
    v_mov_b64 v[54:55], 0
L_slow_waitm:
    s_waitcnt vmcnt(3) lgkmcnt(0)
L_slow_gotm:
    v_max3_u32 v14, v16, v17, v18
    v_max_u32 v14, v14, v19
    v_smfmac_f32_16x16x64_bf16 v[48:51], v[16:19], v[104:111], v1
    s_waitcnt vmcnt(2)
    v_max3_u32 v14, v14, v20, v21
    v_smfmac_f32_16x16x64_bf16 v[52:55], v[16:19], v[112:119], v1
    v_max3_u32 v14, v14, v22, v23
    v_cmp_lt_u32 vcc, s94, v14
    v_smfmac_f32_16x16x64_bf16 v[48:51], v[20:23], v[88:95], v1
    ds_write_b128 v2, v[16:19] offset:0
    s_cbranch_vccnz L_slow_retrym
    v_smfmac_f32_16x16x64_bf16 v[52:55], v[20:23], v[96:103], v1
    ds_write_b128 v2, v[20:23] offset:1024
    v_smfmac_f32_16x16x64_bf16 v[56:59], v[16:19], v[72:79], v1
    buffer_load_dwordx4 v[104:107], v3, s[8:11], s29 offen offset:0 sc1
    buffer_load_dwordx4 v[120:123], v3, s[8:11], s30 offen offset:0 sc1
    v_smfmac_f32_16x16x64_bf16 v[60:63], v[16:19], v[80:87], v1
    buffer_load_dwordx4 v[108:111], v3, s[8:11], s29 offen offset:1024 sc1
    buffer_load_dwordx4 v[124:127], v3, s[8:11], s30 offen offset:1024 sc1
    v_smfmac_f32_16x16x64_bf16 v[56:59], v[20:23], a[80:87], v1
    buffer_load_dwordx4 v[112:115], v3, s[8:11], s29 offen offset:2048 sc1
    buffer_load_dwordx4 v[116:119], v3, s[8:11], s29 offen offset:3072 sc1
    v_smfmac_f32_16x16x64_bf16 v[60:63], v[20:23], a[88:95], v1
    s_waitcnt lgkmcnt(0)
    s_barrier
    ds_read_b128 v[24:27], v28 offset:0
    v_smfmac_f32_16x16x64_bf16 v[64:67], v[16:19], a[160:167], v1
    ds_read_b128 v[28:31], v28 offset:1024
    v_smfmac_f32_16x16x64_bf16 v[68:71], v[16:19], a[168:175], v1
    buffer_load_dword v15, v0, s[8:11], s24 offen sc1
    v_smfmac_f32_16x16x64_bf16 v[64:67], v[20:23], a[176:183], v1
    ds_read_b128 v[32:35], v8 offset:0
    v_smfmac_f32_16x16x64_bf16 v[68:71], v[20:23], a[184:191], v1
    ds_read_b128 v[36:39], v8 offset:1024
    s_waitcnt lgkmcnt(3)
    v_smfmac_f32_16x16x64_bf16 v[48:51], v[24:27], a[0:7], v1
    ds_read_b128 v[40:43], v44 offset:0
    v_smfmac_f32_16x16x64_bf16 v[52:55], v[24:27], a[8:15], v1
    ds_read_b128 v[44:47], v44 offset:1024
    s_waitcnt lgkmcnt(4)
    v_smfmac_f32_16x16x64_bf16 v[48:51], v[28:31], a[16:23], v1
    ds_read_b128 v[88:91], v4 offset:12288
    v_smfmac_f32_16x16x64_bf16 v[52:55], v[28:31], a[24:31], v1
    ds_read_b128 v[92:95], v4 offset:13312
    s_waitcnt lgkmcnt(4)
    v_smfmac_f32_16x16x64_bf16 v[48:51], v[32:35], a[32:39], v1
    ds_read_b128 v[96:99], v4 offset:14336
    v_smfmac_f32_16x16x64_bf16 v[52:55], v[32:35], a[40:47], v1
    ds_read_b128 v[100:103], v4 offset:15360
    s_waitcnt lgkmcnt(4)
    v_smfmac_f32_16x16x64_bf16 v[48:51], v[36:39], a[48:55], v1
    v_smfmac_f32_16x16x64_bf16 v[52:55], v[36:39], a[56:63], v1
    ds_read_b128 v[72:75], v4 offset:16384
    v_smfmac_f32_16x16x64_bf16 v[48:51], v[40:43], a[64:71], v1
    v_smfmac_f32_16x16x64_bf16 v[52:55], v[40:43], a[72:79], v1
    ds_read_b128 v[76:79], v4 offset:17408
    s_waitcnt lgkmcnt(2)
    v_smfmac_f32_16x16x64_bf16 v[48:51], v[44:47], v[88:95], v1
    ds_read_b128 v[80:83], v4 offset:18432
    v_smfmac_f32_16x16x64_bf16 v[52:55], v[44:47], v[96:103], v1
    ds_read_b128 v[84:87], v4 offset:19456
    v_smfmac_f32_16x16x64_bf16 v[56:59], v[28:31], a[96:103], v1
    ds_read_b128 v[88:91], v4 offset:20480
    v_smfmac_f32_16x16x64_bf16 v[60:63], v[28:31], a[104:111], v1
    ds_read_b128 v[92:95], v4 offset:21504
    v_smfmac_f32_16x16x64_bf16 v[56:59], v[32:35], a[112:119], v1
    ds_read_b128 v[96:99], v4 offset:22528
    v_add_f32 v48, v48, v50
    v_add_f32 v49, v49, v51
    v_smfmac_f32_16x16x64_bf16 v[60:63], v[32:35], a[120:127], v1
    ds_read_b128 v[100:103], v4 offset:23552
    v_add_f32 v52, v52, v54
    v_add_f32 v53, v53, v55
    v_smfmac_f32_16x16x64_bf16 v[56:59], v[36:39], a[128:135], v1
    s_waitcnt lgkmcnt(4)
    v_cvt_pk_bf16_f32 v50, v48, v52
    v_cvt_pk_bf16_f32 v51, v49, v53
    v_smfmac_f32_16x16x64_bf16 v[56:59], v[24:27], v[72:79], v1
    ds_write2_b32 v5, v50, v51 offset0:0 offset1:72
    v_smfmac_f32_16x16x64_bf16 v[60:63], v[24:27], v[80:87], v1
    v_smfmac_f32_16x16x64_bf16 v[60:63], v[36:39], a[136:143], v1
    v_smfmac_f32_16x16x64_bf16 v[56:59], v[40:43], a[144:151], v1
    buffer_store_dword v12, v10, s[8:11], s31 offen sc1
    v_smfmac_f32_16x16x64_bf16 v[60:63], v[40:43], a[152:159], v1
    s_waitcnt lgkmcnt(0)
    s_barrier
    v_smfmac_f32_16x16x64_bf16 v[56:59], v[44:47], v[88:95], v1
    ds_read_b128 v[72:75], v6 offset:0
    v_smfmac_f32_16x16x64_bf16 v[60:63], v[44:47], v[96:103], v1
    ds_read_b128 v[76:79], v6 offset:64
    v_smfmac_f32_16x16x64_bf16 v[64:67], v[24:27], a[192:199], v1
    ds_read_b128 v[80:83], v6 offset:128
    v_smfmac_f32_16x16x64_bf16 v[68:71], v[24:27], a[200:207], v1
    ds_read_b128 v[84:87], v6 offset:192
    s_waitcnt vmcnt(2) lgkmcnt(3)
    v_mfma_f32_16x16x32_bf16 v[48:51], v[104:107], v[72:75], 0
    s_waitcnt lgkmcnt(2)
    v_add_f32 v56, v56, v58
    v_add_f32 v57, v57, v59
    v_mfma_f32_16x16x32_bf16 v[48:51], v[108:111], v[76:79], v[48:51]
    s_waitcnt lgkmcnt(1)
    v_add_f32 v60, v60, v62
    v_add_f32 v61, v61, v63
    v_mfma_f32_16x16x32_bf16 v[48:51], v[112:115], v[80:83], v[48:51]
    s_waitcnt lgkmcnt(0)
    v_cvt_pk_bf16_f32 v58, v56, v60
    v_cvt_pk_bf16_f32 v59, v57, v61
    v_mfma_f32_16x16x32_bf16 v[48:51], v[116:119], v[84:87], v[48:51]
    ds_write2_b32 v7, v58, v59 offset0:0 offset1:72
    v_smfmac_f32_16x16x64_bf16 v[64:67], v[28:31], a[208:215], v1
    v_mov_b64 v[104:105], s[4:5]
    v_smfmac_f32_16x16x64_bf16 v[68:71], v[28:31], a[216:223], v1
    s_nop 1
    v_mov_b64 v[106:107], s[4:5]
    v_smfmac_f32_16x16x64_bf16 v[64:67], v[32:35], a[224:231], v1
    v_exp_f32 v48, v48
    v_smfmac_f32_16x16x64_bf16 v[68:71], v[32:35], a[232:239], v1
    s_waitcnt lgkmcnt(0)
    s_barrier
    v_exp_f32 v49, v49
    v_smfmac_f32_16x16x64_bf16 v[64:67], v[36:39], a[240:247], v1
    ds_read_b128 v[88:91], v6 offset:2304
    v_exp_f32 v50, v50
    v_smfmac_f32_16x16x64_bf16 v[68:71], v[36:39], a[248:255], v1
    ds_read_b128 v[92:95], v6 offset:2368
    v_exp_f32 v51, v51
    v_smfmac_f32_16x16x64_bf16 v[64:67], v[40:43], v[128:135], v1
    ds_read_b128 v[96:99], v6 offset:2432
    v_cvt_pk_bf16_f32 v108, v48, v49
    v_cvt_pk_bf16_f32 v109, v50, v51
    v_smfmac_f32_16x16x64_bf16 v[68:71], v[40:43], v[136:143], v1
    ds_read_b128 v[100:103], v6 offset:2496
    ds_write_b64 v2, v[108:109] offset:8192
    s_waitcnt lgkmcnt(4)
    v_mfma_f32_16x16x32_bf16 v[52:55], v[88:91], v[72:75], 0
    s_waitcnt lgkmcnt(3)
    v_mov_b32 v113, 0
    v_mov_b32 v115, 0
    v_mfma_f32_16x16x32_bf16 v[52:55], v[92:95], v[76:79], v[52:55]
    s_waitcnt lgkmcnt(2)
    v_mov_b32 v117, 0
    v_mov_b64 v[16:17], 0
    v_mfma_f32_16x16x32_bf16 v[52:55], v[96:99], v[80:83], v[52:55]
    s_waitcnt lgkmcnt(1)
    v_mov_b64 v[18:19], 0
    v_mov_b64 v[20:21], 0
    v_mfma_f32_16x16x32_bf16 v[52:55], v[100:103], v[84:87], v[52:55]
    s_waitcnt lgkmcnt(0)
    s_barrier
    v_smfmac_f32_16x16x64_bf16 v[64:67], v[44:47], v[144:151], v1
    ds_read_b64 v[110:111], v8 offset:8192
    v_mov_b64 v[22:23], 0
    v_smfmac_f32_16x16x64_bf16 v[68:71], v[44:47], v[152:159], v1
    v_mov_b64 v[24:25], 0
    v_mov_b64 v[26:27], 0
    v_mul_f32 v52, s33, v52
    v_mul_f32 v53, s33, v53
    v_exp_f32 v52, v52
    s_waitcnt lgkmcnt(0)
    v_mfma_f32_16x16x32_bf16 v[48:51], v[104:107], v[108:111], 0
    v_exp_f32 v53, v53
    v_add_f32 v64, v64, v66
    v_mfma_f32_16x16x32_bf16 v[56:59], v[120:123], v[108:111], 0
    v_cvt_pk_bf16_f32 v112, v52, v53
    v_add_f32 v65, v65, v67
    v_mfma_f32_16x16x32_bf16 v[60:63], v[124:127], v[108:111], 0
    v_cvt_pk_bf16_f32 v114, v64, v65
    v_add_f32 v68, v68, v70
    v_mfma_f32_16x16x16_bf16 v[48:51], v[104:105], v[112:113], v[48:51]
    v_add_f32 v69, v69, v71
    v_cvt_pk_bf16_f32 v116, v68, v69
    v_mfma_f32_16x16x16_bf16 v[56:59], v[114:115], v[112:113], v[56:59]
    v_mov_b64 v[28:29], 0
    v_mov_b64 v[30:31], 0
    v_mfma_f32_16x16x16_bf16 v[60:63], v[116:117], v[112:113], v[60:63]
    v_bitop3_b32 v32, v13, s96, -9 bitop3:0x28
    v_bitop3_b32 v36, v13, s97, -9 bitop3:0x28
    v_rcp_f32 v118, v48
    v_bitop3_b32 v40, v13, s98, -9 bitop3:0x28
    v_max_f32 v14, v118, v48
    v_cmp_nge_f32 vcc, s40, v14
    v_pk_mul_f32 v[56:57], v[56:57], v[118:119] op_sel_hi:[1,0]
    v_pk_mul_f32 v[58:59], v[58:59], v[118:119] op_sel_hi:[1,0]
    v_pk_mul_f32 v[60:61], v[60:61], v[118:119] op_sel_hi:[1,0]
    v_pk_mul_f32 v[62:63], v[62:63], v[118:119] op_sel_hi:[1,0]
    v_cvt_pk_bf16_f32 v52, v56, v60
    v_cvt_pk_bf16_f32 v54, v58, v62
    v_cvt_pk_bf16_f32 v53, v57, v61
    v_cvt_pk_bf16_f32 v55, v59, v63
L_slow_rejoin:
    v_cndmask_b32 v50, v52, v54, s[92:93]
    v_cndmask_b32 v51, v53, v55, s[92:93]
    ds_write_b64 v13, v[50:51] offset:9216
    v_smfmac_f32_16x16x64_bf16 v[16:19], v[52:55], v[160:167], v1
    v_smfmac_f32_16x16x64_bf16 v[20:23], v[52:55], v[168:175], v1
    s_waitcnt lgkmcnt(0)
    s_barrier
    ds_read_b128 v[32:35], v32 offset:9216
    ds_read_b128 v[36:39], v36 offset:9216
    v_smfmac_f32_16x16x64_bf16 v[24:27], v[52:55], v[176:183], v1
    ds_read_b128 v[40:43], v40 offset:9216
    v_smfmac_f32_16x16x64_bf16 v[28:31], v[52:55], v[184:191], v1
    ds_read_b128 v[88:91], v4 offset:24576
    ds_read_b128 v[92:95], v4 offset:25600
    s_waitcnt lgkmcnt(4)
    v_smfmac_f32_16x16x64_bf16 v[16:19], v[32:35], v[192:199], v1
    ds_read_b128 v[96:99], v4 offset:26624
    s_waitcnt lgkmcnt(4)
    v_smfmac_f32_16x16x64_bf16 v[16:19], v[36:39], v[216:223], v1
    ds_read_b128 v[100:103], v4 offset:27648
    s_waitcnt lgkmcnt(4)
    v_smfmac_f32_16x16x64_bf16 v[16:19], v[40:43], v[240:247], v1
    ds_read_b128 v[72:75], v4 offset:28672
    s_cmp_lg_u64 vcc, 0
    v_smfmac_f32_16x16x64_bf16 v[20:23], v[32:35], v[200:207], v1
    ds_read_b128 v[76:79], v4 offset:29696
    s_cselect_b32 s60, s28, s27
    v_smfmac_f32_16x16x64_bf16 v[20:23], v[36:39], v[224:231], v1
    ds_read_b128 v[80:83], v4 offset:30720
    s_nop 0
    v_cvt_pk_bf16_f32 v56, v16, v18
    v_smfmac_f32_16x16x64_bf16 v[20:23], v[40:43], v[248:255], v1
    ds_read_b128 v[84:87], v4 offset:31744
    v_cvt_pk_bf16_f32 v57, v17, v19
    v_and_or_b32 v56, v56, -2, s60
    v_smfmac_f32_16x16x64_bf16 v[24:27], v[32:35], v[208:215], v1
    buffer_store_dwordx2 v[56:57], v9, s[8:11], 0 offen offset:0 sc1
    v_smfmac_f32_16x16x64_bf16 v[24:27], v[36:39], v[232:239], v1
    s_waitcnt lgkmcnt(4)
    s_nop 0
    v_cvt_pk_bf16_f32 v58, v20, v22
    v_smfmac_f32_16x16x64_bf16 v[24:27], v[40:43], v[88:95], v1
    ds_read_b128 v[64:67], v3 offset:23040
    v_cvt_pk_bf16_f32 v59, v21, v23
    v_and_or_b32 v58, v58, -2, s60
    v_smfmac_f32_16x16x64_bf16 v[28:31], v[32:35], v[96:103], v1
    buffer_store_dwordx2 v[58:59], v9, s[8:11], 0 offen offset:2048 sc1
    s_waitcnt lgkmcnt(1)
    v_smfmac_f32_16x16x64_bf16 v[28:31], v[36:39], v[72:79], v1
    s_nop 1
    v_cvt_pk_bf16_f32 v60, v24, v26
    v_smfmac_f32_16x16x64_bf16 v[28:31], v[40:43], v[80:87], v1
    s_nop 2
    v_cvt_pk_bf16_f32 v61, v25, v27
    v_and_or_b32 v60, v60, -2, s60
    buffer_store_dwordx2 v[60:61], v9, s[8:11], s26 offen offset:0 sc1
    s_nop 1
    v_cvt_pk_bf16_f32 v62, v28, v30
    v_cvt_pk_bf16_f32 v63, v29, v31
    v_and_or_b32 v62, v62, -2, s60
    buffer_store_dwordx2 v[62:63], v9, s[8:11], s26 offen offset:2048 sc1
L_slow_stored:
    s_cmp_lg_u32 s60, s27
    s_cbranch_scc1 L_slow_safe
    ds_read_b128 v[104:107], v4 offset:0
    ds_read_b128 v[108:111], v4 offset:1024
    ds_read_b128 v[112:115], v4 offset:2048
    ds_read_b128 v[116:119], v4 offset:3072
    ds_read_b128 v[88:91], v4 offset:4096
    ds_read_b128 v[92:95], v4 offset:5120
    ds_read_b128 v[96:99], v4 offset:6144
    ds_read_b128 v[100:103], v4 offset:7168
    ds_read_b128 v[72:75], v4 offset:8192
    ds_read_b128 v[76:79], v4 offset:9216
    ds_read_b128 v[80:83], v4 offset:10240
    ds_read_b128 v[84:87], v4 offset:11264
    s_cmp_lt_u32 s21, 1
    s_cbranch_scc1 L_slow_pollp
    s_nop 13
    s_cmp_lt_u32 s21, 2
    s_cbranch_scc1 L_slow_pollp
    s_nop 13
    s_cmp_lt_u32 s21, 3
    s_cbranch_scc1 L_slow_pollp
    s_nop 13
L_slow_pollp:
    buffer_load_dwordx4 v[120:123], v2, s[8:11], s6 offen sc1
    buffer_load_dwordx4 v[124:127], v2, s[8:11], s6 offen offset:1024 sc1
    v_mov_b64 v[56:57], 0
    v_mov_b64 v[58:59], 0
    v_mov_b64 v[60:61], 0
    v_mov_b64 v[62:63], 0
    s_nop 15
    s_nop 15
    buffer_load_dwordx4 v[32:35], v2, s[8:11], s6 offen sc1
    buffer_load_dwordx4 v[36:39], v2, s[8:11], s6 offen offset:1024 sc1
L_slow_prep:
    s_add_u32 s7, s24, 0x80000
    s_waitcnt vmcnt(3) lgkmcnt(0)
    v_mfma_f32_16x16x32_bf16 v[68:71], v[64:67], v[120:123], 0
    v_bitop3_b32 v14, v120, v122, s27 bitop3:0x7e
    s_waitcnt vmcnt(2)
    v_mfma_f32_16x16x32_bf16 v[68:71], v[64:67], v[124:127], v[68:71]
    v_bitop3_b32 v11, v124, v126, s27 bitop3:0x7e
    v_bitop3_b32 v14, v14, v11, 1 bitop3:0xa8
    v_cmp_ne_u32 vcc, 0, v14
    s_nop 2
    s_cmp_eq_u64 vcc, 0
    s_cselect_b32 s36, s24, s61
    v_add_f32_dpp v68, v68, v68 row_ror:8 row_mask:0xf bank_mask:0xf
    v_add_f32_dpp v69, v69, v69 row_ror:8 row_mask:0xf bank_mask:0xf
    s_nop 0
    v_add_f32_dpp v68, v68, v68 row_ror:4 row_mask:0xf bank_mask:0xf
    v_add_f32_dpp v69, v69, v69 row_ror:4 row_mask:0xf bank_mask:0xf
    v_cvt_pk_bf16_f32 v12, v68, v69
    buffer_store_dword v12, v10, s[8:11], s36 offen sc1
    s_cbranch_scc1 L_slow_gotp
L_slow_retryp:
    buffer_load_dwordx4 v[120:123], v2, s[8:11], s6 offen sc1
    buffer_load_dwordx4 v[124:127], v2, s[8:11], s6 offen offset:1024 sc1
    s_waitcnt vmcnt(4) lgkmcnt(0)
    v_mfma_f32_16x16x32_bf16 v[68:71], v[64:67], v[32:35], 0
    v_bitop3_b32 v14, v32, v34, s27 bitop3:0x7e
    s_waitcnt vmcnt(3)
    v_mfma_f32_16x16x32_bf16 v[68:71], v[64:67], v[36:39], v[68:71]
    v_bitop3_b32 v11, v36, v38, s27 bitop3:0x7e
    v_bitop3_b32 v14, v14, v11, 1 bitop3:0xa8
    v_cmp_ne_u32 vcc, 0, v14
    s_nop 2
    s_cmp_eq_u64 vcc, 0
    s_cselect_b32 s36, s24, s61
    v_add_f32_dpp v68, v68, v68 row_ror:8 row_mask:0xf bank_mask:0xf
    v_add_f32_dpp v69, v69, v69 row_ror:8 row_mask:0xf bank_mask:0xf
    s_nop 0
    v_add_f32_dpp v68, v68, v68 row_ror:4 row_mask:0xf bank_mask:0xf
    v_add_f32_dpp v69, v69, v69 row_ror:4 row_mask:0xf bank_mask:0xf
    v_cvt_pk_bf16_f32 v12, v68, v69
    buffer_store_dword v12, v10, s[8:11], s36 offen sc1
    s_cbranch_scc1 L_slow_gotp
    buffer_load_dwordx4 v[32:35], v2, s[8:11], s6 offen sc1
    buffer_load_dwordx4 v[36:39], v2, s[8:11], s6 offen offset:1024 sc1
    s_waitcnt vmcnt(4) lgkmcnt(0)
    v_mfma_f32_16x16x32_bf16 v[68:71], v[64:67], v[120:123], 0
    v_bitop3_b32 v14, v120, v122, s27 bitop3:0x7e
    s_waitcnt vmcnt(3)
    v_mfma_f32_16x16x32_bf16 v[68:71], v[64:67], v[124:127], v[68:71]
    v_bitop3_b32 v11, v124, v126, s27 bitop3:0x7e
    v_bitop3_b32 v14, v14, v11, 1 bitop3:0xa8
    v_cmp_ne_u32 vcc, 0, v14
    s_nop 2
    s_cmp_eq_u64 vcc, 0
    s_cselect_b32 s36, s24, s61
    v_add_f32_dpp v68, v68, v68 row_ror:8 row_mask:0xf bank_mask:0xf
    v_add_f32_dpp v69, v69, v69 row_ror:8 row_mask:0xf bank_mask:0xf
    s_nop 0
    v_add_f32_dpp v68, v68, v68 row_ror:4 row_mask:0xf bank_mask:0xf
    v_add_f32_dpp v69, v69, v69 row_ror:4 row_mask:0xf bank_mask:0xf
    v_cvt_pk_bf16_f32 v12, v68, v69
    buffer_store_dword v12, v10, s[8:11], s36 offen sc1
    s_cbranch_scc1 L_slow_gotp
    s_add_u32 s32, s32, 1
    s_cmp_le_u32 s32, 200000
    s_cbranch_scc1 L_slow_retryp
    s_mov_b32 s36, s24
    buffer_store_dword v12, v10, s[8:11], s36 offen sc1
L_slow_gotp:
    s_add_u32 s31, s31, 0x2000
    s_cmp_ge_u32 s90, 63
    s_cbranch_scc1 L_slow_last
    s_mov_b32 s23, s24
    s_mov_b32 s22, s90
    s_mov_b32 s27, s28
    v_mov_b64 v[64:65], 0
    v_mov_b64 v[66:67], 0
    v_mov_b64 v[68:69], 0
    v_mov_b64 v[70:71], 0
    s_nop 15
    s_nop 11
    buffer_load_dwordx4 v[16:19], v2, s[8:11], s7 offen sc1
    buffer_load_dwordx4 v[20:23], v2, s[8:11], s7 offen offset:1024 sc1
    s_branch L_slow_step
L_slow_last:
    buffer_store_dword v12, v10, s[8:11], s31 offen sc1
    s_branch L_slow_done
L_slow_refresh:
    buffer_load_dword v15, v0, s[8:11], s23 offen sc1
    s_add_u32 s32, s32, 1
    s_cmp_le_u32 s32, 200000
    s_waitcnt vmcnt(0)
    s_cbranch_scc1 L_slow_step
    s_branch L_slow_fresh
L_slow_safe:
    s_nop 11
    s_waitcnt vmcnt(0) lgkmcnt(0)
    s_barrier
    ds_read_b128 v[72:75], v6 offset:0
    ds_read_b128 v[88:91], v6 offset:2304
    ds_read_b128 v[76:79], v6 offset:64
    ds_read_b128 v[92:95], v6 offset:2368
    ds_read_b128 v[80:83], v6 offset:128
    ds_read_b128 v[96:99], v6 offset:2432
    ds_read_b128 v[84:87], v6 offset:192
    ds_read_b128 v[100:103], v6 offset:2496
    s_xor_b32 s36, s25, 0x1000
    s_add_u32 s36, s36, s23
    buffer_load_dwordx4 v[16:19], v3, s[8:11], s29 offen offset:0 sc1
    buffer_load_dwordx4 v[32:35], v3, s[8:11], s36 offen offset:0 sc1
    buffer_load_dwordx4 v[20:23], v3, s[8:11], s29 offen offset:1024 sc1
    buffer_load_dwordx4 v[36:39], v3, s[8:11], s36 offen offset:1024 sc1
    buffer_load_dwordx4 v[24:27], v3, s[8:11], s29 offen offset:2048 sc1
    buffer_load_dwordx4 v[40:43], v3, s[8:11], s36 offen offset:2048 sc1
    buffer_load_dwordx4 v[28:31], v3, s[8:11], s29 offen offset:3072 sc1
    buffer_load_dwordx4 v[44:47], v3, s[8:11], s36 offen offset:3072 sc1
    s_waitcnt vmcnt(0) lgkmcnt(0)
    v_mfma_f32_16x16x32_bf16 v[48:51], v[16:19], v[72:75], 0
    v_mfma_f32_16x16x32_bf16 v[48:51], v[20:23], v[76:79], v[48:51]
    v_mfma_f32_16x16x32_bf16 v[48:51], v[24:27], v[80:83], v[48:51]
    v_mfma_f32_16x16x32_bf16 v[48:51], v[28:31], v[84:87], v[48:51]
    v_mfma_f32_16x16x32_bf16 v[52:55], v[32:35], v[72:75], 0
    v_mfma_f32_16x16x32_bf16 v[52:55], v[36:39], v[76:79], v[52:55]
    v_mfma_f32_16x16x32_bf16 v[52:55], v[40:43], v[80:83], v[52:55]
    v_mfma_f32_16x16x32_bf16 v[52:55], v[44:47], v[84:87], v[52:55]
    v_mfma_f32_16x16x32_bf16 v[56:59], v[88:91], v[72:75], 0
    v_mfma_f32_16x16x32_bf16 v[56:59], v[92:95], v[76:79], v[56:59]
    v_mfma_f32_16x16x32_bf16 v[56:59], v[96:99], v[80:83], v[56:59]
    v_mfma_f32_16x16x32_bf16 v[56:59], v[100:103], v[84:87], v[56:59]
    s_nop 7
    v_mul_f32 v56, s33, v56
    v_mul_f32 v57, s33, v57
    v_max3_f32 v16, v48, v49, v50
    v_max3_f32 v16, v16, v51, v52
    v_max3_f32 v16, v16, v53, v54
    v_max3_f32 v16, v16, v55, v56
    v_max_f32 v16, v16, v57
    v_mov_b32 v17, v16
    s_nop 1
    v_permlane16_swap_b32 v16, v17
    v_max_f32 v16, v16, v17
    v_mov_b32 v17, v16
    s_nop 1
    v_permlane32_swap_b32 v16, v17
    v_max_f32 v16, v16, v17
    v_sub_f32 v48, v48, v16
    v_exp_f32 v48, v48
    v_sub_f32 v49, v49, v16
    v_exp_f32 v49, v49
    v_sub_f32 v50, v50, v16
    v_exp_f32 v50, v50
    v_sub_f32 v51, v51, v16
    v_exp_f32 v51, v51
    v_sub_f32 v52, v52, v16
    v_exp_f32 v52, v52
    v_sub_f32 v53, v53, v16
    v_exp_f32 v53, v53
    v_sub_f32 v54, v54, v16
    v_exp_f32 v54, v54
    v_sub_f32 v55, v55, v16
    v_exp_f32 v55, v55
    v_sub_f32 v56, v56, v16
    v_exp_f32 v56, v56
    v_sub_f32 v57, v57, v16
    v_exp_f32 v57, v57
    v_cvt_pk_bf16_f32 v108, v48, v49
    v_cvt_pk_bf16_f32 v109, v50, v51
    v_cvt_pk_bf16_f32 v110, v52, v53
    v_cvt_pk_bf16_f32 v111, v54, v55
    v_cvt_pk_bf16_f32 v112, v56, v57
    s_nop 0
    v_mfma_f32_16x16x32_bf16 v[48:51], v[104:107], v[108:111], 0
    v_mfma_f32_16x16x32_bf16 v[56:59], v[120:123], v[108:111], 0
    v_mfma_f32_16x16x32_bf16 v[60:63], v[124:127], v[108:111], 0
    s_nop 3
    v_mfma_f32_16x16x16_bf16 v[48:51], v[104:105], v[112:113], v[48:51]
    v_mfma_f32_16x16x16_bf16 v[56:59], v[114:115], v[112:113], v[56:59]
    v_mfma_f32_16x16x16_bf16 v[60:63], v[116:117], v[112:113], v[60:63]
    s_nop 5
    v_rcp_f32 v118, v48
    s_nop 0
    v_mul_f32 v56, v56, v118
    v_mul_f32 v57, v57, v118
    v_mul_f32 v58, v58, v118
    v_mul_f32 v59, v59, v118
    v_mul_f32 v60, v60, v118
    v_mul_f32 v61, v61, v118
    v_mul_f32 v62, v62, v118
    v_mul_f32 v63, v63, v118
    v_cvt_pk_bf16_f32 v52, v56, v60
    v_cvt_pk_bf16_f32 v53, v57, v61
    v_cvt_pk_bf16_f32 v54, v58, v62
    v_cvt_pk_bf16_f32 v55, v59, v63
    v_mov_b32 v16, 0
    v_mov_b32 v17, 0
    v_mov_b32 v18, 0
    v_mov_b32 v19, 0
    v_mov_b32 v20, 0
    v_mov_b32 v21, 0
    v_mov_b32 v22, 0
    v_mov_b32 v23, 0
    v_mov_b32 v24, 0
    v_mov_b32 v25, 0
    v_mov_b32 v26, 0
    v_mov_b32 v27, 0
    v_mov_b32 v28, 0
    v_mov_b32 v29, 0
    v_mov_b32 v30, 0
    v_mov_b32 v31, 0
    v_bitop3_b32 v32, v13, s96, -9 bitop3:0x28
    v_bitop3_b32 v36, v13, s97, -9 bitop3:0x28
    v_bitop3_b32 v40, v13, s98, -9 bitop3:0x28
    s_mov_b64 vcc, 0
    s_branch L_slow_rejoin
L_slow_done:
    s_branch L_end
L_worker:
    s_cmp_eq_u32 s3, 7
    s_cbranch_scc1 L_mlp
    s_and_b32 s36, s2, 7
    s_sub_u32 s36, s36, 1
    s_lshl_b32 s36, s36, 5
    s_lshr_b32 s37, s2, 3
    s_add_u32 s36, s36, s37
    s_mul_i32 s20, s36, 10923
    s_lshr_b32 s20, s20, 16
    s_mul_i32 s37, s20, 6
    s_sub_u32 s22, s36, s37
    v_lshrrev_b32 v28, 6, v0
    v_bfe_u32 v29, v0, 4, 2
    v_lshl_add_u32 v28, v28, 5, v29
    v_and_b32 v16, 15, v0
    v_lshlrev_b32 v16, 4, v16
    v_lshl_add_u32 v16, v28, 13, v16
    v_bfe_u32 v29, v0, 4, 2
    v_lshlrev_b32 v29, 5, v29
    v_xor_b32 v16, v16, v29
    v_xor_b32 v17, 0, v16
    v_xor_b32 v18, 128, v16
    v_xor_b32 v19, 128, v16
    s_add_u32 s28, s21, 1
    s_lshl_b32 s28, s28, 15
    s_lshl_b32 s3, s20, 8
    s_mov_b32 s76, s52
    s_and_b32 s77, s53, 0xffff
    s_mov_b32 s78, 0x400000
    s_mov_b32 s79, 0x20000
    s_add_u32 m0, s28, 0
    s_add_u32 s37, s3, 0x0
    buffer_load_dwordx4 v16, s[76:79], s37 offen lds
    s_add_u32 m0, s28, 1024
    s_add_u32 s37, s3, 0x8000
    buffer_load_dwordx4 v17, s[76:79], s37 offen lds
    s_add_u32 m0, s28, 2048
    s_add_u32 s37, s3, 0x10000
    buffer_load_dwordx4 v18, s[76:79], s37 offen lds
    s_add_u32 m0, s28, 3072
    s_add_u32 s37, s3, 0x18000
    buffer_load_dwordx4 v19, s[76:79], s37 offen lds
    s_add_u32 m0, s28, 4096
    s_add_u32 s37, s3, 0x20000
    buffer_load_dwordx4 v16, s[76:79], s37 offen lds
    s_add_u32 m0, s28, 5120
    s_add_u32 s37, s3, 0x28000
    buffer_load_dwordx4 v17, s[76:79], s37 offen lds
    s_add_u32 m0, s28, 6144
    s_add_u32 s37, s3, 0x30000
    buffer_load_dwordx4 v18, s[76:79], s37 offen lds
    s_add_u32 m0, s28, 7168
    s_add_u32 s37, s3, 0x38000
    buffer_load_dwordx4 v19, s[76:79], s37 offen lds
    s_add_u32 m0, s28, 8192
    s_add_u32 s37, s3, 0x100000
    buffer_load_dwordx4 v16, s[76:79], s37 offen lds
    s_add_u32 m0, s28, 9216
    s_add_u32 s37, s3, 0x108000
    buffer_load_dwordx4 v17, s[76:79], s37 offen lds
    s_add_u32 m0, s28, 10240
    s_add_u32 s37, s3, 0x110000
    buffer_load_dwordx4 v18, s[76:79], s37 offen lds
    s_add_u32 m0, s28, 11264
    s_add_u32 s37, s3, 0x118000
    buffer_load_dwordx4 v19, s[76:79], s37 offen lds
    s_add_u32 m0, s28, 12288
    s_add_u32 s37, s3, 0x120000
    buffer_load_dwordx4 v16, s[76:79], s37 offen lds
    s_add_u32 m0, s28, 13312
    s_add_u32 s37, s3, 0x128000
    buffer_load_dwordx4 v17, s[76:79], s37 offen lds
    s_add_u32 m0, s28, 14336
    s_add_u32 s37, s3, 0x130000
    buffer_load_dwordx4 v18, s[76:79], s37 offen lds
    s_add_u32 m0, s28, 15360
    s_add_u32 s37, s3, 0x138000
    buffer_load_dwordx4 v19, s[76:79], s37 offen lds
    s_add_u32 m0, s28, 16384
    s_add_u32 s37, s3, 0x200000
    buffer_load_dwordx4 v16, s[76:79], s37 offen lds
    s_add_u32 m0, s28, 17408
    s_add_u32 s37, s3, 0x208000
    buffer_load_dwordx4 v17, s[76:79], s37 offen lds
    s_add_u32 m0, s28, 18432
    s_add_u32 s37, s3, 0x210000
    buffer_load_dwordx4 v18, s[76:79], s37 offen lds
    s_add_u32 m0, s28, 19456
    s_add_u32 s37, s3, 0x218000
    buffer_load_dwordx4 v19, s[76:79], s37 offen lds
    s_add_u32 m0, s28, 20480
    s_add_u32 s37, s3, 0x220000
    buffer_load_dwordx4 v16, s[76:79], s37 offen lds
    s_add_u32 m0, s28, 21504
    s_add_u32 s37, s3, 0x228000
    buffer_load_dwordx4 v17, s[76:79], s37 offen lds
    s_add_u32 m0, s28, 22528
    s_add_u32 s37, s3, 0x230000
    buffer_load_dwordx4 v18, s[76:79], s37 offen lds
    s_add_u32 m0, s28, 23552
    s_add_u32 s37, s3, 0x238000
    buffer_load_dwordx4 v19, s[76:79], s37 offen lds
    s_add_u32 m0, s28, 24576
    s_add_u32 s37, s3, 0x300000
    buffer_load_dwordx4 v16, s[76:79], s37 offen lds
    s_add_u32 m0, s28, 25600
    s_add_u32 s37, s3, 0x308000
    buffer_load_dwordx4 v17, s[76:79], s37 offen lds
    s_add_u32 m0, s28, 26624
    s_add_u32 s37, s3, 0x310000
    buffer_load_dwordx4 v18, s[76:79], s37 offen lds
    s_add_u32 m0, s28, 27648
    s_add_u32 s37, s3, 0x318000
    buffer_load_dwordx4 v19, s[76:79], s37 offen lds
    s_add_u32 m0, s28, 28672
    s_add_u32 s37, s3, 0x320000
    buffer_load_dwordx4 v16, s[76:79], s37 offen lds
    s_add_u32 m0, s28, 29696
    s_add_u32 s37, s3, 0x328000
    buffer_load_dwordx4 v17, s[76:79], s37 offen lds
    s_add_u32 m0, s28, 30720
    s_add_u32 s37, s3, 0x330000
    buffer_load_dwordx4 v18, s[76:79], s37 offen lds
    s_add_u32 m0, s28, 31744
    s_add_u32 s37, s3, 0x338000
    buffer_load_dwordx4 v19, s[76:79], s37 offen lds
    v_mov_b32 v20, 0x0
    v_bfe_u32 v14, v0, 0, 1
    s_mov_b32 s38, 0x8
    v_mad_u32_u24 v20, v14, s38, v20
    v_bfe_u32 v14, v0, 1, 1
    s_mov_b32 s38, 0x10
    v_mad_u32_u24 v20, v14, s38, v20
    v_bfe_u32 v14, v0, 2, 1
    s_mov_b32 s38, 0x100
    v_mad_u32_u24 v20, v14, s38, v20
    v_bfe_u32 v14, v0, 3, 1
    s_mov_b32 s38, 0x200
    v_mad_u32_u24 v20, v14, s38, v20
    v_bfe_u32 v14, v0, 4, 1
    s_mov_b32 s38, 0x800
    v_mad_u32_u24 v20, v14, s38, v20
    v_bfe_u32 v14, v0, 5, 1
    s_mov_b32 s38, 0x1000
    v_mad_u32_u24 v20, v14, s38, v20
    v_mov_b32 v30, 0x0
    v_bfe_u32 v14, v0, 2, 1
    s_mov_b32 s38, 0x20
    v_mad_u32_u24 v30, v14, s38, v30
    v_bfe_u32 v14, v0, 3, 1
    s_mov_b32 s38, 0x40
    v_mad_u32_u24 v30, v14, s38, v30
    v_bfe_u32 v14, v0, 4, 1
    s_mov_b32 s38, 0x80
    v_mad_u32_u24 v30, v14, s38, v30
    v_mov_b32 v31, 0x0
    v_bfe_u32 v14, v0, 6, 1
    s_mov_b32 s38, 0x40
    v_mad_u32_u24 v31, v14, s38, v31
    v_bfe_u32 v14, v0, 7, 1
    s_mov_b32 s38, 0x80
    v_mad_u32_u24 v31, v14, s38, v31
    v_xor_b32 v30, v30, v31
    v_add_u32 v30, v30, v20
    v_add_u32 v20, 0x8000, v30
    v_xor_b32 v21, 32, v20
    v_add_u32 v22, 0x10000, v30
    v_xor_b32 v23, 32, v22
    v_add_u32 v24, 0x18000, v30
    v_xor_b32 v25, 32, v24
    v_add_u32 v26, 0x20000, v30
    v_xor_b32 v27, 32, v26
    s_mov_b32 s12, s54
    s_and_b32 s13, s55, 0xffff
    s_mov_b32 s14, 0x400000
    s_mov_b32 s15, 0x20000
    s_lshl_b32 s24, s20, 17
    s_and_b32 s25, s22, 3
    s_lshl_b32 s25, s25, 15
    s_add_u32 s24, s24, s25
    v_lshlrev_b32 v30, 7, v0
    buffer_load_dword v31, v30, s[12:15], s24 offen
    s_mov_b32 s12, s44
    s_and_b32 s13, s45, 0xffff
    s_mov_b32 s14, 0x200000
    s_mov_b32 s15, 0x20000
    s_mov_b32 s60, s82
    s_and_b32 s61, s83, 0xffff
    s_mov_b32 s62, 0x200000
    s_mov_b32 s63, 0x20000
    s_mov_b32 s92, s80
    s_and_b32 s93, s81, 0xffff
    s_mov_b32 s94, 0x400
    s_mov_b32 s95, 0x20000
    v_mov_b32 v1, 0x0
    v_bfe_u32 v14, v0, 0, 1
    s_mov_b32 s38, 0x10
    v_mad_u32_u24 v1, v14, s38, v1
    v_bfe_u32 v14, v0, 1, 1
    s_mov_b32 s38, 0x20
    v_mad_u32_u24 v1, v14, s38, v1
    v_bfe_u32 v14, v0, 2, 1
    s_mov_b32 s38, 0x40
    v_mad_u32_u24 v1, v14, s38, v1
    v_bfe_u32 v14, v0, 3, 1
    s_mov_b32 s38, 0x80
    v_mad_u32_u24 v1, v14, s38, v1
    v_bfe_u32 v14, v0, 4, 1
    s_mov_b32 s38, 0x100
    v_mad_u32_u24 v1, v14, s38, v1
    v_bfe_u32 v14, v0, 5, 1
    s_mov_b32 s38, 0x200
    v_mad_u32_u24 v1, v14, s38, v1
    v_mov_b32 v2, 0x0
    v_bfe_u32 v14, v0, 0, 1
    s_mov_b32 s38, 0x10
    v_mad_u32_u24 v2, v14, s38, v2
    v_bfe_u32 v14, v0, 1, 1
    s_mov_b32 s38, 0x20
    v_mad_u32_u24 v2, v14, s38, v2
    v_bfe_u32 v14, v0, 2, 1
    s_mov_b32 s38, 0x40
    v_mad_u32_u24 v2, v14, s38, v2
    v_bfe_u32 v14, v0, 3, 1
    s_mov_b32 s38, 0x80
    v_mad_u32_u24 v2, v14, s38, v2
    v_bfe_u32 v14, v0, 4, 1
    s_mov_b32 s38, 0x100
    v_mad_u32_u24 v2, v14, s38, v2
    v_bfe_u32 v14, v0, 5, 1
    s_mov_b32 s38, 0x200
    v_mad_u32_u24 v2, v14, s38, v2
    v_bfe_u32 v14, v0, 6, 1
    s_mov_b32 s38, 0x800
    v_mad_u32_u24 v2, v14, s38, v2
    v_bfe_u32 v14, v0, 7, 1
    s_mov_b32 s38, 0x1000
    v_mad_u32_u24 v2, v14, s38, v2
    v_mov_b32 v9, 0x0
    v_bfe_u32 v14, v0, 0, 1
    s_mov_b32 s38, 0x10
    v_mad_u32_u24 v9, v14, s38, v9
    v_bfe_u32 v14, v0, 1, 1
    s_mov_b32 s38, 0x20
    v_mad_u32_u24 v9, v14, s38, v9
    v_bfe_u32 v14, v0, 2, 1
    s_mov_b32 s38, 0x40
    v_mad_u32_u24 v9, v14, s38, v9
    v_bfe_u32 v14, v0, 3, 1
    s_mov_b32 s38, 0x80
    v_mad_u32_u24 v9, v14, s38, v9
    v_bfe_u32 v14, v0, 4, 1
    s_mov_b32 s38, 0x100
    v_mad_u32_u24 v9, v14, s38, v9
    v_bfe_u32 v14, v0, 5, 1
    s_mov_b32 s38, 0x200
    v_mad_u32_u24 v9, v14, s38, v9
    v_bfe_u32 v14, v0, 6, 1
    s_mov_b32 s38, 0x400
    v_mad_u32_u24 v9, v14, s38, v9
    v_bfe_u32 v14, v0, 7, 1
    s_mov_b32 s38, 0x800
    v_mad_u32_u24 v9, v14, s38, v9
    v_mov_b32 v7, 0x8000
    v_bfe_u32 v14, v0, 0, 1
    s_mov_b32 s38, 0x10
    v_mad_u32_u24 v7, v14, s38, v7
    v_bfe_u32 v14, v0, 1, 1
    s_mov_b32 s38, 0x20
    v_mad_u32_u24 v7, v14, s38, v7
    v_bfe_u32 v14, v0, 2, 1
    s_mov_b32 s38, 0x40
    v_mad_u32_u24 v7, v14, s38, v7
    v_bfe_u32 v14, v0, 3, 1
    s_mov_b32 s38, 0x80
    v_mad_u32_u24 v7, v14, s38, v7
    v_bfe_u32 v14, v0, 4, 1
    s_mov_b32 s38, 0x100
    v_mad_u32_u24 v7, v14, s38, v7
    v_bfe_u32 v14, v0, 5, 1
    s_mov_b32 s38, 0x200
    v_mad_u32_u24 v7, v14, s38, v7
    v_bfe_u32 v14, v0, 6, 1
    s_mov_b32 s38, 0x8000
    v_mad_u32_u24 v7, v14, s38, v7
    v_bfe_u32 v14, v0, 7, 1
    s_mov_b32 s38, 0x10000
    v_mad_u32_u24 v7, v14, s38, v7
    v_mov_b32 v3, 0x0
    v_bfe_u32 v14, v0, 0, 1
    s_mov_b32 s38, 0x10
    v_mad_u32_u24 v3, v14, s38, v3
    v_bfe_u32 v14, v0, 1, 1
    s_mov_b32 s38, 0x20
    v_mad_u32_u24 v3, v14, s38, v3
    v_bfe_u32 v14, v0, 2, 1
    s_mov_b32 s38, 0x40
    v_mad_u32_u24 v3, v14, s38, v3
    v_bfe_u32 v14, v0, 3, 1
    s_mov_b32 s38, 0x400
    v_mad_u32_u24 v3, v14, s38, v3
    v_bfe_u32 v14, v0, 4, 1
    s_mov_b32 s38, 0x800
    v_mad_u32_u24 v3, v14, s38, v3
    v_bfe_u32 v14, v0, 5, 1
    s_mov_b32 s38, 0x1000
    v_mad_u32_u24 v3, v14, s38, v3
    v_bfe_u32 v14, v0, 6, 1
    s_mov_b32 s38, 0x2000
    v_mad_u32_u24 v3, v14, s38, v3
    v_bfe_u32 v14, v0, 7, 1
    s_mov_b32 s38, 0x4000
    v_mad_u32_u24 v3, v14, s38, v3
    v_mov_b32 v4, 0x0
    v_bfe_u32 v14, v0, 0, 1
    s_mov_b32 s38, 0x100
    v_mad_u32_u24 v4, v14, s38, v4
    v_bfe_u32 v14, v0, 1, 1
    s_mov_b32 s38, 0x200
    v_mad_u32_u24 v4, v14, s38, v4
    v_bfe_u32 v14, v0, 2, 1
    s_mov_b32 s38, 0x400
    v_mad_u32_u24 v4, v14, s38, v4
    v_bfe_u32 v14, v0, 6, 1
    s_mov_b32 s38, 0x80
    v_mad_u32_u24 v4, v14, s38, v4
    v_bfe_u32 v14, v0, 7, 1
    s_mov_b32 s38, 0x4000
    v_mad_u32_u24 v4, v14, s38, v4
    v_lshrrev_b32 v15, 3, v0
    v_xor_b32 v15, v15, v0
    v_and_b32 v15, 7, v15
    v_lshl_add_u32 v4, v15, 4, v4
    v_bfe_u32 v15, v0, 4, 2
    v_lshlrev_b32 v15, 4, v15
    v_xor_b32 v5, v15, v1
    v_xor_b32 v6, 64, v5
    v_mov_b32 v8, 0x5000
    v_bfe_u32 v14, v0, 0, 1
    s_mov_b32 s38, 0x10
    v_mad_u32_u24 v8, v14, s38, v8
    v_bfe_u32 v14, v0, 1, 1
    s_mov_b32 s38, 0x40
    v_mad_u32_u24 v8, v14, s38, v8
    v_bfe_u32 v14, v0, 2, 1
    s_mov_b32 s38, 0x80
    v_mad_u32_u24 v8, v14, s38, v8
    v_bfe_u32 v14, v0, 4, 1
    s_mov_b32 s38, 0x20
    v_mad_u32_u24 v8, v14, s38, v8
    v_bfe_u32 v14, v0, 5, 1
    s_mov_b32 s38, 0x100
    v_mad_u32_u24 v8, v14, s38, v8
    v_mov_b32 v10, 0x0
    v_bfe_u32 v14, v0, 0, 1
    s_mov_b32 s38, 0x10
    v_mad_u32_u24 v10, v14, s38, v10
    v_bfe_u32 v14, v0, 1, 1
    s_mov_b32 s38, 0x20
    v_mad_u32_u24 v10, v14, s38, v10
    v_bfe_u32 v14, v0, 2, 1
    s_mov_b32 s38, 0x40
    v_mad_u32_u24 v10, v14, s38, v10
    v_bfe_u32 v14, v0, 3, 1
    s_mov_b32 s38, 0x80
    v_mad_u32_u24 v10, v14, s38, v10
    v_bfe_u32 v14, v0, 4, 1
    s_mov_b32 s38, 0x20000
    v_mad_u32_u24 v10, v14, s38, v10
    v_bfe_u32 v14, v0, 5, 1
    s_mov_b32 s38, 0x40000
    v_mad_u32_u24 v10, v14, s38, v10
    v_bfe_u32 v14, v0, 6, 1
    s_mov_b32 s38, 0x100
    v_mad_u32_u24 v10, v14, s38, v10
    v_bfe_u32 v14, v0, 7, 1
    s_mov_b32 s38, 0x200
    v_mad_u32_u24 v10, v14, s38, v10
    v_mov_b32 v11, 0x0
    v_bfe_u32 v14, v0, 0, 1
    s_mov_b32 s38, 0x10
    v_mad_u32_u24 v11, v14, s38, v11
    v_bfe_u32 v14, v0, 1, 1
    s_mov_b32 s38, 0x20
    v_mad_u32_u24 v11, v14, s38, v11
    v_bfe_u32 v14, v0, 2, 1
    s_mov_b32 s38, 0x40
    v_mad_u32_u24 v11, v14, s38, v11
    v_bfe_u32 v14, v0, 3, 1
    s_mov_b32 s38, 0x80
    v_mad_u32_u24 v11, v14, s38, v11
    v_bfe_u32 v14, v0, 4, 1
    s_mov_b32 s38, 0x400
    v_mad_u32_u24 v11, v14, s38, v11
    v_bfe_u32 v14, v0, 5, 1
    s_mov_b32 s38, 0x800
    v_mad_u32_u24 v11, v14, s38, v11
    v_bfe_u32 v14, v0, 6, 1
    s_mov_b32 s38, 0x100
    v_mad_u32_u24 v11, v14, s38, v11
    v_bfe_u32 v14, v0, 7, 1
    s_mov_b32 s38, 0x200
    v_mad_u32_u24 v11, v14, s38, v11
    v_mov_b32 v12, 0x0
    v_bfe_u32 v14, v0, 0, 1
    s_mov_b32 s38, 0x10
    v_mad_u32_u24 v12, v14, s38, v12
    v_bfe_u32 v14, v0, 1, 1
    s_mov_b32 s38, 0x20
    v_mad_u32_u24 v12, v14, s38, v12
    v_bfe_u32 v14, v0, 2, 1
    s_mov_b32 s38, 0x40
    v_mad_u32_u24 v12, v14, s38, v12
    v_bfe_u32 v14, v0, 3, 1
    s_mov_b32 s38, 0x80
    v_mad_u32_u24 v12, v14, s38, v12
    v_bfe_u32 v14, v0, 4, 1
    s_mov_b32 s38, 0x4
    v_mad_u32_u24 v12, v14, s38, v12
    v_bfe_u32 v14, v0, 5, 1
    s_mov_b32 s38, 0x8
    v_mad_u32_u24 v12, v14, s38, v12
    v_bfe_u32 v14, v0, 6, 1
    s_mov_b32 s38, 0x100
    v_mad_u32_u24 v12, v14, s38, v12
    v_bfe_u32 v14, v0, 7, 1
    s_mov_b32 s38, 0x200
    v_mad_u32_u24 v12, v14, s38, v12
    v_mov_b32 v13, 0xf149f2ca
    v_and_b32 v14, 15, v0
    v_bfe_u32 v15, v0, 4, 2
    v_cmp_gt_u32 s[72:73], 2, v15
    v_lshlrev_b32 v15, 2, v15
    v_cmp_le_u32 s[64:65], v15, v14
    v_add_u32 v15, 1, v15
    v_cmp_le_u32 s[66:67], v15, v14
    v_add_u32 v15, 1, v15
    v_cmp_le_u32 s[68:69], v15, v14
    v_add_u32 v15, 1, v15
    v_cmp_le_u32 s[70:71], v15, v14
    v_add_u32 v15, 1, v15
    s_mov_b32 s34, 0x05040100
    s_mov_b32 s35, 0x07060302
    s_mov_b32 s33, 0x3e0293ee
    s_mov_b32 s32, 0
    s_mov_b32 s4, 0x3f803f80
    s_mov_b32 s5, 0x3f803f80
    s_mov_b32 s23, s22
    s_lshl_b32 s36, s23, 15
    buffer_load_dwordx4 v[96:99], v3, s[12:15], s36 offen offset:0
    buffer_load_dwordx4 v[100:103], v3, s[12:15], s36 offen offset:128
    buffer_load_dwordx4 v[104:107], v3, s[12:15], s36 offen offset:256
    buffer_load_dwordx4 v[108:111], v3, s[12:15], s36 offen offset:384
    buffer_load_dwordx4 v[112:115], v3, s[12:15], s36 offen offset:512
    buffer_load_dwordx4 v[116:119], v3, s[12:15], s36 offen offset:640
    buffer_load_dwordx4 v[120:123], v3, s[12:15], s36 offen offset:768
    buffer_load_dwordx4 v[124:127], v3, s[12:15], s36 offen offset:896
    s_waitcnt vmcnt(33)
    s_barrier
    ds_read_b64_tr_b16 v[128:129], v20 offset:0
    ds_read_b64_tr_b16 v[130:131], v20 offset:1024
    ds_read_b64_tr_b16 v[132:133], v21 offset:0
    ds_read_b64_tr_b16 v[134:135], v21 offset:1024
    ds_read_b64_tr_b16 v[136:137], v22 offset:0
    ds_read_b64_tr_b16 v[138:139], v22 offset:1024
    ds_read_b64_tr_b16 v[140:141], v23 offset:0
    ds_read_b64_tr_b16 v[142:143], v23 offset:1024
    ds_read_b64_tr_b16 v[144:145], v24 offset:0
    ds_read_b64_tr_b16 v[146:147], v24 offset:1024
    ds_read_b64_tr_b16 v[148:149], v25 offset:0
    ds_read_b64_tr_b16 v[150:151], v25 offset:1024
    s_waitcnt lgkmcnt(4)
    ds_read_b64_tr_b16 v[152:153], v26 offset:0
    ds_read_b64_tr_b16 v[154:155], v26 offset:1024
    ds_read_b64_tr_b16 v[156:157], v27 offset:0
    ds_read_b64_tr_b16 v[158:159], v27 offset:1024
    s_waitcnt lgkmcnt(0)
    s_barrier
    s_mov_b32 s40, s50
    s_and_b32 s41, s51, 0xffff
    s_mov_b32 s42, 0x400000
    s_mov_b32 s43, 0x20000
    s_add_u32 m0, s28, 0
    s_add_u32 s37, s3, 0x0
    buffer_load_dwordx4 v16, s[40:43], s37 offen lds
    s_add_u32 m0, s28, 1024
    s_add_u32 s37, s3, 0x8000
    buffer_load_dwordx4 v17, s[40:43], s37 offen lds
    s_add_u32 m0, s28, 2048
    s_add_u32 s37, s3, 0x10000
    buffer_load_dwordx4 v18, s[40:43], s37 offen lds
    s_add_u32 m0, s28, 3072
    s_add_u32 s37, s3, 0x18000
    buffer_load_dwordx4 v19, s[40:43], s37 offen lds
    s_add_u32 m0, s28, 4096
    s_add_u32 s37, s3, 0x20000
    buffer_load_dwordx4 v16, s[40:43], s37 offen lds
    s_add_u32 m0, s28, 5120
    s_add_u32 s37, s3, 0x28000
    buffer_load_dwordx4 v17, s[40:43], s37 offen lds
    s_add_u32 m0, s28, 6144
    s_add_u32 s37, s3, 0x30000
    buffer_load_dwordx4 v18, s[40:43], s37 offen lds
    s_add_u32 m0, s28, 7168
    s_add_u32 s37, s3, 0x38000
    buffer_load_dwordx4 v19, s[40:43], s37 offen lds
    s_waitcnt vmcnt(33)
    s_barrier
    ds_read_b64_tr_b16 v[160:161], v20 offset:8192
    ds_read_b64_tr_b16 v[162:163], v20 offset:9216
    ds_read_b64_tr_b16 v[164:165], v21 offset:8192
    ds_read_b64_tr_b16 v[166:167], v21 offset:9216
    ds_read_b64_tr_b16 v[168:169], v22 offset:8192
    ds_read_b64_tr_b16 v[170:171], v22 offset:9216
    ds_read_b64_tr_b16 v[172:173], v23 offset:8192
    ds_read_b64_tr_b16 v[174:175], v23 offset:9216
    ds_read_b64_tr_b16 v[176:177], v24 offset:8192
    ds_read_b64_tr_b16 v[178:179], v24 offset:9216
    ds_read_b64_tr_b16 v[180:181], v25 offset:8192
    ds_read_b64_tr_b16 v[182:183], v25 offset:9216
    s_waitcnt lgkmcnt(4)
    ds_read_b64_tr_b16 v[184:185], v26 offset:8192
    ds_read_b64_tr_b16 v[186:187], v26 offset:9216
    ds_read_b64_tr_b16 v[188:189], v27 offset:8192
    ds_read_b64_tr_b16 v[190:191], v27 offset:9216
    s_waitcnt lgkmcnt(0)
    s_barrier
    s_add_u32 m0, s28, 8192
    s_add_u32 s37, s3, 0x100000
    buffer_load_dwordx4 v16, s[40:43], s37 offen lds
    s_add_u32 m0, s28, 9216
    s_add_u32 s37, s3, 0x108000
    buffer_load_dwordx4 v17, s[40:43], s37 offen lds
    s_add_u32 m0, s28, 10240
    s_add_u32 s37, s3, 0x110000
    buffer_load_dwordx4 v18, s[40:43], s37 offen lds
    s_add_u32 m0, s28, 11264
    s_add_u32 s37, s3, 0x118000
    buffer_load_dwordx4 v19, s[40:43], s37 offen lds
    s_add_u32 m0, s28, 12288
    s_add_u32 s37, s3, 0x120000
    buffer_load_dwordx4 v16, s[40:43], s37 offen lds
    s_add_u32 m0, s28, 13312
    s_add_u32 s37, s3, 0x128000
    buffer_load_dwordx4 v17, s[40:43], s37 offen lds
    s_add_u32 m0, s28, 14336
    s_add_u32 s37, s3, 0x130000
    buffer_load_dwordx4 v18, s[40:43], s37 offen lds
    s_add_u32 m0, s28, 15360
    s_add_u32 s37, s3, 0x138000
    buffer_load_dwordx4 v19, s[40:43], s37 offen lds
    s_waitcnt vmcnt(33)
    s_barrier
    ds_read_b64_tr_b16 v[192:193], v20 offset:16384
    ds_read_b64_tr_b16 v[194:195], v20 offset:17408
    ds_read_b64_tr_b16 v[196:197], v21 offset:16384
    ds_read_b64_tr_b16 v[198:199], v21 offset:17408
    ds_read_b64_tr_b16 v[200:201], v22 offset:16384
    ds_read_b64_tr_b16 v[202:203], v22 offset:17408
    ds_read_b64_tr_b16 v[204:205], v23 offset:16384
    ds_read_b64_tr_b16 v[206:207], v23 offset:17408
    ds_read_b64_tr_b16 v[208:209], v24 offset:16384
    ds_read_b64_tr_b16 v[210:211], v24 offset:17408
    ds_read_b64_tr_b16 v[212:213], v25 offset:16384
    ds_read_b64_tr_b16 v[214:215], v25 offset:17408
    s_waitcnt lgkmcnt(4)
    ds_read_b64_tr_b16 v[216:217], v26 offset:16384
    ds_read_b64_tr_b16 v[218:219], v26 offset:17408
    ds_read_b64_tr_b16 v[220:221], v27 offset:16384
    ds_read_b64_tr_b16 v[222:223], v27 offset:17408
    s_waitcnt lgkmcnt(0)
    s_barrier
    s_add_u32 m0, s28, 16384
    s_add_u32 s37, s3, 0x200000
    buffer_load_dwordx4 v16, s[40:43], s37 offen lds
    s_add_u32 m0, s28, 17408
    s_add_u32 s37, s3, 0x208000
    buffer_load_dwordx4 v17, s[40:43], s37 offen lds
    s_add_u32 m0, s28, 18432
    s_add_u32 s37, s3, 0x210000
    buffer_load_dwordx4 v18, s[40:43], s37 offen lds
    s_add_u32 m0, s28, 19456
    s_add_u32 s37, s3, 0x218000
    buffer_load_dwordx4 v19, s[40:43], s37 offen lds
    s_add_u32 m0, s28, 20480
    s_add_u32 s37, s3, 0x220000
    buffer_load_dwordx4 v16, s[40:43], s37 offen lds
    s_add_u32 m0, s28, 21504
    s_add_u32 s37, s3, 0x228000
    buffer_load_dwordx4 v17, s[40:43], s37 offen lds
    s_add_u32 m0, s28, 22528
    s_add_u32 s37, s3, 0x230000
    buffer_load_dwordx4 v18, s[40:43], s37 offen lds
    s_add_u32 m0, s28, 23552
    s_add_u32 s37, s3, 0x238000
    buffer_load_dwordx4 v19, s[40:43], s37 offen lds
    s_waitcnt vmcnt(33)
    s_barrier
    ds_read_b64_tr_b16 v[224:225], v20 offset:24576
    ds_read_b64_tr_b16 v[226:227], v20 offset:25600
    ds_read_b64_tr_b16 v[228:229], v21 offset:24576
    ds_read_b64_tr_b16 v[230:231], v21 offset:25600
    ds_read_b64_tr_b16 v[232:233], v22 offset:24576
    ds_read_b64_tr_b16 v[234:235], v22 offset:25600
    ds_read_b64_tr_b16 v[236:237], v23 offset:24576
    ds_read_b64_tr_b16 v[238:239], v23 offset:25600
    ds_read_b64_tr_b16 v[240:241], v24 offset:24576
    ds_read_b64_tr_b16 v[242:243], v24 offset:25600
    ds_read_b64_tr_b16 v[244:245], v25 offset:24576
    ds_read_b64_tr_b16 v[246:247], v25 offset:25600
    s_waitcnt lgkmcnt(4)
    ds_read_b64_tr_b16 v[248:249], v26 offset:24576
    ds_read_b64_tr_b16 v[250:251], v26 offset:25600
    ds_read_b64_tr_b16 v[252:253], v27 offset:24576
    ds_read_b64_tr_b16 v[254:255], v27 offset:25600
    s_waitcnt lgkmcnt(0)
    s_barrier
    s_add_u32 m0, s28, 24576
    s_add_u32 s37, s3, 0x300000
    buffer_load_dwordx4 v16, s[40:43], s37 offen lds
    s_add_u32 m0, s28, 25600
    s_add_u32 s37, s3, 0x308000
    buffer_load_dwordx4 v17, s[40:43], s37 offen lds
    s_add_u32 m0, s28, 26624
    s_add_u32 s37, s3, 0x310000
    buffer_load_dwordx4 v18, s[40:43], s37 offen lds
    s_add_u32 m0, s28, 27648
    s_add_u32 s37, s3, 0x318000
    buffer_load_dwordx4 v19, s[40:43], s37 offen lds
    s_add_u32 m0, s28, 28672
    s_add_u32 s37, s3, 0x320000
    buffer_load_dwordx4 v16, s[40:43], s37 offen lds
    s_add_u32 m0, s28, 29696
    s_add_u32 s37, s3, 0x328000
    buffer_load_dwordx4 v17, s[40:43], s37 offen lds
    s_add_u32 m0, s28, 30720
    s_add_u32 s37, s3, 0x330000
    buffer_load_dwordx4 v18, s[40:43], s37 offen lds
    s_add_u32 m0, s28, 31744
    s_add_u32 s37, s3, 0x338000
    buffer_load_dwordx4 v19, s[40:43], s37 offen lds
    s_waitcnt vmcnt(32)
    v_mov_b32 v88, 0
    v_mov_b32 v89, 0
    v_dot2_f32_bf16 v88, v96, s4, v88
    v_dot2_f32_bf16 v89, v96, v96, v89
    v_dot2_f32_bf16 v88, v97, s4, v88
    v_dot2_f32_bf16 v89, v97, v97, v89
    v_dot2_f32_bf16 v88, v98, s4, v88
    v_dot2_f32_bf16 v89, v98, v98, v89
    v_dot2_f32_bf16 v88, v99, s4, v88
    v_dot2_f32_bf16 v89, v99, v99, v89
    v_dot2_f32_bf16 v88, v100, s4, v88
    v_dot2_f32_bf16 v89, v100, v100, v89
    v_dot2_f32_bf16 v88, v101, s4, v88
    v_dot2_f32_bf16 v89, v101, v101, v89
    v_dot2_f32_bf16 v88, v102, s4, v88
    v_dot2_f32_bf16 v89, v102, v102, v89
    v_dot2_f32_bf16 v88, v103, s4, v88
    v_dot2_f32_bf16 v89, v103, v103, v89
    v_dot2_f32_bf16 v88, v104, s4, v88
    v_dot2_f32_bf16 v89, v104, v104, v89
    v_dot2_f32_bf16 v88, v105, s4, v88
    v_dot2_f32_bf16 v89, v105, v105, v89
    v_dot2_f32_bf16 v88, v106, s4, v88
    v_dot2_f32_bf16 v89, v106, v106, v89
    v_dot2_f32_bf16 v88, v107, s4, v88
    v_dot2_f32_bf16 v89, v107, v107, v89
    v_dot2_f32_bf16 v88, v108, s4, v88
    v_dot2_f32_bf16 v89, v108, v108, v89
    v_dot2_f32_bf16 v88, v109, s4, v88
    v_dot2_f32_bf16 v89, v109, v109, v89
    v_dot2_f32_bf16 v88, v110, s4, v88
    v_dot2_f32_bf16 v89, v110, v110, v89
    v_dot2_f32_bf16 v88, v111, s4, v88
    v_dot2_f32_bf16 v89, v111, v111, v89
    v_dot2_f32_bf16 v88, v112, s4, v88
    v_dot2_f32_bf16 v89, v112, v112, v89
    v_dot2_f32_bf16 v88, v113, s4, v88
    v_dot2_f32_bf16 v89, v113, v113, v89
    v_dot2_f32_bf16 v88, v114, s4, v88
    v_dot2_f32_bf16 v89, v114, v114, v89
    v_dot2_f32_bf16 v88, v115, s4, v88
    v_dot2_f32_bf16 v89, v115, v115, v89
    v_dot2_f32_bf16 v88, v116, s4, v88
    v_dot2_f32_bf16 v89, v116, v116, v89
    v_dot2_f32_bf16 v88, v117, s4, v88
    v_dot2_f32_bf16 v89, v117, v117, v89
    v_dot2_f32_bf16 v88, v118, s4, v88
    v_dot2_f32_bf16 v89, v118, v118, v89
    v_dot2_f32_bf16 v88, v119, s4, v88
    v_dot2_f32_bf16 v89, v119, v119, v89
    v_dot2_f32_bf16 v88, v120, s4, v88
    v_dot2_f32_bf16 v89, v120, v120, v89
    v_dot2_f32_bf16 v88, v121, s4, v88
    v_dot2_f32_bf16 v89, v121, v121, v89
    v_dot2_f32_bf16 v88, v122, s4, v88
    v_dot2_f32_bf16 v89, v122, v122, v89
    v_dot2_f32_bf16 v88, v123, s4, v88
    v_dot2_f32_bf16 v89, v123, v123, v89
    v_dot2_f32_bf16 v88, v124, s4, v88
    v_dot2_f32_bf16 v89, v124, v124, v89
    v_dot2_f32_bf16 v88, v125, s4, v88
    v_dot2_f32_bf16 v89, v125, v125, v89
    v_dot2_f32_bf16 v88, v126, s4, v88
    v_dot2_f32_bf16 v89, v126, v126, v89
    v_dot2_f32_bf16 v88, v127, s4, v88
    v_dot2_f32_bf16 v89, v127, v127, v89
    s_nop 3
    v_add_f32_dpp v88, v88, v88 quad_perm:[1,0,3,2] row_mask:0xf bank_mask:0xf
    v_add_f32_dpp v89, v89, v89 quad_perm:[1,0,3,2] row_mask:0xf bank_mask:0xf
    s_nop 0
    v_add_f32_dpp v88, v88, v88 quad_perm:[2,3,0,1] row_mask:0xf bank_mask:0xf
    v_add_f32_dpp v89, v89, v89 quad_perm:[2,3,0,1] row_mask:0xf bank_mask:0xf
    s_nop 0
    v_add_f32_dpp v88, v88, v88 row_half_mirror row_mask:0xf bank_mask:0xf
    v_add_f32_dpp v89, v89, v89 row_half_mirror row_mask:0xf bank_mask:0xf
    v_mul_f32 v88, 0x3b000000, v88
    v_mul_f32 v89, 0x3b000000, v89
    v_fma_f32 v89, -v88, v88, v89
    v_max_f32 v89, 0, v89
    v_cvt_pk_bf16_f32 v14, v88, v89
    v_lshlrev_b32 v88, 16, v14
    v_and_b32 v89, 0xffff0000, v14
    v_add_f32 v89, 0x3727c5ac, v89
    v_cvt_pk_bf16_f32 v14, v89, v89
    v_lshlrev_b32 v89, 16, v14
    v_sqrt_f32 v89, v89
    s_nop 0
    v_cvt_pk_bf16_f32 v14, v89, v89
    v_lshlrev_b32 v89, 16, v14
    v_rcp_f32 v89, v89
    v_lshlrev_b32 v90, 16, v96
    v_and_b32 v91, 0xffff0000, v96
    v_sub_f32 v90, v90, v88
    v_sub_f32 v91, v91, v88
    v_cvt_pk_bf16_f32 v96, v90, v91
    v_lshlrev_b32 v90, 16, v96
    v_and_b32 v91, 0xffff0000, v96
    v_mul_f32 v90, v90, v89
    v_mul_f32 v91, v91, v89
    v_cvt_pk_bf16_f32 v96, v90, v91
    v_lshlrev_b32 v90, 16, v97
    v_and_b32 v91, 0xffff0000, v97
    v_sub_f32 v90, v90, v88
    v_sub_f32 v91, v91, v88
    v_cvt_pk_bf16_f32 v97, v90, v91
    v_lshlrev_b32 v90, 16, v97
    v_and_b32 v91, 0xffff0000, v97
    v_mul_f32 v90, v90, v89
    v_mul_f32 v91, v91, v89
    v_cvt_pk_bf16_f32 v97, v90, v91
    v_lshlrev_b32 v90, 16, v98
    v_and_b32 v91, 0xffff0000, v98
    v_sub_f32 v90, v90, v88
    v_sub_f32 v91, v91, v88
    v_cvt_pk_bf16_f32 v98, v90, v91
    v_lshlrev_b32 v90, 16, v98
    v_and_b32 v91, 0xffff0000, v98
    v_mul_f32 v90, v90, v89
    v_mul_f32 v91, v91, v89
    v_cvt_pk_bf16_f32 v98, v90, v91
    v_lshlrev_b32 v90, 16, v99
    v_and_b32 v91, 0xffff0000, v99
    v_sub_f32 v90, v90, v88
    v_sub_f32 v91, v91, v88
    v_cvt_pk_bf16_f32 v99, v90, v91
    v_lshlrev_b32 v90, 16, v99
    v_and_b32 v91, 0xffff0000, v99
    v_mul_f32 v90, v90, v89
    v_mul_f32 v91, v91, v89
    v_cvt_pk_bf16_f32 v99, v90, v91
    ds_write_b128 v4, v[96:99] offset:0
    v_lshlrev_b32 v90, 16, v100
    v_and_b32 v91, 0xffff0000, v100
    v_sub_f32 v90, v90, v88
    v_sub_f32 v91, v91, v88
    v_cvt_pk_bf16_f32 v100, v90, v91
    v_lshlrev_b32 v90, 16, v100
    v_and_b32 v91, 0xffff0000, v100
    v_mul_f32 v90, v90, v89
    v_mul_f32 v91, v91, v89
    v_cvt_pk_bf16_f32 v100, v90, v91
    v_lshlrev_b32 v90, 16, v101
    v_and_b32 v91, 0xffff0000, v101
    v_sub_f32 v90, v90, v88
    v_sub_f32 v91, v91, v88
    v_cvt_pk_bf16_f32 v101, v90, v91
    v_lshlrev_b32 v90, 16, v101
    v_and_b32 v91, 0xffff0000, v101
    v_mul_f32 v90, v90, v89
    v_mul_f32 v91, v91, v89
    v_cvt_pk_bf16_f32 v101, v90, v91
    v_lshlrev_b32 v90, 16, v102
    v_and_b32 v91, 0xffff0000, v102
    v_sub_f32 v90, v90, v88
    v_sub_f32 v91, v91, v88
    v_cvt_pk_bf16_f32 v102, v90, v91
    v_lshlrev_b32 v90, 16, v102
    v_and_b32 v91, 0xffff0000, v102
    v_mul_f32 v90, v90, v89
    v_mul_f32 v91, v91, v89
    v_cvt_pk_bf16_f32 v102, v90, v91
    v_lshlrev_b32 v90, 16, v103
    v_and_b32 v91, 0xffff0000, v103
    v_sub_f32 v90, v90, v88
    v_sub_f32 v91, v91, v88
    v_cvt_pk_bf16_f32 v103, v90, v91
    v_lshlrev_b32 v90, 16, v103
    v_and_b32 v91, 0xffff0000, v103
    v_mul_f32 v90, v90, v89
    v_mul_f32 v91, v91, v89
    v_cvt_pk_bf16_f32 v103, v90, v91
    ds_write_b128 v4, v[100:103] offset:2048
    v_lshlrev_b32 v90, 16, v104
    v_and_b32 v91, 0xffff0000, v104
    v_sub_f32 v90, v90, v88
    v_sub_f32 v91, v91, v88
    v_cvt_pk_bf16_f32 v104, v90, v91
    v_lshlrev_b32 v90, 16, v104
    v_and_b32 v91, 0xffff0000, v104
    v_mul_f32 v90, v90, v89
    v_mul_f32 v91, v91, v89
    v_cvt_pk_bf16_f32 v104, v90, v91
    v_lshlrev_b32 v90, 16, v105
    v_and_b32 v91, 0xffff0000, v105
    v_sub_f32 v90, v90, v88
    v_sub_f32 v91, v91, v88
    v_cvt_pk_bf16_f32 v105, v90, v91
    v_lshlrev_b32 v90, 16, v105
    v_and_b32 v91, 0xffff0000, v105
    v_mul_f32 v90, v90, v89
    v_mul_f32 v91, v91, v89
    v_cvt_pk_bf16_f32 v105, v90, v91
    v_lshlrev_b32 v90, 16, v106
    v_and_b32 v91, 0xffff0000, v106
    v_sub_f32 v90, v90, v88
    v_sub_f32 v91, v91, v88
    v_cvt_pk_bf16_f32 v106, v90, v91
    v_lshlrev_b32 v90, 16, v106
    v_and_b32 v91, 0xffff0000, v106
    v_mul_f32 v90, v90, v89
    v_mul_f32 v91, v91, v89
    v_cvt_pk_bf16_f32 v106, v90, v91
    v_lshlrev_b32 v90, 16, v107
    v_and_b32 v91, 0xffff0000, v107
    v_sub_f32 v90, v90, v88
    v_sub_f32 v91, v91, v88
    v_cvt_pk_bf16_f32 v107, v90, v91
    v_lshlrev_b32 v90, 16, v107
    v_and_b32 v91, 0xffff0000, v107
    v_mul_f32 v90, v90, v89
    v_mul_f32 v91, v91, v89
    v_cvt_pk_bf16_f32 v107, v90, v91
    ds_write_b128 v4, v[104:107] offset:4096
    v_lshlrev_b32 v90, 16, v108
    v_and_b32 v91, 0xffff0000, v108
    v_sub_f32 v90, v90, v88
    v_sub_f32 v91, v91, v88
    v_cvt_pk_bf16_f32 v108, v90, v91
    v_lshlrev_b32 v90, 16, v108
    v_and_b32 v91, 0xffff0000, v108
    v_mul_f32 v90, v90, v89
    v_mul_f32 v91, v91, v89
    v_cvt_pk_bf16_f32 v108, v90, v91
    v_lshlrev_b32 v90, 16, v109
    v_and_b32 v91, 0xffff0000, v109
    v_sub_f32 v90, v90, v88
    v_sub_f32 v91, v91, v88
    v_cvt_pk_bf16_f32 v109, v90, v91
    v_lshlrev_b32 v90, 16, v109
    v_and_b32 v91, 0xffff0000, v109
    v_mul_f32 v90, v90, v89
    v_mul_f32 v91, v91, v89
    v_cvt_pk_bf16_f32 v109, v90, v91
    v_lshlrev_b32 v90, 16, v110
    v_and_b32 v91, 0xffff0000, v110
    v_sub_f32 v90, v90, v88
    v_sub_f32 v91, v91, v88
    v_cvt_pk_bf16_f32 v110, v90, v91
    v_lshlrev_b32 v90, 16, v110
    v_and_b32 v91, 0xffff0000, v110
    v_mul_f32 v90, v90, v89
    v_mul_f32 v91, v91, v89
    v_cvt_pk_bf16_f32 v110, v90, v91
    v_lshlrev_b32 v90, 16, v111
    v_and_b32 v91, 0xffff0000, v111
    v_sub_f32 v90, v90, v88
    v_sub_f32 v91, v91, v88
    v_cvt_pk_bf16_f32 v111, v90, v91
    v_lshlrev_b32 v90, 16, v111
    v_and_b32 v91, 0xffff0000, v111
    v_mul_f32 v90, v90, v89
    v_mul_f32 v91, v91, v89
    v_cvt_pk_bf16_f32 v111, v90, v91
    ds_write_b128 v4, v[108:111] offset:6144
    v_lshlrev_b32 v90, 16, v112
    v_and_b32 v91, 0xffff0000, v112
    v_sub_f32 v90, v90, v88
    v_sub_f32 v91, v91, v88
    v_cvt_pk_bf16_f32 v112, v90, v91
    v_lshlrev_b32 v90, 16, v112
    v_and_b32 v91, 0xffff0000, v112
    v_mul_f32 v90, v90, v89
    v_mul_f32 v91, v91, v89
    v_cvt_pk_bf16_f32 v112, v90, v91
    v_lshlrev_b32 v90, 16, v113
    v_and_b32 v91, 0xffff0000, v113
    v_sub_f32 v90, v90, v88
    v_sub_f32 v91, v91, v88
    v_cvt_pk_bf16_f32 v113, v90, v91
    v_lshlrev_b32 v90, 16, v113
    v_and_b32 v91, 0xffff0000, v113
    v_mul_f32 v90, v90, v89
    v_mul_f32 v91, v91, v89
    v_cvt_pk_bf16_f32 v113, v90, v91
    v_lshlrev_b32 v90, 16, v114
    v_and_b32 v91, 0xffff0000, v114
    v_sub_f32 v90, v90, v88
    v_sub_f32 v91, v91, v88
    v_cvt_pk_bf16_f32 v114, v90, v91
    v_lshlrev_b32 v90, 16, v114
    v_and_b32 v91, 0xffff0000, v114
    v_mul_f32 v90, v90, v89
    v_mul_f32 v91, v91, v89
    v_cvt_pk_bf16_f32 v114, v90, v91
    v_lshlrev_b32 v90, 16, v115
    v_and_b32 v91, 0xffff0000, v115
    v_sub_f32 v90, v90, v88
    v_sub_f32 v91, v91, v88
    v_cvt_pk_bf16_f32 v115, v90, v91
    v_lshlrev_b32 v90, 16, v115
    v_and_b32 v91, 0xffff0000, v115
    v_mul_f32 v90, v90, v89
    v_mul_f32 v91, v91, v89
    v_cvt_pk_bf16_f32 v115, v90, v91
    ds_write_b128 v4, v[112:115] offset:8192
    v_lshlrev_b32 v90, 16, v116
    v_and_b32 v91, 0xffff0000, v116
    v_sub_f32 v90, v90, v88
    v_sub_f32 v91, v91, v88
    v_cvt_pk_bf16_f32 v116, v90, v91
    v_lshlrev_b32 v90, 16, v116
    v_and_b32 v91, 0xffff0000, v116
    v_mul_f32 v90, v90, v89
    v_mul_f32 v91, v91, v89
    v_cvt_pk_bf16_f32 v116, v90, v91
    v_lshlrev_b32 v90, 16, v117
    v_and_b32 v91, 0xffff0000, v117
    v_sub_f32 v90, v90, v88
    v_sub_f32 v91, v91, v88
    v_cvt_pk_bf16_f32 v117, v90, v91
    v_lshlrev_b32 v90, 16, v117
    v_and_b32 v91, 0xffff0000, v117
    v_mul_f32 v90, v90, v89
    v_mul_f32 v91, v91, v89
    v_cvt_pk_bf16_f32 v117, v90, v91
    v_lshlrev_b32 v90, 16, v118
    v_and_b32 v91, 0xffff0000, v118
    v_sub_f32 v90, v90, v88
    v_sub_f32 v91, v91, v88
    v_cvt_pk_bf16_f32 v118, v90, v91
    v_lshlrev_b32 v90, 16, v118
    v_and_b32 v91, 0xffff0000, v118
    v_mul_f32 v90, v90, v89
    v_mul_f32 v91, v91, v89
    v_cvt_pk_bf16_f32 v118, v90, v91
    v_lshlrev_b32 v90, 16, v119
    v_and_b32 v91, 0xffff0000, v119
    v_sub_f32 v90, v90, v88
    v_sub_f32 v91, v91, v88
    v_cvt_pk_bf16_f32 v119, v90, v91
    v_lshlrev_b32 v90, 16, v119
    v_and_b32 v91, 0xffff0000, v119
    v_mul_f32 v90, v90, v89
    v_mul_f32 v91, v91, v89
    v_cvt_pk_bf16_f32 v119, v90, v91
    ds_write_b128 v4, v[116:119] offset:10240
    v_lshlrev_b32 v90, 16, v120
    v_and_b32 v91, 0xffff0000, v120
    v_sub_f32 v90, v90, v88
    v_sub_f32 v91, v91, v88
    v_cvt_pk_bf16_f32 v120, v90, v91
    v_lshlrev_b32 v90, 16, v120
    v_and_b32 v91, 0xffff0000, v120
    v_mul_f32 v90, v90, v89
    v_mul_f32 v91, v91, v89
    v_cvt_pk_bf16_f32 v120, v90, v91
    v_lshlrev_b32 v90, 16, v121
    v_and_b32 v91, 0xffff0000, v121
    v_sub_f32 v90, v90, v88
    v_sub_f32 v91, v91, v88
    v_cvt_pk_bf16_f32 v121, v90, v91
    v_lshlrev_b32 v90, 16, v121
    v_and_b32 v91, 0xffff0000, v121
    v_mul_f32 v90, v90, v89
    v_mul_f32 v91, v91, v89
    v_cvt_pk_bf16_f32 v121, v90, v91
    v_lshlrev_b32 v90, 16, v122
    v_and_b32 v91, 0xffff0000, v122
    v_sub_f32 v90, v90, v88
    v_sub_f32 v91, v91, v88
    v_cvt_pk_bf16_f32 v122, v90, v91
    v_lshlrev_b32 v90, 16, v122
    v_and_b32 v91, 0xffff0000, v122
    v_mul_f32 v90, v90, v89
    v_mul_f32 v91, v91, v89
    v_cvt_pk_bf16_f32 v122, v90, v91
    v_lshlrev_b32 v90, 16, v123
    v_and_b32 v91, 0xffff0000, v123
    v_sub_f32 v90, v90, v88
    v_sub_f32 v91, v91, v88
    v_cvt_pk_bf16_f32 v123, v90, v91
    v_lshlrev_b32 v90, 16, v123
    v_and_b32 v91, 0xffff0000, v123
    v_mul_f32 v90, v90, v89
    v_mul_f32 v91, v91, v89
    v_cvt_pk_bf16_f32 v123, v90, v91
    ds_write_b128 v4, v[120:123] offset:12288
    v_lshlrev_b32 v90, 16, v124
    v_and_b32 v91, 0xffff0000, v124
    v_sub_f32 v90, v90, v88
    v_sub_f32 v91, v91, v88
    v_cvt_pk_bf16_f32 v124, v90, v91
    v_lshlrev_b32 v90, 16, v124
    v_and_b32 v91, 0xffff0000, v124
    v_mul_f32 v90, v90, v89
    v_mul_f32 v91, v91, v89
    v_cvt_pk_bf16_f32 v124, v90, v91
    v_lshlrev_b32 v90, 16, v125
    v_and_b32 v91, 0xffff0000, v125
    v_sub_f32 v90, v90, v88
    v_sub_f32 v91, v91, v88
    v_cvt_pk_bf16_f32 v125, v90, v91
    v_lshlrev_b32 v90, 16, v125
    v_and_b32 v91, 0xffff0000, v125
    v_mul_f32 v90, v90, v89
    v_mul_f32 v91, v91, v89
    v_cvt_pk_bf16_f32 v125, v90, v91
    v_lshlrev_b32 v90, 16, v126
    v_and_b32 v91, 0xffff0000, v126
    v_sub_f32 v90, v90, v88
    v_sub_f32 v91, v91, v88
    v_cvt_pk_bf16_f32 v126, v90, v91
    v_lshlrev_b32 v90, 16, v126
    v_and_b32 v91, 0xffff0000, v126
    v_mul_f32 v90, v90, v89
    v_mul_f32 v91, v91, v89
    v_cvt_pk_bf16_f32 v126, v90, v91
    v_lshlrev_b32 v90, 16, v127
    v_and_b32 v91, 0xffff0000, v127
    v_sub_f32 v90, v90, v88
    v_sub_f32 v91, v91, v88
    v_cvt_pk_bf16_f32 v127, v90, v91
    v_lshlrev_b32 v90, 16, v127
    v_and_b32 v91, 0xffff0000, v127
    v_mul_f32 v90, v90, v89
    v_mul_f32 v91, v91, v89
    v_cvt_pk_bf16_f32 v127, v90, v91
    ds_write_b128 v4, v[124:127] offset:14336
    s_lshr_b32 s36, s21, 1
    s_lshl_b32 s36, s36, 14
    s_xor_b32 s37, s36, 16384
    v_add_u32 v80, s36, v5
    v_add_u32 v81, s37, v5
    v_add_u32 v82, s36, v6
    v_add_u32 v83, s37, v6
    s_mov_b32 s31, 0
    s_waitcnt vmcnt(24)
    s_barrier
    ds_read_b64_tr_b16 a[128:129], v20 offset:0
    ds_read_b64_tr_b16 a[130:131], v20 offset:1024
    ds_read_b64_tr_b16 a[132:133], v21 offset:0
    ds_read_b64_tr_b16 a[134:135], v21 offset:1024
    ds_read_b64_tr_b16 a[136:137], v22 offset:0
    ds_read_b64_tr_b16 a[138:139], v22 offset:1024
    ds_read_b64_tr_b16 a[140:141], v23 offset:0
    ds_read_b64_tr_b16 a[142:143], v23 offset:1024
    ds_read_b64_tr_b16 a[144:145], v24 offset:0
    ds_read_b64_tr_b16 a[146:147], v24 offset:1024
    ds_read_b64_tr_b16 a[148:149], v25 offset:0
    ds_read_b64_tr_b16 a[150:151], v25 offset:1024
    s_waitcnt lgkmcnt(4)
    ds_read_b64_tr_b16 a[152:153], v26 offset:0
    ds_read_b64_tr_b16 a[154:155], v26 offset:1024
    ds_read_b64_tr_b16 a[156:157], v27 offset:0
    ds_read_b64_tr_b16 a[158:159], v27 offset:1024
    s_waitcnt lgkmcnt(0)
    s_barrier
    s_mov_b32 s96, s48
    s_and_b32 s97, s49, 0xffff
    s_mov_b32 s98, 0x400000
    s_mov_b32 s99, 0x20000
    s_add_u32 m0, s28, 0
    s_add_u32 s37, s3, 0x0
    buffer_load_dwordx4 v16, s[96:99], s37 offen lds
    s_add_u32 m0, s28, 1024
    s_add_u32 s37, s3, 0x8000
    buffer_load_dwordx4 v17, s[96:99], s37 offen lds
    s_add_u32 m0, s28, 2048
    s_add_u32 s37, s3, 0x10000
    buffer_load_dwordx4 v18, s[96:99], s37 offen lds
    s_add_u32 m0, s28, 3072
    s_add_u32 s37, s3, 0x18000
    buffer_load_dwordx4 v19, s[96:99], s37 offen lds
    s_add_u32 m0, s28, 4096
    s_add_u32 s37, s3, 0x20000
    buffer_load_dwordx4 v16, s[96:99], s37 offen lds
    s_add_u32 m0, s28, 5120
    s_add_u32 s37, s3, 0x28000
    buffer_load_dwordx4 v17, s[96:99], s37 offen lds
    s_add_u32 m0, s28, 6144
    s_add_u32 s37, s3, 0x30000
    buffer_load_dwordx4 v18, s[96:99], s37 offen lds
    s_add_u32 m0, s28, 7168
    s_add_u32 s37, s3, 0x38000
    buffer_load_dwordx4 v19, s[96:99], s37 offen lds
    s_waitcnt vmcnt(24)
    s_barrier
    ds_read_b64_tr_b16 a[160:161], v20 offset:8192
    ds_read_b64_tr_b16 a[162:163], v20 offset:9216
    ds_read_b64_tr_b16 a[164:165], v21 offset:8192
    ds_read_b64_tr_b16 a[166:167], v21 offset:9216
    ds_read_b64_tr_b16 a[168:169], v22 offset:8192
    ds_read_b64_tr_b16 a[170:171], v22 offset:9216
    ds_read_b64_tr_b16 a[172:173], v23 offset:8192
    ds_read_b64_tr_b16 a[174:175], v23 offset:9216
    ds_read_b64_tr_b16 a[176:177], v24 offset:8192
    ds_read_b64_tr_b16 a[178:179], v24 offset:9216
    ds_read_b64_tr_b16 a[180:181], v25 offset:8192
    ds_read_b64_tr_b16 a[182:183], v25 offset:9216
    s_waitcnt lgkmcnt(4)
    ds_read_b64_tr_b16 a[184:185], v26 offset:8192
    ds_read_b64_tr_b16 a[186:187], v26 offset:9216
    ds_read_b64_tr_b16 a[188:189], v27 offset:8192
    ds_read_b64_tr_b16 a[190:191], v27 offset:9216
    s_waitcnt lgkmcnt(0)
    s_barrier
    s_add_u32 m0, s28, 8192
    s_add_u32 s37, s3, 0x100000
    buffer_load_dwordx4 v16, s[96:99], s37 offen lds
    s_add_u32 m0, s28, 9216
    s_add_u32 s37, s3, 0x108000
    buffer_load_dwordx4 v17, s[96:99], s37 offen lds
    s_add_u32 m0, s28, 10240
    s_add_u32 s37, s3, 0x110000
    buffer_load_dwordx4 v18, s[96:99], s37 offen lds
    s_add_u32 m0, s28, 11264
    s_add_u32 s37, s3, 0x118000
    buffer_load_dwordx4 v19, s[96:99], s37 offen lds
    s_add_u32 m0, s28, 12288
    s_add_u32 s37, s3, 0x120000
    buffer_load_dwordx4 v16, s[96:99], s37 offen lds
    s_add_u32 m0, s28, 13312
    s_add_u32 s37, s3, 0x128000
    buffer_load_dwordx4 v17, s[96:99], s37 offen lds
    s_add_u32 m0, s28, 14336
    s_add_u32 s37, s3, 0x130000
    buffer_load_dwordx4 v18, s[96:99], s37 offen lds
    s_add_u32 m0, s28, 15360
    s_add_u32 s37, s3, 0x138000
    buffer_load_dwordx4 v19, s[96:99], s37 offen lds
    s_waitcnt vmcnt(24)
    s_barrier
    ds_read_b64_tr_b16 a[192:193], v20 offset:16384
    ds_read_b64_tr_b16 a[194:195], v20 offset:17408
    ds_read_b64_tr_b16 a[196:197], v21 offset:16384
    ds_read_b64_tr_b16 a[198:199], v21 offset:17408
    ds_read_b64_tr_b16 a[200:201], v22 offset:16384
    ds_read_b64_tr_b16 a[202:203], v22 offset:17408
    ds_read_b64_tr_b16 a[204:205], v23 offset:16384
    ds_read_b64_tr_b16 a[206:207], v23 offset:17408
    ds_read_b64_tr_b16 a[208:209], v24 offset:16384
    ds_read_b64_tr_b16 a[210:211], v24 offset:17408
    ds_read_b64_tr_b16 a[212:213], v25 offset:16384
    ds_read_b64_tr_b16 a[214:215], v25 offset:17408
    s_waitcnt lgkmcnt(4)
    ds_read_b64_tr_b16 a[216:217], v26 offset:16384
    ds_read_b64_tr_b16 a[218:219], v26 offset:17408
    ds_read_b64_tr_b16 a[220:221], v27 offset:16384
    ds_read_b64_tr_b16 a[222:223], v27 offset:17408
    s_waitcnt lgkmcnt(0)
    s_barrier
    s_add_u32 m0, s28, 16384
    s_add_u32 s37, s3, 0x200000
    buffer_load_dwordx4 v16, s[96:99], s37 offen lds
    s_add_u32 m0, s28, 17408
    s_add_u32 s37, s3, 0x208000
    buffer_load_dwordx4 v17, s[96:99], s37 offen lds
    s_add_u32 m0, s28, 18432
    s_add_u32 s37, s3, 0x210000
    buffer_load_dwordx4 v18, s[96:99], s37 offen lds
    s_add_u32 m0, s28, 19456
    s_add_u32 s37, s3, 0x218000
    buffer_load_dwordx4 v19, s[96:99], s37 offen lds
    s_add_u32 m0, s28, 20480
    s_add_u32 s37, s3, 0x220000
    buffer_load_dwordx4 v16, s[96:99], s37 offen lds
    s_add_u32 m0, s28, 21504
    s_add_u32 s37, s3, 0x228000
    buffer_load_dwordx4 v17, s[96:99], s37 offen lds
    s_add_u32 m0, s28, 22528
    s_add_u32 s37, s3, 0x230000
    buffer_load_dwordx4 v18, s[96:99], s37 offen lds
    s_add_u32 m0, s28, 23552
    s_add_u32 s37, s3, 0x238000
    buffer_load_dwordx4 v19, s[96:99], s37 offen lds
    s_waitcnt vmcnt(24)
    s_barrier
    ds_read_b64_tr_b16 a[224:225], v20 offset:24576
    ds_read_b64_tr_b16 a[226:227], v20 offset:25600
    ds_read_b64_tr_b16 a[228:229], v21 offset:24576
    ds_read_b64_tr_b16 a[230:231], v21 offset:25600
    ds_read_b64_tr_b16 a[232:233], v22 offset:24576
    ds_read_b64_tr_b16 a[234:235], v22 offset:25600
    ds_read_b64_tr_b16 a[236:237], v23 offset:24576
    ds_read_b64_tr_b16 a[238:239], v23 offset:25600
    ds_read_b64_tr_b16 a[240:241], v24 offset:24576
    ds_read_b64_tr_b16 a[242:243], v24 offset:25600
    ds_read_b64_tr_b16 a[244:245], v25 offset:24576
    ds_read_b64_tr_b16 a[246:247], v25 offset:25600
    s_waitcnt lgkmcnt(4)
    ds_read_b64_tr_b16 a[248:249], v26 offset:24576
    ds_read_b64_tr_b16 a[250:251], v26 offset:25600
    ds_read_b64_tr_b16 a[252:253], v27 offset:24576
    ds_read_b64_tr_b16 a[254:255], v27 offset:25600
    s_waitcnt lgkmcnt(0)
    s_barrier
    s_add_u32 m0, s28, 24576
    s_add_u32 s37, s3, 0x300000
    buffer_load_dwordx4 v16, s[96:99], s37 offen lds
    s_add_u32 m0, s28, 25600
    s_add_u32 s37, s3, 0x308000
    buffer_load_dwordx4 v17, s[96:99], s37 offen lds
    s_add_u32 m0, s28, 26624
    s_add_u32 s37, s3, 0x310000
    buffer_load_dwordx4 v18, s[96:99], s37 offen lds
    s_add_u32 m0, s28, 27648
    s_add_u32 s37, s3, 0x318000
    buffer_load_dwordx4 v19, s[96:99], s37 offen lds
    s_add_u32 m0, s28, 28672
    s_add_u32 s37, s3, 0x320000
    buffer_load_dwordx4 v16, s[96:99], s37 offen lds
    s_add_u32 m0, s28, 29696
    s_add_u32 s37, s3, 0x328000
    buffer_load_dwordx4 v17, s[96:99], s37 offen lds
    s_add_u32 m0, s28, 30720
    s_add_u32 s37, s3, 0x330000
    buffer_load_dwordx4 v18, s[96:99], s37 offen lds
    s_add_u32 m0, s28, 31744
    s_add_u32 s37, s3, 0x338000
    buffer_load_dwordx4 v19, s[96:99], s37 offen lds
    ds_read_b128 v[64:67], v80 offset:0
    ds_read_b128 v[68:71], v81 offset:0
    ds_read_b128 v[72:75], v82 offset:1024
    ds_read_b128 v[76:79], v83 offset:1024
    s_waitcnt lgkmcnt(2)
    v_mfma_f32_16x16x32_bf16 v[32:35], a[128:131], v[64:67], 0
    v_mfma_f32_16x16x32_bf16 v[36:39], a[128:131], v[68:71], 0
    v_mfma_f32_16x16x32_bf16 v[40:43], a[132:135], v[64:67], 0
    v_mfma_f32_16x16x32_bf16 v[44:47], a[132:135], v[68:71], 0
    v_mfma_f32_16x16x32_bf16 v[48:51], v[64:67], v[128:131], 0
    v_mfma_f32_16x16x32_bf16 v[56:59], v[68:71], v[128:131], 0
    v_mfma_f32_16x16x32_bf16 v[52:55], v[64:67], v[132:135], 0
    v_mfma_f32_16x16x32_bf16 v[60:63], v[68:71], v[132:135], 0
    ds_read_b128 v[64:67], v80 offset:2048
    ds_read_b128 v[68:71], v81 offset:2048
    s_waitcnt lgkmcnt(2)
    v_mfma_f32_16x16x32_bf16 v[32:35], a[136:139], v[72:75], v[32:35]
    v_mfma_f32_16x16x32_bf16 v[36:39], a[136:139], v[76:79], v[36:39]
    v_mfma_f32_16x16x32_bf16 v[40:43], a[140:143], v[72:75], v[40:43]
    v_mfma_f32_16x16x32_bf16 v[44:47], a[140:143], v[76:79], v[44:47]
    v_mfma_f32_16x16x32_bf16 v[48:51], v[72:75], v[136:139], v[48:51]
    v_mfma_f32_16x16x32_bf16 v[56:59], v[76:79], v[136:139], v[56:59]
    v_mfma_f32_16x16x32_bf16 v[52:55], v[72:75], v[140:143], v[52:55]
    v_mfma_f32_16x16x32_bf16 v[60:63], v[76:79], v[140:143], v[60:63]
    ds_read_b128 v[72:75], v82 offset:3072
    ds_read_b128 v[76:79], v83 offset:3072
    s_waitcnt lgkmcnt(2)
    v_mfma_f32_16x16x32_bf16 v[32:35], a[144:147], v[64:67], v[32:35]
    v_mfma_f32_16x16x32_bf16 v[36:39], a[144:147], v[68:71], v[36:39]
    v_mfma_f32_16x16x32_bf16 v[40:43], a[148:151], v[64:67], v[40:43]
    v_mfma_f32_16x16x32_bf16 v[44:47], a[148:151], v[68:71], v[44:47]
    v_mfma_f32_16x16x32_bf16 v[48:51], v[64:67], v[144:147], v[48:51]
    v_mfma_f32_16x16x32_bf16 v[56:59], v[68:71], v[144:147], v[56:59]
    v_mfma_f32_16x16x32_bf16 v[52:55], v[64:67], v[148:151], v[52:55]
    v_mfma_f32_16x16x32_bf16 v[60:63], v[68:71], v[148:151], v[60:63]
    ds_read_b128 v[64:67], v80 offset:4096
    ds_read_b128 v[68:71], v81 offset:4096
    s_waitcnt lgkmcnt(2)
    v_mfma_f32_16x16x32_bf16 v[32:35], a[152:155], v[72:75], v[32:35]
    v_mfma_f32_16x16x32_bf16 v[36:39], a[152:155], v[76:79], v[36:39]
    v_mfma_f32_16x16x32_bf16 v[40:43], a[156:159], v[72:75], v[40:43]
    v_mfma_f32_16x16x32_bf16 v[44:47], a[156:159], v[76:79], v[44:47]
    v_mfma_f32_16x16x32_bf16 v[48:51], v[72:75], v[152:155], v[48:51]
    v_mfma_f32_16x16x32_bf16 v[56:59], v[76:79], v[152:155], v[56:59]
    v_mfma_f32_16x16x32_bf16 v[52:55], v[72:75], v[156:159], v[52:55]
    v_mfma_f32_16x16x32_bf16 v[60:63], v[76:79], v[156:159], v[60:63]
    ds_read_b128 v[72:75], v82 offset:5120
    ds_read_b128 v[76:79], v83 offset:5120
    s_waitcnt lgkmcnt(2)
    v_mfma_f32_16x16x32_bf16 v[32:35], a[160:163], v[64:67], v[32:35]
    v_mfma_f32_16x16x32_bf16 v[36:39], a[160:163], v[68:71], v[36:39]
    v_mfma_f32_16x16x32_bf16 v[40:43], a[164:167], v[64:67], v[40:43]
    v_mfma_f32_16x16x32_bf16 v[44:47], a[164:167], v[68:71], v[44:47]
    v_mfma_f32_16x16x32_bf16 v[48:51], v[64:67], v[160:163], v[48:51]
    v_mfma_f32_16x16x32_bf16 v[56:59], v[68:71], v[160:163], v[56:59]
    v_mfma_f32_16x16x32_bf16 v[52:55], v[64:67], v[164:167], v[52:55]
    v_mfma_f32_16x16x32_bf16 v[60:63], v[68:71], v[164:167], v[60:63]
    ds_read_b128 v[64:67], v80 offset:6144
    ds_read_b128 v[68:71], v81 offset:6144
    s_waitcnt lgkmcnt(2)
    v_mfma_f32_16x16x32_bf16 v[32:35], a[168:171], v[72:75], v[32:35]
    v_mfma_f32_16x16x32_bf16 v[36:39], a[168:171], v[76:79], v[36:39]
    v_mfma_f32_16x16x32_bf16 v[40:43], a[172:175], v[72:75], v[40:43]
    v_mfma_f32_16x16x32_bf16 v[44:47], a[172:175], v[76:79], v[44:47]
    v_mfma_f32_16x16x32_bf16 v[48:51], v[72:75], v[168:171], v[48:51]
    v_mfma_f32_16x16x32_bf16 v[56:59], v[76:79], v[168:171], v[56:59]
    v_mfma_f32_16x16x32_bf16 v[52:55], v[72:75], v[172:175], v[52:55]
    v_mfma_f32_16x16x32_bf16 v[60:63], v[76:79], v[172:175], v[60:63]
    ds_read_b128 v[72:75], v82 offset:7168
    ds_read_b128 v[76:79], v83 offset:7168
    s_waitcnt lgkmcnt(2)
    v_mfma_f32_16x16x32_bf16 v[32:35], a[176:179], v[64:67], v[32:35]
    v_mfma_f32_16x16x32_bf16 v[36:39], a[176:179], v[68:71], v[36:39]
    v_mfma_f32_16x16x32_bf16 v[40:43], a[180:183], v[64:67], v[40:43]
    v_mfma_f32_16x16x32_bf16 v[44:47], a[180:183], v[68:71], v[44:47]
    v_mfma_f32_16x16x32_bf16 v[48:51], v[64:67], v[176:179], v[48:51]
    v_mfma_f32_16x16x32_bf16 v[56:59], v[68:71], v[176:179], v[56:59]
    v_mfma_f32_16x16x32_bf16 v[52:55], v[64:67], v[180:183], v[52:55]
    v_mfma_f32_16x16x32_bf16 v[60:63], v[68:71], v[180:183], v[60:63]
    ds_read_b128 v[64:67], v80 offset:8192
    ds_read_b128 v[68:71], v81 offset:8192
    s_waitcnt lgkmcnt(2)
    v_mfma_f32_16x16x32_bf16 v[32:35], a[184:187], v[72:75], v[32:35]
    v_mfma_f32_16x16x32_bf16 v[36:39], a[184:187], v[76:79], v[36:39]
    v_mfma_f32_16x16x32_bf16 v[40:43], a[188:191], v[72:75], v[40:43]
    v_mfma_f32_16x16x32_bf16 v[44:47], a[188:191], v[76:79], v[44:47]
    v_mfma_f32_16x16x32_bf16 v[48:51], v[72:75], v[184:187], v[48:51]
    v_mfma_f32_16x16x32_bf16 v[56:59], v[76:79], v[184:187], v[56:59]
    v_mfma_f32_16x16x32_bf16 v[52:55], v[72:75], v[188:191], v[52:55]
    v_mfma_f32_16x16x32_bf16 v[60:63], v[76:79], v[188:191], v[60:63]
    ds_read_b128 v[72:75], v82 offset:9216
    ds_read_b128 v[76:79], v83 offset:9216
    s_waitcnt lgkmcnt(2)
    v_mfma_f32_16x16x32_bf16 v[32:35], a[192:195], v[64:67], v[32:35]
    v_mfma_f32_16x16x32_bf16 v[36:39], a[192:195], v[68:71], v[36:39]
    v_mfma_f32_16x16x32_bf16 v[40:43], a[196:199], v[64:67], v[40:43]
    v_mfma_f32_16x16x32_bf16 v[44:47], a[196:199], v[68:71], v[44:47]
    v_mfma_f32_16x16x32_bf16 v[48:51], v[64:67], v[192:195], v[48:51]
    v_mfma_f32_16x16x32_bf16 v[56:59], v[68:71], v[192:195], v[56:59]
    v_mfma_f32_16x16x32_bf16 v[52:55], v[64:67], v[196:199], v[52:55]
    v_mfma_f32_16x16x32_bf16 v[60:63], v[68:71], v[196:199], v[60:63]
    ds_read_b128 v[64:67], v80 offset:10240
    ds_read_b128 v[68:71], v81 offset:10240
    s_waitcnt lgkmcnt(2)
    v_mfma_f32_16x16x32_bf16 v[32:35], a[200:203], v[72:75], v[32:35]
    v_mfma_f32_16x16x32_bf16 v[36:39], a[200:203], v[76:79], v[36:39]
    v_mfma_f32_16x16x32_bf16 v[40:43], a[204:207], v[72:75], v[40:43]
    v_mfma_f32_16x16x32_bf16 v[44:47], a[204:207], v[76:79], v[44:47]
    v_mfma_f32_16x16x32_bf16 v[48:51], v[72:75], v[200:203], v[48:51]
    v_mfma_f32_16x16x32_bf16 v[56:59], v[76:79], v[200:203], v[56:59]
    v_mfma_f32_16x16x32_bf16 v[52:55], v[72:75], v[204:207], v[52:55]
    v_mfma_f32_16x16x32_bf16 v[60:63], v[76:79], v[204:207], v[60:63]
    ds_read_b128 v[72:75], v82 offset:11264
    ds_read_b128 v[76:79], v83 offset:11264
    s_waitcnt lgkmcnt(2)
    v_mfma_f32_16x16x32_bf16 v[32:35], a[208:211], v[64:67], v[32:35]
    v_mfma_f32_16x16x32_bf16 v[36:39], a[208:211], v[68:71], v[36:39]
    v_mfma_f32_16x16x32_bf16 v[40:43], a[212:215], v[64:67], v[40:43]
    v_mfma_f32_16x16x32_bf16 v[44:47], a[212:215], v[68:71], v[44:47]
    v_mfma_f32_16x16x32_bf16 v[48:51], v[64:67], v[208:211], v[48:51]
    v_mfma_f32_16x16x32_bf16 v[56:59], v[68:71], v[208:211], v[56:59]
    v_mfma_f32_16x16x32_bf16 v[52:55], v[64:67], v[212:215], v[52:55]
    v_mfma_f32_16x16x32_bf16 v[60:63], v[68:71], v[212:215], v[60:63]
    ds_read_b128 v[64:67], v80 offset:12288
    ds_read_b128 v[68:71], v81 offset:12288
    s_waitcnt lgkmcnt(2)
    v_mfma_f32_16x16x32_bf16 v[32:35], a[216:219], v[72:75], v[32:35]
    v_mfma_f32_16x16x32_bf16 v[36:39], a[216:219], v[76:79], v[36:39]
    v_mfma_f32_16x16x32_bf16 v[40:43], a[220:223], v[72:75], v[40:43]
    v_mfma_f32_16x16x32_bf16 v[44:47], a[220:223], v[76:79], v[44:47]
    v_mfma_f32_16x16x32_bf16 v[48:51], v[72:75], v[216:219], v[48:51]
    v_mfma_f32_16x16x32_bf16 v[56:59], v[76:79], v[216:219], v[56:59]
    v_mfma_f32_16x16x32_bf16 v[52:55], v[72:75], v[220:223], v[52:55]
    v_mfma_f32_16x16x32_bf16 v[60:63], v[76:79], v[220:223], v[60:63]
    ds_read_b128 v[72:75], v82 offset:13312
    ds_read_b128 v[76:79], v83 offset:13312
    s_waitcnt lgkmcnt(2)
    v_mfma_f32_16x16x32_bf16 v[32:35], a[224:227], v[64:67], v[32:35]
    v_mfma_f32_16x16x32_bf16 v[36:39], a[224:227], v[68:71], v[36:39]
    v_mfma_f32_16x16x32_bf16 v[40:43], a[228:231], v[64:67], v[40:43]
    v_mfma_f32_16x16x32_bf16 v[44:47], a[228:231], v[68:71], v[44:47]
    v_mfma_f32_16x16x32_bf16 v[48:51], v[64:67], v[224:227], v[48:51]
    v_mfma_f32_16x16x32_bf16 v[56:59], v[68:71], v[224:227], v[56:59]
    v_mfma_f32_16x16x32_bf16 v[52:55], v[64:67], v[228:231], v[52:55]
    v_mfma_f32_16x16x32_bf16 v[60:63], v[68:71], v[228:231], v[60:63]
    ds_read_b128 v[64:67], v80 offset:14336
    ds_read_b128 v[68:71], v81 offset:14336
    s_waitcnt lgkmcnt(2)
    v_mfma_f32_16x16x32_bf16 v[32:35], a[232:235], v[72:75], v[32:35]
    v_mfma_f32_16x16x32_bf16 v[36:39], a[232:235], v[76:79], v[36:39]
    v_mfma_f32_16x16x32_bf16 v[40:43], a[236:239], v[72:75], v[40:43]
    v_mfma_f32_16x16x32_bf16 v[44:47], a[236:239], v[76:79], v[44:47]
    v_mfma_f32_16x16x32_bf16 v[48:51], v[72:75], v[232:235], v[48:51]
    v_mfma_f32_16x16x32_bf16 v[56:59], v[76:79], v[232:235], v[56:59]
    v_mfma_f32_16x16x32_bf16 v[52:55], v[72:75], v[236:239], v[52:55]
    v_mfma_f32_16x16x32_bf16 v[60:63], v[76:79], v[236:239], v[60:63]
    ds_read_b128 v[72:75], v82 offset:15360
    ds_read_b128 v[76:79], v83 offset:15360
    s_waitcnt lgkmcnt(2)
    v_mfma_f32_16x16x32_bf16 v[32:35], a[240:243], v[64:67], v[32:35]
    v_mfma_f32_16x16x32_bf16 v[36:39], a[240:243], v[68:71], v[36:39]
    v_mfma_f32_16x16x32_bf16 v[40:43], a[244:247], v[64:67], v[40:43]
    v_mfma_f32_16x16x32_bf16 v[44:47], a[244:247], v[68:71], v[44:47]
    v_mfma_f32_16x16x32_bf16 v[48:51], v[64:67], v[240:243], v[48:51]
    v_mfma_f32_16x16x32_bf16 v[56:59], v[68:71], v[240:243], v[56:59]
    v_mfma_f32_16x16x32_bf16 v[52:55], v[64:67], v[244:247], v[52:55]
    v_mfma_f32_16x16x32_bf16 v[60:63], v[68:71], v[244:247], v[60:63]
    s_waitcnt lgkmcnt(0)
    v_mfma_f32_16x16x32_bf16 v[32:35], a[248:251], v[72:75], v[32:35]
    v_mfma_f32_16x16x32_bf16 v[36:39], a[248:251], v[76:79], v[36:39]
    v_mfma_f32_16x16x32_bf16 v[40:43], a[252:255], v[72:75], v[40:43]
    v_mfma_f32_16x16x32_bf16 v[44:47], a[252:255], v[76:79], v[44:47]
    v_mfma_f32_16x16x32_bf16 v[48:51], v[72:75], v[248:251], v[48:51]
    v_mfma_f32_16x16x32_bf16 v[56:59], v[76:79], v[248:251], v[56:59]
    v_mfma_f32_16x16x32_bf16 v[52:55], v[72:75], v[252:255], v[52:55]
    v_mfma_f32_16x16x32_bf16 v[60:63], v[76:79], v[252:255], v[60:63]
    s_nop 0
    v_mul_f32 v32, s33, v32
    v_mul_f32 v33, s33, v33
    v_mul_f32 v34, s33, v34
    v_mul_f32 v35, s33, v35
    v_mul_f32 v36, s33, v36
    v_mul_f32 v37, s33, v37
    v_mul_f32 v38, s33, v38
    v_mul_f32 v39, s33, v39
    v_mul_f32 v40, s33, v40
    v_mul_f32 v41, s33, v41
    v_mul_f32 v42, s33, v42
    v_mul_f32 v43, s33, v43
    v_mul_f32 v44, s33, v44
    v_mul_f32 v45, s33, v45
    v_mul_f32 v46, s33, v46
    v_mul_f32 v47, s33, v47
    v_cvt_pk_bf16_f32 v88, v32, v40
    v_cvt_pk_bf16_f32 v89, v33, v41
    v_cvt_pk_bf16_f32 v90, v34, v42
    v_cvt_pk_bf16_f32 v91, v35, v43
    v_cvt_pk_bf16_f32 v92, v36, v44
    v_cvt_pk_bf16_f32 v93, v37, v45
    v_cvt_pk_bf16_f32 v94, v38, v46
    v_cvt_pk_bf16_f32 v95, v39, v47
    v_cvt_pk_bf16_f32 v96, v48, v49
    v_cvt_pk_bf16_f32 v97, v50, v51
    v_cvt_pk_bf16_f32 v98, v56, v57
    v_cvt_pk_bf16_f32 v99, v58, v59
    v_cvt_pk_bf16_f32 v100, v52, v53
    v_cvt_pk_bf16_f32 v101, v54, v55
    v_cvt_pk_bf16_f32 v102, v60, v61
    v_cvt_pk_bf16_f32 v103, v62, v63
    s_mul_i32 s24, s23, 0x82100
    s_lshl_b32 s36, s20, 14
    s_add_u32 s24, s24, s36
    s_add_u32 s24, s24, 0x1000000
    s_mov_b32 s30, s24
    s_lshr_b32 s36, s21, 1
    s_lshl_b32 s36, s36, 12
    s_xor_b32 s37, s36, 4096
    s_add_u32 s36, s36, s24
    s_add_u32 s37, s37, s24
    buffer_store_dwordx4 v[88:91], v9, s[8:11], s36 offen sc1
    buffer_store_dwordx4 v[92:95], v9, s[8:11], s37 offen sc1
    s_add_u32 s24, s24, 8192
    buffer_store_dwordx4 v[96:99], v2, s[8:11], s24 offen sc1
    buffer_store_dwordx4 v[100:103], v2, s[8:11], s24 offen offset:1024 sc1
    s_mul_i32 s25, s23, 0x82100
    s_lshl_b32 s36, s20, 2
    s_add_u32 s25, s25, s36
    s_add_u32 s25, s25, 0x1082000
    v_lshrrev_b32 v15, 2, v1
    v_and_b32 v15, 127, v15
L_WHS:
    buffer_load_dword v14, v15, s[16:19], 0 offen sc1
    s_add_u32 s32, s32, 1
    s_cmp_gt_u32 s32, 200000
    s_cbranch_scc1 L_WHS_done
    s_waitcnt vmcnt(0)
    v_cmp_eq_u32 vcc, 0, v14
    s_cbranch_vccnz L_WHS
L_WHS_done:
    s_waitcnt vmcnt(0)
    s_barrier
    v_cmp_ne_u32 vcc, 0, v0
    v_mov_b32 v15, 0x40000000
    v_mov_b32 v14, 1
    v_cndmask_b32 v15, v0, v15, vcc
    buffer_store_dword v14, v15, s[8:11], s25 offen sc1
    s_barrier
    ds_read_b64_tr_b16 a[0:1], v20 offset:0
    ds_read_b64_tr_b16 a[2:3], v20 offset:1024
    ds_read_b64_tr_b16 a[4:5], v21 offset:0
    ds_read_b64_tr_b16 a[6:7], v21 offset:1024
    ds_read_b64_tr_b16 a[8:9], v22 offset:0
    ds_read_b64_tr_b16 a[10:11], v22 offset:1024
    ds_read_b64_tr_b16 a[12:13], v23 offset:0
    ds_read_b64_tr_b16 a[14:15], v23 offset:1024
    ds_read_b64_tr_b16 a[16:17], v24 offset:0
    ds_read_b64_tr_b16 a[18:19], v24 offset:1024
    ds_read_b64_tr_b16 a[20:21], v25 offset:0
    ds_read_b64_tr_b16 a[22:23], v25 offset:1024
    s_waitcnt lgkmcnt(4)
    ds_read_b64_tr_b16 a[24:25], v26 offset:0
    ds_read_b64_tr_b16 a[26:27], v26 offset:1024
    ds_read_b64_tr_b16 a[28:29], v27 offset:0
    ds_read_b64_tr_b16 a[30:31], v27 offset:1024
    s_waitcnt lgkmcnt(0)
    s_barrier
    s_barrier
    ds_read_b64_tr_b16 a[32:33], v20 offset:8192
    ds_read_b64_tr_b16 a[34:35], v20 offset:9216
    ds_read_b64_tr_b16 a[36:37], v21 offset:8192
    ds_read_b64_tr_b16 a[38:39], v21 offset:9216
    ds_read_b64_tr_b16 a[40:41], v22 offset:8192
    ds_read_b64_tr_b16 a[42:43], v22 offset:9216
    ds_read_b64_tr_b16 a[44:45], v23 offset:8192
    ds_read_b64_tr_b16 a[46:47], v23 offset:9216
    ds_read_b64_tr_b16 a[48:49], v24 offset:8192
    ds_read_b64_tr_b16 a[50:51], v24 offset:9216
    ds_read_b64_tr_b16 a[52:53], v25 offset:8192
    ds_read_b64_tr_b16 a[54:55], v25 offset:9216
    s_waitcnt lgkmcnt(4)
    ds_read_b64_tr_b16 a[56:57], v26 offset:8192
    ds_read_b64_tr_b16 a[58:59], v26 offset:9216
    ds_read_b64_tr_b16 a[60:61], v27 offset:8192
    ds_read_b64_tr_b16 a[62:63], v27 offset:9216
    s_waitcnt lgkmcnt(0)
    s_barrier
    s_barrier
    ds_read_b64_tr_b16 a[64:65], v20 offset:16384
    ds_read_b64_tr_b16 a[66:67], v20 offset:17408
    ds_read_b64_tr_b16 a[68:69], v21 offset:16384
    ds_read_b64_tr_b16 a[70:71], v21 offset:17408
    ds_read_b64_tr_b16 a[72:73], v22 offset:16384
    ds_read_b64_tr_b16 a[74:75], v22 offset:17408
    ds_read_b64_tr_b16 a[76:77], v23 offset:16384
    ds_read_b64_tr_b16 a[78:79], v23 offset:17408
    ds_read_b64_tr_b16 a[80:81], v24 offset:16384
    ds_read_b64_tr_b16 a[82:83], v24 offset:17408
    ds_read_b64_tr_b16 a[84:85], v25 offset:16384
    ds_read_b64_tr_b16 a[86:87], v25 offset:17408
    s_waitcnt lgkmcnt(4)
    ds_read_b64_tr_b16 a[88:89], v26 offset:16384
    ds_read_b64_tr_b16 a[90:91], v26 offset:17408
    ds_read_b64_tr_b16 a[92:93], v27 offset:16384
    ds_read_b64_tr_b16 a[94:95], v27 offset:17408
    s_waitcnt lgkmcnt(0)
    s_barrier
    s_barrier
    ds_read_b64_tr_b16 a[96:97], v20 offset:24576
    ds_read_b64_tr_b16 a[98:99], v20 offset:25600
    ds_read_b64_tr_b16 a[100:101], v21 offset:24576
    ds_read_b64_tr_b16 a[102:103], v21 offset:25600
    ds_read_b64_tr_b16 a[104:105], v22 offset:24576
    ds_read_b64_tr_b16 a[106:107], v22 offset:25600
    ds_read_b64_tr_b16 a[108:109], v23 offset:24576
    ds_read_b64_tr_b16 a[110:111], v23 offset:25600
    ds_read_b64_tr_b16 a[112:113], v24 offset:24576
    ds_read_b64_tr_b16 a[114:115], v24 offset:25600
    ds_read_b64_tr_b16 a[116:117], v25 offset:24576
    ds_read_b64_tr_b16 a[118:119], v25 offset:25600
    s_waitcnt lgkmcnt(4)
    ds_read_b64_tr_b16 a[120:121], v26 offset:24576
    ds_read_b64_tr_b16 a[122:123], v26 offset:25600
    ds_read_b64_tr_b16 a[124:125], v27 offset:24576
    ds_read_b64_tr_b16 a[126:127], v27 offset:25600
    s_waitcnt lgkmcnt(0)
    s_barrier
L_P1:
    s_waitcnt vmcnt(6)
    s_barrier
    s_xor_b32 s31, s31, 32768
    s_add_u32 s24, s23, 6
    s_min_u32 s24, s24, 63
    s_lshl_b32 s36, s24, 15
    s_add_u32 s36, s36, 0x800000
    s_lshl_b32 s37, s21, 10
    s_add_u32 s37, s37, s31
    s_add_u32 m0, s37, 0
    s_add_u32 s38, s36, 0
    buffer_load_dwordx4 v9, s[8:11], s38 offen sc1 lds
    s_add_u32 m0, s37, 4096
    s_add_u32 s38, s36, 4096
    buffer_load_dwordx4 v9, s[8:11], s38 offen sc1 lds
    s_add_u32 m0, s37, 8192
    s_add_u32 s38, s36, 8192
    buffer_load_dwordx4 v9, s[8:11], s38 offen sc1 lds
    s_add_u32 m0, s37, 12288
    s_add_u32 s38, s36, 12288
    buffer_load_dwordx4 v9, s[8:11], s38 offen sc1 lds
    s_add_u32 m0, s37, 16384
    s_add_u32 s38, s36, 16384
    buffer_load_dwordx4 v9, s[8:11], s38 offen sc1 lds
    s_add_u32 m0, s37, 20480
    s_add_u32 s38, s36, 20480
    buffer_load_dwordx4 v9, s[8:11], s38 offen sc1 lds
    s_add_u32 m0, s37, 24576
    s_add_u32 s38, s36, 24576
    buffer_load_dwordx4 v9, s[8:11], s38 offen sc1 lds
    s_add_u32 m0, s37, 28672
    s_add_u32 s38, s36, 28672
    buffer_load_dwordx4 v9, s[8:11], s38 offen sc1 lds
    ds_read_b128 v[64:67], v80 offset:0
    ds_read_b128 v[68:71], v81 offset:0
    ds_read_b128 v[72:75], v82 offset:1024
    ds_read_b128 v[76:79], v83 offset:1024
    s_waitcnt lgkmcnt(2)
    v_mfma_f32_16x16x32_bf16 v[32:35], a[128:131], v[64:67], 0
    v_mfma_f32_16x16x32_bf16 v[36:39], a[128:131], v[68:71], 0
    v_mfma_f32_16x16x32_bf16 v[40:43], a[132:135], v[64:67], 0
    v_mfma_f32_16x16x32_bf16 v[44:47], a[132:135], v[68:71], 0
    v_mfma_f32_16x16x32_bf16 v[48:51], v[64:67], v[128:131], 0
    v_mfma_f32_16x16x32_bf16 v[56:59], v[68:71], v[128:131], 0
    v_mfma_f32_16x16x32_bf16 v[52:55], v[64:67], v[132:135], 0
    v_mfma_f32_16x16x32_bf16 v[60:63], v[68:71], v[132:135], 0
    v_mfma_f32_16x16x32_bf16 v[16:19], a[0:3], v[64:67], 0
    v_mfma_f32_16x16x32_bf16 v[20:23], a[0:3], v[68:71], 0
    v_mfma_f32_16x16x32_bf16 v[24:27], a[4:7], v[64:67], 0
    v_mfma_f32_16x16x32_bf16 v[28:31], a[4:7], v[68:71], 0
    ds_read_b128 v[64:67], v80 offset:2048
    ds_read_b128 v[68:71], v81 offset:2048
    s_waitcnt lgkmcnt(2)
    v_mfma_f32_16x16x32_bf16 v[32:35], a[136:139], v[72:75], v[32:35]
    v_mfma_f32_16x16x32_bf16 v[36:39], a[136:139], v[76:79], v[36:39]
    v_mfma_f32_16x16x32_bf16 v[40:43], a[140:143], v[72:75], v[40:43]
    v_mfma_f32_16x16x32_bf16 v[44:47], a[140:143], v[76:79], v[44:47]
    v_mfma_f32_16x16x32_bf16 v[48:51], v[72:75], v[136:139], v[48:51]
    v_mfma_f32_16x16x32_bf16 v[56:59], v[76:79], v[136:139], v[56:59]
    v_mfma_f32_16x16x32_bf16 v[52:55], v[72:75], v[140:143], v[52:55]
    v_mfma_f32_16x16x32_bf16 v[60:63], v[76:79], v[140:143], v[60:63]
    v_mfma_f32_16x16x32_bf16 v[16:19], a[8:11], v[72:75], v[16:19]
    v_mfma_f32_16x16x32_bf16 v[20:23], a[8:11], v[76:79], v[20:23]
    v_mfma_f32_16x16x32_bf16 v[24:27], a[12:15], v[72:75], v[24:27]
    v_mfma_f32_16x16x32_bf16 v[28:31], a[12:15], v[76:79], v[28:31]
    ds_read_b128 v[72:75], v82 offset:3072
    ds_read_b128 v[76:79], v83 offset:3072
    s_waitcnt lgkmcnt(2)
    v_mfma_f32_16x16x32_bf16 v[32:35], a[144:147], v[64:67], v[32:35]
    v_mfma_f32_16x16x32_bf16 v[36:39], a[144:147], v[68:71], v[36:39]
    v_mfma_f32_16x16x32_bf16 v[40:43], a[148:151], v[64:67], v[40:43]
    v_mfma_f32_16x16x32_bf16 v[44:47], a[148:151], v[68:71], v[44:47]
    v_mfma_f32_16x16x32_bf16 v[48:51], v[64:67], v[144:147], v[48:51]
    v_mfma_f32_16x16x32_bf16 v[56:59], v[68:71], v[144:147], v[56:59]
    v_mfma_f32_16x16x32_bf16 v[52:55], v[64:67], v[148:151], v[52:55]
    v_mfma_f32_16x16x32_bf16 v[60:63], v[68:71], v[148:151], v[60:63]
    v_mfma_f32_16x16x32_bf16 v[16:19], a[16:19], v[64:67], v[16:19]
    v_mfma_f32_16x16x32_bf16 v[20:23], a[16:19], v[68:71], v[20:23]
    v_mfma_f32_16x16x32_bf16 v[24:27], a[20:23], v[64:67], v[24:27]
    v_mfma_f32_16x16x32_bf16 v[28:31], a[20:23], v[68:71], v[28:31]
    ds_read_b128 v[64:67], v80 offset:4096
    ds_read_b128 v[68:71], v81 offset:4096
    s_waitcnt lgkmcnt(2)
    v_mfma_f32_16x16x32_bf16 v[32:35], a[152:155], v[72:75], v[32:35]
    v_mfma_f32_16x16x32_bf16 v[36:39], a[152:155], v[76:79], v[36:39]
    v_mfma_f32_16x16x32_bf16 v[40:43], a[156:159], v[72:75], v[40:43]
    v_mfma_f32_16x16x32_bf16 v[44:47], a[156:159], v[76:79], v[44:47]
    v_mfma_f32_16x16x32_bf16 v[48:51], v[72:75], v[152:155], v[48:51]
    v_mfma_f32_16x16x32_bf16 v[56:59], v[76:79], v[152:155], v[56:59]
    v_mfma_f32_16x16x32_bf16 v[52:55], v[72:75], v[156:159], v[52:55]
    v_mfma_f32_16x16x32_bf16 v[60:63], v[76:79], v[156:159], v[60:63]
    v_mfma_f32_16x16x32_bf16 v[16:19], a[24:27], v[72:75], v[16:19]
    v_mfma_f32_16x16x32_bf16 v[20:23], a[24:27], v[76:79], v[20:23]
    v_mfma_f32_16x16x32_bf16 v[24:27], a[28:31], v[72:75], v[24:27]
    v_mfma_f32_16x16x32_bf16 v[28:31], a[28:31], v[76:79], v[28:31]
    ds_read_b128 v[72:75], v82 offset:5120
    ds_read_b128 v[76:79], v83 offset:5120
    s_waitcnt lgkmcnt(2)
    v_mfma_f32_16x16x32_bf16 v[32:35], a[160:163], v[64:67], v[32:35]
    v_mfma_f32_16x16x32_bf16 v[36:39], a[160:163], v[68:71], v[36:39]
    v_mfma_f32_16x16x32_bf16 v[40:43], a[164:167], v[64:67], v[40:43]
    v_mfma_f32_16x16x32_bf16 v[44:47], a[164:167], v[68:71], v[44:47]
    v_mfma_f32_16x16x32_bf16 v[48:51], v[64:67], v[160:163], v[48:51]
    v_mfma_f32_16x16x32_bf16 v[56:59], v[68:71], v[160:163], v[56:59]
    v_mfma_f32_16x16x32_bf16 v[52:55], v[64:67], v[164:167], v[52:55]
    v_mfma_f32_16x16x32_bf16 v[60:63], v[68:71], v[164:167], v[60:63]
    v_mfma_f32_16x16x32_bf16 v[16:19], a[32:35], v[64:67], v[16:19]
    v_mfma_f32_16x16x32_bf16 v[20:23], a[32:35], v[68:71], v[20:23]
    v_mfma_f32_16x16x32_bf16 v[24:27], a[36:39], v[64:67], v[24:27]
    v_mfma_f32_16x16x32_bf16 v[28:31], a[36:39], v[68:71], v[28:31]
    ds_read_b128 v[64:67], v80 offset:6144
    ds_read_b128 v[68:71], v81 offset:6144
    s_waitcnt lgkmcnt(2)
    v_mfma_f32_16x16x32_bf16 v[32:35], a[168:171], v[72:75], v[32:35]
    v_mfma_f32_16x16x32_bf16 v[36:39], a[168:171], v[76:79], v[36:39]
    v_mfma_f32_16x16x32_bf16 v[40:43], a[172:175], v[72:75], v[40:43]
    v_mfma_f32_16x16x32_bf16 v[44:47], a[172:175], v[76:79], v[44:47]
    v_mfma_f32_16x16x32_bf16 v[48:51], v[72:75], v[168:171], v[48:51]
    v_mfma_f32_16x16x32_bf16 v[56:59], v[76:79], v[168:171], v[56:59]
    v_mfma_f32_16x16x32_bf16 v[52:55], v[72:75], v[172:175], v[52:55]
    v_mfma_f32_16x16x32_bf16 v[60:63], v[76:79], v[172:175], v[60:63]
    v_mfma_f32_16x16x32_bf16 v[16:19], a[40:43], v[72:75], v[16:19]
    v_mfma_f32_16x16x32_bf16 v[20:23], a[40:43], v[76:79], v[20:23]
    v_mfma_f32_16x16x32_bf16 v[24:27], a[44:47], v[72:75], v[24:27]
    v_mfma_f32_16x16x32_bf16 v[28:31], a[44:47], v[76:79], v[28:31]
    ds_read_b128 v[72:75], v82 offset:7168
    ds_read_b128 v[76:79], v83 offset:7168
    s_waitcnt lgkmcnt(2)
    s_waitcnt vmcnt(8)
    s_barrier
    v_cmp_ne_u32 vcc, 0, v0
    v_mov_b32 v15, 0x40000000
    v_mov_b32 v14, 1
    v_cndmask_b32 v15, v0, v15, vcc
    buffer_store_dword v14, v15, s[8:11], s25 offen sc1
    v_mfma_f32_16x16x32_bf16 v[32:35], a[176:179], v[64:67], v[32:35]
    v_mfma_f32_16x16x32_bf16 v[36:39], a[176:179], v[68:71], v[36:39]
    v_mfma_f32_16x16x32_bf16 v[40:43], a[180:183], v[64:67], v[40:43]
    v_mfma_f32_16x16x32_bf16 v[44:47], a[180:183], v[68:71], v[44:47]
    v_mfma_f32_16x16x32_bf16 v[48:51], v[64:67], v[176:179], v[48:51]
    v_mfma_f32_16x16x32_bf16 v[56:59], v[68:71], v[176:179], v[56:59]
    v_mfma_f32_16x16x32_bf16 v[52:55], v[64:67], v[180:183], v[52:55]
    v_mfma_f32_16x16x32_bf16 v[60:63], v[68:71], v[180:183], v[60:63]
    v_mfma_f32_16x16x32_bf16 v[16:19], a[48:51], v[64:67], v[16:19]
    v_mfma_f32_16x16x32_bf16 v[20:23], a[48:51], v[68:71], v[20:23]
    v_mfma_f32_16x16x32_bf16 v[24:27], a[52:55], v[64:67], v[24:27]
    v_mfma_f32_16x16x32_bf16 v[28:31], a[52:55], v[68:71], v[28:31]
    ds_read_b128 v[64:67], v80 offset:8192
    ds_read_b128 v[68:71], v81 offset:8192
    s_waitcnt lgkmcnt(2)
    v_mfma_f32_16x16x32_bf16 v[32:35], a[184:187], v[72:75], v[32:35]
    v_mfma_f32_16x16x32_bf16 v[36:39], a[184:187], v[76:79], v[36:39]
    v_mfma_f32_16x16x32_bf16 v[40:43], a[188:191], v[72:75], v[40:43]
    v_mfma_f32_16x16x32_bf16 v[44:47], a[188:191], v[76:79], v[44:47]
    v_mfma_f32_16x16x32_bf16 v[48:51], v[72:75], v[184:187], v[48:51]
    v_mfma_f32_16x16x32_bf16 v[56:59], v[76:79], v[184:187], v[56:59]
    v_mfma_f32_16x16x32_bf16 v[52:55], v[72:75], v[188:191], v[52:55]
    v_mfma_f32_16x16x32_bf16 v[60:63], v[76:79], v[188:191], v[60:63]
    v_mfma_f32_16x16x32_bf16 v[16:19], a[56:59], v[72:75], v[16:19]
    v_mfma_f32_16x16x32_bf16 v[20:23], a[56:59], v[76:79], v[20:23]
    v_mfma_f32_16x16x32_bf16 v[24:27], a[60:63], v[72:75], v[24:27]
    v_mfma_f32_16x16x32_bf16 v[28:31], a[60:63], v[76:79], v[28:31]
    ds_read_b128 v[72:75], v82 offset:9216
    ds_read_b128 v[76:79], v83 offset:9216
    s_waitcnt lgkmcnt(2)
    v_mfma_f32_16x16x32_bf16 v[32:35], a[192:195], v[64:67], v[32:35]
    v_mfma_f32_16x16x32_bf16 v[36:39], a[192:195], v[68:71], v[36:39]
    v_mfma_f32_16x16x32_bf16 v[40:43], a[196:199], v[64:67], v[40:43]
    v_mfma_f32_16x16x32_bf16 v[44:47], a[196:199], v[68:71], v[44:47]
    v_mfma_f32_16x16x32_bf16 v[48:51], v[64:67], v[192:195], v[48:51]
    v_mfma_f32_16x16x32_bf16 v[56:59], v[68:71], v[192:195], v[56:59]
    v_mfma_f32_16x16x32_bf16 v[52:55], v[64:67], v[196:199], v[52:55]
    v_mfma_f32_16x16x32_bf16 v[60:63], v[68:71], v[196:199], v[60:63]
    v_mfma_f32_16x16x32_bf16 v[16:19], a[64:67], v[64:67], v[16:19]
    v_mfma_f32_16x16x32_bf16 v[20:23], a[64:67], v[68:71], v[20:23]
    v_mfma_f32_16x16x32_bf16 v[24:27], a[68:71], v[64:67], v[24:27]
    v_mfma_f32_16x16x32_bf16 v[28:31], a[68:71], v[68:71], v[28:31]
    ds_read_b128 v[64:67], v80 offset:10240
    ds_read_b128 v[68:71], v81 offset:10240
    s_waitcnt lgkmcnt(2)
    v_mfma_f32_16x16x32_bf16 v[32:35], a[200:203], v[72:75], v[32:35]
    v_mfma_f32_16x16x32_bf16 v[36:39], a[200:203], v[76:79], v[36:39]
    v_mfma_f32_16x16x32_bf16 v[40:43], a[204:207], v[72:75], v[40:43]
    v_mfma_f32_16x16x32_bf16 v[44:47], a[204:207], v[76:79], v[44:47]
    v_mfma_f32_16x16x32_bf16 v[48:51], v[72:75], v[200:203], v[48:51]
    v_mfma_f32_16x16x32_bf16 v[56:59], v[76:79], v[200:203], v[56:59]
    v_mfma_f32_16x16x32_bf16 v[52:55], v[72:75], v[204:207], v[52:55]
    v_mfma_f32_16x16x32_bf16 v[60:63], v[76:79], v[204:207], v[60:63]
    v_mfma_f32_16x16x32_bf16 v[16:19], a[72:75], v[72:75], v[16:19]
    v_mfma_f32_16x16x32_bf16 v[20:23], a[72:75], v[76:79], v[20:23]
    v_mfma_f32_16x16x32_bf16 v[24:27], a[76:79], v[72:75], v[24:27]
    v_mfma_f32_16x16x32_bf16 v[28:31], a[76:79], v[76:79], v[28:31]
    ds_read_b128 v[72:75], v82 offset:11264
    ds_read_b128 v[76:79], v83 offset:11264
    s_waitcnt lgkmcnt(2)
    v_mfma_f32_16x16x32_bf16 v[32:35], a[208:211], v[64:67], v[32:35]
    v_mfma_f32_16x16x32_bf16 v[36:39], a[208:211], v[68:71], v[36:39]
    v_mfma_f32_16x16x32_bf16 v[40:43], a[212:215], v[64:67], v[40:43]
    v_mfma_f32_16x16x32_bf16 v[44:47], a[212:215], v[68:71], v[44:47]
    v_mfma_f32_16x16x32_bf16 v[48:51], v[64:67], v[208:211], v[48:51]
    v_mfma_f32_16x16x32_bf16 v[56:59], v[68:71], v[208:211], v[56:59]
    v_mfma_f32_16x16x32_bf16 v[52:55], v[64:67], v[212:215], v[52:55]
    v_mfma_f32_16x16x32_bf16 v[60:63], v[68:71], v[212:215], v[60:63]
    v_mfma_f32_16x16x32_bf16 v[16:19], a[80:83], v[64:67], v[16:19]
    v_mfma_f32_16x16x32_bf16 v[20:23], a[80:83], v[68:71], v[20:23]
    v_mfma_f32_16x16x32_bf16 v[24:27], a[84:87], v[64:67], v[24:27]
    v_mfma_f32_16x16x32_bf16 v[28:31], a[84:87], v[68:71], v[28:31]
    ds_read_b128 v[64:67], v80 offset:12288
    ds_read_b128 v[68:71], v81 offset:12288
    s_waitcnt lgkmcnt(2)
    v_mfma_f32_16x16x32_bf16 v[32:35], a[216:219], v[72:75], v[32:35]
    v_mfma_f32_16x16x32_bf16 v[36:39], a[216:219], v[76:79], v[36:39]
    v_mfma_f32_16x16x32_bf16 v[40:43], a[220:223], v[72:75], v[40:43]
    v_mfma_f32_16x16x32_bf16 v[44:47], a[220:223], v[76:79], v[44:47]
    v_mfma_f32_16x16x32_bf16 v[48:51], v[72:75], v[216:219], v[48:51]
    v_mfma_f32_16x16x32_bf16 v[56:59], v[76:79], v[216:219], v[56:59]
    v_mfma_f32_16x16x32_bf16 v[52:55], v[72:75], v[220:223], v[52:55]
    v_mfma_f32_16x16x32_bf16 v[60:63], v[76:79], v[220:223], v[60:63]
    v_mfma_f32_16x16x32_bf16 v[16:19], a[88:91], v[72:75], v[16:19]
    v_mfma_f32_16x16x32_bf16 v[20:23], a[88:91], v[76:79], v[20:23]
    v_mfma_f32_16x16x32_bf16 v[24:27], a[92:95], v[72:75], v[24:27]
    v_mfma_f32_16x16x32_bf16 v[28:31], a[92:95], v[76:79], v[28:31]
    ds_read_b128 v[72:75], v82 offset:13312
    ds_read_b128 v[76:79], v83 offset:13312
    s_waitcnt lgkmcnt(2)
    v_mfma_f32_16x16x32_bf16 v[32:35], a[224:227], v[64:67], v[32:35]
    v_mfma_f32_16x16x32_bf16 v[36:39], a[224:227], v[68:71], v[36:39]
    v_mfma_f32_16x16x32_bf16 v[40:43], a[228:231], v[64:67], v[40:43]
    v_mfma_f32_16x16x32_bf16 v[44:47], a[228:231], v[68:71], v[44:47]
    v_mfma_f32_16x16x32_bf16 v[48:51], v[64:67], v[224:227], v[48:51]
    v_mfma_f32_16x16x32_bf16 v[56:59], v[68:71], v[224:227], v[56:59]
    v_mfma_f32_16x16x32_bf16 v[52:55], v[64:67], v[228:231], v[52:55]
    v_mfma_f32_16x16x32_bf16 v[60:63], v[68:71], v[228:231], v[60:63]
    v_mfma_f32_16x16x32_bf16 v[16:19], a[96:99], v[64:67], v[16:19]
    v_mfma_f32_16x16x32_bf16 v[20:23], a[96:99], v[68:71], v[20:23]
    v_mfma_f32_16x16x32_bf16 v[24:27], a[100:103], v[64:67], v[24:27]
    v_mfma_f32_16x16x32_bf16 v[28:31], a[100:103], v[68:71], v[28:31]
    ds_read_b128 v[64:67], v80 offset:14336
    ds_read_b128 v[68:71], v81 offset:14336
    s_waitcnt lgkmcnt(2)
    v_mfma_f32_16x16x32_bf16 v[32:35], a[232:235], v[72:75], v[32:35]
    v_mfma_f32_16x16x32_bf16 v[36:39], a[232:235], v[76:79], v[36:39]
    v_mfma_f32_16x16x32_bf16 v[40:43], a[236:239], v[72:75], v[40:43]
    v_mfma_f32_16x16x32_bf16 v[44:47], a[236:239], v[76:79], v[44:47]
    v_mfma_f32_16x16x32_bf16 v[48:51], v[72:75], v[232:235], v[48:51]
    v_mfma_f32_16x16x32_bf16 v[56:59], v[76:79], v[232:235], v[56:59]
    v_mfma_f32_16x16x32_bf16 v[52:55], v[72:75], v[236:239], v[52:55]
    v_mfma_f32_16x16x32_bf16 v[60:63], v[76:79], v[236:239], v[60:63]
    v_mfma_f32_16x16x32_bf16 v[16:19], a[104:107], v[72:75], v[16:19]
    v_mfma_f32_16x16x32_bf16 v[20:23], a[104:107], v[76:79], v[20:23]
    v_mfma_f32_16x16x32_bf16 v[24:27], a[108:111], v[72:75], v[24:27]
    v_mfma_f32_16x16x32_bf16 v[28:31], a[108:111], v[76:79], v[28:31]
    ds_read_b128 v[72:75], v82 offset:15360
    ds_read_b128 v[76:79], v83 offset:15360
    s_waitcnt lgkmcnt(2)
    v_mfma_f32_16x16x32_bf16 v[32:35], a[240:243], v[64:67], v[32:35]
    v_mfma_f32_16x16x32_bf16 v[36:39], a[240:243], v[68:71], v[36:39]
    v_mfma_f32_16x16x32_bf16 v[40:43], a[244:247], v[64:67], v[40:43]
    v_mfma_f32_16x16x32_bf16 v[44:47], a[244:247], v[68:71], v[44:47]
    v_mfma_f32_16x16x32_bf16 v[48:51], v[64:67], v[240:243], v[48:51]
    v_mfma_f32_16x16x32_bf16 v[56:59], v[68:71], v[240:243], v[56:59]
    v_mfma_f32_16x16x32_bf16 v[52:55], v[64:67], v[244:247], v[52:55]
    v_mfma_f32_16x16x32_bf16 v[60:63], v[68:71], v[244:247], v[60:63]
    v_mfma_f32_16x16x32_bf16 v[16:19], a[112:115], v[64:67], v[16:19]
    v_mfma_f32_16x16x32_bf16 v[20:23], a[112:115], v[68:71], v[20:23]
    v_mfma_f32_16x16x32_bf16 v[24:27], a[116:119], v[64:67], v[24:27]
    v_mfma_f32_16x16x32_bf16 v[28:31], a[116:119], v[68:71], v[28:31]
    s_waitcnt lgkmcnt(0)
    v_mfma_f32_16x16x32_bf16 v[32:35], a[248:251], v[72:75], v[32:35]
    v_mfma_f32_16x16x32_bf16 v[36:39], a[248:251], v[76:79], v[36:39]
    v_mfma_f32_16x16x32_bf16 v[40:43], a[252:255], v[72:75], v[40:43]
    v_mfma_f32_16x16x32_bf16 v[44:47], a[252:255], v[76:79], v[44:47]
    v_mfma_f32_16x16x32_bf16 v[48:51], v[72:75], v[248:251], v[48:51]
    v_mfma_f32_16x16x32_bf16 v[56:59], v[76:79], v[248:251], v[56:59]
    v_mfma_f32_16x16x32_bf16 v[52:55], v[72:75], v[252:255], v[52:55]
    v_mfma_f32_16x16x32_bf16 v[60:63], v[76:79], v[252:255], v[60:63]
    v_mfma_f32_16x16x32_bf16 v[16:19], a[120:123], v[72:75], v[16:19]
    v_mfma_f32_16x16x32_bf16 v[20:23], a[120:123], v[76:79], v[20:23]
    v_mfma_f32_16x16x32_bf16 v[24:27], a[124:127], v[72:75], v[24:27]
    v_mfma_f32_16x16x32_bf16 v[28:31], a[124:127], v[76:79], v[28:31]
    v_xor_b32 v80, 0x8000, v80
    v_xor_b32 v81, 0x8000, v81
    v_xor_b32 v82, 0x8000, v82
    v_xor_b32 v83, 0x8000, v83
    v_mul_f32 v32, s33, v32
    v_mul_f32 v33, s33, v33
    v_mul_f32 v34, s33, v34
    v_mul_f32 v35, s33, v35
    v_mul_f32 v36, s33, v36
    v_mul_f32 v37, s33, v37
    v_mul_f32 v38, s33, v38
    v_mul_f32 v39, s33, v39
    v_mul_f32 v40, s33, v40
    v_mul_f32 v41, s33, v41
    v_mul_f32 v42, s33, v42
    v_mul_f32 v43, s33, v43
    v_mul_f32 v44, s33, v44
    v_mul_f32 v45, s33, v45
    v_mul_f32 v46, s33, v46
    v_mul_f32 v47, s33, v47
    v_cvt_pk_bf16_f32 v88, v32, v40
    v_cvt_pk_bf16_f32 v89, v33, v41
    v_cvt_pk_bf16_f32 v90, v34, v42
    v_cvt_pk_bf16_f32 v91, v35, v43
    v_cvt_pk_bf16_f32 v92, v36, v44
    v_cvt_pk_bf16_f32 v93, v37, v45
    v_cvt_pk_bf16_f32 v94, v38, v46
    v_cvt_pk_bf16_f32 v95, v39, v47
    v_cvt_pk_bf16_f32 v96, v48, v49
    v_cvt_pk_bf16_f32 v97, v50, v51
    v_cvt_pk_bf16_f32 v98, v56, v57
    v_cvt_pk_bf16_f32 v99, v58, v59
    v_cvt_pk_bf16_f32 v100, v52, v53
    v_cvt_pk_bf16_f32 v101, v54, v55
    v_cvt_pk_bf16_f32 v102, v60, v61
    v_cvt_pk_bf16_f32 v103, v62, v63
    v_cvt_pk_bf16_f32 v104, v16, v24
    v_cvt_pk_bf16_f32 v105, v17, v25
    v_cvt_pk_bf16_f32 v106, v18, v26
    v_cvt_pk_bf16_f32 v107, v19, v27
    v_cvt_pk_bf16_f32 v108, v20, v28
    v_cvt_pk_bf16_f32 v109, v21, v29
    v_cvt_pk_bf16_f32 v110, v22, v30
    v_cvt_pk_bf16_f32 v111, v23, v31
    s_mul_i32 s24, s23, 0x82100
    s_lshl_b32 s36, s20, 14
    s_add_u32 s24, s24, s36
    s_add_u32 s24, s24, 0x1000000
    s_mov_b32 s30, s24
    s_lshr_b32 s36, s21, 1
    s_lshl_b32 s36, s36, 12
    s_xor_b32 s37, s36, 4096
    s_add_u32 s36, s36, s24
    s_add_u32 s37, s37, s24
    buffer_store_dwordx4 v[88:91], v9, s[8:11], s36 offen sc1
    buffer_store_dwordx4 v[92:95], v9, s[8:11], s37 offen sc1
    s_add_u32 s24, s24, 8192
    buffer_store_dwordx4 v[96:99], v2, s[8:11], s24 offen sc1
    buffer_store_dwordx4 v[100:103], v2, s[8:11], s24 offen offset:1024 sc1
    s_add_u32 s36, s36, 0x7000000
    s_add_u32 s37, s37, 0x7000000
    buffer_store_dwordx4 v[104:107], v9, s[8:11], s36 offen sc1
    buffer_store_dwordx4 v[108:111], v9, s[8:11], s37 offen sc1
    s_mul_i32 s25, s23, 0x82100
    s_lshl_b32 s36, s20, 2
    s_add_u32 s25, s25, s36
    s_add_u32 s25, s25, 0x1082000
    s_add_u32 s23, s23, 6
    s_cmp_lt_u32 s23, 64
    s_cbranch_scc1 L_P1
    v_mov_b32 v20, -1
    v_mov_b32 v21, -1
    v_mov_b32 v22, -1
    v_mov_b32 v23, -1
    s_lshl_b32 s24, s22, 21
    s_lshl_b32 s36, s20, 15
    s_add_u32 s24, s24, s36
    s_add_u32 s36, s24, 0x4000000
    buffer_store_dwordx4 v[20:23], v11, s[8:11], s36 offen sc1
    s_add_u32 s36, s24, 0x4001000
    buffer_store_dwordx4 v[20:23], v11, s[8:11], s36 offen sc1
    s_add_u32 s36, s24, 0x4002000
    buffer_store_dwordx4 v[20:23], v11, s[8:11], s36 offen sc1
    s_add_u32 s36, s24, 0x4003000
    buffer_store_dwordx4 v[20:23], v11, s[8:11], s36 offen sc1
    s_add_u32 s36, s24, 0x4004000
    buffer_store_dwordx4 v[20:23], v11, s[8:11], s36 offen sc1
    s_add_u32 s36, s24, 0x4005000
    buffer_store_dwordx4 v[20:23], v11, s[8:11], s36 offen sc1
    s_add_u32 s36, s24, 0x4006000
    buffer_store_dwordx4 v[20:23], v11, s[8:11], s36 offen sc1
    s_add_u32 s36, s24, 0x4007000
    buffer_store_dwordx4 v[20:23], v11, s[8:11], s36 offen sc1
    s_add_u32 s36, s24, 0x4100000
    buffer_store_dwordx4 v[20:23], v11, s[8:11], s36 offen sc1
    s_add_u32 s36, s24, 0x4101000
    buffer_store_dwordx4 v[20:23], v11, s[8:11], s36 offen sc1
    s_add_u32 s36, s24, 0x4102000
    buffer_store_dwordx4 v[20:23], v11, s[8:11], s36 offen sc1
    s_add_u32 s36, s24, 0x4103000
    buffer_store_dwordx4 v[20:23], v11, s[8:11], s36 offen sc1
    s_add_u32 s36, s24, 0x4104000
    buffer_store_dwordx4 v[20:23], v11, s[8:11], s36 offen sc1
    s_add_u32 s36, s24, 0x4105000
    buffer_store_dwordx4 v[20:23], v11, s[8:11], s36 offen sc1
    s_add_u32 s36, s24, 0x4106000
    buffer_store_dwordx4 v[20:23], v11, s[8:11], s36 offen sc1
    s_add_u32 s36, s24, 0x4107000
    buffer_store_dwordx4 v[20:23], v11, s[8:11], s36 offen sc1
    s_waitcnt vmcnt(0)
    s_barrier
    v_cmp_ne_u32 vcc, 0, v0
    v_mov_b32 v15, 0x40000000
    v_mov_b32 v14, 1
    v_cndmask_b32 v15, v0, v15, vcc
    buffer_store_dword v14, v15, s[8:11], s25 offen sc1
    s_lshl_b32 s25, s22, 7
    s_lshl_b32 s36, s20, 2
    s_add_u32 s36, s36, s25
    s_add_u32 s36, s36, 0x192000
    v_cmp_ne_u32 vcc, 0, v0
    v_mov_b32 v15, 0x40000000
    v_mov_b32 v14, 1
    v_cndmask_b32 v15, v0, v15, vcc
    buffer_store_dword v14, v15, s[8:11], s36 offen sc1
    s_mov_b32 s96, s54
    s_and_b32 s97, s55, 0xffff
    s_mov_b32 s98, 0x400000
    s_mov_b32 s99, 0x20000
    v_mov_b32 v15, 0x0
    v_bfe_u32 v14, v0, 0, 1
    s_mov_b32 s38, 0x10
    v_mad_u32_u24 v15, v14, s38, v15
    v_bfe_u32 v14, v0, 1, 1
    s_mov_b32 s38, 0x20
    v_mad_u32_u24 v15, v14, s38, v15
    v_bfe_u32 v14, v0, 2, 1
    s_mov_b32 s38, 0x40
    v_mad_u32_u24 v15, v14, s38, v15
    v_bfe_u32 v14, v0, 3, 1
    s_mov_b32 s38, 0x80
    v_mad_u32_u24 v15, v14, s38, v15
    v_bfe_u32 v14, v0, 4, 1
    s_mov_b32 s38, 0x1000
    v_mad_u32_u24 v15, v14, s38, v15
    v_bfe_u32 v14, v0, 5, 1
    s_mov_b32 s38, 0x2000
    v_mad_u32_u24 v15, v14, s38, v15
    v_bfe_u32 v14, v0, 6, 1
    s_mov_b32 s38, 0x100
    v_mad_u32_u24 v15, v14, s38, v15
    v_bfe_u32 v14, v0, 7, 1
    s_mov_b32 s38, 0x200
    v_mad_u32_u24 v15, v14, s38, v15
    s_lshl_b32 s36, s20, 17
    s_add_u32 s37, s36, 0x0
    buffer_load_dwordx4 v[16:19], v15, s[96:99], s37 offen
    s_add_u32 s37, s36, 0x4000
    buffer_load_dwordx4 v[20:23], v15, s[96:99], s37 offen
    s_add_u32 s37, s36, 0x400
    buffer_load_dwordx4 v[24:27], v15, s[96:99], s37 offen
    s_add_u32 s37, s36, 0x4400
    buffer_load_dwordx4 v[28:31], v15, s[96:99], s37 offen
    s_add_u32 s37, s36, 0x800
    buffer_load_dwordx4 v[32:35], v15, s[96:99], s37 offen
    s_add_u32 s37, s36, 0x4800
    buffer_load_dwordx4 v[36:39], v15, s[96:99], s37 offen
    s_add_u32 s37, s36, 0xc00
    buffer_load_dwordx4 v[40:43], v15, s[96:99], s37 offen
    s_add_u32 s37, s36, 0x4c00
    buffer_load_dwordx4 v[44:47], v15, s[96:99], s37 offen
    s_add_u32 s37, s36, 0x8000
    buffer_load_dwordx4 v[48:51], v15, s[96:99], s37 offen
    s_add_u32 s37, s36, 0xc000
    buffer_load_dwordx4 v[52:55], v15, s[96:99], s37 offen
    s_add_u32 s37, s36, 0x8400
    buffer_load_dwordx4 v[56:59], v15, s[96:99], s37 offen
    s_add_u32 s37, s36, 0xc400
    buffer_load_dwordx4 v[60:63], v15, s[96:99], s37 offen
    s_add_u32 s37, s36, 0x8800
    buffer_load_dwordx4 v[64:67], v15, s[96:99], s37 offen
    s_add_u32 s37, s36, 0xc800
    buffer_load_dwordx4 v[68:71], v15, s[96:99], s37 offen
    s_add_u32 s37, s36, 0x8c00
    buffer_load_dwordx4 v[72:75], v15, s[96:99], s37 offen
    s_add_u32 s37, s36, 0xcc00
    buffer_load_dwordx4 v[76:79], v15, s[96:99], s37 offen
    s_add_u32 s37, s36, 0x10000
    buffer_load_dwordx4 v[80:83], v15, s[96:99], s37 offen
    s_add_u32 s37, s36, 0x14000
    buffer_load_dwordx4 v[84:87], v15, s[96:99], s37 offen
    s_add_u32 s37, s36, 0x10400
    buffer_load_dwordx4 v[88:91], v15, s[96:99], s37 offen
    s_add_u32 s37, s36, 0x14400
    buffer_load_dwordx4 v[92:95], v15, s[96:99], s37 offen
    s_add_u32 s37, s36, 0x10800
    buffer_load_dwordx4 v[96:99], v15, s[96:99], s37 offen
    s_add_u32 s37, s36, 0x14800
    buffer_load_dwordx4 v[100:103], v15, s[96:99], s37 offen
    s_add_u32 s37, s36, 0x10c00
    buffer_load_dwordx4 v[104:107], v15, s[96:99], s37 offen
    s_add_u32 s37, s36, 0x14c00
    buffer_load_dwordx4 v[108:111], v15, s[96:99], s37 offen
    s_waitcnt vmcnt(16)
    v_perm_b32 v112, v20, v16, s34
    v_perm_b32 v113, v28, v24, s34
    v_perm_b32 v114, v36, v32, s34
    v_perm_b32 v115, v44, v40, s34
    ds_write_b128 v7, v[112:115] offset:0
    v_perm_b32 v116, v20, v16, s35
    v_perm_b32 v117, v28, v24, s35
    v_perm_b32 v118, v36, v32, s35
    v_perm_b32 v119, v44, v40, s35
    ds_write_b128 v7, v[116:119] offset:1024
    v_perm_b32 v120, v21, v17, s34
    v_perm_b32 v121, v29, v25, s34
    v_perm_b32 v122, v37, v33, s34
    v_perm_b32 v123, v45, v41, s34
    ds_write_b128 v7, v[120:123] offset:2048
    v_perm_b32 v124, v21, v17, s35
    v_perm_b32 v125, v29, v25, s35
    v_perm_b32 v126, v37, v33, s35
    v_perm_b32 v127, v45, v41, s35
    ds_write_b128 v7, v[124:127] offset:3072
    s_waitcnt lgkmcnt(0)
    v_perm_b32 v112, v22, v18, s34
    v_perm_b32 v113, v30, v26, s34
    v_perm_b32 v114, v38, v34, s34
    v_perm_b32 v115, v46, v42, s34
    ds_write_b128 v7, v[112:115] offset:4096
    v_perm_b32 v116, v22, v18, s35
    v_perm_b32 v117, v30, v26, s35
    v_perm_b32 v118, v38, v34, s35
    v_perm_b32 v119, v46, v42, s35
    ds_write_b128 v7, v[116:119] offset:5120
    v_perm_b32 v120, v23, v19, s34
    v_perm_b32 v121, v31, v27, s34
    v_perm_b32 v122, v39, v35, s34
    v_perm_b32 v123, v47, v43, s34
    ds_write_b128 v7, v[120:123] offset:6144
    v_perm_b32 v124, v23, v19, s35
    v_perm_b32 v125, v31, v27, s35
    v_perm_b32 v126, v39, v35, s35
    v_perm_b32 v127, v47, v43, s35
    ds_write_b128 v7, v[124:127] offset:7168
    s_waitcnt lgkmcnt(0)
    s_add_u32 s37, s36, 0x18000
    buffer_load_dwordx4 v[16:19], v15, s[96:99], s37 offen
    s_add_u32 s37, s36, 0x1c000
    buffer_load_dwordx4 v[20:23], v15, s[96:99], s37 offen
    s_add_u32 s37, s36, 0x18400
    buffer_load_dwordx4 v[24:27], v15, s[96:99], s37 offen
    s_add_u32 s37, s36, 0x1c400
    buffer_load_dwordx4 v[28:31], v15, s[96:99], s37 offen
    s_add_u32 s37, s36, 0x18800
    buffer_load_dwordx4 v[32:35], v15, s[96:99], s37 offen
    s_add_u32 s37, s36, 0x1c800
    buffer_load_dwordx4 v[36:39], v15, s[96:99], s37 offen
    s_add_u32 s37, s36, 0x18c00
    buffer_load_dwordx4 v[40:43], v15, s[96:99], s37 offen
    s_add_u32 s37, s36, 0x1cc00
    buffer_load_dwordx4 v[44:47], v15, s[96:99], s37 offen
    s_waitcnt vmcnt(16)
    v_perm_b32 v112, v52, v48, s34
    v_perm_b32 v113, v60, v56, s34
    v_perm_b32 v114, v68, v64, s34
    v_perm_b32 v115, v76, v72, s34
    ds_write_b128 v7, v[112:115] offset:8192
    v_perm_b32 v116, v52, v48, s35
    v_perm_b32 v117, v60, v56, s35
    v_perm_b32 v118, v68, v64, s35
    v_perm_b32 v119, v76, v72, s35
    ds_write_b128 v7, v[116:119] offset:9216
    v_perm_b32 v120, v53, v49, s34
    v_perm_b32 v121, v61, v57, s34
    v_perm_b32 v122, v69, v65, s34
    v_perm_b32 v123, v77, v73, s34
    ds_write_b128 v7, v[120:123] offset:10240
    v_perm_b32 v124, v53, v49, s35
    v_perm_b32 v125, v61, v57, s35
    v_perm_b32 v126, v69, v65, s35
    v_perm_b32 v127, v77, v73, s35
    ds_write_b128 v7, v[124:127] offset:11264
    s_waitcnt lgkmcnt(0)
    v_perm_b32 v112, v54, v50, s34
    v_perm_b32 v113, v62, v58, s34
    v_perm_b32 v114, v70, v66, s34
    v_perm_b32 v115, v78, v74, s34
    ds_write_b128 v7, v[112:115] offset:12288
    v_perm_b32 v116, v54, v50, s35
    v_perm_b32 v117, v62, v58, s35
    v_perm_b32 v118, v70, v66, s35
    v_perm_b32 v119, v78, v74, s35
    ds_write_b128 v7, v[116:119] offset:13312
    v_perm_b32 v120, v55, v51, s34
    v_perm_b32 v121, v63, v59, s34
    v_perm_b32 v122, v71, v67, s34
    v_perm_b32 v123, v79, v75, s34
    ds_write_b128 v7, v[120:123] offset:14336
    v_perm_b32 v124, v55, v51, s35
    v_perm_b32 v125, v63, v59, s35
    v_perm_b32 v126, v71, v67, s35
    v_perm_b32 v127, v79, v75, s35
    ds_write_b128 v7, v[124:127] offset:15360
    s_waitcnt lgkmcnt(0)
    s_waitcnt vmcnt(8)
    v_perm_b32 v112, v84, v80, s34
    v_perm_b32 v113, v92, v88, s34
    v_perm_b32 v114, v100, v96, s34
    v_perm_b32 v115, v108, v104, s34
    ds_write_b128 v7, v[112:115] offset:16384
    v_perm_b32 v116, v84, v80, s35
    v_perm_b32 v117, v92, v88, s35
    v_perm_b32 v118, v100, v96, s35
    v_perm_b32 v119, v108, v104, s35
    ds_write_b128 v7, v[116:119] offset:17408
    v_perm_b32 v120, v85, v81, s34
    v_perm_b32 v121, v93, v89, s34
    v_perm_b32 v122, v101, v97, s34
    v_perm_b32 v123, v109, v105, s34
    ds_write_b128 v7, v[120:123] offset:18432
    v_perm_b32 v124, v85, v81, s35
    v_perm_b32 v125, v93, v89, s35
    v_perm_b32 v126, v101, v97, s35
    v_perm_b32 v127, v109, v105, s35
    ds_write_b128 v7, v[124:127] offset:19456
    s_waitcnt lgkmcnt(0)
    v_perm_b32 v112, v86, v82, s34
    v_perm_b32 v113, v94, v90, s34
    v_perm_b32 v114, v102, v98, s34
    v_perm_b32 v115, v110, v106, s34
    ds_write_b128 v7, v[112:115] offset:20480
    v_perm_b32 v116, v86, v82, s35
    v_perm_b32 v117, v94, v90, s35
    v_perm_b32 v118, v102, v98, s35
    v_perm_b32 v119, v110, v106, s35
    ds_write_b128 v7, v[116:119] offset:21504
    v_perm_b32 v120, v87, v83, s34
    v_perm_b32 v121, v95, v91, s34
    v_perm_b32 v122, v103, v99, s34
    v_perm_b32 v123, v111, v107, s34
    ds_write_b128 v7, v[120:123] offset:22528
    v_perm_b32 v124, v87, v83, s35
    v_perm_b32 v125, v95, v91, s35
    v_perm_b32 v126, v103, v99, s35
    v_perm_b32 v127, v111, v107, s35
    ds_write_b128 v7, v[124:127] offset:23552
    s_waitcnt lgkmcnt(0)
    s_waitcnt vmcnt(0)
    v_perm_b32 v112, v20, v16, s34
    v_perm_b32 v113, v28, v24, s34
    v_perm_b32 v114, v36, v32, s34
    v_perm_b32 v115, v44, v40, s34
    ds_write_b128 v7, v[112:115] offset:24576
    v_perm_b32 v116, v20, v16, s35
    v_perm_b32 v117, v28, v24, s35
    v_perm_b32 v118, v36, v32, s35
    v_perm_b32 v119, v44, v40, s35
    ds_write_b128 v7, v[116:119] offset:25600
    v_perm_b32 v120, v21, v17, s34
    v_perm_b32 v121, v29, v25, s34
    v_perm_b32 v122, v37, v33, s34
    v_perm_b32 v123, v45, v41, s34
    ds_write_b128 v7, v[120:123] offset:26624
    v_perm_b32 v124, v21, v17, s35
    v_perm_b32 v125, v29, v25, s35
    v_perm_b32 v126, v37, v33, s35
    v_perm_b32 v127, v45, v41, s35
    ds_write_b128 v7, v[124:127] offset:27648
    s_waitcnt lgkmcnt(0)
    v_perm_b32 v112, v22, v18, s34
    v_perm_b32 v113, v30, v26, s34
    v_perm_b32 v114, v38, v34, s34
    v_perm_b32 v115, v46, v42, s34
    ds_write_b128 v7, v[112:115] offset:28672
    v_perm_b32 v116, v22, v18, s35
    v_perm_b32 v117, v30, v26, s35
    v_perm_b32 v118, v38, v34, s35
    v_perm_b32 v119, v46, v42, s35
    ds_write_b128 v7, v[116:119] offset:29696
    v_perm_b32 v120, v23, v19, s34
    v_perm_b32 v121, v31, v27, s34
    v_perm_b32 v122, v39, v35, s34
    v_perm_b32 v123, v47, v43, s34
    ds_write_b128 v7, v[120:123] offset:30720
    v_perm_b32 v124, v23, v19, s35
    v_perm_b32 v125, v31, v27, s35
    v_perm_b32 v126, v39, v35, s35
    v_perm_b32 v127, v47, v43, s35
    ds_write_b128 v7, v[124:127] offset:31744
    s_waitcnt lgkmcnt(0)
    s_lshl_b32 s25, s22, 7
    s_add_u32 s25, s25, 0x192000
    v_lshrrev_b32 v15, 2, v1
    v_and_b32 v15, 127, v15
L_TPI:
    buffer_load_dword v14, v15, s[8:11], s25 offen sc1
    s_add_u32 s32, s32, 1
    s_cmp_gt_u32 s32, 200000
    s_waitcnt vmcnt(0)
    s_cbranch_scc1 L_TPI_ok
    v_cmp_eq_u32 vcc, 0, v14
    s_cbranch_vccz L_TPI_ok
    s_sleep 8
    s_branch L_TPI
L_TPI_ok:
    s_mov_b32 s23, s22
    s_mov_b32 s29, 0
    s_mov_b32 s30, 0x40000000
    s_mul_i32 s24, s23, 0x82100
    s_lshl_b32 s36, s20, 14
    s_add_u32 s24, s24, s36
    s_add_u32 s24, s24, 0x1000000
    s_add_u32 s36, s24, 0
    s_add_u32 s37, s36, 0x7000000
    buffer_load_dwordx4 a[32:35], v1, s[8:11], s36 offen offset:0 sc1
    buffer_load_dwordx4 a[0:3], v1, s[8:11], s37 offen offset:0 sc1
    buffer_load_dwordx4 a[36:39], v1, s[8:11], s36 offen offset:1024 sc1
    buffer_load_dwordx4 a[4:7], v1, s[8:11], s37 offen offset:1024 sc1
    buffer_load_dwordx4 a[40:43], v1, s[8:11], s36 offen offset:2048 sc1
    buffer_load_dwordx4 a[8:11], v1, s[8:11], s37 offen offset:2048 sc1
    buffer_load_dwordx4 a[44:47], v1, s[8:11], s36 offen offset:3072 sc1
    buffer_load_dwordx4 a[12:15], v1, s[8:11], s37 offen offset:3072 sc1
    s_add_u32 s36, s24, 4096
    s_add_u32 s37, s36, 0x7000000
    buffer_load_dwordx4 a[48:51], v1, s[8:11], s36 offen offset:0 sc1
    buffer_load_dwordx4 a[16:19], v1, s[8:11], s37 offen offset:0 sc1
    buffer_load_dwordx4 a[52:55], v1, s[8:11], s36 offen offset:1024 sc1
    buffer_load_dwordx4 a[20:23], v1, s[8:11], s37 offen offset:1024 sc1
    buffer_load_dwordx4 a[56:59], v1, s[8:11], s36 offen offset:2048 sc1
    buffer_load_dwordx4 a[24:27], v1, s[8:11], s37 offen offset:2048 sc1
    buffer_load_dwordx4 a[60:63], v1, s[8:11], s36 offen offset:3072 sc1
    buffer_load_dwordx4 a[28:31], v1, s[8:11], s37 offen offset:3072 sc1
    s_lshr_b32 s36, s21, 1
    s_lshl_b32 s36, s36, 3
    s_xor_b32 s37, s36, 8
    s_add_u32 s24, s24, 8192
    s_add_u32 s36, s36, s24
    s_add_u32 s37, s37, s24
    buffer_load_dwordx2 a[64:65], v2, s[8:11], s36 offen offset:0 sc1
    buffer_load_dwordx2 a[66:67], v2, s[8:11], s37 offen offset:0 sc1
    buffer_load_dwordx2 a[68:69], v2, s[8:11], s36 offen offset:1024 sc1
    buffer_load_dwordx2 a[70:71], v2, s[8:11], s37 offen offset:1024 sc1
L_P2:
    s_and_b32 s36, s29, 1
    s_lshl_b32 s36, s36, 20
    s_lshl_b32 s26, s22, 21
    s_add_u32 s26, s26, s36
    s_add_u32 s26, s26, 0x4000000
    s_bfe_u32 s27, s29, 0x10001
    s_lshl_b32 s24, s23, 13
    s_add_u32 s24, s24, 0x100000
    s_max_u32 s25, s23, 1
    s_lshl_b32 s25, s25, 13
    s_add_u32 s25, s25, 0xfe000
    buffer_load_dwordx4 v[48:51], v2, s[8:11], s24 offen sc1
    buffer_load_dwordx4 v[52:55], v2, s[8:11], s24 offen offset:1024 sc1
    s_lshl_b32 s36, s23, 5
    s_add_u32 s36, s36, s20
    s_lshl_b32 s36, s36, 10
    buffer_load_dword a72, v12, s[12:15], s36 offen
    buffer_load_dword a73, v12, s[92:95], 0 offen
    s_waitcnt vmcnt(4)
    v_cmp_ne_u32 vcc, 0, v1
    v_mov_b32 v15, 0x40000000
    v_mov_b32 v14, 0
    v_cndmask_b32 v15, v1, v15, vcc
    buffer_store_dword v14, v15, s[8:11], s30 offen sc1
    v_mfma_f32_16x16x32_bf16 v[80:83], a[32:35], a[0:3], 0
    v_mfma_f32_16x16x32_bf16 v[80:83], a[36:39], a[4:7], v[80:83]
    v_mfma_f32_16x16x32_bf16 v[80:83], a[40:43], a[8:11], v[80:83]
    v_mfma_f32_16x16x32_bf16 v[80:83], a[44:47], a[12:15], v[80:83]
    v_mfma_f32_16x16x32_bf16 v[88:91], a[48:51], a[16:19], 0
    v_mfma_f32_16x16x32_bf16 v[88:91], a[52:55], a[20:23], v[88:91]
    v_mfma_f32_16x16x32_bf16 v[88:91], a[56:59], a[24:27], v[88:91]
    v_mfma_f32_16x16x32_bf16 v[88:91], a[60:63], a[28:31], v[88:91]
    v_mfma_f32_16x16x32_bf16 v[84:87], a[32:35], a[16:19], 0
    v_mfma_f32_16x16x32_bf16 v[84:87], a[36:39], a[20:23], v[84:87]
    v_mfma_f32_16x16x32_bf16 v[84:87], a[40:43], a[24:27], v[84:87]
    v_mfma_f32_16x16x32_bf16 v[84:87], a[44:47], a[28:31], v[84:87]
    v_cndmask_b32 v80, v13, v80, s[64:65]
    v_cndmask_b32 v81, v13, v81, s[66:67]
    v_cndmask_b32 v82, v13, v82, s[68:69]
    v_cndmask_b32 v83, v13, v83, s[70:71]
    v_cndmask_b32 v88, v13, v88, s[64:65]
    v_cndmask_b32 v89, v13, v89, s[66:67]
    v_cndmask_b32 v90, v13, v90, s[68:69]
    v_cndmask_b32 v91, v13, v91, s[70:71]
    v_max_f32 v116, v80, v81
    v_max3_f32 v116, v116, v82, v83
    v_max_f32 v117, v84, v85
    v_max3_f32 v117, v117, v86, v87
    v_max3_f32 v117, v117, v88, v89
    v_max3_f32 v117, v117, v90, v91
    v_mov_b32 v14, v116
    s_nop 1
    v_permlane16_swap_b32 v116, v14
    v_max_f32 v116, v116, v14
    v_mov_b32 v14, v117
    s_nop 1
    v_permlane16_swap_b32 v117, v14
    v_max_f32 v117, v117, v14
    v_mov_b32 v14, v116
    s_nop 1
    v_permlane32_swap_b32 v116, v14
    v_max_f32 v116, v116, v14
    v_mov_b32 v14, v117
    s_nop 1
    v_permlane32_swap_b32 v117, v14
    v_max_f32 v117, v117, v14
    v_sub_f32 v80, v80, v116
    v_exp_f32 v80, v80
    v_sub_f32 v81, v81, v116
    v_exp_f32 v81, v81
    v_sub_f32 v82, v82, v116
    v_exp_f32 v82, v82
    v_sub_f32 v83, v83, v116
    v_exp_f32 v83, v83
    v_sub_f32 v84, v84, v117
    v_exp_f32 v84, v84
    v_sub_f32 v85, v85, v117
    v_exp_f32 v85, v85
    v_sub_f32 v86, v86, v117
    v_exp_f32 v86, v86
    v_sub_f32 v87, v87, v117
    v_exp_f32 v87, v87
    v_sub_f32 v88, v88, v117
    v_exp_f32 v88, v88
    v_sub_f32 v89, v89, v117
    v_exp_f32 v89, v89
    v_sub_f32 v90, v90, v117
    v_exp_f32 v90, v90
    v_sub_f32 v91, v91, v117
    v_exp_f32 v91, v91
    v_cvt_pk_bf16_f32 v100, v80, v81
    v_cvt_pk_bf16_f32 v101, v82, v83
    v_mov_b64 v[102:103], 0
    v_cvt_pk_bf16_f32 v104, v84, v85
    v_cvt_pk_bf16_f32 v105, v86, v87
    v_cvt_pk_bf16_f32 v106, v88, v89
    v_cvt_pk_bf16_f32 v107, v90, v91
    v_mov_b64 v[108:109], s[4:5]
    v_mov_b64 v[110:111], s[4:5]
    v_cndmask_b32 v112, 0, v108, s[72:73]
    v_cndmask_b32 v113, 0, v108, s[72:73]
    v_mfma_f32_16x16x32_bf16 v[16:19], v[108:111], v[100:103], 0
    v_mfma_f32_16x16x32_bf16 v[24:27], a[64:67], v[100:103], 0
    v_mfma_f32_16x16x32_bf16 v[28:31], a[68:71], v[100:103], 0
    v_mfma_f32_16x16x32_bf16 v[20:23], v[108:111], v[104:107], 0
    v_mfma_f32_16x16x32_bf16 v[32:35], a[64:67], v[104:107], 0
    v_mfma_f32_16x16x32_bf16 v[36:39], a[68:71], v[104:107], 0
    s_branch L_P2_chk
L_P2_far:
    buffer_load_dword v14, v2, s[8:11], s25 offen sc1
    s_add_u32 s32, s32, 1
    s_cmp_gt_u32 s32, 200000
    s_waitcnt vmcnt(0)
    s_cbranch_scc1 L_P2_poll
    v_cmp_eq_u32 vcc, -1, v14
    s_cbranch_vccz L_P2_near
    s_sleep 12
    s_branch L_P2_far
L_P2_near:
    s_mov_b32 s25, 0x40000000
L_P2_poll:
    buffer_load_dwordx4 v[48:51], v2, s[8:11], s24 offen sc1
    buffer_load_dwordx4 v[52:55], v2, s[8:11], s24 offen offset:1024 sc1
L_P2_chk:
    s_add_u32 s32, s32, 1
    s_waitcnt vmcnt(0)
    ds_write_b128 v2, v[48:51] offset:20480
    ds_write_b128 v2, v[52:55] offset:21504
    v_max3_u32 v14, v48, v49, v50
    v_max3_u32 v15, v51, v52, v53
    v_max3_u32 v14, v14, v54, v55
    v_max_u32 v14, v14, v15
    v_cmp_eq_u32 vcc, -1, v14
    s_cbranch_vccz L_P2_got
    s_cmp_gt_u32 s32, 200000
    s_cbranch_scc1 L_P2_got
    s_cmp_eq_u32 s25, 0x40000000
    s_cbranch_scc1 L_P2_poll
    s_branch L_P2_far
L_P2_got:
    s_waitcnt lgkmcnt(0)
    s_barrier
    ds_read_b128 v[48:51], v8 offset:0
    ds_read_b128 v[52:55], v8 offset:2048
    ds_read_b128 v[56:59], v8 offset:4096
    ds_read_b128 v[60:63], v8 offset:6144
    s_waitcnt lgkmcnt(3)
    v_mfma_f32_16x16x32_bf16 v[80:83], a[128:131], v[48:51], 0
    v_mfma_f32_16x16x32_bf16 v[84:87], a[132:135], v[48:51], 0
    ds_read_b128 v[48:51], v8 offset:512
    s_waitcnt lgkmcnt(3)
    v_mfma_f32_16x16x32_bf16 v[80:83], a[136:139], v[52:55], v[80:83]
    v_mfma_f32_16x16x32_bf16 v[84:87], a[140:143], v[52:55], v[84:87]
    ds_read_b128 v[52:55], v8 offset:2560
    s_waitcnt lgkmcnt(3)
    v_mfma_f32_16x16x32_bf16 v[80:83], a[144:147], v[56:59], v[80:83]
    v_mfma_f32_16x16x32_bf16 v[84:87], a[148:151], v[56:59], v[84:87]
    ds_read_b128 v[56:59], v8 offset:4608
    s_waitcnt lgkmcnt(3)
    v_mfma_f32_16x16x32_bf16 v[80:83], a[152:155], v[60:63], v[80:83]
    v_mfma_f32_16x16x32_bf16 v[84:87], a[156:159], v[60:63], v[84:87]
    ds_read_b128 v[60:63], v8 offset:6656
    s_waitcnt lgkmcnt(3)
    v_mfma_f32_16x16x32_bf16 v[80:83], a[160:163], v[48:51], v[80:83]
    v_mfma_f32_16x16x32_bf16 v[84:87], a[164:167], v[48:51], v[84:87]
    ds_read_b128 v[48:51], v8 offset:1024
    s_waitcnt lgkmcnt(3)
    v_mfma_f32_16x16x32_bf16 v[80:83], a[168:171], v[52:55], v[80:83]
    v_mfma_f32_16x16x32_bf16 v[84:87], a[172:175], v[52:55], v[84:87]
    ds_read_b128 v[52:55], v8 offset:3072
    s_waitcnt lgkmcnt(3)
    v_mfma_f32_16x16x32_bf16 v[80:83], a[176:179], v[56:59], v[80:83]
    v_mfma_f32_16x16x32_bf16 v[84:87], a[180:183], v[56:59], v[84:87]
    ds_read_b128 v[56:59], v8 offset:5120
    s_waitcnt lgkmcnt(3)
    v_mfma_f32_16x16x32_bf16 v[80:83], a[184:187], v[60:63], v[80:83]
    v_mfma_f32_16x16x32_bf16 v[84:87], a[188:191], v[60:63], v[84:87]
    ds_read_b128 v[60:63], v8 offset:7168
    s_waitcnt lgkmcnt(3)
    v_mfma_f32_16x16x32_bf16 v[80:83], a[192:195], v[48:51], v[80:83]
    v_mfma_f32_16x16x32_bf16 v[84:87], a[196:199], v[48:51], v[84:87]
    ds_read_b128 v[48:51], v8 offset:1536
    s_waitcnt lgkmcnt(3)
    v_mfma_f32_16x16x32_bf16 v[80:83], a[200:203], v[52:55], v[80:83]
    v_mfma_f32_16x16x32_bf16 v[84:87], a[204:207], v[52:55], v[84:87]
    ds_read_b128 v[52:55], v8 offset:3584
    s_waitcnt lgkmcnt(3)
    v_mfma_f32_16x16x32_bf16 v[80:83], a[208:211], v[56:59], v[80:83]
    v_mfma_f32_16x16x32_bf16 v[84:87], a[212:215], v[56:59], v[84:87]
    ds_read_b128 v[56:59], v8 offset:5632
    s_waitcnt lgkmcnt(3)
    v_mfma_f32_16x16x32_bf16 v[80:83], a[216:219], v[60:63], v[80:83]
    v_mfma_f32_16x16x32_bf16 v[84:87], a[220:223], v[60:63], v[84:87]
    ds_read_b128 v[60:63], v8 offset:7680
    s_waitcnt lgkmcnt(3)
    v_mfma_f32_16x16x32_bf16 v[80:83], a[224:227], v[48:51], v[80:83]
    v_mfma_f32_16x16x32_bf16 v[84:87], a[228:231], v[48:51], v[84:87]
    ds_read_b128 v[48:51], v8 offset:0
    s_waitcnt lgkmcnt(3)
    v_mfma_f32_16x16x32_bf16 v[80:83], a[232:235], v[52:55], v[80:83]
    v_mfma_f32_16x16x32_bf16 v[84:87], a[236:239], v[52:55], v[84:87]
    ds_read_b128 v[52:55], v8 offset:2048
    s_waitcnt lgkmcnt(3)
    v_mfma_f32_16x16x32_bf16 v[80:83], a[240:243], v[56:59], v[80:83]
    v_mfma_f32_16x16x32_bf16 v[84:87], a[244:247], v[56:59], v[84:87]
    ds_read_b128 v[56:59], v8 offset:4096
    s_waitcnt lgkmcnt(3)
    v_mfma_f32_16x16x32_bf16 v[80:83], a[248:251], v[60:63], v[80:83]
    v_mfma_f32_16x16x32_bf16 v[84:87], a[252:255], v[60:63], v[84:87]
    ds_read_b128 v[60:63], v8 offset:6144
    s_waitcnt lgkmcnt(3)
    v_mfma_f32_16x16x32_bf16 v[40:43], v[48:51], v[128:131], 0
    v_mfma_f32_16x16x32_bf16 v[44:47], v[48:51], v[132:135], 0
    ds_read_b128 v[48:51], v8 offset:512
    s_waitcnt lgkmcnt(3)
    v_mfma_f32_16x16x32_bf16 v[40:43], v[52:55], v[136:139], v[40:43]
    v_mfma_f32_16x16x32_bf16 v[44:47], v[52:55], v[140:143], v[44:47]
    ds_read_b128 v[52:55], v8 offset:2560
    s_waitcnt lgkmcnt(3)
    v_mfma_f32_16x16x32_bf16 v[40:43], v[56:59], v[144:147], v[40:43]
    v_mfma_f32_16x16x32_bf16 v[44:47], v[56:59], v[148:151], v[44:47]
    v_mul_f32 v80, s33, v80
    v_mul_f32 v81, s33, v81
    v_mul_f32 v82, s33, v82
    v_mul_f32 v83, s33, v83
    ds_read_b128 v[56:59], v8 offset:4608
    s_waitcnt lgkmcnt(3)
    v_mfma_f32_16x16x32_bf16 v[40:43], v[60:63], v[152:155], v[40:43]
    v_mfma_f32_16x16x32_bf16 v[44:47], v[60:63], v[156:159], v[44:47]
    v_mul_f32 v84, s33, v84
    v_mul_f32 v85, s33, v85
    v_mul_f32 v86, s33, v86
    v_mul_f32 v87, s33, v87
    ds_read_b128 v[60:63], v8 offset:6656
    s_waitcnt lgkmcnt(3)
    v_mfma_f32_16x16x32_bf16 v[40:43], v[48:51], v[160:163], v[40:43]
    v_mfma_f32_16x16x32_bf16 v[44:47], v[48:51], v[164:167], v[44:47]
    v_cvt_pk_bf16_f32 v88, v80, v84
    v_cvt_pk_bf16_f32 v89, v81, v85
    v_cvt_pk_bf16_f32 v90, v82, v86
    v_cvt_pk_bf16_f32 v91, v83, v87
    ds_write_b128 v9, v[88:91] offset:16384
    ds_read_b128 v[48:51], v8 offset:1024
    s_waitcnt lgkmcnt(4)
    v_mfma_f32_16x16x32_bf16 v[40:43], v[52:55], v[168:171], v[40:43]
    v_mfma_f32_16x16x32_bf16 v[44:47], v[52:55], v[172:175], v[44:47]
    ds_read_b128 v[52:55], v8 offset:3072
    s_waitcnt lgkmcnt(4)
    v_mfma_f32_16x16x32_bf16 v[40:43], v[56:59], v[176:179], v[40:43]
    v_mfma_f32_16x16x32_bf16 v[44:47], v[56:59], v[180:183], v[44:47]
    ds_read_b128 v[56:59], v8 offset:5120
    s_waitcnt lgkmcnt(4)
    v_mfma_f32_16x16x32_bf16 v[40:43], v[60:63], v[184:187], v[40:43]
    v_mfma_f32_16x16x32_bf16 v[44:47], v[60:63], v[188:191], v[44:47]
    s_waitcnt lgkmcnt(3)
    s_barrier
    ds_read_b128 v[64:67], v1 offset:16384
    ds_read_b128 v[68:71], v1 offset:17408
    ds_read_b128 v[72:75], v1 offset:18432
    ds_read_b128 v[76:79], v1 offset:19456
    ds_read_b128 v[60:63], v8 offset:7168
    s_waitcnt lgkmcnt(7)
    v_mfma_f32_16x16x32_bf16 v[40:43], v[48:51], v[192:195], v[40:43]
    v_mfma_f32_16x16x32_bf16 v[44:47], v[48:51], v[196:199], v[44:47]
    ds_read_b128 v[48:51], v8 offset:1536
    s_waitcnt lgkmcnt(7)
    v_mfma_f32_16x16x32_bf16 v[40:43], v[52:55], v[200:203], v[40:43]
    v_mfma_f32_16x16x32_bf16 v[44:47], v[52:55], v[204:207], v[44:47]
    s_waitcnt lgkmcnt(2)
    v_mfma_f32_16x16x32_bf16 v[92:95], v[64:67], a[0:3], 0
    v_mfma_f32_16x16x32_bf16 v[96:99], v[64:67], a[16:19], 0
    v_mfma_f32_16x16x32_bf16 v[92:95], v[68:71], a[4:7], v[92:95]
    v_mfma_f32_16x16x32_bf16 v[96:99], v[68:71], a[20:23], v[96:99]
    v_mfma_f32_16x16x32_bf16 v[92:95], v[72:75], a[8:11], v[92:95]
    v_mfma_f32_16x16x32_bf16 v[96:99], v[72:75], a[24:27], v[96:99]
    v_mfma_f32_16x16x32_bf16 v[92:95], v[76:79], a[12:15], v[92:95]
    v_mfma_f32_16x16x32_bf16 v[96:99], v[76:79], a[28:31], v[96:99]
    ds_read_b128 v[52:55], v8 offset:3584
    s_waitcnt lgkmcnt(3)
    v_mfma_f32_16x16x32_bf16 v[40:43], v[56:59], v[208:211], v[40:43]
    v_mfma_f32_16x16x32_bf16 v[44:47], v[56:59], v[212:215], v[44:47]
    ds_read_b128 v[56:59], v8 offset:5632
    s_waitcnt lgkmcnt(3)
    v_mfma_f32_16x16x32_bf16 v[40:43], v[60:63], v[216:219], v[40:43]
    v_mfma_f32_16x16x32_bf16 v[44:47], v[60:63], v[220:223], v[44:47]
    v_max3_f32 v118, v92, v93, v94
    v_max3_f32 v118, v118, v95, v116
    v_max3_f32 v119, v96, v97, v98
    v_max3_f32 v119, v119, v99, v117
    v_mov_b32 v14, v118
    v_mov_b32 v15, v119
    ds_read_b128 v[60:63], v8 offset:7680
    s_waitcnt lgkmcnt(3)
    v_mfma_f32_16x16x32_bf16 v[40:43], v[48:51], v[224:227], v[40:43]
    v_mfma_f32_16x16x32_bf16 v[44:47], v[48:51], v[228:231], v[44:47]
    v_permlane16_swap_b32 v118, v14
    v_permlane16_swap_b32 v119, v15
    v_max_f32 v118, v118, v14
    v_max_f32 v119, v119, v15
    v_sub_f32 v92, v92, v118
    v_exp_f32 v92, v92
    s_waitcnt lgkmcnt(2)
    v_mfma_f32_16x16x32_bf16 v[40:43], v[52:55], v[232:235], v[40:43]
    v_mfma_f32_16x16x32_bf16 v[44:47], v[52:55], v[236:239], v[44:47]
    v_sub_f32 v93, v93, v118
    v_exp_f32 v93, v93
    v_sub_f32 v94, v94, v118
    v_exp_f32 v94, v94
    v_sub_f32 v95, v95, v118
    v_exp_f32 v95, v95
    s_waitcnt lgkmcnt(1)
    v_mfma_f32_16x16x32_bf16 v[40:43], v[56:59], v[240:243], v[40:43]
    v_mfma_f32_16x16x32_bf16 v[44:47], v[56:59], v[244:247], v[44:47]
    v_sub_f32 v104, v116, v118
    v_exp_f32 v104, v104
    v_cvt_pk_bf16_f32 v100, v92, v93
    v_cvt_pk_bf16_f32 v101, v94, v95
    v_sub_f32 v96, v96, v119
    v_exp_f32 v96, v96
    s_waitcnt lgkmcnt(0)
    v_mfma_f32_16x16x32_bf16 v[40:43], v[60:63], v[248:251], v[40:43]
    v_mfma_f32_16x16x32_bf16 v[44:47], v[60:63], v[252:255], v[44:47]
    v_sub_f32 v97, v97, v119
    v_exp_f32 v97, v97
    v_sub_f32 v98, v98, v119
    v_exp_f32 v98, v98
    v_sub_f32 v99, v99, v119
    v_exp_f32 v99, v99
    v_sub_f32 v105, v117, v119
    v_exp_f32 v105, v105
    v_cvt_pk_bf16_f32 v102, v96, v97
    v_cvt_pk_bf16_f32 v103, v98, v99
    v_mfma_f32_16x16x16_bf16 v[48:51], v[112:113], v[100:101], 0
    s_nop 0
    v_mfma_f32_16x16x16_bf16 v[52:55], v[112:113], v[102:103], 0
    v_cvt_pk_bf16_f32 v80, v40, v41
    v_cndmask_b32 v80, 0, v80, s[72:73]
    v_cvt_pk_bf16_f32 v81, v42, v43
    v_cndmask_b32 v81, 0, v81, s[72:73]
    v_cvt_pk_bf16_f32 v82, v44, v45
    v_cndmask_b32 v82, 0, v82, s[72:73]
    v_cvt_pk_bf16_f32 v83, v46, v47
    v_cndmask_b32 v83, 0, v83, s[72:73]
    v_mfma_f32_16x16x16_bf16 v[56:59], v[80:81], v[100:101], 0
    s_nop 0
    v_mfma_f32_16x16x16_bf16 v[60:63], v[82:83], v[100:101], 0
    v_mfma_f32_16x16x16_bf16 v[64:67], v[80:81], v[102:103], 0
    v_mfma_f32_16x16x16_bf16 v[68:71], v[82:83], v[102:103], 0
    v_fma_f32 v48, v16, v104, v48
    v_rcp_f32 v48, v48
    v_fma_f32 v52, v20, v105, v52
    v_rcp_f32 v52, v52
    v_fma_f32 v56, v24, v104, v56
    v_fma_f32 v57, v25, v104, v57
    v_fma_f32 v58, v26, v104, v58
    v_fma_f32 v59, v27, v104, v59
    v_fma_f32 v60, v28, v104, v60
    v_fma_f32 v61, v29, v104, v61
    v_fma_f32 v62, v30, v104, v62
    v_fma_f32 v63, v31, v104, v63
    v_pk_mul_f32 v[56:57], v[56:57], v[48:49] op_sel_hi:[1,0]
    v_pk_mul_f32 v[58:59], v[58:59], v[48:49] op_sel_hi:[1,0]
    v_pk_mul_f32 v[60:61], v[60:61], v[48:49] op_sel_hi:[1,0]
    v_pk_mul_f32 v[62:63], v[62:63], v[48:49] op_sel_hi:[1,0]
    v_cvt_pk_bf16_f32 v72, v56, v60
    v_cvt_pk_bf16_f32 v73, v57, v61
    v_cvt_pk_bf16_f32 v74, v58, v62
    v_cvt_pk_bf16_f32 v75, v59, v63
    ds_write_b128 v9, v[72:75] offset:0
    v_fma_f32 v64, v32, v105, v64
    v_fma_f32 v65, v33, v105, v65
    v_fma_f32 v66, v34, v105, v66
    v_fma_f32 v67, v35, v105, v67
    v_fma_f32 v68, v36, v105, v68
    v_fma_f32 v69, v37, v105, v69
    v_fma_f32 v70, v38, v105, v70
    v_fma_f32 v71, v39, v105, v71
    v_pk_mul_f32 v[64:65], v[64:65], v[52:53] op_sel_hi:[1,0]
    v_pk_mul_f32 v[66:67], v[66:67], v[52:53] op_sel_hi:[1,0]
    v_pk_mul_f32 v[68:69], v[68:69], v[52:53] op_sel_hi:[1,0]
    v_pk_mul_f32 v[70:71], v[70:71], v[52:53] op_sel_hi:[1,0]
    v_cvt_pk_bf16_f32 v76, v64, v68
    v_cvt_pk_bf16_f32 v77, v65, v69
    v_cvt_pk_bf16_f32 v78, v66, v70
    v_cvt_pk_bf16_f32 v79, v67, v71
    ds_write_b128 v9, v[76:79] offset:4096
    s_waitcnt lgkmcnt(0)
    s_barrier
    ds_read_b128 v[16:19], v1 offset:0
    ds_read_b128 v[20:23], v1 offset:1024
    ds_read_b128 v[24:27], v1 offset:2048
    ds_read_b128 v[28:31], v1 offset:3072
    ds_read_b128 v[32:35], v1 offset:4096
    ds_read_b128 v[36:39], v1 offset:5120
    ds_read_b128 v[40:43], v1 offset:6144
    ds_read_b128 v[44:47], v1 offset:7168
    ds_read_b128 v[48:51], v7 offset:0
    ds_read_b128 v[52:55], v7 offset:1024
    ds_read_b128 v[56:59], v7 offset:2048
    s_lshl_b32 s36, s20, 10
    s_add_u32 s25, s26, s36
    s_waitcnt lgkmcnt(2)
    v_mfma_f32_16x16x32_bf16 v[64:67], v[16:19], v[48:51], 0
    ds_read_b128 v[60:63], v7 offset:3072
    s_waitcnt lgkmcnt(2)
    v_mfma_f32_16x16x32_bf16 v[68:71], v[16:19], v[52:55], 0
    ds_read_b128 v[48:51], v7 offset:4096
    s_waitcnt lgkmcnt(2)
    v_mfma_f32_16x16x32_bf16 v[72:75], v[16:19], v[56:59], 0
    ds_read_b128 v[52:55], v7 offset:5120
    s_waitcnt lgkmcnt(2)
    v_mfma_f32_16x16x32_bf16 v[76:79], v[16:19], v[60:63], 0
    ds_read_b128 v[56:59], v7 offset:6144
    s_waitcnt lgkmcnt(2)
    v_mfma_f32_16x16x32_bf16 v[80:83], v[16:19], v[48:51], 0
    ds_read_b128 v[60:63], v7 offset:7168
    s_waitcnt lgkmcnt(2)
    v_mfma_f32_16x16x32_bf16 v[84:87], v[16:19], v[52:55], 0
    ds_read_b128 v[48:51], v7 offset:8192
    s_waitcnt lgkmcnt(2)
    v_mfma_f32_16x16x32_bf16 v[88:91], v[16:19], v[56:59], 0
    ds_read_b128 v[52:55], v7 offset:9216
    s_waitcnt lgkmcnt(2)
    v_mfma_f32_16x16x32_bf16 v[92:95], v[16:19], v[60:63], 0
    ds_read_b128 v[56:59], v7 offset:10240
    s_waitcnt lgkmcnt(2)
    v_mfma_f32_16x16x32_bf16 v[64:67], v[20:23], v[48:51], v[64:67]
    ds_read_b128 v[60:63], v7 offset:11264
    s_waitcnt lgkmcnt(2)
    v_mfma_f32_16x16x32_bf16 v[68:71], v[20:23], v[52:55], v[68:71]
    ds_read_b128 v[48:51], v7 offset:12288
    s_waitcnt lgkmcnt(2)
    v_mfma_f32_16x16x32_bf16 v[72:75], v[20:23], v[56:59], v[72:75]
    ds_read_b128 v[52:55], v7 offset:13312
    s_waitcnt lgkmcnt(2)
    v_mfma_f32_16x16x32_bf16 v[76:79], v[20:23], v[60:63], v[76:79]
    ds_read_b128 v[56:59], v7 offset:14336
    s_waitcnt lgkmcnt(2)
    v_mfma_f32_16x16x32_bf16 v[80:83], v[20:23], v[48:51], v[80:83]
    ds_read_b128 v[60:63], v7 offset:15360
    s_waitcnt lgkmcnt(2)
    v_mfma_f32_16x16x32_bf16 v[84:87], v[20:23], v[52:55], v[84:87]
    ds_read_b128 v[48:51], v7 offset:16384
    s_waitcnt lgkmcnt(2)
    v_mfma_f32_16x16x32_bf16 v[88:91], v[20:23], v[56:59], v[88:91]
    ds_read_b128 v[52:55], v7 offset:17408
    s_waitcnt lgkmcnt(2)
    v_mfma_f32_16x16x32_bf16 v[92:95], v[20:23], v[60:63], v[92:95]
    ds_read_b128 v[56:59], v7 offset:18432
    s_waitcnt lgkmcnt(2)
    v_mfma_f32_16x16x32_bf16 v[64:67], v[24:27], v[48:51], v[64:67]
    ds_read_b128 v[60:63], v7 offset:19456
    s_waitcnt lgkmcnt(2)
    v_mfma_f32_16x16x32_bf16 v[68:71], v[24:27], v[52:55], v[68:71]
    ds_read_b128 v[48:51], v7 offset:20480
    s_waitcnt lgkmcnt(2)
    v_mfma_f32_16x16x32_bf16 v[72:75], v[24:27], v[56:59], v[72:75]
    ds_read_b128 v[52:55], v7 offset:21504
    s_waitcnt lgkmcnt(2)
    v_mfma_f32_16x16x32_bf16 v[76:79], v[24:27], v[60:63], v[76:79]
    ds_read_b128 v[56:59], v7 offset:22528
    s_waitcnt lgkmcnt(2)
    v_mfma_f32_16x16x32_bf16 v[80:83], v[24:27], v[48:51], v[80:83]
    ds_read_b128 v[60:63], v7 offset:23552
    s_waitcnt lgkmcnt(2)
    v_mfma_f32_16x16x32_bf16 v[84:87], v[24:27], v[52:55], v[84:87]
    ds_read_b128 v[48:51], v7 offset:24576
    s_waitcnt lgkmcnt(2)
    v_mfma_f32_16x16x32_bf16 v[88:91], v[24:27], v[56:59], v[88:91]
    ds_read_b128 v[52:55], v7 offset:25600
    s_waitcnt lgkmcnt(2)
    v_mfma_f32_16x16x32_bf16 v[92:95], v[24:27], v[60:63], v[92:95]
    ds_read_b128 v[56:59], v7 offset:26624
    s_waitcnt lgkmcnt(2)
    v_mfma_f32_16x16x32_bf16 v[64:67], v[28:31], v[48:51], v[64:67]
    ds_read_b128 v[60:63], v7 offset:27648
    s_waitcnt lgkmcnt(2)
    v_mfma_f32_16x16x32_bf16 v[68:71], v[28:31], v[52:55], v[68:71]
    ds_read_b128 v[48:51], v7 offset:28672
    s_waitcnt lgkmcnt(2)
    v_mfma_f32_16x16x32_bf16 v[72:75], v[28:31], v[56:59], v[72:75]
    ds_read_b128 v[52:55], v7 offset:29696
    s_waitcnt lgkmcnt(2)
    v_mfma_f32_16x16x32_bf16 v[76:79], v[28:31], v[60:63], v[76:79]
    ds_read_b128 v[56:59], v7 offset:30720
    s_waitcnt lgkmcnt(2)
    v_mfma_f32_16x16x32_bf16 v[80:83], v[28:31], v[48:51], v[80:83]
    ds_read_b128 v[60:63], v7 offset:31744
    s_waitcnt lgkmcnt(2)
    v_mfma_f32_16x16x32_bf16 v[84:87], v[28:31], v[52:55], v[84:87]
    ds_read_b128 v[48:51], v7 offset:0
    s_waitcnt lgkmcnt(2)
    v_mfma_f32_16x16x32_bf16 v[88:91], v[28:31], v[56:59], v[88:91]
    ds_read_b128 v[52:55], v7 offset:1024
    s_waitcnt lgkmcnt(2)
    v_mfma_f32_16x16x32_bf16 v[92:95], v[28:31], v[60:63], v[92:95]
    ds_read_b128 v[56:59], v7 offset:2048
    s_waitcnt lgkmcnt(2)
    v_mfma_f32_16x16x32_bf16 v[96:99], v[32:35], v[48:51], 0
    ds_read_b128 v[60:63], v7 offset:3072
    s_waitcnt lgkmcnt(2)
    v_mfma_f32_16x16x32_bf16 v[100:103], v[32:35], v[52:55], 0
    ds_read_b128 v[48:51], v7 offset:4096
    s_waitcnt lgkmcnt(2)
    v_mfma_f32_16x16x32_bf16 v[104:107], v[32:35], v[56:59], 0
    ds_read_b128 v[52:55], v7 offset:5120
    s_waitcnt lgkmcnt(2)
    v_mfma_f32_16x16x32_bf16 v[108:111], v[32:35], v[60:63], 0
    ds_read_b128 v[56:59], v7 offset:6144
    v_cvt_pk_bf16_f32 v16, v64, v68
    s_waitcnt lgkmcnt(2)
    v_mfma_f32_16x16x32_bf16 v[112:115], v[32:35], v[48:51], 0
    ds_read_b128 v[60:63], v7 offset:7168
    v_cvt_pk_bf16_f32 v17, v72, v76
    s_waitcnt lgkmcnt(2)
    v_mfma_f32_16x16x32_bf16 v[116:119], v[32:35], v[52:55], 0
    ds_read_b128 v[48:51], v7 offset:8192
    v_cvt_pk_bf16_f32 v18, v80, v84
    s_waitcnt lgkmcnt(2)
    v_mfma_f32_16x16x32_bf16 v[120:123], v[32:35], v[56:59], 0
    ds_read_b128 v[52:55], v7 offset:9216
    v_cvt_pk_bf16_f32 v19, v88, v92
    s_waitcnt lgkmcnt(2)
    v_mfma_f32_16x16x32_bf16 v[124:127], v[32:35], v[60:63], 0
    ds_read_b128 v[56:59], v7 offset:10240
    v_and_or_b32 v16, v16, -2, s27
    s_waitcnt lgkmcnt(2)
    v_mfma_f32_16x16x32_bf16 v[96:99], v[36:39], v[48:51], v[96:99]
    ds_read_b128 v[60:63], v7 offset:11264
    s_add_u32 s36, s25, 0x0
    s_waitcnt lgkmcnt(2)
    v_mfma_f32_16x16x32_bf16 v[100:103], v[36:39], v[52:55], v[100:103]
    ds_read_b128 v[48:51], v7 offset:12288
    buffer_store_dwordx4 v[16:19], v10, s[8:11], s36 offen sc1
    s_waitcnt lgkmcnt(2)
    v_mfma_f32_16x16x32_bf16 v[104:107], v[36:39], v[56:59], v[104:107]
    ds_read_b128 v[52:55], v7 offset:13312
    v_cvt_pk_bf16_f32 v20, v65, v69
    s_waitcnt lgkmcnt(2)
    v_mfma_f32_16x16x32_bf16 v[108:111], v[36:39], v[60:63], v[108:111]
    ds_read_b128 v[56:59], v7 offset:14336
    v_cvt_pk_bf16_f32 v21, v73, v77
    s_waitcnt lgkmcnt(2)
    v_mfma_f32_16x16x32_bf16 v[112:115], v[36:39], v[48:51], v[112:115]
    ds_read_b128 v[60:63], v7 offset:15360
    v_cvt_pk_bf16_f32 v22, v81, v85
    s_waitcnt lgkmcnt(2)
    v_mfma_f32_16x16x32_bf16 v[116:119], v[36:39], v[52:55], v[116:119]
    ds_read_b128 v[48:51], v7 offset:16384
    v_cvt_pk_bf16_f32 v23, v89, v93
    s_waitcnt lgkmcnt(2)
    v_mfma_f32_16x16x32_bf16 v[120:123], v[36:39], v[56:59], v[120:123]
    ds_read_b128 v[52:55], v7 offset:17408
    v_and_or_b32 v20, v20, -2, s27
    s_waitcnt lgkmcnt(2)
    v_mfma_f32_16x16x32_bf16 v[124:127], v[36:39], v[60:63], v[124:127]
    ds_read_b128 v[56:59], v7 offset:18432
    s_add_u32 s36, s25, 0x8000
    s_waitcnt lgkmcnt(2)
    v_mfma_f32_16x16x32_bf16 v[96:99], v[40:43], v[48:51], v[96:99]
    ds_read_b128 v[60:63], v7 offset:19456
    buffer_store_dwordx4 v[20:23], v10, s[8:11], s36 offen sc1
    s_waitcnt lgkmcnt(2)
    v_mfma_f32_16x16x32_bf16 v[100:103], v[40:43], v[52:55], v[100:103]
    ds_read_b128 v[48:51], v7 offset:20480
    v_cvt_pk_bf16_f32 v24, v66, v70
    s_waitcnt lgkmcnt(2)
    v_mfma_f32_16x16x32_bf16 v[104:107], v[40:43], v[56:59], v[104:107]
    ds_read_b128 v[52:55], v7 offset:21504
    v_cvt_pk_bf16_f32 v25, v74, v78
    s_waitcnt lgkmcnt(2)
    v_mfma_f32_16x16x32_bf16 v[108:111], v[40:43], v[60:63], v[108:111]
    ds_read_b128 v[56:59], v7 offset:22528
    v_cvt_pk_bf16_f32 v26, v82, v86
    s_waitcnt lgkmcnt(2)
    v_mfma_f32_16x16x32_bf16 v[112:115], v[40:43], v[48:51], v[112:115]
    ds_read_b128 v[60:63], v7 offset:23552
    v_cvt_pk_bf16_f32 v27, v90, v94
    s_waitcnt lgkmcnt(2)
    v_mfma_f32_16x16x32_bf16 v[116:119], v[40:43], v[52:55], v[116:119]
    ds_read_b128 v[48:51], v7 offset:24576
    v_and_or_b32 v24, v24, -2, s27
    s_waitcnt lgkmcnt(2)
    v_mfma_f32_16x16x32_bf16 v[120:123], v[40:43], v[56:59], v[120:123]
    ds_read_b128 v[52:55], v7 offset:25600
    s_add_u32 s36, s25, 0x10000
    s_waitcnt lgkmcnt(2)
    v_mfma_f32_16x16x32_bf16 v[124:127], v[40:43], v[60:63], v[124:127]
    ds_read_b128 v[56:59], v7 offset:26624
    buffer_store_dwordx4 v[24:27], v10, s[8:11], s36 offen sc1
    s_waitcnt lgkmcnt(2)
    v_mfma_f32_16x16x32_bf16 v[96:99], v[44:47], v[48:51], v[96:99]
    ds_read_b128 v[60:63], v7 offset:27648
    v_cvt_pk_bf16_f32 v28, v67, v71
    s_waitcnt lgkmcnt(2)
    v_mfma_f32_16x16x32_bf16 v[100:103], v[44:47], v[52:55], v[100:103]
    ds_read_b128 v[48:51], v7 offset:28672
    v_cvt_pk_bf16_f32 v29, v75, v79
    s_waitcnt lgkmcnt(2)
    v_mfma_f32_16x16x32_bf16 v[104:107], v[44:47], v[56:59], v[104:107]
    ds_read_b128 v[52:55], v7 offset:29696
    v_cvt_pk_bf16_f32 v30, v83, v87
    s_waitcnt lgkmcnt(2)
    v_mfma_f32_16x16x32_bf16 v[108:111], v[44:47], v[60:63], v[108:111]
    ds_read_b128 v[56:59], v7 offset:30720
    v_cvt_pk_bf16_f32 v31, v91, v95
    s_waitcnt lgkmcnt(2)
    v_mfma_f32_16x16x32_bf16 v[112:115], v[44:47], v[48:51], v[112:115]
    ds_read_b128 v[60:63], v7 offset:31744
    v_and_or_b32 v28, v28, -2, s27
    s_waitcnt lgkmcnt(2)
    v_mfma_f32_16x16x32_bf16 v[116:119], v[44:47], v[52:55], v[116:119]
    s_add_u32 s36, s25, 0x18000
    s_waitcnt lgkmcnt(1)
    v_mfma_f32_16x16x32_bf16 v[120:123], v[44:47], v[56:59], v[120:123]
    buffer_store_dwordx4 v[28:31], v10, s[8:11], s36 offen sc1
    s_waitcnt lgkmcnt(0)
    v_mfma_f32_16x16x32_bf16 v[124:127], v[44:47], v[60:63], v[124:127]
    v_cvt_pk_bf16_f32 v32, v96, v100
    v_cvt_pk_bf16_f32 v33, v104, v108
    v_cvt_pk_bf16_f32 v34, v112, v116
    s_nop 4
    v_cvt_pk_bf16_f32 v35, v120, v124
    v_and_or_b32 v32, v32, -2, s27
    s_add_u32 s36, s25, 0x80000
    buffer_store_dwordx4 v[32:35], v10, s[8:11], s36 offen sc1
    v_cvt_pk_bf16_f32 v36, v97, v101
    v_cvt_pk_bf16_f32 v37, v105, v109
    v_cvt_pk_bf16_f32 v38, v113, v117
    v_cvt_pk_bf16_f32 v39, v121, v125
    v_and_or_b32 v36, v36, -2, s27
    s_add_u32 s36, s25, 0x88000
    buffer_store_dwordx4 v[36:39], v10, s[8:11], s36 offen sc1
    v_cvt_pk_bf16_f32 v40, v98, v102
    v_cvt_pk_bf16_f32 v41, v106, v110
    v_cvt_pk_bf16_f32 v42, v114, v118
    v_cvt_pk_bf16_f32 v43, v122, v126
    v_and_or_b32 v40, v40, -2, s27
    s_add_u32 s36, s25, 0x90000
    buffer_store_dwordx4 v[40:43], v10, s[8:11], s36 offen sc1
    v_cvt_pk_bf16_f32 v44, v99, v103
    v_cvt_pk_bf16_f32 v45, v107, v111
    v_cvt_pk_bf16_f32 v46, v115, v119
    v_cvt_pk_bf16_f32 v47, v123, v127
    v_and_or_b32 v44, v44, -2, s27
    s_add_u32 s36, s25, 0x98000
    buffer_store_dwordx4 v[44:47], v10, s[8:11], s36 offen sc1
    s_add_u32 s38, s23, 6
    s_cmp_ge_u32 s38, 64
    s_cbranch_scc1 L_P2_last
    s_mul_i32 s24, s38, 0x82100
    s_lshl_b32 s36, s20, 14
    s_add_u32 s24, s24, s36
    s_add_u32 s24, s24, 0x1000000
    s_add_u32 s36, s24, 0
    s_add_u32 s37, s36, 0x7000000
    buffer_load_dwordx4 a[32:35], v1, s[8:11], s36 offen offset:0 sc1
    buffer_load_dwordx4 a[0:3], v1, s[8:11], s37 offen offset:0 sc1
    buffer_load_dwordx4 a[36:39], v1, s[8:11], s36 offen offset:1024 sc1
    buffer_load_dwordx4 a[4:7], v1, s[8:11], s37 offen offset:1024 sc1
    buffer_load_dwordx4 a[40:43], v1, s[8:11], s36 offen offset:2048 sc1
    buffer_load_dwordx4 a[8:11], v1, s[8:11], s37 offen offset:2048 sc1
    buffer_load_dwordx4 a[44:47], v1, s[8:11], s36 offen offset:3072 sc1
    buffer_load_dwordx4 a[12:15], v1, s[8:11], s37 offen offset:3072 sc1
    s_add_u32 s36, s24, 4096
    s_add_u32 s37, s36, 0x7000000
    buffer_load_dwordx4 a[48:51], v1, s[8:11], s36 offen offset:0 sc1
    buffer_load_dwordx4 a[16:19], v1, s[8:11], s37 offen offset:0 sc1
    buffer_load_dwordx4 a[52:55], v1, s[8:11], s36 offen offset:1024 sc1
    buffer_load_dwordx4 a[20:23], v1, s[8:11], s37 offen offset:1024 sc1
    buffer_load_dwordx4 a[56:59], v1, s[8:11], s36 offen offset:2048 sc1
    buffer_load_dwordx4 a[24:27], v1, s[8:11], s37 offen offset:2048 sc1
    buffer_load_dwordx4 a[60:63], v1, s[8:11], s36 offen offset:3072 sc1
    buffer_load_dwordx4 a[28:31], v1, s[8:11], s37 offen offset:3072 sc1
    s_lshr_b32 s36, s21, 1
    s_lshl_b32 s36, s36, 3
    s_xor_b32 s37, s36, 8
    s_add_u32 s24, s24, 8192
    s_add_u32 s36, s36, s24
    s_add_u32 s37, s37, s24
    buffer_load_dwordx2 a[64:65], v2, s[8:11], s36 offen offset:0 sc1
    buffer_load_dwordx2 a[66:67], v2, s[8:11], s37 offen offset:0 sc1
    buffer_load_dwordx2 a[68:69], v2, s[8:11], s36 offen offset:1024 sc1
    buffer_load_dwordx2 a[70:71], v2, s[8:11], s37 offen offset:1024 sc1
L_P2_last:
    s_lshl_b32 s24, s23, 5
    s_add_u32 s24, s24, s20
    s_lshl_b32 s24, s24, 10
    v_accvgpr_read_b32 v52, a72
    v_accvgpr_read_b32 v53, a73
    v_and_b32 v15, 15, v0
    v_mov_b32 v48, 0
    v_mov_b32 v14, 0x3f80
    v_cmp_eq_u32 vcc, 0, v15
    s_nop 1
    v_cndmask_b32 v48, v48, v14, vcc
    v_mov_b32 v14, 0x3f800000
    v_cmp_eq_u32 vcc, 1, v15
    s_nop 1
    v_cndmask_b32 v48, v48, v14, vcc
    v_mov_b32 v49, 0
    v_mov_b32 v14, 0x3f80
    v_cmp_eq_u32 vcc, 4, v15
    s_nop 1
    v_cndmask_b32 v49, v49, v14, vcc
    v_mov_b32 v14, 0x3f800000
    v_cmp_eq_u32 vcc, 5, v15
    s_nop 1
    v_cndmask_b32 v49, v49, v14, vcc
    v_mov_b32 v50, 0
    v_mov_b32 v14, 0x3f80
    v_cmp_eq_u32 vcc, 8, v15
    s_nop 1
    v_cndmask_b32 v50, v50, v14, vcc
    v_mov_b32 v14, 0x3f800000
    v_cmp_eq_u32 vcc, 9, v15
    s_nop 1
    v_cndmask_b32 v50, v50, v14, vcc
    v_mov_b32 v51, 0
    v_mov_b32 v14, 0x3f80
    v_cmp_eq_u32 vcc, 12, v15
    s_nop 1
    v_cndmask_b32 v51, v51, v14, vcc
    v_mov_b32 v14, 0x3f800000
    v_cmp_eq_u32 vcc, 13, v15
    s_nop 1
    v_cndmask_b32 v51, v51, v14, vcc
    s_lshl_b32 s25, s20, 15
    s_add_u32 s25, s25, s26
L_P3_poll:
    s_add_u32 s36, s25, 0
    buffer_load_dwordx4 v[80:83], v11, s[8:11], s36 offen sc1
    s_add_u32 s36, s25, 4096
    buffer_load_dwordx4 v[84:87], v11, s[8:11], s36 offen sc1
    s_add_u32 s36, s25, 8192
    buffer_load_dwordx4 v[88:91], v11, s[8:11], s36 offen sc1
    s_add_u32 s36, s25, 12288
    buffer_load_dwordx4 v[92:95], v11, s[8:11], s36 offen sc1
    s_add_u32 s36, s25, 16384
    buffer_load_dwordx4 v[96:99], v11, s[8:11], s36 offen sc1
    s_add_u32 s36, s25, 20480
    buffer_load_dwordx4 v[100:103], v11, s[8:11], s36 offen sc1
    s_add_u32 s36, s25, 24576
    buffer_load_dwordx4 v[104:107], v11, s[8:11], s36 offen sc1
    s_add_u32 s36, s25, 28672
    buffer_load_dwordx4 v[108:111], v11, s[8:11], s36 offen sc1
    s_mov_b64 exec, -1
    s_add_u32 s32, s32, 1
    s_cmp_gt_u32 s32, 200000
    s_waitcnt vmcnt(7)
    v_mfma_f32_16x16x32_bf16 v[56:59], v[48:51], v[80:83], 0
    s_waitcnt vmcnt(6)
    v_mfma_f32_16x16x32_bf16 v[56:59], v[48:51], v[84:87], v[56:59]
    v_bitop3_b32 v60, v80, v84, s27 bitop3:0x7e
    s_waitcnt vmcnt(5)
    v_mfma_f32_16x16x32_bf16 v[56:59], v[48:51], v[88:91], v[56:59]
    s_waitcnt vmcnt(4)
    v_mfma_f32_16x16x32_bf16 v[56:59], v[48:51], v[92:95], v[56:59]
    v_bitop3_b32 v61, v88, v92, s27 bitop3:0x7e
    s_waitcnt vmcnt(3)
    v_mfma_f32_16x16x32_bf16 v[56:59], v[48:51], v[96:99], v[56:59]
    s_waitcnt vmcnt(2)
    v_mfma_f32_16x16x32_bf16 v[56:59], v[48:51], v[100:103], v[56:59]
    v_bitop3_b32 v62, v96, v100, s27 bitop3:0x7e
    s_waitcnt vmcnt(1)
    v_mfma_f32_16x16x32_bf16 v[56:59], v[48:51], v[104:107], v[56:59]
    s_waitcnt vmcnt(0)
    v_mfma_f32_16x16x32_bf16 v[56:59], v[48:51], v[108:111], v[56:59]
    v_bitop3_b32 v63, v104, v108, s27 bitop3:0x7e
    v_or3_b32 v14, v60, v61, v62
    v_bitop3_b32 v14, v14, v63, 1 bitop3:0xa8
    s_cbranch_scc1 L_P3_got
    v_cmp_ne_u32 vcc, 0, v14
    s_cbranch_vccz L_P3_got
    s_mov_b64 exec, vcc
    s_branch L_P3_poll
L_P3_got:
    s_nop 4
    v_cvt_pk_bf16_f32 v62, v56, v57
    v_lshlrev_b32 v65, 16, v62
    v_and_b32 v66, 0xffff0000, v62
    v_lshlrev_b32 v60, 16, v52
    v_and_b32 v61, 0xffff0000, v52
    v_add_f32 v60, v60, v65
    v_add_f32 v61, v61, v66
    v_cvt_pk_bf16_f32 v62, v60, v61
    v_lshlrev_b32 v60, 16, v62
    v_and_b32 v61, 0xffff0000, v62
    v_add_f32 v63, v60, v61
    v_mul_f32 v64, v60, v60
    v_fmac_f32 v64, v61, v61
    v_add_f32_dpp v63, v63, v63 quad_perm:[1,0,3,2] row_mask:0xf bank_mask:0xf
    s_nop 0
    v_add_f32_dpp v64, v64, v64 quad_perm:[1,0,3,2] row_mask:0xf bank_mask:0xf
    v_add_f32_dpp v63, v63, v63 quad_perm:[2,3,0,1] row_mask:0xf bank_mask:0xf
    s_nop 0
    v_add_f32_dpp v64, v64, v64 quad_perm:[2,3,0,1] row_mask:0xf bank_mask:0xf
    v_add_f32_dpp v63, v63, v63 row_half_mirror row_mask:0xf bank_mask:0xf
    s_nop 0
    v_add_f32_dpp v64, v64, v64 row_half_mirror row_mask:0xf bank_mask:0xf
    v_add_f32_dpp v63, v63, v63 row_mirror row_mask:0xf bank_mask:0xf
    s_nop 0
    v_add_f32_dpp v64, v64, v64 row_mirror row_mask:0xf bank_mask:0xf
    v_mov_b32 v14, v63
    s_nop 1
    v_permlane16_swap_b32 v63, v14
    v_add_f32 v63, v63, v14
    v_mov_b32 v14, v64
    s_nop 1
    v_permlane16_swap_b32 v64, v14
    v_add_f32 v64, v64, v14
    v_mov_b32 v14, v63
    s_nop 1
    v_permlane32_swap_b32 v63, v14
    v_add_f32 v63, v63, v14
    v_mov_b32 v14, v64
    s_nop 1
    v_permlane32_swap_b32 v64, v14
    v_add_f32 v64, v64, v14
    v_mov_b32 v15, s21
    v_lshlrev_b32 v15, 3, v15
    v_add_u32 v15, 28672, v15
    ds_write2_b32 v15, v63, v64 offset0:0 offset1:1
    s_add_u32 s36, s24, 0x400000
    buffer_store_dword v62, v12, s[8:11], s36 offen sc1
    s_waitcnt lgkmcnt(0)
    s_barrier
    v_mov_b32 v15, 28672
    ds_read_b128 v[68:71], v15
    ds_read_b128 v[72:75], v15 offset:16
    s_waitcnt lgkmcnt(0)
    v_add_f32 v63, v68, v70
    v_add_f32 v63, v63, v72
    v_add_f32 v63, v63, v74
    v_mul_f32 v63, 0x3b000000, v63
    v_add_f32 v64, v69, v71
    v_add_f32 v64, v64, v73
    v_add_f32 v64, v64, v75
    v_mul_f32 v64, 0x3b000000, v64
    v_fma_f32 v64, -v63, v63, v64
    v_max_f32 v64, 0, v64
    v_cvt_pk_bf16_f32 v14, v63, v64
    v_lshlrev_b32 v63, 16, v14
    v_and_b32 v64, 0xffff0000, v14
    v_add_f32 v64, 0x3727c5ac, v64
    v_cvt_pk_bf16_f32 v14, v64, v64
    v_lshlrev_b32 v64, 16, v14
    v_sqrt_f32 v64, v64
    s_nop 0
    v_cvt_pk_bf16_f32 v14, v64, v64
    v_lshlrev_b32 v64, 16, v14
    v_rcp_f32 v64, v64
    v_sub_f32 v65, v60, v63
    v_sub_f32 v66, v61, v63
    v_cvt_pk_bf16_f32 v14, v65, v66
    v_lshlrev_b32 v65, 16, v14
    v_and_b32 v66, 0xffff0000, v14
    v_mul_f32 v65, v65, v64
    v_mul_f32 v66, v66, v64
    v_cvt_pk_bf16_f32 v67, v65, v66
    v_lshlrev_b32 v65, 16, v67
    v_and_b32 v66, 0xffff0000, v67
    v_lshlrev_b32 v68, 16, v53
    v_and_b32 v69, 0xffff0000, v53
    v_mul_f32 v63, v65, v68
    v_fmac_f32 v63, v66, v69
    s_nop 1
    v_add_f32_dpp v63, v63, v63 quad_perm:[1,0,3,2] row_mask:0xf bank_mask:0xf
    s_nop 1
    v_add_f32_dpp v63, v63, v63 quad_perm:[2,3,0,1] row_mask:0xf bank_mask:0xf
    s_nop 1
    v_add_f32_dpp v63, v63, v63 row_half_mirror row_mask:0xf bank_mask:0xf
    s_nop 1
    v_add_f32_dpp v63, v63, v63 row_mirror row_mask:0xf bank_mask:0xf
    v_mov_b32 v14, v63
    s_nop 1
    v_permlane16_swap_b32 v63, v14
    v_add_f32 v63, v63, v14
    v_mov_b32 v14, v63
    s_nop 1
    v_permlane32_swap_b32 v63, v14
    v_add_f32 v63, v63, v14
    s_lshr_b32 s25, s24, 6
    s_lshl_b32 s37, s21, 2
    s_add_u32 s25, s25, s37
    s_add_u32 s36, s25, 0x194000
    v_cmp_ne_u32 vcc, 0, v1
    v_mov_b32 v15, 0x40000000
    s_nop 0
    v_cndmask_b32 v15, v1, v15, vcc
    buffer_store_dword v63, v15, s[8:11], s36 offen sc1
    v_add_f32 v60, v60, v65
    v_add_f32 v61, v61, v66
    v_cvt_pk_bf16_f32 v62, v60, v61
    buffer_store_dword v62, v12, s[60:63], s24 offen sc1
    s_add_u32 s36, s24, 0x600000
    buffer_store_dword v67, v12, s[8:11], s36 offen sc1
    s_add_u32 s30, s25, 0x1b8000
    s_add_u32 s29, s29, 1
    s_barrier
    s_add_u32 s23, s23, 6
    s_cmp_lt_u32 s23, 64
    s_cbranch_scc1 L_P2
    s_waitcnt vmcnt(0)
    v_cmp_ne_u32 vcc, 0, v1
    v_mov_b32 v15, 0x40000000
    v_mov_b32 v14, 0
    v_cndmask_b32 v15, v1, v15, vcc
    buffer_store_dword v14, v15, s[8:11], s30 offen sc1
    s_branch L_end
L_mlp:
    s_mov_b32 s12, s44
    s_and_b32 s13, s45, 0xffff
    s_mov_b32 s14, 0x200000
    s_mov_b32 s15, 0x20000
    s_mov_b32 s60, s82
    s_and_b32 s61, s83, 0xffff
    s_mov_b32 s62, 0x200000
    s_mov_b32 s63, 0x20000
    s_mov_b32 s92, s80
    s_and_b32 s93, s81, 0xffff
    s_mov_b32 s94, 0x400
    s_mov_b32 s95, 0x20000
    v_mov_b32 v1, 0x0
    v_bfe_u32 v14, v0, 0, 1
    s_mov_b32 s38, 0x10
    v_mad_u32_u24 v1, v14, s38, v1
    v_bfe_u32 v14, v0, 1, 1
    s_mov_b32 s38, 0x20
    v_mad_u32_u24 v1, v14, s38, v1
    v_bfe_u32 v14, v0, 2, 1
    s_mov_b32 s38, 0x40
    v_mad_u32_u24 v1, v14, s38, v1
    v_bfe_u32 v14, v0, 3, 1
    s_mov_b32 s38, 0x80
    v_mad_u32_u24 v1, v14, s38, v1
    v_bfe_u32 v14, v0, 4, 1
    s_mov_b32 s38, 0x100
    v_mad_u32_u24 v1, v14, s38, v1
    v_bfe_u32 v14, v0, 5, 1
    s_mov_b32 s38, 0x200
    v_mad_u32_u24 v1, v14, s38, v1
    v_mov_b32 v2, 0x0
    v_bfe_u32 v14, v0, 0, 1
    s_mov_b32 s38, 0x10
    v_mad_u32_u24 v2, v14, s38, v2
    v_bfe_u32 v14, v0, 1, 1
    s_mov_b32 s38, 0x20
    v_mad_u32_u24 v2, v14, s38, v2
    v_bfe_u32 v14, v0, 2, 1
    s_mov_b32 s38, 0x40
    v_mad_u32_u24 v2, v14, s38, v2
    v_bfe_u32 v14, v0, 3, 1
    s_mov_b32 s38, 0x80
    v_mad_u32_u24 v2, v14, s38, v2
    v_bfe_u32 v14, v0, 4, 1
    s_mov_b32 s38, 0x100
    v_mad_u32_u24 v2, v14, s38, v2
    v_bfe_u32 v14, v0, 5, 1
    s_mov_b32 s38, 0x200
    v_mad_u32_u24 v2, v14, s38, v2
    v_bfe_u32 v14, v0, 6, 1
    s_mov_b32 s38, 0x800
    v_mad_u32_u24 v2, v14, s38, v2
    v_bfe_u32 v14, v0, 7, 1
    s_mov_b32 s38, 0x1000
    v_mad_u32_u24 v2, v14, s38, v2
    v_mov_b32 v9, 0x0
    v_bfe_u32 v14, v0, 0, 1
    s_mov_b32 s38, 0x10
    v_mad_u32_u24 v9, v14, s38, v9
    v_bfe_u32 v14, v0, 1, 1
    s_mov_b32 s38, 0x20
    v_mad_u32_u24 v9, v14, s38, v9
    v_bfe_u32 v14, v0, 2, 1
    s_mov_b32 s38, 0x40
    v_mad_u32_u24 v9, v14, s38, v9
    v_bfe_u32 v14, v0, 3, 1
    s_mov_b32 s38, 0x80
    v_mad_u32_u24 v9, v14, s38, v9
    v_bfe_u32 v14, v0, 4, 1
    s_mov_b32 s38, 0x100
    v_mad_u32_u24 v9, v14, s38, v9
    v_bfe_u32 v14, v0, 5, 1
    s_mov_b32 s38, 0x200
    v_mad_u32_u24 v9, v14, s38, v9
    v_bfe_u32 v14, v0, 6, 1
    s_mov_b32 s38, 0x400
    v_mad_u32_u24 v9, v14, s38, v9
    v_bfe_u32 v14, v0, 7, 1
    s_mov_b32 s38, 0x800
    v_mad_u32_u24 v9, v14, s38, v9
    v_mov_b32 v7, 0x8000
    v_bfe_u32 v14, v0, 0, 1
    s_mov_b32 s38, 0x10
    v_mad_u32_u24 v7, v14, s38, v7
    v_bfe_u32 v14, v0, 1, 1
    s_mov_b32 s38, 0x20
    v_mad_u32_u24 v7, v14, s38, v7
    v_bfe_u32 v14, v0, 2, 1
    s_mov_b32 s38, 0x40
    v_mad_u32_u24 v7, v14, s38, v7
    v_bfe_u32 v14, v0, 3, 1
    s_mov_b32 s38, 0x80
    v_mad_u32_u24 v7, v14, s38, v7
    v_bfe_u32 v14, v0, 4, 1
    s_mov_b32 s38, 0x100
    v_mad_u32_u24 v7, v14, s38, v7
    v_bfe_u32 v14, v0, 5, 1
    s_mov_b32 s38, 0x200
    v_mad_u32_u24 v7, v14, s38, v7
    v_bfe_u32 v14, v0, 6, 1
    s_mov_b32 s38, 0x8000
    v_mad_u32_u24 v7, v14, s38, v7
    v_bfe_u32 v14, v0, 7, 1
    s_mov_b32 s38, 0x10000
    v_mad_u32_u24 v7, v14, s38, v7
    v_mov_b32 v3, 0x0
    v_bfe_u32 v14, v0, 0, 1
    s_mov_b32 s38, 0x10
    v_mad_u32_u24 v3, v14, s38, v3
    v_bfe_u32 v14, v0, 1, 1
    s_mov_b32 s38, 0x20
    v_mad_u32_u24 v3, v14, s38, v3
    v_bfe_u32 v14, v0, 2, 1
    s_mov_b32 s38, 0x40
    v_mad_u32_u24 v3, v14, s38, v3
    v_bfe_u32 v14, v0, 3, 1
    s_mov_b32 s38, 0x400
    v_mad_u32_u24 v3, v14, s38, v3
    v_bfe_u32 v14, v0, 4, 1
    s_mov_b32 s38, 0x800
    v_mad_u32_u24 v3, v14, s38, v3
    v_bfe_u32 v14, v0, 5, 1
    s_mov_b32 s38, 0x1000
    v_mad_u32_u24 v3, v14, s38, v3
    v_bfe_u32 v14, v0, 6, 1
    s_mov_b32 s38, 0x2000
    v_mad_u32_u24 v3, v14, s38, v3
    v_bfe_u32 v14, v0, 7, 1
    s_mov_b32 s38, 0x4000
    v_mad_u32_u24 v3, v14, s38, v3
    v_mov_b32 v4, 0x0
    v_bfe_u32 v14, v0, 0, 1
    s_mov_b32 s38, 0x100
    v_mad_u32_u24 v4, v14, s38, v4
    v_bfe_u32 v14, v0, 1, 1
    s_mov_b32 s38, 0x200
    v_mad_u32_u24 v4, v14, s38, v4
    v_bfe_u32 v14, v0, 2, 1
    s_mov_b32 s38, 0x400
    v_mad_u32_u24 v4, v14, s38, v4
    v_bfe_u32 v14, v0, 6, 1
    s_mov_b32 s38, 0x80
    v_mad_u32_u24 v4, v14, s38, v4
    v_bfe_u32 v14, v0, 7, 1
    s_mov_b32 s38, 0x4000
    v_mad_u32_u24 v4, v14, s38, v4
    v_lshrrev_b32 v15, 3, v0
    v_xor_b32 v15, v15, v0
    v_and_b32 v15, 7, v15
    v_lshl_add_u32 v4, v15, 4, v4
    v_bfe_u32 v15, v0, 4, 2
    v_lshlrev_b32 v15, 4, v15
    v_xor_b32 v5, v15, v1
    v_xor_b32 v6, 64, v5
    v_mov_b32 v8, 0x5000
    v_bfe_u32 v14, v0, 0, 1
    s_mov_b32 s38, 0x10
    v_mad_u32_u24 v8, v14, s38, v8
    v_bfe_u32 v14, v0, 1, 1
    s_mov_b32 s38, 0x40
    v_mad_u32_u24 v8, v14, s38, v8
    v_bfe_u32 v14, v0, 2, 1
    s_mov_b32 s38, 0x80
    v_mad_u32_u24 v8, v14, s38, v8
    v_bfe_u32 v14, v0, 4, 1
    s_mov_b32 s38, 0x20
    v_mad_u32_u24 v8, v14, s38, v8
    v_bfe_u32 v14, v0, 5, 1
    s_mov_b32 s38, 0x100
    v_mad_u32_u24 v8, v14, s38, v8
    v_mov_b32 v10, 0x0
    v_bfe_u32 v14, v0, 0, 1
    s_mov_b32 s38, 0x10
    v_mad_u32_u24 v10, v14, s38, v10
    v_bfe_u32 v14, v0, 1, 1
    s_mov_b32 s38, 0x20
    v_mad_u32_u24 v10, v14, s38, v10
    v_bfe_u32 v14, v0, 2, 1
    s_mov_b32 s38, 0x40
    v_mad_u32_u24 v10, v14, s38, v10
    v_bfe_u32 v14, v0, 3, 1
    s_mov_b32 s38, 0x80
    v_mad_u32_u24 v10, v14, s38, v10
    v_bfe_u32 v14, v0, 4, 1
    s_mov_b32 s38, 0x20000
    v_mad_u32_u24 v10, v14, s38, v10
    v_bfe_u32 v14, v0, 5, 1
    s_mov_b32 s38, 0x40000
    v_mad_u32_u24 v10, v14, s38, v10
    v_bfe_u32 v14, v0, 6, 1
    s_mov_b32 s38, 0x100
    v_mad_u32_u24 v10, v14, s38, v10
    v_bfe_u32 v14, v0, 7, 1
    s_mov_b32 s38, 0x200
    v_mad_u32_u24 v10, v14, s38, v10
    v_mov_b32 v11, 0x0
    v_bfe_u32 v14, v0, 0, 1
    s_mov_b32 s38, 0x10
    v_mad_u32_u24 v11, v14, s38, v11
    v_bfe_u32 v14, v0, 1, 1
    s_mov_b32 s38, 0x20
    v_mad_u32_u24 v11, v14, s38, v11
    v_bfe_u32 v14, v0, 2, 1
    s_mov_b32 s38, 0x40
    v_mad_u32_u24 v11, v14, s38, v11
    v_bfe_u32 v14, v0, 3, 1
    s_mov_b32 s38, 0x80
    v_mad_u32_u24 v11, v14, s38, v11
    v_bfe_u32 v14, v0, 4, 1
    s_mov_b32 s38, 0x400
    v_mad_u32_u24 v11, v14, s38, v11
    v_bfe_u32 v14, v0, 5, 1
    s_mov_b32 s38, 0x800
    v_mad_u32_u24 v11, v14, s38, v11
    v_bfe_u32 v14, v0, 6, 1
    s_mov_b32 s38, 0x100
    v_mad_u32_u24 v11, v14, s38, v11
    v_bfe_u32 v14, v0, 7, 1
    s_mov_b32 s38, 0x200
    v_mad_u32_u24 v11, v14, s38, v11
    v_mov_b32 v12, 0x0
    v_bfe_u32 v14, v0, 0, 1
    s_mov_b32 s38, 0x10
    v_mad_u32_u24 v12, v14, s38, v12
    v_bfe_u32 v14, v0, 1, 1
    s_mov_b32 s38, 0x20
    v_mad_u32_u24 v12, v14, s38, v12
    v_bfe_u32 v14, v0, 2, 1
    s_mov_b32 s38, 0x40
    v_mad_u32_u24 v12, v14, s38, v12
    v_bfe_u32 v14, v0, 3, 1
    s_mov_b32 s38, 0x80
    v_mad_u32_u24 v12, v14, s38, v12
    v_bfe_u32 v14, v0, 4, 1
    s_mov_b32 s38, 0x4
    v_mad_u32_u24 v12, v14, s38, v12
    v_bfe_u32 v14, v0, 5, 1
    s_mov_b32 s38, 0x8
    v_mad_u32_u24 v12, v14, s38, v12
    v_bfe_u32 v14, v0, 6, 1
    s_mov_b32 s38, 0x100
    v_mad_u32_u24 v12, v14, s38, v12
    v_bfe_u32 v14, v0, 7, 1
    s_mov_b32 s38, 0x200
    v_mad_u32_u24 v12, v14, s38, v12
    v_mov_b32 v13, 0xf149f2ca
    v_and_b32 v14, 15, v0
    v_bfe_u32 v15, v0, 4, 2
    v_cmp_gt_u32 s[72:73], 2, v15
    v_lshlrev_b32 v15, 2, v15
    v_cmp_le_u32 s[64:65], v15, v14
    v_add_u32 v15, 1, v15
    v_cmp_le_u32 s[66:67], v15, v14
    v_add_u32 v15, 1, v15
    v_cmp_le_u32 s[68:69], v15, v14
    v_add_u32 v15, 1, v15
    v_cmp_le_u32 s[70:71], v15, v14
    v_add_u32 v15, 1, v15
    s_mov_b32 s34, 0x05040100
    s_mov_b32 s35, 0x07060302
    s_mov_b32 s33, 0x3e0293ee
    s_mov_b32 s32, 0
    s_mov_b32 s4, 0x3f803f80
    s_mov_b32 s5, 0x3f803f80
    s_lshr_b32 s20, s2, 3
    s_lshr_b32 s23, s2, 3
    s_lshl_b32 s23, s23, 1
    s_lshl_b32 s36, s23, 15
    buffer_load_dwordx4 v[96:99], v3, s[12:15], s36 offen offset:0
    buffer_load_dwordx4 v[100:103], v3, s[12:15], s36 offen offset:128
    buffer_load_dwordx4 v[104:107], v3, s[12:15], s36 offen offset:256
    buffer_load_dwordx4 v[108:111], v3, s[12:15], s36 offen offset:384
    buffer_load_dwordx4 v[112:115], v3, s[12:15], s36 offen offset:512
    buffer_load_dwordx4 v[116:119], v3, s[12:15], s36 offen offset:640
    buffer_load_dwordx4 v[120:123], v3, s[12:15], s36 offen offset:768
    buffer_load_dwordx4 v[124:127], v3, s[12:15], s36 offen offset:896
    s_add_u32 s36, s36, 0x8000
    buffer_load_dwordx4 v[128:131], v3, s[12:15], s36 offen offset:0
    buffer_load_dwordx4 v[132:135], v3, s[12:15], s36 offen offset:128
    buffer_load_dwordx4 v[136:139], v3, s[12:15], s36 offen offset:256
    buffer_load_dwordx4 v[140:143], v3, s[12:15], s36 offen offset:384
    buffer_load_dwordx4 v[144:147], v3, s[12:15], s36 offen offset:512
    buffer_load_dwordx4 v[148:151], v3, s[12:15], s36 offen offset:640
    buffer_load_dwordx4 v[152:155], v3, s[12:15], s36 offen offset:768
    buffer_load_dwordx4 v[156:159], v3, s[12:15], s36 offen offset:896
    s_mov_b32 s96, s46
    s_and_b32 s97, s47, 0xffff
    s_mov_b32 s98, 0x2000
    s_mov_b32 s99, 0x20000
    v_mov_b32 v68, 0x0
    v_bfe_u32 v14, v0, 0, 1
    s_mov_b32 s38, 0x8
    v_mad_u32_u24 v68, v14, s38, v68
    v_bfe_u32 v14, v0, 1, 1
    s_mov_b32 s38, 0x10
    v_mad_u32_u24 v68, v14, s38, v68
    v_bfe_u32 v14, v0, 2, 1
    s_mov_b32 s38, 0x10000
    v_mad_u32_u24 v68, v14, s38, v68
    v_bfe_u32 v14, v0, 3, 1
    s_mov_b32 s38, 0x10000
    v_mad_u32_u24 v68, v14, s38, v68
    v_bfe_u32 v14, v0, 4, 1
    s_mov_b32 s38, 0x400
    v_mad_u32_u24 v68, v14, s38, v68
    v_bfe_u32 v14, v0, 5, 1
    s_mov_b32 s38, 0x4
    v_mad_u32_u24 v68, v14, s38, v68
    v_bfe_u32 v14, v0, 6, 1
    s_mov_b32 s38, 0x40
    v_mad_u32_u24 v68, v14, s38, v68
    v_bfe_u32 v14, v0, 7, 1
    s_mov_b32 s38, 0x80
    v_mad_u32_u24 v68, v14, s38, v68
    v_mov_b32 v70, s20
    v_mov_b32 v69, 0x0
    v_bfe_u32 v14, v70, 0, 1
    s_mov_b32 s38, 0x20
    v_mad_u32_u24 v69, v14, s38, v69
    v_bfe_u32 v14, v70, 1, 1
    s_mov_b32 s38, 0x800
    v_mad_u32_u24 v69, v14, s38, v69
    v_bfe_u32 v14, v70, 2, 1
    s_mov_b32 s38, 0x1000
    v_mad_u32_u24 v69, v14, s38, v69
    v_bfe_u32 v14, v70, 3, 1
    s_mov_b32 s38, 0x100
    v_mad_u32_u24 v69, v14, s38, v69
    v_bfe_u32 v14, v70, 4, 1
    s_mov_b32 s38, 0x200
    v_mad_u32_u24 v69, v14, s38, v69
    v_add_u32 v68, v68, v69
    buffer_load_dword v72, v68, s[96:99], 0 offen
    v_mov_b32 v64, -1
    v_mov_b32 v65, -1
    v_mov_b32 v66, -1
    v_mov_b32 v67, -1
    s_lshl_b32 s36, s20, 13
    s_add_u32 s36, s36, 0x0
    buffer_store_dwordx4 v[64:67], v2, s[8:11], s36 offen sc1
    buffer_store_dwordx4 v[64:67], v2, s[8:11], s36 offen offset:1024 sc1
    s_lshl_b32 s36, s20, 14
    s_add_u32 s36, s36, 0x100000
    s_add_u32 s37, s36, 0x2000
    buffer_store_dwordx4 v[64:67], v2, s[8:11], s36 offen sc1
    buffer_store_dwordx4 v[64:67], v2, s[8:11], s36 offen offset:1024 sc1
    buffer_store_dwordx4 v[64:67], v2, s[8:11], s37 offen sc1
    buffer_store_dwordx4 v[64:67], v2, s[8:11], s37 offen offset:1024 sc1
    s_mul_i32 s36, s20, 0x104200
    s_add_u32 s36, s36, 0x1102100
    s_add_u32 s37, s36, 0x82100
    buffer_store_dwordx4 v[64:67], v2, s[8:11], s36 offen sc1
    buffer_store_dwordx4 v[64:67], v2, s[8:11], s36 offen offset:1024 sc1
    buffer_store_dwordx4 v[64:67], v2, s[8:11], s37 offen sc1
    buffer_store_dwordx4 v[64:67], v2, s[8:11], s37 offen offset:1024 sc1
    v_lshlrev_b32 v68, 2, v0
    s_lshl_b32 s36, s20, 10
    s_add_u32 s37, s36, 0x194000
    buffer_store_dword v64, v68, s[8:11], s37 offen sc1
    s_add_u32 s37, s36, 0x1b0000
    buffer_store_dword v64, v68, s[8:11], s37 offen sc1
    s_add_u32 s37, s36, 0x1b8000
    buffer_store_dword v64, v68, s[8:11], s37 offen sc1
    v_mov_b32 v69, 0x40000000
    v_cmp_lt_u32 vcc, 63, v0
    s_nop 1
    v_cndmask_b32 v68, v68, v69, vcc
    v_mov_b32 v73, 0
    s_lshl_b32 s36, s20, 8
    s_add_u32 s37, s36, 0x192000
    buffer_store_dword v73, v68, s[8:11], s37 offen sc1
    s_mul_i32 s36, s20, 0x104200
    s_add_u32 s36, s36, 0x1082000
    s_add_u32 s37, s36, 0x82100
    buffer_store_dword v73, v68, s[8:11], s36 offen sc1
    buffer_store_dword v73, v68, s[8:11], s37 offen sc1
    v_mov_b32 v71, 0x80000
    v_bfe_u32 v14, v0, 0, 1
    s_mov_b32 s38, 0x8
    v_mad_u32_u24 v71, v14, s38, v71
    v_bfe_u32 v14, v0, 1, 1
    s_mov_b32 s38, 0x20
    v_mad_u32_u24 v71, v14, s38, v71
    v_bfe_u32 v14, v0, 4, 1
    s_mov_b32 s38, 0x10
    v_mad_u32_u24 v71, v14, s38, v71
    v_bfe_u32 v14, v0, 5, 1
    s_mov_b32 s38, 0x4
    v_mad_u32_u24 v71, v14, s38, v71
    v_bfe_u32 v14, v0, 6, 1
    s_mov_b32 s38, 0x800
    v_mad_u32_u24 v71, v14, s38, v71
    v_bfe_u32 v14, v0, 7, 1
    s_mov_b32 s38, 0x1000
    v_mad_u32_u24 v71, v14, s38, v71
    v_mov_b32 v69, s20
    v_mov_b32 v68, 0x0
    v_bfe_u32 v14, v69, 0, 1
    s_mov_b32 s38, 0x100
    v_mad_u32_u24 v68, v14, s38, v68
    v_bfe_u32 v14, v69, 1, 1
    s_mov_b32 s38, 0x40
    v_mad_u32_u24 v68, v14, s38, v68
    v_bfe_u32 v14, v69, 2, 1
    s_mov_b32 s38, 0x80
    v_mad_u32_u24 v68, v14, s38, v68
    v_bfe_u32 v14, v69, 3, 1
    s_mov_b32 s38, 0x200
    v_mad_u32_u24 v68, v14, s38, v68
    v_bfe_u32 v14, v69, 4, 1
    s_mov_b32 s38, 0x400
    v_mad_u32_u24 v68, v14, s38, v68
    v_add_u32 v71, v68, v71
    v_and_b32 v68, 12, v0
    v_cmp_ne_u32 vcc, 0, v68
    v_mov_b32 v68, 0x40000000
    s_nop 0
    v_cndmask_b32 v71, v71, v68, vcc
    s_waitcnt vmcnt(16)
    s_mov_b32 s36, 0x1000000
    buffer_store_dword v72, v71, s[8:11], s36 offen sc1
L_XN:
    v_mov_b32 v88, 0
    v_mov_b32 v89, 0
    v_dot2_f32_bf16 v88, v96, s4, v88
    v_dot2_f32_bf16 v89, v96, v96, v89
    v_dot2_f32_bf16 v88, v97, s4, v88
    v_dot2_f32_bf16 v89, v97, v97, v89
    v_dot2_f32_bf16 v88, v98, s4, v88
    v_dot2_f32_bf16 v89, v98, v98, v89
    v_dot2_f32_bf16 v88, v99, s4, v88
    v_dot2_f32_bf16 v89, v99, v99, v89
    v_dot2_f32_bf16 v88, v100, s4, v88
    v_dot2_f32_bf16 v89, v100, v100, v89
    v_dot2_f32_bf16 v88, v101, s4, v88
    v_dot2_f32_bf16 v89, v101, v101, v89
    v_dot2_f32_bf16 v88, v102, s4, v88
    v_dot2_f32_bf16 v89, v102, v102, v89
    v_dot2_f32_bf16 v88, v103, s4, v88
    v_dot2_f32_bf16 v89, v103, v103, v89
    v_dot2_f32_bf16 v88, v104, s4, v88
    v_dot2_f32_bf16 v89, v104, v104, v89
    v_dot2_f32_bf16 v88, v105, s4, v88
    v_dot2_f32_bf16 v89, v105, v105, v89
    v_dot2_f32_bf16 v88, v106, s4, v88
    v_dot2_f32_bf16 v89, v106, v106, v89
    v_dot2_f32_bf16 v88, v107, s4, v88
    v_dot2_f32_bf16 v89, v107, v107, v89
    v_dot2_f32_bf16 v88, v108, s4, v88
    v_dot2_f32_bf16 v89, v108, v108, v89
    v_dot2_f32_bf16 v88, v109, s4, v88
    v_dot2_f32_bf16 v89, v109, v109, v89
    v_dot2_f32_bf16 v88, v110, s4, v88
    v_dot2_f32_bf16 v89, v110, v110, v89
    v_dot2_f32_bf16 v88, v111, s4, v88
    v_dot2_f32_bf16 v89, v111, v111, v89
    v_dot2_f32_bf16 v88, v112, s4, v88
    v_dot2_f32_bf16 v89, v112, v112, v89
    v_dot2_f32_bf16 v88, v113, s4, v88
    v_dot2_f32_bf16 v89, v113, v113, v89
    v_dot2_f32_bf16 v88, v114, s4, v88
    v_dot2_f32_bf16 v89, v114, v114, v89
    v_dot2_f32_bf16 v88, v115, s4, v88
    v_dot2_f32_bf16 v89, v115, v115, v89
    v_dot2_f32_bf16 v88, v116, s4, v88
    v_dot2_f32_bf16 v89, v116, v116, v89
    v_dot2_f32_bf16 v88, v117, s4, v88
    v_dot2_f32_bf16 v89, v117, v117, v89
    v_dot2_f32_bf16 v88, v118, s4, v88
    v_dot2_f32_bf16 v89, v118, v118, v89
    v_dot2_f32_bf16 v88, v119, s4, v88
    v_dot2_f32_bf16 v89, v119, v119, v89
    v_dot2_f32_bf16 v88, v120, s4, v88
    v_dot2_f32_bf16 v89, v120, v120, v89
    v_dot2_f32_bf16 v88, v121, s4, v88
    v_dot2_f32_bf16 v89, v121, v121, v89
    v_dot2_f32_bf16 v88, v122, s4, v88
    v_dot2_f32_bf16 v89, v122, v122, v89
    v_dot2_f32_bf16 v88, v123, s4, v88
    v_dot2_f32_bf16 v89, v123, v123, v89
    v_dot2_f32_bf16 v88, v124, s4, v88
    v_dot2_f32_bf16 v89, v124, v124, v89
    v_dot2_f32_bf16 v88, v125, s4, v88
    v_dot2_f32_bf16 v89, v125, v125, v89
    v_dot2_f32_bf16 v88, v126, s4, v88
    v_dot2_f32_bf16 v89, v126, v126, v89
    v_dot2_f32_bf16 v88, v127, s4, v88
    v_dot2_f32_bf16 v89, v127, v127, v89
    s_nop 3
    v_add_f32_dpp v88, v88, v88 quad_perm:[1,0,3,2] row_mask:0xf bank_mask:0xf
    v_add_f32_dpp v89, v89, v89 quad_perm:[1,0,3,2] row_mask:0xf bank_mask:0xf
    s_nop 0
    v_add_f32_dpp v88, v88, v88 quad_perm:[2,3,0,1] row_mask:0xf bank_mask:0xf
    v_add_f32_dpp v89, v89, v89 quad_perm:[2,3,0,1] row_mask:0xf bank_mask:0xf
    s_nop 0
    v_add_f32_dpp v88, v88, v88 row_half_mirror row_mask:0xf bank_mask:0xf
    v_add_f32_dpp v89, v89, v89 row_half_mirror row_mask:0xf bank_mask:0xf
    v_mul_f32 v88, 0x3b000000, v88
    v_mul_f32 v89, 0x3b000000, v89
    v_fma_f32 v89, -v88, v88, v89
    v_max_f32 v89, 0, v89
    v_cvt_pk_bf16_f32 v14, v88, v89
    v_lshlrev_b32 v88, 16, v14
    v_and_b32 v89, 0xffff0000, v14
    v_add_f32 v89, 0x3727c5ac, v89
    v_cvt_pk_bf16_f32 v14, v89, v89
    v_lshlrev_b32 v89, 16, v14
    v_sqrt_f32 v89, v89
    s_nop 0
    v_cvt_pk_bf16_f32 v14, v89, v89
    v_lshlrev_b32 v89, 16, v14
    v_rcp_f32 v89, v89
    v_lshlrev_b32 v90, 16, v96
    v_and_b32 v91, 0xffff0000, v96
    v_sub_f32 v90, v90, v88
    v_sub_f32 v91, v91, v88
    v_cvt_pk_bf16_f32 v96, v90, v91
    v_lshlrev_b32 v90, 16, v96
    v_and_b32 v91, 0xffff0000, v96
    v_mul_f32 v90, v90, v89
    v_mul_f32 v91, v91, v89
    v_cvt_pk_bf16_f32 v96, v90, v91
    v_lshlrev_b32 v90, 16, v97
    v_and_b32 v91, 0xffff0000, v97
    v_sub_f32 v90, v90, v88
    v_sub_f32 v91, v91, v88
    v_cvt_pk_bf16_f32 v97, v90, v91
    v_lshlrev_b32 v90, 16, v97
    v_and_b32 v91, 0xffff0000, v97
    v_mul_f32 v90, v90, v89
    v_mul_f32 v91, v91, v89
    v_cvt_pk_bf16_f32 v97, v90, v91
    v_lshlrev_b32 v90, 16, v98
    v_and_b32 v91, 0xffff0000, v98
    v_sub_f32 v90, v90, v88
    v_sub_f32 v91, v91, v88
    v_cvt_pk_bf16_f32 v98, v90, v91
    v_lshlrev_b32 v90, 16, v98
    v_and_b32 v91, 0xffff0000, v98
    v_mul_f32 v90, v90, v89
    v_mul_f32 v91, v91, v89
    v_cvt_pk_bf16_f32 v98, v90, v91
    v_lshlrev_b32 v90, 16, v99
    v_and_b32 v91, 0xffff0000, v99
    v_sub_f32 v90, v90, v88
    v_sub_f32 v91, v91, v88
    v_cvt_pk_bf16_f32 v99, v90, v91
    v_lshlrev_b32 v90, 16, v99
    v_and_b32 v91, 0xffff0000, v99
    v_mul_f32 v90, v90, v89
    v_mul_f32 v91, v91, v89
    v_cvt_pk_bf16_f32 v99, v90, v91
    ds_write_b128 v4, v[96:99] offset:0
    v_lshlrev_b32 v90, 16, v100
    v_and_b32 v91, 0xffff0000, v100
    v_sub_f32 v90, v90, v88
    v_sub_f32 v91, v91, v88
    v_cvt_pk_bf16_f32 v100, v90, v91
    v_lshlrev_b32 v90, 16, v100
    v_and_b32 v91, 0xffff0000, v100
    v_mul_f32 v90, v90, v89
    v_mul_f32 v91, v91, v89
    v_cvt_pk_bf16_f32 v100, v90, v91
    v_lshlrev_b32 v90, 16, v101
    v_and_b32 v91, 0xffff0000, v101
    v_sub_f32 v90, v90, v88
    v_sub_f32 v91, v91, v88
    v_cvt_pk_bf16_f32 v101, v90, v91
    v_lshlrev_b32 v90, 16, v101
    v_and_b32 v91, 0xffff0000, v101
    v_mul_f32 v90, v90, v89
    v_mul_f32 v91, v91, v89
    v_cvt_pk_bf16_f32 v101, v90, v91
    v_lshlrev_b32 v90, 16, v102
    v_and_b32 v91, 0xffff0000, v102
    v_sub_f32 v90, v90, v88
    v_sub_f32 v91, v91, v88
    v_cvt_pk_bf16_f32 v102, v90, v91
    v_lshlrev_b32 v90, 16, v102
    v_and_b32 v91, 0xffff0000, v102
    v_mul_f32 v90, v90, v89
    v_mul_f32 v91, v91, v89
    v_cvt_pk_bf16_f32 v102, v90, v91
    v_lshlrev_b32 v90, 16, v103
    v_and_b32 v91, 0xffff0000, v103
    v_sub_f32 v90, v90, v88
    v_sub_f32 v91, v91, v88
    v_cvt_pk_bf16_f32 v103, v90, v91
    v_lshlrev_b32 v90, 16, v103
    v_and_b32 v91, 0xffff0000, v103
    v_mul_f32 v90, v90, v89
    v_mul_f32 v91, v91, v89
    v_cvt_pk_bf16_f32 v103, v90, v91
    ds_write_b128 v4, v[100:103] offset:2048
    v_lshlrev_b32 v90, 16, v104
    v_and_b32 v91, 0xffff0000, v104
    v_sub_f32 v90, v90, v88
    v_sub_f32 v91, v91, v88
    v_cvt_pk_bf16_f32 v104, v90, v91
    v_lshlrev_b32 v90, 16, v104
    v_and_b32 v91, 0xffff0000, v104
    v_mul_f32 v90, v90, v89
    v_mul_f32 v91, v91, v89
    v_cvt_pk_bf16_f32 v104, v90, v91
    v_lshlrev_b32 v90, 16, v105
    v_and_b32 v91, 0xffff0000, v105
    v_sub_f32 v90, v90, v88
    v_sub_f32 v91, v91, v88
    v_cvt_pk_bf16_f32 v105, v90, v91
    v_lshlrev_b32 v90, 16, v105
    v_and_b32 v91, 0xffff0000, v105
    v_mul_f32 v90, v90, v89
    v_mul_f32 v91, v91, v89
    v_cvt_pk_bf16_f32 v105, v90, v91
    v_lshlrev_b32 v90, 16, v106
    v_and_b32 v91, 0xffff0000, v106
    v_sub_f32 v90, v90, v88
    v_sub_f32 v91, v91, v88
    v_cvt_pk_bf16_f32 v106, v90, v91
    v_lshlrev_b32 v90, 16, v106
    v_and_b32 v91, 0xffff0000, v106
    v_mul_f32 v90, v90, v89
    v_mul_f32 v91, v91, v89
    v_cvt_pk_bf16_f32 v106, v90, v91
    v_lshlrev_b32 v90, 16, v107
    v_and_b32 v91, 0xffff0000, v107
    v_sub_f32 v90, v90, v88
    v_sub_f32 v91, v91, v88
    v_cvt_pk_bf16_f32 v107, v90, v91
    v_lshlrev_b32 v90, 16, v107
    v_and_b32 v91, 0xffff0000, v107
    v_mul_f32 v90, v90, v89
    v_mul_f32 v91, v91, v89
    v_cvt_pk_bf16_f32 v107, v90, v91
    ds_write_b128 v4, v[104:107] offset:4096
    v_lshlrev_b32 v90, 16, v108
    v_and_b32 v91, 0xffff0000, v108
    v_sub_f32 v90, v90, v88
    v_sub_f32 v91, v91, v88
    v_cvt_pk_bf16_f32 v108, v90, v91
    v_lshlrev_b32 v90, 16, v108
    v_and_b32 v91, 0xffff0000, v108
    v_mul_f32 v90, v90, v89
    v_mul_f32 v91, v91, v89
    v_cvt_pk_bf16_f32 v108, v90, v91
    v_lshlrev_b32 v90, 16, v109
    v_and_b32 v91, 0xffff0000, v109
    v_sub_f32 v90, v90, v88
    v_sub_f32 v91, v91, v88
    v_cvt_pk_bf16_f32 v109, v90, v91
    v_lshlrev_b32 v90, 16, v109
    v_and_b32 v91, 0xffff0000, v109
    v_mul_f32 v90, v90, v89
    v_mul_f32 v91, v91, v89
    v_cvt_pk_bf16_f32 v109, v90, v91
    v_lshlrev_b32 v90, 16, v110
    v_and_b32 v91, 0xffff0000, v110
    v_sub_f32 v90, v90, v88
    v_sub_f32 v91, v91, v88
    v_cvt_pk_bf16_f32 v110, v90, v91
    v_lshlrev_b32 v90, 16, v110
    v_and_b32 v91, 0xffff0000, v110
    v_mul_f32 v90, v90, v89
    v_mul_f32 v91, v91, v89
    v_cvt_pk_bf16_f32 v110, v90, v91
    v_lshlrev_b32 v90, 16, v111
    v_and_b32 v91, 0xffff0000, v111
    v_sub_f32 v90, v90, v88
    v_sub_f32 v91, v91, v88
    v_cvt_pk_bf16_f32 v111, v90, v91
    v_lshlrev_b32 v90, 16, v111
    v_and_b32 v91, 0xffff0000, v111
    v_mul_f32 v90, v90, v89
    v_mul_f32 v91, v91, v89
    v_cvt_pk_bf16_f32 v111, v90, v91
    ds_write_b128 v4, v[108:111] offset:6144
    v_lshlrev_b32 v90, 16, v112
    v_and_b32 v91, 0xffff0000, v112
    v_sub_f32 v90, v90, v88
    v_sub_f32 v91, v91, v88
    v_cvt_pk_bf16_f32 v112, v90, v91
    v_lshlrev_b32 v90, 16, v112
    v_and_b32 v91, 0xffff0000, v112
    v_mul_f32 v90, v90, v89
    v_mul_f32 v91, v91, v89
    v_cvt_pk_bf16_f32 v112, v90, v91
    v_lshlrev_b32 v90, 16, v113
    v_and_b32 v91, 0xffff0000, v113
    v_sub_f32 v90, v90, v88
    v_sub_f32 v91, v91, v88
    v_cvt_pk_bf16_f32 v113, v90, v91
    v_lshlrev_b32 v90, 16, v113
    v_and_b32 v91, 0xffff0000, v113
    v_mul_f32 v90, v90, v89
    v_mul_f32 v91, v91, v89
    v_cvt_pk_bf16_f32 v113, v90, v91
    v_lshlrev_b32 v90, 16, v114
    v_and_b32 v91, 0xffff0000, v114
    v_sub_f32 v90, v90, v88
    v_sub_f32 v91, v91, v88
    v_cvt_pk_bf16_f32 v114, v90, v91
    v_lshlrev_b32 v90, 16, v114
    v_and_b32 v91, 0xffff0000, v114
    v_mul_f32 v90, v90, v89
    v_mul_f32 v91, v91, v89
    v_cvt_pk_bf16_f32 v114, v90, v91
    v_lshlrev_b32 v90, 16, v115
    v_and_b32 v91, 0xffff0000, v115
    v_sub_f32 v90, v90, v88
    v_sub_f32 v91, v91, v88
    v_cvt_pk_bf16_f32 v115, v90, v91
    v_lshlrev_b32 v90, 16, v115
    v_and_b32 v91, 0xffff0000, v115
    v_mul_f32 v90, v90, v89
    v_mul_f32 v91, v91, v89
    v_cvt_pk_bf16_f32 v115, v90, v91
    ds_write_b128 v4, v[112:115] offset:8192
    v_lshlrev_b32 v90, 16, v116
    v_and_b32 v91, 0xffff0000, v116
    v_sub_f32 v90, v90, v88
    v_sub_f32 v91, v91, v88
    v_cvt_pk_bf16_f32 v116, v90, v91
    v_lshlrev_b32 v90, 16, v116
    v_and_b32 v91, 0xffff0000, v116
    v_mul_f32 v90, v90, v89
    v_mul_f32 v91, v91, v89
    v_cvt_pk_bf16_f32 v116, v90, v91
    v_lshlrev_b32 v90, 16, v117
    v_and_b32 v91, 0xffff0000, v117
    v_sub_f32 v90, v90, v88
    v_sub_f32 v91, v91, v88
    v_cvt_pk_bf16_f32 v117, v90, v91
    v_lshlrev_b32 v90, 16, v117
    v_and_b32 v91, 0xffff0000, v117
    v_mul_f32 v90, v90, v89
    v_mul_f32 v91, v91, v89
    v_cvt_pk_bf16_f32 v117, v90, v91
    v_lshlrev_b32 v90, 16, v118
    v_and_b32 v91, 0xffff0000, v118
    v_sub_f32 v90, v90, v88
    v_sub_f32 v91, v91, v88
    v_cvt_pk_bf16_f32 v118, v90, v91
    v_lshlrev_b32 v90, 16, v118
    v_and_b32 v91, 0xffff0000, v118
    v_mul_f32 v90, v90, v89
    v_mul_f32 v91, v91, v89
    v_cvt_pk_bf16_f32 v118, v90, v91
    v_lshlrev_b32 v90, 16, v119
    v_and_b32 v91, 0xffff0000, v119
    v_sub_f32 v90, v90, v88
    v_sub_f32 v91, v91, v88
    v_cvt_pk_bf16_f32 v119, v90, v91
    v_lshlrev_b32 v90, 16, v119
    v_and_b32 v91, 0xffff0000, v119
    v_mul_f32 v90, v90, v89
    v_mul_f32 v91, v91, v89
    v_cvt_pk_bf16_f32 v119, v90, v91
    ds_write_b128 v4, v[116:119] offset:10240
    v_lshlrev_b32 v90, 16, v120
    v_and_b32 v91, 0xffff0000, v120
    v_sub_f32 v90, v90, v88
    v_sub_f32 v91, v91, v88
    v_cvt_pk_bf16_f32 v120, v90, v91
    v_lshlrev_b32 v90, 16, v120
    v_and_b32 v91, 0xffff0000, v120
    v_mul_f32 v90, v90, v89
    v_mul_f32 v91, v91, v89
    v_cvt_pk_bf16_f32 v120, v90, v91
    v_lshlrev_b32 v90, 16, v121
    v_and_b32 v91, 0xffff0000, v121
    v_sub_f32 v90, v90, v88
    v_sub_f32 v91, v91, v88
    v_cvt_pk_bf16_f32 v121, v90, v91
    v_lshlrev_b32 v90, 16, v121
    v_and_b32 v91, 0xffff0000, v121
    v_mul_f32 v90, v90, v89
    v_mul_f32 v91, v91, v89
    v_cvt_pk_bf16_f32 v121, v90, v91
    v_lshlrev_b32 v90, 16, v122
    v_and_b32 v91, 0xffff0000, v122
    v_sub_f32 v90, v90, v88
    v_sub_f32 v91, v91, v88
    v_cvt_pk_bf16_f32 v122, v90, v91
    v_lshlrev_b32 v90, 16, v122
    v_and_b32 v91, 0xffff0000, v122
    v_mul_f32 v90, v90, v89
    v_mul_f32 v91, v91, v89
    v_cvt_pk_bf16_f32 v122, v90, v91
    v_lshlrev_b32 v90, 16, v123
    v_and_b32 v91, 0xffff0000, v123
    v_sub_f32 v90, v90, v88
    v_sub_f32 v91, v91, v88
    v_cvt_pk_bf16_f32 v123, v90, v91
    v_lshlrev_b32 v90, 16, v123
    v_and_b32 v91, 0xffff0000, v123
    v_mul_f32 v90, v90, v89
    v_mul_f32 v91, v91, v89
    v_cvt_pk_bf16_f32 v123, v90, v91
    ds_write_b128 v4, v[120:123] offset:12288
    v_lshlrev_b32 v90, 16, v124
    v_and_b32 v91, 0xffff0000, v124
    v_sub_f32 v90, v90, v88
    v_sub_f32 v91, v91, v88
    v_cvt_pk_bf16_f32 v124, v90, v91
    v_lshlrev_b32 v90, 16, v124
    v_and_b32 v91, 0xffff0000, v124
    v_mul_f32 v90, v90, v89
    v_mul_f32 v91, v91, v89
    v_cvt_pk_bf16_f32 v124, v90, v91
    v_lshlrev_b32 v90, 16, v125
    v_and_b32 v91, 0xffff0000, v125
    v_sub_f32 v90, v90, v88
    v_sub_f32 v91, v91, v88
    v_cvt_pk_bf16_f32 v125, v90, v91
    v_lshlrev_b32 v90, 16, v125
    v_and_b32 v91, 0xffff0000, v125
    v_mul_f32 v90, v90, v89
    v_mul_f32 v91, v91, v89
    v_cvt_pk_bf16_f32 v125, v90, v91
    v_lshlrev_b32 v90, 16, v126
    v_and_b32 v91, 0xffff0000, v126
    v_sub_f32 v90, v90, v88
    v_sub_f32 v91, v91, v88
    v_cvt_pk_bf16_f32 v126, v90, v91
    v_lshlrev_b32 v90, 16, v126
    v_and_b32 v91, 0xffff0000, v126
    v_mul_f32 v90, v90, v89
    v_mul_f32 v91, v91, v89
    v_cvt_pk_bf16_f32 v126, v90, v91
    v_lshlrev_b32 v90, 16, v127
    v_and_b32 v91, 0xffff0000, v127
    v_sub_f32 v90, v90, v88
    v_sub_f32 v91, v91, v88
    v_cvt_pk_bf16_f32 v127, v90, v91
    v_lshlrev_b32 v90, 16, v127
    v_and_b32 v91, 0xffff0000, v127
    v_mul_f32 v90, v90, v89
    v_mul_f32 v91, v91, v89
    v_cvt_pk_bf16_f32 v127, v90, v91
    ds_write_b128 v4, v[124:127] offset:14336
    s_waitcnt lgkmcnt(0)
    s_barrier
    s_lshl_b32 s24, s23, 15
    s_add_u32 s24, s24, 0x800000
    ds_read_b128 v[24:27], v9 offset:0
    ds_read_b128 v[28:31], v9 offset:4096
    ds_read_b128 v[32:35], v9 offset:8192
    ds_read_b128 v[36:39], v9 offset:12288
    ds_read_b128 v[40:43], v9 offset:16384
    ds_read_b128 v[44:47], v9 offset:20480
    ds_read_b128 v[48:51], v9 offset:24576
    ds_read_b128 v[52:55], v9 offset:28672
    s_waitcnt lgkmcnt(7)
    s_add_u32 s36, s24, 0
    buffer_store_dwordx4 v[24:27], v9, s[8:11], s36 offen sc1
    s_waitcnt lgkmcnt(6)
    s_add_u32 s36, s24, 4096
    buffer_store_dwordx4 v[28:31], v9, s[8:11], s36 offen sc1
    s_waitcnt lgkmcnt(5)
    s_add_u32 s36, s24, 8192
    buffer_store_dwordx4 v[32:35], v9, s[8:11], s36 offen sc1
    s_waitcnt lgkmcnt(4)
    s_add_u32 s36, s24, 12288
    buffer_store_dwordx4 v[36:39], v9, s[8:11], s36 offen sc1
    s_waitcnt lgkmcnt(3)
    s_add_u32 s36, s24, 16384
    buffer_store_dwordx4 v[40:43], v9, s[8:11], s36 offen sc1
    s_waitcnt lgkmcnt(2)
    s_add_u32 s36, s24, 20480
    buffer_store_dwordx4 v[44:47], v9, s[8:11], s36 offen sc1
    s_waitcnt lgkmcnt(1)
    s_add_u32 s36, s24, 24576
    buffer_store_dwordx4 v[48:51], v9, s[8:11], s36 offen sc1
    s_waitcnt lgkmcnt(0)
    s_add_u32 s36, s24, 28672
    buffer_store_dwordx4 v[52:55], v9, s[8:11], s36 offen sc1
    s_barrier
    v_mov_b64 v[96:97], v[128:129]
    v_mov_b64 v[98:99], v[130:131]
    v_mov_b64 v[100:101], v[132:133]
    v_mov_b64 v[102:103], v[134:135]
    v_mov_b64 v[104:105], v[136:137]
    v_mov_b64 v[106:107], v[138:139]
    v_mov_b64 v[108:109], v[140:141]
    v_mov_b64 v[110:111], v[142:143]
    v_mov_b64 v[112:113], v[144:145]
    v_mov_b64 v[114:115], v[146:147]
    v_mov_b64 v[116:117], v[148:149]
    v_mov_b64 v[118:119], v[150:151]
    v_mov_b64 v[120:121], v[152:153]
    v_mov_b64 v[122:123], v[154:155]
    v_mov_b64 v[124:125], v[156:157]
    v_mov_b64 v[126:127], v[158:159]
    s_add_u32 s23, s23, 1
    s_bitcmp1_b32 s23, 0
    s_cbranch_scc1 L_XN
    s_waitcnt vmcnt(0)
    s_barrier
    v_mov_b32 v14, 1
    s_lshl_b32 s37, s20, 2
    v_lshlrev_b32 v15, 20, v0
    buffer_store_dword v14, v15, s[16:19], s37 offen sc1
    s_lshr_b32 s20, s2, 3
    s_mov_b32 s34, 0x05040100
    s_mov_b32 s35, 0x07060302
    s_mov_b32 s32, 0
    s_mov_b32 s64, s84
    s_and_b32 s65, s85, 0xffff
    s_mov_b32 s66, 0x1c0000
    s_mov_b32 s67, 0x20000
    s_mov_b32 s68, s86
    s_and_b32 s69, s87, 0xffff
    s_mov_b32 s70, 0x1c0000
    s_mov_b32 s71, 0x20000
    s_mov_b32 s76, s88
    s_and_b32 s77, s89, 0xffff
    s_mov_b32 s78, 0x1c0000
    s_mov_b32 s79, 0x20000
    v_and_b32 v3, 31, v0
    v_lshlrev_b32 v3, 2, v3
L_M_hs:
    buffer_load_dword v5, v3, s[16:19], 0 offen sc1
    s_add_u32 s32, s32, 1
    s_cmp_gt_u32 s32, 200000
    s_waitcnt vmcnt(0)
    s_cbranch_scc1 L_M_hs_ok
    v_cmp_eq_u32 vcc, 0, v5
    s_cbranch_vccz L_M_hs_ok
    s_sleep 16
    s_branch L_M_hs
L_M_hs_ok:
    v_lshlrev_b32 v3, 4, v0
L_M00_rp:
    s_mov_b32 s36, 0x194000
    buffer_load_dwordx4 v[16:19], v3, s[8:11], s36 offen sc1
    s_add_u32 s32, s32, 1
    v_mov_b32 v5, 0
    s_waitcnt vmcnt(0)
    v_max3_u32 v5, v5, v16, v17
    v_max3_u32 v5, v5, v18, v19
    s_cmp_gt_u32 s32, 200000
    s_cbranch_scc1 L_M00_rp_ok
    v_cmp_eq_u32 vcc, -1, v5
    s_cbranch_vccz L_M00_rp_ok
    s_sleep 64
    s_branch L_M00_rp
L_M00_rp_ok:
    v_add_f32 v16, v16, v17
    v_add_f32 v18, v18, v19
    v_add_f32 v16, v16, v18
    v_cvt_pk_bf16_f32 v5, v16, v16
    v_lshlrev_b32 v16, 16, v5
    v_ashrrev_i32 v5, 31, v16
    v_or_b32 v5, 0x80000000, v5
    v_xor_b32 v5, v5, v16
    v_and_b32 v5, 0xffff0000, v5
    v_sub_u32 v6, 2047, v0
    v_or_b32 v120, v5, v6
    v_lshrrev_b32 v1, 5, v0
    v_and_b32 v2, 31, v0
    s_mov_b32 s36, 229376
    v_mul_lo_u32 v4, v1, s36
    v_lshl_add_u32 v4, v2, 2, v4
    v_mov_b32 v5, 0x40000000
    v_cmp_lt_u32 vcc, 27, v2
    s_nop 1
    v_cndmask_b32 v4, v4, v5, vcc
    s_mul_i32 s23, s20, 112
    s_add_u32 s36, s23, 0
    buffer_load_dword v16, v4, s[64:67], s36 offen
    s_add_u32 s36, s23, 3584
    buffer_load_dword v17, v4, s[64:67], s36 offen
    s_add_u32 s36, s23, 7168
    buffer_load_dword v18, v4, s[64:67], s36 offen
    s_add_u32 s36, s23, 10752
    buffer_load_dword v19, v4, s[64:67], s36 offen
    s_add_u32 s36, s23, 14336
    buffer_load_dword v20, v4, s[64:67], s36 offen
    s_add_u32 s36, s23, 17920
    buffer_load_dword v21, v4, s[64:67], s36 offen
    s_add_u32 s36, s23, 21504
    buffer_load_dword v22, v4, s[64:67], s36 offen
    s_add_u32 s36, s23, 25088
    buffer_load_dword v23, v4, s[64:67], s36 offen
    s_add_u32 s36, s23, 28672
    buffer_load_dword v24, v4, s[64:67], s36 offen
    s_add_u32 s36, s23, 32256
    buffer_load_dword v25, v4, s[64:67], s36 offen
    s_add_u32 s36, s23, 35840
    buffer_load_dword v26, v4, s[64:67], s36 offen
    s_add_u32 s36, s23, 39424
    buffer_load_dword v27, v4, s[64:67], s36 offen
    s_add_u32 s36, s23, 43008
    buffer_load_dword v28, v4, s[64:67], s36 offen
    s_add_u32 s36, s23, 46592
    buffer_load_dword v29, v4, s[64:67], s36 offen
    s_add_u32 s36, s23, 50176
    buffer_load_dword v30, v4, s[64:67], s36 offen
    s_add_u32 s36, s23, 53760
    buffer_load_dword v31, v4, s[64:67], s36 offen
    s_add_u32 s36, s23, 57344
    buffer_load_dword v32, v4, s[64:67], s36 offen
    s_add_u32 s36, s23, 60928
    buffer_load_dword v33, v4, s[64:67], s36 offen
    s_add_u32 s36, s23, 64512
    buffer_load_dword v34, v4, s[64:67], s36 offen
    s_add_u32 s36, s23, 68096
    buffer_load_dword v35, v4, s[64:67], s36 offen
    s_add_u32 s36, s23, 71680
    buffer_load_dword v36, v4, s[64:67], s36 offen
    s_add_u32 s36, s23, 75264
    buffer_load_dword v37, v4, s[64:67], s36 offen
    s_add_u32 s36, s23, 78848
    buffer_load_dword v38, v4, s[64:67], s36 offen
    s_add_u32 s36, s23, 82432
    buffer_load_dword v39, v4, s[64:67], s36 offen
    s_add_u32 s36, s23, 86016
    buffer_load_dword v40, v4, s[64:67], s36 offen
    s_add_u32 s36, s23, 89600
    buffer_load_dword v41, v4, s[64:67], s36 offen
    s_add_u32 s36, s23, 93184
    buffer_load_dword v42, v4, s[64:67], s36 offen
    s_add_u32 s36, s23, 96768
    buffer_load_dword v43, v4, s[64:67], s36 offen
    s_add_u32 s36, s23, 100352
    buffer_load_dword v44, v4, s[64:67], s36 offen
    s_add_u32 s36, s23, 103936
    buffer_load_dword v45, v4, s[64:67], s36 offen
    s_add_u32 s36, s23, 107520
    buffer_load_dword v46, v4, s[64:67], s36 offen
    s_add_u32 s36, s23, 111104
    buffer_load_dword v47, v4, s[64:67], s36 offen
    s_waitcnt vmcnt(0)
    v_perm_b32 v128, v17, v16, s34
    v_perm_b32 v129, v19, v18, s34
    v_perm_b32 v130, v21, v20, s34
    v_perm_b32 v131, v23, v22, s34
    v_perm_b32 v132, v25, v24, s34
    v_perm_b32 v133, v27, v26, s34
    v_perm_b32 v134, v29, v28, s34
    v_perm_b32 v135, v31, v30, s34
    v_perm_b32 v136, v33, v32, s34
    v_perm_b32 v137, v35, v34, s34
    v_perm_b32 v138, v37, v36, s34
    v_perm_b32 v139, v39, v38, s34
    v_perm_b32 v140, v41, v40, s34
    v_perm_b32 v141, v43, v42, s34
    v_perm_b32 v142, v45, v44, s34
    v_perm_b32 v143, v47, v46, s34
    v_perm_b32 v160, v17, v16, s35
    v_perm_b32 v161, v19, v18, s35
    v_perm_b32 v162, v21, v20, s35
    v_perm_b32 v163, v23, v22, s35
    v_perm_b32 v164, v25, v24, s35
    v_perm_b32 v165, v27, v26, s35
    v_perm_b32 v166, v29, v28, s35
    v_perm_b32 v167, v31, v30, s35
    v_perm_b32 v168, v33, v32, s35
    v_perm_b32 v169, v35, v34, s35
    v_perm_b32 v170, v37, v36, s35
    v_perm_b32 v171, v39, v38, s35
    v_perm_b32 v172, v41, v40, s35
    v_perm_b32 v173, v43, v42, s35
    v_perm_b32 v174, v45, v44, s35
    v_perm_b32 v175, v47, v46, s35
    s_add_u32 s36, s23, 114688
    buffer_load_dword v16, v4, s[64:67], s36 offen
    s_add_u32 s36, s23, 118272
    buffer_load_dword v17, v4, s[64:67], s36 offen
    s_add_u32 s36, s23, 121856
    buffer_load_dword v18, v4, s[64:67], s36 offen
    s_add_u32 s36, s23, 125440
    buffer_load_dword v19, v4, s[64:67], s36 offen
    s_add_u32 s36, s23, 129024
    buffer_load_dword v20, v4, s[64:67], s36 offen
    s_add_u32 s36, s23, 132608
    buffer_load_dword v21, v4, s[64:67], s36 offen
    s_add_u32 s36, s23, 136192
    buffer_load_dword v22, v4, s[64:67], s36 offen
    s_add_u32 s36, s23, 139776
    buffer_load_dword v23, v4, s[64:67], s36 offen
    s_add_u32 s36, s23, 143360
    buffer_load_dword v24, v4, s[64:67], s36 offen
    s_add_u32 s36, s23, 146944
    buffer_load_dword v25, v4, s[64:67], s36 offen
    s_add_u32 s36, s23, 150528
    buffer_load_dword v26, v4, s[64:67], s36 offen
    s_add_u32 s36, s23, 154112
    buffer_load_dword v27, v4, s[64:67], s36 offen
    s_add_u32 s36, s23, 157696
    buffer_load_dword v28, v4, s[64:67], s36 offen
    s_add_u32 s36, s23, 161280
    buffer_load_dword v29, v4, s[64:67], s36 offen
    s_add_u32 s36, s23, 164864
    buffer_load_dword v30, v4, s[64:67], s36 offen
    s_add_u32 s36, s23, 168448
    buffer_load_dword v31, v4, s[64:67], s36 offen
    s_add_u32 s36, s23, 172032
    buffer_load_dword v32, v4, s[64:67], s36 offen
    s_add_u32 s36, s23, 175616
    buffer_load_dword v33, v4, s[64:67], s36 offen
    s_add_u32 s36, s23, 179200
    buffer_load_dword v34, v4, s[64:67], s36 offen
    s_add_u32 s36, s23, 182784
    buffer_load_dword v35, v4, s[64:67], s36 offen
    s_add_u32 s36, s23, 186368
    buffer_load_dword v36, v4, s[64:67], s36 offen
    s_add_u32 s36, s23, 189952
    buffer_load_dword v37, v4, s[64:67], s36 offen
    s_add_u32 s36, s23, 193536
    buffer_load_dword v38, v4, s[64:67], s36 offen
    s_add_u32 s36, s23, 197120
    buffer_load_dword v39, v4, s[64:67], s36 offen
    s_add_u32 s36, s23, 200704
    buffer_load_dword v40, v4, s[64:67], s36 offen
    s_add_u32 s36, s23, 204288
    buffer_load_dword v41, v4, s[64:67], s36 offen
    s_add_u32 s36, s23, 207872
    buffer_load_dword v42, v4, s[64:67], s36 offen
    s_add_u32 s36, s23, 211456
    buffer_load_dword v43, v4, s[64:67], s36 offen
    s_add_u32 s36, s23, 215040
    buffer_load_dword v44, v4, s[64:67], s36 offen
    s_add_u32 s36, s23, 218624
    buffer_load_dword v45, v4, s[64:67], s36 offen
    s_add_u32 s36, s23, 222208
    buffer_load_dword v46, v4, s[64:67], s36 offen
    s_add_u32 s36, s23, 225792
    buffer_load_dword v47, v4, s[64:67], s36 offen
    s_waitcnt vmcnt(0)
    v_perm_b32 v144, v17, v16, s34
    v_perm_b32 v145, v19, v18, s34
    v_perm_b32 v146, v21, v20, s34
    v_perm_b32 v147, v23, v22, s34
    v_perm_b32 v148, v25, v24, s34
    v_perm_b32 v149, v27, v26, s34
    v_perm_b32 v150, v29, v28, s34
    v_perm_b32 v151, v31, v30, s34
    v_perm_b32 v152, v33, v32, s34
    v_perm_b32 v153, v35, v34, s34
    v_perm_b32 v154, v37, v36, s34
    v_perm_b32 v155, v39, v38, s34
    v_perm_b32 v156, v41, v40, s34
    v_perm_b32 v157, v43, v42, s34
    v_perm_b32 v158, v45, v44, s34
    v_perm_b32 v159, v47, v46, s34
    v_perm_b32 v176, v17, v16, s35
    v_perm_b32 v177, v19, v18, s35
    v_perm_b32 v178, v21, v20, s35
    v_perm_b32 v179, v23, v22, s35
    v_perm_b32 v180, v25, v24, s35
    v_perm_b32 v181, v27, v26, s35
    v_perm_b32 v182, v29, v28, s35
    v_perm_b32 v183, v31, v30, s35
    v_perm_b32 v184, v33, v32, s35
    v_perm_b32 v185, v35, v34, s35
    v_perm_b32 v186, v37, v36, s35
    v_perm_b32 v187, v39, v38, s35
    v_perm_b32 v188, v41, v40, s35
    v_perm_b32 v189, v43, v42, s35
    v_perm_b32 v190, v45, v44, s35
    v_perm_b32 v191, v47, v46, s35
    s_add_u32 s36, s23, 0
    buffer_load_dword v16, v4, s[68:71], s36 offen
    s_add_u32 s36, s23, 3584
    buffer_load_dword v17, v4, s[68:71], s36 offen
    s_add_u32 s36, s23, 7168
    buffer_load_dword v18, v4, s[68:71], s36 offen
    s_add_u32 s36, s23, 10752
    buffer_load_dword v19, v4, s[68:71], s36 offen
    s_add_u32 s36, s23, 14336
    buffer_load_dword v20, v4, s[68:71], s36 offen
    s_add_u32 s36, s23, 17920
    buffer_load_dword v21, v4, s[68:71], s36 offen
    s_add_u32 s36, s23, 21504
    buffer_load_dword v22, v4, s[68:71], s36 offen
    s_add_u32 s36, s23, 25088
    buffer_load_dword v23, v4, s[68:71], s36 offen
    s_add_u32 s36, s23, 28672
    buffer_load_dword v24, v4, s[68:71], s36 offen
    s_add_u32 s36, s23, 32256
    buffer_load_dword v25, v4, s[68:71], s36 offen
    s_add_u32 s36, s23, 35840
    buffer_load_dword v26, v4, s[68:71], s36 offen
    s_add_u32 s36, s23, 39424
    buffer_load_dword v27, v4, s[68:71], s36 offen
    s_add_u32 s36, s23, 43008
    buffer_load_dword v28, v4, s[68:71], s36 offen
    s_add_u32 s36, s23, 46592
    buffer_load_dword v29, v4, s[68:71], s36 offen
    s_add_u32 s36, s23, 50176
    buffer_load_dword v30, v4, s[68:71], s36 offen
    s_add_u32 s36, s23, 53760
    buffer_load_dword v31, v4, s[68:71], s36 offen
    s_add_u32 s36, s23, 57344
    buffer_load_dword v32, v4, s[68:71], s36 offen
    s_add_u32 s36, s23, 60928
    buffer_load_dword v33, v4, s[68:71], s36 offen
    s_add_u32 s36, s23, 64512
    buffer_load_dword v34, v4, s[68:71], s36 offen
    s_add_u32 s36, s23, 68096
    buffer_load_dword v35, v4, s[68:71], s36 offen
    s_add_u32 s36, s23, 71680
    buffer_load_dword v36, v4, s[68:71], s36 offen
    s_add_u32 s36, s23, 75264
    buffer_load_dword v37, v4, s[68:71], s36 offen
    s_add_u32 s36, s23, 78848
    buffer_load_dword v38, v4, s[68:71], s36 offen
    s_add_u32 s36, s23, 82432
    buffer_load_dword v39, v4, s[68:71], s36 offen
    s_add_u32 s36, s23, 86016
    buffer_load_dword v40, v4, s[68:71], s36 offen
    s_add_u32 s36, s23, 89600
    buffer_load_dword v41, v4, s[68:71], s36 offen
    s_add_u32 s36, s23, 93184
    buffer_load_dword v42, v4, s[68:71], s36 offen
    s_add_u32 s36, s23, 96768
    buffer_load_dword v43, v4, s[68:71], s36 offen
    s_add_u32 s36, s23, 100352
    buffer_load_dword v44, v4, s[68:71], s36 offen
    s_add_u32 s36, s23, 103936
    buffer_load_dword v45, v4, s[68:71], s36 offen
    s_add_u32 s36, s23, 107520
    buffer_load_dword v46, v4, s[68:71], s36 offen
    s_add_u32 s36, s23, 111104
    buffer_load_dword v47, v4, s[68:71], s36 offen
    s_waitcnt vmcnt(0)
    v_perm_b32 v192, v17, v16, s34
    v_perm_b32 v193, v19, v18, s34
    v_perm_b32 v194, v21, v20, s34
    v_perm_b32 v195, v23, v22, s34
    v_perm_b32 v196, v25, v24, s34
    v_perm_b32 v197, v27, v26, s34
    v_perm_b32 v198, v29, v28, s34
    v_perm_b32 v199, v31, v30, s34
    v_perm_b32 v200, v33, v32, s34
    v_perm_b32 v201, v35, v34, s34
    v_perm_b32 v202, v37, v36, s34
    v_perm_b32 v203, v39, v38, s34
    v_perm_b32 v204, v41, v40, s34
    v_perm_b32 v205, v43, v42, s34
    v_perm_b32 v206, v45, v44, s34
    v_perm_b32 v207, v47, v46, s34
    v_perm_b32 v224, v17, v16, s35
    v_perm_b32 v225, v19, v18, s35
    v_perm_b32 v226, v21, v20, s35
    v_perm_b32 v227, v23, v22, s35
    v_perm_b32 v228, v25, v24, s35
    v_perm_b32 v229, v27, v26, s35
    v_perm_b32 v230, v29, v28, s35
    v_perm_b32 v231, v31, v30, s35
    v_perm_b32 v232, v33, v32, s35
    v_perm_b32 v233, v35, v34, s35
    v_perm_b32 v234, v37, v36, s35
    v_perm_b32 v235, v39, v38, s35
    v_perm_b32 v236, v41, v40, s35
    v_perm_b32 v237, v43, v42, s35
    v_perm_b32 v238, v45, v44, s35
    v_perm_b32 v239, v47, v46, s35
    s_add_u32 s36, s23, 114688
    buffer_load_dword v16, v4, s[68:71], s36 offen
    s_add_u32 s36, s23, 118272
    buffer_load_dword v17, v4, s[68:71], s36 offen
    s_add_u32 s36, s23, 121856
    buffer_load_dword v18, v4, s[68:71], s36 offen
    s_add_u32 s36, s23, 125440
    buffer_load_dword v19, v4, s[68:71], s36 offen
    s_add_u32 s36, s23, 129024
    buffer_load_dword v20, v4, s[68:71], s36 offen
    s_add_u32 s36, s23, 132608
    buffer_load_dword v21, v4, s[68:71], s36 offen
    s_add_u32 s36, s23, 136192
    buffer_load_dword v22, v4, s[68:71], s36 offen
    s_add_u32 s36, s23, 139776
    buffer_load_dword v23, v4, s[68:71], s36 offen
    s_add_u32 s36, s23, 143360
    buffer_load_dword v24, v4, s[68:71], s36 offen
    s_add_u32 s36, s23, 146944
    buffer_load_dword v25, v4, s[68:71], s36 offen
    s_add_u32 s36, s23, 150528
    buffer_load_dword v26, v4, s[68:71], s36 offen
    s_add_u32 s36, s23, 154112
    buffer_load_dword v27, v4, s[68:71], s36 offen
    s_add_u32 s36, s23, 157696
    buffer_load_dword v28, v4, s[68:71], s36 offen
    s_add_u32 s36, s23, 161280
    buffer_load_dword v29, v4, s[68:71], s36 offen
    s_add_u32 s36, s23, 164864
    buffer_load_dword v30, v4, s[68:71], s36 offen
    s_add_u32 s36, s23, 168448
    buffer_load_dword v31, v4, s[68:71], s36 offen
    s_add_u32 s36, s23, 172032
    buffer_load_dword v32, v4, s[68:71], s36 offen
    s_add_u32 s36, s23, 175616
    buffer_load_dword v33, v4, s[68:71], s36 offen
    s_add_u32 s36, s23, 179200
    buffer_load_dword v34, v4, s[68:71], s36 offen
    s_add_u32 s36, s23, 182784
    buffer_load_dword v35, v4, s[68:71], s36 offen
    s_add_u32 s36, s23, 186368
    buffer_load_dword v36, v4, s[68:71], s36 offen
    s_add_u32 s36, s23, 189952
    buffer_load_dword v37, v4, s[68:71], s36 offen
    s_add_u32 s36, s23, 193536
    buffer_load_dword v38, v4, s[68:71], s36 offen
    s_add_u32 s36, s23, 197120
    buffer_load_dword v39, v4, s[68:71], s36 offen
    s_add_u32 s36, s23, 200704
    buffer_load_dword v40, v4, s[68:71], s36 offen
    s_add_u32 s36, s23, 204288
    buffer_load_dword v41, v4, s[68:71], s36 offen
    s_add_u32 s36, s23, 207872
    buffer_load_dword v42, v4, s[68:71], s36 offen
    s_add_u32 s36, s23, 211456
    buffer_load_dword v43, v4, s[68:71], s36 offen
    s_add_u32 s36, s23, 215040
    buffer_load_dword v44, v4, s[68:71], s36 offen
    s_add_u32 s36, s23, 218624
    buffer_load_dword v45, v4, s[68:71], s36 offen
    s_add_u32 s36, s23, 222208
    buffer_load_dword v46, v4, s[68:71], s36 offen
    s_add_u32 s36, s23, 225792
    buffer_load_dword v47, v4, s[68:71], s36 offen
    s_waitcnt vmcnt(0)
    v_perm_b32 v208, v17, v16, s34
    v_perm_b32 v209, v19, v18, s34
    v_perm_b32 v210, v21, v20, s34
    v_perm_b32 v211, v23, v22, s34
    v_perm_b32 v212, v25, v24, s34
    v_perm_b32 v213, v27, v26, s34
    v_perm_b32 v214, v29, v28, s34
    v_perm_b32 v215, v31, v30, s34
    v_perm_b32 v216, v33, v32, s34
    v_perm_b32 v217, v35, v34, s34
    v_perm_b32 v218, v37, v36, s34
    v_perm_b32 v219, v39, v38, s34
    v_perm_b32 v220, v41, v40, s34
    v_perm_b32 v221, v43, v42, s34
    v_perm_b32 v222, v45, v44, s34
    v_perm_b32 v223, v47, v46, s34
    v_perm_b32 v240, v17, v16, s35
    v_perm_b32 v241, v19, v18, s35
    v_perm_b32 v242, v21, v20, s35
    v_perm_b32 v243, v23, v22, s35
    v_perm_b32 v244, v25, v24, s35
    v_perm_b32 v245, v27, v26, s35
    v_perm_b32 v246, v29, v28, s35
    v_perm_b32 v247, v31, v30, s35
    v_perm_b32 v248, v33, v32, s35
    v_perm_b32 v249, v35, v34, s35
    v_perm_b32 v250, v37, v36, s35
    v_perm_b32 v251, v39, v38, s35
    v_perm_b32 v252, v41, v40, s35
    v_perm_b32 v253, v43, v42, s35
    v_perm_b32 v254, v45, v44, s35
    v_perm_b32 v255, v47, v46, s35
    v_lshrrev_b32 v3, 3, v0
    v_mul_u32_u24 v4, 57344, v3
    v_and_b32 v3, 7, v0
    v_lshl_add_u32 v4, v3, 2, v4
    s_lshl_b32 s37, s20, 5
    s_add_u32 s36, s37, 0
    buffer_load_dword v16, v4, s[76:79], s36 offen
    s_add_u32 s36, s37, 1024
    buffer_load_dword v17, v4, s[76:79], s36 offen
    s_add_u32 s36, s37, 2048
    buffer_load_dword v18, v4, s[76:79], s36 offen
    s_add_u32 s36, s37, 3072
    buffer_load_dword v19, v4, s[76:79], s36 offen
    s_add_u32 s36, s37, 4096
    buffer_load_dword v20, v4, s[76:79], s36 offen
    s_add_u32 s36, s37, 5120
    buffer_load_dword v21, v4, s[76:79], s36 offen
    s_add_u32 s36, s37, 6144
    buffer_load_dword v22, v4, s[76:79], s36 offen
    s_add_u32 s36, s37, 7168
    buffer_load_dword v23, v4, s[76:79], s36 offen
    s_add_u32 s36, s37, 8192
    buffer_load_dword v24, v4, s[76:79], s36 offen
    s_add_u32 s36, s37, 9216
    buffer_load_dword v25, v4, s[76:79], s36 offen
    s_add_u32 s36, s37, 10240
    buffer_load_dword v26, v4, s[76:79], s36 offen
    s_add_u32 s36, s37, 11264
    buffer_load_dword v27, v4, s[76:79], s36 offen
    s_add_u32 s36, s37, 12288
    buffer_load_dword v28, v4, s[76:79], s36 offen
    s_add_u32 s36, s37, 13312
    buffer_load_dword v29, v4, s[76:79], s36 offen
    s_add_u32 s36, s37, 14336
    buffer_load_dword v30, v4, s[76:79], s36 offen
    s_add_u32 s36, s37, 15360
    buffer_load_dword v31, v4, s[76:79], s36 offen
    s_add_u32 s36, s37, 16384
    buffer_load_dword v32, v4, s[76:79], s36 offen
    s_add_u32 s36, s37, 17408
    buffer_load_dword v33, v4, s[76:79], s36 offen
    s_add_u32 s36, s37, 18432
    buffer_load_dword v34, v4, s[76:79], s36 offen
    s_add_u32 s36, s37, 19456
    buffer_load_dword v35, v4, s[76:79], s36 offen
    s_add_u32 s36, s37, 20480
    buffer_load_dword v36, v4, s[76:79], s36 offen
    s_add_u32 s36, s37, 21504
    buffer_load_dword v37, v4, s[76:79], s36 offen
    s_add_u32 s36, s37, 22528
    buffer_load_dword v38, v4, s[76:79], s36 offen
    s_add_u32 s36, s37, 23552
    buffer_load_dword v39, v4, s[76:79], s36 offen
    s_add_u32 s36, s37, 24576
    buffer_load_dword v40, v4, s[76:79], s36 offen
    s_add_u32 s36, s37, 25600
    buffer_load_dword v41, v4, s[76:79], s36 offen
    s_add_u32 s36, s37, 26624
    buffer_load_dword v42, v4, s[76:79], s36 offen
    s_add_u32 s36, s37, 27648
    buffer_load_dword v43, v4, s[76:79], s36 offen
    s_waitcnt vmcnt(0)
    v_perm_b32 v64, v17, v16, s34
    v_perm_b32 v65, v19, v18, s34
    v_perm_b32 v66, v21, v20, s34
    v_perm_b32 v67, v23, v22, s34
    v_perm_b32 v68, v25, v24, s34
    v_perm_b32 v69, v27, v26, s34
    v_perm_b32 v70, v29, v28, s34
    v_perm_b32 v71, v31, v30, s34
    v_perm_b32 v72, v33, v32, s34
    v_perm_b32 v73, v35, v34, s34
    v_perm_b32 v74, v37, v36, s34
    v_perm_b32 v75, v39, v38, s34
    v_perm_b32 v76, v41, v40, s34
    v_perm_b32 v77, v43, v42, s34
    v_perm_b32 v92, v17, v16, s35
    v_perm_b32 v93, v19, v18, s35
    v_perm_b32 v94, v21, v20, s35
    v_perm_b32 v95, v23, v22, s35
    v_perm_b32 v96, v25, v24, s35
    v_perm_b32 v97, v27, v26, s35
    v_perm_b32 v98, v29, v28, s35
    v_perm_b32 v99, v31, v30, s35
    v_perm_b32 v100, v33, v32, s35
    v_perm_b32 v101, v35, v34, s35
    v_perm_b32 v102, v37, v36, s35
    v_perm_b32 v103, v39, v38, s35
    v_perm_b32 v104, v41, v40, s35
    v_perm_b32 v105, v43, v42, s35
    s_add_u32 s36, s37, 28672
    buffer_load_dword v16, v4, s[76:79], s36 offen
    s_add_u32 s36, s37, 29696
    buffer_load_dword v17, v4, s[76:79], s36 offen
    s_add_u32 s36, s37, 30720
    buffer_load_dword v18, v4, s[76:79], s36 offen
    s_add_u32 s36, s37, 31744
    buffer_load_dword v19, v4, s[76:79], s36 offen
    s_add_u32 s36, s37, 32768
    buffer_load_dword v20, v4, s[76:79], s36 offen
    s_add_u32 s36, s37, 33792
    buffer_load_dword v21, v4, s[76:79], s36 offen
    s_add_u32 s36, s37, 34816
    buffer_load_dword v22, v4, s[76:79], s36 offen
    s_add_u32 s36, s37, 35840
    buffer_load_dword v23, v4, s[76:79], s36 offen
    s_add_u32 s36, s37, 36864
    buffer_load_dword v24, v4, s[76:79], s36 offen
    s_add_u32 s36, s37, 37888
    buffer_load_dword v25, v4, s[76:79], s36 offen
    s_add_u32 s36, s37, 38912
    buffer_load_dword v26, v4, s[76:79], s36 offen
    s_add_u32 s36, s37, 39936
    buffer_load_dword v27, v4, s[76:79], s36 offen
    s_add_u32 s36, s37, 40960
    buffer_load_dword v28, v4, s[76:79], s36 offen
    s_add_u32 s36, s37, 41984
    buffer_load_dword v29, v4, s[76:79], s36 offen
    s_add_u32 s36, s37, 43008
    buffer_load_dword v30, v4, s[76:79], s36 offen
    s_add_u32 s36, s37, 44032
    buffer_load_dword v31, v4, s[76:79], s36 offen
    s_add_u32 s36, s37, 45056
    buffer_load_dword v32, v4, s[76:79], s36 offen
    s_add_u32 s36, s37, 46080
    buffer_load_dword v33, v4, s[76:79], s36 offen
    s_add_u32 s36, s37, 47104
    buffer_load_dword v34, v4, s[76:79], s36 offen
    s_add_u32 s36, s37, 48128
    buffer_load_dword v35, v4, s[76:79], s36 offen
    s_add_u32 s36, s37, 49152
    buffer_load_dword v36, v4, s[76:79], s36 offen
    s_add_u32 s36, s37, 50176
    buffer_load_dword v37, v4, s[76:79], s36 offen
    s_add_u32 s36, s37, 51200
    buffer_load_dword v38, v4, s[76:79], s36 offen
    s_add_u32 s36, s37, 52224
    buffer_load_dword v39, v4, s[76:79], s36 offen
    s_add_u32 s36, s37, 53248
    buffer_load_dword v40, v4, s[76:79], s36 offen
    s_add_u32 s36, s37, 54272
    buffer_load_dword v41, v4, s[76:79], s36 offen
    s_add_u32 s36, s37, 55296
    buffer_load_dword v42, v4, s[76:79], s36 offen
    s_add_u32 s36, s37, 56320
    buffer_load_dword v43, v4, s[76:79], s36 offen
    s_waitcnt vmcnt(0)
    v_perm_b32 v78, v17, v16, s34
    v_perm_b32 v79, v19, v18, s34
    v_perm_b32 v80, v21, v20, s34
    v_perm_b32 v81, v23, v22, s34
    v_perm_b32 v82, v25, v24, s34
    v_perm_b32 v83, v27, v26, s34
    v_perm_b32 v84, v29, v28, s34
    v_perm_b32 v85, v31, v30, s34
    v_perm_b32 v86, v33, v32, s34
    v_perm_b32 v87, v35, v34, s34
    v_perm_b32 v88, v37, v36, s34
    v_perm_b32 v89, v39, v38, s34
    v_perm_b32 v90, v41, v40, s34
    v_perm_b32 v91, v43, v42, s34
    v_perm_b32 v106, v17, v16, s35
    v_perm_b32 v107, v19, v18, s35
    v_perm_b32 v108, v21, v20, s35
    v_perm_b32 v109, v23, v22, s35
    v_perm_b32 v110, v25, v24, s35
    v_perm_b32 v111, v27, v26, s35
    v_perm_b32 v112, v29, v28, s35
    v_perm_b32 v113, v31, v30, s35
    v_perm_b32 v114, v33, v32, s35
    v_perm_b32 v115, v35, v34, s35
    v_perm_b32 v116, v37, v36, s35
    v_perm_b32 v117, v39, v38, s35
    v_perm_b32 v118, v41, v40, s35
    v_perm_b32 v119, v43, v42, s35
    s_mov_b32 s42, 0xffff0000
    s_mov_b32 s24, 0
    s_mov_b64 s[28:29], 0
    v_mov_b32 v12, 0x40000000
    v_mov_b32 v13, 0
    v_lshlrev_b32 v3, 4, v0
L_M06_rp:
    s_mov_b32 s36, 0x19a000
    buffer_load_dwordx4 v[40:43], v3, s[8:11], s36 offen sc1
    s_add_u32 s32, s32, 1
    v_mov_b32 v5, 0
    s_waitcnt vmcnt(0)
    v_max3_u32 v5, v5, v40, v41
    v_max3_u32 v5, v5, v42, v43
    s_cmp_gt_u32 s32, 200000
    s_cbranch_scc1 L_M06_rp_ok
    v_cmp_eq_u32 vcc, -1, v5
    s_cbranch_vccz L_M06_rp_ok
    s_sleep 32
    s_branch L_M06_rp
L_M06_rp_ok:
    v_add_f32 v40, v40, v41
    v_add_f32 v42, v42, v43
    v_add_f32 v40, v40, v42
    v_cvt_pk_bf16_f32 v5, v40, v40
    v_lshlrev_b32 v40, 16, v5
    v_ashrrev_i32 v5, 31, v40
    v_or_b32 v5, 0x80000000, v5
    v_xor_b32 v5, v5, v40
    v_and_b32 v5, 0xffff0000, v5
    v_sub_u32 v6, 511, v0
    v_or_b32 v126, v5, v6
    v_lshlrev_b32 v3, 4, v0
L_M01_rp:
    s_mov_b32 s36, 0x195000
    buffer_load_dwordx4 v[20:23], v3, s[8:11], s36 offen sc1
    s_mov_b32 s36, 0x196000
    buffer_load_dwordx4 v[24:27], v3, s[8:11], s36 offen sc1
    s_mov_b32 s36, 0x197000
    buffer_load_dwordx4 v[28:31], v3, s[8:11], s36 offen sc1
    s_mov_b32 s36, 0x198000
    buffer_load_dwordx4 v[32:35], v3, s[8:11], s36 offen sc1
    s_mov_b32 s36, 0x199000
    buffer_load_dwordx4 v[36:39], v3, s[8:11], s36 offen sc1
    s_add_u32 s32, s32, 1
    v_mov_b32 v5, 0
    s_waitcnt vmcnt(0)
    v_max3_u32 v5, v5, v20, v21
    v_max3_u32 v5, v5, v22, v23
    v_max3_u32 v5, v5, v24, v25
    v_max3_u32 v5, v5, v26, v27
    v_max3_u32 v5, v5, v28, v29
    v_max3_u32 v5, v5, v30, v31
    v_max3_u32 v5, v5, v32, v33
    v_max3_u32 v5, v5, v34, v35
    v_max3_u32 v5, v5, v36, v37
    v_max3_u32 v5, v5, v38, v39
    s_cmp_gt_u32 s32, 200000
    s_cbranch_scc1 L_M01_rp_ok
    v_cmp_eq_u32 vcc, -1, v5
    s_cbranch_vccz L_M01_rp_ok
    s_sleep 8
    s_branch L_M01_rp
L_M01_rp_ok:
    v_add_f32 v20, v20, v21
    v_add_f32 v22, v22, v23
    v_add_f32 v20, v20, v22
    v_cvt_pk_bf16_f32 v5, v20, v20
    v_lshlrev_b32 v20, 16, v5
    v_ashrrev_i32 v5, 31, v20
    v_or_b32 v5, 0x80000000, v5
    v_xor_b32 v5, v5, v20
    v_and_b32 v5, 0xffff0000, v5
    v_sub_u32 v6, 1791, v0
    v_or_b32 v121, v5, v6
    v_add_f32 v24, v24, v25
    v_add_f32 v26, v26, v27
    v_add_f32 v24, v24, v26
    v_cvt_pk_bf16_f32 v5, v24, v24
    v_lshlrev_b32 v24, 16, v5
    v_ashrrev_i32 v5, 31, v24
    v_or_b32 v5, 0x80000000, v5
    v_xor_b32 v5, v5, v24
    v_and_b32 v5, 0xffff0000, v5
    v_sub_u32 v6, 1535, v0
    v_or_b32 v122, v5, v6
    v_add_f32 v28, v28, v29
    v_add_f32 v30, v30, v31
    v_add_f32 v28, v28, v30
    v_cvt_pk_bf16_f32 v5, v28, v28
    v_lshlrev_b32 v28, 16, v5
    v_ashrrev_i32 v5, 31, v28
    v_or_b32 v5, 0x80000000, v5
    v_xor_b32 v5, v5, v28
    v_and_b32 v5, 0xffff0000, v5
    v_sub_u32 v6, 1279, v0
    v_or_b32 v123, v5, v6
    v_add_f32 v32, v32, v33
    v_add_f32 v34, v34, v35
    v_add_f32 v32, v32, v34
    v_cvt_pk_bf16_f32 v5, v32, v32
    v_lshlrev_b32 v32, 16, v5
    v_ashrrev_i32 v5, 31, v32
    v_or_b32 v5, 0x80000000, v5
    v_xor_b32 v5, v5, v32
    v_and_b32 v5, 0xffff0000, v5
    v_sub_u32 v6, 1023, v0
    v_or_b32 v124, v5, v6
    v_add_f32 v36, v36, v37
    v_add_f32 v38, v38, v39
    v_add_f32 v36, v36, v38
    v_cvt_pk_bf16_f32 v5, v36, v36
    v_lshlrev_b32 v36, 16, v5
    v_ashrrev_i32 v5, 31, v36
    v_or_b32 v5, 0x80000000, v5
    v_xor_b32 v5, v5, v36
    v_and_b32 v5, 0xffff0000, v5
    v_sub_u32 v6, 767, v0
    v_or_b32 v125, v5, v6
    v_max_u32 v5, v120, v121
    v_min_u32 v6, v120, v121
    v_med3_u32 v6, v5, v6, v122
    v_max_u32 v5, v5, v122
    v_med3_u32 v6, v5, v6, v123
    v_max_u32 v5, v5, v123
    v_med3_u32 v6, v5, v6, v124
    v_max_u32 v5, v5, v124
    v_med3_u32 v6, v5, v6, v125
    v_max_u32 v5, v5, v125
    v_med3_u32 v6, v5, v6, v126
    v_max_u32 v5, v5, v126
    v_mov_b32 v120, v5
    v_mov_b32 v121, v6
    s_mov_b32 s25, 32
L_M_round:
    v_lshlrev_b32 v3, 4, v0
    v_cmp_gt_u32 s[74:75], s25, v0
L_M7_rp:
    s_mov_b32 s36, 0x19b000
    buffer_load_dwordx4 v[44:47], v3, s[8:11], s36 offen sc1
    s_add_u32 s32, s32, 1
    v_mov_b32 v5, 0
    s_waitcnt vmcnt(0)
    v_max3_u32 v5, v5, v44, v45
    v_max3_u32 v5, v5, v46, v47
    v_cndmask_b32 v5, 0, v5, s[74:75]
    s_cmp_gt_u32 s32, 200000
    s_cbranch_scc1 L_M7_rp_ok
    v_cmp_eq_u32 vcc, -1, v5
    s_cbranch_vccnz L_M7_rp
L_M7_rp_ok:
    v_add_f32 v44, v44, v45
    v_add_f32 v46, v46, v47
    v_add_f32 v44, v44, v46
    v_cvt_pk_bf16_f32 v5, v44, v44
    v_lshlrev_b32 v44, 16, v5
    v_ashrrev_i32 v5, 31, v44
    v_or_b32 v5, 0x80000000, v5
    v_xor_b32 v5, v5, v44
    v_and_b32 v5, 0xffff0000, v5
    v_sub_u32 v6, 255, v0
    v_or_b32 v127, v5, v6
    v_cndmask_b32 v127, 0, v127, s[74:75]
    v_max_u32 v5, v120, v127
    v_med3_u32 v6, v120, v121, v127
    s_nop 0
    v_mov_b32_dpp v7, v5 quad_perm:[1,0,3,2] row_mask:0xf bank_mask:0xf
    v_mov_b32_dpp v8, v6 quad_perm:[1,0,3,2] row_mask:0xf bank_mask:0xf
    v_min_u32 v9, v5, v7
    v_max_u32 v5, v5, v7
    v_max3_u32 v6, v6, v8, v9
    s_nop 0
    v_mov_b32_dpp v7, v5 quad_perm:[2,3,0,1] row_mask:0xf bank_mask:0xf
    v_mov_b32_dpp v8, v6 quad_perm:[2,3,0,1] row_mask:0xf bank_mask:0xf
    v_min_u32 v9, v5, v7
    v_max_u32 v5, v5, v7
    v_max3_u32 v6, v6, v8, v9
    s_nop 0
    v_mov_b32_dpp v7, v5 row_half_mirror row_mask:0xf bank_mask:0xf
    v_mov_b32_dpp v8, v6 row_half_mirror row_mask:0xf bank_mask:0xf
    v_min_u32 v9, v5, v7
    v_max_u32 v5, v5, v7
    v_max3_u32 v6, v6, v8, v9
    s_nop 0
    v_mov_b32_dpp v7, v5 row_mirror row_mask:0xf bank_mask:0xf
    v_mov_b32_dpp v8, v6 row_mirror row_mask:0xf bank_mask:0xf
    v_min_u32 v9, v5, v7
    v_max_u32 v5, v5, v7
    v_max3_u32 v6, v6, v8, v9
    v_lshrrev_b32 v9, 4, v0
    v_lshlrev_b32 v9, 3, v9
    s_barrier
    ds_write2_b32 v9, v5, v6 offset0:0 offset1:1
    v_and_b32 v9, 15, v0
    v_lshlrev_b32 v9, 3, v9
    s_waitcnt lgkmcnt(0)
    s_barrier
    ds_read2_b32 v[10:11], v9 offset0:0 offset1:1
    s_waitcnt lgkmcnt(0)
    v_mov_b32 v5, v10
    v_mov_b32 v6, v11
    s_nop 0
    v_mov_b32_dpp v7, v5 quad_perm:[1,0,3,2] row_mask:0xf bank_mask:0xf
    v_mov_b32_dpp v8, v6 quad_perm:[1,0,3,2] row_mask:0xf bank_mask:0xf
    v_min_u32 v9, v5, v7
    v_max_u32 v5, v5, v7
    v_max3_u32 v6, v6, v8, v9
    s_nop 0
    v_mov_b32_dpp v7, v5 quad_perm:[2,3,0,1] row_mask:0xf bank_mask:0xf
    v_mov_b32_dpp v8, v6 quad_perm:[2,3,0,1] row_mask:0xf bank_mask:0xf
    v_min_u32 v9, v5, v7
    v_max_u32 v5, v5, v7
    v_max3_u32 v6, v6, v8, v9
    s_nop 0
    v_mov_b32_dpp v7, v5 row_half_mirror row_mask:0xf bank_mask:0xf
    v_mov_b32_dpp v8, v6 row_half_mirror row_mask:0xf bank_mask:0xf
    v_min_u32 v9, v5, v7
    v_max_u32 v5, v5, v7
    v_max3_u32 v6, v6, v8, v9
    s_nop 0
    v_mov_b32_dpp v7, v5 row_mirror row_mask:0xf bank_mask:0xf
    v_mov_b32_dpp v8, v6 row_mirror row_mask:0xf bank_mask:0xf
    v_min_u32 v9, v5, v7
    v_max_u32 v5, v5, v7
    v_max3_u32 v6, v6, v8, v9
    v_readfirstlane_b32 s26, v5
    v_readfirstlane_b32 s27, v6
    s_nop 3
    s_cmp_eq_u64 s[26:27], s[28:29]
    s_cbranch_scc1 L_M_next
    s_mov_b64 s[28:29], s[26:27]
    buffer_store_dword v13, v12, s[60:63], 0 offen sc1
    s_and_b32 s36, s26, 0x7ff
    s_sub_u32 s30, 2047, s36
    s_and_b32 s36, s26, 0xffff0000
    s_xor_b32 s37, s36, 0x80000000
    s_xor_b32 s40, s36, 0xffff0000
    s_bitcmp1_b32 s36, 31
    s_cselect_b32 s40, s37, s40
    s_and_b32 s36, s27, 0x7ff
    s_sub_u32 s31, 2047, s36
    s_and_b32 s36, s27, 0xffff0000
    s_xor_b32 s37, s36, 0x80000000
    s_xor_b32 s41, s36, 0xffff0000
    s_bitcmp1_b32 s36, 31
    s_cselect_b32 s41, s37, s41
    v_mov_b32 v8, 0
L_M_rows:
    s_lshl_b32 s36, s30, 4
    s_add_u32 s36, s36, 0x1b8000
    buffer_load_dwordx4 v[16:19], v8, s[8:11], s36 offen sc1
    s_lshl_b32 s36, s31, 4
    s_add_u32 s36, s36, 0x1b8000
    buffer_load_dwordx4 v[20:23], v8, s[8:11], s36 offen sc1
    s_add_u32 s32, s32, 1
    s_cmp_gt_u32 s32, 200000
    s_waitcnt vmcnt(0)
    v_or3_b32 v5, v16, v17, v18
    v_or3_b32 v5, v5, v19, v20
    v_or3_b32 v5, v5, v21, v22
    v_or_b32 v5, v5, v23
    s_cbranch_scc1 L_M_rows_ok
    v_cmp_ne_u32 vcc, 0, v5
    s_cbranch_vccnz L_M_rows
L_M_rows_ok:
    v_bfe_u32 v9, v0, 6, 1
    v_cmp_ne_u32 vcc, 0, v9
    v_mov_b32 v5, s30
    v_mov_b32 v6, s31
    v_cndmask_b32 v7, v5, v6, vcc
    v_lshlrev_b32 v7, 10, v7
    v_and_b32 v8, 63, v0
    v_lshl_add_u32 v7, v8, 4, v7
    s_mov_b32 s37, 0x600000
    buffer_load_dwordx4 v[16:19], v7, s[8:11], s37 offen sc1
    v_bfe_u32 v9, v0, 3, 1
    v_cmp_ne_u32 vcc, 0, v9
    s_nop 1
    v_cndmask_b32 v12, v5, v6, vcc
    v_mov_b32 v5, s40
    v_mov_b32 v6, s41
    v_cndmask_b32 v11, v5, v6, vcc
    v_lshlrev_b32 v12, 10, v12
    v_and_b32 v3, 7, v0
    v_lshl_add_u32 v12, v3, 2, v12
    s_lshl_b32 s36, s20, 5
    v_add_u32 v12, s36, v12
    v_mov_b32 v7, 0x40000000
    v_cmp_lt_u32 vcc, 15, v0
    s_nop 1
    v_cndmask_b32 v12, v12, v7, vcc
    s_mov_b32 s36, 0x400000
    buffer_load_dword v14, v12, s[8:11], s36 offen sc1
    buffer_load_dword v15, v12, s[8:11], s37 offen sc1
    v_and_b32 v8, 127, v0
    v_lshlrev_b32 v8, 4, v8
    s_waitcnt vmcnt(2)
    ds_write_b128 v8, v[16:19] offset:4096
    s_waitcnt lgkmcnt(0)
    s_barrier
    v_mov_b64 v[48:49], 0
    v_mov_b64 v[50:51], 0
    v_mov_b64 v[52:53], 0
    v_mov_b64 v[54:55], 0
    v_lshlrev_b32 v8, 7, v1
    ds_read_b128 v[16:19], v8 offset:4096
    ds_read_b128 v[20:23], v8 offset:4112
    ds_read_b128 v[24:27], v8 offset:4128
    ds_read_b128 v[28:31], v8 offset:4144
    ds_read_b128 v[32:35], v8 offset:5120
    ds_read_b128 v[36:39], v8 offset:5136
    ds_read_b128 v[40:43], v8 offset:5152
    ds_read_b128 v[44:47], v8 offset:5168
    s_waitcnt lgkmcnt(0)
    v_dot2_f32_bf16 v48, v16, v128, v48
    v_dot2_f32_bf16 v49, v16, v160, v49
    v_dot2_f32_bf16 v50, v32, v128, v50
    v_dot2_f32_bf16 v51, v32, v160, v51
    v_dot2_f32_bf16 v52, v16, v192, v52
    v_dot2_f32_bf16 v53, v16, v224, v53
    v_dot2_f32_bf16 v54, v32, v192, v54
    v_dot2_f32_bf16 v55, v32, v224, v55
    v_dot2_f32_bf16 v48, v17, v129, v48
    v_dot2_f32_bf16 v49, v17, v161, v49
    v_dot2_f32_bf16 v50, v33, v129, v50
    v_dot2_f32_bf16 v51, v33, v161, v51
    v_dot2_f32_bf16 v52, v17, v193, v52
    v_dot2_f32_bf16 v53, v17, v225, v53
    v_dot2_f32_bf16 v54, v33, v193, v54
    v_dot2_f32_bf16 v55, v33, v225, v55
    v_dot2_f32_bf16 v48, v18, v130, v48
    v_dot2_f32_bf16 v49, v18, v162, v49
    v_dot2_f32_bf16 v50, v34, v130, v50
    v_dot2_f32_bf16 v51, v34, v162, v51
    v_dot2_f32_bf16 v52, v18, v194, v52
    v_dot2_f32_bf16 v53, v18, v226, v53
    v_dot2_f32_bf16 v54, v34, v194, v54
    v_dot2_f32_bf16 v55, v34, v226, v55
    v_dot2_f32_bf16 v48, v19, v131, v48
    v_dot2_f32_bf16 v49, v19, v163, v49
    v_dot2_f32_bf16 v50, v35, v131, v50
    v_dot2_f32_bf16 v51, v35, v163, v51
    v_dot2_f32_bf16 v52, v19, v195, v52
    v_dot2_f32_bf16 v53, v19, v227, v53
    v_dot2_f32_bf16 v54, v35, v195, v54
    v_dot2_f32_bf16 v55, v35, v227, v55
    v_dot2_f32_bf16 v48, v20, v132, v48
    v_dot2_f32_bf16 v49, v20, v164, v49
    v_dot2_f32_bf16 v50, v36, v132, v50
    v_dot2_f32_bf16 v51, v36, v164, v51
    v_dot2_f32_bf16 v52, v20, v196, v52
    v_dot2_f32_bf16 v53, v20, v228, v53
    v_dot2_f32_bf16 v54, v36, v196, v54
    v_dot2_f32_bf16 v55, v36, v228, v55
    v_dot2_f32_bf16 v48, v21, v133, v48
    v_dot2_f32_bf16 v49, v21, v165, v49
    v_dot2_f32_bf16 v50, v37, v133, v50
    v_dot2_f32_bf16 v51, v37, v165, v51
    v_dot2_f32_bf16 v52, v21, v197, v52
    v_dot2_f32_bf16 v53, v21, v229, v53
    v_dot2_f32_bf16 v54, v37, v197, v54
    v_dot2_f32_bf16 v55, v37, v229, v55
    v_dot2_f32_bf16 v48, v22, v134, v48
    v_dot2_f32_bf16 v49, v22, v166, v49
    v_dot2_f32_bf16 v50, v38, v134, v50
    v_dot2_f32_bf16 v51, v38, v166, v51
    v_dot2_f32_bf16 v52, v22, v198, v52
    v_dot2_f32_bf16 v53, v22, v230, v53
    v_dot2_f32_bf16 v54, v38, v198, v54
    v_dot2_f32_bf16 v55, v38, v230, v55
    v_dot2_f32_bf16 v48, v23, v135, v48
    v_dot2_f32_bf16 v49, v23, v167, v49
    v_dot2_f32_bf16 v50, v39, v135, v50
    v_dot2_f32_bf16 v51, v39, v167, v51
    v_dot2_f32_bf16 v52, v23, v199, v52
    v_dot2_f32_bf16 v53, v23, v231, v53
    v_dot2_f32_bf16 v54, v39, v199, v54
    v_dot2_f32_bf16 v55, v39, v231, v55
    v_dot2_f32_bf16 v48, v24, v136, v48
    v_dot2_f32_bf16 v49, v24, v168, v49
    v_dot2_f32_bf16 v50, v40, v136, v50
    v_dot2_f32_bf16 v51, v40, v168, v51
    v_dot2_f32_bf16 v52, v24, v200, v52
    v_dot2_f32_bf16 v53, v24, v232, v53
    v_dot2_f32_bf16 v54, v40, v200, v54
    v_dot2_f32_bf16 v55, v40, v232, v55
    v_dot2_f32_bf16 v48, v25, v137, v48
    v_dot2_f32_bf16 v49, v25, v169, v49
    v_dot2_f32_bf16 v50, v41, v137, v50
    v_dot2_f32_bf16 v51, v41, v169, v51
    v_dot2_f32_bf16 v52, v25, v201, v52
    v_dot2_f32_bf16 v53, v25, v233, v53
    v_dot2_f32_bf16 v54, v41, v201, v54
    v_dot2_f32_bf16 v55, v41, v233, v55
    v_dot2_f32_bf16 v48, v26, v138, v48
    v_dot2_f32_bf16 v49, v26, v170, v49
    v_dot2_f32_bf16 v50, v42, v138, v50
    v_dot2_f32_bf16 v51, v42, v170, v51
    v_dot2_f32_bf16 v52, v26, v202, v52
    v_dot2_f32_bf16 v53, v26, v234, v53
    v_dot2_f32_bf16 v54, v42, v202, v54
    v_dot2_f32_bf16 v55, v42, v234, v55
    v_dot2_f32_bf16 v48, v27, v139, v48
    v_dot2_f32_bf16 v49, v27, v171, v49
    v_dot2_f32_bf16 v50, v43, v139, v50
    v_dot2_f32_bf16 v51, v43, v171, v51
    v_dot2_f32_bf16 v52, v27, v203, v52
    v_dot2_f32_bf16 v53, v27, v235, v53
    v_dot2_f32_bf16 v54, v43, v203, v54
    v_dot2_f32_bf16 v55, v43, v235, v55
    v_dot2_f32_bf16 v48, v28, v140, v48
    v_dot2_f32_bf16 v49, v28, v172, v49
    v_dot2_f32_bf16 v50, v44, v140, v50
    v_dot2_f32_bf16 v51, v44, v172, v51
    v_dot2_f32_bf16 v52, v28, v204, v52
    v_dot2_f32_bf16 v53, v28, v236, v53
    v_dot2_f32_bf16 v54, v44, v204, v54
    v_dot2_f32_bf16 v55, v44, v236, v55
    v_dot2_f32_bf16 v48, v29, v141, v48
    v_dot2_f32_bf16 v49, v29, v173, v49
    v_dot2_f32_bf16 v50, v45, v141, v50
    v_dot2_f32_bf16 v51, v45, v173, v51
    v_dot2_f32_bf16 v52, v29, v205, v52
    v_dot2_f32_bf16 v53, v29, v237, v53
    v_dot2_f32_bf16 v54, v45, v205, v54
    v_dot2_f32_bf16 v55, v45, v237, v55
    v_dot2_f32_bf16 v48, v30, v142, v48
    v_dot2_f32_bf16 v49, v30, v174, v49
    v_dot2_f32_bf16 v50, v46, v142, v50
    v_dot2_f32_bf16 v51, v46, v174, v51
    v_dot2_f32_bf16 v52, v30, v206, v52
    v_dot2_f32_bf16 v53, v30, v238, v53
    v_dot2_f32_bf16 v54, v46, v206, v54
    v_dot2_f32_bf16 v55, v46, v238, v55
    v_dot2_f32_bf16 v48, v31, v143, v48
    v_dot2_f32_bf16 v49, v31, v175, v49
    v_dot2_f32_bf16 v50, v47, v143, v50
    v_dot2_f32_bf16 v51, v47, v175, v51
    v_dot2_f32_bf16 v52, v31, v207, v52
    v_dot2_f32_bf16 v53, v31, v239, v53
    v_dot2_f32_bf16 v54, v47, v207, v54
    v_dot2_f32_bf16 v55, v47, v239, v55
    ds_read_b128 v[16:19], v8 offset:4160
    ds_read_b128 v[20:23], v8 offset:4176
    ds_read_b128 v[24:27], v8 offset:4192
    ds_read_b128 v[28:31], v8 offset:4208
    ds_read_b128 v[32:35], v8 offset:5184
    ds_read_b128 v[36:39], v8 offset:5200
    ds_read_b128 v[40:43], v8 offset:5216
    ds_read_b128 v[44:47], v8 offset:5232
    s_waitcnt lgkmcnt(0)
    v_dot2_f32_bf16 v48, v16, v144, v48
    v_dot2_f32_bf16 v49, v16, v176, v49
    v_dot2_f32_bf16 v50, v32, v144, v50
    v_dot2_f32_bf16 v51, v32, v176, v51
    v_dot2_f32_bf16 v52, v16, v208, v52
    v_dot2_f32_bf16 v53, v16, v240, v53
    v_dot2_f32_bf16 v54, v32, v208, v54
    v_dot2_f32_bf16 v55, v32, v240, v55
    v_dot2_f32_bf16 v48, v17, v145, v48
    v_dot2_f32_bf16 v49, v17, v177, v49
    v_dot2_f32_bf16 v50, v33, v145, v50
    v_dot2_f32_bf16 v51, v33, v177, v51
    v_dot2_f32_bf16 v52, v17, v209, v52
    v_dot2_f32_bf16 v53, v17, v241, v53
    v_dot2_f32_bf16 v54, v33, v209, v54
    v_dot2_f32_bf16 v55, v33, v241, v55
    v_dot2_f32_bf16 v48, v18, v146, v48
    v_dot2_f32_bf16 v49, v18, v178, v49
    v_dot2_f32_bf16 v50, v34, v146, v50
    v_dot2_f32_bf16 v51, v34, v178, v51
    v_dot2_f32_bf16 v52, v18, v210, v52
    v_dot2_f32_bf16 v53, v18, v242, v53
    v_dot2_f32_bf16 v54, v34, v210, v54
    v_dot2_f32_bf16 v55, v34, v242, v55
    v_dot2_f32_bf16 v48, v19, v147, v48
    v_dot2_f32_bf16 v49, v19, v179, v49
    v_dot2_f32_bf16 v50, v35, v147, v50
    v_dot2_f32_bf16 v51, v35, v179, v51
    v_dot2_f32_bf16 v52, v19, v211, v52
    v_dot2_f32_bf16 v53, v19, v243, v53
    v_dot2_f32_bf16 v54, v35, v211, v54
    v_dot2_f32_bf16 v55, v35, v243, v55
    v_dot2_f32_bf16 v48, v20, v148, v48
    v_dot2_f32_bf16 v49, v20, v180, v49
    v_dot2_f32_bf16 v50, v36, v148, v50
    v_dot2_f32_bf16 v51, v36, v180, v51
    v_dot2_f32_bf16 v52, v20, v212, v52
    v_dot2_f32_bf16 v53, v20, v244, v53
    v_dot2_f32_bf16 v54, v36, v212, v54
    v_dot2_f32_bf16 v55, v36, v244, v55
    v_dot2_f32_bf16 v48, v21, v149, v48
    v_dot2_f32_bf16 v49, v21, v181, v49
    v_dot2_f32_bf16 v50, v37, v149, v50
    v_dot2_f32_bf16 v51, v37, v181, v51
    v_dot2_f32_bf16 v52, v21, v213, v52
    v_dot2_f32_bf16 v53, v21, v245, v53
    v_dot2_f32_bf16 v54, v37, v213, v54
    v_dot2_f32_bf16 v55, v37, v245, v55
    v_dot2_f32_bf16 v48, v22, v150, v48
    v_dot2_f32_bf16 v49, v22, v182, v49
    v_dot2_f32_bf16 v50, v38, v150, v50
    v_dot2_f32_bf16 v51, v38, v182, v51
    v_dot2_f32_bf16 v52, v22, v214, v52
    v_dot2_f32_bf16 v53, v22, v246, v53
    v_dot2_f32_bf16 v54, v38, v214, v54
    v_dot2_f32_bf16 v55, v38, v246, v55
    v_dot2_f32_bf16 v48, v23, v151, v48
    v_dot2_f32_bf16 v49, v23, v183, v49
    v_dot2_f32_bf16 v50, v39, v151, v50
    v_dot2_f32_bf16 v51, v39, v183, v51
    v_dot2_f32_bf16 v52, v23, v215, v52
    v_dot2_f32_bf16 v53, v23, v247, v53
    v_dot2_f32_bf16 v54, v39, v215, v54
    v_dot2_f32_bf16 v55, v39, v247, v55
    v_dot2_f32_bf16 v48, v24, v152, v48
    v_dot2_f32_bf16 v49, v24, v184, v49
    v_dot2_f32_bf16 v50, v40, v152, v50
    v_dot2_f32_bf16 v51, v40, v184, v51
    v_dot2_f32_bf16 v52, v24, v216, v52
    v_dot2_f32_bf16 v53, v24, v248, v53
    v_dot2_f32_bf16 v54, v40, v216, v54
    v_dot2_f32_bf16 v55, v40, v248, v55
    v_dot2_f32_bf16 v48, v25, v153, v48
    v_dot2_f32_bf16 v49, v25, v185, v49
    v_dot2_f32_bf16 v50, v41, v153, v50
    v_dot2_f32_bf16 v51, v41, v185, v51
    v_dot2_f32_bf16 v52, v25, v217, v52
    v_dot2_f32_bf16 v53, v25, v249, v53
    v_dot2_f32_bf16 v54, v41, v217, v54
    v_dot2_f32_bf16 v55, v41, v249, v55
    v_dot2_f32_bf16 v48, v26, v154, v48
    v_dot2_f32_bf16 v49, v26, v186, v49
    v_dot2_f32_bf16 v50, v42, v154, v50
    v_dot2_f32_bf16 v51, v42, v186, v51
    v_dot2_f32_bf16 v52, v26, v218, v52
    v_dot2_f32_bf16 v53, v26, v250, v53
    v_dot2_f32_bf16 v54, v42, v218, v54
    v_dot2_f32_bf16 v55, v42, v250, v55
    v_dot2_f32_bf16 v48, v27, v155, v48
    v_dot2_f32_bf16 v49, v27, v187, v49
    v_dot2_f32_bf16 v50, v43, v155, v50
    v_dot2_f32_bf16 v51, v43, v187, v51
    v_dot2_f32_bf16 v52, v27, v219, v52
    v_dot2_f32_bf16 v53, v27, v251, v53
    v_dot2_f32_bf16 v54, v43, v219, v54
    v_dot2_f32_bf16 v55, v43, v251, v55
    v_dot2_f32_bf16 v48, v28, v156, v48
    v_dot2_f32_bf16 v49, v28, v188, v49
    v_dot2_f32_bf16 v50, v44, v156, v50
    v_dot2_f32_bf16 v51, v44, v188, v51
    v_dot2_f32_bf16 v52, v28, v220, v52
    v_dot2_f32_bf16 v53, v28, v252, v53
    v_dot2_f32_bf16 v54, v44, v220, v54
    v_dot2_f32_bf16 v55, v44, v252, v55
    v_dot2_f32_bf16 v48, v29, v157, v48
    v_dot2_f32_bf16 v49, v29, v189, v49
    v_dot2_f32_bf16 v50, v45, v157, v50
    v_dot2_f32_bf16 v51, v45, v189, v51
    v_dot2_f32_bf16 v52, v29, v221, v52
    v_dot2_f32_bf16 v53, v29, v253, v53
    v_dot2_f32_bf16 v54, v45, v221, v54
    v_dot2_f32_bf16 v55, v45, v253, v55
    v_dot2_f32_bf16 v48, v30, v158, v48
    v_dot2_f32_bf16 v49, v30, v190, v49
    v_dot2_f32_bf16 v50, v46, v158, v50
    v_dot2_f32_bf16 v51, v46, v190, v51
    v_dot2_f32_bf16 v52, v30, v222, v52
    v_dot2_f32_bf16 v53, v30, v254, v53
    v_dot2_f32_bf16 v54, v46, v222, v54
    v_dot2_f32_bf16 v55, v46, v254, v55
    v_dot2_f32_bf16 v48, v31, v159, v48
    v_dot2_f32_bf16 v49, v31, v191, v49
    v_dot2_f32_bf16 v50, v47, v159, v50
    v_dot2_f32_bf16 v51, v47, v191, v51
    v_dot2_f32_bf16 v52, v31, v223, v52
    v_dot2_f32_bf16 v53, v31, v255, v53
    v_dot2_f32_bf16 v54, v47, v223, v54
    v_dot2_f32_bf16 v55, v47, v255, v55
    s_nop 3
    v_lshlrev_b32 v7, 5, v0
    ds_write_b128 v7, v[48:51] offset:8192
    ds_write_b128 v7, v[52:55] offset:8208
    s_waitcnt lgkmcnt(0)
    s_barrier
    v_lshlrev_b32 v7, 5, v2
    v_bfe_u32 v8, v0, 5, 1
    v_lshl_add_u32 v7, v8, 3, v7
    ds_read_b64 v[16:17], v7 offset:8192
    ds_read_b64 v[18:19], v7 offset:8208
    ds_read_b64 v[20:21], v7 offset:9216
    ds_read_b64 v[22:23], v7 offset:9232
    ds_read_b64 v[24:25], v7 offset:10240
    ds_read_b64 v[26:27], v7 offset:10256
    ds_read_b64 v[28:29], v7 offset:11264
    ds_read_b64 v[30:31], v7 offset:11280
    s_waitcnt lgkmcnt(0)
    ds_read_b64 v[32:33], v7 offset:12288
    ds_read_b64 v[34:35], v7 offset:12304
    ds_read_b64 v[36:37], v7 offset:13312
    ds_read_b64 v[38:39], v7 offset:13328
    ds_read_b64 v[40:41], v7 offset:14336
    ds_read_b64 v[42:43], v7 offset:14352
    ds_read_b64 v[44:45], v7 offset:15360
    ds_read_b64 v[46:47], v7 offset:15376
    s_waitcnt lgkmcnt(0)
    v_add_f32 v16, v16, v20
    v_add_f32 v16, v16, v24
    v_add_f32 v16, v16, v28
    v_add_f32 v16, v16, v32
    v_add_f32 v16, v16, v36
    v_add_f32 v16, v16, v40
    v_add_f32 v16, v16, v44
    v_cvt_pk_bf16_f32 v5, v16, v16
    v_lshlrev_b32 v16, 16, v5
    v_add_f32 v17, v17, v21
    v_add_f32 v17, v17, v25
    v_add_f32 v17, v17, v29
    v_add_f32 v17, v17, v33
    v_add_f32 v17, v17, v37
    v_add_f32 v17, v17, v41
    v_add_f32 v17, v17, v45
    v_cvt_pk_bf16_f32 v5, v17, v17
    v_lshlrev_b32 v17, 16, v5
    v_add_f32 v18, v18, v22
    v_add_f32 v18, v18, v26
    v_add_f32 v18, v18, v30
    v_add_f32 v18, v18, v34
    v_add_f32 v18, v18, v38
    v_add_f32 v18, v18, v42
    v_add_f32 v18, v18, v46
    v_cvt_pk_bf16_f32 v5, v18, v18
    v_lshlrev_b32 v18, 16, v5
    v_add_f32 v19, v19, v23
    v_add_f32 v19, v19, v27
    v_add_f32 v19, v19, v31
    v_add_f32 v19, v19, v35
    v_add_f32 v19, v19, v39
    v_add_f32 v19, v19, v43
    v_add_f32 v19, v19, v47
    v_cvt_pk_bf16_f32 v5, v19, v19
    v_lshlrev_b32 v19, 16, v5
    v_mul_f32 v6, 0xbfb8aa3b, v16
    v_exp_f32 v6, v6
    s_nop 0
    v_add_f32 v6, 1.0, v6
    v_rcp_f32 v6, v6
    s_nop 0
    v_mul_f32 v16, v16, v6
    v_cvt_pk_bf16_f32 v5, v16, v16
    v_lshlrev_b32 v16, 16, v5
    v_mul_f32 v16, v16, v18
    v_mul_f32 v6, 0xbfb8aa3b, v17
    v_exp_f32 v6, v6
    s_nop 0
    v_add_f32 v6, 1.0, v6
    v_rcp_f32 v6, v6
    s_nop 0
    v_mul_f32 v17, v17, v6
    v_cvt_pk_bf16_f32 v5, v17, v17
    v_lshlrev_b32 v17, 16, v5
    v_mul_f32 v17, v17, v19
    v_cvt_pk_bf16_f32 v16, v16, v17
    v_mul_u32_u24 v8, 3584, v8
    v_lshl_add_u32 v7, v2, 2, v8
    v_mov_b32 v6, 0x40000000
    v_cmp_lt_u32 vcc, 27, v2
    s_nop 1
    v_cndmask_b32 v7, v7, v6, vcc
    v_cmp_lt_u32 vcc, 63, v0
    s_nop 1
    v_cndmask_b32 v7, v7, v6, vcc
    s_mul_i32 s37, s24, 8192
    s_add_u32 s37, s37, 0x1b0000
    s_add_u32 s36, s37, s23
    buffer_store_dword v16, v7, s[8:11], s36 offen sc1
    v_lshlrev_b32 v7, 4, v0
    v_add_u32 v8, 4096, v7
    v_cmp_lt_u32 vcc, 191, v0
    s_nop 1
    v_cndmask_b32 v8, v8, v6, vcc
L_M_act:
    buffer_load_dwordx4 v[20:23], v7, s[8:11], s37 offen sc1
    buffer_load_dwordx4 v[24:27], v8, s[8:11], s37 offen sc1
    s_add_u32 s32, s32, 1
    s_cmp_gt_u32 s32, 200000
    s_waitcnt vmcnt(0)
    v_max3_u32 v5, v20, v21, v22
    v_max3_u32 v5, v5, v23, v24
    v_max3_u32 v5, v5, v25, v26
    v_max_u32 v5, v5, v27
    s_cbranch_scc1 L_M_act_ok
    v_cmp_eq_u32 vcc, -1, v5
    s_cbranch_vccnz L_M_act
L_M_act_ok:
    ds_write_b128 v7, v[20:23] offset:16384
    ds_write_b128 v7, v[24:27] offset:20480
    s_waitcnt lgkmcnt(0)
    s_barrier
    v_lshrrev_b32 v7, 3, v0
    v_mul_u32_u24 v7, 112, v7
    v_mov_b64 v[48:49], 0
    v_mov_b64 v[50:51], 0
    ds_read_b128 v[16:19], v7 offset:16384
    ds_read_b128 v[20:23], v7 offset:16400
    ds_read_b128 v[24:27], v7 offset:16416
    ds_read_b128 v[28:31], v7 offset:16432
    ds_read_b128 v[32:35], v7 offset:16448
    ds_read_b128 v[36:39], v7 offset:16464
    ds_read_b128 v[40:43], v7 offset:16480
    s_waitcnt lgkmcnt(0)
    v_dot2_f32_bf16 v48, v16, v64, v48
    v_dot2_f32_bf16 v49, v16, v92, v49
    v_dot2_f32_bf16 v48, v17, v65, v48
    v_dot2_f32_bf16 v49, v17, v93, v49
    v_dot2_f32_bf16 v48, v18, v66, v48
    v_dot2_f32_bf16 v49, v18, v94, v49
    v_dot2_f32_bf16 v48, v19, v67, v48
    v_dot2_f32_bf16 v49, v19, v95, v49
    v_dot2_f32_bf16 v48, v20, v68, v48
    v_dot2_f32_bf16 v49, v20, v96, v49
    v_dot2_f32_bf16 v48, v21, v69, v48
    v_dot2_f32_bf16 v49, v21, v97, v49
    v_dot2_f32_bf16 v48, v22, v70, v48
    v_dot2_f32_bf16 v49, v22, v98, v49
    v_dot2_f32_bf16 v48, v23, v71, v48
    v_dot2_f32_bf16 v49, v23, v99, v49
    v_dot2_f32_bf16 v48, v24, v72, v48
    v_dot2_f32_bf16 v49, v24, v100, v49
    v_dot2_f32_bf16 v48, v25, v73, v48
    v_dot2_f32_bf16 v49, v25, v101, v49
    v_dot2_f32_bf16 v48, v26, v74, v48
    v_dot2_f32_bf16 v49, v26, v102, v49
    v_dot2_f32_bf16 v48, v27, v75, v48
    v_dot2_f32_bf16 v49, v27, v103, v49
    v_dot2_f32_bf16 v48, v28, v76, v48
    v_dot2_f32_bf16 v49, v28, v104, v49
    v_dot2_f32_bf16 v48, v29, v77, v48
    v_dot2_f32_bf16 v49, v29, v105, v49
    v_dot2_f32_bf16 v48, v30, v78, v48
    v_dot2_f32_bf16 v49, v30, v106, v49
    v_dot2_f32_bf16 v48, v31, v79, v48
    v_dot2_f32_bf16 v49, v31, v107, v49
    v_dot2_f32_bf16 v48, v32, v80, v48
    v_dot2_f32_bf16 v49, v32, v108, v49
    v_dot2_f32_bf16 v48, v33, v81, v48
    v_dot2_f32_bf16 v49, v33, v109, v49
    v_dot2_f32_bf16 v48, v34, v82, v48
    v_dot2_f32_bf16 v49, v34, v110, v49
    v_dot2_f32_bf16 v48, v35, v83, v48
    v_dot2_f32_bf16 v49, v35, v111, v49
    v_dot2_f32_bf16 v48, v36, v84, v48
    v_dot2_f32_bf16 v49, v36, v112, v49
    v_dot2_f32_bf16 v48, v37, v85, v48
    v_dot2_f32_bf16 v49, v37, v113, v49
    v_dot2_f32_bf16 v48, v38, v86, v48
    v_dot2_f32_bf16 v49, v38, v114, v49
    v_dot2_f32_bf16 v48, v39, v87, v48
    v_dot2_f32_bf16 v49, v39, v115, v49
    v_dot2_f32_bf16 v48, v40, v88, v48
    v_dot2_f32_bf16 v49, v40, v116, v49
    v_dot2_f32_bf16 v48, v41, v89, v48
    v_dot2_f32_bf16 v49, v41, v117, v49
    v_dot2_f32_bf16 v48, v42, v90, v48
    v_dot2_f32_bf16 v49, v42, v118, v49
    v_dot2_f32_bf16 v48, v43, v91, v48
    v_dot2_f32_bf16 v49, v43, v119, v49
    ds_read_b128 v[16:19], v7 offset:19968
    ds_read_b128 v[20:23], v7 offset:19984
    ds_read_b128 v[24:27], v7 offset:20000
    ds_read_b128 v[28:31], v7 offset:20016
    ds_read_b128 v[32:35], v7 offset:20032
    ds_read_b128 v[36:39], v7 offset:20048
    ds_read_b128 v[40:43], v7 offset:20064
    s_waitcnt lgkmcnt(0)
    v_dot2_f32_bf16 v50, v16, v64, v50
    v_dot2_f32_bf16 v51, v16, v92, v51
    v_dot2_f32_bf16 v50, v17, v65, v50
    v_dot2_f32_bf16 v51, v17, v93, v51
    v_dot2_f32_bf16 v50, v18, v66, v50
    v_dot2_f32_bf16 v51, v18, v94, v51
    v_dot2_f32_bf16 v50, v19, v67, v50
    v_dot2_f32_bf16 v51, v19, v95, v51
    v_dot2_f32_bf16 v50, v20, v68, v50
    v_dot2_f32_bf16 v51, v20, v96, v51
    v_dot2_f32_bf16 v50, v21, v69, v50
    v_dot2_f32_bf16 v51, v21, v97, v51
    v_dot2_f32_bf16 v50, v22, v70, v50
    v_dot2_f32_bf16 v51, v22, v98, v51
    v_dot2_f32_bf16 v50, v23, v71, v50
    v_dot2_f32_bf16 v51, v23, v99, v51
    v_dot2_f32_bf16 v50, v24, v72, v50
    v_dot2_f32_bf16 v51, v24, v100, v51
    v_dot2_f32_bf16 v50, v25, v73, v50
    v_dot2_f32_bf16 v51, v25, v101, v51
    v_dot2_f32_bf16 v50, v26, v74, v50
    v_dot2_f32_bf16 v51, v26, v102, v51
    v_dot2_f32_bf16 v50, v27, v75, v50
    v_dot2_f32_bf16 v51, v27, v103, v51
    v_dot2_f32_bf16 v50, v28, v76, v50
    v_dot2_f32_bf16 v51, v28, v104, v51
    v_dot2_f32_bf16 v50, v29, v77, v50
    v_dot2_f32_bf16 v51, v29, v105, v51
    v_dot2_f32_bf16 v50, v30, v78, v50
    v_dot2_f32_bf16 v51, v30, v106, v51
    v_dot2_f32_bf16 v50, v31, v79, v50
    v_dot2_f32_bf16 v51, v31, v107, v51
    v_dot2_f32_bf16 v50, v32, v80, v50
    v_dot2_f32_bf16 v51, v32, v108, v51
    v_dot2_f32_bf16 v50, v33, v81, v50
    v_dot2_f32_bf16 v51, v33, v109, v51
    v_dot2_f32_bf16 v50, v34, v82, v50
    v_dot2_f32_bf16 v51, v34, v110, v51
    v_dot2_f32_bf16 v50, v35, v83, v50
    v_dot2_f32_bf16 v51, v35, v111, v51
    v_dot2_f32_bf16 v50, v36, v84, v50
    v_dot2_f32_bf16 v51, v36, v112, v51
    v_dot2_f32_bf16 v50, v37, v85, v50
    v_dot2_f32_bf16 v51, v37, v113, v51
    v_dot2_f32_bf16 v50, v38, v86, v50
    v_dot2_f32_bf16 v51, v38, v114, v51
    v_dot2_f32_bf16 v50, v39, v87, v50
    v_dot2_f32_bf16 v51, v39, v115, v51
    v_dot2_f32_bf16 v50, v40, v88, v50
    v_dot2_f32_bf16 v51, v40, v116, v51
    v_dot2_f32_bf16 v50, v41, v89, v50
    v_dot2_f32_bf16 v51, v41, v117, v51
    v_dot2_f32_bf16 v50, v42, v90, v50
    v_dot2_f32_bf16 v51, v42, v118, v51
    v_dot2_f32_bf16 v50, v43, v91, v50
    v_dot2_f32_bf16 v51, v43, v119, v51
    s_nop 3
    v_add_f32_dpp v48, v48, v48 row_ror:8 row_mask:0xf bank_mask:0xf
    v_add_f32_dpp v49, v49, v49 row_ror:8 row_mask:0xf bank_mask:0xf
    v_add_f32_dpp v50, v50, v50 row_ror:8 row_mask:0xf bank_mask:0xf
    v_add_f32_dpp v51, v51, v51 row_ror:8 row_mask:0xf bank_mask:0xf
    v_mov_b32 v5, v48
    s_nop 1
    v_permlane16_swap_b32 v48, v5
    v_add_f32 v48, v48, v5
    v_mov_b32 v5, v49
    s_nop 1
    v_permlane16_swap_b32 v49, v5
    v_add_f32 v49, v49, v5
    v_mov_b32 v5, v50
    s_nop 1
    v_permlane16_swap_b32 v50, v5
    v_add_f32 v50, v50, v5
    v_mov_b32 v5, v51
    s_nop 1
    v_permlane16_swap_b32 v51, v5
    v_add_f32 v51, v51, v5
    v_mov_b32 v5, v48
    s_nop 1
    v_permlane32_swap_b32 v48, v5
    v_add_f32 v48, v48, v5
    v_mov_b32 v5, v49
    s_nop 1
    v_permlane32_swap_b32 v49, v5
    v_add_f32 v49, v49, v5
    v_mov_b32 v5, v50
    s_nop 1
    v_permlane32_swap_b32 v50, v5
    v_add_f32 v50, v50, v5
    v_mov_b32 v5, v51
    s_nop 1
    v_permlane32_swap_b32 v51, v5
    v_add_f32 v51, v51, v5
    v_lshrrev_b32 v7, 6, v0
    v_lshlrev_b32 v7, 7, v7
    v_lshl_add_u32 v7, v3, 4, v7
    ds_write_b128 v7, v[48:51] offset:1024
    s_waitcnt lgkmcnt(0)
    s_barrier
    v_lshlrev_b32 v7, 4, v3
    v_lshl_add_u32 v7, v9, 3, v7
    ds_read_b64 v[16:17], v7 offset:1024
    ds_read_b64 v[18:19], v7 offset:1152
    ds_read_b64 v[20:21], v7 offset:1280
    ds_read_b64 v[22:23], v7 offset:1408
    v_mul_f32 v10, 0xbfb8aa3b, v11
    v_exp_f32 v10, v10
    s_nop 0
    v_add_f32 v10, 1.0, v10
    v_rcp_f32 v10, v10
    s_nop 0
    v_cvt_pk_bf16_f32 v5, v10, v10
    v_lshlrev_b32 v10, 16, v5
    s_waitcnt lgkmcnt(0)
    v_lshlrev_b32 v24, 16, v15
    v_and_b32 v25, 0xffff0000, v15
    v_lshlrev_b32 v26, 16, v14
    v_and_b32 v27, 0xffff0000, v14
    v_add_f32 v16, v16, v18
    v_add_f32 v20, v20, v22
    v_add_f32 v16, v16, v20
    v_cvt_pk_bf16_f32 v5, v16, v16
    v_lshlrev_b32 v16, 16, v5
    v_mul_f32 v16, v16, v10
    v_cvt_pk_bf16_f32 v5, v16, v16
    v_lshlrev_b32 v16, 16, v5
    v_add_f32 v16, v16, v24
    v_cvt_pk_bf16_f32 v5, v16, v16
    v_lshlrev_b32 v16, 16, v5
    v_add_f32 v16, v16, v26
    v_add_f32 v17, v17, v19
    v_add_f32 v21, v21, v23
    v_add_f32 v17, v17, v21
    v_cvt_pk_bf16_f32 v5, v17, v17
    v_lshlrev_b32 v17, 16, v5
    v_mul_f32 v17, v17, v10
    v_cvt_pk_bf16_f32 v5, v17, v17
    v_lshlrev_b32 v17, 16, v5
    v_add_f32 v17, v17, v25
    v_cvt_pk_bf16_f32 v5, v17, v17
    v_lshlrev_b32 v17, 16, v5
    v_add_f32 v17, v17, v27
    v_cvt_pk_bf16_f32 v16, v16, v17
    buffer_store_dword v16, v12, s[60:63], 0 offen sc1
    v_add_f32 v24, v24, v26
    v_add_f32 v25, v25, v27
    v_cvt_pk_bf16_f32 v13, v24, v25
L_M_next:
    s_add_u32 s24, s24, 1
    s_mov_b32 s25, 192
    s_cmp_eq_u32 s24, 1
    s_cbranch_scc1 L_M_round
    s_cmp_eq_u32 s24, 3
    s_cbranch_scc1 L_end
    s_mov_b32 s25, 256
    v_and_b32 v7, 63, v0
    v_lshlrev_b32 v3, 4, v7
    s_mov_b32 s36, 0x19bc00
    v_sub_u32 v7, 63, v7
L_M_fin:
    buffer_load_dwordx4 v[16:19], v3, s[8:11], s36 offen sc1
    s_add_u32 s32, s32, 1
    s_cmp_gt_u32 s32, 200000
    s_cselect_b32 s37, -1, -2
    s_waitcnt vmcnt(0)
    v_max3_u32 v5, v16, v17, v18
    v_max_u32 v5, v5, v19
    v_cmp_lt_u32 vcc, s37, v5
    s_cbranch_vccnz L_M_fin
    v_add_f32 v16, v16, v17
    v_add_f32 v18, v18, v19
    v_add_f32 v16, v16, v18
    v_cvt_pk_bf16_f32 v5, v16, v16
    v_lshlrev_b32 v16, 16, v5
    v_ashrrev_i32 v5, 31, v16
    v_or_b32 v5, 0x80000000, v5
    v_xor_b32 v5, v5, v16
    v_and_or_b32 v5, v5, s42, v7
    v_cmp_lt_u32 vcc, s29, v5
    s_cbranch_vccnz L_M_round
L_end:
    s_endpgm
.section .rodata,"a"
.p2align 6
.amdhsa_kernel sequential_preLN__memory_aug_recurrent_mem_tr__moe_arch_mod__prompt_kernel
  .amdhsa_next_free_vgpr 512
  .amdhsa_next_free_sgpr 102
  .amdhsa_accum_offset 256
  .amdhsa_group_segment_fixed_size 0
  .amdhsa_kernarg_size 120
  .amdhsa_user_sgpr_count 2
  .amdhsa_user_sgpr_kernarg_segment_ptr 1
  .amdhsa_system_sgpr_workgroup_id_x 1
.end_amdhsa_kernel
```

```asm
; @launch grid=(256,1,1) block=(256,1,1) lds=163840
.amdgcn_target "amdgcn-amd-amdhsa--gfx950"
.text
.globl sequential_preLN__memory_aug_recurrent_mem_tr__moe_arch_mod__prompt_kernel
.p2align 8
.type sequential_preLN__memory_aug_recurrent_mem_tr__moe_arch_mod__prompt_kernel,@function
sequential_preLN__memory_aug_recurrent_mem_tr__moe_arch_mod__prompt_kernel:
    s_cmp_ge_u32 s2, 256
    s_cbranch_scc1 L_end
    s_load_dwordx8 s[44:51], s[0:1], 0
    s_load_dwordx4 s[52:55], s[0:1], 32
    s_load_dwordx4 s[56:59], s[0:1], 104
    s_load_dwordx2 s[80:81], s[0:1], 64
    s_load_dwordx2 s[82:83], s[0:1], 96
    s_load_dwordx4 s[84:87], s[0:1], 72
    s_load_dwordx2 s[88:89], s[0:1], 88
    v_lshrrev_b32 v1, 6, v0
    s_nop 0
    v_readfirstlane_b32 s21, v1
    s_waitcnt lgkmcnt(0)
    s_mov_b32 s8, s58
    s_and_b32 s9, s59, 0xffff
    s_mov_b32 s10, 0x10000000
    s_mov_b32 s11, 0x20000
    s_mov_b32 s16, s56
    s_and_b32 s17, s57, 0xffff
    s_mov_b32 s18, 0x100
    s_mov_b32 s19, 0x20000
    s_and_b32 s3, s2, 7
    s_cmp_lg_u32 s3, 0
    s_cbranch_scc1 L_worker
    s_lshr_b32 s20, s2, 3
    v_lshrrev_b32 v28, 4, v0
    v_and_b32 v16, 15, v0
    v_lshlrev_b32 v16, 4, v16
    v_lshl_add_u32 v16, v28, 13, v16
    v_bfe_u32 v29, v0, 4, 1
    v_lshlrev_b32 v29, 5, v29
    v_xor_b32 v16, v16, v29
    v_and_b32 v29, 192, v0
    v_xor_b32 v16, v16, v29
    s_lshl_b32 s28, s21, 10
    s_lshl_b32 s3, s20, 8
    s_mov_b32 s60, s52
    s_and_b32 s61, s53, 0xffff
    s_mov_b32 s62, 0x400000
    s_mov_b32 s63, 0x20000
    s_add_u32 m0, s28, 32768
    s_add_u32 s37, s3, 0x0
    buffer_load_dwordx4 v16, s[60:63], s37 offen lds
    s_add_u32 m0, s28, 36864
    s_add_u32 s37, s3, 0x20000
    buffer_load_dwordx4 v16, s[60:63], s37 offen lds
    s_add_u32 m0, s28, 65536
    s_add_u32 s37, s3, 0x40000
    buffer_load_dwordx4 v16, s[60:63], s37 offen lds
    s_add_u32 m0, s28, 69632
    s_add_u32 s37, s3, 0x60000
    buffer_load_dwordx4 v16, s[60:63], s37 offen lds
    s_add_u32 m0, s28, 98304
    s_add_u32 s37, s3, 0x80000
    buffer_load_dwordx4 v16, s[60:63], s37 offen lds
    s_add_u32 m0, s28, 102400
    s_add_u32 s37, s3, 0xa0000
    buffer_load_dwordx4 v16, s[60:63], s37 offen lds
    s_add_u32 m0, s28, 131072
    s_add_u32 s37, s3, 0xc0000
    buffer_load_dwordx4 v16, s[60:63], s37 offen lds
    s_add_u32 m0, s28, 135168
    s_add_u32 s37, s3, 0xe0000
    buffer_load_dwordx4 v16, s[60:63], s37 offen lds
    s_add_u32 m0, s28, 40960
    s_add_u32 s37, s3, 0x100000
    buffer_load_dwordx4 v16, s[60:63], s37 offen lds
    s_add_u32 m0, s28, 45056
    s_add_u32 s37, s3, 0x120000
    buffer_load_dwordx4 v16, s[60:63], s37 offen lds
    s_add_u32 m0, s28, 73728
    s_add_u32 s37, s3, 0x140000
    buffer_load_dwordx4 v16, s[60:63], s37 offen lds
    s_add_u32 m0, s28, 77824
    s_add_u32 s37, s3, 0x160000
    buffer_load_dwordx4 v16, s[60:63], s37 offen lds
    s_add_u32 m0, s28, 106496
    s_add_u32 s37, s3, 0x180000
    buffer_load_dwordx4 v16, s[60:63], s37 offen lds
    s_add_u32 m0, s28, 110592
    s_add_u32 s37, s3, 0x1a0000
    buffer_load_dwordx4 v16, s[60:63], s37 offen lds
    s_add_u32 m0, s28, 139264
    s_add_u32 s37, s3, 0x1c0000
    buffer_load_dwordx4 v16, s[60:63], s37 offen lds
    s_add_u32 m0, s28, 143360
    s_add_u32 s37, s3, 0x1e0000
    buffer_load_dwordx4 v16, s[60:63], s37 offen lds
    s_add_u32 m0, s28, 49152
    s_add_u32 s37, s3, 0x200000
    buffer_load_dwordx4 v16, s[60:63], s37 offen lds
    s_add_u32 m0, s28, 53248
    s_add_u32 s37, s3, 0x220000
    buffer_load_dwordx4 v16, s[60:63], s37 offen lds
    s_add_u32 m0, s28, 81920
    s_add_u32 s37, s3, 0x240000
    buffer_load_dwordx4 v16, s[60:63], s37 offen lds
    s_add_u32 m0, s28, 86016
    s_add_u32 s37, s3, 0x260000
    buffer_load_dwordx4 v16, s[60:63], s37 offen lds
    s_add_u32 m0, s28, 114688
    s_add_u32 s37, s3, 0x280000
    buffer_load_dwordx4 v16, s[60:63], s37 offen lds
    s_add_u32 m0, s28, 118784
    s_add_u32 s37, s3, 0x2a0000
    buffer_load_dwordx4 v16, s[60:63], s37 offen lds
    s_add_u32 m0, s28, 147456
    s_add_u32 s37, s3, 0x2c0000
    buffer_load_dwordx4 v16, s[60:63], s37 offen lds
    s_add_u32 m0, s28, 151552
    s_add_u32 s37, s3, 0x2e0000
    buffer_load_dwordx4 v16, s[60:63], s37 offen lds
    v_mov_b32 v20, 0x0
    v_bfe_u32 v14, v0, 0, 1
    s_mov_b32 s38, 0x8
    v_mad_u32_u24 v20, v14, s38, v20
    v_bfe_u32 v14, v0, 1, 1
    s_mov_b32 s38, 0x10
    v_mad_u32_u24 v20, v14, s38, v20
    v_bfe_u32 v14, v0, 2, 1
    s_mov_b32 s38, 0x100
    v_mad_u32_u24 v20, v14, s38, v20
    v_bfe_u32 v14, v0, 3, 1
    s_mov_b32 s38, 0x800
    v_mad_u32_u24 v20, v14, s38, v20
    v_bfe_u32 v14, v0, 4, 1
    s_mov_b32 s38, 0x400
    v_mad_u32_u24 v20, v14, s38, v20
    v_bfe_u32 v14, v0, 5, 1
    s_mov_b32 s38, 0x1000
    v_mad_u32_u24 v20, v14, s38, v20
    v_mov_b32 v30, 0x0
    v_bfe_u32 v14, v0, 2, 1
    s_mov_b32 s38, 0x20
    v_mad_u32_u24 v30, v14, s38, v30
    v_bfe_u32 v14, v0, 3, 1
    s_mov_b32 s38, 0x80
    v_mad_u32_u24 v30, v14, s38, v30
    v_bfe_u32 v14, v0, 4, 1
    s_mov_b32 s38, 0x40
    v_mad_u32_u24 v30, v14, s38, v30
    v_mov_b32 v31, 0x0
    v_bfe_u32 v14, v0, 6, 1
    s_mov_b32 s38, 0x40
    v_mad_u32_u24 v31, v14, s38, v31
    v_bfe_u32 v14, v0, 7, 1
    s_mov_b32 s38, 0x80
    v_mad_u32_u24 v31, v14, s38, v31
    v_xor_b32 v30, v30, v31
    v_add_u32 v30, v30, v20
    s_xor_b32 s36, s21, 0
    s_add_u32 s36, s36, 1
    s_lshl_b32 s36, s36, 15
    v_add_u32 v20, s36, v30
    v_xor_b32 v21, 32, v20
    s_xor_b32 s36, s21, 1
    s_add_u32 s36, s36, 1
    s_lshl_b32 s36, s36, 15
    v_add_u32 v22, s36, v30
    v_xor_b32 v23, 32, v22
    s_xor_b32 s36, s21, 2
    s_add_u32 s36, s36, 1
    s_lshl_b32 s36, s36, 15
    v_add_u32 v24, s36, v30
    v_xor_b32 v25, 32, v24
    s_xor_b32 s36, s21, 3
    s_add_u32 s36, s36, 1
    s_lshl_b32 s36, s36, 15
    v_add_u32 v26, s36, v30
    v_xor_b32 v27, 32, v26
    v_mov_b32 v11, 0x0
    v_bfe_u32 v14, v0, 0, 1
    s_mov_b32 s38, 0x4
    v_mad_u32_u24 v11, v14, s38, v11
    v_bfe_u32 v14, v0, 1, 1
    s_mov_b32 s38, 0x8
    v_mad_u32_u24 v11, v14, s38, v11
    v_bfe_u32 v14, v0, 2, 1
    s_mov_b32 s38, 0x10
    v_mad_u32_u24 v11, v14, s38, v11
    v_bfe_u32 v14, v0, 3, 1
    s_mov_b32 s38, 0x20
    v_mad_u32_u24 v11, v14, s38, v11
    v_bfe_u32 v14, v0, 4, 1
    s_mov_b32 s38, 0x800
    v_mad_u32_u24 v11, v14, s38, v11
    v_bfe_u32 v14, v0, 5, 1
    s_mov_b32 s38, 0x1000
    v_mad_u32_u24 v11, v14, s38, v11
    v_bfe_u32 v14, v0, 6, 1
    s_mov_b32 s38, 0x100
    v_mad_u32_u24 v11, v14, s38, v11
    v_bfe_u32 v14, v0, 7, 1
    s_mov_b32 s38, 0x200
    v_mad_u32_u24 v11, v14, s38, v11
    s_mov_b32 s92, s54
    s_and_b32 s93, s55, 0xffff
    s_mov_b32 s94, 0x400000
    s_mov_b32 s95, 0x20000
    s_lshl_b32 s29, s20, 17
    s_xor_b32 s36, s21, 3
    s_lshl_b32 s36, s36, 15
    s_add_u32 s36, s36, s29
    s_add_u32 s37, s36, 0x80
    buffer_load_dword v32, v11, s[92:95], s37 offen
    s_add_u32 s37, s36, 0x4080
    buffer_load_dword v33, v11, s[92:95], s37 offen
    s_add_u32 s37, s36, 0x480
    buffer_load_dword v34, v11, s[92:95], s37 offen
    s_add_u32 s37, s36, 0x4480
    buffer_load_dword v35, v11, s[92:95], s37 offen
    s_add_u32 s37, s36, 0x2080
    buffer_load_dword v36, v11, s[92:95], s37 offen
    s_add_u32 s37, s36, 0x6080
    buffer_load_dword v37, v11, s[92:95], s37 offen
    s_add_u32 s37, s36, 0x2480
    buffer_load_dword v38, v11, s[92:95], s37 offen
    s_add_u32 s37, s36, 0x6480
    buffer_load_dword v39, v11, s[92:95], s37 offen
    s_add_u32 s37, s36, 0xc0
    buffer_load_dword v40, v11, s[92:95], s37 offen
    s_add_u32 s37, s36, 0x40c0
    buffer_load_dword v41, v11, s[92:95], s37 offen
    s_add_u32 s37, s36, 0x4c0
    buffer_load_dword v42, v11, s[92:95], s37 offen
    s_add_u32 s37, s36, 0x44c0
    buffer_load_dword v43, v11, s[92:95], s37 offen
    s_add_u32 s37, s36, 0x20c0
    buffer_load_dword v44, v11, s[92:95], s37 offen
    s_add_u32 s37, s36, 0x60c0
    buffer_load_dword v45, v11, s[92:95], s37 offen
    s_add_u32 s37, s36, 0x24c0
    buffer_load_dword v46, v11, s[92:95], s37 offen
    s_add_u32 s37, s36, 0x64c0
    buffer_load_dword v47, v11, s[92:95], s37 offen
    s_getreg_b32 s36, hwreg(HW_REG_XCC_ID)
    s_and_b32 s36, s36, 15
    s_or_b32 s36, s36, 0x100
    v_mov_b32 v30, s36
    s_lshl_b32 s37, s20, 2
    v_lshlrev_b32 v31, 20, v0
    buffer_store_dword v30, v31, s[16:19], s37 offen offset:128 sc1
    s_mov_b32 s12, s46
    s_and_b32 s13, s47, 0xffff
    s_mov_b32 s14, 0x2000
    s_mov_b32 s15, 0x20000
    v_mov_b32 v104, 0x0
    v_bfe_u32 v14, v0, 0, 1
    s_mov_b32 s38, 0x8
    v_mad_u32_u24 v104, v14, s38, v104
    v_bfe_u32 v14, v0, 1, 1
    s_mov_b32 s38, 0x10
    v_mad_u32_u24 v104, v14, s38, v104
    v_bfe_u32 v14, v0, 2, 1
    s_mov_b32 s38, 0x10000
    v_mad_u32_u24 v104, v14, s38, v104
    v_bfe_u32 v14, v0, 3, 1
    s_mov_b32 s38, 0x10000
    v_mad_u32_u24 v104, v14, s38, v104
    v_bfe_u32 v14, v0, 4, 1
    s_mov_b32 s38, 0x400
    v_mad_u32_u24 v104, v14, s38, v104
    v_bfe_u32 v14, v0, 5, 1
    s_mov_b32 s38, 0x4
    v_mad_u32_u24 v104, v14, s38, v104
    v_bfe_u32 v14, v0, 6, 1
    s_mov_b32 s38, 0x40
    v_mad_u32_u24 v104, v14, s38, v104
    v_bfe_u32 v14, v0, 7, 1
    s_mov_b32 s38, 0x80
    v_mad_u32_u24 v104, v14, s38, v104
    v_mov_b32 v106, s20
    v_mov_b32 v105, 0x0
    v_bfe_u32 v14, v106, 0, 1
    s_mov_b32 s38, 0x20
    v_mad_u32_u24 v105, v14, s38, v105
    v_bfe_u32 v14, v106, 1, 1
    s_mov_b32 s38, 0x800
    v_mad_u32_u24 v105, v14, s38, v105
    v_bfe_u32 v14, v106, 2, 1
    s_mov_b32 s38, 0x1000
    v_mad_u32_u24 v105, v14, s38, v105
    v_bfe_u32 v14, v106, 3, 1
    s_mov_b32 s38, 0x100
    v_mad_u32_u24 v105, v14, s38, v105
    v_bfe_u32 v14, v106, 4, 1
    s_mov_b32 s38, 0x200
    v_mad_u32_u24 v105, v14, s38, v105
    v_add_u32 v104, v104, v105
    buffer_load_dword v12, v104, s[12:15], 0 offen
    v_mov_b32 v1, 0x4444
    v_bfe_u32 v14, v0, 1, 1
    s_mov_b32 s38, 0xaaaa
    v_mad_u32_u24 v1, v14, s38, v1
    v_mov_b32 v3, 0x0
    v_bfe_u32 v14, v0, 0, 1
    s_mov_b32 s38, 0x10
    v_mad_u32_u24 v3, v14, s38, v3
    v_bfe_u32 v14, v0, 1, 1
    s_mov_b32 s38, 0x20
    v_mad_u32_u24 v3, v14, s38, v3
    v_bfe_u32 v14, v0, 2, 1
    s_mov_b32 s38, 0x40
    v_mad_u32_u24 v3, v14, s38, v3
    v_bfe_u32 v14, v0, 3, 1
    s_mov_b32 s38, 0x80
    v_mad_u32_u24 v3, v14, s38, v3
    v_bfe_u32 v14, v0, 4, 1
    s_mov_b32 s38, 0x100
    v_mad_u32_u24 v3, v14, s38, v3
    v_bfe_u32 v14, v0, 5, 1
    s_mov_b32 s38, 0x200
    v_mad_u32_u24 v3, v14, s38, v3
    v_mov_b32 v2, 0x0
    v_bfe_u32 v14, v0, 0, 1
    s_mov_b32 s38, 0x10
    v_mad_u32_u24 v2, v14, s38, v2
    v_bfe_u32 v14, v0, 1, 1
    s_mov_b32 s38, 0x20
    v_mad_u32_u24 v2, v14, s38, v2
    v_bfe_u32 v14, v0, 2, 1
    s_mov_b32 s38, 0x40
    v_mad_u32_u24 v2, v14, s38, v2
    v_bfe_u32 v14, v0, 3, 1
    s_mov_b32 s38, 0x80
    v_mad_u32_u24 v2, v14, s38, v2
    v_bfe_u32 v14, v0, 4, 1
    s_mov_b32 s38, 0x100
    v_mad_u32_u24 v2, v14, s38, v2
    v_bfe_u32 v14, v0, 5, 1
    s_mov_b32 s38, 0x200
    v_mad_u32_u24 v2, v14, s38, v2
    v_bfe_u32 v14, v0, 6, 1
    s_mov_b32 s38, 0x800
    v_mad_u32_u24 v2, v14, s38, v2
    v_bfe_u32 v14, v0, 7, 1
    s_mov_b32 s38, 0x1000
    v_mad_u32_u24 v2, v14, s38, v2
    v_mov_b32 v4, 0x8000
    v_bfe_u32 v14, v0, 0, 1
    s_mov_b32 s38, 0x10
    v_mad_u32_u24 v4, v14, s38, v4
    v_bfe_u32 v14, v0, 1, 1
    s_mov_b32 s38, 0x20
    v_mad_u32_u24 v4, v14, s38, v4
    v_bfe_u32 v14, v0, 2, 1
    s_mov_b32 s38, 0x40
    v_mad_u32_u24 v4, v14, s38, v4
    v_bfe_u32 v14, v0, 3, 1
    s_mov_b32 s38, 0x80
    v_mad_u32_u24 v4, v14, s38, v4
    v_bfe_u32 v14, v0, 4, 1
    s_mov_b32 s38, 0x100
    v_mad_u32_u24 v4, v14, s38, v4
    v_bfe_u32 v14, v0, 5, 1
    s_mov_b32 s38, 0x200
    v_mad_u32_u24 v4, v14, s38, v4
    v_bfe_u32 v14, v0, 6, 1
    s_mov_b32 s38, 0x8000
    v_mad_u32_u24 v4, v14, s38, v4
    v_bfe_u32 v14, v0, 7, 1
    s_mov_b32 s38, 0x10000
    v_mad_u32_u24 v4, v14, s38, v4
    v_mov_b32 v5, 0x4000
    v_bfe_u32 v14, v0, 0, 1
    s_mov_b32 s38, 0x4
    v_mad_u32_u24 v5, v14, s38, v5
    v_bfe_u32 v14, v0, 1, 1
    s_mov_b32 s38, 0x8
    v_mad_u32_u24 v5, v14, s38, v5
    v_bfe_u32 v14, v0, 2, 1
    s_mov_b32 s38, 0x10
    v_mad_u32_u24 v5, v14, s38, v5
    v_bfe_u32 v14, v0, 3, 1
    s_mov_b32 s38, 0x20
    v_mad_u32_u24 v5, v14, s38, v5
    v_bfe_u32 v14, v0, 4, 1
    s_mov_b32 s38, 0x240
    v_mad_u32_u24 v5, v14, s38, v5
    v_bfe_u32 v14, v0, 5, 1
    s_mov_b32 s38, 0x480
    v_mad_u32_u24 v5, v14, s38, v5
    v_bfe_u32 v14, v0, 6, 1
    s_mov_b32 s38, 0x40
    v_mad_u32_u24 v5, v14, s38, v5
    v_bfe_u32 v14, v0, 7, 1
    s_mov_b32 s38, 0x80
    v_mad_u32_u24 v5, v14, s38, v5
    v_mov_b32 v6, 0x4000
    v_bfe_u32 v14, v0, 0, 1
    s_mov_b32 s38, 0x120
    v_mad_u32_u24 v6, v14, s38, v6
    v_bfe_u32 v14, v0, 2, 1
    s_mov_b32 s38, 0x240
    v_mad_u32_u24 v6, v14, s38, v6
    v_bfe_u32 v14, v0, 3, 1
    s_mov_b32 s38, 0x480
    v_mad_u32_u24 v6, v14, s38, v6
    v_bfe_u32 v14, v0, 4, 1
    s_mov_b32 s38, 0x10
    v_mad_u32_u24 v6, v14, s38, v6
    v_bfe_u32 v14, v0, 5, 1
    s_mov_b32 s38, 0x20
    v_mad_u32_u24 v6, v14, s38, v6
    v_add_u32 v7, 2304, v5
    v_xor_b32 v8, 0x1000, v2
    v_mov_b32 v104, 0x0
    v_bfe_u32 v14, v0, 3, 1
    s_mov_b32 s38, 0x1
    v_mad_u32_u24 v104, v14, s38, v104
    v_bfe_u32 v14, v0, 4, 1
    s_mov_b32 s38, 0x2
    v_mad_u32_u24 v104, v14, s38, v104
    v_bfe_u32 v14, v0, 5, 1
    s_mov_b32 s38, 0x4
    v_mad_u32_u24 v104, v14, s38, v104
    v_bfe_u32 v14, v0, 6, 1
    s_mov_b32 s38, 0x8
    v_mad_u32_u24 v104, v14, s38, v104
    v_bfe_u32 v14, v0, 7, 1
    s_mov_b32 s38, 0x10
    v_mad_u32_u24 v104, v14, s38, v104
    v_add_u32 v104, s20, v104
    v_and_b32 v104, 31, v104
    v_lshlrev_b32 v104, 6, v104
    v_mov_b32 v9, 0x0
    v_bfe_u32 v14, v0, 0, 1
    s_mov_b32 s38, 0x8
    v_mad_u32_u24 v9, v14, s38, v9
    v_bfe_u32 v14, v0, 1, 1
    s_mov_b32 s38, 0x10
    v_mad_u32_u24 v9, v14, s38, v9
    v_bfe_u32 v14, v0, 2, 1
    s_mov_b32 s38, 0x20
    v_mad_u32_u24 v9, v14, s38, v9
    v_bfe_u32 v14, v0, 3, 1
    s_mov_b32 s38, 0x2000
    v_mad_u32_u24 v9, v14, s38, v9
    v_bfe_u32 v14, v0, 4, 1
    s_mov_b32 s38, 0x4000
    v_mad_u32_u24 v9, v14, s38, v9
    v_bfe_u32 v14, v0, 5, 1
    s_mov_b32 s38, 0x8000
    v_mad_u32_u24 v9, v14, s38, v9
    v_bfe_u32 v14, v0, 6, 1
    s_mov_b32 s38, 0x10000
    v_mad_u32_u24 v9, v14, s38, v9
    v_bfe_u32 v14, v0, 7, 1
    s_mov_b32 s38, 0x20000
    v_mad_u32_u24 v9, v14, s38, v9
    v_add_u32 v9, v9, v104
    v_mov_b32 v10, 0x80000
    v_bfe_u32 v14, v0, 0, 1
    s_mov_b32 s38, 0x8
    v_mad_u32_u24 v10, v14, s38, v10
    v_bfe_u32 v14, v0, 1, 1
    s_mov_b32 s38, 0x20
    v_mad_u32_u24 v10, v14, s38, v10
    v_bfe_u32 v14, v0, 4, 1
    s_mov_b32 s38, 0x10
    v_mad_u32_u24 v10, v14, s38, v10
    v_bfe_u32 v14, v0, 5, 1
    s_mov_b32 s38, 0x4
    v_mad_u32_u24 v10, v14, s38, v10
    v_bfe_u32 v14, v0, 6, 1
    s_mov_b32 s38, 0x800
    v_mad_u32_u24 v10, v14, s38, v10
    v_bfe_u32 v14, v0, 7, 1
    s_mov_b32 s38, 0x1000
    v_mad_u32_u24 v10, v14, s38, v10
    v_mov_b32 v105, s20
    v_mov_b32 v104, 0x0
    v_bfe_u32 v14, v105, 0, 1
    s_mov_b32 s38, 0x100
    v_mad_u32_u24 v104, v14, s38, v104
    v_bfe_u32 v14, v105, 1, 1
    s_mov_b32 s38, 0x40
    v_mad_u32_u24 v104, v14, s38, v104
    v_bfe_u32 v14, v105, 2, 1
    s_mov_b32 s38, 0x80
    v_mad_u32_u24 v104, v14, s38, v104
    v_bfe_u32 v14, v105, 3, 1
    s_mov_b32 s38, 0x200
    v_mad_u32_u24 v104, v14, s38, v104
    v_bfe_u32 v14, v105, 4, 1
    s_mov_b32 s38, 0x400
    v_mad_u32_u24 v104, v14, s38, v104
    v_add_u32 v10, v104, v10
    v_and_b32 v104, 12, v0
    v_cmp_ne_u32 vcc, 0, v104
    v_mov_b32 v104, 0x40000000
    s_nop 0
    v_cndmask_b32 v10, v10, v104, vcc
    v_mov_b32 v13, 0x0
    v_bfe_u32 v14, v0, 0, 1
    s_mov_b32 s38, 0x10
    v_mad_u32_u24 v13, v14, s38, v13
    v_bfe_u32 v14, v0, 1, 1
    s_mov_b32 s38, 0x8
    v_mad_u32_u24 v13, v14, s38, v13
    v_bfe_u32 v14, v0, 2, 1
    s_mov_b32 s38, 0x20
    v_mad_u32_u24 v13, v14, s38, v13
    v_bfe_u32 v14, v0, 3, 1
    s_mov_b32 s38, 0x40
    v_mad_u32_u24 v13, v14, s38, v13
    v_bfe_u32 v14, v0, 4, 1
    s_mov_b32 s38, 0x80
    v_mad_u32_u24 v13, v14, s38, v13
    v_bfe_u32 v14, v0, 5, 1
    s_mov_b32 s38, 0x100
    v_mad_u32_u24 v13, v14, s38, v13
    v_bfe_u32 v14, v0, 6, 1
    s_mov_b32 s38, 0x800
    v_mad_u32_u24 v13, v14, s38, v13
    v_bfe_u32 v14, v0, 7, 1
    s_mov_b32 s38, 0x1000
    v_mad_u32_u24 v13, v14, s38, v13
    s_lshl_b32 s6, s20, 13
    s_add_u32 s6, s6, 0x0
    s_mov_b32 s26, 4096
    v_and_b32 v104, 15, v0
    v_mov_b32 v100, 0
    v_mov_b32 v105, 0x3f80
    v_cmp_eq_u32 vcc, 0, v104
    s_nop 1
    v_cndmask_b32 v100, v100, v105, vcc
    v_mov_b32 v105, 0x3f800000
    v_cmp_eq_u32 vcc, 1, v104
    s_nop 1
    v_cndmask_b32 v100, v100, v105, vcc
    v_mov_b32 v101, 0
    v_mov_b32 v105, 0x3f80
    v_cmp_eq_u32 vcc, 4, v104
    s_nop 1
    v_cndmask_b32 v101, v101, v105, vcc
    v_mov_b32 v105, 0x3f800000
    v_cmp_eq_u32 vcc, 5, v104
    s_nop 1
    v_cndmask_b32 v101, v101, v105, vcc
    v_mov_b32 v102, 0
    v_mov_b32 v105, 0x3f80
    v_cmp_eq_u32 vcc, 8, v104
    s_nop 1
    v_cndmask_b32 v102, v102, v105, vcc
    v_mov_b32 v105, 0x3f800000
    v_cmp_eq_u32 vcc, 9, v104
    s_nop 1
    v_cndmask_b32 v102, v102, v105, vcc
    v_mov_b32 v103, 0
    v_mov_b32 v105, 0x3f80
    v_cmp_eq_u32 vcc, 12, v104
    s_nop 1
    v_cndmask_b32 v103, v103, v105, vcc
    v_mov_b32 v105, 0x3f800000
    v_cmp_eq_u32 vcc, 13, v104
    s_nop 1
    v_cndmask_b32 v103, v103, v105, vcc
    ds_write_b128 v3, v[100:103] offset:23040
    s_mov_b32 s34, 0x05040100
    s_mov_b32 s35, 0x07060302
    s_mov_b32 s33, 0x3e0293ee
    s_mov_b32 s40, 0x4e800000
    s_mov_b32 s32, 0
    s_mov_b32 s4, 0x3f803f80
    s_mov_b32 s5, 0x3f803f80
    s_lshl_b32 s36, s20, 14
    s_lshr_b32 s37, s21, 1
    s_lshl_b32 s37, s37, 12
    s_add_u32 s25, s36, s37
    s_lshl_b32 s37, s21, 11
    s_add_u32 s39, s36, s37
    s_add_u32 s39, s39, 8192
    v_mov_b32 v104, 0x0
    v_bfe_u32 v14, v0, 0, 1
    s_mov_b32 s38, 0x80
    v_mad_u32_u24 v104, v14, s38, v104
    v_bfe_u32 v14, v0, 1, 1
    s_mov_b32 s38, 0x100
    v_mad_u32_u24 v104, v14, s38, v104
    v_bfe_u32 v14, v0, 2, 1
    s_mov_b32 s38, 0x200
    v_mad_u32_u24 v104, v14, s38, v104
    v_bfe_u32 v14, v0, 3, 1
    s_mov_b32 s38, 0x400
    v_mad_u32_u24 v104, v14, s38, v104
    v_bfe_u32 v14, v0, 4, 1
    s_mov_b32 s38, 0x800
    v_mad_u32_u24 v104, v14, s38, v104
    v_bfe_u32 v14, v0, 6, 1
    s_mov_b32 s38, 0x1000
    v_mad_u32_u24 v104, v14, s38, v104
    v_bfe_u32 v14, v0, 7, 1
    s_mov_b32 s38, 0x2000
    v_mad_u32_u24 v104, v14, s38, v104
    s_lshl_b32 s36, s20, 14
    v_add_u32 v104, s36, v104
    s_lshl_b32 s36, s20, 8
    s_lshr_b32 s37, s21, 1
    s_lshl_b32 s37, s37, 7
    s_add_u32 s36, s36, s37
    s_add_u32 s36, s36, 0x102100
    v_and_b32 v14, 63, v0
    v_mov_b32 v105, 0x40000000
    v_cmp_lt_u32 vcc, 32, v14
    s_nop 1
    v_cndmask_b32 v104, v104, v105, vcc
    v_mov_b32 v105, s36
    v_cmp_eq_u32 vcc, 32, v14
    s_nop 1
    v_cndmask_b32 v104, v104, v105, vcc
    s_lshl_b32 s36, s20, 2
    s_add_u32 s36, s36, 0x104100
    v_mov_b32 v105, s36
    v_cmp_eq_u32 vcc, 33, v14
    s_nop 1
    v_cndmask_b32 v0, v104, v105, vcc
    s_waitcnt vmcnt(34)
    s_barrier
    ds_read_b64_tr_b16 a[160:161], v20 offset:0
    ds_read_b64_tr_b16 a[162:163], v20 offset:512
    ds_read_b64_tr_b16 a[168:169], v21 offset:0
    ds_read_b64_tr_b16 a[170:171], v21 offset:512
    ds_read_b64_tr_b16 a[192:193], v22 offset:0
    ds_read_b64_tr_b16 a[194:195], v22 offset:512
    ds_read_b64_tr_b16 a[200:201], v23 offset:0
    ds_read_b64_tr_b16 a[202:203], v23 offset:512
    ds_read_b64_tr_b16 a[224:225], v24 offset:0
    ds_read_b64_tr_b16 a[226:227], v24 offset:512
    ds_read_b64_tr_b16 a[232:233], v25 offset:0
    ds_read_b64_tr_b16 a[234:235], v25 offset:512
    s_waitcnt lgkmcnt(4)
    ds_read_b64_tr_b16 v[128:129], v26 offset:0
    ds_read_b64_tr_b16 v[130:131], v26 offset:512
    ds_read_b64_tr_b16 v[136:137], v27 offset:0
    ds_read_b64_tr_b16 v[138:139], v27 offset:512
    s_waitcnt lgkmcnt(0)
    s_barrier
    s_add_u32 m0, s28, 32768
    s_add_u32 s37, s3, 0x300000
    buffer_load_dwordx4 v16, s[60:63], s37 offen lds
    s_add_u32 m0, s28, 36864
    s_add_u32 s37, s3, 0x320000
    buffer_load_dwordx4 v16, s[60:63], s37 offen lds
    s_add_u32 m0, s28, 65536
    s_add_u32 s37, s3, 0x340000
    buffer_load_dwordx4 v16, s[60:63], s37 offen lds
    s_add_u32 m0, s28, 69632
    s_add_u32 s37, s3, 0x360000
    buffer_load_dwordx4 v16, s[60:63], s37 offen lds
    s_add_u32 m0, s28, 98304
    s_add_u32 s37, s3, 0x380000
    buffer_load_dwordx4 v16, s[60:63], s37 offen lds
    s_add_u32 m0, s28, 102400
    s_add_u32 s37, s3, 0x3a0000
    buffer_load_dwordx4 v16, s[60:63], s37 offen lds
    s_add_u32 m0, s28, 131072
    s_add_u32 s37, s3, 0x3c0000
    buffer_load_dwordx4 v16, s[60:63], s37 offen lds
    s_add_u32 m0, s28, 135168
    s_add_u32 s37, s3, 0x3e0000
    buffer_load_dwordx4 v16, s[60:63], s37 offen lds
    s_xor_b32 s36, s21, 2
    s_lshl_b32 s36, s36, 15
    s_add_u32 s36, s36, s29
    s_add_u32 s37, s36, 0x80
    buffer_load_dword v48, v11, s[92:95], s37 offen
    s_add_u32 s37, s36, 0x4080
    buffer_load_dword v49, v11, s[92:95], s37 offen
    s_add_u32 s37, s36, 0x480
    buffer_load_dword v50, v11, s[92:95], s37 offen
    s_add_u32 s37, s36, 0x4480
    buffer_load_dword v51, v11, s[92:95], s37 offen
    s_add_u32 s37, s36, 0x2080
    buffer_load_dword v52, v11, s[92:95], s37 offen
    s_add_u32 s37, s36, 0x6080
    buffer_load_dword v53, v11, s[92:95], s37 offen
    s_add_u32 s37, s36, 0x2480
    buffer_load_dword v54, v11, s[92:95], s37 offen
    s_add_u32 s37, s36, 0x6480
    buffer_load_dword v55, v11, s[92:95], s37 offen
    s_add_u32 s37, s36, 0xc0
    buffer_load_dword v56, v11, s[92:95], s37 offen
    s_add_u32 s37, s36, 0x40c0
    buffer_load_dword v57, v11, s[92:95], s37 offen
    s_add_u32 s37, s36, 0x4c0
    buffer_load_dword v58, v11, s[92:95], s37 offen
    s_add_u32 s37, s36, 0x44c0
    buffer_load_dword v59, v11, s[92:95], s37 offen
    s_add_u32 s37, s36, 0x20c0
    buffer_load_dword v60, v11, s[92:95], s37 offen
    s_add_u32 s37, s36, 0x60c0
    buffer_load_dword v61, v11, s[92:95], s37 offen
    s_add_u32 s37, s36, 0x24c0
    buffer_load_dword v62, v11, s[92:95], s37 offen
    s_add_u32 s37, s36, 0x64c0
    buffer_load_dword v63, v11, s[92:95], s37 offen
    s_waitcnt vmcnt(50)
    s_barrier
    ds_read_b64_tr_b16 a[164:165], v20 offset:8192
    ds_read_b64_tr_b16 a[166:167], v20 offset:8704
    ds_read_b64_tr_b16 a[172:173], v21 offset:8192
    ds_read_b64_tr_b16 a[174:175], v21 offset:8704
    ds_read_b64_tr_b16 a[196:197], v22 offset:8192
    ds_read_b64_tr_b16 a[198:199], v22 offset:8704
    ds_read_b64_tr_b16 a[204:205], v23 offset:8192
    ds_read_b64_tr_b16 a[206:207], v23 offset:8704
    ds_read_b64_tr_b16 a[228:229], v24 offset:8192
    ds_read_b64_tr_b16 a[230:231], v24 offset:8704
    ds_read_b64_tr_b16 a[236:237], v25 offset:8192
    ds_read_b64_tr_b16 a[238:239], v25 offset:8704
    s_waitcnt lgkmcnt(4)
    ds_read_b64_tr_b16 v[132:133], v26 offset:8192
    ds_read_b64_tr_b16 v[134:135], v26 offset:8704
    ds_read_b64_tr_b16 v[140:141], v27 offset:8192
    ds_read_b64_tr_b16 v[142:143], v27 offset:8704
    s_waitcnt lgkmcnt(0)
    s_barrier
    s_mov_b32 s88, s50
    s_and_b32 s89, s51, 0xffff
    s_mov_b32 s90, 0x400000
    s_mov_b32 s91, 0x20000
    s_add_u32 m0, s28, 40960
    s_add_u32 s37, s3, 0x0
    buffer_load_dwordx4 v16, s[88:91], s37 offen lds
    s_add_u32 m0, s28, 45056
    s_add_u32 s37, s3, 0x20000
    buffer_load_dwordx4 v16, s[88:91], s37 offen lds
    s_add_u32 m0, s28, 73728
    s_add_u32 s37, s3, 0x40000
    buffer_load_dwordx4 v16, s[88:91], s37 offen lds
    s_add_u32 m0, s28, 77824
    s_add_u32 s37, s3, 0x60000
    buffer_load_dwordx4 v16, s[88:91], s37 offen lds
    s_add_u32 m0, s28, 106496
    s_add_u32 s37, s3, 0x80000
    buffer_load_dwordx4 v16, s[88:91], s37 offen lds
    s_add_u32 m0, s28, 110592
    s_add_u32 s37, s3, 0xa0000
    buffer_load_dwordx4 v16, s[88:91], s37 offen lds
    s_add_u32 m0, s28, 139264
    s_add_u32 s37, s3, 0xc0000
    buffer_load_dwordx4 v16, s[88:91], s37 offen lds
    s_add_u32 m0, s28, 143360
    s_add_u32 s37, s3, 0xe0000
    buffer_load_dwordx4 v16, s[88:91], s37 offen lds
    s_waitcnt vmcnt(34)
    v_perm_b32 v120, v33, v32, s34
    v_perm_b32 v121, v33, v32, s35
    v_perm_b32 v122, v35, v34, s34
    v_perm_b32 v123, v35, v34, s35
    v_perm_b32 v124, v37, v36, s34
    v_perm_b32 v125, v37, v36, s35
    v_perm_b32 v126, v39, v38, s34
    v_perm_b32 v127, v39, v38, s35
    ds_write_b128 v4, v[120:123] offset:24576
    ds_write_b128 v4, v[124:127] offset:25600
    s_waitcnt lgkmcnt(0)
    v_perm_b32 v120, v41, v40, s34
    v_perm_b32 v121, v41, v40, s35
    v_perm_b32 v122, v43, v42, s34
    v_perm_b32 v123, v43, v42, s35
    v_perm_b32 v124, v45, v44, s34
    v_perm_b32 v125, v45, v44, s35
    v_perm_b32 v126, v47, v46, s34
    v_perm_b32 v127, v47, v46, s35
    ds_write_b128 v4, v[120:123] offset:30720
    ds_write_b128 v4, v[124:127] offset:31744
    s_waitcnt lgkmcnt(0)
    s_xor_b32 s36, s21, 1
    s_lshl_b32 s36, s36, 15
    s_add_u32 s36, s36, s29
    s_add_u32 s37, s36, 0x80
    buffer_load_dword v80, v11, s[92:95], s37 offen
    s_add_u32 s37, s36, 0x4080
    buffer_load_dword v81, v11, s[92:95], s37 offen
    s_add_u32 s37, s36, 0x480
    buffer_load_dword v82, v11, s[92:95], s37 offen
    s_add_u32 s37, s36, 0x4480
    buffer_load_dword v83, v11, s[92:95], s37 offen
    s_add_u32 s37, s36, 0x2080
    buffer_load_dword v84, v11, s[92:95], s37 offen
    s_add_u32 s37, s36, 0x6080
    buffer_load_dword v85, v11, s[92:95], s37 offen
    s_add_u32 s37, s36, 0x2480
    buffer_load_dword v86, v11, s[92:95], s37 offen
    s_add_u32 s37, s36, 0x6480
    buffer_load_dword v87, v11, s[92:95], s37 offen
    s_add_u32 s37, s36, 0xc0
    buffer_load_dword v88, v11, s[92:95], s37 offen
    s_add_u32 s37, s36, 0x40c0
    buffer_load_dword v89, v11, s[92:95], s37 offen
    s_add_u32 s37, s36, 0x4c0
    buffer_load_dword v90, v11, s[92:95], s37 offen
    s_add_u32 s37, s36, 0x44c0
    buffer_load_dword v91, v11, s[92:95], s37 offen
    s_add_u32 s37, s36, 0x20c0
    buffer_load_dword v92, v11, s[92:95], s37 offen
    s_add_u32 s37, s36, 0x60c0
    buffer_load_dword v93, v11, s[92:95], s37 offen
    s_add_u32 s37, s36, 0x24c0
    buffer_load_dword v94, v11, s[92:95], s37 offen
    s_add_u32 s37, s36, 0x64c0
    buffer_load_dword v95, v11, s[92:95], s37 offen
    s_barrier
    ds_read_b64_tr_b16 a[176:177], v20 offset:16384
    ds_read_b64_tr_b16 a[178:179], v20 offset:16896
    ds_read_b64_tr_b16 a[184:185], v21 offset:16384
    ds_read_b64_tr_b16 a[186:187], v21 offset:16896
    ds_read_b64_tr_b16 a[208:209], v22 offset:16384
    ds_read_b64_tr_b16 a[210:211], v22 offset:16896
    ds_read_b64_tr_b16 a[216:217], v23 offset:16384
    ds_read_b64_tr_b16 a[218:219], v23 offset:16896
    ds_read_b64_tr_b16 a[240:241], v24 offset:16384
    ds_read_b64_tr_b16 a[242:243], v24 offset:16896
    ds_read_b64_tr_b16 a[248:249], v25 offset:16384
    ds_read_b64_tr_b16 a[250:251], v25 offset:16896
    s_waitcnt lgkmcnt(4)
    ds_read_b64_tr_b16 v[144:145], v26 offset:16384
    ds_read_b64_tr_b16 v[146:147], v26 offset:16896
    ds_read_b64_tr_b16 v[152:153], v27 offset:16384
    ds_read_b64_tr_b16 v[154:155], v27 offset:16896
    s_waitcnt lgkmcnt(0)
    s_barrier
    s_add_u32 m0, s28, 49152
    s_add_u32 s37, s3, 0x100000
    buffer_load_dwordx4 v16, s[88:91], s37 offen lds
    s_add_u32 m0, s28, 53248
    s_add_u32 s37, s3, 0x120000
    buffer_load_dwordx4 v16, s[88:91], s37 offen lds
    s_add_u32 m0, s28, 81920
    s_add_u32 s37, s3, 0x140000
    buffer_load_dwordx4 v16, s[88:91], s37 offen lds
    s_add_u32 m0, s28, 86016
    s_add_u32 s37, s3, 0x160000
    buffer_load_dwordx4 v16, s[88:91], s37 offen lds
    s_add_u32 m0, s28, 114688
    s_add_u32 s37, s3, 0x180000
    buffer_load_dwordx4 v16, s[88:91], s37 offen lds
    s_add_u32 m0, s28, 118784
    s_add_u32 s37, s3, 0x1a0000
    buffer_load_dwordx4 v16, s[88:91], s37 offen lds
    s_add_u32 m0, s28, 147456
    s_add_u32 s37, s3, 0x1c0000
    buffer_load_dwordx4 v16, s[88:91], s37 offen lds
    s_add_u32 m0, s28, 151552
    s_add_u32 s37, s3, 0x1e0000
    buffer_load_dwordx4 v16, s[88:91], s37 offen lds
    s_waitcnt vmcnt(32)
    v_perm_b32 v232, v49, v48, s34
    v_perm_b32 v233, v49, v48, s35
    v_perm_b32 v234, v51, v50, s34
    v_perm_b32 v235, v51, v50, s35
    v_perm_b32 v236, v53, v52, s34
    v_perm_b32 v237, v53, v52, s35
    v_perm_b32 v238, v55, v54, s34
    v_perm_b32 v239, v55, v54, s35
    v_perm_b32 v120, v57, v56, s34
    v_perm_b32 v121, v57, v56, s35
    v_perm_b32 v122, v59, v58, s34
    v_perm_b32 v123, v59, v58, s35
    v_perm_b32 v124, v61, v60, s34
    v_perm_b32 v125, v61, v60, s35
    v_perm_b32 v126, v63, v62, s34
    v_perm_b32 v127, v63, v62, s35
    ds_write_b128 v4, v[120:123] offset:28672
    ds_write_b128 v4, v[124:127] offset:29696
    s_waitcnt lgkmcnt(0)
    s_xor_b32 s36, s21, 3
    s_lshl_b32 s36, s36, 15
    s_add_u32 s36, s36, s29
    s_add_u32 s37, s36, 0x0
    buffer_load_dword v32, v11, s[92:95], s37 offen
    s_add_u32 s37, s36, 0x4000
    buffer_load_dword v33, v11, s[92:95], s37 offen
    s_add_u32 s37, s36, 0x400
    buffer_load_dword v34, v11, s[92:95], s37 offen
    s_add_u32 s37, s36, 0x4400
    buffer_load_dword v35, v11, s[92:95], s37 offen
    s_add_u32 s37, s36, 0x2000
    buffer_load_dword v36, v11, s[92:95], s37 offen
    s_add_u32 s37, s36, 0x6000
    buffer_load_dword v37, v11, s[92:95], s37 offen
    s_add_u32 s37, s36, 0x2400
    buffer_load_dword v38, v11, s[92:95], s37 offen
    s_add_u32 s37, s36, 0x6400
    buffer_load_dword v39, v11, s[92:95], s37 offen
    s_add_u32 s37, s36, 0x40
    buffer_load_dword v40, v11, s[92:95], s37 offen
    s_add_u32 s37, s36, 0x4040
    buffer_load_dword v41, v11, s[92:95], s37 offen
    s_add_u32 s37, s36, 0x440
    buffer_load_dword v42, v11, s[92:95], s37 offen
    s_add_u32 s37, s36, 0x4440
    buffer_load_dword v43, v11, s[92:95], s37 offen
    s_add_u32 s37, s36, 0x2040
    buffer_load_dword v44, v11, s[92:95], s37 offen
    s_add_u32 s37, s36, 0x6040
    buffer_load_dword v45, v11, s[92:95], s37 offen
    s_add_u32 s37, s36, 0x2440
    buffer_load_dword v46, v11, s[92:95], s37 offen
    s_add_u32 s37, s36, 0x6440
    buffer_load_dword v47, v11, s[92:95], s37 offen
    s_barrier
    ds_read_b64_tr_b16 a[180:181], v20 offset:0
    ds_read_b64_tr_b16 a[182:183], v20 offset:512
    ds_read_b64_tr_b16 a[188:189], v21 offset:0
    ds_read_b64_tr_b16 a[190:191], v21 offset:512
    ds_read_b64_tr_b16 a[212:213], v22 offset:0
    ds_read_b64_tr_b16 a[214:215], v22 offset:512
    ds_read_b64_tr_b16 a[220:221], v23 offset:0
    ds_read_b64_tr_b16 a[222:223], v23 offset:512
    ds_read_b64_tr_b16 a[244:245], v24 offset:0
    ds_read_b64_tr_b16 a[246:247], v24 offset:512
    ds_read_b64_tr_b16 a[252:253], v25 offset:0
    ds_read_b64_tr_b16 a[254:255], v25 offset:512
    s_waitcnt lgkmcnt(4)
    ds_read_b64_tr_b16 v[148:149], v26 offset:0
    ds_read_b64_tr_b16 v[150:151], v26 offset:512
    ds_read_b64_tr_b16 v[156:157], v27 offset:0
    ds_read_b64_tr_b16 v[158:159], v27 offset:512
    s_waitcnt lgkmcnt(0)
    s_barrier
    s_add_u32 m0, s28, 32768
    s_add_u32 s37, s3, 0x200000
    buffer_load_dwordx4 v16, s[88:91], s37 offen lds
    s_add_u32 m0, s28, 36864
    s_add_u32 s37, s3, 0x220000
    buffer_load_dwordx4 v16, s[88:91], s37 offen lds
    s_add_u32 m0, s28, 65536
    s_add_u32 s37, s3, 0x240000
    buffer_load_dwordx4 v16, s[88:91], s37 offen lds
    s_add_u32 m0, s28, 69632
    s_add_u32 s37, s3, 0x260000
    buffer_load_dwordx4 v16, s[88:91], s37 offen lds
    s_add_u32 m0, s28, 98304
    s_add_u32 s37, s3, 0x280000
    buffer_load_dwordx4 v16, s[88:91], s37 offen lds
    s_add_u32 m0, s28, 102400
    s_add_u32 s37, s3, 0x2a0000
    buffer_load_dwordx4 v16, s[88:91], s37 offen lds
    s_add_u32 m0, s28, 131072
    s_add_u32 s37, s3, 0x2c0000
    buffer_load_dwordx4 v16, s[88:91], s37 offen lds
    s_add_u32 m0, s28, 135168
    s_add_u32 s37, s3, 0x2e0000
    buffer_load_dwordx4 v16, s[88:91], s37 offen lds
    s_waitcnt vmcnt(32)
    v_perm_b32 v208, v81, v80, s34
    v_perm_b32 v209, v81, v80, s35
    v_perm_b32 v210, v83, v82, s34
    v_perm_b32 v211, v83, v82, s35
    v_perm_b32 v212, v85, v84, s34
    v_perm_b32 v213, v85, v84, s35
    v_perm_b32 v214, v87, v86, s34
    v_perm_b32 v215, v87, v86, s35
    v_perm_b32 v120, v89, v88, s34
    v_perm_b32 v121, v89, v88, s35
    v_perm_b32 v122, v91, v90, s34
    v_perm_b32 v123, v91, v90, s35
    v_perm_b32 v124, v93, v92, s34
    v_perm_b32 v125, v93, v92, s35
    v_perm_b32 v126, v95, v94, s34
    v_perm_b32 v127, v95, v94, s35
    ds_write_b128 v4, v[120:123] offset:26624
    ds_write_b128 v4, v[124:127] offset:27648
    s_waitcnt lgkmcnt(0)
    s_xor_b32 s36, s21, 2
    s_lshl_b32 s36, s36, 15
    s_add_u32 s36, s36, s29
    s_add_u32 s37, s36, 0x0
    buffer_load_dword v48, v11, s[92:95], s37 offen
    s_add_u32 s37, s36, 0x4000
    buffer_load_dword v49, v11, s[92:95], s37 offen
    s_add_u32 s37, s36, 0x400
    buffer_load_dword v50, v11, s[92:95], s37 offen
    s_add_u32 s37, s36, 0x4400
    buffer_load_dword v51, v11, s[92:95], s37 offen
    s_add_u32 s37, s36, 0x2000
    buffer_load_dword v52, v11, s[92:95], s37 offen
    s_add_u32 s37, s36, 0x6000
    buffer_load_dword v53, v11, s[92:95], s37 offen
    s_add_u32 s37, s36, 0x2400
    buffer_load_dword v54, v11, s[92:95], s37 offen
    s_add_u32 s37, s36, 0x6400
    buffer_load_dword v55, v11, s[92:95], s37 offen
    s_add_u32 s37, s36, 0x40
    buffer_load_dword v56, v11, s[92:95], s37 offen
    s_add_u32 s37, s36, 0x4040
    buffer_load_dword v57, v11, s[92:95], s37 offen
    s_add_u32 s37, s36, 0x440
    buffer_load_dword v58, v11, s[92:95], s37 offen
    s_add_u32 s37, s36, 0x4440
    buffer_load_dword v59, v11, s[92:95], s37 offen
    s_add_u32 s37, s36, 0x2040
    buffer_load_dword v60, v11, s[92:95], s37 offen
    s_add_u32 s37, s36, 0x6040
    buffer_load_dword v61, v11, s[92:95], s37 offen
    s_add_u32 s37, s36, 0x2440
    buffer_load_dword v62, v11, s[92:95], s37 offen
    s_add_u32 s37, s36, 0x6440
    buffer_load_dword v63, v11, s[92:95], s37 offen
    s_barrier
    ds_read_b64_tr_b16 v[64:65], v20 offset:8192
    ds_read_b64_tr_b16 v[66:67], v20 offset:8704
    ds_read_b64_tr_b16 v[72:73], v21 offset:8192
    ds_read_b64_tr_b16 v[74:75], v21 offset:8704
    ds_read_b64_tr_b16 v[96:97], v22 offset:8192
    ds_read_b64_tr_b16 v[98:99], v22 offset:8704
    ds_read_b64_tr_b16 v[104:105], v23 offset:8192
    ds_read_b64_tr_b16 v[106:107], v23 offset:8704
    ds_read_b64_tr_b16 a[112:113], v24 offset:8192
    ds_read_b64_tr_b16 a[114:115], v24 offset:8704
    ds_read_b64_tr_b16 a[120:121], v25 offset:8192
    ds_read_b64_tr_b16 a[122:123], v25 offset:8704
    s_waitcnt lgkmcnt(4)
    ds_read_b64_tr_b16 a[144:145], v26 offset:8192
    ds_read_b64_tr_b16 a[146:147], v26 offset:8704
    ds_read_b64_tr_b16 a[152:153], v27 offset:8192
    ds_read_b64_tr_b16 a[154:155], v27 offset:8704
    s_waitcnt lgkmcnt(0)
    s_barrier
    s_add_u32 m0, s28, 40960
    s_add_u32 s37, s3, 0x300000
    buffer_load_dwordx4 v16, s[88:91], s37 offen lds
    s_add_u32 m0, s28, 45056
    s_add_u32 s37, s3, 0x320000
    buffer_load_dwordx4 v16, s[88:91], s37 offen lds
    s_add_u32 m0, s28, 73728
    s_add_u32 s37, s3, 0x340000
    buffer_load_dwordx4 v16, s[88:91], s37 offen lds
    s_add_u32 m0, s28, 77824
    s_add_u32 s37, s3, 0x360000
    buffer_load_dwordx4 v16, s[88:91], s37 offen lds
    s_add_u32 m0, s28, 106496
    s_add_u32 s37, s3, 0x380000
    buffer_load_dwordx4 v16, s[88:91], s37 offen lds
    s_add_u32 m0, s28, 110592
    s_add_u32 s37, s3, 0x3a0000
    buffer_load_dwordx4 v16, s[88:91], s37 offen lds
    s_add_u32 m0, s28, 139264
    s_add_u32 s37, s3, 0x3c0000
    buffer_load_dwordx4 v16, s[88:91], s37 offen lds
    s_add_u32 m0, s28, 143360
    s_add_u32 s37, s3, 0x3e0000
    buffer_load_dwordx4 v16, s[88:91], s37 offen lds
    s_waitcnt vmcnt(32)
    v_perm_b32 v240, v33, v32, s34
    v_perm_b32 v241, v33, v32, s35
    v_perm_b32 v242, v35, v34, s34
    v_perm_b32 v243, v35, v34, s35
    v_perm_b32 v244, v37, v36, s34
    v_perm_b32 v245, v37, v36, s35
    v_perm_b32 v246, v39, v38, s34
    v_perm_b32 v247, v39, v38, s35
    v_perm_b32 v248, v41, v40, s34
    v_perm_b32 v249, v41, v40, s35
    v_perm_b32 v250, v43, v42, s34
    v_perm_b32 v251, v43, v42, s35
    v_perm_b32 v252, v45, v44, s34
    v_perm_b32 v253, v45, v44, s35
    v_perm_b32 v254, v47, v46, s34
    v_perm_b32 v255, v47, v46, s35
    s_xor_b32 s36, s21, 1
    s_lshl_b32 s36, s36, 15
    s_add_u32 s36, s36, s29
    s_add_u32 s37, s36, 0x0
    buffer_load_dword v80, v11, s[92:95], s37 offen
    s_add_u32 s37, s36, 0x4000
    buffer_load_dword v81, v11, s[92:95], s37 offen
    s_add_u32 s37, s36, 0x400
    buffer_load_dword v82, v11, s[92:95], s37 offen
    s_add_u32 s37, s36, 0x4400
    buffer_load_dword v83, v11, s[92:95], s37 offen
    s_add_u32 s37, s36, 0x2000
    buffer_load_dword v84, v11, s[92:95], s37 offen
    s_add_u32 s37, s36, 0x6000
    buffer_load_dword v85, v11, s[92:95], s37 offen
    s_add_u32 s37, s36, 0x2400
    buffer_load_dword v86, v11, s[92:95], s37 offen
    s_add_u32 s37, s36, 0x6400
    buffer_load_dword v87, v11, s[92:95], s37 offen
    s_add_u32 s37, s36, 0x40
    buffer_load_dword v88, v11, s[92:95], s37 offen
    s_add_u32 s37, s36, 0x4040
    buffer_load_dword v89, v11, s[92:95], s37 offen
    s_add_u32 s37, s36, 0x440
    buffer_load_dword v90, v11, s[92:95], s37 offen
    s_add_u32 s37, s36, 0x4440
    buffer_load_dword v91, v11, s[92:95], s37 offen
    s_add_u32 s37, s36, 0x2040
    buffer_load_dword v92, v11, s[92:95], s37 offen
    s_add_u32 s37, s36, 0x6040
    buffer_load_dword v93, v11, s[92:95], s37 offen
    s_add_u32 s37, s36, 0x2440
    buffer_load_dword v94, v11, s[92:95], s37 offen
    s_add_u32 s37, s36, 0x6440
    buffer_load_dword v95, v11, s[92:95], s37 offen
    s_barrier
    ds_read_b64_tr_b16 v[68:69], v20 offset:16384
    ds_read_b64_tr_b16 v[70:71], v20 offset:16896
    ds_read_b64_tr_b16 v[76:77], v21 offset:16384
    ds_read_b64_tr_b16 v[78:79], v21 offset:16896
    ds_read_b64_tr_b16 v[100:101], v22 offset:16384
    ds_read_b64_tr_b16 v[102:103], v22 offset:16896
    ds_read_b64_tr_b16 v[108:109], v23 offset:16384
    ds_read_b64_tr_b16 v[110:111], v23 offset:16896
    ds_read_b64_tr_b16 a[116:117], v24 offset:16384
    ds_read_b64_tr_b16 a[118:119], v24 offset:16896
    ds_read_b64_tr_b16 a[124:125], v25 offset:16384
    ds_read_b64_tr_b16 a[126:127], v25 offset:16896
    s_waitcnt lgkmcnt(4)
    ds_read_b64_tr_b16 a[148:149], v26 offset:16384
    ds_read_b64_tr_b16 a[150:151], v26 offset:16896
    ds_read_b64_tr_b16 a[156:157], v27 offset:16384
    ds_read_b64_tr_b16 a[158:159], v27 offset:16896
    s_waitcnt lgkmcnt(0)
    s_barrier
    s_mov_b32 s96, s48
    s_and_b32 s97, s49, 0xffff
    s_mov_b32 s98, 0x400000
    s_mov_b32 s99, 0x20000
    s_add_u32 m0, s28, 49152
    s_add_u32 s37, s3, 0x0
    buffer_load_dwordx4 v16, s[96:99], s37 offen lds
    s_add_u32 m0, s28, 53248
    s_add_u32 s37, s3, 0x20000
    buffer_load_dwordx4 v16, s[96:99], s37 offen lds
    s_add_u32 m0, s28, 81920
    s_add_u32 s37, s3, 0x40000
    buffer_load_dwordx4 v16, s[96:99], s37 offen lds
    s_add_u32 m0, s28, 86016
    s_add_u32 s37, s3, 0x60000
    buffer_load_dwordx4 v16, s[96:99], s37 offen lds
    s_add_u32 m0, s28, 114688
    s_add_u32 s37, s3, 0x80000
    buffer_load_dwordx4 v16, s[96:99], s37 offen lds
    s_add_u32 m0, s28, 118784
    s_add_u32 s37, s3, 0xa0000
    buffer_load_dwordx4 v16, s[96:99], s37 offen lds
    s_add_u32 m0, s28, 147456
    s_add_u32 s37, s3, 0xc0000
    buffer_load_dwordx4 v16, s[96:99], s37 offen lds
    s_add_u32 m0, s28, 151552
    s_add_u32 s37, s3, 0xe0000
    buffer_load_dwordx4 v16, s[96:99], s37 offen lds
    s_waitcnt vmcnt(32)
    v_perm_b32 v216, v49, v48, s34
    v_perm_b32 v217, v49, v48, s35
    v_perm_b32 v218, v51, v50, s34
    v_perm_b32 v219, v51, v50, s35
    v_perm_b32 v220, v53, v52, s34
    v_perm_b32 v221, v53, v52, s35
    v_perm_b32 v222, v55, v54, s34
    v_perm_b32 v223, v55, v54, s35
    v_perm_b32 v224, v57, v56, s34
    v_perm_b32 v225, v57, v56, s35
    v_perm_b32 v226, v59, v58, s34
    v_perm_b32 v227, v59, v58, s35
    v_perm_b32 v228, v61, v60, s34
    v_perm_b32 v229, v61, v60, s35
    v_perm_b32 v230, v63, v62, s34
    v_perm_b32 v231, v63, v62, s35
    s_xor_b32 s36, s21, 0
    s_lshl_b32 s36, s36, 15
    s_add_u32 s36, s36, s29
    s_add_u32 s37, s36, 0x80
    buffer_load_dword v32, v11, s[92:95], s37 offen
    s_add_u32 s37, s36, 0x4080
    buffer_load_dword v33, v11, s[92:95], s37 offen
    s_add_u32 s37, s36, 0x480
    buffer_load_dword v34, v11, s[92:95], s37 offen
    s_add_u32 s37, s36, 0x4480
    buffer_load_dword v35, v11, s[92:95], s37 offen
    s_add_u32 s37, s36, 0x2080
    buffer_load_dword v36, v11, s[92:95], s37 offen
    s_add_u32 s37, s36, 0x6080
    buffer_load_dword v37, v11, s[92:95], s37 offen
    s_add_u32 s37, s36, 0x2480
    buffer_load_dword v38, v11, s[92:95], s37 offen
    s_add_u32 s37, s36, 0x6480
    buffer_load_dword v39, v11, s[92:95], s37 offen
    s_add_u32 s37, s36, 0xc0
    buffer_load_dword v40, v11, s[92:95], s37 offen
    s_add_u32 s37, s36, 0x40c0
    buffer_load_dword v41, v11, s[92:95], s37 offen
    s_add_u32 s37, s36, 0x4c0
    buffer_load_dword v42, v11, s[92:95], s37 offen
    s_add_u32 s37, s36, 0x44c0
    buffer_load_dword v43, v11, s[92:95], s37 offen
    s_add_u32 s37, s36, 0x20c0
    buffer_load_dword v44, v11, s[92:95], s37 offen
    s_add_u32 s37, s36, 0x60c0
    buffer_load_dword v45, v11, s[92:95], s37 offen
    s_add_u32 s37, s36, 0x24c0
    buffer_load_dword v46, v11, s[92:95], s37 offen
    s_add_u32 s37, s36, 0x64c0
    buffer_load_dword v47, v11, s[92:95], s37 offen
    s_barrier
    ds_read_b64_tr_b16 a[80:81], v20 offset:0
    ds_read_b64_tr_b16 a[82:83], v20 offset:512
    ds_read_b64_tr_b16 a[88:89], v21 offset:0
    ds_read_b64_tr_b16 a[90:91], v21 offset:512
    ds_read_b64_tr_b16 a[96:97], v22 offset:0
    ds_read_b64_tr_b16 a[98:99], v22 offset:512
    ds_read_b64_tr_b16 a[104:105], v23 offset:0
    ds_read_b64_tr_b16 a[106:107], v23 offset:512
    ds_read_b64_tr_b16 a[128:129], v24 offset:0
    ds_read_b64_tr_b16 a[130:131], v24 offset:512
    ds_read_b64_tr_b16 a[136:137], v25 offset:0
    ds_read_b64_tr_b16 a[138:139], v25 offset:512
    s_waitcnt lgkmcnt(4)
    ds_read_b64_tr_b16 v[112:113], v26 offset:0
    ds_read_b64_tr_b16 v[114:115], v26 offset:512
    ds_read_b64_tr_b16 v[120:121], v27 offset:0
    ds_read_b64_tr_b16 v[122:123], v27 offset:512
    s_waitcnt lgkmcnt(0)
    s_barrier
    s_add_u32 m0, s28, 32768
    s_add_u32 s37, s3, 0x100000
    buffer_load_dwordx4 v16, s[96:99], s37 offen lds
    s_add_u32 m0, s28, 36864
    s_add_u32 s37, s3, 0x120000
    buffer_load_dwordx4 v16, s[96:99], s37 offen lds
    s_add_u32 m0, s28, 65536
    s_add_u32 s37, s3, 0x140000
    buffer_load_dwordx4 v16, s[96:99], s37 offen lds
    s_add_u32 m0, s28, 69632
    s_add_u32 s37, s3, 0x160000
    buffer_load_dwordx4 v16, s[96:99], s37 offen lds
    s_add_u32 m0, s28, 98304
    s_add_u32 s37, s3, 0x180000
    buffer_load_dwordx4 v16, s[96:99], s37 offen lds
    s_add_u32 m0, s28, 102400
    s_add_u32 s37, s3, 0x1a0000
    buffer_load_dwordx4 v16, s[96:99], s37 offen lds
    s_add_u32 m0, s28, 131072
    s_add_u32 s37, s3, 0x1c0000
    buffer_load_dwordx4 v16, s[96:99], s37 offen lds
    s_add_u32 m0, s28, 135168
    s_add_u32 s37, s3, 0x1e0000
    buffer_load_dwordx4 v16, s[96:99], s37 offen lds
    s_waitcnt vmcnt(32)
    v_perm_b32 v192, v81, v80, s34
    v_perm_b32 v193, v81, v80, s35
    v_perm_b32 v194, v83, v82, s34
    v_perm_b32 v195, v83, v82, s35
    v_perm_b32 v196, v85, v84, s34
    v_perm_b32 v197, v85, v84, s35
    v_perm_b32 v198, v87, v86, s34
    v_perm_b32 v199, v87, v86, s35
    v_perm_b32 v200, v89, v88, s34
    v_perm_b32 v201, v89, v88, s35
    v_perm_b32 v202, v91, v90, s34
    v_perm_b32 v203, v91, v90, s35
    v_perm_b32 v204, v93, v92, s34
    v_perm_b32 v205, v93, v92, s35
    v_perm_b32 v206, v95, v94, s34
    v_perm_b32 v207, v95, v94, s35
    s_xor_b32 s36, s21, 0
    s_lshl_b32 s36, s36, 15
    s_add_u32 s36, s36, s29
    s_add_u32 s37, s36, 0x0
    buffer_load_dword v48, v11, s[92:95], s37 offen
    s_add_u32 s37, s36, 0x4000
    buffer_load_dword v49, v11, s[92:95], s37 offen
    s_add_u32 s37, s36, 0x400
    buffer_load_dword v50, v11, s[92:95], s37 offen
    s_add_u32 s37, s36, 0x4400
    buffer_load_dword v51, v11, s[92:95], s37 offen
    s_add_u32 s37, s36, 0x2000
    buffer_load_dword v52, v11, s[92:95], s37 offen
    s_add_u32 s37, s36, 0x6000
    buffer_load_dword v53, v11, s[92:95], s37 offen
    s_add_u32 s37, s36, 0x2400
    buffer_load_dword v54, v11, s[92:95], s37 offen
    s_add_u32 s37, s36, 0x6400
    buffer_load_dword v55, v11, s[92:95], s37 offen
    s_add_u32 s37, s36, 0x40
    buffer_load_dword v56, v11, s[92:95], s37 offen
    s_add_u32 s37, s36, 0x4040
    buffer_load_dword v57, v11, s[92:95], s37 offen
    s_add_u32 s37, s36, 0x440
    buffer_load_dword v58, v11, s[92:95], s37 offen
    s_add_u32 s37, s36, 0x4440
    buffer_load_dword v59, v11, s[92:95], s37 offen
    s_add_u32 s37, s36, 0x2040
    buffer_load_dword v60, v11, s[92:95], s37 offen
    s_add_u32 s37, s36, 0x6040
    buffer_load_dword v61, v11, s[92:95], s37 offen
    s_add_u32 s37, s36, 0x2440
    buffer_load_dword v62, v11, s[92:95], s37 offen
    s_add_u32 s37, s36, 0x6440
    buffer_load_dword v63, v11, s[92:95], s37 offen
    s_barrier
    ds_read_b64_tr_b16 a[84:85], v20 offset:8192
    ds_read_b64_tr_b16 a[86:87], v20 offset:8704
    ds_read_b64_tr_b16 a[92:93], v21 offset:8192
    ds_read_b64_tr_b16 a[94:95], v21 offset:8704
    ds_read_b64_tr_b16 a[100:101], v22 offset:8192
    ds_read_b64_tr_b16 a[102:103], v22 offset:8704
    ds_read_b64_tr_b16 a[108:109], v23 offset:8192
    ds_read_b64_tr_b16 a[110:111], v23 offset:8704
    ds_read_b64_tr_b16 a[132:133], v24 offset:8192
    ds_read_b64_tr_b16 a[134:135], v24 offset:8704
    ds_read_b64_tr_b16 a[140:141], v25 offset:8192
    ds_read_b64_tr_b16 a[142:143], v25 offset:8704
    s_waitcnt lgkmcnt(4)
    ds_read_b64_tr_b16 v[116:117], v26 offset:8192
    ds_read_b64_tr_b16 v[118:119], v26 offset:8704
    ds_read_b64_tr_b16 v[124:125], v27 offset:8192
    ds_read_b64_tr_b16 v[126:127], v27 offset:8704
    s_waitcnt lgkmcnt(0)
    s_barrier
    s_add_u32 m0, s28, 40960
    s_add_u32 s37, s3, 0x200000
    buffer_load_dwordx4 v16, s[96:99], s37 offen lds
    s_add_u32 m0, s28, 45056
    s_add_u32 s37, s3, 0x220000
    buffer_load_dwordx4 v16, s[96:99], s37 offen lds
    s_add_u32 m0, s28, 73728
    s_add_u32 s37, s3, 0x240000
    buffer_load_dwordx4 v16, s[96:99], s37 offen lds
    s_add_u32 m0, s28, 77824
    s_add_u32 s37, s3, 0x260000
    buffer_load_dwordx4 v16, s[96:99], s37 offen lds
    s_add_u32 m0, s28, 106496
    s_add_u32 s37, s3, 0x280000
    buffer_load_dwordx4 v16, s[96:99], s37 offen lds
    s_add_u32 m0, s28, 110592
    s_add_u32 s37, s3, 0x2a0000
    buffer_load_dwordx4 v16, s[96:99], s37 offen lds
    s_add_u32 m0, s28, 139264
    s_add_u32 s37, s3, 0x2c0000
    buffer_load_dwordx4 v16, s[96:99], s37 offen lds
    s_add_u32 m0, s28, 143360
    s_add_u32 s37, s3, 0x2e0000
    buffer_load_dwordx4 v16, s[96:99], s37 offen lds
    s_waitcnt vmcnt(32)
    v_perm_b32 v176, v33, v32, s34
    v_perm_b32 v177, v33, v32, s35
    v_perm_b32 v178, v35, v34, s34
    v_perm_b32 v179, v35, v34, s35
    v_perm_b32 v180, v37, v36, s34
    v_perm_b32 v181, v37, v36, s35
    v_perm_b32 v182, v39, v38, s34
    v_perm_b32 v183, v39, v38, s35
    v_perm_b32 v184, v41, v40, s34
    v_perm_b32 v185, v41, v40, s35
    v_perm_b32 v186, v43, v42, s34
    v_perm_b32 v187, v43, v42, s35
    v_perm_b32 v188, v45, v44, s34
    v_perm_b32 v189, v45, v44, s35
    v_perm_b32 v190, v47, v46, s34
    v_perm_b32 v191, v47, v46, s35
    v_lshrrev_b32 v31, 2, v3
    buffer_load_dword v30, v31, s[16:19], 0 offen sc1
    s_barrier
    ds_read_b64_tr_b16 v[32:33], v20 offset:16384
    ds_read_b64_tr_b16 v[34:35], v20 offset:16896
    ds_read_b64_tr_b16 v[40:41], v21 offset:16384
    ds_read_b64_tr_b16 v[42:43], v21 offset:16896
    ds_read_b64_tr_b16 a[0:1], v22 offset:16384
    ds_read_b64_tr_b16 a[2:3], v22 offset:16896
    ds_read_b64_tr_b16 a[8:9], v23 offset:16384
    ds_read_b64_tr_b16 a[10:11], v23 offset:16896
    ds_read_b64_tr_b16 a[32:33], v24 offset:16384
    ds_read_b64_tr_b16 a[34:35], v24 offset:16896
    ds_read_b64_tr_b16 a[40:41], v25 offset:16384
    ds_read_b64_tr_b16 a[42:43], v25 offset:16896
    s_waitcnt lgkmcnt(4)
    ds_read_b64_tr_b16 a[64:65], v26 offset:16384
    ds_read_b64_tr_b16 a[66:67], v26 offset:16896
    ds_read_b64_tr_b16 a[72:73], v27 offset:16384
    ds_read_b64_tr_b16 a[74:75], v27 offset:16896
    s_waitcnt lgkmcnt(0)
    s_barrier
    s_add_u32 m0, s28, 49152
    s_add_u32 s37, s3, 0x300000
    buffer_load_dwordx4 v16, s[96:99], s37 offen lds
    s_add_u32 m0, s28, 53248
    s_add_u32 s37, s3, 0x320000
    buffer_load_dwordx4 v16, s[96:99], s37 offen lds
    s_add_u32 m0, s28, 81920
    s_add_u32 s37, s3, 0x340000
    buffer_load_dwordx4 v16, s[96:99], s37 offen lds
    s_add_u32 m0, s28, 86016
    s_add_u32 s37, s3, 0x360000
    buffer_load_dwordx4 v16, s[96:99], s37 offen lds
    s_add_u32 m0, s28, 114688
    s_add_u32 s37, s3, 0x380000
    buffer_load_dwordx4 v16, s[96:99], s37 offen lds
    s_add_u32 m0, s28, 118784
    s_add_u32 s37, s3, 0x3a0000
    buffer_load_dwordx4 v16, s[96:99], s37 offen lds
    s_add_u32 m0, s28, 147456
    s_add_u32 s37, s3, 0x3c0000
    buffer_load_dwordx4 v16, s[96:99], s37 offen lds
    s_add_u32 m0, s28, 151552
    s_add_u32 s37, s3, 0x3e0000
    buffer_load_dwordx4 v16, s[96:99], s37 offen lds
    s_waitcnt vmcnt(17)
    v_perm_b32 v160, v49, v48, s34
    v_perm_b32 v161, v49, v48, s35
    v_perm_b32 v162, v51, v50, s34
    v_perm_b32 v163, v51, v50, s35
    v_perm_b32 v164, v53, v52, s34
    v_perm_b32 v165, v53, v52, s35
    v_perm_b32 v166, v55, v54, s34
    v_perm_b32 v167, v55, v54, s35
    v_perm_b32 v168, v57, v56, s34
    v_perm_b32 v169, v57, v56, s35
    v_perm_b32 v170, v59, v58, s34
    v_perm_b32 v171, v59, v58, s35
    v_perm_b32 v172, v61, v60, s34
    v_perm_b32 v173, v61, v60, s35
    v_perm_b32 v174, v63, v62, s34
    v_perm_b32 v175, v63, v62, s35
    s_waitcnt vmcnt(8)
    s_mov_b32 s41, 1
L_HS:
    v_cmp_eq_u32 vcc, 0, v30
    s_cbranch_vccz L_HS_ok
    buffer_load_dword v30, v31, s[16:19], 0 offen sc1
    s_add_u32 s32, s32, 1
    s_cmp_gt_u32 s32, 200000
    s_waitcnt vmcnt(0)
    s_cbranch_scc0 L_HS
    s_branch L_HS_done
L_HS_ok:
    v_readlane_b32 s36, v30, 63
    s_nop 1
    v_cmp_ne_u32 vcc, s36, v30
    s_nop 1
    s_cmp_lg_u32 vcc_hi, 0
    s_cselect_b32 s41, 1, 0
L_HS_done:
    s_mov_b32 s7, 0xf7df00
    buffer_load_dword v15, v0, s[8:11], s7 offen sc1
    s_barrier
    ds_read_b64_tr_b16 v[36:37], v20 offset:0
    ds_read_b64_tr_b16 v[38:39], v20 offset:512
    ds_read_b64_tr_b16 v[44:45], v21 offset:0
    ds_read_b64_tr_b16 v[46:47], v21 offset:512
    ds_read_b64_tr_b16 a[4:5], v22 offset:0
    ds_read_b64_tr_b16 a[6:7], v22 offset:512
    ds_read_b64_tr_b16 a[12:13], v23 offset:0
    ds_read_b64_tr_b16 a[14:15], v23 offset:512
    ds_read_b64_tr_b16 a[36:37], v24 offset:0
    ds_read_b64_tr_b16 a[38:39], v24 offset:512
    ds_read_b64_tr_b16 a[44:45], v25 offset:0
    ds_read_b64_tr_b16 a[46:47], v25 offset:512
    s_waitcnt lgkmcnt(4)
    ds_read_b64_tr_b16 a[68:69], v26 offset:0
    ds_read_b64_tr_b16 a[70:71], v26 offset:512
    ds_read_b64_tr_b16 a[76:77], v27 offset:0
    ds_read_b64_tr_b16 a[78:79], v27 offset:512
    s_waitcnt lgkmcnt(0)
    s_barrier
    s_barrier
    ds_read_b64_tr_b16 v[48:49], v20 offset:8192
    ds_read_b64_tr_b16 v[50:51], v20 offset:8704
    ds_read_b64_tr_b16 v[56:57], v21 offset:8192
    ds_read_b64_tr_b16 v[58:59], v21 offset:8704
    ds_read_b64_tr_b16 a[16:17], v22 offset:8192
    ds_read_b64_tr_b16 a[18:19], v22 offset:8704
    ds_read_b64_tr_b16 a[24:25], v23 offset:8192
    ds_read_b64_tr_b16 a[26:27], v23 offset:8704
    ds_read_b64_tr_b16 a[48:49], v24 offset:8192
    ds_read_b64_tr_b16 a[50:51], v24 offset:8704
    ds_read_b64_tr_b16 a[56:57], v25 offset:8192
    ds_read_b64_tr_b16 a[58:59], v25 offset:8704
    s_waitcnt lgkmcnt(4)
    ds_read_b64_tr_b16 v[80:81], v26 offset:8192
    ds_read_b64_tr_b16 v[82:83], v26 offset:8704
    ds_read_b64_tr_b16 v[88:89], v27 offset:8192
    ds_read_b64_tr_b16 v[90:91], v27 offset:8704
    s_waitcnt lgkmcnt(0)
    s_barrier
    s_waitcnt vmcnt(0)
L_F0:
    v_readlane_b32 s36, v15, 33
    s_nop 1
    s_cmp_lg_u32 s36, 0
    s_cbranch_scc1 L_F0_ok
    buffer_load_dword v15, v0, s[8:11], s7 offen sc1
    s_add_u32 s32, s32, 1
    s_cmp_gt_u32 s32, 200000
    s_waitcnt vmcnt(0)
    s_cbranch_scc0 L_F0
L_F0_ok:
    s_mov_b32 s7, 0x1000000
    buffer_load_dword v15, v0, s[8:11], s7 offen sc1
    s_barrier
    ds_read_b64_tr_b16 v[52:53], v20 offset:16384
    ds_read_b64_tr_b16 v[54:55], v20 offset:16896
    ds_read_b64_tr_b16 v[60:61], v21 offset:16384
    ds_read_b64_tr_b16 v[62:63], v21 offset:16896
    ds_read_b64_tr_b16 a[20:21], v22 offset:16384
    ds_read_b64_tr_b16 a[22:23], v22 offset:16896
    ds_read_b64_tr_b16 a[28:29], v23 offset:16384
    ds_read_b64_tr_b16 a[30:31], v23 offset:16896
    ds_read_b64_tr_b16 a[52:53], v24 offset:16384
    ds_read_b64_tr_b16 a[54:55], v24 offset:16896
    ds_read_b64_tr_b16 a[60:61], v25 offset:16384
    ds_read_b64_tr_b16 a[62:63], v25 offset:16896
    s_waitcnt lgkmcnt(4)
    ds_read_b64_tr_b16 v[84:85], v26 offset:16384
    ds_read_b64_tr_b16 v[86:87], v26 offset:16896
    ds_read_b64_tr_b16 v[92:93], v27 offset:16384
    ds_read_b64_tr_b16 v[94:95], v27 offset:16896
    s_waitcnt lgkmcnt(0)
    s_barrier
    ds_write_b128 v4, v[32:35] offset:0
    ds_write_b128 v4, v[36:39] offset:1024
    ds_write_b128 v4, v[40:43] offset:2048
    ds_write_b128 v4, v[44:47] offset:3072
    ds_write_b128 v4, v[48:51] offset:4096
    ds_write_b128 v4, v[52:55] offset:5120
    ds_write_b128 v4, v[56:59] offset:6144
    ds_write_b128 v4, v[60:63] offset:7168
    s_waitcnt lgkmcnt(0)
    ds_write_b128 v4, v[64:67] offset:8192
    ds_write_b128 v4, v[68:71] offset:9216
    ds_write_b128 v4, v[72:75] offset:10240
    ds_write_b128 v4, v[76:79] offset:11264
    ds_write_b128 v4, v[80:83] offset:12288
    ds_write_b128 v4, v[84:87] offset:13312
    ds_write_b128 v4, v[88:91] offset:14336
    ds_write_b128 v4, v[92:95] offset:15360
    s_waitcnt lgkmcnt(0)
    ds_write_b128 v4, v[96:99] offset:16384
    ds_write_b128 v4, v[100:103] offset:17408
    ds_write_b128 v4, v[104:107] offset:18432
    ds_write_b128 v4, v[108:111] offset:19456
    ds_write_b128 v4, v[112:115] offset:20480
    ds_write_b128 v4, v[116:119] offset:21504
    ds_write_b128 v4, v[120:123] offset:22528
    ds_write_b128 v4, v[124:127] offset:23552
    s_waitcnt lgkmcnt(0)
    s_waitcnt lgkmcnt(0)
    s_cmp_lg_u32 s41, 0
    s_cbranch_scc1 L_slow_start
L_fast_start:
    s_mov_b32 s22, 0
    s_mov_b32 s23, 0x1000000
    s_mov_b32 s27, 0
    s_mov_b32 s31, 0x80000
    s_mov_b32 s61, 0x40000000
    s_mov_b32 s96, 0x800
    s_mov_b32 s97, 0x1000
    s_mov_b32 s98, 0x1800
    s_mov_b32 s92, 0xcccccccc
    s_mov_b32 s93, 0xcccccccc
    s_mov_b32 s91, 0
    ds_read_b128 v[104:107], v4 offset:0
    ds_read_b128 v[108:111], v4 offset:1024
    ds_read_b128 v[112:115], v4 offset:2048
    ds_read_b128 v[116:119], v4 offset:3072
    ds_read_b128 v[88:91], v4 offset:4096
    ds_read_b128 v[92:95], v4 offset:5120
    ds_read_b128 v[96:99], v4 offset:6144
    ds_read_b128 v[100:103], v4 offset:7168
    ds_read_b128 v[72:75], v4 offset:8192
    ds_read_b128 v[76:79], v4 offset:9216
    ds_read_b128 v[80:83], v4 offset:10240
    ds_read_b128 v[84:87], v4 offset:11264
    v_mov_b64 v[48:49], 0
    v_mov_b64 v[50:51], 0
    v_mov_b64 v[52:53], 0
    v_mov_b64 v[54:55], 0
    v_mov_b64 v[56:57], 0
    v_mov_b64 v[58:59], 0
    v_mov_b64 v[60:61], 0
    v_mov_b64 v[62:63], 0
    v_mov_b64 v[64:65], 0
    v_mov_b64 v[66:67], 0
    v_mov_b64 v[68:69], 0
    v_mov_b64 v[70:71], 0
    s_add_u32 s7, s23, 0x80000
    buffer_load_dwordx4 v[16:19], v2, s[8:11], s7 offen sc1
    buffer_load_dwordx4 v[20:23], v2, s[8:11], s7 offen offset:1024 sc1
    s_waitcnt vmcnt(2)
L_fast_step:
    v_readlane_b32 s36, v15, 33
    s_add_u32 s24, s23, 0x82100
    s_cmp_eq_u32 s36, 0
    s_cbranch_scc1 L_fast_refresh
L_fast_fresh:
    s_add_u32 s29, s23, s25
    s_add_u32 s30, s23, s39
    s_xor_b32 s28, s27, 1
    s_add_u32 s90, s22, 1
    s_nop 15
L_fast_retrym:
    buffer_load_dwordx4 v[16:19], v2, s[8:11], s7 offen sc1
    buffer_load_dwordx4 v[20:23], v2, s[8:11], s7 offen offset:1024 sc1
L_fast_prem:
    s_add_u32 s32, s32, 1
    s_cmp_gt_u32 s32, 200000
    s_cselect_b32 s94, -1, -2
    v_xor_b32 v28, 0x800, v2
    v_xor_b32 v44, 0x1800, v2
    v_mov_b64 v[48:49], 0
    v_mov_b64 v[50:51], 0
    v_mov_b64 v[52:53], 0
    v_mov_b64 v[54:55], 0
L_fast_waitm:
    s_waitcnt vmcnt(3) lgkmcnt(0)
L_fast_gotm:
    v_max3_u32 v14, v16, v17, v18
    v_max_u32 v14, v14, v19
    v_smfmac_f32_16x16x64_bf16 v[48:51], v[16:19], v[104:111], v1
    s_waitcnt vmcnt(2)
    v_max3_u32 v14, v14, v20, v21
    v_smfmac_f32_16x16x64_bf16 v[52:55], v[16:19], v[112:119], v1
    v_max3_u32 v14, v14, v22, v23
    v_cmp_lt_u32 vcc, s94, v14
    v_smfmac_f32_16x16x64_bf16 v[48:51], v[20:23], v[88:95], v1
    ds_write_b128 v2, v[16:19] offset:0
    s_cbranch_vccnz L_fast_retrym
    v_smfmac_f32_16x16x64_bf16 v[52:55], v[20:23], v[96:103], v1
    ds_write_b128 v2, v[20:23] offset:1024
    v_smfmac_f32_16x16x64_bf16 v[56:59], v[16:19], v[72:79], v1
    buffer_load_dwordx4 v[104:107], v3, s[8:11], s29 offen offset:0 sc1
    buffer_load_dwordx4 v[120:123], v3, s[8:11], s30 offen offset:0 sc1
    v_smfmac_f32_16x16x64_bf16 v[60:63], v[16:19], v[80:87], v1
    buffer_load_dwordx4 v[108:111], v3, s[8:11], s29 offen offset:1024 sc1
    buffer_load_dwordx4 v[124:127], v3, s[8:11], s30 offen offset:1024 sc1
    v_smfmac_f32_16x16x64_bf16 v[56:59], v[20:23], a[80:87], v1
    buffer_load_dwordx4 v[112:115], v3, s[8:11], s29 offen offset:2048 sc1
    buffer_load_dwordx4 v[116:119], v3, s[8:11], s29 offen offset:3072 sc1
    v_smfmac_f32_16x16x64_bf16 v[60:63], v[20:23], a[88:95], v1
    s_waitcnt lgkmcnt(0)
    s_barrier
    ds_read_b128 v[24:27], v28 offset:0
    v_smfmac_f32_16x16x64_bf16 v[64:67], v[16:19], a[160:167], v1
    ds_read_b128 v[28:31], v28 offset:1024
    v_smfmac_f32_16x16x64_bf16 v[68:71], v[16:19], a[168:175], v1
    buffer_load_dword v15, v0, s[8:11], s24 offen sc1
    v_smfmac_f32_16x16x64_bf16 v[64:67], v[20:23], a[176:183], v1
    ds_read_b128 v[32:35], v8 offset:0
    v_smfmac_f32_16x16x64_bf16 v[68:71], v[20:23], a[184:191], v1
    ds_read_b128 v[36:39], v8 offset:1024
    s_waitcnt lgkmcnt(3)
    v_smfmac_f32_16x16x64_bf16 v[48:51], v[24:27], a[0:7], v1
    ds_read_b128 v[40:43], v44 offset:0
    v_smfmac_f32_16x16x64_bf16 v[52:55], v[24:27], a[8:15], v1
    ds_read_b128 v[44:47], v44 offset:1024
    s_waitcnt lgkmcnt(4)
    v_smfmac_f32_16x16x64_bf16 v[48:51], v[28:31], a[16:23], v1
    ds_read_b128 v[88:91], v4 offset:12288
    v_smfmac_f32_16x16x64_bf16 v[52:55], v[28:31], a[24:31], v1
    ds_read_b128 v[92:95], v4 offset:13312
    s_waitcnt lgkmcnt(4)
    v_smfmac_f32_16x16x64_bf16 v[48:51], v[32:35], a[32:39], v1
    ds_read_b128 v[96:99], v4 offset:14336
    v_smfmac_f32_16x16x64_bf16 v[52:55], v[32:35], a[40:47], v1
    ds_read_b128 v[100:103], v4 offset:15360
    s_waitcnt lgkmcnt(4)
    v_smfmac_f32_16x16x64_bf16 v[48:51], v[36:39], a[48:55], v1
    v_smfmac_f32_16x16x64_bf16 v[52:55], v[36:39], a[56:63], v1
    ds_read_b128 v[72:75], v4 offset:16384
    v_smfmac_f32_16x16x64_bf16 v[48:51], v[40:43], a[64:71], v1
    v_smfmac_f32_16x16x64_bf16 v[52:55], v[40:43], a[72:79], v1
    ds_read_b128 v[76:79], v4 offset:17408
    s_waitcnt lgkmcnt(2)
    v_smfmac_f32_16x16x64_bf16 v[48:51], v[44:47], v[88:95], v1
    ds_read_b128 v[80:83], v4 offset:18432
    v_smfmac_f32_16x16x64_bf16 v[52:55], v[44:47], v[96:103], v1
    ds_read_b128 v[84:87], v4 offset:19456
    v_smfmac_f32_16x16x64_bf16 v[56:59], v[28:31], a[96:103], v1
    ds_read_b128 v[88:91], v4 offset:20480
    v_smfmac_f32_16x16x64_bf16 v[60:63], v[28:31], a[104:111], v1
    ds_read_b128 v[92:95], v4 offset:21504
    v_smfmac_f32_16x16x64_bf16 v[56:59], v[32:35], a[112:119], v1
    ds_read_b128 v[96:99], v4 offset:22528
    v_add_f32 v48, v48, v50
    v_add_f32 v49, v49, v51
    v_smfmac_f32_16x16x64_bf16 v[60:63], v[32:35], a[120:127], v1
    ds_read_b128 v[100:103], v4 offset:23552
    v_add_f32 v52, v52, v54
    v_add_f32 v53, v53, v55
    v_smfmac_f32_16x16x64_bf16 v[56:59], v[36:39], a[128:135], v1
    s_waitcnt lgkmcnt(4)
    v_cvt_pk_bf16_f32 v50, v48, v52
    v_cvt_pk_bf16_f32 v51, v49, v53
    v_smfmac_f32_16x16x64_bf16 v[56:59], v[24:27], v[72:79], v1
    ds_write2_b32 v5, v50, v51 offset0:0 offset1:72
    v_smfmac_f32_16x16x64_bf16 v[60:63], v[24:27], v[80:87], v1
    v_smfmac_f32_16x16x64_bf16 v[60:63], v[36:39], a[136:143], v1
    v_smfmac_f32_16x16x64_bf16 v[56:59], v[40:43], a[144:151], v1
    buffer_store_dword v12, v10, s[8:11], s31 offen sc1
    v_smfmac_f32_16x16x64_bf16 v[60:63], v[40:43], a[152:159], v1
    s_waitcnt lgkmcnt(0)
    s_barrier
    v_smfmac_f32_16x16x64_bf16 v[56:59], v[44:47], v[88:95], v1
    ds_read_b128 v[72:75], v6 offset:0
    v_smfmac_f32_16x16x64_bf16 v[60:63], v[44:47], v[96:103], v1
    ds_read_b128 v[76:79], v6 offset:64
    v_smfmac_f32_16x16x64_bf16 v[64:67], v[24:27], a[192:199], v1
    ds_read_b128 v[80:83], v6 offset:128
    v_smfmac_f32_16x16x64_bf16 v[68:71], v[24:27], a[200:207], v1
    ds_read_b128 v[84:87], v6 offset:192
    s_waitcnt vmcnt(2) lgkmcnt(3)
    v_mfma_f32_16x16x32_bf16 v[48:51], v[104:107], v[72:75], 0
    s_waitcnt lgkmcnt(2)
    v_add_f32 v56, v56, v58
    v_add_f32 v57, v57, v59
    v_mfma_f32_16x16x32_bf16 v[48:51], v[108:111], v[76:79], v[48:51]
    s_waitcnt lgkmcnt(1)
    v_add_f32 v60, v60, v62
    v_add_f32 v61, v61, v63
    v_mfma_f32_16x16x32_bf16 v[48:51], v[112:115], v[80:83], v[48:51]
    s_waitcnt lgkmcnt(0)
    v_cvt_pk_bf16_f32 v58, v56, v60
    v_cvt_pk_bf16_f32 v59, v57, v61
    v_mfma_f32_16x16x32_bf16 v[48:51], v[116:119], v[84:87], v[48:51]
    ds_write2_b32 v7, v58, v59 offset0:0 offset1:72
    v_smfmac_f32_16x16x64_bf16 v[64:67], v[28:31], a[208:215], v1
    v_mov_b64 v[104:105], s[4:5]
    v_smfmac_f32_16x16x64_bf16 v[68:71], v[28:31], a[216:223], v1
    s_nop 1
    v_mov_b64 v[106:107], s[4:5]
    v_smfmac_f32_16x16x64_bf16 v[64:67], v[32:35], a[224:231], v1
    v_exp_f32 v48, v48
    v_smfmac_f32_16x16x64_bf16 v[68:71], v[32:35], a[232:239], v1
    s_waitcnt lgkmcnt(0)
    s_barrier
    v_exp_f32 v49, v49
    v_smfmac_f32_16x16x64_bf16 v[64:67], v[36:39], a[240:247], v1
    ds_read_b128 v[88:91], v6 offset:2304
    v_exp_f32 v50, v50
    v_smfmac_f32_16x16x64_bf16 v[68:71], v[36:39], a[248:255], v1
    ds_read_b128 v[92:95], v6 offset:2368
    v_exp_f32 v51, v51
    v_smfmac_f32_16x16x64_bf16 v[64:67], v[40:43], v[128:135], v1
    ds_read_b128 v[96:99], v6 offset:2432
    v_cvt_pk_bf16_f32 v108, v48, v49
    v_cvt_pk_bf16_f32 v109, v50, v51
    v_smfmac_f32_16x16x64_bf16 v[68:71], v[40:43], v[136:143], v1
    ds_read_b128 v[100:103], v6 offset:2496
    ds_write_b64 v2, v[108:109] offset:8192
    s_waitcnt lgkmcnt(4)
    v_mfma_f32_16x16x32_bf16 v[52:55], v[88:91], v[72:75], 0
    s_waitcnt lgkmcnt(3)
    v_mov_b32 v113, 0
    v_mov_b32 v115, 0
    v_mfma_f32_16x16x32_bf16 v[52:55], v[92:95], v[76:79], v[52:55]
    s_waitcnt lgkmcnt(2)
    v_mov_b32 v117, 0
    v_mov_b64 v[16:17], 0
    v_mfma_f32_16x16x32_bf16 v[52:55], v[96:99], v[80:83], v[52:55]
    s_waitcnt lgkmcnt(1)
    v_mov_b64 v[18:19], 0
    v_mov_b64 v[20:21], 0
    v_mfma_f32_16x16x32_bf16 v[52:55], v[100:103], v[84:87], v[52:55]
    s_waitcnt lgkmcnt(0)
    s_barrier
    v_smfmac_f32_16x16x64_bf16 v[64:67], v[44:47], v[144:151], v1
    ds_read_b64 v[110:111], v8 offset:8192
    v_mov_b64 v[22:23], 0
    v_smfmac_f32_16x16x64_bf16 v[68:71], v[44:47], v[152:159], v1
    v_mov_b64 v[24:25], 0
    v_mov_b64 v[26:27], 0
    v_mul_f32 v52, s33, v52
    v_mul_f32 v53, s33, v53
    v_exp_f32 v52, v52
    s_waitcnt lgkmcnt(0)
    v_mfma_f32_16x16x32_bf16 v[48:51], v[104:107], v[108:111], 0
    v_exp_f32 v53, v53
    v_add_f32 v64, v64, v66
    v_mfma_f32_16x16x32_bf16 v[56:59], v[120:123], v[108:111], 0
    v_cvt_pk_bf16_f32 v112, v52, v53
    v_add_f32 v65, v65, v67
    v_mfma_f32_16x16x32_bf16 v[60:63], v[124:127], v[108:111], 0
    v_cvt_pk_bf16_f32 v114, v64, v65
    v_add_f32 v68, v68, v70
    v_mfma_f32_16x16x16_bf16 v[48:51], v[104:105], v[112:113], v[48:51]
    v_add_f32 v69, v69, v71
    v_cvt_pk_bf16_f32 v116, v68, v69
    v_mfma_f32_16x16x16_bf16 v[56:59], v[114:115], v[112:113], v[56:59]
    v_mov_b64 v[28:29], 0
    v_mov_b64 v[30:31], 0
    v_mfma_f32_16x16x16_bf16 v[60:63], v[116:117], v[112:113], v[60:63]
    v_bitop3_b32 v32, v13, s96, -9 bitop3:0x28
    v_bitop3_b32 v36, v13, s97, -9 bitop3:0x28
    v_rcp_f32 v118, v48
    v_bitop3_b32 v40, v13, s98, -9 bitop3:0x28
    v_max_f32 v14, v118, v48
    v_cmp_nge_f32 vcc, s40, v14
    v_pk_mul_f32 v[56:57], v[56:57], v[118:119] op_sel_hi:[1,0]
    v_pk_mul_f32 v[58:59], v[58:59], v[118:119] op_sel_hi:[1,0]
    v_pk_mul_f32 v[60:61], v[60:61], v[118:119] op_sel_hi:[1,0]
    v_pk_mul_f32 v[62:63], v[62:63], v[118:119] op_sel_hi:[1,0]
    v_cvt_pk_bf16_f32 v52, v56, v60
    v_cvt_pk_bf16_f32 v54, v58, v62
    v_cvt_pk_bf16_f32 v53, v57, v61
    v_cvt_pk_bf16_f32 v55, v59, v63
L_fast_rejoin:
    v_cndmask_b32 v50, v52, v54, s[92:93]
    v_cndmask_b32 v51, v53, v55, s[92:93]
    ds_write_b64 v13, v[50:51] offset:9216
    v_smfmac_f32_16x16x64_bf16 v[16:19], v[52:55], v[160:167], v1
    v_smfmac_f32_16x16x64_bf16 v[20:23], v[52:55], v[168:175], v1
    s_waitcnt lgkmcnt(0)
    s_barrier
    ds_read_b128 v[32:35], v32 offset:9216
    ds_read_b128 v[36:39], v36 offset:9216
    v_smfmac_f32_16x16x64_bf16 v[24:27], v[52:55], v[176:183], v1
    ds_read_b128 v[40:43], v40 offset:9216
    v_smfmac_f32_16x16x64_bf16 v[28:31], v[52:55], v[184:191], v1
    ds_read_b128 v[88:91], v4 offset:24576
    ds_read_b128 v[92:95], v4 offset:25600
    s_waitcnt lgkmcnt(4)
    v_smfmac_f32_16x16x64_bf16 v[16:19], v[32:35], v[192:199], v1
    ds_read_b128 v[96:99], v4 offset:26624
    s_waitcnt lgkmcnt(4)
    v_smfmac_f32_16x16x64_bf16 v[16:19], v[36:39], v[216:223], v1
    ds_read_b128 v[100:103], v4 offset:27648
    s_waitcnt lgkmcnt(4)
    v_smfmac_f32_16x16x64_bf16 v[16:19], v[40:43], v[240:247], v1
    ds_read_b128 v[72:75], v4 offset:28672
    s_cmp_lg_u64 vcc, 0
    v_smfmac_f32_16x16x64_bf16 v[20:23], v[32:35], v[200:207], v1
    ds_read_b128 v[76:79], v4 offset:29696
    s_cselect_b32 s60, s28, s27
    v_smfmac_f32_16x16x64_bf16 v[20:23], v[36:39], v[224:231], v1
    ds_read_b128 v[80:83], v4 offset:30720
    s_nop 0
    v_cvt_pk_bf16_f32 v56, v16, v18
    v_smfmac_f32_16x16x64_bf16 v[20:23], v[40:43], v[248:255], v1
    ds_read_b128 v[84:87], v4 offset:31744
    v_cvt_pk_bf16_f32 v57, v17, v19
    v_and_or_b32 v56, v56, -2, s60
    v_smfmac_f32_16x16x64_bf16 v[24:27], v[32:35], v[208:215], v1
    buffer_store_dwordx2 v[56:57], v9, s[8:11], 0 offen offset:0
    v_smfmac_f32_16x16x64_bf16 v[24:27], v[36:39], v[232:239], v1
    s_waitcnt lgkmcnt(4)
    s_nop 0
    v_cvt_pk_bf16_f32 v58, v20, v22
    v_smfmac_f32_16x16x64_bf16 v[24:27], v[40:43], v[88:95], v1
    ds_read_b128 v[64:67], v3 offset:23040
    v_cvt_pk_bf16_f32 v59, v21, v23
    v_and_or_b32 v58, v58, -2, s60
    v_smfmac_f32_16x16x64_bf16 v[28:31], v[32:35], v[96:103], v1
    buffer_store_dwordx2 v[58:59], v9, s[8:11], 0 offen offset:2048
    s_waitcnt lgkmcnt(1)
    v_smfmac_f32_16x16x64_bf16 v[28:31], v[36:39], v[72:79], v1
    s_nop 1
    v_cvt_pk_bf16_f32 v60, v24, v26
    v_smfmac_f32_16x16x64_bf16 v[28:31], v[40:43], v[80:87], v1
    s_nop 2
    v_cvt_pk_bf16_f32 v61, v25, v27
    v_and_or_b32 v60, v60, -2, s60
    buffer_store_dwordx2 v[60:61], v9, s[8:11], s26 offen offset:0
    s_nop 1
    v_cvt_pk_bf16_f32 v62, v28, v30
    v_cvt_pk_bf16_f32 v63, v29, v31
    v_and_or_b32 v62, v62, -2, s60
    buffer_store_dwordx2 v[62:63], v9, s[8:11], s26 offen offset:2048
L_fast_stored:
    s_cmp_lg_u32 s60, s27
    s_cbranch_scc1 L_fast_safe
    ds_read_b128 v[104:107], v4 offset:0
    ds_read_b128 v[108:111], v4 offset:1024
    ds_read_b128 v[112:115], v4 offset:2048
    ds_read_b128 v[116:119], v4 offset:3072
    ds_read_b128 v[88:91], v4 offset:4096
    ds_read_b128 v[92:95], v4 offset:5120
    ds_read_b128 v[96:99], v4 offset:6144
    ds_read_b128 v[100:103], v4 offset:7168
    ds_read_b128 v[72:75], v4 offset:8192
    ds_read_b128 v[76:79], v4 offset:9216
    ds_read_b128 v[80:83], v4 offset:10240
    ds_read_b128 v[84:87], v4 offset:11264
    s_cmp_lt_u32 s21, 1
    s_cbranch_scc1 L_fast_pollp
    s_nop 13
    s_cmp_lt_u32 s21, 2
    s_cbranch_scc1 L_fast_pollp
    s_nop 13
    s_cmp_lt_u32 s21, 3
    s_cbranch_scc1 L_fast_pollp
    s_nop 13
L_fast_pollp:
    buffer_load_dwordx4 v[120:123], v2, s[8:11], s6 offen sc1
    buffer_load_dwordx4 v[124:127], v2, s[8:11], s6 offen offset:1024 sc1
    v_mov_b64 v[56:57], 0
    v_mov_b64 v[58:59], 0
    v_mov_b64 v[60:61], 0
    v_mov_b64 v[62:63], 0
    s_nop 15
    s_nop 15
    buffer_load_dwordx4 v[32:35], v2, s[8:11], s6 offen sc1
    buffer_load_dwordx4 v[36:39], v2, s[8:11], s6 offen offset:1024 sc1
L_fast_prep:
    s_add_u32 s7, s24, 0x80000
    s_waitcnt vmcnt(3) lgkmcnt(0)
    v_mfma_f32_16x16x32_bf16 v[68:71], v[64:67], v[120:123], 0
    v_bitop3_b32 v14, v120, v122, s27 bitop3:0x7e
    s_waitcnt vmcnt(2)
    v_mfma_f32_16x16x32_bf16 v[68:71], v[64:67], v[124:127], v[68:71]
    v_bitop3_b32 v11, v124, v126, s27 bitop3:0x7e
    v_bitop3_b32 v14, v14, v11, 1 bitop3:0xa8
    v_cmp_ne_u32 vcc, 0, v14
    s_nop 2
    s_cmp_eq_u64 vcc, 0
    s_cselect_b32 s36, s24, s61
    v_add_f32_dpp v68, v68, v68 row_ror:8 row_mask:0xf bank_mask:0xf
    v_add_f32_dpp v69, v69, v69 row_ror:8 row_mask:0xf bank_mask:0xf
    s_nop 0
    v_add_f32_dpp v68, v68, v68 row_ror:4 row_mask:0xf bank_mask:0xf
    v_add_f32_dpp v69, v69, v69 row_ror:4 row_mask:0xf bank_mask:0xf
    v_cvt_pk_bf16_f32 v12, v68, v69
    buffer_store_dword v12, v10, s[8:11], s36 offen
    s_cbranch_scc1 L_fast_gotp
L_fast_retryp:
    buffer_load_dwordx4 v[120:123], v2, s[8:11], s6 offen sc1
    buffer_load_dwordx4 v[124:127], v2, s[8:11], s6 offen offset:1024 sc1
    s_waitcnt vmcnt(4) lgkmcnt(0)
    v_mfma_f32_16x16x32_bf16 v[68:71], v[64:67], v[32:35], 0
    v_bitop3_b32 v14, v32, v34, s27 bitop3:0x7e
    s_waitcnt vmcnt(3)
    v_mfma_f32_16x16x32_bf16 v[68:71], v[64:67], v[36:39], v[68:71]
    v_bitop3_b32 v11, v36, v38, s27 bitop3:0x7e
    v_bitop3_b32 v14, v14, v11, 1 bitop3:0xa8
    v_cmp_ne_u32 vcc, 0, v14
    s_nop 2
    s_cmp_eq_u64 vcc, 0
    s_cselect_b32 s36, s24, s61
    v_add_f32_dpp v68, v68, v68 row_ror:8 row_mask:0xf bank_mask:0xf
    v_add_f32_dpp v69, v69, v69 row_ror:8 row_mask:0xf bank_mask:0xf
    s_nop 0
    v_add_f32_dpp v68, v68, v68 row_ror:4 row_mask:0xf bank_mask:0xf
    v_add_f32_dpp v69, v69, v69 row_ror:4 row_mask:0xf bank_mask:0xf
    v_cvt_pk_bf16_f32 v12, v68, v69
    buffer_store_dword v12, v10, s[8:11], s36 offen
    s_cbranch_scc1 L_fast_gotp
    buffer_load_dwordx4 v[32:35], v2, s[8:11], s6 offen sc1
    buffer_load_dwordx4 v[36:39], v2, s[8:11], s6 offen offset:1024 sc1
    s_waitcnt vmcnt(4) lgkmcnt(0)
    v_mfma_f32_16x16x32_bf16 v[68:71], v[64:67], v[120:123], 0
    v_bitop3_b32 v14, v120, v122, s27 bitop3:0x7e
    s_waitcnt vmcnt(3)
    v_mfma_f32_16x16x32_bf16 v[68:71], v[64:67], v[124:127], v[68:71]
    v_bitop3_b32 v11, v124, v126, s27 bitop3:0x7e
    v_bitop3_b32 v14, v14, v11, 1 bitop3:0xa8
    v_cmp_ne_u32 vcc, 0, v14
    s_nop 2
    s_cmp_eq_u64 vcc, 0
    s_cselect_b32 s36, s24, s61
    v_add_f32_dpp v68, v68, v68 row_ror:8 row_mask:0xf bank_mask:0xf
    v_add_f32_dpp v69, v69, v69 row_ror:8 row_mask:0xf bank_mask:0xf
    s_nop 0
    v_add_f32_dpp v68, v68, v68 row_ror:4 row_mask:0xf bank_mask:0xf
    v_add_f32_dpp v69, v69, v69 row_ror:4 row_mask:0xf bank_mask:0xf
    v_cvt_pk_bf16_f32 v12, v68, v69
    buffer_store_dword v12, v10, s[8:11], s36 offen
    s_cbranch_scc1 L_fast_gotp
    s_add_u32 s32, s32, 1
    s_cmp_le_u32 s32, 200000
    s_cbranch_scc1 L_fast_retryp
    s_mov_b32 s36, s24
    buffer_store_dword v12, v10, s[8:11], s36 offen
L_fast_gotp:
    s_add_u32 s31, s31, 0x2000
    s_cmp_ge_u32 s90, 63
    s_cbranch_scc1 L_fast_last
    s_mov_b32 s23, s24
    s_mov_b32 s22, s90
    s_mov_b32 s27, s28
    v_mov_b64 v[64:65], 0
    v_mov_b64 v[66:67], 0
    v_mov_b64 v[68:69], 0
    v_mov_b64 v[70:71], 0
    s_nop 15
    s_nop 11
    buffer_load_dwordx4 v[16:19], v2, s[8:11], s7 offen sc1
    buffer_load_dwordx4 v[20:23], v2, s[8:11], s7 offen offset:1024 sc1
    s_branch L_fast_step
L_fast_last:
    buffer_store_dword v12, v10, s[8:11], s31 offen sc1
    s_branch L_fast_done
L_fast_refresh:
    buffer_load_dword v15, v0, s[8:11], s23 offen sc1
    s_add_u32 s32, s32, 1
    s_cmp_le_u32 s32, 200000
    s_waitcnt vmcnt(0)
    s_cbranch_scc1 L_fast_step
    s_branch L_fast_fresh
L_fast_safe:
    s_nop 11
    s_waitcnt vmcnt(0) lgkmcnt(0)
    s_barrier
    ds_read_b128 v[72:75], v6 offset:0
    ds_read_b128 v[88:91], v6 offset:2304
    ds_read_b128 v[76:79], v6 offset:64
    ds_read_b128 v[92:95], v6 offset:2368
    ds_read_b128 v[80:83], v6 offset:128
    ds_read_b128 v[96:99], v6 offset:2432
    ds_read_b128 v[84:87], v6 offset:192
    ds_read_b128 v[100:103], v6 offset:2496
    s_xor_b32 s36, s25, 0x1000
    s_add_u32 s36, s36, s23
    buffer_load_dwordx4 v[16:19], v3, s[8:11], s29 offen offset:0 sc1
    buffer_load_dwordx4 v[32:35], v3, s[8:11], s36 offen offset:0 sc1
    buffer_load_dwordx4 v[20:23], v3, s[8:11], s29 offen offset:1024 sc1
    buffer_load_dwordx4 v[36:39], v3, s[8:11], s36 offen offset:1024 sc1
    buffer_load_dwordx4 v[24:27], v3, s[8:11], s29 offen offset:2048 sc1
    buffer_load_dwordx4 v[40:43], v3, s[8:11], s36 offen offset:2048 sc1
    buffer_load_dwordx4 v[28:31], v3, s[8:11], s29 offen offset:3072 sc1
    buffer_load_dwordx4 v[44:47], v3, s[8:11], s36 offen offset:3072 sc1
    s_waitcnt vmcnt(0) lgkmcnt(0)
    v_mfma_f32_16x16x32_bf16 v[48:51], v[16:19], v[72:75], 0
    v_mfma_f32_16x16x32_bf16 v[48:51], v[20:23], v[76:79], v[48:51]
    v_mfma_f32_16x16x32_bf16 v[48:51], v[24:27], v[80:83], v[48:51]
    v_mfma_f32_16x16x32_bf16 v[48:51], v[28:31], v[84:87], v[48:51]
    v_mfma_f32_16x16x32_bf16 v[52:55], v[32:35], v[72:75], 0
    v_mfma_f32_16x16x32_bf16 v[52:55], v[36:39], v[76:79], v[52:55]
    v_mfma_f32_16x16x32_bf16 v[52:55], v[40:43], v[80:83], v[52:55]
    v_mfma_f32_16x16x32_bf16 v[52:55], v[44:47], v[84:87], v[52:55]
    v_mfma_f32_16x16x32_bf16 v[56:59], v[88:91], v[72:75], 0
    v_mfma_f32_16x16x32_bf16 v[56:59], v[92:95], v[76:79], v[56:59]
    v_mfma_f32_16x16x32_bf16 v[56:59], v[96:99], v[80:83], v[56:59]
    v_mfma_f32_16x16x32_bf16 v[56:59], v[100:103], v[84:87], v[56:59]
    s_nop 7
    v_mul_f32 v56, s33, v56
    v_mul_f32 v57, s33, v57
    v_max3_f32 v16, v48, v49, v50
    v_max3_f32 v16, v16, v51, v52
    v_max3_f32 v16, v16, v53, v54
    v_max3_f32 v16, v16, v55, v56
    v_max_f32 v16, v16, v57
    v_mov_b32 v17, v16
    s_nop 1
    v_permlane16_swap_b32 v16, v17
    v_max_f32 v16, v16, v17
    v_mov_b32 v17, v16
    s_nop 1
    v_permlane32_swap_b32 v16, v17
    v_max_f32 v16, v16, v17
    v_sub_f32 v48, v48, v16
    v_exp_f32 v48, v48
    v_sub_f32 v49, v49, v16
    v_exp_f32 v49, v49
    v_sub_f32 v50, v50, v16
    v_exp_f32 v50, v50
    v_sub_f32 v51, v51, v16
    v_exp_f32 v51, v51
    v_sub_f32 v52, v52, v16
    v_exp_f32 v52, v52
    v_sub_f32 v53, v53, v16
    v_exp_f32 v53, v53
    v_sub_f32 v54, v54, v16
    v_exp_f32 v54, v54
    v_sub_f32 v55, v55, v16
    v_exp_f32 v55, v55
    v_sub_f32 v56, v56, v16
    v_exp_f32 v56, v56
    v_sub_f32 v57, v57, v16
    v_exp_f32 v57, v57
    v_cvt_pk_bf16_f32 v108, v48, v49
    v_cvt_pk_bf16_f32 v109, v50, v51
    v_cvt_pk_bf16_f32 v110, v52, v53
    v_cvt_pk_bf16_f32 v111, v54, v55
    v_cvt_pk_bf16_f32 v112, v56, v57
    s_nop 0
    v_mfma_f32_16x16x32_bf16 v[48:51], v[104:107], v[108:111], 0
    v_mfma_f32_16x16x32_bf16 v[56:59], v[120:123], v[108:111], 0
    v_mfma_f32_16x16x32_bf16 v[60:63], v[124:127], v[108:111], 0
    s_nop 3
    v_mfma_f32_16x16x16_bf16 v[48:51], v[104:105], v[112:113], v[48:51]
    v_mfma_f32_16x16x16_bf16 v[56:59], v[114:115], v[112:113], v[56:59]
    v_mfma_f32_16x16x16_bf16 v[60:63], v[116:117], v[112:113], v[60:63]
    s_nop 5
    v_rcp_f32 v118, v48
    s_nop 0
    v_mul_f32 v56, v56, v118
    v_mul_f32 v57, v57, v118
    v_mul_f32 v58, v58, v118
    v_mul_f32 v59, v59, v118
    v_mul_f32 v60, v60, v118
    v_mul_f32 v61, v61, v118
    v_mul_f32 v62, v62, v118
    v_mul_f32 v63, v63, v118
    v_cvt_pk_bf16_f32 v52, v56, v60
    v_cvt_pk_bf16_f32 v53, v57, v61
    v_cvt_pk_bf16_f32 v54, v58, v62
    v_cvt_pk_bf16_f32 v55, v59, v63
    v_mov_b32 v16, 0
    v_mov_b32 v17, 0
    v_mov_b32 v18, 0
    v_mov_b32 v19, 0
    v_mov_b32 v20, 0
    v_mov_b32 v21, 0
    v_mov_b32 v22, 0
    v_mov_b32 v23, 0
    v_mov_b32 v24, 0
    v_mov_b32 v25, 0
    v_mov_b32 v26, 0
    v_mov_b32 v27, 0
    v_mov_b32 v28, 0
    v_mov_b32 v29, 0
    v_mov_b32 v30, 0
    v_mov_b32 v31, 0
    v_bitop3_b32 v32, v13, s96, -9 bitop3:0x28
    v_bitop3_b32 v36, v13, s97, -9 bitop3:0x28
    v_bitop3_b32 v40, v13, s98, -9 bitop3:0x28
    s_mov_b64 vcc, 0
    s_branch L_fast_rejoin
L_fast_done:
    s_branch L_end
L_slow_start:
    s_mov_b32 s22, 0
    s_mov_b32 s23, 0x1000000
    s_mov_b32 s27, 0
    s_mov_b32 s31, 0x80000
    s_mov_b32 s61, 0x40000000
    s_mov_b32 s96, 0x800
    s_mov_b32 s97, 0x1000
    s_mov_b32 s98, 0x1800
    s_mov_b32 s92, 0xcccccccc
    s_mov_b32 s93, 0xcccccccc
    s_mov_b32 s91, 0
    ds_read_b128 v[104:107], v4 offset:0
    ds_read_b128 v[108:111], v4 offset:1024
    ds_read_b128 v[112:115], v4 offset:2048
    ds_read_b128 v[116:119], v4 offset:3072
    ds_read_b128 v[88:91], v4 offset:4096
    ds_read_b128 v[92:95], v4 offset:5120
    ds_read_b128 v[96:99], v4 offset:6144
    ds_read_b128 v[100:103], v4 offset:7168
    ds_read_b128 v[72:75], v4 offset:8192
    ds_read_b128 v[76:79], v4 offset:9216
    ds_read_b128 v[80:83], v4 offset:10240
    ds_read_b128 v[84:87], v4 offset:11264
    v_mov_b64 v[48:49], 0
    v_mov_b64 v[50:51], 0
    v_mov_b64 v[52:53], 0
    v_mov_b64 v[54:55], 0
    v_mov_b64 v[56:57], 0
    v_mov_b64 v[58:59], 0
    v_mov_b64 v[60:61], 0
    v_mov_b64 v[62:63], 0
    v_mov_b64 v[64:65], 0
    v_mov_b64 v[66:67], 0
    v_mov_b64 v[68:69], 0
    v_mov_b64 v[70:71], 0
    s_add_u32 s7, s23, 0x80000
    buffer_load_dwordx4 v[16:19], v2, s[8:11], s7 offen sc1
    buffer_load_dwordx4 v[20:23], v2, s[8:11], s7 offen offset:1024 sc1
    s_waitcnt vmcnt(2)
L_slow_step:
    v_readlane_b32 s36, v15, 33
    s_add_u32 s24, s23, 0x82100
    s_cmp_eq_u32 s36, 0
    s_cbranch_scc1 L_slow_refresh
L_slow_fresh:
    s_add_u32 s29, s23, s25
    s_add_u32 s30, s23, s39
    s_xor_b32 s28, s27, 1
    s_add_u32 s90, s22, 1
    s_nop 15
L_slow_retrym:
    buffer_load_dwordx4 v[16:19], v2, s[8:11], s7 offen sc1
    buffer_load_dwordx4 v[20:23], v2, s[8:11], s7 offen offset:1024 sc1
L_slow_prem:
    s_add_u32 s32, s32, 1
    s_cmp_gt_u32 s32, 200000
    s_cselect_b32 s94, -1, -2
    v_xor_b32 v28, 0x800, v2
    v_xor_b32 v44, 0x1800, v2
    v_mov_b64 v[48:49], 0
    v_mov_b64 v[50:51], 0
    v_mov_b64 v[52:53], 0
    v_mov_b64 v[54:55], 0
L_slow_waitm:
    s_waitcnt vmcnt(3) lgkmcnt(0)
L_slow_gotm:
    v_max3_u32 v14, v16, v17, v18
    v_max_u32 v14, v14, v19
    v_smfmac_f32_16x16x64_bf16 v[48:51], v[16:19], v[104:111], v1
    s_waitcnt vmcnt(2)
    v_max3_u32 v14, v14, v20, v21
    v_smfmac_f32_16x16x64_bf16 v[52:55], v[16:19], v[112:119], v1
    v_max3_u32 v14, v14, v22, v23
    v_cmp_lt_u32 vcc, s94, v14
    v_smfmac_f32_16x16x64_bf16 v[48:51], v[20:23], v[88:95], v1
    ds_write_b128 v2, v[16:19] offset:0
    s_cbranch_vccnz L_slow_retrym
    v_smfmac_f32_16x16x64_bf16 v[52:55], v[20:23], v[96:103], v1
    ds_write_b128 v2, v[20:23] offset:1024
    v_smfmac_f32_16x16x64_bf16 v[56:59], v[16:19], v[72:79], v1
    buffer_load_dwordx4 v[104:107], v3, s[8:11], s29 offen offset:0 sc1
    buffer_load_dwordx4 v[120:123], v3, s[8:11], s30 offen offset:0 sc1
    v_smfmac_f32_16x16x64_bf16 v[60:63], v[16:19], v[80:87], v1
    buffer_load_dwordx4 v[108:111], v3, s[8:11], s29 offen offset:1024 sc1
    buffer_load_dwordx4 v[124:127], v3, s[8:11], s30 offen offset:1024 sc1
    v_smfmac_f32_16x16x64_bf16 v[56:59], v[20:23], a[80:87], v1
    buffer_load_dwordx4 v[112:115], v3, s[8:11], s29 offen offset:2048 sc1
    buffer_load_dwordx4 v[116:119], v3, s[8:11], s29 offen offset:3072 sc1
    v_smfmac_f32_16x16x64_bf16 v[60:63], v[20:23], a[88:95], v1
    s_waitcnt lgkmcnt(0)
    s_barrier
    ds_read_b128 v[24:27], v28 offset:0
    v_smfmac_f32_16x16x64_bf16 v[64:67], v[16:19], a[160:167], v1
    ds_read_b128 v[28:31], v28 offset:1024
    v_smfmac_f32_16x16x64_bf16 v[68:71], v[16:19], a[168:175], v1
    buffer_load_dword v15, v0, s[8:11], s24 offen sc1
    v_smfmac_f32_16x16x64_bf16 v[64:67], v[20:23], a[176:183], v1
    ds_read_b128 v[32:35], v8 offset:0
    v_smfmac_f32_16x16x64_bf16 v[68:71], v[20:23], a[184:191], v1
    ds_read_b128 v[36:39], v8 offset:1024
    s_waitcnt lgkmcnt(3)
    v_smfmac_f32_16x16x64_bf16 v[48:51], v[24:27], a[0:7], v1
    ds_read_b128 v[40:43], v44 offset:0
    v_smfmac_f32_16x16x64_bf16 v[52:55], v[24:27], a[8:15], v1
    ds_read_b128 v[44:47], v44 offset:1024
    s_waitcnt lgkmcnt(4)
    v_smfmac_f32_16x16x64_bf16 v[48:51], v[28:31], a[16:23], v1
    ds_read_b128 v[88:91], v4 offset:12288
    v_smfmac_f32_16x16x64_bf16 v[52:55], v[28:31], a[24:31], v1
    ds_read_b128 v[92:95], v4 offset:13312
    s_waitcnt lgkmcnt(4)
    v_smfmac_f32_16x16x64_bf16 v[48:51], v[32:35], a[32:39], v1
    ds_read_b128 v[96:99], v4 offset:14336
    v_smfmac_f32_16x16x64_bf16 v[52:55], v[32:35], a[40:47], v1
    ds_read_b128 v[100:103], v4 offset:15360
    s_waitcnt lgkmcnt(4)
    v_smfmac_f32_16x16x64_bf16 v[48:51], v[36:39], a[48:55], v1
    v_smfmac_f32_16x16x64_bf16 v[52:55], v[36:39], a[56:63], v1
    ds_read_b128 v[72:75], v4 offset:16384
    v_smfmac_f32_16x16x64_bf16 v[48:51], v[40:43], a[64:71], v1
    v_smfmac_f32_16x16x64_bf16 v[52:55], v[40:43], a[72:79], v1
    ds_read_b128 v[76:79], v4 offset:17408
    s_waitcnt lgkmcnt(2)
    v_smfmac_f32_16x16x64_bf16 v[48:51], v[44:47], v[88:95], v1
    ds_read_b128 v[80:83], v4 offset:18432
    v_smfmac_f32_16x16x64_bf16 v[52:55], v[44:47], v[96:103], v1
    ds_read_b128 v[84:87], v4 offset:19456
    v_smfmac_f32_16x16x64_bf16 v[56:59], v[28:31], a[96:103], v1
    ds_read_b128 v[88:91], v4 offset:20480
    v_smfmac_f32_16x16x64_bf16 v[60:63], v[28:31], a[104:111], v1
    ds_read_b128 v[92:95], v4 offset:21504
    v_smfmac_f32_16x16x64_bf16 v[56:59], v[32:35], a[112:119], v1
    ds_read_b128 v[96:99], v4 offset:22528
    v_add_f32 v48, v48, v50
    v_add_f32 v49, v49, v51
    v_smfmac_f32_16x16x64_bf16 v[60:63], v[32:35], a[120:127], v1
    ds_read_b128 v[100:103], v4 offset:23552
    v_add_f32 v52, v52, v54
    v_add_f32 v53, v53, v55
    v_smfmac_f32_16x16x64_bf16 v[56:59], v[36:39], a[128:135], v1
    s_waitcnt lgkmcnt(4)
    v_cvt_pk_bf16_f32 v50, v48, v52
    v_cvt_pk_bf16_f32 v51, v49, v53
    v_smfmac_f32_16x16x64_bf16 v[56:59], v[24:27], v[72:79], v1
    ds_write2_b32 v5, v50, v51 offset0:0 offset1:72
    v_smfmac_f32_16x16x64_bf16 v[60:63], v[24:27], v[80:87], v1
    v_smfmac_f32_16x16x64_bf16 v[60:63], v[36:39], a[136:143], v1
    v_smfmac_f32_16x16x64_bf16 v[56:59], v[40:43], a[144:151], v1
    buffer_store_dword v12, v10, s[8:11], s31 offen sc1
    v_smfmac_f32_16x16x64_bf16 v[60:63], v[40:43], a[152:159], v1
    s_waitcnt lgkmcnt(0)
    s_barrier
    v_smfmac_f32_16x16x64_bf16 v[56:59], v[44:47], v[88:95], v1
    ds_read_b128 v[72:75], v6 offset:0
    v_smfmac_f32_16x16x64_bf16 v[60:63], v[44:47], v[96:103], v1
    ds_read_b128 v[76:79], v6 offset:64
    v_smfmac_f32_16x16x64_bf16 v[64:67], v[24:27], a[192:199], v1
    ds_read_b128 v[80:83], v6 offset:128
    v_smfmac_f32_16x16x64_bf16 v[68:71], v[24:27], a[200:207], v1
    ds_read_b128 v[84:87], v6 offset:192
    s_waitcnt vmcnt(2) lgkmcnt(3)
    v_mfma_f32_16x16x32_bf16 v[48:51], v[104:107], v[72:75], 0
    s_waitcnt lgkmcnt(2)
    v_add_f32 v56, v56, v58
    v_add_f32 v57, v57, v59
    v_mfma_f32_16x16x32_bf16 v[48:51], v[108:111], v[76:79], v[48:51]
    s_waitcnt lgkmcnt(1)
    v_add_f32 v60, v60, v62
    v_add_f32 v61, v61, v63
    v_mfma_f32_16x16x32_bf16 v[48:51], v[112:115], v[80:83], v[48:51]
    s_waitcnt lgkmcnt(0)
    v_cvt_pk_bf16_f32 v58, v56, v60
    v_cvt_pk_bf16_f32 v59, v57, v61
    v_mfma_f32_16x16x32_bf16 v[48:51], v[116:119], v[84:87], v[48:51]
    ds_write2_b32 v7, v58, v59 offset0:0 offset1:72
    v_smfmac_f32_16x16x64_bf16 v[64:67], v[28:31], a[208:215], v1
    v_mov_b64 v[104:105], s[4:5]
    v_smfmac_f32_16x16x64_bf16 v[68:71], v[28:31], a[216:223], v1
    s_nop 1
    v_mov_b64 v[106:107], s[4:5]
    v_smfmac_f32_16x16x64_bf16 v[64:67], v[32:35], a[224:231], v1
    v_exp_f32 v48, v48
    v_smfmac_f32_16x16x64_bf16 v[68:71], v[32:35], a[232:239], v1
    s_waitcnt lgkmcnt(0)
    s_barrier
    v_exp_f32 v49, v49
    v_smfmac_f32_16x16x64_bf16 v[64:67], v[36:39], a[240:247], v1
    ds_read_b128 v[88:91], v6 offset:2304
    v_exp_f32 v50, v50
    v_smfmac_f32_16x16x64_bf16 v[68:71], v[36:39], a[248:255], v1
    ds_read_b128 v[92:95], v6 offset:2368
    v_exp_f32 v51, v51
    v_smfmac_f32_16x16x64_bf16 v[64:67], v[40:43], v[128:135], v1
    ds_read_b128 v[96:99], v6 offset:2432
    v_cvt_pk_bf16_f32 v108, v48, v49
    v_cvt_pk_bf16_f32 v109, v50, v51
    v_smfmac_f32_16x16x64_bf16 v[68:71], v[40:43], v[136:143], v1
    ds_read_b128 v[100:103], v6 offset:2496
    ds_write_b64 v2, v[108:109] offset:8192
    s_waitcnt lgkmcnt(4)
    v_mfma_f32_16x16x32_bf16 v[52:55], v[88:91], v[72:75], 0
    s_waitcnt lgkmcnt(3)
    v_mov_b32 v113, 0
    v_mov_b32 v115, 0
    v_mfma_f32_16x16x32_bf16 v[52:55], v[92:95], v[76:79], v[52:55]
    s_waitcnt lgkmcnt(2)
    v_mov_b32 v117, 0
    v_mov_b64 v[16:17], 0
    v_mfma_f32_16x16x32_bf16 v[52:55], v[96:99], v[80:83], v[52:55]
    s_waitcnt lgkmcnt(1)
    v_mov_b64 v[18:19], 0
    v_mov_b64 v[20:21], 0
    v_mfma_f32_16x16x32_bf16 v[52:55], v[100:103], v[84:87], v[52:55]
    s_waitcnt lgkmcnt(0)
    s_barrier
    v_smfmac_f32_16x16x64_bf16 v[64:67], v[44:47], v[144:151], v1
    ds_read_b64 v[110:111], v8 offset:8192
    v_mov_b64 v[22:23], 0
    v_smfmac_f32_16x16x64_bf16 v[68:71], v[44:47], v[152:159], v1
    v_mov_b64 v[24:25], 0
    v_mov_b64 v[26:27], 0
    v_mul_f32 v52, s33, v52
    v_mul_f32 v53, s33, v53
    v_exp_f32 v52, v52
    s_waitcnt lgkmcnt(0)
    v_mfma_f32_16x16x32_bf16 v[48:51], v[104:107], v[108:111], 0
    v_exp_f32 v53, v53
    v_add_f32 v64, v64, v66
    v_mfma_f32_16x16x32_bf16 v[56:59], v[120:123], v[108:111], 0
    v_cvt_pk_bf16_f32 v112, v52, v53
    v_add_f32 v65, v65, v67
    v_mfma_f32_16x16x32_bf16 v[60:63], v[124:127], v[108:111], 0
    v_cvt_pk_bf16_f32 v114, v64, v65
    v_add_f32 v68, v68, v70
    v_mfma_f32_16x16x16_bf16 v[48:51], v[104:105], v[112:113], v[48:51]
    v_add_f32 v69, v69, v71
    v_cvt_pk_bf16_f32 v116, v68, v69
    v_mfma_f32_16x16x16_bf16 v[56:59], v[114:115], v[112:113], v[56:59]
    v_mov_b64 v[28:29], 0
    v_mov_b64 v[30:31], 0
    v_mfma_f32_16x16x16_bf16 v[60:63], v[116:117], v[112:113], v[60:63]
    v_bitop3_b32 v32, v13, s96, -9 bitop3:0x28
    v_bitop3_b32 v36, v13, s97, -9 bitop3:0x28
    v_rcp_f32 v118, v48
    v_bitop3_b32 v40, v13, s98, -9 bitop3:0x28
    v_max_f32 v14, v118, v48
    v_cmp_nge_f32 vcc, s40, v14
    v_pk_mul_f32 v[56:57], v[56:57], v[118:119] op_sel_hi:[1,0]
    v_pk_mul_f32 v[58:59], v[58:59], v[118:119] op_sel_hi:[1,0]
    v_pk_mul_f32 v[60:61], v[60:61], v[118:119] op_sel_hi:[1,0]
    v_pk_mul_f32 v[62:63], v[62:63], v[118:119] op_sel_hi:[1,0]
    v_cvt_pk_bf16_f32 v52, v56, v60
    v_cvt_pk_bf16_f32 v54, v58, v62
    v_cvt_pk_bf16_f32 v53, v57, v61
    v_cvt_pk_bf16_f32 v55, v59, v63
L_slow_rejoin:
    v_cndmask_b32 v50, v52, v54, s[92:93]
    v_cndmask_b32 v51, v53, v55, s[92:93]
    ds_write_b64 v13, v[50:51] offset:9216
    v_smfmac_f32_16x16x64_bf16 v[16:19], v[52:55], v[160:167], v1
    v_smfmac_f32_16x16x64_bf16 v[20:23], v[52:55], v[168:175], v1
    s_waitcnt lgkmcnt(0)
    s_barrier
    ds_read_b128 v[32:35], v32 offset:9216
    ds_read_b128 v[36:39], v36 offset:9216
    v_smfmac_f32_16x16x64_bf16 v[24:27], v[52:55], v[176:183], v1
    ds_read_b128 v[40:43], v40 offset:9216
    v_smfmac_f32_16x16x64_bf16 v[28:31], v[52:55], v[184:191], v1
    ds_read_b128 v[88:91], v4 offset:24576
    ds_read_b128 v[92:95], v4 offset:25600
    s_waitcnt lgkmcnt(4)
    v_smfmac_f32_16x16x64_bf16 v[16:19], v[32:35], v[192:199], v1
    ds_read_b128 v[96:99], v4 offset:26624
    s_waitcnt lgkmcnt(4)
    v_smfmac_f32_16x16x64_bf16 v[16:19], v[36:39], v[216:223], v1
    ds_read_b128 v[100:103], v4 offset:27648
    s_waitcnt lgkmcnt(4)
    v_smfmac_f32_16x16x64_bf16 v[16:19], v[40:43], v[240:247], v1
    ds_read_b128 v[72:75], v4 offset:28672
    s_cmp_lg_u64 vcc, 0
    v_smfmac_f32_16x16x64_bf16 v[20:23], v[32:35], v[200:207], v1
    ds_read_b128 v[76:79], v4 offset:29696
    s_cselect_b32 s60, s28, s27
    v_smfmac_f32_16x16x64_bf16 v[20:23], v[36:39], v[224:231], v1
    ds_read_b128 v[80:83], v4 offset:30720
    s_nop 0
    v_cvt_pk_bf16_f32 v56, v16, v18
    v_smfmac_f32_16x16x64_bf16 v[20:23], v[40:43], v[248:255], v1
    ds_read_b128 v[84:87], v4 offset:31744
    v_cvt_pk_bf16_f32 v57, v17, v19
    v_and_or_b32 v56, v56, -2, s60
    v_smfmac_f32_16x16x64_bf16 v[24:27], v[32:35], v[208:215], v1
    buffer_store_dwordx2 v[56:57], v9, s[8:11], 0 offen offset:0 sc1
    v_smfmac_f32_16x16x64_bf16 v[24:27], v[36:39], v[232:239], v1
    s_waitcnt lgkmcnt(4)
    s_nop 0
    v_cvt_pk_bf16_f32 v58, v20, v22
    v_smfmac_f32_16x16x64_bf16 v[24:27], v[40:43], v[88:95], v1
    ds_read_b128 v[64:67], v3 offset:23040
    v_cvt_pk_bf16_f32 v59, v21, v23
    v_and_or_b32 v58, v58, -2, s60
    v_smfmac_f32_16x16x64_bf16 v[28:31], v[32:35], v[96:103], v1
    buffer_store_dwordx2 v[58:59], v9, s[8:11], 0 offen offset:2048 sc1
    s_waitcnt lgkmcnt(1)
    v_smfmac_f32_16x16x64_bf16 v[28:31], v[36:39], v[72:79], v1
    s_nop 1
    v_cvt_pk_bf16_f32 v60, v24, v26
    v_smfmac_f32_16x16x64_bf16 v[28:31], v[40:43], v[80:87], v1
    s_nop 2
    v_cvt_pk_bf16_f32 v61, v25, v27
    v_and_or_b32 v60, v60, -2, s60
    buffer_store_dwordx2 v[60:61], v9, s[8:11], s26 offen offset:0 sc1
    s_nop 1
    v_cvt_pk_bf16_f32 v62, v28, v30
    v_cvt_pk_bf16_f32 v63, v29, v31
    v_and_or_b32 v62, v62, -2, s60
    buffer_store_dwordx2 v[62:63], v9, s[8:11], s26 offen offset:2048 sc1
L_slow_stored:
    s_cmp_lg_u32 s60, s27
    s_cbranch_scc1 L_slow_safe
    ds_read_b128 v[104:107], v4 offset:0
    ds_read_b128 v[108:111], v4 offset:1024
    ds_read_b128 v[112:115], v4 offset:2048
    ds_read_b128 v[116:119], v4 offset:3072
    ds_read_b128 v[88:91], v4 offset:4096
    ds_read_b128 v[92:95], v4 offset:5120
    ds_read_b128 v[96:99], v4 offset:6144
    ds_read_b128 v[100:103], v4 offset:7168
    ds_read_b128 v[72:75], v4 offset:8192
    ds_read_b128 v[76:79], v4 offset:9216
    ds_read_b128 v[80:83], v4 offset:10240
    ds_read_b128 v[84:87], v4 offset:11264
    s_cmp_lt_u32 s21, 1
    s_cbranch_scc1 L_slow_pollp
    s_nop 13
    s_cmp_lt_u32 s21, 2
    s_cbranch_scc1 L_slow_pollp
    s_nop 13
    s_cmp_lt_u32 s21, 3
    s_cbranch_scc1 L_slow_pollp
    s_nop 13
L_slow_pollp:
    buffer_load_dwordx4 v[120:123], v2, s[8:11], s6 offen sc1
    buffer_load_dwordx4 v[124:127], v2, s[8:11], s6 offen offset:1024 sc1
    v_mov_b64 v[56:57], 0
    v_mov_b64 v[58:59], 0
    v_mov_b64 v[60:61], 0
    v_mov_b64 v[62:63], 0
    s_nop 15
    s_nop 15
    buffer_load_dwordx4 v[32:35], v2, s[8:11], s6 offen sc1
    buffer_load_dwordx4 v[36:39], v2, s[8:11], s6 offen offset:1024 sc1
L_slow_prep:
    s_add_u32 s7, s24, 0x80000
    s_waitcnt vmcnt(3) lgkmcnt(0)
    v_mfma_f32_16x16x32_bf16 v[68:71], v[64:67], v[120:123], 0
    v_bitop3_b32 v14, v120, v122, s27 bitop3:0x7e
    s_waitcnt vmcnt(2)
    v_mfma_f32_16x16x32_bf16 v[68:71], v[64:67], v[124:127], v[68:71]
    v_bitop3_b32 v11, v124, v126, s27 bitop3:0x7e
    v_bitop3_b32 v14, v14, v11, 1 bitop3:0xa8
    v_cmp_ne_u32 vcc, 0, v14
    s_nop 2
    s_cmp_eq_u64 vcc, 0
    s_cselect_b32 s36, s24, s61
    v_add_f32_dpp v68, v68, v68 row_ror:8 row_mask:0xf bank_mask:0xf
    v_add_f32_dpp v69, v69, v69 row_ror:8 row_mask:0xf bank_mask:0xf
    s_nop 0
    v_add_f32_dpp v68, v68, v68 row_ror:4 row_mask:0xf bank_mask:0xf
    v_add_f32_dpp v69, v69, v69 row_ror:4 row_mask:0xf bank_mask:0xf
    v_cvt_pk_bf16_f32 v12, v68, v69
    buffer_store_dword v12, v10, s[8:11], s36 offen sc1
    s_cbranch_scc1 L_slow_gotp
L_slow_retryp:
    buffer_load_dwordx4 v[120:123], v2, s[8:11], s6 offen sc1
    buffer_load_dwordx4 v[124:127], v2, s[8:11], s6 offen offset:1024 sc1
    s_waitcnt vmcnt(4) lgkmcnt(0)
    v_mfma_f32_16x16x32_bf16 v[68:71], v[64:67], v[32:35], 0
    v_bitop3_b32 v14, v32, v34, s27 bitop3:0x7e
    s_waitcnt vmcnt(3)
    v_mfma_f32_16x16x32_bf16 v[68:71], v[64:67], v[36:39], v[68:71]
    v_bitop3_b32 v11, v36, v38, s27 bitop3:0x7e
    v_bitop3_b32 v14, v14, v11, 1 bitop3:0xa8
    v_cmp_ne_u32 vcc, 0, v14
    s_nop 2
    s_cmp_eq_u64 vcc, 0
    s_cselect_b32 s36, s24, s61
    v_add_f32_dpp v68, v68, v68 row_ror:8 row_mask:0xf bank_mask:0xf
    v_add_f32_dpp v69, v69, v69 row_ror:8 row_mask:0xf bank_mask:0xf
    s_nop 0
    v_add_f32_dpp v68, v68, v68 row_ror:4 row_mask:0xf bank_mask:0xf
    v_add_f32_dpp v69, v69, v69 row_ror:4 row_mask:0xf bank_mask:0xf
    v_cvt_pk_bf16_f32 v12, v68, v69
    buffer_store_dword v12, v10, s[8:11], s36 offen sc1
    s_cbranch_scc1 L_slow_gotp
    buffer_load_dwordx4 v[32:35], v2, s[8:11], s6 offen sc1
    buffer_load_dwordx4 v[36:39], v2, s[8:11], s6 offen offset:1024 sc1
    s_waitcnt vmcnt(4) lgkmcnt(0)
    v_mfma_f32_16x16x32_bf16 v[68:71], v[64:67], v[120:123], 0
    v_bitop3_b32 v14, v120, v122, s27 bitop3:0x7e
    s_waitcnt vmcnt(3)
    v_mfma_f32_16x16x32_bf16 v[68:71], v[64:67], v[124:127], v[68:71]
    v_bitop3_b32 v11, v124, v126, s27 bitop3:0x7e
    v_bitop3_b32 v14, v14, v11, 1 bitop3:0xa8
    v_cmp_ne_u32 vcc, 0, v14
    s_nop 2
    s_cmp_eq_u64 vcc, 0
    s_cselect_b32 s36, s24, s61
    v_add_f32_dpp v68, v68, v68 row_ror:8 row_mask:0xf bank_mask:0xf
    v_add_f32_dpp v69, v69, v69 row_ror:8 row_mask:0xf bank_mask:0xf
    s_nop 0
    v_add_f32_dpp v68, v68, v68 row_ror:4 row_mask:0xf bank_mask:0xf
    v_add_f32_dpp v69, v69, v69 row_ror:4 row_mask:0xf bank_mask:0xf
    v_cvt_pk_bf16_f32 v12, v68, v69
    buffer_store_dword v12, v10, s[8:11], s36 offen sc1
    s_cbranch_scc1 L_slow_gotp
    s_add_u32 s32, s32, 1
    s_cmp_le_u32 s32, 200000
    s_cbranch_scc1 L_slow_retryp
    s_mov_b32 s36, s24
    buffer_store_dword v12, v10, s[8:11], s36 offen sc1
L_slow_gotp:
    s_add_u32 s31, s31, 0x2000
    s_cmp_ge_u32 s90, 63
    s_cbranch_scc1 L_slow_last
    s_mov_b32 s23, s24
    s_mov_b32 s22, s90
    s_mov_b32 s27, s28
    v_mov_b64 v[64:65], 0
    v_mov_b64 v[66:67], 0
    v_mov_b64 v[68:69], 0
    v_mov_b64 v[70:71], 0
    s_nop 15
    s_nop 11
    buffer_load_dwordx4 v[16:19], v2, s[8:11], s7 offen sc1
    buffer_load_dwordx4 v[20:23], v2, s[8:11], s7 offen offset:1024 sc1
    s_branch L_slow_step
L_slow_last:
    buffer_store_dword v12, v10, s[8:11], s31 offen sc1
    s_branch L_slow_done
L_slow_refresh:
    buffer_load_dword v15, v0, s[8:11], s23 offen sc1
    s_add_u32 s32, s32, 1
    s_cmp_le_u32 s32, 200000
    s_waitcnt vmcnt(0)
    s_cbranch_scc1 L_slow_step
    s_branch L_slow_fresh
L_slow_safe:
    s_nop 11
    s_waitcnt vmcnt(0) lgkmcnt(0)
    s_barrier
    ds_read_b128 v[72:75], v6 offset:0
    ds_read_b128 v[88:91], v6 offset:2304
    ds_read_b128 v[76:79], v6 offset:64
    ds_read_b128 v[92:95], v6 offset:2368
    ds_read_b128 v[80:83], v6 offset:128
    ds_read_b128 v[96:99], v6 offset:2432
    ds_read_b128 v[84:87], v6 offset:192
    ds_read_b128 v[100:103], v6 offset:2496
    s_xor_b32 s36, s25, 0x1000
    s_add_u32 s36, s36, s23
    buffer_load_dwordx4 v[16:19], v3, s[8:11], s29 offen offset:0 sc1
    buffer_load_dwordx4 v[32:35], v3, s[8:11], s36 offen offset:0 sc1
    buffer_load_dwordx4 v[20:23], v3, s[8:11], s29 offen offset:1024 sc1
    buffer_load_dwordx4 v[36:39], v3, s[8:11], s36 offen offset:1024 sc1
    buffer_load_dwordx4 v[24:27], v3, s[8:11], s29 offen offset:2048 sc1
    buffer_load_dwordx4 v[40:43], v3, s[8:11], s36 offen offset:2048 sc1
    buffer_load_dwordx4 v[28:31], v3, s[8:11], s29 offen offset:3072 sc1
    buffer_load_dwordx4 v[44:47], v3, s[8:11], s36 offen offset:3072 sc1
    s_waitcnt vmcnt(0) lgkmcnt(0)
    v_mfma_f32_16x16x32_bf16 v[48:51], v[16:19], v[72:75], 0
    v_mfma_f32_16x16x32_bf16 v[48:51], v[20:23], v[76:79], v[48:51]
    v_mfma_f32_16x16x32_bf16 v[48:51], v[24:27], v[80:83], v[48:51]
    v_mfma_f32_16x16x32_bf16 v[48:51], v[28:31], v[84:87], v[48:51]
    v_mfma_f32_16x16x32_bf16 v[52:55], v[32:35], v[72:75], 0
    v_mfma_f32_16x16x32_bf16 v[52:55], v[36:39], v[76:79], v[52:55]
    v_mfma_f32_16x16x32_bf16 v[52:55], v[40:43], v[80:83], v[52:55]
    v_mfma_f32_16x16x32_bf16 v[52:55], v[44:47], v[84:87], v[52:55]
    v_mfma_f32_16x16x32_bf16 v[56:59], v[88:91], v[72:75], 0
    v_mfma_f32_16x16x32_bf16 v[56:59], v[92:95], v[76:79], v[56:59]
    v_mfma_f32_16x16x32_bf16 v[56:59], v[96:99], v[80:83], v[56:59]
    v_mfma_f32_16x16x32_bf16 v[56:59], v[100:103], v[84:87], v[56:59]
    s_nop 7
    v_mul_f32 v56, s33, v56
    v_mul_f32 v57, s33, v57
    v_max3_f32 v16, v48, v49, v50
    v_max3_f32 v16, v16, v51, v52
    v_max3_f32 v16, v16, v53, v54
    v_max3_f32 v16, v16, v55, v56
    v_max_f32 v16, v16, v57
    v_mov_b32 v17, v16
    s_nop 1
    v_permlane16_swap_b32 v16, v17
    v_max_f32 v16, v16, v17
    v_mov_b32 v17, v16
    s_nop 1
    v_permlane32_swap_b32 v16, v17
    v_max_f32 v16, v16, v17
    v_sub_f32 v48, v48, v16
    v_exp_f32 v48, v48
    v_sub_f32 v49, v49, v16
    v_exp_f32 v49, v49
    v_sub_f32 v50, v50, v16
    v_exp_f32 v50, v50
    v_sub_f32 v51, v51, v16
    v_exp_f32 v51, v51
    v_sub_f32 v52, v52, v16
    v_exp_f32 v52, v52
    v_sub_f32 v53, v53, v16
    v_exp_f32 v53, v53
    v_sub_f32 v54, v54, v16
    v_exp_f32 v54, v54
    v_sub_f32 v55, v55, v16
    v_exp_f32 v55, v55
    v_sub_f32 v56, v56, v16
    v_exp_f32 v56, v56
    v_sub_f32 v57, v57, v16
    v_exp_f32 v57, v57
    v_cvt_pk_bf16_f32 v108, v48, v49
    v_cvt_pk_bf16_f32 v109, v50, v51
    v_cvt_pk_bf16_f32 v110, v52, v53
    v_cvt_pk_bf16_f32 v111, v54, v55
    v_cvt_pk_bf16_f32 v112, v56, v57
    s_nop 0
    v_mfma_f32_16x16x32_bf16 v[48:51], v[104:107], v[108:111], 0
    v_mfma_f32_16x16x32_bf16 v[56:59], v[120:123], v[108:111], 0
    v_mfma_f32_16x16x32_bf16 v[60:63], v[124:127], v[108:111], 0
    s_nop 3
    v_mfma_f32_16x16x16_bf16 v[48:51], v[104:105], v[112:113], v[48:51]
    v_mfma_f32_16x16x16_bf16 v[56:59], v[114:115], v[112:113], v[56:59]
    v_mfma_f32_16x16x16_bf16 v[60:63], v[116:117], v[112:113], v[60:63]
    s_nop 5
    v_rcp_f32 v118, v48
    s_nop 0
    v_mul_f32 v56, v56, v118
    v_mul_f32 v57, v57, v118
    v_mul_f32 v58, v58, v118
    v_mul_f32 v59, v59, v118
    v_mul_f32 v60, v60, v118
    v_mul_f32 v61, v61, v118
    v_mul_f32 v62, v62, v118
    v_mul_f32 v63, v63, v118
    v_cvt_pk_bf16_f32 v52, v56, v60
    v_cvt_pk_bf16_f32 v53, v57, v61
    v_cvt_pk_bf16_f32 v54, v58, v62
    v_cvt_pk_bf16_f32 v55, v59, v63
    v_mov_b32 v16, 0
    v_mov_b32 v17, 0
    v_mov_b32 v18, 0
    v_mov_b32 v19, 0
    v_mov_b32 v20, 0
    v_mov_b32 v21, 0
    v_mov_b32 v22, 0
    v_mov_b32 v23, 0
    v_mov_b32 v24, 0
    v_mov_b32 v25, 0
    v_mov_b32 v26, 0
    v_mov_b32 v27, 0
    v_mov_b32 v28, 0
    v_mov_b32 v29, 0
    v_mov_b32 v30, 0
    v_mov_b32 v31, 0
    v_bitop3_b32 v32, v13, s96, -9 bitop3:0x28
    v_bitop3_b32 v36, v13, s97, -9 bitop3:0x28
    v_bitop3_b32 v40, v13, s98, -9 bitop3:0x28
    s_mov_b64 vcc, 0
    s_branch L_slow_rejoin
L_slow_done:
    s_branch L_end
L_worker:
    s_cmp_eq_u32 s3, 7
    s_cbranch_scc1 L_mlp
    s_and_b32 s36, s2, 7
    s_sub_u32 s36, s36, 1
    s_lshl_b32 s36, s36, 5
    s_lshr_b32 s37, s2, 3
    s_add_u32 s36, s36, s37
    s_mul_i32 s20, s36, 10923
    s_lshr_b32 s20, s20, 16
    s_mul_i32 s37, s20, 6
    s_sub_u32 s22, s36, s37
    v_lshrrev_b32 v28, 4, v0
    v_and_b32 v16, 15, v0
    v_lshlrev_b32 v16, 4, v16
    v_lshl_add_u32 v16, v28, 13, v16
    v_bfe_u32 v29, v0, 4, 2
    v_lshlrev_b32 v29, 5, v29
    v_xor_b32 v16, v16, v29
    v_and_b32 v29, 128, v0
    v_xor_b32 v16, v16, v29
    s_lshl_b32 s28, s21, 10
    s_lshl_b32 s3, s20, 8
    s_mov_b32 s76, s52
    s_and_b32 s77, s53, 0xffff
    s_mov_b32 s78, 0x400000
    s_mov_b32 s79, 0x20000
    s_add_u32 m0, s28, 32768
    s_add_u32 s37, s3, 0x0
    buffer_load_dwordx4 v16, s[76:79], s37 offen lds
    s_add_u32 m0, s28, 36864
    s_add_u32 s37, s3, 0x20000
    buffer_load_dwordx4 v16, s[76:79], s37 offen lds
    s_add_u32 m0, s28, 65536
    s_add_u32 s37, s3, 0x40000
    buffer_load_dwordx4 v16, s[76:79], s37 offen lds
    s_add_u32 m0, s28, 69632
    s_add_u32 s37, s3, 0x60000
    buffer_load_dwordx4 v16, s[76:79], s37 offen lds
    s_add_u32 m0, s28, 98304
    s_add_u32 s37, s3, 0x80000
    buffer_load_dwordx4 v16, s[76:79], s37 offen lds
    s_add_u32 m0, s28, 102400
    s_add_u32 s37, s3, 0xa0000
    buffer_load_dwordx4 v16, s[76:79], s37 offen lds
    s_add_u32 m0, s28, 131072
    s_add_u32 s37, s3, 0xc0000
    buffer_load_dwordx4 v16, s[76:79], s37 offen lds
    s_add_u32 m0, s28, 135168
    s_add_u32 s37, s3, 0xe0000
    buffer_load_dwordx4 v16, s[76:79], s37 offen lds
    s_add_u32 m0, s28, 40960
    s_add_u32 s37, s3, 0x100000
    buffer_load_dwordx4 v16, s[76:79], s37 offen lds
    s_add_u32 m0, s28, 45056
    s_add_u32 s37, s3, 0x120000
    buffer_load_dwordx4 v16, s[76:79], s37 offen lds
    s_add_u32 m0, s28, 73728
    s_add_u32 s37, s3, 0x140000
    buffer_load_dwordx4 v16, s[76:79], s37 offen lds
    s_add_u32 m0, s28, 77824
    s_add_u32 s37, s3, 0x160000
    buffer_load_dwordx4 v16, s[76:79], s37 offen lds
    s_add_u32 m0, s28, 106496
    s_add_u32 s37, s3, 0x180000
    buffer_load_dwordx4 v16, s[76:79], s37 offen lds
    s_add_u32 m0, s28, 110592
    s_add_u32 s37, s3, 0x1a0000
    buffer_load_dwordx4 v16, s[76:79], s37 offen lds
    s_add_u32 m0, s28, 139264
    s_add_u32 s37, s3, 0x1c0000
    buffer_load_dwordx4 v16, s[76:79], s37 offen lds
    s_add_u32 m0, s28, 143360
    s_add_u32 s37, s3, 0x1e0000
    buffer_load_dwordx4 v16, s[76:79], s37 offen lds
    s_add_u32 m0, s28, 49152
    s_add_u32 s37, s3, 0x200000
    buffer_load_dwordx4 v16, s[76:79], s37 offen lds
    s_add_u32 m0, s28, 53248
    s_add_u32 s37, s3, 0x220000
    buffer_load_dwordx4 v16, s[76:79], s37 offen lds
    s_add_u32 m0, s28, 81920
    s_add_u32 s37, s3, 0x240000
    buffer_load_dwordx4 v16, s[76:79], s37 offen lds
    s_add_u32 m0, s28, 86016
    s_add_u32 s37, s3, 0x260000
    buffer_load_dwordx4 v16, s[76:79], s37 offen lds
    s_add_u32 m0, s28, 114688
    s_add_u32 s37, s3, 0x280000
    buffer_load_dwordx4 v16, s[76:79], s37 offen lds
    s_add_u32 m0, s28, 118784
    s_add_u32 s37, s3, 0x2a0000
    buffer_load_dwordx4 v16, s[76:79], s37 offen lds
    s_add_u32 m0, s28, 147456
    s_add_u32 s37, s3, 0x2c0000
    buffer_load_dwordx4 v16, s[76:79], s37 offen lds
    s_add_u32 m0, s28, 151552
    s_add_u32 s37, s3, 0x2e0000
    buffer_load_dwordx4 v16, s[76:79], s37 offen lds
    s_add_u32 m0, s28, 57344
    s_add_u32 s37, s3, 0x300000
    buffer_load_dwordx4 v16, s[76:79], s37 offen lds
    s_add_u32 m0, s28, 61440
    s_add_u32 s37, s3, 0x320000
    buffer_load_dwordx4 v16, s[76:79], s37 offen lds
    s_add_u32 m0, s28, 90112
    s_add_u32 s37, s3, 0x340000
    buffer_load_dwordx4 v16, s[76:79], s37 offen lds
    s_add_u32 m0, s28, 94208
    s_add_u32 s37, s3, 0x360000
    buffer_load_dwordx4 v16, s[76:79], s37 offen lds
    s_add_u32 m0, s28, 122880
    s_add_u32 s37, s3, 0x380000
    buffer_load_dwordx4 v16, s[76:79], s37 offen lds
    s_add_u32 m0, s28, 126976
    s_add_u32 s37, s3, 0x3a0000
    buffer_load_dwordx4 v16, s[76:79], s37 offen lds
    s_add_u32 m0, s28, 155648
    s_add_u32 s37, s3, 0x3c0000
    buffer_load_dwordx4 v16, s[76:79], s37 offen lds
    s_add_u32 m0, s28, 159744
    s_add_u32 s37, s3, 0x3e0000
    buffer_load_dwordx4 v16, s[76:79], s37 offen lds
    v_mov_b32 v20, 0x0
    v_bfe_u32 v14, v0, 0, 1
    s_mov_b32 s38, 0x8
    v_mad_u32_u24 v20, v14, s38, v20
    v_bfe_u32 v14, v0, 1, 1
    s_mov_b32 s38, 0x10
    v_mad_u32_u24 v20, v14, s38, v20
    v_bfe_u32 v14, v0, 2, 1
    s_mov_b32 s38, 0x100
    v_mad_u32_u24 v20, v14, s38, v20
    v_bfe_u32 v14, v0, 3, 1
    s_mov_b32 s38, 0x200
    v_mad_u32_u24 v20, v14, s38, v20
    v_bfe_u32 v14, v0, 4, 1
    s_mov_b32 s38, 0x800
    v_mad_u32_u24 v20, v14, s38, v20
    v_bfe_u32 v14, v0, 5, 1
    s_mov_b32 s38, 0x1000
    v_mad_u32_u24 v20, v14, s38, v20
    v_mov_b32 v30, 0x0
    v_bfe_u32 v14, v0, 2, 1
    s_mov_b32 s38, 0x20
    v_mad_u32_u24 v30, v14, s38, v30
    v_bfe_u32 v14, v0, 3, 1
    s_mov_b32 s38, 0x40
    v_mad_u32_u24 v30, v14, s38, v30
    v_bfe_u32 v14, v0, 4, 1
    s_mov_b32 s38, 0x80
    v_mad_u32_u24 v30, v14, s38, v30
    v_mov_b32 v31, 0x0
    v_bfe_u32 v14, v0, 6, 1
    s_mov_b32 s38, 0x40
    v_mad_u32_u24 v31, v14, s38, v31
    v_bfe_u32 v14, v0, 7, 1
    s_mov_b32 s38, 0x80
    v_mad_u32_u24 v31, v14, s38, v31
    v_xor_b32 v30, v30, v31
    v_add_u32 v30, v30, v20
    v_add_u32 v20, 0x8000, v30
    v_xor_b32 v21, 32, v20
    v_add_u32 v22, 0x10000, v30
    v_xor_b32 v23, 32, v22
    v_add_u32 v24, 0x18000, v30
    v_xor_b32 v25, 32, v24
    v_add_u32 v26, 0x20000, v30
    v_xor_b32 v27, 32, v26
    s_mov_b32 s12, s54
    s_and_b32 s13, s55, 0xffff
    s_mov_b32 s14, 0x400000
    s_mov_b32 s15, 0x20000
    s_lshl_b32 s24, s20, 17
    s_and_b32 s25, s22, 3
    s_lshl_b32 s25, s25, 15
    s_add_u32 s24, s24, s25
    v_lshlrev_b32 v30, 7, v0
    buffer_load_dword v31, v30, s[12:15], s24 offen
    s_mov_b32 s12, s44
    s_and_b32 s13, s45, 0xffff
    s_mov_b32 s14, 0x200000
    s_mov_b32 s15, 0x20000
    s_mov_b32 s60, s82
    s_and_b32 s61, s83, 0xffff
    s_mov_b32 s62, 0x200000
    s_mov_b32 s63, 0x20000
    s_mov_b32 s92, s80
    s_and_b32 s93, s81, 0xffff
    s_mov_b32 s94, 0x400
    s_mov_b32 s95, 0x20000
    v_mov_b32 v1, 0x0
    v_bfe_u32 v14, v0, 0, 1
    s_mov_b32 s38, 0x10
    v_mad_u32_u24 v1, v14, s38, v1
    v_bfe_u32 v14, v0, 1, 1
    s_mov_b32 s38, 0x20
    v_mad_u32_u24 v1, v14, s38, v1
    v_bfe_u32 v14, v0, 2, 1
    s_mov_b32 s38, 0x40
    v_mad_u32_u24 v1, v14, s38, v1
    v_bfe_u32 v14, v0, 3, 1
    s_mov_b32 s38, 0x80
    v_mad_u32_u24 v1, v14, s38, v1
    v_bfe_u32 v14, v0, 4, 1
    s_mov_b32 s38, 0x100
    v_mad_u32_u24 v1, v14, s38, v1
    v_bfe_u32 v14, v0, 5, 1
    s_mov_b32 s38, 0x200
    v_mad_u32_u24 v1, v14, s38, v1
    v_mov_b32 v2, 0x0
    v_bfe_u32 v14, v0, 0, 1
    s_mov_b32 s38, 0x10
    v_mad_u32_u24 v2, v14, s38, v2
    v_bfe_u32 v14, v0, 1, 1
    s_mov_b32 s38, 0x20
    v_mad_u32_u24 v2, v14, s38, v2
    v_bfe_u32 v14, v0, 2, 1
    s_mov_b32 s38, 0x40
    v_mad_u32_u24 v2, v14, s38, v2
    v_bfe_u32 v14, v0, 3, 1
    s_mov_b32 s38, 0x80
    v_mad_u32_u24 v2, v14, s38, v2
    v_bfe_u32 v14, v0, 4, 1
    s_mov_b32 s38, 0x100
    v_mad_u32_u24 v2, v14, s38, v2
    v_bfe_u32 v14, v0, 5, 1
    s_mov_b32 s38, 0x200
    v_mad_u32_u24 v2, v14, s38, v2
    v_bfe_u32 v14, v0, 6, 1
    s_mov_b32 s38, 0x800
    v_mad_u32_u24 v2, v14, s38, v2
    v_bfe_u32 v14, v0, 7, 1
    s_mov_b32 s38, 0x1000
    v_mad_u32_u24 v2, v14, s38, v2
    v_mov_b32 v9, 0x0
    v_bfe_u32 v14, v0, 0, 1
    s_mov_b32 s38, 0x10
    v_mad_u32_u24 v9, v14, s38, v9
    v_bfe_u32 v14, v0, 1, 1
    s_mov_b32 s38, 0x20
    v_mad_u32_u24 v9, v14, s38, v9
    v_bfe_u32 v14, v0, 2, 1
    s_mov_b32 s38, 0x40
    v_mad_u32_u24 v9, v14, s38, v9
    v_bfe_u32 v14, v0, 3, 1
    s_mov_b32 s38, 0x80
    v_mad_u32_u24 v9, v14, s38, v9
    v_bfe_u32 v14, v0, 4, 1
    s_mov_b32 s38, 0x100
    v_mad_u32_u24 v9, v14, s38, v9
    v_bfe_u32 v14, v0, 5, 1
    s_mov_b32 s38, 0x200
    v_mad_u32_u24 v9, v14, s38, v9
    v_bfe_u32 v14, v0, 6, 1
    s_mov_b32 s38, 0x400
    v_mad_u32_u24 v9, v14, s38, v9
    v_bfe_u32 v14, v0, 7, 1
    s_mov_b32 s38, 0x800
    v_mad_u32_u24 v9, v14, s38, v9
    v_mov_b32 v7, 0x8000
    v_bfe_u32 v14, v0, 0, 1
    s_mov_b32 s38, 0x10
    v_mad_u32_u24 v7, v14, s38, v7
    v_bfe_u32 v14, v0, 1, 1
    s_mov_b32 s38, 0x20
    v_mad_u32_u24 v7, v14, s38, v7
    v_bfe_u32 v14, v0, 2, 1
    s_mov_b32 s38, 0x40
    v_mad_u32_u24 v7, v14, s38, v7
    v_bfe_u32 v14, v0, 3, 1
    s_mov_b32 s38, 0x80
    v_mad_u32_u24 v7, v14, s38, v7
    v_bfe_u32 v14, v0, 4, 1
    s_mov_b32 s38, 0x100
    v_mad_u32_u24 v7, v14, s38, v7
    v_bfe_u32 v14, v0, 5, 1
    s_mov_b32 s38, 0x200
    v_mad_u32_u24 v7, v14, s38, v7
    v_bfe_u32 v14, v0, 6, 1
    s_mov_b32 s38, 0x8000
    v_mad_u32_u24 v7, v14, s38, v7
    v_bfe_u32 v14, v0, 7, 1
    s_mov_b32 s38, 0x10000
    v_mad_u32_u24 v7, v14, s38, v7
    v_mov_b32 v3, 0x0
    v_bfe_u32 v14, v0, 0, 1
    s_mov_b32 s38, 0x10
    v_mad_u32_u24 v3, v14, s38, v3
    v_bfe_u32 v14, v0, 1, 1
    s_mov_b32 s38, 0x20
    v_mad_u32_u24 v3, v14, s38, v3
    v_bfe_u32 v14, v0, 2, 1
    s_mov_b32 s38, 0x40
    v_mad_u32_u24 v3, v14, s38, v3
    v_bfe_u32 v14, v0, 3, 1
    s_mov_b32 s38, 0x400
    v_mad_u32_u24 v3, v14, s38, v3
    v_bfe_u32 v14, v0, 4, 1
    s_mov_b32 s38, 0x800
    v_mad_u32_u24 v3, v14, s38, v3
    v_bfe_u32 v14, v0, 5, 1
    s_mov_b32 s38, 0x1000
    v_mad_u32_u24 v3, v14, s38, v3
    v_bfe_u32 v14, v0, 6, 1
    s_mov_b32 s38, 0x2000
    v_mad_u32_u24 v3, v14, s38, v3
    v_bfe_u32 v14, v0, 7, 1
    s_mov_b32 s38, 0x4000
    v_mad_u32_u24 v3, v14, s38, v3
    v_mov_b32 v4, 0x0
    v_bfe_u32 v14, v0, 0, 1
    s_mov_b32 s38, 0x100
    v_mad_u32_u24 v4, v14, s38, v4
    v_bfe_u32 v14, v0, 1, 1
    s_mov_b32 s38, 0x200
    v_mad_u32_u24 v4, v14, s38, v4
    v_bfe_u32 v14, v0, 2, 1
    s_mov_b32 s38, 0x400
    v_mad_u32_u24 v4, v14, s38, v4
    v_bfe_u32 v14, v0, 6, 1
    s_mov_b32 s38, 0x80
    v_mad_u32_u24 v4, v14, s38, v4
    v_bfe_u32 v14, v0, 7, 1
    s_mov_b32 s38, 0x4000
    v_mad_u32_u24 v4, v14, s38, v4
    v_lshrrev_b32 v15, 3, v0
    v_xor_b32 v15, v15, v0
    v_and_b32 v15, 7, v15
    v_lshl_add_u32 v4, v15, 4, v4
    v_bfe_u32 v15, v0, 4, 2
    v_lshlrev_b32 v15, 4, v15
    v_xor_b32 v5, v15, v1
    v_xor_b32 v6, 64, v5
    v_mov_b32 v8, 0x5000
    v_bfe_u32 v14, v0, 0, 1
    s_mov_b32 s38, 0x10
    v_mad_u32_u24 v8, v14, s38, v8
    v_bfe_u32 v14, v0, 1, 1
    s_mov_b32 s38, 0x40
    v_mad_u32_u24 v8, v14, s38, v8
    v_bfe_u32 v14, v0, 2, 1
    s_mov_b32 s38, 0x80
    v_mad_u32_u24 v8, v14, s38, v8
    v_bfe_u32 v14, v0, 4, 1
    s_mov_b32 s38, 0x20
    v_mad_u32_u24 v8, v14, s38, v8
    v_bfe_u32 v14, v0, 5, 1
    s_mov_b32 s38, 0x100
    v_mad_u32_u24 v8, v14, s38, v8
    v_mov_b32 v10, 0x0
    v_bfe_u32 v14, v0, 0, 1
    s_mov_b32 s38, 0x10
    v_mad_u32_u24 v10, v14, s38, v10
    v_bfe_u32 v14, v0, 1, 1
    s_mov_b32 s38, 0x20
    v_mad_u32_u24 v10, v14, s38, v10
    v_bfe_u32 v14, v0, 2, 1
    s_mov_b32 s38, 0x40
    v_mad_u32_u24 v10, v14, s38, v10
    v_bfe_u32 v14, v0, 3, 1
    s_mov_b32 s38, 0x80
    v_mad_u32_u24 v10, v14, s38, v10
    v_bfe_u32 v14, v0, 4, 1
    s_mov_b32 s38, 0x20000
    v_mad_u32_u24 v10, v14, s38, v10
    v_bfe_u32 v14, v0, 5, 1
    s_mov_b32 s38, 0x40000
    v_mad_u32_u24 v10, v14, s38, v10
    v_bfe_u32 v14, v0, 6, 1
    s_mov_b32 s38, 0x100
    v_mad_u32_u24 v10, v14, s38, v10
    v_bfe_u32 v14, v0, 7, 1
    s_mov_b32 s38, 0x200
    v_mad_u32_u24 v10, v14, s38, v10
    v_mov_b32 v11, 0x0
    v_bfe_u32 v14, v0, 0, 1
    s_mov_b32 s38, 0x10
    v_mad_u32_u24 v11, v14, s38, v11
    v_bfe_u32 v14, v0, 1, 1
    s_mov_b32 s38, 0x20
    v_mad_u32_u24 v11, v14, s38, v11
    v_bfe_u32 v14, v0, 2, 1
    s_mov_b32 s38, 0x40
    v_mad_u32_u24 v11, v14, s38, v11
    v_bfe_u32 v14, v0, 3, 1
    s_mov_b32 s38, 0x80
    v_mad_u32_u24 v11, v14, s38, v11
    v_bfe_u32 v14, v0, 4, 1
    s_mov_b32 s38, 0x400
    v_mad_u32_u24 v11, v14, s38, v11
    v_bfe_u32 v14, v0, 5, 1
    s_mov_b32 s38, 0x800
    v_mad_u32_u24 v11, v14, s38, v11
    v_bfe_u32 v14, v0, 6, 1
    s_mov_b32 s38, 0x100
    v_mad_u32_u24 v11, v14, s38, v11
    v_bfe_u32 v14, v0, 7, 1
    s_mov_b32 s38, 0x200
    v_mad_u32_u24 v11, v14, s38, v11
    v_mov_b32 v12, 0x0
    v_bfe_u32 v14, v0, 0, 1
    s_mov_b32 s38, 0x10
    v_mad_u32_u24 v12, v14, s38, v12
    v_bfe_u32 v14, v0, 1, 1
    s_mov_b32 s38, 0x20
    v_mad_u32_u24 v12, v14, s38, v12
    v_bfe_u32 v14, v0, 2, 1
    s_mov_b32 s38, 0x40
    v_mad_u32_u24 v12, v14, s38, v12
    v_bfe_u32 v14, v0, 3, 1
    s_mov_b32 s38, 0x80
    v_mad_u32_u24 v12, v14, s38, v12
    v_bfe_u32 v14, v0, 4, 1
    s_mov_b32 s38, 0x4
    v_mad_u32_u24 v12, v14, s38, v12
    v_bfe_u32 v14, v0, 5, 1
    s_mov_b32 s38, 0x8
    v_mad_u32_u24 v12, v14, s38, v12
    v_bfe_u32 v14, v0, 6, 1
    s_mov_b32 s38, 0x100
    v_mad_u32_u24 v12, v14, s38, v12
    v_bfe_u32 v14, v0, 7, 1
    s_mov_b32 s38, 0x200
    v_mad_u32_u24 v12, v14, s38, v12
    v_mov_b32 v13, 0xf149f2ca
    v_and_b32 v14, 15, v0
    v_bfe_u32 v15, v0, 4, 2
    v_cmp_gt_u32 s[72:73], 2, v15
    v_lshlrev_b32 v15, 2, v15
    v_cmp_le_u32 s[64:65], v15, v14
    v_add_u32 v15, 1, v15
    v_cmp_le_u32 s[66:67], v15, v14
    v_add_u32 v15, 1, v15
    v_cmp_le_u32 s[68:69], v15, v14
    v_add_u32 v15, 1, v15
    v_cmp_le_u32 s[70:71], v15, v14
    v_add_u32 v15, 1, v15
    s_mov_b32 s34, 0x05040100
    s_mov_b32 s35, 0x07060302
    s_mov_b32 s33, 0x3e0293ee
    s_mov_b32 s32, 0
    s_mov_b32 s4, 0x3f803f80
    s_mov_b32 s5, 0x3f803f80
    s_mov_b32 s23, s22
    s_lshl_b32 s36, s23, 15
    buffer_load_dwordx4 v[96:99], v3, s[12:15], s36 offen offset:0
    buffer_load_dwordx4 v[100:103], v3, s[12:15], s36 offen offset:128
    buffer_load_dwordx4 v[104:107], v3, s[12:15], s36 offen offset:256
    buffer_load_dwordx4 v[108:111], v3, s[12:15], s36 offen offset:384
    buffer_load_dwordx4 v[112:115], v3, s[12:15], s36 offen offset:512
    buffer_load_dwordx4 v[116:119], v3, s[12:15], s36 offen offset:640
    buffer_load_dwordx4 v[120:123], v3, s[12:15], s36 offen offset:768
    buffer_load_dwordx4 v[124:127], v3, s[12:15], s36 offen offset:896
    s_waitcnt vmcnt(33)
    s_barrier
    ds_read_b64_tr_b16 v[128:129], v20 offset:0
    ds_read_b64_tr_b16 v[130:131], v20 offset:1024
    ds_read_b64_tr_b16 v[132:133], v21 offset:0
    ds_read_b64_tr_b16 v[134:135], v21 offset:1024
    ds_read_b64_tr_b16 v[136:137], v22 offset:0
    ds_read_b64_tr_b16 v[138:139], v22 offset:1024
    ds_read_b64_tr_b16 v[140:141], v23 offset:0
    ds_read_b64_tr_b16 v[142:143], v23 offset:1024
    ds_read_b64_tr_b16 v[144:145], v24 offset:0
    ds_read_b64_tr_b16 v[146:147], v24 offset:1024
    ds_read_b64_tr_b16 v[148:149], v25 offset:0
    ds_read_b64_tr_b16 v[150:151], v25 offset:1024
    s_waitcnt lgkmcnt(4)
    ds_read_b64_tr_b16 v[152:153], v26 offset:0
    ds_read_b64_tr_b16 v[154:155], v26 offset:1024
    ds_read_b64_tr_b16 v[156:157], v27 offset:0
    ds_read_b64_tr_b16 v[158:159], v27 offset:1024
    s_waitcnt lgkmcnt(0)
    s_barrier
    s_mov_b32 s40, s50
    s_and_b32 s41, s51, 0xffff
    s_mov_b32 s42, 0x400000
    s_mov_b32 s43, 0x20000
    s_add_u32 m0, s28, 32768
    s_add_u32 s37, s3, 0x0
    buffer_load_dwordx4 v16, s[40:43], s37 offen lds
    s_add_u32 m0, s28, 36864
    s_add_u32 s37, s3, 0x20000
    buffer_load_dwordx4 v16, s[40:43], s37 offen lds
    s_add_u32 m0, s28, 65536
    s_add_u32 s37, s3, 0x40000
    buffer_load_dwordx4 v16, s[40:43], s37 offen lds
    s_add_u32 m0, s28, 69632
    s_add_u32 s37, s3, 0x60000
    buffer_load_dwordx4 v16, s[40:43], s37 offen lds
    s_add_u32 m0, s28, 98304
    s_add_u32 s37, s3, 0x80000
    buffer_load_dwordx4 v16, s[40:43], s37 offen lds
    s_add_u32 m0, s28, 102400
    s_add_u32 s37, s3, 0xa0000
    buffer_load_dwordx4 v16, s[40:43], s37 offen lds
    s_add_u32 m0, s28, 131072
    s_add_u32 s37, s3, 0xc0000
    buffer_load_dwordx4 v16, s[40:43], s37 offen lds
    s_add_u32 m0, s28, 135168
    s_add_u32 s37, s3, 0xe0000
    buffer_load_dwordx4 v16, s[40:43], s37 offen lds
    s_waitcnt vmcnt(33)
    s_barrier
    ds_read_b64_tr_b16 v[160:161], v20 offset:8192
    ds_read_b64_tr_b16 v[162:163], v20 offset:9216
    ds_read_b64_tr_b16 v[164:165], v21 offset:8192
    ds_read_b64_tr_b16 v[166:167], v21 offset:9216
    ds_read_b64_tr_b16 v[168:169], v22 offset:8192
    ds_read_b64_tr_b16 v[170:171], v22 offset:9216
    ds_read_b64_tr_b16 v[172:173], v23 offset:8192
    ds_read_b64_tr_b16 v[174:175], v23 offset:9216
    ds_read_b64_tr_b16 v[176:177], v24 offset:8192
    ds_read_b64_tr_b16 v[178:179], v24 offset:9216
    ds_read_b64_tr_b16 v[180:181], v25 offset:8192
    ds_read_b64_tr_b16 v[182:183], v25 offset:9216
    s_waitcnt lgkmcnt(4)
    ds_read_b64_tr_b16 v[184:185], v26 offset:8192
    ds_read_b64_tr_b16 v[186:187], v26 offset:9216
    ds_read_b64_tr_b16 v[188:189], v27 offset:8192
    ds_read_b64_tr_b16 v[190:191], v27 offset:9216
    s_waitcnt lgkmcnt(0)
    s_barrier
    s_add_u32 m0, s28, 40960
    s_add_u32 s37, s3, 0x100000
    buffer_load_dwordx4 v16, s[40:43], s37 offen lds
    s_add_u32 m0, s28, 45056
    s_add_u32 s37, s3, 0x120000
    buffer_load_dwordx4 v16, s[40:43], s37 offen lds
    s_add_u32 m0, s28, 73728
    s_add_u32 s37, s3, 0x140000
    buffer_load_dwordx4 v16, s[40:43], s37 offen lds
    s_add_u32 m0, s28, 77824
    s_add_u32 s37, s3, 0x160000
    buffer_load_dwordx4 v16, s[40:43], s37 offen lds
    s_add_u32 m0, s28, 106496
    s_add_u32 s37, s3, 0x180000
    buffer_load_dwordx4 v16, s[40:43], s37 offen lds
    s_add_u32 m0, s28, 110592
    s_add_u32 s37, s3, 0x1a0000
    buffer_load_dwordx4 v16, s[40:43], s37 offen lds
    s_add_u32 m0, s28, 139264
    s_add_u32 s37, s3, 0x1c0000
    buffer_load_dwordx4 v16, s[40:43], s37 offen lds
    s_add_u32 m0, s28, 143360
    s_add_u32 s37, s3, 0x1e0000
    buffer_load_dwordx4 v16, s[40:43], s37 offen lds
    s_waitcnt vmcnt(33)
    s_barrier
    ds_read_b64_tr_b16 v[192:193], v20 offset:16384
    ds_read_b64_tr_b16 v[194:195], v20 offset:17408
    ds_read_b64_tr_b16 v[196:197], v21 offset:16384
    ds_read_b64_tr_b16 v[198:199], v21 offset:17408
    ds_read_b64_tr_b16 v[200:201], v22 offset:16384
    ds_read_b64_tr_b16 v[202:203], v22 offset:17408
    ds_read_b64_tr_b16 v[204:205], v23 offset:16384
    ds_read_b64_tr_b16 v[206:207], v23 offset:17408
    ds_read_b64_tr_b16 v[208:209], v24 offset:16384
    ds_read_b64_tr_b16 v[210:211], v24 offset:17408
    ds_read_b64_tr_b16 v[212:213], v25 offset:16384
    ds_read_b64_tr_b16 v[214:215], v25 offset:17408
    s_waitcnt lgkmcnt(4)
    ds_read_b64_tr_b16 v[216:217], v26 offset:16384
    ds_read_b64_tr_b16 v[218:219], v26 offset:17408
    ds_read_b64_tr_b16 v[220:221], v27 offset:16384
    ds_read_b64_tr_b16 v[222:223], v27 offset:17408
    s_waitcnt lgkmcnt(0)
    s_barrier
    s_add_u32 m0, s28, 49152
    s_add_u32 s37, s3, 0x200000
    buffer_load_dwordx4 v16, s[40:43], s37 offen lds
    s_add_u32 m0, s28, 53248
    s_add_u32 s37, s3, 0x220000
    buffer_load_dwordx4 v16, s[40:43], s37 offen lds
    s_add_u32 m0, s28, 81920
    s_add_u32 s37, s3, 0x240000
    buffer_load_dwordx4 v16, s[40:43], s37 offen lds
    s_add_u32 m0, s28, 86016
    s_add_u32 s37, s3, 0x260000
    buffer_load_dwordx4 v16, s[40:43], s37 offen lds
    s_add_u32 m0, s28, 114688
    s_add_u32 s37, s3, 0x280000
    buffer_load_dwordx4 v16, s[40:43], s37 offen lds
    s_add_u32 m0, s28, 118784
    s_add_u32 s37, s3, 0x2a0000
    buffer_load_dwordx4 v16, s[40:43], s37 offen lds
    s_add_u32 m0, s28, 147456
    s_add_u32 s37, s3, 0x2c0000
    buffer_load_dwordx4 v16, s[40:43], s37 offen lds
    s_add_u32 m0, s28, 151552
    s_add_u32 s37, s3, 0x2e0000
    buffer_load_dwordx4 v16, s[40:43], s37 offen lds
    s_waitcnt vmcnt(33)
    s_barrier
    ds_read_b64_tr_b16 v[224:225], v20 offset:24576
    ds_read_b64_tr_b16 v[226:227], v20 offset:25600
    ds_read_b64_tr_b16 v[228:229], v21 offset:24576
    ds_read_b64_tr_b16 v[230:231], v21 offset:25600
    ds_read_b64_tr_b16 v[232:233], v22 offset:24576
    ds_read_b64_tr_b16 v[234:235], v22 offset:25600
    ds_read_b64_tr_b16 v[236:237], v23 offset:24576
    ds_read_b64_tr_b16 v[238:239], v23 offset:25600
    ds_read_b64_tr_b16 v[240:241], v24 offset:24576
    ds_read_b64_tr_b16 v[242:243], v24 offset:25600
    ds_read_b64_tr_b16 v[244:245], v25 offset:24576
    ds_read_b64_tr_b16 v[246:247], v25 offset:25600
    s_waitcnt lgkmcnt(4)
    ds_read_b64_tr_b16 v[248:249], v26 offset:24576
    ds_read_b64_tr_b16 v[250:251], v26 offset:25600
    ds_read_b64_tr_b16 v[252:253], v27 offset:24576
    ds_read_b64_tr_b16 v[254:255], v27 offset:25600
    s_waitcnt lgkmcnt(0)
    s_barrier
    s_add_u32 m0, s28, 57344
    s_add_u32 s37, s3, 0x300000
    buffer_load_dwordx4 v16, s[40:43], s37 offen lds
    s_add_u32 m0, s28, 61440
    s_add_u32 s37, s3, 0x320000
    buffer_load_dwordx4 v16, s[40:43], s37 offen lds
    s_add_u32 m0, s28, 90112
    s_add_u32 s37, s3, 0x340000
    buffer_load_dwordx4 v16, s[40:43], s37 offen lds
    s_add_u32 m0, s28, 94208
    s_add_u32 s37, s3, 0x360000
    buffer_load_dwordx4 v16, s[40:43], s37 offen lds
    s_add_u32 m0, s28, 122880
    s_add_u32 s37, s3, 0x380000
    buffer_load_dwordx4 v16, s[40:43], s37 offen lds
    s_add_u32 m0, s28, 126976
    s_add_u32 s37, s3, 0x3a0000
    buffer_load_dwordx4 v16, s[40:43], s37 offen lds
    s_add_u32 m0, s28, 155648
    s_add_u32 s37, s3, 0x3c0000
    buffer_load_dwordx4 v16, s[40:43], s37 offen lds
    s_add_u32 m0, s28, 159744
    s_add_u32 s37, s3, 0x3e0000
    buffer_load_dwordx4 v16, s[40:43], s37 offen lds
    s_waitcnt vmcnt(32)
    v_mov_b32 v88, 0
    v_mov_b32 v89, 0
    v_dot2_f32_bf16 v88, v96, s4, v88
    v_dot2_f32_bf16 v89, v96, v96, v89
    v_dot2_f32_bf16 v88, v97, s4, v88
    v_dot2_f32_bf16 v89, v97, v97, v89
    v_dot2_f32_bf16 v88, v98, s4, v88
    v_dot2_f32_bf16 v89, v98, v98, v89
    v_dot2_f32_bf16 v88, v99, s4, v88
    v_dot2_f32_bf16 v89, v99, v99, v89
    v_dot2_f32_bf16 v88, v100, s4, v88
    v_dot2_f32_bf16 v89, v100, v100, v89
    v_dot2_f32_bf16 v88, v101, s4, v88
    v_dot2_f32_bf16 v89, v101, v101, v89
    v_dot2_f32_bf16 v88, v102, s4, v88
    v_dot2_f32_bf16 v89, v102, v102, v89
    v_dot2_f32_bf16 v88, v103, s4, v88
    v_dot2_f32_bf16 v89, v103, v103, v89
    v_dot2_f32_bf16 v88, v104, s4, v88
    v_dot2_f32_bf16 v89, v104, v104, v89
    v_dot2_f32_bf16 v88, v105, s4, v88
    v_dot2_f32_bf16 v89, v105, v105, v89
    v_dot2_f32_bf16 v88, v106, s4, v88
    v_dot2_f32_bf16 v89, v106, v106, v89
    v_dot2_f32_bf16 v88, v107, s4, v88
    v_dot2_f32_bf16 v89, v107, v107, v89
    v_dot2_f32_bf16 v88, v108, s4, v88
    v_dot2_f32_bf16 v89, v108, v108, v89
    v_dot2_f32_bf16 v88, v109, s4, v88
    v_dot2_f32_bf16 v89, v109, v109, v89
    v_dot2_f32_bf16 v88, v110, s4, v88
    v_dot2_f32_bf16 v89, v110, v110, v89
    v_dot2_f32_bf16 v88, v111, s4, v88
    v_dot2_f32_bf16 v89, v111, v111, v89
    v_dot2_f32_bf16 v88, v112, s4, v88
    v_dot2_f32_bf16 v89, v112, v112, v89
    v_dot2_f32_bf16 v88, v113, s4, v88
    v_dot2_f32_bf16 v89, v113, v113, v89
    v_dot2_f32_bf16 v88, v114, s4, v88
    v_dot2_f32_bf16 v89, v114, v114, v89
    v_dot2_f32_bf16 v88, v115, s4, v88
    v_dot2_f32_bf16 v89, v115, v115, v89
    v_dot2_f32_bf16 v88, v116, s4, v88
    v_dot2_f32_bf16 v89, v116, v116, v89
    v_dot2_f32_bf16 v88, v117, s4, v88
    v_dot2_f32_bf16 v89, v117, v117, v89
    v_dot2_f32_bf16 v88, v118, s4, v88
    v_dot2_f32_bf16 v89, v118, v118, v89
    v_dot2_f32_bf16 v88, v119, s4, v88
    v_dot2_f32_bf16 v89, v119, v119, v89
    v_dot2_f32_bf16 v88, v120, s4, v88
    v_dot2_f32_bf16 v89, v120, v120, v89
    v_dot2_f32_bf16 v88, v121, s4, v88
    v_dot2_f32_bf16 v89, v121, v121, v89
    v_dot2_f32_bf16 v88, v122, s4, v88
    v_dot2_f32_bf16 v89, v122, v122, v89
    v_dot2_f32_bf16 v88, v123, s4, v88
    v_dot2_f32_bf16 v89, v123, v123, v89
    v_dot2_f32_bf16 v88, v124, s4, v88
    v_dot2_f32_bf16 v89, v124, v124, v89
    v_dot2_f32_bf16 v88, v125, s4, v88
    v_dot2_f32_bf16 v89, v125, v125, v89
    v_dot2_f32_bf16 v88, v126, s4, v88
    v_dot2_f32_bf16 v89, v126, v126, v89
    v_dot2_f32_bf16 v88, v127, s4, v88
    v_dot2_f32_bf16 v89, v127, v127, v89
    s_nop 3
    v_add_f32_dpp v88, v88, v88 quad_perm:[1,0,3,2] row_mask:0xf bank_mask:0xf
    v_add_f32_dpp v89, v89, v89 quad_perm:[1,0,3,2] row_mask:0xf bank_mask:0xf
    s_nop 0
    v_add_f32_dpp v88, v88, v88 quad_perm:[2,3,0,1] row_mask:0xf bank_mask:0xf
    v_add_f32_dpp v89, v89, v89 quad_perm:[2,3,0,1] row_mask:0xf bank_mask:0xf
    s_nop 0
    v_add_f32_dpp v88, v88, v88 row_half_mirror row_mask:0xf bank_mask:0xf
    v_add_f32_dpp v89, v89, v89 row_half_mirror row_mask:0xf bank_mask:0xf
    v_mul_f32 v88, 0x3b000000, v88
    v_mul_f32 v89, 0x3b000000, v89
    v_fma_f32 v89, -v88, v88, v89
    v_max_f32 v89, 0, v89
    v_cvt_pk_bf16_f32 v14, v88, v89
    v_lshlrev_b32 v88, 16, v14
    v_and_b32 v89, 0xffff0000, v14
    v_add_f32 v89, 0x3727c5ac, v89
    v_cvt_pk_bf16_f32 v14, v89, v89
    v_lshlrev_b32 v89, 16, v14
    v_sqrt_f32 v89, v89
    s_nop 0
    v_cvt_pk_bf16_f32 v14, v89, v89
    v_lshlrev_b32 v89, 16, v14
    v_rcp_f32 v89, v89
    v_lshlrev_b32 v90, 16, v96
    v_and_b32 v91, 0xffff0000, v96
    v_sub_f32 v90, v90, v88
    v_sub_f32 v91, v91, v88
    v_cvt_pk_bf16_f32 v96, v90, v91
    v_lshlrev_b32 v90, 16, v96
    v_and_b32 v91, 0xffff0000, v96
    v_mul_f32 v90, v90, v89
    v_mul_f32 v91, v91, v89
    v_cvt_pk_bf16_f32 v96, v90, v91
    v_lshlrev_b32 v90, 16, v97
    v_and_b32 v91, 0xffff0000, v97
    v_sub_f32 v90, v90, v88
    v_sub_f32 v91, v91, v88
    v_cvt_pk_bf16_f32 v97, v90, v91
    v_lshlrev_b32 v90, 16, v97
    v_and_b32 v91, 0xffff0000, v97
    v_mul_f32 v90, v90, v89
    v_mul_f32 v91, v91, v89
    v_cvt_pk_bf16_f32 v97, v90, v91
    v_lshlrev_b32 v90, 16, v98
    v_and_b32 v91, 0xffff0000, v98
    v_sub_f32 v90, v90, v88
    v_sub_f32 v91, v91, v88
    v_cvt_pk_bf16_f32 v98, v90, v91
    v_lshlrev_b32 v90, 16, v98
    v_and_b32 v91, 0xffff0000, v98
    v_mul_f32 v90, v90, v89
    v_mul_f32 v91, v91, v89
    v_cvt_pk_bf16_f32 v98, v90, v91
    v_lshlrev_b32 v90, 16, v99
    v_and_b32 v91, 0xffff0000, v99
    v_sub_f32 v90, v90, v88
    v_sub_f32 v91, v91, v88
    v_cvt_pk_bf16_f32 v99, v90, v91
    v_lshlrev_b32 v90, 16, v99
    v_and_b32 v91, 0xffff0000, v99
    v_mul_f32 v90, v90, v89
    v_mul_f32 v91, v91, v89
    v_cvt_pk_bf16_f32 v99, v90, v91
    ds_write_b128 v4, v[96:99] offset:0
    v_lshlrev_b32 v90, 16, v100
    v_and_b32 v91, 0xffff0000, v100
    v_sub_f32 v90, v90, v88
    v_sub_f32 v91, v91, v88
    v_cvt_pk_bf16_f32 v100, v90, v91
    v_lshlrev_b32 v90, 16, v100
    v_and_b32 v91, 0xffff0000, v100
    v_mul_f32 v90, v90, v89
    v_mul_f32 v91, v91, v89
    v_cvt_pk_bf16_f32 v100, v90, v91
    v_lshlrev_b32 v90, 16, v101
    v_and_b32 v91, 0xffff0000, v101
    v_sub_f32 v90, v90, v88
    v_sub_f32 v91, v91, v88
    v_cvt_pk_bf16_f32 v101, v90, v91
    v_lshlrev_b32 v90, 16, v101
    v_and_b32 v91, 0xffff0000, v101
    v_mul_f32 v90, v90, v89
    v_mul_f32 v91, v91, v89
    v_cvt_pk_bf16_f32 v101, v90, v91
    v_lshlrev_b32 v90, 16, v102
    v_and_b32 v91, 0xffff0000, v102
    v_sub_f32 v90, v90, v88
    v_sub_f32 v91, v91, v88
    v_cvt_pk_bf16_f32 v102, v90, v91
    v_lshlrev_b32 v90, 16, v102
    v_and_b32 v91, 0xffff0000, v102
    v_mul_f32 v90, v90, v89
    v_mul_f32 v91, v91, v89
    v_cvt_pk_bf16_f32 v102, v90, v91
    v_lshlrev_b32 v90, 16, v103
    v_and_b32 v91, 0xffff0000, v103
    v_sub_f32 v90, v90, v88
    v_sub_f32 v91, v91, v88
    v_cvt_pk_bf16_f32 v103, v90, v91
    v_lshlrev_b32 v90, 16, v103
    v_and_b32 v91, 0xffff0000, v103
    v_mul_f32 v90, v90, v89
    v_mul_f32 v91, v91, v89
    v_cvt_pk_bf16_f32 v103, v90, v91
    ds_write_b128 v4, v[100:103] offset:2048
    v_lshlrev_b32 v90, 16, v104
    v_and_b32 v91, 0xffff0000, v104
    v_sub_f32 v90, v90, v88
    v_sub_f32 v91, v91, v88
    v_cvt_pk_bf16_f32 v104, v90, v91
    v_lshlrev_b32 v90, 16, v104
    v_and_b32 v91, 0xffff0000, v104
    v_mul_f32 v90, v90, v89
    v_mul_f32 v91, v91, v89
    v_cvt_pk_bf16_f32 v104, v90, v91
    v_lshlrev_b32 v90, 16, v105
    v_and_b32 v91, 0xffff0000, v105
    v_sub_f32 v90, v90, v88
    v_sub_f32 v91, v91, v88
    v_cvt_pk_bf16_f32 v105, v90, v91
    v_lshlrev_b32 v90, 16, v105
    v_and_b32 v91, 0xffff0000, v105
    v_mul_f32 v90, v90, v89
    v_mul_f32 v91, v91, v89
    v_cvt_pk_bf16_f32 v105, v90, v91
    v_lshlrev_b32 v90, 16, v106
    v_and_b32 v91, 0xffff0000, v106
    v_sub_f32 v90, v90, v88
    v_sub_f32 v91, v91, v88
    v_cvt_pk_bf16_f32 v106, v90, v91
    v_lshlrev_b32 v90, 16, v106
    v_and_b32 v91, 0xffff0000, v106
    v_mul_f32 v90, v90, v89
    v_mul_f32 v91, v91, v89
    v_cvt_pk_bf16_f32 v106, v90, v91
    v_lshlrev_b32 v90, 16, v107
    v_and_b32 v91, 0xffff0000, v107
    v_sub_f32 v90, v90, v88
    v_sub_f32 v91, v91, v88
    v_cvt_pk_bf16_f32 v107, v90, v91
    v_lshlrev_b32 v90, 16, v107
    v_and_b32 v91, 0xffff0000, v107
    v_mul_f32 v90, v90, v89
    v_mul_f32 v91, v91, v89
    v_cvt_pk_bf16_f32 v107, v90, v91
    ds_write_b128 v4, v[104:107] offset:4096
    v_lshlrev_b32 v90, 16, v108
    v_and_b32 v91, 0xffff0000, v108
    v_sub_f32 v90, v90, v88
    v_sub_f32 v91, v91, v88
    v_cvt_pk_bf16_f32 v108, v90, v91
    v_lshlrev_b32 v90, 16, v108
    v_and_b32 v91, 0xffff0000, v108
    v_mul_f32 v90, v90, v89
    v_mul_f32 v91, v91, v89
    v_cvt_pk_bf16_f32 v108, v90, v91
    v_lshlrev_b32 v90, 16, v109
    v_and_b32 v91, 0xffff0000, v109
    v_sub_f32 v90, v90, v88
    v_sub_f32 v91, v91, v88
    v_cvt_pk_bf16_f32 v109, v90, v91
    v_lshlrev_b32 v90, 16, v109
    v_and_b32 v91, 0xffff0000, v109
    v_mul_f32 v90, v90, v89
    v_mul_f32 v91, v91, v89
    v_cvt_pk_bf16_f32 v109, v90, v91
    v_lshlrev_b32 v90, 16, v110
    v_and_b32 v91, 0xffff0000, v110
    v_sub_f32 v90, v90, v88
    v_sub_f32 v91, v91, v88
    v_cvt_pk_bf16_f32 v110, v90, v91
    v_lshlrev_b32 v90, 16, v110
    v_and_b32 v91, 0xffff0000, v110
    v_mul_f32 v90, v90, v89
    v_mul_f32 v91, v91, v89
    v_cvt_pk_bf16_f32 v110, v90, v91
    v_lshlrev_b32 v90, 16, v111
    v_and_b32 v91, 0xffff0000, v111
    v_sub_f32 v90, v90, v88
    v_sub_f32 v91, v91, v88
    v_cvt_pk_bf16_f32 v111, v90, v91
    v_lshlrev_b32 v90, 16, v111
    v_and_b32 v91, 0xffff0000, v111
    v_mul_f32 v90, v90, v89
    v_mul_f32 v91, v91, v89
    v_cvt_pk_bf16_f32 v111, v90, v91
    ds_write_b128 v4, v[108:111] offset:6144
    v_lshlrev_b32 v90, 16, v112
    v_and_b32 v91, 0xffff0000, v112
    v_sub_f32 v90, v90, v88
    v_sub_f32 v91, v91, v88
    v_cvt_pk_bf16_f32 v112, v90, v91
    v_lshlrev_b32 v90, 16, v112
    v_and_b32 v91, 0xffff0000, v112
    v_mul_f32 v90, v90, v89
    v_mul_f32 v91, v91, v89
    v_cvt_pk_bf16_f32 v112, v90, v91
    v_lshlrev_b32 v90, 16, v113
    v_and_b32 v91, 0xffff0000, v113
    v_sub_f32 v90, v90, v88
    v_sub_f32 v91, v91, v88
    v_cvt_pk_bf16_f32 v113, v90, v91
    v_lshlrev_b32 v90, 16, v113
    v_and_b32 v91, 0xffff0000, v113
    v_mul_f32 v90, v90, v89
    v_mul_f32 v91, v91, v89
    v_cvt_pk_bf16_f32 v113, v90, v91
    v_lshlrev_b32 v90, 16, v114
    v_and_b32 v91, 0xffff0000, v114
    v_sub_f32 v90, v90, v88
    v_sub_f32 v91, v91, v88
    v_cvt_pk_bf16_f32 v114, v90, v91
    v_lshlrev_b32 v90, 16, v114
    v_and_b32 v91, 0xffff0000, v114
    v_mul_f32 v90, v90, v89
    v_mul_f32 v91, v91, v89
    v_cvt_pk_bf16_f32 v114, v90, v91
    v_lshlrev_b32 v90, 16, v115
    v_and_b32 v91, 0xffff0000, v115
    v_sub_f32 v90, v90, v88
    v_sub_f32 v91, v91, v88
    v_cvt_pk_bf16_f32 v115, v90, v91
    v_lshlrev_b32 v90, 16, v115
    v_and_b32 v91, 0xffff0000, v115
    v_mul_f32 v90, v90, v89
    v_mul_f32 v91, v91, v89
    v_cvt_pk_bf16_f32 v115, v90, v91
    ds_write_b128 v4, v[112:115] offset:8192
    v_lshlrev_b32 v90, 16, v116
    v_and_b32 v91, 0xffff0000, v116
    v_sub_f32 v90, v90, v88
    v_sub_f32 v91, v91, v88
    v_cvt_pk_bf16_f32 v116, v90, v91
    v_lshlrev_b32 v90, 16, v116
    v_and_b32 v91, 0xffff0000, v116
    v_mul_f32 v90, v90, v89
    v_mul_f32 v91, v91, v89
    v_cvt_pk_bf16_f32 v116, v90, v91
    v_lshlrev_b32 v90, 16, v117
    v_and_b32 v91, 0xffff0000, v117
    v_sub_f32 v90, v90, v88
    v_sub_f32 v91, v91, v88
    v_cvt_pk_bf16_f32 v117, v90, v91
    v_lshlrev_b32 v90, 16, v117
    v_and_b32 v91, 0xffff0000, v117
    v_mul_f32 v90, v90, v89
    v_mul_f32 v91, v91, v89
    v_cvt_pk_bf16_f32 v117, v90, v91
    v_lshlrev_b32 v90, 16, v118
    v_and_b32 v91, 0xffff0000, v118
    v_sub_f32 v90, v90, v88
    v_sub_f32 v91, v91, v88
    v_cvt_pk_bf16_f32 v118, v90, v91
    v_lshlrev_b32 v90, 16, v118
    v_and_b32 v91, 0xffff0000, v118
    v_mul_f32 v90, v90, v89
    v_mul_f32 v91, v91, v89
    v_cvt_pk_bf16_f32 v118, v90, v91
    v_lshlrev_b32 v90, 16, v119
    v_and_b32 v91, 0xffff0000, v119
    v_sub_f32 v90, v90, v88
    v_sub_f32 v91, v91, v88
    v_cvt_pk_bf16_f32 v119, v90, v91
    v_lshlrev_b32 v90, 16, v119
    v_and_b32 v91, 0xffff0000, v119
    v_mul_f32 v90, v90, v89
    v_mul_f32 v91, v91, v89
    v_cvt_pk_bf16_f32 v119, v90, v91
    ds_write_b128 v4, v[116:119] offset:10240
    v_lshlrev_b32 v90, 16, v120
    v_and_b32 v91, 0xffff0000, v120
    v_sub_f32 v90, v90, v88
    v_sub_f32 v91, v91, v88
    v_cvt_pk_bf16_f32 v120, v90, v91
    v_lshlrev_b32 v90, 16, v120
    v_and_b32 v91, 0xffff0000, v120
    v_mul_f32 v90, v90, v89
    v_mul_f32 v91, v91, v89
    v_cvt_pk_bf16_f32 v120, v90, v91
    v_lshlrev_b32 v90, 16, v121
    v_and_b32 v91, 0xffff0000, v121
    v_sub_f32 v90, v90, v88
    v_sub_f32 v91, v91, v88
    v_cvt_pk_bf16_f32 v121, v90, v91
    v_lshlrev_b32 v90, 16, v121
    v_and_b32 v91, 0xffff0000, v121
    v_mul_f32 v90, v90, v89
    v_mul_f32 v91, v91, v89
    v_cvt_pk_bf16_f32 v121, v90, v91
    v_lshlrev_b32 v90, 16, v122
    v_and_b32 v91, 0xffff0000, v122
    v_sub_f32 v90, v90, v88
    v_sub_f32 v91, v91, v88
    v_cvt_pk_bf16_f32 v122, v90, v91
    v_lshlrev_b32 v90, 16, v122
    v_and_b32 v91, 0xffff0000, v122
    v_mul_f32 v90, v90, v89
    v_mul_f32 v91, v91, v89
    v_cvt_pk_bf16_f32 v122, v90, v91
    v_lshlrev_b32 v90, 16, v123
    v_and_b32 v91, 0xffff0000, v123
    v_sub_f32 v90, v90, v88
    v_sub_f32 v91, v91, v88
    v_cvt_pk_bf16_f32 v123, v90, v91
    v_lshlrev_b32 v90, 16, v123
    v_and_b32 v91, 0xffff0000, v123
    v_mul_f32 v90, v90, v89
    v_mul_f32 v91, v91, v89
    v_cvt_pk_bf16_f32 v123, v90, v91
    ds_write_b128 v4, v[120:123] offset:12288
    v_lshlrev_b32 v90, 16, v124
    v_and_b32 v91, 0xffff0000, v124
    v_sub_f32 v90, v90, v88
    v_sub_f32 v91, v91, v88
    v_cvt_pk_bf16_f32 v124, v90, v91
    v_lshlrev_b32 v90, 16, v124
    v_and_b32 v91, 0xffff0000, v124
    v_mul_f32 v90, v90, v89
    v_mul_f32 v91, v91, v89
    v_cvt_pk_bf16_f32 v124, v90, v91
    v_lshlrev_b32 v90, 16, v125
    v_and_b32 v91, 0xffff0000, v125
    v_sub_f32 v90, v90, v88
    v_sub_f32 v91, v91, v88
    v_cvt_pk_bf16_f32 v125, v90, v91
    v_lshlrev_b32 v90, 16, v125
    v_and_b32 v91, 0xffff0000, v125
    v_mul_f32 v90, v90, v89
    v_mul_f32 v91, v91, v89
    v_cvt_pk_bf16_f32 v125, v90, v91
    v_lshlrev_b32 v90, 16, v126
    v_and_b32 v91, 0xffff0000, v126
    v_sub_f32 v90, v90, v88
    v_sub_f32 v91, v91, v88
    v_cvt_pk_bf16_f32 v126, v90, v91
    v_lshlrev_b32 v90, 16, v126
    v_and_b32 v91, 0xffff0000, v126
    v_mul_f32 v90, v90, v89
    v_mul_f32 v91, v91, v89
    v_cvt_pk_bf16_f32 v126, v90, v91
    v_lshlrev_b32 v90, 16, v127
    v_and_b32 v91, 0xffff0000, v127
    v_sub_f32 v90, v90, v88
    v_sub_f32 v91, v91, v88
    v_cvt_pk_bf16_f32 v127, v90, v91
    v_lshlrev_b32 v90, 16, v127
    v_and_b32 v91, 0xffff0000, v127
    v_mul_f32 v90, v90, v89
    v_mul_f32 v91, v91, v89
    v_cvt_pk_bf16_f32 v127, v90, v91
    ds_write_b128 v4, v[124:127] offset:14336
    s_lshr_b32 s36, s21, 1
    s_lshl_b32 s36, s36, 14
    s_xor_b32 s37, s36, 16384
    v_add_u32 v80, s36, v5
    v_add_u32 v81, s37, v5
    v_add_u32 v82, s36, v6
    v_add_u32 v83, s37, v6
    s_mov_b32 s31, 0
    s_waitcnt vmcnt(24)
    s_barrier
    ds_read_b64_tr_b16 a[128:129], v20 offset:0
    ds_read_b64_tr_b16 a[130:131], v20 offset:1024
    ds_read_b64_tr_b16 a[132:133], v21 offset:0
    ds_read_b64_tr_b16 a[134:135], v21 offset:1024
    ds_read_b64_tr_b16 a[136:137], v22 offset:0
    ds_read_b64_tr_b16 a[138:139], v22 offset:1024
    ds_read_b64_tr_b16 a[140:141], v23 offset:0
    ds_read_b64_tr_b16 a[142:143], v23 offset:1024
    ds_read_b64_tr_b16 a[144:145], v24 offset:0
    ds_read_b64_tr_b16 a[146:147], v24 offset:1024
    ds_read_b64_tr_b16 a[148:149], v25 offset:0
    ds_read_b64_tr_b16 a[150:151], v25 offset:1024
    s_waitcnt lgkmcnt(4)
    ds_read_b64_tr_b16 a[152:153], v26 offset:0
    ds_read_b64_tr_b16 a[154:155], v26 offset:1024
    ds_read_b64_tr_b16 a[156:157], v27 offset:0
    ds_read_b64_tr_b16 a[158:159], v27 offset:1024
    s_waitcnt lgkmcnt(0)
    s_barrier
    s_mov_b32 s96, s48
    s_and_b32 s97, s49, 0xffff
    s_mov_b32 s98, 0x400000
    s_mov_b32 s99, 0x20000
    s_add_u32 m0, s28, 32768
    s_add_u32 s37, s3, 0x0
    buffer_load_dwordx4 v16, s[96:99], s37 offen lds
    s_add_u32 m0, s28, 36864
    s_add_u32 s37, s3, 0x20000
    buffer_load_dwordx4 v16, s[96:99], s37 offen lds
    s_add_u32 m0, s28, 65536
    s_add_u32 s37, s3, 0x40000
    buffer_load_dwordx4 v16, s[96:99], s37 offen lds
    s_add_u32 m0, s28, 69632
    s_add_u32 s37, s3, 0x60000
    buffer_load_dwordx4 v16, s[96:99], s37 offen lds
    s_add_u32 m0, s28, 98304
    s_add_u32 s37, s3, 0x80000
    buffer_load_dwordx4 v16, s[96:99], s37 offen lds
    s_add_u32 m0, s28, 102400
    s_add_u32 s37, s3, 0xa0000
    buffer_load_dwordx4 v16, s[96:99], s37 offen lds
    s_add_u32 m0, s28, 131072
    s_add_u32 s37, s3, 0xc0000
    buffer_load_dwordx4 v16, s[96:99], s37 offen lds
    s_add_u32 m0, s28, 135168
    s_add_u32 s37, s3, 0xe0000
    buffer_load_dwordx4 v16, s[96:99], s37 offen lds
    s_waitcnt vmcnt(24)
    s_barrier
    ds_read_b64_tr_b16 a[160:161], v20 offset:8192
    ds_read_b64_tr_b16 a[162:163], v20 offset:9216
    ds_read_b64_tr_b16 a[164:165], v21 offset:8192
    ds_read_b64_tr_b16 a[166:167], v21 offset:9216
    ds_read_b64_tr_b16 a[168:169], v22 offset:8192
    ds_read_b64_tr_b16 a[170:171], v22 offset:9216
    ds_read_b64_tr_b16 a[172:173], v23 offset:8192
    ds_read_b64_tr_b16 a[174:175], v23 offset:9216
    ds_read_b64_tr_b16 a[176:177], v24 offset:8192
    ds_read_b64_tr_b16 a[178:179], v24 offset:9216
    ds_read_b64_tr_b16 a[180:181], v25 offset:8192
    ds_read_b64_tr_b16 a[182:183], v25 offset:9216
    s_waitcnt lgkmcnt(4)
    ds_read_b64_tr_b16 a[184:185], v26 offset:8192
    ds_read_b64_tr_b16 a[186:187], v26 offset:9216
    ds_read_b64_tr_b16 a[188:189], v27 offset:8192
    ds_read_b64_tr_b16 a[190:191], v27 offset:9216
    s_waitcnt lgkmcnt(0)
    s_barrier
    s_add_u32 m0, s28, 40960
    s_add_u32 s37, s3, 0x100000
    buffer_load_dwordx4 v16, s[96:99], s37 offen lds
    s_add_u32 m0, s28, 45056
    s_add_u32 s37, s3, 0x120000
    buffer_load_dwordx4 v16, s[96:99], s37 offen lds
    s_add_u32 m0, s28, 73728
    s_add_u32 s37, s3, 0x140000
    buffer_load_dwordx4 v16, s[96:99], s37 offen lds
    s_add_u32 m0, s28, 77824
    s_add_u32 s37, s3, 0x160000
    buffer_load_dwordx4 v16, s[96:99], s37 offen lds
    s_add_u32 m0, s28, 106496
    s_add_u32 s37, s3, 0x180000
    buffer_load_dwordx4 v16, s[96:99], s37 offen lds
    s_add_u32 m0, s28, 110592
    s_add_u32 s37, s3, 0x1a0000
    buffer_load_dwordx4 v16, s[96:99], s37 offen lds
    s_add_u32 m0, s28, 139264
    s_add_u32 s37, s3, 0x1c0000
    buffer_load_dwordx4 v16, s[96:99], s37 offen lds
    s_add_u32 m0, s28, 143360
    s_add_u32 s37, s3, 0x1e0000
    buffer_load_dwordx4 v16, s[96:99], s37 offen lds
    s_waitcnt vmcnt(24)
    s_barrier
    ds_read_b64_tr_b16 a[192:193], v20 offset:16384
    ds_read_b64_tr_b16 a[194:195], v20 offset:17408
    ds_read_b64_tr_b16 a[196:197], v21 offset:16384
    ds_read_b64_tr_b16 a[198:199], v21 offset:17408
    ds_read_b64_tr_b16 a[200:201], v22 offset:16384
    ds_read_b64_tr_b16 a[202:203], v22 offset:17408
    ds_read_b64_tr_b16 a[204:205], v23 offset:16384
    ds_read_b64_tr_b16 a[206:207], v23 offset:17408
    ds_read_b64_tr_b16 a[208:209], v24 offset:16384
    ds_read_b64_tr_b16 a[210:211], v24 offset:17408
    ds_read_b64_tr_b16 a[212:213], v25 offset:16384
    ds_read_b64_tr_b16 a[214:215], v25 offset:17408
    s_waitcnt lgkmcnt(4)
    ds_read_b64_tr_b16 a[216:217], v26 offset:16384
    ds_read_b64_tr_b16 a[218:219], v26 offset:17408
    ds_read_b64_tr_b16 a[220:221], v27 offset:16384
    ds_read_b64_tr_b16 a[222:223], v27 offset:17408
    s_waitcnt lgkmcnt(0)
    s_barrier
    s_add_u32 m0, s28, 49152
    s_add_u32 s37, s3, 0x200000
    buffer_load_dwordx4 v16, s[96:99], s37 offen lds
    s_add_u32 m0, s28, 53248
    s_add_u32 s37, s3, 0x220000
    buffer_load_dwordx4 v16, s[96:99], s37 offen lds
    s_add_u32 m0, s28, 81920
    s_add_u32 s37, s3, 0x240000
    buffer_load_dwordx4 v16, s[96:99], s37 offen lds
    s_add_u32 m0, s28, 86016
    s_add_u32 s37, s3, 0x260000
    buffer_load_dwordx4 v16, s[96:99], s37 offen lds
    s_add_u32 m0, s28, 114688
    s_add_u32 s37, s3, 0x280000
    buffer_load_dwordx4 v16, s[96:99], s37 offen lds
    s_add_u32 m0, s28, 118784
    s_add_u32 s37, s3, 0x2a0000
    buffer_load_dwordx4 v16, s[96:99], s37 offen lds
    s_add_u32 m0, s28, 147456
    s_add_u32 s37, s3, 0x2c0000
    buffer_load_dwordx4 v16, s[96:99], s37 offen lds
    s_add_u32 m0, s28, 151552
    s_add_u32 s37, s3, 0x2e0000
    buffer_load_dwordx4 v16, s[96:99], s37 offen lds
    s_waitcnt vmcnt(24)
    s_barrier
    ds_read_b64_tr_b16 a[224:225], v20 offset:24576
    ds_read_b64_tr_b16 a[226:227], v20 offset:25600
    ds_read_b64_tr_b16 a[228:229], v21 offset:24576
    ds_read_b64_tr_b16 a[230:231], v21 offset:25600
    ds_read_b64_tr_b16 a[232:233], v22 offset:24576
    ds_read_b64_tr_b16 a[234:235], v22 offset:25600
    ds_read_b64_tr_b16 a[236:237], v23 offset:24576
    ds_read_b64_tr_b16 a[238:239], v23 offset:25600
    ds_read_b64_tr_b16 a[240:241], v24 offset:24576
    ds_read_b64_tr_b16 a[242:243], v24 offset:25600
    ds_read_b64_tr_b16 a[244:245], v25 offset:24576
    ds_read_b64_tr_b16 a[246:247], v25 offset:25600
    s_waitcnt lgkmcnt(4)
    ds_read_b64_tr_b16 a[248:249], v26 offset:24576
    ds_read_b64_tr_b16 a[250:251], v26 offset:25600
    ds_read_b64_tr_b16 a[252:253], v27 offset:24576
    ds_read_b64_tr_b16 a[254:255], v27 offset:25600
    s_waitcnt lgkmcnt(0)
    s_barrier
    s_add_u32 m0, s28, 57344
    s_add_u32 s37, s3, 0x300000
    buffer_load_dwordx4 v16, s[96:99], s37 offen lds
    s_add_u32 m0, s28, 61440
    s_add_u32 s37, s3, 0x320000
    buffer_load_dwordx4 v16, s[96:99], s37 offen lds
    s_add_u32 m0, s28, 90112
    s_add_u32 s37, s3, 0x340000
    buffer_load_dwordx4 v16, s[96:99], s37 offen lds
    s_add_u32 m0, s28, 94208
    s_add_u32 s37, s3, 0x360000
    buffer_load_dwordx4 v16, s[96:99], s37 offen lds
    s_add_u32 m0, s28, 122880
    s_add_u32 s37, s3, 0x380000
    buffer_load_dwordx4 v16, s[96:99], s37 offen lds
    s_add_u32 m0, s28, 126976
    s_add_u32 s37, s3, 0x3a0000
    buffer_load_dwordx4 v16, s[96:99], s37 offen lds
    s_add_u32 m0, s28, 155648
    s_add_u32 s37, s3, 0x3c0000
    buffer_load_dwordx4 v16, s[96:99], s37 offen lds
    s_add_u32 m0, s28, 159744
    s_add_u32 s37, s3, 0x3e0000
    buffer_load_dwordx4 v16, s[96:99], s37 offen lds
    ds_read_b128 v[64:67], v80 offset:0
    ds_read_b128 v[68:71], v81 offset:0
    ds_read_b128 v[72:75], v82 offset:1024
    ds_read_b128 v[76:79], v83 offset:1024
    s_waitcnt lgkmcnt(2)
    v_mfma_f32_16x16x32_bf16 v[32:35], a[128:131], v[64:67], 0
    v_mfma_f32_16x16x32_bf16 v[36:39], a[128:131], v[68:71], 0
    v_mfma_f32_16x16x32_bf16 v[40:43], a[132:135], v[64:67], 0
    v_mfma_f32_16x16x32_bf16 v[44:47], a[132:135], v[68:71], 0
    v_mfma_f32_16x16x32_bf16 v[48:51], v[64:67], v[128:131], 0
    v_mfma_f32_16x16x32_bf16 v[56:59], v[68:71], v[128:131], 0
    v_mfma_f32_16x16x32_bf16 v[52:55], v[64:67], v[132:135], 0
    v_mfma_f32_16x16x32_bf16 v[60:63], v[68:71], v[132:135], 0
    ds_read_b128 v[64:67], v80 offset:2048
    ds_read_b128 v[68:71], v81 offset:2048
    s_waitcnt lgkmcnt(2)
    v_mfma_f32_16x16x32_bf16 v[32:35], a[136:139], v[72:75], v[32:35]
    v_mfma_f32_16x16x32_bf16 v[36:39], a[136:139], v[76:79], v[36:39]
    v_mfma_f32_16x16x32_bf16 v[40:43], a[140:143], v[72:75], v[40:43]
    v_mfma_f32_16x16x32_bf16 v[44:47], a[140:143], v[76:79], v[44:47]
    v_mfma_f32_16x16x32_bf16 v[48:51], v[72:75], v[136:139], v[48:51]
    v_mfma_f32_16x16x32_bf16 v[56:59], v[76:79], v[136:139], v[56:59]
    v_mfma_f32_16x16x32_bf16 v[52:55], v[72:75], v[140:143], v[52:55]
    v_mfma_f32_16x16x32_bf16 v[60:63], v[76:79], v[140:143], v[60:63]
    ds_read_b128 v[72:75], v82 offset:3072
    ds_read_b128 v[76:79], v83 offset:3072
    s_waitcnt lgkmcnt(2)
    v_mfma_f32_16x16x32_bf16 v[32:35], a[144:147], v[64:67], v[32:35]
    v_mfma_f32_16x16x32_bf16 v[36:39], a[144:147], v[68:71], v[36:39]
    v_mfma_f32_16x16x32_bf16 v[40:43], a[148:151], v[64:67], v[40:43]
    v_mfma_f32_16x16x32_bf16 v[44:47], a[148:151], v[68:71], v[44:47]
    v_mfma_f32_16x16x32_bf16 v[48:51], v[64:67], v[144:147], v[48:51]
    v_mfma_f32_16x16x32_bf16 v[56:59], v[68:71], v[144:147], v[56:59]
    v_mfma_f32_16x16x32_bf16 v[52:55], v[64:67], v[148:151], v[52:55]
    v_mfma_f32_16x16x32_bf16 v[60:63], v[68:71], v[148:151], v[60:63]
    ds_read_b128 v[64:67], v80 offset:4096
    ds_read_b128 v[68:71], v81 offset:4096
    s_waitcnt lgkmcnt(2)
    v_mfma_f32_16x16x32_bf16 v[32:35], a[152:155], v[72:75], v[32:35]
    v_mfma_f32_16x16x32_bf16 v[36:39], a[152:155], v[76:79], v[36:39]
    v_mfma_f32_16x16x32_bf16 v[40:43], a[156:159], v[72:75], v[40:43]
    v_mfma_f32_16x16x32_bf16 v[44:47], a[156:159], v[76:79], v[44:47]
    v_mfma_f32_16x16x32_bf16 v[48:51], v[72:75], v[152:155], v[48:51]
    v_mfma_f32_16x16x32_bf16 v[56:59], v[76:79], v[152:155], v[56:59]
    v_mfma_f32_16x16x32_bf16 v[52:55], v[72:75], v[156:159], v[52:55]
    v_mfma_f32_16x16x32_bf16 v[60:63], v[76:79], v[156:159], v[60:63]
    ds_read_b128 v[72:75], v82 offset:5120
    ds_read_b128 v[76:79], v83 offset:5120
    s_waitcnt lgkmcnt(2)
    v_mfma_f32_16x16x32_bf16 v[32:35], a[160:163], v[64:67], v[32:35]
    v_mfma_f32_16x16x32_bf16 v[36:39], a[160:163], v[68:71], v[36:39]
    v_mfma_f32_16x16x32_bf16 v[40:43], a[164:167], v[64:67], v[40:43]
    v_mfma_f32_16x16x32_bf16 v[44:47], a[164:167], v[68:71], v[44:47]
    v_mfma_f32_16x16x32_bf16 v[48:51], v[64:67], v[160:163], v[48:51]
    v_mfma_f32_16x16x32_bf16 v[56:59], v[68:71], v[160:163], v[56:59]
    v_mfma_f32_16x16x32_bf16 v[52:55], v[64:67], v[164:167], v[52:55]
    v_mfma_f32_16x16x32_bf16 v[60:63], v[68:71], v[164:167], v[60:63]
    ds_read_b128 v[64:67], v80 offset:6144
    ds_read_b128 v[68:71], v81 offset:6144
    s_waitcnt lgkmcnt(2)
    v_mfma_f32_16x16x32_bf16 v[32:35], a[168:171], v[72:75], v[32:35]
    v_mfma_f32_16x16x32_bf16 v[36:39], a[168:171], v[76:79], v[36:39]
    v_mfma_f32_16x16x32_bf16 v[40:43], a[172:175], v[72:75], v[40:43]
    v_mfma_f32_16x16x32_bf16 v[44:47], a[172:175], v[76:79], v[44:47]
    v_mfma_f32_16x16x32_bf16 v[48:51], v[72:75], v[168:171], v[48:51]
    v_mfma_f32_16x16x32_bf16 v[56:59], v[76:79], v[168:171], v[56:59]
    v_mfma_f32_16x16x32_bf16 v[52:55], v[72:75], v[172:175], v[52:55]
    v_mfma_f32_16x16x32_bf16 v[60:63], v[76:79], v[172:175], v[60:63]
    ds_read_b128 v[72:75], v82 offset:7168
    ds_read_b128 v[76:79], v83 offset:7168
    s_waitcnt lgkmcnt(2)
    v_mfma_f32_16x16x32_bf16 v[32:35], a[176:179], v[64:67], v[32:35]
    v_mfma_f32_16x16x32_bf16 v[36:39], a[176:179], v[68:71], v[36:39]
    v_mfma_f32_16x16x32_bf16 v[40:43], a[180:183], v[64:67], v[40:43]
    v_mfma_f32_16x16x32_bf16 v[44:47], a[180:183], v[68:71], v[44:47]
    v_mfma_f32_16x16x32_bf16 v[48:51], v[64:67], v[176:179], v[48:51]
    v_mfma_f32_16x16x32_bf16 v[56:59], v[68:71], v[176:179], v[56:59]
    v_mfma_f32_16x16x32_bf16 v[52:55], v[64:67], v[180:183], v[52:55]
    v_mfma_f32_16x16x32_bf16 v[60:63], v[68:71], v[180:183], v[60:63]
    ds_read_b128 v[64:67], v80 offset:8192
    ds_read_b128 v[68:71], v81 offset:8192
    s_waitcnt lgkmcnt(2)
    v_mfma_f32_16x16x32_bf16 v[32:35], a[184:187], v[72:75], v[32:35]
    v_mfma_f32_16x16x32_bf16 v[36:39], a[184:187], v[76:79], v[36:39]
    v_mfma_f32_16x16x32_bf16 v[40:43], a[188:191], v[72:75], v[40:43]
    v_mfma_f32_16x16x32_bf16 v[44:47], a[188:191], v[76:79], v[44:47]
    v_mfma_f32_16x16x32_bf16 v[48:51], v[72:75], v[184:187], v[48:51]
    v_mfma_f32_16x16x32_bf16 v[56:59], v[76:79], v[184:187], v[56:59]
    v_mfma_f32_16x16x32_bf16 v[52:55], v[72:75], v[188:191], v[52:55]
    v_mfma_f32_16x16x32_bf16 v[60:63], v[76:79], v[188:191], v[60:63]
    ds_read_b128 v[72:75], v82 offset:9216
    ds_read_b128 v[76:79], v83 offset:9216
    s_waitcnt lgkmcnt(2)
    v_mfma_f32_16x16x32_bf16 v[32:35], a[192:195], v[64:67], v[32:35]
    v_mfma_f32_16x16x32_bf16 v[36:39], a[192:195], v[68:71], v[36:39]
    v_mfma_f32_16x16x32_bf16 v[40:43], a[196:199], v[64:67], v[40:43]
    v_mfma_f32_16x16x32_bf16 v[44:47], a[196:199], v[68:71], v[44:47]
    v_mfma_f32_16x16x32_bf16 v[48:51], v[64:67], v[192:195], v[48:51]
    v_mfma_f32_16x16x32_bf16 v[56:59], v[68:71], v[192:195], v[56:59]
    v_mfma_f32_16x16x32_bf16 v[52:55], v[64:67], v[196:199], v[52:55]
    v_mfma_f32_16x16x32_bf16 v[60:63], v[68:71], v[196:199], v[60:63]
    ds_read_b128 v[64:67], v80 offset:10240
    ds_read_b128 v[68:71], v81 offset:10240
    s_waitcnt lgkmcnt(2)
    v_mfma_f32_16x16x32_bf16 v[32:35], a[200:203], v[72:75], v[32:35]
    v_mfma_f32_16x16x32_bf16 v[36:39], a[200:203], v[76:79], v[36:39]
    v_mfma_f32_16x16x32_bf16 v[40:43], a[204:207], v[72:75], v[40:43]
    v_mfma_f32_16x16x32_bf16 v[44:47], a[204:207], v[76:79], v[44:47]
    v_mfma_f32_16x16x32_bf16 v[48:51], v[72:75], v[200:203], v[48:51]
    v_mfma_f32_16x16x32_bf16 v[56:59], v[76:79], v[200:203], v[56:59]
    v_mfma_f32_16x16x32_bf16 v[52:55], v[72:75], v[204:207], v[52:55]
    v_mfma_f32_16x16x32_bf16 v[60:63], v[76:79], v[204:207], v[60:63]
    ds_read_b128 v[72:75], v82 offset:11264
    ds_read_b128 v[76:79], v83 offset:11264
    s_waitcnt lgkmcnt(2)
    v_mfma_f32_16x16x32_bf16 v[32:35], a[208:211], v[64:67], v[32:35]
    v_mfma_f32_16x16x32_bf16 v[36:39], a[208:211], v[68:71], v[36:39]
    v_mfma_f32_16x16x32_bf16 v[40:43], a[212:215], v[64:67], v[40:43]
    v_mfma_f32_16x16x32_bf16 v[44:47], a[212:215], v[68:71], v[44:47]
    v_mfma_f32_16x16x32_bf16 v[48:51], v[64:67], v[208:211], v[48:51]
    v_mfma_f32_16x16x32_bf16 v[56:59], v[68:71], v[208:211], v[56:59]
    v_mfma_f32_16x16x32_bf16 v[52:55], v[64:67], v[212:215], v[52:55]
    v_mfma_f32_16x16x32_bf16 v[60:63], v[68:71], v[212:215], v[60:63]
    ds_read_b128 v[64:67], v80 offset:12288
    ds_read_b128 v[68:71], v81 offset:12288
    s_waitcnt lgkmcnt(2)
    v_mfma_f32_16x16x32_bf16 v[32:35], a[216:219], v[72:75], v[32:35]
    v_mfma_f32_16x16x32_bf16 v[36:39], a[216:219], v[76:79], v[36:39]
    v_mfma_f32_16x16x32_bf16 v[40:43], a[220:223], v[72:75], v[40:43]
    v_mfma_f32_16x16x32_bf16 v[44:47], a[220:223], v[76:79], v[44:47]
    v_mfma_f32_16x16x32_bf16 v[48:51], v[72:75], v[216:219], v[48:51]
    v_mfma_f32_16x16x32_bf16 v[56:59], v[76:79], v[216:219], v[56:59]
    v_mfma_f32_16x16x32_bf16 v[52:55], v[72:75], v[220:223], v[52:55]
    v_mfma_f32_16x16x32_bf16 v[60:63], v[76:79], v[220:223], v[60:63]
    ds_read_b128 v[72:75], v82 offset:13312
    ds_read_b128 v[76:79], v83 offset:13312
    s_waitcnt lgkmcnt(2)
    v_mfma_f32_16x16x32_bf16 v[32:35], a[224:227], v[64:67], v[32:35]
    v_mfma_f32_16x16x32_bf16 v[36:39], a[224:227], v[68:71], v[36:39]
    v_mfma_f32_16x16x32_bf16 v[40:43], a[228:231], v[64:67], v[40:43]
    v_mfma_f32_16x16x32_bf16 v[44:47], a[228:231], v[68:71], v[44:47]
    v_mfma_f32_16x16x32_bf16 v[48:51], v[64:67], v[224:227], v[48:51]
    v_mfma_f32_16x16x32_bf16 v[56:59], v[68:71], v[224:227], v[56:59]
    v_mfma_f32_16x16x32_bf16 v[52:55], v[64:67], v[228:231], v[52:55]
    v_mfma_f32_16x16x32_bf16 v[60:63], v[68:71], v[228:231], v[60:63]
    ds_read_b128 v[64:67], v80 offset:14336
    ds_read_b128 v[68:71], v81 offset:14336
    s_waitcnt lgkmcnt(2)
    v_mfma_f32_16x16x32_bf16 v[32:35], a[232:235], v[72:75], v[32:35]
    v_mfma_f32_16x16x32_bf16 v[36:39], a[232:235], v[76:79], v[36:39]
    v_mfma_f32_16x16x32_bf16 v[40:43], a[236:239], v[72:75], v[40:43]
    v_mfma_f32_16x16x32_bf16 v[44:47], a[236:239], v[76:79], v[44:47]
    v_mfma_f32_16x16x32_bf16 v[48:51], v[72:75], v[232:235], v[48:51]
    v_mfma_f32_16x16x32_bf16 v[56:59], v[76:79], v[232:235], v[56:59]
    v_mfma_f32_16x16x32_bf16 v[52:55], v[72:75], v[236:239], v[52:55]
    v_mfma_f32_16x16x32_bf16 v[60:63], v[76:79], v[236:239], v[60:63]
    ds_read_b128 v[72:75], v82 offset:15360
    ds_read_b128 v[76:79], v83 offset:15360
    s_waitcnt lgkmcnt(2)
    v_mfma_f32_16x16x32_bf16 v[32:35], a[240:243], v[64:67], v[32:35]
    v_mfma_f32_16x16x32_bf16 v[36:39], a[240:243], v[68:71], v[36:39]
    v_mfma_f32_16x16x32_bf16 v[40:43], a[244:247], v[64:67], v[40:43]
    v_mfma_f32_16x16x32_bf16 v[44:47], a[244:247], v[68:71], v[44:47]
    v_mfma_f32_16x16x32_bf16 v[48:51], v[64:67], v[240:243], v[48:51]
    v_mfma_f32_16x16x32_bf16 v[56:59], v[68:71], v[240:243], v[56:59]
    v_mfma_f32_16x16x32_bf16 v[52:55], v[64:67], v[244:247], v[52:55]
    v_mfma_f32_16x16x32_bf16 v[60:63], v[68:71], v[244:247], v[60:63]
    s_waitcnt lgkmcnt(0)
    v_mfma_f32_16x16x32_bf16 v[32:35], a[248:251], v[72:75], v[32:35]
    v_mfma_f32_16x16x32_bf16 v[36:39], a[248:251], v[76:79], v[36:39]
    v_mfma_f32_16x16x32_bf16 v[40:43], a[252:255], v[72:75], v[40:43]
    v_mfma_f32_16x16x32_bf16 v[44:47], a[252:255], v[76:79], v[44:47]
    v_mfma_f32_16x16x32_bf16 v[48:51], v[72:75], v[248:251], v[48:51]
    v_mfma_f32_16x16x32_bf16 v[56:59], v[76:79], v[248:251], v[56:59]
    v_mfma_f32_16x16x32_bf16 v[52:55], v[72:75], v[252:255], v[52:55]
    v_mfma_f32_16x16x32_bf16 v[60:63], v[76:79], v[252:255], v[60:63]
    s_nop 0
    v_mul_f32 v32, s33, v32
    v_mul_f32 v33, s33, v33
    v_mul_f32 v34, s33, v34
    v_mul_f32 v35, s33, v35
    v_mul_f32 v36, s33, v36
    v_mul_f32 v37, s33, v37
    v_mul_f32 v38, s33, v38
    v_mul_f32 v39, s33, v39
    v_mul_f32 v40, s33, v40
    v_mul_f32 v41, s33, v41
    v_mul_f32 v42, s33, v42
    v_mul_f32 v43, s33, v43
    v_mul_f32 v44, s33, v44
    v_mul_f32 v45, s33, v45
    v_mul_f32 v46, s33, v46
    v_mul_f32 v47, s33, v47
    v_cvt_pk_bf16_f32 v88, v32, v40
    v_cvt_pk_bf16_f32 v89, v33, v41
    v_cvt_pk_bf16_f32 v90, v34, v42
    v_cvt_pk_bf16_f32 v91, v35, v43
    v_cvt_pk_bf16_f32 v92, v36, v44
    v_cvt_pk_bf16_f32 v93, v37, v45
    v_cvt_pk_bf16_f32 v94, v38, v46
    v_cvt_pk_bf16_f32 v95, v39, v47
    v_cvt_pk_bf16_f32 v96, v48, v49
    v_cvt_pk_bf16_f32 v97, v50, v51
    v_cvt_pk_bf16_f32 v98, v56, v57
    v_cvt_pk_bf16_f32 v99, v58, v59
    v_cvt_pk_bf16_f32 v100, v52, v53
    v_cvt_pk_bf16_f32 v101, v54, v55
    v_cvt_pk_bf16_f32 v102, v60, v61
    v_cvt_pk_bf16_f32 v103, v62, v63
    s_mul_i32 s24, s23, 0x82100
    s_lshl_b32 s36, s20, 14
    s_add_u32 s24, s24, s36
    s_add_u32 s24, s24, 0x1000000
    s_mov_b32 s30, s24
    s_lshr_b32 s36, s21, 1
    s_lshl_b32 s36, s36, 12
    s_xor_b32 s37, s36, 4096
    s_add_u32 s36, s36, s24
    s_add_u32 s37, s37, s24
    buffer_store_dwordx4 v[88:91], v9, s[8:11], s36 offen sc1
    buffer_store_dwordx4 v[92:95], v9, s[8:11], s37 offen sc1
    s_add_u32 s24, s24, 8192
    buffer_store_dwordx4 v[96:99], v2, s[8:11], s24 offen sc1
    buffer_store_dwordx4 v[100:103], v2, s[8:11], s24 offen offset:1024 sc1
    s_mul_i32 s25, s23, 0x82100
    s_lshl_b32 s36, s20, 2
    s_add_u32 s25, s25, s36
    s_add_u32 s25, s25, 0x1082000
    v_lshrrev_b32 v15, 2, v1
    v_and_b32 v15, 127, v15
L_WHS:
    buffer_load_dword v14, v15, s[16:19], 0 offen sc1
    s_add_u32 s32, s32, 1
    s_cmp_gt_u32 s32, 200000
    s_cbranch_scc1 L_WHS_done
    s_waitcnt vmcnt(0)
    v_cmp_eq_u32 vcc, 0, v14
    s_cbranch_vccnz L_WHS
L_WHS_done:
    s_waitcnt vmcnt(0)
    s_barrier
    v_cmp_ne_u32 vcc, 0, v0
    v_mov_b32 v15, 0x40000000
    v_mov_b32 v14, 1
    v_cndmask_b32 v15, v0, v15, vcc
    buffer_store_dword v14, v15, s[8:11], s25 offen sc1
    s_barrier
    ds_read_b64_tr_b16 a[0:1], v20 offset:0
    ds_read_b64_tr_b16 a[2:3], v20 offset:1024
    ds_read_b64_tr_b16 a[4:5], v21 offset:0
    ds_read_b64_tr_b16 a[6:7], v21 offset:1024
    ds_read_b64_tr_b16 a[8:9], v22 offset:0
    ds_read_b64_tr_b16 a[10:11], v22 offset:1024
    ds_read_b64_tr_b16 a[12:13], v23 offset:0
    ds_read_b64_tr_b16 a[14:15], v23 offset:1024
    ds_read_b64_tr_b16 a[16:17], v24 offset:0
    ds_read_b64_tr_b16 a[18:19], v24 offset:1024
    ds_read_b64_tr_b16 a[20:21], v25 offset:0
    ds_read_b64_tr_b16 a[22:23], v25 offset:1024
    s_waitcnt lgkmcnt(4)
    ds_read_b64_tr_b16 a[24:25], v26 offset:0
    ds_read_b64_tr_b16 a[26:27], v26 offset:1024
    ds_read_b64_tr_b16 a[28:29], v27 offset:0
    ds_read_b64_tr_b16 a[30:31], v27 offset:1024
    s_waitcnt lgkmcnt(0)
    s_barrier
    s_barrier
    ds_read_b64_tr_b16 a[32:33], v20 offset:8192
    ds_read_b64_tr_b16 a[34:35], v20 offset:9216
    ds_read_b64_tr_b16 a[36:37], v21 offset:8192
    ds_read_b64_tr_b16 a[38:39], v21 offset:9216
    ds_read_b64_tr_b16 a[40:41], v22 offset:8192
    ds_read_b64_tr_b16 a[42:43], v22 offset:9216
    ds_read_b64_tr_b16 a[44:45], v23 offset:8192
    ds_read_b64_tr_b16 a[46:47], v23 offset:9216
    ds_read_b64_tr_b16 a[48:49], v24 offset:8192
    ds_read_b64_tr_b16 a[50:51], v24 offset:9216
    ds_read_b64_tr_b16 a[52:53], v25 offset:8192
    ds_read_b64_tr_b16 a[54:55], v25 offset:9216
    s_waitcnt lgkmcnt(4)
    ds_read_b64_tr_b16 a[56:57], v26 offset:8192
    ds_read_b64_tr_b16 a[58:59], v26 offset:9216
    ds_read_b64_tr_b16 a[60:61], v27 offset:8192
    ds_read_b64_tr_b16 a[62:63], v27 offset:9216
    s_waitcnt lgkmcnt(0)
    s_barrier
    s_barrier
    ds_read_b64_tr_b16 a[64:65], v20 offset:16384
    ds_read_b64_tr_b16 a[66:67], v20 offset:17408
    ds_read_b64_tr_b16 a[68:69], v21 offset:16384
    ds_read_b64_tr_b16 a[70:71], v21 offset:17408
    ds_read_b64_tr_b16 a[72:73], v22 offset:16384
    ds_read_b64_tr_b16 a[74:75], v22 offset:17408
    ds_read_b64_tr_b16 a[76:77], v23 offset:16384
    ds_read_b64_tr_b16 a[78:79], v23 offset:17408
    ds_read_b64_tr_b16 a[80:81], v24 offset:16384
    ds_read_b64_tr_b16 a[82:83], v24 offset:17408
    ds_read_b64_tr_b16 a[84:85], v25 offset:16384
    ds_read_b64_tr_b16 a[86:87], v25 offset:17408
    s_waitcnt lgkmcnt(4)
    ds_read_b64_tr_b16 a[88:89], v26 offset:16384
    ds_read_b64_tr_b16 a[90:91], v26 offset:17408
    ds_read_b64_tr_b16 a[92:93], v27 offset:16384
    ds_read_b64_tr_b16 a[94:95], v27 offset:17408
    s_waitcnt lgkmcnt(0)
    s_barrier
    s_barrier
    ds_read_b64_tr_b16 a[96:97], v20 offset:24576
    ds_read_b64_tr_b16 a[98:99], v20 offset:25600
    ds_read_b64_tr_b16 a[100:101], v21 offset:24576
    ds_read_b64_tr_b16 a[102:103], v21 offset:25600
    ds_read_b64_tr_b16 a[104:105], v22 offset:24576
    ds_read_b64_tr_b16 a[106:107], v22 offset:25600
    ds_read_b64_tr_b16 a[108:109], v23 offset:24576
    ds_read_b64_tr_b16 a[110:111], v23 offset:25600
    ds_read_b64_tr_b16 a[112:113], v24 offset:24576
    ds_read_b64_tr_b16 a[114:115], v24 offset:25600
    ds_read_b64_tr_b16 a[116:117], v25 offset:24576
    ds_read_b64_tr_b16 a[118:119], v25 offset:25600
    s_waitcnt lgkmcnt(4)
    ds_read_b64_tr_b16 a[120:121], v26 offset:24576
    ds_read_b64_tr_b16 a[122:123], v26 offset:25600
    ds_read_b64_tr_b16 a[124:125], v27 offset:24576
    ds_read_b64_tr_b16 a[126:127], v27 offset:25600
    s_waitcnt lgkmcnt(0)
    s_barrier
L_P1:
    s_waitcnt vmcnt(6)
    s_barrier
    s_xor_b32 s31, s31, 32768
    s_add_u32 s24, s23, 6
    s_min_u32 s24, s24, 63
    s_lshl_b32 s36, s24, 15
    s_add_u32 s36, s36, 0x800000
    s_lshl_b32 s37, s21, 10
    s_add_u32 s37, s37, s31
    s_add_u32 m0, s37, 0
    s_add_u32 s38, s36, 0
    buffer_load_dwordx4 v9, s[8:11], s38 offen sc1 lds
    s_add_u32 m0, s37, 4096
    s_add_u32 s38, s36, 4096
    buffer_load_dwordx4 v9, s[8:11], s38 offen sc1 lds
    s_add_u32 m0, s37, 8192
    s_add_u32 s38, s36, 8192
    buffer_load_dwordx4 v9, s[8:11], s38 offen sc1 lds
    s_add_u32 m0, s37, 12288
    s_add_u32 s38, s36, 12288
    buffer_load_dwordx4 v9, s[8:11], s38 offen sc1 lds
    s_add_u32 m0, s37, 16384
    s_add_u32 s38, s36, 16384
    buffer_load_dwordx4 v9, s[8:11], s38 offen sc1 lds
    s_add_u32 m0, s37, 20480
    s_add_u32 s38, s36, 20480
    buffer_load_dwordx4 v9, s[8:11], s38 offen sc1 lds
    s_add_u32 m0, s37, 24576
    s_add_u32 s38, s36, 24576
    buffer_load_dwordx4 v9, s[8:11], s38 offen sc1 lds
    s_add_u32 m0, s37, 28672
    s_add_u32 s38, s36, 28672
    buffer_load_dwordx4 v9, s[8:11], s38 offen sc1 lds
    ds_read_b128 v[64:67], v80 offset:0
    ds_read_b128 v[68:71], v81 offset:0
    ds_read_b128 v[72:75], v82 offset:1024
    ds_read_b128 v[76:79], v83 offset:1024
    s_waitcnt lgkmcnt(2)
    v_mfma_f32_16x16x32_bf16 v[32:35], a[128:131], v[64:67], 0
    v_mfma_f32_16x16x32_bf16 v[36:39], a[128:131], v[68:71], 0
    v_mfma_f32_16x16x32_bf16 v[40:43], a[132:135], v[64:67], 0
    v_mfma_f32_16x16x32_bf16 v[44:47], a[132:135], v[68:71], 0
    v_mfma_f32_16x16x32_bf16 v[48:51], v[64:67], v[128:131], 0
    v_mfma_f32_16x16x32_bf16 v[56:59], v[68:71], v[128:131], 0
    v_mfma_f32_16x16x32_bf16 v[52:55], v[64:67], v[132:135], 0
    v_mfma_f32_16x16x32_bf16 v[60:63], v[68:71], v[132:135], 0
    v_mfma_f32_16x16x32_bf16 v[16:19], a[0:3], v[64:67], 0
    v_mfma_f32_16x16x32_bf16 v[20:23], a[0:3], v[68:71], 0
    v_mfma_f32_16x16x32_bf16 v[24:27], a[4:7], v[64:67], 0
    v_mfma_f32_16x16x32_bf16 v[28:31], a[4:7], v[68:71], 0
    ds_read_b128 v[64:67], v80 offset:2048
    ds_read_b128 v[68:71], v81 offset:2048
    s_waitcnt lgkmcnt(2)
    v_mfma_f32_16x16x32_bf16 v[32:35], a[136:139], v[72:75], v[32:35]
    v_mfma_f32_16x16x32_bf16 v[36:39], a[136:139], v[76:79], v[36:39]
    v_mfma_f32_16x16x32_bf16 v[40:43], a[140:143], v[72:75], v[40:43]
    v_mfma_f32_16x16x32_bf16 v[44:47], a[140:143], v[76:79], v[44:47]
    v_mfma_f32_16x16x32_bf16 v[48:51], v[72:75], v[136:139], v[48:51]
    v_mfma_f32_16x16x32_bf16 v[56:59], v[76:79], v[136:139], v[56:59]
    v_mfma_f32_16x16x32_bf16 v[52:55], v[72:75], v[140:143], v[52:55]
    v_mfma_f32_16x16x32_bf16 v[60:63], v[76:79], v[140:143], v[60:63]
    v_mfma_f32_16x16x32_bf16 v[16:19], a[8:11], v[72:75], v[16:19]
    v_mfma_f32_16x16x32_bf16 v[20:23], a[8:11], v[76:79], v[20:23]
    v_mfma_f32_16x16x32_bf16 v[24:27], a[12:15], v[72:75], v[24:27]
    v_mfma_f32_16x16x32_bf16 v[28:31], a[12:15], v[76:79], v[28:31]
    ds_read_b128 v[72:75], v82 offset:3072
    ds_read_b128 v[76:79], v83 offset:3072
    s_waitcnt lgkmcnt(2)
    v_mfma_f32_16x16x32_bf16 v[32:35], a[144:147], v[64:67], v[32:35]
    v_mfma_f32_16x16x32_bf16 v[36:39], a[144:147], v[68:71], v[36:39]
    v_mfma_f32_16x16x32_bf16 v[40:43], a[148:151], v[64:67], v[40:43]
    v_mfma_f32_16x16x32_bf16 v[44:47], a[148:151], v[68:71], v[44:47]
    v_mfma_f32_16x16x32_bf16 v[48:51], v[64:67], v[144:147], v[48:51]
    v_mfma_f32_16x16x32_bf16 v[56:59], v[68:71], v[144:147], v[56:59]
    v_mfma_f32_16x16x32_bf16 v[52:55], v[64:67], v[148:151], v[52:55]
    v_mfma_f32_16x16x32_bf16 v[60:63], v[68:71], v[148:151], v[60:63]
    v_mfma_f32_16x16x32_bf16 v[16:19], a[16:19], v[64:67], v[16:19]
    v_mfma_f32_16x16x32_bf16 v[20:23], a[16:19], v[68:71], v[20:23]
    v_mfma_f32_16x16x32_bf16 v[24:27], a[20:23], v[64:67], v[24:27]
    v_mfma_f32_16x16x32_bf16 v[28:31], a[20:23], v[68:71], v[28:31]
    ds_read_b128 v[64:67], v80 offset:4096
    ds_read_b128 v[68:71], v81 offset:4096
    s_waitcnt lgkmcnt(2)
    v_mfma_f32_16x16x32_bf16 v[32:35], a[152:155], v[72:75], v[32:35]
    v_mfma_f32_16x16x32_bf16 v[36:39], a[152:155], v[76:79], v[36:39]
    v_mfma_f32_16x16x32_bf16 v[40:43], a[156:159], v[72:75], v[40:43]
    v_mfma_f32_16x16x32_bf16 v[44:47], a[156:159], v[76:79], v[44:47]
    v_mfma_f32_16x16x32_bf16 v[48:51], v[72:75], v[152:155], v[48:51]
    v_mfma_f32_16x16x32_bf16 v[56:59], v[76:79], v[152:155], v[56:59]
    v_mfma_f32_16x16x32_bf16 v[52:55], v[72:75], v[156:159], v[52:55]
    v_mfma_f32_16x16x32_bf16 v[60:63], v[76:79], v[156:159], v[60:63]
    v_mfma_f32_16x16x32_bf16 v[16:19], a[24:27], v[72:75], v[16:19]
    v_mfma_f32_16x16x32_bf16 v[20:23], a[24:27], v[76:79], v[20:23]
    v_mfma_f32_16x16x32_bf16 v[24:27], a[28:31], v[72:75], v[24:27]
    v_mfma_f32_16x16x32_bf16 v[28:31], a[28:31], v[76:79], v[28:31]
    ds_read_b128 v[72:75], v82 offset:5120
    ds_read_b128 v[76:79], v83 offset:5120
    s_waitcnt lgkmcnt(2)
    v_mfma_f32_16x16x32_bf16 v[32:35], a[160:163], v[64:67], v[32:35]
    v_mfma_f32_16x16x32_bf16 v[36:39], a[160:163], v[68:71], v[36:39]
    v_mfma_f32_16x16x32_bf16 v[40:43], a[164:167], v[64:67], v[40:43]
    v_mfma_f32_16x16x32_bf16 v[44:47], a[164:167], v[68:71], v[44:47]
    v_mfma_f32_16x16x32_bf16 v[48:51], v[64:67], v[160:163], v[48:51]
    v_mfma_f32_16x16x32_bf16 v[56:59], v[68:71], v[160:163], v[56:59]
    v_mfma_f32_16x16x32_bf16 v[52:55], v[64:67], v[164:167], v[52:55]
    v_mfma_f32_16x16x32_bf16 v[60:63], v[68:71], v[164:167], v[60:63]
    v_mfma_f32_16x16x32_bf16 v[16:19], a[32:35], v[64:67], v[16:19]
    v_mfma_f32_16x16x32_bf16 v[20:23], a[32:35], v[68:71], v[20:23]
    v_mfma_f32_16x16x32_bf16 v[24:27], a[36:39], v[64:67], v[24:27]
    v_mfma_f32_16x16x32_bf16 v[28:31], a[36:39], v[68:71], v[28:31]
    ds_read_b128 v[64:67], v80 offset:6144
    ds_read_b128 v[68:71], v81 offset:6144
    s_waitcnt lgkmcnt(2)
    v_mfma_f32_16x16x32_bf16 v[32:35], a[168:171], v[72:75], v[32:35]
    v_mfma_f32_16x16x32_bf16 v[36:39], a[168:171], v[76:79], v[36:39]
    v_mfma_f32_16x16x32_bf16 v[40:43], a[172:175], v[72:75], v[40:43]
    v_mfma_f32_16x16x32_bf16 v[44:47], a[172:175], v[76:79], v[44:47]
    v_mfma_f32_16x16x32_bf16 v[48:51], v[72:75], v[168:171], v[48:51]
    v_mfma_f32_16x16x32_bf16 v[56:59], v[76:79], v[168:171], v[56:59]
    v_mfma_f32_16x16x32_bf16 v[52:55], v[72:75], v[172:175], v[52:55]
    v_mfma_f32_16x16x32_bf16 v[60:63], v[76:79], v[172:175], v[60:63]
    v_mfma_f32_16x16x32_bf16 v[16:19], a[40:43], v[72:75], v[16:19]
    v_mfma_f32_16x16x32_bf16 v[20:23], a[40:43], v[76:79], v[20:23]
    v_mfma_f32_16x16x32_bf16 v[24:27], a[44:47], v[72:75], v[24:27]
    v_mfma_f32_16x16x32_bf16 v[28:31], a[44:47], v[76:79], v[28:31]
    ds_read_b128 v[72:75], v82 offset:7168
    ds_read_b128 v[76:79], v83 offset:7168
    s_waitcnt lgkmcnt(2)
    s_waitcnt vmcnt(8)
    s_barrier
    v_cmp_ne_u32 vcc, 0, v0
    v_mov_b32 v15, 0x40000000
    v_mov_b32 v14, 1
    v_cndmask_b32 v15, v0, v15, vcc
    buffer_store_dword v14, v15, s[8:11], s25 offen sc1
    v_mfma_f32_16x16x32_bf16 v[32:35], a[176:179], v[64:67], v[32:35]
    v_mfma_f32_16x16x32_bf16 v[36:39], a[176:179], v[68:71], v[36:39]
    v_mfma_f32_16x16x32_bf16 v[40:43], a[180:183], v[64:67], v[40:43]
    v_mfma_f32_16x16x32_bf16 v[44:47], a[180:183], v[68:71], v[44:47]
    v_mfma_f32_16x16x32_bf16 v[48:51], v[64:67], v[176:179], v[48:51]
    v_mfma_f32_16x16x32_bf16 v[56:59], v[68:71], v[176:179], v[56:59]
    v_mfma_f32_16x16x32_bf16 v[52:55], v[64:67], v[180:183], v[52:55]
    v_mfma_f32_16x16x32_bf16 v[60:63], v[68:71], v[180:183], v[60:63]
    v_mfma_f32_16x16x32_bf16 v[16:19], a[48:51], v[64:67], v[16:19]
    v_mfma_f32_16x16x32_bf16 v[20:23], a[48:51], v[68:71], v[20:23]
    v_mfma_f32_16x16x32_bf16 v[24:27], a[52:55], v[64:67], v[24:27]
    v_mfma_f32_16x16x32_bf16 v[28:31], a[52:55], v[68:71], v[28:31]
    ds_read_b128 v[64:67], v80 offset:8192
    ds_read_b128 v[68:71], v81 offset:8192
    s_waitcnt lgkmcnt(2)
    v_mfma_f32_16x16x32_bf16 v[32:35], a[184:187], v[72:75], v[32:35]
    v_mfma_f32_16x16x32_bf16 v[36:39], a[184:187], v[76:79], v[36:39]
    v_mfma_f32_16x16x32_bf16 v[40:43], a[188:191], v[72:75], v[40:43]
    v_mfma_f32_16x16x32_bf16 v[44:47], a[188:191], v[76:79], v[44:47]
    v_mfma_f32_16x16x32_bf16 v[48:51], v[72:75], v[184:187], v[48:51]
    v_mfma_f32_16x16x32_bf16 v[56:59], v[76:79], v[184:187], v[56:59]
    v_mfma_f32_16x16x32_bf16 v[52:55], v[72:75], v[188:191], v[52:55]
    v_mfma_f32_16x16x32_bf16 v[60:63], v[76:79], v[188:191], v[60:63]
    v_mfma_f32_16x16x32_bf16 v[16:19], a[56:59], v[72:75], v[16:19]
    v_mfma_f32_16x16x32_bf16 v[20:23], a[56:59], v[76:79], v[20:23]
    v_mfma_f32_16x16x32_bf16 v[24:27], a[60:63], v[72:75], v[24:27]
    v_mfma_f32_16x16x32_bf16 v[28:31], a[60:63], v[76:79], v[28:31]
    ds_read_b128 v[72:75], v82 offset:9216
    ds_read_b128 v[76:79], v83 offset:9216
    s_waitcnt lgkmcnt(2)
    v_mfma_f32_16x16x32_bf16 v[32:35], a[192:195], v[64:67], v[32:35]
    v_mfma_f32_16x16x32_bf16 v[36:39], a[192:195], v[68:71], v[36:39]
    v_mfma_f32_16x16x32_bf16 v[40:43], a[196:199], v[64:67], v[40:43]
    v_mfma_f32_16x16x32_bf16 v[44:47], a[196:199], v[68:71], v[44:47]
    v_mfma_f32_16x16x32_bf16 v[48:51], v[64:67], v[192:195], v[48:51]
    v_mfma_f32_16x16x32_bf16 v[56:59], v[68:71], v[192:195], v[56:59]
    v_mfma_f32_16x16x32_bf16 v[52:55], v[64:67], v[196:199], v[52:55]
    v_mfma_f32_16x16x32_bf16 v[60:63], v[68:71], v[196:199], v[60:63]
    v_mfma_f32_16x16x32_bf16 v[16:19], a[64:67], v[64:67], v[16:19]
    v_mfma_f32_16x16x32_bf16 v[20:23], a[64:67], v[68:71], v[20:23]
    v_mfma_f32_16x16x32_bf16 v[24:27], a[68:71], v[64:67], v[24:27]
    v_mfma_f32_16x16x32_bf16 v[28:31], a[68:71], v[68:71], v[28:31]
    ds_read_b128 v[64:67], v80 offset:10240
    ds_read_b128 v[68:71], v81 offset:10240
    s_waitcnt lgkmcnt(2)
    v_mfma_f32_16x16x32_bf16 v[32:35], a[200:203], v[72:75], v[32:35]
    v_mfma_f32_16x16x32_bf16 v[36:39], a[200:203], v[76:79], v[36:39]
    v_mfma_f32_16x16x32_bf16 v[40:43], a[204:207], v[72:75], v[40:43]
    v_mfma_f32_16x16x32_bf16 v[44:47], a[204:207], v[76:79], v[44:47]
    v_mfma_f32_16x16x32_bf16 v[48:51], v[72:75], v[200:203], v[48:51]
    v_mfma_f32_16x16x32_bf16 v[56:59], v[76:79], v[200:203], v[56:59]
    v_mfma_f32_16x16x32_bf16 v[52:55], v[72:75], v[204:207], v[52:55]
    v_mfma_f32_16x16x32_bf16 v[60:63], v[76:79], v[204:207], v[60:63]
    v_mfma_f32_16x16x32_bf16 v[16:19], a[72:75], v[72:75], v[16:19]
    v_mfma_f32_16x16x32_bf16 v[20:23], a[72:75], v[76:79], v[20:23]
    v_mfma_f32_16x16x32_bf16 v[24:27], a[76:79], v[72:75], v[24:27]
    v_mfma_f32_16x16x32_bf16 v[28:31], a[76:79], v[76:79], v[28:31]
    ds_read_b128 v[72:75], v82 offset:11264
    ds_read_b128 v[76:79], v83 offset:11264
    s_waitcnt lgkmcnt(2)
    v_mfma_f32_16x16x32_bf16 v[32:35], a[208:211], v[64:67], v[32:35]
    v_mfma_f32_16x16x32_bf16 v[36:39], a[208:211], v[68:71], v[36:39]
    v_mfma_f32_16x16x32_bf16 v[40:43], a[212:215], v[64:67], v[40:43]
    v_mfma_f32_16x16x32_bf16 v[44:47], a[212:215], v[68:71], v[44:47]
    v_mfma_f32_16x16x32_bf16 v[48:51], v[64:67], v[208:211], v[48:51]
    v_mfma_f32_16x16x32_bf16 v[56:59], v[68:71], v[208:211], v[56:59]
    v_mfma_f32_16x16x32_bf16 v[52:55], v[64:67], v[212:215], v[52:55]
    v_mfma_f32_16x16x32_bf16 v[60:63], v[68:71], v[212:215], v[60:63]
    v_mfma_f32_16x16x32_bf16 v[16:19], a[80:83], v[64:67], v[16:19]
    v_mfma_f32_16x16x32_bf16 v[20:23], a[80:83], v[68:71], v[20:23]
    v_mfma_f32_16x16x32_bf16 v[24:27], a[84:87], v[64:67], v[24:27]
    v_mfma_f32_16x16x32_bf16 v[28:31], a[84:87], v[68:71], v[28:31]
    ds_read_b128 v[64:67], v80 offset:12288
    ds_read_b128 v[68:71], v81 offset:12288
    s_waitcnt lgkmcnt(2)
    v_mfma_f32_16x16x32_bf16 v[32:35], a[216:219], v[72:75], v[32:35]
    v_mfma_f32_16x16x32_bf16 v[36:39], a[216:219], v[76:79], v[36:39]
    v_mfma_f32_16x16x32_bf16 v[40:43], a[220:223], v[72:75], v[40:43]
    v_mfma_f32_16x16x32_bf16 v[44:47], a[220:223], v[76:79], v[44:47]
    v_mfma_f32_16x16x32_bf16 v[48:51], v[72:75], v[216:219], v[48:51]
    v_mfma_f32_16x16x32_bf16 v[56:59], v[76:79], v[216:219], v[56:59]
    v_mfma_f32_16x16x32_bf16 v[52:55], v[72:75], v[220:223], v[52:55]
    v_mfma_f32_16x16x32_bf16 v[60:63], v[76:79], v[220:223], v[60:63]
    v_mfma_f32_16x16x32_bf16 v[16:19], a[88:91], v[72:75], v[16:19]
    v_mfma_f32_16x16x32_bf16 v[20:23], a[88:91], v[76:79], v[20:23]
    v_mfma_f32_16x16x32_bf16 v[24:27], a[92:95], v[72:75], v[24:27]
    v_mfma_f32_16x16x32_bf16 v[28:31], a[92:95], v[76:79], v[28:31]
    ds_read_b128 v[72:75], v82 offset:13312
    ds_read_b128 v[76:79], v83 offset:13312
    s_waitcnt lgkmcnt(2)
    v_mfma_f32_16x16x32_bf16 v[32:35], a[224:227], v[64:67], v[32:35]
    v_mfma_f32_16x16x32_bf16 v[36:39], a[224:227], v[68:71], v[36:39]
    v_mfma_f32_16x16x32_bf16 v[40:43], a[228:231], v[64:67], v[40:43]
    v_mfma_f32_16x16x32_bf16 v[44:47], a[228:231], v[68:71], v[44:47]
    v_mfma_f32_16x16x32_bf16 v[48:51], v[64:67], v[224:227], v[48:51]
    v_mfma_f32_16x16x32_bf16 v[56:59], v[68:71], v[224:227], v[56:59]
    v_mfma_f32_16x16x32_bf16 v[52:55], v[64:67], v[228:231], v[52:55]
    v_mfma_f32_16x16x32_bf16 v[60:63], v[68:71], v[228:231], v[60:63]
    v_mfma_f32_16x16x32_bf16 v[16:19], a[96:99], v[64:67], v[16:19]
    v_mfma_f32_16x16x32_bf16 v[20:23], a[96:99], v[68:71], v[20:23]
    v_mfma_f32_16x16x32_bf16 v[24:27], a[100:103], v[64:67], v[24:27]
    v_mfma_f32_16x16x32_bf16 v[28:31], a[100:103], v[68:71], v[28:31]
    ds_read_b128 v[64:67], v80 offset:14336
    ds_read_b128 v[68:71], v81 offset:14336
    s_waitcnt lgkmcnt(2)
    v_mfma_f32_16x16x32_bf16 v[32:35], a[232:235], v[72:75], v[32:35]
    v_mfma_f32_16x16x32_bf16 v[36:39], a[232:235], v[76:79], v[36:39]
    v_mfma_f32_16x16x32_bf16 v[40:43], a[236:239], v[72:75], v[40:43]
    v_mfma_f32_16x16x32_bf16 v[44:47], a[236:239], v[76:79], v[44:47]
    v_mfma_f32_16x16x32_bf16 v[48:51], v[72:75], v[232:235], v[48:51]
    v_mfma_f32_16x16x32_bf16 v[56:59], v[76:79], v[232:235], v[56:59]
    v_mfma_f32_16x16x32_bf16 v[52:55], v[72:75], v[236:239], v[52:55]
    v_mfma_f32_16x16x32_bf16 v[60:63], v[76:79], v[236:239], v[60:63]
    v_mfma_f32_16x16x32_bf16 v[16:19], a[104:107], v[72:75], v[16:19]
    v_mfma_f32_16x16x32_bf16 v[20:23], a[104:107], v[76:79], v[20:23]
    v_mfma_f32_16x16x32_bf16 v[24:27], a[108:111], v[72:75], v[24:27]
    v_mfma_f32_16x16x32_bf16 v[28:31], a[108:111], v[76:79], v[28:31]
    ds_read_b128 v[72:75], v82 offset:15360
    ds_read_b128 v[76:79], v83 offset:15360
    s_waitcnt lgkmcnt(2)
    v_mfma_f32_16x16x32_bf16 v[32:35], a[240:243], v[64:67], v[32:35]
    v_mfma_f32_16x16x32_bf16 v[36:39], a[240:243], v[68:71], v[36:39]
    v_mfma_f32_16x16x32_bf16 v[40:43], a[244:247], v[64:67], v[40:43]
    v_mfma_f32_16x16x32_bf16 v[44:47], a[244:247], v[68:71], v[44:47]
    v_mfma_f32_16x16x32_bf16 v[48:51], v[64:67], v[240:243], v[48:51]
    v_mfma_f32_16x16x32_bf16 v[56:59], v[68:71], v[240:243], v[56:59]
    v_mfma_f32_16x16x32_bf16 v[52:55], v[64:67], v[244:247], v[52:55]
    v_mfma_f32_16x16x32_bf16 v[60:63], v[68:71], v[244:247], v[60:63]
    v_mfma_f32_16x16x32_bf16 v[16:19], a[112:115], v[64:67], v[16:19]
    v_mfma_f32_16x16x32_bf16 v[20:23], a[112:115], v[68:71], v[20:23]
    v_mfma_f32_16x16x32_bf16 v[24:27], a[116:119], v[64:67], v[24:27]
    v_mfma_f32_16x16x32_bf16 v[28:31], a[116:119], v[68:71], v[28:31]
    s_waitcnt lgkmcnt(0)
    v_mfma_f32_16x16x32_bf16 v[32:35], a[248:251], v[72:75], v[32:35]
    v_mfma_f32_16x16x32_bf16 v[36:39], a[248:251], v[76:79], v[36:39]
    v_mfma_f32_16x16x32_bf16 v[40:43], a[252:255], v[72:75], v[40:43]
    v_mfma_f32_16x16x32_bf16 v[44:47], a[252:255], v[76:79], v[44:47]
    v_mfma_f32_16x16x32_bf16 v[48:51], v[72:75], v[248:251], v[48:51]
    v_mfma_f32_16x16x32_bf16 v[56:59], v[76:79], v[248:251], v[56:59]
    v_mfma_f32_16x16x32_bf16 v[52:55], v[72:75], v[252:255], v[52:55]
    v_mfma_f32_16x16x32_bf16 v[60:63], v[76:79], v[252:255], v[60:63]
    v_mfma_f32_16x16x32_bf16 v[16:19], a[120:123], v[72:75], v[16:19]
    v_mfma_f32_16x16x32_bf16 v[20:23], a[120:123], v[76:79], v[20:23]
    v_mfma_f32_16x16x32_bf16 v[24:27], a[124:127], v[72:75], v[24:27]
    v_mfma_f32_16x16x32_bf16 v[28:31], a[124:127], v[76:79], v[28:31]
    v_xor_b32 v80, 0x8000, v80
    v_xor_b32 v81, 0x8000, v81
    v_xor_b32 v82, 0x8000, v82
    v_xor_b32 v83, 0x8000, v83
    v_mul_f32 v32, s33, v32
    v_mul_f32 v33, s33, v33
    v_mul_f32 v34, s33, v34
    v_mul_f32 v35, s33, v35
    v_mul_f32 v36, s33, v36
    v_mul_f32 v37, s33, v37
    v_mul_f32 v38, s33, v38
    v_mul_f32 v39, s33, v39
    v_mul_f32 v40, s33, v40
    v_mul_f32 v41, s33, v41
    v_mul_f32 v42, s33, v42
    v_mul_f32 v43, s33, v43
    v_mul_f32 v44, s33, v44
    v_mul_f32 v45, s33, v45
    v_mul_f32 v46, s33, v46
    v_mul_f32 v47, s33, v47
    v_cvt_pk_bf16_f32 v88, v32, v40
    v_cvt_pk_bf16_f32 v89, v33, v41
    v_cvt_pk_bf16_f32 v90, v34, v42
    v_cvt_pk_bf16_f32 v91, v35, v43
    v_cvt_pk_bf16_f32 v92, v36, v44
    v_cvt_pk_bf16_f32 v93, v37, v45
    v_cvt_pk_bf16_f32 v94, v38, v46
    v_cvt_pk_bf16_f32 v95, v39, v47
    v_cvt_pk_bf16_f32 v96, v48, v49
    v_cvt_pk_bf16_f32 v97, v50, v51
    v_cvt_pk_bf16_f32 v98, v56, v57
    v_cvt_pk_bf16_f32 v99, v58, v59
    v_cvt_pk_bf16_f32 v100, v52, v53
    v_cvt_pk_bf16_f32 v101, v54, v55
    v_cvt_pk_bf16_f32 v102, v60, v61
    v_cvt_pk_bf16_f32 v103, v62, v63
    v_cvt_pk_bf16_f32 v104, v16, v24
    v_cvt_pk_bf16_f32 v105, v17, v25
    v_cvt_pk_bf16_f32 v106, v18, v26
    v_cvt_pk_bf16_f32 v107, v19, v27
    v_cvt_pk_bf16_f32 v108, v20, v28
    v_cvt_pk_bf16_f32 v109, v21, v29
    v_cvt_pk_bf16_f32 v110, v22, v30
    v_cvt_pk_bf16_f32 v111, v23, v31
    s_mul_i32 s24, s23, 0x82100
    s_lshl_b32 s36, s20, 14
    s_add_u32 s24, s24, s36
    s_add_u32 s24, s24, 0x1000000
    s_mov_b32 s30, s24
    s_lshr_b32 s36, s21, 1
    s_lshl_b32 s36, s36, 12
    s_xor_b32 s37, s36, 4096
    s_add_u32 s36, s36, s24
    s_add_u32 s37, s37, s24
    buffer_store_dwordx4 v[88:91], v9, s[8:11], s36 offen sc1
    buffer_store_dwordx4 v[92:95], v9, s[8:11], s37 offen sc1
    s_add_u32 s24, s24, 8192
    buffer_store_dwordx4 v[96:99], v2, s[8:11], s24 offen sc1
    buffer_store_dwordx4 v[100:103], v2, s[8:11], s24 offen offset:1024 sc1
    s_add_u32 s36, s36, 0x7000000
    s_add_u32 s37, s37, 0x7000000
    buffer_store_dwordx4 v[104:107], v9, s[8:11], s36 offen sc1
    buffer_store_dwordx4 v[108:111], v9, s[8:11], s37 offen sc1
    s_mul_i32 s25, s23, 0x82100
    s_lshl_b32 s36, s20, 2
    s_add_u32 s25, s25, s36
    s_add_u32 s25, s25, 0x1082000
    s_add_u32 s23, s23, 6
    s_cmp_lt_u32 s23, 64
    s_cbranch_scc1 L_P1
    v_mov_b32 v20, -1
    v_mov_b32 v21, -1
    v_mov_b32 v22, -1
    v_mov_b32 v23, -1
    s_lshl_b32 s24, s22, 21
    s_lshl_b32 s36, s20, 15
    s_add_u32 s24, s24, s36
    s_add_u32 s36, s24, 0x4000000
    buffer_store_dwordx4 v[20:23], v11, s[8:11], s36 offen sc1
    s_add_u32 s36, s24, 0x4001000
    buffer_store_dwordx4 v[20:23], v11, s[8:11], s36 offen sc1
    s_add_u32 s36, s24, 0x4002000
    buffer_store_dwordx4 v[20:23], v11, s[8:11], s36 offen sc1
    s_add_u32 s36, s24, 0x4003000
    buffer_store_dwordx4 v[20:23], v11, s[8:11], s36 offen sc1
    s_add_u32 s36, s24, 0x4004000
    buffer_store_dwordx4 v[20:23], v11, s[8:11], s36 offen sc1
    s_add_u32 s36, s24, 0x4005000
    buffer_store_dwordx4 v[20:23], v11, s[8:11], s36 offen sc1
    s_add_u32 s36, s24, 0x4006000
    buffer_store_dwordx4 v[20:23], v11, s[8:11], s36 offen sc1
    s_add_u32 s36, s24, 0x4007000
    buffer_store_dwordx4 v[20:23], v11, s[8:11], s36 offen sc1
    s_add_u32 s36, s24, 0x4100000
    buffer_store_dwordx4 v[20:23], v11, s[8:11], s36 offen sc1
    s_add_u32 s36, s24, 0x4101000
    buffer_store_dwordx4 v[20:23], v11, s[8:11], s36 offen sc1
    s_add_u32 s36, s24, 0x4102000
    buffer_store_dwordx4 v[20:23], v11, s[8:11], s36 offen sc1
    s_add_u32 s36, s24, 0x4103000
    buffer_store_dwordx4 v[20:23], v11, s[8:11], s36 offen sc1
    s_add_u32 s36, s24, 0x4104000
    buffer_store_dwordx4 v[20:23], v11, s[8:11], s36 offen sc1
    s_add_u32 s36, s24, 0x4105000
    buffer_store_dwordx4 v[20:23], v11, s[8:11], s36 offen sc1
    s_add_u32 s36, s24, 0x4106000
    buffer_store_dwordx4 v[20:23], v11, s[8:11], s36 offen sc1
    s_add_u32 s36, s24, 0x4107000
    buffer_store_dwordx4 v[20:23], v11, s[8:11], s36 offen sc1
    s_waitcnt vmcnt(0)
    s_barrier
    v_cmp_ne_u32 vcc, 0, v0
    v_mov_b32 v15, 0x40000000
    v_mov_b32 v14, 1
    v_cndmask_b32 v15, v0, v15, vcc
    buffer_store_dword v14, v15, s[8:11], s25 offen sc1
    s_lshl_b32 s25, s22, 7
    s_lshl_b32 s36, s20, 2
    s_add_u32 s36, s36, s25
    s_add_u32 s36, s36, 0x192000
    v_cmp_ne_u32 vcc, 0, v0
    v_mov_b32 v15, 0x40000000
    v_mov_b32 v14, 1
    v_cndmask_b32 v15, v0, v15, vcc
    buffer_store_dword v14, v15, s[8:11], s36 offen sc1
    s_mov_b32 s96, s54
    s_and_b32 s97, s55, 0xffff
    s_mov_b32 s98, 0x400000
    s_mov_b32 s99, 0x20000
    v_mov_b32 v15, 0x0
    v_bfe_u32 v14, v0, 0, 1
    s_mov_b32 s38, 0x10
    v_mad_u32_u24 v15, v14, s38, v15
    v_bfe_u32 v14, v0, 1, 1
    s_mov_b32 s38, 0x20
    v_mad_u32_u24 v15, v14, s38, v15
    v_bfe_u32 v14, v0, 2, 1
    s_mov_b32 s38, 0x40
    v_mad_u32_u24 v15, v14, s38, v15
    v_bfe_u32 v14, v0, 3, 1
    s_mov_b32 s38, 0x80
    v_mad_u32_u24 v15, v14, s38, v15
    v_bfe_u32 v14, v0, 4, 1
    s_mov_b32 s38, 0x1000
    v_mad_u32_u24 v15, v14, s38, v15
    v_bfe_u32 v14, v0, 5, 1
    s_mov_b32 s38, 0x2000
    v_mad_u32_u24 v15, v14, s38, v15
    v_bfe_u32 v14, v0, 6, 1
    s_mov_b32 s38, 0x100
    v_mad_u32_u24 v15, v14, s38, v15
    v_bfe_u32 v14, v0, 7, 1
    s_mov_b32 s38, 0x200
    v_mad_u32_u24 v15, v14, s38, v15
    s_lshl_b32 s36, s20, 17
    s_add_u32 s37, s36, 0x0
    buffer_load_dwordx4 v[16:19], v15, s[96:99], s37 offen
    s_add_u32 s37, s36, 0x4000
    buffer_load_dwordx4 v[20:23], v15, s[96:99], s37 offen
    s_add_u32 s37, s36, 0x400
    buffer_load_dwordx4 v[24:27], v15, s[96:99], s37 offen
    s_add_u32 s37, s36, 0x4400
    buffer_load_dwordx4 v[28:31], v15, s[96:99], s37 offen
    s_add_u32 s37, s36, 0x800
    buffer_load_dwordx4 v[32:35], v15, s[96:99], s37 offen
    s_add_u32 s37, s36, 0x4800
    buffer_load_dwordx4 v[36:39], v15, s[96:99], s37 offen
    s_add_u32 s37, s36, 0xc00
    buffer_load_dwordx4 v[40:43], v15, s[96:99], s37 offen
    s_add_u32 s37, s36, 0x4c00
    buffer_load_dwordx4 v[44:47], v15, s[96:99], s37 offen
    s_add_u32 s37, s36, 0x8000
    buffer_load_dwordx4 v[48:51], v15, s[96:99], s37 offen
    s_add_u32 s37, s36, 0xc000
    buffer_load_dwordx4 v[52:55], v15, s[96:99], s37 offen
    s_add_u32 s37, s36, 0x8400
    buffer_load_dwordx4 v[56:59], v15, s[96:99], s37 offen
    s_add_u32 s37, s36, 0xc400
    buffer_load_dwordx4 v[60:63], v15, s[96:99], s37 offen
    s_add_u32 s37, s36, 0x8800
    buffer_load_dwordx4 v[64:67], v15, s[96:99], s37 offen
    s_add_u32 s37, s36, 0xc800
    buffer_load_dwordx4 v[68:71], v15, s[96:99], s37 offen
    s_add_u32 s37, s36, 0x8c00
    buffer_load_dwordx4 v[72:75], v15, s[96:99], s37 offen
    s_add_u32 s37, s36, 0xcc00
    buffer_load_dwordx4 v[76:79], v15, s[96:99], s37 offen
    s_add_u32 s37, s36, 0x10000
    buffer_load_dwordx4 v[80:83], v15, s[96:99], s37 offen
    s_add_u32 s37, s36, 0x14000
    buffer_load_dwordx4 v[84:87], v15, s[96:99], s37 offen
    s_add_u32 s37, s36, 0x10400
    buffer_load_dwordx4 v[88:91], v15, s[96:99], s37 offen
    s_add_u32 s37, s36, 0x14400
    buffer_load_dwordx4 v[92:95], v15, s[96:99], s37 offen
    s_add_u32 s37, s36, 0x10800
    buffer_load_dwordx4 v[96:99], v15, s[96:99], s37 offen
    s_add_u32 s37, s36, 0x14800
    buffer_load_dwordx4 v[100:103], v15, s[96:99], s37 offen
    s_add_u32 s37, s36, 0x10c00
    buffer_load_dwordx4 v[104:107], v15, s[96:99], s37 offen
    s_add_u32 s37, s36, 0x14c00
    buffer_load_dwordx4 v[108:111], v15, s[96:99], s37 offen
    s_waitcnt vmcnt(16)
    v_perm_b32 v112, v20, v16, s34
    v_perm_b32 v113, v28, v24, s34
    v_perm_b32 v114, v36, v32, s34
    v_perm_b32 v115, v44, v40, s34
    ds_write_b128 v7, v[112:115] offset:0
    v_perm_b32 v116, v20, v16, s35
    v_perm_b32 v117, v28, v24, s35
    v_perm_b32 v118, v36, v32, s35
    v_perm_b32 v119, v44, v40, s35
    ds_write_b128 v7, v[116:119] offset:1024
    v_perm_b32 v120, v21, v17, s34
    v_perm_b32 v121, v29, v25, s34
    v_perm_b32 v122, v37, v33, s34
    v_perm_b32 v123, v45, v41, s34
    ds_write_b128 v7, v[120:123] offset:2048
    v_perm_b32 v124, v21, v17, s35
    v_perm_b32 v125, v29, v25, s35
    v_perm_b32 v126, v37, v33, s35
    v_perm_b32 v127, v45, v41, s35
    ds_write_b128 v7, v[124:127] offset:3072
    s_waitcnt lgkmcnt(0)
    v_perm_b32 v112, v22, v18, s34
    v_perm_b32 v113, v30, v26, s34
    v_perm_b32 v114, v38, v34, s34
    v_perm_b32 v115, v46, v42, s34
    ds_write_b128 v7, v[112:115] offset:4096
    v_perm_b32 v116, v22, v18, s35
    v_perm_b32 v117, v30, v26, s35
    v_perm_b32 v118, v38, v34, s35
    v_perm_b32 v119, v46, v42, s35
    ds_write_b128 v7, v[116:119] offset:5120
    v_perm_b32 v120, v23, v19, s34
    v_perm_b32 v121, v31, v27, s34
    v_perm_b32 v122, v39, v35, s34
    v_perm_b32 v123, v47, v43, s34
    ds_write_b128 v7, v[120:123] offset:6144
    v_perm_b32 v124, v23, v19, s35
    v_perm_b32 v125, v31, v27, s35
    v_perm_b32 v126, v39, v35, s35
    v_perm_b32 v127, v47, v43, s35
    ds_write_b128 v7, v[124:127] offset:7168
    s_waitcnt lgkmcnt(0)
    s_add_u32 s37, s36, 0x18000
    buffer_load_dwordx4 v[16:19], v15, s[96:99], s37 offen
    s_add_u32 s37, s36, 0x1c000
    buffer_load_dwordx4 v[20:23], v15, s[96:99], s37 offen
    s_add_u32 s37, s36, 0x18400
    buffer_load_dwordx4 v[24:27], v15, s[96:99], s37 offen
    s_add_u32 s37, s36, 0x1c400
    buffer_load_dwordx4 v[28:31], v15, s[96:99], s37 offen
    s_add_u32 s37, s36, 0x18800
    buffer_load_dwordx4 v[32:35], v15, s[96:99], s37 offen
    s_add_u32 s37, s36, 0x1c800
    buffer_load_dwordx4 v[36:39], v15, s[96:99], s37 offen
    s_add_u32 s37, s36, 0x18c00
    buffer_load_dwordx4 v[40:43], v15, s[96:99], s37 offen
    s_add_u32 s37, s36, 0x1cc00
    buffer_load_dwordx4 v[44:47], v15, s[96:99], s37 offen
    s_waitcnt vmcnt(16)
    v_perm_b32 v112, v52, v48, s34
    v_perm_b32 v113, v60, v56, s34
    v_perm_b32 v114, v68, v64, s34
    v_perm_b32 v115, v76, v72, s34
    ds_write_b128 v7, v[112:115] offset:8192
    v_perm_b32 v116, v52, v48, s35
    v_perm_b32 v117, v60, v56, s35
    v_perm_b32 v118, v68, v64, s35
    v_perm_b32 v119, v76, v72, s35
    ds_write_b128 v7, v[116:119] offset:9216
    v_perm_b32 v120, v53, v49, s34
    v_perm_b32 v121, v61, v57, s34
    v_perm_b32 v122, v69, v65, s34
    v_perm_b32 v123, v77, v73, s34
    ds_write_b128 v7, v[120:123] offset:10240
    v_perm_b32 v124, v53, v49, s35
    v_perm_b32 v125, v61, v57, s35
    v_perm_b32 v126, v69, v65, s35
    v_perm_b32 v127, v77, v73, s35
    ds_write_b128 v7, v[124:127] offset:11264
    s_waitcnt lgkmcnt(0)
    v_perm_b32 v112, v54, v50, s34
    v_perm_b32 v113, v62, v58, s34
    v_perm_b32 v114, v70, v66, s34
    v_perm_b32 v115, v78, v74, s34
    ds_write_b128 v7, v[112:115] offset:12288
    v_perm_b32 v116, v54, v50, s35
    v_perm_b32 v117, v62, v58, s35
    v_perm_b32 v118, v70, v66, s35
    v_perm_b32 v119, v78, v74, s35
    ds_write_b128 v7, v[116:119] offset:13312
    v_perm_b32 v120, v55, v51, s34
    v_perm_b32 v121, v63, v59, s34
    v_perm_b32 v122, v71, v67, s34
    v_perm_b32 v123, v79, v75, s34
    ds_write_b128 v7, v[120:123] offset:14336
    v_perm_b32 v124, v55, v51, s35
    v_perm_b32 v125, v63, v59, s35
    v_perm_b32 v126, v71, v67, s35
    v_perm_b32 v127, v79, v75, s35
    ds_write_b128 v7, v[124:127] offset:15360
    s_waitcnt lgkmcnt(0)
    s_waitcnt vmcnt(8)
    v_perm_b32 v112, v84, v80, s34
    v_perm_b32 v113, v92, v88, s34
    v_perm_b32 v114, v100, v96, s34
    v_perm_b32 v115, v108, v104, s34
    ds_write_b128 v7, v[112:115] offset:16384
    v_perm_b32 v116, v84, v80, s35
    v_perm_b32 v117, v92, v88, s35
    v_perm_b32 v118, v100, v96, s35
    v_perm_b32 v119, v108, v104, s35
    ds_write_b128 v7, v[116:119] offset:17408
    v_perm_b32 v120, v85, v81, s34
    v_perm_b32 v121, v93, v89, s34
    v_perm_b32 v122, v101, v97, s34
    v_perm_b32 v123, v109, v105, s34
    ds_write_b128 v7, v[120:123] offset:18432
    v_perm_b32 v124, v85, v81, s35
    v_perm_b32 v125, v93, v89, s35
    v_perm_b32 v126, v101, v97, s35
    v_perm_b32 v127, v109, v105, s35
    ds_write_b128 v7, v[124:127] offset:19456
    s_waitcnt lgkmcnt(0)
    v_perm_b32 v112, v86, v82, s34
    v_perm_b32 v113, v94, v90, s34
    v_perm_b32 v114, v102, v98, s34
    v_perm_b32 v115, v110, v106, s34
    ds_write_b128 v7, v[112:115] offset:20480
    v_perm_b32 v116, v86, v82, s35
    v_perm_b32 v117, v94, v90, s35
    v_perm_b32 v118, v102, v98, s35
    v_perm_b32 v119, v110, v106, s35
    ds_write_b128 v7, v[116:119] offset:21504
    v_perm_b32 v120, v87, v83, s34
    v_perm_b32 v121, v95, v91, s34
    v_perm_b32 v122, v103, v99, s34
    v_perm_b32 v123, v111, v107, s34
    ds_write_b128 v7, v[120:123] offset:22528
    v_perm_b32 v124, v87, v83, s35
    v_perm_b32 v125, v95, v91, s35
    v_perm_b32 v126, v103, v99, s35
    v_perm_b32 v127, v111, v107, s35
    ds_write_b128 v7, v[124:127] offset:23552
    s_waitcnt lgkmcnt(0)
    s_waitcnt vmcnt(0)
    v_perm_b32 v112, v20, v16, s34
    v_perm_b32 v113, v28, v24, s34
    v_perm_b32 v114, v36, v32, s34
    v_perm_b32 v115, v44, v40, s34
    ds_write_b128 v7, v[112:115] offset:24576
    v_perm_b32 v116, v20, v16, s35
    v_perm_b32 v117, v28, v24, s35
    v_perm_b32 v118, v36, v32, s35
    v_perm_b32 v119, v44, v40, s35
    ds_write_b128 v7, v[116:119] offset:25600
    v_perm_b32 v120, v21, v17, s34
    v_perm_b32 v121, v29, v25, s34
    v_perm_b32 v122, v37, v33, s34
    v_perm_b32 v123, v45, v41, s34
    ds_write_b128 v7, v[120:123] offset:26624
    v_perm_b32 v124, v21, v17, s35
    v_perm_b32 v125, v29, v25, s35
    v_perm_b32 v126, v37, v33, s35
    v_perm_b32 v127, v45, v41, s35
    ds_write_b128 v7, v[124:127] offset:27648
    s_waitcnt lgkmcnt(0)
    v_perm_b32 v112, v22, v18, s34
    v_perm_b32 v113, v30, v26, s34
    v_perm_b32 v114, v38, v34, s34
    v_perm_b32 v115, v46, v42, s34
    ds_write_b128 v7, v[112:115] offset:28672
    v_perm_b32 v116, v22, v18, s35
    v_perm_b32 v117, v30, v26, s35
    v_perm_b32 v118, v38, v34, s35
    v_perm_b32 v119, v46, v42, s35
    ds_write_b128 v7, v[116:119] offset:29696
    v_perm_b32 v120, v23, v19, s34
    v_perm_b32 v121, v31, v27, s34
    v_perm_b32 v122, v39, v35, s34
    v_perm_b32 v123, v47, v43, s34
    ds_write_b128 v7, v[120:123] offset:30720
    v_perm_b32 v124, v23, v19, s35
    v_perm_b32 v125, v31, v27, s35
    v_perm_b32 v126, v39, v35, s35
    v_perm_b32 v127, v47, v43, s35
    ds_write_b128 v7, v[124:127] offset:31744
    s_waitcnt lgkmcnt(0)
    s_lshl_b32 s25, s22, 7
    s_add_u32 s25, s25, 0x192000
    v_lshrrev_b32 v15, 2, v1
    v_and_b32 v15, 127, v15
L_TPI:
    buffer_load_dword v14, v15, s[8:11], s25 offen sc1
    s_add_u32 s32, s32, 1
    s_cmp_gt_u32 s32, 200000
    s_waitcnt vmcnt(0)
    s_cbranch_scc1 L_TPI_ok
    v_cmp_eq_u32 vcc, 0, v14
    s_cbranch_vccz L_TPI_ok
    s_sleep 8
    s_branch L_TPI
L_TPI_ok:
    s_mov_b32 s23, s22
    s_mov_b32 s29, 0
    s_mov_b32 s30, 0x40000000
    s_mul_i32 s24, s23, 0x82100
    s_lshl_b32 s36, s20, 14
    s_add_u32 s24, s24, s36
    s_add_u32 s24, s24, 0x1000000
    s_add_u32 s36, s24, 0
    s_add_u32 s37, s36, 0x7000000
    buffer_load_dwordx4 a[32:35], v1, s[8:11], s36 offen offset:0 sc1
    buffer_load_dwordx4 a[0:3], v1, s[8:11], s37 offen offset:0 sc1
    buffer_load_dwordx4 a[36:39], v1, s[8:11], s36 offen offset:1024 sc1
    buffer_load_dwordx4 a[4:7], v1, s[8:11], s37 offen offset:1024 sc1
    buffer_load_dwordx4 a[40:43], v1, s[8:11], s36 offen offset:2048 sc1
    buffer_load_dwordx4 a[8:11], v1, s[8:11], s37 offen offset:2048 sc1
    buffer_load_dwordx4 a[44:47], v1, s[8:11], s36 offen offset:3072 sc1
    buffer_load_dwordx4 a[12:15], v1, s[8:11], s37 offen offset:3072 sc1
    s_add_u32 s36, s24, 4096
    s_add_u32 s37, s36, 0x7000000
    buffer_load_dwordx4 a[48:51], v1, s[8:11], s36 offen offset:0 sc1
    buffer_load_dwordx4 a[16:19], v1, s[8:11], s37 offen offset:0 sc1
    buffer_load_dwordx4 a[52:55], v1, s[8:11], s36 offen offset:1024 sc1
    buffer_load_dwordx4 a[20:23], v1, s[8:11], s37 offen offset:1024 sc1
    buffer_load_dwordx4 a[56:59], v1, s[8:11], s36 offen offset:2048 sc1
    buffer_load_dwordx4 a[24:27], v1, s[8:11], s37 offen offset:2048 sc1
    buffer_load_dwordx4 a[60:63], v1, s[8:11], s36 offen offset:3072 sc1
    buffer_load_dwordx4 a[28:31], v1, s[8:11], s37 offen offset:3072 sc1
    s_lshr_b32 s36, s21, 1
    s_lshl_b32 s36, s36, 3
    s_xor_b32 s37, s36, 8
    s_add_u32 s24, s24, 8192
    s_add_u32 s36, s36, s24
    s_add_u32 s37, s37, s24
    buffer_load_dwordx2 a[64:65], v2, s[8:11], s36 offen offset:0 sc1
    buffer_load_dwordx2 a[66:67], v2, s[8:11], s37 offen offset:0 sc1
    buffer_load_dwordx2 a[68:69], v2, s[8:11], s36 offen offset:1024 sc1
    buffer_load_dwordx2 a[70:71], v2, s[8:11], s37 offen offset:1024 sc1
L_P2:
    s_and_b32 s36, s29, 1
    s_lshl_b32 s36, s36, 20
    s_lshl_b32 s26, s22, 21
    s_add_u32 s26, s26, s36
    s_add_u32 s26, s26, 0x4000000
    s_bfe_u32 s27, s29, 0x10001
    s_lshl_b32 s24, s23, 13
    s_add_u32 s24, s24, 0x100000
    s_max_u32 s25, s23, 1
    s_lshl_b32 s25, s25, 13
    s_add_u32 s25, s25, 0xfe000
    buffer_load_dwordx4 v[48:51], v2, s[8:11], s24 offen sc1
    buffer_load_dwordx4 v[52:55], v2, s[8:11], s24 offen offset:1024 sc1
    s_lshl_b32 s36, s23, 5
    s_add_u32 s36, s36, s20
    s_lshl_b32 s36, s36, 10
    buffer_load_dword a72, v12, s[12:15], s36 offen
    buffer_load_dword a73, v12, s[92:95], 0 offen
    s_waitcnt vmcnt(4)
    v_cmp_ne_u32 vcc, 0, v1
    v_mov_b32 v15, 0x40000000
    v_mov_b32 v14, 0
    v_cndmask_b32 v15, v1, v15, vcc
    buffer_store_dword v14, v15, s[8:11], s30 offen sc1
    v_mfma_f32_16x16x32_bf16 v[80:83], a[32:35], a[0:3], 0
    v_mfma_f32_16x16x32_bf16 v[80:83], a[36:39], a[4:7], v[80:83]
    v_mfma_f32_16x16x32_bf16 v[80:83], a[40:43], a[8:11], v[80:83]
    v_mfma_f32_16x16x32_bf16 v[80:83], a[44:47], a[12:15], v[80:83]
    v_mfma_f32_16x16x32_bf16 v[88:91], a[48:51], a[16:19], 0
    v_mfma_f32_16x16x32_bf16 v[88:91], a[52:55], a[20:23], v[88:91]
    v_mfma_f32_16x16x32_bf16 v[88:91], a[56:59], a[24:27], v[88:91]
    v_mfma_f32_16x16x32_bf16 v[88:91], a[60:63], a[28:31], v[88:91]
    v_mfma_f32_16x16x32_bf16 v[84:87], a[32:35], a[16:19], 0
    v_mfma_f32_16x16x32_bf16 v[84:87], a[36:39], a[20:23], v[84:87]
    v_mfma_f32_16x16x32_bf16 v[84:87], a[40:43], a[24:27], v[84:87]
    v_mfma_f32_16x16x32_bf16 v[84:87], a[44:47], a[28:31], v[84:87]
    v_cndmask_b32 v80, v13, v80, s[64:65]
    v_cndmask_b32 v81, v13, v81, s[66:67]
    v_cndmask_b32 v82, v13, v82, s[68:69]
    v_cndmask_b32 v83, v13, v83, s[70:71]
    v_cndmask_b32 v88, v13, v88, s[64:65]
    v_cndmask_b32 v89, v13, v89, s[66:67]
    v_cndmask_b32 v90, v13, v90, s[68:69]
    v_cndmask_b32 v91, v13, v91, s[70:71]
    v_max_f32 v116, v80, v81
    v_max3_f32 v116, v116, v82, v83
    v_max_f32 v117, v84, v85
    v_max3_f32 v117, v117, v86, v87
    v_max3_f32 v117, v117, v88, v89
    v_max3_f32 v117, v117, v90, v91
    v_mov_b32 v14, v116
    s_nop 1
    v_permlane16_swap_b32 v116, v14
    v_max_f32 v116, v116, v14
    v_mov_b32 v14, v117
    s_nop 1
    v_permlane16_swap_b32 v117, v14
    v_max_f32 v117, v117, v14
    v_mov_b32 v14, v116
    s_nop 1
    v_permlane32_swap_b32 v116, v14
    v_max_f32 v116, v116, v14
    v_mov_b32 v14, v117
    s_nop 1
    v_permlane32_swap_b32 v117, v14
    v_max_f32 v117, v117, v14
    v_sub_f32 v80, v80, v116
    v_exp_f32 v80, v80
    v_sub_f32 v81, v81, v116
    v_exp_f32 v81, v81
    v_sub_f32 v82, v82, v116
    v_exp_f32 v82, v82
    v_sub_f32 v83, v83, v116
    v_exp_f32 v83, v83
    v_sub_f32 v84, v84, v117
    v_exp_f32 v84, v84
    v_sub_f32 v85, v85, v117
    v_exp_f32 v85, v85
    v_sub_f32 v86, v86, v117
    v_exp_f32 v86, v86
    v_sub_f32 v87, v87, v117
    v_exp_f32 v87, v87
    v_sub_f32 v88, v88, v117
    v_exp_f32 v88, v88
    v_sub_f32 v89, v89, v117
    v_exp_f32 v89, v89
    v_sub_f32 v90, v90, v117
    v_exp_f32 v90, v90
    v_sub_f32 v91, v91, v117
    v_exp_f32 v91, v91
    v_cvt_pk_bf16_f32 v100, v80, v81
    v_cvt_pk_bf16_f32 v101, v82, v83
    v_mov_b64 v[102:103], 0
    v_cvt_pk_bf16_f32 v104, v84, v85
    v_cvt_pk_bf16_f32 v105, v86, v87
    v_cvt_pk_bf16_f32 v106, v88, v89
    v_cvt_pk_bf16_f32 v107, v90, v91
    v_mov_b64 v[108:109], s[4:5]
    v_mov_b64 v[110:111], s[4:5]
    v_cndmask_b32 v112, 0, v108, s[72:73]
    v_cndmask_b32 v113, 0, v108, s[72:73]
    v_mfma_f32_16x16x32_bf16 v[16:19], v[108:111], v[100:103], 0
    v_mfma_f32_16x16x32_bf16 v[24:27], a[64:67], v[100:103], 0
    v_mfma_f32_16x16x32_bf16 v[28:31], a[68:71], v[100:103], 0
    v_mfma_f32_16x16x32_bf16 v[20:23], v[108:111], v[104:107], 0
    v_mfma_f32_16x16x32_bf16 v[32:35], a[64:67], v[104:107], 0
    v_mfma_f32_16x16x32_bf16 v[36:39], a[68:71], v[104:107], 0
    s_branch L_P2_chk
L_P2_far:
    buffer_load_dword v14, v2, s[8:11], s25 offen sc1
    s_add_u32 s32, s32, 1
    s_cmp_gt_u32 s32, 200000
    s_waitcnt vmcnt(0)
    s_cbranch_scc1 L_P2_poll
    v_cmp_eq_u32 vcc, -1, v14
    s_cbranch_vccz L_P2_near
    s_sleep 12
    s_branch L_P2_far
L_P2_near:
    s_mov_b32 s25, 0x40000000
L_P2_poll:
    buffer_load_dwordx4 v[48:51], v2, s[8:11], s24 offen sc1
    buffer_load_dwordx4 v[52:55], v2, s[8:11], s24 offen offset:1024 sc1
L_P2_chk:
    s_add_u32 s32, s32, 1
    s_waitcnt vmcnt(0)
    ds_write_b128 v2, v[48:51] offset:20480
    ds_write_b128 v2, v[52:55] offset:21504
    v_max3_u32 v14, v48, v49, v50
    v_max3_u32 v15, v51, v52, v53
    v_max3_u32 v14, v14, v54, v55
    v_max_u32 v14, v14, v15
    v_cmp_eq_u32 vcc, -1, v14
    s_cbranch_vccz L_P2_got
    s_cmp_gt_u32 s32, 200000
    s_cbranch_scc1 L_P2_got
    s_cmp_eq_u32 s25, 0x40000000
    s_cbranch_scc1 L_P2_poll
    s_branch L_P2_far
L_P2_got:
    s_waitcnt lgkmcnt(0)
    s_barrier
    ds_read_b128 v[48:51], v8 offset:0
    ds_read_b128 v[52:55], v8 offset:2048
    ds_read_b128 v[56:59], v8 offset:4096
    ds_read_b128 v[60:63], v8 offset:6144
    s_waitcnt lgkmcnt(3)
    v_mfma_f32_16x16x32_bf16 v[80:83], a[128:131], v[48:51], 0
    v_mfma_f32_16x16x32_bf16 v[84:87], a[132:135], v[48:51], 0
    ds_read_b128 v[48:51], v8 offset:512
    s_waitcnt lgkmcnt(3)
    v_mfma_f32_16x16x32_bf16 v[80:83], a[136:139], v[52:55], v[80:83]
    v_mfma_f32_16x16x32_bf16 v[84:87], a[140:143], v[52:55], v[84:87]
    ds_read_b128 v[52:55], v8 offset:2560
    s_waitcnt lgkmcnt(3)
    v_mfma_f32_16x16x32_bf16 v[80:83], a[144:147], v[56:59], v[80:83]
    v_mfma_f32_16x16x32_bf16 v[84:87], a[148:151], v[56:59], v[84:87]
    ds_read_b128 v[56:59], v8 offset:4608
    s_waitcnt lgkmcnt(3)
    v_mfma_f32_16x16x32_bf16 v[80:83], a[152:155], v[60:63], v[80:83]
    v_mfma_f32_16x16x32_bf16 v[84:87], a[156:159], v[60:63], v[84:87]
    ds_read_b128 v[60:63], v8 offset:6656
    s_waitcnt lgkmcnt(3)
    v_mfma_f32_16x16x32_bf16 v[80:83], a[160:163], v[48:51], v[80:83]
    v_mfma_f32_16x16x32_bf16 v[84:87], a[164:167], v[48:51], v[84:87]
    ds_read_b128 v[48:51], v8 offset:1024
    s_waitcnt lgkmcnt(3)
    v_mfma_f32_16x16x32_bf16 v[80:83], a[168:171], v[52:55], v[80:83]
    v_mfma_f32_16x16x32_bf16 v[84:87], a[172:175], v[52:55], v[84:87]
    ds_read_b128 v[52:55], v8 offset:3072
    s_waitcnt lgkmcnt(3)
    v_mfma_f32_16x16x32_bf16 v[80:83], a[176:179], v[56:59], v[80:83]
    v_mfma_f32_16x16x32_bf16 v[84:87], a[180:183], v[56:59], v[84:87]
    ds_read_b128 v[56:59], v8 offset:5120
    s_waitcnt lgkmcnt(3)
    v_mfma_f32_16x16x32_bf16 v[80:83], a[184:187], v[60:63], v[80:83]
    v_mfma_f32_16x16x32_bf16 v[84:87], a[188:191], v[60:63], v[84:87]
    ds_read_b128 v[60:63], v8 offset:7168
    s_waitcnt lgkmcnt(3)
    v_mfma_f32_16x16x32_bf16 v[80:83], a[192:195], v[48:51], v[80:83]
    v_mfma_f32_16x16x32_bf16 v[84:87], a[196:199], v[48:51], v[84:87]
    ds_read_b128 v[48:51], v8 offset:1536
    s_waitcnt lgkmcnt(3)
    v_mfma_f32_16x16x32_bf16 v[80:83], a[200:203], v[52:55], v[80:83]
    v_mfma_f32_16x16x32_bf16 v[84:87], a[204:207], v[52:55], v[84:87]
    ds_read_b128 v[52:55], v8 offset:3584
    s_waitcnt lgkmcnt(3)
    v_mfma_f32_16x16x32_bf16 v[80:83], a[208:211], v[56:59], v[80:83]
    v_mfma_f32_16x16x32_bf16 v[84:87], a[212:215], v[56:59], v[84:87]
    ds_read_b128 v[56:59], v8 offset:5632
    s_waitcnt lgkmcnt(3)
    v_mfma_f32_16x16x32_bf16 v[80:83], a[216:219], v[60:63], v[80:83]
    v_mfma_f32_16x16x32_bf16 v[84:87], a[220:223], v[60:63], v[84:87]
    ds_read_b128 v[60:63], v8 offset:7680
    s_waitcnt lgkmcnt(3)
    v_mfma_f32_16x16x32_bf16 v[80:83], a[224:227], v[48:51], v[80:83]
    v_mfma_f32_16x16x32_bf16 v[84:87], a[228:231], v[48:51], v[84:87]
    ds_read_b128 v[48:51], v8 offset:0
    s_waitcnt lgkmcnt(3)
    v_mfma_f32_16x16x32_bf16 v[80:83], a[232:235], v[52:55], v[80:83]
    v_mfma_f32_16x16x32_bf16 v[84:87], a[236:239], v[52:55], v[84:87]
    ds_read_b128 v[52:55], v8 offset:2048
    s_waitcnt lgkmcnt(3)
    v_mfma_f32_16x16x32_bf16 v[80:83], a[240:243], v[56:59], v[80:83]
    v_mfma_f32_16x16x32_bf16 v[84:87], a[244:247], v[56:59], v[84:87]
    ds_read_b128 v[56:59], v8 offset:4096
    s_waitcnt lgkmcnt(3)
    v_mfma_f32_16x16x32_bf16 v[80:83], a[248:251], v[60:63], v[80:83]
    v_mfma_f32_16x16x32_bf16 v[84:87], a[252:255], v[60:63], v[84:87]
    ds_read_b128 v[60:63], v8 offset:6144
    s_waitcnt lgkmcnt(3)
    v_mfma_f32_16x16x32_bf16 v[40:43], v[48:51], v[128:131], 0
    v_mfma_f32_16x16x32_bf16 v[44:47], v[48:51], v[132:135], 0
    ds_read_b128 v[48:51], v8 offset:512
    s_waitcnt lgkmcnt(3)
    v_mfma_f32_16x16x32_bf16 v[40:43], v[52:55], v[136:139], v[40:43]
    v_mfma_f32_16x16x32_bf16 v[44:47], v[52:55], v[140:143], v[44:47]
    ds_read_b128 v[52:55], v8 offset:2560
    s_waitcnt lgkmcnt(3)
    v_mfma_f32_16x16x32_bf16 v[40:43], v[56:59], v[144:147], v[40:43]
    v_mfma_f32_16x16x32_bf16 v[44:47], v[56:59], v[148:151], v[44:47]
    v_mul_f32 v80, s33, v80
    v_mul_f32 v81, s33, v81
    v_mul_f32 v82, s33, v82
    v_mul_f32 v83, s33, v83
    ds_read_b128 v[56:59], v8 offset:4608
    s_waitcnt lgkmcnt(3)
    v_mfma_f32_16x16x32_bf16 v[40:43], v[60:63], v[152:155], v[40:43]
    v_mfma_f32_16x16x32_bf16 v[44:47], v[60:63], v[156:159], v[44:47]
    v_mul_f32 v84, s33, v84
    v_mul_f32 v85, s33, v85
    v_mul_f32 v86, s33, v86
    v_mul_f32 v87, s33, v87
    ds_read_b128 v[60:63], v8 offset:6656
    s_waitcnt lgkmcnt(3)
    v_mfma_f32_16x16x32_bf16 v[40:43], v[48:51], v[160:163], v[40:43]
    v_mfma_f32_16x16x32_bf16 v[44:47], v[48:51], v[164:167], v[44:47]
    v_cvt_pk_bf16_f32 v88, v80, v84
    v_cvt_pk_bf16_f32 v89, v81, v85
    v_cvt_pk_bf16_f32 v90, v82, v86
    v_cvt_pk_bf16_f32 v91, v83, v87
    ds_write_b128 v9, v[88:91] offset:16384
    ds_read_b128 v[48:51], v8 offset:1024
    s_waitcnt lgkmcnt(4)
    v_mfma_f32_16x16x32_bf16 v[40:43], v[52:55], v[168:171], v[40:43]
    v_mfma_f32_16x16x32_bf16 v[44:47], v[52:55], v[172:175], v[44:47]
    ds_read_b128 v[52:55], v8 offset:3072
    s_waitcnt lgkmcnt(4)
    v_mfma_f32_16x16x32_bf16 v[40:43], v[56:59], v[176:179], v[40:43]
    v_mfma_f32_16x16x32_bf16 v[44:47], v[56:59], v[180:183], v[44:47]
    ds_read_b128 v[56:59], v8 offset:5120
    s_waitcnt lgkmcnt(4)
    v_mfma_f32_16x16x32_bf16 v[40:43], v[60:63], v[184:187], v[40:43]
    v_mfma_f32_16x16x32_bf16 v[44:47], v[60:63], v[188:191], v[44:47]
    s_waitcnt lgkmcnt(3)
    s_barrier
    ds_read_b128 v[64:67], v1 offset:16384
    ds_read_b128 v[68:71], v1 offset:17408
    ds_read_b128 v[72:75], v1 offset:18432
    ds_read_b128 v[76:79], v1 offset:19456
    ds_read_b128 v[60:63], v8 offset:7168
    s_waitcnt lgkmcnt(7)
    v_mfma_f32_16x16x32_bf16 v[40:43], v[48:51], v[192:195], v[40:43]
    v_mfma_f32_16x16x32_bf16 v[44:47], v[48:51], v[196:199], v[44:47]
    ds_read_b128 v[48:51], v8 offset:1536
    s_waitcnt lgkmcnt(7)
    v_mfma_f32_16x16x32_bf16 v[40:43], v[52:55], v[200:203], v[40:43]
    v_mfma_f32_16x16x32_bf16 v[44:47], v[52:55], v[204:207], v[44:47]
    s_waitcnt lgkmcnt(2)
    v_mfma_f32_16x16x32_bf16 v[92:95], v[64:67], a[0:3], 0
    v_mfma_f32_16x16x32_bf16 v[96:99], v[64:67], a[16:19], 0
    v_mfma_f32_16x16x32_bf16 v[92:95], v[68:71], a[4:7], v[92:95]
    v_mfma_f32_16x16x32_bf16 v[96:99], v[68:71], a[20:23], v[96:99]
    v_mfma_f32_16x16x32_bf16 v[92:95], v[72:75], a[8:11], v[92:95]
    v_mfma_f32_16x16x32_bf16 v[96:99], v[72:75], a[24:27], v[96:99]
    v_mfma_f32_16x16x32_bf16 v[92:95], v[76:79], a[12:15], v[92:95]
    v_mfma_f32_16x16x32_bf16 v[96:99], v[76:79], a[28:31], v[96:99]
    ds_read_b128 v[52:55], v8 offset:3584
    s_waitcnt lgkmcnt(3)
    v_mfma_f32_16x16x32_bf16 v[40:43], v[56:59], v[208:211], v[40:43]
    v_mfma_f32_16x16x32_bf16 v[44:47], v[56:59], v[212:215], v[44:47]
    ds_read_b128 v[56:59], v8 offset:5632
    s_waitcnt lgkmcnt(3)
    v_mfma_f32_16x16x32_bf16 v[40:43], v[60:63], v[216:219], v[40:43]
    v_mfma_f32_16x16x32_bf16 v[44:47], v[60:63], v[220:223], v[44:47]
    v_max3_f32 v118, v92, v93, v94
    v_max3_f32 v118, v118, v95, v116
    v_max3_f32 v119, v96, v97, v98
    v_max3_f32 v119, v119, v99, v117
    v_mov_b32 v14, v118
    v_mov_b32 v15, v119
    ds_read_b128 v[60:63], v8 offset:7680
    s_waitcnt lgkmcnt(3)
    v_mfma_f32_16x16x32_bf16 v[40:43], v[48:51], v[224:227], v[40:43]
    v_mfma_f32_16x16x32_bf16 v[44:47], v[48:51], v[228:231], v[44:47]
    v_permlane16_swap_b32 v118, v14
    v_permlane16_swap_b32 v119, v15
    v_max_f32 v118, v118, v14
    v_max_f32 v119, v119, v15
    v_sub_f32 v92, v92, v118
    v_exp_f32 v92, v92
    s_waitcnt lgkmcnt(2)
    v_mfma_f32_16x16x32_bf16 v[40:43], v[52:55], v[232:235], v[40:43]
    v_mfma_f32_16x16x32_bf16 v[44:47], v[52:55], v[236:239], v[44:47]
    v_sub_f32 v93, v93, v118
    v_exp_f32 v93, v93
    v_sub_f32 v94, v94, v118
    v_exp_f32 v94, v94
    v_sub_f32 v95, v95, v118
    v_exp_f32 v95, v95
    s_waitcnt lgkmcnt(1)
    v_mfma_f32_16x16x32_bf16 v[40:43], v[56:59], v[240:243], v[40:43]
    v_mfma_f32_16x16x32_bf16 v[44:47], v[56:59], v[244:247], v[44:47]
    v_sub_f32 v104, v116, v118
    v_exp_f32 v104, v104
    v_cvt_pk_bf16_f32 v100, v92, v93
    v_cvt_pk_bf16_f32 v101, v94, v95
    v_sub_f32 v96, v96, v119
    v_exp_f32 v96, v96
    s_waitcnt lgkmcnt(0)
    v_mfma_f32_16x16x32_bf16 v[40:43], v[60:63], v[248:251], v[40:43]
    v_mfma_f32_16x16x32_bf16 v[44:47], v[60:63], v[252:255], v[44:47]
    v_sub_f32 v97, v97, v119
    v_exp_f32 v97, v97
    v_sub_f32 v98, v98, v119
    v_exp_f32 v98, v98
    v_sub_f32 v99, v99, v119
    v_exp_f32 v99, v99
    v_sub_f32 v105, v117, v119
    v_exp_f32 v105, v105
    v_cvt_pk_bf16_f32 v102, v96, v97
    v_cvt_pk_bf16_f32 v103, v98, v99
    v_mfma_f32_16x16x16_bf16 v[48:51], v[112:113], v[100:101], 0
    s_nop 0
    v_mfma_f32_16x16x16_bf16 v[52:55], v[112:113], v[102:103], 0
    v_cvt_pk_bf16_f32 v80, v40, v41
    v_cndmask_b32 v80, 0, v80, s[72:73]
    v_cvt_pk_bf16_f32 v81, v42, v43
    v_cndmask_b32 v81, 0, v81, s[72:73]
    v_cvt_pk_bf16_f32 v82, v44, v45
    v_cndmask_b32 v82, 0, v82, s[72:73]
    v_cvt_pk_bf16_f32 v83, v46, v47
    v_cndmask_b32 v83, 0, v83, s[72:73]
    v_mfma_f32_16x16x16_bf16 v[56:59], v[80:81], v[100:101], 0
    s_nop 0
    v_mfma_f32_16x16x16_bf16 v[60:63], v[82:83], v[100:101], 0
    v_mfma_f32_16x16x16_bf16 v[64:67], v[80:81], v[102:103], 0
    v_mfma_f32_16x16x16_bf16 v[68:71], v[82:83], v[102:103], 0
    v_fma_f32 v48, v16, v104, v48
    v_rcp_f32 v48, v48
    v_fma_f32 v52, v20, v105, v52
    v_rcp_f32 v52, v52
    v_fma_f32 v56, v24, v104, v56
    v_fma_f32 v57, v25, v104, v57
    v_fma_f32 v58, v26, v104, v58
    v_fma_f32 v59, v27, v104, v59
    v_fma_f32 v60, v28, v104, v60
    v_fma_f32 v61, v29, v104, v61
    v_fma_f32 v62, v30, v104, v62
    v_fma_f32 v63, v31, v104, v63
    v_pk_mul_f32 v[56:57], v[56:57], v[48:49] op_sel_hi:[1,0]
    v_pk_mul_f32 v[58:59], v[58:59], v[48:49] op_sel_hi:[1,0]
    v_pk_mul_f32 v[60:61], v[60:61], v[48:49] op_sel_hi:[1,0]
    v_pk_mul_f32 v[62:63], v[62:63], v[48:49] op_sel_hi:[1,0]
    v_cvt_pk_bf16_f32 v72, v56, v60
    v_cvt_pk_bf16_f32 v73, v57, v61
    v_cvt_pk_bf16_f32 v74, v58, v62
    v_cvt_pk_bf16_f32 v75, v59, v63
    ds_write_b128 v9, v[72:75] offset:0
    v_fma_f32 v64, v32, v105, v64
    v_fma_f32 v65, v33, v105, v65
    v_fma_f32 v66, v34, v105, v66
    v_fma_f32 v67, v35, v105, v67
    v_fma_f32 v68, v36, v105, v68
    v_fma_f32 v69, v37, v105, v69
    v_fma_f32 v70, v38, v105, v70
    v_fma_f32 v71, v39, v105, v71
    v_pk_mul_f32 v[64:65], v[64:65], v[52:53] op_sel_hi:[1,0]
    v_pk_mul_f32 v[66:67], v[66:67], v[52:53] op_sel_hi:[1,0]
    v_pk_mul_f32 v[68:69], v[68:69], v[52:53] op_sel_hi:[1,0]
    v_pk_mul_f32 v[70:71], v[70:71], v[52:53] op_sel_hi:[1,0]
    v_cvt_pk_bf16_f32 v76, v64, v68
    v_cvt_pk_bf16_f32 v77, v65, v69
    v_cvt_pk_bf16_f32 v78, v66, v70
    v_cvt_pk_bf16_f32 v79, v67, v71
    ds_write_b128 v9, v[76:79] offset:4096
    s_waitcnt lgkmcnt(0)
    s_barrier
    ds_read_b128 v[16:19], v1 offset:0
    ds_read_b128 v[20:23], v1 offset:1024
    ds_read_b128 v[24:27], v1 offset:2048
    ds_read_b128 v[28:31], v1 offset:3072
    ds_read_b128 v[32:35], v1 offset:4096
    ds_read_b128 v[36:39], v1 offset:5120
    ds_read_b128 v[40:43], v1 offset:6144
    ds_read_b128 v[44:47], v1 offset:7168
    ds_read_b128 v[48:51], v7 offset:0
    ds_read_b128 v[52:55], v7 offset:1024
    ds_read_b128 v[56:59], v7 offset:2048
    s_lshl_b32 s36, s20, 10
    s_add_u32 s25, s26, s36
    s_waitcnt lgkmcnt(2)
    v_mfma_f32_16x16x32_bf16 v[64:67], v[16:19], v[48:51], 0
    ds_read_b128 v[60:63], v7 offset:3072
    s_waitcnt lgkmcnt(2)
    v_mfma_f32_16x16x32_bf16 v[68:71], v[16:19], v[52:55], 0
    ds_read_b128 v[48:51], v7 offset:4096
    s_waitcnt lgkmcnt(2)
    v_mfma_f32_16x16x32_bf16 v[72:75], v[16:19], v[56:59], 0
    ds_read_b128 v[52:55], v7 offset:5120
    s_waitcnt lgkmcnt(2)
    v_mfma_f32_16x16x32_bf16 v[76:79], v[16:19], v[60:63], 0
    ds_read_b128 v[56:59], v7 offset:6144
    s_waitcnt lgkmcnt(2)
    v_mfma_f32_16x16x32_bf16 v[80:83], v[16:19], v[48:51], 0
    ds_read_b128 v[60:63], v7 offset:7168
    s_waitcnt lgkmcnt(2)
    v_mfma_f32_16x16x32_bf16 v[84:87], v[16:19], v[52:55], 0
    ds_read_b128 v[48:51], v7 offset:8192
    s_waitcnt lgkmcnt(2)
    v_mfma_f32_16x16x32_bf16 v[88:91], v[16:19], v[56:59], 0
    ds_read_b128 v[52:55], v7 offset:9216
    s_waitcnt lgkmcnt(2)
    v_mfma_f32_16x16x32_bf16 v[92:95], v[16:19], v[60:63], 0
    ds_read_b128 v[56:59], v7 offset:10240
    s_waitcnt lgkmcnt(2)
    v_mfma_f32_16x16x32_bf16 v[64:67], v[20:23], v[48:51], v[64:67]
    ds_read_b128 v[60:63], v7 offset:11264
    s_waitcnt lgkmcnt(2)
    v_mfma_f32_16x16x32_bf16 v[68:71], v[20:23], v[52:55], v[68:71]
    ds_read_b128 v[48:51], v7 offset:12288
    s_waitcnt lgkmcnt(2)
    v_mfma_f32_16x16x32_bf16 v[72:75], v[20:23], v[56:59], v[72:75]
    ds_read_b128 v[52:55], v7 offset:13312
    s_waitcnt lgkmcnt(2)
    v_mfma_f32_16x16x32_bf16 v[76:79], v[20:23], v[60:63], v[76:79]
    ds_read_b128 v[56:59], v7 offset:14336
    s_waitcnt lgkmcnt(2)
    v_mfma_f32_16x16x32_bf16 v[80:83], v[20:23], v[48:51], v[80:83]
    ds_read_b128 v[60:63], v7 offset:15360
    s_waitcnt lgkmcnt(2)
    v_mfma_f32_16x16x32_bf16 v[84:87], v[20:23], v[52:55], v[84:87]
    ds_read_b128 v[48:51], v7 offset:16384
    s_waitcnt lgkmcnt(2)
    v_mfma_f32_16x16x32_bf16 v[88:91], v[20:23], v[56:59], v[88:91]
    ds_read_b128 v[52:55], v7 offset:17408
    s_waitcnt lgkmcnt(2)
    v_mfma_f32_16x16x32_bf16 v[92:95], v[20:23], v[60:63], v[92:95]
    ds_read_b128 v[56:59], v7 offset:18432
    s_waitcnt lgkmcnt(2)
    v_mfma_f32_16x16x32_bf16 v[64:67], v[24:27], v[48:51], v[64:67]
    ds_read_b128 v[60:63], v7 offset:19456
    s_waitcnt lgkmcnt(2)
    v_mfma_f32_16x16x32_bf16 v[68:71], v[24:27], v[52:55], v[68:71]
    ds_read_b128 v[48:51], v7 offset:20480
    s_waitcnt lgkmcnt(2)
    v_mfma_f32_16x16x32_bf16 v[72:75], v[24:27], v[56:59], v[72:75]
    ds_read_b128 v[52:55], v7 offset:21504
    s_waitcnt lgkmcnt(2)
    v_mfma_f32_16x16x32_bf16 v[76:79], v[24:27], v[60:63], v[76:79]
    ds_read_b128 v[56:59], v7 offset:22528
    s_waitcnt lgkmcnt(2)
    v_mfma_f32_16x16x32_bf16 v[80:83], v[24:27], v[48:51], v[80:83]
    ds_read_b128 v[60:63], v7 offset:23552
    s_waitcnt lgkmcnt(2)
    v_mfma_f32_16x16x32_bf16 v[84:87], v[24:27], v[52:55], v[84:87]
    ds_read_b128 v[48:51], v7 offset:24576
    s_waitcnt lgkmcnt(2)
    v_mfma_f32_16x16x32_bf16 v[88:91], v[24:27], v[56:59], v[88:91]
    ds_read_b128 v[52:55], v7 offset:25600
    s_waitcnt lgkmcnt(2)
    v_mfma_f32_16x16x32_bf16 v[92:95], v[24:27], v[60:63], v[92:95]
    ds_read_b128 v[56:59], v7 offset:26624
    s_waitcnt lgkmcnt(2)
    v_mfma_f32_16x16x32_bf16 v[64:67], v[28:31], v[48:51], v[64:67]
    ds_read_b128 v[60:63], v7 offset:27648
    s_waitcnt lgkmcnt(2)
    v_mfma_f32_16x16x32_bf16 v[68:71], v[28:31], v[52:55], v[68:71]
    ds_read_b128 v[48:51], v7 offset:28672
    s_waitcnt lgkmcnt(2)
    v_mfma_f32_16x16x32_bf16 v[72:75], v[28:31], v[56:59], v[72:75]
    ds_read_b128 v[52:55], v7 offset:29696
    s_waitcnt lgkmcnt(2)
    v_mfma_f32_16x16x32_bf16 v[76:79], v[28:31], v[60:63], v[76:79]
    ds_read_b128 v[56:59], v7 offset:30720
    s_waitcnt lgkmcnt(2)
    v_mfma_f32_16x16x32_bf16 v[80:83], v[28:31], v[48:51], v[80:83]
    ds_read_b128 v[60:63], v7 offset:31744
    s_waitcnt lgkmcnt(2)
    v_mfma_f32_16x16x32_bf16 v[84:87], v[28:31], v[52:55], v[84:87]
    ds_read_b128 v[48:51], v7 offset:0
    s_waitcnt lgkmcnt(2)
    v_mfma_f32_16x16x32_bf16 v[88:91], v[28:31], v[56:59], v[88:91]
    ds_read_b128 v[52:55], v7 offset:1024
    s_waitcnt lgkmcnt(2)
    v_mfma_f32_16x16x32_bf16 v[92:95], v[28:31], v[60:63], v[92:95]
    ds_read_b128 v[56:59], v7 offset:2048
    s_waitcnt lgkmcnt(2)
    v_mfma_f32_16x16x32_bf16 v[96:99], v[32:35], v[48:51], 0
    ds_read_b128 v[60:63], v7 offset:3072
    s_waitcnt lgkmcnt(2)
    v_mfma_f32_16x16x32_bf16 v[100:103], v[32:35], v[52:55], 0
    ds_read_b128 v[48:51], v7 offset:4096
    s_waitcnt lgkmcnt(2)
    v_mfma_f32_16x16x32_bf16 v[104:107], v[32:35], v[56:59], 0
    ds_read_b128 v[52:55], v7 offset:5120
    s_waitcnt lgkmcnt(2)
    v_mfma_f32_16x16x32_bf16 v[108:111], v[32:35], v[60:63], 0
    ds_read_b128 v[56:59], v7 offset:6144
    v_cvt_pk_bf16_f32 v16, v64, v68
    s_waitcnt lgkmcnt(2)
    v_mfma_f32_16x16x32_bf16 v[112:115], v[32:35], v[48:51], 0
    ds_read_b128 v[60:63], v7 offset:7168
    v_cvt_pk_bf16_f32 v17, v72, v76
    s_waitcnt lgkmcnt(2)
    v_mfma_f32_16x16x32_bf16 v[116:119], v[32:35], v[52:55], 0
    ds_read_b128 v[48:51], v7 offset:8192
    v_cvt_pk_bf16_f32 v18, v80, v84
    s_waitcnt lgkmcnt(2)
    v_mfma_f32_16x16x32_bf16 v[120:123], v[32:35], v[56:59], 0
    ds_read_b128 v[52:55], v7 offset:9216
    v_cvt_pk_bf16_f32 v19, v88, v92
    s_waitcnt lgkmcnt(2)
    v_mfma_f32_16x16x32_bf16 v[124:127], v[32:35], v[60:63], 0
    ds_read_b128 v[56:59], v7 offset:10240
    v_and_or_b32 v16, v16, -2, s27
    s_waitcnt lgkmcnt(2)
    v_mfma_f32_16x16x32_bf16 v[96:99], v[36:39], v[48:51], v[96:99]
    ds_read_b128 v[60:63], v7 offset:11264
    s_add_u32 s36, s25, 0x0
    s_waitcnt lgkmcnt(2)
    v_mfma_f32_16x16x32_bf16 v[100:103], v[36:39], v[52:55], v[100:103]
    ds_read_b128 v[48:51], v7 offset:12288
    buffer_store_dwordx4 v[16:19], v10, s[8:11], s36 offen sc1
    s_waitcnt lgkmcnt(2)
    v_mfma_f32_16x16x32_bf16 v[104:107], v[36:39], v[56:59], v[104:107]
    ds_read_b128 v[52:55], v7 offset:13312
    v_cvt_pk_bf16_f32 v20, v65, v69
    s_waitcnt lgkmcnt(2)
    v_mfma_f32_16x16x32_bf16 v[108:111], v[36:39], v[60:63], v[108:111]
    ds_read_b128 v[56:59], v7 offset:14336
    v_cvt_pk_bf16_f32 v21, v73, v77
    s_waitcnt lgkmcnt(2)
    v_mfma_f32_16x16x32_bf16 v[112:115], v[36:39], v[48:51], v[112:115]
    ds_read_b128 v[60:63], v7 offset:15360
    v_cvt_pk_bf16_f32 v22, v81, v85
    s_waitcnt lgkmcnt(2)
    v_mfma_f32_16x16x32_bf16 v[116:119], v[36:39], v[52:55], v[116:119]
    ds_read_b128 v[48:51], v7 offset:16384
    v_cvt_pk_bf16_f32 v23, v89, v93
    s_waitcnt lgkmcnt(2)
    v_mfma_f32_16x16x32_bf16 v[120:123], v[36:39], v[56:59], v[120:123]
    ds_read_b128 v[52:55], v7 offset:17408
    v_and_or_b32 v20, v20, -2, s27
    s_waitcnt lgkmcnt(2)
    v_mfma_f32_16x16x32_bf16 v[124:127], v[36:39], v[60:63], v[124:127]
    ds_read_b128 v[56:59], v7 offset:18432
    s_add_u32 s36, s25, 0x8000
    s_waitcnt lgkmcnt(2)
    v_mfma_f32_16x16x32_bf16 v[96:99], v[40:43], v[48:51], v[96:99]
    ds_read_b128 v[60:63], v7 offset:19456
    buffer_store_dwordx4 v[20:23], v10, s[8:11], s36 offen sc1
    s_waitcnt lgkmcnt(2)
    v_mfma_f32_16x16x32_bf16 v[100:103], v[40:43], v[52:55], v[100:103]
    ds_read_b128 v[48:51], v7 offset:20480
    v_cvt_pk_bf16_f32 v24, v66, v70
    s_waitcnt lgkmcnt(2)
    v_mfma_f32_16x16x32_bf16 v[104:107], v[40:43], v[56:59], v[104:107]
    ds_read_b128 v[52:55], v7 offset:21504
    v_cvt_pk_bf16_f32 v25, v74, v78
    s_waitcnt lgkmcnt(2)
    v_mfma_f32_16x16x32_bf16 v[108:111], v[40:43], v[60:63], v[108:111]
    ds_read_b128 v[56:59], v7 offset:22528
    v_cvt_pk_bf16_f32 v26, v82, v86
    s_waitcnt lgkmcnt(2)
    v_mfma_f32_16x16x32_bf16 v[112:115], v[40:43], v[48:51], v[112:115]
    ds_read_b128 v[60:63], v7 offset:23552
    v_cvt_pk_bf16_f32 v27, v90, v94
    s_waitcnt lgkmcnt(2)
    v_mfma_f32_16x16x32_bf16 v[116:119], v[40:43], v[52:55], v[116:119]
    ds_read_b128 v[48:51], v7 offset:24576
    v_and_or_b32 v24, v24, -2, s27
    s_waitcnt lgkmcnt(2)
    v_mfma_f32_16x16x32_bf16 v[120:123], v[40:43], v[56:59], v[120:123]
    ds_read_b128 v[52:55], v7 offset:25600
    s_add_u32 s36, s25, 0x10000
    s_waitcnt lgkmcnt(2)
    v_mfma_f32_16x16x32_bf16 v[124:127], v[40:43], v[60:63], v[124:127]
    ds_read_b128 v[56:59], v7 offset:26624
    buffer_store_dwordx4 v[24:27], v10, s[8:11], s36 offen sc1
    s_waitcnt lgkmcnt(2)
    v_mfma_f32_16x16x32_bf16 v[96:99], v[44:47], v[48:51], v[96:99]
    ds_read_b128 v[60:63], v7 offset:27648
    v_cvt_pk_bf16_f32 v28, v67, v71
    s_waitcnt lgkmcnt(2)
    v_mfma_f32_16x16x32_bf16 v[100:103], v[44:47], v[52:55], v[100:103]
    ds_read_b128 v[48:51], v7 offset:28672
    v_cvt_pk_bf16_f32 v29, v75, v79
    s_waitcnt lgkmcnt(2)
    v_mfma_f32_16x16x32_bf16 v[104:107], v[44:47], v[56:59], v[104:107]
    ds_read_b128 v[52:55], v7 offset:29696
    v_cvt_pk_bf16_f32 v30, v83, v87
    s_waitcnt lgkmcnt(2)
    v_mfma_f32_16x16x32_bf16 v[108:111], v[44:47], v[60:63], v[108:111]
    ds_read_b128 v[56:59], v7 offset:30720
    v_cvt_pk_bf16_f32 v31, v91, v95
    s_waitcnt lgkmcnt(2)
    v_mfma_f32_16x16x32_bf16 v[112:115], v[44:47], v[48:51], v[112:115]
    ds_read_b128 v[60:63], v7 offset:31744
    v_and_or_b32 v28, v28, -2, s27
    s_waitcnt lgkmcnt(2)
    v_mfma_f32_16x16x32_bf16 v[116:119], v[44:47], v[52:55], v[116:119]
    s_add_u32 s36, s25, 0x18000
    s_waitcnt lgkmcnt(1)
    v_mfma_f32_16x16x32_bf16 v[120:123], v[44:47], v[56:59], v[120:123]
    buffer_store_dwordx4 v[28:31], v10, s[8:11], s36 offen sc1
    s_waitcnt lgkmcnt(0)
    v_mfma_f32_16x16x32_bf16 v[124:127], v[44:47], v[60:63], v[124:127]
    v_cvt_pk_bf16_f32 v32, v96, v100
    v_cvt_pk_bf16_f32 v33, v104, v108
    v_cvt_pk_bf16_f32 v34, v112, v116
    s_nop 4
    v_cvt_pk_bf16_f32 v35, v120, v124
    v_and_or_b32 v32, v32, -2, s27
    s_add_u32 s36, s25, 0x80000
    buffer_store_dwordx4 v[32:35], v10, s[8:11], s36 offen sc1
    v_cvt_pk_bf16_f32 v36, v97, v101
    v_cvt_pk_bf16_f32 v37, v105, v109
    v_cvt_pk_bf16_f32 v38, v113, v117
    v_cvt_pk_bf16_f32 v39, v121, v125
    v_and_or_b32 v36, v36, -2, s27
    s_add_u32 s36, s25, 0x88000
    buffer_store_dwordx4 v[36:39], v10, s[8:11], s36 offen sc1
    v_cvt_pk_bf16_f32 v40, v98, v102
    v_cvt_pk_bf16_f32 v41, v106, v110
    v_cvt_pk_bf16_f32 v42, v114, v118
    v_cvt_pk_bf16_f32 v43, v122, v126
    v_and_or_b32 v40, v40, -2, s27
    s_add_u32 s36, s25, 0x90000
    buffer_store_dwordx4 v[40:43], v10, s[8:11], s36 offen sc1
    v_cvt_pk_bf16_f32 v44, v99, v103
    v_cvt_pk_bf16_f32 v45, v107, v111
    v_cvt_pk_bf16_f32 v46, v115, v119
    v_cvt_pk_bf16_f32 v47, v123, v127
    v_and_or_b32 v44, v44, -2, s27
    s_add_u32 s36, s25, 0x98000
    buffer_store_dwordx4 v[44:47], v10, s[8:11], s36 offen sc1
    s_add_u32 s38, s23, 6
    s_cmp_ge_u32 s38, 64
    s_cbranch_scc1 L_P2_last
    s_mul_i32 s24, s38, 0x82100
    s_lshl_b32 s36, s20, 14
    s_add_u32 s24, s24, s36
    s_add_u32 s24, s24, 0x1000000
    s_add_u32 s36, s24, 0
    s_add_u32 s37, s36, 0x7000000
    buffer_load_dwordx4 a[32:35], v1, s[8:11], s36 offen offset:0 sc1
    buffer_load_dwordx4 a[0:3], v1, s[8:11], s37 offen offset:0 sc1
    buffer_load_dwordx4 a[36:39], v1, s[8:11], s36 offen offset:1024 sc1
    buffer_load_dwordx4 a[4:7], v1, s[8:11], s37 offen offset:1024 sc1
    buffer_load_dwordx4 a[40:43], v1, s[8:11], s36 offen offset:2048 sc1
    buffer_load_dwordx4 a[8:11], v1, s[8:11], s37 offen offset:2048 sc1
    buffer_load_dwordx4 a[44:47], v1, s[8:11], s36 offen offset:3072 sc1
    buffer_load_dwordx4 a[12:15], v1, s[8:11], s37 offen offset:3072 sc1
    s_add_u32 s36, s24, 4096
    s_add_u32 s37, s36, 0x7000000
    buffer_load_dwordx4 a[48:51], v1, s[8:11], s36 offen offset:0 sc1
    buffer_load_dwordx4 a[16:19], v1, s[8:11], s37 offen offset:0 sc1
    buffer_load_dwordx4 a[52:55], v1, s[8:11], s36 offen offset:1024 sc1
    buffer_load_dwordx4 a[20:23], v1, s[8:11], s37 offen offset:1024 sc1
    buffer_load_dwordx4 a[56:59], v1, s[8:11], s36 offen offset:2048 sc1
    buffer_load_dwordx4 a[24:27], v1, s[8:11], s37 offen offset:2048 sc1
    buffer_load_dwordx4 a[60:63], v1, s[8:11], s36 offen offset:3072 sc1
    buffer_load_dwordx4 a[28:31], v1, s[8:11], s37 offen offset:3072 sc1
    s_lshr_b32 s36, s21, 1
    s_lshl_b32 s36, s36, 3
    s_xor_b32 s37, s36, 8
    s_add_u32 s24, s24, 8192
    s_add_u32 s36, s36, s24
    s_add_u32 s37, s37, s24
    buffer_load_dwordx2 a[64:65], v2, s[8:11], s36 offen offset:0 sc1
    buffer_load_dwordx2 a[66:67], v2, s[8:11], s37 offen offset:0 sc1
    buffer_load_dwordx2 a[68:69], v2, s[8:11], s36 offen offset:1024 sc1
    buffer_load_dwordx2 a[70:71], v2, s[8:11], s37 offen offset:1024 sc1
L_P2_last:
    s_lshl_b32 s24, s23, 5
    s_add_u32 s24, s24, s20
    s_lshl_b32 s24, s24, 10
    v_accvgpr_read_b32 v52, a72
    v_accvgpr_read_b32 v53, a73
    v_and_b32 v15, 15, v0
    v_mov_b32 v48, 0
    v_mov_b32 v14, 0x3f80
    v_cmp_eq_u32 vcc, 0, v15
    s_nop 1
    v_cndmask_b32 v48, v48, v14, vcc
    v_mov_b32 v14, 0x3f800000
    v_cmp_eq_u32 vcc, 1, v15
    s_nop 1
    v_cndmask_b32 v48, v48, v14, vcc
    v_mov_b32 v49, 0
    v_mov_b32 v14, 0x3f80
    v_cmp_eq_u32 vcc, 4, v15
    s_nop 1
    v_cndmask_b32 v49, v49, v14, vcc
    v_mov_b32 v14, 0x3f800000
    v_cmp_eq_u32 vcc, 5, v15
    s_nop 1
    v_cndmask_b32 v49, v49, v14, vcc
    v_mov_b32 v50, 0
    v_mov_b32 v14, 0x3f80
    v_cmp_eq_u32 vcc, 8, v15
    s_nop 1
    v_cndmask_b32 v50, v50, v14, vcc
    v_mov_b32 v14, 0x3f800000
    v_cmp_eq_u32 vcc, 9, v15
    s_nop 1
    v_cndmask_b32 v50, v50, v14, vcc
    v_mov_b32 v51, 0
    v_mov_b32 v14, 0x3f80
    v_cmp_eq_u32 vcc, 12, v15
    s_nop 1
    v_cndmask_b32 v51, v51, v14, vcc
    v_mov_b32 v14, 0x3f800000
    v_cmp_eq_u32 vcc, 13, v15
    s_nop 1
    v_cndmask_b32 v51, v51, v14, vcc
    s_lshl_b32 s25, s20, 15
    s_add_u32 s25, s25, s26
L_P3_poll:
    s_add_u32 s36, s25, 0
    buffer_load_dwordx4 v[80:83], v11, s[8:11], s36 offen sc1
    s_add_u32 s36, s25, 4096
    buffer_load_dwordx4 v[84:87], v11, s[8:11], s36 offen sc1
    s_add_u32 s36, s25, 8192
    buffer_load_dwordx4 v[88:91], v11, s[8:11], s36 offen sc1
    s_add_u32 s36, s25, 12288
    buffer_load_dwordx4 v[92:95], v11, s[8:11], s36 offen sc1
    s_add_u32 s36, s25, 16384
    buffer_load_dwordx4 v[96:99], v11, s[8:11], s36 offen sc1
    s_add_u32 s36, s25, 20480
    buffer_load_dwordx4 v[100:103], v11, s[8:11], s36 offen sc1
    s_add_u32 s36, s25, 24576
    buffer_load_dwordx4 v[104:107], v11, s[8:11], s36 offen sc1
    s_add_u32 s36, s25, 28672
    buffer_load_dwordx4 v[108:111], v11, s[8:11], s36 offen sc1
    s_mov_b64 exec, -1
    s_add_u32 s32, s32, 1
    s_cmp_gt_u32 s32, 200000
    s_waitcnt vmcnt(7)
    v_mfma_f32_16x16x32_bf16 v[56:59], v[48:51], v[80:83], 0
    s_waitcnt vmcnt(6)
    v_mfma_f32_16x16x32_bf16 v[56:59], v[48:51], v[84:87], v[56:59]
    v_bitop3_b32 v60, v80, v84, s27 bitop3:0x7e
    s_waitcnt vmcnt(5)
    v_mfma_f32_16x16x32_bf16 v[56:59], v[48:51], v[88:91], v[56:59]
    s_waitcnt vmcnt(4)
    v_mfma_f32_16x16x32_bf16 v[56:59], v[48:51], v[92:95], v[56:59]
    v_bitop3_b32 v61, v88, v92, s27 bitop3:0x7e
    s_waitcnt vmcnt(3)
    v_mfma_f32_16x16x32_bf16 v[56:59], v[48:51], v[96:99], v[56:59]
    s_waitcnt vmcnt(2)
    v_mfma_f32_16x16x32_bf16 v[56:59], v[48:51], v[100:103], v[56:59]
    v_bitop3_b32 v62, v96, v100, s27 bitop3:0x7e
    s_waitcnt vmcnt(1)
    v_mfma_f32_16x16x32_bf16 v[56:59], v[48:51], v[104:107], v[56:59]
    s_waitcnt vmcnt(0)
    v_mfma_f32_16x16x32_bf16 v[56:59], v[48:51], v[108:111], v[56:59]
    v_bitop3_b32 v63, v104, v108, s27 bitop3:0x7e
    v_or3_b32 v14, v60, v61, v62
    v_bitop3_b32 v14, v14, v63, 1 bitop3:0xa8
    s_cbranch_scc1 L_P3_got
    v_cmp_ne_u32 vcc, 0, v14
    s_cbranch_vccz L_P3_got
    s_mov_b64 exec, vcc
    s_branch L_P3_poll
L_P3_got:
    s_nop 4
    v_cvt_pk_bf16_f32 v62, v56, v57
    v_lshlrev_b32 v65, 16, v62
    v_and_b32 v66, 0xffff0000, v62
    v_lshlrev_b32 v60, 16, v52
    v_and_b32 v61, 0xffff0000, v52
    v_add_f32 v60, v60, v65
    v_add_f32 v61, v61, v66
    v_cvt_pk_bf16_f32 v62, v60, v61
    v_lshlrev_b32 v60, 16, v62
    v_and_b32 v61, 0xffff0000, v62
    v_add_f32 v63, v60, v61
    v_mul_f32 v64, v60, v60
    v_fmac_f32 v64, v61, v61
    v_add_f32_dpp v63, v63, v63 quad_perm:[1,0,3,2] row_mask:0xf bank_mask:0xf
    s_nop 0
    v_add_f32_dpp v64, v64, v64 quad_perm:[1,0,3,2] row_mask:0xf bank_mask:0xf
    v_add_f32_dpp v63, v63, v63 quad_perm:[2,3,0,1] row_mask:0xf bank_mask:0xf
    s_nop 0
    v_add_f32_dpp v64, v64, v64 quad_perm:[2,3,0,1] row_mask:0xf bank_mask:0xf
    v_add_f32_dpp v63, v63, v63 row_half_mirror row_mask:0xf bank_mask:0xf
    s_nop 0
    v_add_f32_dpp v64, v64, v64 row_half_mirror row_mask:0xf bank_mask:0xf
    v_add_f32_dpp v63, v63, v63 row_mirror row_mask:0xf bank_mask:0xf
    s_nop 0
    v_add_f32_dpp v64, v64, v64 row_mirror row_mask:0xf bank_mask:0xf
    v_mov_b32 v14, v63
    s_nop 1
    v_permlane16_swap_b32 v63, v14
    v_add_f32 v63, v63, v14
    v_mov_b32 v14, v64
    s_nop 1
    v_permlane16_swap_b32 v64, v14
    v_add_f32 v64, v64, v14
    v_mov_b32 v14, v63
    s_nop 1
    v_permlane32_swap_b32 v63, v14
    v_add_f32 v63, v63, v14
    v_mov_b32 v14, v64
    s_nop 1
    v_permlane32_swap_b32 v64, v14
    v_add_f32 v64, v64, v14
    v_mov_b32 v15, s21
    v_lshlrev_b32 v15, 3, v15
    v_add_u32 v15, 28672, v15
    ds_write2_b32 v15, v63, v64 offset0:0 offset1:1
    s_add_u32 s36, s24, 0x400000
    buffer_store_dword v62, v12, s[8:11], s36 offen sc1
    s_waitcnt lgkmcnt(0)
    s_barrier
    v_mov_b32 v15, 28672
    ds_read_b128 v[68:71], v15
    ds_read_b128 v[72:75], v15 offset:16
    s_waitcnt lgkmcnt(0)
    v_add_f32 v63, v68, v70
    v_add_f32 v63, v63, v72
    v_add_f32 v63, v63, v74
    v_mul_f32 v63, 0x3b000000, v63
    v_add_f32 v64, v69, v71
    v_add_f32 v64, v64, v73
    v_add_f32 v64, v64, v75
    v_mul_f32 v64, 0x3b000000, v64
    v_fma_f32 v64, -v63, v63, v64
    v_max_f32 v64, 0, v64
    v_cvt_pk_bf16_f32 v14, v63, v64
    v_lshlrev_b32 v63, 16, v14
    v_and_b32 v64, 0xffff0000, v14
    v_add_f32 v64, 0x3727c5ac, v64
    v_cvt_pk_bf16_f32 v14, v64, v64
    v_lshlrev_b32 v64, 16, v14
    v_sqrt_f32 v64, v64
    s_nop 0
    v_cvt_pk_bf16_f32 v14, v64, v64
    v_lshlrev_b32 v64, 16, v14
    v_rcp_f32 v64, v64
    v_sub_f32 v65, v60, v63
    v_sub_f32 v66, v61, v63
    v_cvt_pk_bf16_f32 v14, v65, v66
    v_lshlrev_b32 v65, 16, v14
    v_and_b32 v66, 0xffff0000, v14
    v_mul_f32 v65, v65, v64
    v_mul_f32 v66, v66, v64
    v_cvt_pk_bf16_f32 v67, v65, v66
    v_lshlrev_b32 v65, 16, v67
    v_and_b32 v66, 0xffff0000, v67
    v_lshlrev_b32 v68, 16, v53
    v_and_b32 v69, 0xffff0000, v53
    v_mul_f32 v63, v65, v68
    v_fmac_f32 v63, v66, v69
    s_nop 1
    v_add_f32_dpp v63, v63, v63 quad_perm:[1,0,3,2] row_mask:0xf bank_mask:0xf
    s_nop 1
    v_add_f32_dpp v63, v63, v63 quad_perm:[2,3,0,1] row_mask:0xf bank_mask:0xf
    s_nop 1
    v_add_f32_dpp v63, v63, v63 row_half_mirror row_mask:0xf bank_mask:0xf
    s_nop 1
    v_add_f32_dpp v63, v63, v63 row_mirror row_mask:0xf bank_mask:0xf
    v_mov_b32 v14, v63
    s_nop 1
    v_permlane16_swap_b32 v63, v14
    v_add_f32 v63, v63, v14
    v_mov_b32 v14, v63
    s_nop 1
    v_permlane32_swap_b32 v63, v14
    v_add_f32 v63, v63, v14
    s_lshr_b32 s25, s24, 6
    s_lshl_b32 s37, s21, 2
    s_add_u32 s25, s25, s37
    s_add_u32 s36, s25, 0x194000
    v_cmp_ne_u32 vcc, 0, v1
    v_mov_b32 v15, 0x40000000
    s_nop 0
    v_cndmask_b32 v15, v1, v15, vcc
    buffer_store_dword v63, v15, s[8:11], s36 offen sc1
    v_add_f32 v60, v60, v65
    v_add_f32 v61, v61, v66
    v_cvt_pk_bf16_f32 v62, v60, v61
    buffer_store_dword v62, v12, s[60:63], s24 offen sc1
    s_add_u32 s36, s24, 0x600000
    buffer_store_dword v67, v12, s[8:11], s36 offen sc1
    s_add_u32 s30, s25, 0x1b8000
    s_add_u32 s29, s29, 1
    s_barrier
    s_add_u32 s23, s23, 6
    s_cmp_lt_u32 s23, 64
    s_cbranch_scc1 L_P2
    s_waitcnt vmcnt(0)
    v_cmp_ne_u32 vcc, 0, v1
    v_mov_b32 v15, 0x40000000
    v_mov_b32 v14, 0
    v_cndmask_b32 v15, v1, v15, vcc
    buffer_store_dword v14, v15, s[8:11], s30 offen sc1
    s_branch L_end
L_mlp:
    s_mov_b32 s12, s44
    s_and_b32 s13, s45, 0xffff
    s_mov_b32 s14, 0x200000
    s_mov_b32 s15, 0x20000
    s_mov_b32 s60, s82
    s_and_b32 s61, s83, 0xffff
    s_mov_b32 s62, 0x200000
    s_mov_b32 s63, 0x20000
    s_mov_b32 s92, s80
    s_and_b32 s93, s81, 0xffff
    s_mov_b32 s94, 0x400
    s_mov_b32 s95, 0x20000
    v_mov_b32 v1, 0x0
    v_bfe_u32 v14, v0, 0, 1
    s_mov_b32 s38, 0x10
    v_mad_u32_u24 v1, v14, s38, v1
    v_bfe_u32 v14, v0, 1, 1
    s_mov_b32 s38, 0x20
    v_mad_u32_u24 v1, v14, s38, v1
    v_bfe_u32 v14, v0, 2, 1
    s_mov_b32 s38, 0x40
    v_mad_u32_u24 v1, v14, s38, v1
    v_bfe_u32 v14, v0, 3, 1
    s_mov_b32 s38, 0x80
    v_mad_u32_u24 v1, v14, s38, v1
    v_bfe_u32 v14, v0, 4, 1
    s_mov_b32 s38, 0x100
    v_mad_u32_u24 v1, v14, s38, v1
    v_bfe_u32 v14, v0, 5, 1
    s_mov_b32 s38, 0x200
    v_mad_u32_u24 v1, v14, s38, v1
    v_mov_b32 v2, 0x0
    v_bfe_u32 v14, v0, 0, 1
    s_mov_b32 s38, 0x10
    v_mad_u32_u24 v2, v14, s38, v2
    v_bfe_u32 v14, v0, 1, 1
    s_mov_b32 s38, 0x20
    v_mad_u32_u24 v2, v14, s38, v2
    v_bfe_u32 v14, v0, 2, 1
    s_mov_b32 s38, 0x40
    v_mad_u32_u24 v2, v14, s38, v2
    v_bfe_u32 v14, v0, 3, 1
    s_mov_b32 s38, 0x80
    v_mad_u32_u24 v2, v14, s38, v2
    v_bfe_u32 v14, v0, 4, 1
    s_mov_b32 s38, 0x100
    v_mad_u32_u24 v2, v14, s38, v2
    v_bfe_u32 v14, v0, 5, 1
    s_mov_b32 s38, 0x200
    v_mad_u32_u24 v2, v14, s38, v2
    v_bfe_u32 v14, v0, 6, 1
    s_mov_b32 s38, 0x800
    v_mad_u32_u24 v2, v14, s38, v2
    v_bfe_u32 v14, v0, 7, 1
    s_mov_b32 s38, 0x1000
    v_mad_u32_u24 v2, v14, s38, v2
    v_mov_b32 v9, 0x0
    v_bfe_u32 v14, v0, 0, 1
    s_mov_b32 s38, 0x10
    v_mad_u32_u24 v9, v14, s38, v9
    v_bfe_u32 v14, v0, 1, 1
    s_mov_b32 s38, 0x20
    v_mad_u32_u24 v9, v14, s38, v9
    v_bfe_u32 v14, v0, 2, 1
    s_mov_b32 s38, 0x40
    v_mad_u32_u24 v9, v14, s38, v9
    v_bfe_u32 v14, v0, 3, 1
    s_mov_b32 s38, 0x80
    v_mad_u32_u24 v9, v14, s38, v9
    v_bfe_u32 v14, v0, 4, 1
    s_mov_b32 s38, 0x100
    v_mad_u32_u24 v9, v14, s38, v9
    v_bfe_u32 v14, v0, 5, 1
    s_mov_b32 s38, 0x200
    v_mad_u32_u24 v9, v14, s38, v9
    v_bfe_u32 v14, v0, 6, 1
    s_mov_b32 s38, 0x400
    v_mad_u32_u24 v9, v14, s38, v9
    v_bfe_u32 v14, v0, 7, 1
    s_mov_b32 s38, 0x800
    v_mad_u32_u24 v9, v14, s38, v9
    v_mov_b32 v7, 0x8000
    v_bfe_u32 v14, v0, 0, 1
    s_mov_b32 s38, 0x10
    v_mad_u32_u24 v7, v14, s38, v7
    v_bfe_u32 v14, v0, 1, 1
    s_mov_b32 s38, 0x20
    v_mad_u32_u24 v7, v14, s38, v7
    v_bfe_u32 v14, v0, 2, 1
    s_mov_b32 s38, 0x40
    v_mad_u32_u24 v7, v14, s38, v7
    v_bfe_u32 v14, v0, 3, 1
    s_mov_b32 s38, 0x80
    v_mad_u32_u24 v7, v14, s38, v7
    v_bfe_u32 v14, v0, 4, 1
    s_mov_b32 s38, 0x100
    v_mad_u32_u24 v7, v14, s38, v7
    v_bfe_u32 v14, v0, 5, 1
    s_mov_b32 s38, 0x200
    v_mad_u32_u24 v7, v14, s38, v7
    v_bfe_u32 v14, v0, 6, 1
    s_mov_b32 s38, 0x8000
    v_mad_u32_u24 v7, v14, s38, v7
    v_bfe_u32 v14, v0, 7, 1
    s_mov_b32 s38, 0x10000
    v_mad_u32_u24 v7, v14, s38, v7
    v_mov_b32 v3, 0x0
    v_bfe_u32 v14, v0, 0, 1
    s_mov_b32 s38, 0x10
    v_mad_u32_u24 v3, v14, s38, v3
    v_bfe_u32 v14, v0, 1, 1
    s_mov_b32 s38, 0x20
    v_mad_u32_u24 v3, v14, s38, v3
    v_bfe_u32 v14, v0, 2, 1
    s_mov_b32 s38, 0x40
    v_mad_u32_u24 v3, v14, s38, v3
    v_bfe_u32 v14, v0, 3, 1
    s_mov_b32 s38, 0x400
    v_mad_u32_u24 v3, v14, s38, v3
    v_bfe_u32 v14, v0, 4, 1
    s_mov_b32 s38, 0x800
    v_mad_u32_u24 v3, v14, s38, v3
    v_bfe_u32 v14, v0, 5, 1
    s_mov_b32 s38, 0x1000
    v_mad_u32_u24 v3, v14, s38, v3
    v_bfe_u32 v14, v0, 6, 1
    s_mov_b32 s38, 0x2000
    v_mad_u32_u24 v3, v14, s38, v3
    v_bfe_u32 v14, v0, 7, 1
    s_mov_b32 s38, 0x4000
    v_mad_u32_u24 v3, v14, s38, v3
    v_mov_b32 v4, 0x0
    v_bfe_u32 v14, v0, 0, 1
    s_mov_b32 s38, 0x100
    v_mad_u32_u24 v4, v14, s38, v4
    v_bfe_u32 v14, v0, 1, 1
    s_mov_b32 s38, 0x200
    v_mad_u32_u24 v4, v14, s38, v4
    v_bfe_u32 v14, v0, 2, 1
    s_mov_b32 s38, 0x400
    v_mad_u32_u24 v4, v14, s38, v4
    v_bfe_u32 v14, v0, 6, 1
    s_mov_b32 s38, 0x80
    v_mad_u32_u24 v4, v14, s38, v4
    v_bfe_u32 v14, v0, 7, 1
    s_mov_b32 s38, 0x4000
    v_mad_u32_u24 v4, v14, s38, v4
    v_lshrrev_b32 v15, 3, v0
    v_xor_b32 v15, v15, v0
    v_and_b32 v15, 7, v15
    v_lshl_add_u32 v4, v15, 4, v4
    v_bfe_u32 v15, v0, 4, 2
    v_lshlrev_b32 v15, 4, v15
    v_xor_b32 v5, v15, v1
    v_xor_b32 v6, 64, v5
    v_mov_b32 v8, 0x5000
    v_bfe_u32 v14, v0, 0, 1
    s_mov_b32 s38, 0x10
    v_mad_u32_u24 v8, v14, s38, v8
    v_bfe_u32 v14, v0, 1, 1
    s_mov_b32 s38, 0x40
    v_mad_u32_u24 v8, v14, s38, v8
    v_bfe_u32 v14, v0, 2, 1
    s_mov_b32 s38, 0x80
    v_mad_u32_u24 v8, v14, s38, v8
    v_bfe_u32 v14, v0, 4, 1
    s_mov_b32 s38, 0x20
    v_mad_u32_u24 v8, v14, s38, v8
    v_bfe_u32 v14, v0, 5, 1
    s_mov_b32 s38, 0x100
    v_mad_u32_u24 v8, v14, s38, v8
    v_mov_b32 v10, 0x0
    v_bfe_u32 v14, v0, 0, 1
    s_mov_b32 s38, 0x10
    v_mad_u32_u24 v10, v14, s38, v10
    v_bfe_u32 v14, v0, 1, 1
    s_mov_b32 s38, 0x20
    v_mad_u32_u24 v10, v14, s38, v10
    v_bfe_u32 v14, v0, 2, 1
    s_mov_b32 s38, 0x40
    v_mad_u32_u24 v10, v14, s38, v10
    v_bfe_u32 v14, v0, 3, 1
    s_mov_b32 s38, 0x80
    v_mad_u32_u24 v10, v14, s38, v10
    v_bfe_u32 v14, v0, 4, 1
    s_mov_b32 s38, 0x20000
    v_mad_u32_u24 v10, v14, s38, v10
    v_bfe_u32 v14, v0, 5, 1
    s_mov_b32 s38, 0x40000
    v_mad_u32_u24 v10, v14, s38, v10
    v_bfe_u32 v14, v0, 6, 1
    s_mov_b32 s38, 0x100
    v_mad_u32_u24 v10, v14, s38, v10
    v_bfe_u32 v14, v0, 7, 1
    s_mov_b32 s38, 0x200
    v_mad_u32_u24 v10, v14, s38, v10
    v_mov_b32 v11, 0x0
    v_bfe_u32 v14, v0, 0, 1
    s_mov_b32 s38, 0x10
    v_mad_u32_u24 v11, v14, s38, v11
    v_bfe_u32 v14, v0, 1, 1
    s_mov_b32 s38, 0x20
    v_mad_u32_u24 v11, v14, s38, v11
    v_bfe_u32 v14, v0, 2, 1
    s_mov_b32 s38, 0x40
    v_mad_u32_u24 v11, v14, s38, v11
    v_bfe_u32 v14, v0, 3, 1
    s_mov_b32 s38, 0x80
    v_mad_u32_u24 v11, v14, s38, v11
    v_bfe_u32 v14, v0, 4, 1
    s_mov_b32 s38, 0x400
    v_mad_u32_u24 v11, v14, s38, v11
    v_bfe_u32 v14, v0, 5, 1
    s_mov_b32 s38, 0x800
    v_mad_u32_u24 v11, v14, s38, v11
    v_bfe_u32 v14, v0, 6, 1
    s_mov_b32 s38, 0x100
    v_mad_u32_u24 v11, v14, s38, v11
    v_bfe_u32 v14, v0, 7, 1
    s_mov_b32 s38, 0x200
    v_mad_u32_u24 v11, v14, s38, v11
    v_mov_b32 v12, 0x0
    v_bfe_u32 v14, v0, 0, 1
    s_mov_b32 s38, 0x10
    v_mad_u32_u24 v12, v14, s38, v12
    v_bfe_u32 v14, v0, 1, 1
    s_mov_b32 s38, 0x20
    v_mad_u32_u24 v12, v14, s38, v12
    v_bfe_u32 v14, v0, 2, 1
    s_mov_b32 s38, 0x40
    v_mad_u32_u24 v12, v14, s38, v12
    v_bfe_u32 v14, v0, 3, 1
    s_mov_b32 s38, 0x80
    v_mad_u32_u24 v12, v14, s38, v12
    v_bfe_u32 v14, v0, 4, 1
    s_mov_b32 s38, 0x4
    v_mad_u32_u24 v12, v14, s38, v12
    v_bfe_u32 v14, v0, 5, 1
    s_mov_b32 s38, 0x8
    v_mad_u32_u24 v12, v14, s38, v12
    v_bfe_u32 v14, v0, 6, 1
    s_mov_b32 s38, 0x100
    v_mad_u32_u24 v12, v14, s38, v12
    v_bfe_u32 v14, v0, 7, 1
    s_mov_b32 s38, 0x200
    v_mad_u32_u24 v12, v14, s38, v12
    v_mov_b32 v13, 0xf149f2ca
    v_and_b32 v14, 15, v0
    v_bfe_u32 v15, v0, 4, 2
    v_cmp_gt_u32 s[72:73], 2, v15
    v_lshlrev_b32 v15, 2, v15
    v_cmp_le_u32 s[64:65], v15, v14
    v_add_u32 v15, 1, v15
    v_cmp_le_u32 s[66:67], v15, v14
    v_add_u32 v15, 1, v15
    v_cmp_le_u32 s[68:69], v15, v14
    v_add_u32 v15, 1, v15
    v_cmp_le_u32 s[70:71], v15, v14
    v_add_u32 v15, 1, v15
    s_mov_b32 s34, 0x05040100
    s_mov_b32 s35, 0x07060302
    s_mov_b32 s33, 0x3e0293ee
    s_mov_b32 s32, 0
    s_mov_b32 s4, 0x3f803f80
    s_mov_b32 s5, 0x3f803f80
    s_lshr_b32 s20, s2, 3
    s_lshr_b32 s23, s2, 3
    s_lshl_b32 s23, s23, 1
    s_lshl_b32 s36, s23, 15
    buffer_load_dwordx4 v[96:99], v3, s[12:15], s36 offen offset:0
    buffer_load_dwordx4 v[100:103], v3, s[12:15], s36 offen offset:128
    buffer_load_dwordx4 v[104:107], v3, s[12:15], s36 offen offset:256
    buffer_load_dwordx4 v[108:111], v3, s[12:15], s36 offen offset:384
    buffer_load_dwordx4 v[112:115], v3, s[12:15], s36 offen offset:512
    buffer_load_dwordx4 v[116:119], v3, s[12:15], s36 offen offset:640
    buffer_load_dwordx4 v[120:123], v3, s[12:15], s36 offen offset:768
    buffer_load_dwordx4 v[124:127], v3, s[12:15], s36 offen offset:896
    s_add_u32 s36, s36, 0x8000
    buffer_load_dwordx4 v[128:131], v3, s[12:15], s36 offen offset:0
    buffer_load_dwordx4 v[132:135], v3, s[12:15], s36 offen offset:128
    buffer_load_dwordx4 v[136:139], v3, s[12:15], s36 offen offset:256
    buffer_load_dwordx4 v[140:143], v3, s[12:15], s36 offen offset:384
    buffer_load_dwordx4 v[144:147], v3, s[12:15], s36 offen offset:512
    buffer_load_dwordx4 v[148:151], v3, s[12:15], s36 offen offset:640
    buffer_load_dwordx4 v[152:155], v3, s[12:15], s36 offen offset:768
    buffer_load_dwordx4 v[156:159], v3, s[12:15], s36 offen offset:896
    s_mov_b32 s96, s46
    s_and_b32 s97, s47, 0xffff
    s_mov_b32 s98, 0x2000
    s_mov_b32 s99, 0x20000
    v_mov_b32 v68, 0x0
    v_bfe_u32 v14, v0, 0, 1
    s_mov_b32 s38, 0x8
    v_mad_u32_u24 v68, v14, s38, v68
    v_bfe_u32 v14, v0, 1, 1
    s_mov_b32 s38, 0x10
    v_mad_u32_u24 v68, v14, s38, v68
    v_bfe_u32 v14, v0, 2, 1
    s_mov_b32 s38, 0x10000
    v_mad_u32_u24 v68, v14, s38, v68
    v_bfe_u32 v14, v0, 3, 1
    s_mov_b32 s38, 0x10000
    v_mad_u32_u24 v68, v14, s38, v68
    v_bfe_u32 v14, v0, 4, 1
    s_mov_b32 s38, 0x400
    v_mad_u32_u24 v68, v14, s38, v68
    v_bfe_u32 v14, v0, 5, 1
    s_mov_b32 s38, 0x4
    v_mad_u32_u24 v68, v14, s38, v68
    v_bfe_u32 v14, v0, 6, 1
    s_mov_b32 s38, 0x40
    v_mad_u32_u24 v68, v14, s38, v68
    v_bfe_u32 v14, v0, 7, 1
    s_mov_b32 s38, 0x80
    v_mad_u32_u24 v68, v14, s38, v68
    v_mov_b32 v70, s20
    v_mov_b32 v69, 0x0
    v_bfe_u32 v14, v70, 0, 1
    s_mov_b32 s38, 0x20
    v_mad_u32_u24 v69, v14, s38, v69
    v_bfe_u32 v14, v70, 1, 1
    s_mov_b32 s38, 0x800
    v_mad_u32_u24 v69, v14, s38, v69
    v_bfe_u32 v14, v70, 2, 1
    s_mov_b32 s38, 0x1000
    v_mad_u32_u24 v69, v14, s38, v69
    v_bfe_u32 v14, v70, 3, 1
    s_mov_b32 s38, 0x100
    v_mad_u32_u24 v69, v14, s38, v69
    v_bfe_u32 v14, v70, 4, 1
    s_mov_b32 s38, 0x200
    v_mad_u32_u24 v69, v14, s38, v69
    v_add_u32 v68, v68, v69
    buffer_load_dword v72, v68, s[96:99], 0 offen
    v_mov_b32 v64, -1
    v_mov_b32 v65, -1
    v_mov_b32 v66, -1
    v_mov_b32 v67, -1
    s_lshl_b32 s36, s20, 13
    s_add_u32 s36, s36, 0x0
    buffer_store_dwordx4 v[64:67], v2, s[8:11], s36 offen sc1
    buffer_store_dwordx4 v[64:67], v2, s[8:11], s36 offen offset:1024 sc1
    s_lshl_b32 s36, s20, 14
    s_add_u32 s36, s36, 0x100000
    s_add_u32 s37, s36, 0x2000
    buffer_store_dwordx4 v[64:67], v2, s[8:11], s36 offen sc1
    buffer_store_dwordx4 v[64:67], v2, s[8:11], s36 offen offset:1024 sc1
    buffer_store_dwordx4 v[64:67], v2, s[8:11], s37 offen sc1
    buffer_store_dwordx4 v[64:67], v2, s[8:11], s37 offen offset:1024 sc1
    s_mul_i32 s36, s20, 0x104200
    s_add_u32 s36, s36, 0x1102100
    s_add_u32 s37, s36, 0x82100
    buffer_store_dwordx4 v[64:67], v2, s[8:11], s36 offen sc1
    buffer_store_dwordx4 v[64:67], v2, s[8:11], s36 offen offset:1024 sc1
    buffer_store_dwordx4 v[64:67], v2, s[8:11], s37 offen sc1
    buffer_store_dwordx4 v[64:67], v2, s[8:11], s37 offen offset:1024 sc1
    v_lshlrev_b32 v68, 2, v0
    s_lshl_b32 s36, s20, 10
    s_add_u32 s37, s36, 0x194000
    buffer_store_dword v64, v68, s[8:11], s37 offen sc1
    s_add_u32 s37, s36, 0x1b0000
    buffer_store_dword v64, v68, s[8:11], s37 offen sc1
    s_add_u32 s37, s36, 0x1b8000
    buffer_store_dword v64, v68, s[8:11], s37 offen sc1
    v_mov_b32 v69, 0x40000000
    v_cmp_lt_u32 vcc, 63, v0
    s_nop 1
    v_cndmask_b32 v68, v68, v69, vcc
    v_mov_b32 v73, 0
    s_lshl_b32 s36, s20, 8
    s_add_u32 s37, s36, 0x192000
    buffer_store_dword v73, v68, s[8:11], s37 offen sc1
    s_mul_i32 s36, s20, 0x104200
    s_add_u32 s36, s36, 0x1082000
    s_add_u32 s37, s36, 0x82100
    buffer_store_dword v73, v68, s[8:11], s36 offen sc1
    buffer_store_dword v73, v68, s[8:11], s37 offen sc1
    v_mov_b32 v71, 0x80000
    v_bfe_u32 v14, v0, 0, 1
    s_mov_b32 s38, 0x8
    v_mad_u32_u24 v71, v14, s38, v71
    v_bfe_u32 v14, v0, 1, 1
    s_mov_b32 s38, 0x20
    v_mad_u32_u24 v71, v14, s38, v71
    v_bfe_u32 v14, v0, 4, 1
    s_mov_b32 s38, 0x10
    v_mad_u32_u24 v71, v14, s38, v71
    v_bfe_u32 v14, v0, 5, 1
    s_mov_b32 s38, 0x4
    v_mad_u32_u24 v71, v14, s38, v71
    v_bfe_u32 v14, v0, 6, 1
    s_mov_b32 s38, 0x800
    v_mad_u32_u24 v71, v14, s38, v71
    v_bfe_u32 v14, v0, 7, 1
    s_mov_b32 s38, 0x1000
    v_mad_u32_u24 v71, v14, s38, v71
    v_mov_b32 v69, s20
    v_mov_b32 v68, 0x0
    v_bfe_u32 v14, v69, 0, 1
    s_mov_b32 s38, 0x100
    v_mad_u32_u24 v68, v14, s38, v68
    v_bfe_u32 v14, v69, 1, 1
    s_mov_b32 s38, 0x40
    v_mad_u32_u24 v68, v14, s38, v68
    v_bfe_u32 v14, v69, 2, 1
    s_mov_b32 s38, 0x80
    v_mad_u32_u24 v68, v14, s38, v68
    v_bfe_u32 v14, v69, 3, 1
    s_mov_b32 s38, 0x200
    v_mad_u32_u24 v68, v14, s38, v68
    v_bfe_u32 v14, v69, 4, 1
    s_mov_b32 s38, 0x400
    v_mad_u32_u24 v68, v14, s38, v68
    v_add_u32 v71, v68, v71
    v_and_b32 v68, 12, v0
    v_cmp_ne_u32 vcc, 0, v68
    v_mov_b32 v68, 0x40000000
    s_nop 0
    v_cndmask_b32 v71, v71, v68, vcc
    s_waitcnt vmcnt(16)
    s_mov_b32 s36, 0x1000000
    buffer_store_dword v72, v71, s[8:11], s36 offen sc1
L_XN:
    v_mov_b32 v88, 0
    v_mov_b32 v89, 0
    v_dot2_f32_bf16 v88, v96, s4, v88
    v_dot2_f32_bf16 v89, v96, v96, v89
    v_dot2_f32_bf16 v88, v97, s4, v88
    v_dot2_f32_bf16 v89, v97, v97, v89
    v_dot2_f32_bf16 v88, v98, s4, v88
    v_dot2_f32_bf16 v89, v98, v98, v89
    v_dot2_f32_bf16 v88, v99, s4, v88
    v_dot2_f32_bf16 v89, v99, v99, v89
    v_dot2_f32_bf16 v88, v100, s4, v88
    v_dot2_f32_bf16 v89, v100, v100, v89
    v_dot2_f32_bf16 v88, v101, s4, v88
    v_dot2_f32_bf16 v89, v101, v101, v89
    v_dot2_f32_bf16 v88, v102, s4, v88
    v_dot2_f32_bf16 v89, v102, v102, v89
    v_dot2_f32_bf16 v88, v103, s4, v88
    v_dot2_f32_bf16 v89, v103, v103, v89
    v_dot2_f32_bf16 v88, v104, s4, v88
    v_dot2_f32_bf16 v89, v104, v104, v89
    v_dot2_f32_bf16 v88, v105, s4, v88
    v_dot2_f32_bf16 v89, v105, v105, v89
    v_dot2_f32_bf16 v88, v106, s4, v88
    v_dot2_f32_bf16 v89, v106, v106, v89
    v_dot2_f32_bf16 v88, v107, s4, v88
    v_dot2_f32_bf16 v89, v107, v107, v89
    v_dot2_f32_bf16 v88, v108, s4, v88
    v_dot2_f32_bf16 v89, v108, v108, v89
    v_dot2_f32_bf16 v88, v109, s4, v88
    v_dot2_f32_bf16 v89, v109, v109, v89
    v_dot2_f32_bf16 v88, v110, s4, v88
    v_dot2_f32_bf16 v89, v110, v110, v89
    v_dot2_f32_bf16 v88, v111, s4, v88
    v_dot2_f32_bf16 v89, v111, v111, v89
    v_dot2_f32_bf16 v88, v112, s4, v88
    v_dot2_f32_bf16 v89, v112, v112, v89
    v_dot2_f32_bf16 v88, v113, s4, v88
    v_dot2_f32_bf16 v89, v113, v113, v89
    v_dot2_f32_bf16 v88, v114, s4, v88
    v_dot2_f32_bf16 v89, v114, v114, v89
    v_dot2_f32_bf16 v88, v115, s4, v88
    v_dot2_f32_bf16 v89, v115, v115, v89
    v_dot2_f32_bf16 v88, v116, s4, v88
    v_dot2_f32_bf16 v89, v116, v116, v89
    v_dot2_f32_bf16 v88, v117, s4, v88
    v_dot2_f32_bf16 v89, v117, v117, v89
    v_dot2_f32_bf16 v88, v118, s4, v88
    v_dot2_f32_bf16 v89, v118, v118, v89
    v_dot2_f32_bf16 v88, v119, s4, v88
    v_dot2_f32_bf16 v89, v119, v119, v89
    v_dot2_f32_bf16 v88, v120, s4, v88
    v_dot2_f32_bf16 v89, v120, v120, v89
    v_dot2_f32_bf16 v88, v121, s4, v88
    v_dot2_f32_bf16 v89, v121, v121, v89
    v_dot2_f32_bf16 v88, v122, s4, v88
    v_dot2_f32_bf16 v89, v122, v122, v89
    v_dot2_f32_bf16 v88, v123, s4, v88
    v_dot2_f32_bf16 v89, v123, v123, v89
    v_dot2_f32_bf16 v88, v124, s4, v88
    v_dot2_f32_bf16 v89, v124, v124, v89
    v_dot2_f32_bf16 v88, v125, s4, v88
    v_dot2_f32_bf16 v89, v125, v125, v89
    v_dot2_f32_bf16 v88, v126, s4, v88
    v_dot2_f32_bf16 v89, v126, v126, v89
    v_dot2_f32_bf16 v88, v127, s4, v88
    v_dot2_f32_bf16 v89, v127, v127, v89
    s_nop 3
    v_add_f32_dpp v88, v88, v88 quad_perm:[1,0,3,2] row_mask:0xf bank_mask:0xf
    v_add_f32_dpp v89, v89, v89 quad_perm:[1,0,3,2] row_mask:0xf bank_mask:0xf
    s_nop 0
    v_add_f32_dpp v88, v88, v88 quad_perm:[2,3,0,1] row_mask:0xf bank_mask:0xf
    v_add_f32_dpp v89, v89, v89 quad_perm:[2,3,0,1] row_mask:0xf bank_mask:0xf
    s_nop 0
    v_add_f32_dpp v88, v88, v88 row_half_mirror row_mask:0xf bank_mask:0xf
    v_add_f32_dpp v89, v89, v89 row_half_mirror row_mask:0xf bank_mask:0xf
    v_mul_f32 v88, 0x3b000000, v88
    v_mul_f32 v89, 0x3b000000, v89
    v_fma_f32 v89, -v88, v88, v89
    v_max_f32 v89, 0, v89
    v_cvt_pk_bf16_f32 v14, v88, v89
    v_lshlrev_b32 v88, 16, v14
    v_and_b32 v89, 0xffff0000, v14
    v_add_f32 v89, 0x3727c5ac, v89
    v_cvt_pk_bf16_f32 v14, v89, v89
    v_lshlrev_b32 v89, 16, v14
    v_sqrt_f32 v89, v89
    s_nop 0
    v_cvt_pk_bf16_f32 v14, v89, v89
    v_lshlrev_b32 v89, 16, v14
    v_rcp_f32 v89, v89
    v_lshlrev_b32 v90, 16, v96
    v_and_b32 v91, 0xffff0000, v96
    v_sub_f32 v90, v90, v88
    v_sub_f32 v91, v91, v88
    v_cvt_pk_bf16_f32 v96, v90, v91
    v_lshlrev_b32 v90, 16, v96
    v_and_b32 v91, 0xffff0000, v96
    v_mul_f32 v90, v90, v89
    v_mul_f32 v91, v91, v89
    v_cvt_pk_bf16_f32 v96, v90, v91
    v_lshlrev_b32 v90, 16, v97
    v_and_b32 v91, 0xffff0000, v97
    v_sub_f32 v90, v90, v88
    v_sub_f32 v91, v91, v88
    v_cvt_pk_bf16_f32 v97, v90, v91
    v_lshlrev_b32 v90, 16, v97
    v_and_b32 v91, 0xffff0000, v97
    v_mul_f32 v90, v90, v89
    v_mul_f32 v91, v91, v89
    v_cvt_pk_bf16_f32 v97, v90, v91
    v_lshlrev_b32 v90, 16, v98
    v_and_b32 v91, 0xffff0000, v98
    v_sub_f32 v90, v90, v88
    v_sub_f32 v91, v91, v88
    v_cvt_pk_bf16_f32 v98, v90, v91
    v_lshlrev_b32 v90, 16, v98
    v_and_b32 v91, 0xffff0000, v98
    v_mul_f32 v90, v90, v89
    v_mul_f32 v91, v91, v89
    v_cvt_pk_bf16_f32 v98, v90, v91
    v_lshlrev_b32 v90, 16, v99
    v_and_b32 v91, 0xffff0000, v99
    v_sub_f32 v90, v90, v88
    v_sub_f32 v91, v91, v88
    v_cvt_pk_bf16_f32 v99, v90, v91
    v_lshlrev_b32 v90, 16, v99
    v_and_b32 v91, 0xffff0000, v99
    v_mul_f32 v90, v90, v89
    v_mul_f32 v91, v91, v89
    v_cvt_pk_bf16_f32 v99, v90, v91
    ds_write_b128 v4, v[96:99] offset:0
    v_lshlrev_b32 v90, 16, v100
    v_and_b32 v91, 0xffff0000, v100
    v_sub_f32 v90, v90, v88
    v_sub_f32 v91, v91, v88
    v_cvt_pk_bf16_f32 v100, v90, v91
    v_lshlrev_b32 v90, 16, v100
    v_and_b32 v91, 0xffff0000, v100
    v_mul_f32 v90, v90, v89
    v_mul_f32 v91, v91, v89
    v_cvt_pk_bf16_f32 v100, v90, v91
    v_lshlrev_b32 v90, 16, v101
    v_and_b32 v91, 0xffff0000, v101
    v_sub_f32 v90, v90, v88
    v_sub_f32 v91, v91, v88
    v_cvt_pk_bf16_f32 v101, v90, v91
    v_lshlrev_b32 v90, 16, v101
    v_and_b32 v91, 0xffff0000, v101
    v_mul_f32 v90, v90, v89
    v_mul_f32 v91, v91, v89
    v_cvt_pk_bf16_f32 v101, v90, v91
    v_lshlrev_b32 v90, 16, v102
    v_and_b32 v91, 0xffff0000, v102
    v_sub_f32 v90, v90, v88
    v_sub_f32 v91, v91, v88
    v_cvt_pk_bf16_f32 v102, v90, v91
    v_lshlrev_b32 v90, 16, v102
    v_and_b32 v91, 0xffff0000, v102
    v_mul_f32 v90, v90, v89
    v_mul_f32 v91, v91, v89
    v_cvt_pk_bf16_f32 v102, v90, v91
    v_lshlrev_b32 v90, 16, v103
    v_and_b32 v91, 0xffff0000, v103
    v_sub_f32 v90, v90, v88
    v_sub_f32 v91, v91, v88
    v_cvt_pk_bf16_f32 v103, v90, v91
    v_lshlrev_b32 v90, 16, v103
    v_and_b32 v91, 0xffff0000, v103
    v_mul_f32 v90, v90, v89
    v_mul_f32 v91, v91, v89
    v_cvt_pk_bf16_f32 v103, v90, v91
    ds_write_b128 v4, v[100:103] offset:2048
    v_lshlrev_b32 v90, 16, v104
    v_and_b32 v91, 0xffff0000, v104
    v_sub_f32 v90, v90, v88
    v_sub_f32 v91, v91, v88
    v_cvt_pk_bf16_f32 v104, v90, v91
    v_lshlrev_b32 v90, 16, v104
    v_and_b32 v91, 0xffff0000, v104
    v_mul_f32 v90, v90, v89
    v_mul_f32 v91, v91, v89
    v_cvt_pk_bf16_f32 v104, v90, v91
    v_lshlrev_b32 v90, 16, v105
    v_and_b32 v91, 0xffff0000, v105
    v_sub_f32 v90, v90, v88
    v_sub_f32 v91, v91, v88
    v_cvt_pk_bf16_f32 v105, v90, v91
    v_lshlrev_b32 v90, 16, v105
    v_and_b32 v91, 0xffff0000, v105
    v_mul_f32 v90, v90, v89
    v_mul_f32 v91, v91, v89
    v_cvt_pk_bf16_f32 v105, v90, v91
    v_lshlrev_b32 v90, 16, v106
    v_and_b32 v91, 0xffff0000, v106
    v_sub_f32 v90, v90, v88
    v_sub_f32 v91, v91, v88
    v_cvt_pk_bf16_f32 v106, v90, v91
    v_lshlrev_b32 v90, 16, v106
    v_and_b32 v91, 0xffff0000, v106
    v_mul_f32 v90, v90, v89
    v_mul_f32 v91, v91, v89
    v_cvt_pk_bf16_f32 v106, v90, v91
    v_lshlrev_b32 v90, 16, v107
    v_and_b32 v91, 0xffff0000, v107
    v_sub_f32 v90, v90, v88
    v_sub_f32 v91, v91, v88
    v_cvt_pk_bf16_f32 v107, v90, v91
    v_lshlrev_b32 v90, 16, v107
    v_and_b32 v91, 0xffff0000, v107
    v_mul_f32 v90, v90, v89
    v_mul_f32 v91, v91, v89
    v_cvt_pk_bf16_f32 v107, v90, v91
    ds_write_b128 v4, v[104:107] offset:4096
    v_lshlrev_b32 v90, 16, v108
    v_and_b32 v91, 0xffff0000, v108
    v_sub_f32 v90, v90, v88
    v_sub_f32 v91, v91, v88
    v_cvt_pk_bf16_f32 v108, v90, v91
    v_lshlrev_b32 v90, 16, v108
    v_and_b32 v91, 0xffff0000, v108
    v_mul_f32 v90, v90, v89
    v_mul_f32 v91, v91, v89
    v_cvt_pk_bf16_f32 v108, v90, v91
    v_lshlrev_b32 v90, 16, v109
    v_and_b32 v91, 0xffff0000, v109
    v_sub_f32 v90, v90, v88
    v_sub_f32 v91, v91, v88
    v_cvt_pk_bf16_f32 v109, v90, v91
    v_lshlrev_b32 v90, 16, v109
    v_and_b32 v91, 0xffff0000, v109
    v_mul_f32 v90, v90, v89
    v_mul_f32 v91, v91, v89
    v_cvt_pk_bf16_f32 v109, v90, v91
    v_lshlrev_b32 v90, 16, v110
    v_and_b32 v91, 0xffff0000, v110
    v_sub_f32 v90, v90, v88
    v_sub_f32 v91, v91, v88
    v_cvt_pk_bf16_f32 v110, v90, v91
    v_lshlrev_b32 v90, 16, v110
    v_and_b32 v91, 0xffff0000, v110
    v_mul_f32 v90, v90, v89
    v_mul_f32 v91, v91, v89
    v_cvt_pk_bf16_f32 v110, v90, v91
    v_lshlrev_b32 v90, 16, v111
    v_and_b32 v91, 0xffff0000, v111
    v_sub_f32 v90, v90, v88
    v_sub_f32 v91, v91, v88
    v_cvt_pk_bf16_f32 v111, v90, v91
    v_lshlrev_b32 v90, 16, v111
    v_and_b32 v91, 0xffff0000, v111
    v_mul_f32 v90, v90, v89
    v_mul_f32 v91, v91, v89
    v_cvt_pk_bf16_f32 v111, v90, v91
    ds_write_b128 v4, v[108:111] offset:6144
    v_lshlrev_b32 v90, 16, v112
    v_and_b32 v91, 0xffff0000, v112
    v_sub_f32 v90, v90, v88
    v_sub_f32 v91, v91, v88
    v_cvt_pk_bf16_f32 v112, v90, v91
    v_lshlrev_b32 v90, 16, v112
    v_and_b32 v91, 0xffff0000, v112
    v_mul_f32 v90, v90, v89
    v_mul_f32 v91, v91, v89
    v_cvt_pk_bf16_f32 v112, v90, v91
    v_lshlrev_b32 v90, 16, v113
    v_and_b32 v91, 0xffff0000, v113
    v_sub_f32 v90, v90, v88
    v_sub_f32 v91, v91, v88
    v_cvt_pk_bf16_f32 v113, v90, v91
    v_lshlrev_b32 v90, 16, v113
    v_and_b32 v91, 0xffff0000, v113
    v_mul_f32 v90, v90, v89
    v_mul_f32 v91, v91, v89
    v_cvt_pk_bf16_f32 v113, v90, v91
    v_lshlrev_b32 v90, 16, v114
    v_and_b32 v91, 0xffff0000, v114
    v_sub_f32 v90, v90, v88
    v_sub_f32 v91, v91, v88
    v_cvt_pk_bf16_f32 v114, v90, v91
    v_lshlrev_b32 v90, 16, v114
    v_and_b32 v91, 0xffff0000, v114
    v_mul_f32 v90, v90, v89
    v_mul_f32 v91, v91, v89
    v_cvt_pk_bf16_f32 v114, v90, v91
    v_lshlrev_b32 v90, 16, v115
    v_and_b32 v91, 0xffff0000, v115
    v_sub_f32 v90, v90, v88
    v_sub_f32 v91, v91, v88
    v_cvt_pk_bf16_f32 v115, v90, v91
    v_lshlrev_b32 v90, 16, v115
    v_and_b32 v91, 0xffff0000, v115
    v_mul_f32 v90, v90, v89
    v_mul_f32 v91, v91, v89
    v_cvt_pk_bf16_f32 v115, v90, v91
    ds_write_b128 v4, v[112:115] offset:8192
    v_lshlrev_b32 v90, 16, v116
    v_and_b32 v91, 0xffff0000, v116
    v_sub_f32 v90, v90, v88
    v_sub_f32 v91, v91, v88
    v_cvt_pk_bf16_f32 v116, v90, v91
    v_lshlrev_b32 v90, 16, v116
    v_and_b32 v91, 0xffff0000, v116
    v_mul_f32 v90, v90, v89
    v_mul_f32 v91, v91, v89
    v_cvt_pk_bf16_f32 v116, v90, v91
    v_lshlrev_b32 v90, 16, v117
    v_and_b32 v91, 0xffff0000, v117
    v_sub_f32 v90, v90, v88
    v_sub_f32 v91, v91, v88
    v_cvt_pk_bf16_f32 v117, v90, v91
    v_lshlrev_b32 v90, 16, v117
    v_and_b32 v91, 0xffff0000, v117
    v_mul_f32 v90, v90, v89
    v_mul_f32 v91, v91, v89
    v_cvt_pk_bf16_f32 v117, v90, v91
    v_lshlrev_b32 v90, 16, v118
    v_and_b32 v91, 0xffff0000, v118
    v_sub_f32 v90, v90, v88
    v_sub_f32 v91, v91, v88
    v_cvt_pk_bf16_f32 v118, v90, v91
    v_lshlrev_b32 v90, 16, v118
    v_and_b32 v91, 0xffff0000, v118
    v_mul_f32 v90, v90, v89
    v_mul_f32 v91, v91, v89
    v_cvt_pk_bf16_f32 v118, v90, v91
    v_lshlrev_b32 v90, 16, v119
    v_and_b32 v91, 0xffff0000, v119
    v_sub_f32 v90, v90, v88
    v_sub_f32 v91, v91, v88
    v_cvt_pk_bf16_f32 v119, v90, v91
    v_lshlrev_b32 v90, 16, v119
    v_and_b32 v91, 0xffff0000, v119
    v_mul_f32 v90, v90, v89
    v_mul_f32 v91, v91, v89
    v_cvt_pk_bf16_f32 v119, v90, v91
    ds_write_b128 v4, v[116:119] offset:10240
    v_lshlrev_b32 v90, 16, v120
    v_and_b32 v91, 0xffff0000, v120
    v_sub_f32 v90, v90, v88
    v_sub_f32 v91, v91, v88
    v_cvt_pk_bf16_f32 v120, v90, v91
    v_lshlrev_b32 v90, 16, v120
    v_and_b32 v91, 0xffff0000, v120
    v_mul_f32 v90, v90, v89
    v_mul_f32 v91, v91, v89
    v_cvt_pk_bf16_f32 v120, v90, v91
    v_lshlrev_b32 v90, 16, v121
    v_and_b32 v91, 0xffff0000, v121
    v_sub_f32 v90, v90, v88
    v_sub_f32 v91, v91, v88
    v_cvt_pk_bf16_f32 v121, v90, v91
    v_lshlrev_b32 v90, 16, v121
    v_and_b32 v91, 0xffff0000, v121
    v_mul_f32 v90, v90, v89
    v_mul_f32 v91, v91, v89
    v_cvt_pk_bf16_f32 v121, v90, v91
    v_lshlrev_b32 v90, 16, v122
    v_and_b32 v91, 0xffff0000, v122
    v_sub_f32 v90, v90, v88
    v_sub_f32 v91, v91, v88
    v_cvt_pk_bf16_f32 v122, v90, v91
    v_lshlrev_b32 v90, 16, v122
    v_and_b32 v91, 0xffff0000, v122
    v_mul_f32 v90, v90, v89
    v_mul_f32 v91, v91, v89
    v_cvt_pk_bf16_f32 v122, v90, v91
    v_lshlrev_b32 v90, 16, v123
    v_and_b32 v91, 0xffff0000, v123
    v_sub_f32 v90, v90, v88
    v_sub_f32 v91, v91, v88
    v_cvt_pk_bf16_f32 v123, v90, v91
    v_lshlrev_b32 v90, 16, v123
    v_and_b32 v91, 0xffff0000, v123
    v_mul_f32 v90, v90, v89
    v_mul_f32 v91, v91, v89
    v_cvt_pk_bf16_f32 v123, v90, v91
    ds_write_b128 v4, v[120:123] offset:12288
    v_lshlrev_b32 v90, 16, v124
    v_and_b32 v91, 0xffff0000, v124
    v_sub_f32 v90, v90, v88
    v_sub_f32 v91, v91, v88
    v_cvt_pk_bf16_f32 v124, v90, v91
    v_lshlrev_b32 v90, 16, v124
    v_and_b32 v91, 0xffff0000, v124
    v_mul_f32 v90, v90, v89
    v_mul_f32 v91, v91, v89
    v_cvt_pk_bf16_f32 v124, v90, v91
    v_lshlrev_b32 v90, 16, v125
    v_and_b32 v91, 0xffff0000, v125
    v_sub_f32 v90, v90, v88
    v_sub_f32 v91, v91, v88
    v_cvt_pk_bf16_f32 v125, v90, v91
    v_lshlrev_b32 v90, 16, v125
    v_and_b32 v91, 0xffff0000, v125
    v_mul_f32 v90, v90, v89
    v_mul_f32 v91, v91, v89
    v_cvt_pk_bf16_f32 v125, v90, v91
    v_lshlrev_b32 v90, 16, v126
    v_and_b32 v91, 0xffff0000, v126
    v_sub_f32 v90, v90, v88
    v_sub_f32 v91, v91, v88
    v_cvt_pk_bf16_f32 v126, v90, v91
    v_lshlrev_b32 v90, 16, v126
    v_and_b32 v91, 0xffff0000, v126
    v_mul_f32 v90, v90, v89
    v_mul_f32 v91, v91, v89
    v_cvt_pk_bf16_f32 v126, v90, v91
    v_lshlrev_b32 v90, 16, v127
    v_and_b32 v91, 0xffff0000, v127
    v_sub_f32 v90, v90, v88
    v_sub_f32 v91, v91, v88
    v_cvt_pk_bf16_f32 v127, v90, v91
    v_lshlrev_b32 v90, 16, v127
    v_and_b32 v91, 0xffff0000, v127
    v_mul_f32 v90, v90, v89
    v_mul_f32 v91, v91, v89
    v_cvt_pk_bf16_f32 v127, v90, v91
    ds_write_b128 v4, v[124:127] offset:14336
    s_waitcnt lgkmcnt(0)
    s_barrier
    s_lshl_b32 s24, s23, 15
    s_add_u32 s24, s24, 0x800000
    ds_read_b128 v[24:27], v9 offset:0
    ds_read_b128 v[28:31], v9 offset:4096
    ds_read_b128 v[32:35], v9 offset:8192
    ds_read_b128 v[36:39], v9 offset:12288
    ds_read_b128 v[40:43], v9 offset:16384
    ds_read_b128 v[44:47], v9 offset:20480
    ds_read_b128 v[48:51], v9 offset:24576
    ds_read_b128 v[52:55], v9 offset:28672
    s_waitcnt lgkmcnt(7)
    s_add_u32 s36, s24, 0
    buffer_store_dwordx4 v[24:27], v9, s[8:11], s36 offen sc1
    s_waitcnt lgkmcnt(6)
    s_add_u32 s36, s24, 4096
    buffer_store_dwordx4 v[28:31], v9, s[8:11], s36 offen sc1
    s_waitcnt lgkmcnt(5)
    s_add_u32 s36, s24, 8192
    buffer_store_dwordx4 v[32:35], v9, s[8:11], s36 offen sc1
    s_waitcnt lgkmcnt(4)
    s_add_u32 s36, s24, 12288
    buffer_store_dwordx4 v[36:39], v9, s[8:11], s36 offen sc1
    s_waitcnt lgkmcnt(3)
    s_add_u32 s36, s24, 16384
    buffer_store_dwordx4 v[40:43], v9, s[8:11], s36 offen sc1
    s_waitcnt lgkmcnt(2)
    s_add_u32 s36, s24, 20480
    buffer_store_dwordx4 v[44:47], v9, s[8:11], s36 offen sc1
    s_waitcnt lgkmcnt(1)
    s_add_u32 s36, s24, 24576
    buffer_store_dwordx4 v[48:51], v9, s[8:11], s36 offen sc1
    s_waitcnt lgkmcnt(0)
    s_add_u32 s36, s24, 28672
    buffer_store_dwordx4 v[52:55], v9, s[8:11], s36 offen sc1
    s_barrier
    v_mov_b64 v[96:97], v[128:129]
    v_mov_b64 v[98:99], v[130:131]
    v_mov_b64 v[100:101], v[132:133]
    v_mov_b64 v[102:103], v[134:135]
    v_mov_b64 v[104:105], v[136:137]
    v_mov_b64 v[106:107], v[138:139]
    v_mov_b64 v[108:109], v[140:141]
    v_mov_b64 v[110:111], v[142:143]
    v_mov_b64 v[112:113], v[144:145]
    v_mov_b64 v[114:115], v[146:147]
    v_mov_b64 v[116:117], v[148:149]
    v_mov_b64 v[118:119], v[150:151]
    v_mov_b64 v[120:121], v[152:153]
    v_mov_b64 v[122:123], v[154:155]
    v_mov_b64 v[124:125], v[156:157]
    v_mov_b64 v[126:127], v[158:159]
    s_add_u32 s23, s23, 1
    s_bitcmp1_b32 s23, 0
    s_cbranch_scc1 L_XN
    s_waitcnt vmcnt(0)
    s_barrier
    v_mov_b32 v14, 1
    s_lshl_b32 s37, s20, 2
    v_lshlrev_b32 v15, 20, v0
    buffer_store_dword v14, v15, s[16:19], s37 offen sc1
    s_lshr_b32 s20, s2, 3
    s_mov_b32 s34, 0x05040100
    s_mov_b32 s35, 0x07060302
    s_mov_b32 s32, 0
    s_mov_b32 s64, s84
    s_and_b32 s65, s85, 0xffff
    s_mov_b32 s66, 0x1c0000
    s_mov_b32 s67, 0x20000
    s_mov_b32 s68, s86
    s_and_b32 s69, s87, 0xffff
    s_mov_b32 s70, 0x1c0000
    s_mov_b32 s71, 0x20000
    s_mov_b32 s76, s88
    s_and_b32 s77, s89, 0xffff
    s_mov_b32 s78, 0x1c0000
    s_mov_b32 s79, 0x20000
    v_and_b32 v3, 31, v0
    v_lshlrev_b32 v3, 2, v3
L_M_hs:
    buffer_load_dword v5, v3, s[16:19], 0 offen sc1
    s_add_u32 s32, s32, 1
    s_cmp_gt_u32 s32, 200000
    s_waitcnt vmcnt(0)
    s_cbranch_scc1 L_M_hs_ok
    v_cmp_eq_u32 vcc, 0, v5
    s_cbranch_vccz L_M_hs_ok
    s_sleep 16
    s_branch L_M_hs
L_M_hs_ok:
    v_lshlrev_b32 v3, 4, v0
L_M00_rp:
    s_mov_b32 s36, 0x194000
    buffer_load_dwordx4 v[16:19], v3, s[8:11], s36 offen sc1
    s_add_u32 s32, s32, 1
    v_mov_b32 v5, 0
    s_waitcnt vmcnt(0)
    v_max3_u32 v5, v5, v16, v17
    v_max3_u32 v5, v5, v18, v19
    s_cmp_gt_u32 s32, 200000
    s_cbranch_scc1 L_M00_rp_ok
    v_cmp_eq_u32 vcc, -1, v5
    s_cbranch_vccz L_M00_rp_ok
    s_sleep 64
    s_branch L_M00_rp
L_M00_rp_ok:
    v_add_f32 v16, v16, v17
    v_add_f32 v18, v18, v19
    v_add_f32 v16, v16, v18
    v_cvt_pk_bf16_f32 v5, v16, v16
    v_lshlrev_b32 v16, 16, v5
    v_ashrrev_i32 v5, 31, v16
    v_or_b32 v5, 0x80000000, v5
    v_xor_b32 v5, v5, v16
    v_and_b32 v5, 0xffff0000, v5
    v_sub_u32 v6, 2047, v0
    v_or_b32 v120, v5, v6
    v_lshrrev_b32 v1, 5, v0
    v_and_b32 v2, 31, v0
    s_mov_b32 s36, 229376
    v_mul_lo_u32 v4, v1, s36
    v_lshl_add_u32 v4, v2, 2, v4
    v_mov_b32 v5, 0x40000000
    v_cmp_lt_u32 vcc, 27, v2
    s_nop 1
    v_cndmask_b32 v4, v4, v5, vcc
    s_mul_i32 s23, s20, 112
    s_add_u32 s36, s23, 0
    buffer_load_dword v16, v4, s[64:67], s36 offen
    s_add_u32 s36, s23, 3584
    buffer_load_dword v17, v4, s[64:67], s36 offen
    s_add_u32 s36, s23, 7168
    buffer_load_dword v18, v4, s[64:67], s36 offen
    s_add_u32 s36, s23, 10752
    buffer_load_dword v19, v4, s[64:67], s36 offen
    s_add_u32 s36, s23, 14336
    buffer_load_dword v20, v4, s[64:67], s36 offen
    s_add_u32 s36, s23, 17920
    buffer_load_dword v21, v4, s[64:67], s36 offen
    s_add_u32 s36, s23, 21504
    buffer_load_dword v22, v4, s[64:67], s36 offen
    s_add_u32 s36, s23, 25088
    buffer_load_dword v23, v4, s[64:67], s36 offen
    s_add_u32 s36, s23, 28672
    buffer_load_dword v24, v4, s[64:67], s36 offen
    s_add_u32 s36, s23, 32256
    buffer_load_dword v25, v4, s[64:67], s36 offen
    s_add_u32 s36, s23, 35840
    buffer_load_dword v26, v4, s[64:67], s36 offen
    s_add_u32 s36, s23, 39424
    buffer_load_dword v27, v4, s[64:67], s36 offen
    s_add_u32 s36, s23, 43008
    buffer_load_dword v28, v4, s[64:67], s36 offen
    s_add_u32 s36, s23, 46592
    buffer_load_dword v29, v4, s[64:67], s36 offen
    s_add_u32 s36, s23, 50176
    buffer_load_dword v30, v4, s[64:67], s36 offen
    s_add_u32 s36, s23, 53760
    buffer_load_dword v31, v4, s[64:67], s36 offen
    s_add_u32 s36, s23, 57344
    buffer_load_dword v32, v4, s[64:67], s36 offen
    s_add_u32 s36, s23, 60928
    buffer_load_dword v33, v4, s[64:67], s36 offen
    s_add_u32 s36, s23, 64512
    buffer_load_dword v34, v4, s[64:67], s36 offen
    s_add_u32 s36, s23, 68096
    buffer_load_dword v35, v4, s[64:67], s36 offen
    s_add_u32 s36, s23, 71680
    buffer_load_dword v36, v4, s[64:67], s36 offen
    s_add_u32 s36, s23, 75264
    buffer_load_dword v37, v4, s[64:67], s36 offen
    s_add_u32 s36, s23, 78848
    buffer_load_dword v38, v4, s[64:67], s36 offen
    s_add_u32 s36, s23, 82432
    buffer_load_dword v39, v4, s[64:67], s36 offen
    s_add_u32 s36, s23, 86016
    buffer_load_dword v40, v4, s[64:67], s36 offen
    s_add_u32 s36, s23, 89600
    buffer_load_dword v41, v4, s[64:67], s36 offen
    s_add_u32 s36, s23, 93184
    buffer_load_dword v42, v4, s[64:67], s36 offen
    s_add_u32 s36, s23, 96768
    buffer_load_dword v43, v4, s[64:67], s36 offen
    s_add_u32 s36, s23, 100352
    buffer_load_dword v44, v4, s[64:67], s36 offen
    s_add_u32 s36, s23, 103936
    buffer_load_dword v45, v4, s[64:67], s36 offen
    s_add_u32 s36, s23, 107520
    buffer_load_dword v46, v4, s[64:67], s36 offen
    s_add_u32 s36, s23, 111104
    buffer_load_dword v47, v4, s[64:67], s36 offen
    s_waitcnt vmcnt(0)
    v_perm_b32 v128, v17, v16, s34
    v_perm_b32 v129, v19, v18, s34
    v_perm_b32 v130, v21, v20, s34
    v_perm_b32 v131, v23, v22, s34
    v_perm_b32 v132, v25, v24, s34
    v_perm_b32 v133, v27, v26, s34
    v_perm_b32 v134, v29, v28, s34
    v_perm_b32 v135, v31, v30, s34
    v_perm_b32 v136, v33, v32, s34
    v_perm_b32 v137, v35, v34, s34
    v_perm_b32 v138, v37, v36, s34
    v_perm_b32 v139, v39, v38, s34
    v_perm_b32 v140, v41, v40, s34
    v_perm_b32 v141, v43, v42, s34
    v_perm_b32 v142, v45, v44, s34
    v_perm_b32 v143, v47, v46, s34
    v_perm_b32 v160, v17, v16, s35
    v_perm_b32 v161, v19, v18, s35
    v_perm_b32 v162, v21, v20, s35
    v_perm_b32 v163, v23, v22, s35
    v_perm_b32 v164, v25, v24, s35
    v_perm_b32 v165, v27, v26, s35
    v_perm_b32 v166, v29, v28, s35
    v_perm_b32 v167, v31, v30, s35
    v_perm_b32 v168, v33, v32, s35
    v_perm_b32 v169, v35, v34, s35
    v_perm_b32 v170, v37, v36, s35
    v_perm_b32 v171, v39, v38, s35
    v_perm_b32 v172, v41, v40, s35
    v_perm_b32 v173, v43, v42, s35
    v_perm_b32 v174, v45, v44, s35
    v_perm_b32 v175, v47, v46, s35
    s_add_u32 s36, s23, 114688
    buffer_load_dword v16, v4, s[64:67], s36 offen
    s_add_u32 s36, s23, 118272
    buffer_load_dword v17, v4, s[64:67], s36 offen
    s_add_u32 s36, s23, 121856
    buffer_load_dword v18, v4, s[64:67], s36 offen
    s_add_u32 s36, s23, 125440
    buffer_load_dword v19, v4, s[64:67], s36 offen
    s_add_u32 s36, s23, 129024
    buffer_load_dword v20, v4, s[64:67], s36 offen
    s_add_u32 s36, s23, 132608
    buffer_load_dword v21, v4, s[64:67], s36 offen
    s_add_u32 s36, s23, 136192
    buffer_load_dword v22, v4, s[64:67], s36 offen
    s_add_u32 s36, s23, 139776
    buffer_load_dword v23, v4, s[64:67], s36 offen
    s_add_u32 s36, s23, 143360
    buffer_load_dword v24, v4, s[64:67], s36 offen
    s_add_u32 s36, s23, 146944
    buffer_load_dword v25, v4, s[64:67], s36 offen
    s_add_u32 s36, s23, 150528
    buffer_load_dword v26, v4, s[64:67], s36 offen
    s_add_u32 s36, s23, 154112
    buffer_load_dword v27, v4, s[64:67], s36 offen
    s_add_u32 s36, s23, 157696
    buffer_load_dword v28, v4, s[64:67], s36 offen
    s_add_u32 s36, s23, 161280
    buffer_load_dword v29, v4, s[64:67], s36 offen
    s_add_u32 s36, s23, 164864
    buffer_load_dword v30, v4, s[64:67], s36 offen
    s_add_u32 s36, s23, 168448
    buffer_load_dword v31, v4, s[64:67], s36 offen
    s_add_u32 s36, s23, 172032
    buffer_load_dword v32, v4, s[64:67], s36 offen
    s_add_u32 s36, s23, 175616
    buffer_load_dword v33, v4, s[64:67], s36 offen
    s_add_u32 s36, s23, 179200
    buffer_load_dword v34, v4, s[64:67], s36 offen
    s_add_u32 s36, s23, 182784
    buffer_load_dword v35, v4, s[64:67], s36 offen
    s_add_u32 s36, s23, 186368
    buffer_load_dword v36, v4, s[64:67], s36 offen
    s_add_u32 s36, s23, 189952
    buffer_load_dword v37, v4, s[64:67], s36 offen
    s_add_u32 s36, s23, 193536
    buffer_load_dword v38, v4, s[64:67], s36 offen
    s_add_u32 s36, s23, 197120
    buffer_load_dword v39, v4, s[64:67], s36 offen
    s_add_u32 s36, s23, 200704
    buffer_load_dword v40, v4, s[64:67], s36 offen
    s_add_u32 s36, s23, 204288
    buffer_load_dword v41, v4, s[64:67], s36 offen
    s_add_u32 s36, s23, 207872
    buffer_load_dword v42, v4, s[64:67], s36 offen
    s_add_u32 s36, s23, 211456
    buffer_load_dword v43, v4, s[64:67], s36 offen
    s_add_u32 s36, s23, 215040
    buffer_load_dword v44, v4, s[64:67], s36 offen
    s_add_u32 s36, s23, 218624
    buffer_load_dword v45, v4, s[64:67], s36 offen
    s_add_u32 s36, s23, 222208
    buffer_load_dword v46, v4, s[64:67], s36 offen
    s_add_u32 s36, s23, 225792
    buffer_load_dword v47, v4, s[64:67], s36 offen
    s_waitcnt vmcnt(0)
    v_perm_b32 v144, v17, v16, s34
    v_perm_b32 v145, v19, v18, s34
    v_perm_b32 v146, v21, v20, s34
    v_perm_b32 v147, v23, v22, s34
    v_perm_b32 v148, v25, v24, s34
    v_perm_b32 v149, v27, v26, s34
    v_perm_b32 v150, v29, v28, s34
    v_perm_b32 v151, v31, v30, s34
    v_perm_b32 v152, v33, v32, s34
    v_perm_b32 v153, v35, v34, s34
    v_perm_b32 v154, v37, v36, s34
    v_perm_b32 v155, v39, v38, s34
    v_perm_b32 v156, v41, v40, s34
    v_perm_b32 v157, v43, v42, s34
    v_perm_b32 v158, v45, v44, s34
    v_perm_b32 v159, v47, v46, s34
    v_perm_b32 v176, v17, v16, s35
    v_perm_b32 v177, v19, v18, s35
    v_perm_b32 v178, v21, v20, s35
    v_perm_b32 v179, v23, v22, s35
    v_perm_b32 v180, v25, v24, s35
    v_perm_b32 v181, v27, v26, s35
    v_perm_b32 v182, v29, v28, s35
    v_perm_b32 v183, v31, v30, s35
    v_perm_b32 v184, v33, v32, s35
    v_perm_b32 v185, v35, v34, s35
    v_perm_b32 v186, v37, v36, s35
    v_perm_b32 v187, v39, v38, s35
    v_perm_b32 v188, v41, v40, s35
    v_perm_b32 v189, v43, v42, s35
    v_perm_b32 v190, v45, v44, s35
    v_perm_b32 v191, v47, v46, s35
    s_add_u32 s36, s23, 0
    buffer_load_dword v16, v4, s[68:71], s36 offen
    s_add_u32 s36, s23, 3584
    buffer_load_dword v17, v4, s[68:71], s36 offen
    s_add_u32 s36, s23, 7168
    buffer_load_dword v18, v4, s[68:71], s36 offen
    s_add_u32 s36, s23, 10752
    buffer_load_dword v19, v4, s[68:71], s36 offen
    s_add_u32 s36, s23, 14336
    buffer_load_dword v20, v4, s[68:71], s36 offen
    s_add_u32 s36, s23, 17920
    buffer_load_dword v21, v4, s[68:71], s36 offen
    s_add_u32 s36, s23, 21504
    buffer_load_dword v22, v4, s[68:71], s36 offen
    s_add_u32 s36, s23, 25088
    buffer_load_dword v23, v4, s[68:71], s36 offen
    s_add_u32 s36, s23, 28672
    buffer_load_dword v24, v4, s[68:71], s36 offen
    s_add_u32 s36, s23, 32256
    buffer_load_dword v25, v4, s[68:71], s36 offen
    s_add_u32 s36, s23, 35840
    buffer_load_dword v26, v4, s[68:71], s36 offen
    s_add_u32 s36, s23, 39424
    buffer_load_dword v27, v4, s[68:71], s36 offen
    s_add_u32 s36, s23, 43008
    buffer_load_dword v28, v4, s[68:71], s36 offen
    s_add_u32 s36, s23, 46592
    buffer_load_dword v29, v4, s[68:71], s36 offen
    s_add_u32 s36, s23, 50176
    buffer_load_dword v30, v4, s[68:71], s36 offen
    s_add_u32 s36, s23, 53760
    buffer_load_dword v31, v4, s[68:71], s36 offen
    s_add_u32 s36, s23, 57344
    buffer_load_dword v32, v4, s[68:71], s36 offen
    s_add_u32 s36, s23, 60928
    buffer_load_dword v33, v4, s[68:71], s36 offen
    s_add_u32 s36, s23, 64512
    buffer_load_dword v34, v4, s[68:71], s36 offen
    s_add_u32 s36, s23, 68096
    buffer_load_dword v35, v4, s[68:71], s36 offen
    s_add_u32 s36, s23, 71680
    buffer_load_dword v36, v4, s[68:71], s36 offen
    s_add_u32 s36, s23, 75264
    buffer_load_dword v37, v4, s[68:71], s36 offen
    s_add_u32 s36, s23, 78848
    buffer_load_dword v38, v4, s[68:71], s36 offen
    s_add_u32 s36, s23, 82432
    buffer_load_dword v39, v4, s[68:71], s36 offen
    s_add_u32 s36, s23, 86016
    buffer_load_dword v40, v4, s[68:71], s36 offen
    s_add_u32 s36, s23, 89600
    buffer_load_dword v41, v4, s[68:71], s36 offen
    s_add_u32 s36, s23, 93184
    buffer_load_dword v42, v4, s[68:71], s36 offen
    s_add_u32 s36, s23, 96768
    buffer_load_dword v43, v4, s[68:71], s36 offen
    s_add_u32 s36, s23, 100352
    buffer_load_dword v44, v4, s[68:71], s36 offen
    s_add_u32 s36, s23, 103936
    buffer_load_dword v45, v4, s[68:71], s36 offen
    s_add_u32 s36, s23, 107520
    buffer_load_dword v46, v4, s[68:71], s36 offen
    s_add_u32 s36, s23, 111104
    buffer_load_dword v47, v4, s[68:71], s36 offen
    s_waitcnt vmcnt(0)
    v_perm_b32 v192, v17, v16, s34
    v_perm_b32 v193, v19, v18, s34
    v_perm_b32 v194, v21, v20, s34
    v_perm_b32 v195, v23, v22, s34
    v_perm_b32 v196, v25, v24, s34
    v_perm_b32 v197, v27, v26, s34
    v_perm_b32 v198, v29, v28, s34
    v_perm_b32 v199, v31, v30, s34
    v_perm_b32 v200, v33, v32, s34
    v_perm_b32 v201, v35, v34, s34
    v_perm_b32 v202, v37, v36, s34
    v_perm_b32 v203, v39, v38, s34
    v_perm_b32 v204, v41, v40, s34
    v_perm_b32 v205, v43, v42, s34
    v_perm_b32 v206, v45, v44, s34
    v_perm_b32 v207, v47, v46, s34
    v_perm_b32 v224, v17, v16, s35
    v_perm_b32 v225, v19, v18, s35
    v_perm_b32 v226, v21, v20, s35
    v_perm_b32 v227, v23, v22, s35
    v_perm_b32 v228, v25, v24, s35
    v_perm_b32 v229, v27, v26, s35
    v_perm_b32 v230, v29, v28, s35
    v_perm_b32 v231, v31, v30, s35
    v_perm_b32 v232, v33, v32, s35
    v_perm_b32 v233, v35, v34, s35
    v_perm_b32 v234, v37, v36, s35
    v_perm_b32 v235, v39, v38, s35
    v_perm_b32 v236, v41, v40, s35
    v_perm_b32 v237, v43, v42, s35
    v_perm_b32 v238, v45, v44, s35
    v_perm_b32 v239, v47, v46, s35
    s_add_u32 s36, s23, 114688
    buffer_load_dword v16, v4, s[68:71], s36 offen
    s_add_u32 s36, s23, 118272
    buffer_load_dword v17, v4, s[68:71], s36 offen
    s_add_u32 s36, s23, 121856
    buffer_load_dword v18, v4, s[68:71], s36 offen
    s_add_u32 s36, s23, 125440
    buffer_load_dword v19, v4, s[68:71], s36 offen
    s_add_u32 s36, s23, 129024
    buffer_load_dword v20, v4, s[68:71], s36 offen
    s_add_u32 s36, s23, 132608
    buffer_load_dword v21, v4, s[68:71], s36 offen
    s_add_u32 s36, s23, 136192
    buffer_load_dword v22, v4, s[68:71], s36 offen
    s_add_u32 s36, s23, 139776
    buffer_load_dword v23, v4, s[68:71], s36 offen
    s_add_u32 s36, s23, 143360
    buffer_load_dword v24, v4, s[68:71], s36 offen
    s_add_u32 s36, s23, 146944
    buffer_load_dword v25, v4, s[68:71], s36 offen
    s_add_u32 s36, s23, 150528
    buffer_load_dword v26, v4, s[68:71], s36 offen
    s_add_u32 s36, s23, 154112
    buffer_load_dword v27, v4, s[68:71], s36 offen
    s_add_u32 s36, s23, 157696
    buffer_load_dword v28, v4, s[68:71], s36 offen
    s_add_u32 s36, s23, 161280
    buffer_load_dword v29, v4, s[68:71], s36 offen
    s_add_u32 s36, s23, 164864
    buffer_load_dword v30, v4, s[68:71], s36 offen
    s_add_u32 s36, s23, 168448
    buffer_load_dword v31, v4, s[68:71], s36 offen
    s_add_u32 s36, s23, 172032
    buffer_load_dword v32, v4, s[68:71], s36 offen
    s_add_u32 s36, s23, 175616
    buffer_load_dword v33, v4, s[68:71], s36 offen
    s_add_u32 s36, s23, 179200
    buffer_load_dword v34, v4, s[68:71], s36 offen
    s_add_u32 s36, s23, 182784
    buffer_load_dword v35, v4, s[68:71], s36 offen
    s_add_u32 s36, s23, 186368
    buffer_load_dword v36, v4, s[68:71], s36 offen
    s_add_u32 s36, s23, 189952
    buffer_load_dword v37, v4, s[68:71], s36 offen
    s_add_u32 s36, s23, 193536
    buffer_load_dword v38, v4, s[68:71], s36 offen
    s_add_u32 s36, s23, 197120
    buffer_load_dword v39, v4, s[68:71], s36 offen
    s_add_u32 s36, s23, 200704
    buffer_load_dword v40, v4, s[68:71], s36 offen
    s_add_u32 s36, s23, 204288
    buffer_load_dword v41, v4, s[68:71], s36 offen
    s_add_u32 s36, s23, 207872
    buffer_load_dword v42, v4, s[68:71], s36 offen
    s_add_u32 s36, s23, 211456
    buffer_load_dword v43, v4, s[68:71], s36 offen
    s_add_u32 s36, s23, 215040
    buffer_load_dword v44, v4, s[68:71], s36 offen
    s_add_u32 s36, s23, 218624
    buffer_load_dword v45, v4, s[68:71], s36 offen
    s_add_u32 s36, s23, 222208
    buffer_load_dword v46, v4, s[68:71], s36 offen
    s_add_u32 s36, s23, 225792
    buffer_load_dword v47, v4, s[68:71], s36 offen
    s_waitcnt vmcnt(0)
    v_perm_b32 v208, v17, v16, s34
    v_perm_b32 v209, v19, v18, s34
    v_perm_b32 v210, v21, v20, s34
    v_perm_b32 v211, v23, v22, s34
    v_perm_b32 v212, v25, v24, s34
    v_perm_b32 v213, v27, v26, s34
    v_perm_b32 v214, v29, v28, s34
    v_perm_b32 v215, v31, v30, s34
    v_perm_b32 v216, v33, v32, s34
    v_perm_b32 v217, v35, v34, s34
    v_perm_b32 v218, v37, v36, s34
    v_perm_b32 v219, v39, v38, s34
    v_perm_b32 v220, v41, v40, s34
    v_perm_b32 v221, v43, v42, s34
    v_perm_b32 v222, v45, v44, s34
    v_perm_b32 v223, v47, v46, s34
    v_perm_b32 v240, v17, v16, s35
    v_perm_b32 v241, v19, v18, s35
    v_perm_b32 v242, v21, v20, s35
    v_perm_b32 v243, v23, v22, s35
    v_perm_b32 v244, v25, v24, s35
    v_perm_b32 v245, v27, v26, s35
    v_perm_b32 v246, v29, v28, s35
    v_perm_b32 v247, v31, v30, s35
    v_perm_b32 v248, v33, v32, s35
    v_perm_b32 v249, v35, v34, s35
    v_perm_b32 v250, v37, v36, s35
    v_perm_b32 v251, v39, v38, s35
    v_perm_b32 v252, v41, v40, s35
    v_perm_b32 v253, v43, v42, s35
    v_perm_b32 v254, v45, v44, s35
    v_perm_b32 v255, v47, v46, s35
    v_lshrrev_b32 v3, 3, v0
    v_mul_u32_u24 v4, 57344, v3
    v_and_b32 v3, 7, v0
    v_lshl_add_u32 v4, v3, 2, v4
    s_lshl_b32 s37, s20, 5
    s_add_u32 s36, s37, 0
    buffer_load_dword v16, v4, s[76:79], s36 offen
    s_add_u32 s36, s37, 1024
    buffer_load_dword v17, v4, s[76:79], s36 offen
    s_add_u32 s36, s37, 2048
    buffer_load_dword v18, v4, s[76:79], s36 offen
    s_add_u32 s36, s37, 3072
    buffer_load_dword v19, v4, s[76:79], s36 offen
    s_add_u32 s36, s37, 4096
    buffer_load_dword v20, v4, s[76:79], s36 offen
    s_add_u32 s36, s37, 5120
    buffer_load_dword v21, v4, s[76:79], s36 offen
    s_add_u32 s36, s37, 6144
    buffer_load_dword v22, v4, s[76:79], s36 offen
    s_add_u32 s36, s37, 7168
    buffer_load_dword v23, v4, s[76:79], s36 offen
    s_add_u32 s36, s37, 8192
    buffer_load_dword v24, v4, s[76:79], s36 offen
    s_add_u32 s36, s37, 9216
    buffer_load_dword v25, v4, s[76:79], s36 offen
    s_add_u32 s36, s37, 10240
    buffer_load_dword v26, v4, s[76:79], s36 offen
    s_add_u32 s36, s37, 11264
    buffer_load_dword v27, v4, s[76:79], s36 offen
    s_add_u32 s36, s37, 12288
    buffer_load_dword v28, v4, s[76:79], s36 offen
    s_add_u32 s36, s37, 13312
    buffer_load_dword v29, v4, s[76:79], s36 offen
    s_add_u32 s36, s37, 14336
    buffer_load_dword v30, v4, s[76:79], s36 offen
    s_add_u32 s36, s37, 15360
    buffer_load_dword v31, v4, s[76:79], s36 offen
    s_add_u32 s36, s37, 16384
    buffer_load_dword v32, v4, s[76:79], s36 offen
    s_add_u32 s36, s37, 17408
    buffer_load_dword v33, v4, s[76:79], s36 offen
    s_add_u32 s36, s37, 18432
    buffer_load_dword v34, v4, s[76:79], s36 offen
    s_add_u32 s36, s37, 19456
    buffer_load_dword v35, v4, s[76:79], s36 offen
    s_add_u32 s36, s37, 20480
    buffer_load_dword v36, v4, s[76:79], s36 offen
    s_add_u32 s36, s37, 21504
    buffer_load_dword v37, v4, s[76:79], s36 offen
    s_add_u32 s36, s37, 22528
    buffer_load_dword v38, v4, s[76:79], s36 offen
    s_add_u32 s36, s37, 23552
    buffer_load_dword v39, v4, s[76:79], s36 offen
    s_add_u32 s36, s37, 24576
    buffer_load_dword v40, v4, s[76:79], s36 offen
    s_add_u32 s36, s37, 25600
    buffer_load_dword v41, v4, s[76:79], s36 offen
    s_add_u32 s36, s37, 26624
    buffer_load_dword v42, v4, s[76:79], s36 offen
    s_add_u32 s36, s37, 27648
    buffer_load_dword v43, v4, s[76:79], s36 offen
    s_waitcnt vmcnt(0)
    v_perm_b32 v64, v17, v16, s34
    v_perm_b32 v65, v19, v18, s34
    v_perm_b32 v66, v21, v20, s34
    v_perm_b32 v67, v23, v22, s34
    v_perm_b32 v68, v25, v24, s34
    v_perm_b32 v69, v27, v26, s34
    v_perm_b32 v70, v29, v28, s34
    v_perm_b32 v71, v31, v30, s34
    v_perm_b32 v72, v33, v32, s34
    v_perm_b32 v73, v35, v34, s34
    v_perm_b32 v74, v37, v36, s34
    v_perm_b32 v75, v39, v38, s34
    v_perm_b32 v76, v41, v40, s34
    v_perm_b32 v77, v43, v42, s34
    v_perm_b32 v92, v17, v16, s35
    v_perm_b32 v93, v19, v18, s35
    v_perm_b32 v94, v21, v20, s35
    v_perm_b32 v95, v23, v22, s35
    v_perm_b32 v96, v25, v24, s35
    v_perm_b32 v97, v27, v26, s35
    v_perm_b32 v98, v29, v28, s35
    v_perm_b32 v99, v31, v30, s35
    v_perm_b32 v100, v33, v32, s35
    v_perm_b32 v101, v35, v34, s35
    v_perm_b32 v102, v37, v36, s35
    v_perm_b32 v103, v39, v38, s35
    v_perm_b32 v104, v41, v40, s35
    v_perm_b32 v105, v43, v42, s35
    s_add_u32 s36, s37, 28672
    buffer_load_dword v16, v4, s[76:79], s36 offen
    s_add_u32 s36, s37, 29696
    buffer_load_dword v17, v4, s[76:79], s36 offen
    s_add_u32 s36, s37, 30720
    buffer_load_dword v18, v4, s[76:79], s36 offen
    s_add_u32 s36, s37, 31744
    buffer_load_dword v19, v4, s[76:79], s36 offen
    s_add_u32 s36, s37, 32768
    buffer_load_dword v20, v4, s[76:79], s36 offen
    s_add_u32 s36, s37, 33792
    buffer_load_dword v21, v4, s[76:79], s36 offen
    s_add_u32 s36, s37, 34816
    buffer_load_dword v22, v4, s[76:79], s36 offen
    s_add_u32 s36, s37, 35840
    buffer_load_dword v23, v4, s[76:79], s36 offen
    s_add_u32 s36, s37, 36864
    buffer_load_dword v24, v4, s[76:79], s36 offen
    s_add_u32 s36, s37, 37888
    buffer_load_dword v25, v4, s[76:79], s36 offen
    s_add_u32 s36, s37, 38912
    buffer_load_dword v26, v4, s[76:79], s36 offen
    s_add_u32 s36, s37, 39936
    buffer_load_dword v27, v4, s[76:79], s36 offen
    s_add_u32 s36, s37, 40960
    buffer_load_dword v28, v4, s[76:79], s36 offen
    s_add_u32 s36, s37, 41984
    buffer_load_dword v29, v4, s[76:79], s36 offen
    s_add_u32 s36, s37, 43008
    buffer_load_dword v30, v4, s[76:79], s36 offen
    s_add_u32 s36, s37, 44032
    buffer_load_dword v31, v4, s[76:79], s36 offen
    s_add_u32 s36, s37, 45056
    buffer_load_dword v32, v4, s[76:79], s36 offen
    s_add_u32 s36, s37, 46080
    buffer_load_dword v33, v4, s[76:79], s36 offen
    s_add_u32 s36, s37, 47104
    buffer_load_dword v34, v4, s[76:79], s36 offen
    s_add_u32 s36, s37, 48128
    buffer_load_dword v35, v4, s[76:79], s36 offen
    s_add_u32 s36, s37, 49152
    buffer_load_dword v36, v4, s[76:79], s36 offen
    s_add_u32 s36, s37, 50176
    buffer_load_dword v37, v4, s[76:79], s36 offen
    s_add_u32 s36, s37, 51200
    buffer_load_dword v38, v4, s[76:79], s36 offen
    s_add_u32 s36, s37, 52224
    buffer_load_dword v39, v4, s[76:79], s36 offen
    s_add_u32 s36, s37, 53248
    buffer_load_dword v40, v4, s[76:79], s36 offen
    s_add_u32 s36, s37, 54272
    buffer_load_dword v41, v4, s[76:79], s36 offen
    s_add_u32 s36, s37, 55296
    buffer_load_dword v42, v4, s[76:79], s36 offen
    s_add_u32 s36, s37, 56320
    buffer_load_dword v43, v4, s[76:79], s36 offen
    s_waitcnt vmcnt(0)
    v_perm_b32 v78, v17, v16, s34
    v_perm_b32 v79, v19, v18, s34
    v_perm_b32 v80, v21, v20, s34
    v_perm_b32 v81, v23, v22, s34
    v_perm_b32 v82, v25, v24, s34
    v_perm_b32 v83, v27, v26, s34
    v_perm_b32 v84, v29, v28, s34
    v_perm_b32 v85, v31, v30, s34
    v_perm_b32 v86, v33, v32, s34
    v_perm_b32 v87, v35, v34, s34
    v_perm_b32 v88, v37, v36, s34
    v_perm_b32 v89, v39, v38, s34
    v_perm_b32 v90, v41, v40, s34
    v_perm_b32 v91, v43, v42, s34
    v_perm_b32 v106, v17, v16, s35
    v_perm_b32 v107, v19, v18, s35
    v_perm_b32 v108, v21, v20, s35
    v_perm_b32 v109, v23, v22, s35
    v_perm_b32 v110, v25, v24, s35
    v_perm_b32 v111, v27, v26, s35
    v_perm_b32 v112, v29, v28, s35
    v_perm_b32 v113, v31, v30, s35
    v_perm_b32 v114, v33, v32, s35
    v_perm_b32 v115, v35, v34, s35
    v_perm_b32 v116, v37, v36, s35
    v_perm_b32 v117, v39, v38, s35
    v_perm_b32 v118, v41, v40, s35
    v_perm_b32 v119, v43, v42, s35
    s_mov_b32 s42, 0xffff0000
    s_mov_b32 s24, 0
    s_mov_b64 s[28:29], 0
    v_mov_b32 v12, 0x40000000
    v_mov_b32 v13, 0
    v_lshlrev_b32 v3, 4, v0
L_M06_rp:
    s_mov_b32 s36, 0x19a000
    buffer_load_dwordx4 v[40:43], v3, s[8:11], s36 offen sc1
    s_add_u32 s32, s32, 1
    v_mov_b32 v5, 0
    s_waitcnt vmcnt(0)
    v_max3_u32 v5, v5, v40, v41
    v_max3_u32 v5, v5, v42, v43
    s_cmp_gt_u32 s32, 200000
    s_cbranch_scc1 L_M06_rp_ok
    v_cmp_eq_u32 vcc, -1, v5
    s_cbranch_vccz L_M06_rp_ok
    s_sleep 32
    s_branch L_M06_rp
L_M06_rp_ok:
    v_add_f32 v40, v40, v41
    v_add_f32 v42, v42, v43
    v_add_f32 v40, v40, v42
    v_cvt_pk_bf16_f32 v5, v40, v40
    v_lshlrev_b32 v40, 16, v5
    v_ashrrev_i32 v5, 31, v40
    v_or_b32 v5, 0x80000000, v5
    v_xor_b32 v5, v5, v40
    v_and_b32 v5, 0xffff0000, v5
    v_sub_u32 v6, 511, v0
    v_or_b32 v126, v5, v6
    v_lshlrev_b32 v3, 4, v0
L_M01_rp:
    s_mov_b32 s36, 0x195000
    buffer_load_dwordx4 v[20:23], v3, s[8:11], s36 offen sc1
    s_mov_b32 s36, 0x196000
    buffer_load_dwordx4 v[24:27], v3, s[8:11], s36 offen sc1
    s_mov_b32 s36, 0x197000
    buffer_load_dwordx4 v[28:31], v3, s[8:11], s36 offen sc1
    s_mov_b32 s36, 0x198000
    buffer_load_dwordx4 v[32:35], v3, s[8:11], s36 offen sc1
    s_mov_b32 s36, 0x199000
    buffer_load_dwordx4 v[36:39], v3, s[8:11], s36 offen sc1
    s_add_u32 s32, s32, 1
    v_mov_b32 v5, 0
    s_waitcnt vmcnt(0)
    v_max3_u32 v5, v5, v20, v21
    v_max3_u32 v5, v5, v22, v23
    v_max3_u32 v5, v5, v24, v25
    v_max3_u32 v5, v5, v26, v27
    v_max3_u32 v5, v5, v28, v29
    v_max3_u32 v5, v5, v30, v31
    v_max3_u32 v5, v5, v32, v33
    v_max3_u32 v5, v5, v34, v35
    v_max3_u32 v5, v5, v36, v37
    v_max3_u32 v5, v5, v38, v39
    s_cmp_gt_u32 s32, 200000
    s_cbranch_scc1 L_M01_rp_ok
    v_cmp_eq_u32 vcc, -1, v5
    s_cbranch_vccz L_M01_rp_ok
    s_sleep 8
    s_branch L_M01_rp
L_M01_rp_ok:
    v_add_f32 v20, v20, v21
    v_add_f32 v22, v22, v23
    v_add_f32 v20, v20, v22
    v_cvt_pk_bf16_f32 v5, v20, v20
    v_lshlrev_b32 v20, 16, v5
    v_ashrrev_i32 v5, 31, v20
    v_or_b32 v5, 0x80000000, v5
    v_xor_b32 v5, v5, v20
    v_and_b32 v5, 0xffff0000, v5
    v_sub_u32 v6, 1791, v0
    v_or_b32 v121, v5, v6
    v_add_f32 v24, v24, v25
    v_add_f32 v26, v26, v27
    v_add_f32 v24, v24, v26
    v_cvt_pk_bf16_f32 v5, v24, v24
    v_lshlrev_b32 v24, 16, v5
    v_ashrrev_i32 v5, 31, v24
    v_or_b32 v5, 0x80000000, v5
    v_xor_b32 v5, v5, v24
    v_and_b32 v5, 0xffff0000, v5
    v_sub_u32 v6, 1535, v0
    v_or_b32 v122, v5, v6
    v_add_f32 v28, v28, v29
    v_add_f32 v30, v30, v31
    v_add_f32 v28, v28, v30
    v_cvt_pk_bf16_f32 v5, v28, v28
    v_lshlrev_b32 v28, 16, v5
    v_ashrrev_i32 v5, 31, v28
    v_or_b32 v5, 0x80000000, v5
    v_xor_b32 v5, v5, v28
    v_and_b32 v5, 0xffff0000, v5
    v_sub_u32 v6, 1279, v0
    v_or_b32 v123, v5, v6
    v_add_f32 v32, v32, v33
    v_add_f32 v34, v34, v35
    v_add_f32 v32, v32, v34
    v_cvt_pk_bf16_f32 v5, v32, v32
    v_lshlrev_b32 v32, 16, v5
    v_ashrrev_i32 v5, 31, v32
    v_or_b32 v5, 0x80000000, v5
    v_xor_b32 v5, v5, v32
    v_and_b32 v5, 0xffff0000, v5
    v_sub_u32 v6, 1023, v0
    v_or_b32 v124, v5, v6
    v_add_f32 v36, v36, v37
    v_add_f32 v38, v38, v39
    v_add_f32 v36, v36, v38
    v_cvt_pk_bf16_f32 v5, v36, v36
    v_lshlrev_b32 v36, 16, v5
    v_ashrrev_i32 v5, 31, v36
    v_or_b32 v5, 0x80000000, v5
    v_xor_b32 v5, v5, v36
    v_and_b32 v5, 0xffff0000, v5
    v_sub_u32 v6, 767, v0
    v_or_b32 v125, v5, v6
    v_max_u32 v5, v120, v121
    v_min_u32 v6, v120, v121
    v_med3_u32 v6, v5, v6, v122
    v_max_u32 v5, v5, v122
    v_med3_u32 v6, v5, v6, v123
    v_max_u32 v5, v5, v123
    v_med3_u32 v6, v5, v6, v124
    v_max_u32 v5, v5, v124
    v_med3_u32 v6, v5, v6, v125
    v_max_u32 v5, v5, v125
    v_med3_u32 v6, v5, v6, v126
    v_max_u32 v5, v5, v126
    v_mov_b32 v120, v5
    v_mov_b32 v121, v6
    s_mov_b32 s25, 32
L_M_round:
    v_lshlrev_b32 v3, 4, v0
    v_cmp_gt_u32 s[74:75], s25, v0
L_M7_rp:
    s_mov_b32 s36, 0x19b000
    buffer_load_dwordx4 v[44:47], v3, s[8:11], s36 offen sc1
    s_add_u32 s32, s32, 1
    v_mov_b32 v5, 0
    s_waitcnt vmcnt(0)
    v_max3_u32 v5, v5, v44, v45
    v_max3_u32 v5, v5, v46, v47
    v_cndmask_b32 v5, 0, v5, s[74:75]
    s_cmp_gt_u32 s32, 200000
    s_cbranch_scc1 L_M7_rp_ok
    v_cmp_eq_u32 vcc, -1, v5
    s_cbranch_vccnz L_M7_rp
L_M7_rp_ok:
    v_add_f32 v44, v44, v45
    v_add_f32 v46, v46, v47
    v_add_f32 v44, v44, v46
    v_cvt_pk_bf16_f32 v5, v44, v44
    v_lshlrev_b32 v44, 16, v5
    v_ashrrev_i32 v5, 31, v44
    v_or_b32 v5, 0x80000000, v5
    v_xor_b32 v5, v5, v44
    v_and_b32 v5, 0xffff0000, v5
    v_sub_u32 v6, 255, v0
    v_or_b32 v127, v5, v6
    v_cndmask_b32 v127, 0, v127, s[74:75]
    v_max_u32 v5, v120, v127
    v_med3_u32 v6, v120, v121, v127
    s_nop 0
    v_mov_b32_dpp v7, v5 quad_perm:[1,0,3,2] row_mask:0xf bank_mask:0xf
    v_mov_b32_dpp v8, v6 quad_perm:[1,0,3,2] row_mask:0xf bank_mask:0xf
    v_min_u32 v9, v5, v7
    v_max_u32 v5, v5, v7
    v_max3_u32 v6, v6, v8, v9
    s_nop 0
    v_mov_b32_dpp v7, v5 quad_perm:[2,3,0,1] row_mask:0xf bank_mask:0xf
    v_mov_b32_dpp v8, v6 quad_perm:[2,3,0,1] row_mask:0xf bank_mask:0xf
    v_min_u32 v9, v5, v7
    v_max_u32 v5, v5, v7
    v_max3_u32 v6, v6, v8, v9
    s_nop 0
    v_mov_b32_dpp v7, v5 row_half_mirror row_mask:0xf bank_mask:0xf
    v_mov_b32_dpp v8, v6 row_half_mirror row_mask:0xf bank_mask:0xf
    v_min_u32 v9, v5, v7
    v_max_u32 v5, v5, v7
    v_max3_u32 v6, v6, v8, v9
    s_nop 0
    v_mov_b32_dpp v7, v5 row_mirror row_mask:0xf bank_mask:0xf
    v_mov_b32_dpp v8, v6 row_mirror row_mask:0xf bank_mask:0xf
    v_min_u32 v9, v5, v7
    v_max_u32 v5, v5, v7
    v_max3_u32 v6, v6, v8, v9
    v_lshrrev_b32 v9, 4, v0
    v_lshlrev_b32 v9, 3, v9
    s_barrier
    ds_write2_b32 v9, v5, v6 offset0:0 offset1:1
    v_and_b32 v9, 15, v0
    v_lshlrev_b32 v9, 3, v9
    s_waitcnt lgkmcnt(0)
    s_barrier
    ds_read2_b32 v[10:11], v9 offset0:0 offset1:1
    s_waitcnt lgkmcnt(0)
    v_mov_b32 v5, v10
    v_mov_b32 v6, v11
    s_nop 0
    v_mov_b32_dpp v7, v5 quad_perm:[1,0,3,2] row_mask:0xf bank_mask:0xf
    v_mov_b32_dpp v8, v6 quad_perm:[1,0,3,2] row_mask:0xf bank_mask:0xf
    v_min_u32 v9, v5, v7
    v_max_u32 v5, v5, v7
    v_max3_u32 v6, v6, v8, v9
    s_nop 0
    v_mov_b32_dpp v7, v5 quad_perm:[2,3,0,1] row_mask:0xf bank_mask:0xf
    v_mov_b32_dpp v8, v6 quad_perm:[2,3,0,1] row_mask:0xf bank_mask:0xf
    v_min_u32 v9, v5, v7
    v_max_u32 v5, v5, v7
    v_max3_u32 v6, v6, v8, v9
    s_nop 0
    v_mov_b32_dpp v7, v5 row_half_mirror row_mask:0xf bank_mask:0xf
    v_mov_b32_dpp v8, v6 row_half_mirror row_mask:0xf bank_mask:0xf
    v_min_u32 v9, v5, v7
    v_max_u32 v5, v5, v7
    v_max3_u32 v6, v6, v8, v9
    s_nop 0
    v_mov_b32_dpp v7, v5 row_mirror row_mask:0xf bank_mask:0xf
    v_mov_b32_dpp v8, v6 row_mirror row_mask:0xf bank_mask:0xf
    v_min_u32 v9, v5, v7
    v_max_u32 v5, v5, v7
    v_max3_u32 v6, v6, v8, v9
    v_readfirstlane_b32 s26, v5
    v_readfirstlane_b32 s27, v6
    s_nop 3
    s_cmp_eq_u64 s[26:27], s[28:29]
    s_cbranch_scc1 L_M_next
    s_mov_b64 s[28:29], s[26:27]
    buffer_store_dword v13, v12, s[60:63], 0 offen sc1
    s_and_b32 s36, s26, 0x7ff
    s_sub_u32 s30, 2047, s36
    s_and_b32 s36, s26, 0xffff0000
    s_xor_b32 s37, s36, 0x80000000
    s_xor_b32 s40, s36, 0xffff0000
    s_bitcmp1_b32 s36, 31
    s_cselect_b32 s40, s37, s40
    s_and_b32 s36, s27, 0x7ff
    s_sub_u32 s31, 2047, s36
    s_and_b32 s36, s27, 0xffff0000
    s_xor_b32 s37, s36, 0x80000000
    s_xor_b32 s41, s36, 0xffff0000
    s_bitcmp1_b32 s36, 31
    s_cselect_b32 s41, s37, s41
    v_mov_b32 v8, 0
L_M_rows:
    s_lshl_b32 s36, s30, 4
    s_add_u32 s36, s36, 0x1b8000
    buffer_load_dwordx4 v[16:19], v8, s[8:11], s36 offen sc1
    s_lshl_b32 s36, s31, 4
    s_add_u32 s36, s36, 0x1b8000
    buffer_load_dwordx4 v[20:23], v8, s[8:11], s36 offen sc1
    s_add_u32 s32, s32, 1
    s_cmp_gt_u32 s32, 200000
    s_waitcnt vmcnt(0)
    v_or3_b32 v5, v16, v17, v18
    v_or3_b32 v5, v5, v19, v20
    v_or3_b32 v5, v5, v21, v22
    v_or_b32 v5, v5, v23
    s_cbranch_scc1 L_M_rows_ok
    v_cmp_ne_u32 vcc, 0, v5
    s_cbranch_vccnz L_M_rows
L_M_rows_ok:
    v_bfe_u32 v9, v0, 6, 1
    v_cmp_ne_u32 vcc, 0, v9
    v_mov_b32 v5, s30
    v_mov_b32 v6, s31
    v_cndmask_b32 v7, v5, v6, vcc
    v_lshlrev_b32 v7, 10, v7
    v_and_b32 v8, 63, v0
    v_lshl_add_u32 v7, v8, 4, v7
    s_mov_b32 s37, 0x600000
    buffer_load_dwordx4 v[16:19], v7, s[8:11], s37 offen sc1
    v_bfe_u32 v9, v0, 3, 1
    v_cmp_ne_u32 vcc, 0, v9
    s_nop 1
    v_cndmask_b32 v12, v5, v6, vcc
    v_mov_b32 v5, s40
    v_mov_b32 v6, s41
    v_cndmask_b32 v11, v5, v6, vcc
    v_lshlrev_b32 v12, 10, v12
    v_and_b32 v3, 7, v0
    v_lshl_add_u32 v12, v3, 2, v12
    s_lshl_b32 s36, s20, 5
    v_add_u32 v12, s36, v12
    v_mov_b32 v7, 0x40000000
    v_cmp_lt_u32 vcc, 15, v0
    s_nop 1
    v_cndmask_b32 v12, v12, v7, vcc
    s_mov_b32 s36, 0x400000
    buffer_load_dword v14, v12, s[8:11], s36 offen sc1
    buffer_load_dword v15, v12, s[8:11], s37 offen sc1
    v_and_b32 v8, 127, v0
    v_lshlrev_b32 v8, 4, v8
    s_waitcnt vmcnt(2)
    ds_write_b128 v8, v[16:19] offset:4096
    s_waitcnt lgkmcnt(0)
    s_barrier
    v_mov_b64 v[48:49], 0
    v_mov_b64 v[50:51], 0
    v_mov_b64 v[52:53], 0
    v_mov_b64 v[54:55], 0
    v_lshlrev_b32 v8, 7, v1
    ds_read_b128 v[16:19], v8 offset:4096
    ds_read_b128 v[20:23], v8 offset:4112
    ds_read_b128 v[24:27], v8 offset:4128
    ds_read_b128 v[28:31], v8 offset:4144
    ds_read_b128 v[32:35], v8 offset:5120
    ds_read_b128 v[36:39], v8 offset:5136
    ds_read_b128 v[40:43], v8 offset:5152
    ds_read_b128 v[44:47], v8 offset:5168
    s_waitcnt lgkmcnt(0)
    v_dot2_f32_bf16 v48, v16, v128, v48
    v_dot2_f32_bf16 v49, v16, v160, v49
    v_dot2_f32_bf16 v50, v32, v128, v50
    v_dot2_f32_bf16 v51, v32, v160, v51
    v_dot2_f32_bf16 v52, v16, v192, v52
    v_dot2_f32_bf16 v53, v16, v224, v53
    v_dot2_f32_bf16 v54, v32, v192, v54
    v_dot2_f32_bf16 v55, v32, v224, v55
    v_dot2_f32_bf16 v48, v17, v129, v48
    v_dot2_f32_bf16 v49, v17, v161, v49
    v_dot2_f32_bf16 v50, v33, v129, v50
    v_dot2_f32_bf16 v51, v33, v161, v51
    v_dot2_f32_bf16 v52, v17, v193, v52
    v_dot2_f32_bf16 v53, v17, v225, v53
    v_dot2_f32_bf16 v54, v33, v193, v54
    v_dot2_f32_bf16 v55, v33, v225, v55
    v_dot2_f32_bf16 v48, v18, v130, v48
    v_dot2_f32_bf16 v49, v18, v162, v49
    v_dot2_f32_bf16 v50, v34, v130, v50
    v_dot2_f32_bf16 v51, v34, v162, v51
    v_dot2_f32_bf16 v52, v18, v194, v52
    v_dot2_f32_bf16 v53, v18, v226, v53
    v_dot2_f32_bf16 v54, v34, v194, v54
    v_dot2_f32_bf16 v55, v34, v226, v55
    v_dot2_f32_bf16 v48, v19, v131, v48
    v_dot2_f32_bf16 v49, v19, v163, v49
    v_dot2_f32_bf16 v50, v35, v131, v50
    v_dot2_f32_bf16 v51, v35, v163, v51
    v_dot2_f32_bf16 v52, v19, v195, v52
    v_dot2_f32_bf16 v53, v19, v227, v53
    v_dot2_f32_bf16 v54, v35, v195, v54
    v_dot2_f32_bf16 v55, v35, v227, v55
    v_dot2_f32_bf16 v48, v20, v132, v48
    v_dot2_f32_bf16 v49, v20, v164, v49
    v_dot2_f32_bf16 v50, v36, v132, v50
    v_dot2_f32_bf16 v51, v36, v164, v51
    v_dot2_f32_bf16 v52, v20, v196, v52
    v_dot2_f32_bf16 v53, v20, v228, v53
    v_dot2_f32_bf16 v54, v36, v196, v54
    v_dot2_f32_bf16 v55, v36, v228, v55
    v_dot2_f32_bf16 v48, v21, v133, v48
    v_dot2_f32_bf16 v49, v21, v165, v49
    v_dot2_f32_bf16 v50, v37, v133, v50
    v_dot2_f32_bf16 v51, v37, v165, v51
    v_dot2_f32_bf16 v52, v21, v197, v52
    v_dot2_f32_bf16 v53, v21, v229, v53
    v_dot2_f32_bf16 v54, v37, v197, v54
    v_dot2_f32_bf16 v55, v37, v229, v55
    v_dot2_f32_bf16 v48, v22, v134, v48
    v_dot2_f32_bf16 v49, v22, v166, v49
    v_dot2_f32_bf16 v50, v38, v134, v50
    v_dot2_f32_bf16 v51, v38, v166, v51
    v_dot2_f32_bf16 v52, v22, v198, v52
    v_dot2_f32_bf16 v53, v22, v230, v53
    v_dot2_f32_bf16 v54, v38, v198, v54
    v_dot2_f32_bf16 v55, v38, v230, v55
    v_dot2_f32_bf16 v48, v23, v135, v48
    v_dot2_f32_bf16 v49, v23, v167, v49
    v_dot2_f32_bf16 v50, v39, v135, v50
    v_dot2_f32_bf16 v51, v39, v167, v51
    v_dot2_f32_bf16 v52, v23, v199, v52
    v_dot2_f32_bf16 v53, v23, v231, v53
    v_dot2_f32_bf16 v54, v39, v199, v54
    v_dot2_f32_bf16 v55, v39, v231, v55
    v_dot2_f32_bf16 v48, v24, v136, v48
    v_dot2_f32_bf16 v49, v24, v168, v49
    v_dot2_f32_bf16 v50, v40, v136, v50
    v_dot2_f32_bf16 v51, v40, v168, v51
    v_dot2_f32_bf16 v52, v24, v200, v52
    v_dot2_f32_bf16 v53, v24, v232, v53
    v_dot2_f32_bf16 v54, v40, v200, v54
    v_dot2_f32_bf16 v55, v40, v232, v55
    v_dot2_f32_bf16 v48, v25, v137, v48
    v_dot2_f32_bf16 v49, v25, v169, v49
    v_dot2_f32_bf16 v50, v41, v137, v50
    v_dot2_f32_bf16 v51, v41, v169, v51
    v_dot2_f32_bf16 v52, v25, v201, v52
    v_dot2_f32_bf16 v53, v25, v233, v53
    v_dot2_f32_bf16 v54, v41, v201, v54
    v_dot2_f32_bf16 v55, v41, v233, v55
    v_dot2_f32_bf16 v48, v26, v138, v48
    v_dot2_f32_bf16 v49, v26, v170, v49
    v_dot2_f32_bf16 v50, v42, v138, v50
    v_dot2_f32_bf16 v51, v42, v170, v51
    v_dot2_f32_bf16 v52, v26, v202, v52
    v_dot2_f32_bf16 v53, v26, v234, v53
    v_dot2_f32_bf16 v54, v42, v202, v54
    v_dot2_f32_bf16 v55, v42, v234, v55
    v_dot2_f32_bf16 v48, v27, v139, v48
    v_dot2_f32_bf16 v49, v27, v171, v49
    v_dot2_f32_bf16 v50, v43, v139, v50
    v_dot2_f32_bf16 v51, v43, v171, v51
    v_dot2_f32_bf16 v52, v27, v203, v52
    v_dot2_f32_bf16 v53, v27, v235, v53
    v_dot2_f32_bf16 v54, v43, v203, v54
    v_dot2_f32_bf16 v55, v43, v235, v55
    v_dot2_f32_bf16 v48, v28, v140, v48
    v_dot2_f32_bf16 v49, v28, v172, v49
    v_dot2_f32_bf16 v50, v44, v140, v50
    v_dot2_f32_bf16 v51, v44, v172, v51
    v_dot2_f32_bf16 v52, v28, v204, v52
    v_dot2_f32_bf16 v53, v28, v236, v53
    v_dot2_f32_bf16 v54, v44, v204, v54
    v_dot2_f32_bf16 v55, v44, v236, v55
    v_dot2_f32_bf16 v48, v29, v141, v48
    v_dot2_f32_bf16 v49, v29, v173, v49
    v_dot2_f32_bf16 v50, v45, v141, v50
    v_dot2_f32_bf16 v51, v45, v173, v51
    v_dot2_f32_bf16 v52, v29, v205, v52
    v_dot2_f32_bf16 v53, v29, v237, v53
    v_dot2_f32_bf16 v54, v45, v205, v54
    v_dot2_f32_bf16 v55, v45, v237, v55
    v_dot2_f32_bf16 v48, v30, v142, v48
    v_dot2_f32_bf16 v49, v30, v174, v49
    v_dot2_f32_bf16 v50, v46, v142, v50
    v_dot2_f32_bf16 v51, v46, v174, v51
    v_dot2_f32_bf16 v52, v30, v206, v52
    v_dot2_f32_bf16 v53, v30, v238, v53
    v_dot2_f32_bf16 v54, v46, v206, v54
    v_dot2_f32_bf16 v55, v46, v238, v55
    v_dot2_f32_bf16 v48, v31, v143, v48
    v_dot2_f32_bf16 v49, v31, v175, v49
    v_dot2_f32_bf16 v50, v47, v143, v50
    v_dot2_f32_bf16 v51, v47, v175, v51
    v_dot2_f32_bf16 v52, v31, v207, v52
    v_dot2_f32_bf16 v53, v31, v239, v53
    v_dot2_f32_bf16 v54, v47, v207, v54
    v_dot2_f32_bf16 v55, v47, v239, v55
    ds_read_b128 v[16:19], v8 offset:4160
    ds_read_b128 v[20:23], v8 offset:4176
    ds_read_b128 v[24:27], v8 offset:4192
    ds_read_b128 v[28:31], v8 offset:4208
    ds_read_b128 v[32:35], v8 offset:5184
    ds_read_b128 v[36:39], v8 offset:5200
    ds_read_b128 v[40:43], v8 offset:5216
    ds_read_b128 v[44:47], v8 offset:5232
    s_waitcnt lgkmcnt(0)
    v_dot2_f32_bf16 v48, v16, v144, v48
    v_dot2_f32_bf16 v49, v16, v176, v49
    v_dot2_f32_bf16 v50, v32, v144, v50
    v_dot2_f32_bf16 v51, v32, v176, v51
    v_dot2_f32_bf16 v52, v16, v208, v52
    v_dot2_f32_bf16 v53, v16, v240, v53
    v_dot2_f32_bf16 v54, v32, v208, v54
    v_dot2_f32_bf16 v55, v32, v240, v55
    v_dot2_f32_bf16 v48, v17, v145, v48
    v_dot2_f32_bf16 v49, v17, v177, v49
    v_dot2_f32_bf16 v50, v33, v145, v50
    v_dot2_f32_bf16 v51, v33, v177, v51
    v_dot2_f32_bf16 v52, v17, v209, v52
    v_dot2_f32_bf16 v53, v17, v241, v53
    v_dot2_f32_bf16 v54, v33, v209, v54
    v_dot2_f32_bf16 v55, v33, v241, v55
    v_dot2_f32_bf16 v48, v18, v146, v48
    v_dot2_f32_bf16 v49, v18, v178, v49
    v_dot2_f32_bf16 v50, v34, v146, v50
    v_dot2_f32_bf16 v51, v34, v178, v51
    v_dot2_f32_bf16 v52, v18, v210, v52
    v_dot2_f32_bf16 v53, v18, v242, v53
    v_dot2_f32_bf16 v54, v34, v210, v54
    v_dot2_f32_bf16 v55, v34, v242, v55
    v_dot2_f32_bf16 v48, v19, v147, v48
    v_dot2_f32_bf16 v49, v19, v179, v49
    v_dot2_f32_bf16 v50, v35, v147, v50
    v_dot2_f32_bf16 v51, v35, v179, v51
    v_dot2_f32_bf16 v52, v19, v211, v52
    v_dot2_f32_bf16 v53, v19, v243, v53
    v_dot2_f32_bf16 v54, v35, v211, v54
    v_dot2_f32_bf16 v55, v35, v243, v55
    v_dot2_f32_bf16 v48, v20, v148, v48
    v_dot2_f32_bf16 v49, v20, v180, v49
    v_dot2_f32_bf16 v50, v36, v148, v50
    v_dot2_f32_bf16 v51, v36, v180, v51
    v_dot2_f32_bf16 v52, v20, v212, v52
    v_dot2_f32_bf16 v53, v20, v244, v53
    v_dot2_f32_bf16 v54, v36, v212, v54
    v_dot2_f32_bf16 v55, v36, v244, v55
    v_dot2_f32_bf16 v48, v21, v149, v48
    v_dot2_f32_bf16 v49, v21, v181, v49
    v_dot2_f32_bf16 v50, v37, v149, v50
    v_dot2_f32_bf16 v51, v37, v181, v51
    v_dot2_f32_bf16 v52, v21, v213, v52
    v_dot2_f32_bf16 v53, v21, v245, v53
    v_dot2_f32_bf16 v54, v37, v213, v54
    v_dot2_f32_bf16 v55, v37, v245, v55
    v_dot2_f32_bf16 v48, v22, v150, v48
    v_dot2_f32_bf16 v49, v22, v182, v49
    v_dot2_f32_bf16 v50, v38, v150, v50
    v_dot2_f32_bf16 v51, v38, v182, v51
    v_dot2_f32_bf16 v52, v22, v214, v52
    v_dot2_f32_bf16 v53, v22, v246, v53
    v_dot2_f32_bf16 v54, v38, v214, v54
    v_dot2_f32_bf16 v55, v38, v246, v55
    v_dot2_f32_bf16 v48, v23, v151, v48
    v_dot2_f32_bf16 v49, v23, v183, v49
    v_dot2_f32_bf16 v50, v39, v151, v50
    v_dot2_f32_bf16 v51, v39, v183, v51
    v_dot2_f32_bf16 v52, v23, v215, v52
    v_dot2_f32_bf16 v53, v23, v247, v53
    v_dot2_f32_bf16 v54, v39, v215, v54
    v_dot2_f32_bf16 v55, v39, v247, v55
    v_dot2_f32_bf16 v48, v24, v152, v48
    v_dot2_f32_bf16 v49, v24, v184, v49
    v_dot2_f32_bf16 v50, v40, v152, v50
    v_dot2_f32_bf16 v51, v40, v184, v51
    v_dot2_f32_bf16 v52, v24, v216, v52
    v_dot2_f32_bf16 v53, v24, v248, v53
    v_dot2_f32_bf16 v54, v40, v216, v54
    v_dot2_f32_bf16 v55, v40, v248, v55
    v_dot2_f32_bf16 v48, v25, v153, v48
    v_dot2_f32_bf16 v49, v25, v185, v49
    v_dot2_f32_bf16 v50, v41, v153, v50
    v_dot2_f32_bf16 v51, v41, v185, v51
    v_dot2_f32_bf16 v52, v25, v217, v52
    v_dot2_f32_bf16 v53, v25, v249, v53
    v_dot2_f32_bf16 v54, v41, v217, v54
    v_dot2_f32_bf16 v55, v41, v249, v55
    v_dot2_f32_bf16 v48, v26, v154, v48
    v_dot2_f32_bf16 v49, v26, v186, v49
    v_dot2_f32_bf16 v50, v42, v154, v50
    v_dot2_f32_bf16 v51, v42, v186, v51
    v_dot2_f32_bf16 v52, v26, v218, v52
    v_dot2_f32_bf16 v53, v26, v250, v53
    v_dot2_f32_bf16 v54, v42, v218, v54
    v_dot2_f32_bf16 v55, v42, v250, v55
    v_dot2_f32_bf16 v48, v27, v155, v48
    v_dot2_f32_bf16 v49, v27, v187, v49
    v_dot2_f32_bf16 v50, v43, v155, v50
    v_dot2_f32_bf16 v51, v43, v187, v51
    v_dot2_f32_bf16 v52, v27, v219, v52
    v_dot2_f32_bf16 v53, v27, v251, v53
    v_dot2_f32_bf16 v54, v43, v219, v54
    v_dot2_f32_bf16 v55, v43, v251, v55
    v_dot2_f32_bf16 v48, v28, v156, v48
    v_dot2_f32_bf16 v49, v28, v188, v49
    v_dot2_f32_bf16 v50, v44, v156, v50
    v_dot2_f32_bf16 v51, v44, v188, v51
    v_dot2_f32_bf16 v52, v28, v220, v52
    v_dot2_f32_bf16 v53, v28, v252, v53
    v_dot2_f32_bf16 v54, v44, v220, v54
    v_dot2_f32_bf16 v55, v44, v252, v55
    v_dot2_f32_bf16 v48, v29, v157, v48
    v_dot2_f32_bf16 v49, v29, v189, v49
    v_dot2_f32_bf16 v50, v45, v157, v50
    v_dot2_f32_bf16 v51, v45, v189, v51
    v_dot2_f32_bf16 v52, v29, v221, v52
    v_dot2_f32_bf16 v53, v29, v253, v53
    v_dot2_f32_bf16 v54, v45, v221, v54
    v_dot2_f32_bf16 v55, v45, v253, v55
    v_dot2_f32_bf16 v48, v30, v158, v48
    v_dot2_f32_bf16 v49, v30, v190, v49
    v_dot2_f32_bf16 v50, v46, v158, v50
    v_dot2_f32_bf16 v51, v46, v190, v51
    v_dot2_f32_bf16 v52, v30, v222, v52
    v_dot2_f32_bf16 v53, v30, v254, v53
    v_dot2_f32_bf16 v54, v46, v222, v54
    v_dot2_f32_bf16 v55, v46, v254, v55
    v_dot2_f32_bf16 v48, v31, v159, v48
    v_dot2_f32_bf16 v49, v31, v191, v49
    v_dot2_f32_bf16 v50, v47, v159, v50
    v_dot2_f32_bf16 v51, v47, v191, v51
    v_dot2_f32_bf16 v52, v31, v223, v52
    v_dot2_f32_bf16 v53, v31, v255, v53
    v_dot2_f32_bf16 v54, v47, v223, v54
    v_dot2_f32_bf16 v55, v47, v255, v55
    s_nop 3
    v_lshlrev_b32 v7, 5, v0
    ds_write_b128 v7, v[48:51] offset:8192
    ds_write_b128 v7, v[52:55] offset:8208
    s_waitcnt lgkmcnt(0)
    s_barrier
    v_lshlrev_b32 v7, 5, v2
    v_bfe_u32 v8, v0, 5, 1
    v_lshl_add_u32 v7, v8, 3, v7
    ds_read_b64 v[16:17], v7 offset:8192
    ds_read_b64 v[18:19], v7 offset:8208
    ds_read_b64 v[20:21], v7 offset:9216
    ds_read_b64 v[22:23], v7 offset:9232
    ds_read_b64 v[24:25], v7 offset:10240
    ds_read_b64 v[26:27], v7 offset:10256
    ds_read_b64 v[28:29], v7 offset:11264
    ds_read_b64 v[30:31], v7 offset:11280
    s_waitcnt lgkmcnt(0)
    ds_read_b64 v[32:33], v7 offset:12288
    ds_read_b64 v[34:35], v7 offset:12304
    ds_read_b64 v[36:37], v7 offset:13312
    ds_read_b64 v[38:39], v7 offset:13328
    ds_read_b64 v[40:41], v7 offset:14336
    ds_read_b64 v[42:43], v7 offset:14352
    ds_read_b64 v[44:45], v7 offset:15360
    ds_read_b64 v[46:47], v7 offset:15376
    s_waitcnt lgkmcnt(0)
    v_add_f32 v16, v16, v20
    v_add_f32 v16, v16, v24
    v_add_f32 v16, v16, v28
    v_add_f32 v16, v16, v32
    v_add_f32 v16, v16, v36
    v_add_f32 v16, v16, v40
    v_add_f32 v16, v16, v44
    v_cvt_pk_bf16_f32 v5, v16, v16
    v_lshlrev_b32 v16, 16, v5
    v_add_f32 v17, v17, v21
    v_add_f32 v17, v17, v25
    v_add_f32 v17, v17, v29
    v_add_f32 v17, v17, v33
    v_add_f32 v17, v17, v37
    v_add_f32 v17, v17, v41
    v_add_f32 v17, v17, v45
    v_cvt_pk_bf16_f32 v5, v17, v17
    v_lshlrev_b32 v17, 16, v5
    v_add_f32 v18, v18, v22
    v_add_f32 v18, v18, v26
    v_add_f32 v18, v18, v30
    v_add_f32 v18, v18, v34
    v_add_f32 v18, v18, v38
    v_add_f32 v18, v18, v42
    v_add_f32 v18, v18, v46
    v_cvt_pk_bf16_f32 v5, v18, v18
    v_lshlrev_b32 v18, 16, v5
    v_add_f32 v19, v19, v23
    v_add_f32 v19, v19, v27
    v_add_f32 v19, v19, v31
    v_add_f32 v19, v19, v35
    v_add_f32 v19, v19, v39
    v_add_f32 v19, v19, v43
    v_add_f32 v19, v19, v47
    v_cvt_pk_bf16_f32 v5, v19, v19
    v_lshlrev_b32 v19, 16, v5
    v_mul_f32 v6, 0xbfb8aa3b, v16
    v_exp_f32 v6, v6
    s_nop 0
    v_add_f32 v6, 1.0, v6
    v_rcp_f32 v6, v6
    s_nop 0
    v_mul_f32 v16, v16, v6
    v_cvt_pk_bf16_f32 v5, v16, v16
    v_lshlrev_b32 v16, 16, v5
    v_mul_f32 v16, v16, v18
    v_mul_f32 v6, 0xbfb8aa3b, v17
    v_exp_f32 v6, v6
    s_nop 0
    v_add_f32 v6, 1.0, v6
    v_rcp_f32 v6, v6
    s_nop 0
    v_mul_f32 v17, v17, v6
    v_cvt_pk_bf16_f32 v5, v17, v17
    v_lshlrev_b32 v17, 16, v5
    v_mul_f32 v17, v17, v19
    v_cvt_pk_bf16_f32 v16, v16, v17
    v_mul_u32_u24 v8, 3584, v8
    v_lshl_add_u32 v7, v2, 2, v8
    v_mov_b32 v6, 0x40000000
    v_cmp_lt_u32 vcc, 27, v2
    s_nop 1
    v_cndmask_b32 v7, v7, v6, vcc
    v_cmp_lt_u32 vcc, 63, v0
    s_nop 1
    v_cndmask_b32 v7, v7, v6, vcc
    s_mul_i32 s37, s24, 8192
    s_add_u32 s37, s37, 0x1b0000
    s_add_u32 s36, s37, s23
    buffer_store_dword v16, v7, s[8:11], s36 offen sc1
    v_lshlrev_b32 v7, 4, v0
    v_add_u32 v8, 4096, v7
    v_cmp_lt_u32 vcc, 191, v0
    s_nop 1
    v_cndmask_b32 v8, v8, v6, vcc
L_M_act:
    buffer_load_dwordx4 v[20:23], v7, s[8:11], s37 offen sc1
    buffer_load_dwordx4 v[24:27], v8, s[8:11], s37 offen sc1
    s_add_u32 s32, s32, 1
    s_cmp_gt_u32 s32, 200000
    s_waitcnt vmcnt(0)
    v_max3_u32 v5, v20, v21, v22
    v_max3_u32 v5, v5, v23, v24
    v_max3_u32 v5, v5, v25, v26
    v_max_u32 v5, v5, v27
    s_cbranch_scc1 L_M_act_ok
    v_cmp_eq_u32 vcc, -1, v5
    s_cbranch_vccnz L_M_act
L_M_act_ok:
    ds_write_b128 v7, v[20:23] offset:16384
    ds_write_b128 v7, v[24:27] offset:20480
    s_waitcnt lgkmcnt(0)
    s_barrier
    v_lshrrev_b32 v7, 3, v0
    v_mul_u32_u24 v7, 112, v7
    v_mov_b64 v[48:49], 0
    v_mov_b64 v[50:51], 0
    ds_read_b128 v[16:19], v7 offset:16384
    ds_read_b128 v[20:23], v7 offset:16400
    ds_read_b128 v[24:27], v7 offset:16416
    ds_read_b128 v[28:31], v7 offset:16432
    ds_read_b128 v[32:35], v7 offset:16448
    ds_read_b128 v[36:39], v7 offset:16464
    ds_read_b128 v[40:43], v7 offset:16480
    s_waitcnt lgkmcnt(0)
    v_dot2_f32_bf16 v48, v16, v64, v48
    v_dot2_f32_bf16 v49, v16, v92, v49
    v_dot2_f32_bf16 v48, v17, v65, v48
    v_dot2_f32_bf16 v49, v17, v93, v49
    v_dot2_f32_bf16 v48, v18, v66, v48
    v_dot2_f32_bf16 v49, v18, v94, v49
    v_dot2_f32_bf16 v48, v19, v67, v48
    v_dot2_f32_bf16 v49, v19, v95, v49
    v_dot2_f32_bf16 v48, v20, v68, v48
    v_dot2_f32_bf16 v49, v20, v96, v49
    v_dot2_f32_bf16 v48, v21, v69, v48
    v_dot2_f32_bf16 v49, v21, v97, v49
    v_dot2_f32_bf16 v48, v22, v70, v48
    v_dot2_f32_bf16 v49, v22, v98, v49
    v_dot2_f32_bf16 v48, v23, v71, v48
    v_dot2_f32_bf16 v49, v23, v99, v49
    v_dot2_f32_bf16 v48, v24, v72, v48
    v_dot2_f32_bf16 v49, v24, v100, v49
    v_dot2_f32_bf16 v48, v25, v73, v48
    v_dot2_f32_bf16 v49, v25, v101, v49
    v_dot2_f32_bf16 v48, v26, v74, v48
    v_dot2_f32_bf16 v49, v26, v102, v49
    v_dot2_f32_bf16 v48, v27, v75, v48
    v_dot2_f32_bf16 v49, v27, v103, v49
    v_dot2_f32_bf16 v48, v28, v76, v48
    v_dot2_f32_bf16 v49, v28, v104, v49
    v_dot2_f32_bf16 v48, v29, v77, v48
    v_dot2_f32_bf16 v49, v29, v105, v49
    v_dot2_f32_bf16 v48, v30, v78, v48
    v_dot2_f32_bf16 v49, v30, v106, v49
    v_dot2_f32_bf16 v48, v31, v79, v48
    v_dot2_f32_bf16 v49, v31, v107, v49
    v_dot2_f32_bf16 v48, v32, v80, v48
    v_dot2_f32_bf16 v49, v32, v108, v49
    v_dot2_f32_bf16 v48, v33, v81, v48
    v_dot2_f32_bf16 v49, v33, v109, v49
    v_dot2_f32_bf16 v48, v34, v82, v48
    v_dot2_f32_bf16 v49, v34, v110, v49
    v_dot2_f32_bf16 v48, v35, v83, v48
    v_dot2_f32_bf16 v49, v35, v111, v49
    v_dot2_f32_bf16 v48, v36, v84, v48
    v_dot2_f32_bf16 v49, v36, v112, v49
    v_dot2_f32_bf16 v48, v37, v85, v48
    v_dot2_f32_bf16 v49, v37, v113, v49
    v_dot2_f32_bf16 v48, v38, v86, v48
    v_dot2_f32_bf16 v49, v38, v114, v49
    v_dot2_f32_bf16 v48, v39, v87, v48
    v_dot2_f32_bf16 v49, v39, v115, v49
    v_dot2_f32_bf16 v48, v40, v88, v48
    v_dot2_f32_bf16 v49, v40, v116, v49
    v_dot2_f32_bf16 v48, v41, v89, v48
    v_dot2_f32_bf16 v49, v41, v117, v49
    v_dot2_f32_bf16 v48, v42, v90, v48
    v_dot2_f32_bf16 v49, v42, v118, v49
    v_dot2_f32_bf16 v48, v43, v91, v48
    v_dot2_f32_bf16 v49, v43, v119, v49
    ds_read_b128 v[16:19], v7 offset:19968
    ds_read_b128 v[20:23], v7 offset:19984
    ds_read_b128 v[24:27], v7 offset:20000
    ds_read_b128 v[28:31], v7 offset:20016
    ds_read_b128 v[32:35], v7 offset:20032
    ds_read_b128 v[36:39], v7 offset:20048
    ds_read_b128 v[40:43], v7 offset:20064
    s_waitcnt lgkmcnt(0)
    v_dot2_f32_bf16 v50, v16, v64, v50
    v_dot2_f32_bf16 v51, v16, v92, v51
    v_dot2_f32_bf16 v50, v17, v65, v50
    v_dot2_f32_bf16 v51, v17, v93, v51
    v_dot2_f32_bf16 v50, v18, v66, v50
    v_dot2_f32_bf16 v51, v18, v94, v51
    v_dot2_f32_bf16 v50, v19, v67, v50
    v_dot2_f32_bf16 v51, v19, v95, v51
    v_dot2_f32_bf16 v50, v20, v68, v50
    v_dot2_f32_bf16 v51, v20, v96, v51
    v_dot2_f32_bf16 v50, v21, v69, v50
    v_dot2_f32_bf16 v51, v21, v97, v51
    v_dot2_f32_bf16 v50, v22, v70, v50
    v_dot2_f32_bf16 v51, v22, v98, v51
    v_dot2_f32_bf16 v50, v23, v71, v50
    v_dot2_f32_bf16 v51, v23, v99, v51
    v_dot2_f32_bf16 v50, v24, v72, v50
    v_dot2_f32_bf16 v51, v24, v100, v51
    v_dot2_f32_bf16 v50, v25, v73, v50
    v_dot2_f32_bf16 v51, v25, v101, v51
    v_dot2_f32_bf16 v50, v26, v74, v50
    v_dot2_f32_bf16 v51, v26, v102, v51
    v_dot2_f32_bf16 v50, v27, v75, v50
    v_dot2_f32_bf16 v51, v27, v103, v51
    v_dot2_f32_bf16 v50, v28, v76, v50
    v_dot2_f32_bf16 v51, v28, v104, v51
    v_dot2_f32_bf16 v50, v29, v77, v50
    v_dot2_f32_bf16 v51, v29, v105, v51
    v_dot2_f32_bf16 v50, v30, v78, v50
    v_dot2_f32_bf16 v51, v30, v106, v51
    v_dot2_f32_bf16 v50, v31, v79, v50
    v_dot2_f32_bf16 v51, v31, v107, v51
    v_dot2_f32_bf16 v50, v32, v80, v50
    v_dot2_f32_bf16 v51, v32, v108, v51
    v_dot2_f32_bf16 v50, v33, v81, v50
    v_dot2_f32_bf16 v51, v33, v109, v51
    v_dot2_f32_bf16 v50, v34, v82, v50
    v_dot2_f32_bf16 v51, v34, v110, v51
    v_dot2_f32_bf16 v50, v35, v83, v50
    v_dot2_f32_bf16 v51, v35, v111, v51
    v_dot2_f32_bf16 v50, v36, v84, v50
    v_dot2_f32_bf16 v51, v36, v112, v51
    v_dot2_f32_bf16 v50, v37, v85, v50
    v_dot2_f32_bf16 v51, v37, v113, v51
    v_dot2_f32_bf16 v50, v38, v86, v50
    v_dot2_f32_bf16 v51, v38, v114, v51
    v_dot2_f32_bf16 v50, v39, v87, v50
    v_dot2_f32_bf16 v51, v39, v115, v51
    v_dot2_f32_bf16 v50, v40, v88, v50
    v_dot2_f32_bf16 v51, v40, v116, v51
    v_dot2_f32_bf16 v50, v41, v89, v50
    v_dot2_f32_bf16 v51, v41, v117, v51
    v_dot2_f32_bf16 v50, v42, v90, v50
    v_dot2_f32_bf16 v51, v42, v118, v51
    v_dot2_f32_bf16 v50, v43, v91, v50
    v_dot2_f32_bf16 v51, v43, v119, v51
    s_nop 3
    v_add_f32_dpp v48, v48, v48 row_ror:8 row_mask:0xf bank_mask:0xf
    v_add_f32_dpp v49, v49, v49 row_ror:8 row_mask:0xf bank_mask:0xf
    v_add_f32_dpp v50, v50, v50 row_ror:8 row_mask:0xf bank_mask:0xf
    v_add_f32_dpp v51, v51, v51 row_ror:8 row_mask:0xf bank_mask:0xf
    v_mov_b32 v5, v48
    s_nop 1
    v_permlane16_swap_b32 v48, v5
    v_add_f32 v48, v48, v5
    v_mov_b32 v5, v49
    s_nop 1
    v_permlane16_swap_b32 v49, v5
    v_add_f32 v49, v49, v5
    v_mov_b32 v5, v50
    s_nop 1
    v_permlane16_swap_b32 v50, v5
    v_add_f32 v50, v50, v5
    v_mov_b32 v5, v51
    s_nop 1
    v_permlane16_swap_b32 v51, v5
    v_add_f32 v51, v51, v5
    v_mov_b32 v5, v48
    s_nop 1
    v_permlane32_swap_b32 v48, v5
    v_add_f32 v48, v48, v5
    v_mov_b32 v5, v49
    s_nop 1
    v_permlane32_swap_b32 v49, v5
    v_add_f32 v49, v49, v5
    v_mov_b32 v5, v50
    s_nop 1
    v_permlane32_swap_b32 v50, v5
    v_add_f32 v50, v50, v5
    v_mov_b32 v5, v51
    s_nop 1
    v_permlane32_swap_b32 v51, v5
    v_add_f32 v51, v51, v5
    v_lshrrev_b32 v7, 6, v0
    v_lshlrev_b32 v7, 7, v7
    v_lshl_add_u32 v7, v3, 4, v7
    ds_write_b128 v7, v[48:51] offset:1024
    s_waitcnt lgkmcnt(0)
    s_barrier
    v_lshlrev_b32 v7, 4, v3
    v_lshl_add_u32 v7, v9, 3, v7
    ds_read_b64 v[16:17], v7 offset:1024
    ds_read_b64 v[18:19], v7 offset:1152
    ds_read_b64 v[20:21], v7 offset:1280
    ds_read_b64 v[22:23], v7 offset:1408
    v_mul_f32 v10, 0xbfb8aa3b, v11
    v_exp_f32 v10, v10
    s_nop 0
    v_add_f32 v10, 1.0, v10
    v_rcp_f32 v10, v10
    s_nop 0
    v_cvt_pk_bf16_f32 v5, v10, v10
    v_lshlrev_b32 v10, 16, v5
    s_waitcnt lgkmcnt(0)
    v_lshlrev_b32 v24, 16, v15
    v_and_b32 v25, 0xffff0000, v15
    v_lshlrev_b32 v26, 16, v14
    v_and_b32 v27, 0xffff0000, v14
    v_add_f32 v16, v16, v18
    v_add_f32 v20, v20, v22
    v_add_f32 v16, v16, v20
    v_cvt_pk_bf16_f32 v5, v16, v16
    v_lshlrev_b32 v16, 16, v5
    v_mul_f32 v16, v16, v10
    v_cvt_pk_bf16_f32 v5, v16, v16
    v_lshlrev_b32 v16, 16, v5
    v_add_f32 v16, v16, v24
    v_cvt_pk_bf16_f32 v5, v16, v16
    v_lshlrev_b32 v16, 16, v5
    v_add_f32 v16, v16, v26
    v_add_f32 v17, v17, v19
    v_add_f32 v21, v21, v23
    v_add_f32 v17, v17, v21
    v_cvt_pk_bf16_f32 v5, v17, v17
    v_lshlrev_b32 v17, 16, v5
    v_mul_f32 v17, v17, v10
    v_cvt_pk_bf16_f32 v5, v17, v17
    v_lshlrev_b32 v17, 16, v5
    v_add_f32 v17, v17, v25
    v_cvt_pk_bf16_f32 v5, v17, v17
    v_lshlrev_b32 v17, 16, v5
    v_add_f32 v17, v17, v27
    v_cvt_pk_bf16_f32 v16, v16, v17
    buffer_store_dword v16, v12, s[60:63], 0 offen sc1
    v_add_f32 v24, v24, v26
    v_add_f32 v25, v25, v27
    v_cvt_pk_bf16_f32 v13, v24, v25
L_M_next:
    s_add_u32 s24, s24, 1
    s_mov_b32 s25, 192
    s_cmp_eq_u32 s24, 1
    s_cbranch_scc1 L_M_round
    s_cmp_eq_u32 s24, 3
    s_cbranch_scc1 L_end
    s_mov_b32 s25, 256
    v_and_b32 v7, 63, v0
    v_lshlrev_b32 v3, 4, v7
    s_mov_b32 s36, 0x19bc00
    v_sub_u32 v7, 63, v7
L_M_fin:
    buffer_load_dwordx4 v[16:19], v3, s[8:11], s36 offen sc1
    s_add_u32 s32, s32, 1
    s_cmp_gt_u32 s32, 200000
    s_cselect_b32 s37, -1, -2
    s_waitcnt vmcnt(0)
    v_max3_u32 v5, v16, v17, v18
    v_max_u32 v5, v5, v19
    v_cmp_lt_u32 vcc, s37, v5
    s_cbranch_vccnz L_M_fin
    v_add_f32 v16, v16, v17
    v_add_f32 v18, v18, v19
    v_add_f32 v16, v16, v18
    v_cvt_pk_bf16_f32 v5, v16, v16
    v_lshlrev_b32 v16, 16, v5
    v_ashrrev_i32 v5, 31, v16
    v_or_b32 v5, 0x80000000, v5
    v_xor_b32 v5, v5, v16
    v_and_or_b32 v5, v5, s42, v7
    v_cmp_lt_u32 vcc, s29, v5
    s_cbranch_vccnz L_M_round
L_end:
    s_endpgm
.section .rodata,"a"
.p2align 6
.amdhsa_kernel sequential_preLN__memory_aug_recurrent_mem_tr__moe_arch_mod__prompt_kernel
  .amdhsa_next_free_vgpr 512
  .amdhsa_next_free_sgpr 102
  .amdhsa_accum_offset 256
  .amdhsa_group_segment_fixed_size 0
  .amdhsa_kernarg_size 120
  .amdhsa_user_sgpr_count 2
  .amdhsa_user_sgpr_kernarg_segment_ptr 1
  .amdhsa_system_sgpr_workgroup_id_x 1
.end_amdhsa_kernel
```

```asm
; @launch grid=(256,1,1) block=(256,1,1) lds=163840
.amdgcn_target "amdgcn-amd-amdhsa--gfx950"
.text
.globl sequential_preLN__memory_aug_recurrent_mem_tr__moe_arch_mod__prompt_kernel
.p2align 8
.type sequential_preLN__memory_aug_recurrent_mem_tr__moe_arch_mod__prompt_kernel,@function
sequential_preLN__memory_aug_recurrent_mem_tr__moe_arch_mod__prompt_kernel:
    s_cmp_ge_u32 s2, 256
    s_cbranch_scc1 L_end
    s_load_dwordx8 s[44:51], s[0:1], 0
    s_load_dwordx4 s[52:55], s[0:1], 32
    s_load_dwordx4 s[56:59], s[0:1], 104
    s_load_dwordx2 s[80:81], s[0:1], 64
    s_load_dwordx2 s[82:83], s[0:1], 96
    s_load_dwordx4 s[84:87], s[0:1], 72
    s_load_dwordx2 s[88:89], s[0:1], 88
    v_lshrrev_b32 v1, 6, v0
    s_nop 0
    v_readfirstlane_b32 s21, v1
    s_waitcnt lgkmcnt(0)
    s_mov_b32 s8, s58
    s_and_b32 s9, s59, 0xffff
    s_mov_b32 s10, 0x10000000
    s_mov_b32 s11, 0x20000
    s_mov_b32 s16, s56
    s_and_b32 s17, s57, 0xffff
    s_mov_b32 s18, 0x100
    s_mov_b32 s19, 0x20000
    s_and_b32 s3, s2, 7
    s_cmp_lg_u32 s3, 0
    s_cbranch_scc1 L_worker
    s_lshr_b32 s20, s2, 3
    v_lshrrev_b32 v28, 4, v0
    v_and_b32 v16, 15, v0
    v_lshlrev_b32 v16, 4, v16
    v_lshl_add_u32 v16, v28, 13, v16
    v_bfe_u32 v29, v0, 4, 1
    v_lshlrev_b32 v29, 5, v29
    v_xor_b32 v16, v16, v29
    v_and_b32 v29, 192, v0
    v_xor_b32 v16, v16, v29
    s_lshl_b32 s28, s21, 10
    s_lshl_b32 s3, s20, 8
    s_mov_b32 s60, s52
    s_and_b32 s61, s53, 0xffff
    s_mov_b32 s62, 0x400000
    s_mov_b32 s63, 0x20000
    s_add_u32 m0, s28, 32768
    s_add_u32 s37, s3, 0x0
    buffer_load_dwordx4 v16, s[60:63], s37 offen lds
    s_add_u32 m0, s28, 36864
    s_add_u32 s37, s3, 0x20000
    buffer_load_dwordx4 v16, s[60:63], s37 offen lds
    s_add_u32 m0, s28, 65536
    s_add_u32 s37, s3, 0x40000
    buffer_load_dwordx4 v16, s[60:63], s37 offen lds
    s_add_u32 m0, s28, 69632
    s_add_u32 s37, s3, 0x60000
    buffer_load_dwordx4 v16, s[60:63], s37 offen lds
    s_add_u32 m0, s28, 98304
    s_add_u32 s37, s3, 0x80000
    buffer_load_dwordx4 v16, s[60:63], s37 offen lds
    s_add_u32 m0, s28, 102400
    s_add_u32 s37, s3, 0xa0000
    buffer_load_dwordx4 v16, s[60:63], s37 offen lds
    s_add_u32 m0, s28, 131072
    s_add_u32 s37, s3, 0xc0000
    buffer_load_dwordx4 v16, s[60:63], s37 offen lds
    s_add_u32 m0, s28, 135168
    s_add_u32 s37, s3, 0xe0000
    buffer_load_dwordx4 v16, s[60:63], s37 offen lds
    s_add_u32 m0, s28, 40960
    s_add_u32 s37, s3, 0x100000
    buffer_load_dwordx4 v16, s[60:63], s37 offen lds
    s_add_u32 m0, s28, 45056
    s_add_u32 s37, s3, 0x120000
    buffer_load_dwordx4 v16, s[60:63], s37 offen lds
    s_add_u32 m0, s28, 73728
    s_add_u32 s37, s3, 0x140000
    buffer_load_dwordx4 v16, s[60:63], s37 offen lds
    s_add_u32 m0, s28, 77824
    s_add_u32 s37, s3, 0x160000
    buffer_load_dwordx4 v16, s[60:63], s37 offen lds
    s_add_u32 m0, s28, 106496
    s_add_u32 s37, s3, 0x180000
    buffer_load_dwordx4 v16, s[60:63], s37 offen lds
    s_add_u32 m0, s28, 110592
    s_add_u32 s37, s3, 0x1a0000
    buffer_load_dwordx4 v16, s[60:63], s37 offen lds
    s_add_u32 m0, s28, 139264
    s_add_u32 s37, s3, 0x1c0000
    buffer_load_dwordx4 v16, s[60:63], s37 offen lds
    s_add_u32 m0, s28, 143360
    s_add_u32 s37, s3, 0x1e0000
    buffer_load_dwordx4 v16, s[60:63], s37 offen lds
    s_add_u32 m0, s28, 49152
    s_add_u32 s37, s3, 0x200000
    buffer_load_dwordx4 v16, s[60:63], s37 offen lds
    s_add_u32 m0, s28, 53248
    s_add_u32 s37, s3, 0x220000
    buffer_load_dwordx4 v16, s[60:63], s37 offen lds
    s_add_u32 m0, s28, 81920
    s_add_u32 s37, s3, 0x240000
    buffer_load_dwordx4 v16, s[60:63], s37 offen lds
    s_add_u32 m0, s28, 86016
    s_add_u32 s37, s3, 0x260000
    buffer_load_dwordx4 v16, s[60:63], s37 offen lds
    s_add_u32 m0, s28, 114688
    s_add_u32 s37, s3, 0x280000
    buffer_load_dwordx4 v16, s[60:63], s37 offen lds
    s_add_u32 m0, s28, 118784
    s_add_u32 s37, s3, 0x2a0000
    buffer_load_dwordx4 v16, s[60:63], s37 offen lds
    s_add_u32 m0, s28, 147456
    s_add_u32 s37, s3, 0x2c0000
    buffer_load_dwordx4 v16, s[60:63], s37 offen lds
    s_add_u32 m0, s28, 151552
    s_add_u32 s37, s3, 0x2e0000
    buffer_load_dwordx4 v16, s[60:63], s37 offen lds
    v_mov_b32 v20, 0x0
    v_bfe_u32 v14, v0, 0, 1
    s_mov_b32 s38, 0x8
    v_mad_u32_u24 v20, v14, s38, v20
    v_bfe_u32 v14, v0, 1, 1
    s_mov_b32 s38, 0x10
    v_mad_u32_u24 v20, v14, s38, v20
    v_bfe_u32 v14, v0, 2, 1
    s_mov_b32 s38, 0x100
    v_mad_u32_u24 v20, v14, s38, v20
    v_bfe_u32 v14, v0, 3, 1
    s_mov_b32 s38, 0x800
    v_mad_u32_u24 v20, v14, s38, v20
    v_bfe_u32 v14, v0, 4, 1
    s_mov_b32 s38, 0x400
    v_mad_u32_u24 v20, v14, s38, v20
    v_bfe_u32 v14, v0, 5, 1
    s_mov_b32 s38, 0x1000
    v_mad_u32_u24 v20, v14, s38, v20
    v_mov_b32 v30, 0x0
    v_bfe_u32 v14, v0, 2, 1
    s_mov_b32 s38, 0x20
    v_mad_u32_u24 v30, v14, s38, v30
    v_bfe_u32 v14, v0, 3, 1
    s_mov_b32 s38, 0x80
    v_mad_u32_u24 v30, v14, s38, v30
    v_bfe_u32 v14, v0, 4, 1
    s_mov_b32 s38, 0x40
    v_mad_u32_u24 v30, v14, s38, v30
    v_mov_b32 v31, 0x0
    v_bfe_u32 v14, v0, 6, 1
    s_mov_b32 s38, 0x40
    v_mad_u32_u24 v31, v14, s38, v31
    v_bfe_u32 v14, v0, 7, 1
    s_mov_b32 s38, 0x80
    v_mad_u32_u24 v31, v14, s38, v31
    v_xor_b32 v30, v30, v31
    v_add_u32 v30, v30, v20
    s_xor_b32 s36, s21, 0
    s_add_u32 s36, s36, 1
    s_lshl_b32 s36, s36, 15
    v_add_u32 v20, s36, v30
    v_xor_b32 v21, 32, v20
    s_xor_b32 s36, s21, 1
    s_add_u32 s36, s36, 1
    s_lshl_b32 s36, s36, 15
    v_add_u32 v22, s36, v30
    v_xor_b32 v23, 32, v22
    s_xor_b32 s36, s21, 2
    s_add_u32 s36, s36, 1
    s_lshl_b32 s36, s36, 15
    v_add_u32 v24, s36, v30
    v_xor_b32 v25, 32, v24
    s_xor_b32 s36, s21, 3
    s_add_u32 s36, s36, 1
    s_lshl_b32 s36, s36, 15
    v_add_u32 v26, s36, v30
    v_xor_b32 v27, 32, v26
    v_mov_b32 v11, 0x0
    v_bfe_u32 v14, v0, 0, 1
    s_mov_b32 s38, 0x4
    v_mad_u32_u24 v11, v14, s38, v11
    v_bfe_u32 v14, v0, 1, 1
    s_mov_b32 s38, 0x8
    v_mad_u32_u24 v11, v14, s38, v11
    v_bfe_u32 v14, v0, 2, 1
    s_mov_b32 s38, 0x10
    v_mad_u32_u24 v11, v14, s38, v11
    v_bfe_u32 v14, v0, 3, 1
    s_mov_b32 s38, 0x20
    v_mad_u32_u24 v11, v14, s38, v11
    v_bfe_u32 v14, v0, 4, 1
    s_mov_b32 s38, 0x800
    v_mad_u32_u24 v11, v14, s38, v11
    v_bfe_u32 v14, v0, 5, 1
    s_mov_b32 s38, 0x1000
    v_mad_u32_u24 v11, v14, s38, v11
    v_bfe_u32 v14, v0, 6, 1
    s_mov_b32 s38, 0x100
    v_mad_u32_u24 v11, v14, s38, v11
    v_bfe_u32 v14, v0, 7, 1
    s_mov_b32 s38, 0x200
    v_mad_u32_u24 v11, v14, s38, v11
    s_mov_b32 s92, s54
    s_and_b32 s93, s55, 0xffff
    s_mov_b32 s94, 0x400000
    s_mov_b32 s95, 0x20000
    s_lshl_b32 s29, s20, 17
    s_xor_b32 s36, s21, 3
    s_lshl_b32 s36, s36, 15
    s_add_u32 s36, s36, s29
    s_add_u32 s37, s36, 0x80
    buffer_load_dword v32, v11, s[92:95], s37 offen
    s_add_u32 s37, s36, 0x4080
    buffer_load_dword v33, v11, s[92:95], s37 offen
    s_add_u32 s37, s36, 0x480
    buffer_load_dword v34, v11, s[92:95], s37 offen
    s_add_u32 s37, s36, 0x4480
    buffer_load_dword v35, v11, s[92:95], s37 offen
    s_add_u32 s37, s36, 0x2080
    buffer_load_dword v36, v11, s[92:95], s37 offen
    s_add_u32 s37, s36, 0x6080
    buffer_load_dword v37, v11, s[92:95], s37 offen
    s_add_u32 s37, s36, 0x2480
    buffer_load_dword v38, v11, s[92:95], s37 offen
    s_add_u32 s37, s36, 0x6480
    buffer_load_dword v39, v11, s[92:95], s37 offen
    s_add_u32 s37, s36, 0xc0
    buffer_load_dword v40, v11, s[92:95], s37 offen
    s_add_u32 s37, s36, 0x40c0
    buffer_load_dword v41, v11, s[92:95], s37 offen
    s_add_u32 s37, s36, 0x4c0
    buffer_load_dword v42, v11, s[92:95], s37 offen
    s_add_u32 s37, s36, 0x44c0
    buffer_load_dword v43, v11, s[92:95], s37 offen
    s_add_u32 s37, s36, 0x20c0
    buffer_load_dword v44, v11, s[92:95], s37 offen
    s_add_u32 s37, s36, 0x60c0
    buffer_load_dword v45, v11, s[92:95], s37 offen
    s_add_u32 s37, s36, 0x24c0
    buffer_load_dword v46, v11, s[92:95], s37 offen
    s_add_u32 s37, s36, 0x64c0
    buffer_load_dword v47, v11, s[92:95], s37 offen
    s_getreg_b32 s36, hwreg(HW_REG_XCC_ID)
    s_and_b32 s36, s36, 15
    s_or_b32 s36, s36, 0x100
    v_mov_b32 v30, s36
    s_lshl_b32 s37, s20, 2
    v_lshlrev_b32 v31, 20, v0
    buffer_store_dword v30, v31, s[16:19], s37 offen offset:128 sc1
    s_mov_b32 s12, s46
    s_and_b32 s13, s47, 0xffff
    s_mov_b32 s14, 0x2000
    s_mov_b32 s15, 0x20000
    v_mov_b32 v104, 0x0
    v_bfe_u32 v14, v0, 0, 1
    s_mov_b32 s38, 0x8
    v_mad_u32_u24 v104, v14, s38, v104
    v_bfe_u32 v14, v0, 1, 1
    s_mov_b32 s38, 0x10
    v_mad_u32_u24 v104, v14, s38, v104
    v_bfe_u32 v14, v0, 2, 1
    s_mov_b32 s38, 0x10000
    v_mad_u32_u24 v104, v14, s38, v104
    v_bfe_u32 v14, v0, 3, 1
    s_mov_b32 s38, 0x10000
    v_mad_u32_u24 v104, v14, s38, v104
    v_bfe_u32 v14, v0, 4, 1
    s_mov_b32 s38, 0x400
    v_mad_u32_u24 v104, v14, s38, v104
    v_bfe_u32 v14, v0, 5, 1
    s_mov_b32 s38, 0x4
    v_mad_u32_u24 v104, v14, s38, v104
    v_bfe_u32 v14, v0, 6, 1
    s_mov_b32 s38, 0x40
    v_mad_u32_u24 v104, v14, s38, v104
    v_bfe_u32 v14, v0, 7, 1
    s_mov_b32 s38, 0x80
    v_mad_u32_u24 v104, v14, s38, v104
    v_mov_b32 v106, s20
    v_mov_b32 v105, 0x0
    v_bfe_u32 v14, v106, 0, 1
    s_mov_b32 s38, 0x20
    v_mad_u32_u24 v105, v14, s38, v105
    v_bfe_u32 v14, v106, 1, 1
    s_mov_b32 s38, 0x800
    v_mad_u32_u24 v105, v14, s38, v105
    v_bfe_u32 v14, v106, 2, 1
    s_mov_b32 s38, 0x1000
    v_mad_u32_u24 v105, v14, s38, v105
    v_bfe_u32 v14, v106, 3, 1
    s_mov_b32 s38, 0x100
    v_mad_u32_u24 v105, v14, s38, v105
    v_bfe_u32 v14, v106, 4, 1
    s_mov_b32 s38, 0x200
    v_mad_u32_u24 v105, v14, s38, v105
    v_add_u32 v104, v104, v105
    buffer_load_dword v12, v104, s[12:15], 0 offen
    v_mov_b32 v1, 0x4444
    v_bfe_u32 v14, v0, 1, 1
    s_mov_b32 s38, 0xaaaa
    v_mad_u32_u24 v1, v14, s38, v1
    v_mov_b32 v3, 0x0
    v_bfe_u32 v14, v0, 0, 1
    s_mov_b32 s38, 0x10
    v_mad_u32_u24 v3, v14, s38, v3
    v_bfe_u32 v14, v0, 1, 1
    s_mov_b32 s38, 0x20
    v_mad_u32_u24 v3, v14, s38, v3
    v_bfe_u32 v14, v0, 2, 1
    s_mov_b32 s38, 0x40
    v_mad_u32_u24 v3, v14, s38, v3
    v_bfe_u32 v14, v0, 3, 1
    s_mov_b32 s38, 0x80
    v_mad_u32_u24 v3, v14, s38, v3
    v_bfe_u32 v14, v0, 4, 1
    s_mov_b32 s38, 0x100
    v_mad_u32_u24 v3, v14, s38, v3
    v_bfe_u32 v14, v0, 5, 1
    s_mov_b32 s38, 0x200
    v_mad_u32_u24 v3, v14, s38, v3
    v_mov_b32 v2, 0x0
    v_bfe_u32 v14, v0, 0, 1
    s_mov_b32 s38, 0x10
    v_mad_u32_u24 v2, v14, s38, v2
    v_bfe_u32 v14, v0, 1, 1
    s_mov_b32 s38, 0x20
    v_mad_u32_u24 v2, v14, s38, v2
    v_bfe_u32 v14, v0, 2, 1
    s_mov_b32 s38, 0x40
    v_mad_u32_u24 v2, v14, s38, v2
    v_bfe_u32 v14, v0, 3, 1
    s_mov_b32 s38, 0x80
    v_mad_u32_u24 v2, v14, s38, v2
    v_bfe_u32 v14, v0, 4, 1
    s_mov_b32 s38, 0x100
    v_mad_u32_u24 v2, v14, s38, v2
    v_bfe_u32 v14, v0, 5, 1
    s_mov_b32 s38, 0x200
    v_mad_u32_u24 v2, v14, s38, v2
    v_bfe_u32 v14, v0, 6, 1
    s_mov_b32 s38, 0x800
    v_mad_u32_u24 v2, v14, s38, v2
    v_bfe_u32 v14, v0, 7, 1
    s_mov_b32 s38, 0x1000
    v_mad_u32_u24 v2, v14, s38, v2
    v_mov_b32 v4, 0x8000
    v_bfe_u32 v14, v0, 0, 1
    s_mov_b32 s38, 0x10
    v_mad_u32_u24 v4, v14, s38, v4
    v_bfe_u32 v14, v0, 1, 1
    s_mov_b32 s38, 0x20
    v_mad_u32_u24 v4, v14, s38, v4
    v_bfe_u32 v14, v0, 2, 1
    s_mov_b32 s38, 0x40
    v_mad_u32_u24 v4, v14, s38, v4
    v_bfe_u32 v14, v0, 3, 1
    s_mov_b32 s38, 0x80
    v_mad_u32_u24 v4, v14, s38, v4
    v_bfe_u32 v14, v0, 4, 1
    s_mov_b32 s38, 0x100
    v_mad_u32_u24 v4, v14, s38, v4
    v_bfe_u32 v14, v0, 5, 1
    s_mov_b32 s38, 0x200
    v_mad_u32_u24 v4, v14, s38, v4
    v_bfe_u32 v14, v0, 6, 1
    s_mov_b32 s38, 0x8000
    v_mad_u32_u24 v4, v14, s38, v4
    v_bfe_u32 v14, v0, 7, 1
    s_mov_b32 s38, 0x10000
    v_mad_u32_u24 v4, v14, s38, v4
    v_mov_b32 v5, 0x4000
    v_bfe_u32 v14, v0, 0, 1
    s_mov_b32 s38, 0x4
    v_mad_u32_u24 v5, v14, s38, v5
    v_bfe_u32 v14, v0, 1, 1
    s_mov_b32 s38, 0x8
    v_mad_u32_u24 v5, v14, s38, v5
    v_bfe_u32 v14, v0, 2, 1
    s_mov_b32 s38, 0x10
    v_mad_u32_u24 v5, v14, s38, v5
    v_bfe_u32 v14, v0, 3, 1
    s_mov_b32 s38, 0x20
    v_mad_u32_u24 v5, v14, s38, v5
    v_bfe_u32 v14, v0, 4, 1
    s_mov_b32 s38, 0x240
    v_mad_u32_u24 v5, v14, s38, v5
    v_bfe_u32 v14, v0, 5, 1
    s_mov_b32 s38, 0x480
    v_mad_u32_u24 v5, v14, s38, v5
    v_bfe_u32 v14, v0, 6, 1
    s_mov_b32 s38, 0x40
    v_mad_u32_u24 v5, v14, s38, v5
    v_bfe_u32 v14, v0, 7, 1
    s_mov_b32 s38, 0x80
    v_mad_u32_u24 v5, v14, s38, v5
    v_mov_b32 v6, 0x4000
    v_bfe_u32 v14, v0, 0, 1
    s_mov_b32 s38, 0x120
    v_mad_u32_u24 v6, v14, s38, v6
    v_bfe_u32 v14, v0, 2, 1
    s_mov_b32 s38, 0x240
    v_mad_u32_u24 v6, v14, s38, v6
    v_bfe_u32 v14, v0, 3, 1
    s_mov_b32 s38, 0x480
    v_mad_u32_u24 v6, v14, s38, v6
    v_bfe_u32 v14, v0, 4, 1
    s_mov_b32 s38, 0x10
    v_mad_u32_u24 v6, v14, s38, v6
    v_bfe_u32 v14, v0, 5, 1
    s_mov_b32 s38, 0x20
    v_mad_u32_u24 v6, v14, s38, v6
    v_add_u32 v7, 2304, v5
    v_xor_b32 v8, 0x1000, v2
    v_mov_b32 v104, 0x0
    v_bfe_u32 v14, v0, 3, 1
    s_mov_b32 s38, 0x1
    v_mad_u32_u24 v104, v14, s38, v104
    v_bfe_u32 v14, v0, 4, 1
    s_mov_b32 s38, 0x2
    v_mad_u32_u24 v104, v14, s38, v104
    v_bfe_u32 v14, v0, 5, 1
    s_mov_b32 s38, 0x4
    v_mad_u32_u24 v104, v14, s38, v104
    v_bfe_u32 v14, v0, 6, 1
    s_mov_b32 s38, 0x8
    v_mad_u32_u24 v104, v14, s38, v104
    v_bfe_u32 v14, v0, 7, 1
    s_mov_b32 s38, 0x10
    v_mad_u32_u24 v104, v14, s38, v104
    v_add_u32 v104, s20, v104
    v_and_b32 v104, 31, v104
    v_lshlrev_b32 v104, 6, v104
    v_mov_b32 v9, 0x0
    v_bfe_u32 v14, v0, 0, 1
    s_mov_b32 s38, 0x8
    v_mad_u32_u24 v9, v14, s38, v9
    v_bfe_u32 v14, v0, 1, 1
    s_mov_b32 s38, 0x10
    v_mad_u32_u24 v9, v14, s38, v9
    v_bfe_u32 v14, v0, 2, 1
    s_mov_b32 s38, 0x20
    v_mad_u32_u24 v9, v14, s38, v9
    v_bfe_u32 v14, v0, 3, 1
    s_mov_b32 s38, 0x2000
    v_mad_u32_u24 v9, v14, s38, v9
    v_bfe_u32 v14, v0, 4, 1
    s_mov_b32 s38, 0x4000
    v_mad_u32_u24 v9, v14, s38, v9
    v_bfe_u32 v14, v0, 5, 1
    s_mov_b32 s38, 0x8000
    v_mad_u32_u24 v9, v14, s38, v9
    v_bfe_u32 v14, v0, 6, 1
    s_mov_b32 s38, 0x10000
    v_mad_u32_u24 v9, v14, s38, v9
    v_bfe_u32 v14, v0, 7, 1
    s_mov_b32 s38, 0x20000
    v_mad_u32_u24 v9, v14, s38, v9
    v_add_u32 v9, v9, v104
    v_mov_b32 v10, 0x80000
    v_bfe_u32 v14, v0, 0, 1
    s_mov_b32 s38, 0x8
    v_mad_u32_u24 v10, v14, s38, v10
    v_bfe_u32 v14, v0, 1, 1
    s_mov_b32 s38, 0x20
    v_mad_u32_u24 v10, v14, s38, v10
    v_bfe_u32 v14, v0, 4, 1
    s_mov_b32 s38, 0x10
    v_mad_u32_u24 v10, v14, s38, v10
    v_bfe_u32 v14, v0, 5, 1
    s_mov_b32 s38, 0x4
    v_mad_u32_u24 v10, v14, s38, v10
    v_bfe_u32 v14, v0, 6, 1
    s_mov_b32 s38, 0x800
    v_mad_u32_u24 v10, v14, s38, v10
    v_bfe_u32 v14, v0, 7, 1
    s_mov_b32 s38, 0x1000
    v_mad_u32_u24 v10, v14, s38, v10
    v_mov_b32 v105, s20
    v_mov_b32 v104, 0x0
    v_bfe_u32 v14, v105, 0, 1
    s_mov_b32 s38, 0x100
    v_mad_u32_u24 v104, v14, s38, v104
    v_bfe_u32 v14, v105, 1, 1
    s_mov_b32 s38, 0x40
    v_mad_u32_u24 v104, v14, s38, v104
    v_bfe_u32 v14, v105, 2, 1
    s_mov_b32 s38, 0x80
    v_mad_u32_u24 v104, v14, s38, v104
    v_bfe_u32 v14, v105, 3, 1
    s_mov_b32 s38, 0x200
    v_mad_u32_u24 v104, v14, s38, v104
    v_bfe_u32 v14, v105, 4, 1
    s_mov_b32 s38, 0x400
    v_mad_u32_u24 v104, v14, s38, v104
    v_add_u32 v10, v104, v10
    v_and_b32 v104, 12, v0
    v_cmp_ne_u32 vcc, 0, v104
    v_mov_b32 v104, 0x40000000
    s_nop 0
    v_cndmask_b32 v10, v10, v104, vcc
    v_mov_b32 v13, 0x0
    v_bfe_u32 v14, v0, 0, 1
    s_mov_b32 s38, 0x10
    v_mad_u32_u24 v13, v14, s38, v13
    v_bfe_u32 v14, v0, 1, 1
    s_mov_b32 s38, 0x8
    v_mad_u32_u24 v13, v14, s38, v13
    v_bfe_u32 v14, v0, 2, 1
    s_mov_b32 s38, 0x20
    v_mad_u32_u24 v13, v14, s38, v13
    v_bfe_u32 v14, v0, 3, 1
    s_mov_b32 s38, 0x40
    v_mad_u32_u24 v13, v14, s38, v13
    v_bfe_u32 v14, v0, 4, 1
    s_mov_b32 s38, 0x80
    v_mad_u32_u24 v13, v14, s38, v13
    v_bfe_u32 v14, v0, 5, 1
    s_mov_b32 s38, 0x100
    v_mad_u32_u24 v13, v14, s38, v13
    v_bfe_u32 v14, v0, 6, 1
    s_mov_b32 s38, 0x800
    v_mad_u32_u24 v13, v14, s38, v13
    v_bfe_u32 v14, v0, 7, 1
    s_mov_b32 s38, 0x1000
    v_mad_u32_u24 v13, v14, s38, v13
    s_lshl_b32 s6, s20, 13
    s_add_u32 s6, s6, 0x0
    s_mov_b32 s26, 4096
    v_and_b32 v104, 15, v0
    v_mov_b32 v100, 0
    v_mov_b32 v105, 0x3f80
    v_cmp_eq_u32 vcc, 0, v104
    s_nop 1
    v_cndmask_b32 v100, v100, v105, vcc
    v_mov_b32 v105, 0x3f800000
    v_cmp_eq_u32 vcc, 1, v104
    s_nop 1
    v_cndmask_b32 v100, v100, v105, vcc
    v_mov_b32 v101, 0
    v_mov_b32 v105, 0x3f80
    v_cmp_eq_u32 vcc, 4, v104
    s_nop 1
    v_cndmask_b32 v101, v101, v105, vcc
    v_mov_b32 v105, 0x3f800000
    v_cmp_eq_u32 vcc, 5, v104
    s_nop 1
    v_cndmask_b32 v101, v101, v105, vcc
    v_mov_b32 v102, 0
    v_mov_b32 v105, 0x3f80
    v_cmp_eq_u32 vcc, 8, v104
    s_nop 1
    v_cndmask_b32 v102, v102, v105, vcc
    v_mov_b32 v105, 0x3f800000
    v_cmp_eq_u32 vcc, 9, v104
    s_nop 1
    v_cndmask_b32 v102, v102, v105, vcc
    v_mov_b32 v103, 0
    v_mov_b32 v105, 0x3f80
    v_cmp_eq_u32 vcc, 12, v104
    s_nop 1
    v_cndmask_b32 v103, v103, v105, vcc
    v_mov_b32 v105, 0x3f800000
    v_cmp_eq_u32 vcc, 13, v104
    s_nop 1
    v_cndmask_b32 v103, v103, v105, vcc
    ds_write_b128 v3, v[100:103] offset:23040
    s_mov_b32 s34, 0x05040100
    s_mov_b32 s35, 0x07060302
    s_mov_b32 s33, 0x3e0293ee
    s_mov_b32 s40, 0x4e800000
    s_mov_b32 s32, 0
    s_mov_b32 s4, 0x3f803f80
    s_mov_b32 s5, 0x3f803f80
    s_lshl_b32 s36, s20, 14
    s_lshr_b32 s37, s21, 1
    s_lshl_b32 s37, s37, 12
    s_add_u32 s25, s36, s37
    s_lshl_b32 s37, s21, 11
    s_add_u32 s39, s36, s37
    s_add_u32 s39, s39, 8192
    v_mov_b32 v104, 0x0
    v_bfe_u32 v14, v0, 0, 1
    s_mov_b32 s38, 0x80
    v_mad_u32_u24 v104, v14, s38, v104
    v_bfe_u32 v14, v0, 1, 1
    s_mov_b32 s38, 0x100
    v_mad_u32_u24 v104, v14, s38, v104
    v_bfe_u32 v14, v0, 2, 1
    s_mov_b32 s38, 0x200
    v_mad_u32_u24 v104, v14, s38, v104
    v_bfe_u32 v14, v0, 3, 1
    s_mov_b32 s38, 0x400
    v_mad_u32_u24 v104, v14, s38, v104
    v_bfe_u32 v14, v0, 4, 1
    s_mov_b32 s38, 0x800
    v_mad_u32_u24 v104, v14, s38, v104
    v_bfe_u32 v14, v0, 6, 1
    s_mov_b32 s38, 0x1000
    v_mad_u32_u24 v104, v14, s38, v104
    v_bfe_u32 v14, v0, 7, 1
    s_mov_b32 s38, 0x2000
    v_mad_u32_u24 v104, v14, s38, v104
    s_lshl_b32 s36, s20, 14
    v_add_u32 v104, s36, v104
    s_lshl_b32 s36, s20, 8
    s_lshr_b32 s37, s21, 1
    s_lshl_b32 s37, s37, 7
    s_add_u32 s36, s36, s37
    s_add_u32 s36, s36, 0x102100
    v_and_b32 v14, 63, v0
    v_mov_b32 v105, 0x40000000
    v_cmp_lt_u32 vcc, 32, v14
    s_nop 1
    v_cndmask_b32 v104, v104, v105, vcc
    v_mov_b32 v105, s36
    v_cmp_eq_u32 vcc, 32, v14
    s_nop 1
    v_cndmask_b32 v104, v104, v105, vcc
    s_lshl_b32 s36, s20, 2
    s_add_u32 s36, s36, 0x104100
    v_mov_b32 v105, s36
    v_cmp_eq_u32 vcc, 33, v14
    s_nop 1
    v_cndmask_b32 v0, v104, v105, vcc
    s_waitcnt vmcnt(34)
    s_barrier
    ds_read_b64_tr_b16 a[160:161], v20 offset:0
    ds_read_b64_tr_b16 a[162:163], v20 offset:512
    ds_read_b64_tr_b16 a[168:169], v21 offset:0
    ds_read_b64_tr_b16 a[170:171], v21 offset:512
    ds_read_b64_tr_b16 a[192:193], v22 offset:0
    ds_read_b64_tr_b16 a[194:195], v22 offset:512
    ds_read_b64_tr_b16 a[200:201], v23 offset:0
    ds_read_b64_tr_b16 a[202:203], v23 offset:512
    ds_read_b64_tr_b16 a[224:225], v24 offset:0
    ds_read_b64_tr_b16 a[226:227], v24 offset:512
    ds_read_b64_tr_b16 a[232:233], v25 offset:0
    ds_read_b64_tr_b16 a[234:235], v25 offset:512
    s_waitcnt lgkmcnt(4)
    ds_read_b64_tr_b16 v[128:129], v26 offset:0
    ds_read_b64_tr_b16 v[130:131], v26 offset:512
    ds_read_b64_tr_b16 v[136:137], v27 offset:0
    ds_read_b64_tr_b16 v[138:139], v27 offset:512
    s_waitcnt lgkmcnt(0)
    s_barrier
    s_add_u32 m0, s28, 32768
    s_add_u32 s37, s3, 0x300000
    buffer_load_dwordx4 v16, s[60:63], s37 offen lds
    s_add_u32 m0, s28, 36864
    s_add_u32 s37, s3, 0x320000
    buffer_load_dwordx4 v16, s[60:63], s37 offen lds
    s_add_u32 m0, s28, 65536
    s_add_u32 s37, s3, 0x340000
    buffer_load_dwordx4 v16, s[60:63], s37 offen lds
    s_add_u32 m0, s28, 69632
    s_add_u32 s37, s3, 0x360000
    buffer_load_dwordx4 v16, s[60:63], s37 offen lds
    s_add_u32 m0, s28, 98304
    s_add_u32 s37, s3, 0x380000
    buffer_load_dwordx4 v16, s[60:63], s37 offen lds
    s_add_u32 m0, s28, 102400
    s_add_u32 s37, s3, 0x3a0000
    buffer_load_dwordx4 v16, s[60:63], s37 offen lds
    s_add_u32 m0, s28, 131072
    s_add_u32 s37, s3, 0x3c0000
    buffer_load_dwordx4 v16, s[60:63], s37 offen lds
    s_add_u32 m0, s28, 135168
    s_add_u32 s37, s3, 0x3e0000
    buffer_load_dwordx4 v16, s[60:63], s37 offen lds
    s_xor_b32 s36, s21, 2
    s_lshl_b32 s36, s36, 15
    s_add_u32 s36, s36, s29
    s_add_u32 s37, s36, 0x80
    buffer_load_dword v48, v11, s[92:95], s37 offen
    s_add_u32 s37, s36, 0x4080
    buffer_load_dword v49, v11, s[92:95], s37 offen
    s_add_u32 s37, s36, 0x480
    buffer_load_dword v50, v11, s[92:95], s37 offen
    s_add_u32 s37, s36, 0x4480
    buffer_load_dword v51, v11, s[92:95], s37 offen
    s_add_u32 s37, s36, 0x2080
    buffer_load_dword v52, v11, s[92:95], s37 offen
    s_add_u32 s37, s36, 0x6080
    buffer_load_dword v53, v11, s[92:95], s37 offen
    s_add_u32 s37, s36, 0x2480
    buffer_load_dword v54, v11, s[92:95], s37 offen
    s_add_u32 s37, s36, 0x6480
    buffer_load_dword v55, v11, s[92:95], s37 offen
    s_add_u32 s37, s36, 0xc0
    buffer_load_dword v56, v11, s[92:95], s37 offen
    s_add_u32 s37, s36, 0x40c0
    buffer_load_dword v57, v11, s[92:95], s37 offen
    s_add_u32 s37, s36, 0x4c0
    buffer_load_dword v58, v11, s[92:95], s37 offen
    s_add_u32 s37, s36, 0x44c0
    buffer_load_dword v59, v11, s[92:95], s37 offen
    s_add_u32 s37, s36, 0x20c0
    buffer_load_dword v60, v11, s[92:95], s37 offen
    s_add_u32 s37, s36, 0x60c0
    buffer_load_dword v61, v11, s[92:95], s37 offen
    s_add_u32 s37, s36, 0x24c0
    buffer_load_dword v62, v11, s[92:95], s37 offen
    s_add_u32 s37, s36, 0x64c0
    buffer_load_dword v63, v11, s[92:95], s37 offen
    s_waitcnt vmcnt(50)
    s_barrier
    ds_read_b64_tr_b16 a[164:165], v20 offset:8192
    ds_read_b64_tr_b16 a[166:167], v20 offset:8704
    ds_read_b64_tr_b16 a[172:173], v21 offset:8192
    ds_read_b64_tr_b16 a[174:175], v21 offset:8704
    ds_read_b64_tr_b16 a[196:197], v22 offset:8192
    ds_read_b64_tr_b16 a[198:199], v22 offset:8704
    ds_read_b64_tr_b16 a[204:205], v23 offset:8192
    ds_read_b64_tr_b16 a[206:207], v23 offset:8704
    ds_read_b64_tr_b16 a[228:229], v24 offset:8192
    ds_read_b64_tr_b16 a[230:231], v24 offset:8704
    ds_read_b64_tr_b16 a[236:237], v25 offset:8192
    ds_read_b64_tr_b16 a[238:239], v25 offset:8704
    s_waitcnt lgkmcnt(4)
    ds_read_b64_tr_b16 v[132:133], v26 offset:8192
    ds_read_b64_tr_b16 v[134:135], v26 offset:8704
    ds_read_b64_tr_b16 v[140:141], v27 offset:8192
    ds_read_b64_tr_b16 v[142:143], v27 offset:8704
    s_waitcnt lgkmcnt(0)
    s_barrier
    s_mov_b32 s88, s50
    s_and_b32 s89, s51, 0xffff
    s_mov_b32 s90, 0x400000
    s_mov_b32 s91, 0x20000
    s_add_u32 m0, s28, 40960
    s_add_u32 s37, s3, 0x0
    buffer_load_dwordx4 v16, s[88:91], s37 offen lds
    s_add_u32 m0, s28, 45056
    s_add_u32 s37, s3, 0x20000
    buffer_load_dwordx4 v16, s[88:91], s37 offen lds
    s_add_u32 m0, s28, 73728
    s_add_u32 s37, s3, 0x40000
    buffer_load_dwordx4 v16, s[88:91], s37 offen lds
    s_add_u32 m0, s28, 77824
    s_add_u32 s37, s3, 0x60000
    buffer_load_dwordx4 v16, s[88:91], s37 offen lds
    s_add_u32 m0, s28, 106496
    s_add_u32 s37, s3, 0x80000
    buffer_load_dwordx4 v16, s[88:91], s37 offen lds
    s_add_u32 m0, s28, 110592
    s_add_u32 s37, s3, 0xa0000
    buffer_load_dwordx4 v16, s[88:91], s37 offen lds
    s_add_u32 m0, s28, 139264
    s_add_u32 s37, s3, 0xc0000
    buffer_load_dwordx4 v16, s[88:91], s37 offen lds
    s_add_u32 m0, s28, 143360
    s_add_u32 s37, s3, 0xe0000
    buffer_load_dwordx4 v16, s[88:91], s37 offen lds
    s_waitcnt vmcnt(34)
    v_perm_b32 v120, v33, v32, s34
    v_perm_b32 v121, v33, v32, s35
    v_perm_b32 v122, v35, v34, s34
    v_perm_b32 v123, v35, v34, s35
    v_perm_b32 v124, v37, v36, s34
    v_perm_b32 v125, v37, v36, s35
    v_perm_b32 v126, v39, v38, s34
    v_perm_b32 v127, v39, v38, s35
    ds_write_b128 v4, v[120:123] offset:24576
    ds_write_b128 v4, v[124:127] offset:25600
    s_waitcnt lgkmcnt(0)
    v_perm_b32 v120, v41, v40, s34
    v_perm_b32 v121, v41, v40, s35
    v_perm_b32 v122, v43, v42, s34
    v_perm_b32 v123, v43, v42, s35
    v_perm_b32 v124, v45, v44, s34
    v_perm_b32 v125, v45, v44, s35
    v_perm_b32 v126, v47, v46, s34
    v_perm_b32 v127, v47, v46, s35
    ds_write_b128 v4, v[120:123] offset:30720
    ds_write_b128 v4, v[124:127] offset:31744
    s_waitcnt lgkmcnt(0)
    s_xor_b32 s36, s21, 1
    s_lshl_b32 s36, s36, 15
    s_add_u32 s36, s36, s29
    s_add_u32 s37, s36, 0x80
    buffer_load_dword v80, v11, s[92:95], s37 offen
    s_add_u32 s37, s36, 0x4080
    buffer_load_dword v81, v11, s[92:95], s37 offen
    s_add_u32 s37, s36, 0x480
    buffer_load_dword v82, v11, s[92:95], s37 offen
    s_add_u32 s37, s36, 0x4480
    buffer_load_dword v83, v11, s[92:95], s37 offen
    s_add_u32 s37, s36, 0x2080
    buffer_load_dword v84, v11, s[92:95], s37 offen
    s_add_u32 s37, s36, 0x6080
    buffer_load_dword v85, v11, s[92:95], s37 offen
    s_add_u32 s37, s36, 0x2480
    buffer_load_dword v86, v11, s[92:95], s37 offen
    s_add_u32 s37, s36, 0x6480
    buffer_load_dword v87, v11, s[92:95], s37 offen
    s_add_u32 s37, s36, 0xc0
    buffer_load_dword v88, v11, s[92:95], s37 offen
    s_add_u32 s37, s36, 0x40c0
    buffer_load_dword v89, v11, s[92:95], s37 offen
    s_add_u32 s37, s36, 0x4c0
    buffer_load_dword v90, v11, s[92:95], s37 offen
    s_add_u32 s37, s36, 0x44c0
    buffer_load_dword v91, v11, s[92:95], s37 offen
    s_add_u32 s37, s36, 0x20c0
    buffer_load_dword v92, v11, s[92:95], s37 offen
    s_add_u32 s37, s36, 0x60c0
    buffer_load_dword v93, v11, s[92:95], s37 offen
    s_add_u32 s37, s36, 0x24c0
    buffer_load_dword v94, v11, s[92:95], s37 offen
    s_add_u32 s37, s36, 0x64c0
    buffer_load_dword v95, v11, s[92:95], s37 offen
    s_barrier
    ds_read_b64_tr_b16 a[176:177], v20 offset:16384
    ds_read_b64_tr_b16 a[178:179], v20 offset:16896
    ds_read_b64_tr_b16 a[184:185], v21 offset:16384
    ds_read_b64_tr_b16 a[186:187], v21 offset:16896
    ds_read_b64_tr_b16 a[208:209], v22 offset:16384
    ds_read_b64_tr_b16 a[210:211], v22 offset:16896
    ds_read_b64_tr_b16 a[216:217], v23 offset:16384
    ds_read_b64_tr_b16 a[218:219], v23 offset:16896
    ds_read_b64_tr_b16 a[240:241], v24 offset:16384
    ds_read_b64_tr_b16 a[242:243], v24 offset:16896
    ds_read_b64_tr_b16 a[248:249], v25 offset:16384
    ds_read_b64_tr_b16 a[250:251], v25 offset:16896
    s_waitcnt lgkmcnt(4)
    ds_read_b64_tr_b16 v[144:145], v26 offset:16384
    ds_read_b64_tr_b16 v[146:147], v26 offset:16896
    ds_read_b64_tr_b16 v[152:153], v27 offset:16384
    ds_read_b64_tr_b16 v[154:155], v27 offset:16896
    s_waitcnt lgkmcnt(0)
    s_barrier
    s_add_u32 m0, s28, 49152
    s_add_u32 s37, s3, 0x100000
    buffer_load_dwordx4 v16, s[88:91], s37 offen lds
    s_add_u32 m0, s28, 53248
    s_add_u32 s37, s3, 0x120000
    buffer_load_dwordx4 v16, s[88:91], s37 offen lds
    s_add_u32 m0, s28, 81920
    s_add_u32 s37, s3, 0x140000
    buffer_load_dwordx4 v16, s[88:91], s37 offen lds
    s_add_u32 m0, s28, 86016
    s_add_u32 s37, s3, 0x160000
    buffer_load_dwordx4 v16, s[88:91], s37 offen lds
    s_add_u32 m0, s28, 114688
    s_add_u32 s37, s3, 0x180000
    buffer_load_dwordx4 v16, s[88:91], s37 offen lds
    s_add_u32 m0, s28, 118784
    s_add_u32 s37, s3, 0x1a0000
    buffer_load_dwordx4 v16, s[88:91], s37 offen lds
    s_add_u32 m0, s28, 147456
    s_add_u32 s37, s3, 0x1c0000
    buffer_load_dwordx4 v16, s[88:91], s37 offen lds
    s_add_u32 m0, s28, 151552
    s_add_u32 s37, s3, 0x1e0000
    buffer_load_dwordx4 v16, s[88:91], s37 offen lds
    s_waitcnt vmcnt(32)
    v_perm_b32 v232, v49, v48, s34
    v_perm_b32 v233, v49, v48, s35
    v_perm_b32 v234, v51, v50, s34
    v_perm_b32 v235, v51, v50, s35
    v_perm_b32 v236, v53, v52, s34
    v_perm_b32 v237, v53, v52, s35
    v_perm_b32 v238, v55, v54, s34
    v_perm_b32 v239, v55, v54, s35
    v_perm_b32 v120, v57, v56, s34
    v_perm_b32 v121, v57, v56, s35
    v_perm_b32 v122, v59, v58, s34
    v_perm_b32 v123, v59, v58, s35
    v_perm_b32 v124, v61, v60, s34
    v_perm_b32 v125, v61, v60, s35
    v_perm_b32 v126, v63, v62, s34
    v_perm_b32 v127, v63, v62, s35
    ds_write_b128 v4, v[120:123] offset:28672
    ds_write_b128 v4, v[124:127] offset:29696
    s_waitcnt lgkmcnt(0)
    s_xor_b32 s36, s21, 3
    s_lshl_b32 s36, s36, 15
    s_add_u32 s36, s36, s29
    s_add_u32 s37, s36, 0x0
    buffer_load_dword v32, v11, s[92:95], s37 offen
    s_add_u32 s37, s36, 0x4000
    buffer_load_dword v33, v11, s[92:95], s37 offen
    s_add_u32 s37, s36, 0x400
    buffer_load_dword v34, v11, s[92:95], s37 offen
    s_add_u32 s37, s36, 0x4400
    buffer_load_dword v35, v11, s[92:95], s37 offen
    s_add_u32 s37, s36, 0x2000
    buffer_load_dword v36, v11, s[92:95], s37 offen
    s_add_u32 s37, s36, 0x6000
    buffer_load_dword v37, v11, s[92:95], s37 offen
    s_add_u32 s37, s36, 0x2400
    buffer_load_dword v38, v11, s[92:95], s37 offen
    s_add_u32 s37, s36, 0x6400
    buffer_load_dword v39, v11, s[92:95], s37 offen
    s_add_u32 s37, s36, 0x40
    buffer_load_dword v40, v11, s[92:95], s37 offen
    s_add_u32 s37, s36, 0x4040
    buffer_load_dword v41, v11, s[92:95], s37 offen
    s_add_u32 s37, s36, 0x440
    buffer_load_dword v42, v11, s[92:95], s37 offen
    s_add_u32 s37, s36, 0x4440
    buffer_load_dword v43, v11, s[92:95], s37 offen
    s_add_u32 s37, s36, 0x2040
    buffer_load_dword v44, v11, s[92:95], s37 offen
    s_add_u32 s37, s36, 0x6040
    buffer_load_dword v45, v11, s[92:95], s37 offen
    s_add_u32 s37, s36, 0x2440
    buffer_load_dword v46, v11, s[92:95], s37 offen
    s_add_u32 s37, s36, 0x6440
    buffer_load_dword v47, v11, s[92:95], s37 offen
    s_barrier
    ds_read_b64_tr_b16 a[180:181], v20 offset:0
    ds_read_b64_tr_b16 a[182:183], v20 offset:512
    ds_read_b64_tr_b16 a[188:189], v21 offset:0
    ds_read_b64_tr_b16 a[190:191], v21 offset:512
    ds_read_b64_tr_b16 a[212:213], v22 offset:0
    ds_read_b64_tr_b16 a[214:215], v22 offset:512
    ds_read_b64_tr_b16 a[220:221], v23 offset:0
    ds_read_b64_tr_b16 a[222:223], v23 offset:512
    ds_read_b64_tr_b16 a[244:245], v24 offset:0
    ds_read_b64_tr_b16 a[246:247], v24 offset:512
    ds_read_b64_tr_b16 a[252:253], v25 offset:0
    ds_read_b64_tr_b16 a[254:255], v25 offset:512
    s_waitcnt lgkmcnt(4)
    ds_read_b64_tr_b16 v[148:149], v26 offset:0
    ds_read_b64_tr_b16 v[150:151], v26 offset:512
    ds_read_b64_tr_b16 v[156:157], v27 offset:0
    ds_read_b64_tr_b16 v[158:159], v27 offset:512
    s_waitcnt lgkmcnt(0)
    s_barrier
    s_add_u32 m0, s28, 32768
    s_add_u32 s37, s3, 0x200000
    buffer_load_dwordx4 v16, s[88:91], s37 offen lds
    s_add_u32 m0, s28, 36864
    s_add_u32 s37, s3, 0x220000
    buffer_load_dwordx4 v16, s[88:91], s37 offen lds
    s_add_u32 m0, s28, 65536
    s_add_u32 s37, s3, 0x240000
    buffer_load_dwordx4 v16, s[88:91], s37 offen lds
    s_add_u32 m0, s28, 69632
    s_add_u32 s37, s3, 0x260000
    buffer_load_dwordx4 v16, s[88:91], s37 offen lds
    s_add_u32 m0, s28, 98304
    s_add_u32 s37, s3, 0x280000
    buffer_load_dwordx4 v16, s[88:91], s37 offen lds
    s_add_u32 m0, s28, 102400
    s_add_u32 s37, s3, 0x2a0000
    buffer_load_dwordx4 v16, s[88:91], s37 offen lds
    s_add_u32 m0, s28, 131072
    s_add_u32 s37, s3, 0x2c0000
    buffer_load_dwordx4 v16, s[88:91], s37 offen lds
    s_add_u32 m0, s28, 135168
    s_add_u32 s37, s3, 0x2e0000
    buffer_load_dwordx4 v16, s[88:91], s37 offen lds
    s_waitcnt vmcnt(32)
    v_perm_b32 v208, v81, v80, s34
    v_perm_b32 v209, v81, v80, s35
    v_perm_b32 v210, v83, v82, s34
    v_perm_b32 v211, v83, v82, s35
    v_perm_b32 v212, v85, v84, s34
    v_perm_b32 v213, v85, v84, s35
    v_perm_b32 v214, v87, v86, s34
    v_perm_b32 v215, v87, v86, s35
    v_perm_b32 v120, v89, v88, s34
    v_perm_b32 v121, v89, v88, s35
    v_perm_b32 v122, v91, v90, s34
    v_perm_b32 v123, v91, v90, s35
    v_perm_b32 v124, v93, v92, s34
    v_perm_b32 v125, v93, v92, s35
    v_perm_b32 v126, v95, v94, s34
    v_perm_b32 v127, v95, v94, s35
    ds_write_b128 v4, v[120:123] offset:26624
    ds_write_b128 v4, v[124:127] offset:27648
    s_waitcnt lgkmcnt(0)
    s_xor_b32 s36, s21, 2
    s_lshl_b32 s36, s36, 15
    s_add_u32 s36, s36, s29
    s_add_u32 s37, s36, 0x0
    buffer_load_dword v48, v11, s[92:95], s37 offen
    s_add_u32 s37, s36, 0x4000
    buffer_load_dword v49, v11, s[92:95], s37 offen
    s_add_u32 s37, s36, 0x400
    buffer_load_dword v50, v11, s[92:95], s37 offen
    s_add_u32 s37, s36, 0x4400
    buffer_load_dword v51, v11, s[92:95], s37 offen
    s_add_u32 s37, s36, 0x2000
    buffer_load_dword v52, v11, s[92:95], s37 offen
    s_add_u32 s37, s36, 0x6000
    buffer_load_dword v53, v11, s[92:95], s37 offen
    s_add_u32 s37, s36, 0x2400
    buffer_load_dword v54, v11, s[92:95], s37 offen
    s_add_u32 s37, s36, 0x6400
    buffer_load_dword v55, v11, s[92:95], s37 offen
    s_add_u32 s37, s36, 0x40
    buffer_load_dword v56, v11, s[92:95], s37 offen
    s_add_u32 s37, s36, 0x4040
    buffer_load_dword v57, v11, s[92:95], s37 offen
    s_add_u32 s37, s36, 0x440
    buffer_load_dword v58, v11, s[92:95], s37 offen
    s_add_u32 s37, s36, 0x4440
    buffer_load_dword v59, v11, s[92:95], s37 offen
    s_add_u32 s37, s36, 0x2040
    buffer_load_dword v60, v11, s[92:95], s37 offen
    s_add_u32 s37, s36, 0x6040
    buffer_load_dword v61, v11, s[92:95], s37 offen
    s_add_u32 s37, s36, 0x2440
    buffer_load_dword v62, v11, s[92:95], s37 offen
    s_add_u32 s37, s36, 0x6440
    buffer_load_dword v63, v11, s[92:95], s37 offen
    s_barrier
    ds_read_b64_tr_b16 v[64:65], v20 offset:8192
    ds_read_b64_tr_b16 v[66:67], v20 offset:8704
    ds_read_b64_tr_b16 v[72:73], v21 offset:8192
    ds_read_b64_tr_b16 v[74:75], v21 offset:8704
    ds_read_b64_tr_b16 v[96:97], v22 offset:8192
    ds_read_b64_tr_b16 v[98:99], v22 offset:8704
    ds_read_b64_tr_b16 v[104:105], v23 offset:8192
    ds_read_b64_tr_b16 v[106:107], v23 offset:8704
    ds_read_b64_tr_b16 a[112:113], v24 offset:8192
    ds_read_b64_tr_b16 a[114:115], v24 offset:8704
    ds_read_b64_tr_b16 a[120:121], v25 offset:8192
    ds_read_b64_tr_b16 a[122:123], v25 offset:8704
    s_waitcnt lgkmcnt(4)
    ds_read_b64_tr_b16 a[144:145], v26 offset:8192
    ds_read_b64_tr_b16 a[146:147], v26 offset:8704
    ds_read_b64_tr_b16 a[152:153], v27 offset:8192
    ds_read_b64_tr_b16 a[154:155], v27 offset:8704
    s_waitcnt lgkmcnt(0)
    s_barrier
    s_add_u32 m0, s28, 40960
    s_add_u32 s37, s3, 0x300000
    buffer_load_dwordx4 v16, s[88:91], s37 offen lds
    s_add_u32 m0, s28, 45056
    s_add_u32 s37, s3, 0x320000
    buffer_load_dwordx4 v16, s[88:91], s37 offen lds
    s_add_u32 m0, s28, 73728
    s_add_u32 s37, s3, 0x340000
    buffer_load_dwordx4 v16, s[88:91], s37 offen lds
    s_add_u32 m0, s28, 77824
    s_add_u32 s37, s3, 0x360000
    buffer_load_dwordx4 v16, s[88:91], s37 offen lds
    s_add_u32 m0, s28, 106496
    s_add_u32 s37, s3, 0x380000
    buffer_load_dwordx4 v16, s[88:91], s37 offen lds
    s_add_u32 m0, s28, 110592
    s_add_u32 s37, s3, 0x3a0000
    buffer_load_dwordx4 v16, s[88:91], s37 offen lds
    s_add_u32 m0, s28, 139264
    s_add_u32 s37, s3, 0x3c0000
    buffer_load_dwordx4 v16, s[88:91], s37 offen lds
    s_add_u32 m0, s28, 143360
    s_add_u32 s37, s3, 0x3e0000
    buffer_load_dwordx4 v16, s[88:91], s37 offen lds
    s_waitcnt vmcnt(32)
    v_perm_b32 v240, v33, v32, s34
    v_perm_b32 v241, v33, v32, s35
    v_perm_b32 v242, v35, v34, s34
    v_perm_b32 v243, v35, v34, s35
    v_perm_b32 v244, v37, v36, s34
    v_perm_b32 v245, v37, v36, s35
    v_perm_b32 v246, v39, v38, s34
    v_perm_b32 v247, v39, v38, s35
    v_perm_b32 v248, v41, v40, s34
    v_perm_b32 v249, v41, v40, s35
    v_perm_b32 v250, v43, v42, s34
    v_perm_b32 v251, v43, v42, s35
    v_perm_b32 v252, v45, v44, s34
    v_perm_b32 v253, v45, v44, s35
    v_perm_b32 v254, v47, v46, s34
    v_perm_b32 v255, v47, v46, s35
    s_xor_b32 s36, s21, 1
    s_lshl_b32 s36, s36, 15
    s_add_u32 s36, s36, s29
    s_add_u32 s37, s36, 0x0
    buffer_load_dword v80, v11, s[92:95], s37 offen
    s_add_u32 s37, s36, 0x4000
    buffer_load_dword v81, v11, s[92:95], s37 offen
    s_add_u32 s37, s36, 0x400
    buffer_load_dword v82, v11, s[92:95], s37 offen
    s_add_u32 s37, s36, 0x4400
    buffer_load_dword v83, v11, s[92:95], s37 offen
    s_add_u32 s37, s36, 0x2000
    buffer_load_dword v84, v11, s[92:95], s37 offen
    s_add_u32 s37, s36, 0x6000
    buffer_load_dword v85, v11, s[92:95], s37 offen
    s_add_u32 s37, s36, 0x2400
    buffer_load_dword v86, v11, s[92:95], s37 offen
    s_add_u32 s37, s36, 0x6400
    buffer_load_dword v87, v11, s[92:95], s37 offen
    s_add_u32 s37, s36, 0x40
    buffer_load_dword v88, v11, s[92:95], s37 offen
    s_add_u32 s37, s36, 0x4040
    buffer_load_dword v89, v11, s[92:95], s37 offen
    s_add_u32 s37, s36, 0x440
    buffer_load_dword v90, v11, s[92:95], s37 offen
    s_add_u32 s37, s36, 0x4440
    buffer_load_dword v91, v11, s[92:95], s37 offen
    s_add_u32 s37, s36, 0x2040
    buffer_load_dword v92, v11, s[92:95], s37 offen
    s_add_u32 s37, s36, 0x6040
    buffer_load_dword v93, v11, s[92:95], s37 offen
    s_add_u32 s37, s36, 0x2440
    buffer_load_dword v94, v11, s[92:95], s37 offen
    s_add_u32 s37, s36, 0x6440
    buffer_load_dword v95, v11, s[92:95], s37 offen
    s_barrier
    ds_read_b64_tr_b16 v[68:69], v20 offset:16384
    ds_read_b64_tr_b16 v[70:71], v20 offset:16896
    ds_read_b64_tr_b16 v[76:77], v21 offset:16384
    ds_read_b64_tr_b16 v[78:79], v21 offset:16896
    ds_read_b64_tr_b16 v[100:101], v22 offset:16384
    ds_read_b64_tr_b16 v[102:103], v22 offset:16896
    ds_read_b64_tr_b16 v[108:109], v23 offset:16384
    ds_read_b64_tr_b16 v[110:111], v23 offset:16896
    ds_read_b64_tr_b16 a[116:117], v24 offset:16384
    ds_read_b64_tr_b16 a[118:119], v24 offset:16896
    ds_read_b64_tr_b16 a[124:125], v25 offset:16384
    ds_read_b64_tr_b16 a[126:127], v25 offset:16896
    s_waitcnt lgkmcnt(4)
    ds_read_b64_tr_b16 a[148:149], v26 offset:16384
    ds_read_b64_tr_b16 a[150:151], v26 offset:16896
    ds_read_b64_tr_b16 a[156:157], v27 offset:16384
    ds_read_b64_tr_b16 a[158:159], v27 offset:16896
    s_waitcnt lgkmcnt(0)
    s_barrier
    s_mov_b32 s96, s48
    s_and_b32 s97, s49, 0xffff
    s_mov_b32 s98, 0x400000
    s_mov_b32 s99, 0x20000
    s_add_u32 m0, s28, 49152
    s_add_u32 s37, s3, 0x0
    buffer_load_dwordx4 v16, s[96:99], s37 offen lds
    s_add_u32 m0, s28, 53248
    s_add_u32 s37, s3, 0x20000
    buffer_load_dwordx4 v16, s[96:99], s37 offen lds
    s_add_u32 m0, s28, 81920
    s_add_u32 s37, s3, 0x40000
    buffer_load_dwordx4 v16, s[96:99], s37 offen lds
    s_add_u32 m0, s28, 86016
    s_add_u32 s37, s3, 0x60000
    buffer_load_dwordx4 v16, s[96:99], s37 offen lds
    s_add_u32 m0, s28, 114688
    s_add_u32 s37, s3, 0x80000
    buffer_load_dwordx4 v16, s[96:99], s37 offen lds
    s_add_u32 m0, s28, 118784
    s_add_u32 s37, s3, 0xa0000
    buffer_load_dwordx4 v16, s[96:99], s37 offen lds
    s_add_u32 m0, s28, 147456
    s_add_u32 s37, s3, 0xc0000
    buffer_load_dwordx4 v16, s[96:99], s37 offen lds
    s_add_u32 m0, s28, 151552
    s_add_u32 s37, s3, 0xe0000
    buffer_load_dwordx4 v16, s[96:99], s37 offen lds
    s_waitcnt vmcnt(32)
    v_perm_b32 v216, v49, v48, s34
    v_perm_b32 v217, v49, v48, s35
    v_perm_b32 v218, v51, v50, s34
    v_perm_b32 v219, v51, v50, s35
    v_perm_b32 v220, v53, v52, s34
    v_perm_b32 v221, v53, v52, s35
    v_perm_b32 v222, v55, v54, s34
    v_perm_b32 v223, v55, v54, s35
    v_perm_b32 v224, v57, v56, s34
    v_perm_b32 v225, v57, v56, s35
    v_perm_b32 v226, v59, v58, s34
    v_perm_b32 v227, v59, v58, s35
    v_perm_b32 v228, v61, v60, s34
    v_perm_b32 v229, v61, v60, s35
    v_perm_b32 v230, v63, v62, s34
    v_perm_b32 v231, v63, v62, s35
    s_xor_b32 s36, s21, 0
    s_lshl_b32 s36, s36, 15
    s_add_u32 s36, s36, s29
    s_add_u32 s37, s36, 0x80
    buffer_load_dword v32, v11, s[92:95], s37 offen
    s_add_u32 s37, s36, 0x4080
    buffer_load_dword v33, v11, s[92:95], s37 offen
    s_add_u32 s37, s36, 0x480
    buffer_load_dword v34, v11, s[92:95], s37 offen
    s_add_u32 s37, s36, 0x4480
    buffer_load_dword v35, v11, s[92:95], s37 offen
    s_add_u32 s37, s36, 0x2080
    buffer_load_dword v36, v11, s[92:95], s37 offen
    s_add_u32 s37, s36, 0x6080
    buffer_load_dword v37, v11, s[92:95], s37 offen
    s_add_u32 s37, s36, 0x2480
    buffer_load_dword v38, v11, s[92:95], s37 offen
    s_add_u32 s37, s36, 0x6480
    buffer_load_dword v39, v11, s[92:95], s37 offen
    s_add_u32 s37, s36, 0xc0
    buffer_load_dword v40, v11, s[92:95], s37 offen
    s_add_u32 s37, s36, 0x40c0
    buffer_load_dword v41, v11, s[92:95], s37 offen
    s_add_u32 s37, s36, 0x4c0
    buffer_load_dword v42, v11, s[92:95], s37 offen
    s_add_u32 s37, s36, 0x44c0
    buffer_load_dword v43, v11, s[92:95], s37 offen
    s_add_u32 s37, s36, 0x20c0
    buffer_load_dword v44, v11, s[92:95], s37 offen
    s_add_u32 s37, s36, 0x60c0
    buffer_load_dword v45, v11, s[92:95], s37 offen
    s_add_u32 s37, s36, 0x24c0
    buffer_load_dword v46, v11, s[92:95], s37 offen
    s_add_u32 s37, s36, 0x64c0
    buffer_load_dword v47, v11, s[92:95], s37 offen
    s_barrier
    ds_read_b64_tr_b16 a[80:81], v20 offset:0
    ds_read_b64_tr_b16 a[82:83], v20 offset:512
    ds_read_b64_tr_b16 a[88:89], v21 offset:0
    ds_read_b64_tr_b16 a[90:91], v21 offset:512
    ds_read_b64_tr_b16 a[96:97], v22 offset:0
    ds_read_b64_tr_b16 a[98:99], v22 offset:512
    ds_read_b64_tr_b16 a[104:105], v23 offset:0
    ds_read_b64_tr_b16 a[106:107], v23 offset:512
    ds_read_b64_tr_b16 a[128:129], v24 offset:0
    ds_read_b64_tr_b16 a[130:131], v24 offset:512
    ds_read_b64_tr_b16 a[136:137], v25 offset:0
    ds_read_b64_tr_b16 a[138:139], v25 offset:512
    s_waitcnt lgkmcnt(4)
    ds_read_b64_tr_b16 v[112:113], v26 offset:0
    ds_read_b64_tr_b16 v[114:115], v26 offset:512
    ds_read_b64_tr_b16 v[120:121], v27 offset:0
    ds_read_b64_tr_b16 v[122:123], v27 offset:512
    s_waitcnt lgkmcnt(0)
    s_barrier
    s_add_u32 m0, s28, 32768
    s_add_u32 s37, s3, 0x100000
    buffer_load_dwordx4 v16, s[96:99], s37 offen lds
    s_add_u32 m0, s28, 36864
    s_add_u32 s37, s3, 0x120000
    buffer_load_dwordx4 v16, s[96:99], s37 offen lds
    s_add_u32 m0, s28, 65536
    s_add_u32 s37, s3, 0x140000
    buffer_load_dwordx4 v16, s[96:99], s37 offen lds
    s_add_u32 m0, s28, 69632
    s_add_u32 s37, s3, 0x160000
    buffer_load_dwordx4 v16, s[96:99], s37 offen lds
    s_add_u32 m0, s28, 98304
    s_add_u32 s37, s3, 0x180000
    buffer_load_dwordx4 v16, s[96:99], s37 offen lds
    s_add_u32 m0, s28, 102400
    s_add_u32 s37, s3, 0x1a0000
    buffer_load_dwordx4 v16, s[96:99], s37 offen lds
    s_add_u32 m0, s28, 131072
    s_add_u32 s37, s3, 0x1c0000
    buffer_load_dwordx4 v16, s[96:99], s37 offen lds
    s_add_u32 m0, s28, 135168
    s_add_u32 s37, s3, 0x1e0000
    buffer_load_dwordx4 v16, s[96:99], s37 offen lds
    s_waitcnt vmcnt(32)
    v_perm_b32 v192, v81, v80, s34
    v_perm_b32 v193, v81, v80, s35
    v_perm_b32 v194, v83, v82, s34
    v_perm_b32 v195, v83, v82, s35
    v_perm_b32 v196, v85, v84, s34
    v_perm_b32 v197, v85, v84, s35
    v_perm_b32 v198, v87, v86, s34
    v_perm_b32 v199, v87, v86, s35
    v_perm_b32 v200, v89, v88, s34
    v_perm_b32 v201, v89, v88, s35
    v_perm_b32 v202, v91, v90, s34
    v_perm_b32 v203, v91, v90, s35
    v_perm_b32 v204, v93, v92, s34
    v_perm_b32 v205, v93, v92, s35
    v_perm_b32 v206, v95, v94, s34
    v_perm_b32 v207, v95, v94, s35
    s_xor_b32 s36, s21, 0
    s_lshl_b32 s36, s36, 15
    s_add_u32 s36, s36, s29
    s_add_u32 s37, s36, 0x0
    buffer_load_dword v48, v11, s[92:95], s37 offen
    s_add_u32 s37, s36, 0x4000
    buffer_load_dword v49, v11, s[92:95], s37 offen
    s_add_u32 s37, s36, 0x400
    buffer_load_dword v50, v11, s[92:95], s37 offen
    s_add_u32 s37, s36, 0x4400
    buffer_load_dword v51, v11, s[92:95], s37 offen
    s_add_u32 s37, s36, 0x2000
    buffer_load_dword v52, v11, s[92:95], s37 offen
    s_add_u32 s37, s36, 0x6000
    buffer_load_dword v53, v11, s[92:95], s37 offen
    s_add_u32 s37, s36, 0x2400
    buffer_load_dword v54, v11, s[92:95], s37 offen
    s_add_u32 s37, s36, 0x6400
    buffer_load_dword v55, v11, s[92:95], s37 offen
    s_add_u32 s37, s36, 0x40
    buffer_load_dword v56, v11, s[92:95], s37 offen
    s_add_u32 s37, s36, 0x4040
    buffer_load_dword v57, v11, s[92:95], s37 offen
    s_add_u32 s37, s36, 0x440
    buffer_load_dword v58, v11, s[92:95], s37 offen
    s_add_u32 s37, s36, 0x4440
    buffer_load_dword v59, v11, s[92:95], s37 offen
    s_add_u32 s37, s36, 0x2040
    buffer_load_dword v60, v11, s[92:95], s37 offen
    s_add_u32 s37, s36, 0x6040
    buffer_load_dword v61, v11, s[92:95], s37 offen
    s_add_u32 s37, s36, 0x2440
    buffer_load_dword v62, v11, s[92:95], s37 offen
    s_add_u32 s37, s36, 0x6440
    buffer_load_dword v63, v11, s[92:95], s37 offen
    s_barrier
    ds_read_b64_tr_b16 a[84:85], v20 offset:8192
    ds_read_b64_tr_b16 a[86:87], v20 offset:8704
    ds_read_b64_tr_b16 a[92:93], v21 offset:8192
    ds_read_b64_tr_b16 a[94:95], v21 offset:8704
    ds_read_b64_tr_b16 a[100:101], v22 offset:8192
    ds_read_b64_tr_b16 a[102:103], v22 offset:8704
    ds_read_b64_tr_b16 a[108:109], v23 offset:8192
    ds_read_b64_tr_b16 a[110:111], v23 offset:8704
    ds_read_b64_tr_b16 a[132:133], v24 offset:8192
    ds_read_b64_tr_b16 a[134:135], v24 offset:8704
    ds_read_b64_tr_b16 a[140:141], v25 offset:8192
    ds_read_b64_tr_b16 a[142:143], v25 offset:8704
    s_waitcnt lgkmcnt(4)
    ds_read_b64_tr_b16 v[116:117], v26 offset:8192
    ds_read_b64_tr_b16 v[118:119], v26 offset:8704
    ds_read_b64_tr_b16 v[124:125], v27 offset:8192
    ds_read_b64_tr_b16 v[126:127], v27 offset:8704
    s_waitcnt lgkmcnt(0)
    s_barrier
    s_add_u32 m0, s28, 40960
    s_add_u32 s37, s3, 0x200000
    buffer_load_dwordx4 v16, s[96:99], s37 offen lds
    s_add_u32 m0, s28, 45056
    s_add_u32 s37, s3, 0x220000
    buffer_load_dwordx4 v16, s[96:99], s37 offen lds
    s_add_u32 m0, s28, 73728
    s_add_u32 s37, s3, 0x240000
    buffer_load_dwordx4 v16, s[96:99], s37 offen lds
    s_add_u32 m0, s28, 77824
    s_add_u32 s37, s3, 0x260000
    buffer_load_dwordx4 v16, s[96:99], s37 offen lds
    s_add_u32 m0, s28, 106496
    s_add_u32 s37, s3, 0x280000
    buffer_load_dwordx4 v16, s[96:99], s37 offen lds
    s_add_u32 m0, s28, 110592
    s_add_u32 s37, s3, 0x2a0000
    buffer_load_dwordx4 v16, s[96:99], s37 offen lds
    s_add_u32 m0, s28, 139264
    s_add_u32 s37, s3, 0x2c0000
    buffer_load_dwordx4 v16, s[96:99], s37 offen lds
    s_add_u32 m0, s28, 143360
    s_add_u32 s37, s3, 0x2e0000
    buffer_load_dwordx4 v16, s[96:99], s37 offen lds
    s_waitcnt vmcnt(32)
    v_perm_b32 v176, v33, v32, s34
    v_perm_b32 v177, v33, v32, s35
    v_perm_b32 v178, v35, v34, s34
    v_perm_b32 v179, v35, v34, s35
    v_perm_b32 v180, v37, v36, s34
    v_perm_b32 v181, v37, v36, s35
    v_perm_b32 v182, v39, v38, s34
    v_perm_b32 v183, v39, v38, s35
    v_perm_b32 v184, v41, v40, s34
    v_perm_b32 v185, v41, v40, s35
    v_perm_b32 v186, v43, v42, s34
    v_perm_b32 v187, v43, v42, s35
    v_perm_b32 v188, v45, v44, s34
    v_perm_b32 v189, v45, v44, s35
    v_perm_b32 v190, v47, v46, s34
    v_perm_b32 v191, v47, v46, s35
    v_lshrrev_b32 v31, 2, v3
    buffer_load_dword v30, v31, s[16:19], 0 offen sc1
    s_barrier
    ds_read_b64_tr_b16 v[32:33], v20 offset:16384
    ds_read_b64_tr_b16 v[34:35], v20 offset:16896
    ds_read_b64_tr_b16 v[40:41], v21 offset:16384
    ds_read_b64_tr_b16 v[42:43], v21 offset:16896
    ds_read_b64_tr_b16 a[0:1], v22 offset:16384
    ds_read_b64_tr_b16 a[2:3], v22 offset:16896
    ds_read_b64_tr_b16 a[8:9], v23 offset:16384
    ds_read_b64_tr_b16 a[10:11], v23 offset:16896
    ds_read_b64_tr_b16 a[32:33], v24 offset:16384
    ds_read_b64_tr_b16 a[34:35], v24 offset:16896
    ds_read_b64_tr_b16 a[40:41], v25 offset:16384
    ds_read_b64_tr_b16 a[42:43], v25 offset:16896
    s_waitcnt lgkmcnt(4)
    ds_read_b64_tr_b16 a[64:65], v26 offset:16384
    ds_read_b64_tr_b16 a[66:67], v26 offset:16896
    ds_read_b64_tr_b16 a[72:73], v27 offset:16384
    ds_read_b64_tr_b16 a[74:75], v27 offset:16896
    s_waitcnt lgkmcnt(0)
    s_barrier
    s_add_u32 m0, s28, 49152
    s_add_u32 s37, s3, 0x300000
    buffer_load_dwordx4 v16, s[96:99], s37 offen lds
    s_add_u32 m0, s28, 53248
    s_add_u32 s37, s3, 0x320000
    buffer_load_dwordx4 v16, s[96:99], s37 offen lds
    s_add_u32 m0, s28, 81920
    s_add_u32 s37, s3, 0x340000
    buffer_load_dwordx4 v16, s[96:99], s37 offen lds
    s_add_u32 m0, s28, 86016
    s_add_u32 s37, s3, 0x360000
    buffer_load_dwordx4 v16, s[96:99], s37 offen lds
    s_add_u32 m0, s28, 114688
    s_add_u32 s37, s3, 0x380000
    buffer_load_dwordx4 v16, s[96:99], s37 offen lds
    s_add_u32 m0, s28, 118784
    s_add_u32 s37, s3, 0x3a0000
    buffer_load_dwordx4 v16, s[96:99], s37 offen lds
    s_add_u32 m0, s28, 147456
    s_add_u32 s37, s3, 0x3c0000
    buffer_load_dwordx4 v16, s[96:99], s37 offen lds
    s_add_u32 m0, s28, 151552
    s_add_u32 s37, s3, 0x3e0000
    buffer_load_dwordx4 v16, s[96:99], s37 offen lds
    s_waitcnt vmcnt(17)
    v_perm_b32 v160, v49, v48, s34
    v_perm_b32 v161, v49, v48, s35
    v_perm_b32 v162, v51, v50, s34
    v_perm_b32 v163, v51, v50, s35
    v_perm_b32 v164, v53, v52, s34
    v_perm_b32 v165, v53, v52, s35
    v_perm_b32 v166, v55, v54, s34
    v_perm_b32 v167, v55, v54, s35
    v_perm_b32 v168, v57, v56, s34
    v_perm_b32 v169, v57, v56, s35
    v_perm_b32 v170, v59, v58, s34
    v_perm_b32 v171, v59, v58, s35
    v_perm_b32 v172, v61, v60, s34
    v_perm_b32 v173, v61, v60, s35
    v_perm_b32 v174, v63, v62, s34
    v_perm_b32 v175, v63, v62, s35
    s_waitcnt vmcnt(8)
    s_mov_b32 s41, 1
L_HS:
    v_cmp_eq_u32 vcc, 0, v30
    s_cbranch_vccz L_HS_ok
    buffer_load_dword v30, v31, s[16:19], 0 offen sc1
    s_add_u32 s32, s32, 1
    s_cmp_gt_u32 s32, 200000
    s_waitcnt vmcnt(0)
    s_cbranch_scc0 L_HS
    s_branch L_HS_done
L_HS_ok:
    v_readlane_b32 s36, v30, 63
    s_nop 1
    v_cmp_ne_u32 vcc, s36, v30
    s_nop 1
    s_cmp_lg_u32 vcc_hi, 0
    s_cselect_b32 s41, 1, 0
L_HS_done:
    s_mov_b32 s7, 0xf7df00
    buffer_load_dword v15, v0, s[8:11], s7 offen sc1
    s_barrier
    ds_read_b64_tr_b16 v[36:37], v20 offset:0
    ds_read_b64_tr_b16 v[38:39], v20 offset:512
    ds_read_b64_tr_b16 v[44:45], v21 offset:0
    ds_read_b64_tr_b16 v[46:47], v21 offset:512
    ds_read_b64_tr_b16 a[4:5], v22 offset:0
    ds_read_b64_tr_b16 a[6:7], v22 offset:512
    ds_read_b64_tr_b16 a[12:13], v23 offset:0
    ds_read_b64_tr_b16 a[14:15], v23 offset:512
    ds_read_b64_tr_b16 a[36:37], v24 offset:0
    ds_read_b64_tr_b16 a[38:39], v24 offset:512
    ds_read_b64_tr_b16 a[44:45], v25 offset:0
    ds_read_b64_tr_b16 a[46:47], v25 offset:512
    s_waitcnt lgkmcnt(4)
    ds_read_b64_tr_b16 a[68:69], v26 offset:0
    ds_read_b64_tr_b16 a[70:71], v26 offset:512
    ds_read_b64_tr_b16 a[76:77], v27 offset:0
    ds_read_b64_tr_b16 a[78:79], v27 offset:512
    s_waitcnt lgkmcnt(0)
    s_barrier
    s_barrier
    ds_read_b64_tr_b16 v[48:49], v20 offset:8192
    ds_read_b64_tr_b16 v[50:51], v20 offset:8704
    ds_read_b64_tr_b16 v[56:57], v21 offset:8192
    ds_read_b64_tr_b16 v[58:59], v21 offset:8704
    ds_read_b64_tr_b16 a[16:17], v22 offset:8192
    ds_read_b64_tr_b16 a[18:19], v22 offset:8704
    ds_read_b64_tr_b16 a[24:25], v23 offset:8192
    ds_read_b64_tr_b16 a[26:27], v23 offset:8704
    ds_read_b64_tr_b16 a[48:49], v24 offset:8192
    ds_read_b64_tr_b16 a[50:51], v24 offset:8704
    ds_read_b64_tr_b16 a[56:57], v25 offset:8192
    ds_read_b64_tr_b16 a[58:59], v25 offset:8704
    s_waitcnt lgkmcnt(4)
    ds_read_b64_tr_b16 v[80:81], v26 offset:8192
    ds_read_b64_tr_b16 v[82:83], v26 offset:8704
    ds_read_b64_tr_b16 v[88:89], v27 offset:8192
    ds_read_b64_tr_b16 v[90:91], v27 offset:8704
    s_waitcnt lgkmcnt(0)
    s_barrier
    s_waitcnt vmcnt(0)
L_F0:
    v_readlane_b32 s36, v15, 33
    s_nop 1
    s_cmp_lg_u32 s36, 0
    s_cbranch_scc1 L_F0_ok
    buffer_load_dword v15, v0, s[8:11], s7 offen sc1
    s_add_u32 s32, s32, 1
    s_cmp_gt_u32 s32, 200000
    s_waitcnt vmcnt(0)
    s_cbranch_scc0 L_F0
L_F0_ok:
    s_mov_b32 s7, 0x1000000
    buffer_load_dword v15, v0, s[8:11], s7 offen sc1
    s_barrier
    ds_read_b64_tr_b16 v[52:53], v20 offset:16384
    ds_read_b64_tr_b16 v[54:55], v20 offset:16896
    ds_read_b64_tr_b16 v[60:61], v21 offset:16384
    ds_read_b64_tr_b16 v[62:63], v21 offset:16896
    ds_read_b64_tr_b16 a[20:21], v22 offset:16384
    ds_read_b64_tr_b16 a[22:23], v22 offset:16896
    ds_read_b64_tr_b16 a[28:29], v23 offset:16384
    ds_read_b64_tr_b16 a[30:31], v23 offset:16896
    ds_read_b64_tr_b16 a[52:53], v24 offset:16384
    ds_read_b64_tr_b16 a[54:55], v24 offset:16896
    ds_read_b64_tr_b16 a[60:61], v25 offset:16384
    ds_read_b64_tr_b16 a[62:63], v25 offset:16896
    s_waitcnt lgkmcnt(4)
    ds_read_b64_tr_b16 v[84:85], v26 offset:16384
    ds_read_b64_tr_b16 v[86:87], v26 offset:16896
    ds_read_b64_tr_b16 v[92:93], v27 offset:16384
    ds_read_b64_tr_b16 v[94:95], v27 offset:16896
    s_waitcnt lgkmcnt(0)
    s_barrier
    ds_write_b128 v4, v[32:35] offset:0
    ds_write_b128 v4, v[36:39] offset:1024
    ds_write_b128 v4, v[40:43] offset:2048
    ds_write_b128 v4, v[44:47] offset:3072
    ds_write_b128 v4, v[48:51] offset:4096
    ds_write_b128 v4, v[52:55] offset:5120
    ds_write_b128 v4, v[56:59] offset:6144
    ds_write_b128 v4, v[60:63] offset:7168
    s_waitcnt lgkmcnt(0)
    ds_write_b128 v4, v[64:67] offset:8192
    ds_write_b128 v4, v[68:71] offset:9216
    ds_write_b128 v4, v[72:75] offset:10240
    ds_write_b128 v4, v[76:79] offset:11264
    ds_write_b128 v4, v[80:83] offset:12288
    ds_write_b128 v4, v[84:87] offset:13312
    ds_write_b128 v4, v[88:91] offset:14336
    ds_write_b128 v4, v[92:95] offset:15360
    s_waitcnt lgkmcnt(0)
    ds_write_b128 v4, v[96:99] offset:16384
    ds_write_b128 v4, v[100:103] offset:17408
    ds_write_b128 v4, v[104:107] offset:18432
    ds_write_b128 v4, v[108:111] offset:19456
    ds_write_b128 v4, v[112:115] offset:20480
    ds_write_b128 v4, v[116:119] offset:21504
    ds_write_b128 v4, v[120:123] offset:22528
    ds_write_b128 v4, v[124:127] offset:23552
    s_waitcnt lgkmcnt(0)
    s_waitcnt lgkmcnt(0)
    s_cmp_lg_u32 s41, 0
    s_cbranch_scc1 L_slow_start
L_fast_start:
    s_mov_b32 s22, 0
    s_mov_b32 s23, 0x1000000
    s_mov_b32 s27, 0
    s_mov_b32 s31, 0x80000
    s_mov_b32 s61, 0x40000000
    s_mov_b32 s96, 0x800
    s_mov_b32 s97, 0x1000
    s_mov_b32 s98, 0x1800
    s_mov_b32 s92, 0xcccccccc
    s_mov_b32 s93, 0xcccccccc
    s_mov_b32 s91, 0
    ds_read_b128 v[104:107], v4 offset:0
    ds_read_b128 v[108:111], v4 offset:1024
    ds_read_b128 v[112:115], v4 offset:2048
    ds_read_b128 v[116:119], v4 offset:3072
    ds_read_b128 v[88:91], v4 offset:4096
    ds_read_b128 v[92:95], v4 offset:5120
    ds_read_b128 v[96:99], v4 offset:6144
    ds_read_b128 v[100:103], v4 offset:7168
    ds_read_b128 v[72:75], v4 offset:8192
    ds_read_b128 v[76:79], v4 offset:9216
    ds_read_b128 v[80:83], v4 offset:10240
    ds_read_b128 v[84:87], v4 offset:11264
    v_mov_b64 v[48:49], 0
    v_mov_b64 v[50:51], 0
    v_mov_b64 v[52:53], 0
    v_mov_b64 v[54:55], 0
    v_mov_b64 v[56:57], 0
    v_mov_b64 v[58:59], 0
    v_mov_b64 v[60:61], 0
    v_mov_b64 v[62:63], 0
    v_mov_b64 v[64:65], 0
    v_mov_b64 v[66:67], 0
    v_mov_b64 v[68:69], 0
    v_mov_b64 v[70:71], 0
    s_add_u32 s7, s23, 0x80000
    buffer_load_dwordx4 v[16:19], v2, s[8:11], s7 offen sc1
    buffer_load_dwordx4 v[20:23], v2, s[8:11], s7 offen offset:1024 sc1
    s_waitcnt vmcnt(2)
L_fast_step:
    v_readlane_b32 s36, v15, 33
    s_add_u32 s24, s23, 0x82100
    s_cmp_eq_u32 s36, 0
    s_cbranch_scc1 L_fast_refresh
L_fast_fresh:
    s_add_u32 s29, s23, s25
    s_add_u32 s30, s23, s39
    s_xor_b32 s28, s27, 1
    s_add_u32 s90, s22, 1
    s_nop 15
L_fast_retrym:
    buffer_load_dwordx4 v[16:19], v2, s[8:11], s7 offen sc1
    buffer_load_dwordx4 v[20:23], v2, s[8:11], s7 offen offset:1024 sc1
L_fast_prem:
    s_add_u32 s32, s32, 1
    s_cmp_gt_u32 s32, 200000
    s_cselect_b32 s94, -1, -2
    v_xor_b32 v28, 0x800, v2
    v_xor_b32 v44, 0x1800, v2
    v_mov_b64 v[48:49], 0
    v_mov_b64 v[50:51], 0
    v_mov_b64 v[52:53], 0
    v_mov_b64 v[54:55], 0
L_fast_waitm:
    s_waitcnt vmcnt(3) lgkmcnt(0)
L_fast_gotm:
    v_max3_u32 v14, v16, v17, v18
    v_max_u32 v14, v14, v19
    v_smfmac_f32_16x16x64_bf16 v[48:51], v[16:19], v[104:111], v1
    s_waitcnt vmcnt(2)
    v_max3_u32 v14, v14, v20, v21
    v_smfmac_f32_16x16x64_bf16 v[52:55], v[16:19], v[112:119], v1
    v_max3_u32 v14, v14, v22, v23
    v_cmp_lt_u32 vcc, s94, v14
    v_smfmac_f32_16x16x64_bf16 v[48:51], v[20:23], v[88:95], v1
    ds_write_b128 v2, v[16:19] offset:0
    s_cbranch_vccnz L_fast_retrym
    v_smfmac_f32_16x16x64_bf16 v[52:55], v[20:23], v[96:103], v1
    ds_write_b128 v2, v[20:23] offset:1024
    v_smfmac_f32_16x16x64_bf16 v[56:59], v[16:19], v[72:79], v1
    buffer_load_dwordx4 v[104:107], v3, s[8:11], s29 offen offset:0 sc1
    buffer_load_dwordx4 v[120:123], v3, s[8:11], s30 offen offset:0 sc1
    v_smfmac_f32_16x16x64_bf16 v[60:63], v[16:19], v[80:87], v1
    buffer_load_dwordx4 v[108:111], v3, s[8:11], s29 offen offset:1024 sc1
    buffer_load_dwordx4 v[124:127], v3, s[8:11], s30 offen offset:1024 sc1
    v_smfmac_f32_16x16x64_bf16 v[56:59], v[20:23], a[80:87], v1
    buffer_load_dwordx4 v[112:115], v3, s[8:11], s29 offen offset:2048 sc1
    buffer_load_dwordx4 v[116:119], v3, s[8:11], s29 offen offset:3072 sc1
    v_smfmac_f32_16x16x64_bf16 v[60:63], v[20:23], a[88:95], v1
    s_waitcnt lgkmcnt(0)
    s_barrier
    ds_read_b128 v[24:27], v28 offset:0
    v_smfmac_f32_16x16x64_bf16 v[64:67], v[16:19], a[160:167], v1
    ds_read_b128 v[28:31], v28 offset:1024
    v_smfmac_f32_16x16x64_bf16 v[68:71], v[16:19], a[168:175], v1
    buffer_load_dword v15, v0, s[8:11], s24 offen sc1
    v_smfmac_f32_16x16x64_bf16 v[64:67], v[20:23], a[176:183], v1
    ds_read_b128 v[32:35], v8 offset:0
    v_smfmac_f32_16x16x64_bf16 v[68:71], v[20:23], a[184:191], v1
    ds_read_b128 v[36:39], v8 offset:1024
    s_waitcnt lgkmcnt(3)
    v_smfmac_f32_16x16x64_bf16 v[48:51], v[24:27], a[0:7], v1
    ds_read_b128 v[40:43], v44 offset:0
    v_smfmac_f32_16x16x64_bf16 v[52:55], v[24:27], a[8:15], v1
    ds_read_b128 v[44:47], v44 offset:1024
    s_waitcnt lgkmcnt(4)
    v_smfmac_f32_16x16x64_bf16 v[48:51], v[28:31], a[16:23], v1
    ds_read_b128 v[88:91], v4 offset:12288
    v_smfmac_f32_16x16x64_bf16 v[52:55], v[28:31], a[24:31], v1
    ds_read_b128 v[92:95], v4 offset:13312
    s_waitcnt lgkmcnt(4)
    v_smfmac_f32_16x16x64_bf16 v[48:51], v[32:35], a[32:39], v1
    ds_read_b128 v[96:99], v4 offset:14336
    v_smfmac_f32_16x16x64_bf16 v[52:55], v[32:35], a[40:47], v1
    ds_read_b128 v[100:103], v4 offset:15360
    s_waitcnt lgkmcnt(4)
    v_smfmac_f32_16x16x64_bf16 v[48:51], v[36:39], a[48:55], v1
    v_smfmac_f32_16x16x64_bf16 v[52:55], v[36:39], a[56:63], v1
    ds_read_b128 v[72:75], v4 offset:16384
    v_smfmac_f32_16x16x64_bf16 v[48:51], v[40:43], a[64:71], v1
    v_smfmac_f32_16x16x64_bf16 v[52:55], v[40:43], a[72:79], v1
    ds_read_b128 v[76:79], v4 offset:17408
    s_waitcnt lgkmcnt(2)
    v_smfmac_f32_16x16x64_bf16 v[48:51], v[44:47], v[88:95], v1
    ds_read_b128 v[80:83], v4 offset:18432
    v_smfmac_f32_16x16x64_bf16 v[52:55], v[44:47], v[96:103], v1
    ds_read_b128 v[84:87], v4 offset:19456
    v_smfmac_f32_16x16x64_bf16 v[56:59], v[28:31], a[96:103], v1
    ds_read_b128 v[88:91], v4 offset:20480
    v_smfmac_f32_16x16x64_bf16 v[60:63], v[28:31], a[104:111], v1
    ds_read_b128 v[92:95], v4 offset:21504
    v_smfmac_f32_16x16x64_bf16 v[56:59], v[32:35], a[112:119], v1
    ds_read_b128 v[96:99], v4 offset:22528
    v_add_f32 v48, v48, v50
    v_add_f32 v49, v49, v51
    v_smfmac_f32_16x16x64_bf16 v[60:63], v[32:35], a[120:127], v1
    ds_read_b128 v[100:103], v4 offset:23552
    v_add_f32 v52, v52, v54
    v_add_f32 v53, v53, v55
    v_smfmac_f32_16x16x64_bf16 v[56:59], v[36:39], a[128:135], v1
    s_waitcnt lgkmcnt(4)
    v_cvt_pk_bf16_f32 v50, v48, v52
    v_cvt_pk_bf16_f32 v51, v49, v53
    v_smfmac_f32_16x16x64_bf16 v[56:59], v[24:27], v[72:79], v1
    ds_write2_b32 v5, v50, v51 offset0:0 offset1:72
    v_smfmac_f32_16x16x64_bf16 v[60:63], v[24:27], v[80:87], v1
    v_smfmac_f32_16x16x64_bf16 v[60:63], v[36:39], a[136:143], v1
    v_smfmac_f32_16x16x64_bf16 v[56:59], v[40:43], a[144:151], v1
    buffer_store_dword v12, v10, s[8:11], s31 offen sc1
    v_smfmac_f32_16x16x64_bf16 v[60:63], v[40:43], a[152:159], v1
    s_waitcnt lgkmcnt(0)
    s_barrier
    v_smfmac_f32_16x16x64_bf16 v[56:59], v[44:47], v[88:95], v1
    ds_read_b128 v[72:75], v6 offset:0
    v_smfmac_f32_16x16x64_bf16 v[60:63], v[44:47], v[96:103], v1
    ds_read_b128 v[76:79], v6 offset:64
    v_smfmac_f32_16x16x64_bf16 v[64:67], v[24:27], a[192:199], v1
    ds_read_b128 v[80:83], v6 offset:128
    v_smfmac_f32_16x16x64_bf16 v[68:71], v[24:27], a[200:207], v1
    ds_read_b128 v[84:87], v6 offset:192
    s_waitcnt vmcnt(2) lgkmcnt(3)
    v_mfma_f32_16x16x32_bf16 v[48:51], v[104:107], v[72:75], 0
    s_waitcnt lgkmcnt(2)
    v_add_f32 v56, v56, v58
    v_add_f32 v57, v57, v59
    v_mfma_f32_16x16x32_bf16 v[48:51], v[108:111], v[76:79], v[48:51]
    s_waitcnt lgkmcnt(1)
    v_add_f32 v60, v60, v62
    v_add_f32 v61, v61, v63
    v_mfma_f32_16x16x32_bf16 v[48:51], v[112:115], v[80:83], v[48:51]
    s_waitcnt lgkmcnt(0)
    v_cvt_pk_bf16_f32 v58, v56, v60
    v_cvt_pk_bf16_f32 v59, v57, v61
    v_mfma_f32_16x16x32_bf16 v[48:51], v[116:119], v[84:87], v[48:51]
    ds_write2_b32 v7, v58, v59 offset0:0 offset1:72
    v_smfmac_f32_16x16x64_bf16 v[64:67], v[28:31], a[208:215], v1
    v_mov_b64 v[104:105], s[4:5]
    v_smfmac_f32_16x16x64_bf16 v[68:71], v[28:31], a[216:223], v1
    s_nop 1
    v_mov_b64 v[106:107], s[4:5]
    v_smfmac_f32_16x16x64_bf16 v[64:67], v[32:35], a[224:231], v1
    v_exp_f32 v48, v48
    v_smfmac_f32_16x16x64_bf16 v[68:71], v[32:35], a[232:239], v1
    s_waitcnt lgkmcnt(0)
    s_barrier
    v_exp_f32 v49, v49
    v_smfmac_f32_16x16x64_bf16 v[64:67], v[36:39], a[240:247], v1
    ds_read_b128 v[88:91], v6 offset:2304
    v_exp_f32 v50, v50
    v_smfmac_f32_16x16x64_bf16 v[68:71], v[36:39], a[248:255], v1
    ds_read_b128 v[92:95], v6 offset:2368
    v_exp_f32 v51, v51
    v_smfmac_f32_16x16x64_bf16 v[64:67], v[40:43], v[128:135], v1
    ds_read_b128 v[96:99], v6 offset:2432
    v_cvt_pk_bf16_f32 v108, v48, v49
    v_cvt_pk_bf16_f32 v109, v50, v51
    v_smfmac_f32_16x16x64_bf16 v[68:71], v[40:43], v[136:143], v1
    ds_read_b128 v[100:103], v6 offset:2496
    ds_write_b64 v2, v[108:109] offset:8192
    s_waitcnt lgkmcnt(4)
    v_mfma_f32_16x16x32_bf16 v[52:55], v[88:91], v[72:75], 0
    s_waitcnt lgkmcnt(3)
    v_mov_b32 v113, 0
    v_mov_b32 v115, 0
    v_mfma_f32_16x16x32_bf16 v[52:55], v[92:95], v[76:79], v[52:55]
    s_waitcnt lgkmcnt(2)
    v_mov_b32 v117, 0
    v_mov_b64 v[16:17], 0
    v_mfma_f32_16x16x32_bf16 v[52:55], v[96:99], v[80:83], v[52:55]
    s_waitcnt lgkmcnt(1)
    v_mov_b64 v[18:19], 0
    v_mov_b64 v[20:21], 0
    v_mfma_f32_16x16x32_bf16 v[52:55], v[100:103], v[84:87], v[52:55]
    s_waitcnt lgkmcnt(0)
    s_barrier
    v_smfmac_f32_16x16x64_bf16 v[64:67], v[44:47], v[144:151], v1
    ds_read_b64 v[110:111], v8 offset:8192
    v_mov_b64 v[22:23], 0
    v_smfmac_f32_16x16x64_bf16 v[68:71], v[44:47], v[152:159], v1
    v_mov_b64 v[24:25], 0
    v_mov_b64 v[26:27], 0
    v_mul_f32 v52, s33, v52
    v_mul_f32 v53, s33, v53
    v_exp_f32 v52, v52
    s_waitcnt lgkmcnt(0)
    v_mfma_f32_16x16x32_bf16 v[48:51], v[104:107], v[108:111], 0
    v_exp_f32 v53, v53
    v_add_f32 v64, v64, v66
    v_mfma_f32_16x16x32_bf16 v[56:59], v[120:123], v[108:111], 0
    v_cvt_pk_bf16_f32 v112, v52, v53
    v_add_f32 v65, v65, v67
    v_mfma_f32_16x16x32_bf16 v[60:63], v[124:127], v[108:111], 0
    v_cvt_pk_bf16_f32 v114, v64, v65
    v_add_f32 v68, v68, v70
    v_mfma_f32_16x16x16_bf16 v[48:51], v[104:105], v[112:113], v[48:51]
    v_add_f32 v69, v69, v71
    v_cvt_pk_bf16_f32 v116, v68, v69
    v_mfma_f32_16x16x16_bf16 v[56:59], v[114:115], v[112:113], v[56:59]
    v_mov_b64 v[28:29], 0
    v_mov_b64 v[30:31], 0
    v_mfma_f32_16x16x16_bf16 v[60:63], v[116:117], v[112:113], v[60:63]
    v_bitop3_b32 v32, v13, s96, -9 bitop3:0x28
    v_bitop3_b32 v36, v13, s97, -9 bitop3:0x28
    v_rcp_f32 v118, v48
    v_bitop3_b32 v40, v13, s98, -9 bitop3:0x28
    v_max_f32 v14, v118, v48
    v_cmp_nge_f32 vcc, s40, v14
    v_pk_mul_f32 v[56:57], v[56:57], v[118:119] op_sel_hi:[1,0]
    v_pk_mul_f32 v[58:59], v[58:59], v[118:119] op_sel_hi:[1,0]
    v_pk_mul_f32 v[60:61], v[60:61], v[118:119] op_sel_hi:[1,0]
    v_pk_mul_f32 v[62:63], v[62:63], v[118:119] op_sel_hi:[1,0]
    v_cvt_pk_bf16_f32 v52, v56, v60
    v_cvt_pk_bf16_f32 v54, v58, v62
    v_cvt_pk_bf16_f32 v53, v57, v61
    v_cvt_pk_bf16_f32 v55, v59, v63
L_fast_rejoin:
    v_cndmask_b32 v50, v52, v54, s[92:93]
    v_cndmask_b32 v51, v53, v55, s[92:93]
    ds_write_b64 v13, v[50:51] offset:9216
    v_smfmac_f32_16x16x64_bf16 v[16:19], v[52:55], v[160:167], v1
    v_smfmac_f32_16x16x64_bf16 v[20:23], v[52:55], v[168:175], v1
    s_waitcnt lgkmcnt(0)
    s_barrier
    ds_read_b128 v[32:35], v32 offset:9216
    ds_read_b128 v[36:39], v36 offset:9216
    v_smfmac_f32_16x16x64_bf16 v[24:27], v[52:55], v[176:183], v1
    ds_read_b128 v[40:43], v40 offset:9216
    v_smfmac_f32_16x16x64_bf16 v[28:31], v[52:55], v[184:191], v1
    ds_read_b128 v[88:91], v4 offset:24576
    ds_read_b128 v[92:95], v4 offset:25600
    s_waitcnt lgkmcnt(4)
    v_smfmac_f32_16x16x64_bf16 v[16:19], v[32:35], v[192:199], v1
    ds_read_b128 v[96:99], v4 offset:26624
    s_waitcnt lgkmcnt(4)
    v_smfmac_f32_16x16x64_bf16 v[16:19], v[36:39], v[216:223], v1
    ds_read_b128 v[100:103], v4 offset:27648
    s_waitcnt lgkmcnt(4)
    v_smfmac_f32_16x16x64_bf16 v[16:19], v[40:43], v[240:247], v1
    ds_read_b128 v[72:75], v4 offset:28672
    s_cmp_lg_u64 vcc, 0
    v_smfmac_f32_16x16x64_bf16 v[20:23], v[32:35], v[200:207], v1
    ds_read_b128 v[76:79], v4 offset:29696
    s_cselect_b32 s60, s28, s27
    v_smfmac_f32_16x16x64_bf16 v[20:23], v[36:39], v[224:231], v1
    ds_read_b128 v[80:83], v4 offset:30720
    s_nop 0
    v_cvt_pk_bf16_f32 v56, v16, v18
    v_smfmac_f32_16x16x64_bf16 v[20:23], v[40:43], v[248:255], v1
    ds_read_b128 v[84:87], v4 offset:31744
    v_cvt_pk_bf16_f32 v57, v17, v19
    v_and_or_b32 v56, v56, -2, s60
    v_smfmac_f32_16x16x64_bf16 v[24:27], v[32:35], v[208:215], v1
    buffer_store_dwordx2 v[56:57], v9, s[8:11], 0 offen offset:0
    v_smfmac_f32_16x16x64_bf16 v[24:27], v[36:39], v[232:239], v1
    s_waitcnt lgkmcnt(4)
    s_nop 0
    v_cvt_pk_bf16_f32 v58, v20, v22
    v_smfmac_f32_16x16x64_bf16 v[24:27], v[40:43], v[88:95], v1
    ds_read_b128 v[64:67], v3 offset:23040
    v_cvt_pk_bf16_f32 v59, v21, v23
    v_and_or_b32 v58, v58, -2, s60
    v_smfmac_f32_16x16x64_bf16 v[28:31], v[32:35], v[96:103], v1
    buffer_store_dwordx2 v[58:59], v9, s[8:11], 0 offen offset:2048
    s_waitcnt lgkmcnt(1)
    v_smfmac_f32_16x16x64_bf16 v[28:31], v[36:39], v[72:79], v1
    s_nop 1
    v_cvt_pk_bf16_f32 v60, v24, v26
    v_smfmac_f32_16x16x64_bf16 v[28:31], v[40:43], v[80:87], v1
    s_nop 2
    v_cvt_pk_bf16_f32 v61, v25, v27
    v_and_or_b32 v60, v60, -2, s60
    buffer_store_dwordx2 v[60:61], v9, s[8:11], s26 offen offset:0
    s_nop 1
    v_cvt_pk_bf16_f32 v62, v28, v30
    v_cvt_pk_bf16_f32 v63, v29, v31
    v_and_or_b32 v62, v62, -2, s60
    buffer_store_dwordx2 v[62:63], v9, s[8:11], s26 offen offset:2048
L_fast_stored:
    s_cmp_lg_u32 s60, s27
    s_cbranch_scc1 L_fast_safe
    ds_read_b128 v[104:107], v4 offset:0
    ds_read_b128 v[108:111], v4 offset:1024
    ds_read_b128 v[112:115], v4 offset:2048
    ds_read_b128 v[116:119], v4 offset:3072
    ds_read_b128 v[88:91], v4 offset:4096
    ds_read_b128 v[92:95], v4 offset:5120
    ds_read_b128 v[96:99], v4 offset:6144
    ds_read_b128 v[100:103], v4 offset:7168
    ds_read_b128 v[72:75], v4 offset:8192
    ds_read_b128 v[76:79], v4 offset:9216
    ds_read_b128 v[80:83], v4 offset:10240
    ds_read_b128 v[84:87], v4 offset:11264
    s_cmp_lt_u32 s21, 1
    s_cbranch_scc1 L_fast_pollp
    s_nop 11
    s_cmp_lt_u32 s21, 2
    s_cbranch_scc1 L_fast_pollp
    s_nop 11
    s_cmp_lt_u32 s21, 3
    s_cbranch_scc1 L_fast_pollp
    s_nop 11
L_fast_pollp:
    buffer_load_dwordx4 v[120:123], v2, s[8:11], s6 offen sc1
    buffer_load_dwordx4 v[124:127], v2, s[8:11], s6 offen offset:1024 sc1
    v_mov_b64 v[56:57], 0
    v_mov_b64 v[58:59], 0
    v_mov_b64 v[60:61], 0
    v_mov_b64 v[62:63], 0
    s_nop 15
    s_nop 15
    buffer_load_dwordx4 v[32:35], v2, s[8:11], s6 offen sc1
    buffer_load_dwordx4 v[36:39], v2, s[8:11], s6 offen offset:1024 sc1
L_fast_prep:
    s_add_u32 s7, s24, 0x80000
    s_waitcnt vmcnt(3) lgkmcnt(0)
    v_mfma_f32_16x16x32_bf16 v[68:71], v[64:67], v[120:123], 0
    v_bitop3_b32 v14, v120, v122, s27 bitop3:0x7e
    s_waitcnt vmcnt(2)
    v_mfma_f32_16x16x32_bf16 v[68:71], v[64:67], v[124:127], v[68:71]
    v_bitop3_b32 v11, v124, v126, s27 bitop3:0x7e
    v_bitop3_b32 v14, v14, v11, 1 bitop3:0xa8
    v_cmp_ne_u32 vcc, 0, v14
    s_nop 2
    s_cmp_eq_u64 vcc, 0
    s_cselect_b32 s36, s24, s61
    v_add_f32_dpp v68, v68, v68 row_ror:8 row_mask:0xf bank_mask:0xf
    v_add_f32_dpp v69, v69, v69 row_ror:8 row_mask:0xf bank_mask:0xf
    s_nop 0
    v_add_f32_dpp v68, v68, v68 row_ror:4 row_mask:0xf bank_mask:0xf
    v_add_f32_dpp v69, v69, v69 row_ror:4 row_mask:0xf bank_mask:0xf
    v_cvt_pk_bf16_f32 v12, v68, v69
    buffer_store_dword v12, v10, s[8:11], s36 offen
    s_cbranch_scc1 L_fast_gotp
L_fast_retryp:
    buffer_load_dwordx4 v[120:123], v2, s[8:11], s6 offen sc1
    buffer_load_dwordx4 v[124:127], v2, s[8:11], s6 offen offset:1024 sc1
    s_waitcnt vmcnt(4) lgkmcnt(0)
    v_mfma_f32_16x16x32_bf16 v[68:71], v[64:67], v[32:35], 0
    v_bitop3_b32 v14, v32, v34, s27 bitop3:0x7e
    s_waitcnt vmcnt(3)
    v_mfma_f32_16x16x32_bf16 v[68:71], v[64:67], v[36:39], v[68:71]
    v_bitop3_b32 v11, v36, v38, s27 bitop3:0x7e
    v_bitop3_b32 v14, v14, v11, 1 bitop3:0xa8
    v_cmp_ne_u32 vcc, 0, v14
    s_nop 2
    s_cmp_eq_u64 vcc, 0
    s_cselect_b32 s36, s24, s61
    v_add_f32_dpp v68, v68, v68 row_ror:8 row_mask:0xf bank_mask:0xf
    v_add_f32_dpp v69, v69, v69 row_ror:8 row_mask:0xf bank_mask:0xf
    s_nop 0
    v_add_f32_dpp v68, v68, v68 row_ror:4 row_mask:0xf bank_mask:0xf
    v_add_f32_dpp v69, v69, v69 row_ror:4 row_mask:0xf bank_mask:0xf
    v_cvt_pk_bf16_f32 v12, v68, v69
    buffer_store_dword v12, v10, s[8:11], s36 offen
    s_cbranch_scc1 L_fast_gotp
    buffer_load_dwordx4 v[32:35], v2, s[8:11], s6 offen sc1
    buffer_load_dwordx4 v[36:39], v2, s[8:11], s6 offen offset:1024 sc1
    s_waitcnt vmcnt(4) lgkmcnt(0)
    v_mfma_f32_16x16x32_bf16 v[68:71], v[64:67], v[120:123], 0
    v_bitop3_b32 v14, v120, v122, s27 bitop3:0x7e
    s_waitcnt vmcnt(3)
    v_mfma_f32_16x16x32_bf16 v[68:71], v[64:67], v[124:127], v[68:71]
    v_bitop3_b32 v11, v124, v126, s27 bitop3:0x7e
    v_bitop3_b32 v14, v14, v11, 1 bitop3:0xa8
    v_cmp_ne_u32 vcc, 0, v14
    s_nop 2
    s_cmp_eq_u64 vcc, 0
    s_cselect_b32 s36, s24, s61
    v_add_f32_dpp v68, v68, v68 row_ror:8 row_mask:0xf bank_mask:0xf
    v_add_f32_dpp v69, v69, v69 row_ror:8 row_mask:0xf bank_mask:0xf
    s_nop 0
    v_add_f32_dpp v68, v68, v68 row_ror:4 row_mask:0xf bank_mask:0xf
    v_add_f32_dpp v69, v69, v69 row_ror:4 row_mask:0xf bank_mask:0xf
    v_cvt_pk_bf16_f32 v12, v68, v69
    buffer_store_dword v12, v10, s[8:11], s36 offen
    s_cbranch_scc1 L_fast_gotp
    s_add_u32 s32, s32, 1
    s_cmp_le_u32 s32, 200000
    s_cbranch_scc1 L_fast_retryp
    s_mov_b32 s36, s24
    buffer_store_dword v12, v10, s[8:11], s36 offen
L_fast_gotp:
    s_add_u32 s31, s31, 0x2000
    s_cmp_ge_u32 s90, 63
    s_cbranch_scc1 L_fast_last
    s_mov_b32 s23, s24
    s_mov_b32 s22, s90
    s_mov_b32 s27, s28
    v_mov_b64 v[64:65], 0
    v_mov_b64 v[66:67], 0
    v_mov_b64 v[68:69], 0
    v_mov_b64 v[70:71], 0
    s_nop 15
    s_nop 11
    buffer_load_dwordx4 v[16:19], v2, s[8:11], s7 offen sc1
    buffer_load_dwordx4 v[20:23], v2, s[8:11], s7 offen offset:1024 sc1
    s_branch L_fast_step
L_fast_last:
    buffer_store_dword v12, v10, s[8:11], s31 offen sc1
    s_branch L_fast_done
L_fast_refresh:
    buffer_load_dword v15, v0, s[8:11], s23 offen sc1
    s_add_u32 s32, s32, 1
    s_cmp_le_u32 s32, 200000
    s_waitcnt vmcnt(0)
    s_cbranch_scc1 L_fast_step
    s_branch L_fast_fresh
L_fast_safe:
    s_nop 11
    s_waitcnt vmcnt(0) lgkmcnt(0)
    s_barrier
    ds_read_b128 v[72:75], v6 offset:0
    ds_read_b128 v[88:91], v6 offset:2304
    ds_read_b128 v[76:79], v6 offset:64
    ds_read_b128 v[92:95], v6 offset:2368
    ds_read_b128 v[80:83], v6 offset:128
    ds_read_b128 v[96:99], v6 offset:2432
    ds_read_b128 v[84:87], v6 offset:192
    ds_read_b128 v[100:103], v6 offset:2496
    s_xor_b32 s36, s25, 0x1000
    s_add_u32 s36, s36, s23
    buffer_load_dwordx4 v[16:19], v3, s[8:11], s29 offen offset:0 sc1
    buffer_load_dwordx4 v[32:35], v3, s[8:11], s36 offen offset:0 sc1
    buffer_load_dwordx4 v[20:23], v3, s[8:11], s29 offen offset:1024 sc1
    buffer_load_dwordx4 v[36:39], v3, s[8:11], s36 offen offset:1024 sc1
    buffer_load_dwordx4 v[24:27], v3, s[8:11], s29 offen offset:2048 sc1
    buffer_load_dwordx4 v[40:43], v3, s[8:11], s36 offen offset:2048 sc1
    buffer_load_dwordx4 v[28:31], v3, s[8:11], s29 offen offset:3072 sc1
    buffer_load_dwordx4 v[44:47], v3, s[8:11], s36 offen offset:3072 sc1
    s_waitcnt vmcnt(0) lgkmcnt(0)
    v_mfma_f32_16x16x32_bf16 v[48:51], v[16:19], v[72:75], 0
    v_mfma_f32_16x16x32_bf16 v[48:51], v[20:23], v[76:79], v[48:51]
    v_mfma_f32_16x16x32_bf16 v[48:51], v[24:27], v[80:83], v[48:51]
    v_mfma_f32_16x16x32_bf16 v[48:51], v[28:31], v[84:87], v[48:51]
    v_mfma_f32_16x16x32_bf16 v[52:55], v[32:35], v[72:75], 0
    v_mfma_f32_16x16x32_bf16 v[52:55], v[36:39], v[76:79], v[52:55]
    v_mfma_f32_16x16x32_bf16 v[52:55], v[40:43], v[80:83], v[52:55]
    v_mfma_f32_16x16x32_bf16 v[52:55], v[44:47], v[84:87], v[52:55]
    v_mfma_f32_16x16x32_bf16 v[56:59], v[88:91], v[72:75], 0
    v_mfma_f32_16x16x32_bf16 v[56:59], v[92:95], v[76:79], v[56:59]
    v_mfma_f32_16x16x32_bf16 v[56:59], v[96:99], v[80:83], v[56:59]
    v_mfma_f32_16x16x32_bf16 v[56:59], v[100:103], v[84:87], v[56:59]
    s_nop 7
    v_mul_f32 v56, s33, v56
    v_mul_f32 v57, s33, v57
    v_max3_f32 v16, v48, v49, v50
    v_max3_f32 v16, v16, v51, v52
    v_max3_f32 v16, v16, v53, v54
    v_max3_f32 v16, v16, v55, v56
    v_max_f32 v16, v16, v57
    v_mov_b32 v17, v16
    s_nop 1
    v_permlane16_swap_b32 v16, v17
    v_max_f32 v16, v16, v17
    v_mov_b32 v17, v16
    s_nop 1
    v_permlane32_swap_b32 v16, v17
    v_max_f32 v16, v16, v17
    v_sub_f32 v48, v48, v16
    v_exp_f32 v48, v48
    v_sub_f32 v49, v49, v16
    v_exp_f32 v49, v49
    v_sub_f32 v50, v50, v16
    v_exp_f32 v50, v50
    v_sub_f32 v51, v51, v16
    v_exp_f32 v51, v51
    v_sub_f32 v52, v52, v16
    v_exp_f32 v52, v52
    v_sub_f32 v53, v53, v16
    v_exp_f32 v53, v53
    v_sub_f32 v54, v54, v16
    v_exp_f32 v54, v54
    v_sub_f32 v55, v55, v16
    v_exp_f32 v55, v55
    v_sub_f32 v56, v56, v16
    v_exp_f32 v56, v56
    v_sub_f32 v57, v57, v16
    v_exp_f32 v57, v57
    v_cvt_pk_bf16_f32 v108, v48, v49
    v_cvt_pk_bf16_f32 v109, v50, v51
    v_cvt_pk_bf16_f32 v110, v52, v53
    v_cvt_pk_bf16_f32 v111, v54, v55
    v_cvt_pk_bf16_f32 v112, v56, v57
    s_nop 0
    v_mfma_f32_16x16x32_bf16 v[48:51], v[104:107], v[108:111], 0
    v_mfma_f32_16x16x32_bf16 v[56:59], v[120:123], v[108:111], 0
    v_mfma_f32_16x16x32_bf16 v[60:63], v[124:127], v[108:111], 0
    s_nop 3
    v_mfma_f32_16x16x16_bf16 v[48:51], v[104:105], v[112:113], v[48:51]
    v_mfma_f32_16x16x16_bf16 v[56:59], v[114:115], v[112:113], v[56:59]
    v_mfma_f32_16x16x16_bf16 v[60:63], v[116:117], v[112:113], v[60:63]
    s_nop 5
    v_rcp_f32 v118, v48
    s_nop 0
    v_mul_f32 v56, v56, v118
    v_mul_f32 v57, v57, v118
    v_mul_f32 v58, v58, v118
    v_mul_f32 v59, v59, v118
    v_mul_f32 v60, v60, v118
    v_mul_f32 v61, v61, v118
    v_mul_f32 v62, v62, v118
    v_mul_f32 v63, v63, v118
    v_cvt_pk_bf16_f32 v52, v56, v60
    v_cvt_pk_bf16_f32 v53, v57, v61
    v_cvt_pk_bf16_f32 v54, v58, v62
    v_cvt_pk_bf16_f32 v55, v59, v63
    v_mov_b32 v16, 0
    v_mov_b32 v17, 0
    v_mov_b32 v18, 0
    v_mov_b32 v19, 0
    v_mov_b32 v20, 0
    v_mov_b32 v21, 0
    v_mov_b32 v22, 0
    v_mov_b32 v23, 0
    v_mov_b32 v24, 0
    v_mov_b32 v25, 0
    v_mov_b32 v26, 0
    v_mov_b32 v27, 0
    v_mov_b32 v28, 0
    v_mov_b32 v29, 0
    v_mov_b32 v30, 0
    v_mov_b32 v31, 0
    v_bitop3_b32 v32, v13, s96, -9 bitop3:0x28
    v_bitop3_b32 v36, v13, s97, -9 bitop3:0x28
    v_bitop3_b32 v40, v13, s98, -9 bitop3:0x28
    s_mov_b64 vcc, 0
    s_branch L_fast_rejoin
L_fast_done:
    s_branch L_end
L_slow_start:
    s_mov_b32 s22, 0
    s_mov_b32 s23, 0x1000000
    s_mov_b32 s27, 0
    s_mov_b32 s31, 0x80000
    s_mov_b32 s61, 0x40000000
    s_mov_b32 s96, 0x800
    s_mov_b32 s97, 0x1000
    s_mov_b32 s98, 0x1800
    s_mov_b32 s92, 0xcccccccc
    s_mov_b32 s93, 0xcccccccc
    s_mov_b32 s91, 0
    ds_read_b128 v[104:107], v4 offset:0
    ds_read_b128 v[108:111], v4 offset:1024
    ds_read_b128 v[112:115], v4 offset:2048
    ds_read_b128 v[116:119], v4 offset:3072
    ds_read_b128 v[88:91], v4 offset:4096
    ds_read_b128 v[92:95], v4 offset:5120
    ds_read_b128 v[96:99], v4 offset:6144
    ds_read_b128 v[100:103], v4 offset:7168
    ds_read_b128 v[72:75], v4 offset:8192
    ds_read_b128 v[76:79], v4 offset:9216
    ds_read_b128 v[80:83], v4 offset:10240
    ds_read_b128 v[84:87], v4 offset:11264
    v_mov_b64 v[48:49], 0
    v_mov_b64 v[50:51], 0
    v_mov_b64 v[52:53], 0
    v_mov_b64 v[54:55], 0
    v_mov_b64 v[56:57], 0
    v_mov_b64 v[58:59], 0
    v_mov_b64 v[60:61], 0
    v_mov_b64 v[62:63], 0
    v_mov_b64 v[64:65], 0
    v_mov_b64 v[66:67], 0
    v_mov_b64 v[68:69], 0
    v_mov_b64 v[70:71], 0
    s_add_u32 s7, s23, 0x80000
    buffer_load_dwordx4 v[16:19], v2, s[8:11], s7 offen sc1
    buffer_load_dwordx4 v[20:23], v2, s[8:11], s7 offen offset:1024 sc1
    s_waitcnt vmcnt(2)
L_slow_step:
    v_readlane_b32 s36, v15, 33
    s_add_u32 s24, s23, 0x82100
    s_cmp_eq_u32 s36, 0
    s_cbranch_scc1 L_slow_refresh
L_slow_fresh:
    s_add_u32 s29, s23, s25
    s_add_u32 s30, s23, s39
    s_xor_b32 s28, s27, 1
    s_add_u32 s90, s22, 1
    s_nop 15
L_slow_retrym:
    buffer_load_dwordx4 v[16:19], v2, s[8:11], s7 offen sc1
    buffer_load_dwordx4 v[20:23], v2, s[8:11], s7 offen offset:1024 sc1
L_slow_prem:
    s_add_u32 s32, s32, 1
    s_cmp_gt_u32 s32, 200000
    s_cselect_b32 s94, -1, -2
    v_xor_b32 v28, 0x800, v2
    v_xor_b32 v44, 0x1800, v2
    v_mov_b64 v[48:49], 0
    v_mov_b64 v[50:51], 0
    v_mov_b64 v[52:53], 0
    v_mov_b64 v[54:55], 0
L_slow_waitm:
    s_waitcnt vmcnt(3) lgkmcnt(0)
L_slow_gotm:
    v_max3_u32 v14, v16, v17, v18
    v_max_u32 v14, v14, v19
    v_smfmac_f32_16x16x64_bf16 v[48:51], v[16:19], v[104:111], v1
    s_waitcnt vmcnt(2)
    v_max3_u32 v14, v14, v20, v21
    v_smfmac_f32_16x16x64_bf16 v[52:55], v[16:19], v[112:119], v1
    v_max3_u32 v14, v14, v22, v23
    v_cmp_lt_u32 vcc, s94, v14
    v_smfmac_f32_16x16x64_bf16 v[48:51], v[20:23], v[88:95], v1
    ds_write_b128 v2, v[16:19] offset:0
    s_cbranch_vccnz L_slow_retrym
    v_smfmac_f32_16x16x64_bf16 v[52:55], v[20:23], v[96:103], v1
    ds_write_b128 v2, v[20:23] offset:1024
    v_smfmac_f32_16x16x64_bf16 v[56:59], v[16:19], v[72:79], v1
    buffer_load_dwordx4 v[104:107], v3, s[8:11], s29 offen offset:0 sc1
    buffer_load_dwordx4 v[120:123], v3, s[8:11], s30 offen offset:0 sc1
    v_smfmac_f32_16x16x64_bf16 v[60:63], v[16:19], v[80:87], v1
    buffer_load_dwordx4 v[108:111], v3, s[8:11], s29 offen offset:1024 sc1
    buffer_load_dwordx4 v[124:127], v3, s[8:11], s30 offen offset:1024 sc1
    v_smfmac_f32_16x16x64_bf16 v[56:59], v[20:23], a[80:87], v1
    buffer_load_dwordx4 v[112:115], v3, s[8:11], s29 offen offset:2048 sc1
    buffer_load_dwordx4 v[116:119], v3, s[8:11], s29 offen offset:3072 sc1
    v_smfmac_f32_16x16x64_bf16 v[60:63], v[20:23], a[88:95], v1
    s_waitcnt lgkmcnt(0)
    s_barrier
    ds_read_b128 v[24:27], v28 offset:0
    v_smfmac_f32_16x16x64_bf16 v[64:67], v[16:19], a[160:167], v1
    ds_read_b128 v[28:31], v28 offset:1024
    v_smfmac_f32_16x16x64_bf16 v[68:71], v[16:19], a[168:175], v1
    buffer_load_dword v15, v0, s[8:11], s24 offen sc1
    v_smfmac_f32_16x16x64_bf16 v[64:67], v[20:23], a[176:183], v1
    ds_read_b128 v[32:35], v8 offset:0
    v_smfmac_f32_16x16x64_bf16 v[68:71], v[20:23], a[184:191], v1
    ds_read_b128 v[36:39], v8 offset:1024
    s_waitcnt lgkmcnt(3)
    v_smfmac_f32_16x16x64_bf16 v[48:51], v[24:27], a[0:7], v1
    ds_read_b128 v[40:43], v44 offset:0
    v_smfmac_f32_16x16x64_bf16 v[52:55], v[24:27], a[8:15], v1
    ds_read_b128 v[44:47], v44 offset:1024
    s_waitcnt lgkmcnt(4)
    v_smfmac_f32_16x16x64_bf16 v[48:51], v[28:31], a[16:23], v1
    ds_read_b128 v[88:91], v4 offset:12288
    v_smfmac_f32_16x16x64_bf16 v[52:55], v[28:31], a[24:31], v1
    ds_read_b128 v[92:95], v4 offset:13312
    s_waitcnt lgkmcnt(4)
    v_smfmac_f32_16x16x64_bf16 v[48:51], v[32:35], a[32:39], v1
    ds_read_b128 v[96:99], v4 offset:14336
    v_smfmac_f32_16x16x64_bf16 v[52:55], v[32:35], a[40:47], v1
    ds_read_b128 v[100:103], v4 offset:15360
    s_waitcnt lgkmcnt(4)
    v_smfmac_f32_16x16x64_bf16 v[48:51], v[36:39], a[48:55], v1
    v_smfmac_f32_16x16x64_bf16 v[52:55], v[36:39], a[56:63], v1
    ds_read_b128 v[72:75], v4 offset:16384
    v_smfmac_f32_16x16x64_bf16 v[48:51], v[40:43], a[64:71], v1
    v_smfmac_f32_16x16x64_bf16 v[52:55], v[40:43], a[72:79], v1
    ds_read_b128 v[76:79], v4 offset:17408
    s_waitcnt lgkmcnt(2)
    v_smfmac_f32_16x16x64_bf16 v[48:51], v[44:47], v[88:95], v1
    ds_read_b128 v[80:83], v4 offset:18432
    v_smfmac_f32_16x16x64_bf16 v[52:55], v[44:47], v[96:103], v1
    ds_read_b128 v[84:87], v4 offset:19456
    v_smfmac_f32_16x16x64_bf16 v[56:59], v[28:31], a[96:103], v1
    ds_read_b128 v[88:91], v4 offset:20480
    v_smfmac_f32_16x16x64_bf16 v[60:63], v[28:31], a[104:111], v1
    ds_read_b128 v[92:95], v4 offset:21504
    v_smfmac_f32_16x16x64_bf16 v[56:59], v[32:35], a[112:119], v1
    ds_read_b128 v[96:99], v4 offset:22528
    v_add_f32 v48, v48, v50
    v_add_f32 v49, v49, v51
    v_smfmac_f32_16x16x64_bf16 v[60:63], v[32:35], a[120:127], v1
    ds_read_b128 v[100:103], v4 offset:23552
    v_add_f32 v52, v52, v54
    v_add_f32 v53, v53, v55
    v_smfmac_f32_16x16x64_bf16 v[56:59], v[36:39], a[128:135], v1
    s_waitcnt lgkmcnt(4)
    v_cvt_pk_bf16_f32 v50, v48, v52
    v_cvt_pk_bf16_f32 v51, v49, v53
    v_smfmac_f32_16x16x64_bf16 v[56:59], v[24:27], v[72:79], v1
    ds_write2_b32 v5, v50, v51 offset0:0 offset1:72
    v_smfmac_f32_16x16x64_bf16 v[60:63], v[24:27], v[80:87], v1
    v_smfmac_f32_16x16x64_bf16 v[60:63], v[36:39], a[136:143], v1
    v_smfmac_f32_16x16x64_bf16 v[56:59], v[40:43], a[144:151], v1
    buffer_store_dword v12, v10, s[8:11], s31 offen sc1
    v_smfmac_f32_16x16x64_bf16 v[60:63], v[40:43], a[152:159], v1
    s_waitcnt lgkmcnt(0)
    s_barrier
    v_smfmac_f32_16x16x64_bf16 v[56:59], v[44:47], v[88:95], v1
    ds_read_b128 v[72:75], v6 offset:0
    v_smfmac_f32_16x16x64_bf16 v[60:63], v[44:47], v[96:103], v1
    ds_read_b128 v[76:79], v6 offset:64
    v_smfmac_f32_16x16x64_bf16 v[64:67], v[24:27], a[192:199], v1
    ds_read_b128 v[80:83], v6 offset:128
    v_smfmac_f32_16x16x64_bf16 v[68:71], v[24:27], a[200:207], v1
    ds_read_b128 v[84:87], v6 offset:192
    s_waitcnt vmcnt(2) lgkmcnt(3)
    v_mfma_f32_16x16x32_bf16 v[48:51], v[104:107], v[72:75], 0
    s_waitcnt lgkmcnt(2)
    v_add_f32 v56, v56, v58
    v_add_f32 v57, v57, v59
    v_mfma_f32_16x16x32_bf16 v[48:51], v[108:111], v[76:79], v[48:51]
    s_waitcnt lgkmcnt(1)
    v_add_f32 v60, v60, v62
    v_add_f32 v61, v61, v63
    v_mfma_f32_16x16x32_bf16 v[48:51], v[112:115], v[80:83], v[48:51]
    s_waitcnt lgkmcnt(0)
    v_cvt_pk_bf16_f32 v58, v56, v60
    v_cvt_pk_bf16_f32 v59, v57, v61
    v_mfma_f32_16x16x32_bf16 v[48:51], v[116:119], v[84:87], v[48:51]
    ds_write2_b32 v7, v58, v59 offset0:0 offset1:72
    v_smfmac_f32_16x16x64_bf16 v[64:67], v[28:31], a[208:215], v1
    v_mov_b64 v[104:105], s[4:5]
    v_smfmac_f32_16x16x64_bf16 v[68:71], v[28:31], a[216:223], v1
    s_nop 1
    v_mov_b64 v[106:107], s[4:5]
    v_smfmac_f32_16x16x64_bf16 v[64:67], v[32:35], a[224:231], v1
    v_exp_f32 v48, v48
    v_smfmac_f32_16x16x64_bf16 v[68:71], v[32:35], a[232:239], v1
    s_waitcnt lgkmcnt(0)
    s_barrier
    v_exp_f32 v49, v49
    v_smfmac_f32_16x16x64_bf16 v[64:67], v[36:39], a[240:247], v1
    ds_read_b128 v[88:91], v6 offset:2304
    v_exp_f32 v50, v50
    v_smfmac_f32_16x16x64_bf16 v[68:71], v[36:39], a[248:255], v1
    ds_read_b128 v[92:95], v6 offset:2368
    v_exp_f32 v51, v51
    v_smfmac_f32_16x16x64_bf16 v[64:67], v[40:43], v[128:135], v1
    ds_read_b128 v[96:99], v6 offset:2432
    v_cvt_pk_bf16_f32 v108, v48, v49
    v_cvt_pk_bf16_f32 v109, v50, v51
    v_smfmac_f32_16x16x64_bf16 v[68:71], v[40:43], v[136:143], v1
    ds_read_b128 v[100:103], v6 offset:2496
    ds_write_b64 v2, v[108:109] offset:8192
    s_waitcnt lgkmcnt(4)
    v_mfma_f32_16x16x32_bf16 v[52:55], v[88:91], v[72:75], 0
    s_waitcnt lgkmcnt(3)
    v_mov_b32 v113, 0
    v_mov_b32 v115, 0
    v_mfma_f32_16x16x32_bf16 v[52:55], v[92:95], v[76:79], v[52:55]
    s_waitcnt lgkmcnt(2)
    v_mov_b32 v117, 0
    v_mov_b64 v[16:17], 0
    v_mfma_f32_16x16x32_bf16 v[52:55], v[96:99], v[80:83], v[52:55]
    s_waitcnt lgkmcnt(1)
    v_mov_b64 v[18:19], 0
    v_mov_b64 v[20:21], 0
    v_mfma_f32_16x16x32_bf16 v[52:55], v[100:103], v[84:87], v[52:55]
    s_waitcnt lgkmcnt(0)
    s_barrier
    v_smfmac_f32_16x16x64_bf16 v[64:67], v[44:47], v[144:151], v1
    ds_read_b64 v[110:111], v8 offset:8192
    v_mov_b64 v[22:23], 0
    v_smfmac_f32_16x16x64_bf16 v[68:71], v[44:47], v[152:159], v1
    v_mov_b64 v[24:25], 0
    v_mov_b64 v[26:27], 0
    v_mul_f32 v52, s33, v52
    v_mul_f32 v53, s33, v53
    v_exp_f32 v52, v52
    s_waitcnt lgkmcnt(0)
    v_mfma_f32_16x16x32_bf16 v[48:51], v[104:107], v[108:111], 0
    v_exp_f32 v53, v53
    v_add_f32 v64, v64, v66
    v_mfma_f32_16x16x32_bf16 v[56:59], v[120:123], v[108:111], 0
    v_cvt_pk_bf16_f32 v112, v52, v53
    v_add_f32 v65, v65, v67
    v_mfma_f32_16x16x32_bf16 v[60:63], v[124:127], v[108:111], 0
    v_cvt_pk_bf16_f32 v114, v64, v65
    v_add_f32 v68, v68, v70
    v_mfma_f32_16x16x16_bf16 v[48:51], v[104:105], v[112:113], v[48:51]
    v_add_f32 v69, v69, v71
    v_cvt_pk_bf16_f32 v116, v68, v69
    v_mfma_f32_16x16x16_bf16 v[56:59], v[114:115], v[112:113], v[56:59]
    v_mov_b64 v[28:29], 0
    v_mov_b64 v[30:31], 0
    v_mfma_f32_16x16x16_bf16 v[60:63], v[116:117], v[112:113], v[60:63]
    v_bitop3_b32 v32, v13, s96, -9 bitop3:0x28
    v_bitop3_b32 v36, v13, s97, -9 bitop3:0x28
    v_rcp_f32 v118, v48
    v_bitop3_b32 v40, v13, s98, -9 bitop3:0x28
    v_max_f32 v14, v118, v48
    v_cmp_nge_f32 vcc, s40, v14
    v_pk_mul_f32 v[56:57], v[56:57], v[118:119] op_sel_hi:[1,0]
    v_pk_mul_f32 v[58:59], v[58:59], v[118:119] op_sel_hi:[1,0]
    v_pk_mul_f32 v[60:61], v[60:61], v[118:119] op_sel_hi:[1,0]
    v_pk_mul_f32 v[62:63], v[62:63], v[118:119] op_sel_hi:[1,0]
    v_cvt_pk_bf16_f32 v52, v56, v60
    v_cvt_pk_bf16_f32 v54, v58, v62
    v_cvt_pk_bf16_f32 v53, v57, v61
    v_cvt_pk_bf16_f32 v55, v59, v63
L_slow_rejoin:
    v_cndmask_b32 v50, v52, v54, s[92:93]
    v_cndmask_b32 v51, v53, v55, s[92:93]
    ds_write_b64 v13, v[50:51] offset:9216
    v_smfmac_f32_16x16x64_bf16 v[16:19], v[52:55], v[160:167], v1
    v_smfmac_f32_16x16x64_bf16 v[20:23], v[52:55], v[168:175], v1
    s_waitcnt lgkmcnt(0)
    s_barrier
    ds_read_b128 v[32:35], v32 offset:9216
    ds_read_b128 v[36:39], v36 offset:9216
    v_smfmac_f32_16x16x64_bf16 v[24:27], v[52:55], v[176:183], v1
    ds_read_b128 v[40:43], v40 offset:9216
    v_smfmac_f32_16x16x64_bf16 v[28:31], v[52:55], v[184:191], v1
    ds_read_b128 v[88:91], v4 offset:24576
    ds_read_b128 v[92:95], v4 offset:25600
    s_waitcnt lgkmcnt(4)
    v_smfmac_f32_16x16x64_bf16 v[16:19], v[32:35], v[192:199], v1
    ds_read_b128 v[96:99], v4 offset:26624
    s_waitcnt lgkmcnt(4)
    v_smfmac_f32_16x16x64_bf16 v[16:19], v[36:39], v[216:223], v1
    ds_read_b128 v[100:103], v4 offset:27648
    s_waitcnt lgkmcnt(4)
    v_smfmac_f32_16x16x64_bf16 v[16:19], v[40:43], v[240:247], v1
    ds_read_b128 v[72:75], v4 offset:28672
    s_cmp_lg_u64 vcc, 0
    v_smfmac_f32_16x16x64_bf16 v[20:23], v[32:35], v[200:207], v1
    ds_read_b128 v[76:79], v4 offset:29696
    s_cselect_b32 s60, s28, s27
    v_smfmac_f32_16x16x64_bf16 v[20:23], v[36:39], v[224:231], v1
    ds_read_b128 v[80:83], v4 offset:30720
    s_nop 0
    v_cvt_pk_bf16_f32 v56, v16, v18
    v_smfmac_f32_16x16x64_bf16 v[20:23], v[40:43], v[248:255], v1
    ds_read_b128 v[84:87], v4 offset:31744
    v_cvt_pk_bf16_f32 v57, v17, v19
    v_and_or_b32 v56, v56, -2, s60
    v_smfmac_f32_16x16x64_bf16 v[24:27], v[32:35], v[208:215], v1
    buffer_store_dwordx2 v[56:57], v9, s[8:11], 0 offen offset:0 sc1
    v_smfmac_f32_16x16x64_bf16 v[24:27], v[36:39], v[232:239], v1
    s_waitcnt lgkmcnt(4)
    s_nop 0
    v_cvt_pk_bf16_f32 v58, v20, v22
    v_smfmac_f32_16x16x64_bf16 v[24:27], v[40:43], v[88:95], v1
    ds_read_b128 v[64:67], v3 offset:23040
    v_cvt_pk_bf16_f32 v59, v21, v23
    v_and_or_b32 v58, v58, -2, s60
    v_smfmac_f32_16x16x64_bf16 v[28:31], v[32:35], v[96:103], v1
    buffer_store_dwordx2 v[58:59], v9, s[8:11], 0 offen offset:2048 sc1
    s_waitcnt lgkmcnt(1)
    v_smfmac_f32_16x16x64_bf16 v[28:31], v[36:39], v[72:79], v1
    s_nop 1
    v_cvt_pk_bf16_f32 v60, v24, v26
    v_smfmac_f32_16x16x64_bf16 v[28:31], v[40:43], v[80:87], v1
    s_nop 2
    v_cvt_pk_bf16_f32 v61, v25, v27
    v_and_or_b32 v60, v60, -2, s60
    buffer_store_dwordx2 v[60:61], v9, s[8:11], s26 offen offset:0 sc1
    s_nop 1
    v_cvt_pk_bf16_f32 v62, v28, v30
    v_cvt_pk_bf16_f32 v63, v29, v31
    v_and_or_b32 v62, v62, -2, s60
    buffer_store_dwordx2 v[62:63], v9, s[8:11], s26 offen offset:2048 sc1
L_slow_stored:
    s_cmp_lg_u32 s60, s27
    s_cbranch_scc1 L_slow_safe
    ds_read_b128 v[104:107], v4 offset:0
    ds_read_b128 v[108:111], v4 offset:1024
    ds_read_b128 v[112:115], v4 offset:2048
    ds_read_b128 v[116:119], v4 offset:3072
    ds_read_b128 v[88:91], v4 offset:4096
    ds_read_b128 v[92:95], v4 offset:5120
    ds_read_b128 v[96:99], v4 offset:6144
    ds_read_b128 v[100:103], v4 offset:7168
    ds_read_b128 v[72:75], v4 offset:8192
    ds_read_b128 v[76:79], v4 offset:9216
    ds_read_b128 v[80:83], v4 offset:10240
    ds_read_b128 v[84:87], v4 offset:11264
    s_cmp_lt_u32 s21, 1
    s_cbranch_scc1 L_slow_pollp
    s_nop 11
    s_cmp_lt_u32 s21, 2
    s_cbranch_scc1 L_slow_pollp
    s_nop 11
    s_cmp_lt_u32 s21, 3
    s_cbranch_scc1 L_slow_pollp
    s_nop 11
L_slow_pollp:
    buffer_load_dwordx4 v[120:123], v2, s[8:11], s6 offen sc1
    buffer_load_dwordx4 v[124:127], v2, s[8:11], s6 offen offset:1024 sc1
    v_mov_b64 v[56:57], 0
    v_mov_b64 v[58:59], 0
    v_mov_b64 v[60:61], 0
    v_mov_b64 v[62:63], 0
    s_nop 15
    s_nop 15
    buffer_load_dwordx4 v[32:35], v2, s[8:11], s6 offen sc1
    buffer_load_dwordx4 v[36:39], v2, s[8:11], s6 offen offset:1024 sc1
L_slow_prep:
    s_add_u32 s7, s24, 0x80000
    s_waitcnt vmcnt(3) lgkmcnt(0)
    v_mfma_f32_16x16x32_bf16 v[68:71], v[64:67], v[120:123], 0
    v_bitop3_b32 v14, v120, v122, s27 bitop3:0x7e
    s_waitcnt vmcnt(2)
    v_mfma_f32_16x16x32_bf16 v[68:71], v[64:67], v[124:127], v[68:71]
    v_bitop3_b32 v11, v124, v126, s27 bitop3:0x7e
    v_bitop3_b32 v14, v14, v11, 1 bitop3:0xa8
    v_cmp_ne_u32 vcc, 0, v14
    s_nop 2
    s_cmp_eq_u64 vcc, 0
    s_cselect_b32 s36, s24, s61
    v_add_f32_dpp v68, v68, v68 row_ror:8 row_mask:0xf bank_mask:0xf
    v_add_f32_dpp v69, v69, v69 row_ror:8 row_mask:0xf bank_mask:0xf
    s_nop 0
    v_add_f32_dpp v68, v68, v68 row_ror:4 row_mask:0xf bank_mask:0xf
    v_add_f32_dpp v69, v69, v69 row_ror:4 row_mask:0xf bank_mask:0xf
    v_cvt_pk_bf16_f32 v12, v68, v69
    buffer_store_dword v12, v10, s[8:11], s36 offen sc1
    s_cbranch_scc1 L_slow_gotp
L_slow_retryp:
    buffer_load_dwordx4 v[120:123], v2, s[8:11], s6 offen sc1
    buffer_load_dwordx4 v[124:127], v2, s[8:11], s6 offen offset:1024 sc1
    s_waitcnt vmcnt(4) lgkmcnt(0)
    v_mfma_f32_16x16x32_bf16 v[68:71], v[64:67], v[32:35], 0
    v_bitop3_b32 v14, v32, v34, s27 bitop3:0x7e
    s_waitcnt vmcnt(3)
    v_mfma_f32_16x16x32_bf16 v[68:71], v[64:67], v[36:39], v[68:71]
    v_bitop3_b32 v11, v36, v38, s27 bitop3:0x7e
    v_bitop3_b32 v14, v14, v11, 1 bitop3:0xa8
    v_cmp_ne_u32 vcc, 0, v14
    s_nop 2
    s_cmp_eq_u64 vcc, 0
    s_cselect_b32 s36, s24, s61
    v_add_f32_dpp v68, v68, v68 row_ror:8 row_mask:0xf bank_mask:0xf
    v_add_f32_dpp v69, v69, v69 row_ror:8 row_mask:0xf bank_mask:0xf
    s_nop 0
    v_add_f32_dpp v68, v68, v68 row_ror:4 row_mask:0xf bank_mask:0xf
    v_add_f32_dpp v69, v69, v69 row_ror:4 row_mask:0xf bank_mask:0xf
    v_cvt_pk_bf16_f32 v12, v68, v69
    buffer_store_dword v12, v10, s[8:11], s36 offen sc1
    s_cbranch_scc1 L_slow_gotp
    buffer_load_dwordx4 v[32:35], v2, s[8:11], s6 offen sc1
    buffer_load_dwordx4 v[36:39], v2, s[8:11], s6 offen offset:1024 sc1
    s_waitcnt vmcnt(4) lgkmcnt(0)
    v_mfma_f32_16x16x32_bf16 v[68:71], v[64:67], v[120:123], 0
    v_bitop3_b32 v14, v120, v122, s27 bitop3:0x7e
    s_waitcnt vmcnt(3)
    v_mfma_f32_16x16x32_bf16 v[68:71], v[64:67], v[124:127], v[68:71]
    v_bitop3_b32 v11, v124, v126, s27 bitop3:0x7e
    v_bitop3_b32 v14, v14, v11, 1 bitop3:0xa8
    v_cmp_ne_u32 vcc, 0, v14
    s_nop 2
    s_cmp_eq_u64 vcc, 0
    s_cselect_b32 s36, s24, s61
    v_add_f32_dpp v68, v68, v68 row_ror:8 row_mask:0xf bank_mask:0xf
    v_add_f32_dpp v69, v69, v69 row_ror:8 row_mask:0xf bank_mask:0xf
    s_nop 0
    v_add_f32_dpp v68, v68, v68 row_ror:4 row_mask:0xf bank_mask:0xf
    v_add_f32_dpp v69, v69, v69 row_ror:4 row_mask:0xf bank_mask:0xf
    v_cvt_pk_bf16_f32 v12, v68, v69
    buffer_store_dword v12, v10, s[8:11], s36 offen sc1
    s_cbranch_scc1 L_slow_gotp
    s_add_u32 s32, s32, 1
    s_cmp_le_u32 s32, 200000
    s_cbranch_scc1 L_slow_retryp
    s_mov_b32 s36, s24
    buffer_store_dword v12, v10, s[8:11], s36 offen sc1
L_slow_gotp:
    s_add_u32 s31, s31, 0x2000
    s_cmp_ge_u32 s90, 63
    s_cbranch_scc1 L_slow_last
    s_mov_b32 s23, s24
    s_mov_b32 s22, s90
    s_mov_b32 s27, s28
    v_mov_b64 v[64:65], 0
    v_mov_b64 v[66:67], 0
    v_mov_b64 v[68:69], 0
    v_mov_b64 v[70:71], 0
    s_nop 15
    s_nop 11
    buffer_load_dwordx4 v[16:19], v2, s[8:11], s7 offen sc1
    buffer_load_dwordx4 v[20:23], v2, s[8:11], s7 offen offset:1024 sc1
    s_branch L_slow_step
L_slow_last:
    buffer_store_dword v12, v10, s[8:11], s31 offen sc1
    s_branch L_slow_done
L_slow_refresh:
    buffer_load_dword v15, v0, s[8:11], s23 offen sc1
    s_add_u32 s32, s32, 1
    s_cmp_le_u32 s32, 200000
    s_waitcnt vmcnt(0)
    s_cbranch_scc1 L_slow_step
    s_branch L_slow_fresh
L_slow_safe:
    s_nop 11
    s_waitcnt vmcnt(0) lgkmcnt(0)
    s_barrier
    ds_read_b128 v[72:75], v6 offset:0
    ds_read_b128 v[88:91], v6 offset:2304
    ds_read_b128 v[76:79], v6 offset:64
    ds_read_b128 v[92:95], v6 offset:2368
    ds_read_b128 v[80:83], v6 offset:128
    ds_read_b128 v[96:99], v6 offset:2432
    ds_read_b128 v[84:87], v6 offset:192
    ds_read_b128 v[100:103], v6 offset:2496
    s_xor_b32 s36, s25, 0x1000
    s_add_u32 s36, s36, s23
    buffer_load_dwordx4 v[16:19], v3, s[8:11], s29 offen offset:0 sc1
    buffer_load_dwordx4 v[32:35], v3, s[8:11], s36 offen offset:0 sc1
    buffer_load_dwordx4 v[20:23], v3, s[8:11], s29 offen offset:1024 sc1
    buffer_load_dwordx4 v[36:39], v3, s[8:11], s36 offen offset:1024 sc1
    buffer_load_dwordx4 v[24:27], v3, s[8:11], s29 offen offset:2048 sc1
    buffer_load_dwordx4 v[40:43], v3, s[8:11], s36 offen offset:2048 sc1
    buffer_load_dwordx4 v[28:31], v3, s[8:11], s29 offen offset:3072 sc1
    buffer_load_dwordx4 v[44:47], v3, s[8:11], s36 offen offset:3072 sc1
    s_waitcnt vmcnt(0) lgkmcnt(0)
    v_mfma_f32_16x16x32_bf16 v[48:51], v[16:19], v[72:75], 0
    v_mfma_f32_16x16x32_bf16 v[48:51], v[20:23], v[76:79], v[48:51]
    v_mfma_f32_16x16x32_bf16 v[48:51], v[24:27], v[80:83], v[48:51]
    v_mfma_f32_16x16x32_bf16 v[48:51], v[28:31], v[84:87], v[48:51]
    v_mfma_f32_16x16x32_bf16 v[52:55], v[32:35], v[72:75], 0
    v_mfma_f32_16x16x32_bf16 v[52:55], v[36:39], v[76:79], v[52:55]
    v_mfma_f32_16x16x32_bf16 v[52:55], v[40:43], v[80:83], v[52:55]
    v_mfma_f32_16x16x32_bf16 v[52:55], v[44:47], v[84:87], v[52:55]
    v_mfma_f32_16x16x32_bf16 v[56:59], v[88:91], v[72:75], 0
    v_mfma_f32_16x16x32_bf16 v[56:59], v[92:95], v[76:79], v[56:59]
    v_mfma_f32_16x16x32_bf16 v[56:59], v[96:99], v[80:83], v[56:59]
    v_mfma_f32_16x16x32_bf16 v[56:59], v[100:103], v[84:87], v[56:59]
    s_nop 7
    v_mul_f32 v56, s33, v56
    v_mul_f32 v57, s33, v57
    v_max3_f32 v16, v48, v49, v50
    v_max3_f32 v16, v16, v51, v52
    v_max3_f32 v16, v16, v53, v54
    v_max3_f32 v16, v16, v55, v56
    v_max_f32 v16, v16, v57
    v_mov_b32 v17, v16
    s_nop 1
    v_permlane16_swap_b32 v16, v17
    v_max_f32 v16, v16, v17
    v_mov_b32 v17, v16
    s_nop 1
    v_permlane32_swap_b32 v16, v17
    v_max_f32 v16, v16, v17
    v_sub_f32 v48, v48, v16
    v_exp_f32 v48, v48
    v_sub_f32 v49, v49, v16
    v_exp_f32 v49, v49
    v_sub_f32 v50, v50, v16
    v_exp_f32 v50, v50
    v_sub_f32 v51, v51, v16
    v_exp_f32 v51, v51
    v_sub_f32 v52, v52, v16
    v_exp_f32 v52, v52
    v_sub_f32 v53, v53, v16
    v_exp_f32 v53, v53
    v_sub_f32 v54, v54, v16
    v_exp_f32 v54, v54
    v_sub_f32 v55, v55, v16
    v_exp_f32 v55, v55
    v_sub_f32 v56, v56, v16
    v_exp_f32 v56, v56
    v_sub_f32 v57, v57, v16
    v_exp_f32 v57, v57
    v_cvt_pk_bf16_f32 v108, v48, v49
    v_cvt_pk_bf16_f32 v109, v50, v51
    v_cvt_pk_bf16_f32 v110, v52, v53
    v_cvt_pk_bf16_f32 v111, v54, v55
    v_cvt_pk_bf16_f32 v112, v56, v57
    s_nop 0
    v_mfma_f32_16x16x32_bf16 v[48:51], v[104:107], v[108:111], 0
    v_mfma_f32_16x16x32_bf16 v[56:59], v[120:123], v[108:111], 0
    v_mfma_f32_16x16x32_bf16 v[60:63], v[124:127], v[108:111], 0
    s_nop 3
    v_mfma_f32_16x16x16_bf16 v[48:51], v[104:105], v[112:113], v[48:51]
    v_mfma_f32_16x16x16_bf16 v[56:59], v[114:115], v[112:113], v[56:59]
    v_mfma_f32_16x16x16_bf16 v[60:63], v[116:117], v[112:113], v[60:63]
    s_nop 5
    v_rcp_f32 v118, v48
    s_nop 0
    v_mul_f32 v56, v56, v118
    v_mul_f32 v57, v57, v118
    v_mul_f32 v58, v58, v118
    v_mul_f32 v59, v59, v118
    v_mul_f32 v60, v60, v118
    v_mul_f32 v61, v61, v118
    v_mul_f32 v62, v62, v118
    v_mul_f32 v63, v63, v118
    v_cvt_pk_bf16_f32 v52, v56, v60
    v_cvt_pk_bf16_f32 v53, v57, v61
    v_cvt_pk_bf16_f32 v54, v58, v62
    v_cvt_pk_bf16_f32 v55, v59, v63
    v_mov_b32 v16, 0
    v_mov_b32 v17, 0
    v_mov_b32 v18, 0
    v_mov_b32 v19, 0
    v_mov_b32 v20, 0
    v_mov_b32 v21, 0
    v_mov_b32 v22, 0
    v_mov_b32 v23, 0
    v_mov_b32 v24, 0
    v_mov_b32 v25, 0
    v_mov_b32 v26, 0
    v_mov_b32 v27, 0
    v_mov_b32 v28, 0
    v_mov_b32 v29, 0
    v_mov_b32 v30, 0
    v_mov_b32 v31, 0
    v_bitop3_b32 v32, v13, s96, -9 bitop3:0x28
    v_bitop3_b32 v36, v13, s97, -9 bitop3:0x28
    v_bitop3_b32 v40, v13, s98, -9 bitop3:0x28
    s_mov_b64 vcc, 0
    s_branch L_slow_rejoin
L_slow_done:
    s_branch L_end
L_worker:
    s_cmp_eq_u32 s3, 7
    s_cbranch_scc1 L_mlp
    s_and_b32 s36, s2, 7
    s_sub_u32 s36, s36, 1
    s_lshl_b32 s36, s36, 5
    s_lshr_b32 s37, s2, 3
    s_add_u32 s36, s36, s37
    s_mul_i32 s20, s36, 10923
    s_lshr_b32 s20, s20, 16
    s_mul_i32 s37, s20, 6
    s_sub_u32 s22, s36, s37
    v_lshrrev_b32 v28, 4, v0
    v_and_b32 v16, 15, v0
    v_lshlrev_b32 v16, 4, v16
    v_lshl_add_u32 v16, v28, 13, v16
    v_bfe_u32 v29, v0, 4, 2
    v_lshlrev_b32 v29, 5, v29
    v_xor_b32 v16, v16, v29
    v_and_b32 v29, 128, v0
    v_xor_b32 v16, v16, v29
    s_lshl_b32 s28, s21, 10
    s_lshl_b32 s3, s20, 8
    s_mov_b32 s76, s52
    s_and_b32 s77, s53, 0xffff
    s_mov_b32 s78, 0x400000
    s_mov_b32 s79, 0x20000
    s_add_u32 m0, s28, 32768
    s_add_u32 s37, s3, 0x0
    buffer_load_dwordx4 v16, s[76:79], s37 offen lds
    s_add_u32 m0, s28, 36864
    s_add_u32 s37, s3, 0x20000
    buffer_load_dwordx4 v16, s[76:79], s37 offen lds
    s_add_u32 m0, s28, 65536
    s_add_u32 s37, s3, 0x40000
    buffer_load_dwordx4 v16, s[76:79], s37 offen lds
    s_add_u32 m0, s28, 69632
    s_add_u32 s37, s3, 0x60000
    buffer_load_dwordx4 v16, s[76:79], s37 offen lds
    s_add_u32 m0, s28, 98304
    s_add_u32 s37, s3, 0x80000
    buffer_load_dwordx4 v16, s[76:79], s37 offen lds
    s_add_u32 m0, s28, 102400
    s_add_u32 s37, s3, 0xa0000
    buffer_load_dwordx4 v16, s[76:79], s37 offen lds
    s_add_u32 m0, s28, 131072
    s_add_u32 s37, s3, 0xc0000
    buffer_load_dwordx4 v16, s[76:79], s37 offen lds
    s_add_u32 m0, s28, 135168
    s_add_u32 s37, s3, 0xe0000
    buffer_load_dwordx4 v16, s[76:79], s37 offen lds
    s_add_u32 m0, s28, 40960
    s_add_u32 s37, s3, 0x100000
    buffer_load_dwordx4 v16, s[76:79], s37 offen lds
    s_add_u32 m0, s28, 45056
    s_add_u32 s37, s3, 0x120000
    buffer_load_dwordx4 v16, s[76:79], s37 offen lds
    s_add_u32 m0, s28, 73728
    s_add_u32 s37, s3, 0x140000
    buffer_load_dwordx4 v16, s[76:79], s37 offen lds
    s_add_u32 m0, s28, 77824
    s_add_u32 s37, s3, 0x160000
    buffer_load_dwordx4 v16, s[76:79], s37 offen lds
    s_add_u32 m0, s28, 106496
    s_add_u32 s37, s3, 0x180000
    buffer_load_dwordx4 v16, s[76:79], s37 offen lds
    s_add_u32 m0, s28, 110592
    s_add_u32 s37, s3, 0x1a0000
    buffer_load_dwordx4 v16, s[76:79], s37 offen lds
    s_add_u32 m0, s28, 139264
    s_add_u32 s37, s3, 0x1c0000
    buffer_load_dwordx4 v16, s[76:79], s37 offen lds
    s_add_u32 m0, s28, 143360
    s_add_u32 s37, s3, 0x1e0000
    buffer_load_dwordx4 v16, s[76:79], s37 offen lds
    s_add_u32 m0, s28, 49152
    s_add_u32 s37, s3, 0x200000
    buffer_load_dwordx4 v16, s[76:79], s37 offen lds
    s_add_u32 m0, s28, 53248
    s_add_u32 s37, s3, 0x220000
    buffer_load_dwordx4 v16, s[76:79], s37 offen lds
    s_add_u32 m0, s28, 81920
    s_add_u32 s37, s3, 0x240000
    buffer_load_dwordx4 v16, s[76:79], s37 offen lds
    s_add_u32 m0, s28, 86016
    s_add_u32 s37, s3, 0x260000
    buffer_load_dwordx4 v16, s[76:79], s37 offen lds
    s_add_u32 m0, s28, 114688
    s_add_u32 s37, s3, 0x280000
    buffer_load_dwordx4 v16, s[76:79], s37 offen lds
    s_add_u32 m0, s28, 118784
    s_add_u32 s37, s3, 0x2a0000
    buffer_load_dwordx4 v16, s[76:79], s37 offen lds
    s_add_u32 m0, s28, 147456
    s_add_u32 s37, s3, 0x2c0000
    buffer_load_dwordx4 v16, s[76:79], s37 offen lds
    s_add_u32 m0, s28, 151552
    s_add_u32 s37, s3, 0x2e0000
    buffer_load_dwordx4 v16, s[76:79], s37 offen lds
    s_add_u32 m0, s28, 57344
    s_add_u32 s37, s3, 0x300000
    buffer_load_dwordx4 v16, s[76:79], s37 offen lds
    s_add_u32 m0, s28, 61440
    s_add_u32 s37, s3, 0x320000
    buffer_load_dwordx4 v16, s[76:79], s37 offen lds
    s_add_u32 m0, s28, 90112
    s_add_u32 s37, s3, 0x340000
    buffer_load_dwordx4 v16, s[76:79], s37 offen lds
    s_add_u32 m0, s28, 94208
    s_add_u32 s37, s3, 0x360000
    buffer_load_dwordx4 v16, s[76:79], s37 offen lds
    s_add_u32 m0, s28, 122880
    s_add_u32 s37, s3, 0x380000
    buffer_load_dwordx4 v16, s[76:79], s37 offen lds
    s_add_u32 m0, s28, 126976
    s_add_u32 s37, s3, 0x3a0000
    buffer_load_dwordx4 v16, s[76:79], s37 offen lds
    s_add_u32 m0, s28, 155648
    s_add_u32 s37, s3, 0x3c0000
    buffer_load_dwordx4 v16, s[76:79], s37 offen lds
    s_add_u32 m0, s28, 159744
    s_add_u32 s37, s3, 0x3e0000
    buffer_load_dwordx4 v16, s[76:79], s37 offen lds
    v_mov_b32 v20, 0x0
    v_bfe_u32 v14, v0, 0, 1
    s_mov_b32 s38, 0x8
    v_mad_u32_u24 v20, v14, s38, v20
    v_bfe_u32 v14, v0, 1, 1
    s_mov_b32 s38, 0x10
    v_mad_u32_u24 v20, v14, s38, v20
    v_bfe_u32 v14, v0, 2, 1
    s_mov_b32 s38, 0x100
    v_mad_u32_u24 v20, v14, s38, v20
    v_bfe_u32 v14, v0, 3, 1
    s_mov_b32 s38, 0x200
    v_mad_u32_u24 v20, v14, s38, v20
    v_bfe_u32 v14, v0, 4, 1
    s_mov_b32 s38, 0x800
    v_mad_u32_u24 v20, v14, s38, v20
    v_bfe_u32 v14, v0, 5, 1
    s_mov_b32 s38, 0x1000
    v_mad_u32_u24 v20, v14, s38, v20
    v_mov_b32 v30, 0x0
    v_bfe_u32 v14, v0, 2, 1
    s_mov_b32 s38, 0x20
    v_mad_u32_u24 v30, v14, s38, v30
    v_bfe_u32 v14, v0, 3, 1
    s_mov_b32 s38, 0x40
    v_mad_u32_u24 v30, v14, s38, v30
    v_bfe_u32 v14, v0, 4, 1
    s_mov_b32 s38, 0x80
    v_mad_u32_u24 v30, v14, s38, v30
    v_mov_b32 v31, 0x0
    v_bfe_u32 v14, v0, 6, 1
    s_mov_b32 s38, 0x40
    v_mad_u32_u24 v31, v14, s38, v31
    v_bfe_u32 v14, v0, 7, 1
    s_mov_b32 s38, 0x80
    v_mad_u32_u24 v31, v14, s38, v31
    v_xor_b32 v30, v30, v31
    v_add_u32 v30, v30, v20
    v_add_u32 v20, 0x8000, v30
    v_xor_b32 v21, 32, v20
    v_add_u32 v22, 0x10000, v30
    v_xor_b32 v23, 32, v22
    v_add_u32 v24, 0x18000, v30
    v_xor_b32 v25, 32, v24
    v_add_u32 v26, 0x20000, v30
    v_xor_b32 v27, 32, v26
    s_mov_b32 s12, s54
    s_and_b32 s13, s55, 0xffff
    s_mov_b32 s14, 0x400000
    s_mov_b32 s15, 0x20000
    s_lshl_b32 s24, s20, 17
    s_and_b32 s25, s22, 3
    s_lshl_b32 s25, s25, 15
    s_add_u32 s24, s24, s25
    v_lshlrev_b32 v30, 7, v0
    buffer_load_dword v31, v30, s[12:15], s24 offen
    s_mov_b32 s12, s44
    s_and_b32 s13, s45, 0xffff
    s_mov_b32 s14, 0x200000
    s_mov_b32 s15, 0x20000
    s_mov_b32 s60, s82
    s_and_b32 s61, s83, 0xffff
    s_mov_b32 s62, 0x200000
    s_mov_b32 s63, 0x20000
    s_mov_b32 s92, s80
    s_and_b32 s93, s81, 0xffff
    s_mov_b32 s94, 0x400
    s_mov_b32 s95, 0x20000
    v_mov_b32 v1, 0x0
    v_bfe_u32 v14, v0, 0, 1
    s_mov_b32 s38, 0x10
    v_mad_u32_u24 v1, v14, s38, v1
    v_bfe_u32 v14, v0, 1, 1
    s_mov_b32 s38, 0x20
    v_mad_u32_u24 v1, v14, s38, v1
    v_bfe_u32 v14, v0, 2, 1
    s_mov_b32 s38, 0x40
    v_mad_u32_u24 v1, v14, s38, v1
    v_bfe_u32 v14, v0, 3, 1
    s_mov_b32 s38, 0x80
    v_mad_u32_u24 v1, v14, s38, v1
    v_bfe_u32 v14, v0, 4, 1
    s_mov_b32 s38, 0x100
    v_mad_u32_u24 v1, v14, s38, v1
    v_bfe_u32 v14, v0, 5, 1
    s_mov_b32 s38, 0x200
    v_mad_u32_u24 v1, v14, s38, v1
    v_mov_b32 v2, 0x0
    v_bfe_u32 v14, v0, 0, 1
    s_mov_b32 s38, 0x10
    v_mad_u32_u24 v2, v14, s38, v2
    v_bfe_u32 v14, v0, 1, 1
    s_mov_b32 s38, 0x20
    v_mad_u32_u24 v2, v14, s38, v2
    v_bfe_u32 v14, v0, 2, 1
    s_mov_b32 s38, 0x40
    v_mad_u32_u24 v2, v14, s38, v2
    v_bfe_u32 v14, v0, 3, 1
    s_mov_b32 s38, 0x80
    v_mad_u32_u24 v2, v14, s38, v2
    v_bfe_u32 v14, v0, 4, 1
    s_mov_b32 s38, 0x100
    v_mad_u32_u24 v2, v14, s38, v2
    v_bfe_u32 v14, v0, 5, 1
    s_mov_b32 s38, 0x200
    v_mad_u32_u24 v2, v14, s38, v2
    v_bfe_u32 v14, v0, 6, 1
    s_mov_b32 s38, 0x800
    v_mad_u32_u24 v2, v14, s38, v2
    v_bfe_u32 v14, v0, 7, 1
    s_mov_b32 s38, 0x1000
    v_mad_u32_u24 v2, v14, s38, v2
    v_mov_b32 v9, 0x0
    v_bfe_u32 v14, v0, 0, 1
    s_mov_b32 s38, 0x10
    v_mad_u32_u24 v9, v14, s38, v9
    v_bfe_u32 v14, v0, 1, 1
    s_mov_b32 s38, 0x20
    v_mad_u32_u24 v9, v14, s38, v9
    v_bfe_u32 v14, v0, 2, 1
    s_mov_b32 s38, 0x40
    v_mad_u32_u24 v9, v14, s38, v9
    v_bfe_u32 v14, v0, 3, 1
    s_mov_b32 s38, 0x80
    v_mad_u32_u24 v9, v14, s38, v9
    v_bfe_u32 v14, v0, 4, 1
    s_mov_b32 s38, 0x100
    v_mad_u32_u24 v9, v14, s38, v9
    v_bfe_u32 v14, v0, 5, 1
    s_mov_b32 s38, 0x200
    v_mad_u32_u24 v9, v14, s38, v9
    v_bfe_u32 v14, v0, 6, 1
    s_mov_b32 s38, 0x400
    v_mad_u32_u24 v9, v14, s38, v9
    v_bfe_u32 v14, v0, 7, 1
    s_mov_b32 s38, 0x800
    v_mad_u32_u24 v9, v14, s38, v9
    v_mov_b32 v7, 0x8000
    v_bfe_u32 v14, v0, 0, 1
    s_mov_b32 s38, 0x10
    v_mad_u32_u24 v7, v14, s38, v7
    v_bfe_u32 v14, v0, 1, 1
    s_mov_b32 s38, 0x20
    v_mad_u32_u24 v7, v14, s38, v7
    v_bfe_u32 v14, v0, 2, 1
    s_mov_b32 s38, 0x40
    v_mad_u32_u24 v7, v14, s38, v7
    v_bfe_u32 v14, v0, 3, 1
    s_mov_b32 s38, 0x80
    v_mad_u32_u24 v7, v14, s38, v7
    v_bfe_u32 v14, v0, 4, 1
    s_mov_b32 s38, 0x100
    v_mad_u32_u24 v7, v14, s38, v7
    v_bfe_u32 v14, v0, 5, 1
    s_mov_b32 s38, 0x200
    v_mad_u32_u24 v7, v14, s38, v7
    v_bfe_u32 v14, v0, 6, 1
    s_mov_b32 s38, 0x8000
    v_mad_u32_u24 v7, v14, s38, v7
    v_bfe_u32 v14, v0, 7, 1
    s_mov_b32 s38, 0x10000
    v_mad_u32_u24 v7, v14, s38, v7
    v_mov_b32 v3, 0x0
    v_bfe_u32 v14, v0, 0, 1
    s_mov_b32 s38, 0x10
    v_mad_u32_u24 v3, v14, s38, v3
    v_bfe_u32 v14, v0, 1, 1
    s_mov_b32 s38, 0x20
    v_mad_u32_u24 v3, v14, s38, v3
    v_bfe_u32 v14, v0, 2, 1
    s_mov_b32 s38, 0x40
    v_mad_u32_u24 v3, v14, s38, v3
    v_bfe_u32 v14, v0, 3, 1
    s_mov_b32 s38, 0x400
    v_mad_u32_u24 v3, v14, s38, v3
    v_bfe_u32 v14, v0, 4, 1
    s_mov_b32 s38, 0x800
    v_mad_u32_u24 v3, v14, s38, v3
    v_bfe_u32 v14, v0, 5, 1
    s_mov_b32 s38, 0x1000
    v_mad_u32_u24 v3, v14, s38, v3
    v_bfe_u32 v14, v0, 6, 1
    s_mov_b32 s38, 0x2000
    v_mad_u32_u24 v3, v14, s38, v3
    v_bfe_u32 v14, v0, 7, 1
    s_mov_b32 s38, 0x4000
    v_mad_u32_u24 v3, v14, s38, v3
    v_mov_b32 v4, 0x0
    v_bfe_u32 v14, v0, 0, 1
    s_mov_b32 s38, 0x100
    v_mad_u32_u24 v4, v14, s38, v4
    v_bfe_u32 v14, v0, 1, 1
    s_mov_b32 s38, 0x200
    v_mad_u32_u24 v4, v14, s38, v4
    v_bfe_u32 v14, v0, 2, 1
    s_mov_b32 s38, 0x400
    v_mad_u32_u24 v4, v14, s38, v4
    v_bfe_u32 v14, v0, 6, 1
    s_mov_b32 s38, 0x80
    v_mad_u32_u24 v4, v14, s38, v4
    v_bfe_u32 v14, v0, 7, 1
    s_mov_b32 s38, 0x4000
    v_mad_u32_u24 v4, v14, s38, v4
    v_lshrrev_b32 v15, 3, v0
    v_xor_b32 v15, v15, v0
    v_and_b32 v15, 7, v15
    v_lshl_add_u32 v4, v15, 4, v4
    v_bfe_u32 v15, v0, 4, 2
    v_lshlrev_b32 v15, 4, v15
    v_xor_b32 v5, v15, v1
    v_xor_b32 v6, 64, v5
    v_mov_b32 v8, 0x5000
    v_bfe_u32 v14, v0, 0, 1
    s_mov_b32 s38, 0x10
    v_mad_u32_u24 v8, v14, s38, v8
    v_bfe_u32 v14, v0, 1, 1
    s_mov_b32 s38, 0x40
    v_mad_u32_u24 v8, v14, s38, v8
    v_bfe_u32 v14, v0, 2, 1
    s_mov_b32 s38, 0x80
    v_mad_u32_u24 v8, v14, s38, v8
    v_bfe_u32 v14, v0, 4, 1
    s_mov_b32 s38, 0x20
    v_mad_u32_u24 v8, v14, s38, v8
    v_bfe_u32 v14, v0, 5, 1
    s_mov_b32 s38, 0x100
    v_mad_u32_u24 v8, v14, s38, v8
    v_mov_b32 v10, 0x0
    v_bfe_u32 v14, v0, 0, 1
    s_mov_b32 s38, 0x10
    v_mad_u32_u24 v10, v14, s38, v10
    v_bfe_u32 v14, v0, 1, 1
    s_mov_b32 s38, 0x20
    v_mad_u32_u24 v10, v14, s38, v10
    v_bfe_u32 v14, v0, 2, 1
    s_mov_b32 s38, 0x40
    v_mad_u32_u24 v10, v14, s38, v10
    v_bfe_u32 v14, v0, 3, 1
    s_mov_b32 s38, 0x80
    v_mad_u32_u24 v10, v14, s38, v10
    v_bfe_u32 v14, v0, 4, 1
    s_mov_b32 s38, 0x20000
    v_mad_u32_u24 v10, v14, s38, v10
    v_bfe_u32 v14, v0, 5, 1
    s_mov_b32 s38, 0x40000
    v_mad_u32_u24 v10, v14, s38, v10
    v_bfe_u32 v14, v0, 6, 1
    s_mov_b32 s38, 0x100
    v_mad_u32_u24 v10, v14, s38, v10
    v_bfe_u32 v14, v0, 7, 1
    s_mov_b32 s38, 0x200
    v_mad_u32_u24 v10, v14, s38, v10
    v_mov_b32 v11, 0x0
    v_bfe_u32 v14, v0, 0, 1
    s_mov_b32 s38, 0x10
    v_mad_u32_u24 v11, v14, s38, v11
    v_bfe_u32 v14, v0, 1, 1
    s_mov_b32 s38, 0x20
    v_mad_u32_u24 v11, v14, s38, v11
    v_bfe_u32 v14, v0, 2, 1
    s_mov_b32 s38, 0x40
    v_mad_u32_u24 v11, v14, s38, v11
    v_bfe_u32 v14, v0, 3, 1
    s_mov_b32 s38, 0x80
    v_mad_u32_u24 v11, v14, s38, v11
    v_bfe_u32 v14, v0, 4, 1
    s_mov_b32 s38, 0x400
    v_mad_u32_u24 v11, v14, s38, v11
    v_bfe_u32 v14, v0, 5, 1
    s_mov_b32 s38, 0x800
    v_mad_u32_u24 v11, v14, s38, v11
    v_bfe_u32 v14, v0, 6, 1
    s_mov_b32 s38, 0x100
    v_mad_u32_u24 v11, v14, s38, v11
    v_bfe_u32 v14, v0, 7, 1
    s_mov_b32 s38, 0x200
    v_mad_u32_u24 v11, v14, s38, v11
    v_mov_b32 v12, 0x0
    v_bfe_u32 v14, v0, 0, 1
    s_mov_b32 s38, 0x10
    v_mad_u32_u24 v12, v14, s38, v12
    v_bfe_u32 v14, v0, 1, 1
    s_mov_b32 s38, 0x20
    v_mad_u32_u24 v12, v14, s38, v12
    v_bfe_u32 v14, v0, 2, 1
    s_mov_b32 s38, 0x40
    v_mad_u32_u24 v12, v14, s38, v12
    v_bfe_u32 v14, v0, 3, 1
    s_mov_b32 s38, 0x80
    v_mad_u32_u24 v12, v14, s38, v12
    v_bfe_u32 v14, v0, 4, 1
    s_mov_b32 s38, 0x4
    v_mad_u32_u24 v12, v14, s38, v12
    v_bfe_u32 v14, v0, 5, 1
    s_mov_b32 s38, 0x8
    v_mad_u32_u24 v12, v14, s38, v12
    v_bfe_u32 v14, v0, 6, 1
    s_mov_b32 s38, 0x100
    v_mad_u32_u24 v12, v14, s38, v12
    v_bfe_u32 v14, v0, 7, 1
    s_mov_b32 s38, 0x200
    v_mad_u32_u24 v12, v14, s38, v12
    v_mov_b32 v13, 0xf149f2ca
    v_and_b32 v14, 15, v0
    v_bfe_u32 v15, v0, 4, 2
    v_cmp_gt_u32 s[72:73], 2, v15
    v_lshlrev_b32 v15, 2, v15
    v_cmp_le_u32 s[64:65], v15, v14
    v_add_u32 v15, 1, v15
    v_cmp_le_u32 s[66:67], v15, v14
    v_add_u32 v15, 1, v15
    v_cmp_le_u32 s[68:69], v15, v14
    v_add_u32 v15, 1, v15
    v_cmp_le_u32 s[70:71], v15, v14
    v_add_u32 v15, 1, v15
    s_mov_b32 s34, 0x05040100
    s_mov_b32 s35, 0x07060302
    s_mov_b32 s33, 0x3e0293ee
    s_mov_b32 s32, 0
    s_mov_b32 s4, 0x3f803f80
    s_mov_b32 s5, 0x3f803f80
    s_mov_b32 s23, s22
    s_lshl_b32 s36, s23, 15
    buffer_load_dwordx4 v[96:99], v3, s[12:15], s36 offen offset:0
    buffer_load_dwordx4 v[100:103], v3, s[12:15], s36 offen offset:128
    buffer_load_dwordx4 v[104:107], v3, s[12:15], s36 offen offset:256
    buffer_load_dwordx4 v[108:111], v3, s[12:15], s36 offen offset:384
    buffer_load_dwordx4 v[112:115], v3, s[12:15], s36 offen offset:512
    buffer_load_dwordx4 v[116:119], v3, s[12:15], s36 offen offset:640
    buffer_load_dwordx4 v[120:123], v3, s[12:15], s36 offen offset:768
    buffer_load_dwordx4 v[124:127], v3, s[12:15], s36 offen offset:896
    s_waitcnt vmcnt(33)
    s_barrier
    ds_read_b64_tr_b16 v[128:129], v20 offset:0
    ds_read_b64_tr_b16 v[130:131], v20 offset:1024
    ds_read_b64_tr_b16 v[132:133], v21 offset:0
    ds_read_b64_tr_b16 v[134:135], v21 offset:1024
    ds_read_b64_tr_b16 v[136:137], v22 offset:0
    ds_read_b64_tr_b16 v[138:139], v22 offset:1024
    ds_read_b64_tr_b16 v[140:141], v23 offset:0
    ds_read_b64_tr_b16 v[142:143], v23 offset:1024
    ds_read_b64_tr_b16 v[144:145], v24 offset:0
    ds_read_b64_tr_b16 v[146:147], v24 offset:1024
    ds_read_b64_tr_b16 v[148:149], v25 offset:0
    ds_read_b64_tr_b16 v[150:151], v25 offset:1024
    s_waitcnt lgkmcnt(4)
    ds_read_b64_tr_b16 v[152:153], v26 offset:0
    ds_read_b64_tr_b16 v[154:155], v26 offset:1024
    ds_read_b64_tr_b16 v[156:157], v27 offset:0
    ds_read_b64_tr_b16 v[158:159], v27 offset:1024
    s_waitcnt lgkmcnt(0)
    s_barrier
    s_mov_b32 s40, s50
    s_and_b32 s41, s51, 0xffff
    s_mov_b32 s42, 0x400000
    s_mov_b32 s43, 0x20000
    s_add_u32 m0, s28, 32768
    s_add_u32 s37, s3, 0x0
    buffer_load_dwordx4 v16, s[40:43], s37 offen lds
    s_add_u32 m0, s28, 36864
    s_add_u32 s37, s3, 0x20000
    buffer_load_dwordx4 v16, s[40:43], s37 offen lds
    s_add_u32 m0, s28, 65536
    s_add_u32 s37, s3, 0x40000
    buffer_load_dwordx4 v16, s[40:43], s37 offen lds
    s_add_u32 m0, s28, 69632
    s_add_u32 s37, s3, 0x60000
    buffer_load_dwordx4 v16, s[40:43], s37 offen lds
    s_add_u32 m0, s28, 98304
    s_add_u32 s37, s3, 0x80000
    buffer_load_dwordx4 v16, s[40:43], s37 offen lds
    s_add_u32 m0, s28, 102400
    s_add_u32 s37, s3, 0xa0000
    buffer_load_dwordx4 v16, s[40:43], s37 offen lds
    s_add_u32 m0, s28, 131072
    s_add_u32 s37, s3, 0xc0000
    buffer_load_dwordx4 v16, s[40:43], s37 offen lds
    s_add_u32 m0, s28, 135168
    s_add_u32 s37, s3, 0xe0000
    buffer_load_dwordx4 v16, s[40:43], s37 offen lds
    s_waitcnt vmcnt(33)
    s_barrier
    ds_read_b64_tr_b16 v[160:161], v20 offset:8192
    ds_read_b64_tr_b16 v[162:163], v20 offset:9216
    ds_read_b64_tr_b16 v[164:165], v21 offset:8192
    ds_read_b64_tr_b16 v[166:167], v21 offset:9216
    ds_read_b64_tr_b16 v[168:169], v22 offset:8192
    ds_read_b64_tr_b16 v[170:171], v22 offset:9216
    ds_read_b64_tr_b16 v[172:173], v23 offset:8192
    ds_read_b64_tr_b16 v[174:175], v23 offset:9216
    ds_read_b64_tr_b16 v[176:177], v24 offset:8192
    ds_read_b64_tr_b16 v[178:179], v24 offset:9216
    ds_read_b64_tr_b16 v[180:181], v25 offset:8192
    ds_read_b64_tr_b16 v[182:183], v25 offset:9216
    s_waitcnt lgkmcnt(4)
    ds_read_b64_tr_b16 v[184:185], v26 offset:8192
    ds_read_b64_tr_b16 v[186:187], v26 offset:9216
    ds_read_b64_tr_b16 v[188:189], v27 offset:8192
    ds_read_b64_tr_b16 v[190:191], v27 offset:9216
    s_waitcnt lgkmcnt(0)
    s_barrier
    s_add_u32 m0, s28, 40960
    s_add_u32 s37, s3, 0x100000
    buffer_load_dwordx4 v16, s[40:43], s37 offen lds
    s_add_u32 m0, s28, 45056
    s_add_u32 s37, s3, 0x120000
    buffer_load_dwordx4 v16, s[40:43], s37 offen lds
    s_add_u32 m0, s28, 73728
    s_add_u32 s37, s3, 0x140000
    buffer_load_dwordx4 v16, s[40:43], s37 offen lds
    s_add_u32 m0, s28, 77824
    s_add_u32 s37, s3, 0x160000
    buffer_load_dwordx4 v16, s[40:43], s37 offen lds
    s_add_u32 m0, s28, 106496
    s_add_u32 s37, s3, 0x180000
    buffer_load_dwordx4 v16, s[40:43], s37 offen lds
    s_add_u32 m0, s28, 110592
    s_add_u32 s37, s3, 0x1a0000
    buffer_load_dwordx4 v16, s[40:43], s37 offen lds
    s_add_u32 m0, s28, 139264
    s_add_u32 s37, s3, 0x1c0000
    buffer_load_dwordx4 v16, s[40:43], s37 offen lds
    s_add_u32 m0, s28, 143360
    s_add_u32 s37, s3, 0x1e0000
    buffer_load_dwordx4 v16, s[40:43], s37 offen lds
    s_waitcnt vmcnt(33)
    s_barrier
    ds_read_b64_tr_b16 v[192:193], v20 offset:16384
    ds_read_b64_tr_b16 v[194:195], v20 offset:17408
    ds_read_b64_tr_b16 v[196:197], v21 offset:16384
    ds_read_b64_tr_b16 v[198:199], v21 offset:17408
    ds_read_b64_tr_b16 v[200:201], v22 offset:16384
    ds_read_b64_tr_b16 v[202:203], v22 offset:17408
    ds_read_b64_tr_b16 v[204:205], v23 offset:16384
    ds_read_b64_tr_b16 v[206:207], v23 offset:17408
    ds_read_b64_tr_b16 v[208:209], v24 offset:16384
    ds_read_b64_tr_b16 v[210:211], v24 offset:17408
    ds_read_b64_tr_b16 v[212:213], v25 offset:16384
    ds_read_b64_tr_b16 v[214:215], v25 offset:17408
    s_waitcnt lgkmcnt(4)
    ds_read_b64_tr_b16 v[216:217], v26 offset:16384
    ds_read_b64_tr_b16 v[218:219], v26 offset:17408
    ds_read_b64_tr_b16 v[220:221], v27 offset:16384
    ds_read_b64_tr_b16 v[222:223], v27 offset:17408
    s_waitcnt lgkmcnt(0)
    s_barrier
    s_add_u32 m0, s28, 49152
    s_add_u32 s37, s3, 0x200000
    buffer_load_dwordx4 v16, s[40:43], s37 offen lds
    s_add_u32 m0, s28, 53248
    s_add_u32 s37, s3, 0x220000
    buffer_load_dwordx4 v16, s[40:43], s37 offen lds
    s_add_u32 m0, s28, 81920
    s_add_u32 s37, s3, 0x240000
    buffer_load_dwordx4 v16, s[40:43], s37 offen lds
    s_add_u32 m0, s28, 86016
    s_add_u32 s37, s3, 0x260000
    buffer_load_dwordx4 v16, s[40:43], s37 offen lds
    s_add_u32 m0, s28, 114688
    s_add_u32 s37, s3, 0x280000
    buffer_load_dwordx4 v16, s[40:43], s37 offen lds
    s_add_u32 m0, s28, 118784
    s_add_u32 s37, s3, 0x2a0000
    buffer_load_dwordx4 v16, s[40:43], s37 offen lds
    s_add_u32 m0, s28, 147456
    s_add_u32 s37, s3, 0x2c0000
    buffer_load_dwordx4 v16, s[40:43], s37 offen lds
    s_add_u32 m0, s28, 151552
    s_add_u32 s37, s3, 0x2e0000
    buffer_load_dwordx4 v16, s[40:43], s37 offen lds
    s_waitcnt vmcnt(33)
    s_barrier
    ds_read_b64_tr_b16 v[224:225], v20 offset:24576
    ds_read_b64_tr_b16 v[226:227], v20 offset:25600
    ds_read_b64_tr_b16 v[228:229], v21 offset:24576
    ds_read_b64_tr_b16 v[230:231], v21 offset:25600
    ds_read_b64_tr_b16 v[232:233], v22 offset:24576
    ds_read_b64_tr_b16 v[234:235], v22 offset:25600
    ds_read_b64_tr_b16 v[236:237], v23 offset:24576
    ds_read_b64_tr_b16 v[238:239], v23 offset:25600
    ds_read_b64_tr_b16 v[240:241], v24 offset:24576
    ds_read_b64_tr_b16 v[242:243], v24 offset:25600
    ds_read_b64_tr_b16 v[244:245], v25 offset:24576
    ds_read_b64_tr_b16 v[246:247], v25 offset:25600
    s_waitcnt lgkmcnt(4)
    ds_read_b64_tr_b16 v[248:249], v26 offset:24576
    ds_read_b64_tr_b16 v[250:251], v26 offset:25600
    ds_read_b64_tr_b16 v[252:253], v27 offset:24576
    ds_read_b64_tr_b16 v[254:255], v27 offset:25600
    s_waitcnt lgkmcnt(0)
    s_barrier
    s_add_u32 m0, s28, 57344
    s_add_u32 s37, s3, 0x300000
    buffer_load_dwordx4 v16, s[40:43], s37 offen lds
    s_add_u32 m0, s28, 61440
    s_add_u32 s37, s3, 0x320000
    buffer_load_dwordx4 v16, s[40:43], s37 offen lds
    s_add_u32 m0, s28, 90112
    s_add_u32 s37, s3, 0x340000
    buffer_load_dwordx4 v16, s[40:43], s37 offen lds
    s_add_u32 m0, s28, 94208
    s_add_u32 s37, s3, 0x360000
    buffer_load_dwordx4 v16, s[40:43], s37 offen lds
    s_add_u32 m0, s28, 122880
    s_add_u32 s37, s3, 0x380000
    buffer_load_dwordx4 v16, s[40:43], s37 offen lds
    s_add_u32 m0, s28, 126976
    s_add_u32 s37, s3, 0x3a0000
    buffer_load_dwordx4 v16, s[40:43], s37 offen lds
    s_add_u32 m0, s28, 155648
    s_add_u32 s37, s3, 0x3c0000
    buffer_load_dwordx4 v16, s[40:43], s37 offen lds
    s_add_u32 m0, s28, 159744
    s_add_u32 s37, s3, 0x3e0000
    buffer_load_dwordx4 v16, s[40:43], s37 offen lds
    s_waitcnt vmcnt(32)
    v_mov_b32 v88, 0
    v_mov_b32 v89, 0
    v_dot2_f32_bf16 v88, v96, s4, v88
    v_dot2_f32_bf16 v89, v96, v96, v89
    v_dot2_f32_bf16 v88, v97, s4, v88
    v_dot2_f32_bf16 v89, v97, v97, v89
    v_dot2_f32_bf16 v88, v98, s4, v88
    v_dot2_f32_bf16 v89, v98, v98, v89
    v_dot2_f32_bf16 v88, v99, s4, v88
    v_dot2_f32_bf16 v89, v99, v99, v89
    v_dot2_f32_bf16 v88, v100, s4, v88
    v_dot2_f32_bf16 v89, v100, v100, v89
    v_dot2_f32_bf16 v88, v101, s4, v88
    v_dot2_f32_bf16 v89, v101, v101, v89
    v_dot2_f32_bf16 v88, v102, s4, v88
    v_dot2_f32_bf16 v89, v102, v102, v89
    v_dot2_f32_bf16 v88, v103, s4, v88
    v_dot2_f32_bf16 v89, v103, v103, v89
    v_dot2_f32_bf16 v88, v104, s4, v88
    v_dot2_f32_bf16 v89, v104, v104, v89
    v_dot2_f32_bf16 v88, v105, s4, v88
    v_dot2_f32_bf16 v89, v105, v105, v89
    v_dot2_f32_bf16 v88, v106, s4, v88
    v_dot2_f32_bf16 v89, v106, v106, v89
    v_dot2_f32_bf16 v88, v107, s4, v88
    v_dot2_f32_bf16 v89, v107, v107, v89
    v_dot2_f32_bf16 v88, v108, s4, v88
    v_dot2_f32_bf16 v89, v108, v108, v89
    v_dot2_f32_bf16 v88, v109, s4, v88
    v_dot2_f32_bf16 v89, v109, v109, v89
    v_dot2_f32_bf16 v88, v110, s4, v88
    v_dot2_f32_bf16 v89, v110, v110, v89
    v_dot2_f32_bf16 v88, v111, s4, v88
    v_dot2_f32_bf16 v89, v111, v111, v89
    v_dot2_f32_bf16 v88, v112, s4, v88
    v_dot2_f32_bf16 v89, v112, v112, v89
    v_dot2_f32_bf16 v88, v113, s4, v88
    v_dot2_f32_bf16 v89, v113, v113, v89
    v_dot2_f32_bf16 v88, v114, s4, v88
    v_dot2_f32_bf16 v89, v114, v114, v89
    v_dot2_f32_bf16 v88, v115, s4, v88
    v_dot2_f32_bf16 v89, v115, v115, v89
    v_dot2_f32_bf16 v88, v116, s4, v88
    v_dot2_f32_bf16 v89, v116, v116, v89
    v_dot2_f32_bf16 v88, v117, s4, v88
    v_dot2_f32_bf16 v89, v117, v117, v89
    v_dot2_f32_bf16 v88, v118, s4, v88
    v_dot2_f32_bf16 v89, v118, v118, v89
    v_dot2_f32_bf16 v88, v119, s4, v88
    v_dot2_f32_bf16 v89, v119, v119, v89
    v_dot2_f32_bf16 v88, v120, s4, v88
    v_dot2_f32_bf16 v89, v120, v120, v89
    v_dot2_f32_bf16 v88, v121, s4, v88
    v_dot2_f32_bf16 v89, v121, v121, v89
    v_dot2_f32_bf16 v88, v122, s4, v88
    v_dot2_f32_bf16 v89, v122, v122, v89
    v_dot2_f32_bf16 v88, v123, s4, v88
    v_dot2_f32_bf16 v89, v123, v123, v89
    v_dot2_f32_bf16 v88, v124, s4, v88
    v_dot2_f32_bf16 v89, v124, v124, v89
    v_dot2_f32_bf16 v88, v125, s4, v88
    v_dot2_f32_bf16 v89, v125, v125, v89
    v_dot2_f32_bf16 v88, v126, s4, v88
    v_dot2_f32_bf16 v89, v126, v126, v89
    v_dot2_f32_bf16 v88, v127, s4, v88
    v_dot2_f32_bf16 v89, v127, v127, v89
    s_nop 3
    v_add_f32_dpp v88, v88, v88 quad_perm:[1,0,3,2] row_mask:0xf bank_mask:0xf
    v_add_f32_dpp v89, v89, v89 quad_perm:[1,0,3,2] row_mask:0xf bank_mask:0xf
    s_nop 0
    v_add_f32_dpp v88, v88, v88 quad_perm:[2,3,0,1] row_mask:0xf bank_mask:0xf
    v_add_f32_dpp v89, v89, v89 quad_perm:[2,3,0,1] row_mask:0xf bank_mask:0xf
    s_nop 0
    v_add_f32_dpp v88, v88, v88 row_half_mirror row_mask:0xf bank_mask:0xf
    v_add_f32_dpp v89, v89, v89 row_half_mirror row_mask:0xf bank_mask:0xf
    v_mul_f32 v88, 0x3b000000, v88
    v_mul_f32 v89, 0x3b000000, v89
    v_fma_f32 v89, -v88, v88, v89
    v_max_f32 v89, 0, v89
    v_cvt_pk_bf16_f32 v14, v88, v89
    v_lshlrev_b32 v88, 16, v14
    v_and_b32 v89, 0xffff0000, v14
    v_add_f32 v89, 0x3727c5ac, v89
    v_cvt_pk_bf16_f32 v14, v89, v89
    v_lshlrev_b32 v89, 16, v14
    v_sqrt_f32 v89, v89
    s_nop 0
    v_cvt_pk_bf16_f32 v14, v89, v89
    v_lshlrev_b32 v89, 16, v14
    v_rcp_f32 v89, v89
    v_lshlrev_b32 v90, 16, v96
    v_and_b32 v91, 0xffff0000, v96
    v_sub_f32 v90, v90, v88
    v_sub_f32 v91, v91, v88
    v_cvt_pk_bf16_f32 v96, v90, v91
    v_lshlrev_b32 v90, 16, v96
    v_and_b32 v91, 0xffff0000, v96
    v_mul_f32 v90, v90, v89
    v_mul_f32 v91, v91, v89
    v_cvt_pk_bf16_f32 v96, v90, v91
    v_lshlrev_b32 v90, 16, v97
    v_and_b32 v91, 0xffff0000, v97
    v_sub_f32 v90, v90, v88
    v_sub_f32 v91, v91, v88
    v_cvt_pk_bf16_f32 v97, v90, v91
    v_lshlrev_b32 v90, 16, v97
    v_and_b32 v91, 0xffff0000, v97
    v_mul_f32 v90, v90, v89
    v_mul_f32 v91, v91, v89
    v_cvt_pk_bf16_f32 v97, v90, v91
    v_lshlrev_b32 v90, 16, v98
    v_and_b32 v91, 0xffff0000, v98
    v_sub_f32 v90, v90, v88
    v_sub_f32 v91, v91, v88
    v_cvt_pk_bf16_f32 v98, v90, v91
    v_lshlrev_b32 v90, 16, v98
    v_and_b32 v91, 0xffff0000, v98
    v_mul_f32 v90, v90, v89
    v_mul_f32 v91, v91, v89
    v_cvt_pk_bf16_f32 v98, v90, v91
    v_lshlrev_b32 v90, 16, v99
    v_and_b32 v91, 0xffff0000, v99
    v_sub_f32 v90, v90, v88
    v_sub_f32 v91, v91, v88
    v_cvt_pk_bf16_f32 v99, v90, v91
    v_lshlrev_b32 v90, 16, v99
    v_and_b32 v91, 0xffff0000, v99
    v_mul_f32 v90, v90, v89
    v_mul_f32 v91, v91, v89
    v_cvt_pk_bf16_f32 v99, v90, v91
    ds_write_b128 v4, v[96:99] offset:0
    v_lshlrev_b32 v90, 16, v100
    v_and_b32 v91, 0xffff0000, v100
    v_sub_f32 v90, v90, v88
    v_sub_f32 v91, v91, v88
    v_cvt_pk_bf16_f32 v100, v90, v91
    v_lshlrev_b32 v90, 16, v100
    v_and_b32 v91, 0xffff0000, v100
    v_mul_f32 v90, v90, v89
    v_mul_f32 v91, v91, v89
    v_cvt_pk_bf16_f32 v100, v90, v91
    v_lshlrev_b32 v90, 16, v101
    v_and_b32 v91, 0xffff0000, v101
    v_sub_f32 v90, v90, v88
    v_sub_f32 v91, v91, v88
    v_cvt_pk_bf16_f32 v101, v90, v91
    v_lshlrev_b32 v90, 16, v101
    v_and_b32 v91, 0xffff0000, v101
    v_mul_f32 v90, v90, v89
    v_mul_f32 v91, v91, v89
    v_cvt_pk_bf16_f32 v101, v90, v91
    v_lshlrev_b32 v90, 16, v102
    v_and_b32 v91, 0xffff0000, v102
    v_sub_f32 v90, v90, v88
    v_sub_f32 v91, v91, v88
    v_cvt_pk_bf16_f32 v102, v90, v91
    v_lshlrev_b32 v90, 16, v102
    v_and_b32 v91, 0xffff0000, v102
    v_mul_f32 v90, v90, v89
    v_mul_f32 v91, v91, v89
    v_cvt_pk_bf16_f32 v102, v90, v91
    v_lshlrev_b32 v90, 16, v103
    v_and_b32 v91, 0xffff0000, v103
    v_sub_f32 v90, v90, v88
    v_sub_f32 v91, v91, v88
    v_cvt_pk_bf16_f32 v103, v90, v91
    v_lshlrev_b32 v90, 16, v103
    v_and_b32 v91, 0xffff0000, v103
    v_mul_f32 v90, v90, v89
    v_mul_f32 v91, v91, v89
    v_cvt_pk_bf16_f32 v103, v90, v91
    ds_write_b128 v4, v[100:103] offset:2048
    v_lshlrev_b32 v90, 16, v104
    v_and_b32 v91, 0xffff0000, v104
    v_sub_f32 v90, v90, v88
    v_sub_f32 v91, v91, v88
    v_cvt_pk_bf16_f32 v104, v90, v91
    v_lshlrev_b32 v90, 16, v104
    v_and_b32 v91, 0xffff0000, v104
    v_mul_f32 v90, v90, v89
    v_mul_f32 v91, v91, v89
    v_cvt_pk_bf16_f32 v104, v90, v91
    v_lshlrev_b32 v90, 16, v105
    v_and_b32 v91, 0xffff0000, v105
    v_sub_f32 v90, v90, v88
    v_sub_f32 v91, v91, v88
    v_cvt_pk_bf16_f32 v105, v90, v91
    v_lshlrev_b32 v90, 16, v105
    v_and_b32 v91, 0xffff0000, v105
    v_mul_f32 v90, v90, v89
    v_mul_f32 v91, v91, v89
    v_cvt_pk_bf16_f32 v105, v90, v91
    v_lshlrev_b32 v90, 16, v106
    v_and_b32 v91, 0xffff0000, v106
    v_sub_f32 v90, v90, v88
    v_sub_f32 v91, v91, v88
    v_cvt_pk_bf16_f32 v106, v90, v91
    v_lshlrev_b32 v90, 16, v106
    v_and_b32 v91, 0xffff0000, v106
    v_mul_f32 v90, v90, v89
    v_mul_f32 v91, v91, v89
    v_cvt_pk_bf16_f32 v106, v90, v91
    v_lshlrev_b32 v90, 16, v107
    v_and_b32 v91, 0xffff0000, v107
    v_sub_f32 v90, v90, v88
    v_sub_f32 v91, v91, v88
    v_cvt_pk_bf16_f32 v107, v90, v91
    v_lshlrev_b32 v90, 16, v107
    v_and_b32 v91, 0xffff0000, v107
    v_mul_f32 v90, v90, v89
    v_mul_f32 v91, v91, v89
    v_cvt_pk_bf16_f32 v107, v90, v91
    ds_write_b128 v4, v[104:107] offset:4096
    v_lshlrev_b32 v90, 16, v108
    v_and_b32 v91, 0xffff0000, v108
    v_sub_f32 v90, v90, v88
    v_sub_f32 v91, v91, v88
    v_cvt_pk_bf16_f32 v108, v90, v91
    v_lshlrev_b32 v90, 16, v108
    v_and_b32 v91, 0xffff0000, v108
    v_mul_f32 v90, v90, v89
    v_mul_f32 v91, v91, v89
    v_cvt_pk_bf16_f32 v108, v90, v91
    v_lshlrev_b32 v90, 16, v109
    v_and_b32 v91, 0xffff0000, v109
    v_sub_f32 v90, v90, v88
    v_sub_f32 v91, v91, v88
    v_cvt_pk_bf16_f32 v109, v90, v91
    v_lshlrev_b32 v90, 16, v109
    v_and_b32 v91, 0xffff0000, v109
    v_mul_f32 v90, v90, v89
    v_mul_f32 v91, v91, v89
    v_cvt_pk_bf16_f32 v109, v90, v91
    v_lshlrev_b32 v90, 16, v110
    v_and_b32 v91, 0xffff0000, v110
    v_sub_f32 v90, v90, v88
    v_sub_f32 v91, v91, v88
    v_cvt_pk_bf16_f32 v110, v90, v91
    v_lshlrev_b32 v90, 16, v110
    v_and_b32 v91, 0xffff0000, v110
    v_mul_f32 v90, v90, v89
    v_mul_f32 v91, v91, v89
    v_cvt_pk_bf16_f32 v110, v90, v91
    v_lshlrev_b32 v90, 16, v111
    v_and_b32 v91, 0xffff0000, v111
    v_sub_f32 v90, v90, v88
    v_sub_f32 v91, v91, v88
    v_cvt_pk_bf16_f32 v111, v90, v91
    v_lshlrev_b32 v90, 16, v111
    v_and_b32 v91, 0xffff0000, v111
    v_mul_f32 v90, v90, v89
    v_mul_f32 v91, v91, v89
    v_cvt_pk_bf16_f32 v111, v90, v91
    ds_write_b128 v4, v[108:111] offset:6144
    v_lshlrev_b32 v90, 16, v112
    v_and_b32 v91, 0xffff0000, v112
    v_sub_f32 v90, v90, v88
    v_sub_f32 v91, v91, v88
    v_cvt_pk_bf16_f32 v112, v90, v91
    v_lshlrev_b32 v90, 16, v112
    v_and_b32 v91, 0xffff0000, v112
    v_mul_f32 v90, v90, v89
    v_mul_f32 v91, v91, v89
    v_cvt_pk_bf16_f32 v112, v90, v91
    v_lshlrev_b32 v90, 16, v113
    v_and_b32 v91, 0xffff0000, v113
    v_sub_f32 v90, v90, v88
    v_sub_f32 v91, v91, v88
    v_cvt_pk_bf16_f32 v113, v90, v91
    v_lshlrev_b32 v90, 16, v113
    v_and_b32 v91, 0xffff0000, v113
    v_mul_f32 v90, v90, v89
    v_mul_f32 v91, v91, v89
    v_cvt_pk_bf16_f32 v113, v90, v91
    v_lshlrev_b32 v90, 16, v114
    v_and_b32 v91, 0xffff0000, v114
    v_sub_f32 v90, v90, v88
    v_sub_f32 v91, v91, v88
    v_cvt_pk_bf16_f32 v114, v90, v91
    v_lshlrev_b32 v90, 16, v114
    v_and_b32 v91, 0xffff0000, v114
    v_mul_f32 v90, v90, v89
    v_mul_f32 v91, v91, v89
    v_cvt_pk_bf16_f32 v114, v90, v91
    v_lshlrev_b32 v90, 16, v115
    v_and_b32 v91, 0xffff0000, v115
    v_sub_f32 v90, v90, v88
    v_sub_f32 v91, v91, v88
    v_cvt_pk_bf16_f32 v115, v90, v91
    v_lshlrev_b32 v90, 16, v115
    v_and_b32 v91, 0xffff0000, v115
    v_mul_f32 v90, v90, v89
    v_mul_f32 v91, v91, v89
    v_cvt_pk_bf16_f32 v115, v90, v91
    ds_write_b128 v4, v[112:115] offset:8192
    v_lshlrev_b32 v90, 16, v116
    v_and_b32 v91, 0xffff0000, v116
    v_sub_f32 v90, v90, v88
    v_sub_f32 v91, v91, v88
    v_cvt_pk_bf16_f32 v116, v90, v91
    v_lshlrev_b32 v90, 16, v116
    v_and_b32 v91, 0xffff0000, v116
    v_mul_f32 v90, v90, v89
    v_mul_f32 v91, v91, v89
    v_cvt_pk_bf16_f32 v116, v90, v91
    v_lshlrev_b32 v90, 16, v117
    v_and_b32 v91, 0xffff0000, v117
    v_sub_f32 v90, v90, v88
    v_sub_f32 v91, v91, v88
    v_cvt_pk_bf16_f32 v117, v90, v91
    v_lshlrev_b32 v90, 16, v117
    v_and_b32 v91, 0xffff0000, v117
    v_mul_f32 v90, v90, v89
    v_mul_f32 v91, v91, v89
    v_cvt_pk_bf16_f32 v117, v90, v91
    v_lshlrev_b32 v90, 16, v118
    v_and_b32 v91, 0xffff0000, v118
    v_sub_f32 v90, v90, v88
    v_sub_f32 v91, v91, v88
    v_cvt_pk_bf16_f32 v118, v90, v91
    v_lshlrev_b32 v90, 16, v118
    v_and_b32 v91, 0xffff0000, v118
    v_mul_f32 v90, v90, v89
    v_mul_f32 v91, v91, v89
    v_cvt_pk_bf16_f32 v118, v90, v91
    v_lshlrev_b32 v90, 16, v119
    v_and_b32 v91, 0xffff0000, v119
    v_sub_f32 v90, v90, v88
    v_sub_f32 v91, v91, v88
    v_cvt_pk_bf16_f32 v119, v90, v91
    v_lshlrev_b32 v90, 16, v119
    v_and_b32 v91, 0xffff0000, v119
    v_mul_f32 v90, v90, v89
    v_mul_f32 v91, v91, v89
    v_cvt_pk_bf16_f32 v119, v90, v91
    ds_write_b128 v4, v[116:119] offset:10240
    v_lshlrev_b32 v90, 16, v120
    v_and_b32 v91, 0xffff0000, v120
    v_sub_f32 v90, v90, v88
    v_sub_f32 v91, v91, v88
    v_cvt_pk_bf16_f32 v120, v90, v91
    v_lshlrev_b32 v90, 16, v120
    v_and_b32 v91, 0xffff0000, v120
    v_mul_f32 v90, v90, v89
    v_mul_f32 v91, v91, v89
    v_cvt_pk_bf16_f32 v120, v90, v91
    v_lshlrev_b32 v90, 16, v121
    v_and_b32 v91, 0xffff0000, v121
    v_sub_f32 v90, v90, v88
    v_sub_f32 v91, v91, v88
    v_cvt_pk_bf16_f32 v121, v90, v91
    v_lshlrev_b32 v90, 16, v121
    v_and_b32 v91, 0xffff0000, v121
    v_mul_f32 v90, v90, v89
    v_mul_f32 v91, v91, v89
    v_cvt_pk_bf16_f32 v121, v90, v91
    v_lshlrev_b32 v90, 16, v122
    v_and_b32 v91, 0xffff0000, v122
    v_sub_f32 v90, v90, v88
    v_sub_f32 v91, v91, v88
    v_cvt_pk_bf16_f32 v122, v90, v91
    v_lshlrev_b32 v90, 16, v122
    v_and_b32 v91, 0xffff0000, v122
    v_mul_f32 v90, v90, v89
    v_mul_f32 v91, v91, v89
    v_cvt_pk_bf16_f32 v122, v90, v91
    v_lshlrev_b32 v90, 16, v123
    v_and_b32 v91, 0xffff0000, v123
    v_sub_f32 v90, v90, v88
    v_sub_f32 v91, v91, v88
    v_cvt_pk_bf16_f32 v123, v90, v91
    v_lshlrev_b32 v90, 16, v123
    v_and_b32 v91, 0xffff0000, v123
    v_mul_f32 v90, v90, v89
    v_mul_f32 v91, v91, v89
    v_cvt_pk_bf16_f32 v123, v90, v91
    ds_write_b128 v4, v[120:123] offset:12288
    v_lshlrev_b32 v90, 16, v124
    v_and_b32 v91, 0xffff0000, v124
    v_sub_f32 v90, v90, v88
    v_sub_f32 v91, v91, v88
    v_cvt_pk_bf16_f32 v124, v90, v91
    v_lshlrev_b32 v90, 16, v124
    v_and_b32 v91, 0xffff0000, v124
    v_mul_f32 v90, v90, v89
    v_mul_f32 v91, v91, v89
    v_cvt_pk_bf16_f32 v124, v90, v91
    v_lshlrev_b32 v90, 16, v125
    v_and_b32 v91, 0xffff0000, v125
    v_sub_f32 v90, v90, v88
    v_sub_f32 v91, v91, v88
    v_cvt_pk_bf16_f32 v125, v90, v91
    v_lshlrev_b32 v90, 16, v125
    v_and_b32 v91, 0xffff0000, v125
    v_mul_f32 v90, v90, v89
    v_mul_f32 v91, v91, v89
    v_cvt_pk_bf16_f32 v125, v90, v91
    v_lshlrev_b32 v90, 16, v126
    v_and_b32 v91, 0xffff0000, v126
    v_sub_f32 v90, v90, v88
    v_sub_f32 v91, v91, v88
    v_cvt_pk_bf16_f32 v126, v90, v91
    v_lshlrev_b32 v90, 16, v126
    v_and_b32 v91, 0xffff0000, v126
    v_mul_f32 v90, v90, v89
    v_mul_f32 v91, v91, v89
    v_cvt_pk_bf16_f32 v126, v90, v91
    v_lshlrev_b32 v90, 16, v127
    v_and_b32 v91, 0xffff0000, v127
    v_sub_f32 v90, v90, v88
    v_sub_f32 v91, v91, v88
    v_cvt_pk_bf16_f32 v127, v90, v91
    v_lshlrev_b32 v90, 16, v127
    v_and_b32 v91, 0xffff0000, v127
    v_mul_f32 v90, v90, v89
    v_mul_f32 v91, v91, v89
    v_cvt_pk_bf16_f32 v127, v90, v91
    ds_write_b128 v4, v[124:127] offset:14336
    s_lshr_b32 s36, s21, 1
    s_lshl_b32 s36, s36, 14
    s_xor_b32 s37, s36, 16384
    v_add_u32 v80, s36, v5
    v_add_u32 v81, s37, v5
    v_add_u32 v82, s36, v6
    v_add_u32 v83, s37, v6
    s_mov_b32 s31, 0
    s_waitcnt vmcnt(24)
    s_barrier
    ds_read_b64_tr_b16 a[128:129], v20 offset:0
    ds_read_b64_tr_b16 a[130:131], v20 offset:1024
    ds_read_b64_tr_b16 a[132:133], v21 offset:0
    ds_read_b64_tr_b16 a[134:135], v21 offset:1024
    ds_read_b64_tr_b16 a[136:137], v22 offset:0
    ds_read_b64_tr_b16 a[138:139], v22 offset:1024
    ds_read_b64_tr_b16 a[140:141], v23 offset:0
    ds_read_b64_tr_b16 a[142:143], v23 offset:1024
    ds_read_b64_tr_b16 a[144:145], v24 offset:0
    ds_read_b64_tr_b16 a[146:147], v24 offset:1024
    ds_read_b64_tr_b16 a[148:149], v25 offset:0
    ds_read_b64_tr_b16 a[150:151], v25 offset:1024
    s_waitcnt lgkmcnt(4)
    ds_read_b64_tr_b16 a[152:153], v26 offset:0
    ds_read_b64_tr_b16 a[154:155], v26 offset:1024
    ds_read_b64_tr_b16 a[156:157], v27 offset:0
    ds_read_b64_tr_b16 a[158:159], v27 offset:1024
    s_waitcnt lgkmcnt(0)
    s_barrier
    s_mov_b32 s96, s48
    s_and_b32 s97, s49, 0xffff
    s_mov_b32 s98, 0x400000
    s_mov_b32 s99, 0x20000
    s_add_u32 m0, s28, 32768
    s_add_u32 s37, s3, 0x0
    buffer_load_dwordx4 v16, s[96:99], s37 offen lds
    s_add_u32 m0, s28, 36864
    s_add_u32 s37, s3, 0x20000
    buffer_load_dwordx4 v16, s[96:99], s37 offen lds
    s_add_u32 m0, s28, 65536
    s_add_u32 s37, s3, 0x40000
    buffer_load_dwordx4 v16, s[96:99], s37 offen lds
    s_add_u32 m0, s28, 69632
    s_add_u32 s37, s3, 0x60000
    buffer_load_dwordx4 v16, s[96:99], s37 offen lds
    s_add_u32 m0, s28, 98304
    s_add_u32 s37, s3, 0x80000
    buffer_load_dwordx4 v16, s[96:99], s37 offen lds
    s_add_u32 m0, s28, 102400
    s_add_u32 s37, s3, 0xa0000
    buffer_load_dwordx4 v16, s[96:99], s37 offen lds
    s_add_u32 m0, s28, 131072
    s_add_u32 s37, s3, 0xc0000
    buffer_load_dwordx4 v16, s[96:99], s37 offen lds
    s_add_u32 m0, s28, 135168
    s_add_u32 s37, s3, 0xe0000
    buffer_load_dwordx4 v16, s[96:99], s37 offen lds
    s_waitcnt vmcnt(24)
    s_barrier
    ds_read_b64_tr_b16 a[160:161], v20 offset:8192
    ds_read_b64_tr_b16 a[162:163], v20 offset:9216
    ds_read_b64_tr_b16 a[164:165], v21 offset:8192
    ds_read_b64_tr_b16 a[166:167], v21 offset:9216
    ds_read_b64_tr_b16 a[168:169], v22 offset:8192
    ds_read_b64_tr_b16 a[170:171], v22 offset:9216
    ds_read_b64_tr_b16 a[172:173], v23 offset:8192
    ds_read_b64_tr_b16 a[174:175], v23 offset:9216
    ds_read_b64_tr_b16 a[176:177], v24 offset:8192
    ds_read_b64_tr_b16 a[178:179], v24 offset:9216
    ds_read_b64_tr_b16 a[180:181], v25 offset:8192
    ds_read_b64_tr_b16 a[182:183], v25 offset:9216
    s_waitcnt lgkmcnt(4)
    ds_read_b64_tr_b16 a[184:185], v26 offset:8192
    ds_read_b64_tr_b16 a[186:187], v26 offset:9216
    ds_read_b64_tr_b16 a[188:189], v27 offset:8192
    ds_read_b64_tr_b16 a[190:191], v27 offset:9216
    s_waitcnt lgkmcnt(0)
    s_barrier
    s_add_u32 m0, s28, 40960
    s_add_u32 s37, s3, 0x100000
    buffer_load_dwordx4 v16, s[96:99], s37 offen lds
    s_add_u32 m0, s28, 45056
    s_add_u32 s37, s3, 0x120000
    buffer_load_dwordx4 v16, s[96:99], s37 offen lds
    s_add_u32 m0, s28, 73728
    s_add_u32 s37, s3, 0x140000
    buffer_load_dwordx4 v16, s[96:99], s37 offen lds
    s_add_u32 m0, s28, 77824
    s_add_u32 s37, s3, 0x160000
    buffer_load_dwordx4 v16, s[96:99], s37 offen lds
    s_add_u32 m0, s28, 106496
    s_add_u32 s37, s3, 0x180000
    buffer_load_dwordx4 v16, s[96:99], s37 offen lds
    s_add_u32 m0, s28, 110592
    s_add_u32 s37, s3, 0x1a0000
    buffer_load_dwordx4 v16, s[96:99], s37 offen lds
    s_add_u32 m0, s28, 139264
    s_add_u32 s37, s3, 0x1c0000
    buffer_load_dwordx4 v16, s[96:99], s37 offen lds
    s_add_u32 m0, s28, 143360
    s_add_u32 s37, s3, 0x1e0000
    buffer_load_dwordx4 v16, s[96:99], s37 offen lds
    s_waitcnt vmcnt(24)
    s_barrier
    ds_read_b64_tr_b16 a[192:193], v20 offset:16384
    ds_read_b64_tr_b16 a[194:195], v20 offset:17408
    ds_read_b64_tr_b16 a[196:197], v21 offset:16384
    ds_read_b64_tr_b16 a[198:199], v21 offset:17408
    ds_read_b64_tr_b16 a[200:201], v22 offset:16384
    ds_read_b64_tr_b16 a[202:203], v22 offset:17408
    ds_read_b64_tr_b16 a[204:205], v23 offset:16384
    ds_read_b64_tr_b16 a[206:207], v23 offset:17408
    ds_read_b64_tr_b16 a[208:209], v24 offset:16384
    ds_read_b64_tr_b16 a[210:211], v24 offset:17408
    ds_read_b64_tr_b16 a[212:213], v25 offset:16384
    ds_read_b64_tr_b16 a[214:215], v25 offset:17408
    s_waitcnt lgkmcnt(4)
    ds_read_b64_tr_b16 a[216:217], v26 offset:16384
    ds_read_b64_tr_b16 a[218:219], v26 offset:17408
    ds_read_b64_tr_b16 a[220:221], v27 offset:16384
    ds_read_b64_tr_b16 a[222:223], v27 offset:17408
    s_waitcnt lgkmcnt(0)
    s_barrier
    s_add_u32 m0, s28, 49152
    s_add_u32 s37, s3, 0x200000
    buffer_load_dwordx4 v16, s[96:99], s37 offen lds
    s_add_u32 m0, s28, 53248
    s_add_u32 s37, s3, 0x220000
    buffer_load_dwordx4 v16, s[96:99], s37 offen lds
    s_add_u32 m0, s28, 81920
    s_add_u32 s37, s3, 0x240000
    buffer_load_dwordx4 v16, s[96:99], s37 offen lds
    s_add_u32 m0, s28, 86016
    s_add_u32 s37, s3, 0x260000
    buffer_load_dwordx4 v16, s[96:99], s37 offen lds
    s_add_u32 m0, s28, 114688
    s_add_u32 s37, s3, 0x280000
    buffer_load_dwordx4 v16, s[96:99], s37 offen lds
    s_add_u32 m0, s28, 118784
    s_add_u32 s37, s3, 0x2a0000
    buffer_load_dwordx4 v16, s[96:99], s37 offen lds
    s_add_u32 m0, s28, 147456
    s_add_u32 s37, s3, 0x2c0000
    buffer_load_dwordx4 v16, s[96:99], s37 offen lds
    s_add_u32 m0, s28, 151552
    s_add_u32 s37, s3, 0x2e0000
    buffer_load_dwordx4 v16, s[96:99], s37 offen lds
    s_waitcnt vmcnt(24)
    s_barrier
    ds_read_b64_tr_b16 a[224:225], v20 offset:24576
    ds_read_b64_tr_b16 a[226:227], v20 offset:25600
    ds_read_b64_tr_b16 a[228:229], v21 offset:24576
    ds_read_b64_tr_b16 a[230:231], v21 offset:25600
    ds_read_b64_tr_b16 a[232:233], v22 offset:24576
    ds_read_b64_tr_b16 a[234:235], v22 offset:25600
    ds_read_b64_tr_b16 a[236:237], v23 offset:24576
    ds_read_b64_tr_b16 a[238:239], v23 offset:25600
    ds_read_b64_tr_b16 a[240:241], v24 offset:24576
    ds_read_b64_tr_b16 a[242:243], v24 offset:25600
    ds_read_b64_tr_b16 a[244:245], v25 offset:24576
    ds_read_b64_tr_b16 a[246:247], v25 offset:25600
    s_waitcnt lgkmcnt(4)
    ds_read_b64_tr_b16 a[248:249], v26 offset:24576
    ds_read_b64_tr_b16 a[250:251], v26 offset:25600
    ds_read_b64_tr_b16 a[252:253], v27 offset:24576
    ds_read_b64_tr_b16 a[254:255], v27 offset:25600
    s_waitcnt lgkmcnt(0)
    s_barrier
    s_add_u32 m0, s28, 57344
    s_add_u32 s37, s3, 0x300000
    buffer_load_dwordx4 v16, s[96:99], s37 offen lds
    s_add_u32 m0, s28, 61440
    s_add_u32 s37, s3, 0x320000
    buffer_load_dwordx4 v16, s[96:99], s37 offen lds
    s_add_u32 m0, s28, 90112
    s_add_u32 s37, s3, 0x340000
    buffer_load_dwordx4 v16, s[96:99], s37 offen lds
    s_add_u32 m0, s28, 94208
    s_add_u32 s37, s3, 0x360000
    buffer_load_dwordx4 v16, s[96:99], s37 offen lds
    s_add_u32 m0, s28, 122880
    s_add_u32 s37, s3, 0x380000
    buffer_load_dwordx4 v16, s[96:99], s37 offen lds
    s_add_u32 m0, s28, 126976
    s_add_u32 s37, s3, 0x3a0000
    buffer_load_dwordx4 v16, s[96:99], s37 offen lds
    s_add_u32 m0, s28, 155648
    s_add_u32 s37, s3, 0x3c0000
    buffer_load_dwordx4 v16, s[96:99], s37 offen lds
    s_add_u32 m0, s28, 159744
    s_add_u32 s37, s3, 0x3e0000
    buffer_load_dwordx4 v16, s[96:99], s37 offen lds
    ds_read_b128 v[64:67], v80 offset:0
    ds_read_b128 v[68:71], v81 offset:0
    ds_read_b128 v[72:75], v82 offset:1024
    ds_read_b128 v[76:79], v83 offset:1024
    s_waitcnt lgkmcnt(2)
    v_mfma_f32_16x16x32_bf16 v[32:35], a[128:131], v[64:67], 0
    v_mfma_f32_16x16x32_bf16 v[36:39], a[128:131], v[68:71], 0
    v_mfma_f32_16x16x32_bf16 v[40:43], a[132:135], v[64:67], 0
    v_mfma_f32_16x16x32_bf16 v[44:47], a[132:135], v[68:71], 0
    v_mfma_f32_16x16x32_bf16 v[48:51], v[64:67], v[128:131], 0
    v_mfma_f32_16x16x32_bf16 v[56:59], v[68:71], v[128:131], 0
    v_mfma_f32_16x16x32_bf16 v[52:55], v[64:67], v[132:135], 0
    v_mfma_f32_16x16x32_bf16 v[60:63], v[68:71], v[132:135], 0
    ds_read_b128 v[64:67], v80 offset:2048
    ds_read_b128 v[68:71], v81 offset:2048
    s_waitcnt lgkmcnt(2)
    v_mfma_f32_16x16x32_bf16 v[32:35], a[136:139], v[72:75], v[32:35]
    v_mfma_f32_16x16x32_bf16 v[36:39], a[136:139], v[76:79], v[36:39]
    v_mfma_f32_16x16x32_bf16 v[40:43], a[140:143], v[72:75], v[40:43]
    v_mfma_f32_16x16x32_bf16 v[44:47], a[140:143], v[76:79], v[44:47]
    v_mfma_f32_16x16x32_bf16 v[48:51], v[72:75], v[136:139], v[48:51]
    v_mfma_f32_16x16x32_bf16 v[56:59], v[76:79], v[136:139], v[56:59]
    v_mfma_f32_16x16x32_bf16 v[52:55], v[72:75], v[140:143], v[52:55]
    v_mfma_f32_16x16x32_bf16 v[60:63], v[76:79], v[140:143], v[60:63]
    ds_read_b128 v[72:75], v82 offset:3072
    ds_read_b128 v[76:79], v83 offset:3072
    s_waitcnt lgkmcnt(2)
    v_mfma_f32_16x16x32_bf16 v[32:35], a[144:147], v[64:67], v[32:35]
    v_mfma_f32_16x16x32_bf16 v[36:39], a[144:147], v[68:71], v[36:39]
    v_mfma_f32_16x16x32_bf16 v[40:43], a[148:151], v[64:67], v[40:43]
    v_mfma_f32_16x16x32_bf16 v[44:47], a[148:151], v[68:71], v[44:47]
    v_mfma_f32_16x16x32_bf16 v[48:51], v[64:67], v[144:147], v[48:51]
    v_mfma_f32_16x16x32_bf16 v[56:59], v[68:71], v[144:147], v[56:59]
    v_mfma_f32_16x16x32_bf16 v[52:55], v[64:67], v[148:151], v[52:55]
    v_mfma_f32_16x16x32_bf16 v[60:63], v[68:71], v[148:151], v[60:63]
    ds_read_b128 v[64:67], v80 offset:4096
    ds_read_b128 v[68:71], v81 offset:4096
    s_waitcnt lgkmcnt(2)
    v_mfma_f32_16x16x32_bf16 v[32:35], a[152:155], v[72:75], v[32:35]
    v_mfma_f32_16x16x32_bf16 v[36:39], a[152:155], v[76:79], v[36:39]
    v_mfma_f32_16x16x32_bf16 v[40:43], a[156:159], v[72:75], v[40:43]
    v_mfma_f32_16x16x32_bf16 v[44:47], a[156:159], v[76:79], v[44:47]
    v_mfma_f32_16x16x32_bf16 v[48:51], v[72:75], v[152:155], v[48:51]
    v_mfma_f32_16x16x32_bf16 v[56:59], v[76:79], v[152:155], v[56:59]
    v_mfma_f32_16x16x32_bf16 v[52:55], v[72:75], v[156:159], v[52:55]
    v_mfma_f32_16x16x32_bf16 v[60:63], v[76:79], v[156:159], v[60:63]
    ds_read_b128 v[72:75], v82 offset:5120
    ds_read_b128 v[76:79], v83 offset:5120
    s_waitcnt lgkmcnt(2)
    v_mfma_f32_16x16x32_bf16 v[32:35], a[160:163], v[64:67], v[32:35]
    v_mfma_f32_16x16x32_bf16 v[36:39], a[160:163], v[68:71], v[36:39]
    v_mfma_f32_16x16x32_bf16 v[40:43], a[164:167], v[64:67], v[40:43]
    v_mfma_f32_16x16x32_bf16 v[44:47], a[164:167], v[68:71], v[44:47]
    v_mfma_f32_16x16x32_bf16 v[48:51], v[64:67], v[160:163], v[48:51]
    v_mfma_f32_16x16x32_bf16 v[56:59], v[68:71], v[160:163], v[56:59]
    v_mfma_f32_16x16x32_bf16 v[52:55], v[64:67], v[164:167], v[52:55]
    v_mfma_f32_16x16x32_bf16 v[60:63], v[68:71], v[164:167], v[60:63]
    ds_read_b128 v[64:67], v80 offset:6144
    ds_read_b128 v[68:71], v81 offset:6144
    s_waitcnt lgkmcnt(2)
    v_mfma_f32_16x16x32_bf16 v[32:35], a[168:171], v[72:75], v[32:35]
    v_mfma_f32_16x16x32_bf16 v[36:39], a[168:171], v[76:79], v[36:39]
    v_mfma_f32_16x16x32_bf16 v[40:43], a[172:175], v[72:75], v[40:43]
    v_mfma_f32_16x16x32_bf16 v[44:47], a[172:175], v[76:79], v[44:47]
    v_mfma_f32_16x16x32_bf16 v[48:51], v[72:75], v[168:171], v[48:51]
    v_mfma_f32_16x16x32_bf16 v[56:59], v[76:79], v[168:171], v[56:59]
    v_mfma_f32_16x16x32_bf16 v[52:55], v[72:75], v[172:175], v[52:55]
    v_mfma_f32_16x16x32_bf16 v[60:63], v[76:79], v[172:175], v[60:63]
    ds_read_b128 v[72:75], v82 offset:7168
    ds_read_b128 v[76:79], v83 offset:7168
    s_waitcnt lgkmcnt(2)
    v_mfma_f32_16x16x32_bf16 v[32:35], a[176:179], v[64:67], v[32:35]
    v_mfma_f32_16x16x32_bf16 v[36:39], a[176:179], v[68:71], v[36:39]
    v_mfma_f32_16x16x32_bf16 v[40:43], a[180:183], v[64:67], v[40:43]
    v_mfma_f32_16x16x32_bf16 v[44:47], a[180:183], v[68:71], v[44:47]
    v_mfma_f32_16x16x32_bf16 v[48:51], v[64:67], v[176:179], v[48:51]
    v_mfma_f32_16x16x32_bf16 v[56:59], v[68:71], v[176:179], v[56:59]
    v_mfma_f32_16x16x32_bf16 v[52:55], v[64:67], v[180:183], v[52:55]
    v_mfma_f32_16x16x32_bf16 v[60:63], v[68:71], v[180:183], v[60:63]
    ds_read_b128 v[64:67], v80 offset:8192
    ds_read_b128 v[68:71], v81 offset:8192
    s_waitcnt lgkmcnt(2)
    v_mfma_f32_16x16x32_bf16 v[32:35], a[184:187], v[72:75], v[32:35]
    v_mfma_f32_16x16x32_bf16 v[36:39], a[184:187], v[76:79], v[36:39]
    v_mfma_f32_16x16x32_bf16 v[40:43], a[188:191], v[72:75], v[40:43]
    v_mfma_f32_16x16x32_bf16 v[44:47], a[188:191], v[76:79], v[44:47]
    v_mfma_f32_16x16x32_bf16 v[48:51], v[72:75], v[184:187], v[48:51]
    v_mfma_f32_16x16x32_bf16 v[56:59], v[76:79], v[184:187], v[56:59]
    v_mfma_f32_16x16x32_bf16 v[52:55], v[72:75], v[188:191], v[52:55]
    v_mfma_f32_16x16x32_bf16 v[60:63], v[76:79], v[188:191], v[60:63]
    ds_read_b128 v[72:75], v82 offset:9216
    ds_read_b128 v[76:79], v83 offset:9216
    s_waitcnt lgkmcnt(2)
    v_mfma_f32_16x16x32_bf16 v[32:35], a[192:195], v[64:67], v[32:35]
    v_mfma_f32_16x16x32_bf16 v[36:39], a[192:195], v[68:71], v[36:39]
    v_mfma_f32_16x16x32_bf16 v[40:43], a[196:199], v[64:67], v[40:43]
    v_mfma_f32_16x16x32_bf16 v[44:47], a[196:199], v[68:71], v[44:47]
    v_mfma_f32_16x16x32_bf16 v[48:51], v[64:67], v[192:195], v[48:51]
    v_mfma_f32_16x16x32_bf16 v[56:59], v[68:71], v[192:195], v[56:59]
    v_mfma_f32_16x16x32_bf16 v[52:55], v[64:67], v[196:199], v[52:55]
    v_mfma_f32_16x16x32_bf16 v[60:63], v[68:71], v[196:199], v[60:63]
    ds_read_b128 v[64:67], v80 offset:10240
    ds_read_b128 v[68:71], v81 offset:10240
    s_waitcnt lgkmcnt(2)
    v_mfma_f32_16x16x32_bf16 v[32:35], a[200:203], v[72:75], v[32:35]
    v_mfma_f32_16x16x32_bf16 v[36:39], a[200:203], v[76:79], v[36:39]
    v_mfma_f32_16x16x32_bf16 v[40:43], a[204:207], v[72:75], v[40:43]
    v_mfma_f32_16x16x32_bf16 v[44:47], a[204:207], v[76:79], v[44:47]
    v_mfma_f32_16x16x32_bf16 v[48:51], v[72:75], v[200:203], v[48:51]
    v_mfma_f32_16x16x32_bf16 v[56:59], v[76:79], v[200:203], v[56:59]
    v_mfma_f32_16x16x32_bf16 v[52:55], v[72:75], v[204:207], v[52:55]
    v_mfma_f32_16x16x32_bf16 v[60:63], v[76:79], v[204:207], v[60:63]
    ds_read_b128 v[72:75], v82 offset:11264
    ds_read_b128 v[76:79], v83 offset:11264
    s_waitcnt lgkmcnt(2)
    v_mfma_f32_16x16x32_bf16 v[32:35], a[208:211], v[64:67], v[32:35]
    v_mfma_f32_16x16x32_bf16 v[36:39], a[208:211], v[68:71], v[36:39]
    v_mfma_f32_16x16x32_bf16 v[40:43], a[212:215], v[64:67], v[40:43]
    v_mfma_f32_16x16x32_bf16 v[44:47], a[212:215], v[68:71], v[44:47]
    v_mfma_f32_16x16x32_bf16 v[48:51], v[64:67], v[208:211], v[48:51]
    v_mfma_f32_16x16x32_bf16 v[56:59], v[68:71], v[208:211], v[56:59]
    v_mfma_f32_16x16x32_bf16 v[52:55], v[64:67], v[212:215], v[52:55]
    v_mfma_f32_16x16x32_bf16 v[60:63], v[68:71], v[212:215], v[60:63]
    ds_read_b128 v[64:67], v80 offset:12288
    ds_read_b128 v[68:71], v81 offset:12288
    s_waitcnt lgkmcnt(2)
    v_mfma_f32_16x16x32_bf16 v[32:35], a[216:219], v[72:75], v[32:35]
    v_mfma_f32_16x16x32_bf16 v[36:39], a[216:219], v[76:79], v[36:39]
    v_mfma_f32_16x16x32_bf16 v[40:43], a[220:223], v[72:75], v[40:43]
    v_mfma_f32_16x16x32_bf16 v[44:47], a[220:223], v[76:79], v[44:47]
    v_mfma_f32_16x16x32_bf16 v[48:51], v[72:75], v[216:219], v[48:51]
    v_mfma_f32_16x16x32_bf16 v[56:59], v[76:79], v[216:219], v[56:59]
    v_mfma_f32_16x16x32_bf16 v[52:55], v[72:75], v[220:223], v[52:55]
    v_mfma_f32_16x16x32_bf16 v[60:63], v[76:79], v[220:223], v[60:63]
    ds_read_b128 v[72:75], v82 offset:13312
    ds_read_b128 v[76:79], v83 offset:13312
    s_waitcnt lgkmcnt(2)
    v_mfma_f32_16x16x32_bf16 v[32:35], a[224:227], v[64:67], v[32:35]
    v_mfma_f32_16x16x32_bf16 v[36:39], a[224:227], v[68:71], v[36:39]
    v_mfma_f32_16x16x32_bf16 v[40:43], a[228:231], v[64:67], v[40:43]
    v_mfma_f32_16x16x32_bf16 v[44:47], a[228:231], v[68:71], v[44:47]
    v_mfma_f32_16x16x32_bf16 v[48:51], v[64:67], v[224:227], v[48:51]
    v_mfma_f32_16x16x32_bf16 v[56:59], v[68:71], v[224:227], v[56:59]
    v_mfma_f32_16x16x32_bf16 v[52:55], v[64:67], v[228:231], v[52:55]
    v_mfma_f32_16x16x32_bf16 v[60:63], v[68:71], v[228:231], v[60:63]
    ds_read_b128 v[64:67], v80 offset:14336
    ds_read_b128 v[68:71], v81 offset:14336
    s_waitcnt lgkmcnt(2)
    v_mfma_f32_16x16x32_bf16 v[32:35], a[232:235], v[72:75], v[32:35]
    v_mfma_f32_16x16x32_bf16 v[36:39], a[232:235], v[76:79], v[36:39]
    v_mfma_f32_16x16x32_bf16 v[40:43], a[236:239], v[72:75], v[40:43]
    v_mfma_f32_16x16x32_bf16 v[44:47], a[236:239], v[76:79], v[44:47]
    v_mfma_f32_16x16x32_bf16 v[48:51], v[72:75], v[232:235], v[48:51]
    v_mfma_f32_16x16x32_bf16 v[56:59], v[76:79], v[232:235], v[56:59]
    v_mfma_f32_16x16x32_bf16 v[52:55], v[72:75], v[236:239], v[52:55]
    v_mfma_f32_16x16x32_bf16 v[60:63], v[76:79], v[236:239], v[60:63]
    ds_read_b128 v[72:75], v82 offset:15360
    ds_read_b128 v[76:79], v83 offset:15360
    s_waitcnt lgkmcnt(2)
    v_mfma_f32_16x16x32_bf16 v[32:35], a[240:243], v[64:67], v[32:35]
    v_mfma_f32_16x16x32_bf16 v[36:39], a[240:243], v[68:71], v[36:39]
    v_mfma_f32_16x16x32_bf16 v[40:43], a[244:247], v[64:67], v[40:43]
    v_mfma_f32_16x16x32_bf16 v[44:47], a[244:247], v[68:71], v[44:47]
    v_mfma_f32_16x16x32_bf16 v[48:51], v[64:67], v[240:243], v[48:51]
    v_mfma_f32_16x16x32_bf16 v[56:59], v[68:71], v[240:243], v[56:59]
    v_mfma_f32_16x16x32_bf16 v[52:55], v[64:67], v[244:247], v[52:55]
    v_mfma_f32_16x16x32_bf16 v[60:63], v[68:71], v[244:247], v[60:63]
    s_waitcnt lgkmcnt(0)
    v_mfma_f32_16x16x32_bf16 v[32:35], a[248:251], v[72:75], v[32:35]
    v_mfma_f32_16x16x32_bf16 v[36:39], a[248:251], v[76:79], v[36:39]
    v_mfma_f32_16x16x32_bf16 v[40:43], a[252:255], v[72:75], v[40:43]
    v_mfma_f32_16x16x32_bf16 v[44:47], a[252:255], v[76:79], v[44:47]
    v_mfma_f32_16x16x32_bf16 v[48:51], v[72:75], v[248:251], v[48:51]
    v_mfma_f32_16x16x32_bf16 v[56:59], v[76:79], v[248:251], v[56:59]
    v_mfma_f32_16x16x32_bf16 v[52:55], v[72:75], v[252:255], v[52:55]
    v_mfma_f32_16x16x32_bf16 v[60:63], v[76:79], v[252:255], v[60:63]
    s_nop 0
    v_mul_f32 v32, s33, v32
    v_mul_f32 v33, s33, v33
    v_mul_f32 v34, s33, v34
    v_mul_f32 v35, s33, v35
    v_mul_f32 v36, s33, v36
    v_mul_f32 v37, s33, v37
    v_mul_f32 v38, s33, v38
    v_mul_f32 v39, s33, v39
    v_mul_f32 v40, s33, v40
    v_mul_f32 v41, s33, v41
    v_mul_f32 v42, s33, v42
    v_mul_f32 v43, s33, v43
    v_mul_f32 v44, s33, v44
    v_mul_f32 v45, s33, v45
    v_mul_f32 v46, s33, v46
    v_mul_f32 v47, s33, v47
    v_cvt_pk_bf16_f32 v88, v32, v40
    v_cvt_pk_bf16_f32 v89, v33, v41
    v_cvt_pk_bf16_f32 v90, v34, v42
    v_cvt_pk_bf16_f32 v91, v35, v43
    v_cvt_pk_bf16_f32 v92, v36, v44
    v_cvt_pk_bf16_f32 v93, v37, v45
    v_cvt_pk_bf16_f32 v94, v38, v46
    v_cvt_pk_bf16_f32 v95, v39, v47
    v_cvt_pk_bf16_f32 v96, v48, v49
    v_cvt_pk_bf16_f32 v97, v50, v51
    v_cvt_pk_bf16_f32 v98, v56, v57
    v_cvt_pk_bf16_f32 v99, v58, v59
    v_cvt_pk_bf16_f32 v100, v52, v53
    v_cvt_pk_bf16_f32 v101, v54, v55
    v_cvt_pk_bf16_f32 v102, v60, v61
    v_cvt_pk_bf16_f32 v103, v62, v63
    s_mul_i32 s24, s23, 0x82100
    s_lshl_b32 s36, s20, 14
    s_add_u32 s24, s24, s36
    s_add_u32 s24, s24, 0x1000000
    s_mov_b32 s30, s24
    s_lshr_b32 s36, s21, 1
    s_lshl_b32 s36, s36, 12
    s_xor_b32 s37, s36, 4096
    s_add_u32 s36, s36, s24
    s_add_u32 s37, s37, s24
    buffer_store_dwordx4 v[88:91], v9, s[8:11], s36 offen sc1
    buffer_store_dwordx4 v[92:95], v9, s[8:11], s37 offen sc1
    s_add_u32 s24, s24, 8192
    buffer_store_dwordx4 v[96:99], v2, s[8:11], s24 offen sc1
    buffer_store_dwordx4 v[100:103], v2, s[8:11], s24 offen offset:1024 sc1
    s_mul_i32 s25, s23, 0x82100
    s_lshl_b32 s36, s20, 2
    s_add_u32 s25, s25, s36
    s_add_u32 s25, s25, 0x1082000
    v_lshrrev_b32 v15, 2, v1
    v_and_b32 v15, 127, v15
L_WHS:
    buffer_load_dword v14, v15, s[16:19], 0 offen sc1
    s_add_u32 s32, s32, 1
    s_cmp_gt_u32 s32, 200000
    s_cbranch_scc1 L_WHS_done
    s_waitcnt vmcnt(0)
    v_cmp_eq_u32 vcc, 0, v14
    s_cbranch_vccnz L_WHS
L_WHS_done:
    s_waitcnt vmcnt(0)
    s_barrier
    v_cmp_ne_u32 vcc, 0, v0
    v_mov_b32 v15, 0x40000000
    v_mov_b32 v14, 1
    v_cndmask_b32 v15, v0, v15, vcc
    buffer_store_dword v14, v15, s[8:11], s25 offen sc1
    s_barrier
    ds_read_b64_tr_b16 a[0:1], v20 offset:0
    ds_read_b64_tr_b16 a[2:3], v20 offset:1024
    ds_read_b64_tr_b16 a[4:5], v21 offset:0
    ds_read_b64_tr_b16 a[6:7], v21 offset:1024
    ds_read_b64_tr_b16 a[8:9], v22 offset:0
    ds_read_b64_tr_b16 a[10:11], v22 offset:1024
    ds_read_b64_tr_b16 a[12:13], v23 offset:0
    ds_read_b64_tr_b16 a[14:15], v23 offset:1024
    ds_read_b64_tr_b16 a[16:17], v24 offset:0
    ds_read_b64_tr_b16 a[18:19], v24 offset:1024
    ds_read_b64_tr_b16 a[20:21], v25 offset:0
    ds_read_b64_tr_b16 a[22:23], v25 offset:1024
    s_waitcnt lgkmcnt(4)
    ds_read_b64_tr_b16 a[24:25], v26 offset:0
    ds_read_b64_tr_b16 a[26:27], v26 offset:1024
    ds_read_b64_tr_b16 a[28:29], v27 offset:0
    ds_read_b64_tr_b16 a[30:31], v27 offset:1024
    s_waitcnt lgkmcnt(0)
    s_barrier
    s_barrier
    ds_read_b64_tr_b16 a[32:33], v20 offset:8192
    ds_read_b64_tr_b16 a[34:35], v20 offset:9216
    ds_read_b64_tr_b16 a[36:37], v21 offset:8192
    ds_read_b64_tr_b16 a[38:39], v21 offset:9216
    ds_read_b64_tr_b16 a[40:41], v22 offset:8192
    ds_read_b64_tr_b16 a[42:43], v22 offset:9216
    ds_read_b64_tr_b16 a[44:45], v23 offset:8192
    ds_read_b64_tr_b16 a[46:47], v23 offset:9216
    ds_read_b64_tr_b16 a[48:49], v24 offset:8192
    ds_read_b64_tr_b16 a[50:51], v24 offset:9216
    ds_read_b64_tr_b16 a[52:53], v25 offset:8192
    ds_read_b64_tr_b16 a[54:55], v25 offset:9216
    s_waitcnt lgkmcnt(4)
    ds_read_b64_tr_b16 a[56:57], v26 offset:8192
    ds_read_b64_tr_b16 a[58:59], v26 offset:9216
    ds_read_b64_tr_b16 a[60:61], v27 offset:8192
    ds_read_b64_tr_b16 a[62:63], v27 offset:9216
    s_waitcnt lgkmcnt(0)
    s_barrier
    s_barrier
    ds_read_b64_tr_b16 a[64:65], v20 offset:16384
    ds_read_b64_tr_b16 a[66:67], v20 offset:17408
    ds_read_b64_tr_b16 a[68:69], v21 offset:16384
    ds_read_b64_tr_b16 a[70:71], v21 offset:17408
    ds_read_b64_tr_b16 a[72:73], v22 offset:16384
    ds_read_b64_tr_b16 a[74:75], v22 offset:17408
    ds_read_b64_tr_b16 a[76:77], v23 offset:16384
    ds_read_b64_tr_b16 a[78:79], v23 offset:17408
    ds_read_b64_tr_b16 a[80:81], v24 offset:16384
    ds_read_b64_tr_b16 a[82:83], v24 offset:17408
    ds_read_b64_tr_b16 a[84:85], v25 offset:16384
    ds_read_b64_tr_b16 a[86:87], v25 offset:17408
    s_waitcnt lgkmcnt(4)
    ds_read_b64_tr_b16 a[88:89], v26 offset:16384
    ds_read_b64_tr_b16 a[90:91], v26 offset:17408
    ds_read_b64_tr_b16 a[92:93], v27 offset:16384
    ds_read_b64_tr_b16 a[94:95], v27 offset:17408
    s_waitcnt lgkmcnt(0)
    s_barrier
    s_barrier
    ds_read_b64_tr_b16 a[96:97], v20 offset:24576
    ds_read_b64_tr_b16 a[98:99], v20 offset:25600
    ds_read_b64_tr_b16 a[100:101], v21 offset:24576
    ds_read_b64_tr_b16 a[102:103], v21 offset:25600
    ds_read_b64_tr_b16 a[104:105], v22 offset:24576
    ds_read_b64_tr_b16 a[106:107], v22 offset:25600
    ds_read_b64_tr_b16 a[108:109], v23 offset:24576
    ds_read_b64_tr_b16 a[110:111], v23 offset:25600
    ds_read_b64_tr_b16 a[112:113], v24 offset:24576
    ds_read_b64_tr_b16 a[114:115], v24 offset:25600
    ds_read_b64_tr_b16 a[116:117], v25 offset:24576
    ds_read_b64_tr_b16 a[118:119], v25 offset:25600
    s_waitcnt lgkmcnt(4)
    ds_read_b64_tr_b16 a[120:121], v26 offset:24576
    ds_read_b64_tr_b16 a[122:123], v26 offset:25600
    ds_read_b64_tr_b16 a[124:125], v27 offset:24576
    ds_read_b64_tr_b16 a[126:127], v27 offset:25600
    s_waitcnt lgkmcnt(0)
    s_barrier
L_P1:
    s_waitcnt vmcnt(6)
    s_barrier
    s_xor_b32 s31, s31, 32768
    s_add_u32 s24, s23, 6
    s_min_u32 s24, s24, 63
    s_lshl_b32 s36, s24, 15
    s_add_u32 s36, s36, 0x800000
    s_lshl_b32 s37, s21, 10
    s_add_u32 s37, s37, s31
    s_add_u32 m0, s37, 0
    s_add_u32 s38, s36, 0
    buffer_load_dwordx4 v9, s[8:11], s38 offen sc1 lds
    s_add_u32 m0, s37, 4096
    s_add_u32 s38, s36, 4096
    buffer_load_dwordx4 v9, s[8:11], s38 offen sc1 lds
    s_add_u32 m0, s37, 8192
    s_add_u32 s38, s36, 8192
    buffer_load_dwordx4 v9, s[8:11], s38 offen sc1 lds
    s_add_u32 m0, s37, 12288
    s_add_u32 s38, s36, 12288
    buffer_load_dwordx4 v9, s[8:11], s38 offen sc1 lds
    s_add_u32 m0, s37, 16384
    s_add_u32 s38, s36, 16384
    buffer_load_dwordx4 v9, s[8:11], s38 offen sc1 lds
    s_add_u32 m0, s37, 20480
    s_add_u32 s38, s36, 20480
    buffer_load_dwordx4 v9, s[8:11], s38 offen sc1 lds
    s_add_u32 m0, s37, 24576
    s_add_u32 s38, s36, 24576
    buffer_load_dwordx4 v9, s[8:11], s38 offen sc1 lds
    s_add_u32 m0, s37, 28672
    s_add_u32 s38, s36, 28672
    buffer_load_dwordx4 v9, s[8:11], s38 offen sc1 lds
    ds_read_b128 v[64:67], v80 offset:0
    ds_read_b128 v[68:71], v81 offset:0
    ds_read_b128 v[72:75], v82 offset:1024
    ds_read_b128 v[76:79], v83 offset:1024
    s_waitcnt lgkmcnt(2)
    v_mfma_f32_16x16x32_bf16 v[32:35], a[128:131], v[64:67], 0
    v_mfma_f32_16x16x32_bf16 v[36:39], a[128:131], v[68:71], 0
    v_mfma_f32_16x16x32_bf16 v[40:43], a[132:135], v[64:67], 0
    v_mfma_f32_16x16x32_bf16 v[44:47], a[132:135], v[68:71], 0
    v_mfma_f32_16x16x32_bf16 v[48:51], v[64:67], v[128:131], 0
    v_mfma_f32_16x16x32_bf16 v[56:59], v[68:71], v[128:131], 0
    v_mfma_f32_16x16x32_bf16 v[52:55], v[64:67], v[132:135], 0
    v_mfma_f32_16x16x32_bf16 v[60:63], v[68:71], v[132:135], 0
    v_mfma_f32_16x16x32_bf16 v[16:19], a[0:3], v[64:67], 0
    v_mfma_f32_16x16x32_bf16 v[20:23], a[0:3], v[68:71], 0
    v_mfma_f32_16x16x32_bf16 v[24:27], a[4:7], v[64:67], 0
    v_mfma_f32_16x16x32_bf16 v[28:31], a[4:7], v[68:71], 0
    ds_read_b128 v[64:67], v80 offset:2048
    ds_read_b128 v[68:71], v81 offset:2048
    s_waitcnt lgkmcnt(2)
    v_mfma_f32_16x16x32_bf16 v[32:35], a[136:139], v[72:75], v[32:35]
    v_mfma_f32_16x16x32_bf16 v[36:39], a[136:139], v[76:79], v[36:39]
    v_mfma_f32_16x16x32_bf16 v[40:43], a[140:143], v[72:75], v[40:43]
    v_mfma_f32_16x16x32_bf16 v[44:47], a[140:143], v[76:79], v[44:47]
    v_mfma_f32_16x16x32_bf16 v[48:51], v[72:75], v[136:139], v[48:51]
    v_mfma_f32_16x16x32_bf16 v[56:59], v[76:79], v[136:139], v[56:59]
    v_mfma_f32_16x16x32_bf16 v[52:55], v[72:75], v[140:143], v[52:55]
    v_mfma_f32_16x16x32_bf16 v[60:63], v[76:79], v[140:143], v[60:63]
    v_mfma_f32_16x16x32_bf16 v[16:19], a[8:11], v[72:75], v[16:19]
    v_mfma_f32_16x16x32_bf16 v[20:23], a[8:11], v[76:79], v[20:23]
    v_mfma_f32_16x16x32_bf16 v[24:27], a[12:15], v[72:75], v[24:27]
    v_mfma_f32_16x16x32_bf16 v[28:31], a[12:15], v[76:79], v[28:31]
    ds_read_b128 v[72:75], v82 offset:3072
    ds_read_b128 v[76:79], v83 offset:3072
    s_waitcnt lgkmcnt(2)
    v_mfma_f32_16x16x32_bf16 v[32:35], a[144:147], v[64:67], v[32:35]
    v_mfma_f32_16x16x32_bf16 v[36:39], a[144:147], v[68:71], v[36:39]
    v_mfma_f32_16x16x32_bf16 v[40:43], a[148:151], v[64:67], v[40:43]
    v_mfma_f32_16x16x32_bf16 v[44:47], a[148:151], v[68:71], v[44:47]
    v_mfma_f32_16x16x32_bf16 v[48:51], v[64:67], v[144:147], v[48:51]
    v_mfma_f32_16x16x32_bf16 v[56:59], v[68:71], v[144:147], v[56:59]
    v_mfma_f32_16x16x32_bf16 v[52:55], v[64:67], v[148:151], v[52:55]
    v_mfma_f32_16x16x32_bf16 v[60:63], v[68:71], v[148:151], v[60:63]
    v_mfma_f32_16x16x32_bf16 v[16:19], a[16:19], v[64:67], v[16:19]
    v_mfma_f32_16x16x32_bf16 v[20:23], a[16:19], v[68:71], v[20:23]
    v_mfma_f32_16x16x32_bf16 v[24:27], a[20:23], v[64:67], v[24:27]
    v_mfma_f32_16x16x32_bf16 v[28:31], a[20:23], v[68:71], v[28:31]
    ds_read_b128 v[64:67], v80 offset:4096
    ds_read_b128 v[68:71], v81 offset:4096
    s_waitcnt lgkmcnt(2)
    v_mfma_f32_16x16x32_bf16 v[32:35], a[152:155], v[72:75], v[32:35]
    v_mfma_f32_16x16x32_bf16 v[36:39], a[152:155], v[76:79], v[36:39]
    v_mfma_f32_16x16x32_bf16 v[40:43], a[156:159], v[72:75], v[40:43]
    v_mfma_f32_16x16x32_bf16 v[44:47], a[156:159], v[76:79], v[44:47]
    v_mfma_f32_16x16x32_bf16 v[48:51], v[72:75], v[152:155], v[48:51]
    v_mfma_f32_16x16x32_bf16 v[56:59], v[76:79], v[152:155], v[56:59]
    v_mfma_f32_16x16x32_bf16 v[52:55], v[72:75], v[156:159], v[52:55]
    v_mfma_f32_16x16x32_bf16 v[60:63], v[76:79], v[156:159], v[60:63]
    v_mfma_f32_16x16x32_bf16 v[16:19], a[24:27], v[72:75], v[16:19]
    v_mfma_f32_16x16x32_bf16 v[20:23], a[24:27], v[76:79], v[20:23]
    v_mfma_f32_16x16x32_bf16 v[24:27], a[28:31], v[72:75], v[24:27]
    v_mfma_f32_16x16x32_bf16 v[28:31], a[28:31], v[76:79], v[28:31]
    ds_read_b128 v[72:75], v82 offset:5120
    ds_read_b128 v[76:79], v83 offset:5120
    s_waitcnt lgkmcnt(2)
    v_mfma_f32_16x16x32_bf16 v[32:35], a[160:163], v[64:67], v[32:35]
    v_mfma_f32_16x16x32_bf16 v[36:39], a[160:163], v[68:71], v[36:39]
    v_mfma_f32_16x16x32_bf16 v[40:43], a[164:167], v[64:67], v[40:43]
    v_mfma_f32_16x16x32_bf16 v[44:47], a[164:167], v[68:71], v[44:47]
    v_mfma_f32_16x16x32_bf16 v[48:51], v[64:67], v[160:163], v[48:51]
    v_mfma_f32_16x16x32_bf16 v[56:59], v[68:71], v[160:163], v[56:59]
    v_mfma_f32_16x16x32_bf16 v[52:55], v[64:67], v[164:167], v[52:55]
    v_mfma_f32_16x16x32_bf16 v[60:63], v[68:71], v[164:167], v[60:63]
    v_mfma_f32_16x16x32_bf16 v[16:19], a[32:35], v[64:67], v[16:19]
    v_mfma_f32_16x16x32_bf16 v[20:23], a[32:35], v[68:71], v[20:23]
    v_mfma_f32_16x16x32_bf16 v[24:27], a[36:39], v[64:67], v[24:27]
    v_mfma_f32_16x16x32_bf16 v[28:31], a[36:39], v[68:71], v[28:31]
    ds_read_b128 v[64:67], v80 offset:6144
    ds_read_b128 v[68:71], v81 offset:6144
    s_waitcnt lgkmcnt(2)
    v_mfma_f32_16x16x32_bf16 v[32:35], a[168:171], v[72:75], v[32:35]
    v_mfma_f32_16x16x32_bf16 v[36:39], a[168:171], v[76:79], v[36:39]
    v_mfma_f32_16x16x32_bf16 v[40:43], a[172:175], v[72:75], v[40:43]
    v_mfma_f32_16x16x32_bf16 v[44:47], a[172:175], v[76:79], v[44:47]
    v_mfma_f32_16x16x32_bf16 v[48:51], v[72:75], v[168:171], v[48:51]
    v_mfma_f32_16x16x32_bf16 v[56:59], v[76:79], v[168:171], v[56:59]
    v_mfma_f32_16x16x32_bf16 v[52:55], v[72:75], v[172:175], v[52:55]
    v_mfma_f32_16x16x32_bf16 v[60:63], v[76:79], v[172:175], v[60:63]
    v_mfma_f32_16x16x32_bf16 v[16:19], a[40:43], v[72:75], v[16:19]
    v_mfma_f32_16x16x32_bf16 v[20:23], a[40:43], v[76:79], v[20:23]
    v_mfma_f32_16x16x32_bf16 v[24:27], a[44:47], v[72:75], v[24:27]
    v_mfma_f32_16x16x32_bf16 v[28:31], a[44:47], v[76:79], v[28:31]
    ds_read_b128 v[72:75], v82 offset:7168
    ds_read_b128 v[76:79], v83 offset:7168
    s_waitcnt lgkmcnt(2)
    s_waitcnt vmcnt(8)
    s_barrier
    v_cmp_ne_u32 vcc, 0, v0
    v_mov_b32 v15, 0x40000000
    v_mov_b32 v14, 1
    v_cndmask_b32 v15, v0, v15, vcc
    buffer_store_dword v14, v15, s[8:11], s25 offen sc1
    v_mfma_f32_16x16x32_bf16 v[32:35], a[176:179], v[64:67], v[32:35]
    v_mfma_f32_16x16x32_bf16 v[36:39], a[176:179], v[68:71], v[36:39]
    v_mfma_f32_16x16x32_bf16 v[40:43], a[180:183], v[64:67], v[40:43]
    v_mfma_f32_16x16x32_bf16 v[44:47], a[180:183], v[68:71], v[44:47]
    v_mfma_f32_16x16x32_bf16 v[48:51], v[64:67], v[176:179], v[48:51]
    v_mfma_f32_16x16x32_bf16 v[56:59], v[68:71], v[176:179], v[56:59]
    v_mfma_f32_16x16x32_bf16 v[52:55], v[64:67], v[180:183], v[52:55]
    v_mfma_f32_16x16x32_bf16 v[60:63], v[68:71], v[180:183], v[60:63]
    v_mfma_f32_16x16x32_bf16 v[16:19], a[48:51], v[64:67], v[16:19]
    v_mfma_f32_16x16x32_bf16 v[20:23], a[48:51], v[68:71], v[20:23]
    v_mfma_f32_16x16x32_bf16 v[24:27], a[52:55], v[64:67], v[24:27]
    v_mfma_f32_16x16x32_bf16 v[28:31], a[52:55], v[68:71], v[28:31]
    ds_read_b128 v[64:67], v80 offset:8192
    ds_read_b128 v[68:71], v81 offset:8192
    s_waitcnt lgkmcnt(2)
    v_mfma_f32_16x16x32_bf16 v[32:35], a[184:187], v[72:75], v[32:35]
    v_mfma_f32_16x16x32_bf16 v[36:39], a[184:187], v[76:79], v[36:39]
    v_mfma_f32_16x16x32_bf16 v[40:43], a[188:191], v[72:75], v[40:43]
    v_mfma_f32_16x16x32_bf16 v[44:47], a[188:191], v[76:79], v[44:47]
    v_mfma_f32_16x16x32_bf16 v[48:51], v[72:75], v[184:187], v[48:51]
    v_mfma_f32_16x16x32_bf16 v[56:59], v[76:79], v[184:187], v[56:59]
    v_mfma_f32_16x16x32_bf16 v[52:55], v[72:75], v[188:191], v[52:55]
    v_mfma_f32_16x16x32_bf16 v[60:63], v[76:79], v[188:191], v[60:63]
    v_mfma_f32_16x16x32_bf16 v[16:19], a[56:59], v[72:75], v[16:19]
    v_mfma_f32_16x16x32_bf16 v[20:23], a[56:59], v[76:79], v[20:23]
    v_mfma_f32_16x16x32_bf16 v[24:27], a[60:63], v[72:75], v[24:27]
    v_mfma_f32_16x16x32_bf16 v[28:31], a[60:63], v[76:79], v[28:31]
    ds_read_b128 v[72:75], v82 offset:9216
    ds_read_b128 v[76:79], v83 offset:9216
    s_waitcnt lgkmcnt(2)
    v_mfma_f32_16x16x32_bf16 v[32:35], a[192:195], v[64:67], v[32:35]
    v_mfma_f32_16x16x32_bf16 v[36:39], a[192:195], v[68:71], v[36:39]
    v_mfma_f32_16x16x32_bf16 v[40:43], a[196:199], v[64:67], v[40:43]
    v_mfma_f32_16x16x32_bf16 v[44:47], a[196:199], v[68:71], v[44:47]
    v_mfma_f32_16x16x32_bf16 v[48:51], v[64:67], v[192:195], v[48:51]
    v_mfma_f32_16x16x32_bf16 v[56:59], v[68:71], v[192:195], v[56:59]
    v_mfma_f32_16x16x32_bf16 v[52:55], v[64:67], v[196:199], v[52:55]
    v_mfma_f32_16x16x32_bf16 v[60:63], v[68:71], v[196:199], v[60:63]
    v_mfma_f32_16x16x32_bf16 v[16:19], a[64:67], v[64:67], v[16:19]
    v_mfma_f32_16x16x32_bf16 v[20:23], a[64:67], v[68:71], v[20:23]
    v_mfma_f32_16x16x32_bf16 v[24:27], a[68:71], v[64:67], v[24:27]
    v_mfma_f32_16x16x32_bf16 v[28:31], a[68:71], v[68:71], v[28:31]
    ds_read_b128 v[64:67], v80 offset:10240
    ds_read_b128 v[68:71], v81 offset:10240
    s_waitcnt lgkmcnt(2)
    v_mfma_f32_16x16x32_bf16 v[32:35], a[200:203], v[72:75], v[32:35]
    v_mfma_f32_16x16x32_bf16 v[36:39], a[200:203], v[76:79], v[36:39]
    v_mfma_f32_16x16x32_bf16 v[40:43], a[204:207], v[72:75], v[40:43]
    v_mfma_f32_16x16x32_bf16 v[44:47], a[204:207], v[76:79], v[44:47]
    v_mfma_f32_16x16x32_bf16 v[48:51], v[72:75], v[200:203], v[48:51]
    v_mfma_f32_16x16x32_bf16 v[56:59], v[76:79], v[200:203], v[56:59]
    v_mfma_f32_16x16x32_bf16 v[52:55], v[72:75], v[204:207], v[52:55]
    v_mfma_f32_16x16x32_bf16 v[60:63], v[76:79], v[204:207], v[60:63]
    v_mfma_f32_16x16x32_bf16 v[16:19], a[72:75], v[72:75], v[16:19]
    v_mfma_f32_16x16x32_bf16 v[20:23], a[72:75], v[76:79], v[20:23]
    v_mfma_f32_16x16x32_bf16 v[24:27], a[76:79], v[72:75], v[24:27]
    v_mfma_f32_16x16x32_bf16 v[28:31], a[76:79], v[76:79], v[28:31]
    ds_read_b128 v[72:75], v82 offset:11264
    ds_read_b128 v[76:79], v83 offset:11264
    s_waitcnt lgkmcnt(2)
    v_mfma_f32_16x16x32_bf16 v[32:35], a[208:211], v[64:67], v[32:35]
    v_mfma_f32_16x16x32_bf16 v[36:39], a[208:211], v[68:71], v[36:39]
    v_mfma_f32_16x16x32_bf16 v[40:43], a[212:215], v[64:67], v[40:43]
    v_mfma_f32_16x16x32_bf16 v[44:47], a[212:215], v[68:71], v[44:47]
    v_mfma_f32_16x16x32_bf16 v[48:51], v[64:67], v[208:211], v[48:51]
    v_mfma_f32_16x16x32_bf16 v[56:59], v[68:71], v[208:211], v[56:59]
    v_mfma_f32_16x16x32_bf16 v[52:55], v[64:67], v[212:215], v[52:55]
    v_mfma_f32_16x16x32_bf16 v[60:63], v[68:71], v[212:215], v[60:63]
    v_mfma_f32_16x16x32_bf16 v[16:19], a[80:83], v[64:67], v[16:19]
    v_mfma_f32_16x16x32_bf16 v[20:23], a[80:83], v[68:71], v[20:23]
    v_mfma_f32_16x16x32_bf16 v[24:27], a[84:87], v[64:67], v[24:27]
    v_mfma_f32_16x16x32_bf16 v[28:31], a[84:87], v[68:71], v[28:31]
    ds_read_b128 v[64:67], v80 offset:12288
    ds_read_b128 v[68:71], v81 offset:12288
    s_waitcnt lgkmcnt(2)
    v_mfma_f32_16x16x32_bf16 v[32:35], a[216:219], v[72:75], v[32:35]
    v_mfma_f32_16x16x32_bf16 v[36:39], a[216:219], v[76:79], v[36:39]
    v_mfma_f32_16x16x32_bf16 v[40:43], a[220:223], v[72:75], v[40:43]
    v_mfma_f32_16x16x32_bf16 v[44:47], a[220:223], v[76:79], v[44:47]
    v_mfma_f32_16x16x32_bf16 v[48:51], v[72:75], v[216:219], v[48:51]
    v_mfma_f32_16x16x32_bf16 v[56:59], v[76:79], v[216:219], v[56:59]
    v_mfma_f32_16x16x32_bf16 v[52:55], v[72:75], v[220:223], v[52:55]
    v_mfma_f32_16x16x32_bf16 v[60:63], v[76:79], v[220:223], v[60:63]
    v_mfma_f32_16x16x32_bf16 v[16:19], a[88:91], v[72:75], v[16:19]
    v_mfma_f32_16x16x32_bf16 v[20:23], a[88:91], v[76:79], v[20:23]
    v_mfma_f32_16x16x32_bf16 v[24:27], a[92:95], v[72:75], v[24:27]
    v_mfma_f32_16x16x32_bf16 v[28:31], a[92:95], v[76:79], v[28:31]
    ds_read_b128 v[72:75], v82 offset:13312
    ds_read_b128 v[76:79], v83 offset:13312
    s_waitcnt lgkmcnt(2)
    v_mfma_f32_16x16x32_bf16 v[32:35], a[224:227], v[64:67], v[32:35]
    v_mfma_f32_16x16x32_bf16 v[36:39], a[224:227], v[68:71], v[36:39]
    v_mfma_f32_16x16x32_bf16 v[40:43], a[228:231], v[64:67], v[40:43]
    v_mfma_f32_16x16x32_bf16 v[44:47], a[228:231], v[68:71], v[44:47]
    v_mfma_f32_16x16x32_bf16 v[48:51], v[64:67], v[224:227], v[48:51]
    v_mfma_f32_16x16x32_bf16 v[56:59], v[68:71], v[224:227], v[56:59]
    v_mfma_f32_16x16x32_bf16 v[52:55], v[64:67], v[228:231], v[52:55]
    v_mfma_f32_16x16x32_bf16 v[60:63], v[68:71], v[228:231], v[60:63]
    v_mfma_f32_16x16x32_bf16 v[16:19], a[96:99], v[64:67], v[16:19]
    v_mfma_f32_16x16x32_bf16 v[20:23], a[96:99], v[68:71], v[20:23]
    v_mfma_f32_16x16x32_bf16 v[24:27], a[100:103], v[64:67], v[24:27]
    v_mfma_f32_16x16x32_bf16 v[28:31], a[100:103], v[68:71], v[28:31]
    ds_read_b128 v[64:67], v80 offset:14336
    ds_read_b128 v[68:71], v81 offset:14336
    s_waitcnt lgkmcnt(2)
    v_mfma_f32_16x16x32_bf16 v[32:35], a[232:235], v[72:75], v[32:35]
    v_mfma_f32_16x16x32_bf16 v[36:39], a[232:235], v[76:79], v[36:39]
    v_mfma_f32_16x16x32_bf16 v[40:43], a[236:239], v[72:75], v[40:43]
    v_mfma_f32_16x16x32_bf16 v[44:47], a[236:239], v[76:79], v[44:47]
    v_mfma_f32_16x16x32_bf16 v[48:51], v[72:75], v[232:235], v[48:51]
    v_mfma_f32_16x16x32_bf16 v[56:59], v[76:79], v[232:235], v[56:59]
    v_mfma_f32_16x16x32_bf16 v[52:55], v[72:75], v[236:239], v[52:55]
    v_mfma_f32_16x16x32_bf16 v[60:63], v[76:79], v[236:239], v[60:63]
    v_mfma_f32_16x16x32_bf16 v[16:19], a[104:107], v[72:75], v[16:19]
    v_mfma_f32_16x16x32_bf16 v[20:23], a[104:107], v[76:79], v[20:23]
    v_mfma_f32_16x16x32_bf16 v[24:27], a[108:111], v[72:75], v[24:27]
    v_mfma_f32_16x16x32_bf16 v[28:31], a[108:111], v[76:79], v[28:31]
    ds_read_b128 v[72:75], v82 offset:15360
    ds_read_b128 v[76:79], v83 offset:15360
    s_waitcnt lgkmcnt(2)
    v_mfma_f32_16x16x32_bf16 v[32:35], a[240:243], v[64:67], v[32:35]
    v_mfma_f32_16x16x32_bf16 v[36:39], a[240:243], v[68:71], v[36:39]
    v_mfma_f32_16x16x32_bf16 v[40:43], a[244:247], v[64:67], v[40:43]
    v_mfma_f32_16x16x32_bf16 v[44:47], a[244:247], v[68:71], v[44:47]
    v_mfma_f32_16x16x32_bf16 v[48:51], v[64:67], v[240:243], v[48:51]
    v_mfma_f32_16x16x32_bf16 v[56:59], v[68:71], v[240:243], v[56:59]
    v_mfma_f32_16x16x32_bf16 v[52:55], v[64:67], v[244:247], v[52:55]
    v_mfma_f32_16x16x32_bf16 v[60:63], v[68:71], v[244:247], v[60:63]
    v_mfma_f32_16x16x32_bf16 v[16:19], a[112:115], v[64:67], v[16:19]
    v_mfma_f32_16x16x32_bf16 v[20:23], a[112:115], v[68:71], v[20:23]
    v_mfma_f32_16x16x32_bf16 v[24:27], a[116:119], v[64:67], v[24:27]
    v_mfma_f32_16x16x32_bf16 v[28:31], a[116:119], v[68:71], v[28:31]
    s_waitcnt lgkmcnt(0)
    v_mfma_f32_16x16x32_bf16 v[32:35], a[248:251], v[72:75], v[32:35]
    v_mfma_f32_16x16x32_bf16 v[36:39], a[248:251], v[76:79], v[36:39]
    v_mfma_f32_16x16x32_bf16 v[40:43], a[252:255], v[72:75], v[40:43]
    v_mfma_f32_16x16x32_bf16 v[44:47], a[252:255], v[76:79], v[44:47]
    v_mfma_f32_16x16x32_bf16 v[48:51], v[72:75], v[248:251], v[48:51]
    v_mfma_f32_16x16x32_bf16 v[56:59], v[76:79], v[248:251], v[56:59]
    v_mfma_f32_16x16x32_bf16 v[52:55], v[72:75], v[252:255], v[52:55]
    v_mfma_f32_16x16x32_bf16 v[60:63], v[76:79], v[252:255], v[60:63]
    v_mfma_f32_16x16x32_bf16 v[16:19], a[120:123], v[72:75], v[16:19]
    v_mfma_f32_16x16x32_bf16 v[20:23], a[120:123], v[76:79], v[20:23]
    v_mfma_f32_16x16x32_bf16 v[24:27], a[124:127], v[72:75], v[24:27]
    v_mfma_f32_16x16x32_bf16 v[28:31], a[124:127], v[76:79], v[28:31]
    v_xor_b32 v80, 0x8000, v80
    v_xor_b32 v81, 0x8000, v81
    v_xor_b32 v82, 0x8000, v82
    v_xor_b32 v83, 0x8000, v83
    v_mul_f32 v32, s33, v32
    v_mul_f32 v33, s33, v33
    v_mul_f32 v34, s33, v34
    v_mul_f32 v35, s33, v35
    v_mul_f32 v36, s33, v36
    v_mul_f32 v37, s33, v37
    v_mul_f32 v38, s33, v38
    v_mul_f32 v39, s33, v39
    v_mul_f32 v40, s33, v40
    v_mul_f32 v41, s33, v41
    v_mul_f32 v42, s33, v42
    v_mul_f32 v43, s33, v43
    v_mul_f32 v44, s33, v44
    v_mul_f32 v45, s33, v45
    v_mul_f32 v46, s33, v46
    v_mul_f32 v47, s33, v47
    v_cvt_pk_bf16_f32 v88, v32, v40
    v_cvt_pk_bf16_f32 v89, v33, v41
    v_cvt_pk_bf16_f32 v90, v34, v42
    v_cvt_pk_bf16_f32 v91, v35, v43
    v_cvt_pk_bf16_f32 v92, v36, v44
    v_cvt_pk_bf16_f32 v93, v37, v45
    v_cvt_pk_bf16_f32 v94, v38, v46
    v_cvt_pk_bf16_f32 v95, v39, v47
    v_cvt_pk_bf16_f32 v96, v48, v49
    v_cvt_pk_bf16_f32 v97, v50, v51
    v_cvt_pk_bf16_f32 v98, v56, v57
    v_cvt_pk_bf16_f32 v99, v58, v59
    v_cvt_pk_bf16_f32 v100, v52, v53
    v_cvt_pk_bf16_f32 v101, v54, v55
    v_cvt_pk_bf16_f32 v102, v60, v61
    v_cvt_pk_bf16_f32 v103, v62, v63
    v_cvt_pk_bf16_f32 v104, v16, v24
    v_cvt_pk_bf16_f32 v105, v17, v25
    v_cvt_pk_bf16_f32 v106, v18, v26
    v_cvt_pk_bf16_f32 v107, v19, v27
    v_cvt_pk_bf16_f32 v108, v20, v28
    v_cvt_pk_bf16_f32 v109, v21, v29
    v_cvt_pk_bf16_f32 v110, v22, v30
    v_cvt_pk_bf16_f32 v111, v23, v31
    s_mul_i32 s24, s23, 0x82100
    s_lshl_b32 s36, s20, 14
    s_add_u32 s24, s24, s36
    s_add_u32 s24, s24, 0x1000000
    s_mov_b32 s30, s24
    s_lshr_b32 s36, s21, 1
    s_lshl_b32 s36, s36, 12
    s_xor_b32 s37, s36, 4096
    s_add_u32 s36, s36, s24
    s_add_u32 s37, s37, s24
    buffer_store_dwordx4 v[88:91], v9, s[8:11], s36 offen sc1
    buffer_store_dwordx4 v[92:95], v9, s[8:11], s37 offen sc1
    s_add_u32 s24, s24, 8192
    buffer_store_dwordx4 v[96:99], v2, s[8:11], s24 offen sc1
    buffer_store_dwordx4 v[100:103], v2, s[8:11], s24 offen offset:1024 sc1
    s_add_u32 s36, s36, 0x7000000
    s_add_u32 s37, s37, 0x7000000
    buffer_store_dwordx4 v[104:107], v9, s[8:11], s36 offen sc1
    buffer_store_dwordx4 v[108:111], v9, s[8:11], s37 offen sc1
    s_mul_i32 s25, s23, 0x82100
    s_lshl_b32 s36, s20, 2
    s_add_u32 s25, s25, s36
    s_add_u32 s25, s25, 0x1082000
    s_add_u32 s23, s23, 6
    s_cmp_lt_u32 s23, 64
    s_cbranch_scc1 L_P1
    v_mov_b32 v20, -1
    v_mov_b32 v21, -1
    v_mov_b32 v22, -1
    v_mov_b32 v23, -1
    s_lshl_b32 s24, s22, 21
    s_lshl_b32 s36, s20, 15
    s_add_u32 s24, s24, s36
    s_add_u32 s36, s24, 0x4000000
    buffer_store_dwordx4 v[20:23], v11, s[8:11], s36 offen sc1
    s_add_u32 s36, s24, 0x4001000
    buffer_store_dwordx4 v[20:23], v11, s[8:11], s36 offen sc1
    s_add_u32 s36, s24, 0x4002000
    buffer_store_dwordx4 v[20:23], v11, s[8:11], s36 offen sc1
    s_add_u32 s36, s24, 0x4003000
    buffer_store_dwordx4 v[20:23], v11, s[8:11], s36 offen sc1
    s_add_u32 s36, s24, 0x4004000
    buffer_store_dwordx4 v[20:23], v11, s[8:11], s36 offen sc1
    s_add_u32 s36, s24, 0x4005000
    buffer_store_dwordx4 v[20:23], v11, s[8:11], s36 offen sc1
    s_add_u32 s36, s24, 0x4006000
    buffer_store_dwordx4 v[20:23], v11, s[8:11], s36 offen sc1
    s_add_u32 s36, s24, 0x4007000
    buffer_store_dwordx4 v[20:23], v11, s[8:11], s36 offen sc1
    s_add_u32 s36, s24, 0x4100000
    buffer_store_dwordx4 v[20:23], v11, s[8:11], s36 offen sc1
    s_add_u32 s36, s24, 0x4101000
    buffer_store_dwordx4 v[20:23], v11, s[8:11], s36 offen sc1
    s_add_u32 s36, s24, 0x4102000
    buffer_store_dwordx4 v[20:23], v11, s[8:11], s36 offen sc1
    s_add_u32 s36, s24, 0x4103000
    buffer_store_dwordx4 v[20:23], v11, s[8:11], s36 offen sc1
    s_add_u32 s36, s24, 0x4104000
    buffer_store_dwordx4 v[20:23], v11, s[8:11], s36 offen sc1
    s_add_u32 s36, s24, 0x4105000
    buffer_store_dwordx4 v[20:23], v11, s[8:11], s36 offen sc1
    s_add_u32 s36, s24, 0x4106000
    buffer_store_dwordx4 v[20:23], v11, s[8:11], s36 offen sc1
    s_add_u32 s36, s24, 0x4107000
    buffer_store_dwordx4 v[20:23], v11, s[8:11], s36 offen sc1
    s_waitcnt vmcnt(0)
    s_barrier
    v_cmp_ne_u32 vcc, 0, v0
    v_mov_b32 v15, 0x40000000
    v_mov_b32 v14, 1
    v_cndmask_b32 v15, v0, v15, vcc
    buffer_store_dword v14, v15, s[8:11], s25 offen sc1
    s_lshl_b32 s25, s22, 7
    s_lshl_b32 s36, s20, 2
    s_add_u32 s36, s36, s25
    s_add_u32 s36, s36, 0x192000
    v_cmp_ne_u32 vcc, 0, v0
    v_mov_b32 v15, 0x40000000
    v_mov_b32 v14, 1
    v_cndmask_b32 v15, v0, v15, vcc
    buffer_store_dword v14, v15, s[8:11], s36 offen sc1
    s_mov_b32 s96, s54
    s_and_b32 s97, s55, 0xffff
    s_mov_b32 s98, 0x400000
    s_mov_b32 s99, 0x20000
    v_mov_b32 v15, 0x0
    v_bfe_u32 v14, v0, 0, 1
    s_mov_b32 s38, 0x10
    v_mad_u32_u24 v15, v14, s38, v15
    v_bfe_u32 v14, v0, 1, 1
    s_mov_b32 s38, 0x20
    v_mad_u32_u24 v15, v14, s38, v15
    v_bfe_u32 v14, v0, 2, 1
    s_mov_b32 s38, 0x40
    v_mad_u32_u24 v15, v14, s38, v15
    v_bfe_u32 v14, v0, 3, 1
    s_mov_b32 s38, 0x80
    v_mad_u32_u24 v15, v14, s38, v15
    v_bfe_u32 v14, v0, 4, 1
    s_mov_b32 s38, 0x1000
    v_mad_u32_u24 v15, v14, s38, v15
    v_bfe_u32 v14, v0, 5, 1
    s_mov_b32 s38, 0x2000
    v_mad_u32_u24 v15, v14, s38, v15
    v_bfe_u32 v14, v0, 6, 1
    s_mov_b32 s38, 0x100
    v_mad_u32_u24 v15, v14, s38, v15
    v_bfe_u32 v14, v0, 7, 1
    s_mov_b32 s38, 0x200
    v_mad_u32_u24 v15, v14, s38, v15
    s_lshl_b32 s36, s20, 17
    s_add_u32 s37, s36, 0x0
    buffer_load_dwordx4 v[16:19], v15, s[96:99], s37 offen
    s_add_u32 s37, s36, 0x4000
    buffer_load_dwordx4 v[20:23], v15, s[96:99], s37 offen
    s_add_u32 s37, s36, 0x400
    buffer_load_dwordx4 v[24:27], v15, s[96:99], s37 offen
    s_add_u32 s37, s36, 0x4400
    buffer_load_dwordx4 v[28:31], v15, s[96:99], s37 offen
    s_add_u32 s37, s36, 0x800
    buffer_load_dwordx4 v[32:35], v15, s[96:99], s37 offen
    s_add_u32 s37, s36, 0x4800
    buffer_load_dwordx4 v[36:39], v15, s[96:99], s37 offen
    s_add_u32 s37, s36, 0xc00
    buffer_load_dwordx4 v[40:43], v15, s[96:99], s37 offen
    s_add_u32 s37, s36, 0x4c00
    buffer_load_dwordx4 v[44:47], v15, s[96:99], s37 offen
    s_add_u32 s37, s36, 0x8000
    buffer_load_dwordx4 v[48:51], v15, s[96:99], s37 offen
    s_add_u32 s37, s36, 0xc000
    buffer_load_dwordx4 v[52:55], v15, s[96:99], s37 offen
    s_add_u32 s37, s36, 0x8400
    buffer_load_dwordx4 v[56:59], v15, s[96:99], s37 offen
    s_add_u32 s37, s36, 0xc400
    buffer_load_dwordx4 v[60:63], v15, s[96:99], s37 offen
    s_add_u32 s37, s36, 0x8800
    buffer_load_dwordx4 v[64:67], v15, s[96:99], s37 offen
    s_add_u32 s37, s36, 0xc800
    buffer_load_dwordx4 v[68:71], v15, s[96:99], s37 offen
    s_add_u32 s37, s36, 0x8c00
    buffer_load_dwordx4 v[72:75], v15, s[96:99], s37 offen
    s_add_u32 s37, s36, 0xcc00
    buffer_load_dwordx4 v[76:79], v15, s[96:99], s37 offen
    s_add_u32 s37, s36, 0x10000
    buffer_load_dwordx4 v[80:83], v15, s[96:99], s37 offen
    s_add_u32 s37, s36, 0x14000
    buffer_load_dwordx4 v[84:87], v15, s[96:99], s37 offen
    s_add_u32 s37, s36, 0x10400
    buffer_load_dwordx4 v[88:91], v15, s[96:99], s37 offen
    s_add_u32 s37, s36, 0x14400
    buffer_load_dwordx4 v[92:95], v15, s[96:99], s37 offen
    s_add_u32 s37, s36, 0x10800
    buffer_load_dwordx4 v[96:99], v15, s[96:99], s37 offen
    s_add_u32 s37, s36, 0x14800
    buffer_load_dwordx4 v[100:103], v15, s[96:99], s37 offen
    s_add_u32 s37, s36, 0x10c00
    buffer_load_dwordx4 v[104:107], v15, s[96:99], s37 offen
    s_add_u32 s37, s36, 0x14c00
    buffer_load_dwordx4 v[108:111], v15, s[96:99], s37 offen
    s_waitcnt vmcnt(16)
    v_perm_b32 v112, v20, v16, s34
    v_perm_b32 v113, v28, v24, s34
    v_perm_b32 v114, v36, v32, s34
    v_perm_b32 v115, v44, v40, s34
    ds_write_b128 v7, v[112:115] offset:0
    v_perm_b32 v116, v20, v16, s35
    v_perm_b32 v117, v28, v24, s35
    v_perm_b32 v118, v36, v32, s35
    v_perm_b32 v119, v44, v40, s35
    ds_write_b128 v7, v[116:119] offset:1024
    v_perm_b32 v120, v21, v17, s34
    v_perm_b32 v121, v29, v25, s34
    v_perm_b32 v122, v37, v33, s34
    v_perm_b32 v123, v45, v41, s34
    ds_write_b128 v7, v[120:123] offset:2048
    v_perm_b32 v124, v21, v17, s35
    v_perm_b32 v125, v29, v25, s35
    v_perm_b32 v126, v37, v33, s35
    v_perm_b32 v127, v45, v41, s35
    ds_write_b128 v7, v[124:127] offset:3072
    s_waitcnt lgkmcnt(0)
    v_perm_b32 v112, v22, v18, s34
    v_perm_b32 v113, v30, v26, s34
    v_perm_b32 v114, v38, v34, s34
    v_perm_b32 v115, v46, v42, s34
    ds_write_b128 v7, v[112:115] offset:4096
    v_perm_b32 v116, v22, v18, s35
    v_perm_b32 v117, v30, v26, s35
    v_perm_b32 v118, v38, v34, s35
    v_perm_b32 v119, v46, v42, s35
    ds_write_b128 v7, v[116:119] offset:5120
    v_perm_b32 v120, v23, v19, s34
    v_perm_b32 v121, v31, v27, s34
    v_perm_b32 v122, v39, v35, s34
    v_perm_b32 v123, v47, v43, s34
    ds_write_b128 v7, v[120:123] offset:6144
    v_perm_b32 v124, v23, v19, s35
    v_perm_b32 v125, v31, v27, s35
    v_perm_b32 v126, v39, v35, s35
    v_perm_b32 v127, v47, v43, s35
    ds_write_b128 v7, v[124:127] offset:7168
    s_waitcnt lgkmcnt(0)
    s_add_u32 s37, s36, 0x18000
    buffer_load_dwordx4 v[16:19], v15, s[96:99], s37 offen
    s_add_u32 s37, s36, 0x1c000
    buffer_load_dwordx4 v[20:23], v15, s[96:99], s37 offen
    s_add_u32 s37, s36, 0x18400
    buffer_load_dwordx4 v[24:27], v15, s[96:99], s37 offen
    s_add_u32 s37, s36, 0x1c400
    buffer_load_dwordx4 v[28:31], v15, s[96:99], s37 offen
    s_add_u32 s37, s36, 0x18800
    buffer_load_dwordx4 v[32:35], v15, s[96:99], s37 offen
    s_add_u32 s37, s36, 0x1c800
    buffer_load_dwordx4 v[36:39], v15, s[96:99], s37 offen
    s_add_u32 s37, s36, 0x18c00
    buffer_load_dwordx4 v[40:43], v15, s[96:99], s37 offen
    s_add_u32 s37, s36, 0x1cc00
    buffer_load_dwordx4 v[44:47], v15, s[96:99], s37 offen
    s_waitcnt vmcnt(16)
    v_perm_b32 v112, v52, v48, s34
    v_perm_b32 v113, v60, v56, s34
    v_perm_b32 v114, v68, v64, s34
    v_perm_b32 v115, v76, v72, s34
    ds_write_b128 v7, v[112:115] offset:8192
    v_perm_b32 v116, v52, v48, s35
    v_perm_b32 v117, v60, v56, s35
    v_perm_b32 v118, v68, v64, s35
    v_perm_b32 v119, v76, v72, s35
    ds_write_b128 v7, v[116:119] offset:9216
    v_perm_b32 v120, v53, v49, s34
    v_perm_b32 v121, v61, v57, s34
    v_perm_b32 v122, v69, v65, s34
    v_perm_b32 v123, v77, v73, s34
    ds_write_b128 v7, v[120:123] offset:10240
    v_perm_b32 v124, v53, v49, s35
    v_perm_b32 v125, v61, v57, s35
    v_perm_b32 v126, v69, v65, s35
    v_perm_b32 v127, v77, v73, s35
    ds_write_b128 v7, v[124:127] offset:11264
    s_waitcnt lgkmcnt(0)
    v_perm_b32 v112, v54, v50, s34
    v_perm_b32 v113, v62, v58, s34
    v_perm_b32 v114, v70, v66, s34
    v_perm_b32 v115, v78, v74, s34
    ds_write_b128 v7, v[112:115] offset:12288
    v_perm_b32 v116, v54, v50, s35
    v_perm_b32 v117, v62, v58, s35
    v_perm_b32 v118, v70, v66, s35
    v_perm_b32 v119, v78, v74, s35
    ds_write_b128 v7, v[116:119] offset:13312
    v_perm_b32 v120, v55, v51, s34
    v_perm_b32 v121, v63, v59, s34
    v_perm_b32 v122, v71, v67, s34
    v_perm_b32 v123, v79, v75, s34
    ds_write_b128 v7, v[120:123] offset:14336
    v_perm_b32 v124, v55, v51, s35
    v_perm_b32 v125, v63, v59, s35
    v_perm_b32 v126, v71, v67, s35
    v_perm_b32 v127, v79, v75, s35
    ds_write_b128 v7, v[124:127] offset:15360
    s_waitcnt lgkmcnt(0)
    s_waitcnt vmcnt(8)
    v_perm_b32 v112, v84, v80, s34
    v_perm_b32 v113, v92, v88, s34
    v_perm_b32 v114, v100, v96, s34
    v_perm_b32 v115, v108, v104, s34
    ds_write_b128 v7, v[112:115] offset:16384
    v_perm_b32 v116, v84, v80, s35
    v_perm_b32 v117, v92, v88, s35
    v_perm_b32 v118, v100, v96, s35
    v_perm_b32 v119, v108, v104, s35
    ds_write_b128 v7, v[116:119] offset:17408
    v_perm_b32 v120, v85, v81, s34
    v_perm_b32 v121, v93, v89, s34
    v_perm_b32 v122, v101, v97, s34
    v_perm_b32 v123, v109, v105, s34
    ds_write_b128 v7, v[120:123] offset:18432
    v_perm_b32 v124, v85, v81, s35
    v_perm_b32 v125, v93, v89, s35
    v_perm_b32 v126, v101, v97, s35
    v_perm_b32 v127, v109, v105, s35
    ds_write_b128 v7, v[124:127] offset:19456
    s_waitcnt lgkmcnt(0)
    v_perm_b32 v112, v86, v82, s34
    v_perm_b32 v113, v94, v90, s34
    v_perm_b32 v114, v102, v98, s34
    v_perm_b32 v115, v110, v106, s34
    ds_write_b128 v7, v[112:115] offset:20480
    v_perm_b32 v116, v86, v82, s35
    v_perm_b32 v117, v94, v90, s35
    v_perm_b32 v118, v102, v98, s35
    v_perm_b32 v119, v110, v106, s35
    ds_write_b128 v7, v[116:119] offset:21504
    v_perm_b32 v120, v87, v83, s34
    v_perm_b32 v121, v95, v91, s34
    v_perm_b32 v122, v103, v99, s34
    v_perm_b32 v123, v111, v107, s34
    ds_write_b128 v7, v[120:123] offset:22528
    v_perm_b32 v124, v87, v83, s35
    v_perm_b32 v125, v95, v91, s35
    v_perm_b32 v126, v103, v99, s35
    v_perm_b32 v127, v111, v107, s35
    ds_write_b128 v7, v[124:127] offset:23552
    s_waitcnt lgkmcnt(0)
    s_waitcnt vmcnt(0)
    v_perm_b32 v112, v20, v16, s34
    v_perm_b32 v113, v28, v24, s34
    v_perm_b32 v114, v36, v32, s34
    v_perm_b32 v115, v44, v40, s34
    ds_write_b128 v7, v[112:115] offset:24576
    v_perm_b32 v116, v20, v16, s35
    v_perm_b32 v117, v28, v24, s35
    v_perm_b32 v118, v36, v32, s35
    v_perm_b32 v119, v44, v40, s35
    ds_write_b128 v7, v[116:119] offset:25600
    v_perm_b32 v120, v21, v17, s34
    v_perm_b32 v121, v29, v25, s34
    v_perm_b32 v122, v37, v33, s34
    v_perm_b32 v123, v45, v41, s34
    ds_write_b128 v7, v[120:123] offset:26624
    v_perm_b32 v124, v21, v17, s35
    v_perm_b32 v125, v29, v25, s35
    v_perm_b32 v126, v37, v33, s35
    v_perm_b32 v127, v45, v41, s35
    ds_write_b128 v7, v[124:127] offset:27648
    s_waitcnt lgkmcnt(0)
    v_perm_b32 v112, v22, v18, s34
    v_perm_b32 v113, v30, v26, s34
    v_perm_b32 v114, v38, v34, s34
    v_perm_b32 v115, v46, v42, s34
    ds_write_b128 v7, v[112:115] offset:28672
    v_perm_b32 v116, v22, v18, s35
    v_perm_b32 v117, v30, v26, s35
    v_perm_b32 v118, v38, v34, s35
    v_perm_b32 v119, v46, v42, s35
    ds_write_b128 v7, v[116:119] offset:29696
    v_perm_b32 v120, v23, v19, s34
    v_perm_b32 v121, v31, v27, s34
    v_perm_b32 v122, v39, v35, s34
    v_perm_b32 v123, v47, v43, s34
    ds_write_b128 v7, v[120:123] offset:30720
    v_perm_b32 v124, v23, v19, s35
    v_perm_b32 v125, v31, v27, s35
    v_perm_b32 v126, v39, v35, s35
    v_perm_b32 v127, v47, v43, s35
    ds_write_b128 v7, v[124:127] offset:31744
    s_waitcnt lgkmcnt(0)
    s_lshl_b32 s25, s22, 7
    s_add_u32 s25, s25, 0x192000
    v_lshrrev_b32 v15, 2, v1
    v_and_b32 v15, 127, v15
L_TPI:
    buffer_load_dword v14, v15, s[8:11], s25 offen sc1
    s_add_u32 s32, s32, 1
    s_cmp_gt_u32 s32, 200000
    s_waitcnt vmcnt(0)
    s_cbranch_scc1 L_TPI_ok
    v_cmp_eq_u32 vcc, 0, v14
    s_cbranch_vccz L_TPI_ok
    s_sleep 8
    s_branch L_TPI
L_TPI_ok:
    s_mov_b32 s23, s22
    s_mov_b32 s29, 0
    s_mov_b32 s30, 0x40000000
    s_mul_i32 s24, s23, 0x82100
    s_lshl_b32 s36, s20, 14
    s_add_u32 s24, s24, s36
    s_add_u32 s24, s24, 0x1000000
    s_add_u32 s36, s24, 0
    s_add_u32 s37, s36, 0x7000000
    buffer_load_dwordx4 a[32:35], v1, s[8:11], s36 offen offset:0 sc1
    buffer_load_dwordx4 a[0:3], v1, s[8:11], s37 offen offset:0 sc1
    buffer_load_dwordx4 a[36:39], v1, s[8:11], s36 offen offset:1024 sc1
    buffer_load_dwordx4 a[4:7], v1, s[8:11], s37 offen offset:1024 sc1
    buffer_load_dwordx4 a[40:43], v1, s[8:11], s36 offen offset:2048 sc1
    buffer_load_dwordx4 a[8:11], v1, s[8:11], s37 offen offset:2048 sc1
    buffer_load_dwordx4 a[44:47], v1, s[8:11], s36 offen offset:3072 sc1
    buffer_load_dwordx4 a[12:15], v1, s[8:11], s37 offen offset:3072 sc1
    s_add_u32 s36, s24, 4096
    s_add_u32 s37, s36, 0x7000000
    buffer_load_dwordx4 a[48:51], v1, s[8:11], s36 offen offset:0 sc1
    buffer_load_dwordx4 a[16:19], v1, s[8:11], s37 offen offset:0 sc1
    buffer_load_dwordx4 a[52:55], v1, s[8:11], s36 offen offset:1024 sc1
    buffer_load_dwordx4 a[20:23], v1, s[8:11], s37 offen offset:1024 sc1
    buffer_load_dwordx4 a[56:59], v1, s[8:11], s36 offen offset:2048 sc1
    buffer_load_dwordx4 a[24:27], v1, s[8:11], s37 offen offset:2048 sc1
    buffer_load_dwordx4 a[60:63], v1, s[8:11], s36 offen offset:3072 sc1
    buffer_load_dwordx4 a[28:31], v1, s[8:11], s37 offen offset:3072 sc1
    s_lshr_b32 s36, s21, 1
    s_lshl_b32 s36, s36, 3
    s_xor_b32 s37, s36, 8
    s_add_u32 s24, s24, 8192
    s_add_u32 s36, s36, s24
    s_add_u32 s37, s37, s24
    buffer_load_dwordx2 a[64:65], v2, s[8:11], s36 offen offset:0 sc1
    buffer_load_dwordx2 a[66:67], v2, s[8:11], s37 offen offset:0 sc1
    buffer_load_dwordx2 a[68:69], v2, s[8:11], s36 offen offset:1024 sc1
    buffer_load_dwordx2 a[70:71], v2, s[8:11], s37 offen offset:1024 sc1
L_P2:
    s_and_b32 s36, s29, 1
    s_lshl_b32 s36, s36, 20
    s_lshl_b32 s26, s22, 21
    s_add_u32 s26, s26, s36
    s_add_u32 s26, s26, 0x4000000
    s_bfe_u32 s27, s29, 0x10001
    s_lshl_b32 s24, s23, 13
    s_add_u32 s24, s24, 0x100000
    s_max_u32 s25, s23, 1
    s_lshl_b32 s25, s25, 13
    s_add_u32 s25, s25, 0xfe000
    buffer_load_dwordx4 v[48:51], v2, s[8:11], s24 offen sc1
    buffer_load_dwordx4 v[52:55], v2, s[8:11], s24 offen offset:1024 sc1
    s_lshl_b32 s36, s23, 5
    s_add_u32 s36, s36, s20
    s_lshl_b32 s36, s36, 10
    buffer_load_dword a72, v12, s[12:15], s36 offen
    buffer_load_dword a73, v12, s[92:95], 0 offen
    s_waitcnt vmcnt(4)
    v_cmp_ne_u32 vcc, 0, v1
    v_mov_b32 v15, 0x40000000
    v_mov_b32 v14, 0
    v_cndmask_b32 v15, v1, v15, vcc
    buffer_store_dword v14, v15, s[8:11], s30 offen sc1
    v_mfma_f32_16x16x32_bf16 v[80:83], a[32:35], a[0:3], 0
    v_mfma_f32_16x16x32_bf16 v[80:83], a[36:39], a[4:7], v[80:83]
    v_mfma_f32_16x16x32_bf16 v[80:83], a[40:43], a[8:11], v[80:83]
    v_mfma_f32_16x16x32_bf16 v[80:83], a[44:47], a[12:15], v[80:83]
    v_mfma_f32_16x16x32_bf16 v[88:91], a[48:51], a[16:19], 0
    v_mfma_f32_16x16x32_bf16 v[88:91], a[52:55], a[20:23], v[88:91]
    v_mfma_f32_16x16x32_bf16 v[88:91], a[56:59], a[24:27], v[88:91]
    v_mfma_f32_16x16x32_bf16 v[88:91], a[60:63], a[28:31], v[88:91]
    v_mfma_f32_16x16x32_bf16 v[84:87], a[32:35], a[16:19], 0
    v_mfma_f32_16x16x32_bf16 v[84:87], a[36:39], a[20:23], v[84:87]
    v_mfma_f32_16x16x32_bf16 v[84:87], a[40:43], a[24:27], v[84:87]
    v_mfma_f32_16x16x32_bf16 v[84:87], a[44:47], a[28:31], v[84:87]
    v_cndmask_b32 v80, v13, v80, s[64:65]
    v_cndmask_b32 v81, v13, v81, s[66:67]
    v_cndmask_b32 v82, v13, v82, s[68:69]
    v_cndmask_b32 v83, v13, v83, s[70:71]
    v_cndmask_b32 v88, v13, v88, s[64:65]
    v_cndmask_b32 v89, v13, v89, s[66:67]
    v_cndmask_b32 v90, v13, v90, s[68:69]
    v_cndmask_b32 v91, v13, v91, s[70:71]
    v_max_f32 v116, v80, v81
    v_max3_f32 v116, v116, v82, v83
    v_max_f32 v117, v84, v85
    v_max3_f32 v117, v117, v86, v87
    v_max3_f32 v117, v117, v88, v89
    v_max3_f32 v117, v117, v90, v91
    v_mov_b32 v14, v116
    s_nop 1
    v_permlane16_swap_b32 v116, v14
    v_max_f32 v116, v116, v14
    v_mov_b32 v14, v117
    s_nop 1
    v_permlane16_swap_b32 v117, v14
    v_max_f32 v117, v117, v14
    v_mov_b32 v14, v116
    s_nop 1
    v_permlane32_swap_b32 v116, v14
    v_max_f32 v116, v116, v14
    v_mov_b32 v14, v117
    s_nop 1
    v_permlane32_swap_b32 v117, v14
    v_max_f32 v117, v117, v14
    v_sub_f32 v80, v80, v116
    v_exp_f32 v80, v80
    v_sub_f32 v81, v81, v116
    v_exp_f32 v81, v81
    v_sub_f32 v82, v82, v116
    v_exp_f32 v82, v82
    v_sub_f32 v83, v83, v116
    v_exp_f32 v83, v83
    v_sub_f32 v84, v84, v117
    v_exp_f32 v84, v84
    v_sub_f32 v85, v85, v117
    v_exp_f32 v85, v85
    v_sub_f32 v86, v86, v117
    v_exp_f32 v86, v86
    v_sub_f32 v87, v87, v117
    v_exp_f32 v87, v87
    v_sub_f32 v88, v88, v117
    v_exp_f32 v88, v88
    v_sub_f32 v89, v89, v117
    v_exp_f32 v89, v89
    v_sub_f32 v90, v90, v117
    v_exp_f32 v90, v90
    v_sub_f32 v91, v91, v117
    v_exp_f32 v91, v91
    v_cvt_pk_bf16_f32 v100, v80, v81
    v_cvt_pk_bf16_f32 v101, v82, v83
    v_mov_b64 v[102:103], 0
    v_cvt_pk_bf16_f32 v104, v84, v85
    v_cvt_pk_bf16_f32 v105, v86, v87
    v_cvt_pk_bf16_f32 v106, v88, v89
    v_cvt_pk_bf16_f32 v107, v90, v91
    v_mov_b64 v[108:109], s[4:5]
    v_mov_b64 v[110:111], s[4:5]
    v_cndmask_b32 v112, 0, v108, s[72:73]
    v_cndmask_b32 v113, 0, v108, s[72:73]
    v_mfma_f32_16x16x32_bf16 v[16:19], v[108:111], v[100:103], 0
    v_mfma_f32_16x16x32_bf16 v[24:27], a[64:67], v[100:103], 0
    v_mfma_f32_16x16x32_bf16 v[28:31], a[68:71], v[100:103], 0
    v_mfma_f32_16x16x32_bf16 v[20:23], v[108:111], v[104:107], 0
    v_mfma_f32_16x16x32_bf16 v[32:35], a[64:67], v[104:107], 0
    v_mfma_f32_16x16x32_bf16 v[36:39], a[68:71], v[104:107], 0
    s_branch L_P2_chk
L_P2_far:
    buffer_load_dword v14, v2, s[8:11], s25 offen sc1
    s_add_u32 s32, s32, 1
    s_cmp_gt_u32 s32, 200000
    s_waitcnt vmcnt(0)
    s_cbranch_scc1 L_P2_poll
    v_cmp_eq_u32 vcc, -1, v14
    s_cbranch_vccz L_P2_near
    s_sleep 12
    s_branch L_P2_far
L_P2_near:
    s_mov_b32 s25, 0x40000000
L_P2_poll:
    buffer_load_dwordx4 v[48:51], v2, s[8:11], s24 offen sc1
    buffer_load_dwordx4 v[52:55], v2, s[8:11], s24 offen offset:1024 sc1
L_P2_chk:
    s_add_u32 s32, s32, 1
    s_waitcnt vmcnt(0)
    ds_write_b128 v2, v[48:51] offset:20480
    ds_write_b128 v2, v[52:55] offset:21504
    v_max3_u32 v14, v48, v49, v50
    v_max3_u32 v15, v51, v52, v53
    v_max3_u32 v14, v14, v54, v55
    v_max_u32 v14, v14, v15
    v_cmp_eq_u32 vcc, -1, v14
    s_cbranch_vccz L_P2_got
    s_cmp_gt_u32 s32, 200000
    s_cbranch_scc1 L_P2_got
    s_cmp_eq_u32 s25, 0x40000000
    s_cbranch_scc1 L_P2_poll
    s_branch L_P2_far
L_P2_got:
    s_waitcnt lgkmcnt(0)
    s_barrier
    ds_read_b128 v[48:51], v8 offset:0
    ds_read_b128 v[52:55], v8 offset:2048
    ds_read_b128 v[56:59], v8 offset:4096
    ds_read_b128 v[60:63], v8 offset:6144
    s_waitcnt lgkmcnt(3)
    v_mfma_f32_16x16x32_bf16 v[80:83], a[128:131], v[48:51], 0
    v_mfma_f32_16x16x32_bf16 v[84:87], a[132:135], v[48:51], 0
    ds_read_b128 v[48:51], v8 offset:512
    s_waitcnt lgkmcnt(3)
    v_mfma_f32_16x16x32_bf16 v[80:83], a[136:139], v[52:55], v[80:83]
    v_mfma_f32_16x16x32_bf16 v[84:87], a[140:143], v[52:55], v[84:87]
    ds_read_b128 v[52:55], v8 offset:2560
    s_waitcnt lgkmcnt(3)
    v_mfma_f32_16x16x32_bf16 v[80:83], a[144:147], v[56:59], v[80:83]
    v_mfma_f32_16x16x32_bf16 v[84:87], a[148:151], v[56:59], v[84:87]
    ds_read_b128 v[56:59], v8 offset:4608
    s_waitcnt lgkmcnt(3)
    v_mfma_f32_16x16x32_bf16 v[80:83], a[152:155], v[60:63], v[80:83]
    v_mfma_f32_16x16x32_bf16 v[84:87], a[156:159], v[60:63], v[84:87]
    ds_read_b128 v[60:63], v8 offset:6656
    s_waitcnt lgkmcnt(3)
    v_mfma_f32_16x16x32_bf16 v[80:83], a[160:163], v[48:51], v[80:83]
    v_mfma_f32_16x16x32_bf16 v[84:87], a[164:167], v[48:51], v[84:87]
    ds_read_b128 v[48:51], v8 offset:1024
    s_waitcnt lgkmcnt(3)
    v_mfma_f32_16x16x32_bf16 v[80:83], a[168:171], v[52:55], v[80:83]
    v_mfma_f32_16x16x32_bf16 v[84:87], a[172:175], v[52:55], v[84:87]
    ds_read_b128 v[52:55], v8 offset:3072
    s_waitcnt lgkmcnt(3)
    v_mfma_f32_16x16x32_bf16 v[80:83], a[176:179], v[56:59], v[80:83]
    v_mfma_f32_16x16x32_bf16 v[84:87], a[180:183], v[56:59], v[84:87]
    ds_read_b128 v[56:59], v8 offset:5120
    s_waitcnt lgkmcnt(3)
    v_mfma_f32_16x16x32_bf16 v[80:83], a[184:187], v[60:63], v[80:83]
    v_mfma_f32_16x16x32_bf16 v[84:87], a[188:191], v[60:63], v[84:87]
    ds_read_b128 v[60:63], v8 offset:7168
    s_waitcnt lgkmcnt(3)
    v_mfma_f32_16x16x32_bf16 v[80:83], a[192:195], v[48:51], v[80:83]
    v_mfma_f32_16x16x32_bf16 v[84:87], a[196:199], v[48:51], v[84:87]
    ds_read_b128 v[48:51], v8 offset:1536
    s_waitcnt lgkmcnt(3)
    v_mfma_f32_16x16x32_bf16 v[80:83], a[200:203], v[52:55], v[80:83]
    v_mfma_f32_16x16x32_bf16 v[84:87], a[204:207], v[52:55], v[84:87]
    ds_read_b128 v[52:55], v8 offset:3584
    s_waitcnt lgkmcnt(3)
    v_mfma_f32_16x16x32_bf16 v[80:83], a[208:211], v[56:59], v[80:83]
    v_mfma_f32_16x16x32_bf16 v[84:87], a[212:215], v[56:59], v[84:87]
    ds_read_b128 v[56:59], v8 offset:5632
    s_waitcnt lgkmcnt(3)
    v_mfma_f32_16x16x32_bf16 v[80:83], a[216:219], v[60:63], v[80:83]
    v_mfma_f32_16x16x32_bf16 v[84:87], a[220:223], v[60:63], v[84:87]
    ds_read_b128 v[60:63], v8 offset:7680
    s_waitcnt lgkmcnt(3)
    v_mfma_f32_16x16x32_bf16 v[80:83], a[224:227], v[48:51], v[80:83]
    v_mfma_f32_16x16x32_bf16 v[84:87], a[228:231], v[48:51], v[84:87]
    ds_read_b128 v[48:51], v8 offset:0
    s_waitcnt lgkmcnt(3)
    v_mfma_f32_16x16x32_bf16 v[80:83], a[232:235], v[52:55], v[80:83]
    v_mfma_f32_16x16x32_bf16 v[84:87], a[236:239], v[52:55], v[84:87]
    ds_read_b128 v[52:55], v8 offset:2048
    s_waitcnt lgkmcnt(3)
    v_mfma_f32_16x16x32_bf16 v[80:83], a[240:243], v[56:59], v[80:83]
    v_mfma_f32_16x16x32_bf16 v[84:87], a[244:247], v[56:59], v[84:87]
    ds_read_b128 v[56:59], v8 offset:4096
    s_waitcnt lgkmcnt(3)
    v_mfma_f32_16x16x32_bf16 v[80:83], a[248:251], v[60:63], v[80:83]
    v_mfma_f32_16x16x32_bf16 v[84:87], a[252:255], v[60:63], v[84:87]
    ds_read_b128 v[60:63], v8 offset:6144
    s_waitcnt lgkmcnt(3)
    v_mfma_f32_16x16x32_bf16 v[40:43], v[48:51], v[128:131], 0
    v_mfma_f32_16x16x32_bf16 v[44:47], v[48:51], v[132:135], 0
    ds_read_b128 v[48:51], v8 offset:512
    s_waitcnt lgkmcnt(3)
    v_mfma_f32_16x16x32_bf16 v[40:43], v[52:55], v[136:139], v[40:43]
    v_mfma_f32_16x16x32_bf16 v[44:47], v[52:55], v[140:143], v[44:47]
    ds_read_b128 v[52:55], v8 offset:2560
    s_waitcnt lgkmcnt(3)
    v_mfma_f32_16x16x32_bf16 v[40:43], v[56:59], v[144:147], v[40:43]
    v_mfma_f32_16x16x32_bf16 v[44:47], v[56:59], v[148:151], v[44:47]
    v_mul_f32 v80, s33, v80
    v_mul_f32 v81, s33, v81
    v_mul_f32 v82, s33, v82
    v_mul_f32 v83, s33, v83
    ds_read_b128 v[56:59], v8 offset:4608
    s_waitcnt lgkmcnt(3)
    v_mfma_f32_16x16x32_bf16 v[40:43], v[60:63], v[152:155], v[40:43]
    v_mfma_f32_16x16x32_bf16 v[44:47], v[60:63], v[156:159], v[44:47]
    v_mul_f32 v84, s33, v84
    v_mul_f32 v85, s33, v85
    v_mul_f32 v86, s33, v86
    v_mul_f32 v87, s33, v87
    ds_read_b128 v[60:63], v8 offset:6656
    s_waitcnt lgkmcnt(3)
    v_mfma_f32_16x16x32_bf16 v[40:43], v[48:51], v[160:163], v[40:43]
    v_mfma_f32_16x16x32_bf16 v[44:47], v[48:51], v[164:167], v[44:47]
    v_cvt_pk_bf16_f32 v88, v80, v84
    v_cvt_pk_bf16_f32 v89, v81, v85
    v_cvt_pk_bf16_f32 v90, v82, v86
    v_cvt_pk_bf16_f32 v91, v83, v87
    ds_write_b128 v9, v[88:91] offset:16384
    ds_read_b128 v[48:51], v8 offset:1024
    s_waitcnt lgkmcnt(4)
    v_mfma_f32_16x16x32_bf16 v[40:43], v[52:55], v[168:171], v[40:43]
    v_mfma_f32_16x16x32_bf16 v[44:47], v[52:55], v[172:175], v[44:47]
    ds_read_b128 v[52:55], v8 offset:3072
    s_waitcnt lgkmcnt(4)
    v_mfma_f32_16x16x32_bf16 v[40:43], v[56:59], v[176:179], v[40:43]
    v_mfma_f32_16x16x32_bf16 v[44:47], v[56:59], v[180:183], v[44:47]
    ds_read_b128 v[56:59], v8 offset:5120
    s_waitcnt lgkmcnt(4)
    v_mfma_f32_16x16x32_bf16 v[40:43], v[60:63], v[184:187], v[40:43]
    v_mfma_f32_16x16x32_bf16 v[44:47], v[60:63], v[188:191], v[44:47]
    s_waitcnt lgkmcnt(3)
    s_barrier
    ds_read_b128 v[64:67], v1 offset:16384
    ds_read_b128 v[68:71], v1 offset:17408
    ds_read_b128 v[72:75], v1 offset:18432
    ds_read_b128 v[76:79], v1 offset:19456
    ds_read_b128 v[60:63], v8 offset:7168
    s_waitcnt lgkmcnt(7)
    v_mfma_f32_16x16x32_bf16 v[40:43], v[48:51], v[192:195], v[40:43]
    v_mfma_f32_16x16x32_bf16 v[44:47], v[48:51], v[196:199], v[44:47]
    ds_read_b128 v[48:51], v8 offset:1536
    s_waitcnt lgkmcnt(7)
    v_mfma_f32_16x16x32_bf16 v[40:43], v[52:55], v[200:203], v[40:43]
    v_mfma_f32_16x16x32_bf16 v[44:47], v[52:55], v[204:207], v[44:47]
    s_waitcnt lgkmcnt(2)
    v_mfma_f32_16x16x32_bf16 v[92:95], v[64:67], a[0:3], 0
    v_mfma_f32_16x16x32_bf16 v[96:99], v[64:67], a[16:19], 0
    v_mfma_f32_16x16x32_bf16 v[92:95], v[68:71], a[4:7], v[92:95]
    v_mfma_f32_16x16x32_bf16 v[96:99], v[68:71], a[20:23], v[96:99]
    v_mfma_f32_16x16x32_bf16 v[92:95], v[72:75], a[8:11], v[92:95]
    v_mfma_f32_16x16x32_bf16 v[96:99], v[72:75], a[24:27], v[96:99]
    v_mfma_f32_16x16x32_bf16 v[92:95], v[76:79], a[12:15], v[92:95]
    v_mfma_f32_16x16x32_bf16 v[96:99], v[76:79], a[28:31], v[96:99]
    ds_read_b128 v[52:55], v8 offset:3584
    s_waitcnt lgkmcnt(3)
    v_mfma_f32_16x16x32_bf16 v[40:43], v[56:59], v[208:211], v[40:43]
    v_mfma_f32_16x16x32_bf16 v[44:47], v[56:59], v[212:215], v[44:47]
    ds_read_b128 v[56:59], v8 offset:5632
    s_waitcnt lgkmcnt(3)
    v_mfma_f32_16x16x32_bf16 v[40:43], v[60:63], v[216:219], v[40:43]
    v_mfma_f32_16x16x32_bf16 v[44:47], v[60:63], v[220:223], v[44:47]
    v_max3_f32 v118, v92, v93, v94
    v_max3_f32 v118, v118, v95, v116
    v_max3_f32 v119, v96, v97, v98
    v_max3_f32 v119, v119, v99, v117
    v_mov_b32 v14, v118
    v_mov_b32 v15, v119
    ds_read_b128 v[60:63], v8 offset:7680
    s_waitcnt lgkmcnt(3)
    v_mfma_f32_16x16x32_bf16 v[40:43], v[48:51], v[224:227], v[40:43]
    v_mfma_f32_16x16x32_bf16 v[44:47], v[48:51], v[228:231], v[44:47]
    v_permlane16_swap_b32 v118, v14
    v_permlane16_swap_b32 v119, v15
    v_max_f32 v118, v118, v14
    v_max_f32 v119, v119, v15
    v_sub_f32 v92, v92, v118
    v_exp_f32 v92, v92
    s_waitcnt lgkmcnt(2)
    v_mfma_f32_16x16x32_bf16 v[40:43], v[52:55], v[232:235], v[40:43]
    v_mfma_f32_16x16x32_bf16 v[44:47], v[52:55], v[236:239], v[44:47]
    v_sub_f32 v93, v93, v118
    v_exp_f32 v93, v93
    v_sub_f32 v94, v94, v118
    v_exp_f32 v94, v94
    v_sub_f32 v95, v95, v118
    v_exp_f32 v95, v95
    s_waitcnt lgkmcnt(1)
    v_mfma_f32_16x16x32_bf16 v[40:43], v[56:59], v[240:243], v[40:43]
    v_mfma_f32_16x16x32_bf16 v[44:47], v[56:59], v[244:247], v[44:47]
    v_sub_f32 v104, v116, v118
    v_exp_f32 v104, v104
    v_cvt_pk_bf16_f32 v100, v92, v93
    v_cvt_pk_bf16_f32 v101, v94, v95
    v_sub_f32 v96, v96, v119
    v_exp_f32 v96, v96
    s_waitcnt lgkmcnt(0)
    v_mfma_f32_16x16x32_bf16 v[40:43], v[60:63], v[248:251], v[40:43]
    v_mfma_f32_16x16x32_bf16 v[44:47], v[60:63], v[252:255], v[44:47]
    v_sub_f32 v97, v97, v119
    v_exp_f32 v97, v97
    v_sub_f32 v98, v98, v119
    v_exp_f32 v98, v98
    v_sub_f32 v99, v99, v119
    v_exp_f32 v99, v99
    v_sub_f32 v105, v117, v119
    v_exp_f32 v105, v105
    v_cvt_pk_bf16_f32 v102, v96, v97
    v_cvt_pk_bf16_f32 v103, v98, v99
    v_mfma_f32_16x16x16_bf16 v[48:51], v[112:113], v[100:101], 0
    s_nop 0
    v_mfma_f32_16x16x16_bf16 v[52:55], v[112:113], v[102:103], 0
    v_cvt_pk_bf16_f32 v80, v40, v41
    v_cndmask_b32 v80, 0, v80, s[72:73]
    v_cvt_pk_bf16_f32 v81, v42, v43
    v_cndmask_b32 v81, 0, v81, s[72:73]
    v_cvt_pk_bf16_f32 v82, v44, v45
    v_cndmask_b32 v82, 0, v82, s[72:73]
    v_cvt_pk_bf16_f32 v83, v46, v47
    v_cndmask_b32 v83, 0, v83, s[72:73]
    v_mfma_f32_16x16x16_bf16 v[56:59], v[80:81], v[100:101], 0
    s_nop 0
    v_mfma_f32_16x16x16_bf16 v[60:63], v[82:83], v[100:101], 0
    v_mfma_f32_16x16x16_bf16 v[64:67], v[80:81], v[102:103], 0
    v_mfma_f32_16x16x16_bf16 v[68:71], v[82:83], v[102:103], 0
    v_fma_f32 v48, v16, v104, v48
    v_rcp_f32 v48, v48
    v_fma_f32 v52, v20, v105, v52
    v_rcp_f32 v52, v52
    v_fma_f32 v56, v24, v104, v56
    v_fma_f32 v57, v25, v104, v57
    v_fma_f32 v58, v26, v104, v58
    v_fma_f32 v59, v27, v104, v59
    v_fma_f32 v60, v28, v104, v60
    v_fma_f32 v61, v29, v104, v61
    v_fma_f32 v62, v30, v104, v62
    v_fma_f32 v63, v31, v104, v63
    v_pk_mul_f32 v[56:57], v[56:57], v[48:49] op_sel_hi:[1,0]
    v_pk_mul_f32 v[58:59], v[58:59], v[48:49] op_sel_hi:[1,0]
    v_pk_mul_f32 v[60:61], v[60:61], v[48:49] op_sel_hi:[1,0]
    v_pk_mul_f32 v[62:63], v[62:63], v[48:49] op_sel_hi:[1,0]
    v_cvt_pk_bf16_f32 v72, v56, v60
    v_cvt_pk_bf16_f32 v73, v57, v61
    v_cvt_pk_bf16_f32 v74, v58, v62
    v_cvt_pk_bf16_f32 v75, v59, v63
    ds_write_b128 v9, v[72:75] offset:0
    v_fma_f32 v64, v32, v105, v64
    v_fma_f32 v65, v33, v105, v65
    v_fma_f32 v66, v34, v105, v66
    v_fma_f32 v67, v35, v105, v67
    v_fma_f32 v68, v36, v105, v68
    v_fma_f32 v69, v37, v105, v69
    v_fma_f32 v70, v38, v105, v70
    v_fma_f32 v71, v39, v105, v71
    v_pk_mul_f32 v[64:65], v[64:65], v[52:53] op_sel_hi:[1,0]
    v_pk_mul_f32 v[66:67], v[66:67], v[52:53] op_sel_hi:[1,0]
    v_pk_mul_f32 v[68:69], v[68:69], v[52:53] op_sel_hi:[1,0]
    v_pk_mul_f32 v[70:71], v[70:71], v[52:53] op_sel_hi:[1,0]
    v_cvt_pk_bf16_f32 v76, v64, v68
    v_cvt_pk_bf16_f32 v77, v65, v69
    v_cvt_pk_bf16_f32 v78, v66, v70
    v_cvt_pk_bf16_f32 v79, v67, v71
    ds_write_b128 v9, v[76:79] offset:4096
    s_waitcnt lgkmcnt(0)
    s_barrier
    ds_read_b128 v[16:19], v1 offset:0
    ds_read_b128 v[20:23], v1 offset:1024
    ds_read_b128 v[24:27], v1 offset:2048
    ds_read_b128 v[28:31], v1 offset:3072
    ds_read_b128 v[32:35], v1 offset:4096
    ds_read_b128 v[36:39], v1 offset:5120
    ds_read_b128 v[40:43], v1 offset:6144
    ds_read_b128 v[44:47], v1 offset:7168
    ds_read_b128 v[48:51], v7 offset:0
    ds_read_b128 v[52:55], v7 offset:1024
    ds_read_b128 v[56:59], v7 offset:2048
    s_lshl_b32 s36, s20, 10
    s_add_u32 s25, s26, s36
    s_waitcnt lgkmcnt(2)
    v_mfma_f32_16x16x32_bf16 v[64:67], v[16:19], v[48:51], 0
    ds_read_b128 v[60:63], v7 offset:3072
    s_waitcnt lgkmcnt(2)
    v_mfma_f32_16x16x32_bf16 v[68:71], v[16:19], v[52:55], 0
    ds_read_b128 v[48:51], v7 offset:4096
    s_waitcnt lgkmcnt(2)
    v_mfma_f32_16x16x32_bf16 v[72:75], v[16:19], v[56:59], 0
    ds_read_b128 v[52:55], v7 offset:5120
    s_waitcnt lgkmcnt(2)
    v_mfma_f32_16x16x32_bf16 v[76:79], v[16:19], v[60:63], 0
    ds_read_b128 v[56:59], v7 offset:6144
    s_waitcnt lgkmcnt(2)
    v_mfma_f32_16x16x32_bf16 v[80:83], v[16:19], v[48:51], 0
    ds_read_b128 v[60:63], v7 offset:7168
    s_waitcnt lgkmcnt(2)
    v_mfma_f32_16x16x32_bf16 v[84:87], v[16:19], v[52:55], 0
    ds_read_b128 v[48:51], v7 offset:8192
    s_waitcnt lgkmcnt(2)
    v_mfma_f32_16x16x32_bf16 v[88:91], v[16:19], v[56:59], 0
    ds_read_b128 v[52:55], v7 offset:9216
    s_waitcnt lgkmcnt(2)
    v_mfma_f32_16x16x32_bf16 v[92:95], v[16:19], v[60:63], 0
    ds_read_b128 v[56:59], v7 offset:10240
    s_waitcnt lgkmcnt(2)
    v_mfma_f32_16x16x32_bf16 v[64:67], v[20:23], v[48:51], v[64:67]
    ds_read_b128 v[60:63], v7 offset:11264
    s_waitcnt lgkmcnt(2)
    v_mfma_f32_16x16x32_bf16 v[68:71], v[20:23], v[52:55], v[68:71]
    ds_read_b128 v[48:51], v7 offset:12288
    s_waitcnt lgkmcnt(2)
    v_mfma_f32_16x16x32_bf16 v[72:75], v[20:23], v[56:59], v[72:75]
    ds_read_b128 v[52:55], v7 offset:13312
    s_waitcnt lgkmcnt(2)
    v_mfma_f32_16x16x32_bf16 v[76:79], v[20:23], v[60:63], v[76:79]
    ds_read_b128 v[56:59], v7 offset:14336
    s_waitcnt lgkmcnt(2)
    v_mfma_f32_16x16x32_bf16 v[80:83], v[20:23], v[48:51], v[80:83]
    ds_read_b128 v[60:63], v7 offset:15360
    s_waitcnt lgkmcnt(2)
    v_mfma_f32_16x16x32_bf16 v[84:87], v[20:23], v[52:55], v[84:87]
    ds_read_b128 v[48:51], v7 offset:16384
    s_waitcnt lgkmcnt(2)
    v_mfma_f32_16x16x32_bf16 v[88:91], v[20:23], v[56:59], v[88:91]
    ds_read_b128 v[52:55], v7 offset:17408
    s_waitcnt lgkmcnt(2)
    v_mfma_f32_16x16x32_bf16 v[92:95], v[20:23], v[60:63], v[92:95]
    ds_read_b128 v[56:59], v7 offset:18432
    s_waitcnt lgkmcnt(2)
    v_mfma_f32_16x16x32_bf16 v[64:67], v[24:27], v[48:51], v[64:67]
    ds_read_b128 v[60:63], v7 offset:19456
    s_waitcnt lgkmcnt(2)
    v_mfma_f32_16x16x32_bf16 v[68:71], v[24:27], v[52:55], v[68:71]
    ds_read_b128 v[48:51], v7 offset:20480
    s_waitcnt lgkmcnt(2)
    v_mfma_f32_16x16x32_bf16 v[72:75], v[24:27], v[56:59], v[72:75]
    ds_read_b128 v[52:55], v7 offset:21504
    s_waitcnt lgkmcnt(2)
    v_mfma_f32_16x16x32_bf16 v[76:79], v[24:27], v[60:63], v[76:79]
    ds_read_b128 v[56:59], v7 offset:22528
    s_waitcnt lgkmcnt(2)
    v_mfma_f32_16x16x32_bf16 v[80:83], v[24:27], v[48:51], v[80:83]
    ds_read_b128 v[60:63], v7 offset:23552
    s_waitcnt lgkmcnt(2)
    v_mfma_f32_16x16x32_bf16 v[84:87], v[24:27], v[52:55], v[84:87]
    ds_read_b128 v[48:51], v7 offset:24576
    s_waitcnt lgkmcnt(2)
    v_mfma_f32_16x16x32_bf16 v[88:91], v[24:27], v[56:59], v[88:91]
    ds_read_b128 v[52:55], v7 offset:25600
    s_waitcnt lgkmcnt(2)
    v_mfma_f32_16x16x32_bf16 v[92:95], v[24:27], v[60:63], v[92:95]
    ds_read_b128 v[56:59], v7 offset:26624
    s_waitcnt lgkmcnt(2)
    v_mfma_f32_16x16x32_bf16 v[64:67], v[28:31], v[48:51], v[64:67]
    ds_read_b128 v[60:63], v7 offset:27648
    s_waitcnt lgkmcnt(2)
    v_mfma_f32_16x16x32_bf16 v[68:71], v[28:31], v[52:55], v[68:71]
    ds_read_b128 v[48:51], v7 offset:28672
    s_waitcnt lgkmcnt(2)
    v_mfma_f32_16x16x32_bf16 v[72:75], v[28:31], v[56:59], v[72:75]
    ds_read_b128 v[52:55], v7 offset:29696
    s_waitcnt lgkmcnt(2)
    v_mfma_f32_16x16x32_bf16 v[76:79], v[28:31], v[60:63], v[76:79]
    ds_read_b128 v[56:59], v7 offset:30720
    s_waitcnt lgkmcnt(2)
    v_mfma_f32_16x16x32_bf16 v[80:83], v[28:31], v[48:51], v[80:83]
    ds_read_b128 v[60:63], v7 offset:31744
    s_waitcnt lgkmcnt(2)
    v_mfma_f32_16x16x32_bf16 v[84:87], v[28:31], v[52:55], v[84:87]
    ds_read_b128 v[48:51], v7 offset:0
    s_waitcnt lgkmcnt(2)
    v_mfma_f32_16x16x32_bf16 v[88:91], v[28:31], v[56:59], v[88:91]
    ds_read_b128 v[52:55], v7 offset:1024
    s_waitcnt lgkmcnt(2)
    v_mfma_f32_16x16x32_bf16 v[92:95], v[28:31], v[60:63], v[92:95]
    ds_read_b128 v[56:59], v7 offset:2048
    s_waitcnt lgkmcnt(2)
    v_mfma_f32_16x16x32_bf16 v[96:99], v[32:35], v[48:51], 0
    ds_read_b128 v[60:63], v7 offset:3072
    s_waitcnt lgkmcnt(2)
    v_mfma_f32_16x16x32_bf16 v[100:103], v[32:35], v[52:55], 0
    ds_read_b128 v[48:51], v7 offset:4096
    s_waitcnt lgkmcnt(2)
    v_mfma_f32_16x16x32_bf16 v[104:107], v[32:35], v[56:59], 0
    ds_read_b128 v[52:55], v7 offset:5120
    s_waitcnt lgkmcnt(2)
    v_mfma_f32_16x16x32_bf16 v[108:111], v[32:35], v[60:63], 0
    ds_read_b128 v[56:59], v7 offset:6144
    v_cvt_pk_bf16_f32 v16, v64, v68
    s_waitcnt lgkmcnt(2)
    v_mfma_f32_16x16x32_bf16 v[112:115], v[32:35], v[48:51], 0
    ds_read_b128 v[60:63], v7 offset:7168
    v_cvt_pk_bf16_f32 v17, v72, v76
    s_waitcnt lgkmcnt(2)
    v_mfma_f32_16x16x32_bf16 v[116:119], v[32:35], v[52:55], 0
    ds_read_b128 v[48:51], v7 offset:8192
    v_cvt_pk_bf16_f32 v18, v80, v84
    s_waitcnt lgkmcnt(2)
    v_mfma_f32_16x16x32_bf16 v[120:123], v[32:35], v[56:59], 0
    ds_read_b128 v[52:55], v7 offset:9216
    v_cvt_pk_bf16_f32 v19, v88, v92
    s_waitcnt lgkmcnt(2)
    v_mfma_f32_16x16x32_bf16 v[124:127], v[32:35], v[60:63], 0
    ds_read_b128 v[56:59], v7 offset:10240
    v_and_or_b32 v16, v16, -2, s27
    s_waitcnt lgkmcnt(2)
    v_mfma_f32_16x16x32_bf16 v[96:99], v[36:39], v[48:51], v[96:99]
    ds_read_b128 v[60:63], v7 offset:11264
    s_add_u32 s36, s25, 0x0
    s_waitcnt lgkmcnt(2)
    v_mfma_f32_16x16x32_bf16 v[100:103], v[36:39], v[52:55], v[100:103]
    ds_read_b128 v[48:51], v7 offset:12288
    buffer_store_dwordx4 v[16:19], v10, s[8:11], s36 offen sc1
    s_waitcnt lgkmcnt(2)
    v_mfma_f32_16x16x32_bf16 v[104:107], v[36:39], v[56:59], v[104:107]
    ds_read_b128 v[52:55], v7 offset:13312
    v_cvt_pk_bf16_f32 v20, v65, v69
    s_waitcnt lgkmcnt(2)
    v_mfma_f32_16x16x32_bf16 v[108:111], v[36:39], v[60:63], v[108:111]
    ds_read_b128 v[56:59], v7 offset:14336
    v_cvt_pk_bf16_f32 v21, v73, v77
    s_waitcnt lgkmcnt(2)
    v_mfma_f32_16x16x32_bf16 v[112:115], v[36:39], v[48:51], v[112:115]
    ds_read_b128 v[60:63], v7 offset:15360
    v_cvt_pk_bf16_f32 v22, v81, v85
    s_waitcnt lgkmcnt(2)
    v_mfma_f32_16x16x32_bf16 v[116:119], v[36:39], v[52:55], v[116:119]
    ds_read_b128 v[48:51], v7 offset:16384
    v_cvt_pk_bf16_f32 v23, v89, v93
    s_waitcnt lgkmcnt(2)
    v_mfma_f32_16x16x32_bf16 v[120:123], v[36:39], v[56:59], v[120:123]
    ds_read_b128 v[52:55], v7 offset:17408
    v_and_or_b32 v20, v20, -2, s27
    s_waitcnt lgkmcnt(2)
    v_mfma_f32_16x16x32_bf16 v[124:127], v[36:39], v[60:63], v[124:127]
    ds_read_b128 v[56:59], v7 offset:18432
    s_add_u32 s36, s25, 0x8000
    s_waitcnt lgkmcnt(2)
    v_mfma_f32_16x16x32_bf16 v[96:99], v[40:43], v[48:51], v[96:99]
    ds_read_b128 v[60:63], v7 offset:19456
    buffer_store_dwordx4 v[20:23], v10, s[8:11], s36 offen sc1
    s_waitcnt lgkmcnt(2)
    v_mfma_f32_16x16x32_bf16 v[100:103], v[40:43], v[52:55], v[100:103]
    ds_read_b128 v[48:51], v7 offset:20480
    v_cvt_pk_bf16_f32 v24, v66, v70
    s_waitcnt lgkmcnt(2)
    v_mfma_f32_16x16x32_bf16 v[104:107], v[40:43], v[56:59], v[104:107]
    ds_read_b128 v[52:55], v7 offset:21504
    v_cvt_pk_bf16_f32 v25, v74, v78
    s_waitcnt lgkmcnt(2)
    v_mfma_f32_16x16x32_bf16 v[108:111], v[40:43], v[60:63], v[108:111]
    ds_read_b128 v[56:59], v7 offset:22528
    v_cvt_pk_bf16_f32 v26, v82, v86
    s_waitcnt lgkmcnt(2)
    v_mfma_f32_16x16x32_bf16 v[112:115], v[40:43], v[48:51], v[112:115]
    ds_read_b128 v[60:63], v7 offset:23552
    v_cvt_pk_bf16_f32 v27, v90, v94
    s_waitcnt lgkmcnt(2)
    v_mfma_f32_16x16x32_bf16 v[116:119], v[40:43], v[52:55], v[116:119]
    ds_read_b128 v[48:51], v7 offset:24576
    v_and_or_b32 v24, v24, -2, s27
    s_waitcnt lgkmcnt(2)
    v_mfma_f32_16x16x32_bf16 v[120:123], v[40:43], v[56:59], v[120:123]
    ds_read_b128 v[52:55], v7 offset:25600
    s_add_u32 s36, s25, 0x10000
    s_waitcnt lgkmcnt(2)
    v_mfma_f32_16x16x32_bf16 v[124:127], v[40:43], v[60:63], v[124:127]
    ds_read_b128 v[56:59], v7 offset:26624
    buffer_store_dwordx4 v[24:27], v10, s[8:11], s36 offen sc1
    s_waitcnt lgkmcnt(2)
    v_mfma_f32_16x16x32_bf16 v[96:99], v[44:47], v[48:51], v[96:99]
    ds_read_b128 v[60:63], v7 offset:27648
    v_cvt_pk_bf16_f32 v28, v67, v71
    s_waitcnt lgkmcnt(2)
    v_mfma_f32_16x16x32_bf16 v[100:103], v[44:47], v[52:55], v[100:103]
    ds_read_b128 v[48:51], v7 offset:28672
    v_cvt_pk_bf16_f32 v29, v75, v79
    s_waitcnt lgkmcnt(2)
    v_mfma_f32_16x16x32_bf16 v[104:107], v[44:47], v[56:59], v[104:107]
    ds_read_b128 v[52:55], v7 offset:29696
    v_cvt_pk_bf16_f32 v30, v83, v87
    s_waitcnt lgkmcnt(2)
    v_mfma_f32_16x16x32_bf16 v[108:111], v[44:47], v[60:63], v[108:111]
    ds_read_b128 v[56:59], v7 offset:30720
    v_cvt_pk_bf16_f32 v31, v91, v95
    s_waitcnt lgkmcnt(2)
    v_mfma_f32_16x16x32_bf16 v[112:115], v[44:47], v[48:51], v[112:115]
    ds_read_b128 v[60:63], v7 offset:31744
    v_and_or_b32 v28, v28, -2, s27
    s_waitcnt lgkmcnt(2)
    v_mfma_f32_16x16x32_bf16 v[116:119], v[44:47], v[52:55], v[116:119]
    s_add_u32 s36, s25, 0x18000
    s_waitcnt lgkmcnt(1)
    v_mfma_f32_16x16x32_bf16 v[120:123], v[44:47], v[56:59], v[120:123]
    buffer_store_dwordx4 v[28:31], v10, s[8:11], s36 offen sc1
    s_waitcnt lgkmcnt(0)
    v_mfma_f32_16x16x32_bf16 v[124:127], v[44:47], v[60:63], v[124:127]
    v_cvt_pk_bf16_f32 v32, v96, v100
    v_cvt_pk_bf16_f32 v33, v104, v108
    v_cvt_pk_bf16_f32 v34, v112, v116
    s_nop 4
    v_cvt_pk_bf16_f32 v35, v120, v124
    v_and_or_b32 v32, v32, -2, s27
    s_add_u32 s36, s25, 0x80000
    buffer_store_dwordx4 v[32:35], v10, s[8:11], s36 offen sc1
    v_cvt_pk_bf16_f32 v36, v97, v101
    v_cvt_pk_bf16_f32 v37, v105, v109
    v_cvt_pk_bf16_f32 v38, v113, v117
    v_cvt_pk_bf16_f32 v39, v121, v125
    v_and_or_b32 v36, v36, -2, s27
    s_add_u32 s36, s25, 0x88000
    buffer_store_dwordx4 v[36:39], v10, s[8:11], s36 offen sc1
    v_cvt_pk_bf16_f32 v40, v98, v102
    v_cvt_pk_bf16_f32 v41, v106, v110
    v_cvt_pk_bf16_f32 v42, v114, v118
    v_cvt_pk_bf16_f32 v43, v122, v126
    v_and_or_b32 v40, v40, -2, s27
    s_add_u32 s36, s25, 0x90000
    buffer_store_dwordx4 v[40:43], v10, s[8:11], s36 offen sc1
    v_cvt_pk_bf16_f32 v44, v99, v103
    v_cvt_pk_bf16_f32 v45, v107, v111
    v_cvt_pk_bf16_f32 v46, v115, v119
    v_cvt_pk_bf16_f32 v47, v123, v127
    v_and_or_b32 v44, v44, -2, s27
    s_add_u32 s36, s25, 0x98000
    buffer_store_dwordx4 v[44:47], v10, s[8:11], s36 offen sc1
    s_add_u32 s38, s23, 6
    s_cmp_ge_u32 s38, 64
    s_cbranch_scc1 L_P2_last
    s_mul_i32 s24, s38, 0x82100
    s_lshl_b32 s36, s20, 14
    s_add_u32 s24, s24, s36
    s_add_u32 s24, s24, 0x1000000
    s_add_u32 s36, s24, 0
    s_add_u32 s37, s36, 0x7000000
    buffer_load_dwordx4 a[32:35], v1, s[8:11], s36 offen offset:0 sc1
    buffer_load_dwordx4 a[0:3], v1, s[8:11], s37 offen offset:0 sc1
    buffer_load_dwordx4 a[36:39], v1, s[8:11], s36 offen offset:1024 sc1
    buffer_load_dwordx4 a[4:7], v1, s[8:11], s37 offen offset:1024 sc1
    buffer_load_dwordx4 a[40:43], v1, s[8:11], s36 offen offset:2048 sc1
    buffer_load_dwordx4 a[8:11], v1, s[8:11], s37 offen offset:2048 sc1
    buffer_load_dwordx4 a[44:47], v1, s[8:11], s36 offen offset:3072 sc1
    buffer_load_dwordx4 a[12:15], v1, s[8:11], s37 offen offset:3072 sc1
    s_add_u32 s36, s24, 4096
    s_add_u32 s37, s36, 0x7000000
    buffer_load_dwordx4 a[48:51], v1, s[8:11], s36 offen offset:0 sc1
    buffer_load_dwordx4 a[16:19], v1, s[8:11], s37 offen offset:0 sc1
    buffer_load_dwordx4 a[52:55], v1, s[8:11], s36 offen offset:1024 sc1
    buffer_load_dwordx4 a[20:23], v1, s[8:11], s37 offen offset:1024 sc1
    buffer_load_dwordx4 a[56:59], v1, s[8:11], s36 offen offset:2048 sc1
    buffer_load_dwordx4 a[24:27], v1, s[8:11], s37 offen offset:2048 sc1
    buffer_load_dwordx4 a[60:63], v1, s[8:11], s36 offen offset:3072 sc1
    buffer_load_dwordx4 a[28:31], v1, s[8:11], s37 offen offset:3072 sc1
    s_lshr_b32 s36, s21, 1
    s_lshl_b32 s36, s36, 3
    s_xor_b32 s37, s36, 8
    s_add_u32 s24, s24, 8192
    s_add_u32 s36, s36, s24
    s_add_u32 s37, s37, s24
    buffer_load_dwordx2 a[64:65], v2, s[8:11], s36 offen offset:0 sc1
    buffer_load_dwordx2 a[66:67], v2, s[8:11], s37 offen offset:0 sc1
    buffer_load_dwordx2 a[68:69], v2, s[8:11], s36 offen offset:1024 sc1
    buffer_load_dwordx2 a[70:71], v2, s[8:11], s37 offen offset:1024 sc1
L_P2_last:
    s_lshl_b32 s24, s23, 5
    s_add_u32 s24, s24, s20
    s_lshl_b32 s24, s24, 10
    v_accvgpr_read_b32 v52, a72
    v_accvgpr_read_b32 v53, a73
    v_and_b32 v15, 15, v0
    v_mov_b32 v48, 0
    v_mov_b32 v14, 0x3f80
    v_cmp_eq_u32 vcc, 0, v15
    s_nop 1
    v_cndmask_b32 v48, v48, v14, vcc
    v_mov_b32 v14, 0x3f800000
    v_cmp_eq_u32 vcc, 1, v15
    s_nop 1
    v_cndmask_b32 v48, v48, v14, vcc
    v_mov_b32 v49, 0
    v_mov_b32 v14, 0x3f80
    v_cmp_eq_u32 vcc, 4, v15
    s_nop 1
    v_cndmask_b32 v49, v49, v14, vcc
    v_mov_b32 v14, 0x3f800000
    v_cmp_eq_u32 vcc, 5, v15
    s_nop 1
    v_cndmask_b32 v49, v49, v14, vcc
    v_mov_b32 v50, 0
    v_mov_b32 v14, 0x3f80
    v_cmp_eq_u32 vcc, 8, v15
    s_nop 1
    v_cndmask_b32 v50, v50, v14, vcc
    v_mov_b32 v14, 0x3f800000
    v_cmp_eq_u32 vcc, 9, v15
    s_nop 1
    v_cndmask_b32 v50, v50, v14, vcc
    v_mov_b32 v51, 0
    v_mov_b32 v14, 0x3f80
    v_cmp_eq_u32 vcc, 12, v15
    s_nop 1
    v_cndmask_b32 v51, v51, v14, vcc
    v_mov_b32 v14, 0x3f800000
    v_cmp_eq_u32 vcc, 13, v15
    s_nop 1
    v_cndmask_b32 v51, v51, v14, vcc
    s_lshl_b32 s25, s20, 15
    s_add_u32 s25, s25, s26
L_P3_poll:
    s_add_u32 s36, s25, 0
    buffer_load_dwordx4 v[80:83], v11, s[8:11], s36 offen sc1
    s_add_u32 s36, s25, 4096
    buffer_load_dwordx4 v[84:87], v11, s[8:11], s36 offen sc1
    s_add_u32 s36, s25, 8192
    buffer_load_dwordx4 v[88:91], v11, s[8:11], s36 offen sc1
    s_add_u32 s36, s25, 12288
    buffer_load_dwordx4 v[92:95], v11, s[8:11], s36 offen sc1
    s_add_u32 s36, s25, 16384
    buffer_load_dwordx4 v[96:99], v11, s[8:11], s36 offen sc1
    s_add_u32 s36, s25, 20480
    buffer_load_dwordx4 v[100:103], v11, s[8:11], s36 offen sc1
    s_add_u32 s36, s25, 24576
    buffer_load_dwordx4 v[104:107], v11, s[8:11], s36 offen sc1
    s_add_u32 s36, s25, 28672
    buffer_load_dwordx4 v[108:111], v11, s[8:11], s36 offen sc1
    s_mov_b64 exec, -1
    s_add_u32 s32, s32, 1
    s_cmp_gt_u32 s32, 200000
    s_waitcnt vmcnt(7)
    v_mfma_f32_16x16x32_bf16 v[56:59], v[48:51], v[80:83], 0
    s_waitcnt vmcnt(6)
    v_mfma_f32_16x16x32_bf16 v[56:59], v[48:51], v[84:87], v[56:59]
    v_bitop3_b32 v60, v80, v84, s27 bitop3:0x7e
    s_waitcnt vmcnt(5)
    v_mfma_f32_16x16x32_bf16 v[56:59], v[48:51], v[88:91], v[56:59]
    s_waitcnt vmcnt(4)
    v_mfma_f32_16x16x32_bf16 v[56:59], v[48:51], v[92:95], v[56:59]
    v_bitop3_b32 v61, v88, v92, s27 bitop3:0x7e
    s_waitcnt vmcnt(3)
    v_mfma_f32_16x16x32_bf16 v[56:59], v[48:51], v[96:99], v[56:59]
    s_waitcnt vmcnt(2)
    v_mfma_f32_16x16x32_bf16 v[56:59], v[48:51], v[100:103], v[56:59]
    v_bitop3_b32 v62, v96, v100, s27 bitop3:0x7e
    s_waitcnt vmcnt(1)
    v_mfma_f32_16x16x32_bf16 v[56:59], v[48:51], v[104:107], v[56:59]
    s_waitcnt vmcnt(0)
    v_mfma_f32_16x16x32_bf16 v[56:59], v[48:51], v[108:111], v[56:59]
    v_bitop3_b32 v63, v104, v108, s27 bitop3:0x7e
    v_or3_b32 v14, v60, v61, v62
    v_bitop3_b32 v14, v14, v63, 1 bitop3:0xa8
    s_cbranch_scc1 L_P3_got
    v_cmp_ne_u32 vcc, 0, v14
    s_cbranch_vccz L_P3_got
    s_mov_b64 exec, vcc
    s_branch L_P3_poll
L_P3_got:
    s_nop 4
    v_cvt_pk_bf16_f32 v62, v56, v57
    v_lshlrev_b32 v65, 16, v62
    v_and_b32 v66, 0xffff0000, v62
    v_lshlrev_b32 v60, 16, v52
    v_and_b32 v61, 0xffff0000, v52
    v_add_f32 v60, v60, v65
    v_add_f32 v61, v61, v66
    v_cvt_pk_bf16_f32 v62, v60, v61
    v_lshlrev_b32 v60, 16, v62
    v_and_b32 v61, 0xffff0000, v62
    v_add_f32 v63, v60, v61
    v_mul_f32 v64, v60, v60
    v_fmac_f32 v64, v61, v61
    v_add_f32_dpp v63, v63, v63 quad_perm:[1,0,3,2] row_mask:0xf bank_mask:0xf
    s_nop 0
    v_add_f32_dpp v64, v64, v64 quad_perm:[1,0,3,2] row_mask:0xf bank_mask:0xf
    v_add_f32_dpp v63, v63, v63 quad_perm:[2,3,0,1] row_mask:0xf bank_mask:0xf
    s_nop 0
    v_add_f32_dpp v64, v64, v64 quad_perm:[2,3,0,1] row_mask:0xf bank_mask:0xf
    v_add_f32_dpp v63, v63, v63 row_half_mirror row_mask:0xf bank_mask:0xf
    s_nop 0
    v_add_f32_dpp v64, v64, v64 row_half_mirror row_mask:0xf bank_mask:0xf
    v_add_f32_dpp v63, v63, v63 row_mirror row_mask:0xf bank_mask:0xf
    s_nop 0
    v_add_f32_dpp v64, v64, v64 row_mirror row_mask:0xf bank_mask:0xf
    v_mov_b32 v14, v63
    s_nop 1
    v_permlane16_swap_b32 v63, v14
    v_add_f32 v63, v63, v14
    v_mov_b32 v14, v64
    s_nop 1
    v_permlane16_swap_b32 v64, v14
    v_add_f32 v64, v64, v14
    v_mov_b32 v14, v63
    s_nop 1
    v_permlane32_swap_b32 v63, v14
    v_add_f32 v63, v63, v14
    v_mov_b32 v14, v64
    s_nop 1
    v_permlane32_swap_b32 v64, v14
    v_add_f32 v64, v64, v14
    v_mov_b32 v15, s21
    v_lshlrev_b32 v15, 3, v15
    v_add_u32 v15, 28672, v15
    ds_write2_b32 v15, v63, v64 offset0:0 offset1:1
    s_add_u32 s36, s24, 0x400000
    buffer_store_dword v62, v12, s[8:11], s36 offen sc1
    s_waitcnt lgkmcnt(0)
    s_barrier
    v_mov_b32 v15, 28672
    ds_read_b128 v[68:71], v15
    ds_read_b128 v[72:75], v15 offset:16
    s_waitcnt lgkmcnt(0)
    v_add_f32 v63, v68, v70
    v_add_f32 v63, v63, v72
    v_add_f32 v63, v63, v74
    v_mul_f32 v63, 0x3b000000, v63
    v_add_f32 v64, v69, v71
    v_add_f32 v64, v64, v73
    v_add_f32 v64, v64, v75
    v_mul_f32 v64, 0x3b000000, v64
    v_fma_f32 v64, -v63, v63, v64
    v_max_f32 v64, 0, v64
    v_cvt_pk_bf16_f32 v14, v63, v64
    v_lshlrev_b32 v63, 16, v14
    v_and_b32 v64, 0xffff0000, v14
    v_add_f32 v64, 0x3727c5ac, v64
    v_cvt_pk_bf16_f32 v14, v64, v64
    v_lshlrev_b32 v64, 16, v14
    v_sqrt_f32 v64, v64
    s_nop 0
    v_cvt_pk_bf16_f32 v14, v64, v64
    v_lshlrev_b32 v64, 16, v14
    v_rcp_f32 v64, v64
    v_sub_f32 v65, v60, v63
    v_sub_f32 v66, v61, v63
    v_cvt_pk_bf16_f32 v14, v65, v66
    v_lshlrev_b32 v65, 16, v14
    v_and_b32 v66, 0xffff0000, v14
    v_mul_f32 v65, v65, v64
    v_mul_f32 v66, v66, v64
    v_cvt_pk_bf16_f32 v67, v65, v66
    v_lshlrev_b32 v65, 16, v67
    v_and_b32 v66, 0xffff0000, v67
    v_lshlrev_b32 v68, 16, v53
    v_and_b32 v69, 0xffff0000, v53
    v_mul_f32 v63, v65, v68
    v_fmac_f32 v63, v66, v69
    s_nop 1
    v_add_f32_dpp v63, v63, v63 quad_perm:[1,0,3,2] row_mask:0xf bank_mask:0xf
    s_nop 1
    v_add_f32_dpp v63, v63, v63 quad_perm:[2,3,0,1] row_mask:0xf bank_mask:0xf
    s_nop 1
    v_add_f32_dpp v63, v63, v63 row_half_mirror row_mask:0xf bank_mask:0xf
    s_nop 1
    v_add_f32_dpp v63, v63, v63 row_mirror row_mask:0xf bank_mask:0xf
    v_mov_b32 v14, v63
    s_nop 1
    v_permlane16_swap_b32 v63, v14
    v_add_f32 v63, v63, v14
    v_mov_b32 v14, v63
    s_nop 1
    v_permlane32_swap_b32 v63, v14
    v_add_f32 v63, v63, v14
    s_lshr_b32 s25, s24, 6
    s_lshl_b32 s37, s21, 2
    s_add_u32 s25, s25, s37
    s_add_u32 s36, s25, 0x194000
    v_cmp_ne_u32 vcc, 0, v1
    v_mov_b32 v15, 0x40000000
    s_nop 0
    v_cndmask_b32 v15, v1, v15, vcc
    buffer_store_dword v63, v15, s[8:11], s36 offen sc1
    v_add_f32 v60, v60, v65
    v_add_f32 v61, v61, v66
    v_cvt_pk_bf16_f32 v62, v60, v61
    buffer_store_dword v62, v12, s[60:63], s24 offen sc1
    s_add_u32 s36, s24, 0x600000
    buffer_store_dword v67, v12, s[8:11], s36 offen sc1
    s_add_u32 s30, s25, 0x1b8000
    s_add_u32 s29, s29, 1
    s_barrier
    s_add_u32 s23, s23, 6
    s_cmp_lt_u32 s23, 64
    s_cbranch_scc1 L_P2
    s_waitcnt vmcnt(0)
    v_cmp_ne_u32 vcc, 0, v1
    v_mov_b32 v15, 0x40000000
    v_mov_b32 v14, 0
    v_cndmask_b32 v15, v1, v15, vcc
    buffer_store_dword v14, v15, s[8:11], s30 offen sc1
    s_branch L_end
L_mlp:
    s_mov_b32 s12, s44
    s_and_b32 s13, s45, 0xffff
    s_mov_b32 s14, 0x200000
    s_mov_b32 s15, 0x20000
    s_mov_b32 s60, s82
    s_and_b32 s61, s83, 0xffff
    s_mov_b32 s62, 0x200000
    s_mov_b32 s63, 0x20000
    s_mov_b32 s92, s80
    s_and_b32 s93, s81, 0xffff
    s_mov_b32 s94, 0x400
    s_mov_b32 s95, 0x20000
    v_mov_b32 v1, 0x0
    v_bfe_u32 v14, v0, 0, 1
    s_mov_b32 s38, 0x10
    v_mad_u32_u24 v1, v14, s38, v1
    v_bfe_u32 v14, v0, 1, 1
    s_mov_b32 s38, 0x20
    v_mad_u32_u24 v1, v14, s38, v1
    v_bfe_u32 v14, v0, 2, 1
    s_mov_b32 s38, 0x40
    v_mad_u32_u24 v1, v14, s38, v1
    v_bfe_u32 v14, v0, 3, 1
    s_mov_b32 s38, 0x80
    v_mad_u32_u24 v1, v14, s38, v1
    v_bfe_u32 v14, v0, 4, 1
    s_mov_b32 s38, 0x100
    v_mad_u32_u24 v1, v14, s38, v1
    v_bfe_u32 v14, v0, 5, 1
    s_mov_b32 s38, 0x200
    v_mad_u32_u24 v1, v14, s38, v1
    v_mov_b32 v2, 0x0
    v_bfe_u32 v14, v0, 0, 1
    s_mov_b32 s38, 0x10
    v_mad_u32_u24 v2, v14, s38, v2
    v_bfe_u32 v14, v0, 1, 1
    s_mov_b32 s38, 0x20
    v_mad_u32_u24 v2, v14, s38, v2
    v_bfe_u32 v14, v0, 2, 1
    s_mov_b32 s38, 0x40
    v_mad_u32_u24 v2, v14, s38, v2
    v_bfe_u32 v14, v0, 3, 1
    s_mov_b32 s38, 0x80
    v_mad_u32_u24 v2, v14, s38, v2
    v_bfe_u32 v14, v0, 4, 1
    s_mov_b32 s38, 0x100
    v_mad_u32_u24 v2, v14, s38, v2
    v_bfe_u32 v14, v0, 5, 1
    s_mov_b32 s38, 0x200
    v_mad_u32_u24 v2, v14, s38, v2
    v_bfe_u32 v14, v0, 6, 1
    s_mov_b32 s38, 0x800
    v_mad_u32_u24 v2, v14, s38, v2
    v_bfe_u32 v14, v0, 7, 1
    s_mov_b32 s38, 0x1000
    v_mad_u32_u24 v2, v14, s38, v2
    v_mov_b32 v9, 0x0
    v_bfe_u32 v14, v0, 0, 1
    s_mov_b32 s38, 0x10
    v_mad_u32_u24 v9, v14, s38, v9
    v_bfe_u32 v14, v0, 1, 1
    s_mov_b32 s38, 0x20
    v_mad_u32_u24 v9, v14, s38, v9
    v_bfe_u32 v14, v0, 2, 1
    s_mov_b32 s38, 0x40
    v_mad_u32_u24 v9, v14, s38, v9
    v_bfe_u32 v14, v0, 3, 1
    s_mov_b32 s38, 0x80
    v_mad_u32_u24 v9, v14, s38, v9
    v_bfe_u32 v14, v0, 4, 1
    s_mov_b32 s38, 0x100
    v_mad_u32_u24 v9, v14, s38, v9
    v_bfe_u32 v14, v0, 5, 1
    s_mov_b32 s38, 0x200
    v_mad_u32_u24 v9, v14, s38, v9
    v_bfe_u32 v14, v0, 6, 1
    s_mov_b32 s38, 0x400
    v_mad_u32_u24 v9, v14, s38, v9
    v_bfe_u32 v14, v0, 7, 1
    s_mov_b32 s38, 0x800
    v_mad_u32_u24 v9, v14, s38, v9
    v_mov_b32 v7, 0x8000
    v_bfe_u32 v14, v0, 0, 1
    s_mov_b32 s38, 0x10
    v_mad_u32_u24 v7, v14, s38, v7
    v_bfe_u32 v14, v0, 1, 1
    s_mov_b32 s38, 0x20
    v_mad_u32_u24 v7, v14, s38, v7
    v_bfe_u32 v14, v0, 2, 1
    s_mov_b32 s38, 0x40
    v_mad_u32_u24 v7, v14, s38, v7
    v_bfe_u32 v14, v0, 3, 1
    s_mov_b32 s38, 0x80
    v_mad_u32_u24 v7, v14, s38, v7
    v_bfe_u32 v14, v0, 4, 1
    s_mov_b32 s38, 0x100
    v_mad_u32_u24 v7, v14, s38, v7
    v_bfe_u32 v14, v0, 5, 1
    s_mov_b32 s38, 0x200
    v_mad_u32_u24 v7, v14, s38, v7
    v_bfe_u32 v14, v0, 6, 1
    s_mov_b32 s38, 0x8000
    v_mad_u32_u24 v7, v14, s38, v7
    v_bfe_u32 v14, v0, 7, 1
    s_mov_b32 s38, 0x10000
    v_mad_u32_u24 v7, v14, s38, v7
    v_mov_b32 v3, 0x0
    v_bfe_u32 v14, v0, 0, 1
    s_mov_b32 s38, 0x10
    v_mad_u32_u24 v3, v14, s38, v3
    v_bfe_u32 v14, v0, 1, 1
    s_mov_b32 s38, 0x20
    v_mad_u32_u24 v3, v14, s38, v3
    v_bfe_u32 v14, v0, 2, 1
    s_mov_b32 s38, 0x40
    v_mad_u32_u24 v3, v14, s38, v3
    v_bfe_u32 v14, v0, 3, 1
    s_mov_b32 s38, 0x400
    v_mad_u32_u24 v3, v14, s38, v3
    v_bfe_u32 v14, v0, 4, 1
    s_mov_b32 s38, 0x800
    v_mad_u32_u24 v3, v14, s38, v3
    v_bfe_u32 v14, v0, 5, 1
    s_mov_b32 s38, 0x1000
    v_mad_u32_u24 v3, v14, s38, v3
    v_bfe_u32 v14, v0, 6, 1
    s_mov_b32 s38, 0x2000
    v_mad_u32_u24 v3, v14, s38, v3
    v_bfe_u32 v14, v0, 7, 1
    s_mov_b32 s38, 0x4000
    v_mad_u32_u24 v3, v14, s38, v3
    v_mov_b32 v4, 0x0
    v_bfe_u32 v14, v0, 0, 1
    s_mov_b32 s38, 0x100
    v_mad_u32_u24 v4, v14, s38, v4
    v_bfe_u32 v14, v0, 1, 1
    s_mov_b32 s38, 0x200
    v_mad_u32_u24 v4, v14, s38, v4
    v_bfe_u32 v14, v0, 2, 1
    s_mov_b32 s38, 0x400
    v_mad_u32_u24 v4, v14, s38, v4
    v_bfe_u32 v14, v0, 6, 1
    s_mov_b32 s38, 0x80
    v_mad_u32_u24 v4, v14, s38, v4
    v_bfe_u32 v14, v0, 7, 1
    s_mov_b32 s38, 0x4000
    v_mad_u32_u24 v4, v14, s38, v4
    v_lshrrev_b32 v15, 3, v0
    v_xor_b32 v15, v15, v0
    v_and_b32 v15, 7, v15
    v_lshl_add_u32 v4, v15, 4, v4
    v_bfe_u32 v15, v0, 4, 2
    v_lshlrev_b32 v15, 4, v15
    v_xor_b32 v5, v15, v1
    v_xor_b32 v6, 64, v5
    v_mov_b32 v8, 0x5000
    v_bfe_u32 v14, v0, 0, 1
    s_mov_b32 s38, 0x10
    v_mad_u32_u24 v8, v14, s38, v8
    v_bfe_u32 v14, v0, 1, 1
    s_mov_b32 s38, 0x40
    v_mad_u32_u24 v8, v14, s38, v8
    v_bfe_u32 v14, v0, 2, 1
    s_mov_b32 s38, 0x80
    v_mad_u32_u24 v8, v14, s38, v8
    v_bfe_u32 v14, v0, 4, 1
    s_mov_b32 s38, 0x20
    v_mad_u32_u24 v8, v14, s38, v8
    v_bfe_u32 v14, v0, 5, 1
    s_mov_b32 s38, 0x100
    v_mad_u32_u24 v8, v14, s38, v8
    v_mov_b32 v10, 0x0
    v_bfe_u32 v14, v0, 0, 1
    s_mov_b32 s38, 0x10
    v_mad_u32_u24 v10, v14, s38, v10
    v_bfe_u32 v14, v0, 1, 1
    s_mov_b32 s38, 0x20
    v_mad_u32_u24 v10, v14, s38, v10
    v_bfe_u32 v14, v0, 2, 1
    s_mov_b32 s38, 0x40
    v_mad_u32_u24 v10, v14, s38, v10
    v_bfe_u32 v14, v0, 3, 1
    s_mov_b32 s38, 0x80
    v_mad_u32_u24 v10, v14, s38, v10
    v_bfe_u32 v14, v0, 4, 1
    s_mov_b32 s38, 0x20000
    v_mad_u32_u24 v10, v14, s38, v10
    v_bfe_u32 v14, v0, 5, 1
    s_mov_b32 s38, 0x40000
    v_mad_u32_u24 v10, v14, s38, v10
    v_bfe_u32 v14, v0, 6, 1
    s_mov_b32 s38, 0x100
    v_mad_u32_u24 v10, v14, s38, v10
    v_bfe_u32 v14, v0, 7, 1
    s_mov_b32 s38, 0x200
    v_mad_u32_u24 v10, v14, s38, v10
    v_mov_b32 v11, 0x0
    v_bfe_u32 v14, v0, 0, 1
    s_mov_b32 s38, 0x10
    v_mad_u32_u24 v11, v14, s38, v11
    v_bfe_u32 v14, v0, 1, 1
    s_mov_b32 s38, 0x20
    v_mad_u32_u24 v11, v14, s38, v11
    v_bfe_u32 v14, v0, 2, 1
    s_mov_b32 s38, 0x40
    v_mad_u32_u24 v11, v14, s38, v11
    v_bfe_u32 v14, v0, 3, 1
    s_mov_b32 s38, 0x80
    v_mad_u32_u24 v11, v14, s38, v11
    v_bfe_u32 v14, v0, 4, 1
    s_mov_b32 s38, 0x400
    v_mad_u32_u24 v11, v14, s38, v11
    v_bfe_u32 v14, v0, 5, 1
    s_mov_b32 s38, 0x800
    v_mad_u32_u24 v11, v14, s38, v11
    v_bfe_u32 v14, v0, 6, 1
    s_mov_b32 s38, 0x100
    v_mad_u32_u24 v11, v14, s38, v11
    v_bfe_u32 v14, v0, 7, 1
    s_mov_b32 s38, 0x200
    v_mad_u32_u24 v11, v14, s38, v11
    v_mov_b32 v12, 0x0
    v_bfe_u32 v14, v0, 0, 1
    s_mov_b32 s38, 0x10
    v_mad_u32_u24 v12, v14, s38, v12
    v_bfe_u32 v14, v0, 1, 1
    s_mov_b32 s38, 0x20
    v_mad_u32_u24 v12, v14, s38, v12
    v_bfe_u32 v14, v0, 2, 1
    s_mov_b32 s38, 0x40
    v_mad_u32_u24 v12, v14, s38, v12
    v_bfe_u32 v14, v0, 3, 1
    s_mov_b32 s38, 0x80
    v_mad_u32_u24 v12, v14, s38, v12
    v_bfe_u32 v14, v0, 4, 1
    s_mov_b32 s38, 0x4
    v_mad_u32_u24 v12, v14, s38, v12
    v_bfe_u32 v14, v0, 5, 1
    s_mov_b32 s38, 0x8
    v_mad_u32_u24 v12, v14, s38, v12
    v_bfe_u32 v14, v0, 6, 1
    s_mov_b32 s38, 0x100
    v_mad_u32_u24 v12, v14, s38, v12
    v_bfe_u32 v14, v0, 7, 1
    s_mov_b32 s38, 0x200
    v_mad_u32_u24 v12, v14, s38, v12
    v_mov_b32 v13, 0xf149f2ca
    v_and_b32 v14, 15, v0
    v_bfe_u32 v15, v0, 4, 2
    v_cmp_gt_u32 s[72:73], 2, v15
    v_lshlrev_b32 v15, 2, v15
    v_cmp_le_u32 s[64:65], v15, v14
    v_add_u32 v15, 1, v15
    v_cmp_le_u32 s[66:67], v15, v14
    v_add_u32 v15, 1, v15
    v_cmp_le_u32 s[68:69], v15, v14
    v_add_u32 v15, 1, v15
    v_cmp_le_u32 s[70:71], v15, v14
    v_add_u32 v15, 1, v15
    s_mov_b32 s34, 0x05040100
    s_mov_b32 s35, 0x07060302
    s_mov_b32 s33, 0x3e0293ee
    s_mov_b32 s32, 0
    s_mov_b32 s4, 0x3f803f80
    s_mov_b32 s5, 0x3f803f80
    s_lshr_b32 s20, s2, 3
    s_lshr_b32 s23, s2, 3
    s_lshl_b32 s23, s23, 1
    s_lshl_b32 s36, s23, 15
    buffer_load_dwordx4 v[96:99], v3, s[12:15], s36 offen offset:0
    buffer_load_dwordx4 v[100:103], v3, s[12:15], s36 offen offset:128
    buffer_load_dwordx4 v[104:107], v3, s[12:15], s36 offen offset:256
    buffer_load_dwordx4 v[108:111], v3, s[12:15], s36 offen offset:384
    buffer_load_dwordx4 v[112:115], v3, s[12:15], s36 offen offset:512
    buffer_load_dwordx4 v[116:119], v3, s[12:15], s36 offen offset:640
    buffer_load_dwordx4 v[120:123], v3, s[12:15], s36 offen offset:768
    buffer_load_dwordx4 v[124:127], v3, s[12:15], s36 offen offset:896
    s_add_u32 s36, s36, 0x8000
    buffer_load_dwordx4 v[128:131], v3, s[12:15], s36 offen offset:0
    buffer_load_dwordx4 v[132:135], v3, s[12:15], s36 offen offset:128
    buffer_load_dwordx4 v[136:139], v3, s[12:15], s36 offen offset:256
    buffer_load_dwordx4 v[140:143], v3, s[12:15], s36 offen offset:384
    buffer_load_dwordx4 v[144:147], v3, s[12:15], s36 offen offset:512
    buffer_load_dwordx4 v[148:151], v3, s[12:15], s36 offen offset:640
    buffer_load_dwordx4 v[152:155], v3, s[12:15], s36 offen offset:768
    buffer_load_dwordx4 v[156:159], v3, s[12:15], s36 offen offset:896
    s_mov_b32 s96, s46
    s_and_b32 s97, s47, 0xffff
    s_mov_b32 s98, 0x2000
    s_mov_b32 s99, 0x20000
    v_mov_b32 v68, 0x0
    v_bfe_u32 v14, v0, 0, 1
    s_mov_b32 s38, 0x8
    v_mad_u32_u24 v68, v14, s38, v68
    v_bfe_u32 v14, v0, 1, 1
    s_mov_b32 s38, 0x10
    v_mad_u32_u24 v68, v14, s38, v68
    v_bfe_u32 v14, v0, 2, 1
    s_mov_b32 s38, 0x10000
    v_mad_u32_u24 v68, v14, s38, v68
    v_bfe_u32 v14, v0, 3, 1
    s_mov_b32 s38, 0x10000
    v_mad_u32_u24 v68, v14, s38, v68
    v_bfe_u32 v14, v0, 4, 1
    s_mov_b32 s38, 0x400
    v_mad_u32_u24 v68, v14, s38, v68
    v_bfe_u32 v14, v0, 5, 1
    s_mov_b32 s38, 0x4
    v_mad_u32_u24 v68, v14, s38, v68
    v_bfe_u32 v14, v0, 6, 1
    s_mov_b32 s38, 0x40
    v_mad_u32_u24 v68, v14, s38, v68
    v_bfe_u32 v14, v0, 7, 1
    s_mov_b32 s38, 0x80
    v_mad_u32_u24 v68, v14, s38, v68
    v_mov_b32 v70, s20
    v_mov_b32 v69, 0x0
    v_bfe_u32 v14, v70, 0, 1
    s_mov_b32 s38, 0x20
    v_mad_u32_u24 v69, v14, s38, v69
    v_bfe_u32 v14, v70, 1, 1
    s_mov_b32 s38, 0x800
    v_mad_u32_u24 v69, v14, s38, v69
    v_bfe_u32 v14, v70, 2, 1
    s_mov_b32 s38, 0x1000
    v_mad_u32_u24 v69, v14, s38, v69
    v_bfe_u32 v14, v70, 3, 1
    s_mov_b32 s38, 0x100
    v_mad_u32_u24 v69, v14, s38, v69
    v_bfe_u32 v14, v70, 4, 1
    s_mov_b32 s38, 0x200
    v_mad_u32_u24 v69, v14, s38, v69
    v_add_u32 v68, v68, v69
    buffer_load_dword v72, v68, s[96:99], 0 offen
    v_mov_b32 v64, -1
    v_mov_b32 v65, -1
    v_mov_b32 v66, -1
    v_mov_b32 v67, -1
    s_lshl_b32 s36, s20, 13
    s_add_u32 s36, s36, 0x0
    buffer_store_dwordx4 v[64:67], v2, s[8:11], s36 offen sc1
    buffer_store_dwordx4 v[64:67], v2, s[8:11], s36 offen offset:1024 sc1
    s_lshl_b32 s36, s20, 14
    s_add_u32 s36, s36, 0x100000
    s_add_u32 s37, s36, 0x2000
    buffer_store_dwordx4 v[64:67], v2, s[8:11], s36 offen sc1
    buffer_store_dwordx4 v[64:67], v2, s[8:11], s36 offen offset:1024 sc1
    buffer_store_dwordx4 v[64:67], v2, s[8:11], s37 offen sc1
    buffer_store_dwordx4 v[64:67], v2, s[8:11], s37 offen offset:1024 sc1
    s_mul_i32 s36, s20, 0x104200
    s_add_u32 s36, s36, 0x1102100
    s_add_u32 s37, s36, 0x82100
    buffer_store_dwordx4 v[64:67], v2, s[8:11], s36 offen sc1
    buffer_store_dwordx4 v[64:67], v2, s[8:11], s36 offen offset:1024 sc1
    buffer_store_dwordx4 v[64:67], v2, s[8:11], s37 offen sc1
    buffer_store_dwordx4 v[64:67], v2, s[8:11], s37 offen offset:1024 sc1
    v_lshlrev_b32 v68, 2, v0
    s_lshl_b32 s36, s20, 10
    s_add_u32 s37, s36, 0x194000
    buffer_store_dword v64, v68, s[8:11], s37 offen sc1
    s_add_u32 s37, s36, 0x1b0000
    buffer_store_dword v64, v68, s[8:11], s37 offen sc1
    s_add_u32 s37, s36, 0x1b8000
    buffer_store_dword v64, v68, s[8:11], s37 offen sc1
    v_mov_b32 v69, 0x40000000
    v_cmp_lt_u32 vcc, 63, v0
    s_nop 1
    v_cndmask_b32 v68, v68, v69, vcc
    v_mov_b32 v73, 0
    s_lshl_b32 s36, s20, 8
    s_add_u32 s37, s36, 0x192000
    buffer_store_dword v73, v68, s[8:11], s37 offen sc1
    s_mul_i32 s36, s20, 0x104200
    s_add_u32 s36, s36, 0x1082000
    s_add_u32 s37, s36, 0x82100
    buffer_store_dword v73, v68, s[8:11], s36 offen sc1
    buffer_store_dword v73, v68, s[8:11], s37 offen sc1
    v_mov_b32 v71, 0x80000
    v_bfe_u32 v14, v0, 0, 1
    s_mov_b32 s38, 0x8
    v_mad_u32_u24 v71, v14, s38, v71
    v_bfe_u32 v14, v0, 1, 1
    s_mov_b32 s38, 0x20
    v_mad_u32_u24 v71, v14, s38, v71
    v_bfe_u32 v14, v0, 4, 1
    s_mov_b32 s38, 0x10
    v_mad_u32_u24 v71, v14, s38, v71
    v_bfe_u32 v14, v0, 5, 1
    s_mov_b32 s38, 0x4
    v_mad_u32_u24 v71, v14, s38, v71
    v_bfe_u32 v14, v0, 6, 1
    s_mov_b32 s38, 0x800
    v_mad_u32_u24 v71, v14, s38, v71
    v_bfe_u32 v14, v0, 7, 1
    s_mov_b32 s38, 0x1000
    v_mad_u32_u24 v71, v14, s38, v71
    v_mov_b32 v69, s20
    v_mov_b32 v68, 0x0
    v_bfe_u32 v14, v69, 0, 1
    s_mov_b32 s38, 0x100
    v_mad_u32_u24 v68, v14, s38, v68
    v_bfe_u32 v14, v69, 1, 1
    s_mov_b32 s38, 0x40
    v_mad_u32_u24 v68, v14, s38, v68
    v_bfe_u32 v14, v69, 2, 1
    s_mov_b32 s38, 0x80
    v_mad_u32_u24 v68, v14, s38, v68
    v_bfe_u32 v14, v69, 3, 1
    s_mov_b32 s38, 0x200
    v_mad_u32_u24 v68, v14, s38, v68
    v_bfe_u32 v14, v69, 4, 1
    s_mov_b32 s38, 0x400
    v_mad_u32_u24 v68, v14, s38, v68
    v_add_u32 v71, v68, v71
    v_and_b32 v68, 12, v0
    v_cmp_ne_u32 vcc, 0, v68
    v_mov_b32 v68, 0x40000000
    s_nop 0
    v_cndmask_b32 v71, v71, v68, vcc
    s_waitcnt vmcnt(16)
    s_mov_b32 s36, 0x1000000
    buffer_store_dword v72, v71, s[8:11], s36 offen sc1
L_XN:
    v_mov_b32 v88, 0
    v_mov_b32 v89, 0
    v_dot2_f32_bf16 v88, v96, s4, v88
    v_dot2_f32_bf16 v89, v96, v96, v89
    v_dot2_f32_bf16 v88, v97, s4, v88
    v_dot2_f32_bf16 v89, v97, v97, v89
    v_dot2_f32_bf16 v88, v98, s4, v88
    v_dot2_f32_bf16 v89, v98, v98, v89
    v_dot2_f32_bf16 v88, v99, s4, v88
    v_dot2_f32_bf16 v89, v99, v99, v89
    v_dot2_f32_bf16 v88, v100, s4, v88
    v_dot2_f32_bf16 v89, v100, v100, v89
    v_dot2_f32_bf16 v88, v101, s4, v88
    v_dot2_f32_bf16 v89, v101, v101, v89
    v_dot2_f32_bf16 v88, v102, s4, v88
    v_dot2_f32_bf16 v89, v102, v102, v89
    v_dot2_f32_bf16 v88, v103, s4, v88
    v_dot2_f32_bf16 v89, v103, v103, v89
    v_dot2_f32_bf16 v88, v104, s4, v88
    v_dot2_f32_bf16 v89, v104, v104, v89
    v_dot2_f32_bf16 v88, v105, s4, v88
    v_dot2_f32_bf16 v89, v105, v105, v89
    v_dot2_f32_bf16 v88, v106, s4, v88
    v_dot2_f32_bf16 v89, v106, v106, v89
    v_dot2_f32_bf16 v88, v107, s4, v88
    v_dot2_f32_bf16 v89, v107, v107, v89
    v_dot2_f32_bf16 v88, v108, s4, v88
    v_dot2_f32_bf16 v89, v108, v108, v89
    v_dot2_f32_bf16 v88, v109, s4, v88
    v_dot2_f32_bf16 v89, v109, v109, v89
    v_dot2_f32_bf16 v88, v110, s4, v88
    v_dot2_f32_bf16 v89, v110, v110, v89
    v_dot2_f32_bf16 v88, v111, s4, v88
    v_dot2_f32_bf16 v89, v111, v111, v89
    v_dot2_f32_bf16 v88, v112, s4, v88
    v_dot2_f32_bf16 v89, v112, v112, v89
    v_dot2_f32_bf16 v88, v113, s4, v88
    v_dot2_f32_bf16 v89, v113, v113, v89
    v_dot2_f32_bf16 v88, v114, s4, v88
    v_dot2_f32_bf16 v89, v114, v114, v89
    v_dot2_f32_bf16 v88, v115, s4, v88
    v_dot2_f32_bf16 v89, v115, v115, v89
    v_dot2_f32_bf16 v88, v116, s4, v88
    v_dot2_f32_bf16 v89, v116, v116, v89
    v_dot2_f32_bf16 v88, v117, s4, v88
    v_dot2_f32_bf16 v89, v117, v117, v89
    v_dot2_f32_bf16 v88, v118, s4, v88
    v_dot2_f32_bf16 v89, v118, v118, v89
    v_dot2_f32_bf16 v88, v119, s4, v88
    v_dot2_f32_bf16 v89, v119, v119, v89
    v_dot2_f32_bf16 v88, v120, s4, v88
    v_dot2_f32_bf16 v89, v120, v120, v89
    v_dot2_f32_bf16 v88, v121, s4, v88
    v_dot2_f32_bf16 v89, v121, v121, v89
    v_dot2_f32_bf16 v88, v122, s4, v88
    v_dot2_f32_bf16 v89, v122, v122, v89
    v_dot2_f32_bf16 v88, v123, s4, v88
    v_dot2_f32_bf16 v89, v123, v123, v89
    v_dot2_f32_bf16 v88, v124, s4, v88
    v_dot2_f32_bf16 v89, v124, v124, v89
    v_dot2_f32_bf16 v88, v125, s4, v88
    v_dot2_f32_bf16 v89, v125, v125, v89
    v_dot2_f32_bf16 v88, v126, s4, v88
    v_dot2_f32_bf16 v89, v126, v126, v89
    v_dot2_f32_bf16 v88, v127, s4, v88
    v_dot2_f32_bf16 v89, v127, v127, v89
    s_nop 3
    v_add_f32_dpp v88, v88, v88 quad_perm:[1,0,3,2] row_mask:0xf bank_mask:0xf
    v_add_f32_dpp v89, v89, v89 quad_perm:[1,0,3,2] row_mask:0xf bank_mask:0xf
    s_nop 0
    v_add_f32_dpp v88, v88, v88 quad_perm:[2,3,0,1] row_mask:0xf bank_mask:0xf
    v_add_f32_dpp v89, v89, v89 quad_perm:[2,3,0,1] row_mask:0xf bank_mask:0xf
    s_nop 0
    v_add_f32_dpp v88, v88, v88 row_half_mirror row_mask:0xf bank_mask:0xf
    v_add_f32_dpp v89, v89, v89 row_half_mirror row_mask:0xf bank_mask:0xf
    v_mul_f32 v88, 0x3b000000, v88
    v_mul_f32 v89, 0x3b000000, v89
    v_fma_f32 v89, -v88, v88, v89
    v_max_f32 v89, 0, v89
    v_cvt_pk_bf16_f32 v14, v88, v89
    v_lshlrev_b32 v88, 16, v14
    v_and_b32 v89, 0xffff0000, v14
    v_add_f32 v89, 0x3727c5ac, v89
    v_cvt_pk_bf16_f32 v14, v89, v89
    v_lshlrev_b32 v89, 16, v14
    v_sqrt_f32 v89, v89
    s_nop 0
    v_cvt_pk_bf16_f32 v14, v89, v89
    v_lshlrev_b32 v89, 16, v14
    v_rcp_f32 v89, v89
    v_lshlrev_b32 v90, 16, v96
    v_and_b32 v91, 0xffff0000, v96
    v_sub_f32 v90, v90, v88
    v_sub_f32 v91, v91, v88
    v_cvt_pk_bf16_f32 v96, v90, v91
    v_lshlrev_b32 v90, 16, v96
    v_and_b32 v91, 0xffff0000, v96
    v_mul_f32 v90, v90, v89
    v_mul_f32 v91, v91, v89
    v_cvt_pk_bf16_f32 v96, v90, v91
    v_lshlrev_b32 v90, 16, v97
    v_and_b32 v91, 0xffff0000, v97
    v_sub_f32 v90, v90, v88
    v_sub_f32 v91, v91, v88
    v_cvt_pk_bf16_f32 v97, v90, v91
    v_lshlrev_b32 v90, 16, v97
    v_and_b32 v91, 0xffff0000, v97
    v_mul_f32 v90, v90, v89
    v_mul_f32 v91, v91, v89
    v_cvt_pk_bf16_f32 v97, v90, v91
    v_lshlrev_b32 v90, 16, v98
    v_and_b32 v91, 0xffff0000, v98
    v_sub_f32 v90, v90, v88
    v_sub_f32 v91, v91, v88
    v_cvt_pk_bf16_f32 v98, v90, v91
    v_lshlrev_b32 v90, 16, v98
    v_and_b32 v91, 0xffff0000, v98
    v_mul_f32 v90, v90, v89
    v_mul_f32 v91, v91, v89
    v_cvt_pk_bf16_f32 v98, v90, v91
    v_lshlrev_b32 v90, 16, v99
    v_and_b32 v91, 0xffff0000, v99
    v_sub_f32 v90, v90, v88
    v_sub_f32 v91, v91, v88
    v_cvt_pk_bf16_f32 v99, v90, v91
    v_lshlrev_b32 v90, 16, v99
    v_and_b32 v91, 0xffff0000, v99
    v_mul_f32 v90, v90, v89
    v_mul_f32 v91, v91, v89
    v_cvt_pk_bf16_f32 v99, v90, v91
    ds_write_b128 v4, v[96:99] offset:0
    v_lshlrev_b32 v90, 16, v100
    v_and_b32 v91, 0xffff0000, v100
    v_sub_f32 v90, v90, v88
    v_sub_f32 v91, v91, v88
    v_cvt_pk_bf16_f32 v100, v90, v91
    v_lshlrev_b32 v90, 16, v100
    v_and_b32 v91, 0xffff0000, v100
    v_mul_f32 v90, v90, v89
    v_mul_f32 v91, v91, v89
    v_cvt_pk_bf16_f32 v100, v90, v91
    v_lshlrev_b32 v90, 16, v101
    v_and_b32 v91, 0xffff0000, v101
    v_sub_f32 v90, v90, v88
    v_sub_f32 v91, v91, v88
    v_cvt_pk_bf16_f32 v101, v90, v91
    v_lshlrev_b32 v90, 16, v101
    v_and_b32 v91, 0xffff0000, v101
    v_mul_f32 v90, v90, v89
    v_mul_f32 v91, v91, v89
    v_cvt_pk_bf16_f32 v101, v90, v91
    v_lshlrev_b32 v90, 16, v102
    v_and_b32 v91, 0xffff0000, v102
    v_sub_f32 v90, v90, v88
    v_sub_f32 v91, v91, v88
    v_cvt_pk_bf16_f32 v102, v90, v91
    v_lshlrev_b32 v90, 16, v102
    v_and_b32 v91, 0xffff0000, v102
    v_mul_f32 v90, v90, v89
    v_mul_f32 v91, v91, v89
    v_cvt_pk_bf16_f32 v102, v90, v91
    v_lshlrev_b32 v90, 16, v103
    v_and_b32 v91, 0xffff0000, v103
    v_sub_f32 v90, v90, v88
    v_sub_f32 v91, v91, v88
    v_cvt_pk_bf16_f32 v103, v90, v91
    v_lshlrev_b32 v90, 16, v103
    v_and_b32 v91, 0xffff0000, v103
    v_mul_f32 v90, v90, v89
    v_mul_f32 v91, v91, v89
    v_cvt_pk_bf16_f32 v103, v90, v91
    ds_write_b128 v4, v[100:103] offset:2048
    v_lshlrev_b32 v90, 16, v104
    v_and_b32 v91, 0xffff0000, v104
    v_sub_f32 v90, v90, v88
    v_sub_f32 v91, v91, v88
    v_cvt_pk_bf16_f32 v104, v90, v91
    v_lshlrev_b32 v90, 16, v104
    v_and_b32 v91, 0xffff0000, v104
    v_mul_f32 v90, v90, v89
    v_mul_f32 v91, v91, v89
    v_cvt_pk_bf16_f32 v104, v90, v91
    v_lshlrev_b32 v90, 16, v105
    v_and_b32 v91, 0xffff0000, v105
    v_sub_f32 v90, v90, v88
    v_sub_f32 v91, v91, v88
    v_cvt_pk_bf16_f32 v105, v90, v91
    v_lshlrev_b32 v90, 16, v105
    v_and_b32 v91, 0xffff0000, v105
    v_mul_f32 v90, v90, v89
    v_mul_f32 v91, v91, v89
    v_cvt_pk_bf16_f32 v105, v90, v91
    v_lshlrev_b32 v90, 16, v106
    v_and_b32 v91, 0xffff0000, v106
    v_sub_f32 v90, v90, v88
    v_sub_f32 v91, v91, v88
    v_cvt_pk_bf16_f32 v106, v90, v91
    v_lshlrev_b32 v90, 16, v106
    v_and_b32 v91, 0xffff0000, v106
    v_mul_f32 v90, v90, v89
    v_mul_f32 v91, v91, v89
    v_cvt_pk_bf16_f32 v106, v90, v91
    v_lshlrev_b32 v90, 16, v107
    v_and_b32 v91, 0xffff0000, v107
    v_sub_f32 v90, v90, v88
    v_sub_f32 v91, v91, v88
    v_cvt_pk_bf16_f32 v107, v90, v91
    v_lshlrev_b32 v90, 16, v107
    v_and_b32 v91, 0xffff0000, v107
    v_mul_f32 v90, v90, v89
    v_mul_f32 v91, v91, v89
    v_cvt_pk_bf16_f32 v107, v90, v91
    ds_write_b128 v4, v[104:107] offset:4096
    v_lshlrev_b32 v90, 16, v108
    v_and_b32 v91, 0xffff0000, v108
    v_sub_f32 v90, v90, v88
    v_sub_f32 v91, v91, v88
    v_cvt_pk_bf16_f32 v108, v90, v91
    v_lshlrev_b32 v90, 16, v108
    v_and_b32 v91, 0xffff0000, v108
    v_mul_f32 v90, v90, v89
    v_mul_f32 v91, v91, v89
    v_cvt_pk_bf16_f32 v108, v90, v91
    v_lshlrev_b32 v90, 16, v109
    v_and_b32 v91, 0xffff0000, v109
    v_sub_f32 v90, v90, v88
    v_sub_f32 v91, v91, v88
    v_cvt_pk_bf16_f32 v109, v90, v91
    v_lshlrev_b32 v90, 16, v109
    v_and_b32 v91, 0xffff0000, v109
    v_mul_f32 v90, v90, v89
    v_mul_f32 v91, v91, v89
    v_cvt_pk_bf16_f32 v109, v90, v91
    v_lshlrev_b32 v90, 16, v110
    v_and_b32 v91, 0xffff0000, v110
    v_sub_f32 v90, v90, v88
    v_sub_f32 v91, v91, v88
    v_cvt_pk_bf16_f32 v110, v90, v91
    v_lshlrev_b32 v90, 16, v110
    v_and_b32 v91, 0xffff0000, v110
    v_mul_f32 v90, v90, v89
    v_mul_f32 v91, v91, v89
    v_cvt_pk_bf16_f32 v110, v90, v91
    v_lshlrev_b32 v90, 16, v111
    v_and_b32 v91, 0xffff0000, v111
    v_sub_f32 v90, v90, v88
    v_sub_f32 v91, v91, v88
    v_cvt_pk_bf16_f32 v111, v90, v91
    v_lshlrev_b32 v90, 16, v111
    v_and_b32 v91, 0xffff0000, v111
    v_mul_f32 v90, v90, v89
    v_mul_f32 v91, v91, v89
    v_cvt_pk_bf16_f32 v111, v90, v91
    ds_write_b128 v4, v[108:111] offset:6144
    v_lshlrev_b32 v90, 16, v112
    v_and_b32 v91, 0xffff0000, v112
    v_sub_f32 v90, v90, v88
    v_sub_f32 v91, v91, v88
    v_cvt_pk_bf16_f32 v112, v90, v91
    v_lshlrev_b32 v90, 16, v112
    v_and_b32 v91, 0xffff0000, v112
    v_mul_f32 v90, v90, v89
    v_mul_f32 v91, v91, v89
    v_cvt_pk_bf16_f32 v112, v90, v91
    v_lshlrev_b32 v90, 16, v113
    v_and_b32 v91, 0xffff0000, v113
    v_sub_f32 v90, v90, v88
    v_sub_f32 v91, v91, v88
    v_cvt_pk_bf16_f32 v113, v90, v91
    v_lshlrev_b32 v90, 16, v113
    v_and_b32 v91, 0xffff0000, v113
    v_mul_f32 v90, v90, v89
    v_mul_f32 v91, v91, v89
    v_cvt_pk_bf16_f32 v113, v90, v91
    v_lshlrev_b32 v90, 16, v114
    v_and_b32 v91, 0xffff0000, v114
    v_sub_f32 v90, v90, v88
    v_sub_f32 v91, v91, v88
    v_cvt_pk_bf16_f32 v114, v90, v91
    v_lshlrev_b32 v90, 16, v114
    v_and_b32 v91, 0xffff0000, v114
    v_mul_f32 v90, v90, v89
    v_mul_f32 v91, v91, v89
    v_cvt_pk_bf16_f32 v114, v90, v91
    v_lshlrev_b32 v90, 16, v115
    v_and_b32 v91, 0xffff0000, v115
    v_sub_f32 v90, v90, v88
    v_sub_f32 v91, v91, v88
    v_cvt_pk_bf16_f32 v115, v90, v91
    v_lshlrev_b32 v90, 16, v115
    v_and_b32 v91, 0xffff0000, v115
    v_mul_f32 v90, v90, v89
    v_mul_f32 v91, v91, v89
    v_cvt_pk_bf16_f32 v115, v90, v91
    ds_write_b128 v4, v[112:115] offset:8192
    v_lshlrev_b32 v90, 16, v116
    v_and_b32 v91, 0xffff0000, v116
    v_sub_f32 v90, v90, v88
    v_sub_f32 v91, v91, v88
    v_cvt_pk_bf16_f32 v116, v90, v91
    v_lshlrev_b32 v90, 16, v116
    v_and_b32 v91, 0xffff0000, v116
    v_mul_f32 v90, v90, v89
    v_mul_f32 v91, v91, v89
    v_cvt_pk_bf16_f32 v116, v90, v91
    v_lshlrev_b32 v90, 16, v117
    v_and_b32 v91, 0xffff0000, v117
    v_sub_f32 v90, v90, v88
    v_sub_f32 v91, v91, v88
    v_cvt_pk_bf16_f32 v117, v90, v91
    v_lshlrev_b32 v90, 16, v117
    v_and_b32 v91, 0xffff0000, v117
    v_mul_f32 v90, v90, v89
    v_mul_f32 v91, v91, v89
    v_cvt_pk_bf16_f32 v117, v90, v91
    v_lshlrev_b32 v90, 16, v118
    v_and_b32 v91, 0xffff0000, v118
    v_sub_f32 v90, v90, v88
    v_sub_f32 v91, v91, v88
    v_cvt_pk_bf16_f32 v118, v90, v91
    v_lshlrev_b32 v90, 16, v118
    v_and_b32 v91, 0xffff0000, v118
    v_mul_f32 v90, v90, v89
    v_mul_f32 v91, v91, v89
    v_cvt_pk_bf16_f32 v118, v90, v91
    v_lshlrev_b32 v90, 16, v119
    v_and_b32 v91, 0xffff0000, v119
    v_sub_f32 v90, v90, v88
    v_sub_f32 v91, v91, v88
    v_cvt_pk_bf16_f32 v119, v90, v91
    v_lshlrev_b32 v90, 16, v119
    v_and_b32 v91, 0xffff0000, v119
    v_mul_f32 v90, v90, v89
    v_mul_f32 v91, v91, v89
    v_cvt_pk_bf16_f32 v119, v90, v91
    ds_write_b128 v4, v[116:119] offset:10240
    v_lshlrev_b32 v90, 16, v120
    v_and_b32 v91, 0xffff0000, v120
    v_sub_f32 v90, v90, v88
    v_sub_f32 v91, v91, v88
    v_cvt_pk_bf16_f32 v120, v90, v91
    v_lshlrev_b32 v90, 16, v120
    v_and_b32 v91, 0xffff0000, v120
    v_mul_f32 v90, v90, v89
    v_mul_f32 v91, v91, v89
    v_cvt_pk_bf16_f32 v120, v90, v91
    v_lshlrev_b32 v90, 16, v121
    v_and_b32 v91, 0xffff0000, v121
    v_sub_f32 v90, v90, v88
    v_sub_f32 v91, v91, v88
    v_cvt_pk_bf16_f32 v121, v90, v91
    v_lshlrev_b32 v90, 16, v121
    v_and_b32 v91, 0xffff0000, v121
    v_mul_f32 v90, v90, v89
    v_mul_f32 v91, v91, v89
    v_cvt_pk_bf16_f32 v121, v90, v91
    v_lshlrev_b32 v90, 16, v122
    v_and_b32 v91, 0xffff0000, v122
    v_sub_f32 v90, v90, v88
    v_sub_f32 v91, v91, v88
    v_cvt_pk_bf16_f32 v122, v90, v91
    v_lshlrev_b32 v90, 16, v122
    v_and_b32 v91, 0xffff0000, v122
    v_mul_f32 v90, v90, v89
    v_mul_f32 v91, v91, v89
    v_cvt_pk_bf16_f32 v122, v90, v91
    v_lshlrev_b32 v90, 16, v123
    v_and_b32 v91, 0xffff0000, v123
    v_sub_f32 v90, v90, v88
    v_sub_f32 v91, v91, v88
    v_cvt_pk_bf16_f32 v123, v90, v91
    v_lshlrev_b32 v90, 16, v123
    v_and_b32 v91, 0xffff0000, v123
    v_mul_f32 v90, v90, v89
    v_mul_f32 v91, v91, v89
    v_cvt_pk_bf16_f32 v123, v90, v91
    ds_write_b128 v4, v[120:123] offset:12288
    v_lshlrev_b32 v90, 16, v124
    v_and_b32 v91, 0xffff0000, v124
    v_sub_f32 v90, v90, v88
    v_sub_f32 v91, v91, v88
    v_cvt_pk_bf16_f32 v124, v90, v91
    v_lshlrev_b32 v90, 16, v124
    v_and_b32 v91, 0xffff0000, v124
    v_mul_f32 v90, v90, v89
    v_mul_f32 v91, v91, v89
    v_cvt_pk_bf16_f32 v124, v90, v91
    v_lshlrev_b32 v90, 16, v125
    v_and_b32 v91, 0xffff0000, v125
    v_sub_f32 v90, v90, v88
    v_sub_f32 v91, v91, v88
    v_cvt_pk_bf16_f32 v125, v90, v91
    v_lshlrev_b32 v90, 16, v125
    v_and_b32 v91, 0xffff0000, v125
    v_mul_f32 v90, v90, v89
    v_mul_f32 v91, v91, v89
    v_cvt_pk_bf16_f32 v125, v90, v91
    v_lshlrev_b32 v90, 16, v126
    v_and_b32 v91, 0xffff0000, v126
    v_sub_f32 v90, v90, v88
    v_sub_f32 v91, v91, v88
    v_cvt_pk_bf16_f32 v126, v90, v91
    v_lshlrev_b32 v90, 16, v126
    v_and_b32 v91, 0xffff0000, v126
    v_mul_f32 v90, v90, v89
    v_mul_f32 v91, v91, v89
    v_cvt_pk_bf16_f32 v126, v90, v91
    v_lshlrev_b32 v90, 16, v127
    v_and_b32 v91, 0xffff0000, v127
    v_sub_f32 v90, v90, v88
    v_sub_f32 v91, v91, v88
    v_cvt_pk_bf16_f32 v127, v90, v91
    v_lshlrev_b32 v90, 16, v127
    v_and_b32 v91, 0xffff0000, v127
    v_mul_f32 v90, v90, v89
    v_mul_f32 v91, v91, v89
    v_cvt_pk_bf16_f32 v127, v90, v91
    ds_write_b128 v4, v[124:127] offset:14336
    s_waitcnt lgkmcnt(0)
    s_barrier
    s_lshl_b32 s24, s23, 15
    s_add_u32 s24, s24, 0x800000
    ds_read_b128 v[24:27], v9 offset:0
    ds_read_b128 v[28:31], v9 offset:4096
    ds_read_b128 v[32:35], v9 offset:8192
    ds_read_b128 v[36:39], v9 offset:12288
    ds_read_b128 v[40:43], v9 offset:16384
    ds_read_b128 v[44:47], v9 offset:20480
    ds_read_b128 v[48:51], v9 offset:24576
    ds_read_b128 v[52:55], v9 offset:28672
    s_waitcnt lgkmcnt(7)
    s_add_u32 s36, s24, 0
    buffer_store_dwordx4 v[24:27], v9, s[8:11], s36 offen sc1
    s_waitcnt lgkmcnt(6)
    s_add_u32 s36, s24, 4096
    buffer_store_dwordx4 v[28:31], v9, s[8:11], s36 offen sc1
    s_waitcnt lgkmcnt(5)
    s_add_u32 s36, s24, 8192
    buffer_store_dwordx4 v[32:35], v9, s[8:11], s36 offen sc1
    s_waitcnt lgkmcnt(4)
    s_add_u32 s36, s24, 12288
    buffer_store_dwordx4 v[36:39], v9, s[8:11], s36 offen sc1
    s_waitcnt lgkmcnt(3)
    s_add_u32 s36, s24, 16384
    buffer_store_dwordx4 v[40:43], v9, s[8:11], s36 offen sc1
    s_waitcnt lgkmcnt(2)
    s_add_u32 s36, s24, 20480
    buffer_store_dwordx4 v[44:47], v9, s[8:11], s36 offen sc1
    s_waitcnt lgkmcnt(1)
    s_add_u32 s36, s24, 24576
    buffer_store_dwordx4 v[48:51], v9, s[8:11], s36 offen sc1
    s_waitcnt lgkmcnt(0)
    s_add_u32 s36, s24, 28672
    buffer_store_dwordx4 v[52:55], v9, s[8:11], s36 offen sc1
    s_barrier
    v_mov_b64 v[96:97], v[128:129]
    v_mov_b64 v[98:99], v[130:131]
    v_mov_b64 v[100:101], v[132:133]
    v_mov_b64 v[102:103], v[134:135]
    v_mov_b64 v[104:105], v[136:137]
    v_mov_b64 v[106:107], v[138:139]
    v_mov_b64 v[108:109], v[140:141]
    v_mov_b64 v[110:111], v[142:143]
    v_mov_b64 v[112:113], v[144:145]
    v_mov_b64 v[114:115], v[146:147]
    v_mov_b64 v[116:117], v[148:149]
    v_mov_b64 v[118:119], v[150:151]
    v_mov_b64 v[120:121], v[152:153]
    v_mov_b64 v[122:123], v[154:155]
    v_mov_b64 v[124:125], v[156:157]
    v_mov_b64 v[126:127], v[158:159]
    s_add_u32 s23, s23, 1
    s_bitcmp1_b32 s23, 0
    s_cbranch_scc1 L_XN
    s_waitcnt vmcnt(0)
    s_barrier
    v_mov_b32 v14, 1
    s_lshl_b32 s37, s20, 2
    v_lshlrev_b32 v15, 20, v0
    buffer_store_dword v14, v15, s[16:19], s37 offen sc1
    s_lshr_b32 s20, s2, 3
    s_mov_b32 s34, 0x05040100
    s_mov_b32 s35, 0x07060302
    s_mov_b32 s32, 0
    s_mov_b32 s64, s84
    s_and_b32 s65, s85, 0xffff
    s_mov_b32 s66, 0x1c0000
    s_mov_b32 s67, 0x20000
    s_mov_b32 s68, s86
    s_and_b32 s69, s87, 0xffff
    s_mov_b32 s70, 0x1c0000
    s_mov_b32 s71, 0x20000
    s_mov_b32 s76, s88
    s_and_b32 s77, s89, 0xffff
    s_mov_b32 s78, 0x1c0000
    s_mov_b32 s79, 0x20000
    v_and_b32 v3, 31, v0
    v_lshlrev_b32 v3, 2, v3
L_M_hs:
    buffer_load_dword v5, v3, s[16:19], 0 offen sc1
    s_add_u32 s32, s32, 1
    s_cmp_gt_u32 s32, 200000
    s_waitcnt vmcnt(0)
    s_cbranch_scc1 L_M_hs_ok
    v_cmp_eq_u32 vcc, 0, v5
    s_cbranch_vccz L_M_hs_ok
    s_sleep 16
    s_branch L_M_hs
L_M_hs_ok:
    v_lshlrev_b32 v3, 4, v0
L_M00_rp:
    s_mov_b32 s36, 0x194000
    buffer_load_dwordx4 v[16:19], v3, s[8:11], s36 offen sc1
    s_add_u32 s32, s32, 1
    v_mov_b32 v5, 0
    s_waitcnt vmcnt(0)
    v_max3_u32 v5, v5, v16, v17
    v_max3_u32 v5, v5, v18, v19
    s_cmp_gt_u32 s32, 200000
    s_cbranch_scc1 L_M00_rp_ok
    v_cmp_eq_u32 vcc, -1, v5
    s_cbranch_vccz L_M00_rp_ok
    s_sleep 64
    s_branch L_M00_rp
L_M00_rp_ok:
    v_add_f32 v16, v16, v17
    v_add_f32 v18, v18, v19
    v_add_f32 v16, v16, v18
    v_cvt_pk_bf16_f32 v5, v16, v16
    v_lshlrev_b32 v16, 16, v5
    v_ashrrev_i32 v5, 31, v16
    v_or_b32 v5, 0x80000000, v5
    v_xor_b32 v5, v5, v16
    v_and_b32 v5, 0xffff0000, v5
    v_sub_u32 v6, 2047, v0
    v_or_b32 v120, v5, v6
    v_lshrrev_b32 v1, 5, v0
    v_and_b32 v2, 31, v0
    s_mov_b32 s36, 229376
    v_mul_lo_u32 v4, v1, s36
    v_lshl_add_u32 v4, v2, 2, v4
    v_mov_b32 v5, 0x40000000
    v_cmp_lt_u32 vcc, 27, v2
    s_nop 1
    v_cndmask_b32 v4, v4, v5, vcc
    s_mul_i32 s23, s20, 112
    s_add_u32 s36, s23, 0
    buffer_load_dword v16, v4, s[64:67], s36 offen
    s_add_u32 s36, s23, 3584
    buffer_load_dword v17, v4, s[64:67], s36 offen
    s_add_u32 s36, s23, 7168
    buffer_load_dword v18, v4, s[64:67], s36 offen
    s_add_u32 s36, s23, 10752
    buffer_load_dword v19, v4, s[64:67], s36 offen
    s_add_u32 s36, s23, 14336
    buffer_load_dword v20, v4, s[64:67], s36 offen
    s_add_u32 s36, s23, 17920
    buffer_load_dword v21, v4, s[64:67], s36 offen
    s_add_u32 s36, s23, 21504
    buffer_load_dword v22, v4, s[64:67], s36 offen
    s_add_u32 s36, s23, 25088
    buffer_load_dword v23, v4, s[64:67], s36 offen
    s_add_u32 s36, s23, 28672
    buffer_load_dword v24, v4, s[64:67], s36 offen
    s_add_u32 s36, s23, 32256
    buffer_load_dword v25, v4, s[64:67], s36 offen
    s_add_u32 s36, s23, 35840
    buffer_load_dword v26, v4, s[64:67], s36 offen
    s_add_u32 s36, s23, 39424
    buffer_load_dword v27, v4, s[64:67], s36 offen
    s_add_u32 s36, s23, 43008
    buffer_load_dword v28, v4, s[64:67], s36 offen
    s_add_u32 s36, s23, 46592
    buffer_load_dword v29, v4, s[64:67], s36 offen
    s_add_u32 s36, s23, 50176
    buffer_load_dword v30, v4, s[64:67], s36 offen
    s_add_u32 s36, s23, 53760
    buffer_load_dword v31, v4, s[64:67], s36 offen
    s_add_u32 s36, s23, 57344
    buffer_load_dword v32, v4, s[64:67], s36 offen
    s_add_u32 s36, s23, 60928
    buffer_load_dword v33, v4, s[64:67], s36 offen
    s_add_u32 s36, s23, 64512
    buffer_load_dword v34, v4, s[64:67], s36 offen
    s_add_u32 s36, s23, 68096
    buffer_load_dword v35, v4, s[64:67], s36 offen
    s_add_u32 s36, s23, 71680
    buffer_load_dword v36, v4, s[64:67], s36 offen
    s_add_u32 s36, s23, 75264
    buffer_load_dword v37, v4, s[64:67], s36 offen
    s_add_u32 s36, s23, 78848
    buffer_load_dword v38, v4, s[64:67], s36 offen
    s_add_u32 s36, s23, 82432
    buffer_load_dword v39, v4, s[64:67], s36 offen
    s_add_u32 s36, s23, 86016
    buffer_load_dword v40, v4, s[64:67], s36 offen
    s_add_u32 s36, s23, 89600
    buffer_load_dword v41, v4, s[64:67], s36 offen
    s_add_u32 s36, s23, 93184
    buffer_load_dword v42, v4, s[64:67], s36 offen
    s_add_u32 s36, s23, 96768
    buffer_load_dword v43, v4, s[64:67], s36 offen
    s_add_u32 s36, s23, 100352
    buffer_load_dword v44, v4, s[64:67], s36 offen
    s_add_u32 s36, s23, 103936
    buffer_load_dword v45, v4, s[64:67], s36 offen
    s_add_u32 s36, s23, 107520
    buffer_load_dword v46, v4, s[64:67], s36 offen
    s_add_u32 s36, s23, 111104
    buffer_load_dword v47, v4, s[64:67], s36 offen
    s_waitcnt vmcnt(0)
    v_perm_b32 v128, v17, v16, s34
    v_perm_b32 v129, v19, v18, s34
    v_perm_b32 v130, v21, v20, s34
    v_perm_b32 v131, v23, v22, s34
    v_perm_b32 v132, v25, v24, s34
    v_perm_b32 v133, v27, v26, s34
    v_perm_b32 v134, v29, v28, s34
    v_perm_b32 v135, v31, v30, s34
    v_perm_b32 v136, v33, v32, s34
    v_perm_b32 v137, v35, v34, s34
    v_perm_b32 v138, v37, v36, s34
    v_perm_b32 v139, v39, v38, s34
    v_perm_b32 v140, v41, v40, s34
    v_perm_b32 v141, v43, v42, s34
    v_perm_b32 v142, v45, v44, s34
    v_perm_b32 v143, v47, v46, s34
    v_perm_b32 v160, v17, v16, s35
    v_perm_b32 v161, v19, v18, s35
    v_perm_b32 v162, v21, v20, s35
    v_perm_b32 v163, v23, v22, s35
    v_perm_b32 v164, v25, v24, s35
    v_perm_b32 v165, v27, v26, s35
    v_perm_b32 v166, v29, v28, s35
    v_perm_b32 v167, v31, v30, s35
    v_perm_b32 v168, v33, v32, s35
    v_perm_b32 v169, v35, v34, s35
    v_perm_b32 v170, v37, v36, s35
    v_perm_b32 v171, v39, v38, s35
    v_perm_b32 v172, v41, v40, s35
    v_perm_b32 v173, v43, v42, s35
    v_perm_b32 v174, v45, v44, s35
    v_perm_b32 v175, v47, v46, s35
    s_add_u32 s36, s23, 114688
    buffer_load_dword v16, v4, s[64:67], s36 offen
    s_add_u32 s36, s23, 118272
    buffer_load_dword v17, v4, s[64:67], s36 offen
    s_add_u32 s36, s23, 121856
    buffer_load_dword v18, v4, s[64:67], s36 offen
    s_add_u32 s36, s23, 125440
    buffer_load_dword v19, v4, s[64:67], s36 offen
    s_add_u32 s36, s23, 129024
    buffer_load_dword v20, v4, s[64:67], s36 offen
    s_add_u32 s36, s23, 132608
    buffer_load_dword v21, v4, s[64:67], s36 offen
    s_add_u32 s36, s23, 136192
    buffer_load_dword v22, v4, s[64:67], s36 offen
    s_add_u32 s36, s23, 139776
    buffer_load_dword v23, v4, s[64:67], s36 offen
    s_add_u32 s36, s23, 143360
    buffer_load_dword v24, v4, s[64:67], s36 offen
    s_add_u32 s36, s23, 146944
    buffer_load_dword v25, v4, s[64:67], s36 offen
    s_add_u32 s36, s23, 150528
    buffer_load_dword v26, v4, s[64:67], s36 offen
    s_add_u32 s36, s23, 154112
    buffer_load_dword v27, v4, s[64:67], s36 offen
    s_add_u32 s36, s23, 157696
    buffer_load_dword v28, v4, s[64:67], s36 offen
    s_add_u32 s36, s23, 161280
    buffer_load_dword v29, v4, s[64:67], s36 offen
    s_add_u32 s36, s23, 164864
    buffer_load_dword v30, v4, s[64:67], s36 offen
    s_add_u32 s36, s23, 168448
    buffer_load_dword v31, v4, s[64:67], s36 offen
    s_add_u32 s36, s23, 172032
    buffer_load_dword v32, v4, s[64:67], s36 offen
    s_add_u32 s36, s23, 175616
    buffer_load_dword v33, v4, s[64:67], s36 offen
    s_add_u32 s36, s23, 179200
    buffer_load_dword v34, v4, s[64:67], s36 offen
    s_add_u32 s36, s23, 182784
    buffer_load_dword v35, v4, s[64:67], s36 offen
    s_add_u32 s36, s23, 186368
    buffer_load_dword v36, v4, s[64:67], s36 offen
    s_add_u32 s36, s23, 189952
    buffer_load_dword v37, v4, s[64:67], s36 offen
    s_add_u32 s36, s23, 193536
    buffer_load_dword v38, v4, s[64:67], s36 offen
    s_add_u32 s36, s23, 197120
    buffer_load_dword v39, v4, s[64:67], s36 offen
    s_add_u32 s36, s23, 200704
    buffer_load_dword v40, v4, s[64:67], s36 offen
    s_add_u32 s36, s23, 204288
    buffer_load_dword v41, v4, s[64:67], s36 offen
    s_add_u32 s36, s23, 207872
    buffer_load_dword v42, v4, s[64:67], s36 offen
    s_add_u32 s36, s23, 211456
    buffer_load_dword v43, v4, s[64:67], s36 offen
    s_add_u32 s36, s23, 215040
    buffer_load_dword v44, v4, s[64:67], s36 offen
    s_add_u32 s36, s23, 218624
    buffer_load_dword v45, v4, s[64:67], s36 offen
    s_add_u32 s36, s23, 222208
    buffer_load_dword v46, v4, s[64:67], s36 offen
    s_add_u32 s36, s23, 225792
    buffer_load_dword v47, v4, s[64:67], s36 offen
    s_waitcnt vmcnt(0)
    v_perm_b32 v144, v17, v16, s34
    v_perm_b32 v145, v19, v18, s34
    v_perm_b32 v146, v21, v20, s34
    v_perm_b32 v147, v23, v22, s34
    v_perm_b32 v148, v25, v24, s34
    v_perm_b32 v149, v27, v26, s34
    v_perm_b32 v150, v29, v28, s34
    v_perm_b32 v151, v31, v30, s34
    v_perm_b32 v152, v33, v32, s34
    v_perm_b32 v153, v35, v34, s34
    v_perm_b32 v154, v37, v36, s34
    v_perm_b32 v155, v39, v38, s34
    v_perm_b32 v156, v41, v40, s34
    v_perm_b32 v157, v43, v42, s34
    v_perm_b32 v158, v45, v44, s34
    v_perm_b32 v159, v47, v46, s34
    v_perm_b32 v176, v17, v16, s35
    v_perm_b32 v177, v19, v18, s35
    v_perm_b32 v178, v21, v20, s35
    v_perm_b32 v179, v23, v22, s35
    v_perm_b32 v180, v25, v24, s35
    v_perm_b32 v181, v27, v26, s35
    v_perm_b32 v182, v29, v28, s35
    v_perm_b32 v183, v31, v30, s35
    v_perm_b32 v184, v33, v32, s35
    v_perm_b32 v185, v35, v34, s35
    v_perm_b32 v186, v37, v36, s35
    v_perm_b32 v187, v39, v38, s35
    v_perm_b32 v188, v41, v40, s35
    v_perm_b32 v189, v43, v42, s35
    v_perm_b32 v190, v45, v44, s35
    v_perm_b32 v191, v47, v46, s35
    s_add_u32 s36, s23, 0
    buffer_load_dword v16, v4, s[68:71], s36 offen
    s_add_u32 s36, s23, 3584
    buffer_load_dword v17, v4, s[68:71], s36 offen
    s_add_u32 s36, s23, 7168
    buffer_load_dword v18, v4, s[68:71], s36 offen
    s_add_u32 s36, s23, 10752
    buffer_load_dword v19, v4, s[68:71], s36 offen
    s_add_u32 s36, s23, 14336
    buffer_load_dword v20, v4, s[68:71], s36 offen
    s_add_u32 s36, s23, 17920
    buffer_load_dword v21, v4, s[68:71], s36 offen
    s_add_u32 s36, s23, 21504
    buffer_load_dword v22, v4, s[68:71], s36 offen
    s_add_u32 s36, s23, 25088
    buffer_load_dword v23, v4, s[68:71], s36 offen
    s_add_u32 s36, s23, 28672
    buffer_load_dword v24, v4, s[68:71], s36 offen
    s_add_u32 s36, s23, 32256
    buffer_load_dword v25, v4, s[68:71], s36 offen
    s_add_u32 s36, s23, 35840
    buffer_load_dword v26, v4, s[68:71], s36 offen
    s_add_u32 s36, s23, 39424
    buffer_load_dword v27, v4, s[68:71], s36 offen
    s_add_u32 s36, s23, 43008
    buffer_load_dword v28, v4, s[68:71], s36 offen
    s_add_u32 s36, s23, 46592
    buffer_load_dword v29, v4, s[68:71], s36 offen
    s_add_u32 s36, s23, 50176
    buffer_load_dword v30, v4, s[68:71], s36 offen
    s_add_u32 s36, s23, 53760
    buffer_load_dword v31, v4, s[68:71], s36 offen
    s_add_u32 s36, s23, 57344
    buffer_load_dword v32, v4, s[68:71], s36 offen
    s_add_u32 s36, s23, 60928
    buffer_load_dword v33, v4, s[68:71], s36 offen
    s_add_u32 s36, s23, 64512
    buffer_load_dword v34, v4, s[68:71], s36 offen
    s_add_u32 s36, s23, 68096
    buffer_load_dword v35, v4, s[68:71], s36 offen
    s_add_u32 s36, s23, 71680
    buffer_load_dword v36, v4, s[68:71], s36 offen
    s_add_u32 s36, s23, 75264
    buffer_load_dword v37, v4, s[68:71], s36 offen
    s_add_u32 s36, s23, 78848
    buffer_load_dword v38, v4, s[68:71], s36 offen
    s_add_u32 s36, s23, 82432
    buffer_load_dword v39, v4, s[68:71], s36 offen
    s_add_u32 s36, s23, 86016
    buffer_load_dword v40, v4, s[68:71], s36 offen
    s_add_u32 s36, s23, 89600
    buffer_load_dword v41, v4, s[68:71], s36 offen
    s_add_u32 s36, s23, 93184
    buffer_load_dword v42, v4, s[68:71], s36 offen
    s_add_u32 s36, s23, 96768
    buffer_load_dword v43, v4, s[68:71], s36 offen
    s_add_u32 s36, s23, 100352
    buffer_load_dword v44, v4, s[68:71], s36 offen
    s_add_u32 s36, s23, 103936
    buffer_load_dword v45, v4, s[68:71], s36 offen
    s_add_u32 s36, s23, 107520
    buffer_load_dword v46, v4, s[68:71], s36 offen
    s_add_u32 s36, s23, 111104
    buffer_load_dword v47, v4, s[68:71], s36 offen
    s_waitcnt vmcnt(0)
    v_perm_b32 v192, v17, v16, s34
    v_perm_b32 v193, v19, v18, s34
    v_perm_b32 v194, v21, v20, s34
    v_perm_b32 v195, v23, v22, s34
    v_perm_b32 v196, v25, v24, s34
    v_perm_b32 v197, v27, v26, s34
    v_perm_b32 v198, v29, v28, s34
    v_perm_b32 v199, v31, v30, s34
    v_perm_b32 v200, v33, v32, s34
    v_perm_b32 v201, v35, v34, s34
    v_perm_b32 v202, v37, v36, s34
    v_perm_b32 v203, v39, v38, s34
    v_perm_b32 v204, v41, v40, s34
    v_perm_b32 v205, v43, v42, s34
    v_perm_b32 v206, v45, v44, s34
    v_perm_b32 v207, v47, v46, s34
    v_perm_b32 v224, v17, v16, s35
    v_perm_b32 v225, v19, v18, s35
    v_perm_b32 v226, v21, v20, s35
    v_perm_b32 v227, v23, v22, s35
    v_perm_b32 v228, v25, v24, s35
    v_perm_b32 v229, v27, v26, s35
    v_perm_b32 v230, v29, v28, s35
    v_perm_b32 v231, v31, v30, s35
    v_perm_b32 v232, v33, v32, s35
    v_perm_b32 v233, v35, v34, s35
    v_perm_b32 v234, v37, v36, s35
    v_perm_b32 v235, v39, v38, s35
    v_perm_b32 v236, v41, v40, s35
    v_perm_b32 v237, v43, v42, s35
    v_perm_b32 v238, v45, v44, s35
    v_perm_b32 v239, v47, v46, s35
    s_add_u32 s36, s23, 114688
    buffer_load_dword v16, v4, s[68:71], s36 offen
    s_add_u32 s36, s23, 118272
    buffer_load_dword v17, v4, s[68:71], s36 offen
    s_add_u32 s36, s23, 121856
    buffer_load_dword v18, v4, s[68:71], s36 offen
    s_add_u32 s36, s23, 125440
    buffer_load_dword v19, v4, s[68:71], s36 offen
    s_add_u32 s36, s23, 129024
    buffer_load_dword v20, v4, s[68:71], s36 offen
    s_add_u32 s36, s23, 132608
    buffer_load_dword v21, v4, s[68:71], s36 offen
    s_add_u32 s36, s23, 136192
    buffer_load_dword v22, v4, s[68:71], s36 offen
    s_add_u32 s36, s23, 139776
    buffer_load_dword v23, v4, s[68:71], s36 offen
    s_add_u32 s36, s23, 143360
    buffer_load_dword v24, v4, s[68:71], s36 offen
    s_add_u32 s36, s23, 146944
    buffer_load_dword v25, v4, s[68:71], s36 offen
    s_add_u32 s36, s23, 150528
    buffer_load_dword v26, v4, s[68:71], s36 offen
    s_add_u32 s36, s23, 154112
    buffer_load_dword v27, v4, s[68:71], s36 offen
    s_add_u32 s36, s23, 157696
    buffer_load_dword v28, v4, s[68:71], s36 offen
    s_add_u32 s36, s23, 161280
    buffer_load_dword v29, v4, s[68:71], s36 offen
    s_add_u32 s36, s23, 164864
    buffer_load_dword v30, v4, s[68:71], s36 offen
    s_add_u32 s36, s23, 168448
    buffer_load_dword v31, v4, s[68:71], s36 offen
    s_add_u32 s36, s23, 172032
    buffer_load_dword v32, v4, s[68:71], s36 offen
    s_add_u32 s36, s23, 175616
    buffer_load_dword v33, v4, s[68:71], s36 offen
    s_add_u32 s36, s23, 179200
    buffer_load_dword v34, v4, s[68:71], s36 offen
    s_add_u32 s36, s23, 182784
    buffer_load_dword v35, v4, s[68:71], s36 offen
    s_add_u32 s36, s23, 186368
    buffer_load_dword v36, v4, s[68:71], s36 offen
    s_add_u32 s36, s23, 189952
    buffer_load_dword v37, v4, s[68:71], s36 offen
    s_add_u32 s36, s23, 193536
    buffer_load_dword v38, v4, s[68:71], s36 offen
    s_add_u32 s36, s23, 197120
    buffer_load_dword v39, v4, s[68:71], s36 offen
    s_add_u32 s36, s23, 200704
    buffer_load_dword v40, v4, s[68:71], s36 offen
    s_add_u32 s36, s23, 204288
    buffer_load_dword v41, v4, s[68:71], s36 offen
    s_add_u32 s36, s23, 207872
    buffer_load_dword v42, v4, s[68:71], s36 offen
    s_add_u32 s36, s23, 211456
    buffer_load_dword v43, v4, s[68:71], s36 offen
    s_add_u32 s36, s23, 215040
    buffer_load_dword v44, v4, s[68:71], s36 offen
    s_add_u32 s36, s23, 218624
    buffer_load_dword v45, v4, s[68:71], s36 offen
    s_add_u32 s36, s23, 222208
    buffer_load_dword v46, v4, s[68:71], s36 offen
    s_add_u32 s36, s23, 225792
    buffer_load_dword v47, v4, s[68:71], s36 offen
    s_waitcnt vmcnt(0)
    v_perm_b32 v208, v17, v16, s34
    v_perm_b32 v209, v19, v18, s34
    v_perm_b32 v210, v21, v20, s34
    v_perm_b32 v211, v23, v22, s34
    v_perm_b32 v212, v25, v24, s34
    v_perm_b32 v213, v27, v26, s34
    v_perm_b32 v214, v29, v28, s34
    v_perm_b32 v215, v31, v30, s34
    v_perm_b32 v216, v33, v32, s34
    v_perm_b32 v217, v35, v34, s34
    v_perm_b32 v218, v37, v36, s34
    v_perm_b32 v219, v39, v38, s34
    v_perm_b32 v220, v41, v40, s34
    v_perm_b32 v221, v43, v42, s34
    v_perm_b32 v222, v45, v44, s34
    v_perm_b32 v223, v47, v46, s34
    v_perm_b32 v240, v17, v16, s35
    v_perm_b32 v241, v19, v18, s35
    v_perm_b32 v242, v21, v20, s35
    v_perm_b32 v243, v23, v22, s35
    v_perm_b32 v244, v25, v24, s35
    v_perm_b32 v245, v27, v26, s35
    v_perm_b32 v246, v29, v28, s35
    v_perm_b32 v247, v31, v30, s35
    v_perm_b32 v248, v33, v32, s35
    v_perm_b32 v249, v35, v34, s35
    v_perm_b32 v250, v37, v36, s35
    v_perm_b32 v251, v39, v38, s35
    v_perm_b32 v252, v41, v40, s35
    v_perm_b32 v253, v43, v42, s35
    v_perm_b32 v254, v45, v44, s35
    v_perm_b32 v255, v47, v46, s35
    v_lshrrev_b32 v3, 3, v0
    v_mul_u32_u24 v4, 57344, v3
    v_and_b32 v3, 7, v0
    v_lshl_add_u32 v4, v3, 2, v4
    s_lshl_b32 s37, s20, 5
    s_add_u32 s36, s37, 0
    buffer_load_dword v16, v4, s[76:79], s36 offen
    s_add_u32 s36, s37, 1024
    buffer_load_dword v17, v4, s[76:79], s36 offen
    s_add_u32 s36, s37, 2048
    buffer_load_dword v18, v4, s[76:79], s36 offen
    s_add_u32 s36, s37, 3072
    buffer_load_dword v19, v4, s[76:79], s36 offen
    s_add_u32 s36, s37, 4096
    buffer_load_dword v20, v4, s[76:79], s36 offen
    s_add_u32 s36, s37, 5120
    buffer_load_dword v21, v4, s[76:79], s36 offen
    s_add_u32 s36, s37, 6144
    buffer_load_dword v22, v4, s[76:79], s36 offen
    s_add_u32 s36, s37, 7168
    buffer_load_dword v23, v4, s[76:79], s36 offen
    s_add_u32 s36, s37, 8192
    buffer_load_dword v24, v4, s[76:79], s36 offen
    s_add_u32 s36, s37, 9216
    buffer_load_dword v25, v4, s[76:79], s36 offen
    s_add_u32 s36, s37, 10240
    buffer_load_dword v26, v4, s[76:79], s36 offen
    s_add_u32 s36, s37, 11264
    buffer_load_dword v27, v4, s[76:79], s36 offen
    s_add_u32 s36, s37, 12288
    buffer_load_dword v28, v4, s[76:79], s36 offen
    s_add_u32 s36, s37, 13312
    buffer_load_dword v29, v4, s[76:79], s36 offen
    s_add_u32 s36, s37, 14336
    buffer_load_dword v30, v4, s[76:79], s36 offen
    s_add_u32 s36, s37, 15360
    buffer_load_dword v31, v4, s[76:79], s36 offen
    s_add_u32 s36, s37, 16384
    buffer_load_dword v32, v4, s[76:79], s36 offen
    s_add_u32 s36, s37, 17408
    buffer_load_dword v33, v4, s[76:79], s36 offen
    s_add_u32 s36, s37, 18432
    buffer_load_dword v34, v4, s[76:79], s36 offen
    s_add_u32 s36, s37, 19456
    buffer_load_dword v35, v4, s[76:79], s36 offen
    s_add_u32 s36, s37, 20480
    buffer_load_dword v36, v4, s[76:79], s36 offen
    s_add_u32 s36, s37, 21504
    buffer_load_dword v37, v4, s[76:79], s36 offen
    s_add_u32 s36, s37, 22528
    buffer_load_dword v38, v4, s[76:79], s36 offen
    s_add_u32 s36, s37, 23552
    buffer_load_dword v39, v4, s[76:79], s36 offen
    s_add_u32 s36, s37, 24576
    buffer_load_dword v40, v4, s[76:79], s36 offen
    s_add_u32 s36, s37, 25600
    buffer_load_dword v41, v4, s[76:79], s36 offen
    s_add_u32 s36, s37, 26624
    buffer_load_dword v42, v4, s[76:79], s36 offen
    s_add_u32 s36, s37, 27648
    buffer_load_dword v43, v4, s[76:79], s36 offen
    s_waitcnt vmcnt(0)
    v_perm_b32 v64, v17, v16, s34
    v_perm_b32 v65, v19, v18, s34
    v_perm_b32 v66, v21, v20, s34
    v_perm_b32 v67, v23, v22, s34
    v_perm_b32 v68, v25, v24, s34
    v_perm_b32 v69, v27, v26, s34
    v_perm_b32 v70, v29, v28, s34
    v_perm_b32 v71, v31, v30, s34
    v_perm_b32 v72, v33, v32, s34
    v_perm_b32 v73, v35, v34, s34
    v_perm_b32 v74, v37, v36, s34
    v_perm_b32 v75, v39, v38, s34
    v_perm_b32 v76, v41, v40, s34
    v_perm_b32 v77, v43, v42, s34
    v_perm_b32 v92, v17, v16, s35
    v_perm_b32 v93, v19, v18, s35
    v_perm_b32 v94, v21, v20, s35
    v_perm_b32 v95, v23, v22, s35
    v_perm_b32 v96, v25, v24, s35
    v_perm_b32 v97, v27, v26, s35
    v_perm_b32 v98, v29, v28, s35
    v_perm_b32 v99, v31, v30, s35
    v_perm_b32 v100, v33, v32, s35
    v_perm_b32 v101, v35, v34, s35
    v_perm_b32 v102, v37, v36, s35
    v_perm_b32 v103, v39, v38, s35
    v_perm_b32 v104, v41, v40, s35
    v_perm_b32 v105, v43, v42, s35
    s_add_u32 s36, s37, 28672
    buffer_load_dword v16, v4, s[76:79], s36 offen
    s_add_u32 s36, s37, 29696
    buffer_load_dword v17, v4, s[76:79], s36 offen
    s_add_u32 s36, s37, 30720
    buffer_load_dword v18, v4, s[76:79], s36 offen
    s_add_u32 s36, s37, 31744
    buffer_load_dword v19, v4, s[76:79], s36 offen
    s_add_u32 s36, s37, 32768
    buffer_load_dword v20, v4, s[76:79], s36 offen
    s_add_u32 s36, s37, 33792
    buffer_load_dword v21, v4, s[76:79], s36 offen
    s_add_u32 s36, s37, 34816
    buffer_load_dword v22, v4, s[76:79], s36 offen
    s_add_u32 s36, s37, 35840
    buffer_load_dword v23, v4, s[76:79], s36 offen
    s_add_u32 s36, s37, 36864
    buffer_load_dword v24, v4, s[76:79], s36 offen
    s_add_u32 s36, s37, 37888
    buffer_load_dword v25, v4, s[76:79], s36 offen
    s_add_u32 s36, s37, 38912
    buffer_load_dword v26, v4, s[76:79], s36 offen
    s_add_u32 s36, s37, 39936
    buffer_load_dword v27, v4, s[76:79], s36 offen
    s_add_u32 s36, s37, 40960
    buffer_load_dword v28, v4, s[76:79], s36 offen
    s_add_u32 s36, s37, 41984
    buffer_load_dword v29, v4, s[76:79], s36 offen
    s_add_u32 s36, s37, 43008
    buffer_load_dword v30, v4, s[76:79], s36 offen
    s_add_u32 s36, s37, 44032
    buffer_load_dword v31, v4, s[76:79], s36 offen
    s_add_u32 s36, s37, 45056
    buffer_load_dword v32, v4, s[76:79], s36 offen
    s_add_u32 s36, s37, 46080
    buffer_load_dword v33, v4, s[76:79], s36 offen
    s_add_u32 s36, s37, 47104
    buffer_load_dword v34, v4, s[76:79], s36 offen
    s_add_u32 s36, s37, 48128
    buffer_load_dword v35, v4, s[76:79], s36 offen
    s_add_u32 s36, s37, 49152
    buffer_load_dword v36, v4, s[76:79], s36 offen
    s_add_u32 s36, s37, 50176
    buffer_load_dword v37, v4, s[76:79], s36 offen
    s_add_u32 s36, s37, 51200
    buffer_load_dword v38, v4, s[76:79], s36 offen
    s_add_u32 s36, s37, 52224
    buffer_load_dword v39, v4, s[76:79], s36 offen
    s_add_u32 s36, s37, 53248
    buffer_load_dword v40, v4, s[76:79], s36 offen
    s_add_u32 s36, s37, 54272
    buffer_load_dword v41, v4, s[76:79], s36 offen
    s_add_u32 s36, s37, 55296
    buffer_load_dword v42, v4, s[76:79], s36 offen
    s_add_u32 s36, s37, 56320
    buffer_load_dword v43, v4, s[76:79], s36 offen
    s_waitcnt vmcnt(0)
    v_perm_b32 v78, v17, v16, s34
    v_perm_b32 v79, v19, v18, s34
    v_perm_b32 v80, v21, v20, s34
    v_perm_b32 v81, v23, v22, s34
    v_perm_b32 v82, v25, v24, s34
    v_perm_b32 v83, v27, v26, s34
    v_perm_b32 v84, v29, v28, s34
    v_perm_b32 v85, v31, v30, s34
    v_perm_b32 v86, v33, v32, s34
    v_perm_b32 v87, v35, v34, s34
    v_perm_b32 v88, v37, v36, s34
    v_perm_b32 v89, v39, v38, s34
    v_perm_b32 v90, v41, v40, s34
    v_perm_b32 v91, v43, v42, s34
    v_perm_b32 v106, v17, v16, s35
    v_perm_b32 v107, v19, v18, s35
    v_perm_b32 v108, v21, v20, s35
    v_perm_b32 v109, v23, v22, s35
    v_perm_b32 v110, v25, v24, s35
    v_perm_b32 v111, v27, v26, s35
    v_perm_b32 v112, v29, v28, s35
    v_perm_b32 v113, v31, v30, s35
    v_perm_b32 v114, v33, v32, s35
    v_perm_b32 v115, v35, v34, s35
    v_perm_b32 v116, v37, v36, s35
    v_perm_b32 v117, v39, v38, s35
    v_perm_b32 v118, v41, v40, s35
    v_perm_b32 v119, v43, v42, s35
    s_mov_b32 s42, 0xffff0000
    s_mov_b32 s24, 0
    s_mov_b64 s[28:29], 0
    v_mov_b32 v12, 0x40000000
    v_mov_b32 v13, 0
    v_lshlrev_b32 v3, 4, v0
L_M06_rp:
    s_mov_b32 s36, 0x19a000
    buffer_load_dwordx4 v[40:43], v3, s[8:11], s36 offen sc1
    s_add_u32 s32, s32, 1
    v_mov_b32 v5, 0
    s_waitcnt vmcnt(0)
    v_max3_u32 v5, v5, v40, v41
    v_max3_u32 v5, v5, v42, v43
    s_cmp_gt_u32 s32, 200000
    s_cbranch_scc1 L_M06_rp_ok
    v_cmp_eq_u32 vcc, -1, v5
    s_cbranch_vccz L_M06_rp_ok
    s_sleep 32
    s_branch L_M06_rp
L_M06_rp_ok:
    v_add_f32 v40, v40, v41
    v_add_f32 v42, v42, v43
    v_add_f32 v40, v40, v42
    v_cvt_pk_bf16_f32 v5, v40, v40
    v_lshlrev_b32 v40, 16, v5
    v_ashrrev_i32 v5, 31, v40
    v_or_b32 v5, 0x80000000, v5
    v_xor_b32 v5, v5, v40
    v_and_b32 v5, 0xffff0000, v5
    v_sub_u32 v6, 511, v0
    v_or_b32 v126, v5, v6
    v_lshlrev_b32 v3, 4, v0
L_M01_rp:
    s_mov_b32 s36, 0x195000
    buffer_load_dwordx4 v[20:23], v3, s[8:11], s36 offen sc1
    s_mov_b32 s36, 0x196000
    buffer_load_dwordx4 v[24:27], v3, s[8:11], s36 offen sc1
    s_mov_b32 s36, 0x197000
    buffer_load_dwordx4 v[28:31], v3, s[8:11], s36 offen sc1
    s_mov_b32 s36, 0x198000
    buffer_load_dwordx4 v[32:35], v3, s[8:11], s36 offen sc1
    s_mov_b32 s36, 0x199000
    buffer_load_dwordx4 v[36:39], v3, s[8:11], s36 offen sc1
    s_add_u32 s32, s32, 1
    v_mov_b32 v5, 0
    s_waitcnt vmcnt(0)
    v_max3_u32 v5, v5, v20, v21
    v_max3_u32 v5, v5, v22, v23
    v_max3_u32 v5, v5, v24, v25
    v_max3_u32 v5, v5, v26, v27
    v_max3_u32 v5, v5, v28, v29
    v_max3_u32 v5, v5, v30, v31
    v_max3_u32 v5, v5, v32, v33
    v_max3_u32 v5, v5, v34, v35
    v_max3_u32 v5, v5, v36, v37
    v_max3_u32 v5, v5, v38, v39
    s_cmp_gt_u32 s32, 200000
    s_cbranch_scc1 L_M01_rp_ok
    v_cmp_eq_u32 vcc, -1, v5
    s_cbranch_vccz L_M01_rp_ok
    s_sleep 8
    s_branch L_M01_rp
L_M01_rp_ok:
    v_add_f32 v20, v20, v21
    v_add_f32 v22, v22, v23
    v_add_f32 v20, v20, v22
    v_cvt_pk_bf16_f32 v5, v20, v20
    v_lshlrev_b32 v20, 16, v5
    v_ashrrev_i32 v5, 31, v20
    v_or_b32 v5, 0x80000000, v5
    v_xor_b32 v5, v5, v20
    v_and_b32 v5, 0xffff0000, v5
    v_sub_u32 v6, 1791, v0
    v_or_b32 v121, v5, v6
    v_add_f32 v24, v24, v25
    v_add_f32 v26, v26, v27
    v_add_f32 v24, v24, v26
    v_cvt_pk_bf16_f32 v5, v24, v24
    v_lshlrev_b32 v24, 16, v5
    v_ashrrev_i32 v5, 31, v24
    v_or_b32 v5, 0x80000000, v5
    v_xor_b32 v5, v5, v24
    v_and_b32 v5, 0xffff0000, v5
    v_sub_u32 v6, 1535, v0
    v_or_b32 v122, v5, v6
    v_add_f32 v28, v28, v29
    v_add_f32 v30, v30, v31
    v_add_f32 v28, v28, v30
    v_cvt_pk_bf16_f32 v5, v28, v28
    v_lshlrev_b32 v28, 16, v5
    v_ashrrev_i32 v5, 31, v28
    v_or_b32 v5, 0x80000000, v5
    v_xor_b32 v5, v5, v28
    v_and_b32 v5, 0xffff0000, v5
    v_sub_u32 v6, 1279, v0
    v_or_b32 v123, v5, v6
    v_add_f32 v32, v32, v33
    v_add_f32 v34, v34, v35
    v_add_f32 v32, v32, v34
    v_cvt_pk_bf16_f32 v5, v32, v32
    v_lshlrev_b32 v32, 16, v5
    v_ashrrev_i32 v5, 31, v32
    v_or_b32 v5, 0x80000000, v5
    v_xor_b32 v5, v5, v32
    v_and_b32 v5, 0xffff0000, v5
    v_sub_u32 v6, 1023, v0
    v_or_b32 v124, v5, v6
    v_add_f32 v36, v36, v37
    v_add_f32 v38, v38, v39
    v_add_f32 v36, v36, v38
    v_cvt_pk_bf16_f32 v5, v36, v36
    v_lshlrev_b32 v36, 16, v5
    v_ashrrev_i32 v5, 31, v36
    v_or_b32 v5, 0x80000000, v5
    v_xor_b32 v5, v5, v36
    v_and_b32 v5, 0xffff0000, v5
    v_sub_u32 v6, 767, v0
    v_or_b32 v125, v5, v6
    v_max_u32 v5, v120, v121
    v_min_u32 v6, v120, v121
    v_med3_u32 v6, v5, v6, v122
    v_max_u32 v5, v5, v122
    v_med3_u32 v6, v5, v6, v123
    v_max_u32 v5, v5, v123
    v_med3_u32 v6, v5, v6, v124
    v_max_u32 v5, v5, v124
    v_med3_u32 v6, v5, v6, v125
    v_max_u32 v5, v5, v125
    v_med3_u32 v6, v5, v6, v126
    v_max_u32 v5, v5, v126
    v_mov_b32 v120, v5
    v_mov_b32 v121, v6
    s_mov_b32 s25, 32
L_M_round:
    v_lshlrev_b32 v3, 4, v0
    v_cmp_gt_u32 s[74:75], s25, v0
L_M7_rp:
    s_mov_b32 s36, 0x19b000
    buffer_load_dwordx4 v[44:47], v3, s[8:11], s36 offen sc1
    s_add_u32 s32, s32, 1
    v_mov_b32 v5, 0
    s_waitcnt vmcnt(0)
    v_max3_u32 v5, v5, v44, v45
    v_max3_u32 v5, v5, v46, v47
    v_cndmask_b32 v5, 0, v5, s[74:75]
    s_cmp_gt_u32 s32, 200000
    s_cbranch_scc1 L_M7_rp_ok
    v_cmp_eq_u32 vcc, -1, v5
    s_cbranch_vccnz L_M7_rp
L_M7_rp_ok:
    v_add_f32 v44, v44, v45
    v_add_f32 v46, v46, v47
    v_add_f32 v44, v44, v46
    v_cvt_pk_bf16_f32 v5, v44, v44
    v_lshlrev_b32 v44, 16, v5
    v_ashrrev_i32 v5, 31, v44
    v_or_b32 v5, 0x80000000, v5
    v_xor_b32 v5, v5, v44
    v_and_b32 v5, 0xffff0000, v5
    v_sub_u32 v6, 255, v0
    v_or_b32 v127, v5, v6
    v_cndmask_b32 v127, 0, v127, s[74:75]
    v_max_u32 v5, v120, v127
    v_med3_u32 v6, v120, v121, v127
    s_nop 0
    v_mov_b32_dpp v7, v5 quad_perm:[1,0,3,2] row_mask:0xf bank_mask:0xf
    v_mov_b32_dpp v8, v6 quad_perm:[1,0,3,2] row_mask:0xf bank_mask:0xf
    v_min_u32 v9, v5, v7
    v_max_u32 v5, v5, v7
    v_max3_u32 v6, v6, v8, v9
    s_nop 0
    v_mov_b32_dpp v7, v5 quad_perm:[2,3,0,1] row_mask:0xf bank_mask:0xf
    v_mov_b32_dpp v8, v6 quad_perm:[2,3,0,1] row_mask:0xf bank_mask:0xf
    v_min_u32 v9, v5, v7
    v_max_u32 v5, v5, v7
    v_max3_u32 v6, v6, v8, v9
    s_nop 0
    v_mov_b32_dpp v7, v5 row_half_mirror row_mask:0xf bank_mask:0xf
    v_mov_b32_dpp v8, v6 row_half_mirror row_mask:0xf bank_mask:0xf
    v_min_u32 v9, v5, v7
    v_max_u32 v5, v5, v7
    v_max3_u32 v6, v6, v8, v9
    s_nop 0
    v_mov_b32_dpp v7, v5 row_mirror row_mask:0xf bank_mask:0xf
    v_mov_b32_dpp v8, v6 row_mirror row_mask:0xf bank_mask:0xf
    v_min_u32 v9, v5, v7
    v_max_u32 v5, v5, v7
    v_max3_u32 v6, v6, v8, v9
    v_lshrrev_b32 v9, 4, v0
    v_lshlrev_b32 v9, 3, v9
    s_barrier
    ds_write2_b32 v9, v5, v6 offset0:0 offset1:1
    v_and_b32 v9, 15, v0
    v_lshlrev_b32 v9, 3, v9
    s_waitcnt lgkmcnt(0)
    s_barrier
    ds_read2_b32 v[10:11], v9 offset0:0 offset1:1
    s_waitcnt lgkmcnt(0)
    v_mov_b32 v5, v10
    v_mov_b32 v6, v11
    s_nop 0
    v_mov_b32_dpp v7, v5 quad_perm:[1,0,3,2] row_mask:0xf bank_mask:0xf
    v_mov_b32_dpp v8, v6 quad_perm:[1,0,3,2] row_mask:0xf bank_mask:0xf
    v_min_u32 v9, v5, v7
    v_max_u32 v5, v5, v7
    v_max3_u32 v6, v6, v8, v9
    s_nop 0
    v_mov_b32_dpp v7, v5 quad_perm:[2,3,0,1] row_mask:0xf bank_mask:0xf
    v_mov_b32_dpp v8, v6 quad_perm:[2,3,0,1] row_mask:0xf bank_mask:0xf
    v_min_u32 v9, v5, v7
    v_max_u32 v5, v5, v7
    v_max3_u32 v6, v6, v8, v9
    s_nop 0
    v_mov_b32_dpp v7, v5 row_half_mirror row_mask:0xf bank_mask:0xf
    v_mov_b32_dpp v8, v6 row_half_mirror row_mask:0xf bank_mask:0xf
    v_min_u32 v9, v5, v7
    v_max_u32 v5, v5, v7
    v_max3_u32 v6, v6, v8, v9
    s_nop 0
    v_mov_b32_dpp v7, v5 row_mirror row_mask:0xf bank_mask:0xf
    v_mov_b32_dpp v8, v6 row_mirror row_mask:0xf bank_mask:0xf
    v_min_u32 v9, v5, v7
    v_max_u32 v5, v5, v7
    v_max3_u32 v6, v6, v8, v9
    v_readfirstlane_b32 s26, v5
    v_readfirstlane_b32 s27, v6
    s_nop 3
    s_cmp_eq_u64 s[26:27], s[28:29]
    s_cbranch_scc1 L_M_next
    s_mov_b64 s[28:29], s[26:27]
    buffer_store_dword v13, v12, s[60:63], 0 offen sc1
    s_and_b32 s36, s26, 0x7ff
    s_sub_u32 s30, 2047, s36
    s_and_b32 s36, s26, 0xffff0000
    s_xor_b32 s37, s36, 0x80000000
    s_xor_b32 s40, s36, 0xffff0000
    s_bitcmp1_b32 s36, 31
    s_cselect_b32 s40, s37, s40
    s_and_b32 s36, s27, 0x7ff
    s_sub_u32 s31, 2047, s36
    s_and_b32 s36, s27, 0xffff0000
    s_xor_b32 s37, s36, 0x80000000
    s_xor_b32 s41, s36, 0xffff0000
    s_bitcmp1_b32 s36, 31
    s_cselect_b32 s41, s37, s41
    v_mov_b32 v8, 0
L_M_rows:
    s_lshl_b32 s36, s30, 4
    s_add_u32 s36, s36, 0x1b8000
    buffer_load_dwordx4 v[16:19], v8, s[8:11], s36 offen sc1
    s_lshl_b32 s36, s31, 4
    s_add_u32 s36, s36, 0x1b8000
    buffer_load_dwordx4 v[20:23], v8, s[8:11], s36 offen sc1
    s_add_u32 s32, s32, 1
    s_cmp_gt_u32 s32, 200000
    s_waitcnt vmcnt(0)
    v_or3_b32 v5, v16, v17, v18
    v_or3_b32 v5, v5, v19, v20
    v_or3_b32 v5, v5, v21, v22
    v_or_b32 v5, v5, v23
    s_cbranch_scc1 L_M_rows_ok
    v_cmp_ne_u32 vcc, 0, v5
    s_cbranch_vccnz L_M_rows
L_M_rows_ok:
    v_bfe_u32 v9, v0, 6, 1
    v_cmp_ne_u32 vcc, 0, v9
    v_mov_b32 v5, s30
    v_mov_b32 v6, s31
    v_cndmask_b32 v7, v5, v6, vcc
    v_lshlrev_b32 v7, 10, v7
    v_and_b32 v8, 63, v0
    v_lshl_add_u32 v7, v8, 4, v7
    s_mov_b32 s37, 0x600000
    buffer_load_dwordx4 v[16:19], v7, s[8:11], s37 offen sc1
    v_bfe_u32 v9, v0, 3, 1
    v_cmp_ne_u32 vcc, 0, v9
    s_nop 1
    v_cndmask_b32 v12, v5, v6, vcc
    v_mov_b32 v5, s40
    v_mov_b32 v6, s41
    v_cndmask_b32 v11, v5, v6, vcc
    v_lshlrev_b32 v12, 10, v12
    v_and_b32 v3, 7, v0
    v_lshl_add_u32 v12, v3, 2, v12
    s_lshl_b32 s36, s20, 5
    v_add_u32 v12, s36, v12
    v_mov_b32 v7, 0x40000000
    v_cmp_lt_u32 vcc, 15, v0
    s_nop 1
    v_cndmask_b32 v12, v12, v7, vcc
    s_mov_b32 s36, 0x400000
    buffer_load_dword v14, v12, s[8:11], s36 offen sc1
    buffer_load_dword v15, v12, s[8:11], s37 offen sc1
    v_and_b32 v8, 127, v0
    v_lshlrev_b32 v8, 4, v8
    s_waitcnt vmcnt(2)
    ds_write_b128 v8, v[16:19] offset:4096
    s_waitcnt lgkmcnt(0)
    s_barrier
    v_mov_b64 v[48:49], 0
    v_mov_b64 v[50:51], 0
    v_mov_b64 v[52:53], 0
    v_mov_b64 v[54:55], 0
    v_lshlrev_b32 v8, 7, v1
    ds_read_b128 v[16:19], v8 offset:4096
    ds_read_b128 v[20:23], v8 offset:4112
    ds_read_b128 v[24:27], v8 offset:4128
    ds_read_b128 v[28:31], v8 offset:4144
    ds_read_b128 v[32:35], v8 offset:5120
    ds_read_b128 v[36:39], v8 offset:5136
    ds_read_b128 v[40:43], v8 offset:5152
    ds_read_b128 v[44:47], v8 offset:5168
    s_waitcnt lgkmcnt(0)
    v_dot2_f32_bf16 v48, v16, v128, v48
    v_dot2_f32_bf16 v49, v16, v160, v49
    v_dot2_f32_bf16 v50, v32, v128, v50
    v_dot2_f32_bf16 v51, v32, v160, v51
    v_dot2_f32_bf16 v52, v16, v192, v52
    v_dot2_f32_bf16 v53, v16, v224, v53
    v_dot2_f32_bf16 v54, v32, v192, v54
    v_dot2_f32_bf16 v55, v32, v224, v55
    v_dot2_f32_bf16 v48, v17, v129, v48
    v_dot2_f32_bf16 v49, v17, v161, v49
    v_dot2_f32_bf16 v50, v33, v129, v50
    v_dot2_f32_bf16 v51, v33, v161, v51
    v_dot2_f32_bf16 v52, v17, v193, v52
    v_dot2_f32_bf16 v53, v17, v225, v53
    v_dot2_f32_bf16 v54, v33, v193, v54
    v_dot2_f32_bf16 v55, v33, v225, v55
    v_dot2_f32_bf16 v48, v18, v130, v48
    v_dot2_f32_bf16 v49, v18, v162, v49
    v_dot2_f32_bf16 v50, v34, v130, v50
    v_dot2_f32_bf16 v51, v34, v162, v51
    v_dot2_f32_bf16 v52, v18, v194, v52
    v_dot2_f32_bf16 v53, v18, v226, v53
    v_dot2_f32_bf16 v54, v34, v194, v54
    v_dot2_f32_bf16 v55, v34, v226, v55
    v_dot2_f32_bf16 v48, v19, v131, v48
    v_dot2_f32_bf16 v49, v19, v163, v49
    v_dot2_f32_bf16 v50, v35, v131, v50
    v_dot2_f32_bf16 v51, v35, v163, v51
    v_dot2_f32_bf16 v52, v19, v195, v52
    v_dot2_f32_bf16 v53, v19, v227, v53
    v_dot2_f32_bf16 v54, v35, v195, v54
    v_dot2_f32_bf16 v55, v35, v227, v55
    v_dot2_f32_bf16 v48, v20, v132, v48
    v_dot2_f32_bf16 v49, v20, v164, v49
    v_dot2_f32_bf16 v50, v36, v132, v50
    v_dot2_f32_bf16 v51, v36, v164, v51
    v_dot2_f32_bf16 v52, v20, v196, v52
    v_dot2_f32_bf16 v53, v20, v228, v53
    v_dot2_f32_bf16 v54, v36, v196, v54
    v_dot2_f32_bf16 v55, v36, v228, v55
    v_dot2_f32_bf16 v48, v21, v133, v48
    v_dot2_f32_bf16 v49, v21, v165, v49
    v_dot2_f32_bf16 v50, v37, v133, v50
    v_dot2_f32_bf16 v51, v37, v165, v51
    v_dot2_f32_bf16 v52, v21, v197, v52
    v_dot2_f32_bf16 v53, v21, v229, v53
    v_dot2_f32_bf16 v54, v37, v197, v54
    v_dot2_f32_bf16 v55, v37, v229, v55
    v_dot2_f32_bf16 v48, v22, v134, v48
    v_dot2_f32_bf16 v49, v22, v166, v49
    v_dot2_f32_bf16 v50, v38, v134, v50
    v_dot2_f32_bf16 v51, v38, v166, v51
    v_dot2_f32_bf16 v52, v22, v198, v52
    v_dot2_f32_bf16 v53, v22, v230, v53
    v_dot2_f32_bf16 v54, v38, v198, v54
    v_dot2_f32_bf16 v55, v38, v230, v55
    v_dot2_f32_bf16 v48, v23, v135, v48
    v_dot2_f32_bf16 v49, v23, v167, v49
    v_dot2_f32_bf16 v50, v39, v135, v50
    v_dot2_f32_bf16 v51, v39, v167, v51
    v_dot2_f32_bf16 v52, v23, v199, v52
    v_dot2_f32_bf16 v53, v23, v231, v53
    v_dot2_f32_bf16 v54, v39, v199, v54
    v_dot2_f32_bf16 v55, v39, v231, v55
    v_dot2_f32_bf16 v48, v24, v136, v48
    v_dot2_f32_bf16 v49, v24, v168, v49
    v_dot2_f32_bf16 v50, v40, v136, v50
    v_dot2_f32_bf16 v51, v40, v168, v51
    v_dot2_f32_bf16 v52, v24, v200, v52
    v_dot2_f32_bf16 v53, v24, v232, v53
    v_dot2_f32_bf16 v54, v40, v200, v54
    v_dot2_f32_bf16 v55, v40, v232, v55
    v_dot2_f32_bf16 v48, v25, v137, v48
    v_dot2_f32_bf16 v49, v25, v169, v49
    v_dot2_f32_bf16 v50, v41, v137, v50
    v_dot2_f32_bf16 v51, v41, v169, v51
    v_dot2_f32_bf16 v52, v25, v201, v52
    v_dot2_f32_bf16 v53, v25, v233, v53
    v_dot2_f32_bf16 v54, v41, v201, v54
    v_dot2_f32_bf16 v55, v41, v233, v55
    v_dot2_f32_bf16 v48, v26, v138, v48
    v_dot2_f32_bf16 v49, v26, v170, v49
    v_dot2_f32_bf16 v50, v42, v138, v50
    v_dot2_f32_bf16 v51, v42, v170, v51
    v_dot2_f32_bf16 v52, v26, v202, v52
    v_dot2_f32_bf16 v53, v26, v234, v53
    v_dot2_f32_bf16 v54, v42, v202, v54
    v_dot2_f32_bf16 v55, v42, v234, v55
    v_dot2_f32_bf16 v48, v27, v139, v48
    v_dot2_f32_bf16 v49, v27, v171, v49
    v_dot2_f32_bf16 v50, v43, v139, v50
    v_dot2_f32_bf16 v51, v43, v171, v51
    v_dot2_f32_bf16 v52, v27, v203, v52
    v_dot2_f32_bf16 v53, v27, v235, v53
    v_dot2_f32_bf16 v54, v43, v203, v54
    v_dot2_f32_bf16 v55, v43, v235, v55
    v_dot2_f32_bf16 v48, v28, v140, v48
    v_dot2_f32_bf16 v49, v28, v172, v49
    v_dot2_f32_bf16 v50, v44, v140, v50
    v_dot2_f32_bf16 v51, v44, v172, v51
    v_dot2_f32_bf16 v52, v28, v204, v52
    v_dot2_f32_bf16 v53, v28, v236, v53
    v_dot2_f32_bf16 v54, v44, v204, v54
    v_dot2_f32_bf16 v55, v44, v236, v55
    v_dot2_f32_bf16 v48, v29, v141, v48
    v_dot2_f32_bf16 v49, v29, v173, v49
    v_dot2_f32_bf16 v50, v45, v141, v50
    v_dot2_f32_bf16 v51, v45, v173, v51
    v_dot2_f32_bf16 v52, v29, v205, v52
    v_dot2_f32_bf16 v53, v29, v237, v53
    v_dot2_f32_bf16 v54, v45, v205, v54
    v_dot2_f32_bf16 v55, v45, v237, v55
    v_dot2_f32_bf16 v48, v30, v142, v48
    v_dot2_f32_bf16 v49, v30, v174, v49
    v_dot2_f32_bf16 v50, v46, v142, v50
    v_dot2_f32_bf16 v51, v46, v174, v51
    v_dot2_f32_bf16 v52, v30, v206, v52
    v_dot2_f32_bf16 v53, v30, v238, v53
    v_dot2_f32_bf16 v54, v46, v206, v54
    v_dot2_f32_bf16 v55, v46, v238, v55
    v_dot2_f32_bf16 v48, v31, v143, v48
    v_dot2_f32_bf16 v49, v31, v175, v49
    v_dot2_f32_bf16 v50, v47, v143, v50
    v_dot2_f32_bf16 v51, v47, v175, v51
    v_dot2_f32_bf16 v52, v31, v207, v52
    v_dot2_f32_bf16 v53, v31, v239, v53
    v_dot2_f32_bf16 v54, v47, v207, v54
    v_dot2_f32_bf16 v55, v47, v239, v55
    ds_read_b128 v[16:19], v8 offset:4160
    ds_read_b128 v[20:23], v8 offset:4176
    ds_read_b128 v[24:27], v8 offset:4192
    ds_read_b128 v[28:31], v8 offset:4208
    ds_read_b128 v[32:35], v8 offset:5184
    ds_read_b128 v[36:39], v8 offset:5200
    ds_read_b128 v[40:43], v8 offset:5216
    ds_read_b128 v[44:47], v8 offset:5232
    s_waitcnt lgkmcnt(0)
    v_dot2_f32_bf16 v48, v16, v144, v48
    v_dot2_f32_bf16 v49, v16, v176, v49
    v_dot2_f32_bf16 v50, v32, v144, v50
    v_dot2_f32_bf16 v51, v32, v176, v51
    v_dot2_f32_bf16 v52, v16, v208, v52
    v_dot2_f32_bf16 v53, v16, v240, v53
    v_dot2_f32_bf16 v54, v32, v208, v54
    v_dot2_f32_bf16 v55, v32, v240, v55
    v_dot2_f32_bf16 v48, v17, v145, v48
    v_dot2_f32_bf16 v49, v17, v177, v49
    v_dot2_f32_bf16 v50, v33, v145, v50
    v_dot2_f32_bf16 v51, v33, v177, v51
    v_dot2_f32_bf16 v52, v17, v209, v52
    v_dot2_f32_bf16 v53, v17, v241, v53
    v_dot2_f32_bf16 v54, v33, v209, v54
    v_dot2_f32_bf16 v55, v33, v241, v55
    v_dot2_f32_bf16 v48, v18, v146, v48
    v_dot2_f32_bf16 v49, v18, v178, v49
    v_dot2_f32_bf16 v50, v34, v146, v50
    v_dot2_f32_bf16 v51, v34, v178, v51
    v_dot2_f32_bf16 v52, v18, v210, v52
    v_dot2_f32_bf16 v53, v18, v242, v53
    v_dot2_f32_bf16 v54, v34, v210, v54
    v_dot2_f32_bf16 v55, v34, v242, v55
    v_dot2_f32_bf16 v48, v19, v147, v48
    v_dot2_f32_bf16 v49, v19, v179, v49
    v_dot2_f32_bf16 v50, v35, v147, v50
    v_dot2_f32_bf16 v51, v35, v179, v51
    v_dot2_f32_bf16 v52, v19, v211, v52
    v_dot2_f32_bf16 v53, v19, v243, v53
    v_dot2_f32_bf16 v54, v35, v211, v54
    v_dot2_f32_bf16 v55, v35, v243, v55
    v_dot2_f32_bf16 v48, v20, v148, v48
    v_dot2_f32_bf16 v49, v20, v180, v49
    v_dot2_f32_bf16 v50, v36, v148, v50
    v_dot2_f32_bf16 v51, v36, v180, v51
    v_dot2_f32_bf16 v52, v20, v212, v52
    v_dot2_f32_bf16 v53, v20, v244, v53
    v_dot2_f32_bf16 v54, v36, v212, v54
    v_dot2_f32_bf16 v55, v36, v244, v55
    v_dot2_f32_bf16 v48, v21, v149, v48
    v_dot2_f32_bf16 v49, v21, v181, v49
    v_dot2_f32_bf16 v50, v37, v149, v50
    v_dot2_f32_bf16 v51, v37, v181, v51
    v_dot2_f32_bf16 v52, v21, v213, v52
    v_dot2_f32_bf16 v53, v21, v245, v53
    v_dot2_f32_bf16 v54, v37, v213, v54
    v_dot2_f32_bf16 v55, v37, v245, v55
    v_dot2_f32_bf16 v48, v22, v150, v48
    v_dot2_f32_bf16 v49, v22, v182, v49
    v_dot2_f32_bf16 v50, v38, v150, v50
    v_dot2_f32_bf16 v51, v38, v182, v51
    v_dot2_f32_bf16 v52, v22, v214, v52
    v_dot2_f32_bf16 v53, v22, v246, v53
    v_dot2_f32_bf16 v54, v38, v214, v54
    v_dot2_f32_bf16 v55, v38, v246, v55
    v_dot2_f32_bf16 v48, v23, v151, v48
    v_dot2_f32_bf16 v49, v23, v183, v49
    v_dot2_f32_bf16 v50, v39, v151, v50
    v_dot2_f32_bf16 v51, v39, v183, v51
    v_dot2_f32_bf16 v52, v23, v215, v52
    v_dot2_f32_bf16 v53, v23, v247, v53
    v_dot2_f32_bf16 v54, v39, v215, v54
    v_dot2_f32_bf16 v55, v39, v247, v55
    v_dot2_f32_bf16 v48, v24, v152, v48
    v_dot2_f32_bf16 v49, v24, v184, v49
    v_dot2_f32_bf16 v50, v40, v152, v50
    v_dot2_f32_bf16 v51, v40, v184, v51
    v_dot2_f32_bf16 v52, v24, v216, v52
    v_dot2_f32_bf16 v53, v24, v248, v53
    v_dot2_f32_bf16 v54, v40, v216, v54
    v_dot2_f32_bf16 v55, v40, v248, v55
    v_dot2_f32_bf16 v48, v25, v153, v48
    v_dot2_f32_bf16 v49, v25, v185, v49
    v_dot2_f32_bf16 v50, v41, v153, v50
    v_dot2_f32_bf16 v51, v41, v185, v51
    v_dot2_f32_bf16 v52, v25, v217, v52
    v_dot2_f32_bf16 v53, v25, v249, v53
    v_dot2_f32_bf16 v54, v41, v217, v54
    v_dot2_f32_bf16 v55, v41, v249, v55
    v_dot2_f32_bf16 v48, v26, v154, v48
    v_dot2_f32_bf16 v49, v26, v186, v49
    v_dot2_f32_bf16 v50, v42, v154, v50
    v_dot2_f32_bf16 v51, v42, v186, v51
    v_dot2_f32_bf16 v52, v26, v218, v52
    v_dot2_f32_bf16 v53, v26, v250, v53
    v_dot2_f32_bf16 v54, v42, v218, v54
    v_dot2_f32_bf16 v55, v42, v250, v55
    v_dot2_f32_bf16 v48, v27, v155, v48
    v_dot2_f32_bf16 v49, v27, v187, v49
    v_dot2_f32_bf16 v50, v43, v155, v50
    v_dot2_f32_bf16 v51, v43, v187, v51
    v_dot2_f32_bf16 v52, v27, v219, v52
    v_dot2_f32_bf16 v53, v27, v251, v53
    v_dot2_f32_bf16 v54, v43, v219, v54
    v_dot2_f32_bf16 v55, v43, v251, v55
    v_dot2_f32_bf16 v48, v28, v156, v48
    v_dot2_f32_bf16 v49, v28, v188, v49
    v_dot2_f32_bf16 v50, v44, v156, v50
    v_dot2_f32_bf16 v51, v44, v188, v51
    v_dot2_f32_bf16 v52, v28, v220, v52
    v_dot2_f32_bf16 v53, v28, v252, v53
    v_dot2_f32_bf16 v54, v44, v220, v54
    v_dot2_f32_bf16 v55, v44, v252, v55
    v_dot2_f32_bf16 v48, v29, v157, v48
    v_dot2_f32_bf16 v49, v29, v189, v49
    v_dot2_f32_bf16 v50, v45, v157, v50
    v_dot2_f32_bf16 v51, v45, v189, v51
    v_dot2_f32_bf16 v52, v29, v221, v52
    v_dot2_f32_bf16 v53, v29, v253, v53
    v_dot2_f32_bf16 v54, v45, v221, v54
    v_dot2_f32_bf16 v55, v45, v253, v55
    v_dot2_f32_bf16 v48, v30, v158, v48
    v_dot2_f32_bf16 v49, v30, v190, v49
    v_dot2_f32_bf16 v50, v46, v158, v50
    v_dot2_f32_bf16 v51, v46, v190, v51
    v_dot2_f32_bf16 v52, v30, v222, v52
    v_dot2_f32_bf16 v53, v30, v254, v53
    v_dot2_f32_bf16 v54, v46, v222, v54
    v_dot2_f32_bf16 v55, v46, v254, v55
    v_dot2_f32_bf16 v48, v31, v159, v48
    v_dot2_f32_bf16 v49, v31, v191, v49
    v_dot2_f32_bf16 v50, v47, v159, v50
    v_dot2_f32_bf16 v51, v47, v191, v51
    v_dot2_f32_bf16 v52, v31, v223, v52
    v_dot2_f32_bf16 v53, v31, v255, v53
    v_dot2_f32_bf16 v54, v47, v223, v54
    v_dot2_f32_bf16 v55, v47, v255, v55
    s_nop 3
    v_lshlrev_b32 v7, 5, v0
    ds_write_b128 v7, v[48:51] offset:8192
    ds_write_b128 v7, v[52:55] offset:8208
    s_waitcnt lgkmcnt(0)
    s_barrier
    v_lshlrev_b32 v7, 5, v2
    v_bfe_u32 v8, v0, 5, 1
    v_lshl_add_u32 v7, v8, 3, v7
    ds_read_b64 v[16:17], v7 offset:8192
    ds_read_b64 v[18:19], v7 offset:8208
    ds_read_b64 v[20:21], v7 offset:9216
    ds_read_b64 v[22:23], v7 offset:9232
    ds_read_b64 v[24:25], v7 offset:10240
    ds_read_b64 v[26:27], v7 offset:10256
    ds_read_b64 v[28:29], v7 offset:11264
    ds_read_b64 v[30:31], v7 offset:11280
    s_waitcnt lgkmcnt(0)
    ds_read_b64 v[32:33], v7 offset:12288
    ds_read_b64 v[34:35], v7 offset:12304
    ds_read_b64 v[36:37], v7 offset:13312
    ds_read_b64 v[38:39], v7 offset:13328
    ds_read_b64 v[40:41], v7 offset:14336
    ds_read_b64 v[42:43], v7 offset:14352
    ds_read_b64 v[44:45], v7 offset:15360
    ds_read_b64 v[46:47], v7 offset:15376
    s_waitcnt lgkmcnt(0)
    v_add_f32 v16, v16, v20
    v_add_f32 v16, v16, v24
    v_add_f32 v16, v16, v28
    v_add_f32 v16, v16, v32
    v_add_f32 v16, v16, v36
    v_add_f32 v16, v16, v40
    v_add_f32 v16, v16, v44
    v_cvt_pk_bf16_f32 v5, v16, v16
    v_lshlrev_b32 v16, 16, v5
    v_add_f32 v17, v17, v21
    v_add_f32 v17, v17, v25
    v_add_f32 v17, v17, v29
    v_add_f32 v17, v17, v33
    v_add_f32 v17, v17, v37
    v_add_f32 v17, v17, v41
    v_add_f32 v17, v17, v45
    v_cvt_pk_bf16_f32 v5, v17, v17
    v_lshlrev_b32 v17, 16, v5
    v_add_f32 v18, v18, v22
    v_add_f32 v18, v18, v26
    v_add_f32 v18, v18, v30
    v_add_f32 v18, v18, v34
    v_add_f32 v18, v18, v38
    v_add_f32 v18, v18, v42
    v_add_f32 v18, v18, v46
    v_cvt_pk_bf16_f32 v5, v18, v18
    v_lshlrev_b32 v18, 16, v5
    v_add_f32 v19, v19, v23
    v_add_f32 v19, v19, v27
    v_add_f32 v19, v19, v31
    v_add_f32 v19, v19, v35
    v_add_f32 v19, v19, v39
    v_add_f32 v19, v19, v43
    v_add_f32 v19, v19, v47
    v_cvt_pk_bf16_f32 v5, v19, v19
    v_lshlrev_b32 v19, 16, v5
    v_mul_f32 v6, 0xbfb8aa3b, v16
    v_exp_f32 v6, v6
    s_nop 0
    v_add_f32 v6, 1.0, v6
    v_rcp_f32 v6, v6
    s_nop 0
    v_mul_f32 v16, v16, v6
    v_cvt_pk_bf16_f32 v5, v16, v16
    v_lshlrev_b32 v16, 16, v5
    v_mul_f32 v16, v16, v18
    v_mul_f32 v6, 0xbfb8aa3b, v17
    v_exp_f32 v6, v6
    s_nop 0
    v_add_f32 v6, 1.0, v6
    v_rcp_f32 v6, v6
    s_nop 0
    v_mul_f32 v17, v17, v6
    v_cvt_pk_bf16_f32 v5, v17, v17
    v_lshlrev_b32 v17, 16, v5
    v_mul_f32 v17, v17, v19
    v_cvt_pk_bf16_f32 v16, v16, v17
    v_mul_u32_u24 v8, 3584, v8
    v_lshl_add_u32 v7, v2, 2, v8
    v_mov_b32 v6, 0x40000000
    v_cmp_lt_u32 vcc, 27, v2
    s_nop 1
    v_cndmask_b32 v7, v7, v6, vcc
    v_cmp_lt_u32 vcc, 63, v0
    s_nop 1
    v_cndmask_b32 v7, v7, v6, vcc
    s_mul_i32 s37, s24, 8192
    s_add_u32 s37, s37, 0x1b0000
    s_add_u32 s36, s37, s23
    buffer_store_dword v16, v7, s[8:11], s36 offen sc1
    v_lshlrev_b32 v7, 4, v0
    v_add_u32 v8, 4096, v7
    v_cmp_lt_u32 vcc, 191, v0
    s_nop 1
    v_cndmask_b32 v8, v8, v6, vcc
L_M_act:
    buffer_load_dwordx4 v[20:23], v7, s[8:11], s37 offen sc1
    buffer_load_dwordx4 v[24:27], v8, s[8:11], s37 offen sc1
    s_add_u32 s32, s32, 1
    s_cmp_gt_u32 s32, 200000
    s_waitcnt vmcnt(0)
    v_max3_u32 v5, v20, v21, v22
    v_max3_u32 v5, v5, v23, v24
    v_max3_u32 v5, v5, v25, v26
    v_max_u32 v5, v5, v27
    s_cbranch_scc1 L_M_act_ok
    v_cmp_eq_u32 vcc, -1, v5
    s_cbranch_vccnz L_M_act
L_M_act_ok:
    ds_write_b128 v7, v[20:23] offset:16384
    ds_write_b128 v7, v[24:27] offset:20480
    s_waitcnt lgkmcnt(0)
    s_barrier
    v_lshrrev_b32 v7, 3, v0
    v_mul_u32_u24 v7, 112, v7
    v_mov_b64 v[48:49], 0
    v_mov_b64 v[50:51], 0
    ds_read_b128 v[16:19], v7 offset:16384
    ds_read_b128 v[20:23], v7 offset:16400
    ds_read_b128 v[24:27], v7 offset:16416
    ds_read_b128 v[28:31], v7 offset:16432
    ds_read_b128 v[32:35], v7 offset:16448
    ds_read_b128 v[36:39], v7 offset:16464
    ds_read_b128 v[40:43], v7 offset:16480
    s_waitcnt lgkmcnt(0)
    v_dot2_f32_bf16 v48, v16, v64, v48
    v_dot2_f32_bf16 v49, v16, v92, v49
    v_dot2_f32_bf16 v48, v17, v65, v48
    v_dot2_f32_bf16 v49, v17, v93, v49
    v_dot2_f32_bf16 v48, v18, v66, v48
    v_dot2_f32_bf16 v49, v18, v94, v49
    v_dot2_f32_bf16 v48, v19, v67, v48
    v_dot2_f32_bf16 v49, v19, v95, v49
    v_dot2_f32_bf16 v48, v20, v68, v48
    v_dot2_f32_bf16 v49, v20, v96, v49
    v_dot2_f32_bf16 v48, v21, v69, v48
    v_dot2_f32_bf16 v49, v21, v97, v49
    v_dot2_f32_bf16 v48, v22, v70, v48
    v_dot2_f32_bf16 v49, v22, v98, v49
    v_dot2_f32_bf16 v48, v23, v71, v48
    v_dot2_f32_bf16 v49, v23, v99, v49
    v_dot2_f32_bf16 v48, v24, v72, v48
    v_dot2_f32_bf16 v49, v24, v100, v49
    v_dot2_f32_bf16 v48, v25, v73, v48
    v_dot2_f32_bf16 v49, v25, v101, v49
    v_dot2_f32_bf16 v48, v26, v74, v48
    v_dot2_f32_bf16 v49, v26, v102, v49
    v_dot2_f32_bf16 v48, v27, v75, v48
    v_dot2_f32_bf16 v49, v27, v103, v49
    v_dot2_f32_bf16 v48, v28, v76, v48
    v_dot2_f32_bf16 v49, v28, v104, v49
    v_dot2_f32_bf16 v48, v29, v77, v48
    v_dot2_f32_bf16 v49, v29, v105, v49
    v_dot2_f32_bf16 v48, v30, v78, v48
    v_dot2_f32_bf16 v49, v30, v106, v49
    v_dot2_f32_bf16 v48, v31, v79, v48
    v_dot2_f32_bf16 v49, v31, v107, v49
    v_dot2_f32_bf16 v48, v32, v80, v48
    v_dot2_f32_bf16 v49, v32, v108, v49
    v_dot2_f32_bf16 v48, v33, v81, v48
    v_dot2_f32_bf16 v49, v33, v109, v49
    v_dot2_f32_bf16 v48, v34, v82, v48
    v_dot2_f32_bf16 v49, v34, v110, v49
    v_dot2_f32_bf16 v48, v35, v83, v48
    v_dot2_f32_bf16 v49, v35, v111, v49
    v_dot2_f32_bf16 v48, v36, v84, v48
    v_dot2_f32_bf16 v49, v36, v112, v49
    v_dot2_f32_bf16 v48, v37, v85, v48
    v_dot2_f32_bf16 v49, v37, v113, v49
    v_dot2_f32_bf16 v48, v38, v86, v48
    v_dot2_f32_bf16 v49, v38, v114, v49
    v_dot2_f32_bf16 v48, v39, v87, v48
    v_dot2_f32_bf16 v49, v39, v115, v49
    v_dot2_f32_bf16 v48, v40, v88, v48
    v_dot2_f32_bf16 v49, v40, v116, v49
    v_dot2_f32_bf16 v48, v41, v89, v48
    v_dot2_f32_bf16 v49, v41, v117, v49
    v_dot2_f32_bf16 v48, v42, v90, v48
    v_dot2_f32_bf16 v49, v42, v118, v49
    v_dot2_f32_bf16 v48, v43, v91, v48
    v_dot2_f32_bf16 v49, v43, v119, v49
    ds_read_b128 v[16:19], v7 offset:19968
    ds_read_b128 v[20:23], v7 offset:19984
    ds_read_b128 v[24:27], v7 offset:20000
    ds_read_b128 v[28:31], v7 offset:20016
    ds_read_b128 v[32:35], v7 offset:20032
    ds_read_b128 v[36:39], v7 offset:20048
    ds_read_b128 v[40:43], v7 offset:20064
    s_waitcnt lgkmcnt(0)
    v_dot2_f32_bf16 v50, v16, v64, v50
    v_dot2_f32_bf16 v51, v16, v92, v51
    v_dot2_f32_bf16 v50, v17, v65, v50
    v_dot2_f32_bf16 v51, v17, v93, v51
    v_dot2_f32_bf16 v50, v18, v66, v50
    v_dot2_f32_bf16 v51, v18, v94, v51
    v_dot2_f32_bf16 v50, v19, v67, v50
    v_dot2_f32_bf16 v51, v19, v95, v51
    v_dot2_f32_bf16 v50, v20, v68, v50
    v_dot2_f32_bf16 v51, v20, v96, v51
    v_dot2_f32_bf16 v50, v21, v69, v50
    v_dot2_f32_bf16 v51, v21, v97, v51
    v_dot2_f32_bf16 v50, v22, v70, v50
    v_dot2_f32_bf16 v51, v22, v98, v51
    v_dot2_f32_bf16 v50, v23, v71, v50
    v_dot2_f32_bf16 v51, v23, v99, v51
    v_dot2_f32_bf16 v50, v24, v72, v50
    v_dot2_f32_bf16 v51, v24, v100, v51
    v_dot2_f32_bf16 v50, v25, v73, v50
    v_dot2_f32_bf16 v51, v25, v101, v51
    v_dot2_f32_bf16 v50, v26, v74, v50
    v_dot2_f32_bf16 v51, v26, v102, v51
    v_dot2_f32_bf16 v50, v27, v75, v50
    v_dot2_f32_bf16 v51, v27, v103, v51
    v_dot2_f32_bf16 v50, v28, v76, v50
    v_dot2_f32_bf16 v51, v28, v104, v51
    v_dot2_f32_bf16 v50, v29, v77, v50
    v_dot2_f32_bf16 v51, v29, v105, v51
    v_dot2_f32_bf16 v50, v30, v78, v50
    v_dot2_f32_bf16 v51, v30, v106, v51
    v_dot2_f32_bf16 v50, v31, v79, v50
    v_dot2_f32_bf16 v51, v31, v107, v51
    v_dot2_f32_bf16 v50, v32, v80, v50
    v_dot2_f32_bf16 v51, v32, v108, v51
    v_dot2_f32_bf16 v50, v33, v81, v50
    v_dot2_f32_bf16 v51, v33, v109, v51
    v_dot2_f32_bf16 v50, v34, v82, v50
    v_dot2_f32_bf16 v51, v34, v110, v51
    v_dot2_f32_bf16 v50, v35, v83, v50
    v_dot2_f32_bf16 v51, v35, v111, v51
    v_dot2_f32_bf16 v50, v36, v84, v50
    v_dot2_f32_bf16 v51, v36, v112, v51
    v_dot2_f32_bf16 v50, v37, v85, v50
    v_dot2_f32_bf16 v51, v37, v113, v51
    v_dot2_f32_bf16 v50, v38, v86, v50
    v_dot2_f32_bf16 v51, v38, v114, v51
    v_dot2_f32_bf16 v50, v39, v87, v50
    v_dot2_f32_bf16 v51, v39, v115, v51
    v_dot2_f32_bf16 v50, v40, v88, v50
    v_dot2_f32_bf16 v51, v40, v116, v51
    v_dot2_f32_bf16 v50, v41, v89, v50
    v_dot2_f32_bf16 v51, v41, v117, v51
    v_dot2_f32_bf16 v50, v42, v90, v50
    v_dot2_f32_bf16 v51, v42, v118, v51
    v_dot2_f32_bf16 v50, v43, v91, v50
    v_dot2_f32_bf16 v51, v43, v119, v51
    s_nop 3
    v_add_f32_dpp v48, v48, v48 row_ror:8 row_mask:0xf bank_mask:0xf
    v_add_f32_dpp v49, v49, v49 row_ror:8 row_mask:0xf bank_mask:0xf
    v_add_f32_dpp v50, v50, v50 row_ror:8 row_mask:0xf bank_mask:0xf
    v_add_f32_dpp v51, v51, v51 row_ror:8 row_mask:0xf bank_mask:0xf
    v_mov_b32 v5, v48
    s_nop 1
    v_permlane16_swap_b32 v48, v5
    v_add_f32 v48, v48, v5
    v_mov_b32 v5, v49
    s_nop 1
    v_permlane16_swap_b32 v49, v5
    v_add_f32 v49, v49, v5
    v_mov_b32 v5, v50
    s_nop 1
    v_permlane16_swap_b32 v50, v5
    v_add_f32 v50, v50, v5
    v_mov_b32 v5, v51
    s_nop 1
    v_permlane16_swap_b32 v51, v5
    v_add_f32 v51, v51, v5
    v_mov_b32 v5, v48
    s_nop 1
    v_permlane32_swap_b32 v48, v5
    v_add_f32 v48, v48, v5
    v_mov_b32 v5, v49
    s_nop 1
    v_permlane32_swap_b32 v49, v5
    v_add_f32 v49, v49, v5
    v_mov_b32 v5, v50
    s_nop 1
    v_permlane32_swap_b32 v50, v5
    v_add_f32 v50, v50, v5
    v_mov_b32 v5, v51
    s_nop 1
    v_permlane32_swap_b32 v51, v5
    v_add_f32 v51, v51, v5
    v_lshrrev_b32 v7, 6, v0
    v_lshlrev_b32 v7, 7, v7
    v_lshl_add_u32 v7, v3, 4, v7
    ds_write_b128 v7, v[48:51] offset:1024
    s_waitcnt lgkmcnt(0)
    s_barrier
    v_lshlrev_b32 v7, 4, v3
    v_lshl_add_u32 v7, v9, 3, v7
    ds_read_b64 v[16:17], v7 offset:1024
    ds_read_b64 v[18:19], v7 offset:1152
    ds_read_b64 v[20:21], v7 offset:1280
    ds_read_b64 v[22:23], v7 offset:1408
    v_mul_f32 v10, 0xbfb8aa3b, v11
    v_exp_f32 v10, v10
    s_nop 0
    v_add_f32 v10, 1.0, v10
    v_rcp_f32 v10, v10
    s_nop 0
    v_cvt_pk_bf16_f32 v5, v10, v10
    v_lshlrev_b32 v10, 16, v5
    s_waitcnt lgkmcnt(0)
    v_lshlrev_b32 v24, 16, v15
    v_and_b32 v25, 0xffff0000, v15
    v_lshlrev_b32 v26, 16, v14
    v_and_b32 v27, 0xffff0000, v14
    v_add_f32 v16, v16, v18
    v_add_f32 v20, v20, v22
    v_add_f32 v16, v16, v20
    v_cvt_pk_bf16_f32 v5, v16, v16
    v_lshlrev_b32 v16, 16, v5
    v_mul_f32 v16, v16, v10
    v_cvt_pk_bf16_f32 v5, v16, v16
    v_lshlrev_b32 v16, 16, v5
    v_add_f32 v16, v16, v24
    v_cvt_pk_bf16_f32 v5, v16, v16
    v_lshlrev_b32 v16, 16, v5
    v_add_f32 v16, v16, v26
    v_add_f32 v17, v17, v19
    v_add_f32 v21, v21, v23
    v_add_f32 v17, v17, v21
    v_cvt_pk_bf16_f32 v5, v17, v17
    v_lshlrev_b32 v17, 16, v5
    v_mul_f32 v17, v17, v10
    v_cvt_pk_bf16_f32 v5, v17, v17
    v_lshlrev_b32 v17, 16, v5
    v_add_f32 v17, v17, v25
    v_cvt_pk_bf16_f32 v5, v17, v17
    v_lshlrev_b32 v17, 16, v5
    v_add_f32 v17, v17, v27
    v_cvt_pk_bf16_f32 v16, v16, v17
    buffer_store_dword v16, v12, s[60:63], 0 offen sc1
    v_add_f32 v24, v24, v26
    v_add_f32 v25, v25, v27
    v_cvt_pk_bf16_f32 v13, v24, v25
L_M_next:
    s_add_u32 s24, s24, 1
    s_mov_b32 s25, 192
    s_cmp_eq_u32 s24, 1
    s_cbranch_scc1 L_M_round
    s_cmp_eq_u32 s24, 3
    s_cbranch_scc1 L_end
    s_mov_b32 s25, 256
    v_and_b32 v7, 63, v0
    v_lshlrev_b32 v3, 4, v7
    s_mov_b32 s36, 0x19bc00
    v_sub_u32 v7, 63, v7
L_M_fin:
    buffer_load_dwordx4 v[16:19], v3, s[8:11], s36 offen sc1
    s_add_u32 s32, s32, 1
    s_cmp_gt_u32 s32, 200000
    s_cselect_b32 s37, -1, -2
    s_waitcnt vmcnt(0)
    v_max3_u32 v5, v16, v17, v18
    v_max_u32 v5, v5, v19
    v_cmp_lt_u32 vcc, s37, v5
    s_cbranch_vccnz L_M_fin
    v_add_f32 v16, v16, v17
    v_add_f32 v18, v18, v19
    v_add_f32 v16, v16, v18
    v_cvt_pk_bf16_f32 v5, v16, v16
    v_lshlrev_b32 v16, 16, v5
    v_ashrrev_i32 v5, 31, v16
    v_or_b32 v5, 0x80000000, v5
    v_xor_b32 v5, v5, v16
    v_and_or_b32 v5, v5, s42, v7
    v_cmp_lt_u32 vcc, s29, v5
    s_cbranch_vccnz L_M_round
L_end:
    s_endpgm
.section .rodata,"a"
.p2align 6
.amdhsa_kernel sequential_preLN__memory_aug_recurrent_mem_tr__moe_arch_mod__prompt_kernel
  .amdhsa_next_free_vgpr 512
  .amdhsa_next_free_sgpr 102
  .amdhsa_accum_offset 256
  .amdhsa_group_segment_fixed_size 0
  .amdhsa_kernarg_size 120
  .amdhsa_user_sgpr_count 2
  .amdhsa_user_sgpr_kernarg_segment_ptr 1
  .amdhsa_system_sgpr_workgroup_id_x 1
.end_amdhsa_kernel
```

```asm
; @launch grid=(256,1,1) block=(256,1,1) lds=163840
.amdgcn_target "amdgcn-amd-amdhsa--gfx950"
.text
.globl sequential_preLN__memory_aug_recurrent_mem_tr__moe_arch_mod__prompt_kernel
.p2align 8
.type sequential_preLN__memory_aug_recurrent_mem_tr__moe_arch_mod__prompt_kernel,@function
sequential_preLN__memory_aug_recurrent_mem_tr__moe_arch_mod__prompt_kernel:
    s_cmp_ge_u32 s2, 256
    s_cbranch_scc1 L_end
    s_load_dwordx8 s[44:51], s[0:1], 0
    s_load_dwordx4 s[52:55], s[0:1], 32
    s_load_dwordx4 s[56:59], s[0:1], 104
    s_load_dwordx2 s[80:81], s[0:1], 64
    s_load_dwordx2 s[82:83], s[0:1], 96
    s_load_dwordx4 s[84:87], s[0:1], 72
    s_load_dwordx2 s[88:89], s[0:1], 88
    v_lshrrev_b32 v1, 6, v0
    s_nop 0
    v_readfirstlane_b32 s21, v1
    s_waitcnt lgkmcnt(0)
    s_mov_b32 s8, s58
    s_and_b32 s9, s59, 0xffff
    s_mov_b32 s10, 0x10000000
    s_mov_b32 s11, 0x20000
    s_mov_b32 s16, s56
    s_and_b32 s17, s57, 0xffff
    s_mov_b32 s18, 0x100
    s_mov_b32 s19, 0x20000
    s_and_b32 s3, s2, 7
    s_cmp_lg_u32 s3, 0
    s_cbranch_scc1 L_worker
    s_lshr_b32 s20, s2, 3
    v_lshrrev_b32 v28, 4, v0
    v_and_b32 v16, 15, v0
    v_lshlrev_b32 v16, 4, v16
    v_lshl_add_u32 v16, v28, 13, v16
    v_bfe_u32 v29, v0, 4, 1
    v_lshlrev_b32 v29, 5, v29
    v_xor_b32 v16, v16, v29
    v_and_b32 v29, 192, v0
    v_xor_b32 v16, v16, v29
    s_lshl_b32 s28, s21, 10
    s_lshl_b32 s3, s20, 8
    s_mov_b32 s60, s52
    s_and_b32 s61, s53, 0xffff
    s_mov_b32 s62, 0x400000
    s_mov_b32 s63, 0x20000
    s_add_u32 m0, s28, 32768
    s_add_u32 s37, s3, 0x0
    buffer_load_dwordx4 v16, s[60:63], s37 offen lds
    s_add_u32 m0, s28, 36864
    s_add_u32 s37, s3, 0x20000
    buffer_load_dwordx4 v16, s[60:63], s37 offen lds
    s_add_u32 m0, s28, 65536
    s_add_u32 s37, s3, 0x40000
    buffer_load_dwordx4 v16, s[60:63], s37 offen lds
    s_add_u32 m0, s28, 69632
    s_add_u32 s37, s3, 0x60000
    buffer_load_dwordx4 v16, s[60:63], s37 offen lds
    s_add_u32 m0, s28, 98304
    s_add_u32 s37, s3, 0x80000
    buffer_load_dwordx4 v16, s[60:63], s37 offen lds
    s_add_u32 m0, s28, 102400
    s_add_u32 s37, s3, 0xa0000
    buffer_load_dwordx4 v16, s[60:63], s37 offen lds
    s_add_u32 m0, s28, 131072
    s_add_u32 s37, s3, 0xc0000
    buffer_load_dwordx4 v16, s[60:63], s37 offen lds
    s_add_u32 m0, s28, 135168
    s_add_u32 s37, s3, 0xe0000
    buffer_load_dwordx4 v16, s[60:63], s37 offen lds
    s_add_u32 m0, s28, 40960
    s_add_u32 s37, s3, 0x100000
    buffer_load_dwordx4 v16, s[60:63], s37 offen lds
    s_add_u32 m0, s28, 45056
    s_add_u32 s37, s3, 0x120000
    buffer_load_dwordx4 v16, s[60:63], s37 offen lds
    s_add_u32 m0, s28, 73728
    s_add_u32 s37, s3, 0x140000
    buffer_load_dwordx4 v16, s[60:63], s37 offen lds
    s_add_u32 m0, s28, 77824
    s_add_u32 s37, s3, 0x160000
    buffer_load_dwordx4 v16, s[60:63], s37 offen lds
    s_add_u32 m0, s28, 106496
    s_add_u32 s37, s3, 0x180000
    buffer_load_dwordx4 v16, s[60:63], s37 offen lds
    s_add_u32 m0, s28, 110592
    s_add_u32 s37, s3, 0x1a0000
    buffer_load_dwordx4 v16, s[60:63], s37 offen lds
    s_add_u32 m0, s28, 139264
    s_add_u32 s37, s3, 0x1c0000
    buffer_load_dwordx4 v16, s[60:63], s37 offen lds
    s_add_u32 m0, s28, 143360
    s_add_u32 s37, s3, 0x1e0000
    buffer_load_dwordx4 v16, s[60:63], s37 offen lds
    s_add_u32 m0, s28, 49152
    s_add_u32 s37, s3, 0x200000
    buffer_load_dwordx4 v16, s[60:63], s37 offen lds
    s_add_u32 m0, s28, 53248
    s_add_u32 s37, s3, 0x220000
    buffer_load_dwordx4 v16, s[60:63], s37 offen lds
    s_add_u32 m0, s28, 81920
    s_add_u32 s37, s3, 0x240000
    buffer_load_dwordx4 v16, s[60:63], s37 offen lds
    s_add_u32 m0, s28, 86016
    s_add_u32 s37, s3, 0x260000
    buffer_load_dwordx4 v16, s[60:63], s37 offen lds
    s_add_u32 m0, s28, 114688
    s_add_u32 s37, s3, 0x280000
    buffer_load_dwordx4 v16, s[60:63], s37 offen lds
    s_add_u32 m0, s28, 118784
    s_add_u32 s37, s3, 0x2a0000
    buffer_load_dwordx4 v16, s[60:63], s37 offen lds
    s_add_u32 m0, s28, 147456
    s_add_u32 s37, s3, 0x2c0000
    buffer_load_dwordx4 v16, s[60:63], s37 offen lds
    s_add_u32 m0, s28, 151552
    s_add_u32 s37, s3, 0x2e0000
    buffer_load_dwordx4 v16, s[60:63], s37 offen lds
    v_mov_b32 v20, 0x0
    v_bfe_u32 v14, v0, 0, 1
    s_mov_b32 s38, 0x8
    v_mad_u32_u24 v20, v14, s38, v20
    v_bfe_u32 v14, v0, 1, 1
    s_mov_b32 s38, 0x10
    v_mad_u32_u24 v20, v14, s38, v20
    v_bfe_u32 v14, v0, 2, 1
    s_mov_b32 s38, 0x100
    v_mad_u32_u24 v20, v14, s38, v20
    v_bfe_u32 v14, v0, 3, 1
    s_mov_b32 s38, 0x800
    v_mad_u32_u24 v20, v14, s38, v20
    v_bfe_u32 v14, v0, 4, 1
    s_mov_b32 s38, 0x400
    v_mad_u32_u24 v20, v14, s38, v20
    v_bfe_u32 v14, v0, 5, 1
    s_mov_b32 s38, 0x1000
    v_mad_u32_u24 v20, v14, s38, v20
    v_mov_b32 v30, 0x0
    v_bfe_u32 v14, v0, 2, 1
    s_mov_b32 s38, 0x20
    v_mad_u32_u24 v30, v14, s38, v30
    v_bfe_u32 v14, v0, 3, 1
    s_mov_b32 s38, 0x80
    v_mad_u32_u24 v30, v14, s38, v30
    v_bfe_u32 v14, v0, 4, 1
    s_mov_b32 s38, 0x40
    v_mad_u32_u24 v30, v14, s38, v30
    v_mov_b32 v31, 0x0
    v_bfe_u32 v14, v0, 6, 1
    s_mov_b32 s38, 0x40
    v_mad_u32_u24 v31, v14, s38, v31
    v_bfe_u32 v14, v0, 7, 1
    s_mov_b32 s38, 0x80
    v_mad_u32_u24 v31, v14, s38, v31
    v_xor_b32 v30, v30, v31
    v_add_u32 v30, v30, v20
    s_xor_b32 s36, s21, 0
    s_add_u32 s36, s36, 1
    s_lshl_b32 s36, s36, 15
    v_add_u32 v20, s36, v30
    v_xor_b32 v21, 32, v20
    s_xor_b32 s36, s21, 1
    s_add_u32 s36, s36, 1
    s_lshl_b32 s36, s36, 15
    v_add_u32 v22, s36, v30
    v_xor_b32 v23, 32, v22
    s_xor_b32 s36, s21, 2
    s_add_u32 s36, s36, 1
    s_lshl_b32 s36, s36, 15
    v_add_u32 v24, s36, v30
    v_xor_b32 v25, 32, v24
    s_xor_b32 s36, s21, 3
    s_add_u32 s36, s36, 1
    s_lshl_b32 s36, s36, 15
    v_add_u32 v26, s36, v30
    v_xor_b32 v27, 32, v26
    v_mov_b32 v11, 0x0
    v_bfe_u32 v14, v0, 0, 1
    s_mov_b32 s38, 0x4
    v_mad_u32_u24 v11, v14, s38, v11
    v_bfe_u32 v14, v0, 1, 1
    s_mov_b32 s38, 0x8
    v_mad_u32_u24 v11, v14, s38, v11
    v_bfe_u32 v14, v0, 2, 1
    s_mov_b32 s38, 0x10
    v_mad_u32_u24 v11, v14, s38, v11
    v_bfe_u32 v14, v0, 3, 1
    s_mov_b32 s38, 0x20
    v_mad_u32_u24 v11, v14, s38, v11
    v_bfe_u32 v14, v0, 4, 1
    s_mov_b32 s38, 0x800
    v_mad_u32_u24 v11, v14, s38, v11
    v_bfe_u32 v14, v0, 5, 1
    s_mov_b32 s38, 0x1000
    v_mad_u32_u24 v11, v14, s38, v11
    v_bfe_u32 v14, v0, 6, 1
    s_mov_b32 s38, 0x100
    v_mad_u32_u24 v11, v14, s38, v11
    v_bfe_u32 v14, v0, 7, 1
    s_mov_b32 s38, 0x200
    v_mad_u32_u24 v11, v14, s38, v11
    s_mov_b32 s92, s54
    s_and_b32 s93, s55, 0xffff
    s_mov_b32 s94, 0x400000
    s_mov_b32 s95, 0x20000
    s_lshl_b32 s29, s20, 17
    s_xor_b32 s36, s21, 3
    s_lshl_b32 s36, s36, 15
    s_add_u32 s36, s36, s29
    s_add_u32 s37, s36, 0x80
    buffer_load_dword v32, v11, s[92:95], s37 offen
    s_add_u32 s37, s36, 0x4080
    buffer_load_dword v33, v11, s[92:95], s37 offen
    s_add_u32 s37, s36, 0x480
    buffer_load_dword v34, v11, s[92:95], s37 offen
    s_add_u32 s37, s36, 0x4480
    buffer_load_dword v35, v11, s[92:95], s37 offen
    s_add_u32 s37, s36, 0x2080
    buffer_load_dword v36, v11, s[92:95], s37 offen
    s_add_u32 s37, s36, 0x6080
    buffer_load_dword v37, v11, s[92:95], s37 offen
    s_add_u32 s37, s36, 0x2480
    buffer_load_dword v38, v11, s[92:95], s37 offen
    s_add_u32 s37, s36, 0x6480
    buffer_load_dword v39, v11, s[92:95], s37 offen
    s_add_u32 s37, s36, 0xc0
    buffer_load_dword v40, v11, s[92:95], s37 offen
    s_add_u32 s37, s36, 0x40c0
    buffer_load_dword v41, v11, s[92:95], s37 offen
    s_add_u32 s37, s36, 0x4c0
    buffer_load_dword v42, v11, s[92:95], s37 offen
    s_add_u32 s37, s36, 0x44c0
    buffer_load_dword v43, v11, s[92:95], s37 offen
    s_add_u32 s37, s36, 0x20c0
    buffer_load_dword v44, v11, s[92:95], s37 offen
    s_add_u32 s37, s36, 0x60c0
    buffer_load_dword v45, v11, s[92:95], s37 offen
    s_add_u32 s37, s36, 0x24c0
    buffer_load_dword v46, v11, s[92:95], s37 offen
    s_add_u32 s37, s36, 0x64c0
    buffer_load_dword v47, v11, s[92:95], s37 offen
    s_getreg_b32 s36, hwreg(HW_REG_XCC_ID)
    s_and_b32 s36, s36, 15
    s_or_b32 s36, s36, 0x100
    v_mov_b32 v30, s36
    s_lshl_b32 s37, s20, 2
    v_lshlrev_b32 v31, 20, v0
    buffer_store_dword v30, v31, s[16:19], s37 offen offset:128 sc1
    s_mov_b32 s12, s46
    s_and_b32 s13, s47, 0xffff
    s_mov_b32 s14, 0x2000
    s_mov_b32 s15, 0x20000
    v_mov_b32 v104, 0x0
    v_bfe_u32 v14, v0, 0, 1
    s_mov_b32 s38, 0x8
    v_mad_u32_u24 v104, v14, s38, v104
    v_bfe_u32 v14, v0, 1, 1
    s_mov_b32 s38, 0x10
    v_mad_u32_u24 v104, v14, s38, v104
    v_bfe_u32 v14, v0, 2, 1
    s_mov_b32 s38, 0x10000
    v_mad_u32_u24 v104, v14, s38, v104
    v_bfe_u32 v14, v0, 3, 1
    s_mov_b32 s38, 0x10000
    v_mad_u32_u24 v104, v14, s38, v104
    v_bfe_u32 v14, v0, 4, 1
    s_mov_b32 s38, 0x400
    v_mad_u32_u24 v104, v14, s38, v104
    v_bfe_u32 v14, v0, 5, 1
    s_mov_b32 s38, 0x4
    v_mad_u32_u24 v104, v14, s38, v104
    v_bfe_u32 v14, v0, 6, 1
    s_mov_b32 s38, 0x40
    v_mad_u32_u24 v104, v14, s38, v104
    v_bfe_u32 v14, v0, 7, 1
    s_mov_b32 s38, 0x80
    v_mad_u32_u24 v104, v14, s38, v104
    v_mov_b32 v106, s20
    v_mov_b32 v105, 0x0
    v_bfe_u32 v14, v106, 0, 1
    s_mov_b32 s38, 0x20
    v_mad_u32_u24 v105, v14, s38, v105
    v_bfe_u32 v14, v106, 1, 1
    s_mov_b32 s38, 0x800
    v_mad_u32_u24 v105, v14, s38, v105
    v_bfe_u32 v14, v106, 2, 1
    s_mov_b32 s38, 0x1000
    v_mad_u32_u24 v105, v14, s38, v105
    v_bfe_u32 v14, v106, 3, 1
    s_mov_b32 s38, 0x100
    v_mad_u32_u24 v105, v14, s38, v105
    v_bfe_u32 v14, v106, 4, 1
    s_mov_b32 s38, 0x200
    v_mad_u32_u24 v105, v14, s38, v105
    v_add_u32 v104, v104, v105
    buffer_load_dword v12, v104, s[12:15], 0 offen
    v_mov_b32 v1, 0x4444
    v_bfe_u32 v14, v0, 1, 1
    s_mov_b32 s38, 0xaaaa
    v_mad_u32_u24 v1, v14, s38, v1
    v_mov_b32 v3, 0x0
    v_bfe_u32 v14, v0, 0, 1
    s_mov_b32 s38, 0x10
    v_mad_u32_u24 v3, v14, s38, v3
    v_bfe_u32 v14, v0, 1, 1
    s_mov_b32 s38, 0x20
    v_mad_u32_u24 v3, v14, s38, v3
    v_bfe_u32 v14, v0, 2, 1
    s_mov_b32 s38, 0x40
    v_mad_u32_u24 v3, v14, s38, v3
    v_bfe_u32 v14, v0, 3, 1
    s_mov_b32 s38, 0x80
    v_mad_u32_u24 v3, v14, s38, v3
    v_bfe_u32 v14, v0, 4, 1
    s_mov_b32 s38, 0x100
    v_mad_u32_u24 v3, v14, s38, v3
    v_bfe_u32 v14, v0, 5, 1
    s_mov_b32 s38, 0x200
    v_mad_u32_u24 v3, v14, s38, v3
    v_mov_b32 v2, 0x0
    v_bfe_u32 v14, v0, 0, 1
    s_mov_b32 s38, 0x10
    v_mad_u32_u24 v2, v14, s38, v2
    v_bfe_u32 v14, v0, 1, 1
    s_mov_b32 s38, 0x20
    v_mad_u32_u24 v2, v14, s38, v2
    v_bfe_u32 v14, v0, 2, 1
    s_mov_b32 s38, 0x40
    v_mad_u32_u24 v2, v14, s38, v2
    v_bfe_u32 v14, v0, 3, 1
    s_mov_b32 s38, 0x80
    v_mad_u32_u24 v2, v14, s38, v2
    v_bfe_u32 v14, v0, 4, 1
    s_mov_b32 s38, 0x100
    v_mad_u32_u24 v2, v14, s38, v2
    v_bfe_u32 v14, v0, 5, 1
    s_mov_b32 s38, 0x200
    v_mad_u32_u24 v2, v14, s38, v2
    v_bfe_u32 v14, v0, 6, 1
    s_mov_b32 s38, 0x800
    v_mad_u32_u24 v2, v14, s38, v2
    v_bfe_u32 v14, v0, 7, 1
    s_mov_b32 s38, 0x1000
    v_mad_u32_u24 v2, v14, s38, v2
    v_mov_b32 v4, 0x8000
    v_bfe_u32 v14, v0, 0, 1
    s_mov_b32 s38, 0x10
    v_mad_u32_u24 v4, v14, s38, v4
    v_bfe_u32 v14, v0, 1, 1
    s_mov_b32 s38, 0x20
    v_mad_u32_u24 v4, v14, s38, v4
    v_bfe_u32 v14, v0, 2, 1
    s_mov_b32 s38, 0x40
    v_mad_u32_u24 v4, v14, s38, v4
    v_bfe_u32 v14, v0, 3, 1
    s_mov_b32 s38, 0x80
    v_mad_u32_u24 v4, v14, s38, v4
    v_bfe_u32 v14, v0, 4, 1
    s_mov_b32 s38, 0x100
    v_mad_u32_u24 v4, v14, s38, v4
    v_bfe_u32 v14, v0, 5, 1
    s_mov_b32 s38, 0x200
    v_mad_u32_u24 v4, v14, s38, v4
    v_bfe_u32 v14, v0, 6, 1
    s_mov_b32 s38, 0x8000
    v_mad_u32_u24 v4, v14, s38, v4
    v_bfe_u32 v14, v0, 7, 1
    s_mov_b32 s38, 0x10000
    v_mad_u32_u24 v4, v14, s38, v4
    v_mov_b32 v5, 0x4000
    v_bfe_u32 v14, v0, 0, 1
    s_mov_b32 s38, 0x4
    v_mad_u32_u24 v5, v14, s38, v5
    v_bfe_u32 v14, v0, 1, 1
    s_mov_b32 s38, 0x8
    v_mad_u32_u24 v5, v14, s38, v5
    v_bfe_u32 v14, v0, 2, 1
    s_mov_b32 s38, 0x10
    v_mad_u32_u24 v5, v14, s38, v5
    v_bfe_u32 v14, v0, 3, 1
    s_mov_b32 s38, 0x20
    v_mad_u32_u24 v5, v14, s38, v5
    v_bfe_u32 v14, v0, 4, 1
    s_mov_b32 s38, 0x240
    v_mad_u32_u24 v5, v14, s38, v5
    v_bfe_u32 v14, v0, 5, 1
    s_mov_b32 s38, 0x480
    v_mad_u32_u24 v5, v14, s38, v5
    v_bfe_u32 v14, v0, 6, 1
    s_mov_b32 s38, 0x40
    v_mad_u32_u24 v5, v14, s38, v5
    v_bfe_u32 v14, v0, 7, 1
    s_mov_b32 s38, 0x80
    v_mad_u32_u24 v5, v14, s38, v5
    v_mov_b32 v6, 0x4000
    v_bfe_u32 v14, v0, 0, 1
    s_mov_b32 s38, 0x120
    v_mad_u32_u24 v6, v14, s38, v6
    v_bfe_u32 v14, v0, 2, 1
    s_mov_b32 s38, 0x240
    v_mad_u32_u24 v6, v14, s38, v6
    v_bfe_u32 v14, v0, 3, 1
    s_mov_b32 s38, 0x480
    v_mad_u32_u24 v6, v14, s38, v6
    v_bfe_u32 v14, v0, 4, 1
    s_mov_b32 s38, 0x10
    v_mad_u32_u24 v6, v14, s38, v6
    v_bfe_u32 v14, v0, 5, 1
    s_mov_b32 s38, 0x20
    v_mad_u32_u24 v6, v14, s38, v6
    v_add_u32 v7, 2304, v5
    v_xor_b32 v8, 0x1000, v2
    v_mov_b32 v104, 0x0
    v_bfe_u32 v14, v0, 3, 1
    s_mov_b32 s38, 0x1
    v_mad_u32_u24 v104, v14, s38, v104
    v_bfe_u32 v14, v0, 4, 1
    s_mov_b32 s38, 0x2
    v_mad_u32_u24 v104, v14, s38, v104
    v_bfe_u32 v14, v0, 5, 1
    s_mov_b32 s38, 0x4
    v_mad_u32_u24 v104, v14, s38, v104
    v_bfe_u32 v14, v0, 6, 1
    s_mov_b32 s38, 0x8
    v_mad_u32_u24 v104, v14, s38, v104
    v_bfe_u32 v14, v0, 7, 1
    s_mov_b32 s38, 0x10
    v_mad_u32_u24 v104, v14, s38, v104
    v_add_u32 v104, s20, v104
    v_and_b32 v104, 31, v104
    v_lshlrev_b32 v104, 6, v104
    v_mov_b32 v9, 0x0
    v_bfe_u32 v14, v0, 0, 1
    s_mov_b32 s38, 0x8
    v_mad_u32_u24 v9, v14, s38, v9
    v_bfe_u32 v14, v0, 1, 1
    s_mov_b32 s38, 0x10
    v_mad_u32_u24 v9, v14, s38, v9
    v_bfe_u32 v14, v0, 2, 1
    s_mov_b32 s38, 0x20
    v_mad_u32_u24 v9, v14, s38, v9
    v_bfe_u32 v14, v0, 3, 1
    s_mov_b32 s38, 0x2000
    v_mad_u32_u24 v9, v14, s38, v9
    v_bfe_u32 v14, v0, 4, 1
    s_mov_b32 s38, 0x4000
    v_mad_u32_u24 v9, v14, s38, v9
    v_bfe_u32 v14, v0, 5, 1
    s_mov_b32 s38, 0x8000
    v_mad_u32_u24 v9, v14, s38, v9
    v_bfe_u32 v14, v0, 6, 1
    s_mov_b32 s38, 0x10000
    v_mad_u32_u24 v9, v14, s38, v9
    v_bfe_u32 v14, v0, 7, 1
    s_mov_b32 s38, 0x20000
    v_mad_u32_u24 v9, v14, s38, v9
    v_add_u32 v9, v9, v104
    v_mov_b32 v10, 0x80000
    v_bfe_u32 v14, v0, 0, 1
    s_mov_b32 s38, 0x8
    v_mad_u32_u24 v10, v14, s38, v10
    v_bfe_u32 v14, v0, 1, 1
    s_mov_b32 s38, 0x20
    v_mad_u32_u24 v10, v14, s38, v10
    v_bfe_u32 v14, v0, 4, 1
    s_mov_b32 s38, 0x10
    v_mad_u32_u24 v10, v14, s38, v10
    v_bfe_u32 v14, v0, 5, 1
    s_mov_b32 s38, 0x4
    v_mad_u32_u24 v10, v14, s38, v10
    v_bfe_u32 v14, v0, 6, 1
    s_mov_b32 s38, 0x800
    v_mad_u32_u24 v10, v14, s38, v10
    v_bfe_u32 v14, v0, 7, 1
    s_mov_b32 s38, 0x1000
    v_mad_u32_u24 v10, v14, s38, v10
    v_mov_b32 v105, s20
    v_mov_b32 v104, 0x0
    v_bfe_u32 v14, v105, 0, 1
    s_mov_b32 s38, 0x100
    v_mad_u32_u24 v104, v14, s38, v104
    v_bfe_u32 v14, v105, 1, 1
    s_mov_b32 s38, 0x40
    v_mad_u32_u24 v104, v14, s38, v104
    v_bfe_u32 v14, v105, 2, 1
    s_mov_b32 s38, 0x80
    v_mad_u32_u24 v104, v14, s38, v104
    v_bfe_u32 v14, v105, 3, 1
    s_mov_b32 s38, 0x200
    v_mad_u32_u24 v104, v14, s38, v104
    v_bfe_u32 v14, v105, 4, 1
    s_mov_b32 s38, 0x400
    v_mad_u32_u24 v104, v14, s38, v104
    v_add_u32 v10, v104, v10
    v_and_b32 v104, 12, v0
    v_cmp_ne_u32 vcc, 0, v104
    v_mov_b32 v104, 0x40000000
    s_nop 0
    v_cndmask_b32 v10, v10, v104, vcc
    v_mov_b32 v13, 0x0
    v_bfe_u32 v14, v0, 0, 1
    s_mov_b32 s38, 0x10
    v_mad_u32_u24 v13, v14, s38, v13
    v_bfe_u32 v14, v0, 1, 1
    s_mov_b32 s38, 0x8
    v_mad_u32_u24 v13, v14, s38, v13
    v_bfe_u32 v14, v0, 2, 1
    s_mov_b32 s38, 0x20
    v_mad_u32_u24 v13, v14, s38, v13
    v_bfe_u32 v14, v0, 3, 1
    s_mov_b32 s38, 0x40
    v_mad_u32_u24 v13, v14, s38, v13
    v_bfe_u32 v14, v0, 4, 1
    s_mov_b32 s38, 0x80
    v_mad_u32_u24 v13, v14, s38, v13
    v_bfe_u32 v14, v0, 5, 1
    s_mov_b32 s38, 0x100
    v_mad_u32_u24 v13, v14, s38, v13
    v_bfe_u32 v14, v0, 6, 1
    s_mov_b32 s38, 0x800
    v_mad_u32_u24 v13, v14, s38, v13
    v_bfe_u32 v14, v0, 7, 1
    s_mov_b32 s38, 0x1000
    v_mad_u32_u24 v13, v14, s38, v13
    s_lshl_b32 s6, s20, 13
    s_add_u32 s6, s6, 0x0
    s_mov_b32 s26, 4096
    v_and_b32 v104, 15, v0
    v_mov_b32 v100, 0
    v_mov_b32 v105, 0x3f80
    v_cmp_eq_u32 vcc, 0, v104
    s_nop 1
    v_cndmask_b32 v100, v100, v105, vcc
    v_mov_b32 v105, 0x3f800000
    v_cmp_eq_u32 vcc, 1, v104
    s_nop 1
    v_cndmask_b32 v100, v100, v105, vcc
    v_mov_b32 v101, 0
    v_mov_b32 v105, 0x3f80
    v_cmp_eq_u32 vcc, 4, v104
    s_nop 1
    v_cndmask_b32 v101, v101, v105, vcc
    v_mov_b32 v105, 0x3f800000
    v_cmp_eq_u32 vcc, 5, v104
    s_nop 1
    v_cndmask_b32 v101, v101, v105, vcc
    v_mov_b32 v102, 0
    v_mov_b32 v105, 0x3f80
    v_cmp_eq_u32 vcc, 8, v104
    s_nop 1
    v_cndmask_b32 v102, v102, v105, vcc
    v_mov_b32 v105, 0x3f800000
    v_cmp_eq_u32 vcc, 9, v104
    s_nop 1
    v_cndmask_b32 v102, v102, v105, vcc
    v_mov_b32 v103, 0
    v_mov_b32 v105, 0x3f80
    v_cmp_eq_u32 vcc, 12, v104
    s_nop 1
    v_cndmask_b32 v103, v103, v105, vcc
    v_mov_b32 v105, 0x3f800000
    v_cmp_eq_u32 vcc, 13, v104
    s_nop 1
    v_cndmask_b32 v103, v103, v105, vcc
    ds_write_b128 v3, v[100:103] offset:23040
    s_mov_b32 s34, 0x05040100
    s_mov_b32 s35, 0x07060302
    s_mov_b32 s33, 0x3e0293ee
    s_mov_b32 s40, 0x4e800000
    s_mov_b32 s32, 0
    s_mov_b32 s4, 0x3f803f80
    s_mov_b32 s5, 0x3f803f80
    s_lshl_b32 s36, s20, 14
    s_lshr_b32 s37, s21, 1
    s_lshl_b32 s37, s37, 12
    s_add_u32 s25, s36, s37
    s_lshl_b32 s37, s21, 11
    s_add_u32 s39, s36, s37
    s_add_u32 s39, s39, 8192
    v_mov_b32 v104, 0x0
    v_bfe_u32 v14, v0, 0, 1
    s_mov_b32 s38, 0x80
    v_mad_u32_u24 v104, v14, s38, v104
    v_bfe_u32 v14, v0, 1, 1
    s_mov_b32 s38, 0x100
    v_mad_u32_u24 v104, v14, s38, v104
    v_bfe_u32 v14, v0, 2, 1
    s_mov_b32 s38, 0x200
    v_mad_u32_u24 v104, v14, s38, v104
    v_bfe_u32 v14, v0, 3, 1
    s_mov_b32 s38, 0x400
    v_mad_u32_u24 v104, v14, s38, v104
    v_bfe_u32 v14, v0, 4, 1
    s_mov_b32 s38, 0x800
    v_mad_u32_u24 v104, v14, s38, v104
    v_bfe_u32 v14, v0, 6, 1
    s_mov_b32 s38, 0x1000
    v_mad_u32_u24 v104, v14, s38, v104
    v_bfe_u32 v14, v0, 7, 1
    s_mov_b32 s38, 0x2000
    v_mad_u32_u24 v104, v14, s38, v104
    s_lshl_b32 s36, s20, 14
    v_add_u32 v104, s36, v104
    s_lshl_b32 s36, s20, 8
    s_lshr_b32 s37, s21, 1
    s_lshl_b32 s37, s37, 7
    s_add_u32 s36, s36, s37
    s_add_u32 s36, s36, 0x102100
    v_and_b32 v14, 63, v0
    v_mov_b32 v105, 0x40000000
    v_cmp_lt_u32 vcc, 32, v14
    s_nop 1
    v_cndmask_b32 v104, v104, v105, vcc
    v_mov_b32 v105, s36
    v_cmp_eq_u32 vcc, 32, v14
    s_nop 1
    v_cndmask_b32 v104, v104, v105, vcc
    s_lshl_b32 s36, s20, 2
    s_add_u32 s36, s36, 0x104100
    v_mov_b32 v105, s36
    v_cmp_eq_u32 vcc, 33, v14
    s_nop 1
    v_cndmask_b32 v0, v104, v105, vcc
    s_waitcnt vmcnt(34)
    s_barrier
    ds_read_b64_tr_b16 a[160:161], v20 offset:0
    ds_read_b64_tr_b16 a[162:163], v20 offset:512
    ds_read_b64_tr_b16 a[168:169], v21 offset:0
    ds_read_b64_tr_b16 a[170:171], v21 offset:512
    ds_read_b64_tr_b16 a[192:193], v22 offset:0
    ds_read_b64_tr_b16 a[194:195], v22 offset:512
    ds_read_b64_tr_b16 a[200:201], v23 offset:0
    ds_read_b64_tr_b16 a[202:203], v23 offset:512
    ds_read_b64_tr_b16 a[224:225], v24 offset:0
    ds_read_b64_tr_b16 a[226:227], v24 offset:512
    ds_read_b64_tr_b16 a[232:233], v25 offset:0
    ds_read_b64_tr_b16 a[234:235], v25 offset:512
    s_waitcnt lgkmcnt(4)
    ds_read_b64_tr_b16 v[128:129], v26 offset:0
    ds_read_b64_tr_b16 v[130:131], v26 offset:512
    ds_read_b64_tr_b16 v[136:137], v27 offset:0
    ds_read_b64_tr_b16 v[138:139], v27 offset:512
    s_waitcnt lgkmcnt(0)
    s_barrier
    s_add_u32 m0, s28, 32768
    s_add_u32 s37, s3, 0x300000
    buffer_load_dwordx4 v16, s[60:63], s37 offen lds
    s_add_u32 m0, s28, 36864
    s_add_u32 s37, s3, 0x320000
    buffer_load_dwordx4 v16, s[60:63], s37 offen lds
    s_add_u32 m0, s28, 65536
    s_add_u32 s37, s3, 0x340000
    buffer_load_dwordx4 v16, s[60:63], s37 offen lds
    s_add_u32 m0, s28, 69632
    s_add_u32 s37, s3, 0x360000
    buffer_load_dwordx4 v16, s[60:63], s37 offen lds
    s_add_u32 m0, s28, 98304
    s_add_u32 s37, s3, 0x380000
    buffer_load_dwordx4 v16, s[60:63], s37 offen lds
    s_add_u32 m0, s28, 102400
    s_add_u32 s37, s3, 0x3a0000
    buffer_load_dwordx4 v16, s[60:63], s37 offen lds
    s_add_u32 m0, s28, 131072
    s_add_u32 s37, s3, 0x3c0000
    buffer_load_dwordx4 v16, s[60:63], s37 offen lds
    s_add_u32 m0, s28, 135168
    s_add_u32 s37, s3, 0x3e0000
    buffer_load_dwordx4 v16, s[60:63], s37 offen lds
    s_xor_b32 s36, s21, 2
    s_lshl_b32 s36, s36, 15
    s_add_u32 s36, s36, s29
    s_add_u32 s37, s36, 0x80
    buffer_load_dword v48, v11, s[92:95], s37 offen
    s_add_u32 s37, s36, 0x4080
    buffer_load_dword v49, v11, s[92:95], s37 offen
    s_add_u32 s37, s36, 0x480
    buffer_load_dword v50, v11, s[92:95], s37 offen
    s_add_u32 s37, s36, 0x4480
    buffer_load_dword v51, v11, s[92:95], s37 offen
    s_add_u32 s37, s36, 0x2080
    buffer_load_dword v52, v11, s[92:95], s37 offen
    s_add_u32 s37, s36, 0x6080
    buffer_load_dword v53, v11, s[92:95], s37 offen
    s_add_u32 s37, s36, 0x2480
    buffer_load_dword v54, v11, s[92:95], s37 offen
    s_add_u32 s37, s36, 0x6480
    buffer_load_dword v55, v11, s[92:95], s37 offen
    s_add_u32 s37, s36, 0xc0
    buffer_load_dword v56, v11, s[92:95], s37 offen
    s_add_u32 s37, s36, 0x40c0
    buffer_load_dword v57, v11, s[92:95], s37 offen
    s_add_u32 s37, s36, 0x4c0
    buffer_load_dword v58, v11, s[92:95], s37 offen
    s_add_u32 s37, s36, 0x44c0
    buffer_load_dword v59, v11, s[92:95], s37 offen
    s_add_u32 s37, s36, 0x20c0
    buffer_load_dword v60, v11, s[92:95], s37 offen
    s_add_u32 s37, s36, 0x60c0
    buffer_load_dword v61, v11, s[92:95], s37 offen
    s_add_u32 s37, s36, 0x24c0
    buffer_load_dword v62, v11, s[92:95], s37 offen
    s_add_u32 s37, s36, 0x64c0
    buffer_load_dword v63, v11, s[92:95], s37 offen
    s_waitcnt vmcnt(50)
    s_barrier
    ds_read_b64_tr_b16 a[164:165], v20 offset:8192
    ds_read_b64_tr_b16 a[166:167], v20 offset:8704
    ds_read_b64_tr_b16 a[172:173], v21 offset:8192
    ds_read_b64_tr_b16 a[174:175], v21 offset:8704
    ds_read_b64_tr_b16 a[196:197], v22 offset:8192
    ds_read_b64_tr_b16 a[198:199], v22 offset:8704
    ds_read_b64_tr_b16 a[204:205], v23 offset:8192
    ds_read_b64_tr_b16 a[206:207], v23 offset:8704
    ds_read_b64_tr_b16 a[228:229], v24 offset:8192
    ds_read_b64_tr_b16 a[230:231], v24 offset:8704
    ds_read_b64_tr_b16 a[236:237], v25 offset:8192
    ds_read_b64_tr_b16 a[238:239], v25 offset:8704
    s_waitcnt lgkmcnt(4)
    ds_read_b64_tr_b16 v[132:133], v26 offset:8192
    ds_read_b64_tr_b16 v[134:135], v26 offset:8704
    ds_read_b64_tr_b16 v[140:141], v27 offset:8192
    ds_read_b64_tr_b16 v[142:143], v27 offset:8704
    s_waitcnt lgkmcnt(0)
    s_barrier
    s_mov_b32 s88, s50
    s_and_b32 s89, s51, 0xffff
    s_mov_b32 s90, 0x400000
    s_mov_b32 s91, 0x20000
    s_add_u32 m0, s28, 40960
    s_add_u32 s37, s3, 0x0
    buffer_load_dwordx4 v16, s[88:91], s37 offen lds
    s_add_u32 m0, s28, 45056
    s_add_u32 s37, s3, 0x20000
    buffer_load_dwordx4 v16, s[88:91], s37 offen lds
    s_add_u32 m0, s28, 73728
    s_add_u32 s37, s3, 0x40000
    buffer_load_dwordx4 v16, s[88:91], s37 offen lds
    s_add_u32 m0, s28, 77824
    s_add_u32 s37, s3, 0x60000
    buffer_load_dwordx4 v16, s[88:91], s37 offen lds
    s_add_u32 m0, s28, 106496
    s_add_u32 s37, s3, 0x80000
    buffer_load_dwordx4 v16, s[88:91], s37 offen lds
    s_add_u32 m0, s28, 110592
    s_add_u32 s37, s3, 0xa0000
    buffer_load_dwordx4 v16, s[88:91], s37 offen lds
    s_add_u32 m0, s28, 139264
    s_add_u32 s37, s3, 0xc0000
    buffer_load_dwordx4 v16, s[88:91], s37 offen lds
    s_add_u32 m0, s28, 143360
    s_add_u32 s37, s3, 0xe0000
    buffer_load_dwordx4 v16, s[88:91], s37 offen lds
    s_waitcnt vmcnt(34)
    v_perm_b32 v120, v33, v32, s34
    v_perm_b32 v121, v33, v32, s35
    v_perm_b32 v122, v35, v34, s34
    v_perm_b32 v123, v35, v34, s35
    v_perm_b32 v124, v37, v36, s34
    v_perm_b32 v125, v37, v36, s35
    v_perm_b32 v126, v39, v38, s34
    v_perm_b32 v127, v39, v38, s35
    ds_write_b128 v4, v[120:123] offset:24576
    ds_write_b128 v4, v[124:127] offset:25600
    s_waitcnt lgkmcnt(0)
    v_perm_b32 v120, v41, v40, s34
    v_perm_b32 v121, v41, v40, s35
    v_perm_b32 v122, v43, v42, s34
    v_perm_b32 v123, v43, v42, s35
    v_perm_b32 v124, v45, v44, s34
    v_perm_b32 v125, v45, v44, s35
    v_perm_b32 v126, v47, v46, s34
    v_perm_b32 v127, v47, v46, s35
    ds_write_b128 v4, v[120:123] offset:30720
    ds_write_b128 v4, v[124:127] offset:31744
    s_waitcnt lgkmcnt(0)
    s_xor_b32 s36, s21, 1
    s_lshl_b32 s36, s36, 15
    s_add_u32 s36, s36, s29
    s_add_u32 s37, s36, 0x80
    buffer_load_dword v80, v11, s[92:95], s37 offen
    s_add_u32 s37, s36, 0x4080
    buffer_load_dword v81, v11, s[92:95], s37 offen
    s_add_u32 s37, s36, 0x480
    buffer_load_dword v82, v11, s[92:95], s37 offen
    s_add_u32 s37, s36, 0x4480
    buffer_load_dword v83, v11, s[92:95], s37 offen
    s_add_u32 s37, s36, 0x2080
    buffer_load_dword v84, v11, s[92:95], s37 offen
    s_add_u32 s37, s36, 0x6080
    buffer_load_dword v85, v11, s[92:95], s37 offen
    s_add_u32 s37, s36, 0x2480
    buffer_load_dword v86, v11, s[92:95], s37 offen
    s_add_u32 s37, s36, 0x6480
    buffer_load_dword v87, v11, s[92:95], s37 offen
    s_add_u32 s37, s36, 0xc0
    buffer_load_dword v88, v11, s[92:95], s37 offen
    s_add_u32 s37, s36, 0x40c0
    buffer_load_dword v89, v11, s[92:95], s37 offen
    s_add_u32 s37, s36, 0x4c0
    buffer_load_dword v90, v11, s[92:95], s37 offen
    s_add_u32 s37, s36, 0x44c0
    buffer_load_dword v91, v11, s[92:95], s37 offen
    s_add_u32 s37, s36, 0x20c0
    buffer_load_dword v92, v11, s[92:95], s37 offen
    s_add_u32 s37, s36, 0x60c0
    buffer_load_dword v93, v11, s[92:95], s37 offen
    s_add_u32 s37, s36, 0x24c0
    buffer_load_dword v94, v11, s[92:95], s37 offen
    s_add_u32 s37, s36, 0x64c0
    buffer_load_dword v95, v11, s[92:95], s37 offen
    s_barrier
    ds_read_b64_tr_b16 a[176:177], v20 offset:16384
    ds_read_b64_tr_b16 a[178:179], v20 offset:16896
    ds_read_b64_tr_b16 a[184:185], v21 offset:16384
    ds_read_b64_tr_b16 a[186:187], v21 offset:16896
    ds_read_b64_tr_b16 a[208:209], v22 offset:16384
    ds_read_b64_tr_b16 a[210:211], v22 offset:16896
    ds_read_b64_tr_b16 a[216:217], v23 offset:16384
    ds_read_b64_tr_b16 a[218:219], v23 offset:16896
    ds_read_b64_tr_b16 a[240:241], v24 offset:16384
    ds_read_b64_tr_b16 a[242:243], v24 offset:16896
    ds_read_b64_tr_b16 a[248:249], v25 offset:16384
    ds_read_b64_tr_b16 a[250:251], v25 offset:16896
    s_waitcnt lgkmcnt(4)
    ds_read_b64_tr_b16 v[144:145], v26 offset:16384
    ds_read_b64_tr_b16 v[146:147], v26 offset:16896
    ds_read_b64_tr_b16 v[152:153], v27 offset:16384
    ds_read_b64_tr_b16 v[154:155], v27 offset:16896
    s_waitcnt lgkmcnt(0)
    s_barrier
    s_add_u32 m0, s28, 49152
    s_add_u32 s37, s3, 0x100000
    buffer_load_dwordx4 v16, s[88:91], s37 offen lds
    s_add_u32 m0, s28, 53248
    s_add_u32 s37, s3, 0x120000
    buffer_load_dwordx4 v16, s[88:91], s37 offen lds
    s_add_u32 m0, s28, 81920
    s_add_u32 s37, s3, 0x140000
    buffer_load_dwordx4 v16, s[88:91], s37 offen lds
    s_add_u32 m0, s28, 86016
    s_add_u32 s37, s3, 0x160000
    buffer_load_dwordx4 v16, s[88:91], s37 offen lds
    s_add_u32 m0, s28, 114688
    s_add_u32 s37, s3, 0x180000
    buffer_load_dwordx4 v16, s[88:91], s37 offen lds
    s_add_u32 m0, s28, 118784
    s_add_u32 s37, s3, 0x1a0000
    buffer_load_dwordx4 v16, s[88:91], s37 offen lds
    s_add_u32 m0, s28, 147456
    s_add_u32 s37, s3, 0x1c0000
    buffer_load_dwordx4 v16, s[88:91], s37 offen lds
    s_add_u32 m0, s28, 151552
    s_add_u32 s37, s3, 0x1e0000
    buffer_load_dwordx4 v16, s[88:91], s37 offen lds
    s_waitcnt vmcnt(32)
    v_perm_b32 v232, v49, v48, s34
    v_perm_b32 v233, v49, v48, s35
    v_perm_b32 v234, v51, v50, s34
    v_perm_b32 v235, v51, v50, s35
    v_perm_b32 v236, v53, v52, s34
    v_perm_b32 v237, v53, v52, s35
    v_perm_b32 v238, v55, v54, s34
    v_perm_b32 v239, v55, v54, s35
    v_perm_b32 v120, v57, v56, s34
    v_perm_b32 v121, v57, v56, s35
    v_perm_b32 v122, v59, v58, s34
    v_perm_b32 v123, v59, v58, s35
    v_perm_b32 v124, v61, v60, s34
    v_perm_b32 v125, v61, v60, s35
    v_perm_b32 v126, v63, v62, s34
    v_perm_b32 v127, v63, v62, s35
    ds_write_b128 v4, v[120:123] offset:28672
    ds_write_b128 v4, v[124:127] offset:29696
    s_waitcnt lgkmcnt(0)
    s_xor_b32 s36, s21, 3
    s_lshl_b32 s36, s36, 15
    s_add_u32 s36, s36, s29
    s_add_u32 s37, s36, 0x0
    buffer_load_dword v32, v11, s[92:95], s37 offen
    s_add_u32 s37, s36, 0x4000
    buffer_load_dword v33, v11, s[92:95], s37 offen
    s_add_u32 s37, s36, 0x400
    buffer_load_dword v34, v11, s[92:95], s37 offen
    s_add_u32 s37, s36, 0x4400
    buffer_load_dword v35, v11, s[92:95], s37 offen
    s_add_u32 s37, s36, 0x2000
    buffer_load_dword v36, v11, s[92:95], s37 offen
    s_add_u32 s37, s36, 0x6000
    buffer_load_dword v37, v11, s[92:95], s37 offen
    s_add_u32 s37, s36, 0x2400
    buffer_load_dword v38, v11, s[92:95], s37 offen
    s_add_u32 s37, s36, 0x6400
    buffer_load_dword v39, v11, s[92:95], s37 offen
    s_add_u32 s37, s36, 0x40
    buffer_load_dword v40, v11, s[92:95], s37 offen
    s_add_u32 s37, s36, 0x4040
    buffer_load_dword v41, v11, s[92:95], s37 offen
    s_add_u32 s37, s36, 0x440
    buffer_load_dword v42, v11, s[92:95], s37 offen
    s_add_u32 s37, s36, 0x4440
    buffer_load_dword v43, v11, s[92:95], s37 offen
    s_add_u32 s37, s36, 0x2040
    buffer_load_dword v44, v11, s[92:95], s37 offen
    s_add_u32 s37, s36, 0x6040
    buffer_load_dword v45, v11, s[92:95], s37 offen
    s_add_u32 s37, s36, 0x2440
    buffer_load_dword v46, v11, s[92:95], s37 offen
    s_add_u32 s37, s36, 0x6440
    buffer_load_dword v47, v11, s[92:95], s37 offen
    s_barrier
    ds_read_b64_tr_b16 a[180:181], v20 offset:0
    ds_read_b64_tr_b16 a[182:183], v20 offset:512
    ds_read_b64_tr_b16 a[188:189], v21 offset:0
    ds_read_b64_tr_b16 a[190:191], v21 offset:512
    ds_read_b64_tr_b16 a[212:213], v22 offset:0
    ds_read_b64_tr_b16 a[214:215], v22 offset:512
    ds_read_b64_tr_b16 a[220:221], v23 offset:0
    ds_read_b64_tr_b16 a[222:223], v23 offset:512
    ds_read_b64_tr_b16 a[244:245], v24 offset:0
    ds_read_b64_tr_b16 a[246:247], v24 offset:512
    ds_read_b64_tr_b16 a[252:253], v25 offset:0
    ds_read_b64_tr_b16 a[254:255], v25 offset:512
    s_waitcnt lgkmcnt(4)
    ds_read_b64_tr_b16 v[148:149], v26 offset:0
    ds_read_b64_tr_b16 v[150:151], v26 offset:512
    ds_read_b64_tr_b16 v[156:157], v27 offset:0
    ds_read_b64_tr_b16 v[158:159], v27 offset:512
    s_waitcnt lgkmcnt(0)
    s_barrier
    s_add_u32 m0, s28, 32768
    s_add_u32 s37, s3, 0x200000
    buffer_load_dwordx4 v16, s[88:91], s37 offen lds
    s_add_u32 m0, s28, 36864
    s_add_u32 s37, s3, 0x220000
    buffer_load_dwordx4 v16, s[88:91], s37 offen lds
    s_add_u32 m0, s28, 65536
    s_add_u32 s37, s3, 0x240000
    buffer_load_dwordx4 v16, s[88:91], s37 offen lds
    s_add_u32 m0, s28, 69632
    s_add_u32 s37, s3, 0x260000
    buffer_load_dwordx4 v16, s[88:91], s37 offen lds
    s_add_u32 m0, s28, 98304
    s_add_u32 s37, s3, 0x280000
    buffer_load_dwordx4 v16, s[88:91], s37 offen lds
    s_add_u32 m0, s28, 102400
    s_add_u32 s37, s3, 0x2a0000
    buffer_load_dwordx4 v16, s[88:91], s37 offen lds
    s_add_u32 m0, s28, 131072
    s_add_u32 s37, s3, 0x2c0000
    buffer_load_dwordx4 v16, s[88:91], s37 offen lds
    s_add_u32 m0, s28, 135168
    s_add_u32 s37, s3, 0x2e0000
    buffer_load_dwordx4 v16, s[88:91], s37 offen lds
    s_waitcnt vmcnt(32)
    v_perm_b32 v208, v81, v80, s34
    v_perm_b32 v209, v81, v80, s35
    v_perm_b32 v210, v83, v82, s34
    v_perm_b32 v211, v83, v82, s35
    v_perm_b32 v212, v85, v84, s34
    v_perm_b32 v213, v85, v84, s35
    v_perm_b32 v214, v87, v86, s34
    v_perm_b32 v215, v87, v86, s35
    v_perm_b32 v120, v89, v88, s34
    v_perm_b32 v121, v89, v88, s35
    v_perm_b32 v122, v91, v90, s34
    v_perm_b32 v123, v91, v90, s35
    v_perm_b32 v124, v93, v92, s34
    v_perm_b32 v125, v93, v92, s35
    v_perm_b32 v126, v95, v94, s34
    v_perm_b32 v127, v95, v94, s35
    ds_write_b128 v4, v[120:123] offset:26624
    ds_write_b128 v4, v[124:127] offset:27648
    s_waitcnt lgkmcnt(0)
    s_xor_b32 s36, s21, 2
    s_lshl_b32 s36, s36, 15
    s_add_u32 s36, s36, s29
    s_add_u32 s37, s36, 0x0
    buffer_load_dword v48, v11, s[92:95], s37 offen
    s_add_u32 s37, s36, 0x4000
    buffer_load_dword v49, v11, s[92:95], s37 offen
    s_add_u32 s37, s36, 0x400
    buffer_load_dword v50, v11, s[92:95], s37 offen
    s_add_u32 s37, s36, 0x4400
    buffer_load_dword v51, v11, s[92:95], s37 offen
    s_add_u32 s37, s36, 0x2000
    buffer_load_dword v52, v11, s[92:95], s37 offen
    s_add_u32 s37, s36, 0x6000
    buffer_load_dword v53, v11, s[92:95], s37 offen
    s_add_u32 s37, s36, 0x2400
    buffer_load_dword v54, v11, s[92:95], s37 offen
    s_add_u32 s37, s36, 0x6400
    buffer_load_dword v55, v11, s[92:95], s37 offen
    s_add_u32 s37, s36, 0x40
    buffer_load_dword v56, v11, s[92:95], s37 offen
    s_add_u32 s37, s36, 0x4040
    buffer_load_dword v57, v11, s[92:95], s37 offen
    s_add_u32 s37, s36, 0x440
    buffer_load_dword v58, v11, s[92:95], s37 offen
    s_add_u32 s37, s36, 0x4440
    buffer_load_dword v59, v11, s[92:95], s37 offen
    s_add_u32 s37, s36, 0x2040
    buffer_load_dword v60, v11, s[92:95], s37 offen
    s_add_u32 s37, s36, 0x6040
    buffer_load_dword v61, v11, s[92:95], s37 offen
    s_add_u32 s37, s36, 0x2440
    buffer_load_dword v62, v11, s[92:95], s37 offen
    s_add_u32 s37, s36, 0x6440
    buffer_load_dword v63, v11, s[92:95], s37 offen
    s_barrier
    ds_read_b64_tr_b16 v[64:65], v20 offset:8192
    ds_read_b64_tr_b16 v[66:67], v20 offset:8704
    ds_read_b64_tr_b16 v[72:73], v21 offset:8192
    ds_read_b64_tr_b16 v[74:75], v21 offset:8704
    ds_read_b64_tr_b16 v[96:97], v22 offset:8192
    ds_read_b64_tr_b16 v[98:99], v22 offset:8704
    ds_read_b64_tr_b16 v[104:105], v23 offset:8192
    ds_read_b64_tr_b16 v[106:107], v23 offset:8704
    ds_read_b64_tr_b16 a[112:113], v24 offset:8192
    ds_read_b64_tr_b16 a[114:115], v24 offset:8704
    ds_read_b64_tr_b16 a[120:121], v25 offset:8192
    ds_read_b64_tr_b16 a[122:123], v25 offset:8704
    s_waitcnt lgkmcnt(4)
    ds_read_b64_tr_b16 a[144:145], v26 offset:8192
    ds_read_b64_tr_b16 a[146:147], v26 offset:8704
    ds_read_b64_tr_b16 a[152:153], v27 offset:8192
    ds_read_b64_tr_b16 a[154:155], v27 offset:8704
    s_waitcnt lgkmcnt(0)
    s_barrier
    s_add_u32 m0, s28, 40960
    s_add_u32 s37, s3, 0x300000
    buffer_load_dwordx4 v16, s[88:91], s37 offen lds
    s_add_u32 m0, s28, 45056
    s_add_u32 s37, s3, 0x320000
    buffer_load_dwordx4 v16, s[88:91], s37 offen lds
    s_add_u32 m0, s28, 73728
    s_add_u32 s37, s3, 0x340000
    buffer_load_dwordx4 v16, s[88:91], s37 offen lds
    s_add_u32 m0, s28, 77824
    s_add_u32 s37, s3, 0x360000
    buffer_load_dwordx4 v16, s[88:91], s37 offen lds
    s_add_u32 m0, s28, 106496
    s_add_u32 s37, s3, 0x380000
    buffer_load_dwordx4 v16, s[88:91], s37 offen lds
    s_add_u32 m0, s28, 110592
    s_add_u32 s37, s3, 0x3a0000
    buffer_load_dwordx4 v16, s[88:91], s37 offen lds
    s_add_u32 m0, s28, 139264
    s_add_u32 s37, s3, 0x3c0000
    buffer_load_dwordx4 v16, s[88:91], s37 offen lds
    s_add_u32 m0, s28, 143360
    s_add_u32 s37, s3, 0x3e0000
    buffer_load_dwordx4 v16, s[88:91], s37 offen lds
    s_waitcnt vmcnt(32)
    v_perm_b32 v240, v33, v32, s34
    v_perm_b32 v241, v33, v32, s35
    v_perm_b32 v242, v35, v34, s34
    v_perm_b32 v243, v35, v34, s35
    v_perm_b32 v244, v37, v36, s34
    v_perm_b32 v245, v37, v36, s35
    v_perm_b32 v246, v39, v38, s34
    v_perm_b32 v247, v39, v38, s35
    v_perm_b32 v248, v41, v40, s34
    v_perm_b32 v249, v41, v40, s35
    v_perm_b32 v250, v43, v42, s34
    v_perm_b32 v251, v43, v42, s35
    v_perm_b32 v252, v45, v44, s34
    v_perm_b32 v253, v45, v44, s35
    v_perm_b32 v254, v47, v46, s34
    v_perm_b32 v255, v47, v46, s35
    s_xor_b32 s36, s21, 1
    s_lshl_b32 s36, s36, 15
    s_add_u32 s36, s36, s29
    s_add_u32 s37, s36, 0x0
    buffer_load_dword v80, v11, s[92:95], s37 offen
    s_add_u32 s37, s36, 0x4000
    buffer_load_dword v81, v11, s[92:95], s37 offen
    s_add_u32 s37, s36, 0x400
    buffer_load_dword v82, v11, s[92:95], s37 offen
    s_add_u32 s37, s36, 0x4400
    buffer_load_dword v83, v11, s[92:95], s37 offen
    s_add_u32 s37, s36, 0x2000
    buffer_load_dword v84, v11, s[92:95], s37 offen
    s_add_u32 s37, s36, 0x6000
    buffer_load_dword v85, v11, s[92:95], s37 offen
    s_add_u32 s37, s36, 0x2400
    buffer_load_dword v86, v11, s[92:95], s37 offen
    s_add_u32 s37, s36, 0x6400
    buffer_load_dword v87, v11, s[92:95], s37 offen
    s_add_u32 s37, s36, 0x40
    buffer_load_dword v88, v11, s[92:95], s37 offen
    s_add_u32 s37, s36, 0x4040
    buffer_load_dword v89, v11, s[92:95], s37 offen
    s_add_u32 s37, s36, 0x440
    buffer_load_dword v90, v11, s[92:95], s37 offen
    s_add_u32 s37, s36, 0x4440
    buffer_load_dword v91, v11, s[92:95], s37 offen
    s_add_u32 s37, s36, 0x2040
    buffer_load_dword v92, v11, s[92:95], s37 offen
    s_add_u32 s37, s36, 0x6040
    buffer_load_dword v93, v11, s[92:95], s37 offen
    s_add_u32 s37, s36, 0x2440
    buffer_load_dword v94, v11, s[92:95], s37 offen
    s_add_u32 s37, s36, 0x6440
    buffer_load_dword v95, v11, s[92:95], s37 offen
    s_barrier
    ds_read_b64_tr_b16 v[68:69], v20 offset:16384
    ds_read_b64_tr_b16 v[70:71], v20 offset:16896
    ds_read_b64_tr_b16 v[76:77], v21 offset:16384
    ds_read_b64_tr_b16 v[78:79], v21 offset:16896
    ds_read_b64_tr_b16 v[100:101], v22 offset:16384
    ds_read_b64_tr_b16 v[102:103], v22 offset:16896
    ds_read_b64_tr_b16 v[108:109], v23 offset:16384
    ds_read_b64_tr_b16 v[110:111], v23 offset:16896
    ds_read_b64_tr_b16 a[116:117], v24 offset:16384
    ds_read_b64_tr_b16 a[118:119], v24 offset:16896
    ds_read_b64_tr_b16 a[124:125], v25 offset:16384
    ds_read_b64_tr_b16 a[126:127], v25 offset:16896
    s_waitcnt lgkmcnt(4)
    ds_read_b64_tr_b16 a[148:149], v26 offset:16384
    ds_read_b64_tr_b16 a[150:151], v26 offset:16896
    ds_read_b64_tr_b16 a[156:157], v27 offset:16384
    ds_read_b64_tr_b16 a[158:159], v27 offset:16896
    s_waitcnt lgkmcnt(0)
    s_barrier
    s_mov_b32 s96, s48
    s_and_b32 s97, s49, 0xffff
    s_mov_b32 s98, 0x400000
    s_mov_b32 s99, 0x20000
    s_add_u32 m0, s28, 49152
    s_add_u32 s37, s3, 0x0
    buffer_load_dwordx4 v16, s[96:99], s37 offen lds
    s_add_u32 m0, s28, 53248
    s_add_u32 s37, s3, 0x20000
    buffer_load_dwordx4 v16, s[96:99], s37 offen lds
    s_add_u32 m0, s28, 81920
    s_add_u32 s37, s3, 0x40000
    buffer_load_dwordx4 v16, s[96:99], s37 offen lds
    s_add_u32 m0, s28, 86016
    s_add_u32 s37, s3, 0x60000
    buffer_load_dwordx4 v16, s[96:99], s37 offen lds
    s_add_u32 m0, s28, 114688
    s_add_u32 s37, s3, 0x80000
    buffer_load_dwordx4 v16, s[96:99], s37 offen lds
    s_add_u32 m0, s28, 118784
    s_add_u32 s37, s3, 0xa0000
    buffer_load_dwordx4 v16, s[96:99], s37 offen lds
    s_add_u32 m0, s28, 147456
    s_add_u32 s37, s3, 0xc0000
    buffer_load_dwordx4 v16, s[96:99], s37 offen lds
    s_add_u32 m0, s28, 151552
    s_add_u32 s37, s3, 0xe0000
    buffer_load_dwordx4 v16, s[96:99], s37 offen lds
    s_waitcnt vmcnt(32)
    v_perm_b32 v216, v49, v48, s34
    v_perm_b32 v217, v49, v48, s35
    v_perm_b32 v218, v51, v50, s34
    v_perm_b32 v219, v51, v50, s35
    v_perm_b32 v220, v53, v52, s34
    v_perm_b32 v221, v53, v52, s35
    v_perm_b32 v222, v55, v54, s34
    v_perm_b32 v223, v55, v54, s35
    v_perm_b32 v224, v57, v56, s34
    v_perm_b32 v225, v57, v56, s35
    v_perm_b32 v226, v59, v58, s34
    v_perm_b32 v227, v59, v58, s35
    v_perm_b32 v228, v61, v60, s34
    v_perm_b32 v229, v61, v60, s35
    v_perm_b32 v230, v63, v62, s34
    v_perm_b32 v231, v63, v62, s35
    s_xor_b32 s36, s21, 0
    s_lshl_b32 s36, s36, 15
    s_add_u32 s36, s36, s29
    s_add_u32 s37, s36, 0x80
    buffer_load_dword v32, v11, s[92:95], s37 offen
    s_add_u32 s37, s36, 0x4080
    buffer_load_dword v33, v11, s[92:95], s37 offen
    s_add_u32 s37, s36, 0x480
    buffer_load_dword v34, v11, s[92:95], s37 offen
    s_add_u32 s37, s36, 0x4480
    buffer_load_dword v35, v11, s[92:95], s37 offen
    s_add_u32 s37, s36, 0x2080
    buffer_load_dword v36, v11, s[92:95], s37 offen
    s_add_u32 s37, s36, 0x6080
    buffer_load_dword v37, v11, s[92:95], s37 offen
    s_add_u32 s37, s36, 0x2480
    buffer_load_dword v38, v11, s[92:95], s37 offen
    s_add_u32 s37, s36, 0x6480
    buffer_load_dword v39, v11, s[92:95], s37 offen
    s_add_u32 s37, s36, 0xc0
    buffer_load_dword v40, v11, s[92:95], s37 offen
    s_add_u32 s37, s36, 0x40c0
    buffer_load_dword v41, v11, s[92:95], s37 offen
    s_add_u32 s37, s36, 0x4c0
    buffer_load_dword v42, v11, s[92:95], s37 offen
    s_add_u32 s37, s36, 0x44c0
    buffer_load_dword v43, v11, s[92:95], s37 offen
    s_add_u32 s37, s36, 0x20c0
    buffer_load_dword v44, v11, s[92:95], s37 offen
    s_add_u32 s37, s36, 0x60c0
    buffer_load_dword v45, v11, s[92:95], s37 offen
    s_add_u32 s37, s36, 0x24c0
    buffer_load_dword v46, v11, s[92:95], s37 offen
    s_add_u32 s37, s36, 0x64c0
    buffer_load_dword v47, v11, s[92:95], s37 offen
    s_barrier
    ds_read_b64_tr_b16 a[80:81], v20 offset:0
    ds_read_b64_tr_b16 a[82:83], v20 offset:512
    ds_read_b64_tr_b16 a[88:89], v21 offset:0
    ds_read_b64_tr_b16 a[90:91], v21 offset:512
    ds_read_b64_tr_b16 a[96:97], v22 offset:0
    ds_read_b64_tr_b16 a[98:99], v22 offset:512
    ds_read_b64_tr_b16 a[104:105], v23 offset:0
    ds_read_b64_tr_b16 a[106:107], v23 offset:512
    ds_read_b64_tr_b16 a[128:129], v24 offset:0
    ds_read_b64_tr_b16 a[130:131], v24 offset:512
    ds_read_b64_tr_b16 a[136:137], v25 offset:0
    ds_read_b64_tr_b16 a[138:139], v25 offset:512
    s_waitcnt lgkmcnt(4)
    ds_read_b64_tr_b16 v[112:113], v26 offset:0
    ds_read_b64_tr_b16 v[114:115], v26 offset:512
    ds_read_b64_tr_b16 v[120:121], v27 offset:0
    ds_read_b64_tr_b16 v[122:123], v27 offset:512
    s_waitcnt lgkmcnt(0)
    s_barrier
    s_add_u32 m0, s28, 32768
    s_add_u32 s37, s3, 0x100000
    buffer_load_dwordx4 v16, s[96:99], s37 offen lds
    s_add_u32 m0, s28, 36864
    s_add_u32 s37, s3, 0x120000
    buffer_load_dwordx4 v16, s[96:99], s37 offen lds
    s_add_u32 m0, s28, 65536
    s_add_u32 s37, s3, 0x140000
    buffer_load_dwordx4 v16, s[96:99], s37 offen lds
    s_add_u32 m0, s28, 69632
    s_add_u32 s37, s3, 0x160000
    buffer_load_dwordx4 v16, s[96:99], s37 offen lds
    s_add_u32 m0, s28, 98304
    s_add_u32 s37, s3, 0x180000
    buffer_load_dwordx4 v16, s[96:99], s37 offen lds
    s_add_u32 m0, s28, 102400
    s_add_u32 s37, s3, 0x1a0000
    buffer_load_dwordx4 v16, s[96:99], s37 offen lds
    s_add_u32 m0, s28, 131072
    s_add_u32 s37, s3, 0x1c0000
    buffer_load_dwordx4 v16, s[96:99], s37 offen lds
    s_add_u32 m0, s28, 135168
    s_add_u32 s37, s3, 0x1e0000
    buffer_load_dwordx4 v16, s[96:99], s37 offen lds
    s_waitcnt vmcnt(32)
    v_perm_b32 v192, v81, v80, s34
    v_perm_b32 v193, v81, v80, s35
    v_perm_b32 v194, v83, v82, s34
    v_perm_b32 v195, v83, v82, s35
    v_perm_b32 v196, v85, v84, s34
    v_perm_b32 v197, v85, v84, s35
    v_perm_b32 v198, v87, v86, s34
    v_perm_b32 v199, v87, v86, s35
    v_perm_b32 v200, v89, v88, s34
    v_perm_b32 v201, v89, v88, s35
    v_perm_b32 v202, v91, v90, s34
    v_perm_b32 v203, v91, v90, s35
    v_perm_b32 v204, v93, v92, s34
    v_perm_b32 v205, v93, v92, s35
    v_perm_b32 v206, v95, v94, s34
    v_perm_b32 v207, v95, v94, s35
    s_xor_b32 s36, s21, 0
    s_lshl_b32 s36, s36, 15
    s_add_u32 s36, s36, s29
    s_add_u32 s37, s36, 0x0
    buffer_load_dword v48, v11, s[92:95], s37 offen
    s_add_u32 s37, s36, 0x4000
    buffer_load_dword v49, v11, s[92:95], s37 offen
    s_add_u32 s37, s36, 0x400
    buffer_load_dword v50, v11, s[92:95], s37 offen
    s_add_u32 s37, s36, 0x4400
    buffer_load_dword v51, v11, s[92:95], s37 offen
    s_add_u32 s37, s36, 0x2000
    buffer_load_dword v52, v11, s[92:95], s37 offen
    s_add_u32 s37, s36, 0x6000
    buffer_load_dword v53, v11, s[92:95], s37 offen
    s_add_u32 s37, s36, 0x2400
    buffer_load_dword v54, v11, s[92:95], s37 offen
    s_add_u32 s37, s36, 0x6400
    buffer_load_dword v55, v11, s[92:95], s37 offen
    s_add_u32 s37, s36, 0x40
    buffer_load_dword v56, v11, s[92:95], s37 offen
    s_add_u32 s37, s36, 0x4040
    buffer_load_dword v57, v11, s[92:95], s37 offen
    s_add_u32 s37, s36, 0x440
    buffer_load_dword v58, v11, s[92:95], s37 offen
    s_add_u32 s37, s36, 0x4440
    buffer_load_dword v59, v11, s[92:95], s37 offen
    s_add_u32 s37, s36, 0x2040
    buffer_load_dword v60, v11, s[92:95], s37 offen
    s_add_u32 s37, s36, 0x6040
    buffer_load_dword v61, v11, s[92:95], s37 offen
    s_add_u32 s37, s36, 0x2440
    buffer_load_dword v62, v11, s[92:95], s37 offen
    s_add_u32 s37, s36, 0x6440
    buffer_load_dword v63, v11, s[92:95], s37 offen
    s_barrier
    ds_read_b64_tr_b16 a[84:85], v20 offset:8192
    ds_read_b64_tr_b16 a[86:87], v20 offset:8704
    ds_read_b64_tr_b16 a[92:93], v21 offset:8192
    ds_read_b64_tr_b16 a[94:95], v21 offset:8704
    ds_read_b64_tr_b16 a[100:101], v22 offset:8192
    ds_read_b64_tr_b16 a[102:103], v22 offset:8704
    ds_read_b64_tr_b16 a[108:109], v23 offset:8192
    ds_read_b64_tr_b16 a[110:111], v23 offset:8704
    ds_read_b64_tr_b16 a[132:133], v24 offset:8192
    ds_read_b64_tr_b16 a[134:135], v24 offset:8704
    ds_read_b64_tr_b16 a[140:141], v25 offset:8192
    ds_read_b64_tr_b16 a[142:143], v25 offset:8704
    s_waitcnt lgkmcnt(4)
    ds_read_b64_tr_b16 v[116:117], v26 offset:8192
    ds_read_b64_tr_b16 v[118:119], v26 offset:8704
    ds_read_b64_tr_b16 v[124:125], v27 offset:8192
    ds_read_b64_tr_b16 v[126:127], v27 offset:8704
    s_waitcnt lgkmcnt(0)
    s_barrier
    s_add_u32 m0, s28, 40960
    s_add_u32 s37, s3, 0x200000
    buffer_load_dwordx4 v16, s[96:99], s37 offen lds
    s_add_u32 m0, s28, 45056
    s_add_u32 s37, s3, 0x220000
    buffer_load_dwordx4 v16, s[96:99], s37 offen lds
    s_add_u32 m0, s28, 73728
    s_add_u32 s37, s3, 0x240000
    buffer_load_dwordx4 v16, s[96:99], s37 offen lds
    s_add_u32 m0, s28, 77824
    s_add_u32 s37, s3, 0x260000
    buffer_load_dwordx4 v16, s[96:99], s37 offen lds
    s_add_u32 m0, s28, 106496
    s_add_u32 s37, s3, 0x280000
    buffer_load_dwordx4 v16, s[96:99], s37 offen lds
    s_add_u32 m0, s28, 110592
    s_add_u32 s37, s3, 0x2a0000
    buffer_load_dwordx4 v16, s[96:99], s37 offen lds
    s_add_u32 m0, s28, 139264
    s_add_u32 s37, s3, 0x2c0000
    buffer_load_dwordx4 v16, s[96:99], s37 offen lds
    s_add_u32 m0, s28, 143360
    s_add_u32 s37, s3, 0x2e0000
    buffer_load_dwordx4 v16, s[96:99], s37 offen lds
    s_waitcnt vmcnt(32)
    v_perm_b32 v176, v33, v32, s34
    v_perm_b32 v177, v33, v32, s35
    v_perm_b32 v178, v35, v34, s34
    v_perm_b32 v179, v35, v34, s35
    v_perm_b32 v180, v37, v36, s34
    v_perm_b32 v181, v37, v36, s35
    v_perm_b32 v182, v39, v38, s34
    v_perm_b32 v183, v39, v38, s35
    v_perm_b32 v184, v41, v40, s34
    v_perm_b32 v185, v41, v40, s35
    v_perm_b32 v186, v43, v42, s34
    v_perm_b32 v187, v43, v42, s35
    v_perm_b32 v188, v45, v44, s34
    v_perm_b32 v189, v45, v44, s35
    v_perm_b32 v190, v47, v46, s34
    v_perm_b32 v191, v47, v46, s35
    v_lshrrev_b32 v31, 2, v3
    buffer_load_dword v30, v31, s[16:19], 0 offen sc1
    s_barrier
    ds_read_b64_tr_b16 v[32:33], v20 offset:16384
    ds_read_b64_tr_b16 v[34:35], v20 offset:16896
    ds_read_b64_tr_b16 v[40:41], v21 offset:16384
    ds_read_b64_tr_b16 v[42:43], v21 offset:16896
    ds_read_b64_tr_b16 a[0:1], v22 offset:16384
    ds_read_b64_tr_b16 a[2:3], v22 offset:16896
    ds_read_b64_tr_b16 a[8:9], v23 offset:16384
    ds_read_b64_tr_b16 a[10:11], v23 offset:16896
    ds_read_b64_tr_b16 a[32:33], v24 offset:16384
    ds_read_b64_tr_b16 a[34:35], v24 offset:16896
    ds_read_b64_tr_b16 a[40:41], v25 offset:16384
    ds_read_b64_tr_b16 a[42:43], v25 offset:16896
    s_waitcnt lgkmcnt(4)
    ds_read_b64_tr_b16 a[64:65], v26 offset:16384
    ds_read_b64_tr_b16 a[66:67], v26 offset:16896
    ds_read_b64_tr_b16 a[72:73], v27 offset:16384
    ds_read_b64_tr_b16 a[74:75], v27 offset:16896
    s_waitcnt lgkmcnt(0)
    s_barrier
    s_add_u32 m0, s28, 49152
    s_add_u32 s37, s3, 0x300000
    buffer_load_dwordx4 v16, s[96:99], s37 offen lds
    s_add_u32 m0, s28, 53248
    s_add_u32 s37, s3, 0x320000
    buffer_load_dwordx4 v16, s[96:99], s37 offen lds
    s_add_u32 m0, s28, 81920
    s_add_u32 s37, s3, 0x340000
    buffer_load_dwordx4 v16, s[96:99], s37 offen lds
    s_add_u32 m0, s28, 86016
    s_add_u32 s37, s3, 0x360000
    buffer_load_dwordx4 v16, s[96:99], s37 offen lds
    s_add_u32 m0, s28, 114688
    s_add_u32 s37, s3, 0x380000
    buffer_load_dwordx4 v16, s[96:99], s37 offen lds
    s_add_u32 m0, s28, 118784
    s_add_u32 s37, s3, 0x3a0000
    buffer_load_dwordx4 v16, s[96:99], s37 offen lds
    s_add_u32 m0, s28, 147456
    s_add_u32 s37, s3, 0x3c0000
    buffer_load_dwordx4 v16, s[96:99], s37 offen lds
    s_add_u32 m0, s28, 151552
    s_add_u32 s37, s3, 0x3e0000
    buffer_load_dwordx4 v16, s[96:99], s37 offen lds
    s_waitcnt vmcnt(17)
    v_perm_b32 v160, v49, v48, s34
    v_perm_b32 v161, v49, v48, s35
    v_perm_b32 v162, v51, v50, s34
    v_perm_b32 v163, v51, v50, s35
    v_perm_b32 v164, v53, v52, s34
    v_perm_b32 v165, v53, v52, s35
    v_perm_b32 v166, v55, v54, s34
    v_perm_b32 v167, v55, v54, s35
    v_perm_b32 v168, v57, v56, s34
    v_perm_b32 v169, v57, v56, s35
    v_perm_b32 v170, v59, v58, s34
    v_perm_b32 v171, v59, v58, s35
    v_perm_b32 v172, v61, v60, s34
    v_perm_b32 v173, v61, v60, s35
    v_perm_b32 v174, v63, v62, s34
    v_perm_b32 v175, v63, v62, s35
    s_waitcnt vmcnt(8)
    s_mov_b32 s41, 1
L_HS:
    v_cmp_eq_u32 vcc, 0, v30
    s_cbranch_vccz L_HS_ok
    buffer_load_dword v30, v31, s[16:19], 0 offen sc1
    s_add_u32 s32, s32, 1
    s_cmp_gt_u32 s32, 200000
    s_waitcnt vmcnt(0)
    s_cbranch_scc0 L_HS
    s_branch L_HS_done
L_HS_ok:
    v_readlane_b32 s36, v30, 63
    s_nop 1
    v_cmp_ne_u32 vcc, s36, v30
    s_nop 1
    s_cmp_lg_u32 vcc_hi, 0
    s_cselect_b32 s41, 1, 0
L_HS_done:
    s_mov_b32 s7, 0xf7df00
    buffer_load_dword v15, v0, s[8:11], s7 offen sc1
    s_barrier
    ds_read_b64_tr_b16 v[36:37], v20 offset:0
    ds_read_b64_tr_b16 v[38:39], v20 offset:512
    ds_read_b64_tr_b16 v[44:45], v21 offset:0
    ds_read_b64_tr_b16 v[46:47], v21 offset:512
    ds_read_b64_tr_b16 a[4:5], v22 offset:0
    ds_read_b64_tr_b16 a[6:7], v22 offset:512
    ds_read_b64_tr_b16 a[12:13], v23 offset:0
    ds_read_b64_tr_b16 a[14:15], v23 offset:512
    ds_read_b64_tr_b16 a[36:37], v24 offset:0
    ds_read_b64_tr_b16 a[38:39], v24 offset:512
    ds_read_b64_tr_b16 a[44:45], v25 offset:0
    ds_read_b64_tr_b16 a[46:47], v25 offset:512
    s_waitcnt lgkmcnt(4)
    ds_read_b64_tr_b16 a[68:69], v26 offset:0
    ds_read_b64_tr_b16 a[70:71], v26 offset:512
    ds_read_b64_tr_b16 a[76:77], v27 offset:0
    ds_read_b64_tr_b16 a[78:79], v27 offset:512
    s_waitcnt lgkmcnt(0)
    s_barrier
    s_barrier
    ds_read_b64_tr_b16 v[48:49], v20 offset:8192
    ds_read_b64_tr_b16 v[50:51], v20 offset:8704
    ds_read_b64_tr_b16 v[56:57], v21 offset:8192
    ds_read_b64_tr_b16 v[58:59], v21 offset:8704
    ds_read_b64_tr_b16 a[16:17], v22 offset:8192
    ds_read_b64_tr_b16 a[18:19], v22 offset:8704
    ds_read_b64_tr_b16 a[24:25], v23 offset:8192
    ds_read_b64_tr_b16 a[26:27], v23 offset:8704
    ds_read_b64_tr_b16 a[48:49], v24 offset:8192
    ds_read_b64_tr_b16 a[50:51], v24 offset:8704
    ds_read_b64_tr_b16 a[56:57], v25 offset:8192
    ds_read_b64_tr_b16 a[58:59], v25 offset:8704
    s_waitcnt lgkmcnt(4)
    ds_read_b64_tr_b16 v[80:81], v26 offset:8192
    ds_read_b64_tr_b16 v[82:83], v26 offset:8704
    ds_read_b64_tr_b16 v[88:89], v27 offset:8192
    ds_read_b64_tr_b16 v[90:91], v27 offset:8704
    s_waitcnt lgkmcnt(0)
    s_barrier
    s_waitcnt vmcnt(0)
L_F0:
    v_readlane_b32 s36, v15, 33
    s_nop 1
    s_cmp_lg_u32 s36, 0
    s_cbranch_scc1 L_F0_ok
    buffer_load_dword v15, v0, s[8:11], s7 offen sc1
    s_add_u32 s32, s32, 1
    s_cmp_gt_u32 s32, 200000
    s_waitcnt vmcnt(0)
    s_cbranch_scc0 L_F0
L_F0_ok:
    s_mov_b32 s7, 0x1000000
    buffer_load_dword v15, v0, s[8:11], s7 offen sc1
    s_barrier
    ds_read_b64_tr_b16 v[52:53], v20 offset:16384
    ds_read_b64_tr_b16 v[54:55], v20 offset:16896
    ds_read_b64_tr_b16 v[60:61], v21 offset:16384
    ds_read_b64_tr_b16 v[62:63], v21 offset:16896
    ds_read_b64_tr_b16 a[20:21], v22 offset:16384
    ds_read_b64_tr_b16 a[22:23], v22 offset:16896
    ds_read_b64_tr_b16 a[28:29], v23 offset:16384
    ds_read_b64_tr_b16 a[30:31], v23 offset:16896
    ds_read_b64_tr_b16 a[52:53], v24 offset:16384
    ds_read_b64_tr_b16 a[54:55], v24 offset:16896
    ds_read_b64_tr_b16 a[60:61], v25 offset:16384
    ds_read_b64_tr_b16 a[62:63], v25 offset:16896
    s_waitcnt lgkmcnt(4)
    ds_read_b64_tr_b16 v[84:85], v26 offset:16384
    ds_read_b64_tr_b16 v[86:87], v26 offset:16896
    ds_read_b64_tr_b16 v[92:93], v27 offset:16384
    ds_read_b64_tr_b16 v[94:95], v27 offset:16896
    s_waitcnt lgkmcnt(0)
    s_barrier
    ds_write_b128 v4, v[32:35] offset:0
    ds_write_b128 v4, v[36:39] offset:1024
    ds_write_b128 v4, v[40:43] offset:2048
    ds_write_b128 v4, v[44:47] offset:3072
    ds_write_b128 v4, v[48:51] offset:4096
    ds_write_b128 v4, v[52:55] offset:5120
    ds_write_b128 v4, v[56:59] offset:6144
    ds_write_b128 v4, v[60:63] offset:7168
    s_waitcnt lgkmcnt(0)
    ds_write_b128 v4, v[64:67] offset:8192
    ds_write_b128 v4, v[68:71] offset:9216
    ds_write_b128 v4, v[72:75] offset:10240
    ds_write_b128 v4, v[76:79] offset:11264
    ds_write_b128 v4, v[80:83] offset:12288
    ds_write_b128 v4, v[84:87] offset:13312
    ds_write_b128 v4, v[88:91] offset:14336
    ds_write_b128 v4, v[92:95] offset:15360
    s_waitcnt lgkmcnt(0)
    ds_write_b128 v4, v[96:99] offset:16384
    ds_write_b128 v4, v[100:103] offset:17408
    ds_write_b128 v4, v[104:107] offset:18432
    ds_write_b128 v4, v[108:111] offset:19456
    ds_write_b128 v4, v[112:115] offset:20480
    ds_write_b128 v4, v[116:119] offset:21504
    ds_write_b128 v4, v[120:123] offset:22528
    ds_write_b128 v4, v[124:127] offset:23552
    s_waitcnt lgkmcnt(0)
    s_waitcnt lgkmcnt(0)
    s_cmp_lg_u32 s41, 0
    s_cbranch_scc1 L_slow_start
L_fast_start:
    s_mov_b32 s22, 0
    s_mov_b32 s23, 0x1000000
    s_mov_b32 s27, 0
    s_mov_b32 s31, 0x80000
    s_mov_b32 s61, 0x40000000
    s_mov_b32 s96, 0x800
    s_mov_b32 s97, 0x1000
    s_mov_b32 s98, 0x1800
    s_mov_b32 s92, 0xcccccccc
    s_mov_b32 s93, 0xcccccccc
    s_mov_b32 s91, 0
    ds_read_b128 v[104:107], v4 offset:0
    ds_read_b128 v[108:111], v4 offset:1024
    ds_read_b128 v[112:115], v4 offset:2048
    ds_read_b128 v[116:119], v4 offset:3072
    ds_read_b128 v[88:91], v4 offset:4096
    ds_read_b128 v[92:95], v4 offset:5120
    ds_read_b128 v[96:99], v4 offset:6144
    ds_read_b128 v[100:103], v4 offset:7168
    ds_read_b128 v[72:75], v4 offset:8192
    ds_read_b128 v[76:79], v4 offset:9216
    ds_read_b128 v[80:83], v4 offset:10240
    ds_read_b128 v[84:87], v4 offset:11264
    v_mov_b64 v[48:49], 0
    v_mov_b64 v[50:51], 0
    v_mov_b64 v[52:53], 0
    v_mov_b64 v[54:55], 0
    v_mov_b64 v[56:57], 0
    v_mov_b64 v[58:59], 0
    v_mov_b64 v[60:61], 0
    v_mov_b64 v[62:63], 0
    v_mov_b64 v[64:65], 0
    v_mov_b64 v[66:67], 0
    v_mov_b64 v[68:69], 0
    v_mov_b64 v[70:71], 0
    s_add_u32 s7, s23, 0x80000
    buffer_load_dwordx4 v[16:19], v2, s[8:11], s7 offen sc1
    buffer_load_dwordx4 v[20:23], v2, s[8:11], s7 offen offset:1024 sc1
    s_waitcnt vmcnt(2)
L_fast_step:
    v_readlane_b32 s36, v15, 33
    s_add_u32 s24, s23, 0x82100
    s_cmp_eq_u32 s36, 0
    s_cbranch_scc1 L_fast_refresh
L_fast_fresh:
    s_add_u32 s29, s23, s25
    s_add_u32 s30, s23, s39
    s_xor_b32 s28, s27, 1
    s_add_u32 s90, s22, 1
    s_nop 15
L_fast_retrym:
    buffer_load_dwordx4 v[16:19], v2, s[8:11], s7 offen sc1
    buffer_load_dwordx4 v[20:23], v2, s[8:11], s7 offen offset:1024 sc1
L_fast_prem:
    s_add_u32 s32, s32, 1
    s_cmp_gt_u32 s32, 200000
    s_cselect_b32 s94, -1, -2
    v_xor_b32 v28, 0x800, v2
    v_xor_b32 v44, 0x1800, v2
    v_mov_b64 v[48:49], 0
    v_mov_b64 v[50:51], 0
    v_mov_b64 v[52:53], 0
    v_mov_b64 v[54:55], 0
L_fast_waitm:
    s_waitcnt vmcnt(3) lgkmcnt(0)
L_fast_gotm:
    v_max3_u32 v14, v16, v17, v18
    v_max_u32 v14, v14, v19
    v_smfmac_f32_16x16x64_bf16 v[48:51], v[16:19], v[104:111], v1
    s_waitcnt vmcnt(2)
    v_max3_u32 v14, v14, v20, v21
    v_smfmac_f32_16x16x64_bf16 v[52:55], v[16:19], v[112:119], v1
    v_max3_u32 v14, v14, v22, v23
    v_cmp_lt_u32 vcc, s94, v14
    v_smfmac_f32_16x16x64_bf16 v[48:51], v[20:23], v[88:95], v1
    ds_write_b128 v2, v[16:19] offset:0
    s_cbranch_vccnz L_fast_retrym
    v_smfmac_f32_16x16x64_bf16 v[52:55], v[20:23], v[96:103], v1
    ds_write_b128 v2, v[20:23] offset:1024
    v_smfmac_f32_16x16x64_bf16 v[56:59], v[16:19], v[72:79], v1
    buffer_load_dwordx4 v[104:107], v3, s[8:11], s29 offen offset:0 sc1
    buffer_load_dwordx4 v[120:123], v3, s[8:11], s30 offen offset:0 sc1
    v_smfmac_f32_16x16x64_bf16 v[60:63], v[16:19], v[80:87], v1
    buffer_load_dwordx4 v[108:111], v3, s[8:11], s29 offen offset:1024 sc1
    buffer_load_dwordx4 v[124:127], v3, s[8:11], s30 offen offset:1024 sc1
    v_smfmac_f32_16x16x64_bf16 v[56:59], v[20:23], a[80:87], v1
    buffer_load_dwordx4 v[112:115], v3, s[8:11], s29 offen offset:2048 sc1
    buffer_load_dwordx4 v[116:119], v3, s[8:11], s29 offen offset:3072 sc1
    v_smfmac_f32_16x16x64_bf16 v[60:63], v[20:23], a[88:95], v1
    s_waitcnt lgkmcnt(0)
    s_barrier
    ds_read_b128 v[24:27], v28 offset:0
    v_smfmac_f32_16x16x64_bf16 v[64:67], v[16:19], a[160:167], v1
    ds_read_b128 v[28:31], v28 offset:1024
    v_smfmac_f32_16x16x64_bf16 v[68:71], v[16:19], a[168:175], v1
    buffer_load_dword v15, v0, s[8:11], s24 offen sc1
    v_smfmac_f32_16x16x64_bf16 v[64:67], v[20:23], a[176:183], v1
    ds_read_b128 v[32:35], v8 offset:0
    v_smfmac_f32_16x16x64_bf16 v[68:71], v[20:23], a[184:191], v1
    ds_read_b128 v[36:39], v8 offset:1024
    s_waitcnt lgkmcnt(3)
    v_smfmac_f32_16x16x64_bf16 v[48:51], v[24:27], a[0:7], v1
    ds_read_b128 v[40:43], v44 offset:0
    v_smfmac_f32_16x16x64_bf16 v[52:55], v[24:27], a[8:15], v1
    ds_read_b128 v[44:47], v44 offset:1024
    s_waitcnt lgkmcnt(4)
    v_smfmac_f32_16x16x64_bf16 v[48:51], v[28:31], a[16:23], v1
    ds_read_b128 v[88:91], v4 offset:12288
    v_smfmac_f32_16x16x64_bf16 v[52:55], v[28:31], a[24:31], v1
    ds_read_b128 v[92:95], v4 offset:13312
    s_waitcnt lgkmcnt(4)
    v_smfmac_f32_16x16x64_bf16 v[48:51], v[32:35], a[32:39], v1
    ds_read_b128 v[96:99], v4 offset:14336
    v_smfmac_f32_16x16x64_bf16 v[52:55], v[32:35], a[40:47], v1
    ds_read_b128 v[100:103], v4 offset:15360
    s_waitcnt lgkmcnt(4)
    v_smfmac_f32_16x16x64_bf16 v[48:51], v[36:39], a[48:55], v1
    v_smfmac_f32_16x16x64_bf16 v[52:55], v[36:39], a[56:63], v1
    ds_read_b128 v[72:75], v4 offset:16384
    v_smfmac_f32_16x16x64_bf16 v[48:51], v[40:43], a[64:71], v1
    v_smfmac_f32_16x16x64_bf16 v[52:55], v[40:43], a[72:79], v1
    ds_read_b128 v[76:79], v4 offset:17408
    s_waitcnt lgkmcnt(2)
    v_smfmac_f32_16x16x64_bf16 v[48:51], v[44:47], v[88:95], v1
    ds_read_b128 v[80:83], v4 offset:18432
    v_smfmac_f32_16x16x64_bf16 v[52:55], v[44:47], v[96:103], v1
    ds_read_b128 v[84:87], v4 offset:19456
    v_smfmac_f32_16x16x64_bf16 v[56:59], v[28:31], a[96:103], v1
    ds_read_b128 v[88:91], v4 offset:20480
    v_smfmac_f32_16x16x64_bf16 v[60:63], v[28:31], a[104:111], v1
    ds_read_b128 v[92:95], v4 offset:21504
    v_smfmac_f32_16x16x64_bf16 v[56:59], v[32:35], a[112:119], v1
    ds_read_b128 v[96:99], v4 offset:22528
    v_add_f32 v48, v48, v50
    v_add_f32 v49, v49, v51
    v_smfmac_f32_16x16x64_bf16 v[60:63], v[32:35], a[120:127], v1
    ds_read_b128 v[100:103], v4 offset:23552
    v_add_f32 v52, v52, v54
    v_add_f32 v53, v53, v55
    v_smfmac_f32_16x16x64_bf16 v[56:59], v[36:39], a[128:135], v1
    s_waitcnt lgkmcnt(4)
    v_cvt_pk_bf16_f32 v50, v48, v52
    v_cvt_pk_bf16_f32 v51, v49, v53
    v_smfmac_f32_16x16x64_bf16 v[56:59], v[24:27], v[72:79], v1
    ds_write2_b32 v5, v50, v51 offset0:0 offset1:72
    v_smfmac_f32_16x16x64_bf16 v[60:63], v[24:27], v[80:87], v1
    v_smfmac_f32_16x16x64_bf16 v[60:63], v[36:39], a[136:143], v1
    v_smfmac_f32_16x16x64_bf16 v[56:59], v[40:43], a[144:151], v1
    buffer_store_dword v12, v10, s[8:11], s31 offen sc1
    v_smfmac_f32_16x16x64_bf16 v[60:63], v[40:43], a[152:159], v1
    s_waitcnt lgkmcnt(0)
    s_barrier
    v_smfmac_f32_16x16x64_bf16 v[56:59], v[44:47], v[88:95], v1
    ds_read_b128 v[72:75], v6 offset:0
    v_smfmac_f32_16x16x64_bf16 v[60:63], v[44:47], v[96:103], v1
    ds_read_b128 v[76:79], v6 offset:64
    v_smfmac_f32_16x16x64_bf16 v[64:67], v[24:27], a[192:199], v1
    ds_read_b128 v[80:83], v6 offset:128
    v_smfmac_f32_16x16x64_bf16 v[68:71], v[24:27], a[200:207], v1
    ds_read_b128 v[84:87], v6 offset:192
    s_waitcnt vmcnt(2) lgkmcnt(3)
    v_mfma_f32_16x16x32_bf16 v[48:51], v[104:107], v[72:75], 0
    s_waitcnt lgkmcnt(2)
    v_add_f32 v56, v56, v58
    v_add_f32 v57, v57, v59
    v_mfma_f32_16x16x32_bf16 v[48:51], v[108:111], v[76:79], v[48:51]
    s_waitcnt lgkmcnt(1)
    v_add_f32 v60, v60, v62
    v_add_f32 v61, v61, v63
    v_mfma_f32_16x16x32_bf16 v[48:51], v[112:115], v[80:83], v[48:51]
    s_waitcnt lgkmcnt(0)
    v_cvt_pk_bf16_f32 v58, v56, v60
    v_cvt_pk_bf16_f32 v59, v57, v61
    v_mfma_f32_16x16x32_bf16 v[48:51], v[116:119], v[84:87], v[48:51]
    ds_write2_b32 v7, v58, v59 offset0:0 offset1:72
    v_smfmac_f32_16x16x64_bf16 v[64:67], v[28:31], a[208:215], v1
    v_mov_b64 v[104:105], s[4:5]
    v_smfmac_f32_16x16x64_bf16 v[68:71], v[28:31], a[216:223], v1
    s_nop 1
    v_mov_b64 v[106:107], s[4:5]
    v_smfmac_f32_16x16x64_bf16 v[64:67], v[32:35], a[224:231], v1
    v_exp_f32 v48, v48
    v_smfmac_f32_16x16x64_bf16 v[68:71], v[32:35], a[232:239], v1
    s_waitcnt lgkmcnt(0)
    s_barrier
    v_exp_f32 v49, v49
    v_smfmac_f32_16x16x64_bf16 v[64:67], v[36:39], a[240:247], v1
    ds_read_b128 v[88:91], v6 offset:2304
    v_exp_f32 v50, v50
    v_smfmac_f32_16x16x64_bf16 v[68:71], v[36:39], a[248:255], v1
    ds_read_b128 v[92:95], v6 offset:2368
    v_exp_f32 v51, v51
    v_smfmac_f32_16x16x64_bf16 v[64:67], v[40:43], v[128:135], v1
    ds_read_b128 v[96:99], v6 offset:2432
    v_cvt_pk_bf16_f32 v108, v48, v49
    v_cvt_pk_bf16_f32 v109, v50, v51
    v_smfmac_f32_16x16x64_bf16 v[68:71], v[40:43], v[136:143], v1
    ds_read_b128 v[100:103], v6 offset:2496
    ds_write_b64 v2, v[108:109] offset:8192
    s_waitcnt lgkmcnt(4)
    v_mfma_f32_16x16x32_bf16 v[52:55], v[88:91], v[72:75], 0
    s_waitcnt lgkmcnt(3)
    v_mov_b32 v113, 0
    v_mov_b32 v115, 0
    v_mfma_f32_16x16x32_bf16 v[52:55], v[92:95], v[76:79], v[52:55]
    s_waitcnt lgkmcnt(2)
    v_mov_b32 v117, 0
    v_mov_b64 v[16:17], 0
    v_mfma_f32_16x16x32_bf16 v[52:55], v[96:99], v[80:83], v[52:55]
    s_waitcnt lgkmcnt(1)
    v_mov_b64 v[18:19], 0
    v_mov_b64 v[20:21], 0
    v_mfma_f32_16x16x32_bf16 v[52:55], v[100:103], v[84:87], v[52:55]
    s_waitcnt lgkmcnt(0)
    s_barrier
    v_smfmac_f32_16x16x64_bf16 v[64:67], v[44:47], v[144:151], v1
    ds_read_b64 v[110:111], v8 offset:8192
    v_mov_b64 v[22:23], 0
    v_smfmac_f32_16x16x64_bf16 v[68:71], v[44:47], v[152:159], v1
    v_mov_b64 v[24:25], 0
    v_mov_b64 v[26:27], 0
    v_mul_f32 v52, s33, v52
    v_mul_f32 v53, s33, v53
    v_exp_f32 v52, v52
    s_waitcnt lgkmcnt(0)
    v_mfma_f32_16x16x32_bf16 v[48:51], v[104:107], v[108:111], 0
    v_exp_f32 v53, v53
    v_add_f32 v64, v64, v66
    v_mfma_f32_16x16x32_bf16 v[56:59], v[120:123], v[108:111], 0
    v_cvt_pk_bf16_f32 v112, v52, v53
    v_add_f32 v65, v65, v67
    v_mfma_f32_16x16x32_bf16 v[60:63], v[124:127], v[108:111], 0
    v_cvt_pk_bf16_f32 v114, v64, v65
    v_add_f32 v68, v68, v70
    v_mfma_f32_16x16x16_bf16 v[48:51], v[104:105], v[112:113], v[48:51]
    v_add_f32 v69, v69, v71
    v_cvt_pk_bf16_f32 v116, v68, v69
    v_mfma_f32_16x16x16_bf16 v[56:59], v[114:115], v[112:113], v[56:59]
    v_mov_b64 v[28:29], 0
    v_mov_b64 v[30:31], 0
    v_mfma_f32_16x16x16_bf16 v[60:63], v[116:117], v[112:113], v[60:63]
    v_bitop3_b32 v32, v13, s96, -9 bitop3:0x28
    v_bitop3_b32 v36, v13, s97, -9 bitop3:0x28
    v_rcp_f32 v118, v48
    v_bitop3_b32 v40, v13, s98, -9 bitop3:0x28
    v_max_f32 v14, v118, v48
    v_cmp_nge_f32 vcc, s40, v14
    v_pk_mul_f32 v[56:57], v[56:57], v[118:119] op_sel_hi:[1,0]
    v_pk_mul_f32 v[58:59], v[58:59], v[118:119] op_sel_hi:[1,0]
    v_pk_mul_f32 v[60:61], v[60:61], v[118:119] op_sel_hi:[1,0]
    v_pk_mul_f32 v[62:63], v[62:63], v[118:119] op_sel_hi:[1,0]
    v_cvt_pk_bf16_f32 v52, v56, v60
    v_cvt_pk_bf16_f32 v54, v58, v62
    v_cvt_pk_bf16_f32 v53, v57, v61
    v_cvt_pk_bf16_f32 v55, v59, v63
L_fast_rejoin:
    v_cndmask_b32 v50, v52, v54, s[92:93]
    v_cndmask_b32 v51, v53, v55, s[92:93]
    ds_write_b64 v13, v[50:51] offset:9216
    v_smfmac_f32_16x16x64_bf16 v[16:19], v[52:55], v[160:167], v1
    v_smfmac_f32_16x16x64_bf16 v[20:23], v[52:55], v[168:175], v1
    s_waitcnt lgkmcnt(0)
    s_barrier
    ds_read_b128 v[32:35], v32 offset:9216
    ds_read_b128 v[36:39], v36 offset:9216
    v_smfmac_f32_16x16x64_bf16 v[24:27], v[52:55], v[176:183], v1
    ds_read_b128 v[40:43], v40 offset:9216
    v_smfmac_f32_16x16x64_bf16 v[28:31], v[52:55], v[184:191], v1
    ds_read_b128 v[88:91], v4 offset:24576
    ds_read_b128 v[92:95], v4 offset:25600
    s_waitcnt lgkmcnt(4)
    v_smfmac_f32_16x16x64_bf16 v[16:19], v[32:35], v[192:199], v1
    ds_read_b128 v[96:99], v4 offset:26624
    s_waitcnt lgkmcnt(4)
    v_smfmac_f32_16x16x64_bf16 v[16:19], v[36:39], v[216:223], v1
    ds_read_b128 v[100:103], v4 offset:27648
    s_waitcnt lgkmcnt(4)
    v_smfmac_f32_16x16x64_bf16 v[16:19], v[40:43], v[240:247], v1
    ds_read_b128 v[72:75], v4 offset:28672
    s_cmp_lg_u64 vcc, 0
    v_smfmac_f32_16x16x64_bf16 v[20:23], v[32:35], v[200:207], v1
    ds_read_b128 v[76:79], v4 offset:29696
    s_cselect_b32 s60, s28, s27
    v_smfmac_f32_16x16x64_bf16 v[20:23], v[36:39], v[224:231], v1
    ds_read_b128 v[80:83], v4 offset:30720
    s_nop 0
    v_cvt_pk_bf16_f32 v56, v16, v18
    v_smfmac_f32_16x16x64_bf16 v[20:23], v[40:43], v[248:255], v1
    ds_read_b128 v[84:87], v4 offset:31744
    v_cvt_pk_bf16_f32 v57, v17, v19
    v_and_or_b32 v56, v56, -2, s60
    v_smfmac_f32_16x16x64_bf16 v[24:27], v[32:35], v[208:215], v1
    buffer_store_dwordx2 v[56:57], v9, s[8:11], 0 offen offset:0
    v_smfmac_f32_16x16x64_bf16 v[24:27], v[36:39], v[232:239], v1
    s_waitcnt lgkmcnt(4)
    s_nop 0
    v_cvt_pk_bf16_f32 v58, v20, v22
    v_smfmac_f32_16x16x64_bf16 v[24:27], v[40:43], v[88:95], v1
    ds_read_b128 v[64:67], v3 offset:23040
    v_cvt_pk_bf16_f32 v59, v21, v23
    v_and_or_b32 v58, v58, -2, s60
    v_smfmac_f32_16x16x64_bf16 v[28:31], v[32:35], v[96:103], v1
    buffer_store_dwordx2 v[58:59], v9, s[8:11], 0 offen offset:2048
    s_waitcnt lgkmcnt(1)
    v_smfmac_f32_16x16x64_bf16 v[28:31], v[36:39], v[72:79], v1
    s_nop 1
    v_cvt_pk_bf16_f32 v60, v24, v26
    v_smfmac_f32_16x16x64_bf16 v[28:31], v[40:43], v[80:87], v1
    s_nop 2
    v_cvt_pk_bf16_f32 v61, v25, v27
    v_and_or_b32 v60, v60, -2, s60
    buffer_store_dwordx2 v[60:61], v9, s[8:11], s26 offen offset:0
    s_nop 1
    v_cvt_pk_bf16_f32 v62, v28, v30
    v_cvt_pk_bf16_f32 v63, v29, v31
    v_and_or_b32 v62, v62, -2, s60
    buffer_store_dwordx2 v[62:63], v9, s[8:11], s26 offen offset:2048
L_fast_stored:
    s_cmp_lg_u32 s60, s27
    s_cbranch_scc1 L_fast_safe
    ds_read_b128 v[104:107], v4 offset:0
    ds_read_b128 v[108:111], v4 offset:1024
    ds_read_b128 v[112:115], v4 offset:2048
    ds_read_b128 v[116:119], v4 offset:3072
    ds_read_b128 v[88:91], v4 offset:4096
    ds_read_b128 v[92:95], v4 offset:5120
    ds_read_b128 v[96:99], v4 offset:6144
    ds_read_b128 v[100:103], v4 offset:7168
    ds_read_b128 v[72:75], v4 offset:8192
    ds_read_b128 v[76:79], v4 offset:9216
    ds_read_b128 v[80:83], v4 offset:10240
    ds_read_b128 v[84:87], v4 offset:11264
    s_cmp_lt_u32 s21, 1
    s_cbranch_scc1 L_fast_pollp
    s_nop 11
    s_cmp_lt_u32 s21, 2
    s_cbranch_scc1 L_fast_pollp
    s_nop 11
    s_cmp_lt_u32 s21, 3
    s_cbranch_scc1 L_fast_pollp
    s_nop 11
L_fast_pollp:
    buffer_load_dwordx4 v[120:123], v2, s[8:11], s6 offen sc1
    buffer_load_dwordx4 v[124:127], v2, s[8:11], s6 offen offset:1024 sc1
    v_mov_b64 v[56:57], 0
    v_mov_b64 v[58:59], 0
    v_mov_b64 v[60:61], 0
    v_mov_b64 v[62:63], 0
    s_nop 15
    s_nop 15
    buffer_load_dwordx4 v[32:35], v2, s[8:11], s6 offen sc1
    buffer_load_dwordx4 v[36:39], v2, s[8:11], s6 offen offset:1024 sc1
L_fast_prep:
    s_add_u32 s7, s24, 0x80000
    s_waitcnt vmcnt(3) lgkmcnt(0)
    v_mfma_f32_16x16x32_bf16 v[68:71], v[64:67], v[120:123], 0
    v_bitop3_b32 v14, v120, v122, s27 bitop3:0x7e
    s_waitcnt vmcnt(2)
    v_mfma_f32_16x16x32_bf16 v[68:71], v[64:67], v[124:127], v[68:71]
    v_bitop3_b32 v11, v124, v126, s27 bitop3:0x7e
    v_bitop3_b32 v14, v14, v11, 1 bitop3:0xa8
    v_cmp_ne_u32 vcc, 0, v14
    s_nop 2
    s_cmp_eq_u64 vcc, 0
    s_cselect_b32 s36, s24, s61
    v_add_f32_dpp v68, v68, v68 row_ror:8 row_mask:0xf bank_mask:0xf
    v_add_f32_dpp v69, v69, v69 row_ror:8 row_mask:0xf bank_mask:0xf
    s_nop 0
    v_add_f32_dpp v68, v68, v68 row_ror:4 row_mask:0xf bank_mask:0xf
    v_add_f32_dpp v69, v69, v69 row_ror:4 row_mask:0xf bank_mask:0xf
    v_cvt_pk_bf16_f32 v12, v68, v69
    buffer_store_dword v12, v10, s[8:11], s36 offen
    s_cbranch_scc1 L_fast_gotp
L_fast_retryp:
    buffer_load_dwordx4 v[120:123], v2, s[8:11], s6 offen sc1
    buffer_load_dwordx4 v[124:127], v2, s[8:11], s6 offen offset:1024 sc1
    s_waitcnt vmcnt(4) lgkmcnt(0)
    v_mfma_f32_16x16x32_bf16 v[68:71], v[64:67], v[32:35], 0
    v_bitop3_b32 v14, v32, v34, s27 bitop3:0x7e
    s_waitcnt vmcnt(3)
    v_mfma_f32_16x16x32_bf16 v[68:71], v[64:67], v[36:39], v[68:71]
    v_bitop3_b32 v11, v36, v38, s27 bitop3:0x7e
    v_bitop3_b32 v14, v14, v11, 1 bitop3:0xa8
    v_cmp_ne_u32 vcc, 0, v14
    s_nop 2
    s_cmp_eq_u64 vcc, 0
    s_cselect_b32 s36, s24, s61
    v_add_f32_dpp v68, v68, v68 row_ror:8 row_mask:0xf bank_mask:0xf
    v_add_f32_dpp v69, v69, v69 row_ror:8 row_mask:0xf bank_mask:0xf
    s_nop 0
    v_add_f32_dpp v68, v68, v68 row_ror:4 row_mask:0xf bank_mask:0xf
    v_add_f32_dpp v69, v69, v69 row_ror:4 row_mask:0xf bank_mask:0xf
    v_cvt_pk_bf16_f32 v12, v68, v69
    buffer_store_dword v12, v10, s[8:11], s36 offen
    s_cbranch_scc1 L_fast_gotp
    buffer_load_dwordx4 v[32:35], v2, s[8:11], s6 offen sc1
    buffer_load_dwordx4 v[36:39], v2, s[8:11], s6 offen offset:1024 sc1
    s_waitcnt vmcnt(4) lgkmcnt(0)
    v_mfma_f32_16x16x32_bf16 v[68:71], v[64:67], v[120:123], 0
    v_bitop3_b32 v14, v120, v122, s27 bitop3:0x7e
    s_waitcnt vmcnt(3)
    v_mfma_f32_16x16x32_bf16 v[68:71], v[64:67], v[124:127], v[68:71]
    v_bitop3_b32 v11, v124, v126, s27 bitop3:0x7e
    v_bitop3_b32 v14, v14, v11, 1 bitop3:0xa8
    v_cmp_ne_u32 vcc, 0, v14
    s_nop 2
    s_cmp_eq_u64 vcc, 0
    s_cselect_b32 s36, s24, s61
    v_add_f32_dpp v68, v68, v68 row_ror:8 row_mask:0xf bank_mask:0xf
    v_add_f32_dpp v69, v69, v69 row_ror:8 row_mask:0xf bank_mask:0xf
    s_nop 0
    v_add_f32_dpp v68, v68, v68 row_ror:4 row_mask:0xf bank_mask:0xf
    v_add_f32_dpp v69, v69, v69 row_ror:4 row_mask:0xf bank_mask:0xf
    v_cvt_pk_bf16_f32 v12, v68, v69
    buffer_store_dword v12, v10, s[8:11], s36 offen
    s_cbranch_scc1 L_fast_gotp
    s_add_u32 s32, s32, 1
    s_cmp_le_u32 s32, 200000
    s_cbranch_scc1 L_fast_retryp
    s_mov_b32 s36, s24
    buffer_store_dword v12, v10, s[8:11], s36 offen
L_fast_gotp:
    s_add_u32 s31, s31, 0x2000
    s_cmp_ge_u32 s90, 63
    s_cbranch_scc1 L_fast_last
    s_mov_b32 s23, s24
    s_mov_b32 s22, s90
    s_mov_b32 s27, s28
    v_mov_b64 v[64:65], 0
    v_mov_b64 v[66:67], 0
    v_mov_b64 v[68:69], 0
    v_mov_b64 v[70:71], 0
    s_nop 15
    s_nop 11
    buffer_load_dwordx4 v[16:19], v2, s[8:11], s7 offen sc1
    buffer_load_dwordx4 v[20:23], v2, s[8:11], s7 offen offset:1024 sc1
    s_branch L_fast_step
L_fast_last:
    buffer_store_dword v12, v10, s[8:11], s31 offen sc1
    s_branch L_fast_done
L_fast_refresh:
    buffer_load_dword v15, v0, s[8:11], s23 offen sc1
    s_add_u32 s32, s32, 1
    s_cmp_le_u32 s32, 200000
    s_waitcnt vmcnt(0)
    s_cbranch_scc1 L_fast_step
    s_branch L_fast_fresh
L_fast_safe:
    s_nop 11
    s_waitcnt vmcnt(0) lgkmcnt(0)
    s_barrier
    ds_read_b128 v[72:75], v6 offset:0
    ds_read_b128 v[88:91], v6 offset:2304
    ds_read_b128 v[76:79], v6 offset:64
    ds_read_b128 v[92:95], v6 offset:2368
    ds_read_b128 v[80:83], v6 offset:128
    ds_read_b128 v[96:99], v6 offset:2432
    ds_read_b128 v[84:87], v6 offset:192
    ds_read_b128 v[100:103], v6 offset:2496
    s_xor_b32 s36, s25, 0x1000
    s_add_u32 s36, s36, s23
    buffer_load_dwordx4 v[16:19], v3, s[8:11], s29 offen offset:0 sc1
    buffer_load_dwordx4 v[32:35], v3, s[8:11], s36 offen offset:0 sc1
    buffer_load_dwordx4 v[20:23], v3, s[8:11], s29 offen offset:1024 sc1
    buffer_load_dwordx4 v[36:39], v3, s[8:11], s36 offen offset:1024 sc1
    buffer_load_dwordx4 v[24:27], v3, s[8:11], s29 offen offset:2048 sc1
    buffer_load_dwordx4 v[40:43], v3, s[8:11], s36 offen offset:2048 sc1
    buffer_load_dwordx4 v[28:31], v3, s[8:11], s29 offen offset:3072 sc1
    buffer_load_dwordx4 v[44:47], v3, s[8:11], s36 offen offset:3072 sc1
    s_waitcnt vmcnt(0) lgkmcnt(0)
    v_mfma_f32_16x16x32_bf16 v[48:51], v[16:19], v[72:75], 0
    v_mfma_f32_16x16x32_bf16 v[48:51], v[20:23], v[76:79], v[48:51]
    v_mfma_f32_16x16x32_bf16 v[48:51], v[24:27], v[80:83], v[48:51]
    v_mfma_f32_16x16x32_bf16 v[48:51], v[28:31], v[84:87], v[48:51]
    v_mfma_f32_16x16x32_bf16 v[52:55], v[32:35], v[72:75], 0
    v_mfma_f32_16x16x32_bf16 v[52:55], v[36:39], v[76:79], v[52:55]
    v_mfma_f32_16x16x32_bf16 v[52:55], v[40:43], v[80:83], v[52:55]
    v_mfma_f32_16x16x32_bf16 v[52:55], v[44:47], v[84:87], v[52:55]
    v_mfma_f32_16x16x32_bf16 v[56:59], v[88:91], v[72:75], 0
    v_mfma_f32_16x16x32_bf16 v[56:59], v[92:95], v[76:79], v[56:59]
    v_mfma_f32_16x16x32_bf16 v[56:59], v[96:99], v[80:83], v[56:59]
    v_mfma_f32_16x16x32_bf16 v[56:59], v[100:103], v[84:87], v[56:59]
    s_nop 7
    v_mul_f32 v56, s33, v56
    v_mul_f32 v57, s33, v57
    v_max3_f32 v16, v48, v49, v50
    v_max3_f32 v16, v16, v51, v52
    v_max3_f32 v16, v16, v53, v54
    v_max3_f32 v16, v16, v55, v56
    v_max_f32 v16, v16, v57
    v_mov_b32 v17, v16
    s_nop 1
    v_permlane16_swap_b32 v16, v17
    v_max_f32 v16, v16, v17
    v_mov_b32 v17, v16
    s_nop 1
    v_permlane32_swap_b32 v16, v17
    v_max_f32 v16, v16, v17
    v_sub_f32 v48, v48, v16
    v_exp_f32 v48, v48
    v_sub_f32 v49, v49, v16
    v_exp_f32 v49, v49
    v_sub_f32 v50, v50, v16
    v_exp_f32 v50, v50
    v_sub_f32 v51, v51, v16
    v_exp_f32 v51, v51
    v_sub_f32 v52, v52, v16
    v_exp_f32 v52, v52
    v_sub_f32 v53, v53, v16
    v_exp_f32 v53, v53
    v_sub_f32 v54, v54, v16
    v_exp_f32 v54, v54
    v_sub_f32 v55, v55, v16
    v_exp_f32 v55, v55
    v_sub_f32 v56, v56, v16
    v_exp_f32 v56, v56
    v_sub_f32 v57, v57, v16
    v_exp_f32 v57, v57
    v_cvt_pk_bf16_f32 v108, v48, v49
    v_cvt_pk_bf16_f32 v109, v50, v51
    v_cvt_pk_bf16_f32 v110, v52, v53
    v_cvt_pk_bf16_f32 v111, v54, v55
    v_cvt_pk_bf16_f32 v112, v56, v57
    s_nop 0
    v_mfma_f32_16x16x32_bf16 v[48:51], v[104:107], v[108:111], 0
    v_mfma_f32_16x16x32_bf16 v[56:59], v[120:123], v[108:111], 0
    v_mfma_f32_16x16x32_bf16 v[60:63], v[124:127], v[108:111], 0
    s_nop 3
    v_mfma_f32_16x16x16_bf16 v[48:51], v[104:105], v[112:113], v[48:51]
    v_mfma_f32_16x16x16_bf16 v[56:59], v[114:115], v[112:113], v[56:59]
    v_mfma_f32_16x16x16_bf16 v[60:63], v[116:117], v[112:113], v[60:63]
    s_nop 5
    v_rcp_f32 v118, v48
    s_nop 0
    v_mul_f32 v56, v56, v118
    v_mul_f32 v57, v57, v118
    v_mul_f32 v58, v58, v118
    v_mul_f32 v59, v59, v118
    v_mul_f32 v60, v60, v118
    v_mul_f32 v61, v61, v118
    v_mul_f32 v62, v62, v118
    v_mul_f32 v63, v63, v118
    v_cvt_pk_bf16_f32 v52, v56, v60
    v_cvt_pk_bf16_f32 v53, v57, v61
    v_cvt_pk_bf16_f32 v54, v58, v62
    v_cvt_pk_bf16_f32 v55, v59, v63
    v_mov_b32 v16, 0
    v_mov_b32 v17, 0
    v_mov_b32 v18, 0
    v_mov_b32 v19, 0
    v_mov_b32 v20, 0
    v_mov_b32 v21, 0
    v_mov_b32 v22, 0
    v_mov_b32 v23, 0
    v_mov_b32 v24, 0
    v_mov_b32 v25, 0
    v_mov_b32 v26, 0
    v_mov_b32 v27, 0
    v_mov_b32 v28, 0
    v_mov_b32 v29, 0
    v_mov_b32 v30, 0
    v_mov_b32 v31, 0
    v_bitop3_b32 v32, v13, s96, -9 bitop3:0x28
    v_bitop3_b32 v36, v13, s97, -9 bitop3:0x28
    v_bitop3_b32 v40, v13, s98, -9 bitop3:0x28
    s_mov_b64 vcc, 0
    s_branch L_fast_rejoin
L_fast_done:
    s_branch L_end
L_slow_start:
    s_mov_b32 s22, 0
    s_mov_b32 s23, 0x1000000
    s_mov_b32 s27, 0
    s_mov_b32 s31, 0x80000
    s_mov_b32 s61, 0x40000000
    s_mov_b32 s96, 0x800
    s_mov_b32 s97, 0x1000
    s_mov_b32 s98, 0x1800
    s_mov_b32 s92, 0xcccccccc
    s_mov_b32 s93, 0xcccccccc
    s_mov_b32 s91, 0
    ds_read_b128 v[104:107], v4 offset:0
    ds_read_b128 v[108:111], v4 offset:1024
    ds_read_b128 v[112:115], v4 offset:2048
    ds_read_b128 v[116:119], v4 offset:3072
    ds_read_b128 v[88:91], v4 offset:4096
    ds_read_b128 v[92:95], v4 offset:5120
    ds_read_b128 v[96:99], v4 offset:6144
    ds_read_b128 v[100:103], v4 offset:7168
    ds_read_b128 v[72:75], v4 offset:8192
    ds_read_b128 v[76:79], v4 offset:9216
    ds_read_b128 v[80:83], v4 offset:10240
    ds_read_b128 v[84:87], v4 offset:11264
    v_mov_b64 v[48:49], 0
    v_mov_b64 v[50:51], 0
    v_mov_b64 v[52:53], 0
    v_mov_b64 v[54:55], 0
    v_mov_b64 v[56:57], 0
    v_mov_b64 v[58:59], 0
    v_mov_b64 v[60:61], 0
    v_mov_b64 v[62:63], 0
    v_mov_b64 v[64:65], 0
    v_mov_b64 v[66:67], 0
    v_mov_b64 v[68:69], 0
    v_mov_b64 v[70:71], 0
    s_add_u32 s7, s23, 0x80000
    buffer_load_dwordx4 v[16:19], v2, s[8:11], s7 offen sc1
    buffer_load_dwordx4 v[20:23], v2, s[8:11], s7 offen offset:1024 sc1
    s_waitcnt vmcnt(2)
L_slow_step:
    v_readlane_b32 s36, v15, 33
    s_add_u32 s24, s23, 0x82100
    s_cmp_eq_u32 s36, 0
    s_cbranch_scc1 L_slow_refresh
L_slow_fresh:
    s_add_u32 s29, s23, s25
    s_add_u32 s30, s23, s39
    s_xor_b32 s28, s27, 1
    s_add_u32 s90, s22, 1
    s_nop 15
L_slow_retrym:
    buffer_load_dwordx4 v[16:19], v2, s[8:11], s7 offen sc1
    buffer_load_dwordx4 v[20:23], v2, s[8:11], s7 offen offset:1024 sc1
L_slow_prem:
    s_add_u32 s32, s32, 1
    s_cmp_gt_u32 s32, 200000
    s_cselect_b32 s94, -1, -2
    v_xor_b32 v28, 0x800, v2
    v_xor_b32 v44, 0x1800, v2
    v_mov_b64 v[48:49], 0
    v_mov_b64 v[50:51], 0
    v_mov_b64 v[52:53], 0
    v_mov_b64 v[54:55], 0
L_slow_waitm:
    s_waitcnt vmcnt(3) lgkmcnt(0)
L_slow_gotm:
    v_max3_u32 v14, v16, v17, v18
    v_max_u32 v14, v14, v19
    v_smfmac_f32_16x16x64_bf16 v[48:51], v[16:19], v[104:111], v1
    s_waitcnt vmcnt(2)
    v_max3_u32 v14, v14, v20, v21
    v_smfmac_f32_16x16x64_bf16 v[52:55], v[16:19], v[112:119], v1
    v_max3_u32 v14, v14, v22, v23
    v_cmp_lt_u32 vcc, s94, v14
    v_smfmac_f32_16x16x64_bf16 v[48:51], v[20:23], v[88:95], v1
    ds_write_b128 v2, v[16:19] offset:0
    s_cbranch_vccnz L_slow_retrym
    v_smfmac_f32_16x16x64_bf16 v[52:55], v[20:23], v[96:103], v1
    ds_write_b128 v2, v[20:23] offset:1024
    v_smfmac_f32_16x16x64_bf16 v[56:59], v[16:19], v[72:79], v1
    buffer_load_dwordx4 v[104:107], v3, s[8:11], s29 offen offset:0 sc1
    buffer_load_dwordx4 v[120:123], v3, s[8:11], s30 offen offset:0 sc1
    v_smfmac_f32_16x16x64_bf16 v[60:63], v[16:19], v[80:87], v1
    buffer_load_dwordx4 v[108:111], v3, s[8:11], s29 offen offset:1024 sc1
    buffer_load_dwordx4 v[124:127], v3, s[8:11], s30 offen offset:1024 sc1
    v_smfmac_f32_16x16x64_bf16 v[56:59], v[20:23], a[80:87], v1
    buffer_load_dwordx4 v[112:115], v3, s[8:11], s29 offen offset:2048 sc1
    buffer_load_dwordx4 v[116:119], v3, s[8:11], s29 offen offset:3072 sc1
    v_smfmac_f32_16x16x64_bf16 v[60:63], v[20:23], a[88:95], v1
    s_waitcnt lgkmcnt(0)
    s_barrier
    ds_read_b128 v[24:27], v28 offset:0
    v_smfmac_f32_16x16x64_bf16 v[64:67], v[16:19], a[160:167], v1
    ds_read_b128 v[28:31], v28 offset:1024
    v_smfmac_f32_16x16x64_bf16 v[68:71], v[16:19], a[168:175], v1
    buffer_load_dword v15, v0, s[8:11], s24 offen sc1
    v_smfmac_f32_16x16x64_bf16 v[64:67], v[20:23], a[176:183], v1
    ds_read_b128 v[32:35], v8 offset:0
    v_smfmac_f32_16x16x64_bf16 v[68:71], v[20:23], a[184:191], v1
    ds_read_b128 v[36:39], v8 offset:1024
    s_waitcnt lgkmcnt(3)
    v_smfmac_f32_16x16x64_bf16 v[48:51], v[24:27], a[0:7], v1
    ds_read_b128 v[40:43], v44 offset:0
    v_smfmac_f32_16x16x64_bf16 v[52:55], v[24:27], a[8:15], v1
    ds_read_b128 v[44:47], v44 offset:1024
    s_waitcnt lgkmcnt(4)
    v_smfmac_f32_16x16x64_bf16 v[48:51], v[28:31], a[16:23], v1
    ds_read_b128 v[88:91], v4 offset:12288
    v_smfmac_f32_16x16x64_bf16 v[52:55], v[28:31], a[24:31], v1
    ds_read_b128 v[92:95], v4 offset:13312
    s_waitcnt lgkmcnt(4)
    v_smfmac_f32_16x16x64_bf16 v[48:51], v[32:35], a[32:39], v1
    ds_read_b128 v[96:99], v4 offset:14336
    v_smfmac_f32_16x16x64_bf16 v[52:55], v[32:35], a[40:47], v1
    ds_read_b128 v[100:103], v4 offset:15360
    s_waitcnt lgkmcnt(4)
    v_smfmac_f32_16x16x64_bf16 v[48:51], v[36:39], a[48:55], v1
    v_smfmac_f32_16x16x64_bf16 v[52:55], v[36:39], a[56:63], v1
    ds_read_b128 v[72:75], v4 offset:16384
    v_smfmac_f32_16x16x64_bf16 v[48:51], v[40:43], a[64:71], v1
    v_smfmac_f32_16x16x64_bf16 v[52:55], v[40:43], a[72:79], v1
    ds_read_b128 v[76:79], v4 offset:17408
    s_waitcnt lgkmcnt(2)
    v_smfmac_f32_16x16x64_bf16 v[48:51], v[44:47], v[88:95], v1
    ds_read_b128 v[80:83], v4 offset:18432
    v_smfmac_f32_16x16x64_bf16 v[52:55], v[44:47], v[96:103], v1
    ds_read_b128 v[84:87], v4 offset:19456
    v_smfmac_f32_16x16x64_bf16 v[56:59], v[28:31], a[96:103], v1
    ds_read_b128 v[88:91], v4 offset:20480
    v_smfmac_f32_16x16x64_bf16 v[60:63], v[28:31], a[104:111], v1
    ds_read_b128 v[92:95], v4 offset:21504
    v_smfmac_f32_16x16x64_bf16 v[56:59], v[32:35], a[112:119], v1
    ds_read_b128 v[96:99], v4 offset:22528
    v_add_f32 v48, v48, v50
    v_add_f32 v49, v49, v51
    v_smfmac_f32_16x16x64_bf16 v[60:63], v[32:35], a[120:127], v1
    ds_read_b128 v[100:103], v4 offset:23552
    v_add_f32 v52, v52, v54
    v_add_f32 v53, v53, v55
    v_smfmac_f32_16x16x64_bf16 v[56:59], v[36:39], a[128:135], v1
    s_waitcnt lgkmcnt(4)
    v_cvt_pk_bf16_f32 v50, v48, v52
    v_cvt_pk_bf16_f32 v51, v49, v53
    v_smfmac_f32_16x16x64_bf16 v[56:59], v[24:27], v[72:79], v1
    ds_write2_b32 v5, v50, v51 offset0:0 offset1:72
    v_smfmac_f32_16x16x64_bf16 v[60:63], v[24:27], v[80:87], v1
    v_smfmac_f32_16x16x64_bf16 v[60:63], v[36:39], a[136:143], v1
    v_smfmac_f32_16x16x64_bf16 v[56:59], v[40:43], a[144:151], v1
    buffer_store_dword v12, v10, s[8:11], s31 offen sc1
    v_smfmac_f32_16x16x64_bf16 v[60:63], v[40:43], a[152:159], v1
    s_waitcnt lgkmcnt(0)
    s_barrier
    v_smfmac_f32_16x16x64_bf16 v[56:59], v[44:47], v[88:95], v1
    ds_read_b128 v[72:75], v6 offset:0
    v_smfmac_f32_16x16x64_bf16 v[60:63], v[44:47], v[96:103], v1
    ds_read_b128 v[76:79], v6 offset:64
    v_smfmac_f32_16x16x64_bf16 v[64:67], v[24:27], a[192:199], v1
    ds_read_b128 v[80:83], v6 offset:128
    v_smfmac_f32_16x16x64_bf16 v[68:71], v[24:27], a[200:207], v1
    ds_read_b128 v[84:87], v6 offset:192
    s_waitcnt vmcnt(2) lgkmcnt(3)
    v_mfma_f32_16x16x32_bf16 v[48:51], v[104:107], v[72:75], 0
    s_waitcnt lgkmcnt(2)
    v_add_f32 v56, v56, v58
    v_add_f32 v57, v57, v59
    v_mfma_f32_16x16x32_bf16 v[48:51], v[108:111], v[76:79], v[48:51]
    s_waitcnt lgkmcnt(1)
    v_add_f32 v60, v60, v62
    v_add_f32 v61, v61, v63
    v_mfma_f32_16x16x32_bf16 v[48:51], v[112:115], v[80:83], v[48:51]
    s_waitcnt lgkmcnt(0)
    v_cvt_pk_bf16_f32 v58, v56, v60
    v_cvt_pk_bf16_f32 v59, v57, v61
    v_mfma_f32_16x16x32_bf16 v[48:51], v[116:119], v[84:87], v[48:51]
    ds_write2_b32 v7, v58, v59 offset0:0 offset1:72
    v_smfmac_f32_16x16x64_bf16 v[64:67], v[28:31], a[208:215], v1
    v_mov_b64 v[104:105], s[4:5]
    v_smfmac_f32_16x16x64_bf16 v[68:71], v[28:31], a[216:223], v1
    s_nop 1
    v_mov_b64 v[106:107], s[4:5]
    v_smfmac_f32_16x16x64_bf16 v[64:67], v[32:35], a[224:231], v1
    v_exp_f32 v48, v48
    v_smfmac_f32_16x16x64_bf16 v[68:71], v[32:35], a[232:239], v1
    s_waitcnt lgkmcnt(0)
    s_barrier
    v_exp_f32 v49, v49
    v_smfmac_f32_16x16x64_bf16 v[64:67], v[36:39], a[240:247], v1
    ds_read_b128 v[88:91], v6 offset:2304
    v_exp_f32 v50, v50
    v_smfmac_f32_16x16x64_bf16 v[68:71], v[36:39], a[248:255], v1
    ds_read_b128 v[92:95], v6 offset:2368
    v_exp_f32 v51, v51
    v_smfmac_f32_16x16x64_bf16 v[64:67], v[40:43], v[128:135], v1
    ds_read_b128 v[96:99], v6 offset:2432
    v_cvt_pk_bf16_f32 v108, v48, v49
    v_cvt_pk_bf16_f32 v109, v50, v51
    v_smfmac_f32_16x16x64_bf16 v[68:71], v[40:43], v[136:143], v1
    ds_read_b128 v[100:103], v6 offset:2496
    ds_write_b64 v2, v[108:109] offset:8192
    s_waitcnt lgkmcnt(4)
    v_mfma_f32_16x16x32_bf16 v[52:55], v[88:91], v[72:75], 0
    s_waitcnt lgkmcnt(3)
    v_mov_b32 v113, 0
    v_mov_b32 v115, 0
    v_mfma_f32_16x16x32_bf16 v[52:55], v[92:95], v[76:79], v[52:55]
    s_waitcnt lgkmcnt(2)
    v_mov_b32 v117, 0
    v_mov_b64 v[16:17], 0
    v_mfma_f32_16x16x32_bf16 v[52:55], v[96:99], v[80:83], v[52:55]
    s_waitcnt lgkmcnt(1)
    v_mov_b64 v[18:19], 0
    v_mov_b64 v[20:21], 0
    v_mfma_f32_16x16x32_bf16 v[52:55], v[100:103], v[84:87], v[52:55]
    s_waitcnt lgkmcnt(0)
    s_barrier
    v_smfmac_f32_16x16x64_bf16 v[64:67], v[44:47], v[144:151], v1
    ds_read_b64 v[110:111], v8 offset:8192
    v_mov_b64 v[22:23], 0
    v_smfmac_f32_16x16x64_bf16 v[68:71], v[44:47], v[152:159], v1
    v_mov_b64 v[24:25], 0
    v_mov_b64 v[26:27], 0
    v_mul_f32 v52, s33, v52
    v_mul_f32 v53, s33, v53
    v_exp_f32 v52, v52
    s_waitcnt lgkmcnt(0)
    v_mfma_f32_16x16x32_bf16 v[48:51], v[104:107], v[108:111], 0
    v_exp_f32 v53, v53
    v_add_f32 v64, v64, v66
    v_mfma_f32_16x16x32_bf16 v[56:59], v[120:123], v[108:111], 0
    v_cvt_pk_bf16_f32 v112, v52, v53
    v_add_f32 v65, v65, v67
    v_mfma_f32_16x16x32_bf16 v[60:63], v[124:127], v[108:111], 0
    v_cvt_pk_bf16_f32 v114, v64, v65
    v_add_f32 v68, v68, v70
    v_mfma_f32_16x16x16_bf16 v[48:51], v[104:105], v[112:113], v[48:51]
    v_add_f32 v69, v69, v71
    v_cvt_pk_bf16_f32 v116, v68, v69
    v_mfma_f32_16x16x16_bf16 v[56:59], v[114:115], v[112:113], v[56:59]
    v_mov_b64 v[28:29], 0
    v_mov_b64 v[30:31], 0
    v_mfma_f32_16x16x16_bf16 v[60:63], v[116:117], v[112:113], v[60:63]
    v_bitop3_b32 v32, v13, s96, -9 bitop3:0x28
    v_bitop3_b32 v36, v13, s97, -9 bitop3:0x28
    v_rcp_f32 v118, v48
    v_bitop3_b32 v40, v13, s98, -9 bitop3:0x28
    v_max_f32 v14, v118, v48
    v_cmp_nge_f32 vcc, s40, v14
    v_pk_mul_f32 v[56:57], v[56:57], v[118:119] op_sel_hi:[1,0]
    v_pk_mul_f32 v[58:59], v[58:59], v[118:119] op_sel_hi:[1,0]
    v_pk_mul_f32 v[60:61], v[60:61], v[118:119] op_sel_hi:[1,0]
    v_pk_mul_f32 v[62:63], v[62:63], v[118:119] op_sel_hi:[1,0]
    v_cvt_pk_bf16_f32 v52, v56, v60
    v_cvt_pk_bf16_f32 v54, v58, v62
    v_cvt_pk_bf16_f32 v53, v57, v61
    v_cvt_pk_bf16_f32 v55, v59, v63
L_slow_rejoin:
    v_cndmask_b32 v50, v52, v54, s[92:93]
    v_cndmask_b32 v51, v53, v55, s[92:93]
    ds_write_b64 v13, v[50:51] offset:9216
    v_smfmac_f32_16x16x64_bf16 v[16:19], v[52:55], v[160:167], v1
    v_smfmac_f32_16x16x64_bf16 v[20:23], v[52:55], v[168:175], v1
    s_waitcnt lgkmcnt(0)
    s_barrier
    ds_read_b128 v[32:35], v32 offset:9216
    ds_read_b128 v[36:39], v36 offset:9216
    v_smfmac_f32_16x16x64_bf16 v[24:27], v[52:55], v[176:183], v1
    ds_read_b128 v[40:43], v40 offset:9216
    v_smfmac_f32_16x16x64_bf16 v[28:31], v[52:55], v[184:191], v1
    ds_read_b128 v[88:91], v4 offset:24576
    ds_read_b128 v[92:95], v4 offset:25600
    s_waitcnt lgkmcnt(4)
    v_smfmac_f32_16x16x64_bf16 v[16:19], v[32:35], v[192:199], v1
    ds_read_b128 v[96:99], v4 offset:26624
    s_waitcnt lgkmcnt(4)
    v_smfmac_f32_16x16x64_bf16 v[16:19], v[36:39], v[216:223], v1
    ds_read_b128 v[100:103], v4 offset:27648
    s_waitcnt lgkmcnt(4)
    v_smfmac_f32_16x16x64_bf16 v[16:19], v[40:43], v[240:247], v1
    ds_read_b128 v[72:75], v4 offset:28672
    s_cmp_lg_u64 vcc, 0
    v_smfmac_f32_16x16x64_bf16 v[20:23], v[32:35], v[200:207], v1
    ds_read_b128 v[76:79], v4 offset:29696
    s_cselect_b32 s60, s28, s27
    v_smfmac_f32_16x16x64_bf16 v[20:23], v[36:39], v[224:231], v1
    ds_read_b128 v[80:83], v4 offset:30720
    s_nop 0
    v_cvt_pk_bf16_f32 v56, v16, v18
    v_smfmac_f32_16x16x64_bf16 v[20:23], v[40:43], v[248:255], v1
    ds_read_b128 v[84:87], v4 offset:31744
    v_cvt_pk_bf16_f32 v57, v17, v19
    v_and_or_b32 v56, v56, -2, s60
    v_smfmac_f32_16x16x64_bf16 v[24:27], v[32:35], v[208:215], v1
    buffer_store_dwordx2 v[56:57], v9, s[8:11], 0 offen offset:0 sc1
    v_smfmac_f32_16x16x64_bf16 v[24:27], v[36:39], v[232:239], v1
    s_waitcnt lgkmcnt(4)
    s_nop 0
    v_cvt_pk_bf16_f32 v58, v20, v22
    v_smfmac_f32_16x16x64_bf16 v[24:27], v[40:43], v[88:95], v1
    ds_read_b128 v[64:67], v3 offset:23040
    v_cvt_pk_bf16_f32 v59, v21, v23
    v_and_or_b32 v58, v58, -2, s60
    v_smfmac_f32_16x16x64_bf16 v[28:31], v[32:35], v[96:103], v1
    buffer_store_dwordx2 v[58:59], v9, s[8:11], 0 offen offset:2048 sc1
    s_waitcnt lgkmcnt(1)
    v_smfmac_f32_16x16x64_bf16 v[28:31], v[36:39], v[72:79], v1
    s_nop 1
    v_cvt_pk_bf16_f32 v60, v24, v26
    v_smfmac_f32_16x16x64_bf16 v[28:31], v[40:43], v[80:87], v1
    s_nop 2
    v_cvt_pk_bf16_f32 v61, v25, v27
    v_and_or_b32 v60, v60, -2, s60
    buffer_store_dwordx2 v[60:61], v9, s[8:11], s26 offen offset:0 sc1
    s_nop 1
    v_cvt_pk_bf16_f32 v62, v28, v30
    v_cvt_pk_bf16_f32 v63, v29, v31
    v_and_or_b32 v62, v62, -2, s60
    buffer_store_dwordx2 v[62:63], v9, s[8:11], s26 offen offset:2048 sc1
L_slow_stored:
    s_cmp_lg_u32 s60, s27
    s_cbranch_scc1 L_slow_safe
    ds_read_b128 v[104:107], v4 offset:0
    ds_read_b128 v[108:111], v4 offset:1024
    ds_read_b128 v[112:115], v4 offset:2048
    ds_read_b128 v[116:119], v4 offset:3072
    ds_read_b128 v[88:91], v4 offset:4096
    ds_read_b128 v[92:95], v4 offset:5120
    ds_read_b128 v[96:99], v4 offset:6144
    ds_read_b128 v[100:103], v4 offset:7168
    ds_read_b128 v[72:75], v4 offset:8192
    ds_read_b128 v[76:79], v4 offset:9216
    ds_read_b128 v[80:83], v4 offset:10240
    ds_read_b128 v[84:87], v4 offset:11264
    s_cmp_lt_u32 s21, 1
    s_cbranch_scc1 L_slow_pollp
    s_nop 11
    s_cmp_lt_u32 s21, 2
    s_cbranch_scc1 L_slow_pollp
    s_nop 11
    s_cmp_lt_u32 s21, 3
    s_cbranch_scc1 L_slow_pollp
    s_nop 11
L_slow_pollp:
    buffer_load_dwordx4 v[120:123], v2, s[8:11], s6 offen sc1
    buffer_load_dwordx4 v[124:127], v2, s[8:11], s6 offen offset:1024 sc1
    v_mov_b64 v[56:57], 0
    v_mov_b64 v[58:59], 0
    v_mov_b64 v[60:61], 0
    v_mov_b64 v[62:63], 0
    s_nop 15
    s_nop 15
    buffer_load_dwordx4 v[32:35], v2, s[8:11], s6 offen sc1
    buffer_load_dwordx4 v[36:39], v2, s[8:11], s6 offen offset:1024 sc1
L_slow_prep:
    s_add_u32 s7, s24, 0x80000
    s_waitcnt vmcnt(3) lgkmcnt(0)
    v_mfma_f32_16x16x32_bf16 v[68:71], v[64:67], v[120:123], 0
    v_bitop3_b32 v14, v120, v122, s27 bitop3:0x7e
    s_waitcnt vmcnt(2)
    v_mfma_f32_16x16x32_bf16 v[68:71], v[64:67], v[124:127], v[68:71]
    v_bitop3_b32 v11, v124, v126, s27 bitop3:0x7e
    v_bitop3_b32 v14, v14, v11, 1 bitop3:0xa8
    v_cmp_ne_u32 vcc, 0, v14
    s_nop 2
    s_cmp_eq_u64 vcc, 0
    s_cselect_b32 s36, s24, s61
    v_add_f32_dpp v68, v68, v68 row_ror:8 row_mask:0xf bank_mask:0xf
    v_add_f32_dpp v69, v69, v69 row_ror:8 row_mask:0xf bank_mask:0xf
    s_nop 0
    v_add_f32_dpp v68, v68, v68 row_ror:4 row_mask:0xf bank_mask:0xf
    v_add_f32_dpp v69, v69, v69 row_ror:4 row_mask:0xf bank_mask:0xf
    v_cvt_pk_bf16_f32 v12, v68, v69
    buffer_store_dword v12, v10, s[8:11], s36 offen sc1
    s_cbranch_scc1 L_slow_gotp
L_slow_retryp:
    buffer_load_dwordx4 v[120:123], v2, s[8:11], s6 offen sc1
    buffer_load_dwordx4 v[124:127], v2, s[8:11], s6 offen offset:1024 sc1
    s_waitcnt vmcnt(4) lgkmcnt(0)
    v_mfma_f32_16x16x32_bf16 v[68:71], v[64:67], v[32:35], 0
    v_bitop3_b32 v14, v32, v34, s27 bitop3:0x7e
    s_waitcnt vmcnt(3)
    v_mfma_f32_16x16x32_bf16 v[68:71], v[64:67], v[36:39], v[68:71]
    v_bitop3_b32 v11, v36, v38, s27 bitop3:0x7e
    v_bitop3_b32 v14, v14, v11, 1 bitop3:0xa8
    v_cmp_ne_u32 vcc, 0, v14
    s_nop 2
    s_cmp_eq_u64 vcc, 0
    s_cselect_b32 s36, s24, s61
    v_add_f32_dpp v68, v68, v68 row_ror:8 row_mask:0xf bank_mask:0xf
    v_add_f32_dpp v69, v69, v69 row_ror:8 row_mask:0xf bank_mask:0xf
    s_nop 0
    v_add_f32_dpp v68, v68, v68 row_ror:4 row_mask:0xf bank_mask:0xf
    v_add_f32_dpp v69, v69, v69 row_ror:4 row_mask:0xf bank_mask:0xf
    v_cvt_pk_bf16_f32 v12, v68, v69
    buffer_store_dword v12, v10, s[8:11], s36 offen sc1
    s_cbranch_scc1 L_slow_gotp
    buffer_load_dwordx4 v[32:35], v2, s[8:11], s6 offen sc1
    buffer_load_dwordx4 v[36:39], v2, s[8:11], s6 offen offset:1024 sc1
    s_waitcnt vmcnt(4) lgkmcnt(0)
    v_mfma_f32_16x16x32_bf16 v[68:71], v[64:67], v[120:123], 0
    v_bitop3_b32 v14, v120, v122, s27 bitop3:0x7e
    s_waitcnt vmcnt(3)
    v_mfma_f32_16x16x32_bf16 v[68:71], v[64:67], v[124:127], v[68:71]
    v_bitop3_b32 v11, v124, v126, s27 bitop3:0x7e
    v_bitop3_b32 v14, v14, v11, 1 bitop3:0xa8
    v_cmp_ne_u32 vcc, 0, v14
    s_nop 2
    s_cmp_eq_u64 vcc, 0
    s_cselect_b32 s36, s24, s61
    v_add_f32_dpp v68, v68, v68 row_ror:8 row_mask:0xf bank_mask:0xf
    v_add_f32_dpp v69, v69, v69 row_ror:8 row_mask:0xf bank_mask:0xf
    s_nop 0
    v_add_f32_dpp v68, v68, v68 row_ror:4 row_mask:0xf bank_mask:0xf
    v_add_f32_dpp v69, v69, v69 row_ror:4 row_mask:0xf bank_mask:0xf
    v_cvt_pk_bf16_f32 v12, v68, v69
    buffer_store_dword v12, v10, s[8:11], s36 offen sc1
    s_cbranch_scc1 L_slow_gotp
    s_add_u32 s32, s32, 1
    s_cmp_le_u32 s32, 200000
    s_cbranch_scc1 L_slow_retryp
    s_mov_b32 s36, s24
    buffer_store_dword v12, v10, s[8:11], s36 offen sc1
L_slow_gotp:
    s_add_u32 s31, s31, 0x2000
    s_cmp_ge_u32 s90, 63
    s_cbranch_scc1 L_slow_last
    s_mov_b32 s23, s24
    s_mov_b32 s22, s90
    s_mov_b32 s27, s28
    v_mov_b64 v[64:65], 0
    v_mov_b64 v[66:67], 0
    v_mov_b64 v[68:69], 0
    v_mov_b64 v[70:71], 0
    s_nop 15
    s_nop 11
    buffer_load_dwordx4 v[16:19], v2, s[8:11], s7 offen sc1
    buffer_load_dwordx4 v[20:23], v2, s[8:11], s7 offen offset:1024 sc1
    s_branch L_slow_step
L_slow_last:
    buffer_store_dword v12, v10, s[8:11], s31 offen sc1
    s_branch L_slow_done
L_slow_refresh:
    buffer_load_dword v15, v0, s[8:11], s23 offen sc1
    s_add_u32 s32, s32, 1
    s_cmp_le_u32 s32, 200000
    s_waitcnt vmcnt(0)
    s_cbranch_scc1 L_slow_step
    s_branch L_slow_fresh
L_slow_safe:
    s_nop 11
    s_waitcnt vmcnt(0) lgkmcnt(0)
    s_barrier
    ds_read_b128 v[72:75], v6 offset:0
    ds_read_b128 v[88:91], v6 offset:2304
    ds_read_b128 v[76:79], v6 offset:64
    ds_read_b128 v[92:95], v6 offset:2368
    ds_read_b128 v[80:83], v6 offset:128
    ds_read_b128 v[96:99], v6 offset:2432
    ds_read_b128 v[84:87], v6 offset:192
    ds_read_b128 v[100:103], v6 offset:2496
    s_xor_b32 s36, s25, 0x1000
    s_add_u32 s36, s36, s23
    buffer_load_dwordx4 v[16:19], v3, s[8:11], s29 offen offset:0 sc1
    buffer_load_dwordx4 v[32:35], v3, s[8:11], s36 offen offset:0 sc1
    buffer_load_dwordx4 v[20:23], v3, s[8:11], s29 offen offset:1024 sc1
    buffer_load_dwordx4 v[36:39], v3, s[8:11], s36 offen offset:1024 sc1
    buffer_load_dwordx4 v[24:27], v3, s[8:11], s29 offen offset:2048 sc1
    buffer_load_dwordx4 v[40:43], v3, s[8:11], s36 offen offset:2048 sc1
    buffer_load_dwordx4 v[28:31], v3, s[8:11], s29 offen offset:3072 sc1
    buffer_load_dwordx4 v[44:47], v3, s[8:11], s36 offen offset:3072 sc1
    s_waitcnt vmcnt(0) lgkmcnt(0)
    v_mfma_f32_16x16x32_bf16 v[48:51], v[16:19], v[72:75], 0
    v_mfma_f32_16x16x32_bf16 v[48:51], v[20:23], v[76:79], v[48:51]
    v_mfma_f32_16x16x32_bf16 v[48:51], v[24:27], v[80:83], v[48:51]
    v_mfma_f32_16x16x32_bf16 v[48:51], v[28:31], v[84:87], v[48:51]
    v_mfma_f32_16x16x32_bf16 v[52:55], v[32:35], v[72:75], 0
    v_mfma_f32_16x16x32_bf16 v[52:55], v[36:39], v[76:79], v[52:55]
    v_mfma_f32_16x16x32_bf16 v[52:55], v[40:43], v[80:83], v[52:55]
    v_mfma_f32_16x16x32_bf16 v[52:55], v[44:47], v[84:87], v[52:55]
    v_mfma_f32_16x16x32_bf16 v[56:59], v[88:91], v[72:75], 0
    v_mfma_f32_16x16x32_bf16 v[56:59], v[92:95], v[76:79], v[56:59]
    v_mfma_f32_16x16x32_bf16 v[56:59], v[96:99], v[80:83], v[56:59]
    v_mfma_f32_16x16x32_bf16 v[56:59], v[100:103], v[84:87], v[56:59]
    s_nop 7
    v_mul_f32 v56, s33, v56
    v_mul_f32 v57, s33, v57
    v_max3_f32 v16, v48, v49, v50
    v_max3_f32 v16, v16, v51, v52
    v_max3_f32 v16, v16, v53, v54
    v_max3_f32 v16, v16, v55, v56
    v_max_f32 v16, v16, v57
    v_mov_b32 v17, v16
    s_nop 1
    v_permlane16_swap_b32 v16, v17
    v_max_f32 v16, v16, v17
    v_mov_b32 v17, v16
    s_nop 1
    v_permlane32_swap_b32 v16, v17
    v_max_f32 v16, v16, v17
    v_sub_f32 v48, v48, v16
    v_exp_f32 v48, v48
    v_sub_f32 v49, v49, v16
    v_exp_f32 v49, v49
    v_sub_f32 v50, v50, v16
    v_exp_f32 v50, v50
    v_sub_f32 v51, v51, v16
    v_exp_f32 v51, v51
    v_sub_f32 v52, v52, v16
    v_exp_f32 v52, v52
    v_sub_f32 v53, v53, v16
    v_exp_f32 v53, v53
    v_sub_f32 v54, v54, v16
    v_exp_f32 v54, v54
    v_sub_f32 v55, v55, v16
    v_exp_f32 v55, v55
    v_sub_f32 v56, v56, v16
    v_exp_f32 v56, v56
    v_sub_f32 v57, v57, v16
    v_exp_f32 v57, v57
    v_cvt_pk_bf16_f32 v108, v48, v49
    v_cvt_pk_bf16_f32 v109, v50, v51
    v_cvt_pk_bf16_f32 v110, v52, v53
    v_cvt_pk_bf16_f32 v111, v54, v55
    v_cvt_pk_bf16_f32 v112, v56, v57
    s_nop 0
    v_mfma_f32_16x16x32_bf16 v[48:51], v[104:107], v[108:111], 0
    v_mfma_f32_16x16x32_bf16 v[56:59], v[120:123], v[108:111], 0
    v_mfma_f32_16x16x32_bf16 v[60:63], v[124:127], v[108:111], 0
    s_nop 3
    v_mfma_f32_16x16x16_bf16 v[48:51], v[104:105], v[112:113], v[48:51]
    v_mfma_f32_16x16x16_bf16 v[56:59], v[114:115], v[112:113], v[56:59]
    v_mfma_f32_16x16x16_bf16 v[60:63], v[116:117], v[112:113], v[60:63]
    s_nop 5
    v_rcp_f32 v118, v48
    s_nop 0
    v_mul_f32 v56, v56, v118
    v_mul_f32 v57, v57, v118
    v_mul_f32 v58, v58, v118
    v_mul_f32 v59, v59, v118
    v_mul_f32 v60, v60, v118
    v_mul_f32 v61, v61, v118
    v_mul_f32 v62, v62, v118
    v_mul_f32 v63, v63, v118
    v_cvt_pk_bf16_f32 v52, v56, v60
    v_cvt_pk_bf16_f32 v53, v57, v61
    v_cvt_pk_bf16_f32 v54, v58, v62
    v_cvt_pk_bf16_f32 v55, v59, v63
    v_mov_b32 v16, 0
    v_mov_b32 v17, 0
    v_mov_b32 v18, 0
    v_mov_b32 v19, 0
    v_mov_b32 v20, 0
    v_mov_b32 v21, 0
    v_mov_b32 v22, 0
    v_mov_b32 v23, 0
    v_mov_b32 v24, 0
    v_mov_b32 v25, 0
    v_mov_b32 v26, 0
    v_mov_b32 v27, 0
    v_mov_b32 v28, 0
    v_mov_b32 v29, 0
    v_mov_b32 v30, 0
    v_mov_b32 v31, 0
    v_bitop3_b32 v32, v13, s96, -9 bitop3:0x28
    v_bitop3_b32 v36, v13, s97, -9 bitop3:0x28
    v_bitop3_b32 v40, v13, s98, -9 bitop3:0x28
    s_mov_b64 vcc, 0
    s_branch L_slow_rejoin
L_slow_done:
    s_branch L_end
L_worker:
    s_cmp_eq_u32 s3, 7
    s_cbranch_scc1 L_mlp
    s_and_b32 s36, s2, 7
    s_sub_u32 s36, s36, 1
    s_lshl_b32 s36, s36, 5
    s_lshr_b32 s37, s2, 3
    s_add_u32 s36, s36, s37
    s_mul_i32 s20, s36, 10923
    s_lshr_b32 s20, s20, 16
    s_mul_i32 s37, s20, 6
    s_sub_u32 s22, s36, s37
    v_lshrrev_b32 v28, 4, v0
    v_and_b32 v16, 15, v0
    v_lshlrev_b32 v16, 4, v16
    v_lshl_add_u32 v16, v28, 13, v16
    v_bfe_u32 v29, v0, 4, 2
    v_lshlrev_b32 v29, 5, v29
    v_xor_b32 v16, v16, v29
    v_and_b32 v29, 128, v0
    v_xor_b32 v16, v16, v29
    s_lshl_b32 s28, s21, 10
    s_lshl_b32 s3, s20, 8
    s_mov_b32 s76, s52
    s_and_b32 s77, s53, 0xffff
    s_mov_b32 s78, 0x400000
    s_mov_b32 s79, 0x20000
    s_add_u32 m0, s28, 32768
    s_add_u32 s37, s3, 0x0
    buffer_load_dwordx4 v16, s[76:79], s37 offen lds
    s_add_u32 m0, s28, 36864
    s_add_u32 s37, s3, 0x20000
    buffer_load_dwordx4 v16, s[76:79], s37 offen lds
    s_add_u32 m0, s28, 65536
    s_add_u32 s37, s3, 0x40000
    buffer_load_dwordx4 v16, s[76:79], s37 offen lds
    s_add_u32 m0, s28, 69632
    s_add_u32 s37, s3, 0x60000
    buffer_load_dwordx4 v16, s[76:79], s37 offen lds
    s_add_u32 m0, s28, 98304
    s_add_u32 s37, s3, 0x80000
    buffer_load_dwordx4 v16, s[76:79], s37 offen lds
    s_add_u32 m0, s28, 102400
    s_add_u32 s37, s3, 0xa0000
    buffer_load_dwordx4 v16, s[76:79], s37 offen lds
    s_add_u32 m0, s28, 131072
    s_add_u32 s37, s3, 0xc0000
    buffer_load_dwordx4 v16, s[76:79], s37 offen lds
    s_add_u32 m0, s28, 135168
    s_add_u32 s37, s3, 0xe0000
    buffer_load_dwordx4 v16, s[76:79], s37 offen lds
    s_add_u32 m0, s28, 40960
    s_add_u32 s37, s3, 0x100000
    buffer_load_dwordx4 v16, s[76:79], s37 offen lds
    s_add_u32 m0, s28, 45056
    s_add_u32 s37, s3, 0x120000
    buffer_load_dwordx4 v16, s[76:79], s37 offen lds
    s_add_u32 m0, s28, 73728
    s_add_u32 s37, s3, 0x140000
    buffer_load_dwordx4 v16, s[76:79], s37 offen lds
    s_add_u32 m0, s28, 77824
    s_add_u32 s37, s3, 0x160000
    buffer_load_dwordx4 v16, s[76:79], s37 offen lds
    s_add_u32 m0, s28, 106496
    s_add_u32 s37, s3, 0x180000
    buffer_load_dwordx4 v16, s[76:79], s37 offen lds
    s_add_u32 m0, s28, 110592
    s_add_u32 s37, s3, 0x1a0000
    buffer_load_dwordx4 v16, s[76:79], s37 offen lds
    s_add_u32 m0, s28, 139264
    s_add_u32 s37, s3, 0x1c0000
    buffer_load_dwordx4 v16, s[76:79], s37 offen lds
    s_add_u32 m0, s28, 143360
    s_add_u32 s37, s3, 0x1e0000
    buffer_load_dwordx4 v16, s[76:79], s37 offen lds
    s_add_u32 m0, s28, 49152
    s_add_u32 s37, s3, 0x200000
    buffer_load_dwordx4 v16, s[76:79], s37 offen lds
    s_add_u32 m0, s28, 53248
    s_add_u32 s37, s3, 0x220000
    buffer_load_dwordx4 v16, s[76:79], s37 offen lds
    s_add_u32 m0, s28, 81920
    s_add_u32 s37, s3, 0x240000
    buffer_load_dwordx4 v16, s[76:79], s37 offen lds
    s_add_u32 m0, s28, 86016
    s_add_u32 s37, s3, 0x260000
    buffer_load_dwordx4 v16, s[76:79], s37 offen lds
    s_add_u32 m0, s28, 114688
    s_add_u32 s37, s3, 0x280000
    buffer_load_dwordx4 v16, s[76:79], s37 offen lds
    s_add_u32 m0, s28, 118784
    s_add_u32 s37, s3, 0x2a0000
    buffer_load_dwordx4 v16, s[76:79], s37 offen lds
    s_add_u32 m0, s28, 147456
    s_add_u32 s37, s3, 0x2c0000
    buffer_load_dwordx4 v16, s[76:79], s37 offen lds
    s_add_u32 m0, s28, 151552
    s_add_u32 s37, s3, 0x2e0000
    buffer_load_dwordx4 v16, s[76:79], s37 offen lds
    s_add_u32 m0, s28, 57344
    s_add_u32 s37, s3, 0x300000
    buffer_load_dwordx4 v16, s[76:79], s37 offen lds
    s_add_u32 m0, s28, 61440
    s_add_u32 s37, s3, 0x320000
    buffer_load_dwordx4 v16, s[76:79], s37 offen lds
    s_add_u32 m0, s28, 90112
    s_add_u32 s37, s3, 0x340000
    buffer_load_dwordx4 v16, s[76:79], s37 offen lds
    s_add_u32 m0, s28, 94208
    s_add_u32 s37, s3, 0x360000
    buffer_load_dwordx4 v16, s[76:79], s37 offen lds
    s_add_u32 m0, s28, 122880
    s_add_u32 s37, s3, 0x380000
    buffer_load_dwordx4 v16, s[76:79], s37 offen lds
    s_add_u32 m0, s28, 126976
    s_add_u32 s37, s3, 0x3a0000
    buffer_load_dwordx4 v16, s[76:79], s37 offen lds
    s_add_u32 m0, s28, 155648
    s_add_u32 s37, s3, 0x3c0000
    buffer_load_dwordx4 v16, s[76:79], s37 offen lds
    s_add_u32 m0, s28, 159744
    s_add_u32 s37, s3, 0x3e0000
    buffer_load_dwordx4 v16, s[76:79], s37 offen lds
    v_mov_b32 v20, 0x0
    v_bfe_u32 v14, v0, 0, 1
    s_mov_b32 s38, 0x8
    v_mad_u32_u24 v20, v14, s38, v20
    v_bfe_u32 v14, v0, 1, 1
    s_mov_b32 s38, 0x10
    v_mad_u32_u24 v20, v14, s38, v20
    v_bfe_u32 v14, v0, 2, 1
    s_mov_b32 s38, 0x100
    v_mad_u32_u24 v20, v14, s38, v20
    v_bfe_u32 v14, v0, 3, 1
    s_mov_b32 s38, 0x200
    v_mad_u32_u24 v20, v14, s38, v20
    v_bfe_u32 v14, v0, 4, 1
    s_mov_b32 s38, 0x800
    v_mad_u32_u24 v20, v14, s38, v20
    v_bfe_u32 v14, v0, 5, 1
    s_mov_b32 s38, 0x1000
    v_mad_u32_u24 v20, v14, s38, v20
    v_mov_b32 v30, 0x0
    v_bfe_u32 v14, v0, 2, 1
    s_mov_b32 s38, 0x20
    v_mad_u32_u24 v30, v14, s38, v30
    v_bfe_u32 v14, v0, 3, 1
    s_mov_b32 s38, 0x40
    v_mad_u32_u24 v30, v14, s38, v30
    v_bfe_u32 v14, v0, 4, 1
    s_mov_b32 s38, 0x80
    v_mad_u32_u24 v30, v14, s38, v30
    v_mov_b32 v31, 0x0
    v_bfe_u32 v14, v0, 6, 1
    s_mov_b32 s38, 0x40
    v_mad_u32_u24 v31, v14, s38, v31
    v_bfe_u32 v14, v0, 7, 1
    s_mov_b32 s38, 0x80
    v_mad_u32_u24 v31, v14, s38, v31
    v_xor_b32 v30, v30, v31
    v_add_u32 v30, v30, v20
    v_add_u32 v20, 0x8000, v30
    v_xor_b32 v21, 32, v20
    v_add_u32 v22, 0x10000, v30
    v_xor_b32 v23, 32, v22
    v_add_u32 v24, 0x18000, v30
    v_xor_b32 v25, 32, v24
    v_add_u32 v26, 0x20000, v30
    v_xor_b32 v27, 32, v26
    s_mov_b32 s12, s54
    s_and_b32 s13, s55, 0xffff
    s_mov_b32 s14, 0x400000
    s_mov_b32 s15, 0x20000
    s_lshl_b32 s24, s20, 17
    s_and_b32 s25, s22, 3
    s_lshl_b32 s25, s25, 15
    s_add_u32 s24, s24, s25
    v_lshlrev_b32 v30, 7, v0
    buffer_load_dword v31, v30, s[12:15], s24 offen
    s_mov_b32 s12, s44
    s_and_b32 s13, s45, 0xffff
    s_mov_b32 s14, 0x200000
    s_mov_b32 s15, 0x20000
    s_mov_b32 s60, s82
    s_and_b32 s61, s83, 0xffff
    s_mov_b32 s62, 0x200000
    s_mov_b32 s63, 0x20000
    s_mov_b32 s92, s80
    s_and_b32 s93, s81, 0xffff
    s_mov_b32 s94, 0x400
    s_mov_b32 s95, 0x20000
    v_mov_b32 v1, 0x0
    v_bfe_u32 v14, v0, 0, 1
    s_mov_b32 s38, 0x10
    v_mad_u32_u24 v1, v14, s38, v1
    v_bfe_u32 v14, v0, 1, 1
    s_mov_b32 s38, 0x20
    v_mad_u32_u24 v1, v14, s38, v1
    v_bfe_u32 v14, v0, 2, 1
    s_mov_b32 s38, 0x40
    v_mad_u32_u24 v1, v14, s38, v1
    v_bfe_u32 v14, v0, 3, 1
    s_mov_b32 s38, 0x80
    v_mad_u32_u24 v1, v14, s38, v1
    v_bfe_u32 v14, v0, 4, 1
    s_mov_b32 s38, 0x100
    v_mad_u32_u24 v1, v14, s38, v1
    v_bfe_u32 v14, v0, 5, 1
    s_mov_b32 s38, 0x200
    v_mad_u32_u24 v1, v14, s38, v1
    v_mov_b32 v2, 0x0
    v_bfe_u32 v14, v0, 0, 1
    s_mov_b32 s38, 0x10
    v_mad_u32_u24 v2, v14, s38, v2
    v_bfe_u32 v14, v0, 1, 1
    s_mov_b32 s38, 0x20
    v_mad_u32_u24 v2, v14, s38, v2
    v_bfe_u32 v14, v0, 2, 1
    s_mov_b32 s38, 0x40
    v_mad_u32_u24 v2, v14, s38, v2
    v_bfe_u32 v14, v0, 3, 1
    s_mov_b32 s38, 0x80
    v_mad_u32_u24 v2, v14, s38, v2
    v_bfe_u32 v14, v0, 4, 1
    s_mov_b32 s38, 0x100
    v_mad_u32_u24 v2, v14, s38, v2
    v_bfe_u32 v14, v0, 5, 1
    s_mov_b32 s38, 0x200
    v_mad_u32_u24 v2, v14, s38, v2
    v_bfe_u32 v14, v0, 6, 1
    s_mov_b32 s38, 0x800
    v_mad_u32_u24 v2, v14, s38, v2
    v_bfe_u32 v14, v0, 7, 1
    s_mov_b32 s38, 0x1000
    v_mad_u32_u24 v2, v14, s38, v2
    v_mov_b32 v9, 0x0
    v_bfe_u32 v14, v0, 0, 1
    s_mov_b32 s38, 0x10
    v_mad_u32_u24 v9, v14, s38, v9
    v_bfe_u32 v14, v0, 1, 1
    s_mov_b32 s38, 0x20
    v_mad_u32_u24 v9, v14, s38, v9
    v_bfe_u32 v14, v0, 2, 1
    s_mov_b32 s38, 0x40
    v_mad_u32_u24 v9, v14, s38, v9
    v_bfe_u32 v14, v0, 3, 1
    s_mov_b32 s38, 0x80
    v_mad_u32_u24 v9, v14, s38, v9
    v_bfe_u32 v14, v0, 4, 1
    s_mov_b32 s38, 0x100
    v_mad_u32_u24 v9, v14, s38, v9
    v_bfe_u32 v14, v0, 5, 1
    s_mov_b32 s38, 0x200
    v_mad_u32_u24 v9, v14, s38, v9
    v_bfe_u32 v14, v0, 6, 1
    s_mov_b32 s38, 0x400
    v_mad_u32_u24 v9, v14, s38, v9
    v_bfe_u32 v14, v0, 7, 1
    s_mov_b32 s38, 0x800
    v_mad_u32_u24 v9, v14, s38, v9
    v_mov_b32 v7, 0x8000
    v_bfe_u32 v14, v0, 0, 1
    s_mov_b32 s38, 0x10
    v_mad_u32_u24 v7, v14, s38, v7
    v_bfe_u32 v14, v0, 1, 1
    s_mov_b32 s38, 0x20
    v_mad_u32_u24 v7, v14, s38, v7
    v_bfe_u32 v14, v0, 2, 1
    s_mov_b32 s38, 0x40
    v_mad_u32_u24 v7, v14, s38, v7
    v_bfe_u32 v14, v0, 3, 1
    s_mov_b32 s38, 0x80
    v_mad_u32_u24 v7, v14, s38, v7
    v_bfe_u32 v14, v0, 4, 1
    s_mov_b32 s38, 0x100
    v_mad_u32_u24 v7, v14, s38, v7
    v_bfe_u32 v14, v0, 5, 1
    s_mov_b32 s38, 0x200
    v_mad_u32_u24 v7, v14, s38, v7
    v_bfe_u32 v14, v0, 6, 1
    s_mov_b32 s38, 0x8000
    v_mad_u32_u24 v7, v14, s38, v7
    v_bfe_u32 v14, v0, 7, 1
    s_mov_b32 s38, 0x10000
    v_mad_u32_u24 v7, v14, s38, v7
    v_mov_b32 v3, 0x0
    v_bfe_u32 v14, v0, 0, 1
    s_mov_b32 s38, 0x10
    v_mad_u32_u24 v3, v14, s38, v3
    v_bfe_u32 v14, v0, 1, 1
    s_mov_b32 s38, 0x20
    v_mad_u32_u24 v3, v14, s38, v3
    v_bfe_u32 v14, v0, 2, 1
    s_mov_b32 s38, 0x40
    v_mad_u32_u24 v3, v14, s38, v3
    v_bfe_u32 v14, v0, 3, 1
    s_mov_b32 s38, 0x400
    v_mad_u32_u24 v3, v14, s38, v3
    v_bfe_u32 v14, v0, 4, 1
    s_mov_b32 s38, 0x800
    v_mad_u32_u24 v3, v14, s38, v3
    v_bfe_u32 v14, v0, 5, 1
    s_mov_b32 s38, 0x1000
    v_mad_u32_u24 v3, v14, s38, v3
    v_bfe_u32 v14, v0, 6, 1
    s_mov_b32 s38, 0x2000
    v_mad_u32_u24 v3, v14, s38, v3
    v_bfe_u32 v14, v0, 7, 1
    s_mov_b32 s38, 0x4000
    v_mad_u32_u24 v3, v14, s38, v3
    v_mov_b32 v4, 0x0
    v_bfe_u32 v14, v0, 0, 1
    s_mov_b32 s38, 0x100
    v_mad_u32_u24 v4, v14, s38, v4
    v_bfe_u32 v14, v0, 1, 1
    s_mov_b32 s38, 0x200
    v_mad_u32_u24 v4, v14, s38, v4
    v_bfe_u32 v14, v0, 2, 1
    s_mov_b32 s38, 0x400
    v_mad_u32_u24 v4, v14, s38, v4
    v_bfe_u32 v14, v0, 6, 1
    s_mov_b32 s38, 0x80
    v_mad_u32_u24 v4, v14, s38, v4
    v_bfe_u32 v14, v0, 7, 1
    s_mov_b32 s38, 0x4000
    v_mad_u32_u24 v4, v14, s38, v4
    v_lshrrev_b32 v15, 3, v0
    v_xor_b32 v15, v15, v0
    v_and_b32 v15, 7, v15
    v_lshl_add_u32 v4, v15, 4, v4
    v_bfe_u32 v15, v0, 4, 2
    v_lshlrev_b32 v15, 4, v15
    v_xor_b32 v5, v15, v1
    v_xor_b32 v6, 64, v5
    v_mov_b32 v8, 0x5000
    v_bfe_u32 v14, v0, 0, 1
    s_mov_b32 s38, 0x10
    v_mad_u32_u24 v8, v14, s38, v8
    v_bfe_u32 v14, v0, 1, 1
    s_mov_b32 s38, 0x40
    v_mad_u32_u24 v8, v14, s38, v8
    v_bfe_u32 v14, v0, 2, 1
    s_mov_b32 s38, 0x80
    v_mad_u32_u24 v8, v14, s38, v8
    v_bfe_u32 v14, v0, 4, 1
    s_mov_b32 s38, 0x20
    v_mad_u32_u24 v8, v14, s38, v8
    v_bfe_u32 v14, v0, 5, 1
    s_mov_b32 s38, 0x100
    v_mad_u32_u24 v8, v14, s38, v8
    v_mov_b32 v10, 0x0
    v_bfe_u32 v14, v0, 0, 1
    s_mov_b32 s38, 0x10
    v_mad_u32_u24 v10, v14, s38, v10
    v_bfe_u32 v14, v0, 1, 1
    s_mov_b32 s38, 0x20
    v_mad_u32_u24 v10, v14, s38, v10
    v_bfe_u32 v14, v0, 2, 1
    s_mov_b32 s38, 0x40
    v_mad_u32_u24 v10, v14, s38, v10
    v_bfe_u32 v14, v0, 3, 1
    s_mov_b32 s38, 0x80
    v_mad_u32_u24 v10, v14, s38, v10
    v_bfe_u32 v14, v0, 4, 1
    s_mov_b32 s38, 0x20000
    v_mad_u32_u24 v10, v14, s38, v10
    v_bfe_u32 v14, v0, 5, 1
    s_mov_b32 s38, 0x40000
    v_mad_u32_u24 v10, v14, s38, v10
    v_bfe_u32 v14, v0, 6, 1
    s_mov_b32 s38, 0x100
    v_mad_u32_u24 v10, v14, s38, v10
    v_bfe_u32 v14, v0, 7, 1
    s_mov_b32 s38, 0x200
    v_mad_u32_u24 v10, v14, s38, v10
    v_mov_b32 v11, 0x0
    v_bfe_u32 v14, v0, 0, 1
    s_mov_b32 s38, 0x10
    v_mad_u32_u24 v11, v14, s38, v11
    v_bfe_u32 v14, v0, 1, 1
    s_mov_b32 s38, 0x20
    v_mad_u32_u24 v11, v14, s38, v11
    v_bfe_u32 v14, v0, 2, 1
    s_mov_b32 s38, 0x40
    v_mad_u32_u24 v11, v14, s38, v11
    v_bfe_u32 v14, v0, 3, 1
    s_mov_b32 s38, 0x80
    v_mad_u32_u24 v11, v14, s38, v11
    v_bfe_u32 v14, v0, 4, 1
    s_mov_b32 s38, 0x400
    v_mad_u32_u24 v11, v14, s38, v11
    v_bfe_u32 v14, v0, 5, 1
    s_mov_b32 s38, 0x800
    v_mad_u32_u24 v11, v14, s38, v11
    v_bfe_u32 v14, v0, 6, 1
    s_mov_b32 s38, 0x100
    v_mad_u32_u24 v11, v14, s38, v11
    v_bfe_u32 v14, v0, 7, 1
    s_mov_b32 s38, 0x200
    v_mad_u32_u24 v11, v14, s38, v11
    v_mov_b32 v12, 0x0
    v_bfe_u32 v14, v0, 0, 1
    s_mov_b32 s38, 0x10
    v_mad_u32_u24 v12, v14, s38, v12
    v_bfe_u32 v14, v0, 1, 1
    s_mov_b32 s38, 0x20
    v_mad_u32_u24 v12, v14, s38, v12
    v_bfe_u32 v14, v0, 2, 1
    s_mov_b32 s38, 0x40
    v_mad_u32_u24 v12, v14, s38, v12
    v_bfe_u32 v14, v0, 3, 1
    s_mov_b32 s38, 0x80
    v_mad_u32_u24 v12, v14, s38, v12
    v_bfe_u32 v14, v0, 4, 1
    s_mov_b32 s38, 0x4
    v_mad_u32_u24 v12, v14, s38, v12
    v_bfe_u32 v14, v0, 5, 1
    s_mov_b32 s38, 0x8
    v_mad_u32_u24 v12, v14, s38, v12
    v_bfe_u32 v14, v0, 6, 1
    s_mov_b32 s38, 0x100
    v_mad_u32_u24 v12, v14, s38, v12
    v_bfe_u32 v14, v0, 7, 1
    s_mov_b32 s38, 0x200
    v_mad_u32_u24 v12, v14, s38, v12
    v_mov_b32 v13, 0xf149f2ca
    v_and_b32 v14, 15, v0
    v_bfe_u32 v15, v0, 4, 2
    v_cmp_gt_u32 s[72:73], 2, v15
    v_lshlrev_b32 v15, 2, v15
    v_cmp_le_u32 s[64:65], v15, v14
    v_add_u32 v15, 1, v15
    v_cmp_le_u32 s[66:67], v15, v14
    v_add_u32 v15, 1, v15
    v_cmp_le_u32 s[68:69], v15, v14
    v_add_u32 v15, 1, v15
    v_cmp_le_u32 s[70:71], v15, v14
    v_add_u32 v15, 1, v15
    s_mov_b32 s34, 0x05040100
    s_mov_b32 s35, 0x07060302
    s_mov_b32 s33, 0x3e0293ee
    s_mov_b32 s32, 0
    s_mov_b32 s4, 0x3f803f80
    s_mov_b32 s5, 0x3f803f80
    s_mov_b32 s23, s22
    s_lshl_b32 s36, s23, 15
    buffer_load_dwordx4 v[96:99], v3, s[12:15], s36 offen offset:0
    buffer_load_dwordx4 v[100:103], v3, s[12:15], s36 offen offset:128
    buffer_load_dwordx4 v[104:107], v3, s[12:15], s36 offen offset:256
    buffer_load_dwordx4 v[108:111], v3, s[12:15], s36 offen offset:384
    buffer_load_dwordx4 v[112:115], v3, s[12:15], s36 offen offset:512
    buffer_load_dwordx4 v[116:119], v3, s[12:15], s36 offen offset:640
    buffer_load_dwordx4 v[120:123], v3, s[12:15], s36 offen offset:768
    buffer_load_dwordx4 v[124:127], v3, s[12:15], s36 offen offset:896
    s_waitcnt vmcnt(33)
    s_barrier
    ds_read_b64_tr_b16 v[128:129], v20 offset:0
    ds_read_b64_tr_b16 v[130:131], v20 offset:1024
    ds_read_b64_tr_b16 v[132:133], v21 offset:0
    ds_read_b64_tr_b16 v[134:135], v21 offset:1024
    ds_read_b64_tr_b16 v[136:137], v22 offset:0
    ds_read_b64_tr_b16 v[138:139], v22 offset:1024
    ds_read_b64_tr_b16 v[140:141], v23 offset:0
    ds_read_b64_tr_b16 v[142:143], v23 offset:1024
    ds_read_b64_tr_b16 v[144:145], v24 offset:0
    ds_read_b64_tr_b16 v[146:147], v24 offset:1024
    ds_read_b64_tr_b16 v[148:149], v25 offset:0
    ds_read_b64_tr_b16 v[150:151], v25 offset:1024
    s_waitcnt lgkmcnt(4)
    ds_read_b64_tr_b16 v[152:153], v26 offset:0
    ds_read_b64_tr_b16 v[154:155], v26 offset:1024
    ds_read_b64_tr_b16 v[156:157], v27 offset:0
    ds_read_b64_tr_b16 v[158:159], v27 offset:1024
    s_waitcnt lgkmcnt(0)
    s_barrier
    s_mov_b32 s40, s50
    s_and_b32 s41, s51, 0xffff
    s_mov_b32 s42, 0x400000
    s_mov_b32 s43, 0x20000
    s_add_u32 m0, s28, 32768
    s_add_u32 s37, s3, 0x0
    buffer_load_dwordx4 v16, s[40:43], s37 offen lds
    s_add_u32 m0, s28, 36864
    s_add_u32 s37, s3, 0x20000
    buffer_load_dwordx4 v16, s[40:43], s37 offen lds
    s_add_u32 m0, s28, 65536
    s_add_u32 s37, s3, 0x40000
    buffer_load_dwordx4 v16, s[40:43], s37 offen lds
    s_add_u32 m0, s28, 69632
    s_add_u32 s37, s3, 0x60000
    buffer_load_dwordx4 v16, s[40:43], s37 offen lds
    s_add_u32 m0, s28, 98304
    s_add_u32 s37, s3, 0x80000
    buffer_load_dwordx4 v16, s[40:43], s37 offen lds
    s_add_u32 m0, s28, 102400
    s_add_u32 s37, s3, 0xa0000
    buffer_load_dwordx4 v16, s[40:43], s37 offen lds
    s_add_u32 m0, s28, 131072
    s_add_u32 s37, s3, 0xc0000
    buffer_load_dwordx4 v16, s[40:43], s37 offen lds
    s_add_u32 m0, s28, 135168
    s_add_u32 s37, s3, 0xe0000
    buffer_load_dwordx4 v16, s[40:43], s37 offen lds
    s_waitcnt vmcnt(33)
    s_barrier
    ds_read_b64_tr_b16 v[160:161], v20 offset:8192
    ds_read_b64_tr_b16 v[162:163], v20 offset:9216
    ds_read_b64_tr_b16 v[164:165], v21 offset:8192
    ds_read_b64_tr_b16 v[166:167], v21 offset:9216
    ds_read_b64_tr_b16 v[168:169], v22 offset:8192
    ds_read_b64_tr_b16 v[170:171], v22 offset:9216
    ds_read_b64_tr_b16 v[172:173], v23 offset:8192
    ds_read_b64_tr_b16 v[174:175], v23 offset:9216
    ds_read_b64_tr_b16 v[176:177], v24 offset:8192
    ds_read_b64_tr_b16 v[178:179], v24 offset:9216
    ds_read_b64_tr_b16 v[180:181], v25 offset:8192
    ds_read_b64_tr_b16 v[182:183], v25 offset:9216
    s_waitcnt lgkmcnt(4)
    ds_read_b64_tr_b16 v[184:185], v26 offset:8192
    ds_read_b64_tr_b16 v[186:187], v26 offset:9216
    ds_read_b64_tr_b16 v[188:189], v27 offset:8192
    ds_read_b64_tr_b16 v[190:191], v27 offset:9216
    s_waitcnt lgkmcnt(0)
    s_barrier
    s_add_u32 m0, s28, 40960
    s_add_u32 s37, s3, 0x100000
    buffer_load_dwordx4 v16, s[40:43], s37 offen lds
    s_add_u32 m0, s28, 45056
    s_add_u32 s37, s3, 0x120000
    buffer_load_dwordx4 v16, s[40:43], s37 offen lds
    s_add_u32 m0, s28, 73728
    s_add_u32 s37, s3, 0x140000
    buffer_load_dwordx4 v16, s[40:43], s37 offen lds
    s_add_u32 m0, s28, 77824
    s_add_u32 s37, s3, 0x160000
    buffer_load_dwordx4 v16, s[40:43], s37 offen lds
    s_add_u32 m0, s28, 106496
    s_add_u32 s37, s3, 0x180000
    buffer_load_dwordx4 v16, s[40:43], s37 offen lds
    s_add_u32 m0, s28, 110592
    s_add_u32 s37, s3, 0x1a0000
    buffer_load_dwordx4 v16, s[40:43], s37 offen lds
    s_add_u32 m0, s28, 139264
    s_add_u32 s37, s3, 0x1c0000
    buffer_load_dwordx4 v16, s[40:43], s37 offen lds
    s_add_u32 m0, s28, 143360
    s_add_u32 s37, s3, 0x1e0000
    buffer_load_dwordx4 v16, s[40:43], s37 offen lds
    s_waitcnt vmcnt(33)
    s_barrier
    ds_read_b64_tr_b16 v[192:193], v20 offset:16384
    ds_read_b64_tr_b16 v[194:195], v20 offset:17408
    ds_read_b64_tr_b16 v[196:197], v21 offset:16384
    ds_read_b64_tr_b16 v[198:199], v21 offset:17408
    ds_read_b64_tr_b16 v[200:201], v22 offset:16384
    ds_read_b64_tr_b16 v[202:203], v22 offset:17408
    ds_read_b64_tr_b16 v[204:205], v23 offset:16384
    ds_read_b64_tr_b16 v[206:207], v23 offset:17408
    ds_read_b64_tr_b16 v[208:209], v24 offset:16384
    ds_read_b64_tr_b16 v[210:211], v24 offset:17408
    ds_read_b64_tr_b16 v[212:213], v25 offset:16384
    ds_read_b64_tr_b16 v[214:215], v25 offset:17408
    s_waitcnt lgkmcnt(4)
    ds_read_b64_tr_b16 v[216:217], v26 offset:16384
    ds_read_b64_tr_b16 v[218:219], v26 offset:17408
    ds_read_b64_tr_b16 v[220:221], v27 offset:16384
    ds_read_b64_tr_b16 v[222:223], v27 offset:17408
    s_waitcnt lgkmcnt(0)
    s_barrier
    s_add_u32 m0, s28, 49152
    s_add_u32 s37, s3, 0x200000
    buffer_load_dwordx4 v16, s[40:43], s37 offen lds
    s_add_u32 m0, s28, 53248
    s_add_u32 s37, s3, 0x220000
    buffer_load_dwordx4 v16, s[40:43], s37 offen lds
    s_add_u32 m0, s28, 81920
    s_add_u32 s37, s3, 0x240000
    buffer_load_dwordx4 v16, s[40:43], s37 offen lds
    s_add_u32 m0, s28, 86016
    s_add_u32 s37, s3, 0x260000
    buffer_load_dwordx4 v16, s[40:43], s37 offen lds
    s_add_u32 m0, s28, 114688
    s_add_u32 s37, s3, 0x280000
    buffer_load_dwordx4 v16, s[40:43], s37 offen lds
    s_add_u32 m0, s28, 118784
    s_add_u32 s37, s3, 0x2a0000
    buffer_load_dwordx4 v16, s[40:43], s37 offen lds
    s_add_u32 m0, s28, 147456
    s_add_u32 s37, s3, 0x2c0000
    buffer_load_dwordx4 v16, s[40:43], s37 offen lds
    s_add_u32 m0, s28, 151552
    s_add_u32 s37, s3, 0x2e0000
    buffer_load_dwordx4 v16, s[40:43], s37 offen lds
    s_waitcnt vmcnt(33)
    s_barrier
    ds_read_b64_tr_b16 v[224:225], v20 offset:24576
    ds_read_b64_tr_b16 v[226:227], v20 offset:25600
    ds_read_b64_tr_b16 v[228:229], v21 offset:24576
    ds_read_b64_tr_b16 v[230:231], v21 offset:25600
    ds_read_b64_tr_b16 v[232:233], v22 offset:24576
    ds_read_b64_tr_b16 v[234:235], v22 offset:25600
    ds_read_b64_tr_b16 v[236:237], v23 offset:24576
    ds_read_b64_tr_b16 v[238:239], v23 offset:25600
    ds_read_b64_tr_b16 v[240:241], v24 offset:24576
    ds_read_b64_tr_b16 v[242:243], v24 offset:25600
    ds_read_b64_tr_b16 v[244:245], v25 offset:24576
    ds_read_b64_tr_b16 v[246:247], v25 offset:25600
    s_waitcnt lgkmcnt(4)
    ds_read_b64_tr_b16 v[248:249], v26 offset:24576
    ds_read_b64_tr_b16 v[250:251], v26 offset:25600
    ds_read_b64_tr_b16 v[252:253], v27 offset:24576
    ds_read_b64_tr_b16 v[254:255], v27 offset:25600
    s_waitcnt lgkmcnt(0)
    s_barrier
    s_add_u32 m0, s28, 57344
    s_add_u32 s37, s3, 0x300000
    buffer_load_dwordx4 v16, s[40:43], s37 offen lds
    s_add_u32 m0, s28, 61440
    s_add_u32 s37, s3, 0x320000
    buffer_load_dwordx4 v16, s[40:43], s37 offen lds
    s_add_u32 m0, s28, 90112
    s_add_u32 s37, s3, 0x340000
    buffer_load_dwordx4 v16, s[40:43], s37 offen lds
    s_add_u32 m0, s28, 94208
    s_add_u32 s37, s3, 0x360000
    buffer_load_dwordx4 v16, s[40:43], s37 offen lds
    s_add_u32 m0, s28, 122880
    s_add_u32 s37, s3, 0x380000
    buffer_load_dwordx4 v16, s[40:43], s37 offen lds
    s_add_u32 m0, s28, 126976
    s_add_u32 s37, s3, 0x3a0000
    buffer_load_dwordx4 v16, s[40:43], s37 offen lds
    s_add_u32 m0, s28, 155648
    s_add_u32 s37, s3, 0x3c0000
    buffer_load_dwordx4 v16, s[40:43], s37 offen lds
    s_add_u32 m0, s28, 159744
    s_add_u32 s37, s3, 0x3e0000
    buffer_load_dwordx4 v16, s[40:43], s37 offen lds
    s_waitcnt vmcnt(32)
    v_mov_b32 v88, 0
    v_mov_b32 v89, 0
    v_dot2_f32_bf16 v88, v96, s4, v88
    v_dot2_f32_bf16 v89, v96, v96, v89
    v_dot2_f32_bf16 v88, v97, s4, v88
    v_dot2_f32_bf16 v89, v97, v97, v89
    v_dot2_f32_bf16 v88, v98, s4, v88
    v_dot2_f32_bf16 v89, v98, v98, v89
    v_dot2_f32_bf16 v88, v99, s4, v88
    v_dot2_f32_bf16 v89, v99, v99, v89
    v_dot2_f32_bf16 v88, v100, s4, v88
    v_dot2_f32_bf16 v89, v100, v100, v89
    v_dot2_f32_bf16 v88, v101, s4, v88
    v_dot2_f32_bf16 v89, v101, v101, v89
    v_dot2_f32_bf16 v88, v102, s4, v88
    v_dot2_f32_bf16 v89, v102, v102, v89
    v_dot2_f32_bf16 v88, v103, s4, v88
    v_dot2_f32_bf16 v89, v103, v103, v89
    v_dot2_f32_bf16 v88, v104, s4, v88
    v_dot2_f32_bf16 v89, v104, v104, v89
    v_dot2_f32_bf16 v88, v105, s4, v88
    v_dot2_f32_bf16 v89, v105, v105, v89
    v_dot2_f32_bf16 v88, v106, s4, v88
    v_dot2_f32_bf16 v89, v106, v106, v89
    v_dot2_f32_bf16 v88, v107, s4, v88
    v_dot2_f32_bf16 v89, v107, v107, v89
    v_dot2_f32_bf16 v88, v108, s4, v88
    v_dot2_f32_bf16 v89, v108, v108, v89
    v_dot2_f32_bf16 v88, v109, s4, v88
    v_dot2_f32_bf16 v89, v109, v109, v89
    v_dot2_f32_bf16 v88, v110, s4, v88
    v_dot2_f32_bf16 v89, v110, v110, v89
    v_dot2_f32_bf16 v88, v111, s4, v88
    v_dot2_f32_bf16 v89, v111, v111, v89
    v_dot2_f32_bf16 v88, v112, s4, v88
    v_dot2_f32_bf16 v89, v112, v112, v89
    v_dot2_f32_bf16 v88, v113, s4, v88
    v_dot2_f32_bf16 v89, v113, v113, v89
    v_dot2_f32_bf16 v88, v114, s4, v88
    v_dot2_f32_bf16 v89, v114, v114, v89
    v_dot2_f32_bf16 v88, v115, s4, v88
    v_dot2_f32_bf16 v89, v115, v115, v89
    v_dot2_f32_bf16 v88, v116, s4, v88
    v_dot2_f32_bf16 v89, v116, v116, v89
    v_dot2_f32_bf16 v88, v117, s4, v88
    v_dot2_f32_bf16 v89, v117, v117, v89
    v_dot2_f32_bf16 v88, v118, s4, v88
    v_dot2_f32_bf16 v89, v118, v118, v89
    v_dot2_f32_bf16 v88, v119, s4, v88
    v_dot2_f32_bf16 v89, v119, v119, v89
    v_dot2_f32_bf16 v88, v120, s4, v88
    v_dot2_f32_bf16 v89, v120, v120, v89
    v_dot2_f32_bf16 v88, v121, s4, v88
    v_dot2_f32_bf16 v89, v121, v121, v89
    v_dot2_f32_bf16 v88, v122, s4, v88
    v_dot2_f32_bf16 v89, v122, v122, v89
    v_dot2_f32_bf16 v88, v123, s4, v88
    v_dot2_f32_bf16 v89, v123, v123, v89
    v_dot2_f32_bf16 v88, v124, s4, v88
    v_dot2_f32_bf16 v89, v124, v124, v89
    v_dot2_f32_bf16 v88, v125, s4, v88
    v_dot2_f32_bf16 v89, v125, v125, v89
    v_dot2_f32_bf16 v88, v126, s4, v88
    v_dot2_f32_bf16 v89, v126, v126, v89
    v_dot2_f32_bf16 v88, v127, s4, v88
    v_dot2_f32_bf16 v89, v127, v127, v89
    s_nop 3
    v_add_f32_dpp v88, v88, v88 quad_perm:[1,0,3,2] row_mask:0xf bank_mask:0xf
    v_add_f32_dpp v89, v89, v89 quad_perm:[1,0,3,2] row_mask:0xf bank_mask:0xf
    s_nop 0
    v_add_f32_dpp v88, v88, v88 quad_perm:[2,3,0,1] row_mask:0xf bank_mask:0xf
    v_add_f32_dpp v89, v89, v89 quad_perm:[2,3,0,1] row_mask:0xf bank_mask:0xf
    s_nop 0
    v_add_f32_dpp v88, v88, v88 row_half_mirror row_mask:0xf bank_mask:0xf
    v_add_f32_dpp v89, v89, v89 row_half_mirror row_mask:0xf bank_mask:0xf
    v_mul_f32 v88, 0x3b000000, v88
    v_mul_f32 v89, 0x3b000000, v89
    v_fma_f32 v89, -v88, v88, v89
    v_max_f32 v89, 0, v89
    v_cvt_pk_bf16_f32 v14, v88, v89
    v_lshlrev_b32 v88, 16, v14
    v_and_b32 v89, 0xffff0000, v14
    v_add_f32 v89, 0x3727c5ac, v89
    v_cvt_pk_bf16_f32 v14, v89, v89
    v_lshlrev_b32 v89, 16, v14
    v_sqrt_f32 v89, v89
    s_nop 0
    v_cvt_pk_bf16_f32 v14, v89, v89
    v_lshlrev_b32 v89, 16, v14
    v_rcp_f32 v89, v89
    v_lshlrev_b32 v90, 16, v96
    v_and_b32 v91, 0xffff0000, v96
    v_sub_f32 v90, v90, v88
    v_sub_f32 v91, v91, v88
    v_cvt_pk_bf16_f32 v96, v90, v91
    v_lshlrev_b32 v90, 16, v96
    v_and_b32 v91, 0xffff0000, v96
    v_mul_f32 v90, v90, v89
    v_mul_f32 v91, v91, v89
    v_cvt_pk_bf16_f32 v96, v90, v91
    v_lshlrev_b32 v90, 16, v97
    v_and_b32 v91, 0xffff0000, v97
    v_sub_f32 v90, v90, v88
    v_sub_f32 v91, v91, v88
    v_cvt_pk_bf16_f32 v97, v90, v91
    v_lshlrev_b32 v90, 16, v97
    v_and_b32 v91, 0xffff0000, v97
    v_mul_f32 v90, v90, v89
    v_mul_f32 v91, v91, v89
    v_cvt_pk_bf16_f32 v97, v90, v91
    v_lshlrev_b32 v90, 16, v98
    v_and_b32 v91, 0xffff0000, v98
    v_sub_f32 v90, v90, v88
    v_sub_f32 v91, v91, v88
    v_cvt_pk_bf16_f32 v98, v90, v91
    v_lshlrev_b32 v90, 16, v98
    v_and_b32 v91, 0xffff0000, v98
    v_mul_f32 v90, v90, v89
    v_mul_f32 v91, v91, v89
    v_cvt_pk_bf16_f32 v98, v90, v91
    v_lshlrev_b32 v90, 16, v99
    v_and_b32 v91, 0xffff0000, v99
    v_sub_f32 v90, v90, v88
    v_sub_f32 v91, v91, v88
    v_cvt_pk_bf16_f32 v99, v90, v91
    v_lshlrev_b32 v90, 16, v99
    v_and_b32 v91, 0xffff0000, v99
    v_mul_f32 v90, v90, v89
    v_mul_f32 v91, v91, v89
    v_cvt_pk_bf16_f32 v99, v90, v91
    ds_write_b128 v4, v[96:99] offset:0
    v_lshlrev_b32 v90, 16, v100
    v_and_b32 v91, 0xffff0000, v100
    v_sub_f32 v90, v90, v88
    v_sub_f32 v91, v91, v88
    v_cvt_pk_bf16_f32 v100, v90, v91
    v_lshlrev_b32 v90, 16, v100
    v_and_b32 v91, 0xffff0000, v100
    v_mul_f32 v90, v90, v89
    v_mul_f32 v91, v91, v89
    v_cvt_pk_bf16_f32 v100, v90, v91
    v_lshlrev_b32 v90, 16, v101
    v_and_b32 v91, 0xffff0000, v101
    v_sub_f32 v90, v90, v88
    v_sub_f32 v91, v91, v88
    v_cvt_pk_bf16_f32 v101, v90, v91
    v_lshlrev_b32 v90, 16, v101
    v_and_b32 v91, 0xffff0000, v101
    v_mul_f32 v90, v90, v89
    v_mul_f32 v91, v91, v89
    v_cvt_pk_bf16_f32 v101, v90, v91
    v_lshlrev_b32 v90, 16, v102
    v_and_b32 v91, 0xffff0000, v102
    v_sub_f32 v90, v90, v88
    v_sub_f32 v91, v91, v88
    v_cvt_pk_bf16_f32 v102, v90, v91
    v_lshlrev_b32 v90, 16, v102
    v_and_b32 v91, 0xffff0000, v102
    v_mul_f32 v90, v90, v89
    v_mul_f32 v91, v91, v89
    v_cvt_pk_bf16_f32 v102, v90, v91
    v_lshlrev_b32 v90, 16, v103
    v_and_b32 v91, 0xffff0000, v103
    v_sub_f32 v90, v90, v88
    v_sub_f32 v91, v91, v88
    v_cvt_pk_bf16_f32 v103, v90, v91
    v_lshlrev_b32 v90, 16, v103
    v_and_b32 v91, 0xffff0000, v103
    v_mul_f32 v90, v90, v89
    v_mul_f32 v91, v91, v89
    v_cvt_pk_bf16_f32 v103, v90, v91
    ds_write_b128 v4, v[100:103] offset:2048
    v_lshlrev_b32 v90, 16, v104
    v_and_b32 v91, 0xffff0000, v104
    v_sub_f32 v90, v90, v88
    v_sub_f32 v91, v91, v88
    v_cvt_pk_bf16_f32 v104, v90, v91
    v_lshlrev_b32 v90, 16, v104
    v_and_b32 v91, 0xffff0000, v104
    v_mul_f32 v90, v90, v89
    v_mul_f32 v91, v91, v89
    v_cvt_pk_bf16_f32 v104, v90, v91
    v_lshlrev_b32 v90, 16, v105
    v_and_b32 v91, 0xffff0000, v105
    v_sub_f32 v90, v90, v88
    v_sub_f32 v91, v91, v88
    v_cvt_pk_bf16_f32 v105, v90, v91
    v_lshlrev_b32 v90, 16, v105
    v_and_b32 v91, 0xffff0000, v105
    v_mul_f32 v90, v90, v89
    v_mul_f32 v91, v91, v89
    v_cvt_pk_bf16_f32 v105, v90, v91
    v_lshlrev_b32 v90, 16, v106
    v_and_b32 v91, 0xffff0000, v106
    v_sub_f32 v90, v90, v88
    v_sub_f32 v91, v91, v88
    v_cvt_pk_bf16_f32 v106, v90, v91
    v_lshlrev_b32 v90, 16, v106
    v_and_b32 v91, 0xffff0000, v106
    v_mul_f32 v90, v90, v89
    v_mul_f32 v91, v91, v89
    v_cvt_pk_bf16_f32 v106, v90, v91
    v_lshlrev_b32 v90, 16, v107
    v_and_b32 v91, 0xffff0000, v107
    v_sub_f32 v90, v90, v88
    v_sub_f32 v91, v91, v88
    v_cvt_pk_bf16_f32 v107, v90, v91
    v_lshlrev_b32 v90, 16, v107
    v_and_b32 v91, 0xffff0000, v107
    v_mul_f32 v90, v90, v89
    v_mul_f32 v91, v91, v89
    v_cvt_pk_bf16_f32 v107, v90, v91
    ds_write_b128 v4, v[104:107] offset:4096
    v_lshlrev_b32 v90, 16, v108
    v_and_b32 v91, 0xffff0000, v108
    v_sub_f32 v90, v90, v88
    v_sub_f32 v91, v91, v88
    v_cvt_pk_bf16_f32 v108, v90, v91
    v_lshlrev_b32 v90, 16, v108
    v_and_b32 v91, 0xffff0000, v108
    v_mul_f32 v90, v90, v89
    v_mul_f32 v91, v91, v89
    v_cvt_pk_bf16_f32 v108, v90, v91
    v_lshlrev_b32 v90, 16, v109
    v_and_b32 v91, 0xffff0000, v109
    v_sub_f32 v90, v90, v88
    v_sub_f32 v91, v91, v88
    v_cvt_pk_bf16_f32 v109, v90, v91
    v_lshlrev_b32 v90, 16, v109
    v_and_b32 v91, 0xffff0000, v109
    v_mul_f32 v90, v90, v89
    v_mul_f32 v91, v91, v89
    v_cvt_pk_bf16_f32 v109, v90, v91
    v_lshlrev_b32 v90, 16, v110
    v_and_b32 v91, 0xffff0000, v110
    v_sub_f32 v90, v90, v88
    v_sub_f32 v91, v91, v88
    v_cvt_pk_bf16_f32 v110, v90, v91
    v_lshlrev_b32 v90, 16, v110
    v_and_b32 v91, 0xffff0000, v110
    v_mul_f32 v90, v90, v89
    v_mul_f32 v91, v91, v89
    v_cvt_pk_bf16_f32 v110, v90, v91
    v_lshlrev_b32 v90, 16, v111
    v_and_b32 v91, 0xffff0000, v111
    v_sub_f32 v90, v90, v88
    v_sub_f32 v91, v91, v88
    v_cvt_pk_bf16_f32 v111, v90, v91
    v_lshlrev_b32 v90, 16, v111
    v_and_b32 v91, 0xffff0000, v111
    v_mul_f32 v90, v90, v89
    v_mul_f32 v91, v91, v89
    v_cvt_pk_bf16_f32 v111, v90, v91
    ds_write_b128 v4, v[108:111] offset:6144
    v_lshlrev_b32 v90, 16, v112
    v_and_b32 v91, 0xffff0000, v112
    v_sub_f32 v90, v90, v88
    v_sub_f32 v91, v91, v88
    v_cvt_pk_bf16_f32 v112, v90, v91
    v_lshlrev_b32 v90, 16, v112
    v_and_b32 v91, 0xffff0000, v112
    v_mul_f32 v90, v90, v89
    v_mul_f32 v91, v91, v89
    v_cvt_pk_bf16_f32 v112, v90, v91
    v_lshlrev_b32 v90, 16, v113
    v_and_b32 v91, 0xffff0000, v113
    v_sub_f32 v90, v90, v88
    v_sub_f32 v91, v91, v88
    v_cvt_pk_bf16_f32 v113, v90, v91
    v_lshlrev_b32 v90, 16, v113
    v_and_b32 v91, 0xffff0000, v113
    v_mul_f32 v90, v90, v89
    v_mul_f32 v91, v91, v89
    v_cvt_pk_bf16_f32 v113, v90, v91
    v_lshlrev_b32 v90, 16, v114
    v_and_b32 v91, 0xffff0000, v114
    v_sub_f32 v90, v90, v88
    v_sub_f32 v91, v91, v88
    v_cvt_pk_bf16_f32 v114, v90, v91
    v_lshlrev_b32 v90, 16, v114
    v_and_b32 v91, 0xffff0000, v114
    v_mul_f32 v90, v90, v89
    v_mul_f32 v91, v91, v89
    v_cvt_pk_bf16_f32 v114, v90, v91
    v_lshlrev_b32 v90, 16, v115
    v_and_b32 v91, 0xffff0000, v115
    v_sub_f32 v90, v90, v88
    v_sub_f32 v91, v91, v88
    v_cvt_pk_bf16_f32 v115, v90, v91
    v_lshlrev_b32 v90, 16, v115
    v_and_b32 v91, 0xffff0000, v115
    v_mul_f32 v90, v90, v89
    v_mul_f32 v91, v91, v89
    v_cvt_pk_bf16_f32 v115, v90, v91
    ds_write_b128 v4, v[112:115] offset:8192
    v_lshlrev_b32 v90, 16, v116
    v_and_b32 v91, 0xffff0000, v116
    v_sub_f32 v90, v90, v88
    v_sub_f32 v91, v91, v88
    v_cvt_pk_bf16_f32 v116, v90, v91
    v_lshlrev_b32 v90, 16, v116
    v_and_b32 v91, 0xffff0000, v116
    v_mul_f32 v90, v90, v89
    v_mul_f32 v91, v91, v89
    v_cvt_pk_bf16_f32 v116, v90, v91
    v_lshlrev_b32 v90, 16, v117
    v_and_b32 v91, 0xffff0000, v117
    v_sub_f32 v90, v90, v88
    v_sub_f32 v91, v91, v88
    v_cvt_pk_bf16_f32 v117, v90, v91
    v_lshlrev_b32 v90, 16, v117
    v_and_b32 v91, 0xffff0000, v117
    v_mul_f32 v90, v90, v89
    v_mul_f32 v91, v91, v89
    v_cvt_pk_bf16_f32 v117, v90, v91
    v_lshlrev_b32 v90, 16, v118
    v_and_b32 v91, 0xffff0000, v118
    v_sub_f32 v90, v90, v88
    v_sub_f32 v91, v91, v88
    v_cvt_pk_bf16_f32 v118, v90, v91
    v_lshlrev_b32 v90, 16, v118
    v_and_b32 v91, 0xffff0000, v118
    v_mul_f32 v90, v90, v89
    v_mul_f32 v91, v91, v89
    v_cvt_pk_bf16_f32 v118, v90, v91
    v_lshlrev_b32 v90, 16, v119
    v_and_b32 v91, 0xffff0000, v119
    v_sub_f32 v90, v90, v88
    v_sub_f32 v91, v91, v88
    v_cvt_pk_bf16_f32 v119, v90, v91
    v_lshlrev_b32 v90, 16, v119
    v_and_b32 v91, 0xffff0000, v119
    v_mul_f32 v90, v90, v89
    v_mul_f32 v91, v91, v89
    v_cvt_pk_bf16_f32 v119, v90, v91
    ds_write_b128 v4, v[116:119] offset:10240
    v_lshlrev_b32 v90, 16, v120
    v_and_b32 v91, 0xffff0000, v120
    v_sub_f32 v90, v90, v88
    v_sub_f32 v91, v91, v88
    v_cvt_pk_bf16_f32 v120, v90, v91
    v_lshlrev_b32 v90, 16, v120
    v_and_b32 v91, 0xffff0000, v120
    v_mul_f32 v90, v90, v89
    v_mul_f32 v91, v91, v89
    v_cvt_pk_bf16_f32 v120, v90, v91
    v_lshlrev_b32 v90, 16, v121
    v_and_b32 v91, 0xffff0000, v121
    v_sub_f32 v90, v90, v88
    v_sub_f32 v91, v91, v88
    v_cvt_pk_bf16_f32 v121, v90, v91
    v_lshlrev_b32 v90, 16, v121
    v_and_b32 v91, 0xffff0000, v121
    v_mul_f32 v90, v90, v89
    v_mul_f32 v91, v91, v89
    v_cvt_pk_bf16_f32 v121, v90, v91
    v_lshlrev_b32 v90, 16, v122
    v_and_b32 v91, 0xffff0000, v122
    v_sub_f32 v90, v90, v88
    v_sub_f32 v91, v91, v88
    v_cvt_pk_bf16_f32 v122, v90, v91
    v_lshlrev_b32 v90, 16, v122
    v_and_b32 v91, 0xffff0000, v122
    v_mul_f32 v90, v90, v89
    v_mul_f32 v91, v91, v89
    v_cvt_pk_bf16_f32 v122, v90, v91
    v_lshlrev_b32 v90, 16, v123
    v_and_b32 v91, 0xffff0000, v123
    v_sub_f32 v90, v90, v88
    v_sub_f32 v91, v91, v88
    v_cvt_pk_bf16_f32 v123, v90, v91
    v_lshlrev_b32 v90, 16, v123
    v_and_b32 v91, 0xffff0000, v123
    v_mul_f32 v90, v90, v89
    v_mul_f32 v91, v91, v89
    v_cvt_pk_bf16_f32 v123, v90, v91
    ds_write_b128 v4, v[120:123] offset:12288
    v_lshlrev_b32 v90, 16, v124
    v_and_b32 v91, 0xffff0000, v124
    v_sub_f32 v90, v90, v88
    v_sub_f32 v91, v91, v88
    v_cvt_pk_bf16_f32 v124, v90, v91
    v_lshlrev_b32 v90, 16, v124
    v_and_b32 v91, 0xffff0000, v124
    v_mul_f32 v90, v90, v89
    v_mul_f32 v91, v91, v89
    v_cvt_pk_bf16_f32 v124, v90, v91
    v_lshlrev_b32 v90, 16, v125
    v_and_b32 v91, 0xffff0000, v125
    v_sub_f32 v90, v90, v88
    v_sub_f32 v91, v91, v88
    v_cvt_pk_bf16_f32 v125, v90, v91
    v_lshlrev_b32 v90, 16, v125
    v_and_b32 v91, 0xffff0000, v125
    v_mul_f32 v90, v90, v89
    v_mul_f32 v91, v91, v89
    v_cvt_pk_bf16_f32 v125, v90, v91
    v_lshlrev_b32 v90, 16, v126
    v_and_b32 v91, 0xffff0000, v126
    v_sub_f32 v90, v90, v88
    v_sub_f32 v91, v91, v88
    v_cvt_pk_bf16_f32 v126, v90, v91
    v_lshlrev_b32 v90, 16, v126
    v_and_b32 v91, 0xffff0000, v126
    v_mul_f32 v90, v90, v89
    v_mul_f32 v91, v91, v89
    v_cvt_pk_bf16_f32 v126, v90, v91
    v_lshlrev_b32 v90, 16, v127
    v_and_b32 v91, 0xffff0000, v127
    v_sub_f32 v90, v90, v88
    v_sub_f32 v91, v91, v88
    v_cvt_pk_bf16_f32 v127, v90, v91
    v_lshlrev_b32 v90, 16, v127
    v_and_b32 v91, 0xffff0000, v127
    v_mul_f32 v90, v90, v89
    v_mul_f32 v91, v91, v89
    v_cvt_pk_bf16_f32 v127, v90, v91
    ds_write_b128 v4, v[124:127] offset:14336
    s_lshr_b32 s36, s21, 1
    s_lshl_b32 s36, s36, 14
    s_xor_b32 s37, s36, 16384
    v_add_u32 v80, s36, v5
    v_add_u32 v81, s37, v5
    v_add_u32 v82, s36, v6
    v_add_u32 v83, s37, v6
    s_mov_b32 s31, 0
    s_waitcnt vmcnt(24)
    s_barrier
    ds_read_b64_tr_b16 a[128:129], v20 offset:0
    ds_read_b64_tr_b16 a[130:131], v20 offset:1024
    ds_read_b64_tr_b16 a[132:133], v21 offset:0
    ds_read_b64_tr_b16 a[134:135], v21 offset:1024
    ds_read_b64_tr_b16 a[136:137], v22 offset:0
    ds_read_b64_tr_b16 a[138:139], v22 offset:1024
    ds_read_b64_tr_b16 a[140:141], v23 offset:0
    ds_read_b64_tr_b16 a[142:143], v23 offset:1024
    ds_read_b64_tr_b16 a[144:145], v24 offset:0
    ds_read_b64_tr_b16 a[146:147], v24 offset:1024
    ds_read_b64_tr_b16 a[148:149], v25 offset:0
    ds_read_b64_tr_b16 a[150:151], v25 offset:1024
    s_waitcnt lgkmcnt(4)
    ds_read_b64_tr_b16 a[152:153], v26 offset:0
    ds_read_b64_tr_b16 a[154:155], v26 offset:1024
    ds_read_b64_tr_b16 a[156:157], v27 offset:0
    ds_read_b64_tr_b16 a[158:159], v27 offset:1024
    s_waitcnt lgkmcnt(0)
    s_barrier
    s_mov_b32 s96, s48
    s_and_b32 s97, s49, 0xffff
    s_mov_b32 s98, 0x400000
    s_mov_b32 s99, 0x20000
    s_add_u32 m0, s28, 32768
    s_add_u32 s37, s3, 0x0
    buffer_load_dwordx4 v16, s[96:99], s37 offen lds
    s_add_u32 m0, s28, 36864
    s_add_u32 s37, s3, 0x20000
    buffer_load_dwordx4 v16, s[96:99], s37 offen lds
    s_add_u32 m0, s28, 65536
    s_add_u32 s37, s3, 0x40000
    buffer_load_dwordx4 v16, s[96:99], s37 offen lds
    s_add_u32 m0, s28, 69632
    s_add_u32 s37, s3, 0x60000
    buffer_load_dwordx4 v16, s[96:99], s37 offen lds
    s_add_u32 m0, s28, 98304
    s_add_u32 s37, s3, 0x80000
    buffer_load_dwordx4 v16, s[96:99], s37 offen lds
    s_add_u32 m0, s28, 102400
    s_add_u32 s37, s3, 0xa0000
    buffer_load_dwordx4 v16, s[96:99], s37 offen lds
    s_add_u32 m0, s28, 131072
    s_add_u32 s37, s3, 0xc0000
    buffer_load_dwordx4 v16, s[96:99], s37 offen lds
    s_add_u32 m0, s28, 135168
    s_add_u32 s37, s3, 0xe0000
    buffer_load_dwordx4 v16, s[96:99], s37 offen lds
    s_waitcnt vmcnt(24)
    s_barrier
    ds_read_b64_tr_b16 a[160:161], v20 offset:8192
    ds_read_b64_tr_b16 a[162:163], v20 offset:9216
    ds_read_b64_tr_b16 a[164:165], v21 offset:8192
    ds_read_b64_tr_b16 a[166:167], v21 offset:9216
    ds_read_b64_tr_b16 a[168:169], v22 offset:8192
    ds_read_b64_tr_b16 a[170:171], v22 offset:9216
    ds_read_b64_tr_b16 a[172:173], v23 offset:8192
    ds_read_b64_tr_b16 a[174:175], v23 offset:9216
    ds_read_b64_tr_b16 a[176:177], v24 offset:8192
    ds_read_b64_tr_b16 a[178:179], v24 offset:9216
    ds_read_b64_tr_b16 a[180:181], v25 offset:8192
    ds_read_b64_tr_b16 a[182:183], v25 offset:9216
    s_waitcnt lgkmcnt(4)
    ds_read_b64_tr_b16 a[184:185], v26 offset:8192
    ds_read_b64_tr_b16 a[186:187], v26 offset:9216
    ds_read_b64_tr_b16 a[188:189], v27 offset:8192
    ds_read_b64_tr_b16 a[190:191], v27 offset:9216
    s_waitcnt lgkmcnt(0)
    s_barrier
    s_add_u32 m0, s28, 40960
    s_add_u32 s37, s3, 0x100000
    buffer_load_dwordx4 v16, s[96:99], s37 offen lds
    s_add_u32 m0, s28, 45056
    s_add_u32 s37, s3, 0x120000
    buffer_load_dwordx4 v16, s[96:99], s37 offen lds
    s_add_u32 m0, s28, 73728
    s_add_u32 s37, s3, 0x140000
    buffer_load_dwordx4 v16, s[96:99], s37 offen lds
    s_add_u32 m0, s28, 77824
    s_add_u32 s37, s3, 0x160000
    buffer_load_dwordx4 v16, s[96:99], s37 offen lds
    s_add_u32 m0, s28, 106496
    s_add_u32 s37, s3, 0x180000
    buffer_load_dwordx4 v16, s[96:99], s37 offen lds
    s_add_u32 m0, s28, 110592
    s_add_u32 s37, s3, 0x1a0000
    buffer_load_dwordx4 v16, s[96:99], s37 offen lds
    s_add_u32 m0, s28, 139264
    s_add_u32 s37, s3, 0x1c0000
    buffer_load_dwordx4 v16, s[96:99], s37 offen lds
    s_add_u32 m0, s28, 143360
    s_add_u32 s37, s3, 0x1e0000
    buffer_load_dwordx4 v16, s[96:99], s37 offen lds
    s_waitcnt vmcnt(24)
    s_barrier
    ds_read_b64_tr_b16 a[192:193], v20 offset:16384
    ds_read_b64_tr_b16 a[194:195], v20 offset:17408
    ds_read_b64_tr_b16 a[196:197], v21 offset:16384
    ds_read_b64_tr_b16 a[198:199], v21 offset:17408
    ds_read_b64_tr_b16 a[200:201], v22 offset:16384
    ds_read_b64_tr_b16 a[202:203], v22 offset:17408
    ds_read_b64_tr_b16 a[204:205], v23 offset:16384
    ds_read_b64_tr_b16 a[206:207], v23 offset:17408
    ds_read_b64_tr_b16 a[208:209], v24 offset:16384
    ds_read_b64_tr_b16 a[210:211], v24 offset:17408
    ds_read_b64_tr_b16 a[212:213], v25 offset:16384
    ds_read_b64_tr_b16 a[214:215], v25 offset:17408
    s_waitcnt lgkmcnt(4)
    ds_read_b64_tr_b16 a[216:217], v26 offset:16384
    ds_read_b64_tr_b16 a[218:219], v26 offset:17408
    ds_read_b64_tr_b16 a[220:221], v27 offset:16384
    ds_read_b64_tr_b16 a[222:223], v27 offset:17408
    s_waitcnt lgkmcnt(0)
    s_barrier
    s_add_u32 m0, s28, 49152
    s_add_u32 s37, s3, 0x200000
    buffer_load_dwordx4 v16, s[96:99], s37 offen lds
    s_add_u32 m0, s28, 53248
    s_add_u32 s37, s3, 0x220000
    buffer_load_dwordx4 v16, s[96:99], s37 offen lds
    s_add_u32 m0, s28, 81920
    s_add_u32 s37, s3, 0x240000
    buffer_load_dwordx4 v16, s[96:99], s37 offen lds
    s_add_u32 m0, s28, 86016
    s_add_u32 s37, s3, 0x260000
    buffer_load_dwordx4 v16, s[96:99], s37 offen lds
    s_add_u32 m0, s28, 114688
    s_add_u32 s37, s3, 0x280000
    buffer_load_dwordx4 v16, s[96:99], s37 offen lds
    s_add_u32 m0, s28, 118784
    s_add_u32 s37, s3, 0x2a0000
    buffer_load_dwordx4 v16, s[96:99], s37 offen lds
    s_add_u32 m0, s28, 147456
    s_add_u32 s37, s3, 0x2c0000
    buffer_load_dwordx4 v16, s[96:99], s37 offen lds
    s_add_u32 m0, s28, 151552
    s_add_u32 s37, s3, 0x2e0000
    buffer_load_dwordx4 v16, s[96:99], s37 offen lds
    s_waitcnt vmcnt(24)
    s_barrier
    ds_read_b64_tr_b16 a[224:225], v20 offset:24576
    ds_read_b64_tr_b16 a[226:227], v20 offset:25600
    ds_read_b64_tr_b16 a[228:229], v21 offset:24576
    ds_read_b64_tr_b16 a[230:231], v21 offset:25600
    ds_read_b64_tr_b16 a[232:233], v22 offset:24576
    ds_read_b64_tr_b16 a[234:235], v22 offset:25600
    ds_read_b64_tr_b16 a[236:237], v23 offset:24576
    ds_read_b64_tr_b16 a[238:239], v23 offset:25600
    ds_read_b64_tr_b16 a[240:241], v24 offset:24576
    ds_read_b64_tr_b16 a[242:243], v24 offset:25600
    ds_read_b64_tr_b16 a[244:245], v25 offset:24576
    ds_read_b64_tr_b16 a[246:247], v25 offset:25600
    s_waitcnt lgkmcnt(4)
    ds_read_b64_tr_b16 a[248:249], v26 offset:24576
    ds_read_b64_tr_b16 a[250:251], v26 offset:25600
    ds_read_b64_tr_b16 a[252:253], v27 offset:24576
    ds_read_b64_tr_b16 a[254:255], v27 offset:25600
    s_waitcnt lgkmcnt(0)
    s_barrier
    s_add_u32 m0, s28, 57344
    s_add_u32 s37, s3, 0x300000
    buffer_load_dwordx4 v16, s[96:99], s37 offen lds
    s_add_u32 m0, s28, 61440
    s_add_u32 s37, s3, 0x320000
    buffer_load_dwordx4 v16, s[96:99], s37 offen lds
    s_add_u32 m0, s28, 90112
    s_add_u32 s37, s3, 0x340000
    buffer_load_dwordx4 v16, s[96:99], s37 offen lds
    s_add_u32 m0, s28, 94208
    s_add_u32 s37, s3, 0x360000
    buffer_load_dwordx4 v16, s[96:99], s37 offen lds
    s_add_u32 m0, s28, 122880
    s_add_u32 s37, s3, 0x380000
    buffer_load_dwordx4 v16, s[96:99], s37 offen lds
    s_add_u32 m0, s28, 126976
    s_add_u32 s37, s3, 0x3a0000
    buffer_load_dwordx4 v16, s[96:99], s37 offen lds
    s_add_u32 m0, s28, 155648
    s_add_u32 s37, s3, 0x3c0000
    buffer_load_dwordx4 v16, s[96:99], s37 offen lds
    s_add_u32 m0, s28, 159744
    s_add_u32 s37, s3, 0x3e0000
    buffer_load_dwordx4 v16, s[96:99], s37 offen lds
    ds_read_b128 v[64:67], v80 offset:0
    ds_read_b128 v[68:71], v81 offset:0
    ds_read_b128 v[72:75], v82 offset:1024
    ds_read_b128 v[76:79], v83 offset:1024
    s_waitcnt lgkmcnt(2)
    v_mfma_f32_16x16x32_bf16 v[32:35], a[128:131], v[64:67], 0
    v_mfma_f32_16x16x32_bf16 v[36:39], a[128:131], v[68:71], 0
    v_mfma_f32_16x16x32_bf16 v[40:43], a[132:135], v[64:67], 0
    v_mfma_f32_16x16x32_bf16 v[44:47], a[132:135], v[68:71], 0
    v_mfma_f32_16x16x32_bf16 v[48:51], v[64:67], v[128:131], 0
    v_mfma_f32_16x16x32_bf16 v[56:59], v[68:71], v[128:131], 0
    v_mfma_f32_16x16x32_bf16 v[52:55], v[64:67], v[132:135], 0
    v_mfma_f32_16x16x32_bf16 v[60:63], v[68:71], v[132:135], 0
    ds_read_b128 v[64:67], v80 offset:2048
    ds_read_b128 v[68:71], v81 offset:2048
    s_waitcnt lgkmcnt(2)
    v_mfma_f32_16x16x32_bf16 v[32:35], a[136:139], v[72:75], v[32:35]
    v_mfma_f32_16x16x32_bf16 v[36:39], a[136:139], v[76:79], v[36:39]
    v_mfma_f32_16x16x32_bf16 v[40:43], a[140:143], v[72:75], v[40:43]
    v_mfma_f32_16x16x32_bf16 v[44:47], a[140:143], v[76:79], v[44:47]
    v_mfma_f32_16x16x32_bf16 v[48:51], v[72:75], v[136:139], v[48:51]
    v_mfma_f32_16x16x32_bf16 v[56:59], v[76:79], v[136:139], v[56:59]
    v_mfma_f32_16x16x32_bf16 v[52:55], v[72:75], v[140:143], v[52:55]
    v_mfma_f32_16x16x32_bf16 v[60:63], v[76:79], v[140:143], v[60:63]
    ds_read_b128 v[72:75], v82 offset:3072
    ds_read_b128 v[76:79], v83 offset:3072
    s_waitcnt lgkmcnt(2)
    v_mfma_f32_16x16x32_bf16 v[32:35], a[144:147], v[64:67], v[32:35]
    v_mfma_f32_16x16x32_bf16 v[36:39], a[144:147], v[68:71], v[36:39]
    v_mfma_f32_16x16x32_bf16 v[40:43], a[148:151], v[64:67], v[40:43]
    v_mfma_f32_16x16x32_bf16 v[44:47], a[148:151], v[68:71], v[44:47]
    v_mfma_f32_16x16x32_bf16 v[48:51], v[64:67], v[144:147], v[48:51]
    v_mfma_f32_16x16x32_bf16 v[56:59], v[68:71], v[144:147], v[56:59]
    v_mfma_f32_16x16x32_bf16 v[52:55], v[64:67], v[148:151], v[52:55]
    v_mfma_f32_16x16x32_bf16 v[60:63], v[68:71], v[148:151], v[60:63]
    ds_read_b128 v[64:67], v80 offset:4096
    ds_read_b128 v[68:71], v81 offset:4096
    s_waitcnt lgkmcnt(2)
    v_mfma_f32_16x16x32_bf16 v[32:35], a[152:155], v[72:75], v[32:35]
    v_mfma_f32_16x16x32_bf16 v[36:39], a[152:155], v[76:79], v[36:39]
    v_mfma_f32_16x16x32_bf16 v[40:43], a[156:159], v[72:75], v[40:43]
    v_mfma_f32_16x16x32_bf16 v[44:47], a[156:159], v[76:79], v[44:47]
    v_mfma_f32_16x16x32_bf16 v[48:51], v[72:75], v[152:155], v[48:51]
    v_mfma_f32_16x16x32_bf16 v[56:59], v[76:79], v[152:155], v[56:59]
    v_mfma_f32_16x16x32_bf16 v[52:55], v[72:75], v[156:159], v[52:55]
    v_mfma_f32_16x16x32_bf16 v[60:63], v[76:79], v[156:159], v[60:63]
    ds_read_b128 v[72:75], v82 offset:5120
    ds_read_b128 v[76:79], v83 offset:5120
    s_waitcnt lgkmcnt(2)
    v_mfma_f32_16x16x32_bf16 v[32:35], a[160:163], v[64:67], v[32:35]
    v_mfma_f32_16x16x32_bf16 v[36:39], a[160:163], v[68:71], v[36:39]
    v_mfma_f32_16x16x32_bf16 v[40:43], a[164:167], v[64:67], v[40:43]
    v_mfma_f32_16x16x32_bf16 v[44:47], a[164:167], v[68:71], v[44:47]
    v_mfma_f32_16x16x32_bf16 v[48:51], v[64:67], v[160:163], v[48:51]
    v_mfma_f32_16x16x32_bf16 v[56:59], v[68:71], v[160:163], v[56:59]
    v_mfma_f32_16x16x32_bf16 v[52:55], v[64:67], v[164:167], v[52:55]
    v_mfma_f32_16x16x32_bf16 v[60:63], v[68:71], v[164:167], v[60:63]
    ds_read_b128 v[64:67], v80 offset:6144
    ds_read_b128 v[68:71], v81 offset:6144
    s_waitcnt lgkmcnt(2)
    v_mfma_f32_16x16x32_bf16 v[32:35], a[168:171], v[72:75], v[32:35]
    v_mfma_f32_16x16x32_bf16 v[36:39], a[168:171], v[76:79], v[36:39]
    v_mfma_f32_16x16x32_bf16 v[40:43], a[172:175], v[72:75], v[40:43]
    v_mfma_f32_16x16x32_bf16 v[44:47], a[172:175], v[76:79], v[44:47]
    v_mfma_f32_16x16x32_bf16 v[48:51], v[72:75], v[168:171], v[48:51]
    v_mfma_f32_16x16x32_bf16 v[56:59], v[76:79], v[168:171], v[56:59]
    v_mfma_f32_16x16x32_bf16 v[52:55], v[72:75], v[172:175], v[52:55]
    v_mfma_f32_16x16x32_bf16 v[60:63], v[76:79], v[172:175], v[60:63]
    ds_read_b128 v[72:75], v82 offset:7168
    ds_read_b128 v[76:79], v83 offset:7168
    s_waitcnt lgkmcnt(2)
    v_mfma_f32_16x16x32_bf16 v[32:35], a[176:179], v[64:67], v[32:35]
    v_mfma_f32_16x16x32_bf16 v[36:39], a[176:179], v[68:71], v[36:39]
    v_mfma_f32_16x16x32_bf16 v[40:43], a[180:183], v[64:67], v[40:43]
    v_mfma_f32_16x16x32_bf16 v[44:47], a[180:183], v[68:71], v[44:47]
    v_mfma_f32_16x16x32_bf16 v[48:51], v[64:67], v[176:179], v[48:51]
    v_mfma_f32_16x16x32_bf16 v[56:59], v[68:71], v[176:179], v[56:59]
    v_mfma_f32_16x16x32_bf16 v[52:55], v[64:67], v[180:183], v[52:55]
    v_mfma_f32_16x16x32_bf16 v[60:63], v[68:71], v[180:183], v[60:63]
    ds_read_b128 v[64:67], v80 offset:8192
    ds_read_b128 v[68:71], v81 offset:8192
    s_waitcnt lgkmcnt(2)
    v_mfma_f32_16x16x32_bf16 v[32:35], a[184:187], v[72:75], v[32:35]
    v_mfma_f32_16x16x32_bf16 v[36:39], a[184:187], v[76:79], v[36:39]
    v_mfma_f32_16x16x32_bf16 v[40:43], a[188:191], v[72:75], v[40:43]
    v_mfma_f32_16x16x32_bf16 v[44:47], a[188:191], v[76:79], v[44:47]
    v_mfma_f32_16x16x32_bf16 v[48:51], v[72:75], v[184:187], v[48:51]
    v_mfma_f32_16x16x32_bf16 v[56:59], v[76:79], v[184:187], v[56:59]
    v_mfma_f32_16x16x32_bf16 v[52:55], v[72:75], v[188:191], v[52:55]
    v_mfma_f32_16x16x32_bf16 v[60:63], v[76:79], v[188:191], v[60:63]
    ds_read_b128 v[72:75], v82 offset:9216
    ds_read_b128 v[76:79], v83 offset:9216
    s_waitcnt lgkmcnt(2)
    v_mfma_f32_16x16x32_bf16 v[32:35], a[192:195], v[64:67], v[32:35]
    v_mfma_f32_16x16x32_bf16 v[36:39], a[192:195], v[68:71], v[36:39]
    v_mfma_f32_16x16x32_bf16 v[40:43], a[196:199], v[64:67], v[40:43]
    v_mfma_f32_16x16x32_bf16 v[44:47], a[196:199], v[68:71], v[44:47]
    v_mfma_f32_16x16x32_bf16 v[48:51], v[64:67], v[192:195], v[48:51]
    v_mfma_f32_16x16x32_bf16 v[56:59], v[68:71], v[192:195], v[56:59]
    v_mfma_f32_16x16x32_bf16 v[52:55], v[64:67], v[196:199], v[52:55]
    v_mfma_f32_16x16x32_bf16 v[60:63], v[68:71], v[196:199], v[60:63]
    ds_read_b128 v[64:67], v80 offset:10240
    ds_read_b128 v[68:71], v81 offset:10240
    s_waitcnt lgkmcnt(2)
    v_mfma_f32_16x16x32_bf16 v[32:35], a[200:203], v[72:75], v[32:35]
    v_mfma_f32_16x16x32_bf16 v[36:39], a[200:203], v[76:79], v[36:39]
    v_mfma_f32_16x16x32_bf16 v[40:43], a[204:207], v[72:75], v[40:43]
    v_mfma_f32_16x16x32_bf16 v[44:47], a[204:207], v[76:79], v[44:47]
    v_mfma_f32_16x16x32_bf16 v[48:51], v[72:75], v[200:203], v[48:51]
    v_mfma_f32_16x16x32_bf16 v[56:59], v[76:79], v[200:203], v[56:59]
    v_mfma_f32_16x16x32_bf16 v[52:55], v[72:75], v[204:207], v[52:55]
    v_mfma_f32_16x16x32_bf16 v[60:63], v[76:79], v[204:207], v[60:63]
    ds_read_b128 v[72:75], v82 offset:11264
    ds_read_b128 v[76:79], v83 offset:11264
    s_waitcnt lgkmcnt(2)
    v_mfma_f32_16x16x32_bf16 v[32:35], a[208:211], v[64:67], v[32:35]
    v_mfma_f32_16x16x32_bf16 v[36:39], a[208:211], v[68:71], v[36:39]
    v_mfma_f32_16x16x32_bf16 v[40:43], a[212:215], v[64:67], v[40:43]
    v_mfma_f32_16x16x32_bf16 v[44:47], a[212:215], v[68:71], v[44:47]
    v_mfma_f32_16x16x32_bf16 v[48:51], v[64:67], v[208:211], v[48:51]
    v_mfma_f32_16x16x32_bf16 v[56:59], v[68:71], v[208:211], v[56:59]
    v_mfma_f32_16x16x32_bf16 v[52:55], v[64:67], v[212:215], v[52:55]
    v_mfma_f32_16x16x32_bf16 v[60:63], v[68:71], v[212:215], v[60:63]
    ds_read_b128 v[64:67], v80 offset:12288
    ds_read_b128 v[68:71], v81 offset:12288
    s_waitcnt lgkmcnt(2)
    v_mfma_f32_16x16x32_bf16 v[32:35], a[216:219], v[72:75], v[32:35]
    v_mfma_f32_16x16x32_bf16 v[36:39], a[216:219], v[76:79], v[36:39]
    v_mfma_f32_16x16x32_bf16 v[40:43], a[220:223], v[72:75], v[40:43]
    v_mfma_f32_16x16x32_bf16 v[44:47], a[220:223], v[76:79], v[44:47]
    v_mfma_f32_16x16x32_bf16 v[48:51], v[72:75], v[216:219], v[48:51]
    v_mfma_f32_16x16x32_bf16 v[56:59], v[76:79], v[216:219], v[56:59]
    v_mfma_f32_16x16x32_bf16 v[52:55], v[72:75], v[220:223], v[52:55]
    v_mfma_f32_16x16x32_bf16 v[60:63], v[76:79], v[220:223], v[60:63]
    ds_read_b128 v[72:75], v82 offset:13312
    ds_read_b128 v[76:79], v83 offset:13312
    s_waitcnt lgkmcnt(2)
    v_mfma_f32_16x16x32_bf16 v[32:35], a[224:227], v[64:67], v[32:35]
    v_mfma_f32_16x16x32_bf16 v[36:39], a[224:227], v[68:71], v[36:39]
    v_mfma_f32_16x16x32_bf16 v[40:43], a[228:231], v[64:67], v[40:43]
    v_mfma_f32_16x16x32_bf16 v[44:47], a[228:231], v[68:71], v[44:47]
    v_mfma_f32_16x16x32_bf16 v[48:51], v[64:67], v[224:227], v[48:51]
    v_mfma_f32_16x16x32_bf16 v[56:59], v[68:71], v[224:227], v[56:59]
    v_mfma_f32_16x16x32_bf16 v[52:55], v[64:67], v[228:231], v[52:55]
    v_mfma_f32_16x16x32_bf16 v[60:63], v[68:71], v[228:231], v[60:63]
    ds_read_b128 v[64:67], v80 offset:14336
    ds_read_b128 v[68:71], v81 offset:14336
    s_waitcnt lgkmcnt(2)
    v_mfma_f32_16x16x32_bf16 v[32:35], a[232:235], v[72:75], v[32:35]
    v_mfma_f32_16x16x32_bf16 v[36:39], a[232:235], v[76:79], v[36:39]
    v_mfma_f32_16x16x32_bf16 v[40:43], a[236:239], v[72:75], v[40:43]
    v_mfma_f32_16x16x32_bf16 v[44:47], a[236:239], v[76:79], v[44:47]
    v_mfma_f32_16x16x32_bf16 v[48:51], v[72:75], v[232:235], v[48:51]
    v_mfma_f32_16x16x32_bf16 v[56:59], v[76:79], v[232:235], v[56:59]
    v_mfma_f32_16x16x32_bf16 v[52:55], v[72:75], v[236:239], v[52:55]
    v_mfma_f32_16x16x32_bf16 v[60:63], v[76:79], v[236:239], v[60:63]
    ds_read_b128 v[72:75], v82 offset:15360
    ds_read_b128 v[76:79], v83 offset:15360
    s_waitcnt lgkmcnt(2)
    v_mfma_f32_16x16x32_bf16 v[32:35], a[240:243], v[64:67], v[32:35]
    v_mfma_f32_16x16x32_bf16 v[36:39], a[240:243], v[68:71], v[36:39]
    v_mfma_f32_16x16x32_bf16 v[40:43], a[244:247], v[64:67], v[40:43]
    v_mfma_f32_16x16x32_bf16 v[44:47], a[244:247], v[68:71], v[44:47]
    v_mfma_f32_16x16x32_bf16 v[48:51], v[64:67], v[240:243], v[48:51]
    v_mfma_f32_16x16x32_bf16 v[56:59], v[68:71], v[240:243], v[56:59]
    v_mfma_f32_16x16x32_bf16 v[52:55], v[64:67], v[244:247], v[52:55]
    v_mfma_f32_16x16x32_bf16 v[60:63], v[68:71], v[244:247], v[60:63]
    s_waitcnt lgkmcnt(0)
    v_mfma_f32_16x16x32_bf16 v[32:35], a[248:251], v[72:75], v[32:35]
    v_mfma_f32_16x16x32_bf16 v[36:39], a[248:251], v[76:79], v[36:39]
    v_mfma_f32_16x16x32_bf16 v[40:43], a[252:255], v[72:75], v[40:43]
    v_mfma_f32_16x16x32_bf16 v[44:47], a[252:255], v[76:79], v[44:47]
    v_mfma_f32_16x16x32_bf16 v[48:51], v[72:75], v[248:251], v[48:51]
    v_mfma_f32_16x16x32_bf16 v[56:59], v[76:79], v[248:251], v[56:59]
    v_mfma_f32_16x16x32_bf16 v[52:55], v[72:75], v[252:255], v[52:55]
    v_mfma_f32_16x16x32_bf16 v[60:63], v[76:79], v[252:255], v[60:63]
    s_nop 0
    v_mul_f32 v32, s33, v32
    v_mul_f32 v33, s33, v33
    v_mul_f32 v34, s33, v34
    v_mul_f32 v35, s33, v35
    v_mul_f32 v36, s33, v36
    v_mul_f32 v37, s33, v37
    v_mul_f32 v38, s33, v38
    v_mul_f32 v39, s33, v39
    v_mul_f32 v40, s33, v40
    v_mul_f32 v41, s33, v41
    v_mul_f32 v42, s33, v42
    v_mul_f32 v43, s33, v43
    v_mul_f32 v44, s33, v44
    v_mul_f32 v45, s33, v45
    v_mul_f32 v46, s33, v46
    v_mul_f32 v47, s33, v47
    v_cvt_pk_bf16_f32 v88, v32, v40
    v_cvt_pk_bf16_f32 v89, v33, v41
    v_cvt_pk_bf16_f32 v90, v34, v42
    v_cvt_pk_bf16_f32 v91, v35, v43
    v_cvt_pk_bf16_f32 v92, v36, v44
    v_cvt_pk_bf16_f32 v93, v37, v45
    v_cvt_pk_bf16_f32 v94, v38, v46
    v_cvt_pk_bf16_f32 v95, v39, v47
    v_cvt_pk_bf16_f32 v96, v48, v49
    v_cvt_pk_bf16_f32 v97, v50, v51
    v_cvt_pk_bf16_f32 v98, v56, v57
    v_cvt_pk_bf16_f32 v99, v58, v59
    v_cvt_pk_bf16_f32 v100, v52, v53
    v_cvt_pk_bf16_f32 v101, v54, v55
    v_cvt_pk_bf16_f32 v102, v60, v61
    v_cvt_pk_bf16_f32 v103, v62, v63
    s_mul_i32 s24, s23, 0x82100
    s_lshl_b32 s36, s20, 14
    s_add_u32 s24, s24, s36
    s_add_u32 s24, s24, 0x1000000
    s_mov_b32 s30, s24
    s_lshr_b32 s36, s21, 1
    s_lshl_b32 s36, s36, 12
    s_xor_b32 s37, s36, 4096
    s_add_u32 s36, s36, s24
    s_add_u32 s37, s37, s24
    buffer_store_dwordx4 v[88:91], v9, s[8:11], s36 offen sc1
    buffer_store_dwordx4 v[92:95], v9, s[8:11], s37 offen sc1
    s_add_u32 s24, s24, 8192
    buffer_store_dwordx4 v[96:99], v2, s[8:11], s24 offen sc1
    buffer_store_dwordx4 v[100:103], v2, s[8:11], s24 offen offset:1024 sc1
    s_mul_i32 s25, s23, 0x82100
    s_lshl_b32 s36, s20, 2
    s_add_u32 s25, s25, s36
    s_add_u32 s25, s25, 0x1082000
    v_lshrrev_b32 v15, 2, v1
    v_and_b32 v15, 127, v15
L_WHS:
    buffer_load_dword v14, v15, s[16:19], 0 offen sc1
    s_add_u32 s32, s32, 1
    s_cmp_gt_u32 s32, 200000
    s_cbranch_scc1 L_WHS_done
    s_waitcnt vmcnt(0)
    v_cmp_eq_u32 vcc, 0, v14
    s_cbranch_vccnz L_WHS
L_WHS_done:
    s_waitcnt vmcnt(0)
    s_barrier
    v_cmp_ne_u32 vcc, 0, v0
    v_mov_b32 v15, 0x40000000
    v_mov_b32 v14, 1
    v_cndmask_b32 v15, v0, v15, vcc
    buffer_store_dword v14, v15, s[8:11], s25 offen sc1
    s_barrier
    ds_read_b64_tr_b16 a[0:1], v20 offset:0
    ds_read_b64_tr_b16 a[2:3], v20 offset:1024
    ds_read_b64_tr_b16 a[4:5], v21 offset:0
    ds_read_b64_tr_b16 a[6:7], v21 offset:1024
    ds_read_b64_tr_b16 a[8:9], v22 offset:0
    ds_read_b64_tr_b16 a[10:11], v22 offset:1024
    ds_read_b64_tr_b16 a[12:13], v23 offset:0
    ds_read_b64_tr_b16 a[14:15], v23 offset:1024
    ds_read_b64_tr_b16 a[16:17], v24 offset:0
    ds_read_b64_tr_b16 a[18:19], v24 offset:1024
    ds_read_b64_tr_b16 a[20:21], v25 offset:0
    ds_read_b64_tr_b16 a[22:23], v25 offset:1024
    s_waitcnt lgkmcnt(4)
    ds_read_b64_tr_b16 a[24:25], v26 offset:0
    ds_read_b64_tr_b16 a[26:27], v26 offset:1024
    ds_read_b64_tr_b16 a[28:29], v27 offset:0
    ds_read_b64_tr_b16 a[30:31], v27 offset:1024
    s_waitcnt lgkmcnt(0)
    s_barrier
    s_barrier
    ds_read_b64_tr_b16 a[32:33], v20 offset:8192
    ds_read_b64_tr_b16 a[34:35], v20 offset:9216
    ds_read_b64_tr_b16 a[36:37], v21 offset:8192
    ds_read_b64_tr_b16 a[38:39], v21 offset:9216
    ds_read_b64_tr_b16 a[40:41], v22 offset:8192
    ds_read_b64_tr_b16 a[42:43], v22 offset:9216
    ds_read_b64_tr_b16 a[44:45], v23 offset:8192
    ds_read_b64_tr_b16 a[46:47], v23 offset:9216
    ds_read_b64_tr_b16 a[48:49], v24 offset:8192
    ds_read_b64_tr_b16 a[50:51], v24 offset:9216
    ds_read_b64_tr_b16 a[52:53], v25 offset:8192
    ds_read_b64_tr_b16 a[54:55], v25 offset:9216
    s_waitcnt lgkmcnt(4)
    ds_read_b64_tr_b16 a[56:57], v26 offset:8192
    ds_read_b64_tr_b16 a[58:59], v26 offset:9216
    ds_read_b64_tr_b16 a[60:61], v27 offset:8192
    ds_read_b64_tr_b16 a[62:63], v27 offset:9216
    s_waitcnt lgkmcnt(0)
    s_barrier
    s_barrier
    ds_read_b64_tr_b16 a[64:65], v20 offset:16384
    ds_read_b64_tr_b16 a[66:67], v20 offset:17408
    ds_read_b64_tr_b16 a[68:69], v21 offset:16384
    ds_read_b64_tr_b16 a[70:71], v21 offset:17408
    ds_read_b64_tr_b16 a[72:73], v22 offset:16384
    ds_read_b64_tr_b16 a[74:75], v22 offset:17408
    ds_read_b64_tr_b16 a[76:77], v23 offset:16384
    ds_read_b64_tr_b16 a[78:79], v23 offset:17408
    ds_read_b64_tr_b16 a[80:81], v24 offset:16384
    ds_read_b64_tr_b16 a[82:83], v24 offset:17408
    ds_read_b64_tr_b16 a[84:85], v25 offset:16384
    ds_read_b64_tr_b16 a[86:87], v25 offset:17408
    s_waitcnt lgkmcnt(4)
    ds_read_b64_tr_b16 a[88:89], v26 offset:16384
    ds_read_b64_tr_b16 a[90:91], v26 offset:17408
    ds_read_b64_tr_b16 a[92:93], v27 offset:16384
    ds_read_b64_tr_b16 a[94:95], v27 offset:17408
    s_waitcnt lgkmcnt(0)
    s_barrier
    s_barrier
    ds_read_b64_tr_b16 a[96:97], v20 offset:24576
    ds_read_b64_tr_b16 a[98:99], v20 offset:25600
    ds_read_b64_tr_b16 a[100:101], v21 offset:24576
    ds_read_b64_tr_b16 a[102:103], v21 offset:25600
    ds_read_b64_tr_b16 a[104:105], v22 offset:24576
    ds_read_b64_tr_b16 a[106:107], v22 offset:25600
    ds_read_b64_tr_b16 a[108:109], v23 offset:24576
    ds_read_b64_tr_b16 a[110:111], v23 offset:25600
    ds_read_b64_tr_b16 a[112:113], v24 offset:24576
    ds_read_b64_tr_b16 a[114:115], v24 offset:25600
    ds_read_b64_tr_b16 a[116:117], v25 offset:24576
    ds_read_b64_tr_b16 a[118:119], v25 offset:25600
    s_waitcnt lgkmcnt(4)
    ds_read_b64_tr_b16 a[120:121], v26 offset:24576
    ds_read_b64_tr_b16 a[122:123], v26 offset:25600
    ds_read_b64_tr_b16 a[124:125], v27 offset:24576
    ds_read_b64_tr_b16 a[126:127], v27 offset:25600
    s_waitcnt lgkmcnt(0)
    s_barrier
L_P1:
    s_waitcnt vmcnt(8)
    s_barrier
    s_xor_b32 s31, s31, 32768
    s_add_u32 s24, s23, 6
    s_min_u32 s24, s24, 63
    s_lshl_b32 s36, s24, 15
    s_add_u32 s36, s36, 0x800000
    s_lshl_b32 s37, s21, 10
    s_add_u32 s37, s37, s31
    s_add_u32 m0, s37, 0
    s_add_u32 s38, s36, 0
    buffer_load_dwordx4 v9, s[8:11], s38 offen sc1 lds
    s_add_u32 m0, s37, 4096
    s_add_u32 s38, s36, 4096
    buffer_load_dwordx4 v9, s[8:11], s38 offen sc1 lds
    s_add_u32 m0, s37, 8192
    s_add_u32 s38, s36, 8192
    buffer_load_dwordx4 v9, s[8:11], s38 offen sc1 lds
    s_add_u32 m0, s37, 12288
    s_add_u32 s38, s36, 12288
    buffer_load_dwordx4 v9, s[8:11], s38 offen sc1 lds
    s_add_u32 m0, s37, 16384
    s_add_u32 s38, s36, 16384
    buffer_load_dwordx4 v9, s[8:11], s38 offen sc1 lds
    s_add_u32 m0, s37, 20480
    s_add_u32 s38, s36, 20480
    buffer_load_dwordx4 v9, s[8:11], s38 offen sc1 lds
    s_add_u32 m0, s37, 24576
    s_add_u32 s38, s36, 24576
    buffer_load_dwordx4 v9, s[8:11], s38 offen sc1 lds
    s_add_u32 m0, s37, 28672
    s_add_u32 s38, s36, 28672
    buffer_load_dwordx4 v9, s[8:11], s38 offen sc1 lds
    ds_read_b128 v[64:67], v80 offset:0
    ds_read_b128 v[68:71], v81 offset:0
    ds_read_b128 v[72:75], v82 offset:1024
    ds_read_b128 v[76:79], v83 offset:1024
    s_waitcnt lgkmcnt(2)
    v_mfma_f32_16x16x32_bf16 v[32:35], a[128:131], v[64:67], 0
    v_mfma_f32_16x16x32_bf16 v[36:39], a[128:131], v[68:71], 0
    v_mfma_f32_16x16x32_bf16 v[40:43], a[132:135], v[64:67], 0
    v_mfma_f32_16x16x32_bf16 v[44:47], a[132:135], v[68:71], 0
    v_mfma_f32_16x16x32_bf16 v[48:51], v[64:67], v[128:131], 0
    v_mfma_f32_16x16x32_bf16 v[56:59], v[68:71], v[128:131], 0
    v_mfma_f32_16x16x32_bf16 v[52:55], v[64:67], v[132:135], 0
    v_mfma_f32_16x16x32_bf16 v[60:63], v[68:71], v[132:135], 0
    v_mfma_f32_16x16x32_bf16 v[16:19], a[0:3], v[64:67], 0
    v_mfma_f32_16x16x32_bf16 v[20:23], a[0:3], v[68:71], 0
    v_mfma_f32_16x16x32_bf16 v[24:27], a[4:7], v[64:67], 0
    v_mfma_f32_16x16x32_bf16 v[28:31], a[4:7], v[68:71], 0
    ds_read_b128 v[64:67], v80 offset:2048
    ds_read_b128 v[68:71], v81 offset:2048
    s_waitcnt lgkmcnt(2)
    v_mfma_f32_16x16x32_bf16 v[32:35], a[136:139], v[72:75], v[32:35]
    v_mfma_f32_16x16x32_bf16 v[36:39], a[136:139], v[76:79], v[36:39]
    v_mfma_f32_16x16x32_bf16 v[40:43], a[140:143], v[72:75], v[40:43]
    v_mfma_f32_16x16x32_bf16 v[44:47], a[140:143], v[76:79], v[44:47]
    v_mfma_f32_16x16x32_bf16 v[48:51], v[72:75], v[136:139], v[48:51]
    v_mfma_f32_16x16x32_bf16 v[56:59], v[76:79], v[136:139], v[56:59]
    v_mfma_f32_16x16x32_bf16 v[52:55], v[72:75], v[140:143], v[52:55]
    v_mfma_f32_16x16x32_bf16 v[60:63], v[76:79], v[140:143], v[60:63]
    v_mfma_f32_16x16x32_bf16 v[16:19], a[8:11], v[72:75], v[16:19]
    v_mfma_f32_16x16x32_bf16 v[20:23], a[8:11], v[76:79], v[20:23]
    v_mfma_f32_16x16x32_bf16 v[24:27], a[12:15], v[72:75], v[24:27]
    v_mfma_f32_16x16x32_bf16 v[28:31], a[12:15], v[76:79], v[28:31]
    ds_read_b128 v[72:75], v82 offset:3072
    ds_read_b128 v[76:79], v83 offset:3072
    s_waitcnt lgkmcnt(2)
    v_mfma_f32_16x16x32_bf16 v[32:35], a[144:147], v[64:67], v[32:35]
    v_mfma_f32_16x16x32_bf16 v[36:39], a[144:147], v[68:71], v[36:39]
    v_mfma_f32_16x16x32_bf16 v[40:43], a[148:151], v[64:67], v[40:43]
    v_mfma_f32_16x16x32_bf16 v[44:47], a[148:151], v[68:71], v[44:47]
    v_mfma_f32_16x16x32_bf16 v[48:51], v[64:67], v[144:147], v[48:51]
    v_mfma_f32_16x16x32_bf16 v[56:59], v[68:71], v[144:147], v[56:59]
    v_mfma_f32_16x16x32_bf16 v[52:55], v[64:67], v[148:151], v[52:55]
    v_mfma_f32_16x16x32_bf16 v[60:63], v[68:71], v[148:151], v[60:63]
    v_mfma_f32_16x16x32_bf16 v[16:19], a[16:19], v[64:67], v[16:19]
    v_mfma_f32_16x16x32_bf16 v[20:23], a[16:19], v[68:71], v[20:23]
    v_mfma_f32_16x16x32_bf16 v[24:27], a[20:23], v[64:67], v[24:27]
    v_mfma_f32_16x16x32_bf16 v[28:31], a[20:23], v[68:71], v[28:31]
    ds_read_b128 v[64:67], v80 offset:4096
    ds_read_b128 v[68:71], v81 offset:4096
    s_waitcnt lgkmcnt(2)
    v_mfma_f32_16x16x32_bf16 v[32:35], a[152:155], v[72:75], v[32:35]
    v_mfma_f32_16x16x32_bf16 v[36:39], a[152:155], v[76:79], v[36:39]
    v_mfma_f32_16x16x32_bf16 v[40:43], a[156:159], v[72:75], v[40:43]
    v_mfma_f32_16x16x32_bf16 v[44:47], a[156:159], v[76:79], v[44:47]
    v_mfma_f32_16x16x32_bf16 v[48:51], v[72:75], v[152:155], v[48:51]
    v_mfma_f32_16x16x32_bf16 v[56:59], v[76:79], v[152:155], v[56:59]
    v_mfma_f32_16x16x32_bf16 v[52:55], v[72:75], v[156:159], v[52:55]
    v_mfma_f32_16x16x32_bf16 v[60:63], v[76:79], v[156:159], v[60:63]
    v_mfma_f32_16x16x32_bf16 v[16:19], a[24:27], v[72:75], v[16:19]
    v_mfma_f32_16x16x32_bf16 v[20:23], a[24:27], v[76:79], v[20:23]
    v_mfma_f32_16x16x32_bf16 v[24:27], a[28:31], v[72:75], v[24:27]
    v_mfma_f32_16x16x32_bf16 v[28:31], a[28:31], v[76:79], v[28:31]
    ds_read_b128 v[72:75], v82 offset:5120
    ds_read_b128 v[76:79], v83 offset:5120
    s_waitcnt lgkmcnt(2)
    v_mfma_f32_16x16x32_bf16 v[32:35], a[160:163], v[64:67], v[32:35]
    v_mfma_f32_16x16x32_bf16 v[36:39], a[160:163], v[68:71], v[36:39]
    v_mfma_f32_16x16x32_bf16 v[40:43], a[164:167], v[64:67], v[40:43]
    v_mfma_f32_16x16x32_bf16 v[44:47], a[164:167], v[68:71], v[44:47]
    v_mfma_f32_16x16x32_bf16 v[48:51], v[64:67], v[160:163], v[48:51]
    v_mfma_f32_16x16x32_bf16 v[56:59], v[68:71], v[160:163], v[56:59]
    v_mfma_f32_16x16x32_bf16 v[52:55], v[64:67], v[164:167], v[52:55]
    v_mfma_f32_16x16x32_bf16 v[60:63], v[68:71], v[164:167], v[60:63]
    v_mfma_f32_16x16x32_bf16 v[16:19], a[32:35], v[64:67], v[16:19]
    v_mfma_f32_16x16x32_bf16 v[20:23], a[32:35], v[68:71], v[20:23]
    v_mfma_f32_16x16x32_bf16 v[24:27], a[36:39], v[64:67], v[24:27]
    v_mfma_f32_16x16x32_bf16 v[28:31], a[36:39], v[68:71], v[28:31]
    ds_read_b128 v[64:67], v80 offset:6144
    ds_read_b128 v[68:71], v81 offset:6144
    s_waitcnt lgkmcnt(2)
    v_mfma_f32_16x16x32_bf16 v[32:35], a[168:171], v[72:75], v[32:35]
    v_mfma_f32_16x16x32_bf16 v[36:39], a[168:171], v[76:79], v[36:39]
    v_mfma_f32_16x16x32_bf16 v[40:43], a[172:175], v[72:75], v[40:43]
    v_mfma_f32_16x16x32_bf16 v[44:47], a[172:175], v[76:79], v[44:47]
    v_mfma_f32_16x16x32_bf16 v[48:51], v[72:75], v[168:171], v[48:51]
    v_mfma_f32_16x16x32_bf16 v[56:59], v[76:79], v[168:171], v[56:59]
    v_mfma_f32_16x16x32_bf16 v[52:55], v[72:75], v[172:175], v[52:55]
    v_mfma_f32_16x16x32_bf16 v[60:63], v[76:79], v[172:175], v[60:63]
    v_mfma_f32_16x16x32_bf16 v[16:19], a[40:43], v[72:75], v[16:19]
    v_mfma_f32_16x16x32_bf16 v[20:23], a[40:43], v[76:79], v[20:23]
    v_mfma_f32_16x16x32_bf16 v[24:27], a[44:47], v[72:75], v[24:27]
    v_mfma_f32_16x16x32_bf16 v[28:31], a[44:47], v[76:79], v[28:31]
    ds_read_b128 v[72:75], v82 offset:7168
    ds_read_b128 v[76:79], v83 offset:7168
    s_waitcnt lgkmcnt(2)
    s_waitcnt vmcnt(8)
    s_barrier
    v_cmp_ne_u32 vcc, 0, v0
    v_mov_b32 v15, 0x40000000
    v_mov_b32 v14, 1
    v_cndmask_b32 v15, v0, v15, vcc
    buffer_store_dword v14, v15, s[8:11], s25 offen sc1
    v_mfma_f32_16x16x32_bf16 v[32:35], a[176:179], v[64:67], v[32:35]
    v_mfma_f32_16x16x32_bf16 v[36:39], a[176:179], v[68:71], v[36:39]
    v_mfma_f32_16x16x32_bf16 v[40:43], a[180:183], v[64:67], v[40:43]
    v_mfma_f32_16x16x32_bf16 v[44:47], a[180:183], v[68:71], v[44:47]
    v_mfma_f32_16x16x32_bf16 v[48:51], v[64:67], v[176:179], v[48:51]
    v_mfma_f32_16x16x32_bf16 v[56:59], v[68:71], v[176:179], v[56:59]
    v_mfma_f32_16x16x32_bf16 v[52:55], v[64:67], v[180:183], v[52:55]
    v_mfma_f32_16x16x32_bf16 v[60:63], v[68:71], v[180:183], v[60:63]
    v_mfma_f32_16x16x32_bf16 v[16:19], a[48:51], v[64:67], v[16:19]
    v_mfma_f32_16x16x32_bf16 v[20:23], a[48:51], v[68:71], v[20:23]
    v_mfma_f32_16x16x32_bf16 v[24:27], a[52:55], v[64:67], v[24:27]
    v_mfma_f32_16x16x32_bf16 v[28:31], a[52:55], v[68:71], v[28:31]
    ds_read_b128 v[64:67], v80 offset:8192
    ds_read_b128 v[68:71], v81 offset:8192
    s_waitcnt lgkmcnt(2)
    v_mfma_f32_16x16x32_bf16 v[32:35], a[184:187], v[72:75], v[32:35]
    v_mfma_f32_16x16x32_bf16 v[36:39], a[184:187], v[76:79], v[36:39]
    v_mfma_f32_16x16x32_bf16 v[40:43], a[188:191], v[72:75], v[40:43]
    v_mfma_f32_16x16x32_bf16 v[44:47], a[188:191], v[76:79], v[44:47]
    v_mfma_f32_16x16x32_bf16 v[48:51], v[72:75], v[184:187], v[48:51]
    v_mfma_f32_16x16x32_bf16 v[56:59], v[76:79], v[184:187], v[56:59]
    v_mfma_f32_16x16x32_bf16 v[52:55], v[72:75], v[188:191], v[52:55]
    v_mfma_f32_16x16x32_bf16 v[60:63], v[76:79], v[188:191], v[60:63]
    v_mfma_f32_16x16x32_bf16 v[16:19], a[56:59], v[72:75], v[16:19]
    v_mfma_f32_16x16x32_bf16 v[20:23], a[56:59], v[76:79], v[20:23]
    v_mfma_f32_16x16x32_bf16 v[24:27], a[60:63], v[72:75], v[24:27]
    v_mfma_f32_16x16x32_bf16 v[28:31], a[60:63], v[76:79], v[28:31]
    ds_read_b128 v[72:75], v82 offset:9216
    ds_read_b128 v[76:79], v83 offset:9216
    s_waitcnt lgkmcnt(2)
    v_mfma_f32_16x16x32_bf16 v[32:35], a[192:195], v[64:67], v[32:35]
    v_mfma_f32_16x16x32_bf16 v[36:39], a[192:195], v[68:71], v[36:39]
    v_mfma_f32_16x16x32_bf16 v[40:43], a[196:199], v[64:67], v[40:43]
    v_mfma_f32_16x16x32_bf16 v[44:47], a[196:199], v[68:71], v[44:47]
    v_mfma_f32_16x16x32_bf16 v[48:51], v[64:67], v[192:195], v[48:51]
    v_mfma_f32_16x16x32_bf16 v[56:59], v[68:71], v[192:195], v[56:59]
    v_mfma_f32_16x16x32_bf16 v[52:55], v[64:67], v[196:199], v[52:55]
    v_mfma_f32_16x16x32_bf16 v[60:63], v[68:71], v[196:199], v[60:63]
    v_mfma_f32_16x16x32_bf16 v[16:19], a[64:67], v[64:67], v[16:19]
    v_mfma_f32_16x16x32_bf16 v[20:23], a[64:67], v[68:71], v[20:23]
    v_mfma_f32_16x16x32_bf16 v[24:27], a[68:71], v[64:67], v[24:27]
    v_mfma_f32_16x16x32_bf16 v[28:31], a[68:71], v[68:71], v[28:31]
    ds_read_b128 v[64:67], v80 offset:10240
    ds_read_b128 v[68:71], v81 offset:10240
    s_waitcnt lgkmcnt(2)
    v_mfma_f32_16x16x32_bf16 v[32:35], a[200:203], v[72:75], v[32:35]
    v_mfma_f32_16x16x32_bf16 v[36:39], a[200:203], v[76:79], v[36:39]
    v_mfma_f32_16x16x32_bf16 v[40:43], a[204:207], v[72:75], v[40:43]
    v_mfma_f32_16x16x32_bf16 v[44:47], a[204:207], v[76:79], v[44:47]
    v_mfma_f32_16x16x32_bf16 v[48:51], v[72:75], v[200:203], v[48:51]
    v_mfma_f32_16x16x32_bf16 v[56:59], v[76:79], v[200:203], v[56:59]
    v_mfma_f32_16x16x32_bf16 v[52:55], v[72:75], v[204:207], v[52:55]
    v_mfma_f32_16x16x32_bf16 v[60:63], v[76:79], v[204:207], v[60:63]
    v_mfma_f32_16x16x32_bf16 v[16:19], a[72:75], v[72:75], v[16:19]
    v_mfma_f32_16x16x32_bf16 v[20:23], a[72:75], v[76:79], v[20:23]
    v_mfma_f32_16x16x32_bf16 v[24:27], a[76:79], v[72:75], v[24:27]
    v_mfma_f32_16x16x32_bf16 v[28:31], a[76:79], v[76:79], v[28:31]
    ds_read_b128 v[72:75], v82 offset:11264
    ds_read_b128 v[76:79], v83 offset:11264
    s_waitcnt lgkmcnt(2)
    v_mfma_f32_16x16x32_bf16 v[32:35], a[208:211], v[64:67], v[32:35]
    v_mfma_f32_16x16x32_bf16 v[36:39], a[208:211], v[68:71], v[36:39]
    v_mfma_f32_16x16x32_bf16 v[40:43], a[212:215], v[64:67], v[40:43]
    v_mfma_f32_16x16x32_bf16 v[44:47], a[212:215], v[68:71], v[44:47]
    v_mfma_f32_16x16x32_bf16 v[48:51], v[64:67], v[208:211], v[48:51]
    v_mfma_f32_16x16x32_bf16 v[56:59], v[68:71], v[208:211], v[56:59]
    v_mfma_f32_16x16x32_bf16 v[52:55], v[64:67], v[212:215], v[52:55]
    v_mfma_f32_16x16x32_bf16 v[60:63], v[68:71], v[212:215], v[60:63]
    v_mfma_f32_16x16x32_bf16 v[16:19], a[80:83], v[64:67], v[16:19]
    v_mfma_f32_16x16x32_bf16 v[20:23], a[80:83], v[68:71], v[20:23]
    v_mfma_f32_16x16x32_bf16 v[24:27], a[84:87], v[64:67], v[24:27]
    v_mfma_f32_16x16x32_bf16 v[28:31], a[84:87], v[68:71], v[28:31]
    ds_read_b128 v[64:67], v80 offset:12288
    ds_read_b128 v[68:71], v81 offset:12288
    s_waitcnt lgkmcnt(2)
    v_mfma_f32_16x16x32_bf16 v[32:35], a[216:219], v[72:75], v[32:35]
    v_mfma_f32_16x16x32_bf16 v[36:39], a[216:219], v[76:79], v[36:39]
    v_mfma_f32_16x16x32_bf16 v[40:43], a[220:223], v[72:75], v[40:43]
    v_mfma_f32_16x16x32_bf16 v[44:47], a[220:223], v[76:79], v[44:47]
    v_mfma_f32_16x16x32_bf16 v[48:51], v[72:75], v[216:219], v[48:51]
    v_mfma_f32_16x16x32_bf16 v[56:59], v[76:79], v[216:219], v[56:59]
    v_mfma_f32_16x16x32_bf16 v[52:55], v[72:75], v[220:223], v[52:55]
    v_mfma_f32_16x16x32_bf16 v[60:63], v[76:79], v[220:223], v[60:63]
    v_mfma_f32_16x16x32_bf16 v[16:19], a[88:91], v[72:75], v[16:19]
    v_mfma_f32_16x16x32_bf16 v[20:23], a[88:91], v[76:79], v[20:23]
    v_mfma_f32_16x16x32_bf16 v[24:27], a[92:95], v[72:75], v[24:27]
    v_mfma_f32_16x16x32_bf16 v[28:31], a[92:95], v[76:79], v[28:31]
    ds_read_b128 v[72:75], v82 offset:13312
    ds_read_b128 v[76:79], v83 offset:13312
    s_waitcnt lgkmcnt(2)
    v_mfma_f32_16x16x32_bf16 v[32:35], a[224:227], v[64:67], v[32:35]
    v_mfma_f32_16x16x32_bf16 v[36:39], a[224:227], v[68:71], v[36:39]
    v_mfma_f32_16x16x32_bf16 v[40:43], a[228:231], v[64:67], v[40:43]
    v_mfma_f32_16x16x32_bf16 v[44:47], a[228:231], v[68:71], v[44:47]
    v_mfma_f32_16x16x32_bf16 v[48:51], v[64:67], v[224:227], v[48:51]
    v_mfma_f32_16x16x32_bf16 v[56:59], v[68:71], v[224:227], v[56:59]
    v_mfma_f32_16x16x32_bf16 v[52:55], v[64:67], v[228:231], v[52:55]
    v_mfma_f32_16x16x32_bf16 v[60:63], v[68:71], v[228:231], v[60:63]
    v_mfma_f32_16x16x32_bf16 v[16:19], a[96:99], v[64:67], v[16:19]
    v_mfma_f32_16x16x32_bf16 v[20:23], a[96:99], v[68:71], v[20:23]
    v_mfma_f32_16x16x32_bf16 v[24:27], a[100:103], v[64:67], v[24:27]
    v_mfma_f32_16x16x32_bf16 v[28:31], a[100:103], v[68:71], v[28:31]
    ds_read_b128 v[64:67], v80 offset:14336
    ds_read_b128 v[68:71], v81 offset:14336
    s_waitcnt lgkmcnt(2)
    v_mfma_f32_16x16x32_bf16 v[32:35], a[232:235], v[72:75], v[32:35]
    v_mfma_f32_16x16x32_bf16 v[36:39], a[232:235], v[76:79], v[36:39]
    v_mfma_f32_16x16x32_bf16 v[40:43], a[236:239], v[72:75], v[40:43]
    v_mfma_f32_16x16x32_bf16 v[44:47], a[236:239], v[76:79], v[44:47]
    v_mfma_f32_16x16x32_bf16 v[48:51], v[72:75], v[232:235], v[48:51]
    v_mfma_f32_16x16x32_bf16 v[56:59], v[76:79], v[232:235], v[56:59]
    v_mfma_f32_16x16x32_bf16 v[52:55], v[72:75], v[236:239], v[52:55]
    v_mfma_f32_16x16x32_bf16 v[60:63], v[76:79], v[236:239], v[60:63]
    v_mfma_f32_16x16x32_bf16 v[16:19], a[104:107], v[72:75], v[16:19]
    v_mfma_f32_16x16x32_bf16 v[20:23], a[104:107], v[76:79], v[20:23]
    v_mfma_f32_16x16x32_bf16 v[24:27], a[108:111], v[72:75], v[24:27]
    v_mfma_f32_16x16x32_bf16 v[28:31], a[108:111], v[76:79], v[28:31]
    ds_read_b128 v[72:75], v82 offset:15360
    ds_read_b128 v[76:79], v83 offset:15360
    s_waitcnt lgkmcnt(2)
    v_mfma_f32_16x16x32_bf16 v[32:35], a[240:243], v[64:67], v[32:35]
    v_mfma_f32_16x16x32_bf16 v[36:39], a[240:243], v[68:71], v[36:39]
    v_mfma_f32_16x16x32_bf16 v[40:43], a[244:247], v[64:67], v[40:43]
    v_mfma_f32_16x16x32_bf16 v[44:47], a[244:247], v[68:71], v[44:47]
    v_mfma_f32_16x16x32_bf16 v[48:51], v[64:67], v[240:243], v[48:51]
    v_mfma_f32_16x16x32_bf16 v[56:59], v[68:71], v[240:243], v[56:59]
    v_mfma_f32_16x16x32_bf16 v[52:55], v[64:67], v[244:247], v[52:55]
    v_mfma_f32_16x16x32_bf16 v[60:63], v[68:71], v[244:247], v[60:63]
    v_mfma_f32_16x16x32_bf16 v[16:19], a[112:115], v[64:67], v[16:19]
    v_mfma_f32_16x16x32_bf16 v[20:23], a[112:115], v[68:71], v[20:23]
    v_mfma_f32_16x16x32_bf16 v[24:27], a[116:119], v[64:67], v[24:27]
    v_mfma_f32_16x16x32_bf16 v[28:31], a[116:119], v[68:71], v[28:31]
    s_waitcnt lgkmcnt(0)
    v_mfma_f32_16x16x32_bf16 v[32:35], a[248:251], v[72:75], v[32:35]
    v_mfma_f32_16x16x32_bf16 v[36:39], a[248:251], v[76:79], v[36:39]
    v_mfma_f32_16x16x32_bf16 v[40:43], a[252:255], v[72:75], v[40:43]
    v_mfma_f32_16x16x32_bf16 v[44:47], a[252:255], v[76:79], v[44:47]
    v_mfma_f32_16x16x32_bf16 v[48:51], v[72:75], v[248:251], v[48:51]
    v_mfma_f32_16x16x32_bf16 v[56:59], v[76:79], v[248:251], v[56:59]
    v_mfma_f32_16x16x32_bf16 v[52:55], v[72:75], v[252:255], v[52:55]
    v_mfma_f32_16x16x32_bf16 v[60:63], v[76:79], v[252:255], v[60:63]
    v_mfma_f32_16x16x32_bf16 v[16:19], a[120:123], v[72:75], v[16:19]
    v_mfma_f32_16x16x32_bf16 v[20:23], a[120:123], v[76:79], v[20:23]
    v_mfma_f32_16x16x32_bf16 v[24:27], a[124:127], v[72:75], v[24:27]
    v_mfma_f32_16x16x32_bf16 v[28:31], a[124:127], v[76:79], v[28:31]
    v_xor_b32 v80, 0x8000, v80
    v_xor_b32 v81, 0x8000, v81
    v_xor_b32 v82, 0x8000, v82
    v_xor_b32 v83, 0x8000, v83
    v_cvt_pk_bf16_f32 v112, v32, v40
    v_cvt_pk_bf16_f32 v113, v33, v41
    v_cvt_pk_bf16_f32 v114, v34, v42
    v_cvt_pk_bf16_f32 v115, v35, v43
    v_cvt_pk_bf16_f32 v116, v36, v44
    v_cvt_pk_bf16_f32 v117, v37, v45
    v_cvt_pk_bf16_f32 v118, v38, v46
    v_cvt_pk_bf16_f32 v119, v39, v47
    v_mul_f32 v32, s33, v32
    v_mul_f32 v33, s33, v33
    v_mul_f32 v34, s33, v34
    v_mul_f32 v35, s33, v35
    v_mul_f32 v36, s33, v36
    v_mul_f32 v37, s33, v37
    v_mul_f32 v38, s33, v38
    v_mul_f32 v39, s33, v39
    v_mul_f32 v40, s33, v40
    v_mul_f32 v41, s33, v41
    v_mul_f32 v42, s33, v42
    v_mul_f32 v43, s33, v43
    v_mul_f32 v44, s33, v44
    v_mul_f32 v45, s33, v45
    v_mul_f32 v46, s33, v46
    v_mul_f32 v47, s33, v47
    v_cvt_pk_bf16_f32 v88, v32, v40
    v_cvt_pk_bf16_f32 v89, v33, v41
    v_cvt_pk_bf16_f32 v90, v34, v42
    v_cvt_pk_bf16_f32 v91, v35, v43
    v_cvt_pk_bf16_f32 v92, v36, v44
    v_cvt_pk_bf16_f32 v93, v37, v45
    v_cvt_pk_bf16_f32 v94, v38, v46
    v_cvt_pk_bf16_f32 v95, v39, v47
    v_cvt_pk_bf16_f32 v96, v48, v49
    v_cvt_pk_bf16_f32 v97, v50, v51
    v_cvt_pk_bf16_f32 v98, v56, v57
    v_cvt_pk_bf16_f32 v99, v58, v59
    v_cvt_pk_bf16_f32 v100, v52, v53
    v_cvt_pk_bf16_f32 v101, v54, v55
    v_cvt_pk_bf16_f32 v102, v60, v61
    v_cvt_pk_bf16_f32 v103, v62, v63
    v_cvt_pk_bf16_f32 v104, v16, v24
    v_cvt_pk_bf16_f32 v105, v17, v25
    v_cvt_pk_bf16_f32 v106, v18, v26
    v_cvt_pk_bf16_f32 v107, v19, v27
    v_cvt_pk_bf16_f32 v108, v20, v28
    v_cvt_pk_bf16_f32 v109, v21, v29
    v_cvt_pk_bf16_f32 v110, v22, v30
    v_cvt_pk_bf16_f32 v111, v23, v31
    s_mul_i32 s24, s23, 0x82100
    s_lshl_b32 s36, s20, 14
    s_add_u32 s24, s24, s36
    s_add_u32 s24, s24, 0x1000000
    s_mov_b32 s30, s24
    s_lshr_b32 s36, s21, 1
    s_lshl_b32 s36, s36, 12
    s_xor_b32 s37, s36, 4096
    s_add_u32 s36, s36, s24
    s_add_u32 s37, s37, s24
    buffer_store_dwordx4 v[88:91], v9, s[8:11], s36 offen sc1
    buffer_store_dwordx4 v[92:95], v9, s[8:11], s37 offen sc1
    s_add_u32 s24, s24, 8192
    buffer_store_dwordx4 v[96:99], v2, s[8:11], s24 offen sc1
    buffer_store_dwordx4 v[100:103], v2, s[8:11], s24 offen offset:1024 sc1
    s_add_u32 s36, s36, 0x7000000
    s_add_u32 s37, s37, 0x7000000
    buffer_store_dwordx4 v[104:107], v9, s[8:11], s36 offen sc1
    buffer_store_dwordx4 v[108:111], v9, s[8:11], s37 offen sc1
    s_add_u32 s36, s36, 8192
    s_add_u32 s37, s37, 8192
    buffer_store_dwordx4 v[112:115], v9, s[8:11], s36 offen sc1
    buffer_store_dwordx4 v[116:119], v9, s[8:11], s37 offen sc1
    s_mul_i32 s25, s23, 0x82100
    s_lshl_b32 s36, s20, 2
    s_add_u32 s25, s25, s36
    s_add_u32 s25, s25, 0x1082000
    s_add_u32 s23, s23, 6
    s_cmp_lt_u32 s23, 64
    s_cbranch_scc1 L_P1
    v_mov_b32 v20, -1
    v_mov_b32 v21, -1
    v_mov_b32 v22, -1
    v_mov_b32 v23, -1
    s_lshl_b32 s24, s22, 21
    s_lshl_b32 s36, s20, 15
    s_add_u32 s24, s24, s36
    s_add_u32 s36, s24, 0x4000000
    buffer_store_dwordx4 v[20:23], v11, s[8:11], s36 offen sc1
    s_add_u32 s36, s24, 0x4001000
    buffer_store_dwordx4 v[20:23], v11, s[8:11], s36 offen sc1
    s_add_u32 s36, s24, 0x4002000
    buffer_store_dwordx4 v[20:23], v11, s[8:11], s36 offen sc1
    s_add_u32 s36, s24, 0x4003000
    buffer_store_dwordx4 v[20:23], v11, s[8:11], s36 offen sc1
    s_add_u32 s36, s24, 0x4004000
    buffer_store_dwordx4 v[20:23], v11, s[8:11], s36 offen sc1
    s_add_u32 s36, s24, 0x4005000
    buffer_store_dwordx4 v[20:23], v11, s[8:11], s36 offen sc1
    s_add_u32 s36, s24, 0x4006000
    buffer_store_dwordx4 v[20:23], v11, s[8:11], s36 offen sc1
    s_add_u32 s36, s24, 0x4007000
    buffer_store_dwordx4 v[20:23], v11, s[8:11], s36 offen sc1
    s_add_u32 s36, s24, 0x4100000
    buffer_store_dwordx4 v[20:23], v11, s[8:11], s36 offen sc1
    s_add_u32 s36, s24, 0x4101000
    buffer_store_dwordx4 v[20:23], v11, s[8:11], s36 offen sc1
    s_add_u32 s36, s24, 0x4102000
    buffer_store_dwordx4 v[20:23], v11, s[8:11], s36 offen sc1
    s_add_u32 s36, s24, 0x4103000
    buffer_store_dwordx4 v[20:23], v11, s[8:11], s36 offen sc1
    s_add_u32 s36, s24, 0x4104000
    buffer_store_dwordx4 v[20:23], v11, s[8:11], s36 offen sc1
    s_add_u32 s36, s24, 0x4105000
    buffer_store_dwordx4 v[20:23], v11, s[8:11], s36 offen sc1
    s_add_u32 s36, s24, 0x4106000
    buffer_store_dwordx4 v[20:23], v11, s[8:11], s36 offen sc1
    s_add_u32 s36, s24, 0x4107000
    buffer_store_dwordx4 v[20:23], v11, s[8:11], s36 offen sc1
    s_waitcnt vmcnt(0)
    s_barrier
    v_cmp_ne_u32 vcc, 0, v0
    v_mov_b32 v15, 0x40000000
    v_mov_b32 v14, 1
    v_cndmask_b32 v15, v0, v15, vcc
    buffer_store_dword v14, v15, s[8:11], s25 offen sc1
    s_lshl_b32 s25, s22, 7
    s_lshl_b32 s36, s20, 2
    s_add_u32 s36, s36, s25
    s_add_u32 s36, s36, 0x192000
    v_cmp_ne_u32 vcc, 0, v0
    v_mov_b32 v15, 0x40000000
    v_mov_b32 v14, 1
    v_cndmask_b32 v15, v0, v15, vcc
    buffer_store_dword v14, v15, s[8:11], s36 offen sc1
    s_mov_b32 s96, s54
    s_and_b32 s97, s55, 0xffff
    s_mov_b32 s98, 0x400000
    s_mov_b32 s99, 0x20000
    v_mov_b32 v15, 0x0
    v_bfe_u32 v14, v0, 0, 1
    s_mov_b32 s38, 0x10
    v_mad_u32_u24 v15, v14, s38, v15
    v_bfe_u32 v14, v0, 1, 1
    s_mov_b32 s38, 0x20
    v_mad_u32_u24 v15, v14, s38, v15
    v_bfe_u32 v14, v0, 2, 1
    s_mov_b32 s38, 0x40
    v_mad_u32_u24 v15, v14, s38, v15
    v_bfe_u32 v14, v0, 3, 1
    s_mov_b32 s38, 0x80
    v_mad_u32_u24 v15, v14, s38, v15
    v_bfe_u32 v14, v0, 4, 1
    s_mov_b32 s38, 0x1000
    v_mad_u32_u24 v15, v14, s38, v15
    v_bfe_u32 v14, v0, 5, 1
    s_mov_b32 s38, 0x2000
    v_mad_u32_u24 v15, v14, s38, v15
    v_bfe_u32 v14, v0, 6, 1
    s_mov_b32 s38, 0x100
    v_mad_u32_u24 v15, v14, s38, v15
    v_bfe_u32 v14, v0, 7, 1
    s_mov_b32 s38, 0x200
    v_mad_u32_u24 v15, v14, s38, v15
    s_lshl_b32 s36, s20, 17
    s_add_u32 s37, s36, 0x0
    buffer_load_dwordx4 v[16:19], v15, s[96:99], s37 offen
    s_add_u32 s37, s36, 0x4000
    buffer_load_dwordx4 v[20:23], v15, s[96:99], s37 offen
    s_add_u32 s37, s36, 0x400
    buffer_load_dwordx4 v[24:27], v15, s[96:99], s37 offen
    s_add_u32 s37, s36, 0x4400
    buffer_load_dwordx4 v[28:31], v15, s[96:99], s37 offen
    s_add_u32 s37, s36, 0x800
    buffer_load_dwordx4 v[32:35], v15, s[96:99], s37 offen
    s_add_u32 s37, s36, 0x4800
    buffer_load_dwordx4 v[36:39], v15, s[96:99], s37 offen
    s_add_u32 s37, s36, 0xc00
    buffer_load_dwordx4 v[40:43], v15, s[96:99], s37 offen
    s_add_u32 s37, s36, 0x4c00
    buffer_load_dwordx4 v[44:47], v15, s[96:99], s37 offen
    s_add_u32 s37, s36, 0x8000
    buffer_load_dwordx4 v[48:51], v15, s[96:99], s37 offen
    s_add_u32 s37, s36, 0xc000
    buffer_load_dwordx4 v[52:55], v15, s[96:99], s37 offen
    s_add_u32 s37, s36, 0x8400
    buffer_load_dwordx4 v[56:59], v15, s[96:99], s37 offen
    s_add_u32 s37, s36, 0xc400
    buffer_load_dwordx4 v[60:63], v15, s[96:99], s37 offen
    s_add_u32 s37, s36, 0x8800
    buffer_load_dwordx4 v[64:67], v15, s[96:99], s37 offen
    s_add_u32 s37, s36, 0xc800
    buffer_load_dwordx4 v[68:71], v15, s[96:99], s37 offen
    s_add_u32 s37, s36, 0x8c00
    buffer_load_dwordx4 v[72:75], v15, s[96:99], s37 offen
    s_add_u32 s37, s36, 0xcc00
    buffer_load_dwordx4 v[76:79], v15, s[96:99], s37 offen
    s_add_u32 s37, s36, 0x10000
    buffer_load_dwordx4 v[80:83], v15, s[96:99], s37 offen
    s_add_u32 s37, s36, 0x14000
    buffer_load_dwordx4 v[84:87], v15, s[96:99], s37 offen
    s_add_u32 s37, s36, 0x10400
    buffer_load_dwordx4 v[88:91], v15, s[96:99], s37 offen
    s_add_u32 s37, s36, 0x14400
    buffer_load_dwordx4 v[92:95], v15, s[96:99], s37 offen
    s_add_u32 s37, s36, 0x10800
    buffer_load_dwordx4 v[96:99], v15, s[96:99], s37 offen
    s_add_u32 s37, s36, 0x14800
    buffer_load_dwordx4 v[100:103], v15, s[96:99], s37 offen
    s_add_u32 s37, s36, 0x10c00
    buffer_load_dwordx4 v[104:107], v15, s[96:99], s37 offen
    s_add_u32 s37, s36, 0x14c00
    buffer_load_dwordx4 v[108:111], v15, s[96:99], s37 offen
    s_waitcnt vmcnt(16)
    v_perm_b32 v112, v20, v16, s34
    v_perm_b32 v113, v28, v24, s34
    v_perm_b32 v114, v36, v32, s34
    v_perm_b32 v115, v44, v40, s34
    ds_write_b128 v7, v[112:115] offset:0
    v_perm_b32 v116, v20, v16, s35
    v_perm_b32 v117, v28, v24, s35
    v_perm_b32 v118, v36, v32, s35
    v_perm_b32 v119, v44, v40, s35
    ds_write_b128 v7, v[116:119] offset:1024
    v_perm_b32 v120, v21, v17, s34
    v_perm_b32 v121, v29, v25, s34
    v_perm_b32 v122, v37, v33, s34
    v_perm_b32 v123, v45, v41, s34
    ds_write_b128 v7, v[120:123] offset:2048
    v_perm_b32 v124, v21, v17, s35
    v_perm_b32 v125, v29, v25, s35
    v_perm_b32 v126, v37, v33, s35
    v_perm_b32 v127, v45, v41, s35
    ds_write_b128 v7, v[124:127] offset:3072
    s_waitcnt lgkmcnt(0)
    v_perm_b32 v112, v22, v18, s34
    v_perm_b32 v113, v30, v26, s34
    v_perm_b32 v114, v38, v34, s34
    v_perm_b32 v115, v46, v42, s34
    ds_write_b128 v7, v[112:115] offset:4096
    v_perm_b32 v116, v22, v18, s35
    v_perm_b32 v117, v30, v26, s35
    v_perm_b32 v118, v38, v34, s35
    v_perm_b32 v119, v46, v42, s35
    ds_write_b128 v7, v[116:119] offset:5120
    v_perm_b32 v120, v23, v19, s34
    v_perm_b32 v121, v31, v27, s34
    v_perm_b32 v122, v39, v35, s34
    v_perm_b32 v123, v47, v43, s34
    ds_write_b128 v7, v[120:123] offset:6144
    v_perm_b32 v124, v23, v19, s35
    v_perm_b32 v125, v31, v27, s35
    v_perm_b32 v126, v39, v35, s35
    v_perm_b32 v127, v47, v43, s35
    ds_write_b128 v7, v[124:127] offset:7168
    s_waitcnt lgkmcnt(0)
    s_add_u32 s37, s36, 0x18000
    buffer_load_dwordx4 v[16:19], v15, s[96:99], s37 offen
    s_add_u32 s37, s36, 0x1c000
    buffer_load_dwordx4 v[20:23], v15, s[96:99], s37 offen
    s_add_u32 s37, s36, 0x18400
    buffer_load_dwordx4 v[24:27], v15, s[96:99], s37 offen
    s_add_u32 s37, s36, 0x1c400
    buffer_load_dwordx4 v[28:31], v15, s[96:99], s37 offen
    s_add_u32 s37, s36, 0x18800
    buffer_load_dwordx4 v[32:35], v15, s[96:99], s37 offen
    s_add_u32 s37, s36, 0x1c800
    buffer_load_dwordx4 v[36:39], v15, s[96:99], s37 offen
    s_add_u32 s37, s36, 0x18c00
    buffer_load_dwordx4 v[40:43], v15, s[96:99], s37 offen
    s_add_u32 s37, s36, 0x1cc00
    buffer_load_dwordx4 v[44:47], v15, s[96:99], s37 offen
    s_waitcnt vmcnt(16)
    v_perm_b32 v112, v52, v48, s34
    v_perm_b32 v113, v60, v56, s34
    v_perm_b32 v114, v68, v64, s34
    v_perm_b32 v115, v76, v72, s34
    ds_write_b128 v7, v[112:115] offset:8192
    v_perm_b32 v116, v52, v48, s35
    v_perm_b32 v117, v60, v56, s35
    v_perm_b32 v118, v68, v64, s35
    v_perm_b32 v119, v76, v72, s35
    ds_write_b128 v7, v[116:119] offset:9216
    v_perm_b32 v120, v53, v49, s34
    v_perm_b32 v121, v61, v57, s34
    v_perm_b32 v122, v69, v65, s34
    v_perm_b32 v123, v77, v73, s34
    ds_write_b128 v7, v[120:123] offset:10240
    v_perm_b32 v124, v53, v49, s35
    v_perm_b32 v125, v61, v57, s35
    v_perm_b32 v126, v69, v65, s35
    v_perm_b32 v127, v77, v73, s35
    ds_write_b128 v7, v[124:127] offset:11264
    s_waitcnt lgkmcnt(0)
    v_perm_b32 v112, v54, v50, s34
    v_perm_b32 v113, v62, v58, s34
    v_perm_b32 v114, v70, v66, s34
    v_perm_b32 v115, v78, v74, s34
    ds_write_b128 v7, v[112:115] offset:12288
    v_perm_b32 v116, v54, v50, s35
    v_perm_b32 v117, v62, v58, s35
    v_perm_b32 v118, v70, v66, s35
    v_perm_b32 v119, v78, v74, s35
    ds_write_b128 v7, v[116:119] offset:13312
    v_perm_b32 v120, v55, v51, s34
    v_perm_b32 v121, v63, v59, s34
    v_perm_b32 v122, v71, v67, s34
    v_perm_b32 v123, v79, v75, s34
    ds_write_b128 v7, v[120:123] offset:14336
    v_perm_b32 v124, v55, v51, s35
    v_perm_b32 v125, v63, v59, s35
    v_perm_b32 v126, v71, v67, s35
    v_perm_b32 v127, v79, v75, s35
    ds_write_b128 v7, v[124:127] offset:15360
    s_waitcnt lgkmcnt(0)
    s_waitcnt vmcnt(8)
    v_perm_b32 v112, v84, v80, s34
    v_perm_b32 v113, v92, v88, s34
    v_perm_b32 v114, v100, v96, s34
    v_perm_b32 v115, v108, v104, s34
    ds_write_b128 v7, v[112:115] offset:16384
    v_perm_b32 v116, v84, v80, s35
    v_perm_b32 v117, v92, v88, s35
    v_perm_b32 v118, v100, v96, s35
    v_perm_b32 v119, v108, v104, s35
    ds_write_b128 v7, v[116:119] offset:17408
    v_perm_b32 v120, v85, v81, s34
    v_perm_b32 v121, v93, v89, s34
    v_perm_b32 v122, v101, v97, s34
    v_perm_b32 v123, v109, v105, s34
    ds_write_b128 v7, v[120:123] offset:18432
    v_perm_b32 v124, v85, v81, s35
    v_perm_b32 v125, v93, v89, s35
    v_perm_b32 v126, v101, v97, s35
    v_perm_b32 v127, v109, v105, s35
    ds_write_b128 v7, v[124:127] offset:19456
    s_waitcnt lgkmcnt(0)
    v_perm_b32 v112, v86, v82, s34
    v_perm_b32 v113, v94, v90, s34
    v_perm_b32 v114, v102, v98, s34
    v_perm_b32 v115, v110, v106, s34
    ds_write_b128 v7, v[112:115] offset:20480
    v_perm_b32 v116, v86, v82, s35
    v_perm_b32 v117, v94, v90, s35
    v_perm_b32 v118, v102, v98, s35
    v_perm_b32 v119, v110, v106, s35
    ds_write_b128 v7, v[116:119] offset:21504
    v_perm_b32 v120, v87, v83, s34
    v_perm_b32 v121, v95, v91, s34
    v_perm_b32 v122, v103, v99, s34
    v_perm_b32 v123, v111, v107, s34
    ds_write_b128 v7, v[120:123] offset:22528
    v_perm_b32 v124, v87, v83, s35
    v_perm_b32 v125, v95, v91, s35
    v_perm_b32 v126, v103, v99, s35
    v_perm_b32 v127, v111, v107, s35
    ds_write_b128 v7, v[124:127] offset:23552
    s_waitcnt lgkmcnt(0)
    s_waitcnt vmcnt(0)
    v_perm_b32 v112, v20, v16, s34
    v_perm_b32 v113, v28, v24, s34
    v_perm_b32 v114, v36, v32, s34
    v_perm_b32 v115, v44, v40, s34
    ds_write_b128 v7, v[112:115] offset:24576
    v_perm_b32 v116, v20, v16, s35
    v_perm_b32 v117, v28, v24, s35
    v_perm_b32 v118, v36, v32, s35
    v_perm_b32 v119, v44, v40, s35
    ds_write_b128 v7, v[116:119] offset:25600
    v_perm_b32 v120, v21, v17, s34
    v_perm_b32 v121, v29, v25, s34
    v_perm_b32 v122, v37, v33, s34
    v_perm_b32 v123, v45, v41, s34
    ds_write_b128 v7, v[120:123] offset:26624
    v_perm_b32 v124, v21, v17, s35
    v_perm_b32 v125, v29, v25, s35
    v_perm_b32 v126, v37, v33, s35
    v_perm_b32 v127, v45, v41, s35
    ds_write_b128 v7, v[124:127] offset:27648
    s_waitcnt lgkmcnt(0)
    v_perm_b32 v112, v22, v18, s34
    v_perm_b32 v113, v30, v26, s34
    v_perm_b32 v114, v38, v34, s34
    v_perm_b32 v115, v46, v42, s34
    ds_write_b128 v7, v[112:115] offset:28672
    v_perm_b32 v116, v22, v18, s35
    v_perm_b32 v117, v30, v26, s35
    v_perm_b32 v118, v38, v34, s35
    v_perm_b32 v119, v46, v42, s35
    ds_write_b128 v7, v[116:119] offset:29696
    v_perm_b32 v120, v23, v19, s34
    v_perm_b32 v121, v31, v27, s34
    v_perm_b32 v122, v39, v35, s34
    v_perm_b32 v123, v47, v43, s34
    ds_write_b128 v7, v[120:123] offset:30720
    v_perm_b32 v124, v23, v19, s35
    v_perm_b32 v125, v31, v27, s35
    v_perm_b32 v126, v39, v35, s35
    v_perm_b32 v127, v47, v43, s35
    ds_write_b128 v7, v[124:127] offset:31744
    s_waitcnt lgkmcnt(0)
    s_lshl_b32 s25, s22, 7
    s_add_u32 s25, s25, 0x192000
    v_lshrrev_b32 v15, 2, v1
    v_and_b32 v15, 127, v15
L_TPI:
    buffer_load_dword v14, v15, s[8:11], s25 offen sc1
    s_add_u32 s32, s32, 1
    s_cmp_gt_u32 s32, 200000
    s_waitcnt vmcnt(0)
    s_cbranch_scc1 L_TPI_ok
    v_cmp_eq_u32 vcc, 0, v14
    s_cbranch_vccz L_TPI_ok
    s_sleep 8
    s_branch L_TPI
L_TPI_ok:
    s_mov_b32 s23, s22
    s_mov_b32 s29, 0
    s_mov_b32 s30, 0x40000000
    s_mov_b32 s42, 0x3db504f3
    s_mov_b32 s43, 0x3fb8aa3b
    s_mul_i32 s24, s23, 0x82100
    s_lshl_b32 s36, s20, 14
    s_add_u32 s24, s24, s36
    s_add_u32 s24, s24, 0x1000000
    s_add_u32 s37, s24, 0x7000000
    s_add_u32 s36, s37, 8192
    buffer_load_dwordx4 a[32:35], v1, s[8:11], s36 offen offset:0 sc1
    buffer_load_dwordx4 a[0:3], v1, s[8:11], s37 offen offset:0 sc1
    buffer_load_dwordx4 a[36:39], v1, s[8:11], s36 offen offset:1024 sc1
    buffer_load_dwordx4 a[4:7], v1, s[8:11], s37 offen offset:1024 sc1
    buffer_load_dwordx4 a[40:43], v1, s[8:11], s36 offen offset:2048 sc1
    buffer_load_dwordx4 a[8:11], v1, s[8:11], s37 offen offset:2048 sc1
    buffer_load_dwordx4 a[44:47], v1, s[8:11], s36 offen offset:3072 sc1
    buffer_load_dwordx4 a[12:15], v1, s[8:11], s37 offen offset:3072 sc1
    s_add_u32 s37, s24, 0x7001000
    s_add_u32 s36, s37, 8192
    buffer_load_dwordx4 a[48:51], v1, s[8:11], s36 offen offset:0 sc1
    buffer_load_dwordx4 a[16:19], v1, s[8:11], s37 offen offset:0 sc1
    buffer_load_dwordx4 a[52:55], v1, s[8:11], s36 offen offset:1024 sc1
    buffer_load_dwordx4 a[20:23], v1, s[8:11], s37 offen offset:1024 sc1
    buffer_load_dwordx4 a[56:59], v1, s[8:11], s36 offen offset:2048 sc1
    buffer_load_dwordx4 a[24:27], v1, s[8:11], s37 offen offset:2048 sc1
    buffer_load_dwordx4 a[60:63], v1, s[8:11], s36 offen offset:3072 sc1
    buffer_load_dwordx4 a[28:31], v1, s[8:11], s37 offen offset:3072 sc1
    s_lshr_b32 s36, s21, 1
    s_lshl_b32 s36, s36, 3
    s_xor_b32 s37, s36, 8
    s_add_u32 s24, s24, 8192
    s_add_u32 s36, s36, s24
    s_add_u32 s37, s37, s24
    buffer_load_dwordx2 a[64:65], v2, s[8:11], s36 offen offset:0 sc1
    buffer_load_dwordx2 a[66:67], v2, s[8:11], s37 offen offset:0 sc1
    buffer_load_dwordx2 a[68:69], v2, s[8:11], s36 offen offset:1024 sc1
    buffer_load_dwordx2 a[70:71], v2, s[8:11], s37 offen offset:1024 sc1
L_P2:
    s_and_b32 s36, s29, 1
    s_lshl_b32 s36, s36, 20
    s_lshl_b32 s26, s22, 21
    s_add_u32 s26, s26, s36
    s_add_u32 s26, s26, 0x4000000
    s_bfe_u32 s27, s29, 0x10001
    s_lshl_b32 s24, s23, 13
    s_add_u32 s24, s24, 0x100000
    s_max_u32 s25, s23, 1
    s_lshl_b32 s25, s25, 13
    s_add_u32 s25, s25, 0xfe000
    buffer_load_dwordx4 v[48:51], v2, s[8:11], s24 offen sc1
    buffer_load_dwordx4 v[52:55], v2, s[8:11], s24 offen offset:1024 sc1
    s_lshl_b32 s36, s23, 5
    s_add_u32 s36, s36, s20
    s_lshl_b32 s36, s36, 10
    buffer_load_dword a72, v12, s[12:15], s36 offen
    buffer_load_dword a73, v12, s[92:95], 0 offen
    s_waitcnt vmcnt(4)
    v_cmp_ne_u32 vcc, 0, v1
    v_mov_b32 v15, 0x40000000
    v_mov_b32 v14, 0
    v_cndmask_b32 v15, v1, v15, vcc
    buffer_store_dword v14, v15, s[8:11], s30 offen sc1
    v_mfma_f32_16x16x32_bf16 v[80:83], a[32:35], a[0:3], 0
    v_mfma_f32_16x16x32_bf16 v[80:83], a[36:39], a[4:7], v[80:83]
    v_mfma_f32_16x16x32_bf16 v[80:83], a[40:43], a[8:11], v[80:83]
    v_mfma_f32_16x16x32_bf16 v[80:83], a[44:47], a[12:15], v[80:83]
    v_mfma_f32_16x16x32_bf16 v[88:91], a[48:51], a[16:19], 0
    v_mfma_f32_16x16x32_bf16 v[88:91], a[52:55], a[20:23], v[88:91]
    v_mfma_f32_16x16x32_bf16 v[88:91], a[56:59], a[24:27], v[88:91]
    v_mfma_f32_16x16x32_bf16 v[88:91], a[60:63], a[28:31], v[88:91]
    v_mfma_f32_16x16x32_bf16 v[84:87], a[32:35], a[16:19], 0
    v_mfma_f32_16x16x32_bf16 v[84:87], a[36:39], a[20:23], v[84:87]
    v_mfma_f32_16x16x32_bf16 v[84:87], a[40:43], a[24:27], v[84:87]
    v_mfma_f32_16x16x32_bf16 v[84:87], a[44:47], a[28:31], v[84:87]
    v_cvt_pk_bf16_f32 v81, v80, v81
    v_lshlrev_b32 v80, 16, v81
    v_and_b32 v81, 0xffff0000, v81
    v_mul_f32 v80, s42, v80
    v_mul_f32 v81, s42, v81
    v_cvt_pk_bf16_f32 v81, v80, v81
    v_lshlrev_b32 v80, 16, v81
    v_and_b32 v81, 0xffff0000, v81
    v_cvt_pk_bf16_f32 v83, v82, v83
    v_lshlrev_b32 v82, 16, v83
    v_and_b32 v83, 0xffff0000, v83
    v_mul_f32 v82, s42, v82
    v_mul_f32 v83, s42, v83
    v_cvt_pk_bf16_f32 v83, v82, v83
    v_lshlrev_b32 v82, 16, v83
    v_and_b32 v83, 0xffff0000, v83
    v_cvt_pk_bf16_f32 v89, v88, v89
    v_lshlrev_b32 v88, 16, v89
    v_and_b32 v89, 0xffff0000, v89
    v_mul_f32 v88, s42, v88
    v_mul_f32 v89, s42, v89
    v_cvt_pk_bf16_f32 v89, v88, v89
    v_lshlrev_b32 v88, 16, v89
    v_and_b32 v89, 0xffff0000, v89
    v_cvt_pk_bf16_f32 v91, v90, v91
    v_lshlrev_b32 v90, 16, v91
    v_and_b32 v91, 0xffff0000, v91
    v_mul_f32 v90, s42, v90
    v_mul_f32 v91, s42, v91
    v_cvt_pk_bf16_f32 v91, v90, v91
    v_lshlrev_b32 v90, 16, v91
    v_and_b32 v91, 0xffff0000, v91
    v_cvt_pk_bf16_f32 v85, v84, v85
    v_lshlrev_b32 v84, 16, v85
    v_and_b32 v85, 0xffff0000, v85
    v_mul_f32 v84, s42, v84
    v_mul_f32 v85, s42, v85
    v_cvt_pk_bf16_f32 v85, v84, v85
    v_lshlrev_b32 v84, 16, v85
    v_and_b32 v85, 0xffff0000, v85
    v_cvt_pk_bf16_f32 v87, v86, v87
    v_lshlrev_b32 v86, 16, v87
    v_and_b32 v87, 0xffff0000, v87
    v_mul_f32 v86, s42, v86
    v_mul_f32 v87, s42, v87
    v_cvt_pk_bf16_f32 v87, v86, v87
    v_lshlrev_b32 v86, 16, v87
    v_and_b32 v87, 0xffff0000, v87
    v_cndmask_b32 v80, v13, v80, s[64:65]
    v_cndmask_b32 v81, v13, v81, s[66:67]
    v_cndmask_b32 v82, v13, v82, s[68:69]
    v_cndmask_b32 v83, v13, v83, s[70:71]
    v_cndmask_b32 v88, v13, v88, s[64:65]
    v_cndmask_b32 v89, v13, v89, s[66:67]
    v_cndmask_b32 v90, v13, v90, s[68:69]
    v_cndmask_b32 v91, v13, v91, s[70:71]
    v_max_f32 v116, v80, v81
    v_max3_f32 v116, v116, v82, v83
    v_max_f32 v117, v84, v85
    v_max3_f32 v117, v117, v86, v87
    v_max3_f32 v117, v117, v88, v89
    v_max3_f32 v117, v117, v90, v91
    v_mov_b32 v14, v116
    s_nop 1
    v_permlane16_swap_b32 v116, v14
    v_max_f32 v116, v116, v14
    v_mov_b32 v14, v117
    s_nop 1
    v_permlane16_swap_b32 v117, v14
    v_max_f32 v117, v117, v14
    v_mov_b32 v14, v116
    s_nop 1
    v_permlane32_swap_b32 v116, v14
    v_max_f32 v116, v116, v14
    v_mov_b32 v14, v117
    s_nop 1
    v_permlane32_swap_b32 v117, v14
    v_max_f32 v117, v117, v14
    v_mul_f32 v14, s43, v116
    v_fma_f32 v80, v80, s43, -v14
    v_exp_f32 v80, v80
    v_fma_f32 v81, v81, s43, -v14
    v_exp_f32 v81, v81
    v_fma_f32 v82, v82, s43, -v14
    v_exp_f32 v82, v82
    v_fma_f32 v83, v83, s43, -v14
    v_exp_f32 v83, v83
    v_mul_f32 v14, s43, v117
    v_fma_f32 v84, v84, s43, -v14
    v_exp_f32 v84, v84
    v_fma_f32 v85, v85, s43, -v14
    v_exp_f32 v85, v85
    v_fma_f32 v86, v86, s43, -v14
    v_exp_f32 v86, v86
    v_fma_f32 v87, v87, s43, -v14
    v_exp_f32 v87, v87
    v_fma_f32 v88, v88, s43, -v14
    v_exp_f32 v88, v88
    v_fma_f32 v89, v89, s43, -v14
    v_exp_f32 v89, v89
    v_fma_f32 v90, v90, s43, -v14
    v_exp_f32 v90, v90
    v_fma_f32 v91, v91, s43, -v14
    v_exp_f32 v91, v91
    v_cvt_pk_bf16_f32 v100, v80, v81
    v_cvt_pk_bf16_f32 v101, v82, v83
    v_mov_b64 v[102:103], 0
    v_cvt_pk_bf16_f32 v104, v84, v85
    v_cvt_pk_bf16_f32 v105, v86, v87
    v_cvt_pk_bf16_f32 v106, v88, v89
    v_cvt_pk_bf16_f32 v107, v90, v91
    v_mov_b64 v[108:109], s[4:5]
    v_mov_b64 v[110:111], s[4:5]
    v_cndmask_b32 v112, 0, v108, s[72:73]
    v_cndmask_b32 v113, 0, v108, s[72:73]
    v_mfma_f32_16x16x32_bf16 v[16:19], v[108:111], v[100:103], 0
    v_mfma_f32_16x16x32_bf16 v[24:27], a[64:67], v[100:103], 0
    v_mfma_f32_16x16x32_bf16 v[28:31], a[68:71], v[100:103], 0
    v_mfma_f32_16x16x32_bf16 v[20:23], v[108:111], v[104:107], 0
    v_mfma_f32_16x16x32_bf16 v[32:35], a[64:67], v[104:107], 0
    v_mfma_f32_16x16x32_bf16 v[36:39], a[68:71], v[104:107], 0
    s_branch L_P2_chk
L_P2_far:
    buffer_load_dword v14, v2, s[8:11], s25 offen sc1
    s_add_u32 s32, s32, 1
    s_cmp_gt_u32 s32, 200000
    s_waitcnt vmcnt(0)
    s_cbranch_scc1 L_P2_poll
    v_cmp_eq_u32 vcc, -1, v14
    s_cbranch_vccz L_P2_near
    s_sleep 12
    s_branch L_P2_far
L_P2_near:
    s_mov_b32 s25, 0x40000000
L_P2_poll:
    buffer_load_dwordx4 v[48:51], v2, s[8:11], s24 offen sc1
    buffer_load_dwordx4 v[52:55], v2, s[8:11], s24 offen offset:1024 sc1
L_P2_chk:
    s_add_u32 s32, s32, 1
    s_waitcnt vmcnt(0)
    ds_write_b128 v2, v[48:51] offset:20480
    ds_write_b128 v2, v[52:55] offset:21504
    v_max3_u32 v14, v48, v49, v50
    v_max3_u32 v15, v51, v52, v53
    v_max3_u32 v14, v14, v54, v55
    v_max_u32 v14, v14, v15
    v_cmp_eq_u32 vcc, -1, v14
    s_cbranch_vccz L_P2_got
    s_cmp_gt_u32 s32, 200000
    s_cbranch_scc1 L_P2_got
    s_cmp_eq_u32 s25, 0x40000000
    s_cbranch_scc1 L_P2_poll
    s_branch L_P2_far
L_P2_got:
    s_waitcnt lgkmcnt(0)
    s_barrier
    ds_read_b128 v[48:51], v8 offset:0
    ds_read_b128 v[52:55], v8 offset:2048
    ds_read_b128 v[56:59], v8 offset:4096
    ds_read_b128 v[60:63], v8 offset:6144
    s_waitcnt lgkmcnt(3)
    v_mfma_f32_16x16x32_bf16 v[80:83], a[128:131], v[48:51], 0
    v_mfma_f32_16x16x32_bf16 v[84:87], a[132:135], v[48:51], 0
    ds_read_b128 v[48:51], v8 offset:512
    s_waitcnt lgkmcnt(3)
    v_mfma_f32_16x16x32_bf16 v[80:83], a[136:139], v[52:55], v[80:83]
    v_mfma_f32_16x16x32_bf16 v[84:87], a[140:143], v[52:55], v[84:87]
    ds_read_b128 v[52:55], v8 offset:2560
    s_waitcnt lgkmcnt(3)
    v_mfma_f32_16x16x32_bf16 v[80:83], a[144:147], v[56:59], v[80:83]
    v_mfma_f32_16x16x32_bf16 v[84:87], a[148:151], v[56:59], v[84:87]
    ds_read_b128 v[56:59], v8 offset:4608
    s_waitcnt lgkmcnt(3)
    v_mfma_f32_16x16x32_bf16 v[80:83], a[152:155], v[60:63], v[80:83]
    v_mfma_f32_16x16x32_bf16 v[84:87], a[156:159], v[60:63], v[84:87]
    ds_read_b128 v[60:63], v8 offset:6656
    s_waitcnt lgkmcnt(3)
    v_mfma_f32_16x16x32_bf16 v[80:83], a[160:163], v[48:51], v[80:83]
    v_mfma_f32_16x16x32_bf16 v[84:87], a[164:167], v[48:51], v[84:87]
    ds_read_b128 v[48:51], v8 offset:1024
    s_waitcnt lgkmcnt(3)
    v_mfma_f32_16x16x32_bf16 v[80:83], a[168:171], v[52:55], v[80:83]
    v_mfma_f32_16x16x32_bf16 v[84:87], a[172:175], v[52:55], v[84:87]
    ds_read_b128 v[52:55], v8 offset:3072
    s_waitcnt lgkmcnt(3)
    v_mfma_f32_16x16x32_bf16 v[80:83], a[176:179], v[56:59], v[80:83]
    v_mfma_f32_16x16x32_bf16 v[84:87], a[180:183], v[56:59], v[84:87]
    ds_read_b128 v[56:59], v8 offset:5120
    s_waitcnt lgkmcnt(3)
    v_mfma_f32_16x16x32_bf16 v[80:83], a[184:187], v[60:63], v[80:83]
    v_mfma_f32_16x16x32_bf16 v[84:87], a[188:191], v[60:63], v[84:87]
    ds_read_b128 v[60:63], v8 offset:7168
    s_waitcnt lgkmcnt(3)
    v_mfma_f32_16x16x32_bf16 v[80:83], a[192:195], v[48:51], v[80:83]
    v_mfma_f32_16x16x32_bf16 v[84:87], a[196:199], v[48:51], v[84:87]
    ds_read_b128 v[48:51], v8 offset:1536
    s_waitcnt lgkmcnt(3)
    v_mfma_f32_16x16x32_bf16 v[80:83], a[200:203], v[52:55], v[80:83]
    v_mfma_f32_16x16x32_bf16 v[84:87], a[204:207], v[52:55], v[84:87]
    ds_read_b128 v[52:55], v8 offset:3584
    s_waitcnt lgkmcnt(3)
    v_mfma_f32_16x16x32_bf16 v[80:83], a[208:211], v[56:59], v[80:83]
    v_mfma_f32_16x16x32_bf16 v[84:87], a[212:215], v[56:59], v[84:87]
    ds_read_b128 v[56:59], v8 offset:5632
    s_waitcnt lgkmcnt(3)
    v_mfma_f32_16x16x32_bf16 v[80:83], a[216:219], v[60:63], v[80:83]
    v_mfma_f32_16x16x32_bf16 v[84:87], a[220:223], v[60:63], v[84:87]
    ds_read_b128 v[60:63], v8 offset:7680
    s_waitcnt lgkmcnt(3)
    v_mfma_f32_16x16x32_bf16 v[80:83], a[224:227], v[48:51], v[80:83]
    v_mfma_f32_16x16x32_bf16 v[84:87], a[228:231], v[48:51], v[84:87]
    ds_read_b128 v[48:51], v8 offset:0
    s_waitcnt lgkmcnt(3)
    v_mfma_f32_16x16x32_bf16 v[80:83], a[232:235], v[52:55], v[80:83]
    v_mfma_f32_16x16x32_bf16 v[84:87], a[236:239], v[52:55], v[84:87]
    ds_read_b128 v[52:55], v8 offset:2048
    s_waitcnt lgkmcnt(3)
    v_mfma_f32_16x16x32_bf16 v[80:83], a[240:243], v[56:59], v[80:83]
    v_mfma_f32_16x16x32_bf16 v[84:87], a[244:247], v[56:59], v[84:87]
    ds_read_b128 v[56:59], v8 offset:4096
    s_waitcnt lgkmcnt(3)
    v_mfma_f32_16x16x32_bf16 v[80:83], a[248:251], v[60:63], v[80:83]
    v_mfma_f32_16x16x32_bf16 v[84:87], a[252:255], v[60:63], v[84:87]
    ds_read_b128 v[60:63], v8 offset:6144
    s_waitcnt lgkmcnt(3)
    v_mfma_f32_16x16x32_bf16 v[40:43], v[48:51], v[128:131], 0
    v_mfma_f32_16x16x32_bf16 v[44:47], v[48:51], v[132:135], 0
    ds_read_b128 v[48:51], v8 offset:512
    s_waitcnt lgkmcnt(3)
    v_mfma_f32_16x16x32_bf16 v[40:43], v[52:55], v[136:139], v[40:43]
    v_mfma_f32_16x16x32_bf16 v[44:47], v[52:55], v[140:143], v[44:47]
    v_cvt_pk_bf16_f32 v88, v80, v84
    v_cvt_pk_bf16_f32 v89, v81, v85
    v_cvt_pk_bf16_f32 v90, v82, v86
    v_cvt_pk_bf16_f32 v91, v83, v87
    ds_write_b128 v9, v[88:91] offset:16384
    ds_read_b128 v[52:55], v8 offset:2560
    s_waitcnt lgkmcnt(4)
    v_mfma_f32_16x16x32_bf16 v[40:43], v[56:59], v[144:147], v[40:43]
    v_mfma_f32_16x16x32_bf16 v[44:47], v[56:59], v[148:151], v[44:47]
    ds_read_b128 v[56:59], v8 offset:4608
    s_waitcnt lgkmcnt(4)
    v_mfma_f32_16x16x32_bf16 v[40:43], v[60:63], v[152:155], v[40:43]
    v_mfma_f32_16x16x32_bf16 v[44:47], v[60:63], v[156:159], v[44:47]
    ds_read_b128 v[60:63], v8 offset:6656
    s_waitcnt lgkmcnt(4)
    v_mfma_f32_16x16x32_bf16 v[40:43], v[48:51], v[160:163], v[40:43]
    v_mfma_f32_16x16x32_bf16 v[44:47], v[48:51], v[164:167], v[44:47]
    s_waitcnt lgkmcnt(3)
    s_barrier
    ds_read_b128 v[64:67], v1 offset:16384
    ds_read_b128 v[68:71], v1 offset:17408
    ds_read_b128 v[72:75], v1 offset:18432
    ds_read_b128 v[76:79], v1 offset:19456
    ds_read_b128 v[48:51], v8 offset:1024
    s_waitcnt lgkmcnt(7)
    v_mfma_f32_16x16x32_bf16 v[40:43], v[52:55], v[168:171], v[40:43]
    v_mfma_f32_16x16x32_bf16 v[44:47], v[52:55], v[172:175], v[44:47]
    ds_read_b128 v[52:55], v8 offset:3072
    s_waitcnt lgkmcnt(7)
    v_mfma_f32_16x16x32_bf16 v[40:43], v[56:59], v[176:179], v[40:43]
    v_mfma_f32_16x16x32_bf16 v[44:47], v[56:59], v[180:183], v[44:47]
    s_waitcnt lgkmcnt(2)
    v_mfma_f32_16x16x32_bf16 v[92:95], v[64:67], a[0:3], 0
    v_mfma_f32_16x16x32_bf16 v[96:99], v[64:67], a[16:19], 0
    v_mfma_f32_16x16x32_bf16 v[92:95], v[68:71], a[4:7], v[92:95]
    v_mfma_f32_16x16x32_bf16 v[96:99], v[68:71], a[20:23], v[96:99]
    v_mfma_f32_16x16x32_bf16 v[92:95], v[72:75], a[8:11], v[92:95]
    v_mfma_f32_16x16x32_bf16 v[96:99], v[72:75], a[24:27], v[96:99]
    v_mfma_f32_16x16x32_bf16 v[92:95], v[76:79], a[12:15], v[92:95]
    v_mfma_f32_16x16x32_bf16 v[96:99], v[76:79], a[28:31], v[96:99]
    ds_read_b128 v[56:59], v8 offset:5120
    s_waitcnt lgkmcnt(3)
    v_mfma_f32_16x16x32_bf16 v[40:43], v[60:63], v[184:187], v[40:43]
    v_mfma_f32_16x16x32_bf16 v[44:47], v[60:63], v[188:191], v[44:47]
    ds_read_b128 v[60:63], v8 offset:7168
    s_waitcnt lgkmcnt(3)
    v_mfma_f32_16x16x32_bf16 v[40:43], v[48:51], v[192:195], v[40:43]
    v_mfma_f32_16x16x32_bf16 v[44:47], v[48:51], v[196:199], v[44:47]
    v_cvt_pk_bf16_f32 v93, v92, v93
    v_lshlrev_b32 v92, 16, v93
    v_and_b32 v93, 0xffff0000, v93
    v_mul_f32 v92, s42, v92
    v_mul_f32 v93, s42, v93
    v_cvt_pk_bf16_f32 v93, v92, v93
    v_lshlrev_b32 v92, 16, v93
    ds_read_b128 v[48:51], v8 offset:1536
    s_waitcnt lgkmcnt(3)
    v_mfma_f32_16x16x32_bf16 v[40:43], v[52:55], v[200:203], v[40:43]
    v_mfma_f32_16x16x32_bf16 v[44:47], v[52:55], v[204:207], v[44:47]
    v_and_b32 v93, 0xffff0000, v93
    v_cvt_pk_bf16_f32 v95, v94, v95
    v_lshlrev_b32 v94, 16, v95
    v_and_b32 v95, 0xffff0000, v95
    v_mul_f32 v94, s42, v94
    v_mul_f32 v95, s42, v95
    v_cvt_pk_bf16_f32 v95, v94, v95
    ds_read_b128 v[52:55], v8 offset:3584
    s_waitcnt lgkmcnt(3)
    v_mfma_f32_16x16x32_bf16 v[40:43], v[56:59], v[208:211], v[40:43]
    v_mfma_f32_16x16x32_bf16 v[44:47], v[56:59], v[212:215], v[44:47]
    v_lshlrev_b32 v94, 16, v95
    v_and_b32 v95, 0xffff0000, v95
    v_cvt_pk_bf16_f32 v97, v96, v97
    v_lshlrev_b32 v96, 16, v97
    v_and_b32 v97, 0xffff0000, v97
    v_mul_f32 v96, s42, v96
    v_mul_f32 v97, s42, v97
    ds_read_b128 v[56:59], v8 offset:5632
    s_waitcnt lgkmcnt(3)
    v_mfma_f32_16x16x32_bf16 v[40:43], v[60:63], v[216:219], v[40:43]
    v_mfma_f32_16x16x32_bf16 v[44:47], v[60:63], v[220:223], v[44:47]
    v_cvt_pk_bf16_f32 v97, v96, v97
    v_lshlrev_b32 v96, 16, v97
    v_and_b32 v97, 0xffff0000, v97
    v_cvt_pk_bf16_f32 v99, v98, v99
    v_lshlrev_b32 v98, 16, v99
    v_and_b32 v99, 0xffff0000, v99
    v_mul_f32 v98, s42, v98
    ds_read_b128 v[60:63], v8 offset:7680
    s_waitcnt lgkmcnt(3)
    v_mfma_f32_16x16x32_bf16 v[40:43], v[48:51], v[224:227], v[40:43]
    v_mfma_f32_16x16x32_bf16 v[44:47], v[48:51], v[228:231], v[44:47]
    v_mul_f32 v99, s42, v99
    v_cvt_pk_bf16_f32 v99, v98, v99
    v_lshlrev_b32 v98, 16, v99
    v_and_b32 v99, 0xffff0000, v99
    v_max3_f32 v118, v92, v93, v94
    v_max3_f32 v118, v118, v95, v116
    v_max3_f32 v119, v96, v97, v98
    s_waitcnt lgkmcnt(2)
    v_mfma_f32_16x16x32_bf16 v[40:43], v[52:55], v[232:235], v[40:43]
    v_mfma_f32_16x16x32_bf16 v[44:47], v[52:55], v[236:239], v[44:47]
    v_max3_f32 v119, v119, v99, v117
    v_mov_b32 v14, v118
    v_mov_b32 v15, v119
    s_nop 0
    v_permlane16_swap_b32 v118, v14
    v_permlane16_swap_b32 v119, v15
    v_max_f32 v118, v118, v14
    v_max_f32 v119, v119, v15
    s_waitcnt lgkmcnt(1)
    v_mfma_f32_16x16x32_bf16 v[40:43], v[56:59], v[240:243], v[40:43]
    v_mfma_f32_16x16x32_bf16 v[44:47], v[56:59], v[244:247], v[44:47]
    v_sub_f32 v104, v116, v118
    v_mul_f32 v118, s43, v118
    v_mul_f32 v104, s43, v104
    v_exp_f32 v104, v104
    v_fma_f32 v92, v92, s43, -v118
    v_exp_f32 v92, v92
    v_fma_f32 v93, v93, s43, -v118
    s_waitcnt lgkmcnt(0)
    v_mfma_f32_16x16x32_bf16 v[40:43], v[60:63], v[248:251], v[40:43]
    v_mfma_f32_16x16x32_bf16 v[44:47], v[60:63], v[252:255], v[44:47]
    v_exp_f32 v93, v93
    v_fma_f32 v94, v94, s43, -v118
    v_exp_f32 v94, v94
    v_fma_f32 v95, v95, s43, -v118
    v_exp_f32 v95, v95
    v_cvt_pk_bf16_f32 v100, v92, v93
    v_cvt_pk_bf16_f32 v101, v94, v95
    v_sub_f32 v105, v117, v119
    v_mul_f32 v119, s43, v119
    v_mul_f32 v105, s43, v105
    v_exp_f32 v105, v105
    v_fma_f32 v96, v96, s43, -v119
    v_exp_f32 v96, v96
    v_fma_f32 v97, v97, s43, -v119
    v_exp_f32 v97, v97
    v_fma_f32 v98, v98, s43, -v119
    v_exp_f32 v98, v98
    v_fma_f32 v99, v99, s43, -v119
    v_exp_f32 v99, v99
    v_cvt_pk_bf16_f32 v102, v96, v97
    v_cvt_pk_bf16_f32 v103, v98, v99
    v_mfma_f32_16x16x16_bf16 v[48:51], v[112:113], v[100:101], 0
    s_nop 0
    v_mfma_f32_16x16x16_bf16 v[52:55], v[112:113], v[102:103], 0
    v_cvt_pk_bf16_f32 v80, v40, v41
    v_cndmask_b32 v80, 0, v80, s[72:73]
    v_cvt_pk_bf16_f32 v81, v42, v43
    v_cndmask_b32 v81, 0, v81, s[72:73]
    v_cvt_pk_bf16_f32 v82, v44, v45
    v_cndmask_b32 v82, 0, v82, s[72:73]
    v_cvt_pk_bf16_f32 v83, v46, v47
    v_cndmask_b32 v83, 0, v83, s[72:73]
    v_mfma_f32_16x16x16_bf16 v[56:59], v[80:81], v[100:101], 0
    s_nop 0
    v_mfma_f32_16x16x16_bf16 v[60:63], v[82:83], v[100:101], 0
    v_mfma_f32_16x16x16_bf16 v[64:67], v[80:81], v[102:103], 0
    v_mfma_f32_16x16x16_bf16 v[68:71], v[82:83], v[102:103], 0
    v_fma_f32 v48, v16, v104, v48
    v_rcp_f32 v48, v48
    v_fma_f32 v52, v20, v105, v52
    v_rcp_f32 v52, v52
    v_fma_f32 v56, v24, v104, v56
    v_fma_f32 v57, v25, v104, v57
    v_fma_f32 v58, v26, v104, v58
    v_fma_f32 v59, v27, v104, v59
    v_fma_f32 v60, v28, v104, v60
    v_fma_f32 v61, v29, v104, v61
    v_fma_f32 v62, v30, v104, v62
    v_fma_f32 v63, v31, v104, v63
    v_pk_mul_f32 v[56:57], v[56:57], v[48:49] op_sel_hi:[1,0]
    v_pk_mul_f32 v[58:59], v[58:59], v[48:49] op_sel_hi:[1,0]
    v_pk_mul_f32 v[60:61], v[60:61], v[48:49] op_sel_hi:[1,0]
    v_pk_mul_f32 v[62:63], v[62:63], v[48:49] op_sel_hi:[1,0]
    v_cvt_pk_bf16_f32 v72, v56, v60
    v_cvt_pk_bf16_f32 v73, v57, v61
    v_cvt_pk_bf16_f32 v74, v58, v62
    v_cvt_pk_bf16_f32 v75, v59, v63
    ds_write_b128 v9, v[72:75] offset:0
    v_fma_f32 v64, v32, v105, v64
    v_fma_f32 v65, v33, v105, v65
    v_fma_f32 v66, v34, v105, v66
    v_fma_f32 v67, v35, v105, v67
    v_fma_f32 v68, v36, v105, v68
    v_fma_f32 v69, v37, v105, v69
    v_fma_f32 v70, v38, v105, v70
    v_fma_f32 v71, v39, v105, v71
    v_pk_mul_f32 v[64:65], v[64:65], v[52:53] op_sel_hi:[1,0]
    v_pk_mul_f32 v[66:67], v[66:67], v[52:53] op_sel_hi:[1,0]
    v_pk_mul_f32 v[68:69], v[68:69], v[52:53] op_sel_hi:[1,0]
    v_pk_mul_f32 v[70:71], v[70:71], v[52:53] op_sel_hi:[1,0]
    v_cvt_pk_bf16_f32 v76, v64, v68
    v_cvt_pk_bf16_f32 v77, v65, v69
    v_cvt_pk_bf16_f32 v78, v66, v70
    v_cvt_pk_bf16_f32 v79, v67, v71
    ds_write_b128 v9, v[76:79] offset:4096
    s_waitcnt lgkmcnt(0)
    s_barrier
    ds_read_b128 v[16:19], v1 offset:0
    ds_read_b128 v[20:23], v1 offset:1024
    ds_read_b128 v[24:27], v1 offset:2048
    ds_read_b128 v[28:31], v1 offset:3072
    ds_read_b128 v[32:35], v1 offset:4096
    ds_read_b128 v[36:39], v1 offset:5120
    ds_read_b128 v[40:43], v1 offset:6144
    ds_read_b128 v[44:47], v1 offset:7168
    ds_read_b128 v[48:51], v7 offset:0
    ds_read_b128 v[52:55], v7 offset:1024
    ds_read_b128 v[56:59], v7 offset:2048
    s_lshl_b32 s36, s20, 10
    s_add_u32 s25, s26, s36
    s_waitcnt lgkmcnt(2)
    v_mfma_f32_16x16x32_bf16 v[64:67], v[16:19], v[48:51], 0
    ds_read_b128 v[60:63], v7 offset:3072
    s_waitcnt lgkmcnt(2)
    v_mfma_f32_16x16x32_bf16 v[68:71], v[16:19], v[52:55], 0
    ds_read_b128 v[48:51], v7 offset:4096
    s_waitcnt lgkmcnt(2)
    v_mfma_f32_16x16x32_bf16 v[72:75], v[16:19], v[56:59], 0
    ds_read_b128 v[52:55], v7 offset:5120
    s_waitcnt lgkmcnt(2)
    v_mfma_f32_16x16x32_bf16 v[76:79], v[16:19], v[60:63], 0
    ds_read_b128 v[56:59], v7 offset:6144
    s_waitcnt lgkmcnt(2)
    v_mfma_f32_16x16x32_bf16 v[80:83], v[16:19], v[48:51], 0
    ds_read_b128 v[60:63], v7 offset:7168
    s_waitcnt lgkmcnt(2)
    v_mfma_f32_16x16x32_bf16 v[84:87], v[16:19], v[52:55], 0
    ds_read_b128 v[48:51], v7 offset:8192
    s_waitcnt lgkmcnt(2)
    v_mfma_f32_16x16x32_bf16 v[88:91], v[16:19], v[56:59], 0
    ds_read_b128 v[52:55], v7 offset:9216
    s_waitcnt lgkmcnt(2)
    v_mfma_f32_16x16x32_bf16 v[92:95], v[16:19], v[60:63], 0
    ds_read_b128 v[56:59], v7 offset:10240
    s_waitcnt lgkmcnt(2)
    v_mfma_f32_16x16x32_bf16 v[64:67], v[20:23], v[48:51], v[64:67]
    ds_read_b128 v[60:63], v7 offset:11264
    s_waitcnt lgkmcnt(2)
    v_mfma_f32_16x16x32_bf16 v[68:71], v[20:23], v[52:55], v[68:71]
    ds_read_b128 v[48:51], v7 offset:12288
    s_waitcnt lgkmcnt(2)
    v_mfma_f32_16x16x32_bf16 v[72:75], v[20:23], v[56:59], v[72:75]
    ds_read_b128 v[52:55], v7 offset:13312
    s_waitcnt lgkmcnt(2)
    v_mfma_f32_16x16x32_bf16 v[76:79], v[20:23], v[60:63], v[76:79]
    ds_read_b128 v[56:59], v7 offset:14336
    s_waitcnt lgkmcnt(2)
    v_mfma_f32_16x16x32_bf16 v[80:83], v[20:23], v[48:51], v[80:83]
    ds_read_b128 v[60:63], v7 offset:15360
    s_waitcnt lgkmcnt(2)
    v_mfma_f32_16x16x32_bf16 v[84:87], v[20:23], v[52:55], v[84:87]
    ds_read_b128 v[48:51], v7 offset:16384
    s_waitcnt lgkmcnt(2)
    v_mfma_f32_16x16x32_bf16 v[88:91], v[20:23], v[56:59], v[88:91]
    ds_read_b128 v[52:55], v7 offset:17408
    s_waitcnt lgkmcnt(2)
    v_mfma_f32_16x16x32_bf16 v[92:95], v[20:23], v[60:63], v[92:95]
    ds_read_b128 v[56:59], v7 offset:18432
    s_waitcnt lgkmcnt(2)
    v_mfma_f32_16x16x32_bf16 v[64:67], v[24:27], v[48:51], v[64:67]
    ds_read_b128 v[60:63], v7 offset:19456
    s_waitcnt lgkmcnt(2)
    v_mfma_f32_16x16x32_bf16 v[68:71], v[24:27], v[52:55], v[68:71]
    ds_read_b128 v[48:51], v7 offset:20480
    s_waitcnt lgkmcnt(2)
    v_mfma_f32_16x16x32_bf16 v[72:75], v[24:27], v[56:59], v[72:75]
    ds_read_b128 v[52:55], v7 offset:21504
    s_waitcnt lgkmcnt(2)
    v_mfma_f32_16x16x32_bf16 v[76:79], v[24:27], v[60:63], v[76:79]
    ds_read_b128 v[56:59], v7 offset:22528
    s_waitcnt lgkmcnt(2)
    v_mfma_f32_16x16x32_bf16 v[80:83], v[24:27], v[48:51], v[80:83]
    ds_read_b128 v[60:63], v7 offset:23552
    s_waitcnt lgkmcnt(2)
    v_mfma_f32_16x16x32_bf16 v[84:87], v[24:27], v[52:55], v[84:87]
    ds_read_b128 v[48:51], v7 offset:24576
    s_waitcnt lgkmcnt(2)
    v_mfma_f32_16x16x32_bf16 v[88:91], v[24:27], v[56:59], v[88:91]
    ds_read_b128 v[52:55], v7 offset:25600
    s_waitcnt lgkmcnt(2)
    v_mfma_f32_16x16x32_bf16 v[92:95], v[24:27], v[60:63], v[92:95]
    ds_read_b128 v[56:59], v7 offset:26624
    s_waitcnt lgkmcnt(2)
    v_mfma_f32_16x16x32_bf16 v[64:67], v[28:31], v[48:51], v[64:67]
    ds_read_b128 v[60:63], v7 offset:27648
    s_waitcnt lgkmcnt(2)
    v_mfma_f32_16x16x32_bf16 v[68:71], v[28:31], v[52:55], v[68:71]
    ds_read_b128 v[48:51], v7 offset:28672
    s_waitcnt lgkmcnt(2)
    v_mfma_f32_16x16x32_bf16 v[72:75], v[28:31], v[56:59], v[72:75]
    ds_read_b128 v[52:55], v7 offset:29696
    s_waitcnt lgkmcnt(2)
    v_mfma_f32_16x16x32_bf16 v[76:79], v[28:31], v[60:63], v[76:79]
    ds_read_b128 v[56:59], v7 offset:30720
    s_waitcnt lgkmcnt(2)
    v_mfma_f32_16x16x32_bf16 v[80:83], v[28:31], v[48:51], v[80:83]
    ds_read_b128 v[60:63], v7 offset:31744
    s_waitcnt lgkmcnt(2)
    v_mfma_f32_16x16x32_bf16 v[84:87], v[28:31], v[52:55], v[84:87]
    ds_read_b128 v[48:51], v7 offset:0
    s_waitcnt lgkmcnt(2)
    v_mfma_f32_16x16x32_bf16 v[88:91], v[28:31], v[56:59], v[88:91]
    ds_read_b128 v[52:55], v7 offset:1024
    s_waitcnt lgkmcnt(2)
    v_mfma_f32_16x16x32_bf16 v[92:95], v[28:31], v[60:63], v[92:95]
    ds_read_b128 v[56:59], v7 offset:2048
    s_waitcnt lgkmcnt(2)
    v_mfma_f32_16x16x32_bf16 v[96:99], v[32:35], v[48:51], 0
    ds_read_b128 v[60:63], v7 offset:3072
    s_waitcnt lgkmcnt(2)
    v_mfma_f32_16x16x32_bf16 v[100:103], v[32:35], v[52:55], 0
    ds_read_b128 v[48:51], v7 offset:4096
    s_waitcnt lgkmcnt(2)
    v_mfma_f32_16x16x32_bf16 v[104:107], v[32:35], v[56:59], 0
    ds_read_b128 v[52:55], v7 offset:5120
    s_waitcnt lgkmcnt(2)
    v_mfma_f32_16x16x32_bf16 v[108:111], v[32:35], v[60:63], 0
    ds_read_b128 v[56:59], v7 offset:6144
    v_cvt_pk_bf16_f32 v16, v64, v68
    s_waitcnt lgkmcnt(2)
    v_mfma_f32_16x16x32_bf16 v[112:115], v[32:35], v[48:51], 0
    ds_read_b128 v[60:63], v7 offset:7168
    v_cvt_pk_bf16_f32 v17, v72, v76
    s_waitcnt lgkmcnt(2)
    v_mfma_f32_16x16x32_bf16 v[116:119], v[32:35], v[52:55], 0
    ds_read_b128 v[48:51], v7 offset:8192
    v_cvt_pk_bf16_f32 v18, v80, v84
    s_waitcnt lgkmcnt(2)
    v_mfma_f32_16x16x32_bf16 v[120:123], v[32:35], v[56:59], 0
    ds_read_b128 v[52:55], v7 offset:9216
    v_cvt_pk_bf16_f32 v19, v88, v92
    s_waitcnt lgkmcnt(2)
    v_mfma_f32_16x16x32_bf16 v[124:127], v[32:35], v[60:63], 0
    ds_read_b128 v[56:59], v7 offset:10240
    v_and_or_b32 v16, v16, -2, s27
    s_waitcnt lgkmcnt(2)
    v_mfma_f32_16x16x32_bf16 v[96:99], v[36:39], v[48:51], v[96:99]
    ds_read_b128 v[60:63], v7 offset:11264
    s_add_u32 s36, s25, 0x0
    s_waitcnt lgkmcnt(2)
    v_mfma_f32_16x16x32_bf16 v[100:103], v[36:39], v[52:55], v[100:103]
    ds_read_b128 v[48:51], v7 offset:12288
    buffer_store_dwordx4 v[16:19], v10, s[8:11], s36 offen sc1
    s_waitcnt lgkmcnt(2)
    v_mfma_f32_16x16x32_bf16 v[104:107], v[36:39], v[56:59], v[104:107]
    ds_read_b128 v[52:55], v7 offset:13312
    v_cvt_pk_bf16_f32 v20, v65, v69
    s_waitcnt lgkmcnt(2)
    v_mfma_f32_16x16x32_bf16 v[108:111], v[36:39], v[60:63], v[108:111]
    ds_read_b128 v[56:59], v7 offset:14336
    v_cvt_pk_bf16_f32 v21, v73, v77
    s_waitcnt lgkmcnt(2)
    v_mfma_f32_16x16x32_bf16 v[112:115], v[36:39], v[48:51], v[112:115]
    ds_read_b128 v[60:63], v7 offset:15360
    v_cvt_pk_bf16_f32 v22, v81, v85
    s_waitcnt lgkmcnt(2)
    v_mfma_f32_16x16x32_bf16 v[116:119], v[36:39], v[52:55], v[116:119]
    ds_read_b128 v[48:51], v7 offset:16384
    v_cvt_pk_bf16_f32 v23, v89, v93
    s_waitcnt lgkmcnt(2)
    v_mfma_f32_16x16x32_bf16 v[120:123], v[36:39], v[56:59], v[120:123]
    ds_read_b128 v[52:55], v7 offset:17408
    v_and_or_b32 v20, v20, -2, s27
    s_waitcnt lgkmcnt(2)
    v_mfma_f32_16x16x32_bf16 v[124:127], v[36:39], v[60:63], v[124:127]
    ds_read_b128 v[56:59], v7 offset:18432
    s_add_u32 s36, s25, 0x8000
    s_waitcnt lgkmcnt(2)
    v_mfma_f32_16x16x32_bf16 v[96:99], v[40:43], v[48:51], v[96:99]
    ds_read_b128 v[60:63], v7 offset:19456
    buffer_store_dwordx4 v[20:23], v10, s[8:11], s36 offen sc1
    s_waitcnt lgkmcnt(2)
    v_mfma_f32_16x16x32_bf16 v[100:103], v[40:43], v[52:55], v[100:103]
    ds_read_b128 v[48:51], v7 offset:20480
    v_cvt_pk_bf16_f32 v24, v66, v70
    s_waitcnt lgkmcnt(2)
    v_mfma_f32_16x16x32_bf16 v[104:107], v[40:43], v[56:59], v[104:107]
    ds_read_b128 v[52:55], v7 offset:21504
    v_cvt_pk_bf16_f32 v25, v74, v78
    s_waitcnt lgkmcnt(2)
    v_mfma_f32_16x16x32_bf16 v[108:111], v[40:43], v[60:63], v[108:111]
    ds_read_b128 v[56:59], v7 offset:22528
    v_cvt_pk_bf16_f32 v26, v82, v86
    s_waitcnt lgkmcnt(2)
    v_mfma_f32_16x16x32_bf16 v[112:115], v[40:43], v[48:51], v[112:115]
    ds_read_b128 v[60:63], v7 offset:23552
    v_cvt_pk_bf16_f32 v27, v90, v94
    s_waitcnt lgkmcnt(2)
    v_mfma_f32_16x16x32_bf16 v[116:119], v[40:43], v[52:55], v[116:119]
    ds_read_b128 v[48:51], v7 offset:24576
    v_and_or_b32 v24, v24, -2, s27
    s_waitcnt lgkmcnt(2)
    v_mfma_f32_16x16x32_bf16 v[120:123], v[40:43], v[56:59], v[120:123]
    ds_read_b128 v[52:55], v7 offset:25600
    s_add_u32 s36, s25, 0x10000
    s_waitcnt lgkmcnt(2)
    v_mfma_f32_16x16x32_bf16 v[124:127], v[40:43], v[60:63], v[124:127]
    ds_read_b128 v[56:59], v7 offset:26624
    buffer_store_dwordx4 v[24:27], v10, s[8:11], s36 offen sc1
    s_waitcnt lgkmcnt(2)
    v_mfma_f32_16x16x32_bf16 v[96:99], v[44:47], v[48:51], v[96:99]
    ds_read_b128 v[60:63], v7 offset:27648
    v_cvt_pk_bf16_f32 v28, v67, v71
    s_waitcnt lgkmcnt(2)
    v_mfma_f32_16x16x32_bf16 v[100:103], v[44:47], v[52:55], v[100:103]
    ds_read_b128 v[48:51], v7 offset:28672
    v_cvt_pk_bf16_f32 v29, v75, v79
    s_waitcnt lgkmcnt(2)
    v_mfma_f32_16x16x32_bf16 v[104:107], v[44:47], v[56:59], v[104:107]
    ds_read_b128 v[52:55], v7 offset:29696
    v_cvt_pk_bf16_f32 v30, v83, v87
    s_waitcnt lgkmcnt(2)
    v_mfma_f32_16x16x32_bf16 v[108:111], v[44:47], v[60:63], v[108:111]
    ds_read_b128 v[56:59], v7 offset:30720
    v_cvt_pk_bf16_f32 v31, v91, v95
    s_waitcnt lgkmcnt(2)
    v_mfma_f32_16x16x32_bf16 v[112:115], v[44:47], v[48:51], v[112:115]
    ds_read_b128 v[60:63], v7 offset:31744
    v_and_or_b32 v28, v28, -2, s27
    s_waitcnt lgkmcnt(2)
    v_mfma_f32_16x16x32_bf16 v[116:119], v[44:47], v[52:55], v[116:119]
    s_add_u32 s36, s25, 0x18000
    s_waitcnt lgkmcnt(1)
    v_mfma_f32_16x16x32_bf16 v[120:123], v[44:47], v[56:59], v[120:123]
    buffer_store_dwordx4 v[28:31], v10, s[8:11], s36 offen sc1
    s_waitcnt lgkmcnt(0)
    v_mfma_f32_16x16x32_bf16 v[124:127], v[44:47], v[60:63], v[124:127]
    v_cvt_pk_bf16_f32 v32, v96, v100
    v_cvt_pk_bf16_f32 v33, v104, v108
    v_cvt_pk_bf16_f32 v34, v112, v116
    s_nop 4
    v_cvt_pk_bf16_f32 v35, v120, v124
    v_and_or_b32 v32, v32, -2, s27
    s_add_u32 s36, s25, 0x80000
    buffer_store_dwordx4 v[32:35], v10, s[8:11], s36 offen sc1
    v_cvt_pk_bf16_f32 v36, v97, v101
    v_cvt_pk_bf16_f32 v37, v105, v109
    v_cvt_pk_bf16_f32 v38, v113, v117
    v_cvt_pk_bf16_f32 v39, v121, v125
    v_and_or_b32 v36, v36, -2, s27
    s_add_u32 s36, s25, 0x88000
    buffer_store_dwordx4 v[36:39], v10, s[8:11], s36 offen sc1
    v_cvt_pk_bf16_f32 v40, v98, v102
    v_cvt_pk_bf16_f32 v41, v106, v110
    v_cvt_pk_bf16_f32 v42, v114, v118
    v_cvt_pk_bf16_f32 v43, v122, v126
    v_and_or_b32 v40, v40, -2, s27
    s_add_u32 s36, s25, 0x90000
    buffer_store_dwordx4 v[40:43], v10, s[8:11], s36 offen sc1
    v_cvt_pk_bf16_f32 v44, v99, v103
    v_cvt_pk_bf16_f32 v45, v107, v111
    v_cvt_pk_bf16_f32 v46, v115, v119
    v_cvt_pk_bf16_f32 v47, v123, v127
    v_and_or_b32 v44, v44, -2, s27
    s_add_u32 s36, s25, 0x98000
    buffer_store_dwordx4 v[44:47], v10, s[8:11], s36 offen sc1
    s_add_u32 s38, s23, 6
    s_cmp_ge_u32 s38, 64
    s_cbranch_scc1 L_P2_last
    s_mul_i32 s24, s38, 0x82100
    s_lshl_b32 s36, s20, 14
    s_add_u32 s24, s24, s36
    s_add_u32 s24, s24, 0x1000000
    s_add_u32 s37, s24, 0x7000000
    s_add_u32 s36, s37, 8192
    buffer_load_dwordx4 a[32:35], v1, s[8:11], s36 offen offset:0 sc1
    buffer_load_dwordx4 a[0:3], v1, s[8:11], s37 offen offset:0 sc1
    buffer_load_dwordx4 a[36:39], v1, s[8:11], s36 offen offset:1024 sc1
    buffer_load_dwordx4 a[4:7], v1, s[8:11], s37 offen offset:1024 sc1
    buffer_load_dwordx4 a[40:43], v1, s[8:11], s36 offen offset:2048 sc1
    buffer_load_dwordx4 a[8:11], v1, s[8:11], s37 offen offset:2048 sc1
    buffer_load_dwordx4 a[44:47], v1, s[8:11], s36 offen offset:3072 sc1
    buffer_load_dwordx4 a[12:15], v1, s[8:11], s37 offen offset:3072 sc1
    s_add_u32 s37, s24, 0x7001000
    s_add_u32 s36, s37, 8192
    buffer_load_dwordx4 a[48:51], v1, s[8:11], s36 offen offset:0 sc1
    buffer_load_dwordx4 a[16:19], v1, s[8:11], s37 offen offset:0 sc1
    buffer_load_dwordx4 a[52:55], v1, s[8:11], s36 offen offset:1024 sc1
    buffer_load_dwordx4 a[20:23], v1, s[8:11], s37 offen offset:1024 sc1
    buffer_load_dwordx4 a[56:59], v1, s[8:11], s36 offen offset:2048 sc1
    buffer_load_dwordx4 a[24:27], v1, s[8:11], s37 offen offset:2048 sc1
    buffer_load_dwordx4 a[60:63], v1, s[8:11], s36 offen offset:3072 sc1
    buffer_load_dwordx4 a[28:31], v1, s[8:11], s37 offen offset:3072 sc1
    s_lshr_b32 s36, s21, 1
    s_lshl_b32 s36, s36, 3
    s_xor_b32 s37, s36, 8
    s_add_u32 s24, s24, 8192
    s_add_u32 s36, s36, s24
    s_add_u32 s37, s37, s24
    buffer_load_dwordx2 a[64:65], v2, s[8:11], s36 offen offset:0 sc1
    buffer_load_dwordx2 a[66:67], v2, s[8:11], s37 offen offset:0 sc1
    buffer_load_dwordx2 a[68:69], v2, s[8:11], s36 offen offset:1024 sc1
    buffer_load_dwordx2 a[70:71], v2, s[8:11], s37 offen offset:1024 sc1
L_P2_last:
    s_lshl_b32 s24, s23, 5
    s_add_u32 s24, s24, s20
    s_lshl_b32 s24, s24, 10
    v_accvgpr_read_b32 v52, a72
    v_accvgpr_read_b32 v53, a73
    v_and_b32 v15, 15, v0
    v_mov_b32 v48, 0
    v_mov_b32 v14, 0x3f80
    v_cmp_eq_u32 vcc, 0, v15
    s_nop 1
    v_cndmask_b32 v48, v48, v14, vcc
    v_mov_b32 v14, 0x3f800000
    v_cmp_eq_u32 vcc, 1, v15
    s_nop 1
    v_cndmask_b32 v48, v48, v14, vcc
    v_mov_b32 v49, 0
    v_mov_b32 v14, 0x3f80
    v_cmp_eq_u32 vcc, 4, v15
    s_nop 1
    v_cndmask_b32 v49, v49, v14, vcc
    v_mov_b32 v14, 0x3f800000
    v_cmp_eq_u32 vcc, 5, v15
    s_nop 1
    v_cndmask_b32 v49, v49, v14, vcc
    v_mov_b32 v50, 0
    v_mov_b32 v14, 0x3f80
    v_cmp_eq_u32 vcc, 8, v15
    s_nop 1
    v_cndmask_b32 v50, v50, v14, vcc
    v_mov_b32 v14, 0x3f800000
    v_cmp_eq_u32 vcc, 9, v15
    s_nop 1
    v_cndmask_b32 v50, v50, v14, vcc
    v_mov_b32 v51, 0
    v_mov_b32 v14, 0x3f80
    v_cmp_eq_u32 vcc, 12, v15
    s_nop 1
    v_cndmask_b32 v51, v51, v14, vcc
    v_mov_b32 v14, 0x3f800000
    v_cmp_eq_u32 vcc, 13, v15
    s_nop 1
    v_cndmask_b32 v51, v51, v14, vcc
    s_lshl_b32 s25, s20, 15
    s_add_u32 s25, s25, s26
L_P3_poll:
    s_add_u32 s36, s25, 0
    buffer_load_dwordx4 v[80:83], v11, s[8:11], s36 offen sc1
    s_add_u32 s36, s25, 4096
    buffer_load_dwordx4 v[84:87], v11, s[8:11], s36 offen sc1
    s_add_u32 s36, s25, 8192
    buffer_load_dwordx4 v[88:91], v11, s[8:11], s36 offen sc1
    s_add_u32 s36, s25, 12288
    buffer_load_dwordx4 v[92:95], v11, s[8:11], s36 offen sc1
    s_add_u32 s36, s25, 16384
    buffer_load_dwordx4 v[96:99], v11, s[8:11], s36 offen sc1
    s_add_u32 s36, s25, 20480
    buffer_load_dwordx4 v[100:103], v11, s[8:11], s36 offen sc1
    s_add_u32 s36, s25, 24576
    buffer_load_dwordx4 v[104:107], v11, s[8:11], s36 offen sc1
    s_add_u32 s36, s25, 28672
    buffer_load_dwordx4 v[108:111], v11, s[8:11], s36 offen sc1
    s_mov_b64 exec, -1
    s_add_u32 s32, s32, 1
    s_cmp_gt_u32 s32, 200000
    s_waitcnt vmcnt(7)
    v_mfma_f32_16x16x32_bf16 v[56:59], v[48:51], v[80:83], 0
    s_waitcnt vmcnt(6)
    v_mfma_f32_16x16x32_bf16 v[56:59], v[48:51], v[84:87], v[56:59]
    v_bitop3_b32 v60, v80, v84, s27 bitop3:0x7e
    s_waitcnt vmcnt(5)
    v_mfma_f32_16x16x32_bf16 v[56:59], v[48:51], v[88:91], v[56:59]
    s_waitcnt vmcnt(4)
    v_mfma_f32_16x16x32_bf16 v[56:59], v[48:51], v[92:95], v[56:59]
    v_bitop3_b32 v61, v88, v92, s27 bitop3:0x7e
    s_waitcnt vmcnt(3)
    v_mfma_f32_16x16x32_bf16 v[56:59], v[48:51], v[96:99], v[56:59]
    s_waitcnt vmcnt(2)
    v_mfma_f32_16x16x32_bf16 v[56:59], v[48:51], v[100:103], v[56:59]
    v_bitop3_b32 v62, v96, v100, s27 bitop3:0x7e
    s_waitcnt vmcnt(1)
    v_mfma_f32_16x16x32_bf16 v[56:59], v[48:51], v[104:107], v[56:59]
    s_waitcnt vmcnt(0)
    v_mfma_f32_16x16x32_bf16 v[56:59], v[48:51], v[108:111], v[56:59]
    v_bitop3_b32 v63, v104, v108, s27 bitop3:0x7e
    v_or3_b32 v14, v60, v61, v62
    v_bitop3_b32 v14, v14, v63, 1 bitop3:0xa8
    s_cbranch_scc1 L_P3_got
    v_cmp_ne_u32 vcc, 0, v14
    s_cbranch_vccz L_P3_got
    s_mov_b64 exec, vcc
    s_branch L_P3_poll
L_P3_got:
    s_nop 4
    v_cvt_pk_bf16_f32 v62, v56, v57
    v_lshlrev_b32 v65, 16, v62
    v_and_b32 v66, 0xffff0000, v62
    v_lshlrev_b32 v60, 16, v52
    v_and_b32 v61, 0xffff0000, v52
    v_add_f32 v60, v60, v65
    v_add_f32 v61, v61, v66
    v_cvt_pk_bf16_f32 v62, v60, v61
    v_lshlrev_b32 v60, 16, v62
    v_and_b32 v61, 0xffff0000, v62
    v_add_f32 v63, v60, v61
    v_mul_f32 v64, v60, v60
    v_fmac_f32 v64, v61, v61
    v_add_f32_dpp v63, v63, v63 quad_perm:[1,0,3,2] row_mask:0xf bank_mask:0xf
    s_nop 0
    v_add_f32_dpp v64, v64, v64 quad_perm:[1,0,3,2] row_mask:0xf bank_mask:0xf
    v_add_f32_dpp v63, v63, v63 quad_perm:[2,3,0,1] row_mask:0xf bank_mask:0xf
    s_nop 0
    v_add_f32_dpp v64, v64, v64 quad_perm:[2,3,0,1] row_mask:0xf bank_mask:0xf
    v_add_f32_dpp v63, v63, v63 row_half_mirror row_mask:0xf bank_mask:0xf
    s_nop 0
    v_add_f32_dpp v64, v64, v64 row_half_mirror row_mask:0xf bank_mask:0xf
    v_add_f32_dpp v63, v63, v63 row_mirror row_mask:0xf bank_mask:0xf
    s_nop 0
    v_add_f32_dpp v64, v64, v64 row_mirror row_mask:0xf bank_mask:0xf
    v_mov_b32 v14, v63
    s_nop 1
    v_permlane16_swap_b32 v63, v14
    v_add_f32 v63, v63, v14
    v_mov_b32 v14, v64
    s_nop 1
    v_permlane16_swap_b32 v64, v14
    v_add_f32 v64, v64, v14
    v_mov_b32 v14, v63
    s_nop 1
    v_permlane32_swap_b32 v63, v14
    v_add_f32 v63, v63, v14
    v_mov_b32 v14, v64
    s_nop 1
    v_permlane32_swap_b32 v64, v14
    v_add_f32 v64, v64, v14
    v_mov_b32 v15, s21
    v_lshlrev_b32 v15, 3, v15
    v_add_u32 v15, 28672, v15
    ds_write2_b32 v15, v63, v64 offset0:0 offset1:1
    s_add_u32 s36, s24, 0x400000
    buffer_store_dword v62, v12, s[8:11], s36 offen sc1
    s_waitcnt lgkmcnt(0)
    s_barrier
    v_mov_b32 v15, 28672
    ds_read_b128 v[68:71], v15
    ds_read_b128 v[72:75], v15 offset:16
    s_waitcnt lgkmcnt(0)
    v_add_f32 v63, v68, v70
    v_add_f32 v63, v63, v72
    v_add_f32 v63, v63, v74
    v_mul_f32 v63, 0x3b000000, v63
    v_add_f32 v64, v69, v71
    v_add_f32 v64, v64, v73
    v_add_f32 v64, v64, v75
    v_mul_f32 v64, 0x3b000000, v64
    v_fma_f32 v64, -v63, v63, v64
    v_max_f32 v64, 0, v64
    v_cvt_pk_bf16_f32 v14, v63, v64
    v_lshlrev_b32 v63, 16, v14
    v_and_b32 v64, 0xffff0000, v14
    v_add_f32 v64, 0x3727c5ac, v64
    v_cvt_pk_bf16_f32 v14, v64, v64
    v_lshlrev_b32 v64, 16, v14
    v_sqrt_f32 v64, v64
    s_nop 0
    v_cvt_pk_bf16_f32 v14, v64, v64
    v_lshlrev_b32 v64, 16, v14
    v_rcp_f32 v64, v64
    v_sub_f32 v65, v60, v63
    v_sub_f32 v66, v61, v63
    v_cvt_pk_bf16_f32 v14, v65, v66
    v_lshlrev_b32 v65, 16, v14
    v_and_b32 v66, 0xffff0000, v14
    v_mul_f32 v65, v65, v64
    v_mul_f32 v66, v66, v64
    v_cvt_pk_bf16_f32 v67, v65, v66
    v_lshlrev_b32 v65, 16, v67
    v_and_b32 v66, 0xffff0000, v67
    v_lshlrev_b32 v68, 16, v53
    v_and_b32 v69, 0xffff0000, v53
    v_mul_f32 v63, v65, v68
    v_fmac_f32 v63, v66, v69
    s_nop 1
    v_add_f32_dpp v63, v63, v63 quad_perm:[1,0,3,2] row_mask:0xf bank_mask:0xf
    s_nop 1
    v_add_f32_dpp v63, v63, v63 quad_perm:[2,3,0,1] row_mask:0xf bank_mask:0xf
    s_nop 1
    v_add_f32_dpp v63, v63, v63 row_half_mirror row_mask:0xf bank_mask:0xf
    s_nop 1
    v_add_f32_dpp v63, v63, v63 row_mirror row_mask:0xf bank_mask:0xf
    v_mov_b32 v14, v63
    s_nop 1
    v_permlane16_swap_b32 v63, v14
    v_add_f32 v63, v63, v14
    v_mov_b32 v14, v63
    s_nop 1
    v_permlane32_swap_b32 v63, v14
    v_add_f32 v63, v63, v14
    s_lshr_b32 s25, s24, 6
    s_lshl_b32 s37, s21, 2
    s_add_u32 s25, s25, s37
    s_add_u32 s36, s25, 0x194000
    v_cmp_ne_u32 vcc, 0, v1
    v_mov_b32 v15, 0x40000000
    s_nop 0
    v_cndmask_b32 v15, v1, v15, vcc
    buffer_store_dword v63, v15, s[8:11], s36 offen sc1
    v_add_f32 v60, v60, v65
    v_add_f32 v61, v61, v66
    v_cvt_pk_bf16_f32 v62, v60, v61
    buffer_store_dword v62, v12, s[60:63], s24 offen sc1
    s_add_u32 s36, s24, 0x600000
    buffer_store_dword v67, v12, s[8:11], s36 offen sc1
    s_add_u32 s30, s25, 0x1b8000
    s_add_u32 s29, s29, 1
    s_barrier
    s_add_u32 s23, s23, 6
    s_cmp_lt_u32 s23, 64
    s_cbranch_scc1 L_P2
    s_waitcnt vmcnt(0)
    v_cmp_ne_u32 vcc, 0, v1
    v_mov_b32 v15, 0x40000000
    v_mov_b32 v14, 0
    v_cndmask_b32 v15, v1, v15, vcc
    buffer_store_dword v14, v15, s[8:11], s30 offen sc1
    s_branch L_end
L_mlp:
    s_mov_b32 s12, s44
    s_and_b32 s13, s45, 0xffff
    s_mov_b32 s14, 0x200000
    s_mov_b32 s15, 0x20000
    s_mov_b32 s60, s82
    s_and_b32 s61, s83, 0xffff
    s_mov_b32 s62, 0x200000
    s_mov_b32 s63, 0x20000
    s_mov_b32 s92, s80
    s_and_b32 s93, s81, 0xffff
    s_mov_b32 s94, 0x400
    s_mov_b32 s95, 0x20000
    v_mov_b32 v1, 0x0
    v_bfe_u32 v14, v0, 0, 1
    s_mov_b32 s38, 0x10
    v_mad_u32_u24 v1, v14, s38, v1
    v_bfe_u32 v14, v0, 1, 1
    s_mov_b32 s38, 0x20
    v_mad_u32_u24 v1, v14, s38, v1
    v_bfe_u32 v14, v0, 2, 1
    s_mov_b32 s38, 0x40
    v_mad_u32_u24 v1, v14, s38, v1
    v_bfe_u32 v14, v0, 3, 1
    s_mov_b32 s38, 0x80
    v_mad_u32_u24 v1, v14, s38, v1
    v_bfe_u32 v14, v0, 4, 1
    s_mov_b32 s38, 0x100
    v_mad_u32_u24 v1, v14, s38, v1
    v_bfe_u32 v14, v0, 5, 1
    s_mov_b32 s38, 0x200
    v_mad_u32_u24 v1, v14, s38, v1
    v_mov_b32 v2, 0x0
    v_bfe_u32 v14, v0, 0, 1
    s_mov_b32 s38, 0x10
    v_mad_u32_u24 v2, v14, s38, v2
    v_bfe_u32 v14, v0, 1, 1
    s_mov_b32 s38, 0x20
    v_mad_u32_u24 v2, v14, s38, v2
    v_bfe_u32 v14, v0, 2, 1
    s_mov_b32 s38, 0x40
    v_mad_u32_u24 v2, v14, s38, v2
    v_bfe_u32 v14, v0, 3, 1
    s_mov_b32 s38, 0x80
    v_mad_u32_u24 v2, v14, s38, v2
    v_bfe_u32 v14, v0, 4, 1
    s_mov_b32 s38, 0x100
    v_mad_u32_u24 v2, v14, s38, v2
    v_bfe_u32 v14, v0, 5, 1
    s_mov_b32 s38, 0x200
    v_mad_u32_u24 v2, v14, s38, v2
    v_bfe_u32 v14, v0, 6, 1
    s_mov_b32 s38, 0x800
    v_mad_u32_u24 v2, v14, s38, v2
    v_bfe_u32 v14, v0, 7, 1
    s_mov_b32 s38, 0x1000
    v_mad_u32_u24 v2, v14, s38, v2
    v_mov_b32 v9, 0x0
    v_bfe_u32 v14, v0, 0, 1
    s_mov_b32 s38, 0x10
    v_mad_u32_u24 v9, v14, s38, v9
    v_bfe_u32 v14, v0, 1, 1
    s_mov_b32 s38, 0x20
    v_mad_u32_u24 v9, v14, s38, v9
    v_bfe_u32 v14, v0, 2, 1
    s_mov_b32 s38, 0x40
    v_mad_u32_u24 v9, v14, s38, v9
    v_bfe_u32 v14, v0, 3, 1
    s_mov_b32 s38, 0x80
    v_mad_u32_u24 v9, v14, s38, v9
    v_bfe_u32 v14, v0, 4, 1
    s_mov_b32 s38, 0x100
    v_mad_u32_u24 v9, v14, s38, v9
    v_bfe_u32 v14, v0, 5, 1
    s_mov_b32 s38, 0x200
    v_mad_u32_u24 v9, v14, s38, v9
    v_bfe_u32 v14, v0, 6, 1
    s_mov_b32 s38, 0x400
    v_mad_u32_u24 v9, v14, s38, v9
    v_bfe_u32 v14, v0, 7, 1
    s_mov_b32 s38, 0x800
    v_mad_u32_u24 v9, v14, s38, v9
    v_mov_b32 v7, 0x8000
    v_bfe_u32 v14, v0, 0, 1
    s_mov_b32 s38, 0x10
    v_mad_u32_u24 v7, v14, s38, v7
    v_bfe_u32 v14, v0, 1, 1
    s_mov_b32 s38, 0x20
    v_mad_u32_u24 v7, v14, s38, v7
    v_bfe_u32 v14, v0, 2, 1
    s_mov_b32 s38, 0x40
    v_mad_u32_u24 v7, v14, s38, v7
    v_bfe_u32 v14, v0, 3, 1
    s_mov_b32 s38, 0x80
    v_mad_u32_u24 v7, v14, s38, v7
    v_bfe_u32 v14, v0, 4, 1
    s_mov_b32 s38, 0x100
    v_mad_u32_u24 v7, v14, s38, v7
    v_bfe_u32 v14, v0, 5, 1
    s_mov_b32 s38, 0x200
    v_mad_u32_u24 v7, v14, s38, v7
    v_bfe_u32 v14, v0, 6, 1
    s_mov_b32 s38, 0x8000
    v_mad_u32_u24 v7, v14, s38, v7
    v_bfe_u32 v14, v0, 7, 1
    s_mov_b32 s38, 0x10000
    v_mad_u32_u24 v7, v14, s38, v7
    v_mov_b32 v3, 0x0
    v_bfe_u32 v14, v0, 0, 1
    s_mov_b32 s38, 0x10
    v_mad_u32_u24 v3, v14, s38, v3
    v_bfe_u32 v14, v0, 1, 1
    s_mov_b32 s38, 0x20
    v_mad_u32_u24 v3, v14, s38, v3
    v_bfe_u32 v14, v0, 2, 1
    s_mov_b32 s38, 0x40
    v_mad_u32_u24 v3, v14, s38, v3
    v_bfe_u32 v14, v0, 3, 1
    s_mov_b32 s38, 0x400
    v_mad_u32_u24 v3, v14, s38, v3
    v_bfe_u32 v14, v0, 4, 1
    s_mov_b32 s38, 0x800
    v_mad_u32_u24 v3, v14, s38, v3
    v_bfe_u32 v14, v0, 5, 1
    s_mov_b32 s38, 0x1000
    v_mad_u32_u24 v3, v14, s38, v3
    v_bfe_u32 v14, v0, 6, 1
    s_mov_b32 s38, 0x2000
    v_mad_u32_u24 v3, v14, s38, v3
    v_bfe_u32 v14, v0, 7, 1
    s_mov_b32 s38, 0x4000
    v_mad_u32_u24 v3, v14, s38, v3
    v_mov_b32 v4, 0x0
    v_bfe_u32 v14, v0, 0, 1
    s_mov_b32 s38, 0x100
    v_mad_u32_u24 v4, v14, s38, v4
    v_bfe_u32 v14, v0, 1, 1
    s_mov_b32 s38, 0x200
    v_mad_u32_u24 v4, v14, s38, v4
    v_bfe_u32 v14, v0, 2, 1
    s_mov_b32 s38, 0x400
    v_mad_u32_u24 v4, v14, s38, v4
    v_bfe_u32 v14, v0, 6, 1
    s_mov_b32 s38, 0x80
    v_mad_u32_u24 v4, v14, s38, v4
    v_bfe_u32 v14, v0, 7, 1
    s_mov_b32 s38, 0x4000
    v_mad_u32_u24 v4, v14, s38, v4
    v_lshrrev_b32 v15, 3, v0
    v_xor_b32 v15, v15, v0
    v_and_b32 v15, 7, v15
    v_lshl_add_u32 v4, v15, 4, v4
    v_bfe_u32 v15, v0, 4, 2
    v_lshlrev_b32 v15, 4, v15
    v_xor_b32 v5, v15, v1
    v_xor_b32 v6, 64, v5
    v_mov_b32 v8, 0x5000
    v_bfe_u32 v14, v0, 0, 1
    s_mov_b32 s38, 0x10
    v_mad_u32_u24 v8, v14, s38, v8
    v_bfe_u32 v14, v0, 1, 1
    s_mov_b32 s38, 0x40
    v_mad_u32_u24 v8, v14, s38, v8
    v_bfe_u32 v14, v0, 2, 1
    s_mov_b32 s38, 0x80
    v_mad_u32_u24 v8, v14, s38, v8
    v_bfe_u32 v14, v0, 4, 1
    s_mov_b32 s38, 0x20
    v_mad_u32_u24 v8, v14, s38, v8
    v_bfe_u32 v14, v0, 5, 1
    s_mov_b32 s38, 0x100
    v_mad_u32_u24 v8, v14, s38, v8
    v_mov_b32 v10, 0x0
    v_bfe_u32 v14, v0, 0, 1
    s_mov_b32 s38, 0x10
    v_mad_u32_u24 v10, v14, s38, v10
    v_bfe_u32 v14, v0, 1, 1
    s_mov_b32 s38, 0x20
    v_mad_u32_u24 v10, v14, s38, v10
    v_bfe_u32 v14, v0, 2, 1
    s_mov_b32 s38, 0x40
    v_mad_u32_u24 v10, v14, s38, v10
    v_bfe_u32 v14, v0, 3, 1
    s_mov_b32 s38, 0x80
    v_mad_u32_u24 v10, v14, s38, v10
    v_bfe_u32 v14, v0, 4, 1
    s_mov_b32 s38, 0x20000
    v_mad_u32_u24 v10, v14, s38, v10
    v_bfe_u32 v14, v0, 5, 1
    s_mov_b32 s38, 0x40000
    v_mad_u32_u24 v10, v14, s38, v10
    v_bfe_u32 v14, v0, 6, 1
    s_mov_b32 s38, 0x100
    v_mad_u32_u24 v10, v14, s38, v10
    v_bfe_u32 v14, v0, 7, 1
    s_mov_b32 s38, 0x200
    v_mad_u32_u24 v10, v14, s38, v10
    v_mov_b32 v11, 0x0
    v_bfe_u32 v14, v0, 0, 1
    s_mov_b32 s38, 0x10
    v_mad_u32_u24 v11, v14, s38, v11
    v_bfe_u32 v14, v0, 1, 1
    s_mov_b32 s38, 0x20
    v_mad_u32_u24 v11, v14, s38, v11
    v_bfe_u32 v14, v0, 2, 1
    s_mov_b32 s38, 0x40
    v_mad_u32_u24 v11, v14, s38, v11
    v_bfe_u32 v14, v0, 3, 1
    s_mov_b32 s38, 0x80
    v_mad_u32_u24 v11, v14, s38, v11
    v_bfe_u32 v14, v0, 4, 1
    s_mov_b32 s38, 0x400
    v_mad_u32_u24 v11, v14, s38, v11
    v_bfe_u32 v14, v0, 5, 1
    s_mov_b32 s38, 0x800
    v_mad_u32_u24 v11, v14, s38, v11
    v_bfe_u32 v14, v0, 6, 1
    s_mov_b32 s38, 0x100
    v_mad_u32_u24 v11, v14, s38, v11
    v_bfe_u32 v14, v0, 7, 1
    s_mov_b32 s38, 0x200
    v_mad_u32_u24 v11, v14, s38, v11
    v_mov_b32 v12, 0x0
    v_bfe_u32 v14, v0, 0, 1
    s_mov_b32 s38, 0x10
    v_mad_u32_u24 v12, v14, s38, v12
    v_bfe_u32 v14, v0, 1, 1
    s_mov_b32 s38, 0x20
    v_mad_u32_u24 v12, v14, s38, v12
    v_bfe_u32 v14, v0, 2, 1
    s_mov_b32 s38, 0x40
    v_mad_u32_u24 v12, v14, s38, v12
    v_bfe_u32 v14, v0, 3, 1
    s_mov_b32 s38, 0x80
    v_mad_u32_u24 v12, v14, s38, v12
    v_bfe_u32 v14, v0, 4, 1
    s_mov_b32 s38, 0x4
    v_mad_u32_u24 v12, v14, s38, v12
    v_bfe_u32 v14, v0, 5, 1
    s_mov_b32 s38, 0x8
    v_mad_u32_u24 v12, v14, s38, v12
    v_bfe_u32 v14, v0, 6, 1
    s_mov_b32 s38, 0x100
    v_mad_u32_u24 v12, v14, s38, v12
    v_bfe_u32 v14, v0, 7, 1
    s_mov_b32 s38, 0x200
    v_mad_u32_u24 v12, v14, s38, v12
    v_mov_b32 v13, 0xf149f2ca
    v_and_b32 v14, 15, v0
    v_bfe_u32 v15, v0, 4, 2
    v_cmp_gt_u32 s[72:73], 2, v15
    v_lshlrev_b32 v15, 2, v15
    v_cmp_le_u32 s[64:65], v15, v14
    v_add_u32 v15, 1, v15
    v_cmp_le_u32 s[66:67], v15, v14
    v_add_u32 v15, 1, v15
    v_cmp_le_u32 s[68:69], v15, v14
    v_add_u32 v15, 1, v15
    v_cmp_le_u32 s[70:71], v15, v14
    v_add_u32 v15, 1, v15
    s_mov_b32 s34, 0x05040100
    s_mov_b32 s35, 0x07060302
    s_mov_b32 s33, 0x3e0293ee
    s_mov_b32 s32, 0
    s_mov_b32 s4, 0x3f803f80
    s_mov_b32 s5, 0x3f803f80
    s_lshr_b32 s20, s2, 3
    s_lshr_b32 s23, s2, 3
    s_lshl_b32 s23, s23, 1
    s_lshl_b32 s36, s23, 15
    buffer_load_dwordx4 v[96:99], v3, s[12:15], s36 offen offset:0
    buffer_load_dwordx4 v[100:103], v3, s[12:15], s36 offen offset:128
    buffer_load_dwordx4 v[104:107], v3, s[12:15], s36 offen offset:256
    buffer_load_dwordx4 v[108:111], v3, s[12:15], s36 offen offset:384
    buffer_load_dwordx4 v[112:115], v3, s[12:15], s36 offen offset:512
    buffer_load_dwordx4 v[116:119], v3, s[12:15], s36 offen offset:640
    buffer_load_dwordx4 v[120:123], v3, s[12:15], s36 offen offset:768
    buffer_load_dwordx4 v[124:127], v3, s[12:15], s36 offen offset:896
    s_add_u32 s36, s36, 0x8000
    buffer_load_dwordx4 v[128:131], v3, s[12:15], s36 offen offset:0
    buffer_load_dwordx4 v[132:135], v3, s[12:15], s36 offen offset:128
    buffer_load_dwordx4 v[136:139], v3, s[12:15], s36 offen offset:256
    buffer_load_dwordx4 v[140:143], v3, s[12:15], s36 offen offset:384
    buffer_load_dwordx4 v[144:147], v3, s[12:15], s36 offen offset:512
    buffer_load_dwordx4 v[148:151], v3, s[12:15], s36 offen offset:640
    buffer_load_dwordx4 v[152:155], v3, s[12:15], s36 offen offset:768
    buffer_load_dwordx4 v[156:159], v3, s[12:15], s36 offen offset:896
    s_mov_b32 s96, s46
    s_and_b32 s97, s47, 0xffff
    s_mov_b32 s98, 0x2000
    s_mov_b32 s99, 0x20000
    v_mov_b32 v68, 0x0
    v_bfe_u32 v14, v0, 0, 1
    s_mov_b32 s38, 0x8
    v_mad_u32_u24 v68, v14, s38, v68
    v_bfe_u32 v14, v0, 1, 1
    s_mov_b32 s38, 0x10
    v_mad_u32_u24 v68, v14, s38, v68
    v_bfe_u32 v14, v0, 2, 1
    s_mov_b32 s38, 0x10000
    v_mad_u32_u24 v68, v14, s38, v68
    v_bfe_u32 v14, v0, 3, 1
    s_mov_b32 s38, 0x10000
    v_mad_u32_u24 v68, v14, s38, v68
    v_bfe_u32 v14, v0, 4, 1
    s_mov_b32 s38, 0x400
    v_mad_u32_u24 v68, v14, s38, v68
    v_bfe_u32 v14, v0, 5, 1
    s_mov_b32 s38, 0x4
    v_mad_u32_u24 v68, v14, s38, v68
    v_bfe_u32 v14, v0, 6, 1
    s_mov_b32 s38, 0x40
    v_mad_u32_u24 v68, v14, s38, v68
    v_bfe_u32 v14, v0, 7, 1
    s_mov_b32 s38, 0x80
    v_mad_u32_u24 v68, v14, s38, v68
    v_mov_b32 v70, s20
    v_mov_b32 v69, 0x0
    v_bfe_u32 v14, v70, 0, 1
    s_mov_b32 s38, 0x20
    v_mad_u32_u24 v69, v14, s38, v69
    v_bfe_u32 v14, v70, 1, 1
    s_mov_b32 s38, 0x800
    v_mad_u32_u24 v69, v14, s38, v69
    v_bfe_u32 v14, v70, 2, 1
    s_mov_b32 s38, 0x1000
    v_mad_u32_u24 v69, v14, s38, v69
    v_bfe_u32 v14, v70, 3, 1
    s_mov_b32 s38, 0x100
    v_mad_u32_u24 v69, v14, s38, v69
    v_bfe_u32 v14, v70, 4, 1
    s_mov_b32 s38, 0x200
    v_mad_u32_u24 v69, v14, s38, v69
    v_add_u32 v68, v68, v69
    buffer_load_dword v72, v68, s[96:99], 0 offen
    v_mov_b32 v64, -1
    v_mov_b32 v65, -1
    v_mov_b32 v66, -1
    v_mov_b32 v67, -1
    s_lshl_b32 s36, s20, 13
    s_add_u32 s36, s36, 0x0
    buffer_store_dwordx4 v[64:67], v2, s[8:11], s36 offen sc1
    buffer_store_dwordx4 v[64:67], v2, s[8:11], s36 offen offset:1024 sc1
    s_lshl_b32 s36, s20, 14
    s_add_u32 s36, s36, 0x100000
    s_add_u32 s37, s36, 0x2000
    buffer_store_dwordx4 v[64:67], v2, s[8:11], s36 offen sc1
    buffer_store_dwordx4 v[64:67], v2, s[8:11], s36 offen offset:1024 sc1
    buffer_store_dwordx4 v[64:67], v2, s[8:11], s37 offen sc1
    buffer_store_dwordx4 v[64:67], v2, s[8:11], s37 offen offset:1024 sc1
    s_mul_i32 s36, s20, 0x104200
    s_add_u32 s36, s36, 0x1102100
    s_add_u32 s37, s36, 0x82100
    buffer_store_dwordx4 v[64:67], v2, s[8:11], s36 offen sc1
    buffer_store_dwordx4 v[64:67], v2, s[8:11], s36 offen offset:1024 sc1
    buffer_store_dwordx4 v[64:67], v2, s[8:11], s37 offen sc1
    buffer_store_dwordx4 v[64:67], v2, s[8:11], s37 offen offset:1024 sc1
    v_lshlrev_b32 v68, 2, v0
    s_lshl_b32 s36, s20, 10
    s_add_u32 s37, s36, 0x194000
    buffer_store_dword v64, v68, s[8:11], s37 offen sc1
    s_add_u32 s37, s36, 0x1b0000
    buffer_store_dword v64, v68, s[8:11], s37 offen sc1
    s_add_u32 s37, s36, 0x1b8000
    buffer_store_dword v64, v68, s[8:11], s37 offen sc1
    v_mov_b32 v69, 0x40000000
    v_cmp_lt_u32 vcc, 63, v0
    s_nop 1
    v_cndmask_b32 v68, v68, v69, vcc
    v_mov_b32 v73, 0
    s_lshl_b32 s36, s20, 8
    s_add_u32 s37, s36, 0x192000
    buffer_store_dword v73, v68, s[8:11], s37 offen sc1
    s_mul_i32 s36, s20, 0x104200
    s_add_u32 s36, s36, 0x1082000
    s_add_u32 s37, s36, 0x82100
    buffer_store_dword v73, v68, s[8:11], s36 offen sc1
    buffer_store_dword v73, v68, s[8:11], s37 offen sc1
    v_mov_b32 v71, 0x80000
    v_bfe_u32 v14, v0, 0, 1
    s_mov_b32 s38, 0x8
    v_mad_u32_u24 v71, v14, s38, v71
    v_bfe_u32 v14, v0, 1, 1
    s_mov_b32 s38, 0x20
    v_mad_u32_u24 v71, v14, s38, v71
    v_bfe_u32 v14, v0, 4, 1
    s_mov_b32 s38, 0x10
    v_mad_u32_u24 v71, v14, s38, v71
    v_bfe_u32 v14, v0, 5, 1
    s_mov_b32 s38, 0x4
    v_mad_u32_u24 v71, v14, s38, v71
    v_bfe_u32 v14, v0, 6, 1
    s_mov_b32 s38, 0x800
    v_mad_u32_u24 v71, v14, s38, v71
    v_bfe_u32 v14, v0, 7, 1
    s_mov_b32 s38, 0x1000
    v_mad_u32_u24 v71, v14, s38, v71
    v_mov_b32 v69, s20
    v_mov_b32 v68, 0x0
    v_bfe_u32 v14, v69, 0, 1
    s_mov_b32 s38, 0x100
    v_mad_u32_u24 v68, v14, s38, v68
    v_bfe_u32 v14, v69, 1, 1
    s_mov_b32 s38, 0x40
    v_mad_u32_u24 v68, v14, s38, v68
    v_bfe_u32 v14, v69, 2, 1
    s_mov_b32 s38, 0x80
    v_mad_u32_u24 v68, v14, s38, v68
    v_bfe_u32 v14, v69, 3, 1
    s_mov_b32 s38, 0x200
    v_mad_u32_u24 v68, v14, s38, v68
    v_bfe_u32 v14, v69, 4, 1
    s_mov_b32 s38, 0x400
    v_mad_u32_u24 v68, v14, s38, v68
    v_add_u32 v71, v68, v71
    v_and_b32 v68, 12, v0
    v_cmp_ne_u32 vcc, 0, v68
    v_mov_b32 v68, 0x40000000
    s_nop 0
    v_cndmask_b32 v71, v71, v68, vcc
    s_waitcnt vmcnt(16)
    s_mov_b32 s36, 0x1000000
    buffer_store_dword v72, v71, s[8:11], s36 offen sc1
L_XN:
    v_mov_b32 v88, 0
    v_mov_b32 v89, 0
    v_dot2_f32_bf16 v88, v96, s4, v88
    v_dot2_f32_bf16 v89, v96, v96, v89
    v_dot2_f32_bf16 v88, v97, s4, v88
    v_dot2_f32_bf16 v89, v97, v97, v89
    v_dot2_f32_bf16 v88, v98, s4, v88
    v_dot2_f32_bf16 v89, v98, v98, v89
    v_dot2_f32_bf16 v88, v99, s4, v88
    v_dot2_f32_bf16 v89, v99, v99, v89
    v_dot2_f32_bf16 v88, v100, s4, v88
    v_dot2_f32_bf16 v89, v100, v100, v89
    v_dot2_f32_bf16 v88, v101, s4, v88
    v_dot2_f32_bf16 v89, v101, v101, v89
    v_dot2_f32_bf16 v88, v102, s4, v88
    v_dot2_f32_bf16 v89, v102, v102, v89
    v_dot2_f32_bf16 v88, v103, s4, v88
    v_dot2_f32_bf16 v89, v103, v103, v89
    v_dot2_f32_bf16 v88, v104, s4, v88
    v_dot2_f32_bf16 v89, v104, v104, v89
    v_dot2_f32_bf16 v88, v105, s4, v88
    v_dot2_f32_bf16 v89, v105, v105, v89
    v_dot2_f32_bf16 v88, v106, s4, v88
    v_dot2_f32_bf16 v89, v106, v106, v89
    v_dot2_f32_bf16 v88, v107, s4, v88
    v_dot2_f32_bf16 v89, v107, v107, v89
    v_dot2_f32_bf16 v88, v108, s4, v88
    v_dot2_f32_bf16 v89, v108, v108, v89
    v_dot2_f32_bf16 v88, v109, s4, v88
    v_dot2_f32_bf16 v89, v109, v109, v89
    v_dot2_f32_bf16 v88, v110, s4, v88
    v_dot2_f32_bf16 v89, v110, v110, v89
    v_dot2_f32_bf16 v88, v111, s4, v88
    v_dot2_f32_bf16 v89, v111, v111, v89
    v_dot2_f32_bf16 v88, v112, s4, v88
    v_dot2_f32_bf16 v89, v112, v112, v89
    v_dot2_f32_bf16 v88, v113, s4, v88
    v_dot2_f32_bf16 v89, v113, v113, v89
    v_dot2_f32_bf16 v88, v114, s4, v88
    v_dot2_f32_bf16 v89, v114, v114, v89
    v_dot2_f32_bf16 v88, v115, s4, v88
    v_dot2_f32_bf16 v89, v115, v115, v89
    v_dot2_f32_bf16 v88, v116, s4, v88
    v_dot2_f32_bf16 v89, v116, v116, v89
    v_dot2_f32_bf16 v88, v117, s4, v88
    v_dot2_f32_bf16 v89, v117, v117, v89
    v_dot2_f32_bf16 v88, v118, s4, v88
    v_dot2_f32_bf16 v89, v118, v118, v89
    v_dot2_f32_bf16 v88, v119, s4, v88
    v_dot2_f32_bf16 v89, v119, v119, v89
    v_dot2_f32_bf16 v88, v120, s4, v88
    v_dot2_f32_bf16 v89, v120, v120, v89
    v_dot2_f32_bf16 v88, v121, s4, v88
    v_dot2_f32_bf16 v89, v121, v121, v89
    v_dot2_f32_bf16 v88, v122, s4, v88
    v_dot2_f32_bf16 v89, v122, v122, v89
    v_dot2_f32_bf16 v88, v123, s4, v88
    v_dot2_f32_bf16 v89, v123, v123, v89
    v_dot2_f32_bf16 v88, v124, s4, v88
    v_dot2_f32_bf16 v89, v124, v124, v89
    v_dot2_f32_bf16 v88, v125, s4, v88
    v_dot2_f32_bf16 v89, v125, v125, v89
    v_dot2_f32_bf16 v88, v126, s4, v88
    v_dot2_f32_bf16 v89, v126, v126, v89
    v_dot2_f32_bf16 v88, v127, s4, v88
    v_dot2_f32_bf16 v89, v127, v127, v89
    s_nop 3
    v_add_f32_dpp v88, v88, v88 quad_perm:[1,0,3,2] row_mask:0xf bank_mask:0xf
    v_add_f32_dpp v89, v89, v89 quad_perm:[1,0,3,2] row_mask:0xf bank_mask:0xf
    s_nop 0
    v_add_f32_dpp v88, v88, v88 quad_perm:[2,3,0,1] row_mask:0xf bank_mask:0xf
    v_add_f32_dpp v89, v89, v89 quad_perm:[2,3,0,1] row_mask:0xf bank_mask:0xf
    s_nop 0
    v_add_f32_dpp v88, v88, v88 row_half_mirror row_mask:0xf bank_mask:0xf
    v_add_f32_dpp v89, v89, v89 row_half_mirror row_mask:0xf bank_mask:0xf
    v_mul_f32 v88, 0x3b000000, v88
    v_mul_f32 v89, 0x3b000000, v89
    v_fma_f32 v89, -v88, v88, v89
    v_max_f32 v89, 0, v89
    v_cvt_pk_bf16_f32 v14, v88, v89
    v_lshlrev_b32 v88, 16, v14
    v_and_b32 v89, 0xffff0000, v14
    v_add_f32 v89, 0x3727c5ac, v89
    v_cvt_pk_bf16_f32 v14, v89, v89
    v_lshlrev_b32 v89, 16, v14
    v_sqrt_f32 v89, v89
    s_nop 0
    v_cvt_pk_bf16_f32 v14, v89, v89
    v_lshlrev_b32 v89, 16, v14
    v_rcp_f32 v89, v89
    v_lshlrev_b32 v90, 16, v96
    v_and_b32 v91, 0xffff0000, v96
    v_sub_f32 v90, v90, v88
    v_sub_f32 v91, v91, v88
    v_cvt_pk_bf16_f32 v96, v90, v91
    v_lshlrev_b32 v90, 16, v96
    v_and_b32 v91, 0xffff0000, v96
    v_mul_f32 v90, v90, v89
    v_mul_f32 v91, v91, v89
    v_cvt_pk_bf16_f32 v96, v90, v91
    v_lshlrev_b32 v90, 16, v97
    v_and_b32 v91, 0xffff0000, v97
    v_sub_f32 v90, v90, v88
    v_sub_f32 v91, v91, v88
    v_cvt_pk_bf16_f32 v97, v90, v91
    v_lshlrev_b32 v90, 16, v97
    v_and_b32 v91, 0xffff0000, v97
    v_mul_f32 v90, v90, v89
    v_mul_f32 v91, v91, v89
    v_cvt_pk_bf16_f32 v97, v90, v91
    v_lshlrev_b32 v90, 16, v98
    v_and_b32 v91, 0xffff0000, v98
    v_sub_f32 v90, v90, v88
    v_sub_f32 v91, v91, v88
    v_cvt_pk_bf16_f32 v98, v90, v91
    v_lshlrev_b32 v90, 16, v98
    v_and_b32 v91, 0xffff0000, v98
    v_mul_f32 v90, v90, v89
    v_mul_f32 v91, v91, v89
    v_cvt_pk_bf16_f32 v98, v90, v91
    v_lshlrev_b32 v90, 16, v99
    v_and_b32 v91, 0xffff0000, v99
    v_sub_f32 v90, v90, v88
    v_sub_f32 v91, v91, v88
    v_cvt_pk_bf16_f32 v99, v90, v91
    v_lshlrev_b32 v90, 16, v99
    v_and_b32 v91, 0xffff0000, v99
    v_mul_f32 v90, v90, v89
    v_mul_f32 v91, v91, v89
    v_cvt_pk_bf16_f32 v99, v90, v91
    ds_write_b128 v4, v[96:99] offset:0
    v_lshlrev_b32 v90, 16, v100
    v_and_b32 v91, 0xffff0000, v100
    v_sub_f32 v90, v90, v88
    v_sub_f32 v91, v91, v88
    v_cvt_pk_bf16_f32 v100, v90, v91
    v_lshlrev_b32 v90, 16, v100
    v_and_b32 v91, 0xffff0000, v100
    v_mul_f32 v90, v90, v89
    v_mul_f32 v91, v91, v89
    v_cvt_pk_bf16_f32 v100, v90, v91
    v_lshlrev_b32 v90, 16, v101
    v_and_b32 v91, 0xffff0000, v101
    v_sub_f32 v90, v90, v88
    v_sub_f32 v91, v91, v88
    v_cvt_pk_bf16_f32 v101, v90, v91
    v_lshlrev_b32 v90, 16, v101
    v_and_b32 v91, 0xffff0000, v101
    v_mul_f32 v90, v90, v89
    v_mul_f32 v91, v91, v89
    v_cvt_pk_bf16_f32 v101, v90, v91
    v_lshlrev_b32 v90, 16, v102
    v_and_b32 v91, 0xffff0000, v102
    v_sub_f32 v90, v90, v88
    v_sub_f32 v91, v91, v88
    v_cvt_pk_bf16_f32 v102, v90, v91
    v_lshlrev_b32 v90, 16, v102
    v_and_b32 v91, 0xffff0000, v102
    v_mul_f32 v90, v90, v89
    v_mul_f32 v91, v91, v89
    v_cvt_pk_bf16_f32 v102, v90, v91
    v_lshlrev_b32 v90, 16, v103
    v_and_b32 v91, 0xffff0000, v103
    v_sub_f32 v90, v90, v88
    v_sub_f32 v91, v91, v88
    v_cvt_pk_bf16_f32 v103, v90, v91
    v_lshlrev_b32 v90, 16, v103
    v_and_b32 v91, 0xffff0000, v103
    v_mul_f32 v90, v90, v89
    v_mul_f32 v91, v91, v89
    v_cvt_pk_bf16_f32 v103, v90, v91
    ds_write_b128 v4, v[100:103] offset:2048
    v_lshlrev_b32 v90, 16, v104
    v_and_b32 v91, 0xffff0000, v104
    v_sub_f32 v90, v90, v88
    v_sub_f32 v91, v91, v88
    v_cvt_pk_bf16_f32 v104, v90, v91
    v_lshlrev_b32 v90, 16, v104
    v_and_b32 v91, 0xffff0000, v104
    v_mul_f32 v90, v90, v89
    v_mul_f32 v91, v91, v89
    v_cvt_pk_bf16_f32 v104, v90, v91
    v_lshlrev_b32 v90, 16, v105
    v_and_b32 v91, 0xffff0000, v105
    v_sub_f32 v90, v90, v88
    v_sub_f32 v91, v91, v88
    v_cvt_pk_bf16_f32 v105, v90, v91
    v_lshlrev_b32 v90, 16, v105
    v_and_b32 v91, 0xffff0000, v105
    v_mul_f32 v90, v90, v89
    v_mul_f32 v91, v91, v89
    v_cvt_pk_bf16_f32 v105, v90, v91
    v_lshlrev_b32 v90, 16, v106
    v_and_b32 v91, 0xffff0000, v106
    v_sub_f32 v90, v90, v88
    v_sub_f32 v91, v91, v88
    v_cvt_pk_bf16_f32 v106, v90, v91
    v_lshlrev_b32 v90, 16, v106
    v_and_b32 v91, 0xffff0000, v106
    v_mul_f32 v90, v90, v89
    v_mul_f32 v91, v91, v89
    v_cvt_pk_bf16_f32 v106, v90, v91
    v_lshlrev_b32 v90, 16, v107
    v_and_b32 v91, 0xffff0000, v107
    v_sub_f32 v90, v90, v88
    v_sub_f32 v91, v91, v88
    v_cvt_pk_bf16_f32 v107, v90, v91
    v_lshlrev_b32 v90, 16, v107
    v_and_b32 v91, 0xffff0000, v107
    v_mul_f32 v90, v90, v89
    v_mul_f32 v91, v91, v89
    v_cvt_pk_bf16_f32 v107, v90, v91
    ds_write_b128 v4, v[104:107] offset:4096
    v_lshlrev_b32 v90, 16, v108
    v_and_b32 v91, 0xffff0000, v108
    v_sub_f32 v90, v90, v88
    v_sub_f32 v91, v91, v88
    v_cvt_pk_bf16_f32 v108, v90, v91
    v_lshlrev_b32 v90, 16, v108
    v_and_b32 v91, 0xffff0000, v108
    v_mul_f32 v90, v90, v89
    v_mul_f32 v91, v91, v89
    v_cvt_pk_bf16_f32 v108, v90, v91
    v_lshlrev_b32 v90, 16, v109
    v_and_b32 v91, 0xffff0000, v109
    v_sub_f32 v90, v90, v88
    v_sub_f32 v91, v91, v88
    v_cvt_pk_bf16_f32 v109, v90, v91
    v_lshlrev_b32 v90, 16, v109
    v_and_b32 v91, 0xffff0000, v109
    v_mul_f32 v90, v90, v89
    v_mul_f32 v91, v91, v89
    v_cvt_pk_bf16_f32 v109, v90, v91
    v_lshlrev_b32 v90, 16, v110
    v_and_b32 v91, 0xffff0000, v110
    v_sub_f32 v90, v90, v88
    v_sub_f32 v91, v91, v88
    v_cvt_pk_bf16_f32 v110, v90, v91
    v_lshlrev_b32 v90, 16, v110
    v_and_b32 v91, 0xffff0000, v110
    v_mul_f32 v90, v90, v89
    v_mul_f32 v91, v91, v89
    v_cvt_pk_bf16_f32 v110, v90, v91
    v_lshlrev_b32 v90, 16, v111
    v_and_b32 v91, 0xffff0000, v111
    v_sub_f32 v90, v90, v88
    v_sub_f32 v91, v91, v88
    v_cvt_pk_bf16_f32 v111, v90, v91
    v_lshlrev_b32 v90, 16, v111
    v_and_b32 v91, 0xffff0000, v111
    v_mul_f32 v90, v90, v89
    v_mul_f32 v91, v91, v89
    v_cvt_pk_bf16_f32 v111, v90, v91
    ds_write_b128 v4, v[108:111] offset:6144
    v_lshlrev_b32 v90, 16, v112
    v_and_b32 v91, 0xffff0000, v112
    v_sub_f32 v90, v90, v88
    v_sub_f32 v91, v91, v88
    v_cvt_pk_bf16_f32 v112, v90, v91
    v_lshlrev_b32 v90, 16, v112
    v_and_b32 v91, 0xffff0000, v112
    v_mul_f32 v90, v90, v89
    v_mul_f32 v91, v91, v89
    v_cvt_pk_bf16_f32 v112, v90, v91
    v_lshlrev_b32 v90, 16, v113
    v_and_b32 v91, 0xffff0000, v113
    v_sub_f32 v90, v90, v88
    v_sub_f32 v91, v91, v88
    v_cvt_pk_bf16_f32 v113, v90, v91
    v_lshlrev_b32 v90, 16, v113
    v_and_b32 v91, 0xffff0000, v113
    v_mul_f32 v90, v90, v89
    v_mul_f32 v91, v91, v89
    v_cvt_pk_bf16_f32 v113, v90, v91
    v_lshlrev_b32 v90, 16, v114
    v_and_b32 v91, 0xffff0000, v114
    v_sub_f32 v90, v90, v88
    v_sub_f32 v91, v91, v88
    v_cvt_pk_bf16_f32 v114, v90, v91
    v_lshlrev_b32 v90, 16, v114
    v_and_b32 v91, 0xffff0000, v114
    v_mul_f32 v90, v90, v89
    v_mul_f32 v91, v91, v89
    v_cvt_pk_bf16_f32 v114, v90, v91
    v_lshlrev_b32 v90, 16, v115
    v_and_b32 v91, 0xffff0000, v115
    v_sub_f32 v90, v90, v88
    v_sub_f32 v91, v91, v88
    v_cvt_pk_bf16_f32 v115, v90, v91
    v_lshlrev_b32 v90, 16, v115
    v_and_b32 v91, 0xffff0000, v115
    v_mul_f32 v90, v90, v89
    v_mul_f32 v91, v91, v89
    v_cvt_pk_bf16_f32 v115, v90, v91
    ds_write_b128 v4, v[112:115] offset:8192
    v_lshlrev_b32 v90, 16, v116
    v_and_b32 v91, 0xffff0000, v116
    v_sub_f32 v90, v90, v88
    v_sub_f32 v91, v91, v88
    v_cvt_pk_bf16_f32 v116, v90, v91
    v_lshlrev_b32 v90, 16, v116
    v_and_b32 v91, 0xffff0000, v116
    v_mul_f32 v90, v90, v89
    v_mul_f32 v91, v91, v89
    v_cvt_pk_bf16_f32 v116, v90, v91
    v_lshlrev_b32 v90, 16, v117
    v_and_b32 v91, 0xffff0000, v117
    v_sub_f32 v90, v90, v88
    v_sub_f32 v91, v91, v88
    v_cvt_pk_bf16_f32 v117, v90, v91
    v_lshlrev_b32 v90, 16, v117
    v_and_b32 v91, 0xffff0000, v117
    v_mul_f32 v90, v90, v89
    v_mul_f32 v91, v91, v89
    v_cvt_pk_bf16_f32 v117, v90, v91
    v_lshlrev_b32 v90, 16, v118
    v_and_b32 v91, 0xffff0000, v118
    v_sub_f32 v90, v90, v88
    v_sub_f32 v91, v91, v88
    v_cvt_pk_bf16_f32 v118, v90, v91
    v_lshlrev_b32 v90, 16, v118
    v_and_b32 v91, 0xffff0000, v118
    v_mul_f32 v90, v90, v89
    v_mul_f32 v91, v91, v89
    v_cvt_pk_bf16_f32 v118, v90, v91
    v_lshlrev_b32 v90, 16, v119
    v_and_b32 v91, 0xffff0000, v119
    v_sub_f32 v90, v90, v88
    v_sub_f32 v91, v91, v88
    v_cvt_pk_bf16_f32 v119, v90, v91
    v_lshlrev_b32 v90, 16, v119
    v_and_b32 v91, 0xffff0000, v119
    v_mul_f32 v90, v90, v89
    v_mul_f32 v91, v91, v89
    v_cvt_pk_bf16_f32 v119, v90, v91
    ds_write_b128 v4, v[116:119] offset:10240
    v_lshlrev_b32 v90, 16, v120
    v_and_b32 v91, 0xffff0000, v120
    v_sub_f32 v90, v90, v88
    v_sub_f32 v91, v91, v88
    v_cvt_pk_bf16_f32 v120, v90, v91
    v_lshlrev_b32 v90, 16, v120
    v_and_b32 v91, 0xffff0000, v120
    v_mul_f32 v90, v90, v89
    v_mul_f32 v91, v91, v89
    v_cvt_pk_bf16_f32 v120, v90, v91
    v_lshlrev_b32 v90, 16, v121
    v_and_b32 v91, 0xffff0000, v121
    v_sub_f32 v90, v90, v88
    v_sub_f32 v91, v91, v88
    v_cvt_pk_bf16_f32 v121, v90, v91
    v_lshlrev_b32 v90, 16, v121
    v_and_b32 v91, 0xffff0000, v121
    v_mul_f32 v90, v90, v89
    v_mul_f32 v91, v91, v89
    v_cvt_pk_bf16_f32 v121, v90, v91
    v_lshlrev_b32 v90, 16, v122
    v_and_b32 v91, 0xffff0000, v122
    v_sub_f32 v90, v90, v88
    v_sub_f32 v91, v91, v88
    v_cvt_pk_bf16_f32 v122, v90, v91
    v_lshlrev_b32 v90, 16, v122
    v_and_b32 v91, 0xffff0000, v122
    v_mul_f32 v90, v90, v89
    v_mul_f32 v91, v91, v89
    v_cvt_pk_bf16_f32 v122, v90, v91
    v_lshlrev_b32 v90, 16, v123
    v_and_b32 v91, 0xffff0000, v123
    v_sub_f32 v90, v90, v88
    v_sub_f32 v91, v91, v88
    v_cvt_pk_bf16_f32 v123, v90, v91
    v_lshlrev_b32 v90, 16, v123
    v_and_b32 v91, 0xffff0000, v123
    v_mul_f32 v90, v90, v89
    v_mul_f32 v91, v91, v89
    v_cvt_pk_bf16_f32 v123, v90, v91
    ds_write_b128 v4, v[120:123] offset:12288
    v_lshlrev_b32 v90, 16, v124
    v_and_b32 v91, 0xffff0000, v124
    v_sub_f32 v90, v90, v88
    v_sub_f32 v91, v91, v88
    v_cvt_pk_bf16_f32 v124, v90, v91
    v_lshlrev_b32 v90, 16, v124
    v_and_b32 v91, 0xffff0000, v124
    v_mul_f32 v90, v90, v89
    v_mul_f32 v91, v91, v89
    v_cvt_pk_bf16_f32 v124, v90, v91
    v_lshlrev_b32 v90, 16, v125
    v_and_b32 v91, 0xffff0000, v125
    v_sub_f32 v90, v90, v88
    v_sub_f32 v91, v91, v88
    v_cvt_pk_bf16_f32 v125, v90, v91
    v_lshlrev_b32 v90, 16, v125
    v_and_b32 v91, 0xffff0000, v125
    v_mul_f32 v90, v90, v89
    v_mul_f32 v91, v91, v89
    v_cvt_pk_bf16_f32 v125, v90, v91
    v_lshlrev_b32 v90, 16, v126
    v_and_b32 v91, 0xffff0000, v126
    v_sub_f32 v90, v90, v88
    v_sub_f32 v91, v91, v88
    v_cvt_pk_bf16_f32 v126, v90, v91
    v_lshlrev_b32 v90, 16, v126
    v_and_b32 v91, 0xffff0000, v126
    v_mul_f32 v90, v90, v89
    v_mul_f32 v91, v91, v89
    v_cvt_pk_bf16_f32 v126, v90, v91
    v_lshlrev_b32 v90, 16, v127
    v_and_b32 v91, 0xffff0000, v127
    v_sub_f32 v90, v90, v88
    v_sub_f32 v91, v91, v88
    v_cvt_pk_bf16_f32 v127, v90, v91
    v_lshlrev_b32 v90, 16, v127
    v_and_b32 v91, 0xffff0000, v127
    v_mul_f32 v90, v90, v89
    v_mul_f32 v91, v91, v89
    v_cvt_pk_bf16_f32 v127, v90, v91
    ds_write_b128 v4, v[124:127] offset:14336
    s_waitcnt lgkmcnt(0)
    s_barrier
    s_lshl_b32 s24, s23, 15
    s_add_u32 s24, s24, 0x800000
    ds_read_b128 v[24:27], v9 offset:0
    ds_read_b128 v[28:31], v9 offset:4096
    ds_read_b128 v[32:35], v9 offset:8192
    ds_read_b128 v[36:39], v9 offset:12288
    ds_read_b128 v[40:43], v9 offset:16384
    ds_read_b128 v[44:47], v9 offset:20480
    ds_read_b128 v[48:51], v9 offset:24576
    ds_read_b128 v[52:55], v9 offset:28672
    s_waitcnt lgkmcnt(7)
    s_add_u32 s36, s24, 0
    buffer_store_dwordx4 v[24:27], v9, s[8:11], s36 offen sc1
    s_waitcnt lgkmcnt(6)
    s_add_u32 s36, s24, 4096
    buffer_store_dwordx4 v[28:31], v9, s[8:11], s36 offen sc1
    s_waitcnt lgkmcnt(5)
    s_add_u32 s36, s24, 8192
    buffer_store_dwordx4 v[32:35], v9, s[8:11], s36 offen sc1
    s_waitcnt lgkmcnt(4)
    s_add_u32 s36, s24, 12288
    buffer_store_dwordx4 v[36:39], v9, s[8:11], s36 offen sc1
    s_waitcnt lgkmcnt(3)
    s_add_u32 s36, s24, 16384
    buffer_store_dwordx4 v[40:43], v9, s[8:11], s36 offen sc1
    s_waitcnt lgkmcnt(2)
    s_add_u32 s36, s24, 20480
    buffer_store_dwordx4 v[44:47], v9, s[8:11], s36 offen sc1
    s_waitcnt lgkmcnt(1)
    s_add_u32 s36, s24, 24576
    buffer_store_dwordx4 v[48:51], v9, s[8:11], s36 offen sc1
    s_waitcnt lgkmcnt(0)
    s_add_u32 s36, s24, 28672
    buffer_store_dwordx4 v[52:55], v9, s[8:11], s36 offen sc1
    s_barrier
    v_mov_b64 v[96:97], v[128:129]
    v_mov_b64 v[98:99], v[130:131]
    v_mov_b64 v[100:101], v[132:133]
    v_mov_b64 v[102:103], v[134:135]
    v_mov_b64 v[104:105], v[136:137]
    v_mov_b64 v[106:107], v[138:139]
    v_mov_b64 v[108:109], v[140:141]
    v_mov_b64 v[110:111], v[142:143]
    v_mov_b64 v[112:113], v[144:145]
    v_mov_b64 v[114:115], v[146:147]
    v_mov_b64 v[116:117], v[148:149]
    v_mov_b64 v[118:119], v[150:151]
    v_mov_b64 v[120:121], v[152:153]
    v_mov_b64 v[122:123], v[154:155]
    v_mov_b64 v[124:125], v[156:157]
    v_mov_b64 v[126:127], v[158:159]
    s_add_u32 s23, s23, 1
    s_bitcmp1_b32 s23, 0
    s_cbranch_scc1 L_XN
    s_waitcnt vmcnt(0)
    s_barrier
    v_mov_b32 v14, 1
    s_lshl_b32 s37, s20, 2
    v_lshlrev_b32 v15, 20, v0
    buffer_store_dword v14, v15, s[16:19], s37 offen sc1
    s_lshr_b32 s20, s2, 3
    s_mov_b32 s34, 0x05040100
    s_mov_b32 s35, 0x07060302
    s_mov_b32 s32, 0
    s_mov_b32 s64, s84
    s_and_b32 s65, s85, 0xffff
    s_mov_b32 s66, 0x1c0000
    s_mov_b32 s67, 0x20000
    s_mov_b32 s68, s86
    s_and_b32 s69, s87, 0xffff
    s_mov_b32 s70, 0x1c0000
    s_mov_b32 s71, 0x20000
    s_mov_b32 s76, s88
    s_and_b32 s77, s89, 0xffff
    s_mov_b32 s78, 0x1c0000
    s_mov_b32 s79, 0x20000
    v_and_b32 v3, 31, v0
    v_lshlrev_b32 v3, 2, v3
L_M_hs:
    buffer_load_dword v5, v3, s[16:19], 0 offen sc1
    s_add_u32 s32, s32, 1
    s_cmp_gt_u32 s32, 200000
    s_waitcnt vmcnt(0)
    s_cbranch_scc1 L_M_hs_ok
    v_cmp_eq_u32 vcc, 0, v5
    s_cbranch_vccz L_M_hs_ok
    s_sleep 16
    s_branch L_M_hs
L_M_hs_ok:
    v_lshlrev_b32 v3, 4, v0
L_M00_rp:
    s_mov_b32 s36, 0x194000
    buffer_load_dwordx4 v[16:19], v3, s[8:11], s36 offen sc1
    s_add_u32 s32, s32, 1
    v_mov_b32 v5, 0
    s_waitcnt vmcnt(0)
    v_max3_u32 v5, v5, v16, v17
    v_max3_u32 v5, v5, v18, v19
    s_cmp_gt_u32 s32, 200000
    s_cbranch_scc1 L_M00_rp_ok
    v_cmp_eq_u32 vcc, -1, v5
    s_cbranch_vccz L_M00_rp_ok
    s_sleep 64
    s_branch L_M00_rp
L_M00_rp_ok:
    v_add_f32 v16, v16, v17
    v_add_f32 v18, v18, v19
    v_add_f32 v16, v16, v18
    v_cvt_pk_bf16_f32 v5, v16, v16
    v_lshlrev_b32 v16, 16, v5
    v_ashrrev_i32 v5, 31, v16
    v_or_b32 v5, 0x80000000, v5
    v_xor_b32 v5, v5, v16
    v_and_b32 v5, 0xffff0000, v5
    v_sub_u32 v6, 2047, v0
    v_or_b32 v120, v5, v6
    v_lshrrev_b32 v1, 5, v0
    v_and_b32 v2, 31, v0
    s_mov_b32 s36, 229376
    v_mul_lo_u32 v4, v1, s36
    v_lshl_add_u32 v4, v2, 2, v4
    v_mov_b32 v5, 0x40000000
    v_cmp_lt_u32 vcc, 27, v2
    s_nop 1
    v_cndmask_b32 v4, v4, v5, vcc
    s_mul_i32 s23, s20, 112
    s_add_u32 s36, s23, 0
    buffer_load_dword v16, v4, s[64:67], s36 offen
    s_add_u32 s36, s23, 3584
    buffer_load_dword v17, v4, s[64:67], s36 offen
    s_add_u32 s36, s23, 7168
    buffer_load_dword v18, v4, s[64:67], s36 offen
    s_add_u32 s36, s23, 10752
    buffer_load_dword v19, v4, s[64:67], s36 offen
    s_add_u32 s36, s23, 14336
    buffer_load_dword v20, v4, s[64:67], s36 offen
    s_add_u32 s36, s23, 17920
    buffer_load_dword v21, v4, s[64:67], s36 offen
    s_add_u32 s36, s23, 21504
    buffer_load_dword v22, v4, s[64:67], s36 offen
    s_add_u32 s36, s23, 25088
    buffer_load_dword v23, v4, s[64:67], s36 offen
    s_add_u32 s36, s23, 28672
    buffer_load_dword v24, v4, s[64:67], s36 offen
    s_add_u32 s36, s23, 32256
    buffer_load_dword v25, v4, s[64:67], s36 offen
    s_add_u32 s36, s23, 35840
    buffer_load_dword v26, v4, s[64:67], s36 offen
    s_add_u32 s36, s23, 39424
    buffer_load_dword v27, v4, s[64:67], s36 offen
    s_add_u32 s36, s23, 43008
    buffer_load_dword v28, v4, s[64:67], s36 offen
    s_add_u32 s36, s23, 46592
    buffer_load_dword v29, v4, s[64:67], s36 offen
    s_add_u32 s36, s23, 50176
    buffer_load_dword v30, v4, s[64:67], s36 offen
    s_add_u32 s36, s23, 53760
    buffer_load_dword v31, v4, s[64:67], s36 offen
    s_add_u32 s36, s23, 57344
    buffer_load_dword v32, v4, s[64:67], s36 offen
    s_add_u32 s36, s23, 60928
    buffer_load_dword v33, v4, s[64:67], s36 offen
    s_add_u32 s36, s23, 64512
    buffer_load_dword v34, v4, s[64:67], s36 offen
    s_add_u32 s36, s23, 68096
    buffer_load_dword v35, v4, s[64:67], s36 offen
    s_add_u32 s36, s23, 71680
    buffer_load_dword v36, v4, s[64:67], s36 offen
    s_add_u32 s36, s23, 75264
    buffer_load_dword v37, v4, s[64:67], s36 offen
    s_add_u32 s36, s23, 78848
    buffer_load_dword v38, v4, s[64:67], s36 offen
    s_add_u32 s36, s23, 82432
    buffer_load_dword v39, v4, s[64:67], s36 offen
    s_add_u32 s36, s23, 86016
    buffer_load_dword v40, v4, s[64:67], s36 offen
    s_add_u32 s36, s23, 89600
    buffer_load_dword v41, v4, s[64:67], s36 offen
    s_add_u32 s36, s23, 93184
    buffer_load_dword v42, v4, s[64:67], s36 offen
    s_add_u32 s36, s23, 96768
    buffer_load_dword v43, v4, s[64:67], s36 offen
    s_add_u32 s36, s23, 100352
    buffer_load_dword v44, v4, s[64:67], s36 offen
    s_add_u32 s36, s23, 103936
    buffer_load_dword v45, v4, s[64:67], s36 offen
    s_add_u32 s36, s23, 107520
    buffer_load_dword v46, v4, s[64:67], s36 offen
    s_add_u32 s36, s23, 111104
    buffer_load_dword v47, v4, s[64:67], s36 offen
    s_waitcnt vmcnt(0)
    v_perm_b32 v128, v17, v16, s34
    v_perm_b32 v129, v19, v18, s34
    v_perm_b32 v130, v21, v20, s34
    v_perm_b32 v131, v23, v22, s34
    v_perm_b32 v132, v25, v24, s34
    v_perm_b32 v133, v27, v26, s34
    v_perm_b32 v134, v29, v28, s34
    v_perm_b32 v135, v31, v30, s34
    v_perm_b32 v136, v33, v32, s34
    v_perm_b32 v137, v35, v34, s34
    v_perm_b32 v138, v37, v36, s34
    v_perm_b32 v139, v39, v38, s34
    v_perm_b32 v140, v41, v40, s34
    v_perm_b32 v141, v43, v42, s34
    v_perm_b32 v142, v45, v44, s34
    v_perm_b32 v143, v47, v46, s34
    v_perm_b32 v160, v17, v16, s35
    v_perm_b32 v161, v19, v18, s35
    v_perm_b32 v162, v21, v20, s35
    v_perm_b32 v163, v23, v22, s35
    v_perm_b32 v164, v25, v24, s35
    v_perm_b32 v165, v27, v26, s35
    v_perm_b32 v166, v29, v28, s35
    v_perm_b32 v167, v31, v30, s35
    v_perm_b32 v168, v33, v32, s35
    v_perm_b32 v169, v35, v34, s35
    v_perm_b32 v170, v37, v36, s35
    v_perm_b32 v171, v39, v38, s35
    v_perm_b32 v172, v41, v40, s35
    v_perm_b32 v173, v43, v42, s35
    v_perm_b32 v174, v45, v44, s35
    v_perm_b32 v175, v47, v46, s35
    s_add_u32 s36, s23, 114688
    buffer_load_dword v16, v4, s[64:67], s36 offen
    s_add_u32 s36, s23, 118272
    buffer_load_dword v17, v4, s[64:67], s36 offen
    s_add_u32 s36, s23, 121856
    buffer_load_dword v18, v4, s[64:67], s36 offen
    s_add_u32 s36, s23, 125440
    buffer_load_dword v19, v4, s[64:67], s36 offen
    s_add_u32 s36, s23, 129024
    buffer_load_dword v20, v4, s[64:67], s36 offen
    s_add_u32 s36, s23, 132608
    buffer_load_dword v21, v4, s[64:67], s36 offen
    s_add_u32 s36, s23, 136192
    buffer_load_dword v22, v4, s[64:67], s36 offen
    s_add_u32 s36, s23, 139776
    buffer_load_dword v23, v4, s[64:67], s36 offen
    s_add_u32 s36, s23, 143360
    buffer_load_dword v24, v4, s[64:67], s36 offen
    s_add_u32 s36, s23, 146944
    buffer_load_dword v25, v4, s[64:67], s36 offen
    s_add_u32 s36, s23, 150528
    buffer_load_dword v26, v4, s[64:67], s36 offen
    s_add_u32 s36, s23, 154112
    buffer_load_dword v27, v4, s[64:67], s36 offen
    s_add_u32 s36, s23, 157696
    buffer_load_dword v28, v4, s[64:67], s36 offen
    s_add_u32 s36, s23, 161280
    buffer_load_dword v29, v4, s[64:67], s36 offen
    s_add_u32 s36, s23, 164864
    buffer_load_dword v30, v4, s[64:67], s36 offen
    s_add_u32 s36, s23, 168448
    buffer_load_dword v31, v4, s[64:67], s36 offen
    s_add_u32 s36, s23, 172032
    buffer_load_dword v32, v4, s[64:67], s36 offen
    s_add_u32 s36, s23, 175616
    buffer_load_dword v33, v4, s[64:67], s36 offen
    s_add_u32 s36, s23, 179200
    buffer_load_dword v34, v4, s[64:67], s36 offen
    s_add_u32 s36, s23, 182784
    buffer_load_dword v35, v4, s[64:67], s36 offen
    s_add_u32 s36, s23, 186368
    buffer_load_dword v36, v4, s[64:67], s36 offen
    s_add_u32 s36, s23, 189952
    buffer_load_dword v37, v4, s[64:67], s36 offen
    s_add_u32 s36, s23, 193536
    buffer_load_dword v38, v4, s[64:67], s36 offen
    s_add_u32 s36, s23, 197120
    buffer_load_dword v39, v4, s[64:67], s36 offen
    s_add_u32 s36, s23, 200704
    buffer_load_dword v40, v4, s[64:67], s36 offen
    s_add_u32 s36, s23, 204288
    buffer_load_dword v41, v4, s[64:67], s36 offen
    s_add_u32 s36, s23, 207872
    buffer_load_dword v42, v4, s[64:67], s36 offen
    s_add_u32 s36, s23, 211456
    buffer_load_dword v43, v4, s[64:67], s36 offen
    s_add_u32 s36, s23, 215040
    buffer_load_dword v44, v4, s[64:67], s36 offen
    s_add_u32 s36, s23, 218624
    buffer_load_dword v45, v4, s[64:67], s36 offen
    s_add_u32 s36, s23, 222208
    buffer_load_dword v46, v4, s[64:67], s36 offen
    s_add_u32 s36, s23, 225792
    buffer_load_dword v47, v4, s[64:67], s36 offen
    s_waitcnt vmcnt(0)
    v_perm_b32 v144, v17, v16, s34
    v_perm_b32 v145, v19, v18, s34
    v_perm_b32 v146, v21, v20, s34
    v_perm_b32 v147, v23, v22, s34
    v_perm_b32 v148, v25, v24, s34
    v_perm_b32 v149, v27, v26, s34
    v_perm_b32 v150, v29, v28, s34
    v_perm_b32 v151, v31, v30, s34
    v_perm_b32 v152, v33, v32, s34
    v_perm_b32 v153, v35, v34, s34
    v_perm_b32 v154, v37, v36, s34
    v_perm_b32 v155, v39, v38, s34
    v_perm_b32 v156, v41, v40, s34
    v_perm_b32 v157, v43, v42, s34
    v_perm_b32 v158, v45, v44, s34
    v_perm_b32 v159, v47, v46, s34
    v_perm_b32 v176, v17, v16, s35
    v_perm_b32 v177, v19, v18, s35
    v_perm_b32 v178, v21, v20, s35
    v_perm_b32 v179, v23, v22, s35
    v_perm_b32 v180, v25, v24, s35
    v_perm_b32 v181, v27, v26, s35
    v_perm_b32 v182, v29, v28, s35
    v_perm_b32 v183, v31, v30, s35
    v_perm_b32 v184, v33, v32, s35
    v_perm_b32 v185, v35, v34, s35
    v_perm_b32 v186, v37, v36, s35
    v_perm_b32 v187, v39, v38, s35
    v_perm_b32 v188, v41, v40, s35
    v_perm_b32 v189, v43, v42, s35
    v_perm_b32 v190, v45, v44, s35
    v_perm_b32 v191, v47, v46, s35
    s_add_u32 s36, s23, 0
    buffer_load_dword v16, v4, s[68:71], s36 offen
    s_add_u32 s36, s23, 3584
    buffer_load_dword v17, v4, s[68:71], s36 offen
    s_add_u32 s36, s23, 7168
    buffer_load_dword v18, v4, s[68:71], s36 offen
    s_add_u32 s36, s23, 10752
    buffer_load_dword v19, v4, s[68:71], s36 offen
    s_add_u32 s36, s23, 14336
    buffer_load_dword v20, v4, s[68:71], s36 offen
    s_add_u32 s36, s23, 17920
    buffer_load_dword v21, v4, s[68:71], s36 offen
    s_add_u32 s36, s23, 21504
    buffer_load_dword v22, v4, s[68:71], s36 offen
    s_add_u32 s36, s23, 25088
    buffer_load_dword v23, v4, s[68:71], s36 offen
    s_add_u32 s36, s23, 28672
    buffer_load_dword v24, v4, s[68:71], s36 offen
    s_add_u32 s36, s23, 32256
    buffer_load_dword v25, v4, s[68:71], s36 offen
    s_add_u32 s36, s23, 35840
    buffer_load_dword v26, v4, s[68:71], s36 offen
    s_add_u32 s36, s23, 39424
    buffer_load_dword v27, v4, s[68:71], s36 offen
    s_add_u32 s36, s23, 43008
    buffer_load_dword v28, v4, s[68:71], s36 offen
    s_add_u32 s36, s23, 46592
    buffer_load_dword v29, v4, s[68:71], s36 offen
    s_add_u32 s36, s23, 50176
    buffer_load_dword v30, v4, s[68:71], s36 offen
    s_add_u32 s36, s23, 53760
    buffer_load_dword v31, v4, s[68:71], s36 offen
    s_add_u32 s36, s23, 57344
    buffer_load_dword v32, v4, s[68:71], s36 offen
    s_add_u32 s36, s23, 60928
    buffer_load_dword v33, v4, s[68:71], s36 offen
    s_add_u32 s36, s23, 64512
    buffer_load_dword v34, v4, s[68:71], s36 offen
    s_add_u32 s36, s23, 68096
    buffer_load_dword v35, v4, s[68:71], s36 offen
    s_add_u32 s36, s23, 71680
    buffer_load_dword v36, v4, s[68:71], s36 offen
    s_add_u32 s36, s23, 75264
    buffer_load_dword v37, v4, s[68:71], s36 offen
    s_add_u32 s36, s23, 78848
    buffer_load_dword v38, v4, s[68:71], s36 offen
    s_add_u32 s36, s23, 82432
    buffer_load_dword v39, v4, s[68:71], s36 offen
    s_add_u32 s36, s23, 86016
    buffer_load_dword v40, v4, s[68:71], s36 offen
    s_add_u32 s36, s23, 89600
    buffer_load_dword v41, v4, s[68:71], s36 offen
    s_add_u32 s36, s23, 93184
    buffer_load_dword v42, v4, s[68:71], s36 offen
    s_add_u32 s36, s23, 96768
    buffer_load_dword v43, v4, s[68:71], s36 offen
    s_add_u32 s36, s23, 100352
    buffer_load_dword v44, v4, s[68:71], s36 offen
    s_add_u32 s36, s23, 103936
    buffer_load_dword v45, v4, s[68:71], s36 offen
    s_add_u32 s36, s23, 107520
    buffer_load_dword v46, v4, s[68:71], s36 offen
    s_add_u32 s36, s23, 111104
    buffer_load_dword v47, v4, s[68:71], s36 offen
    s_waitcnt vmcnt(0)
    v_perm_b32 v192, v17, v16, s34
    v_perm_b32 v193, v19, v18, s34
    v_perm_b32 v194, v21, v20, s34
    v_perm_b32 v195, v23, v22, s34
    v_perm_b32 v196, v25, v24, s34
    v_perm_b32 v197, v27, v26, s34
    v_perm_b32 v198, v29, v28, s34
    v_perm_b32 v199, v31, v30, s34
    v_perm_b32 v200, v33, v32, s34
    v_perm_b32 v201, v35, v34, s34
    v_perm_b32 v202, v37, v36, s34
    v_perm_b32 v203, v39, v38, s34
    v_perm_b32 v204, v41, v40, s34
    v_perm_b32 v205, v43, v42, s34
    v_perm_b32 v206, v45, v44, s34
    v_perm_b32 v207, v47, v46, s34
    v_perm_b32 v224, v17, v16, s35
    v_perm_b32 v225, v19, v18, s35
    v_perm_b32 v226, v21, v20, s35
    v_perm_b32 v227, v23, v22, s35
    v_perm_b32 v228, v25, v24, s35
    v_perm_b32 v229, v27, v26, s35
    v_perm_b32 v230, v29, v28, s35
    v_perm_b32 v231, v31, v30, s35
    v_perm_b32 v232, v33, v32, s35
    v_perm_b32 v233, v35, v34, s35
    v_perm_b32 v234, v37, v36, s35
    v_perm_b32 v235, v39, v38, s35
    v_perm_b32 v236, v41, v40, s35
    v_perm_b32 v237, v43, v42, s35
    v_perm_b32 v238, v45, v44, s35
    v_perm_b32 v239, v47, v46, s35
    s_add_u32 s36, s23, 114688
    buffer_load_dword v16, v4, s[68:71], s36 offen
    s_add_u32 s36, s23, 118272
    buffer_load_dword v17, v4, s[68:71], s36 offen
    s_add_u32 s36, s23, 121856
    buffer_load_dword v18, v4, s[68:71], s36 offen
    s_add_u32 s36, s23, 125440
    buffer_load_dword v19, v4, s[68:71], s36 offen
    s_add_u32 s36, s23, 129024
    buffer_load_dword v20, v4, s[68:71], s36 offen
    s_add_u32 s36, s23, 132608
    buffer_load_dword v21, v4, s[68:71], s36 offen
    s_add_u32 s36, s23, 136192
    buffer_load_dword v22, v4, s[68:71], s36 offen
    s_add_u32 s36, s23, 139776
    buffer_load_dword v23, v4, s[68:71], s36 offen
    s_add_u32 s36, s23, 143360
    buffer_load_dword v24, v4, s[68:71], s36 offen
    s_add_u32 s36, s23, 146944
    buffer_load_dword v25, v4, s[68:71], s36 offen
    s_add_u32 s36, s23, 150528
    buffer_load_dword v26, v4, s[68:71], s36 offen
    s_add_u32 s36, s23, 154112
    buffer_load_dword v27, v4, s[68:71], s36 offen
    s_add_u32 s36, s23, 157696
    buffer_load_dword v28, v4, s[68:71], s36 offen
    s_add_u32 s36, s23, 161280
    buffer_load_dword v29, v4, s[68:71], s36 offen
    s_add_u32 s36, s23, 164864
    buffer_load_dword v30, v4, s[68:71], s36 offen
    s_add_u32 s36, s23, 168448
    buffer_load_dword v31, v4, s[68:71], s36 offen
    s_add_u32 s36, s23, 172032
    buffer_load_dword v32, v4, s[68:71], s36 offen
    s_add_u32 s36, s23, 175616
    buffer_load_dword v33, v4, s[68:71], s36 offen
    s_add_u32 s36, s23, 179200
    buffer_load_dword v34, v4, s[68:71], s36 offen
    s_add_u32 s36, s23, 182784
    buffer_load_dword v35, v4, s[68:71], s36 offen
    s_add_u32 s36, s23, 186368
    buffer_load_dword v36, v4, s[68:71], s36 offen
    s_add_u32 s36, s23, 189952
    buffer_load_dword v37, v4, s[68:71], s36 offen
    s_add_u32 s36, s23, 193536
    buffer_load_dword v38, v4, s[68:71], s36 offen
    s_add_u32 s36, s23, 197120
    buffer_load_dword v39, v4, s[68:71], s36 offen
    s_add_u32 s36, s23, 200704
    buffer_load_dword v40, v4, s[68:71], s36 offen
    s_add_u32 s36, s23, 204288
    buffer_load_dword v41, v4, s[68:71], s36 offen
    s_add_u32 s36, s23, 207872
    buffer_load_dword v42, v4, s[68:71], s36 offen
    s_add_u32 s36, s23, 211456
    buffer_load_dword v43, v4, s[68:71], s36 offen
    s_add_u32 s36, s23, 215040
    buffer_load_dword v44, v4, s[68:71], s36 offen
    s_add_u32 s36, s23, 218624
    buffer_load_dword v45, v4, s[68:71], s36 offen
    s_add_u32 s36, s23, 222208
    buffer_load_dword v46, v4, s[68:71], s36 offen
    s_add_u32 s36, s23, 225792
    buffer_load_dword v47, v4, s[68:71], s36 offen
    s_waitcnt vmcnt(0)
    v_perm_b32 v208, v17, v16, s34
    v_perm_b32 v209, v19, v18, s34
    v_perm_b32 v210, v21, v20, s34
    v_perm_b32 v211, v23, v22, s34
    v_perm_b32 v212, v25, v24, s34
    v_perm_b32 v213, v27, v26, s34
    v_perm_b32 v214, v29, v28, s34
    v_perm_b32 v215, v31, v30, s34
    v_perm_b32 v216, v33, v32, s34
    v_perm_b32 v217, v35, v34, s34
    v_perm_b32 v218, v37, v36, s34
    v_perm_b32 v219, v39, v38, s34
    v_perm_b32 v220, v41, v40, s34
    v_perm_b32 v221, v43, v42, s34
    v_perm_b32 v222, v45, v44, s34
    v_perm_b32 v223, v47, v46, s34
    v_perm_b32 v240, v17, v16, s35
    v_perm_b32 v241, v19, v18, s35
    v_perm_b32 v242, v21, v20, s35
    v_perm_b32 v243, v23, v22, s35
    v_perm_b32 v244, v25, v24, s35
    v_perm_b32 v245, v27, v26, s35
    v_perm_b32 v246, v29, v28, s35
    v_perm_b32 v247, v31, v30, s35
    v_perm_b32 v248, v33, v32, s35
    v_perm_b32 v249, v35, v34, s35
    v_perm_b32 v250, v37, v36, s35
    v_perm_b32 v251, v39, v38, s35
    v_perm_b32 v252, v41, v40, s35
    v_perm_b32 v253, v43, v42, s35
    v_perm_b32 v254, v45, v44, s35
    v_perm_b32 v255, v47, v46, s35
    v_lshrrev_b32 v3, 3, v0
    v_mul_u32_u24 v4, 57344, v3
    v_and_b32 v3, 7, v0
    v_lshl_add_u32 v4, v3, 2, v4
    s_lshl_b32 s37, s20, 5
    s_add_u32 s36, s37, 0
    buffer_load_dword v16, v4, s[76:79], s36 offen
    s_add_u32 s36, s37, 1024
    buffer_load_dword v17, v4, s[76:79], s36 offen
    s_add_u32 s36, s37, 2048
    buffer_load_dword v18, v4, s[76:79], s36 offen
    s_add_u32 s36, s37, 3072
    buffer_load_dword v19, v4, s[76:79], s36 offen
    s_add_u32 s36, s37, 4096
    buffer_load_dword v20, v4, s[76:79], s36 offen
    s_add_u32 s36, s37, 5120
    buffer_load_dword v21, v4, s[76:79], s36 offen
    s_add_u32 s36, s37, 6144
    buffer_load_dword v22, v4, s[76:79], s36 offen
    s_add_u32 s36, s37, 7168
    buffer_load_dword v23, v4, s[76:79], s36 offen
    s_add_u32 s36, s37, 8192
    buffer_load_dword v24, v4, s[76:79], s36 offen
    s_add_u32 s36, s37, 9216
    buffer_load_dword v25, v4, s[76:79], s36 offen
    s_add_u32 s36, s37, 10240
    buffer_load_dword v26, v4, s[76:79], s36 offen
    s_add_u32 s36, s37, 11264
    buffer_load_dword v27, v4, s[76:79], s36 offen
    s_add_u32 s36, s37, 12288
    buffer_load_dword v28, v4, s[76:79], s36 offen
    s_add_u32 s36, s37, 13312
    buffer_load_dword v29, v4, s[76:79], s36 offen
    s_add_u32 s36, s37, 14336
    buffer_load_dword v30, v4, s[76:79], s36 offen
    s_add_u32 s36, s37, 15360
    buffer_load_dword v31, v4, s[76:79], s36 offen
    s_add_u32 s36, s37, 16384
    buffer_load_dword v32, v4, s[76:79], s36 offen
    s_add_u32 s36, s37, 17408
    buffer_load_dword v33, v4, s[76:79], s36 offen
    s_add_u32 s36, s37, 18432
    buffer_load_dword v34, v4, s[76:79], s36 offen
    s_add_u32 s36, s37, 19456
    buffer_load_dword v35, v4, s[76:79], s36 offen
    s_add_u32 s36, s37, 20480
    buffer_load_dword v36, v4, s[76:79], s36 offen
    s_add_u32 s36, s37, 21504
    buffer_load_dword v37, v4, s[76:79], s36 offen
    s_add_u32 s36, s37, 22528
    buffer_load_dword v38, v4, s[76:79], s36 offen
    s_add_u32 s36, s37, 23552
    buffer_load_dword v39, v4, s[76:79], s36 offen
    s_add_u32 s36, s37, 24576
    buffer_load_dword v40, v4, s[76:79], s36 offen
    s_add_u32 s36, s37, 25600
    buffer_load_dword v41, v4, s[76:79], s36 offen
    s_add_u32 s36, s37, 26624
    buffer_load_dword v42, v4, s[76:79], s36 offen
    s_add_u32 s36, s37, 27648
    buffer_load_dword v43, v4, s[76:79], s36 offen
    s_waitcnt vmcnt(0)
    v_perm_b32 v64, v17, v16, s34
    v_perm_b32 v65, v19, v18, s34
    v_perm_b32 v66, v21, v20, s34
    v_perm_b32 v67, v23, v22, s34
    v_perm_b32 v68, v25, v24, s34
    v_perm_b32 v69, v27, v26, s34
    v_perm_b32 v70, v29, v28, s34
    v_perm_b32 v71, v31, v30, s34
    v_perm_b32 v72, v33, v32, s34
    v_perm_b32 v73, v35, v34, s34
    v_perm_b32 v74, v37, v36, s34
    v_perm_b32 v75, v39, v38, s34
    v_perm_b32 v76, v41, v40, s34
    v_perm_b32 v77, v43, v42, s34
    v_perm_b32 v92, v17, v16, s35
    v_perm_b32 v93, v19, v18, s35
    v_perm_b32 v94, v21, v20, s35
    v_perm_b32 v95, v23, v22, s35
    v_perm_b32 v96, v25, v24, s35
    v_perm_b32 v97, v27, v26, s35
    v_perm_b32 v98, v29, v28, s35
    v_perm_b32 v99, v31, v30, s35
    v_perm_b32 v100, v33, v32, s35
    v_perm_b32 v101, v35, v34, s35
    v_perm_b32 v102, v37, v36, s35
    v_perm_b32 v103, v39, v38, s35
    v_perm_b32 v104, v41, v40, s35
    v_perm_b32 v105, v43, v42, s35
    s_add_u32 s36, s37, 28672
    buffer_load_dword v16, v4, s[76:79], s36 offen
    s_add_u32 s36, s37, 29696
    buffer_load_dword v17, v4, s[76:79], s36 offen
    s_add_u32 s36, s37, 30720
    buffer_load_dword v18, v4, s[76:79], s36 offen
    s_add_u32 s36, s37, 31744
    buffer_load_dword v19, v4, s[76:79], s36 offen
    s_add_u32 s36, s37, 32768
    buffer_load_dword v20, v4, s[76:79], s36 offen
    s_add_u32 s36, s37, 33792
    buffer_load_dword v21, v4, s[76:79], s36 offen
    s_add_u32 s36, s37, 34816
    buffer_load_dword v22, v4, s[76:79], s36 offen
    s_add_u32 s36, s37, 35840
    buffer_load_dword v23, v4, s[76:79], s36 offen
    s_add_u32 s36, s37, 36864
    buffer_load_dword v24, v4, s[76:79], s36 offen
    s_add_u32 s36, s37, 37888
    buffer_load_dword v25, v4, s[76:79], s36 offen
    s_add_u32 s36, s37, 38912
    buffer_load_dword v26, v4, s[76:79], s36 offen
    s_add_u32 s36, s37, 39936
    buffer_load_dword v27, v4, s[76:79], s36 offen
    s_add_u32 s36, s37, 40960
    buffer_load_dword v28, v4, s[76:79], s36 offen
    s_add_u32 s36, s37, 41984
    buffer_load_dword v29, v4, s[76:79], s36 offen
    s_add_u32 s36, s37, 43008
    buffer_load_dword v30, v4, s[76:79], s36 offen
    s_add_u32 s36, s37, 44032
    buffer_load_dword v31, v4, s[76:79], s36 offen
    s_add_u32 s36, s37, 45056
    buffer_load_dword v32, v4, s[76:79], s36 offen
    s_add_u32 s36, s37, 46080
    buffer_load_dword v33, v4, s[76:79], s36 offen
    s_add_u32 s36, s37, 47104
    buffer_load_dword v34, v4, s[76:79], s36 offen
    s_add_u32 s36, s37, 48128
    buffer_load_dword v35, v4, s[76:79], s36 offen
    s_add_u32 s36, s37, 49152
    buffer_load_dword v36, v4, s[76:79], s36 offen
    s_add_u32 s36, s37, 50176
    buffer_load_dword v37, v4, s[76:79], s36 offen
    s_add_u32 s36, s37, 51200
    buffer_load_dword v38, v4, s[76:79], s36 offen
    s_add_u32 s36, s37, 52224
    buffer_load_dword v39, v4, s[76:79], s36 offen
    s_add_u32 s36, s37, 53248
    buffer_load_dword v40, v4, s[76:79], s36 offen
    s_add_u32 s36, s37, 54272
    buffer_load_dword v41, v4, s[76:79], s36 offen
    s_add_u32 s36, s37, 55296
    buffer_load_dword v42, v4, s[76:79], s36 offen
    s_add_u32 s36, s37, 56320
    buffer_load_dword v43, v4, s[76:79], s36 offen
    s_waitcnt vmcnt(0)
    v_perm_b32 v78, v17, v16, s34
    v_perm_b32 v79, v19, v18, s34
    v_perm_b32 v80, v21, v20, s34
    v_perm_b32 v81, v23, v22, s34
    v_perm_b32 v82, v25, v24, s34
    v_perm_b32 v83, v27, v26, s34
    v_perm_b32 v84, v29, v28, s34
    v_perm_b32 v85, v31, v30, s34
    v_perm_b32 v86, v33, v32, s34
    v_perm_b32 v87, v35, v34, s34
    v_perm_b32 v88, v37, v36, s34
    v_perm_b32 v89, v39, v38, s34
    v_perm_b32 v90, v41, v40, s34
    v_perm_b32 v91, v43, v42, s34
    v_perm_b32 v106, v17, v16, s35
    v_perm_b32 v107, v19, v18, s35
    v_perm_b32 v108, v21, v20, s35
    v_perm_b32 v109, v23, v22, s35
    v_perm_b32 v110, v25, v24, s35
    v_perm_b32 v111, v27, v26, s35
    v_perm_b32 v112, v29, v28, s35
    v_perm_b32 v113, v31, v30, s35
    v_perm_b32 v114, v33, v32, s35
    v_perm_b32 v115, v35, v34, s35
    v_perm_b32 v116, v37, v36, s35
    v_perm_b32 v117, v39, v38, s35
    v_perm_b32 v118, v41, v40, s35
    v_perm_b32 v119, v43, v42, s35
    s_mov_b32 s42, 0xffff0000
    s_mov_b32 s24, 0
    s_mov_b64 s[28:29], 0
    v_mov_b32 v12, 0x40000000
    v_mov_b32 v13, 0
    v_lshlrev_b32 v3, 4, v0
L_M06_rp:
    s_mov_b32 s36, 0x19a000
    buffer_load_dwordx4 v[40:43], v3, s[8:11], s36 offen sc1
    s_add_u32 s32, s32, 1
    v_mov_b32 v5, 0
    s_waitcnt vmcnt(0)
    v_max3_u32 v5, v5, v40, v41
    v_max3_u32 v5, v5, v42, v43
    s_cmp_gt_u32 s32, 200000
    s_cbranch_scc1 L_M06_rp_ok
    v_cmp_eq_u32 vcc, -1, v5
    s_cbranch_vccz L_M06_rp_ok
    s_sleep 32
    s_branch L_M06_rp
L_M06_rp_ok:
    v_add_f32 v40, v40, v41
    v_add_f32 v42, v42, v43
    v_add_f32 v40, v40, v42
    v_cvt_pk_bf16_f32 v5, v40, v40
    v_lshlrev_b32 v40, 16, v5
    v_ashrrev_i32 v5, 31, v40
    v_or_b32 v5, 0x80000000, v5
    v_xor_b32 v5, v5, v40
    v_and_b32 v5, 0xffff0000, v5
    v_sub_u32 v6, 511, v0
    v_or_b32 v126, v5, v6
    v_lshlrev_b32 v3, 4, v0
L_M01_rp:
    s_mov_b32 s36, 0x195000
    buffer_load_dwordx4 v[20:23], v3, s[8:11], s36 offen sc1
    s_mov_b32 s36, 0x196000
    buffer_load_dwordx4 v[24:27], v3, s[8:11], s36 offen sc1
    s_mov_b32 s36, 0x197000
    buffer_load_dwordx4 v[28:31], v3, s[8:11], s36 offen sc1
    s_mov_b32 s36, 0x198000
    buffer_load_dwordx4 v[32:35], v3, s[8:11], s36 offen sc1
    s_mov_b32 s36, 0x199000
    buffer_load_dwordx4 v[36:39], v3, s[8:11], s36 offen sc1
    s_add_u32 s32, s32, 1
    v_mov_b32 v5, 0
    s_waitcnt vmcnt(0)
    v_max3_u32 v5, v5, v20, v21
    v_max3_u32 v5, v5, v22, v23
    v_max3_u32 v5, v5, v24, v25
    v_max3_u32 v5, v5, v26, v27
    v_max3_u32 v5, v5, v28, v29
    v_max3_u32 v5, v5, v30, v31
    v_max3_u32 v5, v5, v32, v33
    v_max3_u32 v5, v5, v34, v35
    v_max3_u32 v5, v5, v36, v37
    v_max3_u32 v5, v5, v38, v39
    s_cmp_gt_u32 s32, 200000
    s_cbranch_scc1 L_M01_rp_ok
    v_cmp_eq_u32 vcc, -1, v5
    s_cbranch_vccz L_M01_rp_ok
    s_sleep 8
    s_branch L_M01_rp
L_M01_rp_ok:
    v_add_f32 v20, v20, v21
    v_add_f32 v22, v22, v23
    v_add_f32 v20, v20, v22
    v_cvt_pk_bf16_f32 v5, v20, v20
    v_lshlrev_b32 v20, 16, v5
    v_ashrrev_i32 v5, 31, v20
    v_or_b32 v5, 0x80000000, v5
    v_xor_b32 v5, v5, v20
    v_and_b32 v5, 0xffff0000, v5
    v_sub_u32 v6, 1791, v0
    v_or_b32 v121, v5, v6
    v_add_f32 v24, v24, v25
    v_add_f32 v26, v26, v27
    v_add_f32 v24, v24, v26
    v_cvt_pk_bf16_f32 v5, v24, v24
    v_lshlrev_b32 v24, 16, v5
    v_ashrrev_i32 v5, 31, v24
    v_or_b32 v5, 0x80000000, v5
    v_xor_b32 v5, v5, v24
    v_and_b32 v5, 0xffff0000, v5
    v_sub_u32 v6, 1535, v0
    v_or_b32 v122, v5, v6
    v_add_f32 v28, v28, v29
    v_add_f32 v30, v30, v31
    v_add_f32 v28, v28, v30
    v_cvt_pk_bf16_f32 v5, v28, v28
    v_lshlrev_b32 v28, 16, v5
    v_ashrrev_i32 v5, 31, v28
    v_or_b32 v5, 0x80000000, v5
    v_xor_b32 v5, v5, v28
    v_and_b32 v5, 0xffff0000, v5
    v_sub_u32 v6, 1279, v0
    v_or_b32 v123, v5, v6
    v_add_f32 v32, v32, v33
    v_add_f32 v34, v34, v35
    v_add_f32 v32, v32, v34
    v_cvt_pk_bf16_f32 v5, v32, v32
    v_lshlrev_b32 v32, 16, v5
    v_ashrrev_i32 v5, 31, v32
    v_or_b32 v5, 0x80000000, v5
    v_xor_b32 v5, v5, v32
    v_and_b32 v5, 0xffff0000, v5
    v_sub_u32 v6, 1023, v0
    v_or_b32 v124, v5, v6
    v_add_f32 v36, v36, v37
    v_add_f32 v38, v38, v39
    v_add_f32 v36, v36, v38
    v_cvt_pk_bf16_f32 v5, v36, v36
    v_lshlrev_b32 v36, 16, v5
    v_ashrrev_i32 v5, 31, v36
    v_or_b32 v5, 0x80000000, v5
    v_xor_b32 v5, v5, v36
    v_and_b32 v5, 0xffff0000, v5
    v_sub_u32 v6, 767, v0
    v_or_b32 v125, v5, v6
    v_max_u32 v5, v120, v121
    v_min_u32 v6, v120, v121
    v_med3_u32 v6, v5, v6, v122
    v_max_u32 v5, v5, v122
    v_med3_u32 v6, v5, v6, v123
    v_max_u32 v5, v5, v123
    v_med3_u32 v6, v5, v6, v124
    v_max_u32 v5, v5, v124
    v_med3_u32 v6, v5, v6, v125
    v_max_u32 v5, v5, v125
    v_med3_u32 v6, v5, v6, v126
    v_max_u32 v5, v5, v126
    v_mov_b32 v120, v5
    v_mov_b32 v121, v6
    s_mov_b32 s25, 32
L_M_round:
    v_lshlrev_b32 v3, 4, v0
    v_cmp_gt_u32 s[74:75], s25, v0
L_M7_rp:
    s_mov_b32 s36, 0x19b000
    buffer_load_dwordx4 v[44:47], v3, s[8:11], s36 offen sc1
    s_add_u32 s32, s32, 1
    v_mov_b32 v5, 0
    s_waitcnt vmcnt(0)
    v_max3_u32 v5, v5, v44, v45
    v_max3_u32 v5, v5, v46, v47
    v_cndmask_b32 v5, 0, v5, s[74:75]
    s_cmp_gt_u32 s32, 200000
    s_cbranch_scc1 L_M7_rp_ok
    v_cmp_eq_u32 vcc, -1, v5
    s_cbranch_vccnz L_M7_rp
L_M7_rp_ok:
    v_add_f32 v44, v44, v45
    v_add_f32 v46, v46, v47
    v_add_f32 v44, v44, v46
    v_cvt_pk_bf16_f32 v5, v44, v44
    v_lshlrev_b32 v44, 16, v5
    v_ashrrev_i32 v5, 31, v44
    v_or_b32 v5, 0x80000000, v5
    v_xor_b32 v5, v5, v44
    v_and_b32 v5, 0xffff0000, v5
    v_sub_u32 v6, 255, v0
    v_or_b32 v127, v5, v6
    v_cndmask_b32 v127, 0, v127, s[74:75]
    v_max_u32 v5, v120, v127
    v_med3_u32 v6, v120, v121, v127
    s_nop 0
    v_mov_b32_dpp v7, v5 quad_perm:[1,0,3,2] row_mask:0xf bank_mask:0xf
    v_mov_b32_dpp v8, v6 quad_perm:[1,0,3,2] row_mask:0xf bank_mask:0xf
    v_min_u32 v9, v5, v7
    v_max_u32 v5, v5, v7
    v_max3_u32 v6, v6, v8, v9
    s_nop 0
    v_mov_b32_dpp v7, v5 quad_perm:[2,3,0,1] row_mask:0xf bank_mask:0xf
    v_mov_b32_dpp v8, v6 quad_perm:[2,3,0,1] row_mask:0xf bank_mask:0xf
    v_min_u32 v9, v5, v7
    v_max_u32 v5, v5, v7
    v_max3_u32 v6, v6, v8, v9
    s_nop 0
    v_mov_b32_dpp v7, v5 row_half_mirror row_mask:0xf bank_mask:0xf
    v_mov_b32_dpp v8, v6 row_half_mirror row_mask:0xf bank_mask:0xf
    v_min_u32 v9, v5, v7
    v_max_u32 v5, v5, v7
    v_max3_u32 v6, v6, v8, v9
    s_nop 0
    v_mov_b32_dpp v7, v5 row_mirror row_mask:0xf bank_mask:0xf
    v_mov_b32_dpp v8, v6 row_mirror row_mask:0xf bank_mask:0xf
    v_min_u32 v9, v5, v7
    v_max_u32 v5, v5, v7
    v_max3_u32 v6, v6, v8, v9
    v_lshrrev_b32 v9, 4, v0
    v_lshlrev_b32 v9, 3, v9
    s_barrier
    ds_write2_b32 v9, v5, v6 offset0:0 offset1:1
    v_and_b32 v9, 15, v0
    v_lshlrev_b32 v9, 3, v9
    s_waitcnt lgkmcnt(0)
    s_barrier
    ds_read2_b32 v[10:11], v9 offset0:0 offset1:1
    s_waitcnt lgkmcnt(0)
    v_mov_b32 v5, v10
    v_mov_b32 v6, v11
    s_nop 0
    v_mov_b32_dpp v7, v5 quad_perm:[1,0,3,2] row_mask:0xf bank_mask:0xf
    v_mov_b32_dpp v8, v6 quad_perm:[1,0,3,2] row_mask:0xf bank_mask:0xf
    v_min_u32 v9, v5, v7
    v_max_u32 v5, v5, v7
    v_max3_u32 v6, v6, v8, v9
    s_nop 0
    v_mov_b32_dpp v7, v5 quad_perm:[2,3,0,1] row_mask:0xf bank_mask:0xf
    v_mov_b32_dpp v8, v6 quad_perm:[2,3,0,1] row_mask:0xf bank_mask:0xf
    v_min_u32 v9, v5, v7
    v_max_u32 v5, v5, v7
    v_max3_u32 v6, v6, v8, v9
    s_nop 0
    v_mov_b32_dpp v7, v5 row_half_mirror row_mask:0xf bank_mask:0xf
    v_mov_b32_dpp v8, v6 row_half_mirror row_mask:0xf bank_mask:0xf
    v_min_u32 v9, v5, v7
    v_max_u32 v5, v5, v7
    v_max3_u32 v6, v6, v8, v9
    s_nop 0
    v_mov_b32_dpp v7, v5 row_mirror row_mask:0xf bank_mask:0xf
    v_mov_b32_dpp v8, v6 row_mirror row_mask:0xf bank_mask:0xf
    v_min_u32 v9, v5, v7
    v_max_u32 v5, v5, v7
    v_max3_u32 v6, v6, v8, v9
    v_readfirstlane_b32 s26, v5
    v_readfirstlane_b32 s27, v6
    s_nop 3
    s_cmp_eq_u64 s[26:27], s[28:29]
    s_cbranch_scc1 L_M_next
    s_mov_b64 s[28:29], s[26:27]
    buffer_store_dword v13, v12, s[60:63], 0 offen sc1
    s_and_b32 s36, s26, 0x7ff
    s_sub_u32 s30, 2047, s36
    s_and_b32 s36, s26, 0xffff0000
    s_xor_b32 s37, s36, 0x80000000
    s_xor_b32 s40, s36, 0xffff0000
    s_bitcmp1_b32 s36, 31
    s_cselect_b32 s40, s37, s40
    s_and_b32 s36, s27, 0x7ff
    s_sub_u32 s31, 2047, s36
    s_and_b32 s36, s27, 0xffff0000
    s_xor_b32 s37, s36, 0x80000000
    s_xor_b32 s41, s36, 0xffff0000
    s_bitcmp1_b32 s36, 31
    s_cselect_b32 s41, s37, s41
    v_mov_b32 v8, 0
L_M_rows:
    s_lshl_b32 s36, s30, 4
    s_add_u32 s36, s36, 0x1b8000
    buffer_load_dwordx4 v[16:19], v8, s[8:11], s36 offen sc1
    s_lshl_b32 s36, s31, 4
    s_add_u32 s36, s36, 0x1b8000
    buffer_load_dwordx4 v[20:23], v8, s[8:11], s36 offen sc1
    s_add_u32 s32, s32, 1
    s_cmp_gt_u32 s32, 200000
    s_waitcnt vmcnt(0)
    v_or3_b32 v5, v16, v17, v18
    v_or3_b32 v5, v5, v19, v20
    v_or3_b32 v5, v5, v21, v22
    v_or_b32 v5, v5, v23
    s_cbranch_scc1 L_M_rows_ok
    v_cmp_ne_u32 vcc, 0, v5
    s_cbranch_vccnz L_M_rows
L_M_rows_ok:
    v_bfe_u32 v9, v0, 6, 1
    v_cmp_ne_u32 vcc, 0, v9
    v_mov_b32 v5, s30
    v_mov_b32 v6, s31
    v_cndmask_b32 v7, v5, v6, vcc
    v_lshlrev_b32 v7, 10, v7
    v_and_b32 v8, 63, v0
    v_lshl_add_u32 v7, v8, 4, v7
    s_mov_b32 s37, 0x600000
    buffer_load_dwordx4 v[16:19], v7, s[8:11], s37 offen sc1
    v_bfe_u32 v9, v0, 3, 1
    v_cmp_ne_u32 vcc, 0, v9
    s_nop 1
    v_cndmask_b32 v12, v5, v6, vcc
    v_mov_b32 v5, s40
    v_mov_b32 v6, s41
    v_cndmask_b32 v11, v5, v6, vcc
    v_lshlrev_b32 v12, 10, v12
    v_and_b32 v3, 7, v0
    v_lshl_add_u32 v12, v3, 2, v12
    s_lshl_b32 s36, s20, 5
    v_add_u32 v12, s36, v12
    v_mov_b32 v7, 0x40000000
    v_cmp_lt_u32 vcc, 15, v0
    s_nop 1
    v_cndmask_b32 v12, v12, v7, vcc
    s_mov_b32 s36, 0x400000
    buffer_load_dword v14, v12, s[8:11], s36 offen sc1
    buffer_load_dword v15, v12, s[8:11], s37 offen sc1
    v_and_b32 v8, 127, v0
    v_lshlrev_b32 v8, 4, v8
    s_waitcnt vmcnt(2)
    ds_write_b128 v8, v[16:19] offset:4096
    s_waitcnt lgkmcnt(0)
    s_barrier
    v_mov_b64 v[48:49], 0
    v_mov_b64 v[50:51], 0
    v_mov_b64 v[52:53], 0
    v_mov_b64 v[54:55], 0
    v_lshlrev_b32 v8, 7, v1
    ds_read_b128 v[16:19], v8 offset:4096
    ds_read_b128 v[20:23], v8 offset:4112
    ds_read_b128 v[24:27], v8 offset:4128
    ds_read_b128 v[28:31], v8 offset:4144
    ds_read_b128 v[32:35], v8 offset:5120
    ds_read_b128 v[36:39], v8 offset:5136
    ds_read_b128 v[40:43], v8 offset:5152
    ds_read_b128 v[44:47], v8 offset:5168
    s_waitcnt lgkmcnt(0)
    v_dot2_f32_bf16 v48, v16, v128, v48
    v_dot2_f32_bf16 v49, v16, v160, v49
    v_dot2_f32_bf16 v50, v32, v128, v50
    v_dot2_f32_bf16 v51, v32, v160, v51
    v_dot2_f32_bf16 v52, v16, v192, v52
    v_dot2_f32_bf16 v53, v16, v224, v53
    v_dot2_f32_bf16 v54, v32, v192, v54
    v_dot2_f32_bf16 v55, v32, v224, v55
    v_dot2_f32_bf16 v48, v17, v129, v48
    v_dot2_f32_bf16 v49, v17, v161, v49
    v_dot2_f32_bf16 v50, v33, v129, v50
    v_dot2_f32_bf16 v51, v33, v161, v51
    v_dot2_f32_bf16 v52, v17, v193, v52
    v_dot2_f32_bf16 v53, v17, v225, v53
    v_dot2_f32_bf16 v54, v33, v193, v54
    v_dot2_f32_bf16 v55, v33, v225, v55
    v_dot2_f32_bf16 v48, v18, v130, v48
    v_dot2_f32_bf16 v49, v18, v162, v49
    v_dot2_f32_bf16 v50, v34, v130, v50
    v_dot2_f32_bf16 v51, v34, v162, v51
    v_dot2_f32_bf16 v52, v18, v194, v52
    v_dot2_f32_bf16 v53, v18, v226, v53
    v_dot2_f32_bf16 v54, v34, v194, v54
    v_dot2_f32_bf16 v55, v34, v226, v55
    v_dot2_f32_bf16 v48, v19, v131, v48
    v_dot2_f32_bf16 v49, v19, v163, v49
    v_dot2_f32_bf16 v50, v35, v131, v50
    v_dot2_f32_bf16 v51, v35, v163, v51
    v_dot2_f32_bf16 v52, v19, v195, v52
    v_dot2_f32_bf16 v53, v19, v227, v53
    v_dot2_f32_bf16 v54, v35, v195, v54
    v_dot2_f32_bf16 v55, v35, v227, v55
    v_dot2_f32_bf16 v48, v20, v132, v48
    v_dot2_f32_bf16 v49, v20, v164, v49
    v_dot2_f32_bf16 v50, v36, v132, v50
    v_dot2_f32_bf16 v51, v36, v164, v51
    v_dot2_f32_bf16 v52, v20, v196, v52
    v_dot2_f32_bf16 v53, v20, v228, v53
    v_dot2_f32_bf16 v54, v36, v196, v54
    v_dot2_f32_bf16 v55, v36, v228, v55
    v_dot2_f32_bf16 v48, v21, v133, v48
    v_dot2_f32_bf16 v49, v21, v165, v49
    v_dot2_f32_bf16 v50, v37, v133, v50
    v_dot2_f32_bf16 v51, v37, v165, v51
    v_dot2_f32_bf16 v52, v21, v197, v52
    v_dot2_f32_bf16 v53, v21, v229, v53
    v_dot2_f32_bf16 v54, v37, v197, v54
    v_dot2_f32_bf16 v55, v37, v229, v55
    v_dot2_f32_bf16 v48, v22, v134, v48
    v_dot2_f32_bf16 v49, v22, v166, v49
    v_dot2_f32_bf16 v50, v38, v134, v50
    v_dot2_f32_bf16 v51, v38, v166, v51
    v_dot2_f32_bf16 v52, v22, v198, v52
    v_dot2_f32_bf16 v53, v22, v230, v53
    v_dot2_f32_bf16 v54, v38, v198, v54
    v_dot2_f32_bf16 v55, v38, v230, v55
    v_dot2_f32_bf16 v48, v23, v135, v48
    v_dot2_f32_bf16 v49, v23, v167, v49
    v_dot2_f32_bf16 v50, v39, v135, v50
    v_dot2_f32_bf16 v51, v39, v167, v51
    v_dot2_f32_bf16 v52, v23, v199, v52
    v_dot2_f32_bf16 v53, v23, v231, v53
    v_dot2_f32_bf16 v54, v39, v199, v54
    v_dot2_f32_bf16 v55, v39, v231, v55
    v_dot2_f32_bf16 v48, v24, v136, v48
    v_dot2_f32_bf16 v49, v24, v168, v49
    v_dot2_f32_bf16 v50, v40, v136, v50
    v_dot2_f32_bf16 v51, v40, v168, v51
    v_dot2_f32_bf16 v52, v24, v200, v52
    v_dot2_f32_bf16 v53, v24, v232, v53
    v_dot2_f32_bf16 v54, v40, v200, v54
    v_dot2_f32_bf16 v55, v40, v232, v55
    v_dot2_f32_bf16 v48, v25, v137, v48
    v_dot2_f32_bf16 v49, v25, v169, v49
    v_dot2_f32_bf16 v50, v41, v137, v50
    v_dot2_f32_bf16 v51, v41, v169, v51
    v_dot2_f32_bf16 v52, v25, v201, v52
    v_dot2_f32_bf16 v53, v25, v233, v53
    v_dot2_f32_bf16 v54, v41, v201, v54
    v_dot2_f32_bf16 v55, v41, v233, v55
    v_dot2_f32_bf16 v48, v26, v138, v48
    v_dot2_f32_bf16 v49, v26, v170, v49
    v_dot2_f32_bf16 v50, v42, v138, v50
    v_dot2_f32_bf16 v51, v42, v170, v51
    v_dot2_f32_bf16 v52, v26, v202, v52
    v_dot2_f32_bf16 v53, v26, v234, v53
    v_dot2_f32_bf16 v54, v42, v202, v54
    v_dot2_f32_bf16 v55, v42, v234, v55
    v_dot2_f32_bf16 v48, v27, v139, v48
    v_dot2_f32_bf16 v49, v27, v171, v49
    v_dot2_f32_bf16 v50, v43, v139, v50
    v_dot2_f32_bf16 v51, v43, v171, v51
    v_dot2_f32_bf16 v52, v27, v203, v52
    v_dot2_f32_bf16 v53, v27, v235, v53
    v_dot2_f32_bf16 v54, v43, v203, v54
    v_dot2_f32_bf16 v55, v43, v235, v55
    v_dot2_f32_bf16 v48, v28, v140, v48
    v_dot2_f32_bf16 v49, v28, v172, v49
    v_dot2_f32_bf16 v50, v44, v140, v50
    v_dot2_f32_bf16 v51, v44, v172, v51
    v_dot2_f32_bf16 v52, v28, v204, v52
    v_dot2_f32_bf16 v53, v28, v236, v53
    v_dot2_f32_bf16 v54, v44, v204, v54
    v_dot2_f32_bf16 v55, v44, v236, v55
    v_dot2_f32_bf16 v48, v29, v141, v48
    v_dot2_f32_bf16 v49, v29, v173, v49
    v_dot2_f32_bf16 v50, v45, v141, v50
    v_dot2_f32_bf16 v51, v45, v173, v51
    v_dot2_f32_bf16 v52, v29, v205, v52
    v_dot2_f32_bf16 v53, v29, v237, v53
    v_dot2_f32_bf16 v54, v45, v205, v54
    v_dot2_f32_bf16 v55, v45, v237, v55
    v_dot2_f32_bf16 v48, v30, v142, v48
    v_dot2_f32_bf16 v49, v30, v174, v49
    v_dot2_f32_bf16 v50, v46, v142, v50
    v_dot2_f32_bf16 v51, v46, v174, v51
    v_dot2_f32_bf16 v52, v30, v206, v52
    v_dot2_f32_bf16 v53, v30, v238, v53
    v_dot2_f32_bf16 v54, v46, v206, v54
    v_dot2_f32_bf16 v55, v46, v238, v55
    v_dot2_f32_bf16 v48, v31, v143, v48
    v_dot2_f32_bf16 v49, v31, v175, v49
    v_dot2_f32_bf16 v50, v47, v143, v50
    v_dot2_f32_bf16 v51, v47, v175, v51
    v_dot2_f32_bf16 v52, v31, v207, v52
    v_dot2_f32_bf16 v53, v31, v239, v53
    v_dot2_f32_bf16 v54, v47, v207, v54
    v_dot2_f32_bf16 v55, v47, v239, v55
    ds_read_b128 v[16:19], v8 offset:4160
    ds_read_b128 v[20:23], v8 offset:4176
    ds_read_b128 v[24:27], v8 offset:4192
    ds_read_b128 v[28:31], v8 offset:4208
    ds_read_b128 v[32:35], v8 offset:5184
    ds_read_b128 v[36:39], v8 offset:5200
    ds_read_b128 v[40:43], v8 offset:5216
    ds_read_b128 v[44:47], v8 offset:5232
    s_waitcnt lgkmcnt(0)
    v_dot2_f32_bf16 v48, v16, v144, v48
    v_dot2_f32_bf16 v49, v16, v176, v49
    v_dot2_f32_bf16 v50, v32, v144, v50
    v_dot2_f32_bf16 v51, v32, v176, v51
    v_dot2_f32_bf16 v52, v16, v208, v52
    v_dot2_f32_bf16 v53, v16, v240, v53
    v_dot2_f32_bf16 v54, v32, v208, v54
    v_dot2_f32_bf16 v55, v32, v240, v55
    v_dot2_f32_bf16 v48, v17, v145, v48
    v_dot2_f32_bf16 v49, v17, v177, v49
    v_dot2_f32_bf16 v50, v33, v145, v50
    v_dot2_f32_bf16 v51, v33, v177, v51
    v_dot2_f32_bf16 v52, v17, v209, v52
    v_dot2_f32_bf16 v53, v17, v241, v53
    v_dot2_f32_bf16 v54, v33, v209, v54
    v_dot2_f32_bf16 v55, v33, v241, v55
    v_dot2_f32_bf16 v48, v18, v146, v48
    v_dot2_f32_bf16 v49, v18, v178, v49
    v_dot2_f32_bf16 v50, v34, v146, v50
    v_dot2_f32_bf16 v51, v34, v178, v51
    v_dot2_f32_bf16 v52, v18, v210, v52
    v_dot2_f32_bf16 v53, v18, v242, v53
    v_dot2_f32_bf16 v54, v34, v210, v54
    v_dot2_f32_bf16 v55, v34, v242, v55
    v_dot2_f32_bf16 v48, v19, v147, v48
    v_dot2_f32_bf16 v49, v19, v179, v49
    v_dot2_f32_bf16 v50, v35, v147, v50
    v_dot2_f32_bf16 v51, v35, v179, v51
    v_dot2_f32_bf16 v52, v19, v211, v52
    v_dot2_f32_bf16 v53, v19, v243, v53
    v_dot2_f32_bf16 v54, v35, v211, v54
    v_dot2_f32_bf16 v55, v35, v243, v55
    v_dot2_f32_bf16 v48, v20, v148, v48
    v_dot2_f32_bf16 v49, v20, v180, v49
    v_dot2_f32_bf16 v50, v36, v148, v50
    v_dot2_f32_bf16 v51, v36, v180, v51
    v_dot2_f32_bf16 v52, v20, v212, v52
    v_dot2_f32_bf16 v53, v20, v244, v53
    v_dot2_f32_bf16 v54, v36, v212, v54
    v_dot2_f32_bf16 v55, v36, v244, v55
    v_dot2_f32_bf16 v48, v21, v149, v48
    v_dot2_f32_bf16 v49, v21, v181, v49
    v_dot2_f32_bf16 v50, v37, v149, v50
    v_dot2_f32_bf16 v51, v37, v181, v51
    v_dot2_f32_bf16 v52, v21, v213, v52
    v_dot2_f32_bf16 v53, v21, v245, v53
    v_dot2_f32_bf16 v54, v37, v213, v54
    v_dot2_f32_bf16 v55, v37, v245, v55
    v_dot2_f32_bf16 v48, v22, v150, v48
    v_dot2_f32_bf16 v49, v22, v182, v49
    v_dot2_f32_bf16 v50, v38, v150, v50
    v_dot2_f32_bf16 v51, v38, v182, v51
    v_dot2_f32_bf16 v52, v22, v214, v52
    v_dot2_f32_bf16 v53, v22, v246, v53
    v_dot2_f32_bf16 v54, v38, v214, v54
    v_dot2_f32_bf16 v55, v38, v246, v55
    v_dot2_f32_bf16 v48, v23, v151, v48
    v_dot2_f32_bf16 v49, v23, v183, v49
    v_dot2_f32_bf16 v50, v39, v151, v50
    v_dot2_f32_bf16 v51, v39, v183, v51
    v_dot2_f32_bf16 v52, v23, v215, v52
    v_dot2_f32_bf16 v53, v23, v247, v53
    v_dot2_f32_bf16 v54, v39, v215, v54
    v_dot2_f32_bf16 v55, v39, v247, v55
    v_dot2_f32_bf16 v48, v24, v152, v48
    v_dot2_f32_bf16 v49, v24, v184, v49
    v_dot2_f32_bf16 v50, v40, v152, v50
    v_dot2_f32_bf16 v51, v40, v184, v51
    v_dot2_f32_bf16 v52, v24, v216, v52
    v_dot2_f32_bf16 v53, v24, v248, v53
    v_dot2_f32_bf16 v54, v40, v216, v54
    v_dot2_f32_bf16 v55, v40, v248, v55
    v_dot2_f32_bf16 v48, v25, v153, v48
    v_dot2_f32_bf16 v49, v25, v185, v49
    v_dot2_f32_bf16 v50, v41, v153, v50
    v_dot2_f32_bf16 v51, v41, v185, v51
    v_dot2_f32_bf16 v52, v25, v217, v52
    v_dot2_f32_bf16 v53, v25, v249, v53
    v_dot2_f32_bf16 v54, v41, v217, v54
    v_dot2_f32_bf16 v55, v41, v249, v55
    v_dot2_f32_bf16 v48, v26, v154, v48
    v_dot2_f32_bf16 v49, v26, v186, v49
    v_dot2_f32_bf16 v50, v42, v154, v50
    v_dot2_f32_bf16 v51, v42, v186, v51
    v_dot2_f32_bf16 v52, v26, v218, v52
    v_dot2_f32_bf16 v53, v26, v250, v53
    v_dot2_f32_bf16 v54, v42, v218, v54
    v_dot2_f32_bf16 v55, v42, v250, v55
    v_dot2_f32_bf16 v48, v27, v155, v48
    v_dot2_f32_bf16 v49, v27, v187, v49
    v_dot2_f32_bf16 v50, v43, v155, v50
    v_dot2_f32_bf16 v51, v43, v187, v51
    v_dot2_f32_bf16 v52, v27, v219, v52
    v_dot2_f32_bf16 v53, v27, v251, v53
    v_dot2_f32_bf16 v54, v43, v219, v54
    v_dot2_f32_bf16 v55, v43, v251, v55
    v_dot2_f32_bf16 v48, v28, v156, v48
    v_dot2_f32_bf16 v49, v28, v188, v49
    v_dot2_f32_bf16 v50, v44, v156, v50
    v_dot2_f32_bf16 v51, v44, v188, v51
    v_dot2_f32_bf16 v52, v28, v220, v52
    v_dot2_f32_bf16 v53, v28, v252, v53
    v_dot2_f32_bf16 v54, v44, v220, v54
    v_dot2_f32_bf16 v55, v44, v252, v55
    v_dot2_f32_bf16 v48, v29, v157, v48
    v_dot2_f32_bf16 v49, v29, v189, v49
    v_dot2_f32_bf16 v50, v45, v157, v50
    v_dot2_f32_bf16 v51, v45, v189, v51
    v_dot2_f32_bf16 v52, v29, v221, v52
    v_dot2_f32_bf16 v53, v29, v253, v53
    v_dot2_f32_bf16 v54, v45, v221, v54
    v_dot2_f32_bf16 v55, v45, v253, v55
    v_dot2_f32_bf16 v48, v30, v158, v48
    v_dot2_f32_bf16 v49, v30, v190, v49
    v_dot2_f32_bf16 v50, v46, v158, v50
    v_dot2_f32_bf16 v51, v46, v190, v51
    v_dot2_f32_bf16 v52, v30, v222, v52
    v_dot2_f32_bf16 v53, v30, v254, v53
    v_dot2_f32_bf16 v54, v46, v222, v54
    v_dot2_f32_bf16 v55, v46, v254, v55
    v_dot2_f32_bf16 v48, v31, v159, v48
    v_dot2_f32_bf16 v49, v31, v191, v49
    v_dot2_f32_bf16 v50, v47, v159, v50
    v_dot2_f32_bf16 v51, v47, v191, v51
    v_dot2_f32_bf16 v52, v31, v223, v52
    v_dot2_f32_bf16 v53, v31, v255, v53
    v_dot2_f32_bf16 v54, v47, v223, v54
    v_dot2_f32_bf16 v55, v47, v255, v55
    s_nop 3
    v_lshlrev_b32 v7, 5, v0
    ds_write_b128 v7, v[48:51] offset:8192
    ds_write_b128 v7, v[52:55] offset:8208
    s_waitcnt lgkmcnt(0)
    s_barrier
    v_lshlrev_b32 v7, 5, v2
    v_bfe_u32 v8, v0, 5, 1
    v_lshl_add_u32 v7, v8, 3, v7
    ds_read_b64 v[16:17], v7 offset:8192
    ds_read_b64 v[18:19], v7 offset:8208
    ds_read_b64 v[20:21], v7 offset:9216
    ds_read_b64 v[22:23], v7 offset:9232
    ds_read_b64 v[24:25], v7 offset:10240
    ds_read_b64 v[26:27], v7 offset:10256
    ds_read_b64 v[28:29], v7 offset:11264
    ds_read_b64 v[30:31], v7 offset:11280
    s_waitcnt lgkmcnt(0)
    ds_read_b64 v[32:33], v7 offset:12288
    ds_read_b64 v[34:35], v7 offset:12304
    ds_read_b64 v[36:37], v7 offset:13312
    ds_read_b64 v[38:39], v7 offset:13328
    ds_read_b64 v[40:41], v7 offset:14336
    ds_read_b64 v[42:43], v7 offset:14352
    ds_read_b64 v[44:45], v7 offset:15360
    ds_read_b64 v[46:47], v7 offset:15376
    s_waitcnt lgkmcnt(0)
    v_add_f32 v16, v16, v20
    v_add_f32 v16, v16, v24
    v_add_f32 v16, v16, v28
    v_add_f32 v16, v16, v32
    v_add_f32 v16, v16, v36
    v_add_f32 v16, v16, v40
    v_add_f32 v16, v16, v44
    v_cvt_pk_bf16_f32 v5, v16, v16
    v_lshlrev_b32 v16, 16, v5
    v_add_f32 v17, v17, v21
    v_add_f32 v17, v17, v25
    v_add_f32 v17, v17, v29
    v_add_f32 v17, v17, v33
    v_add_f32 v17, v17, v37
    v_add_f32 v17, v17, v41
    v_add_f32 v17, v17, v45
    v_cvt_pk_bf16_f32 v5, v17, v17
    v_lshlrev_b32 v17, 16, v5
    v_add_f32 v18, v18, v22
    v_add_f32 v18, v18, v26
    v_add_f32 v18, v18, v30
    v_add_f32 v18, v18, v34
    v_add_f32 v18, v18, v38
    v_add_f32 v18, v18, v42
    v_add_f32 v18, v18, v46
    v_cvt_pk_bf16_f32 v5, v18, v18
    v_lshlrev_b32 v18, 16, v5
    v_add_f32 v19, v19, v23
    v_add_f32 v19, v19, v27
    v_add_f32 v19, v19, v31
    v_add_f32 v19, v19, v35
    v_add_f32 v19, v19, v39
    v_add_f32 v19, v19, v43
    v_add_f32 v19, v19, v47
    v_cvt_pk_bf16_f32 v5, v19, v19
    v_lshlrev_b32 v19, 16, v5
    v_mul_f32 v6, 0xbfb8aa3b, v16
    v_exp_f32 v6, v6
    s_nop 0
    v_add_f32 v6, 1.0, v6
    v_rcp_f32 v6, v6
    s_nop 0
    v_mul_f32 v16, v16, v6
    v_cvt_pk_bf16_f32 v5, v16, v16
    v_lshlrev_b32 v16, 16, v5
    v_mul_f32 v16, v16, v18
    v_mul_f32 v6, 0xbfb8aa3b, v17
    v_exp_f32 v6, v6
    s_nop 0
    v_add_f32 v6, 1.0, v6
    v_rcp_f32 v6, v6
    s_nop 0
    v_mul_f32 v17, v17, v6
    v_cvt_pk_bf16_f32 v5, v17, v17
    v_lshlrev_b32 v17, 16, v5
    v_mul_f32 v17, v17, v19
    v_cvt_pk_bf16_f32 v16, v16, v17
    v_mul_u32_u24 v8, 3584, v8
    v_lshl_add_u32 v7, v2, 2, v8
    v_mov_b32 v6, 0x40000000
    v_cmp_lt_u32 vcc, 27, v2
    s_nop 1
    v_cndmask_b32 v7, v7, v6, vcc
    v_cmp_lt_u32 vcc, 63, v0
    s_nop 1
    v_cndmask_b32 v7, v7, v6, vcc
    s_mul_i32 s37, s24, 8192
    s_add_u32 s37, s37, 0x1b0000
    s_add_u32 s36, s37, s23
    buffer_store_dword v16, v7, s[8:11], s36 offen sc1
    v_lshlrev_b32 v7, 4, v0
    v_add_u32 v8, 4096, v7
    v_cmp_lt_u32 vcc, 191, v0
    s_nop 1
    v_cndmask_b32 v8, v8, v6, vcc
L_M_act:
    buffer_load_dwordx4 v[20:23], v7, s[8:11], s37 offen sc1
    buffer_load_dwordx4 v[24:27], v8, s[8:11], s37 offen sc1
    s_add_u32 s32, s32, 1
    s_cmp_gt_u32 s32, 200000
    s_waitcnt vmcnt(0)
    v_max3_u32 v5, v20, v21, v22
    v_max3_u32 v5, v5, v23, v24
    v_max3_u32 v5, v5, v25, v26
    v_max_u32 v5, v5, v27
    s_cbranch_scc1 L_M_act_ok
    v_cmp_eq_u32 vcc, -1, v5
    s_cbranch_vccnz L_M_act
L_M_act_ok:
    ds_write_b128 v7, v[20:23] offset:16384
    ds_write_b128 v7, v[24:27] offset:20480
    s_waitcnt lgkmcnt(0)
    s_barrier
    v_lshrrev_b32 v7, 3, v0
    v_mul_u32_u24 v7, 112, v7
    v_mov_b64 v[48:49], 0
    v_mov_b64 v[50:51], 0
    ds_read_b128 v[16:19], v7 offset:16384
    ds_read_b128 v[20:23], v7 offset:16400
    ds_read_b128 v[24:27], v7 offset:16416
    ds_read_b128 v[28:31], v7 offset:16432
    ds_read_b128 v[32:35], v7 offset:16448
    ds_read_b128 v[36:39], v7 offset:16464
    ds_read_b128 v[40:43], v7 offset:16480
    s_waitcnt lgkmcnt(0)
    v_dot2_f32_bf16 v48, v16, v64, v48
    v_dot2_f32_bf16 v49, v16, v92, v49
    v_dot2_f32_bf16 v48, v17, v65, v48
    v_dot2_f32_bf16 v49, v17, v93, v49
    v_dot2_f32_bf16 v48, v18, v66, v48
    v_dot2_f32_bf16 v49, v18, v94, v49
    v_dot2_f32_bf16 v48, v19, v67, v48
    v_dot2_f32_bf16 v49, v19, v95, v49
    v_dot2_f32_bf16 v48, v20, v68, v48
    v_dot2_f32_bf16 v49, v20, v96, v49
    v_dot2_f32_bf16 v48, v21, v69, v48
    v_dot2_f32_bf16 v49, v21, v97, v49
    v_dot2_f32_bf16 v48, v22, v70, v48
    v_dot2_f32_bf16 v49, v22, v98, v49
    v_dot2_f32_bf16 v48, v23, v71, v48
    v_dot2_f32_bf16 v49, v23, v99, v49
    v_dot2_f32_bf16 v48, v24, v72, v48
    v_dot2_f32_bf16 v49, v24, v100, v49
    v_dot2_f32_bf16 v48, v25, v73, v48
    v_dot2_f32_bf16 v49, v25, v101, v49
    v_dot2_f32_bf16 v48, v26, v74, v48
    v_dot2_f32_bf16 v49, v26, v102, v49
    v_dot2_f32_bf16 v48, v27, v75, v48
    v_dot2_f32_bf16 v49, v27, v103, v49
    v_dot2_f32_bf16 v48, v28, v76, v48
    v_dot2_f32_bf16 v49, v28, v104, v49
    v_dot2_f32_bf16 v48, v29, v77, v48
    v_dot2_f32_bf16 v49, v29, v105, v49
    v_dot2_f32_bf16 v48, v30, v78, v48
    v_dot2_f32_bf16 v49, v30, v106, v49
    v_dot2_f32_bf16 v48, v31, v79, v48
    v_dot2_f32_bf16 v49, v31, v107, v49
    v_dot2_f32_bf16 v48, v32, v80, v48
    v_dot2_f32_bf16 v49, v32, v108, v49
    v_dot2_f32_bf16 v48, v33, v81, v48
    v_dot2_f32_bf16 v49, v33, v109, v49
    v_dot2_f32_bf16 v48, v34, v82, v48
    v_dot2_f32_bf16 v49, v34, v110, v49
    v_dot2_f32_bf16 v48, v35, v83, v48
    v_dot2_f32_bf16 v49, v35, v111, v49
    v_dot2_f32_bf16 v48, v36, v84, v48
    v_dot2_f32_bf16 v49, v36, v112, v49
    v_dot2_f32_bf16 v48, v37, v85, v48
    v_dot2_f32_bf16 v49, v37, v113, v49
    v_dot2_f32_bf16 v48, v38, v86, v48
    v_dot2_f32_bf16 v49, v38, v114, v49
    v_dot2_f32_bf16 v48, v39, v87, v48
    v_dot2_f32_bf16 v49, v39, v115, v49
    v_dot2_f32_bf16 v48, v40, v88, v48
    v_dot2_f32_bf16 v49, v40, v116, v49
    v_dot2_f32_bf16 v48, v41, v89, v48
    v_dot2_f32_bf16 v49, v41, v117, v49
    v_dot2_f32_bf16 v48, v42, v90, v48
    v_dot2_f32_bf16 v49, v42, v118, v49
    v_dot2_f32_bf16 v48, v43, v91, v48
    v_dot2_f32_bf16 v49, v43, v119, v49
    ds_read_b128 v[16:19], v7 offset:19968
    ds_read_b128 v[20:23], v7 offset:19984
    ds_read_b128 v[24:27], v7 offset:20000
    ds_read_b128 v[28:31], v7 offset:20016
    ds_read_b128 v[32:35], v7 offset:20032
    ds_read_b128 v[36:39], v7 offset:20048
    ds_read_b128 v[40:43], v7 offset:20064
    s_waitcnt lgkmcnt(0)
    v_dot2_f32_bf16 v50, v16, v64, v50
    v_dot2_f32_bf16 v51, v16, v92, v51
    v_dot2_f32_bf16 v50, v17, v65, v50
    v_dot2_f32_bf16 v51, v17, v93, v51
    v_dot2_f32_bf16 v50, v18, v66, v50
    v_dot2_f32_bf16 v51, v18, v94, v51
    v_dot2_f32_bf16 v50, v19, v67, v50
    v_dot2_f32_bf16 v51, v19, v95, v51
    v_dot2_f32_bf16 v50, v20, v68, v50
    v_dot2_f32_bf16 v51, v20, v96, v51
    v_dot2_f32_bf16 v50, v21, v69, v50
    v_dot2_f32_bf16 v51, v21, v97, v51
    v_dot2_f32_bf16 v50, v22, v70, v50
    v_dot2_f32_bf16 v51, v22, v98, v51
    v_dot2_f32_bf16 v50, v23, v71, v50
    v_dot2_f32_bf16 v51, v23, v99, v51
    v_dot2_f32_bf16 v50, v24, v72, v50
    v_dot2_f32_bf16 v51, v24, v100, v51
    v_dot2_f32_bf16 v50, v25, v73, v50
    v_dot2_f32_bf16 v51, v25, v101, v51
    v_dot2_f32_bf16 v50, v26, v74, v50
    v_dot2_f32_bf16 v51, v26, v102, v51
    v_dot2_f32_bf16 v50, v27, v75, v50
    v_dot2_f32_bf16 v51, v27, v103, v51
    v_dot2_f32_bf16 v50, v28, v76, v50
    v_dot2_f32_bf16 v51, v28, v104, v51
    v_dot2_f32_bf16 v50, v29, v77, v50
    v_dot2_f32_bf16 v51, v29, v105, v51
    v_dot2_f32_bf16 v50, v30, v78, v50
    v_dot2_f32_bf16 v51, v30, v106, v51
    v_dot2_f32_bf16 v50, v31, v79, v50
    v_dot2_f32_bf16 v51, v31, v107, v51
    v_dot2_f32_bf16 v50, v32, v80, v50
    v_dot2_f32_bf16 v51, v32, v108, v51
    v_dot2_f32_bf16 v50, v33, v81, v50
    v_dot2_f32_bf16 v51, v33, v109, v51
    v_dot2_f32_bf16 v50, v34, v82, v50
    v_dot2_f32_bf16 v51, v34, v110, v51
    v_dot2_f32_bf16 v50, v35, v83, v50
    v_dot2_f32_bf16 v51, v35, v111, v51
    v_dot2_f32_bf16 v50, v36, v84, v50
    v_dot2_f32_bf16 v51, v36, v112, v51
    v_dot2_f32_bf16 v50, v37, v85, v50
    v_dot2_f32_bf16 v51, v37, v113, v51
    v_dot2_f32_bf16 v50, v38, v86, v50
    v_dot2_f32_bf16 v51, v38, v114, v51
    v_dot2_f32_bf16 v50, v39, v87, v50
    v_dot2_f32_bf16 v51, v39, v115, v51
    v_dot2_f32_bf16 v50, v40, v88, v50
    v_dot2_f32_bf16 v51, v40, v116, v51
    v_dot2_f32_bf16 v50, v41, v89, v50
    v_dot2_f32_bf16 v51, v41, v117, v51
    v_dot2_f32_bf16 v50, v42, v90, v50
    v_dot2_f32_bf16 v51, v42, v118, v51
    v_dot2_f32_bf16 v50, v43, v91, v50
    v_dot2_f32_bf16 v51, v43, v119, v51
    s_nop 3
    v_add_f32_dpp v48, v48, v48 row_ror:8 row_mask:0xf bank_mask:0xf
    v_add_f32_dpp v49, v49, v49 row_ror:8 row_mask:0xf bank_mask:0xf
    v_add_f32_dpp v50, v50, v50 row_ror:8 row_mask:0xf bank_mask:0xf
    v_add_f32_dpp v51, v51, v51 row_ror:8 row_mask:0xf bank_mask:0xf
    v_mov_b32 v5, v48
    s_nop 1
    v_permlane16_swap_b32 v48, v5
    v_add_f32 v48, v48, v5
    v_mov_b32 v5, v49
    s_nop 1
    v_permlane16_swap_b32 v49, v5
    v_add_f32 v49, v49, v5
    v_mov_b32 v5, v50
    s_nop 1
    v_permlane16_swap_b32 v50, v5
    v_add_f32 v50, v50, v5
    v_mov_b32 v5, v51
    s_nop 1
    v_permlane16_swap_b32 v51, v5
    v_add_f32 v51, v51, v5
    v_mov_b32 v5, v48
    s_nop 1
    v_permlane32_swap_b32 v48, v5
    v_add_f32 v48, v48, v5
    v_mov_b32 v5, v49
    s_nop 1
    v_permlane32_swap_b32 v49, v5
    v_add_f32 v49, v49, v5
    v_mov_b32 v5, v50
    s_nop 1
    v_permlane32_swap_b32 v50, v5
    v_add_f32 v50, v50, v5
    v_mov_b32 v5, v51
    s_nop 1
    v_permlane32_swap_b32 v51, v5
    v_add_f32 v51, v51, v5
    v_lshrrev_b32 v7, 6, v0
    v_lshlrev_b32 v7, 7, v7
    v_lshl_add_u32 v7, v3, 4, v7
    ds_write_b128 v7, v[48:51] offset:1024
    s_waitcnt lgkmcnt(0)
    s_barrier
    v_lshlrev_b32 v7, 4, v3
    v_lshl_add_u32 v7, v9, 3, v7
    ds_read_b64 v[16:17], v7 offset:1024
    ds_read_b64 v[18:19], v7 offset:1152
    ds_read_b64 v[20:21], v7 offset:1280
    ds_read_b64 v[22:23], v7 offset:1408
    v_mul_f32 v10, 0xbfb8aa3b, v11
    v_exp_f32 v10, v10
    s_nop 0
    v_add_f32 v10, 1.0, v10
    v_rcp_f32 v10, v10
    s_nop 0
    v_cvt_pk_bf16_f32 v5, v10, v10
    v_lshlrev_b32 v10, 16, v5
    s_waitcnt lgkmcnt(0)
    v_lshlrev_b32 v24, 16, v15
    v_and_b32 v25, 0xffff0000, v15
    v_lshlrev_b32 v26, 16, v14
    v_and_b32 v27, 0xffff0000, v14
    v_add_f32 v16, v16, v18
    v_add_f32 v20, v20, v22
    v_add_f32 v16, v16, v20
    v_cvt_pk_bf16_f32 v5, v16, v16
    v_lshlrev_b32 v16, 16, v5
    v_mul_f32 v16, v16, v10
    v_cvt_pk_bf16_f32 v5, v16, v16
    v_lshlrev_b32 v16, 16, v5
    v_add_f32 v16, v16, v24
    v_cvt_pk_bf16_f32 v5, v16, v16
    v_lshlrev_b32 v16, 16, v5
    v_add_f32 v16, v16, v26
    v_add_f32 v17, v17, v19
    v_add_f32 v21, v21, v23
    v_add_f32 v17, v17, v21
    v_cvt_pk_bf16_f32 v5, v17, v17
    v_lshlrev_b32 v17, 16, v5
    v_mul_f32 v17, v17, v10
    v_cvt_pk_bf16_f32 v5, v17, v17
    v_lshlrev_b32 v17, 16, v5
    v_add_f32 v17, v17, v25
    v_cvt_pk_bf16_f32 v5, v17, v17
    v_lshlrev_b32 v17, 16, v5
    v_add_f32 v17, v17, v27
    v_cvt_pk_bf16_f32 v16, v16, v17
    buffer_store_dword v16, v12, s[60:63], 0 offen sc1
    v_add_f32 v24, v24, v26
    v_add_f32 v25, v25, v27
    v_cvt_pk_bf16_f32 v13, v24, v25
L_M_next:
    s_add_u32 s24, s24, 1
    s_mov_b32 s25, 192
    s_cmp_eq_u32 s24, 1
    s_cbranch_scc1 L_M_round
    s_cmp_eq_u32 s24, 3
    s_cbranch_scc1 L_end
    s_mov_b32 s25, 256
    v_and_b32 v7, 63, v0
    v_lshlrev_b32 v3, 4, v7
    s_mov_b32 s36, 0x19bc00
    v_sub_u32 v7, 63, v7
L_M_fin:
    buffer_load_dwordx4 v[16:19], v3, s[8:11], s36 offen sc1
    s_add_u32 s32, s32, 1
    s_cmp_gt_u32 s32, 200000
    s_cselect_b32 s37, -1, -2
    s_waitcnt vmcnt(0)
    v_max3_u32 v5, v16, v17, v18
    v_max_u32 v5, v5, v19
    v_cmp_lt_u32 vcc, s37, v5
    s_cbranch_vccnz L_M_fin
    v_add_f32 v16, v16, v17
    v_add_f32 v18, v18, v19
    v_add_f32 v16, v16, v18
    v_cvt_pk_bf16_f32 v5, v16, v16
    v_lshlrev_b32 v16, 16, v5
    v_ashrrev_i32 v5, 31, v16
    v_or_b32 v5, 0x80000000, v5
    v_xor_b32 v5, v5, v16
    v_and_or_b32 v5, v5, s42, v7
    v_cmp_lt_u32 vcc, s29, v5
    s_cbranch_vccnz L_M_round
L_end:
    s_endpgm
.section .rodata,"a"
.p2align 6
.amdhsa_kernel sequential_preLN__memory_aug_recurrent_mem_tr__moe_arch_mod__prompt_kernel
  .amdhsa_next_free_vgpr 512
  .amdhsa_next_free_sgpr 102
  .amdhsa_accum_offset 256
  .amdhsa_group_segment_fixed_size 0
  .amdhsa_kernarg_size 120
  .amdhsa_user_sgpr_count 2
  .amdhsa_user_sgpr_kernarg_segment_ptr 1
  .amdhsa_system_sgpr_workgroup_id_x 1
.end_amdhsa_kernel
```

```asm
; @launch grid=(256,1,1) block=(256,1,1) lds=163840
.amdgcn_target "amdgcn-amd-amdhsa--gfx950"
.text
.globl sequential_preLN__memory_aug_recurrent_mem_tr__moe_arch_mod__prompt_kernel
.p2align 8
.type sequential_preLN__memory_aug_recurrent_mem_tr__moe_arch_mod__prompt_kernel,@function
sequential_preLN__memory_aug_recurrent_mem_tr__moe_arch_mod__prompt_kernel:
    s_cmp_ge_u32 s2, 256
    s_cbranch_scc1 L_end
    s_load_dwordx8 s[44:51], s[0:1], 0
    s_load_dwordx4 s[52:55], s[0:1], 32
    s_load_dwordx4 s[56:59], s[0:1], 104
    s_load_dwordx2 s[80:81], s[0:1], 64
    s_load_dwordx2 s[82:83], s[0:1], 96
    s_load_dwordx4 s[84:87], s[0:1], 72
    s_load_dwordx2 s[88:89], s[0:1], 88
    v_lshrrev_b32 v1, 6, v0
    s_nop 0
    v_readfirstlane_b32 s21, v1
    s_waitcnt lgkmcnt(0)
    s_mov_b32 s8, s58
    s_and_b32 s9, s59, 0xffff
    s_mov_b32 s10, 0x10000000
    s_mov_b32 s11, 0x20000
    s_mov_b32 s16, s56
    s_and_b32 s17, s57, 0xffff
    s_mov_b32 s18, 0x100
    s_mov_b32 s19, 0x20000
    s_and_b32 s3, s2, 7
    s_cmp_lg_u32 s3, 0
    s_cbranch_scc1 L_worker
    s_lshr_b32 s20, s2, 3
    v_lshrrev_b32 v28, 4, v0
    v_and_b32 v16, 15, v0
    v_lshlrev_b32 v16, 4, v16
    v_lshl_add_u32 v16, v28, 13, v16
    v_bfe_u32 v29, v0, 4, 1
    v_lshlrev_b32 v29, 5, v29
    v_xor_b32 v16, v16, v29
    v_and_b32 v29, 192, v0
    v_xor_b32 v16, v16, v29
    s_lshl_b32 s28, s21, 10
    s_lshl_b32 s3, s20, 8
    s_mov_b32 s60, s52
    s_and_b32 s61, s53, 0xffff
    s_mov_b32 s62, 0x400000
    s_mov_b32 s63, 0x20000
    s_add_u32 m0, s28, 32768
    s_add_u32 s37, s3, 0x0
    buffer_load_dwordx4 v16, s[60:63], s37 offen lds
    s_add_u32 m0, s28, 36864
    s_add_u32 s37, s3, 0x20000
    buffer_load_dwordx4 v16, s[60:63], s37 offen lds
    s_add_u32 m0, s28, 65536
    s_add_u32 s37, s3, 0x40000
    buffer_load_dwordx4 v16, s[60:63], s37 offen lds
    s_add_u32 m0, s28, 69632
    s_add_u32 s37, s3, 0x60000
    buffer_load_dwordx4 v16, s[60:63], s37 offen lds
    s_add_u32 m0, s28, 98304
    s_add_u32 s37, s3, 0x80000
    buffer_load_dwordx4 v16, s[60:63], s37 offen lds
    s_add_u32 m0, s28, 102400
    s_add_u32 s37, s3, 0xa0000
    buffer_load_dwordx4 v16, s[60:63], s37 offen lds
    s_add_u32 m0, s28, 131072
    s_add_u32 s37, s3, 0xc0000
    buffer_load_dwordx4 v16, s[60:63], s37 offen lds
    s_add_u32 m0, s28, 135168
    s_add_u32 s37, s3, 0xe0000
    buffer_load_dwordx4 v16, s[60:63], s37 offen lds
    s_add_u32 m0, s28, 40960
    s_add_u32 s37, s3, 0x100000
    buffer_load_dwordx4 v16, s[60:63], s37 offen lds
    s_add_u32 m0, s28, 45056
    s_add_u32 s37, s3, 0x120000
    buffer_load_dwordx4 v16, s[60:63], s37 offen lds
    s_add_u32 m0, s28, 73728
    s_add_u32 s37, s3, 0x140000
    buffer_load_dwordx4 v16, s[60:63], s37 offen lds
    s_add_u32 m0, s28, 77824
    s_add_u32 s37, s3, 0x160000
    buffer_load_dwordx4 v16, s[60:63], s37 offen lds
    s_add_u32 m0, s28, 106496
    s_add_u32 s37, s3, 0x180000
    buffer_load_dwordx4 v16, s[60:63], s37 offen lds
    s_add_u32 m0, s28, 110592
    s_add_u32 s37, s3, 0x1a0000
    buffer_load_dwordx4 v16, s[60:63], s37 offen lds
    s_add_u32 m0, s28, 139264
    s_add_u32 s37, s3, 0x1c0000
    buffer_load_dwordx4 v16, s[60:63], s37 offen lds
    s_add_u32 m0, s28, 143360
    s_add_u32 s37, s3, 0x1e0000
    buffer_load_dwordx4 v16, s[60:63], s37 offen lds
    s_add_u32 m0, s28, 49152
    s_add_u32 s37, s3, 0x200000
    buffer_load_dwordx4 v16, s[60:63], s37 offen lds
    s_add_u32 m0, s28, 53248
    s_add_u32 s37, s3, 0x220000
    buffer_load_dwordx4 v16, s[60:63], s37 offen lds
    s_add_u32 m0, s28, 81920
    s_add_u32 s37, s3, 0x240000
    buffer_load_dwordx4 v16, s[60:63], s37 offen lds
    s_add_u32 m0, s28, 86016
    s_add_u32 s37, s3, 0x260000
    buffer_load_dwordx4 v16, s[60:63], s37 offen lds
    s_add_u32 m0, s28, 114688
    s_add_u32 s37, s3, 0x280000
    buffer_load_dwordx4 v16, s[60:63], s37 offen lds
    s_add_u32 m0, s28, 118784
    s_add_u32 s37, s3, 0x2a0000
    buffer_load_dwordx4 v16, s[60:63], s37 offen lds
    s_add_u32 m0, s28, 147456
    s_add_u32 s37, s3, 0x2c0000
    buffer_load_dwordx4 v16, s[60:63], s37 offen lds
    s_add_u32 m0, s28, 151552
    s_add_u32 s37, s3, 0x2e0000
    buffer_load_dwordx4 v16, s[60:63], s37 offen lds
    v_mov_b32 v20, 0x0
    v_bfe_u32 v14, v0, 0, 1
    s_mov_b32 s38, 0x8
    v_mad_u32_u24 v20, v14, s38, v20
    v_bfe_u32 v14, v0, 1, 1
    s_mov_b32 s38, 0x10
    v_mad_u32_u24 v20, v14, s38, v20
    v_bfe_u32 v14, v0, 2, 1
    s_mov_b32 s38, 0x100
    v_mad_u32_u24 v20, v14, s38, v20
    v_bfe_u32 v14, v0, 3, 1
    s_mov_b32 s38, 0x800
    v_mad_u32_u24 v20, v14, s38, v20
    v_bfe_u32 v14, v0, 4, 1
    s_mov_b32 s38, 0x400
    v_mad_u32_u24 v20, v14, s38, v20
    v_bfe_u32 v14, v0, 5, 1
    s_mov_b32 s38, 0x1000
    v_mad_u32_u24 v20, v14, s38, v20
    v_mov_b32 v30, 0x0
    v_bfe_u32 v14, v0, 2, 1
    s_mov_b32 s38, 0x20
    v_mad_u32_u24 v30, v14, s38, v30
    v_bfe_u32 v14, v0, 3, 1
    s_mov_b32 s38, 0x80
    v_mad_u32_u24 v30, v14, s38, v30
    v_bfe_u32 v14, v0, 4, 1
    s_mov_b32 s38, 0x40
    v_mad_u32_u24 v30, v14, s38, v30
    v_mov_b32 v31, 0x0
    v_bfe_u32 v14, v0, 6, 1
    s_mov_b32 s38, 0x40
    v_mad_u32_u24 v31, v14, s38, v31
    v_bfe_u32 v14, v0, 7, 1
    s_mov_b32 s38, 0x80
    v_mad_u32_u24 v31, v14, s38, v31
    v_xor_b32 v30, v30, v31
    v_add_u32 v30, v30, v20
    s_xor_b32 s36, s21, 0
    s_add_u32 s36, s36, 1
    s_lshl_b32 s36, s36, 15
    v_add_u32 v20, s36, v30
    v_xor_b32 v21, 32, v20
    s_xor_b32 s36, s21, 1
    s_add_u32 s36, s36, 1
    s_lshl_b32 s36, s36, 15
    v_add_u32 v22, s36, v30
    v_xor_b32 v23, 32, v22
    s_xor_b32 s36, s21, 2
    s_add_u32 s36, s36, 1
    s_lshl_b32 s36, s36, 15
    v_add_u32 v24, s36, v30
    v_xor_b32 v25, 32, v24
    s_xor_b32 s36, s21, 3
    s_add_u32 s36, s36, 1
    s_lshl_b32 s36, s36, 15
    v_add_u32 v26, s36, v30
    v_xor_b32 v27, 32, v26
    v_mov_b32 v11, 0x0
    v_bfe_u32 v14, v0, 0, 1
    s_mov_b32 s38, 0x4
    v_mad_u32_u24 v11, v14, s38, v11
    v_bfe_u32 v14, v0, 1, 1
    s_mov_b32 s38, 0x8
    v_mad_u32_u24 v11, v14, s38, v11
    v_bfe_u32 v14, v0, 2, 1
    s_mov_b32 s38, 0x10
    v_mad_u32_u24 v11, v14, s38, v11
    v_bfe_u32 v14, v0, 3, 1
    s_mov_b32 s38, 0x20
    v_mad_u32_u24 v11, v14, s38, v11
    v_bfe_u32 v14, v0, 4, 1
    s_mov_b32 s38, 0x800
    v_mad_u32_u24 v11, v14, s38, v11
    v_bfe_u32 v14, v0, 5, 1
    s_mov_b32 s38, 0x1000
    v_mad_u32_u24 v11, v14, s38, v11
    v_bfe_u32 v14, v0, 6, 1
    s_mov_b32 s38, 0x100
    v_mad_u32_u24 v11, v14, s38, v11
    v_bfe_u32 v14, v0, 7, 1
    s_mov_b32 s38, 0x200
    v_mad_u32_u24 v11, v14, s38, v11
    s_mov_b32 s92, s54
    s_and_b32 s93, s55, 0xffff
    s_mov_b32 s94, 0x400000
    s_mov_b32 s95, 0x20000
    s_lshl_b32 s29, s20, 17
    s_xor_b32 s36, s21, 3
    s_lshl_b32 s36, s36, 15
    s_add_u32 s36, s36, s29
    s_add_u32 s37, s36, 0x80
    buffer_load_dword v32, v11, s[92:95], s37 offen
    s_add_u32 s37, s36, 0x4080
    buffer_load_dword v33, v11, s[92:95], s37 offen
    s_add_u32 s37, s36, 0x480
    buffer_load_dword v34, v11, s[92:95], s37 offen
    s_add_u32 s37, s36, 0x4480
    buffer_load_dword v35, v11, s[92:95], s37 offen
    s_add_u32 s37, s36, 0x2080
    buffer_load_dword v36, v11, s[92:95], s37 offen
    s_add_u32 s37, s36, 0x6080
    buffer_load_dword v37, v11, s[92:95], s37 offen
    s_add_u32 s37, s36, 0x2480
    buffer_load_dword v38, v11, s[92:95], s37 offen
    s_add_u32 s37, s36, 0x6480
    buffer_load_dword v39, v11, s[92:95], s37 offen
    s_add_u32 s37, s36, 0xc0
    buffer_load_dword v40, v11, s[92:95], s37 offen
    s_add_u32 s37, s36, 0x40c0
    buffer_load_dword v41, v11, s[92:95], s37 offen
    s_add_u32 s37, s36, 0x4c0
    buffer_load_dword v42, v11, s[92:95], s37 offen
    s_add_u32 s37, s36, 0x44c0
    buffer_load_dword v43, v11, s[92:95], s37 offen
    s_add_u32 s37, s36, 0x20c0
    buffer_load_dword v44, v11, s[92:95], s37 offen
    s_add_u32 s37, s36, 0x60c0
    buffer_load_dword v45, v11, s[92:95], s37 offen
    s_add_u32 s37, s36, 0x24c0
    buffer_load_dword v46, v11, s[92:95], s37 offen
    s_add_u32 s37, s36, 0x64c0
    buffer_load_dword v47, v11, s[92:95], s37 offen
    s_getreg_b32 s36, hwreg(HW_REG_XCC_ID)
    s_and_b32 s36, s36, 15
    s_or_b32 s36, s36, 0x100
    v_mov_b32 v30, s36
    s_lshl_b32 s37, s20, 2
    v_lshlrev_b32 v31, 20, v0
    buffer_store_dword v30, v31, s[16:19], s37 offen offset:128 sc1
    s_mov_b32 s12, s46
    s_and_b32 s13, s47, 0xffff
    s_mov_b32 s14, 0x2000
    s_mov_b32 s15, 0x20000
    v_mov_b32 v104, 0x0
    v_bfe_u32 v14, v0, 0, 1
    s_mov_b32 s38, 0x8
    v_mad_u32_u24 v104, v14, s38, v104
    v_bfe_u32 v14, v0, 1, 1
    s_mov_b32 s38, 0x10
    v_mad_u32_u24 v104, v14, s38, v104
    v_bfe_u32 v14, v0, 2, 1
    s_mov_b32 s38, 0x10000
    v_mad_u32_u24 v104, v14, s38, v104
    v_bfe_u32 v14, v0, 3, 1
    s_mov_b32 s38, 0x10000
    v_mad_u32_u24 v104, v14, s38, v104
    v_bfe_u32 v14, v0, 4, 1
    s_mov_b32 s38, 0x400
    v_mad_u32_u24 v104, v14, s38, v104
    v_bfe_u32 v14, v0, 5, 1
    s_mov_b32 s38, 0x4
    v_mad_u32_u24 v104, v14, s38, v104
    v_bfe_u32 v14, v0, 6, 1
    s_mov_b32 s38, 0x40
    v_mad_u32_u24 v104, v14, s38, v104
    v_bfe_u32 v14, v0, 7, 1
    s_mov_b32 s38, 0x80
    v_mad_u32_u24 v104, v14, s38, v104
    v_mov_b32 v106, s20
    v_mov_b32 v105, 0x0
    v_bfe_u32 v14, v106, 0, 1
    s_mov_b32 s38, 0x20
    v_mad_u32_u24 v105, v14, s38, v105
    v_bfe_u32 v14, v106, 1, 1
    s_mov_b32 s38, 0x800
    v_mad_u32_u24 v105, v14, s38, v105
    v_bfe_u32 v14, v106, 2, 1
    s_mov_b32 s38, 0x1000
    v_mad_u32_u24 v105, v14, s38, v105
    v_bfe_u32 v14, v106, 3, 1
    s_mov_b32 s38, 0x100
    v_mad_u32_u24 v105, v14, s38, v105
    v_bfe_u32 v14, v106, 4, 1
    s_mov_b32 s38, 0x200
    v_mad_u32_u24 v105, v14, s38, v105
    v_add_u32 v104, v104, v105
    buffer_load_dword v12, v104, s[12:15], 0 offen
    v_mov_b32 v1, 0x4444
    v_bfe_u32 v14, v0, 1, 1
    s_mov_b32 s38, 0xaaaa
    v_mad_u32_u24 v1, v14, s38, v1
    v_mov_b32 v3, 0x0
    v_bfe_u32 v14, v0, 0, 1
    s_mov_b32 s38, 0x10
    v_mad_u32_u24 v3, v14, s38, v3
    v_bfe_u32 v14, v0, 1, 1
    s_mov_b32 s38, 0x20
    v_mad_u32_u24 v3, v14, s38, v3
    v_bfe_u32 v14, v0, 2, 1
    s_mov_b32 s38, 0x40
    v_mad_u32_u24 v3, v14, s38, v3
    v_bfe_u32 v14, v0, 3, 1
    s_mov_b32 s38, 0x80
    v_mad_u32_u24 v3, v14, s38, v3
    v_bfe_u32 v14, v0, 4, 1
    s_mov_b32 s38, 0x100
    v_mad_u32_u24 v3, v14, s38, v3
    v_bfe_u32 v14, v0, 5, 1
    s_mov_b32 s38, 0x200
    v_mad_u32_u24 v3, v14, s38, v3
    v_mov_b32 v2, 0x0
    v_bfe_u32 v14, v0, 0, 1
    s_mov_b32 s38, 0x10
    v_mad_u32_u24 v2, v14, s38, v2
    v_bfe_u32 v14, v0, 1, 1
    s_mov_b32 s38, 0x20
    v_mad_u32_u24 v2, v14, s38, v2
    v_bfe_u32 v14, v0, 2, 1
    s_mov_b32 s38, 0x40
    v_mad_u32_u24 v2, v14, s38, v2
    v_bfe_u32 v14, v0, 3, 1
    s_mov_b32 s38, 0x80
    v_mad_u32_u24 v2, v14, s38, v2
    v_bfe_u32 v14, v0, 4, 1
    s_mov_b32 s38, 0x100
    v_mad_u32_u24 v2, v14, s38, v2
    v_bfe_u32 v14, v0, 5, 1
    s_mov_b32 s38, 0x200
    v_mad_u32_u24 v2, v14, s38, v2
    v_bfe_u32 v14, v0, 6, 1
    s_mov_b32 s38, 0x800
    v_mad_u32_u24 v2, v14, s38, v2
    v_bfe_u32 v14, v0, 7, 1
    s_mov_b32 s38, 0x1000
    v_mad_u32_u24 v2, v14, s38, v2
    v_mov_b32 v4, 0x8000
    v_bfe_u32 v14, v0, 0, 1
    s_mov_b32 s38, 0x10
    v_mad_u32_u24 v4, v14, s38, v4
    v_bfe_u32 v14, v0, 1, 1
    s_mov_b32 s38, 0x20
    v_mad_u32_u24 v4, v14, s38, v4
    v_bfe_u32 v14, v0, 2, 1
    s_mov_b32 s38, 0x40
    v_mad_u32_u24 v4, v14, s38, v4
    v_bfe_u32 v14, v0, 3, 1
    s_mov_b32 s38, 0x80
    v_mad_u32_u24 v4, v14, s38, v4
    v_bfe_u32 v14, v0, 4, 1
    s_mov_b32 s38, 0x100
    v_mad_u32_u24 v4, v14, s38, v4
    v_bfe_u32 v14, v0, 5, 1
    s_mov_b32 s38, 0x200
    v_mad_u32_u24 v4, v14, s38, v4
    v_bfe_u32 v14, v0, 6, 1
    s_mov_b32 s38, 0x8000
    v_mad_u32_u24 v4, v14, s38, v4
    v_bfe_u32 v14, v0, 7, 1
    s_mov_b32 s38, 0x10000
    v_mad_u32_u24 v4, v14, s38, v4
    v_mov_b32 v5, 0x4000
    v_bfe_u32 v14, v0, 0, 1
    s_mov_b32 s38, 0x4
    v_mad_u32_u24 v5, v14, s38, v5
    v_bfe_u32 v14, v0, 1, 1
    s_mov_b32 s38, 0x8
    v_mad_u32_u24 v5, v14, s38, v5
    v_bfe_u32 v14, v0, 2, 1
    s_mov_b32 s38, 0x10
    v_mad_u32_u24 v5, v14, s38, v5
    v_bfe_u32 v14, v0, 3, 1
    s_mov_b32 s38, 0x20
    v_mad_u32_u24 v5, v14, s38, v5
    v_bfe_u32 v14, v0, 4, 1
    s_mov_b32 s38, 0x240
    v_mad_u32_u24 v5, v14, s38, v5
    v_bfe_u32 v14, v0, 5, 1
    s_mov_b32 s38, 0x480
    v_mad_u32_u24 v5, v14, s38, v5
    v_bfe_u32 v14, v0, 6, 1
    s_mov_b32 s38, 0x40
    v_mad_u32_u24 v5, v14, s38, v5
    v_bfe_u32 v14, v0, 7, 1
    s_mov_b32 s38, 0x80
    v_mad_u32_u24 v5, v14, s38, v5
    v_mov_b32 v6, 0x4000
    v_bfe_u32 v14, v0, 0, 1
    s_mov_b32 s38, 0x120
    v_mad_u32_u24 v6, v14, s38, v6
    v_bfe_u32 v14, v0, 2, 1
    s_mov_b32 s38, 0x240
    v_mad_u32_u24 v6, v14, s38, v6
    v_bfe_u32 v14, v0, 3, 1
    s_mov_b32 s38, 0x480
    v_mad_u32_u24 v6, v14, s38, v6
    v_bfe_u32 v14, v0, 4, 1
    s_mov_b32 s38, 0x10
    v_mad_u32_u24 v6, v14, s38, v6
    v_bfe_u32 v14, v0, 5, 1
    s_mov_b32 s38, 0x20
    v_mad_u32_u24 v6, v14, s38, v6
    v_add_u32 v7, 2304, v5
    v_xor_b32 v8, 0x1000, v2
    v_mov_b32 v104, 0x0
    v_bfe_u32 v14, v0, 3, 1
    s_mov_b32 s38, 0x1
    v_mad_u32_u24 v104, v14, s38, v104
    v_bfe_u32 v14, v0, 4, 1
    s_mov_b32 s38, 0x2
    v_mad_u32_u24 v104, v14, s38, v104
    v_bfe_u32 v14, v0, 5, 1
    s_mov_b32 s38, 0x4
    v_mad_u32_u24 v104, v14, s38, v104
    v_bfe_u32 v14, v0, 6, 1
    s_mov_b32 s38, 0x8
    v_mad_u32_u24 v104, v14, s38, v104
    v_bfe_u32 v14, v0, 7, 1
    s_mov_b32 s38, 0x10
    v_mad_u32_u24 v104, v14, s38, v104
    v_add_u32 v104, s20, v104
    v_and_b32 v104, 31, v104
    v_lshlrev_b32 v104, 6, v104
    v_mov_b32 v9, 0x0
    v_bfe_u32 v14, v0, 0, 1
    s_mov_b32 s38, 0x8
    v_mad_u32_u24 v9, v14, s38, v9
    v_bfe_u32 v14, v0, 1, 1
    s_mov_b32 s38, 0x10
    v_mad_u32_u24 v9, v14, s38, v9
    v_bfe_u32 v14, v0, 2, 1
    s_mov_b32 s38, 0x20
    v_mad_u32_u24 v9, v14, s38, v9
    v_bfe_u32 v14, v0, 3, 1
    s_mov_b32 s38, 0x2000
    v_mad_u32_u24 v9, v14, s38, v9
    v_bfe_u32 v14, v0, 4, 1
    s_mov_b32 s38, 0x4000
    v_mad_u32_u24 v9, v14, s38, v9
    v_bfe_u32 v14, v0, 5, 1
    s_mov_b32 s38, 0x8000
    v_mad_u32_u24 v9, v14, s38, v9
    v_bfe_u32 v14, v0, 6, 1
    s_mov_b32 s38, 0x10000
    v_mad_u32_u24 v9, v14, s38, v9
    v_bfe_u32 v14, v0, 7, 1
    s_mov_b32 s38, 0x20000
    v_mad_u32_u24 v9, v14, s38, v9
    v_add_u32 v9, v9, v104
    v_mov_b32 v10, 0x80000
    v_bfe_u32 v14, v0, 0, 1
    s_mov_b32 s38, 0x8
    v_mad_u32_u24 v10, v14, s38, v10
    v_bfe_u32 v14, v0, 1, 1
    s_mov_b32 s38, 0x20
    v_mad_u32_u24 v10, v14, s38, v10
    v_bfe_u32 v14, v0, 4, 1
    s_mov_b32 s38, 0x10
    v_mad_u32_u24 v10, v14, s38, v10
    v_bfe_u32 v14, v0, 5, 1
    s_mov_b32 s38, 0x4
    v_mad_u32_u24 v10, v14, s38, v10
    v_bfe_u32 v14, v0, 6, 1
    s_mov_b32 s38, 0x800
    v_mad_u32_u24 v10, v14, s38, v10
    v_bfe_u32 v14, v0, 7, 1
    s_mov_b32 s38, 0x1000
    v_mad_u32_u24 v10, v14, s38, v10
    v_mov_b32 v105, s20
    v_mov_b32 v104, 0x0
    v_bfe_u32 v14, v105, 0, 1
    s_mov_b32 s38, 0x100
    v_mad_u32_u24 v104, v14, s38, v104
    v_bfe_u32 v14, v105, 1, 1
    s_mov_b32 s38, 0x40
    v_mad_u32_u24 v104, v14, s38, v104
    v_bfe_u32 v14, v105, 2, 1
    s_mov_b32 s38, 0x80
    v_mad_u32_u24 v104, v14, s38, v104
    v_bfe_u32 v14, v105, 3, 1
    s_mov_b32 s38, 0x200
    v_mad_u32_u24 v104, v14, s38, v104
    v_bfe_u32 v14, v105, 4, 1
    s_mov_b32 s38, 0x400
    v_mad_u32_u24 v104, v14, s38, v104
    v_add_u32 v10, v104, v10
    v_and_b32 v104, 12, v0
    v_cmp_ne_u32 vcc, 0, v104
    v_mov_b32 v104, 0x40000000
    s_nop 0
    v_cndmask_b32 v10, v10, v104, vcc
    v_mov_b32 v13, 0x0
    v_bfe_u32 v14, v0, 0, 1
    s_mov_b32 s38, 0x10
    v_mad_u32_u24 v13, v14, s38, v13
    v_bfe_u32 v14, v0, 1, 1
    s_mov_b32 s38, 0x8
    v_mad_u32_u24 v13, v14, s38, v13
    v_bfe_u32 v14, v0, 2, 1
    s_mov_b32 s38, 0x20
    v_mad_u32_u24 v13, v14, s38, v13
    v_bfe_u32 v14, v0, 3, 1
    s_mov_b32 s38, 0x40
    v_mad_u32_u24 v13, v14, s38, v13
    v_bfe_u32 v14, v0, 4, 1
    s_mov_b32 s38, 0x80
    v_mad_u32_u24 v13, v14, s38, v13
    v_bfe_u32 v14, v0, 5, 1
    s_mov_b32 s38, 0x100
    v_mad_u32_u24 v13, v14, s38, v13
    v_bfe_u32 v14, v0, 6, 1
    s_mov_b32 s38, 0x800
    v_mad_u32_u24 v13, v14, s38, v13
    v_bfe_u32 v14, v0, 7, 1
    s_mov_b32 s38, 0x1000
    v_mad_u32_u24 v13, v14, s38, v13
    s_lshl_b32 s6, s20, 13
    s_add_u32 s6, s6, 0x0
    s_mov_b32 s26, 4096
    v_and_b32 v104, 15, v0
    v_mov_b32 v100, 0
    v_mov_b32 v105, 0x3f80
    v_cmp_eq_u32 vcc, 0, v104
    s_nop 1
    v_cndmask_b32 v100, v100, v105, vcc
    v_mov_b32 v105, 0x3f800000
    v_cmp_eq_u32 vcc, 1, v104
    s_nop 1
    v_cndmask_b32 v100, v100, v105, vcc
    v_mov_b32 v101, 0
    v_mov_b32 v105, 0x3f80
    v_cmp_eq_u32 vcc, 4, v104
    s_nop 1
    v_cndmask_b32 v101, v101, v105, vcc
    v_mov_b32 v105, 0x3f800000
    v_cmp_eq_u32 vcc, 5, v104
    s_nop 1
    v_cndmask_b32 v101, v101, v105, vcc
    v_mov_b32 v102, 0
    v_mov_b32 v105, 0x3f80
    v_cmp_eq_u32 vcc, 8, v104
    s_nop 1
    v_cndmask_b32 v102, v102, v105, vcc
    v_mov_b32 v105, 0x3f800000
    v_cmp_eq_u32 vcc, 9, v104
    s_nop 1
    v_cndmask_b32 v102, v102, v105, vcc
    v_mov_b32 v103, 0
    v_mov_b32 v105, 0x3f80
    v_cmp_eq_u32 vcc, 12, v104
    s_nop 1
    v_cndmask_b32 v103, v103, v105, vcc
    v_mov_b32 v105, 0x3f800000
    v_cmp_eq_u32 vcc, 13, v104
    s_nop 1
    v_cndmask_b32 v103, v103, v105, vcc
    ds_write_b128 v3, v[100:103] offset:23040
    s_mov_b32 s34, 0x05040100
    s_mov_b32 s35, 0x07060302
    s_mov_b32 s33, 0x3e0293ee
    s_mov_b32 s40, 0x4e800000
    s_mov_b32 s32, 0
    s_mov_b32 s4, 0x3f803f80
    s_mov_b32 s5, 0x3f803f80
    s_lshl_b32 s36, s20, 14
    s_lshr_b32 s37, s21, 1
    s_lshl_b32 s37, s37, 12
    s_add_u32 s25, s36, s37
    s_lshl_b32 s37, s21, 11
    s_add_u32 s39, s36, s37
    s_add_u32 s39, s39, 8192
    v_mov_b32 v104, 0x0
    v_bfe_u32 v14, v0, 0, 1
    s_mov_b32 s38, 0x80
    v_mad_u32_u24 v104, v14, s38, v104
    v_bfe_u32 v14, v0, 1, 1
    s_mov_b32 s38, 0x100
    v_mad_u32_u24 v104, v14, s38, v104
    v_bfe_u32 v14, v0, 2, 1
    s_mov_b32 s38, 0x200
    v_mad_u32_u24 v104, v14, s38, v104
    v_bfe_u32 v14, v0, 3, 1
    s_mov_b32 s38, 0x400
    v_mad_u32_u24 v104, v14, s38, v104
    v_bfe_u32 v14, v0, 4, 1
    s_mov_b32 s38, 0x800
    v_mad_u32_u24 v104, v14, s38, v104
    v_bfe_u32 v14, v0, 6, 1
    s_mov_b32 s38, 0x1000
    v_mad_u32_u24 v104, v14, s38, v104
    v_bfe_u32 v14, v0, 7, 1
    s_mov_b32 s38, 0x2000
    v_mad_u32_u24 v104, v14, s38, v104
    s_lshl_b32 s36, s20, 14
    v_add_u32 v104, s36, v104
    s_lshl_b32 s36, s20, 8
    s_lshr_b32 s37, s21, 1
    s_lshl_b32 s37, s37, 7
    s_add_u32 s36, s36, s37
    s_add_u32 s36, s36, 0x102100
    v_and_b32 v14, 63, v0
    v_mov_b32 v105, 0x40000000
    v_cmp_lt_u32 vcc, 32, v14
    s_nop 1
    v_cndmask_b32 v104, v104, v105, vcc
    v_mov_b32 v105, s36
    v_cmp_eq_u32 vcc, 32, v14
    s_nop 1
    v_cndmask_b32 v104, v104, v105, vcc
    s_lshl_b32 s36, s20, 2
    s_add_u32 s36, s36, 0x104100
    v_mov_b32 v105, s36
    v_cmp_eq_u32 vcc, 33, v14
    s_nop 1
    v_cndmask_b32 v0, v104, v105, vcc
    s_waitcnt vmcnt(34)
    s_barrier
    ds_read_b64_tr_b16 a[160:161], v20 offset:0
    ds_read_b64_tr_b16 a[162:163], v20 offset:512
    ds_read_b64_tr_b16 a[168:169], v21 offset:0
    ds_read_b64_tr_b16 a[170:171], v21 offset:512
    ds_read_b64_tr_b16 a[192:193], v22 offset:0
    ds_read_b64_tr_b16 a[194:195], v22 offset:512
    ds_read_b64_tr_b16 a[200:201], v23 offset:0
    ds_read_b64_tr_b16 a[202:203], v23 offset:512
    ds_read_b64_tr_b16 a[224:225], v24 offset:0
    ds_read_b64_tr_b16 a[226:227], v24 offset:512
    ds_read_b64_tr_b16 a[232:233], v25 offset:0
    ds_read_b64_tr_b16 a[234:235], v25 offset:512
    s_waitcnt lgkmcnt(4)
    ds_read_b64_tr_b16 v[128:129], v26 offset:0
    ds_read_b64_tr_b16 v[130:131], v26 offset:512
    ds_read_b64_tr_b16 v[136:137], v27 offset:0
    ds_read_b64_tr_b16 v[138:139], v27 offset:512
    s_waitcnt lgkmcnt(0)
    s_barrier
    s_add_u32 m0, s28, 32768
    s_add_u32 s37, s3, 0x300000
    buffer_load_dwordx4 v16, s[60:63], s37 offen lds
    s_add_u32 m0, s28, 36864
    s_add_u32 s37, s3, 0x320000
    buffer_load_dwordx4 v16, s[60:63], s37 offen lds
    s_add_u32 m0, s28, 65536
    s_add_u32 s37, s3, 0x340000
    buffer_load_dwordx4 v16, s[60:63], s37 offen lds
    s_add_u32 m0, s28, 69632
    s_add_u32 s37, s3, 0x360000
    buffer_load_dwordx4 v16, s[60:63], s37 offen lds
    s_add_u32 m0, s28, 98304
    s_add_u32 s37, s3, 0x380000
    buffer_load_dwordx4 v16, s[60:63], s37 offen lds
    s_add_u32 m0, s28, 102400
    s_add_u32 s37, s3, 0x3a0000
    buffer_load_dwordx4 v16, s[60:63], s37 offen lds
    s_add_u32 m0, s28, 131072
    s_add_u32 s37, s3, 0x3c0000
    buffer_load_dwordx4 v16, s[60:63], s37 offen lds
    s_add_u32 m0, s28, 135168
    s_add_u32 s37, s3, 0x3e0000
    buffer_load_dwordx4 v16, s[60:63], s37 offen lds
    s_xor_b32 s36, s21, 2
    s_lshl_b32 s36, s36, 15
    s_add_u32 s36, s36, s29
    s_add_u32 s37, s36, 0x80
    buffer_load_dword v48, v11, s[92:95], s37 offen
    s_add_u32 s37, s36, 0x4080
    buffer_load_dword v49, v11, s[92:95], s37 offen
    s_add_u32 s37, s36, 0x480
    buffer_load_dword v50, v11, s[92:95], s37 offen
    s_add_u32 s37, s36, 0x4480
    buffer_load_dword v51, v11, s[92:95], s37 offen
    s_add_u32 s37, s36, 0x2080
    buffer_load_dword v52, v11, s[92:95], s37 offen
    s_add_u32 s37, s36, 0x6080
    buffer_load_dword v53, v11, s[92:95], s37 offen
    s_add_u32 s37, s36, 0x2480
    buffer_load_dword v54, v11, s[92:95], s37 offen
    s_add_u32 s37, s36, 0x6480
    buffer_load_dword v55, v11, s[92:95], s37 offen
    s_add_u32 s37, s36, 0xc0
    buffer_load_dword v56, v11, s[92:95], s37 offen
    s_add_u32 s37, s36, 0x40c0
    buffer_load_dword v57, v11, s[92:95], s37 offen
    s_add_u32 s37, s36, 0x4c0
    buffer_load_dword v58, v11, s[92:95], s37 offen
    s_add_u32 s37, s36, 0x44c0
    buffer_load_dword v59, v11, s[92:95], s37 offen
    s_add_u32 s37, s36, 0x20c0
    buffer_load_dword v60, v11, s[92:95], s37 offen
    s_add_u32 s37, s36, 0x60c0
    buffer_load_dword v61, v11, s[92:95], s37 offen
    s_add_u32 s37, s36, 0x24c0
    buffer_load_dword v62, v11, s[92:95], s37 offen
    s_add_u32 s37, s36, 0x64c0
    buffer_load_dword v63, v11, s[92:95], s37 offen
    s_waitcnt vmcnt(50)
    s_barrier
    ds_read_b64_tr_b16 a[164:165], v20 offset:8192
    ds_read_b64_tr_b16 a[166:167], v20 offset:8704
    ds_read_b64_tr_b16 a[172:173], v21 offset:8192
    ds_read_b64_tr_b16 a[174:175], v21 offset:8704
    ds_read_b64_tr_b16 a[196:197], v22 offset:8192
    ds_read_b64_tr_b16 a[198:199], v22 offset:8704
    ds_read_b64_tr_b16 a[204:205], v23 offset:8192
    ds_read_b64_tr_b16 a[206:207], v23 offset:8704
    ds_read_b64_tr_b16 a[228:229], v24 offset:8192
    ds_read_b64_tr_b16 a[230:231], v24 offset:8704
    ds_read_b64_tr_b16 a[236:237], v25 offset:8192
    ds_read_b64_tr_b16 a[238:239], v25 offset:8704
    s_waitcnt lgkmcnt(4)
    ds_read_b64_tr_b16 v[132:133], v26 offset:8192
    ds_read_b64_tr_b16 v[134:135], v26 offset:8704
    ds_read_b64_tr_b16 v[140:141], v27 offset:8192
    ds_read_b64_tr_b16 v[142:143], v27 offset:8704
    s_waitcnt lgkmcnt(0)
    s_barrier
    s_mov_b32 s88, s50
    s_and_b32 s89, s51, 0xffff
    s_mov_b32 s90, 0x400000
    s_mov_b32 s91, 0x20000
    s_add_u32 m0, s28, 40960
    s_add_u32 s37, s3, 0x0
    buffer_load_dwordx4 v16, s[88:91], s37 offen lds
    s_add_u32 m0, s28, 45056
    s_add_u32 s37, s3, 0x20000
    buffer_load_dwordx4 v16, s[88:91], s37 offen lds
    s_add_u32 m0, s28, 73728
    s_add_u32 s37, s3, 0x40000
    buffer_load_dwordx4 v16, s[88:91], s37 offen lds
    s_add_u32 m0, s28, 77824
    s_add_u32 s37, s3, 0x60000
    buffer_load_dwordx4 v16, s[88:91], s37 offen lds
    s_add_u32 m0, s28, 106496
    s_add_u32 s37, s3, 0x80000
    buffer_load_dwordx4 v16, s[88:91], s37 offen lds
    s_add_u32 m0, s28, 110592
    s_add_u32 s37, s3, 0xa0000
    buffer_load_dwordx4 v16, s[88:91], s37 offen lds
    s_add_u32 m0, s28, 139264
    s_add_u32 s37, s3, 0xc0000
    buffer_load_dwordx4 v16, s[88:91], s37 offen lds
    s_add_u32 m0, s28, 143360
    s_add_u32 s37, s3, 0xe0000
    buffer_load_dwordx4 v16, s[88:91], s37 offen lds
    s_waitcnt vmcnt(34)
    v_perm_b32 v120, v33, v32, s34
    v_perm_b32 v121, v33, v32, s35
    v_perm_b32 v122, v35, v34, s34
    v_perm_b32 v123, v35, v34, s35
    v_perm_b32 v124, v37, v36, s34
    v_perm_b32 v125, v37, v36, s35
    v_perm_b32 v126, v39, v38, s34
    v_perm_b32 v127, v39, v38, s35
    ds_write_b128 v4, v[120:123] offset:24576
    ds_write_b128 v4, v[124:127] offset:25600
    s_waitcnt lgkmcnt(0)
    v_perm_b32 v120, v41, v40, s34
    v_perm_b32 v121, v41, v40, s35
    v_perm_b32 v122, v43, v42, s34
    v_perm_b32 v123, v43, v42, s35
    v_perm_b32 v124, v45, v44, s34
    v_perm_b32 v125, v45, v44, s35
    v_perm_b32 v126, v47, v46, s34
    v_perm_b32 v127, v47, v46, s35
    ds_write_b128 v4, v[120:123] offset:30720
    ds_write_b128 v4, v[124:127] offset:31744
    s_waitcnt lgkmcnt(0)
    s_xor_b32 s36, s21, 1
    s_lshl_b32 s36, s36, 15
    s_add_u32 s36, s36, s29
    s_add_u32 s37, s36, 0x80
    buffer_load_dword v80, v11, s[92:95], s37 offen
    s_add_u32 s37, s36, 0x4080
    buffer_load_dword v81, v11, s[92:95], s37 offen
    s_add_u32 s37, s36, 0x480
    buffer_load_dword v82, v11, s[92:95], s37 offen
    s_add_u32 s37, s36, 0x4480
    buffer_load_dword v83, v11, s[92:95], s37 offen
    s_add_u32 s37, s36, 0x2080
    buffer_load_dword v84, v11, s[92:95], s37 offen
    s_add_u32 s37, s36, 0x6080
    buffer_load_dword v85, v11, s[92:95], s37 offen
    s_add_u32 s37, s36, 0x2480
    buffer_load_dword v86, v11, s[92:95], s37 offen
    s_add_u32 s37, s36, 0x6480
    buffer_load_dword v87, v11, s[92:95], s37 offen
    s_add_u32 s37, s36, 0xc0
    buffer_load_dword v88, v11, s[92:95], s37 offen
    s_add_u32 s37, s36, 0x40c0
    buffer_load_dword v89, v11, s[92:95], s37 offen
    s_add_u32 s37, s36, 0x4c0
    buffer_load_dword v90, v11, s[92:95], s37 offen
    s_add_u32 s37, s36, 0x44c0
    buffer_load_dword v91, v11, s[92:95], s37 offen
    s_add_u32 s37, s36, 0x20c0
    buffer_load_dword v92, v11, s[92:95], s37 offen
    s_add_u32 s37, s36, 0x60c0
    buffer_load_dword v93, v11, s[92:95], s37 offen
    s_add_u32 s37, s36, 0x24c0
    buffer_load_dword v94, v11, s[92:95], s37 offen
    s_add_u32 s37, s36, 0x64c0
    buffer_load_dword v95, v11, s[92:95], s37 offen
    s_barrier
    ds_read_b64_tr_b16 a[176:177], v20 offset:16384
    ds_read_b64_tr_b16 a[178:179], v20 offset:16896
    ds_read_b64_tr_b16 a[184:185], v21 offset:16384
    ds_read_b64_tr_b16 a[186:187], v21 offset:16896
    ds_read_b64_tr_b16 a[208:209], v22 offset:16384
    ds_read_b64_tr_b16 a[210:211], v22 offset:16896
    ds_read_b64_tr_b16 a[216:217], v23 offset:16384
    ds_read_b64_tr_b16 a[218:219], v23 offset:16896
    ds_read_b64_tr_b16 a[240:241], v24 offset:16384
    ds_read_b64_tr_b16 a[242:243], v24 offset:16896
    ds_read_b64_tr_b16 a[248:249], v25 offset:16384
    ds_read_b64_tr_b16 a[250:251], v25 offset:16896
    s_waitcnt lgkmcnt(4)
    ds_read_b64_tr_b16 v[144:145], v26 offset:16384
    ds_read_b64_tr_b16 v[146:147], v26 offset:16896
    ds_read_b64_tr_b16 v[152:153], v27 offset:16384
    ds_read_b64_tr_b16 v[154:155], v27 offset:16896
    s_waitcnt lgkmcnt(0)
    s_barrier
    s_add_u32 m0, s28, 49152
    s_add_u32 s37, s3, 0x100000
    buffer_load_dwordx4 v16, s[88:91], s37 offen lds
    s_add_u32 m0, s28, 53248
    s_add_u32 s37, s3, 0x120000
    buffer_load_dwordx4 v16, s[88:91], s37 offen lds
    s_add_u32 m0, s28, 81920
    s_add_u32 s37, s3, 0x140000
    buffer_load_dwordx4 v16, s[88:91], s37 offen lds
    s_add_u32 m0, s28, 86016
    s_add_u32 s37, s3, 0x160000
    buffer_load_dwordx4 v16, s[88:91], s37 offen lds
    s_add_u32 m0, s28, 114688
    s_add_u32 s37, s3, 0x180000
    buffer_load_dwordx4 v16, s[88:91], s37 offen lds
    s_add_u32 m0, s28, 118784
    s_add_u32 s37, s3, 0x1a0000
    buffer_load_dwordx4 v16, s[88:91], s37 offen lds
    s_add_u32 m0, s28, 147456
    s_add_u32 s37, s3, 0x1c0000
    buffer_load_dwordx4 v16, s[88:91], s37 offen lds
    s_add_u32 m0, s28, 151552
    s_add_u32 s37, s3, 0x1e0000
    buffer_load_dwordx4 v16, s[88:91], s37 offen lds
    s_waitcnt vmcnt(32)
    v_perm_b32 v232, v49, v48, s34
    v_perm_b32 v233, v49, v48, s35
    v_perm_b32 v234, v51, v50, s34
    v_perm_b32 v235, v51, v50, s35
    v_perm_b32 v236, v53, v52, s34
    v_perm_b32 v237, v53, v52, s35
    v_perm_b32 v238, v55, v54, s34
    v_perm_b32 v239, v55, v54, s35
    v_perm_b32 v120, v57, v56, s34
    v_perm_b32 v121, v57, v56, s35
    v_perm_b32 v122, v59, v58, s34
    v_perm_b32 v123, v59, v58, s35
    v_perm_b32 v124, v61, v60, s34
    v_perm_b32 v125, v61, v60, s35
    v_perm_b32 v126, v63, v62, s34
    v_perm_b32 v127, v63, v62, s35
    ds_write_b128 v4, v[120:123] offset:28672
    ds_write_b128 v4, v[124:127] offset:29696
    s_waitcnt lgkmcnt(0)
    s_xor_b32 s36, s21, 3
    s_lshl_b32 s36, s36, 15
    s_add_u32 s36, s36, s29
    s_add_u32 s37, s36, 0x0
    buffer_load_dword v32, v11, s[92:95], s37 offen
    s_add_u32 s37, s36, 0x4000
    buffer_load_dword v33, v11, s[92:95], s37 offen
    s_add_u32 s37, s36, 0x400
    buffer_load_dword v34, v11, s[92:95], s37 offen
    s_add_u32 s37, s36, 0x4400
    buffer_load_dword v35, v11, s[92:95], s37 offen
    s_add_u32 s37, s36, 0x2000
    buffer_load_dword v36, v11, s[92:95], s37 offen
    s_add_u32 s37, s36, 0x6000
    buffer_load_dword v37, v11, s[92:95], s37 offen
    s_add_u32 s37, s36, 0x2400
    buffer_load_dword v38, v11, s[92:95], s37 offen
    s_add_u32 s37, s36, 0x6400
    buffer_load_dword v39, v11, s[92:95], s37 offen
    s_add_u32 s37, s36, 0x40
    buffer_load_dword v40, v11, s[92:95], s37 offen
    s_add_u32 s37, s36, 0x4040
    buffer_load_dword v41, v11, s[92:95], s37 offen
    s_add_u32 s37, s36, 0x440
    buffer_load_dword v42, v11, s[92:95], s37 offen
    s_add_u32 s37, s36, 0x4440
    buffer_load_dword v43, v11, s[92:95], s37 offen
    s_add_u32 s37, s36, 0x2040
    buffer_load_dword v44, v11, s[92:95], s37 offen
    s_add_u32 s37, s36, 0x6040
    buffer_load_dword v45, v11, s[92:95], s37 offen
    s_add_u32 s37, s36, 0x2440
    buffer_load_dword v46, v11, s[92:95], s37 offen
    s_add_u32 s37, s36, 0x6440
    buffer_load_dword v47, v11, s[92:95], s37 offen
    s_barrier
    ds_read_b64_tr_b16 a[180:181], v20 offset:0
    ds_read_b64_tr_b16 a[182:183], v20 offset:512
    ds_read_b64_tr_b16 a[188:189], v21 offset:0
    ds_read_b64_tr_b16 a[190:191], v21 offset:512
    ds_read_b64_tr_b16 a[212:213], v22 offset:0
    ds_read_b64_tr_b16 a[214:215], v22 offset:512
    ds_read_b64_tr_b16 a[220:221], v23 offset:0
    ds_read_b64_tr_b16 a[222:223], v23 offset:512
    ds_read_b64_tr_b16 a[244:245], v24 offset:0
    ds_read_b64_tr_b16 a[246:247], v24 offset:512
    ds_read_b64_tr_b16 a[252:253], v25 offset:0
    ds_read_b64_tr_b16 a[254:255], v25 offset:512
    s_waitcnt lgkmcnt(4)
    ds_read_b64_tr_b16 v[148:149], v26 offset:0
    ds_read_b64_tr_b16 v[150:151], v26 offset:512
    ds_read_b64_tr_b16 v[156:157], v27 offset:0
    ds_read_b64_tr_b16 v[158:159], v27 offset:512
    s_waitcnt lgkmcnt(0)
    s_barrier
    s_add_u32 m0, s28, 32768
    s_add_u32 s37, s3, 0x200000
    buffer_load_dwordx4 v16, s[88:91], s37 offen lds
    s_add_u32 m0, s28, 36864
    s_add_u32 s37, s3, 0x220000
    buffer_load_dwordx4 v16, s[88:91], s37 offen lds
    s_add_u32 m0, s28, 65536
    s_add_u32 s37, s3, 0x240000
    buffer_load_dwordx4 v16, s[88:91], s37 offen lds
    s_add_u32 m0, s28, 69632
    s_add_u32 s37, s3, 0x260000
    buffer_load_dwordx4 v16, s[88:91], s37 offen lds
    s_add_u32 m0, s28, 98304
    s_add_u32 s37, s3, 0x280000
    buffer_load_dwordx4 v16, s[88:91], s37 offen lds
    s_add_u32 m0, s28, 102400
    s_add_u32 s37, s3, 0x2a0000
    buffer_load_dwordx4 v16, s[88:91], s37 offen lds
    s_add_u32 m0, s28, 131072
    s_add_u32 s37, s3, 0x2c0000
    buffer_load_dwordx4 v16, s[88:91], s37 offen lds
    s_add_u32 m0, s28, 135168
    s_add_u32 s37, s3, 0x2e0000
    buffer_load_dwordx4 v16, s[88:91], s37 offen lds
    s_waitcnt vmcnt(32)
    v_perm_b32 v208, v81, v80, s34
    v_perm_b32 v209, v81, v80, s35
    v_perm_b32 v210, v83, v82, s34
    v_perm_b32 v211, v83, v82, s35
    v_perm_b32 v212, v85, v84, s34
    v_perm_b32 v213, v85, v84, s35
    v_perm_b32 v214, v87, v86, s34
    v_perm_b32 v215, v87, v86, s35
    v_perm_b32 v120, v89, v88, s34
    v_perm_b32 v121, v89, v88, s35
    v_perm_b32 v122, v91, v90, s34
    v_perm_b32 v123, v91, v90, s35
    v_perm_b32 v124, v93, v92, s34
    v_perm_b32 v125, v93, v92, s35
    v_perm_b32 v126, v95, v94, s34
    v_perm_b32 v127, v95, v94, s35
    ds_write_b128 v4, v[120:123] offset:26624
    ds_write_b128 v4, v[124:127] offset:27648
    s_waitcnt lgkmcnt(0)
    s_xor_b32 s36, s21, 2
    s_lshl_b32 s36, s36, 15
    s_add_u32 s36, s36, s29
    s_add_u32 s37, s36, 0x0
    buffer_load_dword v48, v11, s[92:95], s37 offen
    s_add_u32 s37, s36, 0x4000
    buffer_load_dword v49, v11, s[92:95], s37 offen
    s_add_u32 s37, s36, 0x400
    buffer_load_dword v50, v11, s[92:95], s37 offen
    s_add_u32 s37, s36, 0x4400
    buffer_load_dword v51, v11, s[92:95], s37 offen
    s_add_u32 s37, s36, 0x2000
    buffer_load_dword v52, v11, s[92:95], s37 offen
    s_add_u32 s37, s36, 0x6000
    buffer_load_dword v53, v11, s[92:95], s37 offen
    s_add_u32 s37, s36, 0x2400
    buffer_load_dword v54, v11, s[92:95], s37 offen
    s_add_u32 s37, s36, 0x6400
    buffer_load_dword v55, v11, s[92:95], s37 offen
    s_add_u32 s37, s36, 0x40
    buffer_load_dword v56, v11, s[92:95], s37 offen
    s_add_u32 s37, s36, 0x4040
    buffer_load_dword v57, v11, s[92:95], s37 offen
    s_add_u32 s37, s36, 0x440
    buffer_load_dword v58, v11, s[92:95], s37 offen
    s_add_u32 s37, s36, 0x4440
    buffer_load_dword v59, v11, s[92:95], s37 offen
    s_add_u32 s37, s36, 0x2040
    buffer_load_dword v60, v11, s[92:95], s37 offen
    s_add_u32 s37, s36, 0x6040
    buffer_load_dword v61, v11, s[92:95], s37 offen
    s_add_u32 s37, s36, 0x2440
    buffer_load_dword v62, v11, s[92:95], s37 offen
    s_add_u32 s37, s36, 0x6440
    buffer_load_dword v63, v11, s[92:95], s37 offen
    s_barrier
    ds_read_b64_tr_b16 v[64:65], v20 offset:8192
    ds_read_b64_tr_b16 v[66:67], v20 offset:8704
    ds_read_b64_tr_b16 v[72:73], v21 offset:8192
    ds_read_b64_tr_b16 v[74:75], v21 offset:8704
    ds_read_b64_tr_b16 v[96:97], v22 offset:8192
    ds_read_b64_tr_b16 v[98:99], v22 offset:8704
    ds_read_b64_tr_b16 v[104:105], v23 offset:8192
    ds_read_b64_tr_b16 v[106:107], v23 offset:8704
    ds_read_b64_tr_b16 a[112:113], v24 offset:8192
    ds_read_b64_tr_b16 a[114:115], v24 offset:8704
    ds_read_b64_tr_b16 a[120:121], v25 offset:8192
    ds_read_b64_tr_b16 a[122:123], v25 offset:8704
    s_waitcnt lgkmcnt(4)
    ds_read_b64_tr_b16 a[144:145], v26 offset:8192
    ds_read_b64_tr_b16 a[146:147], v26 offset:8704
    ds_read_b64_tr_b16 a[152:153], v27 offset:8192
    ds_read_b64_tr_b16 a[154:155], v27 offset:8704
    s_waitcnt lgkmcnt(0)
    s_barrier
    s_add_u32 m0, s28, 40960
    s_add_u32 s37, s3, 0x300000
    buffer_load_dwordx4 v16, s[88:91], s37 offen lds
    s_add_u32 m0, s28, 45056
    s_add_u32 s37, s3, 0x320000
    buffer_load_dwordx4 v16, s[88:91], s37 offen lds
    s_add_u32 m0, s28, 73728
    s_add_u32 s37, s3, 0x340000
    buffer_load_dwordx4 v16, s[88:91], s37 offen lds
    s_add_u32 m0, s28, 77824
    s_add_u32 s37, s3, 0x360000
    buffer_load_dwordx4 v16, s[88:91], s37 offen lds
    s_add_u32 m0, s28, 106496
    s_add_u32 s37, s3, 0x380000
    buffer_load_dwordx4 v16, s[88:91], s37 offen lds
    s_add_u32 m0, s28, 110592
    s_add_u32 s37, s3, 0x3a0000
    buffer_load_dwordx4 v16, s[88:91], s37 offen lds
    s_add_u32 m0, s28, 139264
    s_add_u32 s37, s3, 0x3c0000
    buffer_load_dwordx4 v16, s[88:91], s37 offen lds
    s_add_u32 m0, s28, 143360
    s_add_u32 s37, s3, 0x3e0000
    buffer_load_dwordx4 v16, s[88:91], s37 offen lds
    s_waitcnt vmcnt(32)
    v_perm_b32 v240, v33, v32, s34
    v_perm_b32 v241, v33, v32, s35
    v_perm_b32 v242, v35, v34, s34
    v_perm_b32 v243, v35, v34, s35
    v_perm_b32 v244, v37, v36, s34
    v_perm_b32 v245, v37, v36, s35
    v_perm_b32 v246, v39, v38, s34
    v_perm_b32 v247, v39, v38, s35
    v_perm_b32 v248, v41, v40, s34
    v_perm_b32 v249, v41, v40, s35
    v_perm_b32 v250, v43, v42, s34
    v_perm_b32 v251, v43, v42, s35
    v_perm_b32 v252, v45, v44, s34
    v_perm_b32 v253, v45, v44, s35
    v_perm_b32 v254, v47, v46, s34
    v_perm_b32 v255, v47, v46, s35
    s_xor_b32 s36, s21, 1
    s_lshl_b32 s36, s36, 15
    s_add_u32 s36, s36, s29
    s_add_u32 s37, s36, 0x0
    buffer_load_dword v80, v11, s[92:95], s37 offen
    s_add_u32 s37, s36, 0x4000
    buffer_load_dword v81, v11, s[92:95], s37 offen
    s_add_u32 s37, s36, 0x400
    buffer_load_dword v82, v11, s[92:95], s37 offen
    s_add_u32 s37, s36, 0x4400
    buffer_load_dword v83, v11, s[92:95], s37 offen
    s_add_u32 s37, s36, 0x2000
    buffer_load_dword v84, v11, s[92:95], s37 offen
    s_add_u32 s37, s36, 0x6000
    buffer_load_dword v85, v11, s[92:95], s37 offen
    s_add_u32 s37, s36, 0x2400
    buffer_load_dword v86, v11, s[92:95], s37 offen
    s_add_u32 s37, s36, 0x6400
    buffer_load_dword v87, v11, s[92:95], s37 offen
    s_add_u32 s37, s36, 0x40
    buffer_load_dword v88, v11, s[92:95], s37 offen
    s_add_u32 s37, s36, 0x4040
    buffer_load_dword v89, v11, s[92:95], s37 offen
    s_add_u32 s37, s36, 0x440
    buffer_load_dword v90, v11, s[92:95], s37 offen
    s_add_u32 s37, s36, 0x4440
    buffer_load_dword v91, v11, s[92:95], s37 offen
    s_add_u32 s37, s36, 0x2040
    buffer_load_dword v92, v11, s[92:95], s37 offen
    s_add_u32 s37, s36, 0x6040
    buffer_load_dword v93, v11, s[92:95], s37 offen
    s_add_u32 s37, s36, 0x2440
    buffer_load_dword v94, v11, s[92:95], s37 offen
    s_add_u32 s37, s36, 0x6440
    buffer_load_dword v95, v11, s[92:95], s37 offen
    s_barrier
    ds_read_b64_tr_b16 v[68:69], v20 offset:16384
    ds_read_b64_tr_b16 v[70:71], v20 offset:16896
    ds_read_b64_tr_b16 v[76:77], v21 offset:16384
    ds_read_b64_tr_b16 v[78:79], v21 offset:16896
    ds_read_b64_tr_b16 v[100:101], v22 offset:16384
    ds_read_b64_tr_b16 v[102:103], v22 offset:16896
    ds_read_b64_tr_b16 v[108:109], v23 offset:16384
    ds_read_b64_tr_b16 v[110:111], v23 offset:16896
    ds_read_b64_tr_b16 a[116:117], v24 offset:16384
    ds_read_b64_tr_b16 a[118:119], v24 offset:16896
    ds_read_b64_tr_b16 a[124:125], v25 offset:16384
    ds_read_b64_tr_b16 a[126:127], v25 offset:16896
    s_waitcnt lgkmcnt(4)
    ds_read_b64_tr_b16 a[148:149], v26 offset:16384
    ds_read_b64_tr_b16 a[150:151], v26 offset:16896
    ds_read_b64_tr_b16 a[156:157], v27 offset:16384
    ds_read_b64_tr_b16 a[158:159], v27 offset:16896
    s_waitcnt lgkmcnt(0)
    s_barrier
    s_mov_b32 s96, s48
    s_and_b32 s97, s49, 0xffff
    s_mov_b32 s98, 0x400000
    s_mov_b32 s99, 0x20000
    s_add_u32 m0, s28, 49152
    s_add_u32 s37, s3, 0x0
    buffer_load_dwordx4 v16, s[96:99], s37 offen lds
    s_add_u32 m0, s28, 53248
    s_add_u32 s37, s3, 0x20000
    buffer_load_dwordx4 v16, s[96:99], s37 offen lds
    s_add_u32 m0, s28, 81920
    s_add_u32 s37, s3, 0x40000
    buffer_load_dwordx4 v16, s[96:99], s37 offen lds
    s_add_u32 m0, s28, 86016
    s_add_u32 s37, s3, 0x60000
    buffer_load_dwordx4 v16, s[96:99], s37 offen lds
    s_add_u32 m0, s28, 114688
    s_add_u32 s37, s3, 0x80000
    buffer_load_dwordx4 v16, s[96:99], s37 offen lds
    s_add_u32 m0, s28, 118784
    s_add_u32 s37, s3, 0xa0000
    buffer_load_dwordx4 v16, s[96:99], s37 offen lds
    s_add_u32 m0, s28, 147456
    s_add_u32 s37, s3, 0xc0000
    buffer_load_dwordx4 v16, s[96:99], s37 offen lds
    s_add_u32 m0, s28, 151552
    s_add_u32 s37, s3, 0xe0000
    buffer_load_dwordx4 v16, s[96:99], s37 offen lds
    s_waitcnt vmcnt(32)
    v_perm_b32 v216, v49, v48, s34
    v_perm_b32 v217, v49, v48, s35
    v_perm_b32 v218, v51, v50, s34
    v_perm_b32 v219, v51, v50, s35
    v_perm_b32 v220, v53, v52, s34
    v_perm_b32 v221, v53, v52, s35
    v_perm_b32 v222, v55, v54, s34
    v_perm_b32 v223, v55, v54, s35
    v_perm_b32 v224, v57, v56, s34
    v_perm_b32 v225, v57, v56, s35
    v_perm_b32 v226, v59, v58, s34
    v_perm_b32 v227, v59, v58, s35
    v_perm_b32 v228, v61, v60, s34
    v_perm_b32 v229, v61, v60, s35
    v_perm_b32 v230, v63, v62, s34
    v_perm_b32 v231, v63, v62, s35
    s_xor_b32 s36, s21, 0
    s_lshl_b32 s36, s36, 15
    s_add_u32 s36, s36, s29
    s_add_u32 s37, s36, 0x80
    buffer_load_dword v32, v11, s[92:95], s37 offen
    s_add_u32 s37, s36, 0x4080
    buffer_load_dword v33, v11, s[92:95], s37 offen
    s_add_u32 s37, s36, 0x480
    buffer_load_dword v34, v11, s[92:95], s37 offen
    s_add_u32 s37, s36, 0x4480
    buffer_load_dword v35, v11, s[92:95], s37 offen
    s_add_u32 s37, s36, 0x2080
    buffer_load_dword v36, v11, s[92:95], s37 offen
    s_add_u32 s37, s36, 0x6080
    buffer_load_dword v37, v11, s[92:95], s37 offen
    s_add_u32 s37, s36, 0x2480
    buffer_load_dword v38, v11, s[92:95], s37 offen
    s_add_u32 s37, s36, 0x6480
    buffer_load_dword v39, v11, s[92:95], s37 offen
    s_add_u32 s37, s36, 0xc0
    buffer_load_dword v40, v11, s[92:95], s37 offen
    s_add_u32 s37, s36, 0x40c0
    buffer_load_dword v41, v11, s[92:95], s37 offen
    s_add_u32 s37, s36, 0x4c0
    buffer_load_dword v42, v11, s[92:95], s37 offen
    s_add_u32 s37, s36, 0x44c0
    buffer_load_dword v43, v11, s[92:95], s37 offen
    s_add_u32 s37, s36, 0x20c0
    buffer_load_dword v44, v11, s[92:95], s37 offen
    s_add_u32 s37, s36, 0x60c0
    buffer_load_dword v45, v11, s[92:95], s37 offen
    s_add_u32 s37, s36, 0x24c0
    buffer_load_dword v46, v11, s[92:95], s37 offen
    s_add_u32 s37, s36, 0x64c0
    buffer_load_dword v47, v11, s[92:95], s37 offen
    s_barrier
    ds_read_b64_tr_b16 a[80:81], v20 offset:0
    ds_read_b64_tr_b16 a[82:83], v20 offset:512
    ds_read_b64_tr_b16 a[88:89], v21 offset:0
    ds_read_b64_tr_b16 a[90:91], v21 offset:512
    ds_read_b64_tr_b16 a[96:97], v22 offset:0
    ds_read_b64_tr_b16 a[98:99], v22 offset:512
    ds_read_b64_tr_b16 a[104:105], v23 offset:0
    ds_read_b64_tr_b16 a[106:107], v23 offset:512
    ds_read_b64_tr_b16 a[128:129], v24 offset:0
    ds_read_b64_tr_b16 a[130:131], v24 offset:512
    ds_read_b64_tr_b16 a[136:137], v25 offset:0
    ds_read_b64_tr_b16 a[138:139], v25 offset:512
    s_waitcnt lgkmcnt(4)
    ds_read_b64_tr_b16 v[112:113], v26 offset:0
    ds_read_b64_tr_b16 v[114:115], v26 offset:512
    ds_read_b64_tr_b16 v[120:121], v27 offset:0
    ds_read_b64_tr_b16 v[122:123], v27 offset:512
    s_waitcnt lgkmcnt(0)
    s_barrier
    s_add_u32 m0, s28, 32768
    s_add_u32 s37, s3, 0x100000
    buffer_load_dwordx4 v16, s[96:99], s37 offen lds
    s_add_u32 m0, s28, 36864
    s_add_u32 s37, s3, 0x120000
    buffer_load_dwordx4 v16, s[96:99], s37 offen lds
    s_add_u32 m0, s28, 65536
    s_add_u32 s37, s3, 0x140000
    buffer_load_dwordx4 v16, s[96:99], s37 offen lds
    s_add_u32 m0, s28, 69632
    s_add_u32 s37, s3, 0x160000
    buffer_load_dwordx4 v16, s[96:99], s37 offen lds
    s_add_u32 m0, s28, 98304
    s_add_u32 s37, s3, 0x180000
    buffer_load_dwordx4 v16, s[96:99], s37 offen lds
    s_add_u32 m0, s28, 102400
    s_add_u32 s37, s3, 0x1a0000
    buffer_load_dwordx4 v16, s[96:99], s37 offen lds
    s_add_u32 m0, s28, 131072
    s_add_u32 s37, s3, 0x1c0000
    buffer_load_dwordx4 v16, s[96:99], s37 offen lds
    s_add_u32 m0, s28, 135168
    s_add_u32 s37, s3, 0x1e0000
    buffer_load_dwordx4 v16, s[96:99], s37 offen lds
    s_waitcnt vmcnt(32)
    v_perm_b32 v192, v81, v80, s34
    v_perm_b32 v193, v81, v80, s35
    v_perm_b32 v194, v83, v82, s34
    v_perm_b32 v195, v83, v82, s35
    v_perm_b32 v196, v85, v84, s34
    v_perm_b32 v197, v85, v84, s35
    v_perm_b32 v198, v87, v86, s34
    v_perm_b32 v199, v87, v86, s35
    v_perm_b32 v200, v89, v88, s34
    v_perm_b32 v201, v89, v88, s35
    v_perm_b32 v202, v91, v90, s34
    v_perm_b32 v203, v91, v90, s35
    v_perm_b32 v204, v93, v92, s34
    v_perm_b32 v205, v93, v92, s35
    v_perm_b32 v206, v95, v94, s34
    v_perm_b32 v207, v95, v94, s35
    s_xor_b32 s36, s21, 0
    s_lshl_b32 s36, s36, 15
    s_add_u32 s36, s36, s29
    s_add_u32 s37, s36, 0x0
    buffer_load_dword v48, v11, s[92:95], s37 offen
    s_add_u32 s37, s36, 0x4000
    buffer_load_dword v49, v11, s[92:95], s37 offen
    s_add_u32 s37, s36, 0x400
    buffer_load_dword v50, v11, s[92:95], s37 offen
    s_add_u32 s37, s36, 0x4400
    buffer_load_dword v51, v11, s[92:95], s37 offen
    s_add_u32 s37, s36, 0x2000
    buffer_load_dword v52, v11, s[92:95], s37 offen
    s_add_u32 s37, s36, 0x6000
    buffer_load_dword v53, v11, s[92:95], s37 offen
    s_add_u32 s37, s36, 0x2400
    buffer_load_dword v54, v11, s[92:95], s37 offen
    s_add_u32 s37, s36, 0x6400
    buffer_load_dword v55, v11, s[92:95], s37 offen
    s_add_u32 s37, s36, 0x40
    buffer_load_dword v56, v11, s[92:95], s37 offen
    s_add_u32 s37, s36, 0x4040
    buffer_load_dword v57, v11, s[92:95], s37 offen
    s_add_u32 s37, s36, 0x440
    buffer_load_dword v58, v11, s[92:95], s37 offen
    s_add_u32 s37, s36, 0x4440
    buffer_load_dword v59, v11, s[92:95], s37 offen
    s_add_u32 s37, s36, 0x2040
    buffer_load_dword v60, v11, s[92:95], s37 offen
    s_add_u32 s37, s36, 0x6040
    buffer_load_dword v61, v11, s[92:95], s37 offen
    s_add_u32 s37, s36, 0x2440
    buffer_load_dword v62, v11, s[92:95], s37 offen
    s_add_u32 s37, s36, 0x6440
    buffer_load_dword v63, v11, s[92:95], s37 offen
    s_barrier
    ds_read_b64_tr_b16 a[84:85], v20 offset:8192
    ds_read_b64_tr_b16 a[86:87], v20 offset:8704
    ds_read_b64_tr_b16 a[92:93], v21 offset:8192
    ds_read_b64_tr_b16 a[94:95], v21 offset:8704
    ds_read_b64_tr_b16 a[100:101], v22 offset:8192
    ds_read_b64_tr_b16 a[102:103], v22 offset:8704
    ds_read_b64_tr_b16 a[108:109], v23 offset:8192
    ds_read_b64_tr_b16 a[110:111], v23 offset:8704
    ds_read_b64_tr_b16 a[132:133], v24 offset:8192
    ds_read_b64_tr_b16 a[134:135], v24 offset:8704
    ds_read_b64_tr_b16 a[140:141], v25 offset:8192
    ds_read_b64_tr_b16 a[142:143], v25 offset:8704
    s_waitcnt lgkmcnt(4)
    ds_read_b64_tr_b16 v[116:117], v26 offset:8192
    ds_read_b64_tr_b16 v[118:119], v26 offset:8704
    ds_read_b64_tr_b16 v[124:125], v27 offset:8192
    ds_read_b64_tr_b16 v[126:127], v27 offset:8704
    s_waitcnt lgkmcnt(0)
    s_barrier
    s_add_u32 m0, s28, 40960
    s_add_u32 s37, s3, 0x200000
    buffer_load_dwordx4 v16, s[96:99], s37 offen lds
    s_add_u32 m0, s28, 45056
    s_add_u32 s37, s3, 0x220000
    buffer_load_dwordx4 v16, s[96:99], s37 offen lds
    s_add_u32 m0, s28, 73728
    s_add_u32 s37, s3, 0x240000
    buffer_load_dwordx4 v16, s[96:99], s37 offen lds
    s_add_u32 m0, s28, 77824
    s_add_u32 s37, s3, 0x260000
    buffer_load_dwordx4 v16, s[96:99], s37 offen lds
    s_add_u32 m0, s28, 106496
    s_add_u32 s37, s3, 0x280000
    buffer_load_dwordx4 v16, s[96:99], s37 offen lds
    s_add_u32 m0, s28, 110592
    s_add_u32 s37, s3, 0x2a0000
    buffer_load_dwordx4 v16, s[96:99], s37 offen lds
    s_add_u32 m0, s28, 139264
    s_add_u32 s37, s3, 0x2c0000
    buffer_load_dwordx4 v16, s[96:99], s37 offen lds
    s_add_u32 m0, s28, 143360
    s_add_u32 s37, s3, 0x2e0000
    buffer_load_dwordx4 v16, s[96:99], s37 offen lds
    s_waitcnt vmcnt(32)
    v_perm_b32 v176, v33, v32, s34
    v_perm_b32 v177, v33, v32, s35
    v_perm_b32 v178, v35, v34, s34
    v_perm_b32 v179, v35, v34, s35
    v_perm_b32 v180, v37, v36, s34
    v_perm_b32 v181, v37, v36, s35
    v_perm_b32 v182, v39, v38, s34
    v_perm_b32 v183, v39, v38, s35
    v_perm_b32 v184, v41, v40, s34
    v_perm_b32 v185, v41, v40, s35
    v_perm_b32 v186, v43, v42, s34
    v_perm_b32 v187, v43, v42, s35
    v_perm_b32 v188, v45, v44, s34
    v_perm_b32 v189, v45, v44, s35
    v_perm_b32 v190, v47, v46, s34
    v_perm_b32 v191, v47, v46, s35
    v_lshrrev_b32 v31, 2, v3
    buffer_load_dword v30, v31, s[16:19], 0 offen sc1
    s_barrier
    ds_read_b64_tr_b16 v[32:33], v20 offset:16384
    ds_read_b64_tr_b16 v[34:35], v20 offset:16896
    ds_read_b64_tr_b16 v[40:41], v21 offset:16384
    ds_read_b64_tr_b16 v[42:43], v21 offset:16896
    ds_read_b64_tr_b16 a[0:1], v22 offset:16384
    ds_read_b64_tr_b16 a[2:3], v22 offset:16896
    ds_read_b64_tr_b16 a[8:9], v23 offset:16384
    ds_read_b64_tr_b16 a[10:11], v23 offset:16896
    ds_read_b64_tr_b16 a[32:33], v24 offset:16384
    ds_read_b64_tr_b16 a[34:35], v24 offset:16896
    ds_read_b64_tr_b16 a[40:41], v25 offset:16384
    ds_read_b64_tr_b16 a[42:43], v25 offset:16896
    s_waitcnt lgkmcnt(4)
    ds_read_b64_tr_b16 a[64:65], v26 offset:16384
    ds_read_b64_tr_b16 a[66:67], v26 offset:16896
    ds_read_b64_tr_b16 a[72:73], v27 offset:16384
    ds_read_b64_tr_b16 a[74:75], v27 offset:16896
    s_waitcnt lgkmcnt(0)
    s_barrier
    s_add_u32 m0, s28, 49152
    s_add_u32 s37, s3, 0x300000
    buffer_load_dwordx4 v16, s[96:99], s37 offen lds
    s_add_u32 m0, s28, 53248
    s_add_u32 s37, s3, 0x320000
    buffer_load_dwordx4 v16, s[96:99], s37 offen lds
    s_add_u32 m0, s28, 81920
    s_add_u32 s37, s3, 0x340000
    buffer_load_dwordx4 v16, s[96:99], s37 offen lds
    s_add_u32 m0, s28, 86016
    s_add_u32 s37, s3, 0x360000
    buffer_load_dwordx4 v16, s[96:99], s37 offen lds
    s_add_u32 m0, s28, 114688
    s_add_u32 s37, s3, 0x380000
    buffer_load_dwordx4 v16, s[96:99], s37 offen lds
    s_add_u32 m0, s28, 118784
    s_add_u32 s37, s3, 0x3a0000
    buffer_load_dwordx4 v16, s[96:99], s37 offen lds
    s_add_u32 m0, s28, 147456
    s_add_u32 s37, s3, 0x3c0000
    buffer_load_dwordx4 v16, s[96:99], s37 offen lds
    s_add_u32 m0, s28, 151552
    s_add_u32 s37, s3, 0x3e0000
    buffer_load_dwordx4 v16, s[96:99], s37 offen lds
    s_waitcnt vmcnt(17)
    v_perm_b32 v160, v49, v48, s34
    v_perm_b32 v161, v49, v48, s35
    v_perm_b32 v162, v51, v50, s34
    v_perm_b32 v163, v51, v50, s35
    v_perm_b32 v164, v53, v52, s34
    v_perm_b32 v165, v53, v52, s35
    v_perm_b32 v166, v55, v54, s34
    v_perm_b32 v167, v55, v54, s35
    v_perm_b32 v168, v57, v56, s34
    v_perm_b32 v169, v57, v56, s35
    v_perm_b32 v170, v59, v58, s34
    v_perm_b32 v171, v59, v58, s35
    v_perm_b32 v172, v61, v60, s34
    v_perm_b32 v173, v61, v60, s35
    v_perm_b32 v174, v63, v62, s34
    v_perm_b32 v175, v63, v62, s35
    s_waitcnt vmcnt(8)
    s_mov_b32 s41, 1
L_HS:
    v_cmp_eq_u32 vcc, 0, v30
    s_cbranch_vccz L_HS_ok
    buffer_load_dword v30, v31, s[16:19], 0 offen sc1
    s_add_u32 s32, s32, 1
    s_cmp_gt_u32 s32, 200000
    s_waitcnt vmcnt(0)
    s_cbranch_scc0 L_HS
    s_branch L_HS_done
L_HS_ok:
    v_readlane_b32 s36, v30, 63
    s_nop 1
    v_cmp_ne_u32 vcc, s36, v30
    s_nop 1
    s_cmp_lg_u32 vcc_hi, 0
    s_cselect_b32 s41, 1, 0
L_HS_done:
    s_mov_b32 s7, 0xf7df00
    buffer_load_dword v15, v0, s[8:11], s7 offen sc1
    s_barrier
    ds_read_b64_tr_b16 v[36:37], v20 offset:0
    ds_read_b64_tr_b16 v[38:39], v20 offset:512
    ds_read_b64_tr_b16 v[44:45], v21 offset:0
    ds_read_b64_tr_b16 v[46:47], v21 offset:512
    ds_read_b64_tr_b16 a[4:5], v22 offset:0
    ds_read_b64_tr_b16 a[6:7], v22 offset:512
    ds_read_b64_tr_b16 a[12:13], v23 offset:0
    ds_read_b64_tr_b16 a[14:15], v23 offset:512
    ds_read_b64_tr_b16 a[36:37], v24 offset:0
    ds_read_b64_tr_b16 a[38:39], v24 offset:512
    ds_read_b64_tr_b16 a[44:45], v25 offset:0
    ds_read_b64_tr_b16 a[46:47], v25 offset:512
    s_waitcnt lgkmcnt(4)
    ds_read_b64_tr_b16 a[68:69], v26 offset:0
    ds_read_b64_tr_b16 a[70:71], v26 offset:512
    ds_read_b64_tr_b16 a[76:77], v27 offset:0
    ds_read_b64_tr_b16 a[78:79], v27 offset:512
    s_waitcnt lgkmcnt(0)
    s_barrier
    s_barrier
    ds_read_b64_tr_b16 v[48:49], v20 offset:8192
    ds_read_b64_tr_b16 v[50:51], v20 offset:8704
    ds_read_b64_tr_b16 v[56:57], v21 offset:8192
    ds_read_b64_tr_b16 v[58:59], v21 offset:8704
    ds_read_b64_tr_b16 a[16:17], v22 offset:8192
    ds_read_b64_tr_b16 a[18:19], v22 offset:8704
    ds_read_b64_tr_b16 a[24:25], v23 offset:8192
    ds_read_b64_tr_b16 a[26:27], v23 offset:8704
    ds_read_b64_tr_b16 a[48:49], v24 offset:8192
    ds_read_b64_tr_b16 a[50:51], v24 offset:8704
    ds_read_b64_tr_b16 a[56:57], v25 offset:8192
    ds_read_b64_tr_b16 a[58:59], v25 offset:8704
    s_waitcnt lgkmcnt(4)
    ds_read_b64_tr_b16 v[80:81], v26 offset:8192
    ds_read_b64_tr_b16 v[82:83], v26 offset:8704
    ds_read_b64_tr_b16 v[88:89], v27 offset:8192
    ds_read_b64_tr_b16 v[90:91], v27 offset:8704
    s_waitcnt lgkmcnt(0)
    s_barrier
    s_waitcnt vmcnt(0)
L_F0:
    v_readlane_b32 s36, v15, 33
    s_nop 1
    s_cmp_lg_u32 s36, 0
    s_cbranch_scc1 L_F0_ok
    buffer_load_dword v15, v0, s[8:11], s7 offen sc1
    s_add_u32 s32, s32, 1
    s_cmp_gt_u32 s32, 200000
    s_waitcnt vmcnt(0)
    s_cbranch_scc0 L_F0
L_F0_ok:
    s_mov_b32 s7, 0x1000000
    buffer_load_dword v15, v0, s[8:11], s7 offen sc1
    s_barrier
    ds_read_b64_tr_b16 v[52:53], v20 offset:16384
    ds_read_b64_tr_b16 v[54:55], v20 offset:16896
    ds_read_b64_tr_b16 v[60:61], v21 offset:16384
    ds_read_b64_tr_b16 v[62:63], v21 offset:16896
    ds_read_b64_tr_b16 a[20:21], v22 offset:16384
    ds_read_b64_tr_b16 a[22:23], v22 offset:16896
    ds_read_b64_tr_b16 a[28:29], v23 offset:16384
    ds_read_b64_tr_b16 a[30:31], v23 offset:16896
    ds_read_b64_tr_b16 a[52:53], v24 offset:16384
    ds_read_b64_tr_b16 a[54:55], v24 offset:16896
    ds_read_b64_tr_b16 a[60:61], v25 offset:16384
    ds_read_b64_tr_b16 a[62:63], v25 offset:16896
    s_waitcnt lgkmcnt(4)
    ds_read_b64_tr_b16 v[84:85], v26 offset:16384
    ds_read_b64_tr_b16 v[86:87], v26 offset:16896
    ds_read_b64_tr_b16 v[92:93], v27 offset:16384
    ds_read_b64_tr_b16 v[94:95], v27 offset:16896
    s_waitcnt lgkmcnt(0)
    s_barrier
    ds_write_b128 v4, v[32:35] offset:0
    ds_write_b128 v4, v[36:39] offset:1024
    ds_write_b128 v4, v[40:43] offset:2048
    ds_write_b128 v4, v[44:47] offset:3072
    ds_write_b128 v4, v[48:51] offset:4096
    ds_write_b128 v4, v[52:55] offset:5120
    ds_write_b128 v4, v[56:59] offset:6144
    ds_write_b128 v4, v[60:63] offset:7168
    s_waitcnt lgkmcnt(0)
    ds_write_b128 v4, v[64:67] offset:8192
    ds_write_b128 v4, v[68:71] offset:9216
    ds_write_b128 v4, v[72:75] offset:10240
    ds_write_b128 v4, v[76:79] offset:11264
    ds_write_b128 v4, v[80:83] offset:12288
    ds_write_b128 v4, v[84:87] offset:13312
    ds_write_b128 v4, v[88:91] offset:14336
    ds_write_b128 v4, v[92:95] offset:15360
    s_waitcnt lgkmcnt(0)
    ds_write_b128 v4, v[96:99] offset:16384
    ds_write_b128 v4, v[100:103] offset:17408
    ds_write_b128 v4, v[104:107] offset:18432
    ds_write_b128 v4, v[108:111] offset:19456
    ds_write_b128 v4, v[112:115] offset:20480
    ds_write_b128 v4, v[116:119] offset:21504
    ds_write_b128 v4, v[120:123] offset:22528
    ds_write_b128 v4, v[124:127] offset:23552
    s_waitcnt lgkmcnt(0)
    s_waitcnt lgkmcnt(0)
    s_cmp_lg_u32 s41, 0
    s_cbranch_scc1 L_slow_start
L_fast_start:
    s_mov_b32 s22, 0
    s_mov_b32 s23, 0x1000000
    s_mov_b32 s27, 0
    s_mov_b32 s31, 0x80000
    s_mov_b32 s61, 0x40000000
    s_mov_b32 s96, 0x800
    s_mov_b32 s97, 0x1000
    s_mov_b32 s98, 0x1800
    s_mov_b32 s92, 0xcccccccc
    s_mov_b32 s93, 0xcccccccc
    s_mov_b32 s91, 0
    ds_read_b128 v[104:107], v4 offset:0
    ds_read_b128 v[108:111], v4 offset:1024
    ds_read_b128 v[112:115], v4 offset:2048
    ds_read_b128 v[116:119], v4 offset:3072
    ds_read_b128 v[88:91], v4 offset:4096
    ds_read_b128 v[92:95], v4 offset:5120
    ds_read_b128 v[96:99], v4 offset:6144
    ds_read_b128 v[100:103], v4 offset:7168
    ds_read_b128 v[72:75], v4 offset:8192
    ds_read_b128 v[76:79], v4 offset:9216
    ds_read_b128 v[80:83], v4 offset:10240
    ds_read_b128 v[84:87], v4 offset:11264
    v_mov_b64 v[48:49], 0
    v_mov_b64 v[50:51], 0
    v_mov_b64 v[52:53], 0
    v_mov_b64 v[54:55], 0
    v_mov_b64 v[56:57], 0
    v_mov_b64 v[58:59], 0
    v_mov_b64 v[60:61], 0
    v_mov_b64 v[62:63], 0
    v_mov_b64 v[64:65], 0
    v_mov_b64 v[66:67], 0
    v_mov_b64 v[68:69], 0
    v_mov_b64 v[70:71], 0
    s_add_u32 s7, s23, 0x80000
    buffer_load_dwordx4 v[16:19], v2, s[8:11], s7 offen sc1
    buffer_load_dwordx4 v[20:23], v2, s[8:11], s7 offen offset:1024 sc1
    s_waitcnt vmcnt(2)
L_fast_step:
    v_readlane_b32 s36, v15, 33
    s_add_u32 s24, s23, 0x82100
    s_cmp_eq_u32 s36, 0
    s_cbranch_scc1 L_fast_refresh
L_fast_fresh:
    s_add_u32 s29, s23, s25
    s_add_u32 s30, s23, s39
    s_xor_b32 s28, s27, 1
    s_add_u32 s90, s22, 1
    s_nop 15
L_fast_retrym:
    buffer_load_dwordx4 v[16:19], v2, s[8:11], s7 offen sc1
    buffer_load_dwordx4 v[20:23], v2, s[8:11], s7 offen offset:1024 sc1
L_fast_prem:
    s_add_u32 s32, s32, 1
    s_cmp_gt_u32 s32, 200000
    s_cselect_b32 s94, -1, -2
    v_xor_b32 v28, 0x800, v2
    v_xor_b32 v44, 0x1800, v2
    v_mov_b64 v[48:49], 0
    v_mov_b64 v[50:51], 0
    v_mov_b64 v[52:53], 0
    v_mov_b64 v[54:55], 0
L_fast_waitm:
    s_waitcnt vmcnt(3) lgkmcnt(0)
L_fast_gotm:
    v_max3_u32 v14, v16, v17, v18
    v_max_u32 v14, v14, v19
    v_smfmac_f32_16x16x64_bf16 v[48:51], v[16:19], v[104:111], v1
    s_waitcnt vmcnt(2)
    v_max3_u32 v14, v14, v20, v21
    v_smfmac_f32_16x16x64_bf16 v[52:55], v[16:19], v[112:119], v1
    v_max3_u32 v14, v14, v22, v23
    v_cmp_lt_u32 vcc, s94, v14
    v_smfmac_f32_16x16x64_bf16 v[48:51], v[20:23], v[88:95], v1
    ds_write_b128 v2, v[16:19] offset:0
    s_cbranch_vccnz L_fast_retrym
    v_smfmac_f32_16x16x64_bf16 v[52:55], v[20:23], v[96:103], v1
    ds_write_b128 v2, v[20:23] offset:1024
    v_smfmac_f32_16x16x64_bf16 v[56:59], v[16:19], v[72:79], v1
    buffer_load_dwordx4 v[104:107], v3, s[8:11], s29 offen offset:0 sc1
    buffer_load_dwordx4 v[120:123], v3, s[8:11], s30 offen offset:0 sc1
    v_smfmac_f32_16x16x64_bf16 v[60:63], v[16:19], v[80:87], v1
    buffer_load_dwordx4 v[108:111], v3, s[8:11], s29 offen offset:1024 sc1
    buffer_load_dwordx4 v[124:127], v3, s[8:11], s30 offen offset:1024 sc1
    v_smfmac_f32_16x16x64_bf16 v[56:59], v[20:23], a[80:87], v1
    buffer_load_dwordx4 v[112:115], v3, s[8:11], s29 offen offset:2048 sc1
    buffer_load_dwordx4 v[116:119], v3, s[8:11], s29 offen offset:3072 sc1
    v_smfmac_f32_16x16x64_bf16 v[60:63], v[20:23], a[88:95], v1
    s_waitcnt lgkmcnt(0)
    s_barrier
    ds_read_b128 v[24:27], v28 offset:0
    v_smfmac_f32_16x16x64_bf16 v[64:67], v[16:19], a[160:167], v1
    ds_read_b128 v[28:31], v28 offset:1024
    v_smfmac_f32_16x16x64_bf16 v[68:71], v[16:19], a[168:175], v1
    buffer_load_dword v15, v0, s[8:11], s24 offen sc1
    v_smfmac_f32_16x16x64_bf16 v[64:67], v[20:23], a[176:183], v1
    ds_read_b128 v[32:35], v8 offset:0
    v_smfmac_f32_16x16x64_bf16 v[68:71], v[20:23], a[184:191], v1
    ds_read_b128 v[36:39], v8 offset:1024
    s_waitcnt lgkmcnt(3)
    v_smfmac_f32_16x16x64_bf16 v[48:51], v[24:27], a[0:7], v1
    ds_read_b128 v[40:43], v44 offset:0
    v_smfmac_f32_16x16x64_bf16 v[52:55], v[24:27], a[8:15], v1
    ds_read_b128 v[44:47], v44 offset:1024
    s_waitcnt lgkmcnt(4)
    v_smfmac_f32_16x16x64_bf16 v[48:51], v[28:31], a[16:23], v1
    ds_read_b128 v[88:91], v4 offset:12288
    v_smfmac_f32_16x16x64_bf16 v[52:55], v[28:31], a[24:31], v1
    ds_read_b128 v[92:95], v4 offset:13312
    s_waitcnt lgkmcnt(4)
    v_smfmac_f32_16x16x64_bf16 v[48:51], v[32:35], a[32:39], v1
    ds_read_b128 v[96:99], v4 offset:14336
    v_smfmac_f32_16x16x64_bf16 v[52:55], v[32:35], a[40:47], v1
    ds_read_b128 v[100:103], v4 offset:15360
    s_waitcnt lgkmcnt(4)
    v_smfmac_f32_16x16x64_bf16 v[48:51], v[36:39], a[48:55], v1
    v_smfmac_f32_16x16x64_bf16 v[52:55], v[36:39], a[56:63], v1
    ds_read_b128 v[72:75], v4 offset:16384
    v_smfmac_f32_16x16x64_bf16 v[48:51], v[40:43], a[64:71], v1
    v_smfmac_f32_16x16x64_bf16 v[52:55], v[40:43], a[72:79], v1
    ds_read_b128 v[76:79], v4 offset:17408
    s_waitcnt lgkmcnt(2)
    v_smfmac_f32_16x16x64_bf16 v[48:51], v[44:47], v[88:95], v1
    ds_read_b128 v[80:83], v4 offset:18432
    v_smfmac_f32_16x16x64_bf16 v[52:55], v[44:47], v[96:103], v1
    ds_read_b128 v[84:87], v4 offset:19456
    v_smfmac_f32_16x16x64_bf16 v[56:59], v[28:31], a[96:103], v1
    ds_read_b128 v[88:91], v4 offset:20480
    v_smfmac_f32_16x16x64_bf16 v[60:63], v[28:31], a[104:111], v1
    ds_read_b128 v[92:95], v4 offset:21504
    v_smfmac_f32_16x16x64_bf16 v[56:59], v[32:35], a[112:119], v1
    ds_read_b128 v[96:99], v4 offset:22528
    v_add_f32 v48, v48, v50
    v_add_f32 v49, v49, v51
    v_smfmac_f32_16x16x64_bf16 v[60:63], v[32:35], a[120:127], v1
    ds_read_b128 v[100:103], v4 offset:23552
    v_add_f32 v52, v52, v54
    v_add_f32 v53, v53, v55
    v_smfmac_f32_16x16x64_bf16 v[56:59], v[36:39], a[128:135], v1
    s_waitcnt lgkmcnt(4)
    v_mul_f32 v48, s33, v48
    v_mul_f32 v52, s33, v52
    v_smfmac_f32_16x16x64_bf16 v[56:59], v[24:27], v[72:79], v1
    v_mul_f32 v49, s33, v49
    v_mul_f32 v53, s33, v53
    v_smfmac_f32_16x16x64_bf16 v[60:63], v[24:27], v[80:87], v1
    v_cvt_pk_bf16_f32 v50, v48, v52
    v_cvt_pk_bf16_f32 v51, v49, v53
    v_smfmac_f32_16x16x64_bf16 v[60:63], v[36:39], a[136:143], v1
    ds_write2_b32 v5, v50, v51 offset0:0 offset1:72
    v_smfmac_f32_16x16x64_bf16 v[56:59], v[40:43], a[144:151], v1
    buffer_store_dword v12, v10, s[8:11], s31 offen sc1
    v_smfmac_f32_16x16x64_bf16 v[60:63], v[40:43], a[152:159], v1
    s_waitcnt lgkmcnt(1)
    v_smfmac_f32_16x16x64_bf16 v[56:59], v[44:47], v[88:95], v1
    v_smfmac_f32_16x16x64_bf16 v[60:63], v[44:47], v[96:103], v1
    s_waitcnt lgkmcnt(0)
    s_barrier
    v_smfmac_f32_16x16x64_bf16 v[64:67], v[24:27], a[192:199], v1
    ds_read_b128 v[72:75], v6 offset:0
    v_smfmac_f32_16x16x64_bf16 v[68:71], v[24:27], a[200:207], v1
    ds_read_b128 v[76:79], v6 offset:64
    s_nop 0
    v_add_f32 v56, v56, v58
    v_smfmac_f32_16x16x64_bf16 v[64:67], v[28:31], a[208:215], v1
    ds_read_b128 v[80:83], v6 offset:128
    v_add_f32 v57, v57, v59
    v_smfmac_f32_16x16x64_bf16 v[68:71], v[28:31], a[216:223], v1
    ds_read_b128 v[84:87], v6 offset:192
    s_waitcnt vmcnt(2) lgkmcnt(3)
    v_mfma_f32_16x16x32_bf16 v[48:51], v[104:107], v[72:75], 0
    s_waitcnt lgkmcnt(2)
    v_add_f32 v60, v60, v62
    v_add_f32 v61, v61, v63
    v_mfma_f32_16x16x32_bf16 v[48:51], v[108:111], v[76:79], v[48:51]
    s_waitcnt lgkmcnt(1)
    v_cvt_pk_bf16_f32 v58, v56, v60
    v_cvt_pk_bf16_f32 v59, v57, v61
    v_mfma_f32_16x16x32_bf16 v[48:51], v[112:115], v[80:83], v[48:51]
    ds_write2_b32 v7, v58, v59 offset0:0 offset1:72
    s_waitcnt lgkmcnt(1)
    v_mfma_f32_16x16x32_bf16 v[48:51], v[116:119], v[84:87], v[48:51]
    v_mov_b64 v[104:105], s[4:5]
    v_mov_b64 v[106:107], s[4:5]
    v_smfmac_f32_16x16x64_bf16 v[64:67], v[32:35], a[224:231], v1
    v_mov_b32 v113, 0
    v_smfmac_f32_16x16x64_bf16 v[68:71], v[32:35], a[232:239], v1
    s_nop 1
    v_mov_b32 v115, 0
    v_smfmac_f32_16x16x64_bf16 v[64:67], v[36:39], a[240:247], v1
    s_waitcnt lgkmcnt(0)
    s_barrier
    v_exp_f32 v48, v48
    v_smfmac_f32_16x16x64_bf16 v[68:71], v[36:39], a[248:255], v1
    ds_read_b128 v[88:91], v6 offset:2304
    v_exp_f32 v49, v49
    v_smfmac_f32_16x16x64_bf16 v[64:67], v[40:43], v[128:135], v1
    ds_read_b128 v[92:95], v6 offset:2368
    v_exp_f32 v50, v50
    v_smfmac_f32_16x16x64_bf16 v[68:71], v[40:43], v[136:143], v1
    ds_read_b128 v[96:99], v6 offset:2432
    v_exp_f32 v51, v51
    v_smfmac_f32_16x16x64_bf16 v[64:67], v[44:47], v[144:151], v1
    ds_read_b128 v[100:103], v6 offset:2496
    v_cvt_pk_bf16_f32 v108, v48, v49
    v_cvt_pk_bf16_f32 v109, v50, v51
    v_smfmac_f32_16x16x64_bf16 v[68:71], v[44:47], v[152:159], v1
    ds_write_b64 v2, v[108:109] offset:8192
    s_waitcnt lgkmcnt(4)
    v_mfma_f32_16x16x32_bf16 v[52:55], v[88:91], v[72:75], 0
    s_waitcnt lgkmcnt(3)
    v_mov_b32 v117, 0
    v_mov_b64 v[16:17], 0
    v_mfma_f32_16x16x32_bf16 v[52:55], v[92:95], v[76:79], v[52:55]
    s_waitcnt lgkmcnt(2)
    v_mov_b64 v[18:19], 0
    v_mov_b64 v[20:21], 0
    v_mfma_f32_16x16x32_bf16 v[52:55], v[96:99], v[80:83], v[52:55]
    s_waitcnt lgkmcnt(1)
    v_add_f32 v64, v64, v66
    v_add_f32 v65, v65, v67
    v_mfma_f32_16x16x32_bf16 v[52:55], v[100:103], v[84:87], v[52:55]
    s_waitcnt lgkmcnt(0)
    s_barrier
    ds_read_b64 v[110:111], v8 offset:8192
    v_add_f32 v68, v68, v70
    v_add_f32 v69, v69, v71
    v_cvt_pk_bf16_f32 v114, v64, v65
    v_cvt_pk_bf16_f32 v116, v68, v69
    v_mov_b64 v[22:23], 0
    v_exp_f32 v52, v52
    v_exp_f32 v53, v53
    s_waitcnt lgkmcnt(0)
    v_mfma_f32_16x16x32_bf16 v[48:51], v[104:107], v[108:111], 0
    v_cvt_pk_bf16_f32 v112, v52, v53
    v_mov_b64 v[24:25], 0
    v_mfma_f32_16x16x32_bf16 v[56:59], v[120:123], v[108:111], 0
    v_mov_b64 v[26:27], 0
    v_mov_b64 v[28:29], 0
    v_mfma_f32_16x16x32_bf16 v[60:63], v[124:127], v[108:111], 0
    v_mov_b64 v[30:31], 0
    v_bitop3_b32 v32, v13, s96, -9 bitop3:0x28
    v_mfma_f32_16x16x16_bf16 v[48:51], v[104:105], v[112:113], v[48:51]
    v_bitop3_b32 v36, v13, s97, -9 bitop3:0x28
    v_bitop3_b32 v40, v13, s98, -9 bitop3:0x28
    v_mfma_f32_16x16x16_bf16 v[56:59], v[114:115], v[112:113], v[56:59]
    s_nop 1
    v_mfma_f32_16x16x16_bf16 v[60:63], v[116:117], v[112:113], v[60:63]
    s_nop 1
    v_rcp_f32 v118, v48
    s_nop 0
    v_max_f32 v14, v118, v48
    v_cmp_nge_f32 vcc, s40, v14
    v_pk_mul_f32 v[56:57], v[56:57], v[118:119] op_sel_hi:[1,0]
    v_pk_mul_f32 v[58:59], v[58:59], v[118:119] op_sel_hi:[1,0]
    v_pk_mul_f32 v[60:61], v[60:61], v[118:119] op_sel_hi:[1,0]
    v_pk_mul_f32 v[62:63], v[62:63], v[118:119] op_sel_hi:[1,0]
    v_cvt_pk_bf16_f32 v52, v56, v60
    v_cvt_pk_bf16_f32 v54, v58, v62
    v_cvt_pk_bf16_f32 v53, v57, v61
    v_cvt_pk_bf16_f32 v55, v59, v63
L_fast_rejoin:
    v_cndmask_b32 v50, v52, v54, s[92:93]
    v_cndmask_b32 v51, v53, v55, s[92:93]
    ds_write_b64 v13, v[50:51] offset:9216
    v_smfmac_f32_16x16x64_bf16 v[16:19], v[52:55], v[160:167], v1
    v_smfmac_f32_16x16x64_bf16 v[20:23], v[52:55], v[168:175], v1
    s_waitcnt lgkmcnt(0)
    s_barrier
    ds_read_b128 v[32:35], v32 offset:9216
    ds_read_b128 v[36:39], v36 offset:9216
    v_smfmac_f32_16x16x64_bf16 v[24:27], v[52:55], v[176:183], v1
    ds_read_b128 v[40:43], v40 offset:9216
    v_smfmac_f32_16x16x64_bf16 v[28:31], v[52:55], v[184:191], v1
    ds_read_b128 v[88:91], v4 offset:24576
    ds_read_b128 v[92:95], v4 offset:25600
    s_waitcnt lgkmcnt(4)
    v_smfmac_f32_16x16x64_bf16 v[16:19], v[32:35], v[192:199], v1
    ds_read_b128 v[96:99], v4 offset:26624
    s_waitcnt lgkmcnt(4)
    v_smfmac_f32_16x16x64_bf16 v[16:19], v[36:39], v[216:223], v1
    ds_read_b128 v[100:103], v4 offset:27648
    s_waitcnt lgkmcnt(4)
    v_smfmac_f32_16x16x64_bf16 v[16:19], v[40:43], v[240:247], v1
    ds_read_b128 v[72:75], v4 offset:28672
    s_cmp_lg_u64 vcc, 0
    v_smfmac_f32_16x16x64_bf16 v[20:23], v[32:35], v[200:207], v1
    ds_read_b128 v[76:79], v4 offset:29696
    s_cselect_b32 s60, s28, s27
    v_smfmac_f32_16x16x64_bf16 v[20:23], v[36:39], v[224:231], v1
    ds_read_b128 v[80:83], v4 offset:30720
    s_nop 0
    v_cvt_pk_bf16_f32 v56, v16, v18
    v_smfmac_f32_16x16x64_bf16 v[20:23], v[40:43], v[248:255], v1
    ds_read_b128 v[84:87], v4 offset:31744
    v_cvt_pk_bf16_f32 v57, v17, v19
    v_and_or_b32 v56, v56, -2, s60
    v_smfmac_f32_16x16x64_bf16 v[24:27], v[32:35], v[208:215], v1
    buffer_store_dwordx2 v[56:57], v9, s[8:11], 0 offen offset:0
    v_smfmac_f32_16x16x64_bf16 v[24:27], v[36:39], v[232:239], v1
    s_waitcnt lgkmcnt(4)
    s_nop 0
    v_cvt_pk_bf16_f32 v58, v20, v22
    v_smfmac_f32_16x16x64_bf16 v[24:27], v[40:43], v[88:95], v1
    ds_read_b128 v[64:67], v3 offset:23040
    v_cvt_pk_bf16_f32 v59, v21, v23
    v_and_or_b32 v58, v58, -2, s60
    v_smfmac_f32_16x16x64_bf16 v[28:31], v[32:35], v[96:103], v1
    buffer_store_dwordx2 v[58:59], v9, s[8:11], 0 offen offset:2048
    s_waitcnt lgkmcnt(1)
    v_smfmac_f32_16x16x64_bf16 v[28:31], v[36:39], v[72:79], v1
    s_nop 1
    v_cvt_pk_bf16_f32 v60, v24, v26
    v_smfmac_f32_16x16x64_bf16 v[28:31], v[40:43], v[80:87], v1
    s_nop 2
    v_cvt_pk_bf16_f32 v61, v25, v27
    v_and_or_b32 v60, v60, -2, s60
    buffer_store_dwordx2 v[60:61], v9, s[8:11], s26 offen offset:0
    s_nop 1
    v_cvt_pk_bf16_f32 v62, v28, v30
    v_cvt_pk_bf16_f32 v63, v29, v31
    v_and_or_b32 v62, v62, -2, s60
    buffer_store_dwordx2 v[62:63], v9, s[8:11], s26 offen offset:2048
L_fast_stored:
    s_cmp_lg_u32 s60, s27
    s_cbranch_scc1 L_fast_safe
    ds_read_b128 v[104:107], v4 offset:0
    ds_read_b128 v[108:111], v4 offset:1024
    ds_read_b128 v[112:115], v4 offset:2048
    ds_read_b128 v[116:119], v4 offset:3072
    ds_read_b128 v[88:91], v4 offset:4096
    ds_read_b128 v[92:95], v4 offset:5120
    ds_read_b128 v[96:99], v4 offset:6144
    ds_read_b128 v[100:103], v4 offset:7168
    ds_read_b128 v[72:75], v4 offset:8192
    ds_read_b128 v[76:79], v4 offset:9216
    ds_read_b128 v[80:83], v4 offset:10240
    ds_read_b128 v[84:87], v4 offset:11264
    s_cmp_lt_u32 s21, 1
    s_cbranch_scc1 L_fast_pollp
    s_nop 9
    s_cmp_lt_u32 s21, 2
    s_cbranch_scc1 L_fast_pollp
    s_nop 9
    s_cmp_lt_u32 s21, 3
    s_cbranch_scc1 L_fast_pollp
    s_nop 9
L_fast_pollp:
    buffer_load_dwordx4 v[120:123], v2, s[8:11], s6 offen sc1
    buffer_load_dwordx4 v[124:127], v2, s[8:11], s6 offen offset:1024 sc1
    v_mov_b64 v[56:57], 0
    v_mov_b64 v[58:59], 0
    v_mov_b64 v[60:61], 0
    v_mov_b64 v[62:63], 0
    s_nop 15
    s_nop 15
    buffer_load_dwordx4 v[32:35], v2, s[8:11], s6 offen sc1
    buffer_load_dwordx4 v[36:39], v2, s[8:11], s6 offen offset:1024 sc1
L_fast_prep:
    s_add_u32 s7, s24, 0x80000
    s_waitcnt vmcnt(3) lgkmcnt(0)
    v_mfma_f32_16x16x32_bf16 v[68:71], v[64:67], v[120:123], 0
    v_bitop3_b32 v14, v120, v122, s27 bitop3:0x7e
    s_waitcnt vmcnt(2)
    v_mfma_f32_16x16x32_bf16 v[68:71], v[64:67], v[124:127], v[68:71]
    v_bitop3_b32 v11, v124, v126, s27 bitop3:0x7e
    v_bitop3_b32 v14, v14, v11, 1 bitop3:0xa8
    v_cmp_ne_u32 vcc, 0, v14
    s_nop 2
    s_cmp_eq_u64 vcc, 0
    s_cselect_b32 s36, s24, s61
    v_add_f32_dpp v68, v68, v68 row_ror:8 row_mask:0xf bank_mask:0xf
    v_add_f32_dpp v69, v69, v69 row_ror:8 row_mask:0xf bank_mask:0xf
    s_nop 0
    v_add_f32_dpp v68, v68, v68 row_ror:4 row_mask:0xf bank_mask:0xf
    v_add_f32_dpp v69, v69, v69 row_ror:4 row_mask:0xf bank_mask:0xf
    v_cvt_pk_bf16_f32 v12, v68, v69
    buffer_store_dword v12, v10, s[8:11], s36 offen
    s_cbranch_scc1 L_fast_gotp
L_fast_retryp:
    buffer_load_dwordx4 v[120:123], v2, s[8:11], s6 offen sc1
    buffer_load_dwordx4 v[124:127], v2, s[8:11], s6 offen offset:1024 sc1
    s_waitcnt vmcnt(4) lgkmcnt(0)
    v_mfma_f32_16x16x32_bf16 v[68:71], v[64:67], v[32:35], 0
    v_bitop3_b32 v14, v32, v34, s27 bitop3:0x7e
    s_waitcnt vmcnt(3)
    v_mfma_f32_16x16x32_bf16 v[68:71], v[64:67], v[36:39], v[68:71]
    v_bitop3_b32 v11, v36, v38, s27 bitop3:0x7e
    v_bitop3_b32 v14, v14, v11, 1 bitop3:0xa8
    v_cmp_ne_u32 vcc, 0, v14
    s_nop 2
    s_cmp_eq_u64 vcc, 0
    s_cselect_b32 s36, s24, s61
    v_add_f32_dpp v68, v68, v68 row_ror:8 row_mask:0xf bank_mask:0xf
    v_add_f32_dpp v69, v69, v69 row_ror:8 row_mask:0xf bank_mask:0xf
    s_nop 0
    v_add_f32_dpp v68, v68, v68 row_ror:4 row_mask:0xf bank_mask:0xf
    v_add_f32_dpp v69, v69, v69 row_ror:4 row_mask:0xf bank_mask:0xf
    v_cvt_pk_bf16_f32 v12, v68, v69
    buffer_store_dword v12, v10, s[8:11], s36 offen
    s_cbranch_scc1 L_fast_gotp
    buffer_load_dwordx4 v[32:35], v2, s[8:11], s6 offen sc1
    buffer_load_dwordx4 v[36:39], v2, s[8:11], s6 offen offset:1024 sc1
    s_waitcnt vmcnt(4) lgkmcnt(0)
    v_mfma_f32_16x16x32_bf16 v[68:71], v[64:67], v[120:123], 0
    v_bitop3_b32 v14, v120, v122, s27 bitop3:0x7e
    s_waitcnt vmcnt(3)
    v_mfma_f32_16x16x32_bf16 v[68:71], v[64:67], v[124:127], v[68:71]
    v_bitop3_b32 v11, v124, v126, s27 bitop3:0x7e
    v_bitop3_b32 v14, v14, v11, 1 bitop3:0xa8
    v_cmp_ne_u32 vcc, 0, v14
    s_nop 2
    s_cmp_eq_u64 vcc, 0
    s_cselect_b32 s36, s24, s61
    v_add_f32_dpp v68, v68, v68 row_ror:8 row_mask:0xf bank_mask:0xf
    v_add_f32_dpp v69, v69, v69 row_ror:8 row_mask:0xf bank_mask:0xf
    s_nop 0
    v_add_f32_dpp v68, v68, v68 row_ror:4 row_mask:0xf bank_mask:0xf
    v_add_f32_dpp v69, v69, v69 row_ror:4 row_mask:0xf bank_mask:0xf
    v_cvt_pk_bf16_f32 v12, v68, v69
    buffer_store_dword v12, v10, s[8:11], s36 offen
    s_cbranch_scc1 L_fast_gotp
    s_add_u32 s32, s32, 1
    s_cmp_le_u32 s32, 200000
    s_cbranch_scc1 L_fast_retryp
    s_mov_b32 s36, s24
    buffer_store_dword v12, v10, s[8:11], s36 offen
L_fast_gotp:
    s_add_u32 s31, s31, 0x2000
    s_cmp_ge_u32 s90, 63
    s_cbranch_scc1 L_fast_last
    s_mov_b32 s23, s24
    s_mov_b32 s22, s90
    s_mov_b32 s27, s28
    v_mov_b64 v[64:65], 0
    v_mov_b64 v[66:67], 0
    v_mov_b64 v[68:69], 0
    v_mov_b64 v[70:71], 0
    s_nop 15
    s_nop 11
    buffer_load_dwordx4 v[16:19], v2, s[8:11], s7 offen sc1
    buffer_load_dwordx4 v[20:23], v2, s[8:11], s7 offen offset:1024 sc1
    s_branch L_fast_step
L_fast_last:
    buffer_store_dword v12, v10, s[8:11], s31 offen sc1
    s_branch L_fast_done
L_fast_refresh:
    buffer_load_dword v15, v0, s[8:11], s23 offen sc1
    s_add_u32 s32, s32, 1
    s_cmp_le_u32 s32, 200000
    s_waitcnt vmcnt(0)
    s_cbranch_scc1 L_fast_step
    s_branch L_fast_fresh
L_fast_safe:
    s_nop 11
    s_waitcnt vmcnt(0) lgkmcnt(0)
    s_barrier
    ds_read_b128 v[72:75], v6 offset:0
    ds_read_b128 v[88:91], v6 offset:2304
    ds_read_b128 v[76:79], v6 offset:64
    ds_read_b128 v[92:95], v6 offset:2368
    ds_read_b128 v[80:83], v6 offset:128
    ds_read_b128 v[96:99], v6 offset:2432
    ds_read_b128 v[84:87], v6 offset:192
    ds_read_b128 v[100:103], v6 offset:2496
    s_xor_b32 s36, s25, 0x1000
    s_add_u32 s36, s36, s23
    buffer_load_dwordx4 v[16:19], v3, s[8:11], s29 offen offset:0 sc1
    buffer_load_dwordx4 v[32:35], v3, s[8:11], s36 offen offset:0 sc1
    buffer_load_dwordx4 v[20:23], v3, s[8:11], s29 offen offset:1024 sc1
    buffer_load_dwordx4 v[36:39], v3, s[8:11], s36 offen offset:1024 sc1
    buffer_load_dwordx4 v[24:27], v3, s[8:11], s29 offen offset:2048 sc1
    buffer_load_dwordx4 v[40:43], v3, s[8:11], s36 offen offset:2048 sc1
    buffer_load_dwordx4 v[28:31], v3, s[8:11], s29 offen offset:3072 sc1
    buffer_load_dwordx4 v[44:47], v3, s[8:11], s36 offen offset:3072 sc1
    s_waitcnt vmcnt(0) lgkmcnt(0)
    v_mfma_f32_16x16x32_bf16 v[48:51], v[16:19], v[72:75], 0
    v_mfma_f32_16x16x32_bf16 v[48:51], v[20:23], v[76:79], v[48:51]
    v_mfma_f32_16x16x32_bf16 v[48:51], v[24:27], v[80:83], v[48:51]
    v_mfma_f32_16x16x32_bf16 v[48:51], v[28:31], v[84:87], v[48:51]
    v_mfma_f32_16x16x32_bf16 v[52:55], v[32:35], v[72:75], 0
    v_mfma_f32_16x16x32_bf16 v[52:55], v[36:39], v[76:79], v[52:55]
    v_mfma_f32_16x16x32_bf16 v[52:55], v[40:43], v[80:83], v[52:55]
    v_mfma_f32_16x16x32_bf16 v[52:55], v[44:47], v[84:87], v[52:55]
    v_mfma_f32_16x16x32_bf16 v[56:59], v[88:91], v[72:75], 0
    v_mfma_f32_16x16x32_bf16 v[56:59], v[92:95], v[76:79], v[56:59]
    v_mfma_f32_16x16x32_bf16 v[56:59], v[96:99], v[80:83], v[56:59]
    v_mfma_f32_16x16x32_bf16 v[56:59], v[100:103], v[84:87], v[56:59]
    v_max3_f32 v16, v48, v49, v50
    s_nop 2
    v_max3_f32 v16, v16, v51, v52
    v_max3_f32 v16, v16, v53, v54
    s_nop 1
    v_max3_f32 v16, v16, v55, v56
    v_max_f32 v16, v16, v57
    v_mov_b32 v17, v16
    s_nop 1
    v_permlane16_swap_b32 v16, v17
    v_max_f32 v16, v16, v17
    v_mov_b32 v17, v16
    s_nop 1
    v_permlane32_swap_b32 v16, v17
    v_max_f32 v16, v16, v17
    v_sub_f32 v48, v48, v16
    v_exp_f32 v48, v48
    v_sub_f32 v49, v49, v16
    v_exp_f32 v49, v49
    v_sub_f32 v50, v50, v16
    v_exp_f32 v50, v50
    v_sub_f32 v51, v51, v16
    v_exp_f32 v51, v51
    v_sub_f32 v52, v52, v16
    v_exp_f32 v52, v52
    v_sub_f32 v53, v53, v16
    v_exp_f32 v53, v53
    v_sub_f32 v54, v54, v16
    v_exp_f32 v54, v54
    v_sub_f32 v55, v55, v16
    v_exp_f32 v55, v55
    v_sub_f32 v56, v56, v16
    v_exp_f32 v56, v56
    v_sub_f32 v57, v57, v16
    v_exp_f32 v57, v57
    v_cvt_pk_bf16_f32 v108, v48, v49
    v_cvt_pk_bf16_f32 v109, v50, v51
    v_cvt_pk_bf16_f32 v110, v52, v53
    v_cvt_pk_bf16_f32 v111, v54, v55
    v_cvt_pk_bf16_f32 v112, v56, v57
    s_nop 0
    v_mfma_f32_16x16x32_bf16 v[48:51], v[104:107], v[108:111], 0
    v_mfma_f32_16x16x32_bf16 v[56:59], v[120:123], v[108:111], 0
    v_mfma_f32_16x16x32_bf16 v[60:63], v[124:127], v[108:111], 0
    s_nop 3
    v_mfma_f32_16x16x16_bf16 v[48:51], v[104:105], v[112:113], v[48:51]
    v_mfma_f32_16x16x16_bf16 v[56:59], v[114:115], v[112:113], v[56:59]
    v_mfma_f32_16x16x16_bf16 v[60:63], v[116:117], v[112:113], v[60:63]
    s_nop 5
    v_rcp_f32 v118, v48
    s_nop 0
    v_mul_f32 v56, v56, v118
    v_mul_f32 v57, v57, v118
    v_mul_f32 v58, v58, v118
    v_mul_f32 v59, v59, v118
    v_mul_f32 v60, v60, v118
    v_mul_f32 v61, v61, v118
    v_mul_f32 v62, v62, v118
    v_mul_f32 v63, v63, v118
    v_cvt_pk_bf16_f32 v52, v56, v60
    v_cvt_pk_bf16_f32 v53, v57, v61
    v_cvt_pk_bf16_f32 v54, v58, v62
    v_cvt_pk_bf16_f32 v55, v59, v63
    v_mov_b32 v16, 0
    v_mov_b32 v17, 0
    v_mov_b32 v18, 0
    v_mov_b32 v19, 0
    v_mov_b32 v20, 0
    v_mov_b32 v21, 0
    v_mov_b32 v22, 0
    v_mov_b32 v23, 0
    v_mov_b32 v24, 0
    v_mov_b32 v25, 0
    v_mov_b32 v26, 0
    v_mov_b32 v27, 0
    v_mov_b32 v28, 0
    v_mov_b32 v29, 0
    v_mov_b32 v30, 0
    v_mov_b32 v31, 0
    v_bitop3_b32 v32, v13, s96, -9 bitop3:0x28
    v_bitop3_b32 v36, v13, s97, -9 bitop3:0x28
    v_bitop3_b32 v40, v13, s98, -9 bitop3:0x28
    s_mov_b64 vcc, 0
    s_branch L_fast_rejoin
L_fast_done:
    s_branch L_end
L_slow_start:
    s_mov_b32 s22, 0
    s_mov_b32 s23, 0x1000000
    s_mov_b32 s27, 0
    s_mov_b32 s31, 0x80000
    s_mov_b32 s61, 0x40000000
    s_mov_b32 s96, 0x800
    s_mov_b32 s97, 0x1000
    s_mov_b32 s98, 0x1800
    s_mov_b32 s92, 0xcccccccc
    s_mov_b32 s93, 0xcccccccc
    s_mov_b32 s91, 0
    ds_read_b128 v[104:107], v4 offset:0
    ds_read_b128 v[108:111], v4 offset:1024
    ds_read_b128 v[112:115], v4 offset:2048
    ds_read_b128 v[116:119], v4 offset:3072
    ds_read_b128 v[88:91], v4 offset:4096
    ds_read_b128 v[92:95], v4 offset:5120
    ds_read_b128 v[96:99], v4 offset:6144
    ds_read_b128 v[100:103], v4 offset:7168
    ds_read_b128 v[72:75], v4 offset:8192
    ds_read_b128 v[76:79], v4 offset:9216
    ds_read_b128 v[80:83], v4 offset:10240
    ds_read_b128 v[84:87], v4 offset:11264
    v_mov_b64 v[48:49], 0
    v_mov_b64 v[50:51], 0
    v_mov_b64 v[52:53], 0
    v_mov_b64 v[54:55], 0
    v_mov_b64 v[56:57], 0
    v_mov_b64 v[58:59], 0
    v_mov_b64 v[60:61], 0
    v_mov_b64 v[62:63], 0
    v_mov_b64 v[64:65], 0
    v_mov_b64 v[66:67], 0
    v_mov_b64 v[68:69], 0
    v_mov_b64 v[70:71], 0
    s_add_u32 s7, s23, 0x80000
    buffer_load_dwordx4 v[16:19], v2, s[8:11], s7 offen sc1
    buffer_load_dwordx4 v[20:23], v2, s[8:11], s7 offen offset:1024 sc1
    s_waitcnt vmcnt(2)
L_slow_step:
    v_readlane_b32 s36, v15, 33
    s_add_u32 s24, s23, 0x82100
    s_cmp_eq_u32 s36, 0
    s_cbranch_scc1 L_slow_refresh
L_slow_fresh:
    s_add_u32 s29, s23, s25
    s_add_u32 s30, s23, s39
    s_xor_b32 s28, s27, 1
    s_add_u32 s90, s22, 1
    s_nop 15
L_slow_retrym:
    buffer_load_dwordx4 v[16:19], v2, s[8:11], s7 offen sc1
    buffer_load_dwordx4 v[20:23], v2, s[8:11], s7 offen offset:1024 sc1
L_slow_prem:
    s_add_u32 s32, s32, 1
    s_cmp_gt_u32 s32, 200000
    s_cselect_b32 s94, -1, -2
    v_xor_b32 v28, 0x800, v2
    v_xor_b32 v44, 0x1800, v2
    v_mov_b64 v[48:49], 0
    v_mov_b64 v[50:51], 0
    v_mov_b64 v[52:53], 0
    v_mov_b64 v[54:55], 0
L_slow_waitm:
    s_waitcnt vmcnt(3) lgkmcnt(0)
L_slow_gotm:
    v_max3_u32 v14, v16, v17, v18
    v_max_u32 v14, v14, v19
    v_smfmac_f32_16x16x64_bf16 v[48:51], v[16:19], v[104:111], v1
    s_waitcnt vmcnt(2)
    v_max3_u32 v14, v14, v20, v21
    v_smfmac_f32_16x16x64_bf16 v[52:55], v[16:19], v[112:119], v1
    v_max3_u32 v14, v14, v22, v23
    v_cmp_lt_u32 vcc, s94, v14
    v_smfmac_f32_16x16x64_bf16 v[48:51], v[20:23], v[88:95], v1
    ds_write_b128 v2, v[16:19] offset:0
    s_cbranch_vccnz L_slow_retrym
    v_smfmac_f32_16x16x64_bf16 v[52:55], v[20:23], v[96:103], v1
    ds_write_b128 v2, v[20:23] offset:1024
    v_smfmac_f32_16x16x64_bf16 v[56:59], v[16:19], v[72:79], v1
    buffer_load_dwordx4 v[104:107], v3, s[8:11], s29 offen offset:0 sc1
    buffer_load_dwordx4 v[120:123], v3, s[8:11], s30 offen offset:0 sc1
    v_smfmac_f32_16x16x64_bf16 v[60:63], v[16:19], v[80:87], v1
    buffer_load_dwordx4 v[108:111], v3, s[8:11], s29 offen offset:1024 sc1
    buffer_load_dwordx4 v[124:127], v3, s[8:11], s30 offen offset:1024 sc1
    v_smfmac_f32_16x16x64_bf16 v[56:59], v[20:23], a[80:87], v1
    buffer_load_dwordx4 v[112:115], v3, s[8:11], s29 offen offset:2048 sc1
    buffer_load_dwordx4 v[116:119], v3, s[8:11], s29 offen offset:3072 sc1
    v_smfmac_f32_16x16x64_bf16 v[60:63], v[20:23], a[88:95], v1
    s_waitcnt lgkmcnt(0)
    s_barrier
    ds_read_b128 v[24:27], v28 offset:0
    v_smfmac_f32_16x16x64_bf16 v[64:67], v[16:19], a[160:167], v1
    ds_read_b128 v[28:31], v28 offset:1024
    v_smfmac_f32_16x16x64_bf16 v[68:71], v[16:19], a[168:175], v1
    buffer_load_dword v15, v0, s[8:11], s24 offen sc1
    v_smfmac_f32_16x16x64_bf16 v[64:67], v[20:23], a[176:183], v1
    ds_read_b128 v[32:35], v8 offset:0
    v_smfmac_f32_16x16x64_bf16 v[68:71], v[20:23], a[184:191], v1
    ds_read_b128 v[36:39], v8 offset:1024
    s_waitcnt lgkmcnt(3)
    v_smfmac_f32_16x16x64_bf16 v[48:51], v[24:27], a[0:7], v1
    ds_read_b128 v[40:43], v44 offset:0
    v_smfmac_f32_16x16x64_bf16 v[52:55], v[24:27], a[8:15], v1
    ds_read_b128 v[44:47], v44 offset:1024
    s_waitcnt lgkmcnt(4)
    v_smfmac_f32_16x16x64_bf16 v[48:51], v[28:31], a[16:23], v1
    ds_read_b128 v[88:91], v4 offset:12288
    v_smfmac_f32_16x16x64_bf16 v[52:55], v[28:31], a[24:31], v1
    ds_read_b128 v[92:95], v4 offset:13312
    s_waitcnt lgkmcnt(4)
    v_smfmac_f32_16x16x64_bf16 v[48:51], v[32:35], a[32:39], v1
    ds_read_b128 v[96:99], v4 offset:14336
    v_smfmac_f32_16x16x64_bf16 v[52:55], v[32:35], a[40:47], v1
    ds_read_b128 v[100:103], v4 offset:15360
    s_waitcnt lgkmcnt(4)
    v_smfmac_f32_16x16x64_bf16 v[48:51], v[36:39], a[48:55], v1
    v_smfmac_f32_16x16x64_bf16 v[52:55], v[36:39], a[56:63], v1
    ds_read_b128 v[72:75], v4 offset:16384
    v_smfmac_f32_16x16x64_bf16 v[48:51], v[40:43], a[64:71], v1
    v_smfmac_f32_16x16x64_bf16 v[52:55], v[40:43], a[72:79], v1
    ds_read_b128 v[76:79], v4 offset:17408
    s_waitcnt lgkmcnt(2)
    v_smfmac_f32_16x16x64_bf16 v[48:51], v[44:47], v[88:95], v1
    ds_read_b128 v[80:83], v4 offset:18432
    v_smfmac_f32_16x16x64_bf16 v[52:55], v[44:47], v[96:103], v1
    ds_read_b128 v[84:87], v4 offset:19456
    v_smfmac_f32_16x16x64_bf16 v[56:59], v[28:31], a[96:103], v1
    ds_read_b128 v[88:91], v4 offset:20480
    v_smfmac_f32_16x16x64_bf16 v[60:63], v[28:31], a[104:111], v1
    ds_read_b128 v[92:95], v4 offset:21504
    v_smfmac_f32_16x16x64_bf16 v[56:59], v[32:35], a[112:119], v1
    ds_read_b128 v[96:99], v4 offset:22528
    v_add_f32 v48, v48, v50
    v_add_f32 v49, v49, v51
    v_smfmac_f32_16x16x64_bf16 v[60:63], v[32:35], a[120:127], v1
    ds_read_b128 v[100:103], v4 offset:23552
    v_add_f32 v52, v52, v54
    v_add_f32 v53, v53, v55
    v_smfmac_f32_16x16x64_bf16 v[56:59], v[36:39], a[128:135], v1
    s_waitcnt lgkmcnt(4)
    v_mul_f32 v48, s33, v48
    v_mul_f32 v52, s33, v52
    v_smfmac_f32_16x16x64_bf16 v[56:59], v[24:27], v[72:79], v1
    v_mul_f32 v49, s33, v49
    v_mul_f32 v53, s33, v53
    v_smfmac_f32_16x16x64_bf16 v[60:63], v[24:27], v[80:87], v1
    v_cvt_pk_bf16_f32 v50, v48, v52
    v_cvt_pk_bf16_f32 v51, v49, v53
    v_smfmac_f32_16x16x64_bf16 v[60:63], v[36:39], a[136:143], v1
    ds_write2_b32 v5, v50, v51 offset0:0 offset1:72
    v_smfmac_f32_16x16x64_bf16 v[56:59], v[40:43], a[144:151], v1
    buffer_store_dword v12, v10, s[8:11], s31 offen sc1
    v_smfmac_f32_16x16x64_bf16 v[60:63], v[40:43], a[152:159], v1
    s_waitcnt lgkmcnt(1)
    v_smfmac_f32_16x16x64_bf16 v[56:59], v[44:47], v[88:95], v1
    v_smfmac_f32_16x16x64_bf16 v[60:63], v[44:47], v[96:103], v1
    s_waitcnt lgkmcnt(0)
    s_barrier
    v_smfmac_f32_16x16x64_bf16 v[64:67], v[24:27], a[192:199], v1
    ds_read_b128 v[72:75], v6 offset:0
    v_smfmac_f32_16x16x64_bf16 v[68:71], v[24:27], a[200:207], v1
    ds_read_b128 v[76:79], v6 offset:64
    s_nop 0
    v_add_f32 v56, v56, v58
    v_smfmac_f32_16x16x64_bf16 v[64:67], v[28:31], a[208:215], v1
    ds_read_b128 v[80:83], v6 offset:128
    v_add_f32 v57, v57, v59
    v_smfmac_f32_16x16x64_bf16 v[68:71], v[28:31], a[216:223], v1
    ds_read_b128 v[84:87], v6 offset:192
    s_waitcnt vmcnt(2) lgkmcnt(3)
    v_mfma_f32_16x16x32_bf16 v[48:51], v[104:107], v[72:75], 0
    s_waitcnt lgkmcnt(2)
    v_add_f32 v60, v60, v62
    v_add_f32 v61, v61, v63
    v_mfma_f32_16x16x32_bf16 v[48:51], v[108:111], v[76:79], v[48:51]
    s_waitcnt lgkmcnt(1)
    v_cvt_pk_bf16_f32 v58, v56, v60
    v_cvt_pk_bf16_f32 v59, v57, v61
    v_mfma_f32_16x16x32_bf16 v[48:51], v[112:115], v[80:83], v[48:51]
    ds_write2_b32 v7, v58, v59 offset0:0 offset1:72
    s_waitcnt lgkmcnt(1)
    v_mfma_f32_16x16x32_bf16 v[48:51], v[116:119], v[84:87], v[48:51]
    v_mov_b64 v[104:105], s[4:5]
    v_mov_b64 v[106:107], s[4:5]
    v_smfmac_f32_16x16x64_bf16 v[64:67], v[32:35], a[224:231], v1
    v_mov_b32 v113, 0
    v_smfmac_f32_16x16x64_bf16 v[68:71], v[32:35], a[232:239], v1
    s_nop 1
    v_mov_b32 v115, 0
    v_smfmac_f32_16x16x64_bf16 v[64:67], v[36:39], a[240:247], v1
    s_waitcnt lgkmcnt(0)
    s_barrier
    v_exp_f32 v48, v48
    v_smfmac_f32_16x16x64_bf16 v[68:71], v[36:39], a[248:255], v1
    ds_read_b128 v[88:91], v6 offset:2304
    v_exp_f32 v49, v49
    v_smfmac_f32_16x16x64_bf16 v[64:67], v[40:43], v[128:135], v1
    ds_read_b128 v[92:95], v6 offset:2368
    v_exp_f32 v50, v50
    v_smfmac_f32_16x16x64_bf16 v[68:71], v[40:43], v[136:143], v1
    ds_read_b128 v[96:99], v6 offset:2432
    v_exp_f32 v51, v51
    v_smfmac_f32_16x16x64_bf16 v[64:67], v[44:47], v[144:151], v1
    ds_read_b128 v[100:103], v6 offset:2496
    v_cvt_pk_bf16_f32 v108, v48, v49
    v_cvt_pk_bf16_f32 v109, v50, v51
    v_smfmac_f32_16x16x64_bf16 v[68:71], v[44:47], v[152:159], v1
    ds_write_b64 v2, v[108:109] offset:8192
    s_waitcnt lgkmcnt(4)
    v_mfma_f32_16x16x32_bf16 v[52:55], v[88:91], v[72:75], 0
    s_waitcnt lgkmcnt(3)
    v_mov_b32 v117, 0
    v_mov_b64 v[16:17], 0
    v_mfma_f32_16x16x32_bf16 v[52:55], v[92:95], v[76:79], v[52:55]
    s_waitcnt lgkmcnt(2)
    v_mov_b64 v[18:19], 0
    v_mov_b64 v[20:21], 0
    v_mfma_f32_16x16x32_bf16 v[52:55], v[96:99], v[80:83], v[52:55]
    s_waitcnt lgkmcnt(1)
    v_add_f32 v64, v64, v66
    v_add_f32 v65, v65, v67
    v_mfma_f32_16x16x32_bf16 v[52:55], v[100:103], v[84:87], v[52:55]
    s_waitcnt lgkmcnt(0)
    s_barrier
    ds_read_b64 v[110:111], v8 offset:8192
    v_add_f32 v68, v68, v70
    v_add_f32 v69, v69, v71
    v_cvt_pk_bf16_f32 v114, v64, v65
    v_cvt_pk_bf16_f32 v116, v68, v69
    v_mov_b64 v[22:23], 0
    v_exp_f32 v52, v52
    v_exp_f32 v53, v53
    s_waitcnt lgkmcnt(0)
    v_mfma_f32_16x16x32_bf16 v[48:51], v[104:107], v[108:111], 0
    v_cvt_pk_bf16_f32 v112, v52, v53
    v_mov_b64 v[24:25], 0
    v_mfma_f32_16x16x32_bf16 v[56:59], v[120:123], v[108:111], 0
    v_mov_b64 v[26:27], 0
    v_mov_b64 v[28:29], 0
    v_mfma_f32_16x16x32_bf16 v[60:63], v[124:127], v[108:111], 0
    v_mov_b64 v[30:31], 0
    v_bitop3_b32 v32, v13, s96, -9 bitop3:0x28
    v_mfma_f32_16x16x16_bf16 v[48:51], v[104:105], v[112:113], v[48:51]
    v_bitop3_b32 v36, v13, s97, -9 bitop3:0x28
    v_bitop3_b32 v40, v13, s98, -9 bitop3:0x28
    v_mfma_f32_16x16x16_bf16 v[56:59], v[114:115], v[112:113], v[56:59]
    s_nop 1
    v_mfma_f32_16x16x16_bf16 v[60:63], v[116:117], v[112:113], v[60:63]
    s_nop 1
    v_rcp_f32 v118, v48
    s_nop 0
    v_max_f32 v14, v118, v48
    v_cmp_nge_f32 vcc, s40, v14
    v_pk_mul_f32 v[56:57], v[56:57], v[118:119] op_sel_hi:[1,0]
    v_pk_mul_f32 v[58:59], v[58:59], v[118:119] op_sel_hi:[1,0]
    v_pk_mul_f32 v[60:61], v[60:61], v[118:119] op_sel_hi:[1,0]
    v_pk_mul_f32 v[62:63], v[62:63], v[118:119] op_sel_hi:[1,0]
    v_cvt_pk_bf16_f32 v52, v56, v60
    v_cvt_pk_bf16_f32 v54, v58, v62
    v_cvt_pk_bf16_f32 v53, v57, v61
    v_cvt_pk_bf16_f32 v55, v59, v63
L_slow_rejoin:
    v_cndmask_b32 v50, v52, v54, s[92:93]
    v_cndmask_b32 v51, v53, v55, s[92:93]
    ds_write_b64 v13, v[50:51] offset:9216
    v_smfmac_f32_16x16x64_bf16 v[16:19], v[52:55], v[160:167], v1
    v_smfmac_f32_16x16x64_bf16 v[20:23], v[52:55], v[168:175], v1
    s_waitcnt lgkmcnt(0)
    s_barrier
    ds_read_b128 v[32:35], v32 offset:9216
    ds_read_b128 v[36:39], v36 offset:9216
    v_smfmac_f32_16x16x64_bf16 v[24:27], v[52:55], v[176:183], v1
    ds_read_b128 v[40:43], v40 offset:9216
    v_smfmac_f32_16x16x64_bf16 v[28:31], v[52:55], v[184:191], v1
    ds_read_b128 v[88:91], v4 offset:24576
    ds_read_b128 v[92:95], v4 offset:25600
    s_waitcnt lgkmcnt(4)
    v_smfmac_f32_16x16x64_bf16 v[16:19], v[32:35], v[192:199], v1
    ds_read_b128 v[96:99], v4 offset:26624
    s_waitcnt lgkmcnt(4)
    v_smfmac_f32_16x16x64_bf16 v[16:19], v[36:39], v[216:223], v1
    ds_read_b128 v[100:103], v4 offset:27648
    s_waitcnt lgkmcnt(4)
    v_smfmac_f32_16x16x64_bf16 v[16:19], v[40:43], v[240:247], v1
    ds_read_b128 v[72:75], v4 offset:28672
    s_cmp_lg_u64 vcc, 0
    v_smfmac_f32_16x16x64_bf16 v[20:23], v[32:35], v[200:207], v1
    ds_read_b128 v[76:79], v4 offset:29696
    s_cselect_b32 s60, s28, s27
    v_smfmac_f32_16x16x64_bf16 v[20:23], v[36:39], v[224:231], v1
    ds_read_b128 v[80:83], v4 offset:30720
    s_nop 0
    v_cvt_pk_bf16_f32 v56, v16, v18
    v_smfmac_f32_16x16x64_bf16 v[20:23], v[40:43], v[248:255], v1
    ds_read_b128 v[84:87], v4 offset:31744
    v_cvt_pk_bf16_f32 v57, v17, v19
    v_and_or_b32 v56, v56, -2, s60
    v_smfmac_f32_16x16x64_bf16 v[24:27], v[32:35], v[208:215], v1
    buffer_store_dwordx2 v[56:57], v9, s[8:11], 0 offen offset:0 sc1
    v_smfmac_f32_16x16x64_bf16 v[24:27], v[36:39], v[232:239], v1
    s_waitcnt lgkmcnt(4)
    s_nop 0
    v_cvt_pk_bf16_f32 v58, v20, v22
    v_smfmac_f32_16x16x64_bf16 v[24:27], v[40:43], v[88:95], v1
    ds_read_b128 v[64:67], v3 offset:23040
    v_cvt_pk_bf16_f32 v59, v21, v23
    v_and_or_b32 v58, v58, -2, s60
    v_smfmac_f32_16x16x64_bf16 v[28:31], v[32:35], v[96:103], v1
    buffer_store_dwordx2 v[58:59], v9, s[8:11], 0 offen offset:2048 sc1
    s_waitcnt lgkmcnt(1)
    v_smfmac_f32_16x16x64_bf16 v[28:31], v[36:39], v[72:79], v1
    s_nop 1
    v_cvt_pk_bf16_f32 v60, v24, v26
    v_smfmac_f32_16x16x64_bf16 v[28:31], v[40:43], v[80:87], v1
    s_nop 2
    v_cvt_pk_bf16_f32 v61, v25, v27
    v_and_or_b32 v60, v60, -2, s60
    buffer_store_dwordx2 v[60:61], v9, s[8:11], s26 offen offset:0 sc1
    s_nop 1
    v_cvt_pk_bf16_f32 v62, v28, v30
    v_cvt_pk_bf16_f32 v63, v29, v31
    v_and_or_b32 v62, v62, -2, s60
    buffer_store_dwordx2 v[62:63], v9, s[8:11], s26 offen offset:2048 sc1
L_slow_stored:
    s_cmp_lg_u32 s60, s27
    s_cbranch_scc1 L_slow_safe
    ds_read_b128 v[104:107], v4 offset:0
    ds_read_b128 v[108:111], v4 offset:1024
    ds_read_b128 v[112:115], v4 offset:2048
    ds_read_b128 v[116:119], v4 offset:3072
    ds_read_b128 v[88:91], v4 offset:4096
    ds_read_b128 v[92:95], v4 offset:5120
    ds_read_b128 v[96:99], v4 offset:6144
    ds_read_b128 v[100:103], v4 offset:7168
    ds_read_b128 v[72:75], v4 offset:8192
    ds_read_b128 v[76:79], v4 offset:9216
    ds_read_b128 v[80:83], v4 offset:10240
    ds_read_b128 v[84:87], v4 offset:11264
    s_cmp_lt_u32 s21, 1
    s_cbranch_scc1 L_slow_pollp
    s_nop 9
    s_cmp_lt_u32 s21, 2
    s_cbranch_scc1 L_slow_pollp
    s_nop 9
    s_cmp_lt_u32 s21, 3
    s_cbranch_scc1 L_slow_pollp
    s_nop 9
L_slow_pollp:
    buffer_load_dwordx4 v[120:123], v2, s[8:11], s6 offen sc1
    buffer_load_dwordx4 v[124:127], v2, s[8:11], s6 offen offset:1024 sc1
    v_mov_b64 v[56:57], 0
    v_mov_b64 v[58:59], 0
    v_mov_b64 v[60:61], 0
    v_mov_b64 v[62:63], 0
    s_nop 15
    s_nop 15
    buffer_load_dwordx4 v[32:35], v2, s[8:11], s6 offen sc1
    buffer_load_dwordx4 v[36:39], v2, s[8:11], s6 offen offset:1024 sc1
L_slow_prep:
    s_add_u32 s7, s24, 0x80000
    s_waitcnt vmcnt(3) lgkmcnt(0)
    v_mfma_f32_16x16x32_bf16 v[68:71], v[64:67], v[120:123], 0
    v_bitop3_b32 v14, v120, v122, s27 bitop3:0x7e
    s_waitcnt vmcnt(2)
    v_mfma_f32_16x16x32_bf16 v[68:71], v[64:67], v[124:127], v[68:71]
    v_bitop3_b32 v11, v124, v126, s27 bitop3:0x7e
    v_bitop3_b32 v14, v14, v11, 1 bitop3:0xa8
    v_cmp_ne_u32 vcc, 0, v14
    s_nop 2
    s_cmp_eq_u64 vcc, 0
    s_cselect_b32 s36, s24, s61
    v_add_f32_dpp v68, v68, v68 row_ror:8 row_mask:0xf bank_mask:0xf
    v_add_f32_dpp v69, v69, v69 row_ror:8 row_mask:0xf bank_mask:0xf
    s_nop 0
    v_add_f32_dpp v68, v68, v68 row_ror:4 row_mask:0xf bank_mask:0xf
    v_add_f32_dpp v69, v69, v69 row_ror:4 row_mask:0xf bank_mask:0xf
    v_cvt_pk_bf16_f32 v12, v68, v69
    buffer_store_dword v12, v10, s[8:11], s36 offen sc1
    s_cbranch_scc1 L_slow_gotp
L_slow_retryp:
    buffer_load_dwordx4 v[120:123], v2, s[8:11], s6 offen sc1
    buffer_load_dwordx4 v[124:127], v2, s[8:11], s6 offen offset:1024 sc1
    s_waitcnt vmcnt(4) lgkmcnt(0)
    v_mfma_f32_16x16x32_bf16 v[68:71], v[64:67], v[32:35], 0
    v_bitop3_b32 v14, v32, v34, s27 bitop3:0x7e
    s_waitcnt vmcnt(3)
    v_mfma_f32_16x16x32_bf16 v[68:71], v[64:67], v[36:39], v[68:71]
    v_bitop3_b32 v11, v36, v38, s27 bitop3:0x7e
    v_bitop3_b32 v14, v14, v11, 1 bitop3:0xa8
    v_cmp_ne_u32 vcc, 0, v14
    s_nop 2
    s_cmp_eq_u64 vcc, 0
    s_cselect_b32 s36, s24, s61
    v_add_f32_dpp v68, v68, v68 row_ror:8 row_mask:0xf bank_mask:0xf
    v_add_f32_dpp v69, v69, v69 row_ror:8 row_mask:0xf bank_mask:0xf
    s_nop 0
    v_add_f32_dpp v68, v68, v68 row_ror:4 row_mask:0xf bank_mask:0xf
    v_add_f32_dpp v69, v69, v69 row_ror:4 row_mask:0xf bank_mask:0xf
    v_cvt_pk_bf16_f32 v12, v68, v69
    buffer_store_dword v12, v10, s[8:11], s36 offen sc1
    s_cbranch_scc1 L_slow_gotp
    buffer_load_dwordx4 v[32:35], v2, s[8:11], s6 offen sc1
    buffer_load_dwordx4 v[36:39], v2, s[8:11], s6 offen offset:1024 sc1
    s_waitcnt vmcnt(4) lgkmcnt(0)
    v_mfma_f32_16x16x32_bf16 v[68:71], v[64:67], v[120:123], 0
    v_bitop3_b32 v14, v120, v122, s27 bitop3:0x7e
    s_waitcnt vmcnt(3)
    v_mfma_f32_16x16x32_bf16 v[68:71], v[64:67], v[124:127], v[68:71]
    v_bitop3_b32 v11, v124, v126, s27 bitop3:0x7e
    v_bitop3_b32 v14, v14, v11, 1 bitop3:0xa8
    v_cmp_ne_u32 vcc, 0, v14
    s_nop 2
    s_cmp_eq_u64 vcc, 0
    s_cselect_b32 s36, s24, s61
    v_add_f32_dpp v68, v68, v68 row_ror:8 row_mask:0xf bank_mask:0xf
    v_add_f32_dpp v69, v69, v69 row_ror:8 row_mask:0xf bank_mask:0xf
    s_nop 0
    v_add_f32_dpp v68, v68, v68 row_ror:4 row_mask:0xf bank_mask:0xf
    v_add_f32_dpp v69, v69, v69 row_ror:4 row_mask:0xf bank_mask:0xf
    v_cvt_pk_bf16_f32 v12, v68, v69
    buffer_store_dword v12, v10, s[8:11], s36 offen sc1
    s_cbranch_scc1 L_slow_gotp
    s_add_u32 s32, s32, 1
    s_cmp_le_u32 s32, 200000
    s_cbranch_scc1 L_slow_retryp
    s_mov_b32 s36, s24
    buffer_store_dword v12, v10, s[8:11], s36 offen sc1
L_slow_gotp:
    s_add_u32 s31, s31, 0x2000
    s_cmp_ge_u32 s90, 63
    s_cbranch_scc1 L_slow_last
    s_mov_b32 s23, s24
    s_mov_b32 s22, s90
    s_mov_b32 s27, s28
    v_mov_b64 v[64:65], 0
    v_mov_b64 v[66:67], 0
    v_mov_b64 v[68:69], 0
    v_mov_b64 v[70:71], 0
    s_nop 15
    s_nop 11
    buffer_load_dwordx4 v[16:19], v2, s[8:11], s7 offen sc1
    buffer_load_dwordx4 v[20:23], v2, s[8:11], s7 offen offset:1024 sc1
    s_branch L_slow_step
L_slow_last:
    buffer_store_dword v12, v10, s[8:11], s31 offen sc1
    s_branch L_slow_done
L_slow_refresh:
    buffer_load_dword v15, v0, s[8:11], s23 offen sc1
    s_add_u32 s32, s32, 1
    s_cmp_le_u32 s32, 200000
    s_waitcnt vmcnt(0)
    s_cbranch_scc1 L_slow_step
    s_branch L_slow_fresh
L_slow_safe:
    s_nop 11
    s_waitcnt vmcnt(0) lgkmcnt(0)
    s_barrier
    ds_read_b128 v[72:75], v6 offset:0
    ds_read_b128 v[88:91], v6 offset:2304
    ds_read_b128 v[76:79], v6 offset:64
    ds_read_b128 v[92:95], v6 offset:2368
    ds_read_b128 v[80:83], v6 offset:128
    ds_read_b128 v[96:99], v6 offset:2432
    ds_read_b128 v[84:87], v6 offset:192
    ds_read_b128 v[100:103], v6 offset:2496
    s_xor_b32 s36, s25, 0x1000
    s_add_u32 s36, s36, s23
    buffer_load_dwordx4 v[16:19], v3, s[8:11], s29 offen offset:0 sc1
    buffer_load_dwordx4 v[32:35], v3, s[8:11], s36 offen offset:0 sc1
    buffer_load_dwordx4 v[20:23], v3, s[8:11], s29 offen offset:1024 sc1
    buffer_load_dwordx4 v[36:39], v3, s[8:11], s36 offen offset:1024 sc1
    buffer_load_dwordx4 v[24:27], v3, s[8:11], s29 offen offset:2048 sc1
    buffer_load_dwordx4 v[40:43], v3, s[8:11], s36 offen offset:2048 sc1
    buffer_load_dwordx4 v[28:31], v3, s[8:11], s29 offen offset:3072 sc1
    buffer_load_dwordx4 v[44:47], v3, s[8:11], s36 offen offset:3072 sc1
    s_waitcnt vmcnt(0) lgkmcnt(0)
    v_mfma_f32_16x16x32_bf16 v[48:51], v[16:19], v[72:75], 0
    v_mfma_f32_16x16x32_bf16 v[48:51], v[20:23], v[76:79], v[48:51]
    v_mfma_f32_16x16x32_bf16 v[48:51], v[24:27], v[80:83], v[48:51]
    v_mfma_f32_16x16x32_bf16 v[48:51], v[28:31], v[84:87], v[48:51]
    v_mfma_f32_16x16x32_bf16 v[52:55], v[32:35], v[72:75], 0
    v_mfma_f32_16x16x32_bf16 v[52:55], v[36:39], v[76:79], v[52:55]
    v_mfma_f32_16x16x32_bf16 v[52:55], v[40:43], v[80:83], v[52:55]
    v_mfma_f32_16x16x32_bf16 v[52:55], v[44:47], v[84:87], v[52:55]
    v_mfma_f32_16x16x32_bf16 v[56:59], v[88:91], v[72:75], 0
    v_mfma_f32_16x16x32_bf16 v[56:59], v[92:95], v[76:79], v[56:59]
    v_mfma_f32_16x16x32_bf16 v[56:59], v[96:99], v[80:83], v[56:59]
    v_mfma_f32_16x16x32_bf16 v[56:59], v[100:103], v[84:87], v[56:59]
    v_max3_f32 v16, v48, v49, v50
    s_nop 2
    v_max3_f32 v16, v16, v51, v52
    v_max3_f32 v16, v16, v53, v54
    s_nop 1
    v_max3_f32 v16, v16, v55, v56
    v_max_f32 v16, v16, v57
    v_mov_b32 v17, v16
    s_nop 1
    v_permlane16_swap_b32 v16, v17
    v_max_f32 v16, v16, v17
    v_mov_b32 v17, v16
    s_nop 1
    v_permlane32_swap_b32 v16, v17
    v_max_f32 v16, v16, v17
    v_sub_f32 v48, v48, v16
    v_exp_f32 v48, v48
    v_sub_f32 v49, v49, v16
    v_exp_f32 v49, v49
    v_sub_f32 v50, v50, v16
    v_exp_f32 v50, v50
    v_sub_f32 v51, v51, v16
    v_exp_f32 v51, v51
    v_sub_f32 v52, v52, v16
    v_exp_f32 v52, v52
    v_sub_f32 v53, v53, v16
    v_exp_f32 v53, v53
    v_sub_f32 v54, v54, v16
    v_exp_f32 v54, v54
    v_sub_f32 v55, v55, v16
    v_exp_f32 v55, v55
    v_sub_f32 v56, v56, v16
    v_exp_f32 v56, v56
    v_sub_f32 v57, v57, v16
    v_exp_f32 v57, v57
    v_cvt_pk_bf16_f32 v108, v48, v49
    v_cvt_pk_bf16_f32 v109, v50, v51
    v_cvt_pk_bf16_f32 v110, v52, v53
    v_cvt_pk_bf16_f32 v111, v54, v55
    v_cvt_pk_bf16_f32 v112, v56, v57
    s_nop 0
    v_mfma_f32_16x16x32_bf16 v[48:51], v[104:107], v[108:111], 0
    v_mfma_f32_16x16x32_bf16 v[56:59], v[120:123], v[108:111], 0
    v_mfma_f32_16x16x32_bf16 v[60:63], v[124:127], v[108:111], 0
    s_nop 3
    v_mfma_f32_16x16x16_bf16 v[48:51], v[104:105], v[112:113], v[48:51]
    v_mfma_f32_16x16x16_bf16 v[56:59], v[114:115], v[112:113], v[56:59]
    v_mfma_f32_16x16x16_bf16 v[60:63], v[116:117], v[112:113], v[60:63]
    s_nop 5
    v_rcp_f32 v118, v48
    s_nop 0
    v_mul_f32 v56, v56, v118
    v_mul_f32 v57, v57, v118
    v_mul_f32 v58, v58, v118
    v_mul_f32 v59, v59, v118
    v_mul_f32 v60, v60, v118
    v_mul_f32 v61, v61, v118
    v_mul_f32 v62, v62, v118
    v_mul_f32 v63, v63, v118
    v_cvt_pk_bf16_f32 v52, v56, v60
    v_cvt_pk_bf16_f32 v53, v57, v61
    v_cvt_pk_bf16_f32 v54, v58, v62
    v_cvt_pk_bf16_f32 v55, v59, v63
    v_mov_b32 v16, 0
    v_mov_b32 v17, 0
    v_mov_b32 v18, 0
    v_mov_b32 v19, 0
    v_mov_b32 v20, 0
    v_mov_b32 v21, 0
    v_mov_b32 v22, 0
    v_mov_b32 v23, 0
    v_mov_b32 v24, 0
    v_mov_b32 v25, 0
    v_mov_b32 v26, 0
    v_mov_b32 v27, 0
    v_mov_b32 v28, 0
    v_mov_b32 v29, 0
    v_mov_b32 v30, 0
    v_mov_b32 v31, 0
    v_bitop3_b32 v32, v13, s96, -9 bitop3:0x28
    v_bitop3_b32 v36, v13, s97, -9 bitop3:0x28
    v_bitop3_b32 v40, v13, s98, -9 bitop3:0x28
    s_mov_b64 vcc, 0
    s_branch L_slow_rejoin
L_slow_done:
    s_branch L_end
L_worker:
    s_cmp_eq_u32 s3, 7
    s_cbranch_scc1 L_mlp
    s_and_b32 s36, s2, 7
    s_sub_u32 s36, s36, 1
    s_lshl_b32 s36, s36, 5
    s_lshr_b32 s37, s2, 3
    s_add_u32 s36, s36, s37
    s_mul_i32 s20, s36, 10923
    s_lshr_b32 s20, s20, 16
    s_mul_i32 s37, s20, 6
    s_sub_u32 s22, s36, s37
    v_lshrrev_b32 v28, 4, v0
    v_and_b32 v16, 15, v0
    v_lshlrev_b32 v16, 4, v16
    v_lshl_add_u32 v16, v28, 13, v16
    v_bfe_u32 v29, v0, 4, 2
    v_lshlrev_b32 v29, 5, v29
    v_xor_b32 v16, v16, v29
    v_and_b32 v29, 128, v0
    v_xor_b32 v16, v16, v29
    s_lshl_b32 s28, s21, 10
    s_lshl_b32 s3, s20, 8
    s_mov_b32 s76, s52
    s_and_b32 s77, s53, 0xffff
    s_mov_b32 s78, 0x400000
    s_mov_b32 s79, 0x20000
    s_add_u32 m0, s28, 32768
    s_add_u32 s37, s3, 0x0
    buffer_load_dwordx4 v16, s[76:79], s37 offen lds
    s_add_u32 m0, s28, 36864
    s_add_u32 s37, s3, 0x20000
    buffer_load_dwordx4 v16, s[76:79], s37 offen lds
    s_add_u32 m0, s28, 65536
    s_add_u32 s37, s3, 0x40000
    buffer_load_dwordx4 v16, s[76:79], s37 offen lds
    s_add_u32 m0, s28, 69632
    s_add_u32 s37, s3, 0x60000
    buffer_load_dwordx4 v16, s[76:79], s37 offen lds
    s_add_u32 m0, s28, 98304
    s_add_u32 s37, s3, 0x80000
    buffer_load_dwordx4 v16, s[76:79], s37 offen lds
    s_add_u32 m0, s28, 102400
    s_add_u32 s37, s3, 0xa0000
    buffer_load_dwordx4 v16, s[76:79], s37 offen lds
    s_add_u32 m0, s28, 131072
    s_add_u32 s37, s3, 0xc0000
    buffer_load_dwordx4 v16, s[76:79], s37 offen lds
    s_add_u32 m0, s28, 135168
    s_add_u32 s37, s3, 0xe0000
    buffer_load_dwordx4 v16, s[76:79], s37 offen lds
    s_add_u32 m0, s28, 40960
    s_add_u32 s37, s3, 0x100000
    buffer_load_dwordx4 v16, s[76:79], s37 offen lds
    s_add_u32 m0, s28, 45056
    s_add_u32 s37, s3, 0x120000
    buffer_load_dwordx4 v16, s[76:79], s37 offen lds
    s_add_u32 m0, s28, 73728
    s_add_u32 s37, s3, 0x140000
    buffer_load_dwordx4 v16, s[76:79], s37 offen lds
    s_add_u32 m0, s28, 77824
    s_add_u32 s37, s3, 0x160000
    buffer_load_dwordx4 v16, s[76:79], s37 offen lds
    s_add_u32 m0, s28, 106496
    s_add_u32 s37, s3, 0x180000
    buffer_load_dwordx4 v16, s[76:79], s37 offen lds
    s_add_u32 m0, s28, 110592
    s_add_u32 s37, s3, 0x1a0000
    buffer_load_dwordx4 v16, s[76:79], s37 offen lds
    s_add_u32 m0, s28, 139264
    s_add_u32 s37, s3, 0x1c0000
    buffer_load_dwordx4 v16, s[76:79], s37 offen lds
    s_add_u32 m0, s28, 143360
    s_add_u32 s37, s3, 0x1e0000
    buffer_load_dwordx4 v16, s[76:79], s37 offen lds
    s_add_u32 m0, s28, 49152
    s_add_u32 s37, s3, 0x200000
    buffer_load_dwordx4 v16, s[76:79], s37 offen lds
    s_add_u32 m0, s28, 53248
    s_add_u32 s37, s3, 0x220000
    buffer_load_dwordx4 v16, s[76:79], s37 offen lds
    s_add_u32 m0, s28, 81920
    s_add_u32 s37, s3, 0x240000
    buffer_load_dwordx4 v16, s[76:79], s37 offen lds
    s_add_u32 m0, s28, 86016
    s_add_u32 s37, s3, 0x260000
    buffer_load_dwordx4 v16, s[76:79], s37 offen lds
    s_add_u32 m0, s28, 114688
    s_add_u32 s37, s3, 0x280000
    buffer_load_dwordx4 v16, s[76:79], s37 offen lds
    s_add_u32 m0, s28, 118784
    s_add_u32 s37, s3, 0x2a0000
    buffer_load_dwordx4 v16, s[76:79], s37 offen lds
    s_add_u32 m0, s28, 147456
    s_add_u32 s37, s3, 0x2c0000
    buffer_load_dwordx4 v16, s[76:79], s37 offen lds
    s_add_u32 m0, s28, 151552
    s_add_u32 s37, s3, 0x2e0000
    buffer_load_dwordx4 v16, s[76:79], s37 offen lds
    s_add_u32 m0, s28, 57344
    s_add_u32 s37, s3, 0x300000
    buffer_load_dwordx4 v16, s[76:79], s37 offen lds
    s_add_u32 m0, s28, 61440
    s_add_u32 s37, s3, 0x320000
    buffer_load_dwordx4 v16, s[76:79], s37 offen lds
    s_add_u32 m0, s28, 90112
    s_add_u32 s37, s3, 0x340000
    buffer_load_dwordx4 v16, s[76:79], s37 offen lds
    s_add_u32 m0, s28, 94208
    s_add_u32 s37, s3, 0x360000
    buffer_load_dwordx4 v16, s[76:79], s37 offen lds
    s_add_u32 m0, s28, 122880
    s_add_u32 s37, s3, 0x380000
    buffer_load_dwordx4 v16, s[76:79], s37 offen lds
    s_add_u32 m0, s28, 126976
    s_add_u32 s37, s3, 0x3a0000
    buffer_load_dwordx4 v16, s[76:79], s37 offen lds
    s_add_u32 m0, s28, 155648
    s_add_u32 s37, s3, 0x3c0000
    buffer_load_dwordx4 v16, s[76:79], s37 offen lds
    s_add_u32 m0, s28, 159744
    s_add_u32 s37, s3, 0x3e0000
    buffer_load_dwordx4 v16, s[76:79], s37 offen lds
    v_mov_b32 v20, 0x0
    v_bfe_u32 v14, v0, 0, 1
    s_mov_b32 s38, 0x8
    v_mad_u32_u24 v20, v14, s38, v20
    v_bfe_u32 v14, v0, 1, 1
    s_mov_b32 s38, 0x10
    v_mad_u32_u24 v20, v14, s38, v20
    v_bfe_u32 v14, v0, 2, 1
    s_mov_b32 s38, 0x100
    v_mad_u32_u24 v20, v14, s38, v20
    v_bfe_u32 v14, v0, 3, 1
    s_mov_b32 s38, 0x200
    v_mad_u32_u24 v20, v14, s38, v20
    v_bfe_u32 v14, v0, 4, 1
    s_mov_b32 s38, 0x800
    v_mad_u32_u24 v20, v14, s38, v20
    v_bfe_u32 v14, v0, 5, 1
    s_mov_b32 s38, 0x1000
    v_mad_u32_u24 v20, v14, s38, v20
    v_mov_b32 v30, 0x0
    v_bfe_u32 v14, v0, 2, 1
    s_mov_b32 s38, 0x20
    v_mad_u32_u24 v30, v14, s38, v30
    v_bfe_u32 v14, v0, 3, 1
    s_mov_b32 s38, 0x40
    v_mad_u32_u24 v30, v14, s38, v30
    v_bfe_u32 v14, v0, 4, 1
    s_mov_b32 s38, 0x80
    v_mad_u32_u24 v30, v14, s38, v30
    v_mov_b32 v31, 0x0
    v_bfe_u32 v14, v0, 6, 1
    s_mov_b32 s38, 0x40
    v_mad_u32_u24 v31, v14, s38, v31
    v_bfe_u32 v14, v0, 7, 1
    s_mov_b32 s38, 0x80
    v_mad_u32_u24 v31, v14, s38, v31
    v_xor_b32 v30, v30, v31
    v_add_u32 v30, v30, v20
    v_add_u32 v20, 0x8000, v30
    v_xor_b32 v21, 32, v20
    v_add_u32 v22, 0x10000, v30
    v_xor_b32 v23, 32, v22
    v_add_u32 v24, 0x18000, v30
    v_xor_b32 v25, 32, v24
    v_add_u32 v26, 0x20000, v30
    v_xor_b32 v27, 32, v26
    s_mov_b32 s12, s54
    s_and_b32 s13, s55, 0xffff
    s_mov_b32 s14, 0x400000
    s_mov_b32 s15, 0x20000
    s_lshl_b32 s24, s20, 17
    s_and_b32 s25, s22, 3
    s_lshl_b32 s25, s25, 15
    s_add_u32 s24, s24, s25
    v_lshlrev_b32 v30, 7, v0
    buffer_load_dword v31, v30, s[12:15], s24 offen
    s_mov_b32 s12, s44
    s_and_b32 s13, s45, 0xffff
    s_mov_b32 s14, 0x200000
    s_mov_b32 s15, 0x20000
    s_mov_b32 s60, s82
    s_and_b32 s61, s83, 0xffff
    s_mov_b32 s62, 0x200000
    s_mov_b32 s63, 0x20000
    s_mov_b32 s92, s80
    s_and_b32 s93, s81, 0xffff
    s_mov_b32 s94, 0x400
    s_mov_b32 s95, 0x20000
    v_mov_b32 v1, 0x0
    v_bfe_u32 v14, v0, 0, 1
    s_mov_b32 s38, 0x10
    v_mad_u32_u24 v1, v14, s38, v1
    v_bfe_u32 v14, v0, 1, 1
    s_mov_b32 s38, 0x20
    v_mad_u32_u24 v1, v14, s38, v1
    v_bfe_u32 v14, v0, 2, 1
    s_mov_b32 s38, 0x40
    v_mad_u32_u24 v1, v14, s38, v1
    v_bfe_u32 v14, v0, 3, 1
    s_mov_b32 s38, 0x80
    v_mad_u32_u24 v1, v14, s38, v1
    v_bfe_u32 v14, v0, 4, 1
    s_mov_b32 s38, 0x100
    v_mad_u32_u24 v1, v14, s38, v1
    v_bfe_u32 v14, v0, 5, 1
    s_mov_b32 s38, 0x200
    v_mad_u32_u24 v1, v14, s38, v1
    v_mov_b32 v2, 0x0
    v_bfe_u32 v14, v0, 0, 1
    s_mov_b32 s38, 0x10
    v_mad_u32_u24 v2, v14, s38, v2
    v_bfe_u32 v14, v0, 1, 1
    s_mov_b32 s38, 0x20
    v_mad_u32_u24 v2, v14, s38, v2
    v_bfe_u32 v14, v0, 2, 1
    s_mov_b32 s38, 0x40
    v_mad_u32_u24 v2, v14, s38, v2
    v_bfe_u32 v14, v0, 3, 1
    s_mov_b32 s38, 0x80
    v_mad_u32_u24 v2, v14, s38, v2
    v_bfe_u32 v14, v0, 4, 1
    s_mov_b32 s38, 0x100
    v_mad_u32_u24 v2, v14, s38, v2
    v_bfe_u32 v14, v0, 5, 1
    s_mov_b32 s38, 0x200
    v_mad_u32_u24 v2, v14, s38, v2
    v_bfe_u32 v14, v0, 6, 1
    s_mov_b32 s38, 0x800
    v_mad_u32_u24 v2, v14, s38, v2
    v_bfe_u32 v14, v0, 7, 1
    s_mov_b32 s38, 0x1000
    v_mad_u32_u24 v2, v14, s38, v2
    v_mov_b32 v9, 0x0
    v_bfe_u32 v14, v0, 0, 1
    s_mov_b32 s38, 0x10
    v_mad_u32_u24 v9, v14, s38, v9
    v_bfe_u32 v14, v0, 1, 1
    s_mov_b32 s38, 0x20
    v_mad_u32_u24 v9, v14, s38, v9
    v_bfe_u32 v14, v0, 2, 1
    s_mov_b32 s38, 0x40
    v_mad_u32_u24 v9, v14, s38, v9
    v_bfe_u32 v14, v0, 3, 1
    s_mov_b32 s38, 0x80
    v_mad_u32_u24 v9, v14, s38, v9
    v_bfe_u32 v14, v0, 4, 1
    s_mov_b32 s38, 0x100
    v_mad_u32_u24 v9, v14, s38, v9
    v_bfe_u32 v14, v0, 5, 1
    s_mov_b32 s38, 0x200
    v_mad_u32_u24 v9, v14, s38, v9
    v_bfe_u32 v14, v0, 6, 1
    s_mov_b32 s38, 0x400
    v_mad_u32_u24 v9, v14, s38, v9
    v_bfe_u32 v14, v0, 7, 1
    s_mov_b32 s38, 0x800
    v_mad_u32_u24 v9, v14, s38, v9
    v_mov_b32 v7, 0x8000
    v_bfe_u32 v14, v0, 0, 1
    s_mov_b32 s38, 0x10
    v_mad_u32_u24 v7, v14, s38, v7
    v_bfe_u32 v14, v0, 1, 1
    s_mov_b32 s38, 0x20
    v_mad_u32_u24 v7, v14, s38, v7
    v_bfe_u32 v14, v0, 2, 1
    s_mov_b32 s38, 0x40
    v_mad_u32_u24 v7, v14, s38, v7
    v_bfe_u32 v14, v0, 3, 1
    s_mov_b32 s38, 0x80
    v_mad_u32_u24 v7, v14, s38, v7
    v_bfe_u32 v14, v0, 4, 1
    s_mov_b32 s38, 0x100
    v_mad_u32_u24 v7, v14, s38, v7
    v_bfe_u32 v14, v0, 5, 1
    s_mov_b32 s38, 0x200
    v_mad_u32_u24 v7, v14, s38, v7
    v_bfe_u32 v14, v0, 6, 1
    s_mov_b32 s38, 0x8000
    v_mad_u32_u24 v7, v14, s38, v7
    v_bfe_u32 v14, v0, 7, 1
    s_mov_b32 s38, 0x10000
    v_mad_u32_u24 v7, v14, s38, v7
    v_mov_b32 v3, 0x0
    v_bfe_u32 v14, v0, 0, 1
    s_mov_b32 s38, 0x10
    v_mad_u32_u24 v3, v14, s38, v3
    v_bfe_u32 v14, v0, 1, 1
    s_mov_b32 s38, 0x20
    v_mad_u32_u24 v3, v14, s38, v3
    v_bfe_u32 v14, v0, 2, 1
    s_mov_b32 s38, 0x40
    v_mad_u32_u24 v3, v14, s38, v3
    v_bfe_u32 v14, v0, 3, 1
    s_mov_b32 s38, 0x400
    v_mad_u32_u24 v3, v14, s38, v3
    v_bfe_u32 v14, v0, 4, 1
    s_mov_b32 s38, 0x800
    v_mad_u32_u24 v3, v14, s38, v3
    v_bfe_u32 v14, v0, 5, 1
    s_mov_b32 s38, 0x1000
    v_mad_u32_u24 v3, v14, s38, v3
    v_bfe_u32 v14, v0, 6, 1
    s_mov_b32 s38, 0x2000
    v_mad_u32_u24 v3, v14, s38, v3
    v_bfe_u32 v14, v0, 7, 1
    s_mov_b32 s38, 0x4000
    v_mad_u32_u24 v3, v14, s38, v3
    v_mov_b32 v4, 0x0
    v_bfe_u32 v14, v0, 0, 1
    s_mov_b32 s38, 0x100
    v_mad_u32_u24 v4, v14, s38, v4
    v_bfe_u32 v14, v0, 1, 1
    s_mov_b32 s38, 0x200
    v_mad_u32_u24 v4, v14, s38, v4
    v_bfe_u32 v14, v0, 2, 1
    s_mov_b32 s38, 0x400
    v_mad_u32_u24 v4, v14, s38, v4
    v_bfe_u32 v14, v0, 6, 1
    s_mov_b32 s38, 0x80
    v_mad_u32_u24 v4, v14, s38, v4
    v_bfe_u32 v14, v0, 7, 1
    s_mov_b32 s38, 0x4000
    v_mad_u32_u24 v4, v14, s38, v4
    v_lshrrev_b32 v15, 3, v0
    v_xor_b32 v15, v15, v0
    v_and_b32 v15, 7, v15
    v_lshl_add_u32 v4, v15, 4, v4
    v_bfe_u32 v15, v0, 4, 2
    v_lshlrev_b32 v15, 4, v15
    v_xor_b32 v5, v15, v1
    v_xor_b32 v6, 64, v5
    v_mov_b32 v8, 0x5000
    v_bfe_u32 v14, v0, 0, 1
    s_mov_b32 s38, 0x10
    v_mad_u32_u24 v8, v14, s38, v8
    v_bfe_u32 v14, v0, 1, 1
    s_mov_b32 s38, 0x40
    v_mad_u32_u24 v8, v14, s38, v8
    v_bfe_u32 v14, v0, 2, 1
    s_mov_b32 s38, 0x80
    v_mad_u32_u24 v8, v14, s38, v8
    v_bfe_u32 v14, v0, 4, 1
    s_mov_b32 s38, 0x20
    v_mad_u32_u24 v8, v14, s38, v8
    v_bfe_u32 v14, v0, 5, 1
    s_mov_b32 s38, 0x100
    v_mad_u32_u24 v8, v14, s38, v8
    v_mov_b32 v10, 0x0
    v_bfe_u32 v14, v0, 0, 1
    s_mov_b32 s38, 0x10
    v_mad_u32_u24 v10, v14, s38, v10
    v_bfe_u32 v14, v0, 1, 1
    s_mov_b32 s38, 0x20
    v_mad_u32_u24 v10, v14, s38, v10
    v_bfe_u32 v14, v0, 2, 1
    s_mov_b32 s38, 0x40
    v_mad_u32_u24 v10, v14, s38, v10
    v_bfe_u32 v14, v0, 3, 1
    s_mov_b32 s38, 0x80
    v_mad_u32_u24 v10, v14, s38, v10
    v_bfe_u32 v14, v0, 4, 1
    s_mov_b32 s38, 0x20000
    v_mad_u32_u24 v10, v14, s38, v10
    v_bfe_u32 v14, v0, 5, 1
    s_mov_b32 s38, 0x40000
    v_mad_u32_u24 v10, v14, s38, v10
    v_bfe_u32 v14, v0, 6, 1
    s_mov_b32 s38, 0x100
    v_mad_u32_u24 v10, v14, s38, v10
    v_bfe_u32 v14, v0, 7, 1
    s_mov_b32 s38, 0x200
    v_mad_u32_u24 v10, v14, s38, v10
    v_mov_b32 v11, 0x0
    v_bfe_u32 v14, v0, 0, 1
    s_mov_b32 s38, 0x10
    v_mad_u32_u24 v11, v14, s38, v11
    v_bfe_u32 v14, v0, 1, 1
    s_mov_b32 s38, 0x20
    v_mad_u32_u24 v11, v14, s38, v11
    v_bfe_u32 v14, v0, 2, 1
    s_mov_b32 s38, 0x40
    v_mad_u32_u24 v11, v14, s38, v11
    v_bfe_u32 v14, v0, 3, 1
    s_mov_b32 s38, 0x80
    v_mad_u32_u24 v11, v14, s38, v11
    v_bfe_u32 v14, v0, 4, 1
    s_mov_b32 s38, 0x400
    v_mad_u32_u24 v11, v14, s38, v11
    v_bfe_u32 v14, v0, 5, 1
    s_mov_b32 s38, 0x800
    v_mad_u32_u24 v11, v14, s38, v11
    v_bfe_u32 v14, v0, 6, 1
    s_mov_b32 s38, 0x100
    v_mad_u32_u24 v11, v14, s38, v11
    v_bfe_u32 v14, v0, 7, 1
    s_mov_b32 s38, 0x200
    v_mad_u32_u24 v11, v14, s38, v11
    v_mov_b32 v12, 0x0
    v_bfe_u32 v14, v0, 0, 1
    s_mov_b32 s38, 0x10
    v_mad_u32_u24 v12, v14, s38, v12
    v_bfe_u32 v14, v0, 1, 1
    s_mov_b32 s38, 0x20
    v_mad_u32_u24 v12, v14, s38, v12
    v_bfe_u32 v14, v0, 2, 1
    s_mov_b32 s38, 0x40
    v_mad_u32_u24 v12, v14, s38, v12
    v_bfe_u32 v14, v0, 3, 1
    s_mov_b32 s38, 0x80
    v_mad_u32_u24 v12, v14, s38, v12
    v_bfe_u32 v14, v0, 4, 1
    s_mov_b32 s38, 0x4
    v_mad_u32_u24 v12, v14, s38, v12
    v_bfe_u32 v14, v0, 5, 1
    s_mov_b32 s38, 0x8
    v_mad_u32_u24 v12, v14, s38, v12
    v_bfe_u32 v14, v0, 6, 1
    s_mov_b32 s38, 0x100
    v_mad_u32_u24 v12, v14, s38, v12
    v_bfe_u32 v14, v0, 7, 1
    s_mov_b32 s38, 0x200
    v_mad_u32_u24 v12, v14, s38, v12
    v_mov_b32 v13, 0xf149f2ca
    v_and_b32 v14, 15, v0
    v_bfe_u32 v15, v0, 4, 2
    v_cmp_gt_u32 s[72:73], 2, v15
    v_lshlrev_b32 v15, 2, v15
    v_cmp_le_u32 s[64:65], v15, v14
    v_add_u32 v15, 1, v15
    v_cmp_le_u32 s[66:67], v15, v14
    v_add_u32 v15, 1, v15
    v_cmp_le_u32 s[68:69], v15, v14
    v_add_u32 v15, 1, v15
    v_cmp_le_u32 s[70:71], v15, v14
    v_add_u32 v15, 1, v15
    s_mov_b32 s34, 0x05040100
    s_mov_b32 s35, 0x07060302
    s_mov_b32 s33, 0x3e0293ee
    s_mov_b32 s32, 0
    s_mov_b32 s4, 0x3f803f80
    s_mov_b32 s5, 0x3f803f80
    s_mov_b32 s23, s22
    s_lshl_b32 s36, s23, 15
    buffer_load_dwordx4 v[96:99], v3, s[12:15], s36 offen offset:0
    buffer_load_dwordx4 v[100:103], v3, s[12:15], s36 offen offset:128
    buffer_load_dwordx4 v[104:107], v3, s[12:15], s36 offen offset:256
    buffer_load_dwordx4 v[108:111], v3, s[12:15], s36 offen offset:384
    buffer_load_dwordx4 v[112:115], v3, s[12:15], s36 offen offset:512
    buffer_load_dwordx4 v[116:119], v3, s[12:15], s36 offen offset:640
    buffer_load_dwordx4 v[120:123], v3, s[12:15], s36 offen offset:768
    buffer_load_dwordx4 v[124:127], v3, s[12:15], s36 offen offset:896
    s_waitcnt vmcnt(33)
    s_barrier
    ds_read_b64_tr_b16 v[128:129], v20 offset:0
    ds_read_b64_tr_b16 v[130:131], v20 offset:1024
    ds_read_b64_tr_b16 v[132:133], v21 offset:0
    ds_read_b64_tr_b16 v[134:135], v21 offset:1024
    ds_read_b64_tr_b16 v[136:137], v22 offset:0
    ds_read_b64_tr_b16 v[138:139], v22 offset:1024
    ds_read_b64_tr_b16 v[140:141], v23 offset:0
    ds_read_b64_tr_b16 v[142:143], v23 offset:1024
    ds_read_b64_tr_b16 v[144:145], v24 offset:0
    ds_read_b64_tr_b16 v[146:147], v24 offset:1024
    ds_read_b64_tr_b16 v[148:149], v25 offset:0
    ds_read_b64_tr_b16 v[150:151], v25 offset:1024
    s_waitcnt lgkmcnt(4)
    ds_read_b64_tr_b16 v[152:153], v26 offset:0
    ds_read_b64_tr_b16 v[154:155], v26 offset:1024
    ds_read_b64_tr_b16 v[156:157], v27 offset:0
    ds_read_b64_tr_b16 v[158:159], v27 offset:1024
    s_waitcnt lgkmcnt(0)
    s_barrier
    s_mov_b32 s40, s50
    s_and_b32 s41, s51, 0xffff
    s_mov_b32 s42, 0x400000
    s_mov_b32 s43, 0x20000
    s_add_u32 m0, s28, 32768
    s_add_u32 s37, s3, 0x0
    buffer_load_dwordx4 v16, s[40:43], s37 offen lds
    s_add_u32 m0, s28, 36864
    s_add_u32 s37, s3, 0x20000
    buffer_load_dwordx4 v16, s[40:43], s37 offen lds
    s_add_u32 m0, s28, 65536
    s_add_u32 s37, s3, 0x40000
    buffer_load_dwordx4 v16, s[40:43], s37 offen lds
    s_add_u32 m0, s28, 69632
    s_add_u32 s37, s3, 0x60000
    buffer_load_dwordx4 v16, s[40:43], s37 offen lds
    s_add_u32 m0, s28, 98304
    s_add_u32 s37, s3, 0x80000
    buffer_load_dwordx4 v16, s[40:43], s37 offen lds
    s_add_u32 m0, s28, 102400
    s_add_u32 s37, s3, 0xa0000
    buffer_load_dwordx4 v16, s[40:43], s37 offen lds
    s_add_u32 m0, s28, 131072
    s_add_u32 s37, s3, 0xc0000
    buffer_load_dwordx4 v16, s[40:43], s37 offen lds
    s_add_u32 m0, s28, 135168
    s_add_u32 s37, s3, 0xe0000
    buffer_load_dwordx4 v16, s[40:43], s37 offen lds
    s_waitcnt vmcnt(33)
    s_barrier
    ds_read_b64_tr_b16 v[160:161], v20 offset:8192
    ds_read_b64_tr_b16 v[162:163], v20 offset:9216
    ds_read_b64_tr_b16 v[164:165], v21 offset:8192
    ds_read_b64_tr_b16 v[166:167], v21 offset:9216
    ds_read_b64_tr_b16 v[168:169], v22 offset:8192
    ds_read_b64_tr_b16 v[170:171], v22 offset:9216
    ds_read_b64_tr_b16 v[172:173], v23 offset:8192
    ds_read_b64_tr_b16 v[174:175], v23 offset:9216
    ds_read_b64_tr_b16 v[176:177], v24 offset:8192
    ds_read_b64_tr_b16 v[178:179], v24 offset:9216
    ds_read_b64_tr_b16 v[180:181], v25 offset:8192
    ds_read_b64_tr_b16 v[182:183], v25 offset:9216
    s_waitcnt lgkmcnt(4)
    ds_read_b64_tr_b16 v[184:185], v26 offset:8192
    ds_read_b64_tr_b16 v[186:187], v26 offset:9216
    ds_read_b64_tr_b16 v[188:189], v27 offset:8192
    ds_read_b64_tr_b16 v[190:191], v27 offset:9216
    s_waitcnt lgkmcnt(0)
    s_barrier
    s_add_u32 m0, s28, 40960
    s_add_u32 s37, s3, 0x100000
    buffer_load_dwordx4 v16, s[40:43], s37 offen lds
    s_add_u32 m0, s28, 45056
    s_add_u32 s37, s3, 0x120000
    buffer_load_dwordx4 v16, s[40:43], s37 offen lds
    s_add_u32 m0, s28, 73728
    s_add_u32 s37, s3, 0x140000
    buffer_load_dwordx4 v16, s[40:43], s37 offen lds
    s_add_u32 m0, s28, 77824
    s_add_u32 s37, s3, 0x160000
    buffer_load_dwordx4 v16, s[40:43], s37 offen lds
    s_add_u32 m0, s28, 106496
    s_add_u32 s37, s3, 0x180000
    buffer_load_dwordx4 v16, s[40:43], s37 offen lds
    s_add_u32 m0, s28, 110592
    s_add_u32 s37, s3, 0x1a0000
    buffer_load_dwordx4 v16, s[40:43], s37 offen lds
    s_add_u32 m0, s28, 139264
    s_add_u32 s37, s3, 0x1c0000
    buffer_load_dwordx4 v16, s[40:43], s37 offen lds
    s_add_u32 m0, s28, 143360
    s_add_u32 s37, s3, 0x1e0000
    buffer_load_dwordx4 v16, s[40:43], s37 offen lds
    s_waitcnt vmcnt(33)
    s_barrier
    ds_read_b64_tr_b16 v[192:193], v20 offset:16384
    ds_read_b64_tr_b16 v[194:195], v20 offset:17408
    ds_read_b64_tr_b16 v[196:197], v21 offset:16384
    ds_read_b64_tr_b16 v[198:199], v21 offset:17408
    ds_read_b64_tr_b16 v[200:201], v22 offset:16384
    ds_read_b64_tr_b16 v[202:203], v22 offset:17408
    ds_read_b64_tr_b16 v[204:205], v23 offset:16384
    ds_read_b64_tr_b16 v[206:207], v23 offset:17408
    ds_read_b64_tr_b16 v[208:209], v24 offset:16384
    ds_read_b64_tr_b16 v[210:211], v24 offset:17408
    ds_read_b64_tr_b16 v[212:213], v25 offset:16384
    ds_read_b64_tr_b16 v[214:215], v25 offset:17408
    s_waitcnt lgkmcnt(4)
    ds_read_b64_tr_b16 v[216:217], v26 offset:16384
    ds_read_b64_tr_b16 v[218:219], v26 offset:17408
    ds_read_b64_tr_b16 v[220:221], v27 offset:16384
    ds_read_b64_tr_b16 v[222:223], v27 offset:17408
    s_waitcnt lgkmcnt(0)
    s_barrier
    s_add_u32 m0, s28, 49152
    s_add_u32 s37, s3, 0x200000
    buffer_load_dwordx4 v16, s[40:43], s37 offen lds
    s_add_u32 m0, s28, 53248
    s_add_u32 s37, s3, 0x220000
    buffer_load_dwordx4 v16, s[40:43], s37 offen lds
    s_add_u32 m0, s28, 81920
    s_add_u32 s37, s3, 0x240000
    buffer_load_dwordx4 v16, s[40:43], s37 offen lds
    s_add_u32 m0, s28, 86016
    s_add_u32 s37, s3, 0x260000
    buffer_load_dwordx4 v16, s[40:43], s37 offen lds
    s_add_u32 m0, s28, 114688
    s_add_u32 s37, s3, 0x280000
    buffer_load_dwordx4 v16, s[40:43], s37 offen lds
    s_add_u32 m0, s28, 118784
    s_add_u32 s37, s3, 0x2a0000
    buffer_load_dwordx4 v16, s[40:43], s37 offen lds
    s_add_u32 m0, s28, 147456
    s_add_u32 s37, s3, 0x2c0000
    buffer_load_dwordx4 v16, s[40:43], s37 offen lds
    s_add_u32 m0, s28, 151552
    s_add_u32 s37, s3, 0x2e0000
    buffer_load_dwordx4 v16, s[40:43], s37 offen lds
    s_waitcnt vmcnt(33)
    s_barrier
    ds_read_b64_tr_b16 v[224:225], v20 offset:24576
    ds_read_b64_tr_b16 v[226:227], v20 offset:25600
    ds_read_b64_tr_b16 v[228:229], v21 offset:24576
    ds_read_b64_tr_b16 v[230:231], v21 offset:25600
    ds_read_b64_tr_b16 v[232:233], v22 offset:24576
    ds_read_b64_tr_b16 v[234:235], v22 offset:25600
    ds_read_b64_tr_b16 v[236:237], v23 offset:24576
    ds_read_b64_tr_b16 v[238:239], v23 offset:25600
    ds_read_b64_tr_b16 v[240:241], v24 offset:24576
    ds_read_b64_tr_b16 v[242:243], v24 offset:25600
    ds_read_b64_tr_b16 v[244:245], v25 offset:24576
    ds_read_b64_tr_b16 v[246:247], v25 offset:25600
    s_waitcnt lgkmcnt(4)
    ds_read_b64_tr_b16 v[248:249], v26 offset:24576
    ds_read_b64_tr_b16 v[250:251], v26 offset:25600
    ds_read_b64_tr_b16 v[252:253], v27 offset:24576
    ds_read_b64_tr_b16 v[254:255], v27 offset:25600
    s_waitcnt lgkmcnt(0)
    s_barrier
    s_add_u32 m0, s28, 57344
    s_add_u32 s37, s3, 0x300000
    buffer_load_dwordx4 v16, s[40:43], s37 offen lds
    s_add_u32 m0, s28, 61440
    s_add_u32 s37, s3, 0x320000
    buffer_load_dwordx4 v16, s[40:43], s37 offen lds
    s_add_u32 m0, s28, 90112
    s_add_u32 s37, s3, 0x340000
    buffer_load_dwordx4 v16, s[40:43], s37 offen lds
    s_add_u32 m0, s28, 94208
    s_add_u32 s37, s3, 0x360000
    buffer_load_dwordx4 v16, s[40:43], s37 offen lds
    s_add_u32 m0, s28, 122880
    s_add_u32 s37, s3, 0x380000
    buffer_load_dwordx4 v16, s[40:43], s37 offen lds
    s_add_u32 m0, s28, 126976
    s_add_u32 s37, s3, 0x3a0000
    buffer_load_dwordx4 v16, s[40:43], s37 offen lds
    s_add_u32 m0, s28, 155648
    s_add_u32 s37, s3, 0x3c0000
    buffer_load_dwordx4 v16, s[40:43], s37 offen lds
    s_add_u32 m0, s28, 159744
    s_add_u32 s37, s3, 0x3e0000
    buffer_load_dwordx4 v16, s[40:43], s37 offen lds
    s_waitcnt vmcnt(32)
    v_mov_b32 v88, 0
    v_mov_b32 v89, 0
    v_dot2_f32_bf16 v88, v96, s4, v88
    v_dot2_f32_bf16 v89, v96, v96, v89
    v_dot2_f32_bf16 v88, v97, s4, v88
    v_dot2_f32_bf16 v89, v97, v97, v89
    v_dot2_f32_bf16 v88, v98, s4, v88
    v_dot2_f32_bf16 v89, v98, v98, v89
    v_dot2_f32_bf16 v88, v99, s4, v88
    v_dot2_f32_bf16 v89, v99, v99, v89
    v_dot2_f32_bf16 v88, v100, s4, v88
    v_dot2_f32_bf16 v89, v100, v100, v89
    v_dot2_f32_bf16 v88, v101, s4, v88
    v_dot2_f32_bf16 v89, v101, v101, v89
    v_dot2_f32_bf16 v88, v102, s4, v88
    v_dot2_f32_bf16 v89, v102, v102, v89
    v_dot2_f32_bf16 v88, v103, s4, v88
    v_dot2_f32_bf16 v89, v103, v103, v89
    v_dot2_f32_bf16 v88, v104, s4, v88
    v_dot2_f32_bf16 v89, v104, v104, v89
    v_dot2_f32_bf16 v88, v105, s4, v88
    v_dot2_f32_bf16 v89, v105, v105, v89
    v_dot2_f32_bf16 v88, v106, s4, v88
    v_dot2_f32_bf16 v89, v106, v106, v89
    v_dot2_f32_bf16 v88, v107, s4, v88
    v_dot2_f32_bf16 v89, v107, v107, v89
    v_dot2_f32_bf16 v88, v108, s4, v88
    v_dot2_f32_bf16 v89, v108, v108, v89
    v_dot2_f32_bf16 v88, v109, s4, v88
    v_dot2_f32_bf16 v89, v109, v109, v89
    v_dot2_f32_bf16 v88, v110, s4, v88
    v_dot2_f32_bf16 v89, v110, v110, v89
    v_dot2_f32_bf16 v88, v111, s4, v88
    v_dot2_f32_bf16 v89, v111, v111, v89
    v_dot2_f32_bf16 v88, v112, s4, v88
    v_dot2_f32_bf16 v89, v112, v112, v89
    v_dot2_f32_bf16 v88, v113, s4, v88
    v_dot2_f32_bf16 v89, v113, v113, v89
    v_dot2_f32_bf16 v88, v114, s4, v88
    v_dot2_f32_bf16 v89, v114, v114, v89
    v_dot2_f32_bf16 v88, v115, s4, v88
    v_dot2_f32_bf16 v89, v115, v115, v89
    v_dot2_f32_bf16 v88, v116, s4, v88
    v_dot2_f32_bf16 v89, v116, v116, v89
    v_dot2_f32_bf16 v88, v117, s4, v88
    v_dot2_f32_bf16 v89, v117, v117, v89
    v_dot2_f32_bf16 v88, v118, s4, v88
    v_dot2_f32_bf16 v89, v118, v118, v89
    v_dot2_f32_bf16 v88, v119, s4, v88
    v_dot2_f32_bf16 v89, v119, v119, v89
    v_dot2_f32_bf16 v88, v120, s4, v88
    v_dot2_f32_bf16 v89, v120, v120, v89
    v_dot2_f32_bf16 v88, v121, s4, v88
    v_dot2_f32_bf16 v89, v121, v121, v89
    v_dot2_f32_bf16 v88, v122, s4, v88
    v_dot2_f32_bf16 v89, v122, v122, v89
    v_dot2_f32_bf16 v88, v123, s4, v88
    v_dot2_f32_bf16 v89, v123, v123, v89
    v_dot2_f32_bf16 v88, v124, s4, v88
    v_dot2_f32_bf16 v89, v124, v124, v89
    v_dot2_f32_bf16 v88, v125, s4, v88
    v_dot2_f32_bf16 v89, v125, v125, v89
    v_dot2_f32_bf16 v88, v126, s4, v88
    v_dot2_f32_bf16 v89, v126, v126, v89
    v_dot2_f32_bf16 v88, v127, s4, v88
    v_dot2_f32_bf16 v89, v127, v127, v89
    s_nop 3
    v_add_f32_dpp v88, v88, v88 quad_perm:[1,0,3,2] row_mask:0xf bank_mask:0xf
    v_add_f32_dpp v89, v89, v89 quad_perm:[1,0,3,2] row_mask:0xf bank_mask:0xf
    s_nop 0
    v_add_f32_dpp v88, v88, v88 quad_perm:[2,3,0,1] row_mask:0xf bank_mask:0xf
    v_add_f32_dpp v89, v89, v89 quad_perm:[2,3,0,1] row_mask:0xf bank_mask:0xf
    s_nop 0
    v_add_f32_dpp v88, v88, v88 row_half_mirror row_mask:0xf bank_mask:0xf
    v_add_f32_dpp v89, v89, v89 row_half_mirror row_mask:0xf bank_mask:0xf
    v_mul_f32 v88, 0x3b000000, v88
    v_mul_f32 v89, 0x3b000000, v89
    v_fma_f32 v89, -v88, v88, v89
    v_max_f32 v89, 0, v89
    v_cvt_pk_bf16_f32 v14, v88, v89
    v_lshlrev_b32 v88, 16, v14
    v_and_b32 v89, 0xffff0000, v14
    v_add_f32 v89, 0x3727c5ac, v89
    v_cvt_pk_bf16_f32 v14, v89, v89
    v_lshlrev_b32 v89, 16, v14
    v_sqrt_f32 v89, v89
    s_nop 0
    v_cvt_pk_bf16_f32 v14, v89, v89
    v_lshlrev_b32 v89, 16, v14
    v_rcp_f32 v89, v89
    v_lshlrev_b32 v90, 16, v96
    v_and_b32 v91, 0xffff0000, v96
    v_sub_f32 v90, v90, v88
    v_sub_f32 v91, v91, v88
    v_cvt_pk_bf16_f32 v96, v90, v91
    v_lshlrev_b32 v90, 16, v96
    v_and_b32 v91, 0xffff0000, v96
    v_mul_f32 v90, v90, v89
    v_mul_f32 v91, v91, v89
    v_cvt_pk_bf16_f32 v96, v90, v91
    v_lshlrev_b32 v90, 16, v97
    v_and_b32 v91, 0xffff0000, v97
    v_sub_f32 v90, v90, v88
    v_sub_f32 v91, v91, v88
    v_cvt_pk_bf16_f32 v97, v90, v91
    v_lshlrev_b32 v90, 16, v97
    v_and_b32 v91, 0xffff0000, v97
    v_mul_f32 v90, v90, v89
    v_mul_f32 v91, v91, v89
    v_cvt_pk_bf16_f32 v97, v90, v91
    v_lshlrev_b32 v90, 16, v98
    v_and_b32 v91, 0xffff0000, v98
    v_sub_f32 v90, v90, v88
    v_sub_f32 v91, v91, v88
    v_cvt_pk_bf16_f32 v98, v90, v91
    v_lshlrev_b32 v90, 16, v98
    v_and_b32 v91, 0xffff0000, v98
    v_mul_f32 v90, v90, v89
    v_mul_f32 v91, v91, v89
    v_cvt_pk_bf16_f32 v98, v90, v91
    v_lshlrev_b32 v90, 16, v99
    v_and_b32 v91, 0xffff0000, v99
    v_sub_f32 v90, v90, v88
    v_sub_f32 v91, v91, v88
    v_cvt_pk_bf16_f32 v99, v90, v91
    v_lshlrev_b32 v90, 16, v99
    v_and_b32 v91, 0xffff0000, v99
    v_mul_f32 v90, v90, v89
    v_mul_f32 v91, v91, v89
    v_cvt_pk_bf16_f32 v99, v90, v91
    ds_write_b128 v4, v[96:99] offset:0
    v_lshlrev_b32 v90, 16, v100
    v_and_b32 v91, 0xffff0000, v100
    v_sub_f32 v90, v90, v88
    v_sub_f32 v91, v91, v88
    v_cvt_pk_bf16_f32 v100, v90, v91
    v_lshlrev_b32 v90, 16, v100
    v_and_b32 v91, 0xffff0000, v100
    v_mul_f32 v90, v90, v89
    v_mul_f32 v91, v91, v89
    v_cvt_pk_bf16_f32 v100, v90, v91
    v_lshlrev_b32 v90, 16, v101
    v_and_b32 v91, 0xffff0000, v101
    v_sub_f32 v90, v90, v88
    v_sub_f32 v91, v91, v88
    v_cvt_pk_bf16_f32 v101, v90, v91
    v_lshlrev_b32 v90, 16, v101
    v_and_b32 v91, 0xffff0000, v101
    v_mul_f32 v90, v90, v89
    v_mul_f32 v91, v91, v89
    v_cvt_pk_bf16_f32 v101, v90, v91
    v_lshlrev_b32 v90, 16, v102
    v_and_b32 v91, 0xffff0000, v102
    v_sub_f32 v90, v90, v88
    v_sub_f32 v91, v91, v88
    v_cvt_pk_bf16_f32 v102, v90, v91
    v_lshlrev_b32 v90, 16, v102
    v_and_b32 v91, 0xffff0000, v102
    v_mul_f32 v90, v90, v89
    v_mul_f32 v91, v91, v89
    v_cvt_pk_bf16_f32 v102, v90, v91
    v_lshlrev_b32 v90, 16, v103
    v_and_b32 v91, 0xffff0000, v103
    v_sub_f32 v90, v90, v88
    v_sub_f32 v91, v91, v88
    v_cvt_pk_bf16_f32 v103, v90, v91
    v_lshlrev_b32 v90, 16, v103
    v_and_b32 v91, 0xffff0000, v103
    v_mul_f32 v90, v90, v89
    v_mul_f32 v91, v91, v89
    v_cvt_pk_bf16_f32 v103, v90, v91
    ds_write_b128 v4, v[100:103] offset:2048
    v_lshlrev_b32 v90, 16, v104
    v_and_b32 v91, 0xffff0000, v104
    v_sub_f32 v90, v90, v88
    v_sub_f32 v91, v91, v88
    v_cvt_pk_bf16_f32 v104, v90, v91
    v_lshlrev_b32 v90, 16, v104
    v_and_b32 v91, 0xffff0000, v104
    v_mul_f32 v90, v90, v89
    v_mul_f32 v91, v91, v89
    v_cvt_pk_bf16_f32 v104, v90, v91
    v_lshlrev_b32 v90, 16, v105
    v_and_b32 v91, 0xffff0000, v105
    v_sub_f32 v90, v90, v88
    v_sub_f32 v91, v91, v88
    v_cvt_pk_bf16_f32 v105, v90, v91
    v_lshlrev_b32 v90, 16, v105
    v_and_b32 v91, 0xffff0000, v105
    v_mul_f32 v90, v90, v89
    v_mul_f32 v91, v91, v89
    v_cvt_pk_bf16_f32 v105, v90, v91
    v_lshlrev_b32 v90, 16, v106
    v_and_b32 v91, 0xffff0000, v106
    v_sub_f32 v90, v90, v88
    v_sub_f32 v91, v91, v88
    v_cvt_pk_bf16_f32 v106, v90, v91
    v_lshlrev_b32 v90, 16, v106
    v_and_b32 v91, 0xffff0000, v106
    v_mul_f32 v90, v90, v89
    v_mul_f32 v91, v91, v89
    v_cvt_pk_bf16_f32 v106, v90, v91
    v_lshlrev_b32 v90, 16, v107
    v_and_b32 v91, 0xffff0000, v107
    v_sub_f32 v90, v90, v88
    v_sub_f32 v91, v91, v88
    v_cvt_pk_bf16_f32 v107, v90, v91
    v_lshlrev_b32 v90, 16, v107
    v_and_b32 v91, 0xffff0000, v107
    v_mul_f32 v90, v90, v89
    v_mul_f32 v91, v91, v89
    v_cvt_pk_bf16_f32 v107, v90, v91
    ds_write_b128 v4, v[104:107] offset:4096
    v_lshlrev_b32 v90, 16, v108
    v_and_b32 v91, 0xffff0000, v108
    v_sub_f32 v90, v90, v88
    v_sub_f32 v91, v91, v88
    v_cvt_pk_bf16_f32 v108, v90, v91
    v_lshlrev_b32 v90, 16, v108
    v_and_b32 v91, 0xffff0000, v108
    v_mul_f32 v90, v90, v89
    v_mul_f32 v91, v91, v89
    v_cvt_pk_bf16_f32 v108, v90, v91
    v_lshlrev_b32 v90, 16, v109
    v_and_b32 v91, 0xffff0000, v109
    v_sub_f32 v90, v90, v88
    v_sub_f32 v91, v91, v88
    v_cvt_pk_bf16_f32 v109, v90, v91
    v_lshlrev_b32 v90, 16, v109
    v_and_b32 v91, 0xffff0000, v109
    v_mul_f32 v90, v90, v89
    v_mul_f32 v91, v91, v89
    v_cvt_pk_bf16_f32 v109, v90, v91
    v_lshlrev_b32 v90, 16, v110
    v_and_b32 v91, 0xffff0000, v110
    v_sub_f32 v90, v90, v88
    v_sub_f32 v91, v91, v88
    v_cvt_pk_bf16_f32 v110, v90, v91
    v_lshlrev_b32 v90, 16, v110
    v_and_b32 v91, 0xffff0000, v110
    v_mul_f32 v90, v90, v89
    v_mul_f32 v91, v91, v89
    v_cvt_pk_bf16_f32 v110, v90, v91
    v_lshlrev_b32 v90, 16, v111
    v_and_b32 v91, 0xffff0000, v111
    v_sub_f32 v90, v90, v88
    v_sub_f32 v91, v91, v88
    v_cvt_pk_bf16_f32 v111, v90, v91
    v_lshlrev_b32 v90, 16, v111
    v_and_b32 v91, 0xffff0000, v111
    v_mul_f32 v90, v90, v89
    v_mul_f32 v91, v91, v89
    v_cvt_pk_bf16_f32 v111, v90, v91
    ds_write_b128 v4, v[108:111] offset:6144
    v_lshlrev_b32 v90, 16, v112
    v_and_b32 v91, 0xffff0000, v112
    v_sub_f32 v90, v90, v88
    v_sub_f32 v91, v91, v88
    v_cvt_pk_bf16_f32 v112, v90, v91
    v_lshlrev_b32 v90, 16, v112
    v_and_b32 v91, 0xffff0000, v112
    v_mul_f32 v90, v90, v89
    v_mul_f32 v91, v91, v89
    v_cvt_pk_bf16_f32 v112, v90, v91
    v_lshlrev_b32 v90, 16, v113
    v_and_b32 v91, 0xffff0000, v113
    v_sub_f32 v90, v90, v88
    v_sub_f32 v91, v91, v88
    v_cvt_pk_bf16_f32 v113, v90, v91
    v_lshlrev_b32 v90, 16, v113
    v_and_b32 v91, 0xffff0000, v113
    v_mul_f32 v90, v90, v89
    v_mul_f32 v91, v91, v89
    v_cvt_pk_bf16_f32 v113, v90, v91
    v_lshlrev_b32 v90, 16, v114
    v_and_b32 v91, 0xffff0000, v114
    v_sub_f32 v90, v90, v88
    v_sub_f32 v91, v91, v88
    v_cvt_pk_bf16_f32 v114, v90, v91
    v_lshlrev_b32 v90, 16, v114
    v_and_b32 v91, 0xffff0000, v114
    v_mul_f32 v90, v90, v89
    v_mul_f32 v91, v91, v89
    v_cvt_pk_bf16_f32 v114, v90, v91
    v_lshlrev_b32 v90, 16, v115
    v_and_b32 v91, 0xffff0000, v115
    v_sub_f32 v90, v90, v88
    v_sub_f32 v91, v91, v88
    v_cvt_pk_bf16_f32 v115, v90, v91
    v_lshlrev_b32 v90, 16, v115
    v_and_b32 v91, 0xffff0000, v115
    v_mul_f32 v90, v90, v89
    v_mul_f32 v91, v91, v89
    v_cvt_pk_bf16_f32 v115, v90, v91
    ds_write_b128 v4, v[112:115] offset:8192
    v_lshlrev_b32 v90, 16, v116
    v_and_b32 v91, 0xffff0000, v116
    v_sub_f32 v90, v90, v88
    v_sub_f32 v91, v91, v88
    v_cvt_pk_bf16_f32 v116, v90, v91
    v_lshlrev_b32 v90, 16, v116
    v_and_b32 v91, 0xffff0000, v116
    v_mul_f32 v90, v90, v89
    v_mul_f32 v91, v91, v89
    v_cvt_pk_bf16_f32 v116, v90, v91
    v_lshlrev_b32 v90, 16, v117
    v_and_b32 v91, 0xffff0000, v117
    v_sub_f32 v90, v90, v88
    v_sub_f32 v91, v91, v88
    v_cvt_pk_bf16_f32 v117, v90, v91
    v_lshlrev_b32 v90, 16, v117
    v_and_b32 v91, 0xffff0000, v117
    v_mul_f32 v90, v90, v89
    v_mul_f32 v91, v91, v89
    v_cvt_pk_bf16_f32 v117, v90, v91
    v_lshlrev_b32 v90, 16, v118
    v_and_b32 v91, 0xffff0000, v118
    v_sub_f32 v90, v90, v88
    v_sub_f32 v91, v91, v88
    v_cvt_pk_bf16_f32 v118, v90, v91
    v_lshlrev_b32 v90, 16, v118
    v_and_b32 v91, 0xffff0000, v118
    v_mul_f32 v90, v90, v89
    v_mul_f32 v91, v91, v89
    v_cvt_pk_bf16_f32 v118, v90, v91
    v_lshlrev_b32 v90, 16, v119
    v_and_b32 v91, 0xffff0000, v119
    v_sub_f32 v90, v90, v88
    v_sub_f32 v91, v91, v88
    v_cvt_pk_bf16_f32 v119, v90, v91
    v_lshlrev_b32 v90, 16, v119
    v_and_b32 v91, 0xffff0000, v119
    v_mul_f32 v90, v90, v89
    v_mul_f32 v91, v91, v89
    v_cvt_pk_bf16_f32 v119, v90, v91
    ds_write_b128 v4, v[116:119] offset:10240
    v_lshlrev_b32 v90, 16, v120
    v_and_b32 v91, 0xffff0000, v120
    v_sub_f32 v90, v90, v88
    v_sub_f32 v91, v91, v88
    v_cvt_pk_bf16_f32 v120, v90, v91
    v_lshlrev_b32 v90, 16, v120
    v_and_b32 v91, 0xffff0000, v120
    v_mul_f32 v90, v90, v89
    v_mul_f32 v91, v91, v89
    v_cvt_pk_bf16_f32 v120, v90, v91
    v_lshlrev_b32 v90, 16, v121
    v_and_b32 v91, 0xffff0000, v121
    v_sub_f32 v90, v90, v88
    v_sub_f32 v91, v91, v88
    v_cvt_pk_bf16_f32 v121, v90, v91
    v_lshlrev_b32 v90, 16, v121
    v_and_b32 v91, 0xffff0000, v121
    v_mul_f32 v90, v90, v89
    v_mul_f32 v91, v91, v89
    v_cvt_pk_bf16_f32 v121, v90, v91
    v_lshlrev_b32 v90, 16, v122
    v_and_b32 v91, 0xffff0000, v122
    v_sub_f32 v90, v90, v88
    v_sub_f32 v91, v91, v88
    v_cvt_pk_bf16_f32 v122, v90, v91
    v_lshlrev_b32 v90, 16, v122
    v_and_b32 v91, 0xffff0000, v122
    v_mul_f32 v90, v90, v89
    v_mul_f32 v91, v91, v89
    v_cvt_pk_bf16_f32 v122, v90, v91
    v_lshlrev_b32 v90, 16, v123
    v_and_b32 v91, 0xffff0000, v123
    v_sub_f32 v90, v90, v88
    v_sub_f32 v91, v91, v88
    v_cvt_pk_bf16_f32 v123, v90, v91
    v_lshlrev_b32 v90, 16, v123
    v_and_b32 v91, 0xffff0000, v123
    v_mul_f32 v90, v90, v89
    v_mul_f32 v91, v91, v89
    v_cvt_pk_bf16_f32 v123, v90, v91
    ds_write_b128 v4, v[120:123] offset:12288
    v_lshlrev_b32 v90, 16, v124
    v_and_b32 v91, 0xffff0000, v124
    v_sub_f32 v90, v90, v88
    v_sub_f32 v91, v91, v88
    v_cvt_pk_bf16_f32 v124, v90, v91
    v_lshlrev_b32 v90, 16, v124
    v_and_b32 v91, 0xffff0000, v124
    v_mul_f32 v90, v90, v89
    v_mul_f32 v91, v91, v89
    v_cvt_pk_bf16_f32 v124, v90, v91
    v_lshlrev_b32 v90, 16, v125
    v_and_b32 v91, 0xffff0000, v125
    v_sub_f32 v90, v90, v88
    v_sub_f32 v91, v91, v88
    v_cvt_pk_bf16_f32 v125, v90, v91
    v_lshlrev_b32 v90, 16, v125
    v_and_b32 v91, 0xffff0000, v125
    v_mul_f32 v90, v90, v89
    v_mul_f32 v91, v91, v89
    v_cvt_pk_bf16_f32 v125, v90, v91
    v_lshlrev_b32 v90, 16, v126
    v_and_b32 v91, 0xffff0000, v126
    v_sub_f32 v90, v90, v88
    v_sub_f32 v91, v91, v88
    v_cvt_pk_bf16_f32 v126, v90, v91
    v_lshlrev_b32 v90, 16, v126
    v_and_b32 v91, 0xffff0000, v126
    v_mul_f32 v90, v90, v89
    v_mul_f32 v91, v91, v89
    v_cvt_pk_bf16_f32 v126, v90, v91
    v_lshlrev_b32 v90, 16, v127
    v_and_b32 v91, 0xffff0000, v127
    v_sub_f32 v90, v90, v88
    v_sub_f32 v91, v91, v88
    v_cvt_pk_bf16_f32 v127, v90, v91
    v_lshlrev_b32 v90, 16, v127
    v_and_b32 v91, 0xffff0000, v127
    v_mul_f32 v90, v90, v89
    v_mul_f32 v91, v91, v89
    v_cvt_pk_bf16_f32 v127, v90, v91
    ds_write_b128 v4, v[124:127] offset:14336
    s_lshr_b32 s36, s21, 1
    s_lshl_b32 s36, s36, 14
    s_xor_b32 s37, s36, 16384
    v_add_u32 v80, s36, v5
    v_add_u32 v81, s37, v5
    v_add_u32 v82, s36, v6
    v_add_u32 v83, s37, v6
    s_mov_b32 s31, 0
    s_waitcnt vmcnt(24)
    s_barrier
    ds_read_b64_tr_b16 a[128:129], v20 offset:0
    ds_read_b64_tr_b16 a[130:131], v20 offset:1024
    ds_read_b64_tr_b16 a[132:133], v21 offset:0
    ds_read_b64_tr_b16 a[134:135], v21 offset:1024
    ds_read_b64_tr_b16 a[136:137], v22 offset:0
    ds_read_b64_tr_b16 a[138:139], v22 offset:1024
    ds_read_b64_tr_b16 a[140:141], v23 offset:0
    ds_read_b64_tr_b16 a[142:143], v23 offset:1024
    ds_read_b64_tr_b16 a[144:145], v24 offset:0
    ds_read_b64_tr_b16 a[146:147], v24 offset:1024
    ds_read_b64_tr_b16 a[148:149], v25 offset:0
    ds_read_b64_tr_b16 a[150:151], v25 offset:1024
    s_waitcnt lgkmcnt(4)
    ds_read_b64_tr_b16 a[152:153], v26 offset:0
    ds_read_b64_tr_b16 a[154:155], v26 offset:1024
    ds_read_b64_tr_b16 a[156:157], v27 offset:0
    ds_read_b64_tr_b16 a[158:159], v27 offset:1024
    s_waitcnt lgkmcnt(0)
    s_barrier
    s_mov_b32 s96, s48
    s_and_b32 s97, s49, 0xffff
    s_mov_b32 s98, 0x400000
    s_mov_b32 s99, 0x20000
    s_add_u32 m0, s28, 32768
    s_add_u32 s37, s3, 0x0
    buffer_load_dwordx4 v16, s[96:99], s37 offen lds
    s_add_u32 m0, s28, 36864
    s_add_u32 s37, s3, 0x20000
    buffer_load_dwordx4 v16, s[96:99], s37 offen lds
    s_add_u32 m0, s28, 65536
    s_add_u32 s37, s3, 0x40000
    buffer_load_dwordx4 v16, s[96:99], s37 offen lds
    s_add_u32 m0, s28, 69632
    s_add_u32 s37, s3, 0x60000
    buffer_load_dwordx4 v16, s[96:99], s37 offen lds
    s_add_u32 m0, s28, 98304
    s_add_u32 s37, s3, 0x80000
    buffer_load_dwordx4 v16, s[96:99], s37 offen lds
    s_add_u32 m0, s28, 102400
    s_add_u32 s37, s3, 0xa0000
    buffer_load_dwordx4 v16, s[96:99], s37 offen lds
    s_add_u32 m0, s28, 131072
    s_add_u32 s37, s3, 0xc0000
    buffer_load_dwordx4 v16, s[96:99], s37 offen lds
    s_add_u32 m0, s28, 135168
    s_add_u32 s37, s3, 0xe0000
    buffer_load_dwordx4 v16, s[96:99], s37 offen lds
    s_waitcnt vmcnt(24)
    s_barrier
    ds_read_b64_tr_b16 a[160:161], v20 offset:8192
    ds_read_b64_tr_b16 a[162:163], v20 offset:9216
    ds_read_b64_tr_b16 a[164:165], v21 offset:8192
    ds_read_b64_tr_b16 a[166:167], v21 offset:9216
    ds_read_b64_tr_b16 a[168:169], v22 offset:8192
    ds_read_b64_tr_b16 a[170:171], v22 offset:9216
    ds_read_b64_tr_b16 a[172:173], v23 offset:8192
    ds_read_b64_tr_b16 a[174:175], v23 offset:9216
    ds_read_b64_tr_b16 a[176:177], v24 offset:8192
    ds_read_b64_tr_b16 a[178:179], v24 offset:9216
    ds_read_b64_tr_b16 a[180:181], v25 offset:8192
    ds_read_b64_tr_b16 a[182:183], v25 offset:9216
    s_waitcnt lgkmcnt(4)
    ds_read_b64_tr_b16 a[184:185], v26 offset:8192
    ds_read_b64_tr_b16 a[186:187], v26 offset:9216
    ds_read_b64_tr_b16 a[188:189], v27 offset:8192
    ds_read_b64_tr_b16 a[190:191], v27 offset:9216
    s_waitcnt lgkmcnt(0)
    s_barrier
    s_add_u32 m0, s28, 40960
    s_add_u32 s37, s3, 0x100000
    buffer_load_dwordx4 v16, s[96:99], s37 offen lds
    s_add_u32 m0, s28, 45056
    s_add_u32 s37, s3, 0x120000
    buffer_load_dwordx4 v16, s[96:99], s37 offen lds
    s_add_u32 m0, s28, 73728
    s_add_u32 s37, s3, 0x140000
    buffer_load_dwordx4 v16, s[96:99], s37 offen lds
    s_add_u32 m0, s28, 77824
    s_add_u32 s37, s3, 0x160000
    buffer_load_dwordx4 v16, s[96:99], s37 offen lds
    s_add_u32 m0, s28, 106496
    s_add_u32 s37, s3, 0x180000
    buffer_load_dwordx4 v16, s[96:99], s37 offen lds
    s_add_u32 m0, s28, 110592
    s_add_u32 s37, s3, 0x1a0000
    buffer_load_dwordx4 v16, s[96:99], s37 offen lds
    s_add_u32 m0, s28, 139264
    s_add_u32 s37, s3, 0x1c0000
    buffer_load_dwordx4 v16, s[96:99], s37 offen lds
    s_add_u32 m0, s28, 143360
    s_add_u32 s37, s3, 0x1e0000
    buffer_load_dwordx4 v16, s[96:99], s37 offen lds
    s_waitcnt vmcnt(24)
    s_barrier
    ds_read_b64_tr_b16 a[192:193], v20 offset:16384
    ds_read_b64_tr_b16 a[194:195], v20 offset:17408
    ds_read_b64_tr_b16 a[196:197], v21 offset:16384
    ds_read_b64_tr_b16 a[198:199], v21 offset:17408
    ds_read_b64_tr_b16 a[200:201], v22 offset:16384
    ds_read_b64_tr_b16 a[202:203], v22 offset:17408
    ds_read_b64_tr_b16 a[204:205], v23 offset:16384
    ds_read_b64_tr_b16 a[206:207], v23 offset:17408
    ds_read_b64_tr_b16 a[208:209], v24 offset:16384
    ds_read_b64_tr_b16 a[210:211], v24 offset:17408
    ds_read_b64_tr_b16 a[212:213], v25 offset:16384
    ds_read_b64_tr_b16 a[214:215], v25 offset:17408
    s_waitcnt lgkmcnt(4)
    ds_read_b64_tr_b16 a[216:217], v26 offset:16384
    ds_read_b64_tr_b16 a[218:219], v26 offset:17408
    ds_read_b64_tr_b16 a[220:221], v27 offset:16384
    ds_read_b64_tr_b16 a[222:223], v27 offset:17408
    s_waitcnt lgkmcnt(0)
    s_barrier
    s_add_u32 m0, s28, 49152
    s_add_u32 s37, s3, 0x200000
    buffer_load_dwordx4 v16, s[96:99], s37 offen lds
    s_add_u32 m0, s28, 53248
    s_add_u32 s37, s3, 0x220000
    buffer_load_dwordx4 v16, s[96:99], s37 offen lds
    s_add_u32 m0, s28, 81920
    s_add_u32 s37, s3, 0x240000
    buffer_load_dwordx4 v16, s[96:99], s37 offen lds
    s_add_u32 m0, s28, 86016
    s_add_u32 s37, s3, 0x260000
    buffer_load_dwordx4 v16, s[96:99], s37 offen lds
    s_add_u32 m0, s28, 114688
    s_add_u32 s37, s3, 0x280000
    buffer_load_dwordx4 v16, s[96:99], s37 offen lds
    s_add_u32 m0, s28, 118784
    s_add_u32 s37, s3, 0x2a0000
    buffer_load_dwordx4 v16, s[96:99], s37 offen lds
    s_add_u32 m0, s28, 147456
    s_add_u32 s37, s3, 0x2c0000
    buffer_load_dwordx4 v16, s[96:99], s37 offen lds
    s_add_u32 m0, s28, 151552
    s_add_u32 s37, s3, 0x2e0000
    buffer_load_dwordx4 v16, s[96:99], s37 offen lds
    s_waitcnt vmcnt(24)
    s_barrier
    ds_read_b64_tr_b16 a[224:225], v20 offset:24576
    ds_read_b64_tr_b16 a[226:227], v20 offset:25600
    ds_read_b64_tr_b16 a[228:229], v21 offset:24576
    ds_read_b64_tr_b16 a[230:231], v21 offset:25600
    ds_read_b64_tr_b16 a[232:233], v22 offset:24576
    ds_read_b64_tr_b16 a[234:235], v22 offset:25600
    ds_read_b64_tr_b16 a[236:237], v23 offset:24576
    ds_read_b64_tr_b16 a[238:239], v23 offset:25600
    ds_read_b64_tr_b16 a[240:241], v24 offset:24576
    ds_read_b64_tr_b16 a[242:243], v24 offset:25600
    ds_read_b64_tr_b16 a[244:245], v25 offset:24576
    ds_read_b64_tr_b16 a[246:247], v25 offset:25600
    s_waitcnt lgkmcnt(4)
    ds_read_b64_tr_b16 a[248:249], v26 offset:24576
    ds_read_b64_tr_b16 a[250:251], v26 offset:25600
    ds_read_b64_tr_b16 a[252:253], v27 offset:24576
    ds_read_b64_tr_b16 a[254:255], v27 offset:25600
    s_waitcnt lgkmcnt(0)
    s_barrier
    s_add_u32 m0, s28, 57344
    s_add_u32 s37, s3, 0x300000
    buffer_load_dwordx4 v16, s[96:99], s37 offen lds
    s_add_u32 m0, s28, 61440
    s_add_u32 s37, s3, 0x320000
    buffer_load_dwordx4 v16, s[96:99], s37 offen lds
    s_add_u32 m0, s28, 90112
    s_add_u32 s37, s3, 0x340000
    buffer_load_dwordx4 v16, s[96:99], s37 offen lds
    s_add_u32 m0, s28, 94208
    s_add_u32 s37, s3, 0x360000
    buffer_load_dwordx4 v16, s[96:99], s37 offen lds
    s_add_u32 m0, s28, 122880
    s_add_u32 s37, s3, 0x380000
    buffer_load_dwordx4 v16, s[96:99], s37 offen lds
    s_add_u32 m0, s28, 126976
    s_add_u32 s37, s3, 0x3a0000
    buffer_load_dwordx4 v16, s[96:99], s37 offen lds
    s_add_u32 m0, s28, 155648
    s_add_u32 s37, s3, 0x3c0000
    buffer_load_dwordx4 v16, s[96:99], s37 offen lds
    s_add_u32 m0, s28, 159744
    s_add_u32 s37, s3, 0x3e0000
    buffer_load_dwordx4 v16, s[96:99], s37 offen lds
    ds_read_b128 v[64:67], v80 offset:0
    ds_read_b128 v[68:71], v81 offset:0
    ds_read_b128 v[72:75], v82 offset:1024
    ds_read_b128 v[76:79], v83 offset:1024
    s_waitcnt lgkmcnt(2)
    v_mfma_f32_16x16x32_bf16 v[32:35], a[128:131], v[64:67], 0
    v_mfma_f32_16x16x32_bf16 v[36:39], a[128:131], v[68:71], 0
    v_mfma_f32_16x16x32_bf16 v[40:43], a[132:135], v[64:67], 0
    v_mfma_f32_16x16x32_bf16 v[44:47], a[132:135], v[68:71], 0
    v_mfma_f32_16x16x32_bf16 v[48:51], v[64:67], v[128:131], 0
    v_mfma_f32_16x16x32_bf16 v[56:59], v[68:71], v[128:131], 0
    v_mfma_f32_16x16x32_bf16 v[52:55], v[64:67], v[132:135], 0
    v_mfma_f32_16x16x32_bf16 v[60:63], v[68:71], v[132:135], 0
    ds_read_b128 v[64:67], v80 offset:2048
    ds_read_b128 v[68:71], v81 offset:2048
    s_waitcnt lgkmcnt(2)
    v_mfma_f32_16x16x32_bf16 v[32:35], a[136:139], v[72:75], v[32:35]
    v_mfma_f32_16x16x32_bf16 v[36:39], a[136:139], v[76:79], v[36:39]
    v_mfma_f32_16x16x32_bf16 v[40:43], a[140:143], v[72:75], v[40:43]
    v_mfma_f32_16x16x32_bf16 v[44:47], a[140:143], v[76:79], v[44:47]
    v_mfma_f32_16x16x32_bf16 v[48:51], v[72:75], v[136:139], v[48:51]
    v_mfma_f32_16x16x32_bf16 v[56:59], v[76:79], v[136:139], v[56:59]
    v_mfma_f32_16x16x32_bf16 v[52:55], v[72:75], v[140:143], v[52:55]
    v_mfma_f32_16x16x32_bf16 v[60:63], v[76:79], v[140:143], v[60:63]
    ds_read_b128 v[72:75], v82 offset:3072
    ds_read_b128 v[76:79], v83 offset:3072
    s_waitcnt lgkmcnt(2)
    v_mfma_f32_16x16x32_bf16 v[32:35], a[144:147], v[64:67], v[32:35]
    v_mfma_f32_16x16x32_bf16 v[36:39], a[144:147], v[68:71], v[36:39]
    v_mfma_f32_16x16x32_bf16 v[40:43], a[148:151], v[64:67], v[40:43]
    v_mfma_f32_16x16x32_bf16 v[44:47], a[148:151], v[68:71], v[44:47]
    v_mfma_f32_16x16x32_bf16 v[48:51], v[64:67], v[144:147], v[48:51]
    v_mfma_f32_16x16x32_bf16 v[56:59], v[68:71], v[144:147], v[56:59]
    v_mfma_f32_16x16x32_bf16 v[52:55], v[64:67], v[148:151], v[52:55]
    v_mfma_f32_16x16x32_bf16 v[60:63], v[68:71], v[148:151], v[60:63]
    ds_read_b128 v[64:67], v80 offset:4096
    ds_read_b128 v[68:71], v81 offset:4096
    s_waitcnt lgkmcnt(2)
    v_mfma_f32_16x16x32_bf16 v[32:35], a[152:155], v[72:75], v[32:35]
    v_mfma_f32_16x16x32_bf16 v[36:39], a[152:155], v[76:79], v[36:39]
    v_mfma_f32_16x16x32_bf16 v[40:43], a[156:159], v[72:75], v[40:43]
    v_mfma_f32_16x16x32_bf16 v[44:47], a[156:159], v[76:79], v[44:47]
    v_mfma_f32_16x16x32_bf16 v[48:51], v[72:75], v[152:155], v[48:51]
    v_mfma_f32_16x16x32_bf16 v[56:59], v[76:79], v[152:155], v[56:59]
    v_mfma_f32_16x16x32_bf16 v[52:55], v[72:75], v[156:159], v[52:55]
    v_mfma_f32_16x16x32_bf16 v[60:63], v[76:79], v[156:159], v[60:63]
    ds_read_b128 v[72:75], v82 offset:5120
    ds_read_b128 v[76:79], v83 offset:5120
    s_waitcnt lgkmcnt(2)
    v_mfma_f32_16x16x32_bf16 v[32:35], a[160:163], v[64:67], v[32:35]
    v_mfma_f32_16x16x32_bf16 v[36:39], a[160:163], v[68:71], v[36:39]
    v_mfma_f32_16x16x32_bf16 v[40:43], a[164:167], v[64:67], v[40:43]
    v_mfma_f32_16x16x32_bf16 v[44:47], a[164:167], v[68:71], v[44:47]
    v_mfma_f32_16x16x32_bf16 v[48:51], v[64:67], v[160:163], v[48:51]
    v_mfma_f32_16x16x32_bf16 v[56:59], v[68:71], v[160:163], v[56:59]
    v_mfma_f32_16x16x32_bf16 v[52:55], v[64:67], v[164:167], v[52:55]
    v_mfma_f32_16x16x32_bf16 v[60:63], v[68:71], v[164:167], v[60:63]
    ds_read_b128 v[64:67], v80 offset:6144
    ds_read_b128 v[68:71], v81 offset:6144
    s_waitcnt lgkmcnt(2)
    v_mfma_f32_16x16x32_bf16 v[32:35], a[168:171], v[72:75], v[32:35]
    v_mfma_f32_16x16x32_bf16 v[36:39], a[168:171], v[76:79], v[36:39]
    v_mfma_f32_16x16x32_bf16 v[40:43], a[172:175], v[72:75], v[40:43]
    v_mfma_f32_16x16x32_bf16 v[44:47], a[172:175], v[76:79], v[44:47]
    v_mfma_f32_16x16x32_bf16 v[48:51], v[72:75], v[168:171], v[48:51]
    v_mfma_f32_16x16x32_bf16 v[56:59], v[76:79], v[168:171], v[56:59]
    v_mfma_f32_16x16x32_bf16 v[52:55], v[72:75], v[172:175], v[52:55]
    v_mfma_f32_16x16x32_bf16 v[60:63], v[76:79], v[172:175], v[60:63]
    ds_read_b128 v[72:75], v82 offset:7168
    ds_read_b128 v[76:79], v83 offset:7168
    s_waitcnt lgkmcnt(2)
    v_mfma_f32_16x16x32_bf16 v[32:35], a[176:179], v[64:67], v[32:35]
    v_mfma_f32_16x16x32_bf16 v[36:39], a[176:179], v[68:71], v[36:39]
    v_mfma_f32_16x16x32_bf16 v[40:43], a[180:183], v[64:67], v[40:43]
    v_mfma_f32_16x16x32_bf16 v[44:47], a[180:183], v[68:71], v[44:47]
    v_mfma_f32_16x16x32_bf16 v[48:51], v[64:67], v[176:179], v[48:51]
    v_mfma_f32_16x16x32_bf16 v[56:59], v[68:71], v[176:179], v[56:59]
    v_mfma_f32_16x16x32_bf16 v[52:55], v[64:67], v[180:183], v[52:55]
    v_mfma_f32_16x16x32_bf16 v[60:63], v[68:71], v[180:183], v[60:63]
    ds_read_b128 v[64:67], v80 offset:8192
    ds_read_b128 v[68:71], v81 offset:8192
    s_waitcnt lgkmcnt(2)
    v_mfma_f32_16x16x32_bf16 v[32:35], a[184:187], v[72:75], v[32:35]
    v_mfma_f32_16x16x32_bf16 v[36:39], a[184:187], v[76:79], v[36:39]
    v_mfma_f32_16x16x32_bf16 v[40:43], a[188:191], v[72:75], v[40:43]
    v_mfma_f32_16x16x32_bf16 v[44:47], a[188:191], v[76:79], v[44:47]
    v_mfma_f32_16x16x32_bf16 v[48:51], v[72:75], v[184:187], v[48:51]
    v_mfma_f32_16x16x32_bf16 v[56:59], v[76:79], v[184:187], v[56:59]
    v_mfma_f32_16x16x32_bf16 v[52:55], v[72:75], v[188:191], v[52:55]
    v_mfma_f32_16x16x32_bf16 v[60:63], v[76:79], v[188:191], v[60:63]
    ds_read_b128 v[72:75], v82 offset:9216
    ds_read_b128 v[76:79], v83 offset:9216
    s_waitcnt lgkmcnt(2)
    v_mfma_f32_16x16x32_bf16 v[32:35], a[192:195], v[64:67], v[32:35]
    v_mfma_f32_16x16x32_bf16 v[36:39], a[192:195], v[68:71], v[36:39]
    v_mfma_f32_16x16x32_bf16 v[40:43], a[196:199], v[64:67], v[40:43]
    v_mfma_f32_16x16x32_bf16 v[44:47], a[196:199], v[68:71], v[44:47]
    v_mfma_f32_16x16x32_bf16 v[48:51], v[64:67], v[192:195], v[48:51]
    v_mfma_f32_16x16x32_bf16 v[56:59], v[68:71], v[192:195], v[56:59]
    v_mfma_f32_16x16x32_bf16 v[52:55], v[64:67], v[196:199], v[52:55]
    v_mfma_f32_16x16x32_bf16 v[60:63], v[68:71], v[196:199], v[60:63]
    ds_read_b128 v[64:67], v80 offset:10240
    ds_read_b128 v[68:71], v81 offset:10240
    s_waitcnt lgkmcnt(2)
    v_mfma_f32_16x16x32_bf16 v[32:35], a[200:203], v[72:75], v[32:35]
    v_mfma_f32_16x16x32_bf16 v[36:39], a[200:203], v[76:79], v[36:39]
    v_mfma_f32_16x16x32_bf16 v[40:43], a[204:207], v[72:75], v[40:43]
    v_mfma_f32_16x16x32_bf16 v[44:47], a[204:207], v[76:79], v[44:47]
    v_mfma_f32_16x16x32_bf16 v[48:51], v[72:75], v[200:203], v[48:51]
    v_mfma_f32_16x16x32_bf16 v[56:59], v[76:79], v[200:203], v[56:59]
    v_mfma_f32_16x16x32_bf16 v[52:55], v[72:75], v[204:207], v[52:55]
    v_mfma_f32_16x16x32_bf16 v[60:63], v[76:79], v[204:207], v[60:63]
    ds_read_b128 v[72:75], v82 offset:11264
    ds_read_b128 v[76:79], v83 offset:11264
    s_waitcnt lgkmcnt(2)
    v_mfma_f32_16x16x32_bf16 v[32:35], a[208:211], v[64:67], v[32:35]
    v_mfma_f32_16x16x32_bf16 v[36:39], a[208:211], v[68:71], v[36:39]
    v_mfma_f32_16x16x32_bf16 v[40:43], a[212:215], v[64:67], v[40:43]
    v_mfma_f32_16x16x32_bf16 v[44:47], a[212:215], v[68:71], v[44:47]
    v_mfma_f32_16x16x32_bf16 v[48:51], v[64:67], v[208:211], v[48:51]
    v_mfma_f32_16x16x32_bf16 v[56:59], v[68:71], v[208:211], v[56:59]
    v_mfma_f32_16x16x32_bf16 v[52:55], v[64:67], v[212:215], v[52:55]
    v_mfma_f32_16x16x32_bf16 v[60:63], v[68:71], v[212:215], v[60:63]
    ds_read_b128 v[64:67], v80 offset:12288
    ds_read_b128 v[68:71], v81 offset:12288
    s_waitcnt lgkmcnt(2)
    v_mfma_f32_16x16x32_bf16 v[32:35], a[216:219], v[72:75], v[32:35]
    v_mfma_f32_16x16x32_bf16 v[36:39], a[216:219], v[76:79], v[36:39]
    v_mfma_f32_16x16x32_bf16 v[40:43], a[220:223], v[72:75], v[40:43]
    v_mfma_f32_16x16x32_bf16 v[44:47], a[220:223], v[76:79], v[44:47]
    v_mfma_f32_16x16x32_bf16 v[48:51], v[72:75], v[216:219], v[48:51]
    v_mfma_f32_16x16x32_bf16 v[56:59], v[76:79], v[216:219], v[56:59]
    v_mfma_f32_16x16x32_bf16 v[52:55], v[72:75], v[220:223], v[52:55]
    v_mfma_f32_16x16x32_bf16 v[60:63], v[76:79], v[220:223], v[60:63]
    ds_read_b128 v[72:75], v82 offset:13312
    ds_read_b128 v[76:79], v83 offset:13312
    s_waitcnt lgkmcnt(2)
    v_mfma_f32_16x16x32_bf16 v[32:35], a[224:227], v[64:67], v[32:35]
    v_mfma_f32_16x16x32_bf16 v[36:39], a[224:227], v[68:71], v[36:39]
    v_mfma_f32_16x16x32_bf16 v[40:43], a[228:231], v[64:67], v[40:43]
    v_mfma_f32_16x16x32_bf16 v[44:47], a[228:231], v[68:71], v[44:47]
    v_mfma_f32_16x16x32_bf16 v[48:51], v[64:67], v[224:227], v[48:51]
    v_mfma_f32_16x16x32_bf16 v[56:59], v[68:71], v[224:227], v[56:59]
    v_mfma_f32_16x16x32_bf16 v[52:55], v[64:67], v[228:231], v[52:55]
    v_mfma_f32_16x16x32_bf16 v[60:63], v[68:71], v[228:231], v[60:63]
    ds_read_b128 v[64:67], v80 offset:14336
    ds_read_b128 v[68:71], v81 offset:14336
    s_waitcnt lgkmcnt(2)
    v_mfma_f32_16x16x32_bf16 v[32:35], a[232:235], v[72:75], v[32:35]
    v_mfma_f32_16x16x32_bf16 v[36:39], a[232:235], v[76:79], v[36:39]
    v_mfma_f32_16x16x32_bf16 v[40:43], a[236:239], v[72:75], v[40:43]
    v_mfma_f32_16x16x32_bf16 v[44:47], a[236:239], v[76:79], v[44:47]
    v_mfma_f32_16x16x32_bf16 v[48:51], v[72:75], v[232:235], v[48:51]
    v_mfma_f32_16x16x32_bf16 v[56:59], v[76:79], v[232:235], v[56:59]
    v_mfma_f32_16x16x32_bf16 v[52:55], v[72:75], v[236:239], v[52:55]
    v_mfma_f32_16x16x32_bf16 v[60:63], v[76:79], v[236:239], v[60:63]
    ds_read_b128 v[72:75], v82 offset:15360
    ds_read_b128 v[76:79], v83 offset:15360
    s_waitcnt lgkmcnt(2)
    v_mfma_f32_16x16x32_bf16 v[32:35], a[240:243], v[64:67], v[32:35]
    v_mfma_f32_16x16x32_bf16 v[36:39], a[240:243], v[68:71], v[36:39]
    v_mfma_f32_16x16x32_bf16 v[40:43], a[244:247], v[64:67], v[40:43]
    v_mfma_f32_16x16x32_bf16 v[44:47], a[244:247], v[68:71], v[44:47]
    v_mfma_f32_16x16x32_bf16 v[48:51], v[64:67], v[240:243], v[48:51]
    v_mfma_f32_16x16x32_bf16 v[56:59], v[68:71], v[240:243], v[56:59]
    v_mfma_f32_16x16x32_bf16 v[52:55], v[64:67], v[244:247], v[52:55]
    v_mfma_f32_16x16x32_bf16 v[60:63], v[68:71], v[244:247], v[60:63]
    s_waitcnt lgkmcnt(0)
    v_mfma_f32_16x16x32_bf16 v[32:35], a[248:251], v[72:75], v[32:35]
    v_mfma_f32_16x16x32_bf16 v[36:39], a[248:251], v[76:79], v[36:39]
    v_mfma_f32_16x16x32_bf16 v[40:43], a[252:255], v[72:75], v[40:43]
    v_mfma_f32_16x16x32_bf16 v[44:47], a[252:255], v[76:79], v[44:47]
    v_mfma_f32_16x16x32_bf16 v[48:51], v[72:75], v[248:251], v[48:51]
    v_mfma_f32_16x16x32_bf16 v[56:59], v[76:79], v[248:251], v[56:59]
    v_mfma_f32_16x16x32_bf16 v[52:55], v[72:75], v[252:255], v[52:55]
    v_mfma_f32_16x16x32_bf16 v[60:63], v[76:79], v[252:255], v[60:63]
    s_nop 2
    v_cvt_pk_bf16_f32 v88, v32, v40
    v_cvt_pk_bf16_f32 v89, v33, v41
    v_cvt_pk_bf16_f32 v90, v34, v42
    v_cvt_pk_bf16_f32 v91, v35, v43
    v_cvt_pk_bf16_f32 v92, v36, v44
    v_cvt_pk_bf16_f32 v93, v37, v45
    v_cvt_pk_bf16_f32 v94, v38, v46
    v_cvt_pk_bf16_f32 v95, v39, v47
    v_cvt_pk_bf16_f32 v96, v48, v49
    v_cvt_pk_bf16_f32 v97, v50, v51
    v_cvt_pk_bf16_f32 v98, v56, v57
    v_cvt_pk_bf16_f32 v99, v58, v59
    v_cvt_pk_bf16_f32 v100, v52, v53
    v_cvt_pk_bf16_f32 v101, v54, v55
    v_cvt_pk_bf16_f32 v102, v60, v61
    v_cvt_pk_bf16_f32 v103, v62, v63
    s_mul_i32 s24, s23, 0x82100
    s_lshl_b32 s36, s20, 14
    s_add_u32 s24, s24, s36
    s_add_u32 s24, s24, 0x1000000
    s_mov_b32 s30, s24
    s_lshr_b32 s36, s21, 1
    s_lshl_b32 s36, s36, 12
    s_xor_b32 s37, s36, 4096
    s_add_u32 s36, s36, s24
    s_add_u32 s37, s37, s24
    buffer_store_dwordx4 v[88:91], v9, s[8:11], s36 offen sc1
    buffer_store_dwordx4 v[92:95], v9, s[8:11], s37 offen sc1
    s_add_u32 s24, s24, 8192
    buffer_store_dwordx4 v[96:99], v2, s[8:11], s24 offen sc1
    buffer_store_dwordx4 v[100:103], v2, s[8:11], s24 offen offset:1024 sc1
    s_mul_i32 s25, s23, 0x82100
    s_lshl_b32 s36, s20, 2
    s_add_u32 s25, s25, s36
    s_add_u32 s25, s25, 0x1082000
    v_lshrrev_b32 v15, 2, v1
    v_and_b32 v15, 127, v15
L_WHS:
    buffer_load_dword v14, v15, s[16:19], 0 offen sc1
    s_add_u32 s32, s32, 1
    s_cmp_gt_u32 s32, 200000
    s_cbranch_scc1 L_WHS_done
    s_waitcnt vmcnt(0)
    v_cmp_eq_u32 vcc, 0, v14
    s_cbranch_vccnz L_WHS
L_WHS_done:
    s_waitcnt vmcnt(0)
    s_barrier
    v_cmp_ne_u32 vcc, 0, v0
    v_mov_b32 v15, 0x40000000
    v_mov_b32 v14, 1
    v_cndmask_b32 v15, v0, v15, vcc
    buffer_store_dword v14, v15, s[8:11], s25 offen sc1
    s_barrier
    ds_read_b64_tr_b16 a[0:1], v20 offset:0
    ds_read_b64_tr_b16 a[2:3], v20 offset:1024
    ds_read_b64_tr_b16 a[4:5], v21 offset:0
    ds_read_b64_tr_b16 a[6:7], v21 offset:1024
    ds_read_b64_tr_b16 a[8:9], v22 offset:0
    ds_read_b64_tr_b16 a[10:11], v22 offset:1024
    ds_read_b64_tr_b16 a[12:13], v23 offset:0
    ds_read_b64_tr_b16 a[14:15], v23 offset:1024
    ds_read_b64_tr_b16 a[16:17], v24 offset:0
    ds_read_b64_tr_b16 a[18:19], v24 offset:1024
    ds_read_b64_tr_b16 a[20:21], v25 offset:0
    ds_read_b64_tr_b16 a[22:23], v25 offset:1024
    s_waitcnt lgkmcnt(4)
    ds_read_b64_tr_b16 a[24:25], v26 offset:0
    ds_read_b64_tr_b16 a[26:27], v26 offset:1024
    ds_read_b64_tr_b16 a[28:29], v27 offset:0
    ds_read_b64_tr_b16 a[30:31], v27 offset:1024
    s_waitcnt lgkmcnt(0)
    s_barrier
    s_barrier
    ds_read_b64_tr_b16 a[32:33], v20 offset:8192
    ds_read_b64_tr_b16 a[34:35], v20 offset:9216
    ds_read_b64_tr_b16 a[36:37], v21 offset:8192
    ds_read_b64_tr_b16 a[38:39], v21 offset:9216
    ds_read_b64_tr_b16 a[40:41], v22 offset:8192
    ds_read_b64_tr_b16 a[42:43], v22 offset:9216
    ds_read_b64_tr_b16 a[44:45], v23 offset:8192
    ds_read_b64_tr_b16 a[46:47], v23 offset:9216
    ds_read_b64_tr_b16 a[48:49], v24 offset:8192
    ds_read_b64_tr_b16 a[50:51], v24 offset:9216
    ds_read_b64_tr_b16 a[52:53], v25 offset:8192
    ds_read_b64_tr_b16 a[54:55], v25 offset:9216
    s_waitcnt lgkmcnt(4)
    ds_read_b64_tr_b16 a[56:57], v26 offset:8192
    ds_read_b64_tr_b16 a[58:59], v26 offset:9216
    ds_read_b64_tr_b16 a[60:61], v27 offset:8192
    ds_read_b64_tr_b16 a[62:63], v27 offset:9216
    s_waitcnt lgkmcnt(0)
    s_barrier
    s_barrier
    ds_read_b64_tr_b16 a[64:65], v20 offset:16384
    ds_read_b64_tr_b16 a[66:67], v20 offset:17408
    ds_read_b64_tr_b16 a[68:69], v21 offset:16384
    ds_read_b64_tr_b16 a[70:71], v21 offset:17408
    ds_read_b64_tr_b16 a[72:73], v22 offset:16384
    ds_read_b64_tr_b16 a[74:75], v22 offset:17408
    ds_read_b64_tr_b16 a[76:77], v23 offset:16384
    ds_read_b64_tr_b16 a[78:79], v23 offset:17408
    ds_read_b64_tr_b16 a[80:81], v24 offset:16384
    ds_read_b64_tr_b16 a[82:83], v24 offset:17408
    ds_read_b64_tr_b16 a[84:85], v25 offset:16384
    ds_read_b64_tr_b16 a[86:87], v25 offset:17408
    s_waitcnt lgkmcnt(4)
    ds_read_b64_tr_b16 a[88:89], v26 offset:16384
    ds_read_b64_tr_b16 a[90:91], v26 offset:17408
    ds_read_b64_tr_b16 a[92:93], v27 offset:16384
    ds_read_b64_tr_b16 a[94:95], v27 offset:17408
    s_waitcnt lgkmcnt(0)
    s_barrier
    s_barrier
    ds_read_b64_tr_b16 a[96:97], v20 offset:24576
    ds_read_b64_tr_b16 a[98:99], v20 offset:25600
    ds_read_b64_tr_b16 a[100:101], v21 offset:24576
    ds_read_b64_tr_b16 a[102:103], v21 offset:25600
    ds_read_b64_tr_b16 a[104:105], v22 offset:24576
    ds_read_b64_tr_b16 a[106:107], v22 offset:25600
    ds_read_b64_tr_b16 a[108:109], v23 offset:24576
    ds_read_b64_tr_b16 a[110:111], v23 offset:25600
    ds_read_b64_tr_b16 a[112:113], v24 offset:24576
    ds_read_b64_tr_b16 a[114:115], v24 offset:25600
    ds_read_b64_tr_b16 a[116:117], v25 offset:24576
    ds_read_b64_tr_b16 a[118:119], v25 offset:25600
    s_waitcnt lgkmcnt(4)
    ds_read_b64_tr_b16 a[120:121], v26 offset:24576
    ds_read_b64_tr_b16 a[122:123], v26 offset:25600
    ds_read_b64_tr_b16 a[124:125], v27 offset:24576
    ds_read_b64_tr_b16 a[126:127], v27 offset:25600
    s_waitcnt lgkmcnt(0)
    s_barrier
L_P1:
    s_waitcnt vmcnt(6)
    s_barrier
    s_xor_b32 s31, s31, 32768
    s_add_u32 s24, s23, 6
    s_min_u32 s24, s24, 63
    s_lshl_b32 s36, s24, 15
    s_add_u32 s36, s36, 0x800000
    s_lshl_b32 s37, s21, 10
    s_add_u32 s37, s37, s31
    s_add_u32 m0, s37, 0
    s_add_u32 s38, s36, 0
    buffer_load_dwordx4 v9, s[8:11], s38 offen sc1 lds
    s_add_u32 m0, s37, 4096
    s_add_u32 s38, s36, 4096
    buffer_load_dwordx4 v9, s[8:11], s38 offen sc1 lds
    s_add_u32 m0, s37, 8192
    s_add_u32 s38, s36, 8192
    buffer_load_dwordx4 v9, s[8:11], s38 offen sc1 lds
    s_add_u32 m0, s37, 12288
    s_add_u32 s38, s36, 12288
    buffer_load_dwordx4 v9, s[8:11], s38 offen sc1 lds
    s_add_u32 m0, s37, 16384
    s_add_u32 s38, s36, 16384
    buffer_load_dwordx4 v9, s[8:11], s38 offen sc1 lds
    s_add_u32 m0, s37, 20480
    s_add_u32 s38, s36, 20480
    buffer_load_dwordx4 v9, s[8:11], s38 offen sc1 lds
    s_add_u32 m0, s37, 24576
    s_add_u32 s38, s36, 24576
    buffer_load_dwordx4 v9, s[8:11], s38 offen sc1 lds
    s_add_u32 m0, s37, 28672
    s_add_u32 s38, s36, 28672
    buffer_load_dwordx4 v9, s[8:11], s38 offen sc1 lds
    ds_read_b128 v[64:67], v80 offset:0
    ds_read_b128 v[68:71], v81 offset:0
    ds_read_b128 v[72:75], v82 offset:1024
    ds_read_b128 v[76:79], v83 offset:1024
    s_waitcnt lgkmcnt(2)
    v_mfma_f32_16x16x32_bf16 v[32:35], a[128:131], v[64:67], 0
    v_mfma_f32_16x16x32_bf16 v[36:39], a[128:131], v[68:71], 0
    v_mfma_f32_16x16x32_bf16 v[40:43], a[132:135], v[64:67], 0
    v_mfma_f32_16x16x32_bf16 v[44:47], a[132:135], v[68:71], 0
    v_mfma_f32_16x16x32_bf16 v[48:51], v[64:67], v[128:131], 0
    v_mfma_f32_16x16x32_bf16 v[56:59], v[68:71], v[128:131], 0
    v_mfma_f32_16x16x32_bf16 v[52:55], v[64:67], v[132:135], 0
    v_mfma_f32_16x16x32_bf16 v[60:63], v[68:71], v[132:135], 0
    v_mfma_f32_16x16x32_bf16 v[16:19], a[0:3], v[64:67], 0
    v_mfma_f32_16x16x32_bf16 v[20:23], a[0:3], v[68:71], 0
    v_mfma_f32_16x16x32_bf16 v[24:27], a[4:7], v[64:67], 0
    v_mfma_f32_16x16x32_bf16 v[28:31], a[4:7], v[68:71], 0
    ds_read_b128 v[64:67], v80 offset:2048
    ds_read_b128 v[68:71], v81 offset:2048
    s_waitcnt lgkmcnt(2)
    v_mfma_f32_16x16x32_bf16 v[32:35], a[136:139], v[72:75], v[32:35]
    v_mfma_f32_16x16x32_bf16 v[36:39], a[136:139], v[76:79], v[36:39]
    v_mfma_f32_16x16x32_bf16 v[40:43], a[140:143], v[72:75], v[40:43]
    v_mfma_f32_16x16x32_bf16 v[44:47], a[140:143], v[76:79], v[44:47]
    v_mfma_f32_16x16x32_bf16 v[48:51], v[72:75], v[136:139], v[48:51]
    v_mfma_f32_16x16x32_bf16 v[56:59], v[76:79], v[136:139], v[56:59]
    v_mfma_f32_16x16x32_bf16 v[52:55], v[72:75], v[140:143], v[52:55]
    v_mfma_f32_16x16x32_bf16 v[60:63], v[76:79], v[140:143], v[60:63]
    v_mfma_f32_16x16x32_bf16 v[16:19], a[8:11], v[72:75], v[16:19]
    v_mfma_f32_16x16x32_bf16 v[20:23], a[8:11], v[76:79], v[20:23]
    v_mfma_f32_16x16x32_bf16 v[24:27], a[12:15], v[72:75], v[24:27]
    v_mfma_f32_16x16x32_bf16 v[28:31], a[12:15], v[76:79], v[28:31]
    ds_read_b128 v[72:75], v82 offset:3072
    ds_read_b128 v[76:79], v83 offset:3072
    s_waitcnt lgkmcnt(2)
    v_mfma_f32_16x16x32_bf16 v[32:35], a[144:147], v[64:67], v[32:35]
    v_mfma_f32_16x16x32_bf16 v[36:39], a[144:147], v[68:71], v[36:39]
    v_mfma_f32_16x16x32_bf16 v[40:43], a[148:151], v[64:67], v[40:43]
    v_mfma_f32_16x16x32_bf16 v[44:47], a[148:151], v[68:71], v[44:47]
    v_mfma_f32_16x16x32_bf16 v[48:51], v[64:67], v[144:147], v[48:51]
    v_mfma_f32_16x16x32_bf16 v[56:59], v[68:71], v[144:147], v[56:59]
    v_mfma_f32_16x16x32_bf16 v[52:55], v[64:67], v[148:151], v[52:55]
    v_mfma_f32_16x16x32_bf16 v[60:63], v[68:71], v[148:151], v[60:63]
    v_mfma_f32_16x16x32_bf16 v[16:19], a[16:19], v[64:67], v[16:19]
    v_mfma_f32_16x16x32_bf16 v[20:23], a[16:19], v[68:71], v[20:23]
    v_mfma_f32_16x16x32_bf16 v[24:27], a[20:23], v[64:67], v[24:27]
    v_mfma_f32_16x16x32_bf16 v[28:31], a[20:23], v[68:71], v[28:31]
    ds_read_b128 v[64:67], v80 offset:4096
    ds_read_b128 v[68:71], v81 offset:4096
    s_waitcnt lgkmcnt(2)
    v_mfma_f32_16x16x32_bf16 v[32:35], a[152:155], v[72:75], v[32:35]
    v_mfma_f32_16x16x32_bf16 v[36:39], a[152:155], v[76:79], v[36:39]
    v_mfma_f32_16x16x32_bf16 v[40:43], a[156:159], v[72:75], v[40:43]
    v_mfma_f32_16x16x32_bf16 v[44:47], a[156:159], v[76:79], v[44:47]
    v_mfma_f32_16x16x32_bf16 v[48:51], v[72:75], v[152:155], v[48:51]
    v_mfma_f32_16x16x32_bf16 v[56:59], v[76:79], v[152:155], v[56:59]
    v_mfma_f32_16x16x32_bf16 v[52:55], v[72:75], v[156:159], v[52:55]
    v_mfma_f32_16x16x32_bf16 v[60:63], v[76:79], v[156:159], v[60:63]
    v_mfma_f32_16x16x32_bf16 v[16:19], a[24:27], v[72:75], v[16:19]
    v_mfma_f32_16x16x32_bf16 v[20:23], a[24:27], v[76:79], v[20:23]
    v_mfma_f32_16x16x32_bf16 v[24:27], a[28:31], v[72:75], v[24:27]
    v_mfma_f32_16x16x32_bf16 v[28:31], a[28:31], v[76:79], v[28:31]
    ds_read_b128 v[72:75], v82 offset:5120
    ds_read_b128 v[76:79], v83 offset:5120
    s_waitcnt lgkmcnt(2)
    v_mfma_f32_16x16x32_bf16 v[32:35], a[160:163], v[64:67], v[32:35]
    v_mfma_f32_16x16x32_bf16 v[36:39], a[160:163], v[68:71], v[36:39]
    v_mfma_f32_16x16x32_bf16 v[40:43], a[164:167], v[64:67], v[40:43]
    v_mfma_f32_16x16x32_bf16 v[44:47], a[164:167], v[68:71], v[44:47]
    v_mfma_f32_16x16x32_bf16 v[48:51], v[64:67], v[160:163], v[48:51]
    v_mfma_f32_16x16x32_bf16 v[56:59], v[68:71], v[160:163], v[56:59]
    v_mfma_f32_16x16x32_bf16 v[52:55], v[64:67], v[164:167], v[52:55]
    v_mfma_f32_16x16x32_bf16 v[60:63], v[68:71], v[164:167], v[60:63]
    v_mfma_f32_16x16x32_bf16 v[16:19], a[32:35], v[64:67], v[16:19]
    v_mfma_f32_16x16x32_bf16 v[20:23], a[32:35], v[68:71], v[20:23]
    v_mfma_f32_16x16x32_bf16 v[24:27], a[36:39], v[64:67], v[24:27]
    v_mfma_f32_16x16x32_bf16 v[28:31], a[36:39], v[68:71], v[28:31]
    ds_read_b128 v[64:67], v80 offset:6144
    ds_read_b128 v[68:71], v81 offset:6144
    s_waitcnt lgkmcnt(2)
    v_mfma_f32_16x16x32_bf16 v[32:35], a[168:171], v[72:75], v[32:35]
    v_mfma_f32_16x16x32_bf16 v[36:39], a[168:171], v[76:79], v[36:39]
    v_mfma_f32_16x16x32_bf16 v[40:43], a[172:175], v[72:75], v[40:43]
    v_mfma_f32_16x16x32_bf16 v[44:47], a[172:175], v[76:79], v[44:47]
    v_mfma_f32_16x16x32_bf16 v[48:51], v[72:75], v[168:171], v[48:51]
    v_mfma_f32_16x16x32_bf16 v[56:59], v[76:79], v[168:171], v[56:59]
    v_mfma_f32_16x16x32_bf16 v[52:55], v[72:75], v[172:175], v[52:55]
    v_mfma_f32_16x16x32_bf16 v[60:63], v[76:79], v[172:175], v[60:63]
    v_mfma_f32_16x16x32_bf16 v[16:19], a[40:43], v[72:75], v[16:19]
    v_mfma_f32_16x16x32_bf16 v[20:23], a[40:43], v[76:79], v[20:23]
    v_mfma_f32_16x16x32_bf16 v[24:27], a[44:47], v[72:75], v[24:27]
    v_mfma_f32_16x16x32_bf16 v[28:31], a[44:47], v[76:79], v[28:31]
    ds_read_b128 v[72:75], v82 offset:7168
    ds_read_b128 v[76:79], v83 offset:7168
    s_waitcnt lgkmcnt(2)
    s_waitcnt vmcnt(8)
    s_barrier
    v_cmp_ne_u32 vcc, 0, v0
    v_mov_b32 v15, 0x40000000
    v_mov_b32 v14, 1
    v_cndmask_b32 v15, v0, v15, vcc
    buffer_store_dword v14, v15, s[8:11], s25 offen sc1
    v_mfma_f32_16x16x32_bf16 v[32:35], a[176:179], v[64:67], v[32:35]
    v_mfma_f32_16x16x32_bf16 v[36:39], a[176:179], v[68:71], v[36:39]
    v_mfma_f32_16x16x32_bf16 v[40:43], a[180:183], v[64:67], v[40:43]
    v_mfma_f32_16x16x32_bf16 v[44:47], a[180:183], v[68:71], v[44:47]
    v_mfma_f32_16x16x32_bf16 v[48:51], v[64:67], v[176:179], v[48:51]
    v_mfma_f32_16x16x32_bf16 v[56:59], v[68:71], v[176:179], v[56:59]
    v_mfma_f32_16x16x32_bf16 v[52:55], v[64:67], v[180:183], v[52:55]
    v_mfma_f32_16x16x32_bf16 v[60:63], v[68:71], v[180:183], v[60:63]
    v_mfma_f32_16x16x32_bf16 v[16:19], a[48:51], v[64:67], v[16:19]
    v_mfma_f32_16x16x32_bf16 v[20:23], a[48:51], v[68:71], v[20:23]
    v_mfma_f32_16x16x32_bf16 v[24:27], a[52:55], v[64:67], v[24:27]
    v_mfma_f32_16x16x32_bf16 v[28:31], a[52:55], v[68:71], v[28:31]
    ds_read_b128 v[64:67], v80 offset:8192
    ds_read_b128 v[68:71], v81 offset:8192
    s_waitcnt lgkmcnt(2)
    v_mfma_f32_16x16x32_bf16 v[32:35], a[184:187], v[72:75], v[32:35]
    v_mfma_f32_16x16x32_bf16 v[36:39], a[184:187], v[76:79], v[36:39]
    v_mfma_f32_16x16x32_bf16 v[40:43], a[188:191], v[72:75], v[40:43]
    v_mfma_f32_16x16x32_bf16 v[44:47], a[188:191], v[76:79], v[44:47]
    v_mfma_f32_16x16x32_bf16 v[48:51], v[72:75], v[184:187], v[48:51]
    v_mfma_f32_16x16x32_bf16 v[56:59], v[76:79], v[184:187], v[56:59]
    v_mfma_f32_16x16x32_bf16 v[52:55], v[72:75], v[188:191], v[52:55]
    v_mfma_f32_16x16x32_bf16 v[60:63], v[76:79], v[188:191], v[60:63]
    v_mfma_f32_16x16x32_bf16 v[16:19], a[56:59], v[72:75], v[16:19]
    v_mfma_f32_16x16x32_bf16 v[20:23], a[56:59], v[76:79], v[20:23]
    v_mfma_f32_16x16x32_bf16 v[24:27], a[60:63], v[72:75], v[24:27]
    v_mfma_f32_16x16x32_bf16 v[28:31], a[60:63], v[76:79], v[28:31]
    ds_read_b128 v[72:75], v82 offset:9216
    ds_read_b128 v[76:79], v83 offset:9216
    s_waitcnt lgkmcnt(2)
    v_mfma_f32_16x16x32_bf16 v[32:35], a[192:195], v[64:67], v[32:35]
    v_mfma_f32_16x16x32_bf16 v[36:39], a[192:195], v[68:71], v[36:39]
    v_mfma_f32_16x16x32_bf16 v[40:43], a[196:199], v[64:67], v[40:43]
    v_mfma_f32_16x16x32_bf16 v[44:47], a[196:199], v[68:71], v[44:47]
    v_mfma_f32_16x16x32_bf16 v[48:51], v[64:67], v[192:195], v[48:51]
    v_mfma_f32_16x16x32_bf16 v[56:59], v[68:71], v[192:195], v[56:59]
    v_mfma_f32_16x16x32_bf16 v[52:55], v[64:67], v[196:199], v[52:55]
    v_mfma_f32_16x16x32_bf16 v[60:63], v[68:71], v[196:199], v[60:63]
    v_mfma_f32_16x16x32_bf16 v[16:19], a[64:67], v[64:67], v[16:19]
    v_mfma_f32_16x16x32_bf16 v[20:23], a[64:67], v[68:71], v[20:23]
    v_mfma_f32_16x16x32_bf16 v[24:27], a[68:71], v[64:67], v[24:27]
    v_mfma_f32_16x16x32_bf16 v[28:31], a[68:71], v[68:71], v[28:31]
    ds_read_b128 v[64:67], v80 offset:10240
    ds_read_b128 v[68:71], v81 offset:10240
    s_waitcnt lgkmcnt(2)
    v_mfma_f32_16x16x32_bf16 v[32:35], a[200:203], v[72:75], v[32:35]
    v_mfma_f32_16x16x32_bf16 v[36:39], a[200:203], v[76:79], v[36:39]
    v_mfma_f32_16x16x32_bf16 v[40:43], a[204:207], v[72:75], v[40:43]
    v_mfma_f32_16x16x32_bf16 v[44:47], a[204:207], v[76:79], v[44:47]
    v_mfma_f32_16x16x32_bf16 v[48:51], v[72:75], v[200:203], v[48:51]
    v_mfma_f32_16x16x32_bf16 v[56:59], v[76:79], v[200:203], v[56:59]
    v_mfma_f32_16x16x32_bf16 v[52:55], v[72:75], v[204:207], v[52:55]
    v_mfma_f32_16x16x32_bf16 v[60:63], v[76:79], v[204:207], v[60:63]
    v_mfma_f32_16x16x32_bf16 v[16:19], a[72:75], v[72:75], v[16:19]
    v_mfma_f32_16x16x32_bf16 v[20:23], a[72:75], v[76:79], v[20:23]
    v_mfma_f32_16x16x32_bf16 v[24:27], a[76:79], v[72:75], v[24:27]
    v_mfma_f32_16x16x32_bf16 v[28:31], a[76:79], v[76:79], v[28:31]
    ds_read_b128 v[72:75], v82 offset:11264
    ds_read_b128 v[76:79], v83 offset:11264
    s_waitcnt lgkmcnt(2)
    v_mfma_f32_16x16x32_bf16 v[32:35], a[208:211], v[64:67], v[32:35]
    v_mfma_f32_16x16x32_bf16 v[36:39], a[208:211], v[68:71], v[36:39]
    v_mfma_f32_16x16x32_bf16 v[40:43], a[212:215], v[64:67], v[40:43]
    v_mfma_f32_16x16x32_bf16 v[44:47], a[212:215], v[68:71], v[44:47]
    v_mfma_f32_16x16x32_bf16 v[48:51], v[64:67], v[208:211], v[48:51]
    v_mfma_f32_16x16x32_bf16 v[56:59], v[68:71], v[208:211], v[56:59]
    v_mfma_f32_16x16x32_bf16 v[52:55], v[64:67], v[212:215], v[52:55]
    v_mfma_f32_16x16x32_bf16 v[60:63], v[68:71], v[212:215], v[60:63]
    v_mfma_f32_16x16x32_bf16 v[16:19], a[80:83], v[64:67], v[16:19]
    v_mfma_f32_16x16x32_bf16 v[20:23], a[80:83], v[68:71], v[20:23]
    v_mfma_f32_16x16x32_bf16 v[24:27], a[84:87], v[64:67], v[24:27]
    v_mfma_f32_16x16x32_bf16 v[28:31], a[84:87], v[68:71], v[28:31]
    ds_read_b128 v[64:67], v80 offset:12288
    ds_read_b128 v[68:71], v81 offset:12288
    s_waitcnt lgkmcnt(2)
    v_mfma_f32_16x16x32_bf16 v[32:35], a[216:219], v[72:75], v[32:35]
    v_mfma_f32_16x16x32_bf16 v[36:39], a[216:219], v[76:79], v[36:39]
    v_mfma_f32_16x16x32_bf16 v[40:43], a[220:223], v[72:75], v[40:43]
    v_mfma_f32_16x16x32_bf16 v[44:47], a[220:223], v[76:79], v[44:47]
    v_mfma_f32_16x16x32_bf16 v[48:51], v[72:75], v[216:219], v[48:51]
    v_mfma_f32_16x16x32_bf16 v[56:59], v[76:79], v[216:219], v[56:59]
    v_mfma_f32_16x16x32_bf16 v[52:55], v[72:75], v[220:223], v[52:55]
    v_mfma_f32_16x16x32_bf16 v[60:63], v[76:79], v[220:223], v[60:63]
    v_mfma_f32_16x16x32_bf16 v[16:19], a[88:91], v[72:75], v[16:19]
    v_mfma_f32_16x16x32_bf16 v[20:23], a[88:91], v[76:79], v[20:23]
    v_mfma_f32_16x16x32_bf16 v[24:27], a[92:95], v[72:75], v[24:27]
    v_mfma_f32_16x16x32_bf16 v[28:31], a[92:95], v[76:79], v[28:31]
    ds_read_b128 v[72:75], v82 offset:13312
    ds_read_b128 v[76:79], v83 offset:13312
    s_waitcnt lgkmcnt(2)
    v_mfma_f32_16x16x32_bf16 v[32:35], a[224:227], v[64:67], v[32:35]
    v_mfma_f32_16x16x32_bf16 v[36:39], a[224:227], v[68:71], v[36:39]
    v_mfma_f32_16x16x32_bf16 v[40:43], a[228:231], v[64:67], v[40:43]
    v_mfma_f32_16x16x32_bf16 v[44:47], a[228:231], v[68:71], v[44:47]
    v_mfma_f32_16x16x32_bf16 v[48:51], v[64:67], v[224:227], v[48:51]
    v_mfma_f32_16x16x32_bf16 v[56:59], v[68:71], v[224:227], v[56:59]
    v_mfma_f32_16x16x32_bf16 v[52:55], v[64:67], v[228:231], v[52:55]
    v_mfma_f32_16x16x32_bf16 v[60:63], v[68:71], v[228:231], v[60:63]
    v_mfma_f32_16x16x32_bf16 v[16:19], a[96:99], v[64:67], v[16:19]
    v_mfma_f32_16x16x32_bf16 v[20:23], a[96:99], v[68:71], v[20:23]
    v_mfma_f32_16x16x32_bf16 v[24:27], a[100:103], v[64:67], v[24:27]
    v_mfma_f32_16x16x32_bf16 v[28:31], a[100:103], v[68:71], v[28:31]
    ds_read_b128 v[64:67], v80 offset:14336
    ds_read_b128 v[68:71], v81 offset:14336
    s_waitcnt lgkmcnt(2)
    v_mfma_f32_16x16x32_bf16 v[32:35], a[232:235], v[72:75], v[32:35]
    v_mfma_f32_16x16x32_bf16 v[36:39], a[232:235], v[76:79], v[36:39]
    v_mfma_f32_16x16x32_bf16 v[40:43], a[236:239], v[72:75], v[40:43]
    v_mfma_f32_16x16x32_bf16 v[44:47], a[236:239], v[76:79], v[44:47]
    v_mfma_f32_16x16x32_bf16 v[48:51], v[72:75], v[232:235], v[48:51]
    v_mfma_f32_16x16x32_bf16 v[56:59], v[76:79], v[232:235], v[56:59]
    v_mfma_f32_16x16x32_bf16 v[52:55], v[72:75], v[236:239], v[52:55]
    v_mfma_f32_16x16x32_bf16 v[60:63], v[76:79], v[236:239], v[60:63]
    v_mfma_f32_16x16x32_bf16 v[16:19], a[104:107], v[72:75], v[16:19]
    v_mfma_f32_16x16x32_bf16 v[20:23], a[104:107], v[76:79], v[20:23]
    v_mfma_f32_16x16x32_bf16 v[24:27], a[108:111], v[72:75], v[24:27]
    v_mfma_f32_16x16x32_bf16 v[28:31], a[108:111], v[76:79], v[28:31]
    ds_read_b128 v[72:75], v82 offset:15360
    ds_read_b128 v[76:79], v83 offset:15360
    s_waitcnt lgkmcnt(2)
    v_mfma_f32_16x16x32_bf16 v[32:35], a[240:243], v[64:67], v[32:35]
    v_mfma_f32_16x16x32_bf16 v[36:39], a[240:243], v[68:71], v[36:39]
    v_mfma_f32_16x16x32_bf16 v[40:43], a[244:247], v[64:67], v[40:43]
    v_mfma_f32_16x16x32_bf16 v[44:47], a[244:247], v[68:71], v[44:47]
    v_mfma_f32_16x16x32_bf16 v[48:51], v[64:67], v[240:243], v[48:51]
    v_mfma_f32_16x16x32_bf16 v[56:59], v[68:71], v[240:243], v[56:59]
    v_mfma_f32_16x16x32_bf16 v[52:55], v[64:67], v[244:247], v[52:55]
    v_mfma_f32_16x16x32_bf16 v[60:63], v[68:71], v[244:247], v[60:63]
    v_mfma_f32_16x16x32_bf16 v[16:19], a[112:115], v[64:67], v[16:19]
    v_mfma_f32_16x16x32_bf16 v[20:23], a[112:115], v[68:71], v[20:23]
    v_mfma_f32_16x16x32_bf16 v[24:27], a[116:119], v[64:67], v[24:27]
    v_mfma_f32_16x16x32_bf16 v[28:31], a[116:119], v[68:71], v[28:31]
    s_waitcnt lgkmcnt(0)
    v_mfma_f32_16x16x32_bf16 v[32:35], a[248:251], v[72:75], v[32:35]
    v_mfma_f32_16x16x32_bf16 v[36:39], a[248:251], v[76:79], v[36:39]
    v_mfma_f32_16x16x32_bf16 v[40:43], a[252:255], v[72:75], v[40:43]
    v_mfma_f32_16x16x32_bf16 v[44:47], a[252:255], v[76:79], v[44:47]
    v_mfma_f32_16x16x32_bf16 v[48:51], v[72:75], v[248:251], v[48:51]
    v_mfma_f32_16x16x32_bf16 v[56:59], v[76:79], v[248:251], v[56:59]
    v_mfma_f32_16x16x32_bf16 v[52:55], v[72:75], v[252:255], v[52:55]
    v_mfma_f32_16x16x32_bf16 v[60:63], v[76:79], v[252:255], v[60:63]
    v_mfma_f32_16x16x32_bf16 v[16:19], a[120:123], v[72:75], v[16:19]
    v_mfma_f32_16x16x32_bf16 v[20:23], a[120:123], v[76:79], v[20:23]
    v_mfma_f32_16x16x32_bf16 v[24:27], a[124:127], v[72:75], v[24:27]
    v_mfma_f32_16x16x32_bf16 v[28:31], a[124:127], v[76:79], v[28:31]
    v_xor_b32 v80, 0x8000, v80
    v_xor_b32 v81, 0x8000, v81
    v_xor_b32 v82, 0x8000, v82
    v_xor_b32 v83, 0x8000, v83
    v_cvt_pk_bf16_f32 v88, v32, v40
    v_cvt_pk_bf16_f32 v89, v33, v41
    v_cvt_pk_bf16_f32 v90, v34, v42
    v_cvt_pk_bf16_f32 v91, v35, v43
    v_cvt_pk_bf16_f32 v92, v36, v44
    v_cvt_pk_bf16_f32 v93, v37, v45
    v_cvt_pk_bf16_f32 v94, v38, v46
    v_cvt_pk_bf16_f32 v95, v39, v47
    v_cvt_pk_bf16_f32 v96, v48, v49
    v_cvt_pk_bf16_f32 v97, v50, v51
    v_cvt_pk_bf16_f32 v98, v56, v57
    v_cvt_pk_bf16_f32 v99, v58, v59
    v_cvt_pk_bf16_f32 v100, v52, v53
    v_cvt_pk_bf16_f32 v101, v54, v55
    v_cvt_pk_bf16_f32 v102, v60, v61
    v_cvt_pk_bf16_f32 v103, v62, v63
    v_cvt_pk_bf16_f32 v104, v16, v24
    v_cvt_pk_bf16_f32 v105, v17, v25
    v_cvt_pk_bf16_f32 v106, v18, v26
    v_cvt_pk_bf16_f32 v107, v19, v27
    v_cvt_pk_bf16_f32 v108, v20, v28
    v_cvt_pk_bf16_f32 v109, v21, v29
    v_cvt_pk_bf16_f32 v110, v22, v30
    v_cvt_pk_bf16_f32 v111, v23, v31
    s_mul_i32 s24, s23, 0x82100
    s_lshl_b32 s36, s20, 14
    s_add_u32 s24, s24, s36
    s_add_u32 s24, s24, 0x1000000
    s_mov_b32 s30, s24
    s_lshr_b32 s36, s21, 1
    s_lshl_b32 s36, s36, 12
    s_xor_b32 s37, s36, 4096
    s_add_u32 s36, s36, s24
    s_add_u32 s37, s37, s24
    buffer_store_dwordx4 v[88:91], v9, s[8:11], s36 offen sc1
    buffer_store_dwordx4 v[92:95], v9, s[8:11], s37 offen sc1
    s_add_u32 s24, s24, 8192
    buffer_store_dwordx4 v[96:99], v2, s[8:11], s24 offen sc1
    buffer_store_dwordx4 v[100:103], v2, s[8:11], s24 offen offset:1024 sc1
    s_add_u32 s36, s36, 0x7000000
    s_add_u32 s37, s37, 0x7000000
    buffer_store_dwordx4 v[104:107], v9, s[8:11], s36 offen sc1
    buffer_store_dwordx4 v[108:111], v9, s[8:11], s37 offen sc1
    s_mul_i32 s25, s23, 0x82100
    s_lshl_b32 s36, s20, 2
    s_add_u32 s25, s25, s36
    s_add_u32 s25, s25, 0x1082000
    s_add_u32 s23, s23, 6
    s_cmp_lt_u32 s23, 64
    s_cbranch_scc1 L_P1
    v_mov_b32 v20, -1
    v_mov_b32 v21, -1
    v_mov_b32 v22, -1
    v_mov_b32 v23, -1
    s_lshl_b32 s24, s22, 21
    s_lshl_b32 s36, s20, 15
    s_add_u32 s24, s24, s36
    s_add_u32 s36, s24, 0x4000000
    buffer_store_dwordx4 v[20:23], v11, s[8:11], s36 offen sc1
    s_add_u32 s36, s24, 0x4001000
    buffer_store_dwordx4 v[20:23], v11, s[8:11], s36 offen sc1
    s_add_u32 s36, s24, 0x4002000
    buffer_store_dwordx4 v[20:23], v11, s[8:11], s36 offen sc1
    s_add_u32 s36, s24, 0x4003000
    buffer_store_dwordx4 v[20:23], v11, s[8:11], s36 offen sc1
    s_add_u32 s36, s24, 0x4004000
    buffer_store_dwordx4 v[20:23], v11, s[8:11], s36 offen sc1
    s_add_u32 s36, s24, 0x4005000
    buffer_store_dwordx4 v[20:23], v11, s[8:11], s36 offen sc1
    s_add_u32 s36, s24, 0x4006000
    buffer_store_dwordx4 v[20:23], v11, s[8:11], s36 offen sc1
    s_add_u32 s36, s24, 0x4007000
    buffer_store_dwordx4 v[20:23], v11, s[8:11], s36 offen sc1
    s_add_u32 s36, s24, 0x4100000
    buffer_store_dwordx4 v[20:23], v11, s[8:11], s36 offen sc1
    s_add_u32 s36, s24, 0x4101000
    buffer_store_dwordx4 v[20:23], v11, s[8:11], s36 offen sc1
    s_add_u32 s36, s24, 0x4102000
    buffer_store_dwordx4 v[20:23], v11, s[8:11], s36 offen sc1
    s_add_u32 s36, s24, 0x4103000
    buffer_store_dwordx4 v[20:23], v11, s[8:11], s36 offen sc1
    s_add_u32 s36, s24, 0x4104000
    buffer_store_dwordx4 v[20:23], v11, s[8:11], s36 offen sc1
    s_add_u32 s36, s24, 0x4105000
    buffer_store_dwordx4 v[20:23], v11, s[8:11], s36 offen sc1
    s_add_u32 s36, s24, 0x4106000
    buffer_store_dwordx4 v[20:23], v11, s[8:11], s36 offen sc1
    s_add_u32 s36, s24, 0x4107000
    buffer_store_dwordx4 v[20:23], v11, s[8:11], s36 offen sc1
    s_waitcnt vmcnt(0)
    s_barrier
    v_cmp_ne_u32 vcc, 0, v0
    v_mov_b32 v15, 0x40000000
    v_mov_b32 v14, 1
    v_cndmask_b32 v15, v0, v15, vcc
    buffer_store_dword v14, v15, s[8:11], s25 offen sc1
    s_lshl_b32 s25, s22, 7
    s_lshl_b32 s36, s20, 2
    s_add_u32 s36, s36, s25
    s_add_u32 s36, s36, 0x192000
    v_cmp_ne_u32 vcc, 0, v0
    v_mov_b32 v15, 0x40000000
    v_mov_b32 v14, 1
    v_cndmask_b32 v15, v0, v15, vcc
    buffer_store_dword v14, v15, s[8:11], s36 offen sc1
    s_mov_b32 s96, s54
    s_and_b32 s97, s55, 0xffff
    s_mov_b32 s98, 0x400000
    s_mov_b32 s99, 0x20000
    v_mov_b32 v15, 0x0
    v_bfe_u32 v14, v0, 0, 1
    s_mov_b32 s38, 0x10
    v_mad_u32_u24 v15, v14, s38, v15
    v_bfe_u32 v14, v0, 1, 1
    s_mov_b32 s38, 0x20
    v_mad_u32_u24 v15, v14, s38, v15
    v_bfe_u32 v14, v0, 2, 1
    s_mov_b32 s38, 0x40
    v_mad_u32_u24 v15, v14, s38, v15
    v_bfe_u32 v14, v0, 3, 1
    s_mov_b32 s38, 0x80
    v_mad_u32_u24 v15, v14, s38, v15
    v_bfe_u32 v14, v0, 4, 1
    s_mov_b32 s38, 0x1000
    v_mad_u32_u24 v15, v14, s38, v15
    v_bfe_u32 v14, v0, 5, 1
    s_mov_b32 s38, 0x2000
    v_mad_u32_u24 v15, v14, s38, v15
    v_bfe_u32 v14, v0, 6, 1
    s_mov_b32 s38, 0x100
    v_mad_u32_u24 v15, v14, s38, v15
    v_bfe_u32 v14, v0, 7, 1
    s_mov_b32 s38, 0x200
    v_mad_u32_u24 v15, v14, s38, v15
    s_lshl_b32 s36, s20, 17
    s_add_u32 s37, s36, 0x0
    buffer_load_dwordx4 v[16:19], v15, s[96:99], s37 offen
    s_add_u32 s37, s36, 0x4000
    buffer_load_dwordx4 v[20:23], v15, s[96:99], s37 offen
    s_add_u32 s37, s36, 0x400
    buffer_load_dwordx4 v[24:27], v15, s[96:99], s37 offen
    s_add_u32 s37, s36, 0x4400
    buffer_load_dwordx4 v[28:31], v15, s[96:99], s37 offen
    s_add_u32 s37, s36, 0x800
    buffer_load_dwordx4 v[32:35], v15, s[96:99], s37 offen
    s_add_u32 s37, s36, 0x4800
    buffer_load_dwordx4 v[36:39], v15, s[96:99], s37 offen
    s_add_u32 s37, s36, 0xc00
    buffer_load_dwordx4 v[40:43], v15, s[96:99], s37 offen
    s_add_u32 s37, s36, 0x4c00
    buffer_load_dwordx4 v[44:47], v15, s[96:99], s37 offen
    s_add_u32 s37, s36, 0x8000
    buffer_load_dwordx4 v[48:51], v15, s[96:99], s37 offen
    s_add_u32 s37, s36, 0xc000
    buffer_load_dwordx4 v[52:55], v15, s[96:99], s37 offen
    s_add_u32 s37, s36, 0x8400
    buffer_load_dwordx4 v[56:59], v15, s[96:99], s37 offen
    s_add_u32 s37, s36, 0xc400
    buffer_load_dwordx4 v[60:63], v15, s[96:99], s37 offen
    s_add_u32 s37, s36, 0x8800
    buffer_load_dwordx4 v[64:67], v15, s[96:99], s37 offen
    s_add_u32 s37, s36, 0xc800
    buffer_load_dwordx4 v[68:71], v15, s[96:99], s37 offen
    s_add_u32 s37, s36, 0x8c00
    buffer_load_dwordx4 v[72:75], v15, s[96:99], s37 offen
    s_add_u32 s37, s36, 0xcc00
    buffer_load_dwordx4 v[76:79], v15, s[96:99], s37 offen
    s_add_u32 s37, s36, 0x10000
    buffer_load_dwordx4 v[80:83], v15, s[96:99], s37 offen
    s_add_u32 s37, s36, 0x14000
    buffer_load_dwordx4 v[84:87], v15, s[96:99], s37 offen
    s_add_u32 s37, s36, 0x10400
    buffer_load_dwordx4 v[88:91], v15, s[96:99], s37 offen
    s_add_u32 s37, s36, 0x14400
    buffer_load_dwordx4 v[92:95], v15, s[96:99], s37 offen
    s_add_u32 s37, s36, 0x10800
    buffer_load_dwordx4 v[96:99], v15, s[96:99], s37 offen
    s_add_u32 s37, s36, 0x14800
    buffer_load_dwordx4 v[100:103], v15, s[96:99], s37 offen
    s_add_u32 s37, s36, 0x10c00
    buffer_load_dwordx4 v[104:107], v15, s[96:99], s37 offen
    s_add_u32 s37, s36, 0x14c00
    buffer_load_dwordx4 v[108:111], v15, s[96:99], s37 offen
    s_waitcnt vmcnt(16)
    v_perm_b32 v112, v20, v16, s34
    v_perm_b32 v113, v28, v24, s34
    v_perm_b32 v114, v36, v32, s34
    v_perm_b32 v115, v44, v40, s34
    ds_write_b128 v7, v[112:115] offset:0
    v_perm_b32 v116, v20, v16, s35
    v_perm_b32 v117, v28, v24, s35
    v_perm_b32 v118, v36, v32, s35
    v_perm_b32 v119, v44, v40, s35
    ds_write_b128 v7, v[116:119] offset:1024
    v_perm_b32 v120, v21, v17, s34
    v_perm_b32 v121, v29, v25, s34
    v_perm_b32 v122, v37, v33, s34
    v_perm_b32 v123, v45, v41, s34
    ds_write_b128 v7, v[120:123] offset:2048
    v_perm_b32 v124, v21, v17, s35
    v_perm_b32 v125, v29, v25, s35
    v_perm_b32 v126, v37, v33, s35
    v_perm_b32 v127, v45, v41, s35
    ds_write_b128 v7, v[124:127] offset:3072
    s_waitcnt lgkmcnt(0)
    v_perm_b32 v112, v22, v18, s34
    v_perm_b32 v113, v30, v26, s34
    v_perm_b32 v114, v38, v34, s34
    v_perm_b32 v115, v46, v42, s34
    ds_write_b128 v7, v[112:115] offset:4096
    v_perm_b32 v116, v22, v18, s35
    v_perm_b32 v117, v30, v26, s35
    v_perm_b32 v118, v38, v34, s35
    v_perm_b32 v119, v46, v42, s35
    ds_write_b128 v7, v[116:119] offset:5120
    v_perm_b32 v120, v23, v19, s34
    v_perm_b32 v121, v31, v27, s34
    v_perm_b32 v122, v39, v35, s34
    v_perm_b32 v123, v47, v43, s34
    ds_write_b128 v7, v[120:123] offset:6144
    v_perm_b32 v124, v23, v19, s35
    v_perm_b32 v125, v31, v27, s35
    v_perm_b32 v126, v39, v35, s35
    v_perm_b32 v127, v47, v43, s35
    ds_write_b128 v7, v[124:127] offset:7168
    s_waitcnt lgkmcnt(0)
    s_add_u32 s37, s36, 0x18000
    buffer_load_dwordx4 v[16:19], v15, s[96:99], s37 offen
    s_add_u32 s37, s36, 0x1c000
    buffer_load_dwordx4 v[20:23], v15, s[96:99], s37 offen
    s_add_u32 s37, s36, 0x18400
    buffer_load_dwordx4 v[24:27], v15, s[96:99], s37 offen
    s_add_u32 s37, s36, 0x1c400
    buffer_load_dwordx4 v[28:31], v15, s[96:99], s37 offen
    s_add_u32 s37, s36, 0x18800
    buffer_load_dwordx4 v[32:35], v15, s[96:99], s37 offen
    s_add_u32 s37, s36, 0x1c800
    buffer_load_dwordx4 v[36:39], v15, s[96:99], s37 offen
    s_add_u32 s37, s36, 0x18c00
    buffer_load_dwordx4 v[40:43], v15, s[96:99], s37 offen
    s_add_u32 s37, s36, 0x1cc00
    buffer_load_dwordx4 v[44:47], v15, s[96:99], s37 offen
    s_waitcnt vmcnt(16)
    v_perm_b32 v112, v52, v48, s34
    v_perm_b32 v113, v60, v56, s34
    v_perm_b32 v114, v68, v64, s34
    v_perm_b32 v115, v76, v72, s34
    ds_write_b128 v7, v[112:115] offset:8192
    v_perm_b32 v116, v52, v48, s35
    v_perm_b32 v117, v60, v56, s35
    v_perm_b32 v118, v68, v64, s35
    v_perm_b32 v119, v76, v72, s35
    ds_write_b128 v7, v[116:119] offset:9216
    v_perm_b32 v120, v53, v49, s34
    v_perm_b32 v121, v61, v57, s34
    v_perm_b32 v122, v69, v65, s34
    v_perm_b32 v123, v77, v73, s34
    ds_write_b128 v7, v[120:123] offset:10240
    v_perm_b32 v124, v53, v49, s35
    v_perm_b32 v125, v61, v57, s35
    v_perm_b32 v126, v69, v65, s35
    v_perm_b32 v127, v77, v73, s35
    ds_write_b128 v7, v[124:127] offset:11264
    s_waitcnt lgkmcnt(0)
    v_perm_b32 v112, v54, v50, s34
    v_perm_b32 v113, v62, v58, s34
    v_perm_b32 v114, v70, v66, s34
    v_perm_b32 v115, v78, v74, s34
    ds_write_b128 v7, v[112:115] offset:12288
    v_perm_b32 v116, v54, v50, s35
    v_perm_b32 v117, v62, v58, s35
    v_perm_b32 v118, v70, v66, s35
    v_perm_b32 v119, v78, v74, s35
    ds_write_b128 v7, v[116:119] offset:13312
    v_perm_b32 v120, v55, v51, s34
    v_perm_b32 v121, v63, v59, s34
    v_perm_b32 v122, v71, v67, s34
    v_perm_b32 v123, v79, v75, s34
    ds_write_b128 v7, v[120:123] offset:14336
    v_perm_b32 v124, v55, v51, s35
    v_perm_b32 v125, v63, v59, s35
    v_perm_b32 v126, v71, v67, s35
    v_perm_b32 v127, v79, v75, s35
    ds_write_b128 v7, v[124:127] offset:15360
    s_waitcnt lgkmcnt(0)
    s_waitcnt vmcnt(8)
    v_perm_b32 v112, v84, v80, s34
    v_perm_b32 v113, v92, v88, s34
    v_perm_b32 v114, v100, v96, s34
    v_perm_b32 v115, v108, v104, s34
    ds_write_b128 v7, v[112:115] offset:16384
    v_perm_b32 v116, v84, v80, s35
    v_perm_b32 v117, v92, v88, s35
    v_perm_b32 v118, v100, v96, s35
    v_perm_b32 v119, v108, v104, s35
    ds_write_b128 v7, v[116:119] offset:17408
    v_perm_b32 v120, v85, v81, s34
    v_perm_b32 v121, v93, v89, s34
    v_perm_b32 v122, v101, v97, s34
    v_perm_b32 v123, v109, v105, s34
    ds_write_b128 v7, v[120:123] offset:18432
    v_perm_b32 v124, v85, v81, s35
    v_perm_b32 v125, v93, v89, s35
    v_perm_b32 v126, v101, v97, s35
    v_perm_b32 v127, v109, v105, s35
    ds_write_b128 v7, v[124:127] offset:19456
    s_waitcnt lgkmcnt(0)
    v_perm_b32 v112, v86, v82, s34
    v_perm_b32 v113, v94, v90, s34
    v_perm_b32 v114, v102, v98, s34
    v_perm_b32 v115, v110, v106, s34
    ds_write_b128 v7, v[112:115] offset:20480
    v_perm_b32 v116, v86, v82, s35
    v_perm_b32 v117, v94, v90, s35
    v_perm_b32 v118, v102, v98, s35
    v_perm_b32 v119, v110, v106, s35
    ds_write_b128 v7, v[116:119] offset:21504
    v_perm_b32 v120, v87, v83, s34
    v_perm_b32 v121, v95, v91, s34
    v_perm_b32 v122, v103, v99, s34
    v_perm_b32 v123, v111, v107, s34
    ds_write_b128 v7, v[120:123] offset:22528
    v_perm_b32 v124, v87, v83, s35
    v_perm_b32 v125, v95, v91, s35
    v_perm_b32 v126, v103, v99, s35
    v_perm_b32 v127, v111, v107, s35
    ds_write_b128 v7, v[124:127] offset:23552
    s_waitcnt lgkmcnt(0)
    s_waitcnt vmcnt(0)
    v_perm_b32 v112, v20, v16, s34
    v_perm_b32 v113, v28, v24, s34
    v_perm_b32 v114, v36, v32, s34
    v_perm_b32 v115, v44, v40, s34
    ds_write_b128 v7, v[112:115] offset:24576
    v_perm_b32 v116, v20, v16, s35
    v_perm_b32 v117, v28, v24, s35
    v_perm_b32 v118, v36, v32, s35
    v_perm_b32 v119, v44, v40, s35
    ds_write_b128 v7, v[116:119] offset:25600
    v_perm_b32 v120, v21, v17, s34
    v_perm_b32 v121, v29, v25, s34
    v_perm_b32 v122, v37, v33, s34
    v_perm_b32 v123, v45, v41, s34
    ds_write_b128 v7, v[120:123] offset:26624
    v_perm_b32 v124, v21, v17, s35
    v_perm_b32 v125, v29, v25, s35
    v_perm_b32 v126, v37, v33, s35
    v_perm_b32 v127, v45, v41, s35
    ds_write_b128 v7, v[124:127] offset:27648
    s_waitcnt lgkmcnt(0)
    v_perm_b32 v112, v22, v18, s34
    v_perm_b32 v113, v30, v26, s34
    v_perm_b32 v114, v38, v34, s34
    v_perm_b32 v115, v46, v42, s34
    ds_write_b128 v7, v[112:115] offset:28672
    v_perm_b32 v116, v22, v18, s35
    v_perm_b32 v117, v30, v26, s35
    v_perm_b32 v118, v38, v34, s35
    v_perm_b32 v119, v46, v42, s35
    ds_write_b128 v7, v[116:119] offset:29696
    v_perm_b32 v120, v23, v19, s34
    v_perm_b32 v121, v31, v27, s34
    v_perm_b32 v122, v39, v35, s34
    v_perm_b32 v123, v47, v43, s34
    ds_write_b128 v7, v[120:123] offset:30720
    v_perm_b32 v124, v23, v19, s35
    v_perm_b32 v125, v31, v27, s35
    v_perm_b32 v126, v39, v35, s35
    v_perm_b32 v127, v47, v43, s35
    ds_write_b128 v7, v[124:127] offset:31744
    s_waitcnt lgkmcnt(0)
    s_lshl_b32 s25, s22, 7
    s_add_u32 s25, s25, 0x192000
    v_lshrrev_b32 v15, 2, v1
    v_and_b32 v15, 127, v15
L_TPI:
    buffer_load_dword v14, v15, s[8:11], s25 offen sc1
    s_add_u32 s32, s32, 1
    s_cmp_gt_u32 s32, 200000
    s_waitcnt vmcnt(0)
    s_cbranch_scc1 L_TPI_ok
    v_cmp_eq_u32 vcc, 0, v14
    s_cbranch_vccz L_TPI_ok
    s_sleep 8
    s_branch L_TPI
L_TPI_ok:
    s_mov_b32 s23, s22
    s_mov_b32 s29, 0
    s_mov_b32 s30, 0x40000000
    s_mov_b32 s42, 0x3db504f3
    s_mov_b32 s43, 0x3fb8aa3b
    s_mul_i32 s24, s23, 0x82100
    s_lshl_b32 s36, s20, 14
    s_add_u32 s24, s24, s36
    s_add_u32 s24, s24, 0x1000000
    s_add_u32 s36, s24, 0
    s_add_u32 s37, s36, 0x7000000
    buffer_load_dwordx4 a[32:35], v1, s[8:11], s36 offen offset:0 sc1
    buffer_load_dwordx4 a[0:3], v1, s[8:11], s37 offen offset:0 sc1
    buffer_load_dwordx4 a[36:39], v1, s[8:11], s36 offen offset:1024 sc1
    buffer_load_dwordx4 a[4:7], v1, s[8:11], s37 offen offset:1024 sc1
    buffer_load_dwordx4 a[40:43], v1, s[8:11], s36 offen offset:2048 sc1
    buffer_load_dwordx4 a[8:11], v1, s[8:11], s37 offen offset:2048 sc1
    buffer_load_dwordx4 a[44:47], v1, s[8:11], s36 offen offset:3072 sc1
    buffer_load_dwordx4 a[12:15], v1, s[8:11], s37 offen offset:3072 sc1
    s_add_u32 s36, s24, 4096
    s_add_u32 s37, s36, 0x7000000
    buffer_load_dwordx4 a[48:51], v1, s[8:11], s36 offen offset:0 sc1
    buffer_load_dwordx4 a[16:19], v1, s[8:11], s37 offen offset:0 sc1
    buffer_load_dwordx4 a[52:55], v1, s[8:11], s36 offen offset:1024 sc1
    buffer_load_dwordx4 a[20:23], v1, s[8:11], s37 offen offset:1024 sc1
    buffer_load_dwordx4 a[56:59], v1, s[8:11], s36 offen offset:2048 sc1
    buffer_load_dwordx4 a[24:27], v1, s[8:11], s37 offen offset:2048 sc1
    buffer_load_dwordx4 a[60:63], v1, s[8:11], s36 offen offset:3072 sc1
    buffer_load_dwordx4 a[28:31], v1, s[8:11], s37 offen offset:3072 sc1
    s_lshr_b32 s36, s21, 1
    s_lshl_b32 s36, s36, 3
    s_xor_b32 s37, s36, 8
    s_add_u32 s24, s24, 8192
    s_add_u32 s36, s36, s24
    s_add_u32 s37, s37, s24
    buffer_load_dwordx2 a[64:65], v2, s[8:11], s36 offen offset:0 sc1
    buffer_load_dwordx2 a[66:67], v2, s[8:11], s37 offen offset:0 sc1
    buffer_load_dwordx2 a[68:69], v2, s[8:11], s36 offen offset:1024 sc1
    buffer_load_dwordx2 a[70:71], v2, s[8:11], s37 offen offset:1024 sc1
L_P2:
    s_and_b32 s36, s29, 1
    s_lshl_b32 s36, s36, 20
    s_lshl_b32 s26, s22, 21
    s_add_u32 s26, s26, s36
    s_add_u32 s26, s26, 0x4000000
    s_bfe_u32 s27, s29, 0x10001
    s_lshl_b32 s24, s23, 13
    s_add_u32 s24, s24, 0x100000
    s_max_u32 s25, s23, 1
    s_lshl_b32 s25, s25, 13
    s_add_u32 s25, s25, 0xfe000
    buffer_load_dwordx4 v[48:51], v2, s[8:11], s24 offen sc1
    buffer_load_dwordx4 v[52:55], v2, s[8:11], s24 offen offset:1024 sc1
    s_lshl_b32 s36, s23, 5
    s_add_u32 s36, s36, s20
    s_lshl_b32 s36, s36, 10
    buffer_load_dword a72, v12, s[12:15], s36 offen
    buffer_load_dword a73, v12, s[92:95], 0 offen
    s_waitcnt vmcnt(4)
    v_cmp_ne_u32 vcc, 0, v1
    v_mov_b32 v15, 0x40000000
    v_mov_b32 v14, 0
    v_cndmask_b32 v15, v1, v15, vcc
    buffer_store_dword v14, v15, s[8:11], s30 offen sc1
    v_mfma_f32_16x16x32_bf16 v[80:83], a[32:35], a[0:3], 0
    v_mfma_f32_16x16x32_bf16 v[80:83], a[36:39], a[4:7], v[80:83]
    v_mfma_f32_16x16x32_bf16 v[80:83], a[40:43], a[8:11], v[80:83]
    v_mfma_f32_16x16x32_bf16 v[80:83], a[44:47], a[12:15], v[80:83]
    v_mfma_f32_16x16x32_bf16 v[88:91], a[48:51], a[16:19], 0
    v_mfma_f32_16x16x32_bf16 v[88:91], a[52:55], a[20:23], v[88:91]
    v_mfma_f32_16x16x32_bf16 v[88:91], a[56:59], a[24:27], v[88:91]
    v_mfma_f32_16x16x32_bf16 v[88:91], a[60:63], a[28:31], v[88:91]
    v_mfma_f32_16x16x32_bf16 v[84:87], a[32:35], a[16:19], 0
    v_mfma_f32_16x16x32_bf16 v[84:87], a[36:39], a[20:23], v[84:87]
    v_mfma_f32_16x16x32_bf16 v[84:87], a[40:43], a[24:27], v[84:87]
    v_mfma_f32_16x16x32_bf16 v[84:87], a[44:47], a[28:31], v[84:87]
    v_cvt_pk_bf16_f32 v81, v80, v81
    v_lshlrev_b32 v80, 16, v81
    v_and_b32 v81, 0xffff0000, v81
    v_mul_f32 v80, s42, v80
    v_mul_f32 v81, s42, v81
    v_cvt_pk_bf16_f32 v81, v80, v81
    v_lshlrev_b32 v80, 16, v81
    v_and_b32 v81, 0xffff0000, v81
    v_cvt_pk_bf16_f32 v83, v82, v83
    v_lshlrev_b32 v82, 16, v83
    v_and_b32 v83, 0xffff0000, v83
    v_mul_f32 v82, s42, v82
    v_mul_f32 v83, s42, v83
    v_cvt_pk_bf16_f32 v83, v82, v83
    v_lshlrev_b32 v82, 16, v83
    v_and_b32 v83, 0xffff0000, v83
    v_cvt_pk_bf16_f32 v89, v88, v89
    v_lshlrev_b32 v88, 16, v89
    v_and_b32 v89, 0xffff0000, v89
    v_mul_f32 v88, s42, v88
    v_mul_f32 v89, s42, v89
    v_cvt_pk_bf16_f32 v89, v88, v89
    v_lshlrev_b32 v88, 16, v89
    v_and_b32 v89, 0xffff0000, v89
    v_cvt_pk_bf16_f32 v91, v90, v91
    v_lshlrev_b32 v90, 16, v91
    v_and_b32 v91, 0xffff0000, v91
    v_mul_f32 v90, s42, v90
    v_mul_f32 v91, s42, v91
    v_cvt_pk_bf16_f32 v91, v90, v91
    v_lshlrev_b32 v90, 16, v91
    v_and_b32 v91, 0xffff0000, v91
    v_cvt_pk_bf16_f32 v85, v84, v85
    v_lshlrev_b32 v84, 16, v85
    v_and_b32 v85, 0xffff0000, v85
    v_mul_f32 v84, s42, v84
    v_mul_f32 v85, s42, v85
    v_cvt_pk_bf16_f32 v85, v84, v85
    v_lshlrev_b32 v84, 16, v85
    v_and_b32 v85, 0xffff0000, v85
    v_cvt_pk_bf16_f32 v87, v86, v87
    v_lshlrev_b32 v86, 16, v87
    v_and_b32 v87, 0xffff0000, v87
    v_mul_f32 v86, s42, v86
    v_mul_f32 v87, s42, v87
    v_cvt_pk_bf16_f32 v87, v86, v87
    v_lshlrev_b32 v86, 16, v87
    v_and_b32 v87, 0xffff0000, v87
    v_cndmask_b32 v80, v13, v80, s[64:65]
    v_cndmask_b32 v81, v13, v81, s[66:67]
    v_cndmask_b32 v82, v13, v82, s[68:69]
    v_cndmask_b32 v83, v13, v83, s[70:71]
    v_cndmask_b32 v88, v13, v88, s[64:65]
    v_cndmask_b32 v89, v13, v89, s[66:67]
    v_cndmask_b32 v90, v13, v90, s[68:69]
    v_cndmask_b32 v91, v13, v91, s[70:71]
    v_max_f32 v116, v80, v81
    v_max3_f32 v116, v116, v82, v83
    v_max_f32 v117, v84, v85
    v_max3_f32 v117, v117, v86, v87
    v_max3_f32 v117, v117, v88, v89
    v_max3_f32 v117, v117, v90, v91
    v_mov_b32 v14, v116
    s_nop 1
    v_permlane16_swap_b32 v116, v14
    v_max_f32 v116, v116, v14
    v_mov_b32 v14, v117
    s_nop 1
    v_permlane16_swap_b32 v117, v14
    v_max_f32 v117, v117, v14
    v_mov_b32 v14, v116
    s_nop 1
    v_permlane32_swap_b32 v116, v14
    v_max_f32 v116, v116, v14
    v_mov_b32 v14, v117
    s_nop 1
    v_permlane32_swap_b32 v117, v14
    v_max_f32 v117, v117, v14
    v_mul_f32 v14, s43, v116
    v_fma_f32 v80, v80, s43, -v14
    v_exp_f32 v80, v80
    v_fma_f32 v81, v81, s43, -v14
    v_exp_f32 v81, v81
    v_fma_f32 v82, v82, s43, -v14
    v_exp_f32 v82, v82
    v_fma_f32 v83, v83, s43, -v14
    v_exp_f32 v83, v83
    v_mul_f32 v14, s43, v117
    v_fma_f32 v84, v84, s43, -v14
    v_exp_f32 v84, v84
    v_fma_f32 v85, v85, s43, -v14
    v_exp_f32 v85, v85
    v_fma_f32 v86, v86, s43, -v14
    v_exp_f32 v86, v86
    v_fma_f32 v87, v87, s43, -v14
    v_exp_f32 v87, v87
    v_fma_f32 v88, v88, s43, -v14
    v_exp_f32 v88, v88
    v_fma_f32 v89, v89, s43, -v14
    v_exp_f32 v89, v89
    v_fma_f32 v90, v90, s43, -v14
    v_exp_f32 v90, v90
    v_fma_f32 v91, v91, s43, -v14
    v_exp_f32 v91, v91
    v_cvt_pk_bf16_f32 v100, v80, v81
    v_cvt_pk_bf16_f32 v101, v82, v83
    v_mov_b64 v[102:103], 0
    v_cvt_pk_bf16_f32 v104, v84, v85
    v_cvt_pk_bf16_f32 v105, v86, v87
    v_cvt_pk_bf16_f32 v106, v88, v89
    v_cvt_pk_bf16_f32 v107, v90, v91
    v_mov_b64 v[108:109], s[4:5]
    v_mov_b64 v[110:111], s[4:5]
    v_cndmask_b32 v112, 0, v108, s[72:73]
    v_cndmask_b32 v113, 0, v108, s[72:73]
    v_mfma_f32_16x16x32_bf16 v[16:19], v[108:111], v[100:103], 0
    v_mfma_f32_16x16x32_bf16 v[24:27], a[64:67], v[100:103], 0
    v_mfma_f32_16x16x32_bf16 v[28:31], a[68:71], v[100:103], 0
    v_mfma_f32_16x16x32_bf16 v[20:23], v[108:111], v[104:107], 0
    v_mfma_f32_16x16x32_bf16 v[32:35], a[64:67], v[104:107], 0
    v_mfma_f32_16x16x32_bf16 v[36:39], a[68:71], v[104:107], 0
    s_branch L_P2_chk
L_P2_far:
    buffer_load_dword v14, v2, s[8:11], s25 offen sc1
    s_add_u32 s32, s32, 1
    s_cmp_gt_u32 s32, 200000
    s_waitcnt vmcnt(0)
    s_cbranch_scc1 L_P2_poll
    v_cmp_eq_u32 vcc, -1, v14
    s_cbranch_vccz L_P2_near
    s_sleep 12
    s_branch L_P2_far
L_P2_near:
    s_mov_b32 s25, 0x40000000
L_P2_poll:
    buffer_load_dwordx4 v[48:51], v2, s[8:11], s24 offen sc1
    buffer_load_dwordx4 v[52:55], v2, s[8:11], s24 offen offset:1024 sc1
L_P2_chk:
    s_add_u32 s32, s32, 1
    s_waitcnt vmcnt(0)
    ds_write_b128 v2, v[48:51] offset:20480
    ds_write_b128 v2, v[52:55] offset:21504
    v_max3_u32 v14, v48, v49, v50
    v_max3_u32 v15, v51, v52, v53
    v_max3_u32 v14, v14, v54, v55
    v_max_u32 v14, v14, v15
    v_cmp_eq_u32 vcc, -1, v14
    s_cbranch_vccz L_P2_got
    s_cmp_gt_u32 s32, 200000
    s_cbranch_scc1 L_P2_got
    s_cmp_eq_u32 s25, 0x40000000
    s_cbranch_scc1 L_P2_poll
    s_branch L_P2_far
L_P2_got:
    s_waitcnt lgkmcnt(0)
    s_barrier
    ds_read_b128 v[48:51], v8 offset:0
    ds_read_b128 v[52:55], v8 offset:2048
    ds_read_b128 v[56:59], v8 offset:4096
    ds_read_b128 v[60:63], v8 offset:6144
    s_waitcnt lgkmcnt(3)
    v_mfma_f32_16x16x32_bf16 v[80:83], a[128:131], v[48:51], 0
    v_mfma_f32_16x16x32_bf16 v[84:87], a[132:135], v[48:51], 0
    ds_read_b128 v[48:51], v8 offset:512
    s_waitcnt lgkmcnt(3)
    v_mfma_f32_16x16x32_bf16 v[80:83], a[136:139], v[52:55], v[80:83]
    v_mfma_f32_16x16x32_bf16 v[84:87], a[140:143], v[52:55], v[84:87]
    ds_read_b128 v[52:55], v8 offset:2560
    s_waitcnt lgkmcnt(3)
    v_mfma_f32_16x16x32_bf16 v[80:83], a[144:147], v[56:59], v[80:83]
    v_mfma_f32_16x16x32_bf16 v[84:87], a[148:151], v[56:59], v[84:87]
    ds_read_b128 v[56:59], v8 offset:4608
    s_waitcnt lgkmcnt(3)
    v_mfma_f32_16x16x32_bf16 v[80:83], a[152:155], v[60:63], v[80:83]
    v_mfma_f32_16x16x32_bf16 v[84:87], a[156:159], v[60:63], v[84:87]
    ds_read_b128 v[60:63], v8 offset:6656
    s_waitcnt lgkmcnt(3)
    v_mfma_f32_16x16x32_bf16 v[80:83], a[160:163], v[48:51], v[80:83]
    v_mfma_f32_16x16x32_bf16 v[84:87], a[164:167], v[48:51], v[84:87]
    ds_read_b128 v[48:51], v8 offset:1024
    s_waitcnt lgkmcnt(3)
    v_mfma_f32_16x16x32_bf16 v[80:83], a[168:171], v[52:55], v[80:83]
    v_mfma_f32_16x16x32_bf16 v[84:87], a[172:175], v[52:55], v[84:87]
    ds_read_b128 v[52:55], v8 offset:3072
    s_waitcnt lgkmcnt(3)
    v_mfma_f32_16x16x32_bf16 v[80:83], a[176:179], v[56:59], v[80:83]
    v_mfma_f32_16x16x32_bf16 v[84:87], a[180:183], v[56:59], v[84:87]
    ds_read_b128 v[56:59], v8 offset:5120
    s_waitcnt lgkmcnt(3)
    v_mfma_f32_16x16x32_bf16 v[80:83], a[184:187], v[60:63], v[80:83]
    v_mfma_f32_16x16x32_bf16 v[84:87], a[188:191], v[60:63], v[84:87]
    ds_read_b128 v[60:63], v8 offset:7168
    s_waitcnt lgkmcnt(3)
    v_mfma_f32_16x16x32_bf16 v[80:83], a[192:195], v[48:51], v[80:83]
    v_mfma_f32_16x16x32_bf16 v[84:87], a[196:199], v[48:51], v[84:87]
    ds_read_b128 v[48:51], v8 offset:1536
    s_waitcnt lgkmcnt(3)
    v_mfma_f32_16x16x32_bf16 v[80:83], a[200:203], v[52:55], v[80:83]
    v_mfma_f32_16x16x32_bf16 v[84:87], a[204:207], v[52:55], v[84:87]
    ds_read_b128 v[52:55], v8 offset:3584
    s_waitcnt lgkmcnt(3)
    v_mfma_f32_16x16x32_bf16 v[80:83], a[208:211], v[56:59], v[80:83]
    v_mfma_f32_16x16x32_bf16 v[84:87], a[212:215], v[56:59], v[84:87]
    ds_read_b128 v[56:59], v8 offset:5632
    s_waitcnt lgkmcnt(3)
    v_mfma_f32_16x16x32_bf16 v[80:83], a[216:219], v[60:63], v[80:83]
    v_mfma_f32_16x16x32_bf16 v[84:87], a[220:223], v[60:63], v[84:87]
    ds_read_b128 v[60:63], v8 offset:7680
    s_waitcnt lgkmcnt(3)
    v_mfma_f32_16x16x32_bf16 v[80:83], a[224:227], v[48:51], v[80:83]
    v_mfma_f32_16x16x32_bf16 v[84:87], a[228:231], v[48:51], v[84:87]
    ds_read_b128 v[48:51], v8 offset:0
    s_waitcnt lgkmcnt(3)
    v_mfma_f32_16x16x32_bf16 v[80:83], a[232:235], v[52:55], v[80:83]
    v_mfma_f32_16x16x32_bf16 v[84:87], a[236:239], v[52:55], v[84:87]
    ds_read_b128 v[52:55], v8 offset:2048
    s_waitcnt lgkmcnt(3)
    v_mfma_f32_16x16x32_bf16 v[80:83], a[240:243], v[56:59], v[80:83]
    v_mfma_f32_16x16x32_bf16 v[84:87], a[244:247], v[56:59], v[84:87]
    ds_read_b128 v[56:59], v8 offset:4096
    s_waitcnt lgkmcnt(3)
    v_mfma_f32_16x16x32_bf16 v[80:83], a[248:251], v[60:63], v[80:83]
    v_mfma_f32_16x16x32_bf16 v[84:87], a[252:255], v[60:63], v[84:87]
    ds_read_b128 v[60:63], v8 offset:6144
    s_waitcnt lgkmcnt(3)
    v_mfma_f32_16x16x32_bf16 v[40:43], v[48:51], v[128:131], 0
    v_mfma_f32_16x16x32_bf16 v[44:47], v[48:51], v[132:135], 0
    ds_read_b128 v[48:51], v8 offset:512
    s_waitcnt lgkmcnt(3)
    v_mfma_f32_16x16x32_bf16 v[40:43], v[52:55], v[136:139], v[40:43]
    v_mfma_f32_16x16x32_bf16 v[44:47], v[52:55], v[140:143], v[44:47]
    v_cvt_pk_bf16_f32 v88, v80, v84
    v_cvt_pk_bf16_f32 v89, v81, v85
    v_cvt_pk_bf16_f32 v90, v82, v86
    v_cvt_pk_bf16_f32 v91, v83, v87
    ds_write_b128 v9, v[88:91] offset:16384
    ds_read_b128 v[52:55], v8 offset:2560
    s_waitcnt lgkmcnt(4)
    v_mfma_f32_16x16x32_bf16 v[40:43], v[56:59], v[144:147], v[40:43]
    v_mfma_f32_16x16x32_bf16 v[44:47], v[56:59], v[148:151], v[44:47]
    ds_read_b128 v[56:59], v8 offset:4608
    s_waitcnt lgkmcnt(4)
    v_mfma_f32_16x16x32_bf16 v[40:43], v[60:63], v[152:155], v[40:43]
    v_mfma_f32_16x16x32_bf16 v[44:47], v[60:63], v[156:159], v[44:47]
    ds_read_b128 v[60:63], v8 offset:6656
    s_waitcnt lgkmcnt(4)
    v_mfma_f32_16x16x32_bf16 v[40:43], v[48:51], v[160:163], v[40:43]
    v_mfma_f32_16x16x32_bf16 v[44:47], v[48:51], v[164:167], v[44:47]
    s_waitcnt lgkmcnt(3)
    s_barrier
    ds_read_b128 v[64:67], v1 offset:16384
    ds_read_b128 v[68:71], v1 offset:17408
    ds_read_b128 v[72:75], v1 offset:18432
    ds_read_b128 v[76:79], v1 offset:19456
    ds_read_b128 v[48:51], v8 offset:1024
    s_waitcnt lgkmcnt(7)
    v_mfma_f32_16x16x32_bf16 v[40:43], v[52:55], v[168:171], v[40:43]
    v_mfma_f32_16x16x32_bf16 v[44:47], v[52:55], v[172:175], v[44:47]
    ds_read_b128 v[52:55], v8 offset:3072
    s_waitcnt lgkmcnt(7)
    v_mfma_f32_16x16x32_bf16 v[40:43], v[56:59], v[176:179], v[40:43]
    v_mfma_f32_16x16x32_bf16 v[44:47], v[56:59], v[180:183], v[44:47]
    s_waitcnt lgkmcnt(2)
    v_mfma_f32_16x16x32_bf16 v[92:95], v[64:67], a[0:3], 0
    v_mfma_f32_16x16x32_bf16 v[96:99], v[64:67], a[16:19], 0
    v_mfma_f32_16x16x32_bf16 v[92:95], v[68:71], a[4:7], v[92:95]
    v_mfma_f32_16x16x32_bf16 v[96:99], v[68:71], a[20:23], v[96:99]
    v_mfma_f32_16x16x32_bf16 v[92:95], v[72:75], a[8:11], v[92:95]
    v_mfma_f32_16x16x32_bf16 v[96:99], v[72:75], a[24:27], v[96:99]
    v_mfma_f32_16x16x32_bf16 v[92:95], v[76:79], a[12:15], v[92:95]
    v_mfma_f32_16x16x32_bf16 v[96:99], v[76:79], a[28:31], v[96:99]
    ds_read_b128 v[56:59], v8 offset:5120
    s_waitcnt lgkmcnt(3)
    v_mfma_f32_16x16x32_bf16 v[40:43], v[60:63], v[184:187], v[40:43]
    v_mfma_f32_16x16x32_bf16 v[44:47], v[60:63], v[188:191], v[44:47]
    ds_read_b128 v[60:63], v8 offset:7168
    s_waitcnt lgkmcnt(3)
    v_mfma_f32_16x16x32_bf16 v[40:43], v[48:51], v[192:195], v[40:43]
    v_mfma_f32_16x16x32_bf16 v[44:47], v[48:51], v[196:199], v[44:47]
    v_cvt_pk_bf16_f32 v93, v92, v93
    v_lshlrev_b32 v92, 16, v93
    v_and_b32 v93, 0xffff0000, v93
    v_mul_f32 v92, s42, v92
    v_mul_f32 v93, s42, v93
    v_cvt_pk_bf16_f32 v93, v92, v93
    v_lshlrev_b32 v92, 16, v93
    ds_read_b128 v[48:51], v8 offset:1536
    s_waitcnt lgkmcnt(3)
    v_mfma_f32_16x16x32_bf16 v[40:43], v[52:55], v[200:203], v[40:43]
    v_mfma_f32_16x16x32_bf16 v[44:47], v[52:55], v[204:207], v[44:47]
    v_and_b32 v93, 0xffff0000, v93
    v_cvt_pk_bf16_f32 v95, v94, v95
    v_lshlrev_b32 v94, 16, v95
    v_and_b32 v95, 0xffff0000, v95
    v_mul_f32 v94, s42, v94
    v_mul_f32 v95, s42, v95
    v_cvt_pk_bf16_f32 v95, v94, v95
    ds_read_b128 v[52:55], v8 offset:3584
    s_waitcnt lgkmcnt(3)
    v_mfma_f32_16x16x32_bf16 v[40:43], v[56:59], v[208:211], v[40:43]
    v_mfma_f32_16x16x32_bf16 v[44:47], v[56:59], v[212:215], v[44:47]
    v_lshlrev_b32 v94, 16, v95
    v_and_b32 v95, 0xffff0000, v95
    v_cvt_pk_bf16_f32 v97, v96, v97
    v_lshlrev_b32 v96, 16, v97
    v_and_b32 v97, 0xffff0000, v97
    v_mul_f32 v96, s42, v96
    v_mul_f32 v97, s42, v97
    ds_read_b128 v[56:59], v8 offset:5632
    s_waitcnt lgkmcnt(3)
    v_mfma_f32_16x16x32_bf16 v[40:43], v[60:63], v[216:219], v[40:43]
    v_mfma_f32_16x16x32_bf16 v[44:47], v[60:63], v[220:223], v[44:47]
    v_cvt_pk_bf16_f32 v97, v96, v97
    v_lshlrev_b32 v96, 16, v97
    v_and_b32 v97, 0xffff0000, v97
    v_cvt_pk_bf16_f32 v99, v98, v99
    v_lshlrev_b32 v98, 16, v99
    v_and_b32 v99, 0xffff0000, v99
    v_mul_f32 v98, s42, v98
    ds_read_b128 v[60:63], v8 offset:7680
    s_waitcnt lgkmcnt(3)
    v_mfma_f32_16x16x32_bf16 v[40:43], v[48:51], v[224:227], v[40:43]
    v_mfma_f32_16x16x32_bf16 v[44:47], v[48:51], v[228:231], v[44:47]
    v_mul_f32 v99, s42, v99
    v_cvt_pk_bf16_f32 v99, v98, v99
    v_lshlrev_b32 v98, 16, v99
    v_and_b32 v99, 0xffff0000, v99
    v_max3_f32 v118, v92, v93, v94
    v_max3_f32 v118, v118, v95, v116
    v_max3_f32 v119, v96, v97, v98
    s_waitcnt lgkmcnt(2)
    v_mfma_f32_16x16x32_bf16 v[40:43], v[52:55], v[232:235], v[40:43]
    v_mfma_f32_16x16x32_bf16 v[44:47], v[52:55], v[236:239], v[44:47]
    v_max3_f32 v119, v119, v99, v117
    v_mov_b32 v14, v118
    v_mov_b32 v15, v119
    s_nop 0
    v_permlane16_swap_b32 v118, v14
    v_permlane16_swap_b32 v119, v15
    v_max_f32 v118, v118, v14
    v_max_f32 v119, v119, v15
    s_waitcnt lgkmcnt(1)
    v_mfma_f32_16x16x32_bf16 v[40:43], v[56:59], v[240:243], v[40:43]
    v_mfma_f32_16x16x32_bf16 v[44:47], v[56:59], v[244:247], v[44:47]
    v_sub_f32 v104, v116, v118
    v_mul_f32 v118, s43, v118
    v_mul_f32 v104, s43, v104
    v_exp_f32 v104, v104
    v_fma_f32 v92, v92, s43, -v118
    v_exp_f32 v92, v92
    v_fma_f32 v93, v93, s43, -v118
    s_waitcnt lgkmcnt(0)
    v_mfma_f32_16x16x32_bf16 v[40:43], v[60:63], v[248:251], v[40:43]
    v_mfma_f32_16x16x32_bf16 v[44:47], v[60:63], v[252:255], v[44:47]
    v_exp_f32 v93, v93
    v_fma_f32 v94, v94, s43, -v118
    v_exp_f32 v94, v94
    v_fma_f32 v95, v95, s43, -v118
    v_exp_f32 v95, v95
    v_cvt_pk_bf16_f32 v100, v92, v93
    v_cvt_pk_bf16_f32 v101, v94, v95
    v_sub_f32 v105, v117, v119
    v_mul_f32 v119, s43, v119
    v_mul_f32 v105, s43, v105
    v_exp_f32 v105, v105
    v_fma_f32 v96, v96, s43, -v119
    v_exp_f32 v96, v96
    v_fma_f32 v97, v97, s43, -v119
    v_exp_f32 v97, v97
    v_fma_f32 v98, v98, s43, -v119
    v_exp_f32 v98, v98
    v_fma_f32 v99, v99, s43, -v119
    v_exp_f32 v99, v99
    v_cvt_pk_bf16_f32 v102, v96, v97
    v_cvt_pk_bf16_f32 v103, v98, v99
    v_mfma_f32_16x16x16_bf16 v[48:51], v[112:113], v[100:101], 0
    s_nop 0
    v_mfma_f32_16x16x16_bf16 v[52:55], v[112:113], v[102:103], 0
    v_cvt_pk_bf16_f32 v80, v40, v41
    v_cndmask_b32 v80, 0, v80, s[72:73]
    v_cvt_pk_bf16_f32 v81, v42, v43
    v_cndmask_b32 v81, 0, v81, s[72:73]
    v_cvt_pk_bf16_f32 v82, v44, v45
    v_cndmask_b32 v82, 0, v82, s[72:73]
    v_cvt_pk_bf16_f32 v83, v46, v47
    v_cndmask_b32 v83, 0, v83, s[72:73]
    v_mfma_f32_16x16x16_bf16 v[56:59], v[80:81], v[100:101], 0
    s_nop 0
    v_mfma_f32_16x16x16_bf16 v[60:63], v[82:83], v[100:101], 0
    v_mfma_f32_16x16x16_bf16 v[64:67], v[80:81], v[102:103], 0
    v_mfma_f32_16x16x16_bf16 v[68:71], v[82:83], v[102:103], 0
    v_fma_f32 v48, v16, v104, v48
    v_rcp_f32 v48, v48
    v_fma_f32 v52, v20, v105, v52
    v_rcp_f32 v52, v52
    v_fma_f32 v56, v24, v104, v56
    v_fma_f32 v57, v25, v104, v57
    v_fma_f32 v58, v26, v104, v58
    v_fma_f32 v59, v27, v104, v59
    v_fma_f32 v60, v28, v104, v60
    v_fma_f32 v61, v29, v104, v61
    v_fma_f32 v62, v30, v104, v62
    v_fma_f32 v63, v31, v104, v63
    v_pk_mul_f32 v[56:57], v[56:57], v[48:49] op_sel_hi:[1,0]
    v_pk_mul_f32 v[58:59], v[58:59], v[48:49] op_sel_hi:[1,0]
    v_pk_mul_f32 v[60:61], v[60:61], v[48:49] op_sel_hi:[1,0]
    v_pk_mul_f32 v[62:63], v[62:63], v[48:49] op_sel_hi:[1,0]
    v_cvt_pk_bf16_f32 v72, v56, v60
    v_cvt_pk_bf16_f32 v73, v57, v61
    v_cvt_pk_bf16_f32 v74, v58, v62
    v_cvt_pk_bf16_f32 v75, v59, v63
    ds_write_b128 v9, v[72:75] offset:0
    v_fma_f32 v64, v32, v105, v64
    v_fma_f32 v65, v33, v105, v65
    v_fma_f32 v66, v34, v105, v66
    v_fma_f32 v67, v35, v105, v67
    v_fma_f32 v68, v36, v105, v68
    v_fma_f32 v69, v37, v105, v69
    v_fma_f32 v70, v38, v105, v70
    v_fma_f32 v71, v39, v105, v71
    v_pk_mul_f32 v[64:65], v[64:65], v[52:53] op_sel_hi:[1,0]
    v_pk_mul_f32 v[66:67], v[66:67], v[52:53] op_sel_hi:[1,0]
    v_pk_mul_f32 v[68:69], v[68:69], v[52:53] op_sel_hi:[1,0]
    v_pk_mul_f32 v[70:71], v[70:71], v[52:53] op_sel_hi:[1,0]
    v_cvt_pk_bf16_f32 v76, v64, v68
    v_cvt_pk_bf16_f32 v77, v65, v69
    v_cvt_pk_bf16_f32 v78, v66, v70
    v_cvt_pk_bf16_f32 v79, v67, v71
    ds_write_b128 v9, v[76:79] offset:4096
    s_waitcnt lgkmcnt(0)
    s_barrier
    ds_read_b128 v[16:19], v1 offset:0
    ds_read_b128 v[20:23], v1 offset:1024
    ds_read_b128 v[24:27], v1 offset:2048
    ds_read_b128 v[28:31], v1 offset:3072
    ds_read_b128 v[32:35], v1 offset:4096
    ds_read_b128 v[36:39], v1 offset:5120
    ds_read_b128 v[40:43], v1 offset:6144
    ds_read_b128 v[44:47], v1 offset:7168
    ds_read_b128 v[48:51], v7 offset:0
    ds_read_b128 v[52:55], v7 offset:1024
    ds_read_b128 v[56:59], v7 offset:2048
    s_lshl_b32 s36, s20, 10
    s_add_u32 s25, s26, s36
    s_waitcnt lgkmcnt(2)
    v_mfma_f32_16x16x32_bf16 v[64:67], v[16:19], v[48:51], 0
    ds_read_b128 v[60:63], v7 offset:3072
    s_waitcnt lgkmcnt(2)
    v_mfma_f32_16x16x32_bf16 v[68:71], v[16:19], v[52:55], 0
    ds_read_b128 v[48:51], v7 offset:4096
    s_waitcnt lgkmcnt(2)
    v_mfma_f32_16x16x32_bf16 v[72:75], v[16:19], v[56:59], 0
    ds_read_b128 v[52:55], v7 offset:5120
    s_waitcnt lgkmcnt(2)
    v_mfma_f32_16x16x32_bf16 v[76:79], v[16:19], v[60:63], 0
    ds_read_b128 v[56:59], v7 offset:6144
    s_waitcnt lgkmcnt(2)
    v_mfma_f32_16x16x32_bf16 v[80:83], v[16:19], v[48:51], 0
    ds_read_b128 v[60:63], v7 offset:7168
    s_waitcnt lgkmcnt(2)
    v_mfma_f32_16x16x32_bf16 v[84:87], v[16:19], v[52:55], 0
    ds_read_b128 v[48:51], v7 offset:8192
    s_waitcnt lgkmcnt(2)
    v_mfma_f32_16x16x32_bf16 v[88:91], v[16:19], v[56:59], 0
    ds_read_b128 v[52:55], v7 offset:9216
    s_waitcnt lgkmcnt(2)
    v_mfma_f32_16x16x32_bf16 v[92:95], v[16:19], v[60:63], 0
    ds_read_b128 v[56:59], v7 offset:10240
    s_waitcnt lgkmcnt(2)
    v_mfma_f32_16x16x32_bf16 v[64:67], v[20:23], v[48:51], v[64:67]
    ds_read_b128 v[60:63], v7 offset:11264
    s_waitcnt lgkmcnt(2)
    v_mfma_f32_16x16x32_bf16 v[68:71], v[20:23], v[52:55], v[68:71]
    ds_read_b128 v[48:51], v7 offset:12288
    s_waitcnt lgkmcnt(2)
    v_mfma_f32_16x16x32_bf16 v[72:75], v[20:23], v[56:59], v[72:75]
    ds_read_b128 v[52:55], v7 offset:13312
    s_waitcnt lgkmcnt(2)
    v_mfma_f32_16x16x32_bf16 v[76:79], v[20:23], v[60:63], v[76:79]
    ds_read_b128 v[56:59], v7 offset:14336
    s_waitcnt lgkmcnt(2)
    v_mfma_f32_16x16x32_bf16 v[80:83], v[20:23], v[48:51], v[80:83]
    ds_read_b128 v[60:63], v7 offset:15360
    s_waitcnt lgkmcnt(2)
    v_mfma_f32_16x16x32_bf16 v[84:87], v[20:23], v[52:55], v[84:87]
    ds_read_b128 v[48:51], v7 offset:16384
    s_waitcnt lgkmcnt(2)
    v_mfma_f32_16x16x32_bf16 v[88:91], v[20:23], v[56:59], v[88:91]
    ds_read_b128 v[52:55], v7 offset:17408
    s_waitcnt lgkmcnt(2)
    v_mfma_f32_16x16x32_bf16 v[92:95], v[20:23], v[60:63], v[92:95]
    ds_read_b128 v[56:59], v7 offset:18432
    s_waitcnt lgkmcnt(2)
    v_mfma_f32_16x16x32_bf16 v[64:67], v[24:27], v[48:51], v[64:67]
    ds_read_b128 v[60:63], v7 offset:19456
    s_waitcnt lgkmcnt(2)
    v_mfma_f32_16x16x32_bf16 v[68:71], v[24:27], v[52:55], v[68:71]
    ds_read_b128 v[48:51], v7 offset:20480
    s_waitcnt lgkmcnt(2)
    v_mfma_f32_16x16x32_bf16 v[72:75], v[24:27], v[56:59], v[72:75]
    ds_read_b128 v[52:55], v7 offset:21504
    s_waitcnt lgkmcnt(2)
    v_mfma_f32_16x16x32_bf16 v[76:79], v[24:27], v[60:63], v[76:79]
    ds_read_b128 v[56:59], v7 offset:22528
    s_waitcnt lgkmcnt(2)
    v_mfma_f32_16x16x32_bf16 v[80:83], v[24:27], v[48:51], v[80:83]
    ds_read_b128 v[60:63], v7 offset:23552
    s_waitcnt lgkmcnt(2)
    v_mfma_f32_16x16x32_bf16 v[84:87], v[24:27], v[52:55], v[84:87]
    ds_read_b128 v[48:51], v7 offset:24576
    s_waitcnt lgkmcnt(2)
    v_mfma_f32_16x16x32_bf16 v[88:91], v[24:27], v[56:59], v[88:91]
    ds_read_b128 v[52:55], v7 offset:25600
    s_waitcnt lgkmcnt(2)
    v_mfma_f32_16x16x32_bf16 v[92:95], v[24:27], v[60:63], v[92:95]
    ds_read_b128 v[56:59], v7 offset:26624
    s_waitcnt lgkmcnt(2)
    v_mfma_f32_16x16x32_bf16 v[64:67], v[28:31], v[48:51], v[64:67]
    ds_read_b128 v[60:63], v7 offset:27648
    s_waitcnt lgkmcnt(2)
    v_mfma_f32_16x16x32_bf16 v[68:71], v[28:31], v[52:55], v[68:71]
    ds_read_b128 v[48:51], v7 offset:28672
    s_waitcnt lgkmcnt(2)
    v_mfma_f32_16x16x32_bf16 v[72:75], v[28:31], v[56:59], v[72:75]
    ds_read_b128 v[52:55], v7 offset:29696
    s_waitcnt lgkmcnt(2)
    v_mfma_f32_16x16x32_bf16 v[76:79], v[28:31], v[60:63], v[76:79]
    ds_read_b128 v[56:59], v7 offset:30720
    s_waitcnt lgkmcnt(2)
    v_mfma_f32_16x16x32_bf16 v[80:83], v[28:31], v[48:51], v[80:83]
    ds_read_b128 v[60:63], v7 offset:31744
    s_waitcnt lgkmcnt(2)
    v_mfma_f32_16x16x32_bf16 v[84:87], v[28:31], v[52:55], v[84:87]
    ds_read_b128 v[48:51], v7 offset:0
    s_waitcnt lgkmcnt(2)
    v_mfma_f32_16x16x32_bf16 v[88:91], v[28:31], v[56:59], v[88:91]
    ds_read_b128 v[52:55], v7 offset:1024
    s_waitcnt lgkmcnt(2)
    v_mfma_f32_16x16x32_bf16 v[92:95], v[28:31], v[60:63], v[92:95]
    ds_read_b128 v[56:59], v7 offset:2048
    s_waitcnt lgkmcnt(2)
    v_mfma_f32_16x16x32_bf16 v[96:99], v[32:35], v[48:51], 0
    ds_read_b128 v[60:63], v7 offset:3072
    s_waitcnt lgkmcnt(2)
    v_mfma_f32_16x16x32_bf16 v[100:103], v[32:35], v[52:55], 0
    ds_read_b128 v[48:51], v7 offset:4096
    s_waitcnt lgkmcnt(2)
    v_mfma_f32_16x16x32_bf16 v[104:107], v[32:35], v[56:59], 0
    ds_read_b128 v[52:55], v7 offset:5120
    s_waitcnt lgkmcnt(2)
    v_mfma_f32_16x16x32_bf16 v[108:111], v[32:35], v[60:63], 0
    ds_read_b128 v[56:59], v7 offset:6144
    v_cvt_pk_bf16_f32 v16, v64, v68
    s_waitcnt lgkmcnt(2)
    v_mfma_f32_16x16x32_bf16 v[112:115], v[32:35], v[48:51], 0
    ds_read_b128 v[60:63], v7 offset:7168
    v_cvt_pk_bf16_f32 v17, v72, v76
    s_waitcnt lgkmcnt(2)
    v_mfma_f32_16x16x32_bf16 v[116:119], v[32:35], v[52:55], 0
    ds_read_b128 v[48:51], v7 offset:8192
    v_cvt_pk_bf16_f32 v18, v80, v84
    s_waitcnt lgkmcnt(2)
    v_mfma_f32_16x16x32_bf16 v[120:123], v[32:35], v[56:59], 0
    ds_read_b128 v[52:55], v7 offset:9216
    v_cvt_pk_bf16_f32 v19, v88, v92
    s_waitcnt lgkmcnt(2)
    v_mfma_f32_16x16x32_bf16 v[124:127], v[32:35], v[60:63], 0
    ds_read_b128 v[56:59], v7 offset:10240
    v_and_or_b32 v16, v16, -2, s27
    s_waitcnt lgkmcnt(2)
    v_mfma_f32_16x16x32_bf16 v[96:99], v[36:39], v[48:51], v[96:99]
    ds_read_b128 v[60:63], v7 offset:11264
    s_add_u32 s36, s25, 0x0
    s_waitcnt lgkmcnt(2)
    v_mfma_f32_16x16x32_bf16 v[100:103], v[36:39], v[52:55], v[100:103]
    ds_read_b128 v[48:51], v7 offset:12288
    buffer_store_dwordx4 v[16:19], v10, s[8:11], s36 offen sc1
    s_waitcnt lgkmcnt(2)
    v_mfma_f32_16x16x32_bf16 v[104:107], v[36:39], v[56:59], v[104:107]
    ds_read_b128 v[52:55], v7 offset:13312
    v_cvt_pk_bf16_f32 v20, v65, v69
    s_waitcnt lgkmcnt(2)
    v_mfma_f32_16x16x32_bf16 v[108:111], v[36:39], v[60:63], v[108:111]
    ds_read_b128 v[56:59], v7 offset:14336
    v_cvt_pk_bf16_f32 v21, v73, v77
    s_waitcnt lgkmcnt(2)
    v_mfma_f32_16x16x32_bf16 v[112:115], v[36:39], v[48:51], v[112:115]
    ds_read_b128 v[60:63], v7 offset:15360
    v_cvt_pk_bf16_f32 v22, v81, v85
    s_waitcnt lgkmcnt(2)
    v_mfma_f32_16x16x32_bf16 v[116:119], v[36:39], v[52:55], v[116:119]
    ds_read_b128 v[48:51], v7 offset:16384
    v_cvt_pk_bf16_f32 v23, v89, v93
    s_waitcnt lgkmcnt(2)
    v_mfma_f32_16x16x32_bf16 v[120:123], v[36:39], v[56:59], v[120:123]
    ds_read_b128 v[52:55], v7 offset:17408
    v_and_or_b32 v20, v20, -2, s27
    s_waitcnt lgkmcnt(2)
    v_mfma_f32_16x16x32_bf16 v[124:127], v[36:39], v[60:63], v[124:127]
    ds_read_b128 v[56:59], v7 offset:18432
    s_add_u32 s36, s25, 0x8000
    s_waitcnt lgkmcnt(2)
    v_mfma_f32_16x16x32_bf16 v[96:99], v[40:43], v[48:51], v[96:99]
    ds_read_b128 v[60:63], v7 offset:19456
    buffer_store_dwordx4 v[20:23], v10, s[8:11], s36 offen sc1
    s_waitcnt lgkmcnt(2)
    v_mfma_f32_16x16x32_bf16 v[100:103], v[40:43], v[52:55], v[100:103]
    ds_read_b128 v[48:51], v7 offset:20480
    v_cvt_pk_bf16_f32 v24, v66, v70
    s_waitcnt lgkmcnt(2)
    v_mfma_f32_16x16x32_bf16 v[104:107], v[40:43], v[56:59], v[104:107]
    ds_read_b128 v[52:55], v7 offset:21504
    v_cvt_pk_bf16_f32 v25, v74, v78
    s_waitcnt lgkmcnt(2)
    v_mfma_f32_16x16x32_bf16 v[108:111], v[40:43], v[60:63], v[108:111]
    ds_read_b128 v[56:59], v7 offset:22528
    v_cvt_pk_bf16_f32 v26, v82, v86
    s_waitcnt lgkmcnt(2)
    v_mfma_f32_16x16x32_bf16 v[112:115], v[40:43], v[48:51], v[112:115]
    ds_read_b128 v[60:63], v7 offset:23552
    v_cvt_pk_bf16_f32 v27, v90, v94
    s_waitcnt lgkmcnt(2)
    v_mfma_f32_16x16x32_bf16 v[116:119], v[40:43], v[52:55], v[116:119]
    ds_read_b128 v[48:51], v7 offset:24576
    v_and_or_b32 v24, v24, -2, s27
    s_waitcnt lgkmcnt(2)
    v_mfma_f32_16x16x32_bf16 v[120:123], v[40:43], v[56:59], v[120:123]
    ds_read_b128 v[52:55], v7 offset:25600
    s_add_u32 s36, s25, 0x10000
    s_waitcnt lgkmcnt(2)
    v_mfma_f32_16x16x32_bf16 v[124:127], v[40:43], v[60:63], v[124:127]
    ds_read_b128 v[56:59], v7 offset:26624
    buffer_store_dwordx4 v[24:27], v10, s[8:11], s36 offen sc1
    s_waitcnt lgkmcnt(2)
    v_mfma_f32_16x16x32_bf16 v[96:99], v[44:47], v[48:51], v[96:99]
    ds_read_b128 v[60:63], v7 offset:27648
    v_cvt_pk_bf16_f32 v28, v67, v71
    s_waitcnt lgkmcnt(2)
    v_mfma_f32_16x16x32_bf16 v[100:103], v[44:47], v[52:55], v[100:103]
    ds_read_b128 v[48:51], v7 offset:28672
    v_cvt_pk_bf16_f32 v29, v75, v79
    s_waitcnt lgkmcnt(2)
    v_mfma_f32_16x16x32_bf16 v[104:107], v[44:47], v[56:59], v[104:107]
    ds_read_b128 v[52:55], v7 offset:29696
    v_cvt_pk_bf16_f32 v30, v83, v87
    s_waitcnt lgkmcnt(2)
    v_mfma_f32_16x16x32_bf16 v[108:111], v[44:47], v[60:63], v[108:111]
    ds_read_b128 v[56:59], v7 offset:30720
    v_cvt_pk_bf16_f32 v31, v91, v95
    s_waitcnt lgkmcnt(2)
    v_mfma_f32_16x16x32_bf16 v[112:115], v[44:47], v[48:51], v[112:115]
    ds_read_b128 v[60:63], v7 offset:31744
    v_and_or_b32 v28, v28, -2, s27
    s_waitcnt lgkmcnt(2)
    v_mfma_f32_16x16x32_bf16 v[116:119], v[44:47], v[52:55], v[116:119]
    s_add_u32 s36, s25, 0x18000
    s_waitcnt lgkmcnt(1)
    v_mfma_f32_16x16x32_bf16 v[120:123], v[44:47], v[56:59], v[120:123]
    buffer_store_dwordx4 v[28:31], v10, s[8:11], s36 offen sc1
    s_waitcnt lgkmcnt(0)
    v_mfma_f32_16x16x32_bf16 v[124:127], v[44:47], v[60:63], v[124:127]
    v_cvt_pk_bf16_f32 v32, v96, v100
    v_cvt_pk_bf16_f32 v33, v104, v108
    v_cvt_pk_bf16_f32 v34, v112, v116
    s_nop 4
    v_cvt_pk_bf16_f32 v35, v120, v124
    v_and_or_b32 v32, v32, -2, s27
    s_add_u32 s36, s25, 0x80000
    buffer_store_dwordx4 v[32:35], v10, s[8:11], s36 offen sc1
    v_cvt_pk_bf16_f32 v36, v97, v101
    v_cvt_pk_bf16_f32 v37, v105, v109
    v_cvt_pk_bf16_f32 v38, v113, v117
    v_cvt_pk_bf16_f32 v39, v121, v125
    v_and_or_b32 v36, v36, -2, s27
    s_add_u32 s36, s25, 0x88000
    buffer_store_dwordx4 v[36:39], v10, s[8:11], s36 offen sc1
    v_cvt_pk_bf16_f32 v40, v98, v102
    v_cvt_pk_bf16_f32 v41, v106, v110
    v_cvt_pk_bf16_f32 v42, v114, v118
    v_cvt_pk_bf16_f32 v43, v122, v126
    v_and_or_b32 v40, v40, -2, s27
    s_add_u32 s36, s25, 0x90000
    buffer_store_dwordx4 v[40:43], v10, s[8:11], s36 offen sc1
    v_cvt_pk_bf16_f32 v44, v99, v103
    v_cvt_pk_bf16_f32 v45, v107, v111
    v_cvt_pk_bf16_f32 v46, v115, v119
    v_cvt_pk_bf16_f32 v47, v123, v127
    v_and_or_b32 v44, v44, -2, s27
    s_add_u32 s36, s25, 0x98000
    buffer_store_dwordx4 v[44:47], v10, s[8:11], s36 offen sc1
    s_add_u32 s38, s23, 6
    s_cmp_ge_u32 s38, 64
    s_cbranch_scc1 L_P2_last
    s_mul_i32 s24, s38, 0x82100
    s_lshl_b32 s36, s20, 14
    s_add_u32 s24, s24, s36
    s_add_u32 s24, s24, 0x1000000
    s_add_u32 s36, s24, 0
    s_add_u32 s37, s36, 0x7000000
    buffer_load_dwordx4 a[32:35], v1, s[8:11], s36 offen offset:0 sc1
    buffer_load_dwordx4 a[0:3], v1, s[8:11], s37 offen offset:0 sc1
    buffer_load_dwordx4 a[36:39], v1, s[8:11], s36 offen offset:1024 sc1
    buffer_load_dwordx4 a[4:7], v1, s[8:11], s37 offen offset:1024 sc1
    buffer_load_dwordx4 a[40:43], v1, s[8:11], s36 offen offset:2048 sc1
    buffer_load_dwordx4 a[8:11], v1, s[8:11], s37 offen offset:2048 sc1
    buffer_load_dwordx4 a[44:47], v1, s[8:11], s36 offen offset:3072 sc1
    buffer_load_dwordx4 a[12:15], v1, s[8:11], s37 offen offset:3072 sc1
    s_add_u32 s36, s24, 4096
    s_add_u32 s37, s36, 0x7000000
    buffer_load_dwordx4 a[48:51], v1, s[8:11], s36 offen offset:0 sc1
    buffer_load_dwordx4 a[16:19], v1, s[8:11], s37 offen offset:0 sc1
    buffer_load_dwordx4 a[52:55], v1, s[8:11], s36 offen offset:1024 sc1
    buffer_load_dwordx4 a[20:23], v1, s[8:11], s37 offen offset:1024 sc1
    buffer_load_dwordx4 a[56:59], v1, s[8:11], s36 offen offset:2048 sc1
    buffer_load_dwordx4 a[24:27], v1, s[8:11], s37 offen offset:2048 sc1
    buffer_load_dwordx4 a[60:63], v1, s[8:11], s36 offen offset:3072 sc1
    buffer_load_dwordx4 a[28:31], v1, s[8:11], s37 offen offset:3072 sc1
    s_lshr_b32 s36, s21, 1
    s_lshl_b32 s36, s36, 3
    s_xor_b32 s37, s36, 8
    s_add_u32 s24, s24, 8192
    s_add_u32 s36, s36, s24
    s_add_u32 s37, s37, s24
    buffer_load_dwordx2 a[64:65], v2, s[8:11], s36 offen offset:0 sc1
    buffer_load_dwordx2 a[66:67], v2, s[8:11], s37 offen offset:0 sc1
    buffer_load_dwordx2 a[68:69], v2, s[8:11], s36 offen offset:1024 sc1
    buffer_load_dwordx2 a[70:71], v2, s[8:11], s37 offen offset:1024 sc1
L_P2_last:
    s_lshl_b32 s24, s23, 5
    s_add_u32 s24, s24, s20
    s_lshl_b32 s24, s24, 10
    v_accvgpr_read_b32 v52, a72
    v_accvgpr_read_b32 v53, a73
    v_and_b32 v15, 15, v0
    v_mov_b32 v48, 0
    v_mov_b32 v14, 0x3f80
    v_cmp_eq_u32 vcc, 0, v15
    s_nop 1
    v_cndmask_b32 v48, v48, v14, vcc
    v_mov_b32 v14, 0x3f800000
    v_cmp_eq_u32 vcc, 1, v15
    s_nop 1
    v_cndmask_b32 v48, v48, v14, vcc
    v_mov_b32 v49, 0
    v_mov_b32 v14, 0x3f80
    v_cmp_eq_u32 vcc, 4, v15
    s_nop 1
    v_cndmask_b32 v49, v49, v14, vcc
    v_mov_b32 v14, 0x3f800000
    v_cmp_eq_u32 vcc, 5, v15
    s_nop 1
    v_cndmask_b32 v49, v49, v14, vcc
    v_mov_b32 v50, 0
    v_mov_b32 v14, 0x3f80
    v_cmp_eq_u32 vcc, 8, v15
    s_nop 1
    v_cndmask_b32 v50, v50, v14, vcc
    v_mov_b32 v14, 0x3f800000
    v_cmp_eq_u32 vcc, 9, v15
    s_nop 1
    v_cndmask_b32 v50, v50, v14, vcc
    v_mov_b32 v51, 0
    v_mov_b32 v14, 0x3f80
    v_cmp_eq_u32 vcc, 12, v15
    s_nop 1
    v_cndmask_b32 v51, v51, v14, vcc
    v_mov_b32 v14, 0x3f800000
    v_cmp_eq_u32 vcc, 13, v15
    s_nop 1
    v_cndmask_b32 v51, v51, v14, vcc
    s_lshl_b32 s25, s20, 15
    s_add_u32 s25, s25, s26
L_P3_poll:
    s_add_u32 s36, s25, 0
    buffer_load_dwordx4 v[80:83], v11, s[8:11], s36 offen sc1
    s_add_u32 s36, s25, 4096
    buffer_load_dwordx4 v[84:87], v11, s[8:11], s36 offen sc1
    s_add_u32 s36, s25, 8192
    buffer_load_dwordx4 v[88:91], v11, s[8:11], s36 offen sc1
    s_add_u32 s36, s25, 12288
    buffer_load_dwordx4 v[92:95], v11, s[8:11], s36 offen sc1
    s_add_u32 s36, s25, 16384
    buffer_load_dwordx4 v[96:99], v11, s[8:11], s36 offen sc1
    s_add_u32 s36, s25, 20480
    buffer_load_dwordx4 v[100:103], v11, s[8:11], s36 offen sc1
    s_add_u32 s36, s25, 24576
    buffer_load_dwordx4 v[104:107], v11, s[8:11], s36 offen sc1
    s_add_u32 s36, s25, 28672
    buffer_load_dwordx4 v[108:111], v11, s[8:11], s36 offen sc1
    s_mov_b64 exec, -1
    s_add_u32 s32, s32, 1
    s_cmp_gt_u32 s32, 200000
    s_waitcnt vmcnt(7)
    v_mfma_f32_16x16x32_bf16 v[56:59], v[48:51], v[80:83], 0
    s_waitcnt vmcnt(6)
    v_mfma_f32_16x16x32_bf16 v[56:59], v[48:51], v[84:87], v[56:59]
    v_bitop3_b32 v60, v80, v84, s27 bitop3:0x7e
    s_waitcnt vmcnt(5)
    v_mfma_f32_16x16x32_bf16 v[56:59], v[48:51], v[88:91], v[56:59]
    s_waitcnt vmcnt(4)
    v_mfma_f32_16x16x32_bf16 v[56:59], v[48:51], v[92:95], v[56:59]
    v_bitop3_b32 v61, v88, v92, s27 bitop3:0x7e
    s_waitcnt vmcnt(3)
    v_mfma_f32_16x16x32_bf16 v[56:59], v[48:51], v[96:99], v[56:59]
    s_waitcnt vmcnt(2)
    v_mfma_f32_16x16x32_bf16 v[56:59], v[48:51], v[100:103], v[56:59]
    v_bitop3_b32 v62, v96, v100, s27 bitop3:0x7e
    s_waitcnt vmcnt(1)
    v_mfma_f32_16x16x32_bf16 v[56:59], v[48:51], v[104:107], v[56:59]
    s_waitcnt vmcnt(0)
    v_mfma_f32_16x16x32_bf16 v[56:59], v[48:51], v[108:111], v[56:59]
    v_bitop3_b32 v63, v104, v108, s27 bitop3:0x7e
    v_or3_b32 v14, v60, v61, v62
    v_bitop3_b32 v14, v14, v63, 1 bitop3:0xa8
    s_cbranch_scc1 L_P3_got
    v_cmp_ne_u32 vcc, 0, v14
    s_cbranch_vccz L_P3_got
    s_mov_b64 exec, vcc
    s_branch L_P3_poll
L_P3_got:
    s_nop 4
    v_cvt_pk_bf16_f32 v62, v56, v57
    v_lshlrev_b32 v65, 16, v62
    v_and_b32 v66, 0xffff0000, v62
    v_lshlrev_b32 v60, 16, v52
    v_and_b32 v61, 0xffff0000, v52
    v_add_f32 v60, v60, v65
    v_add_f32 v61, v61, v66
    v_cvt_pk_bf16_f32 v62, v60, v61
    v_lshlrev_b32 v60, 16, v62
    v_and_b32 v61, 0xffff0000, v62
    v_add_f32 v63, v60, v61
    v_mul_f32 v64, v60, v60
    v_fmac_f32 v64, v61, v61
    v_add_f32_dpp v63, v63, v63 quad_perm:[1,0,3,2] row_mask:0xf bank_mask:0xf
    s_nop 0
    v_add_f32_dpp v64, v64, v64 quad_perm:[1,0,3,2] row_mask:0xf bank_mask:0xf
    v_add_f32_dpp v63, v63, v63 quad_perm:[2,3,0,1] row_mask:0xf bank_mask:0xf
    s_nop 0
    v_add_f32_dpp v64, v64, v64 quad_perm:[2,3,0,1] row_mask:0xf bank_mask:0xf
    v_add_f32_dpp v63, v63, v63 row_half_mirror row_mask:0xf bank_mask:0xf
    s_nop 0
    v_add_f32_dpp v64, v64, v64 row_half_mirror row_mask:0xf bank_mask:0xf
    v_add_f32_dpp v63, v63, v63 row_mirror row_mask:0xf bank_mask:0xf
    s_nop 0
    v_add_f32_dpp v64, v64, v64 row_mirror row_mask:0xf bank_mask:0xf
    v_mov_b32 v14, v63
    s_nop 1
    v_permlane16_swap_b32 v63, v14
    v_add_f32 v63, v63, v14
    v_mov_b32 v14, v64
    s_nop 1
    v_permlane16_swap_b32 v64, v14
    v_add_f32 v64, v64, v14
    v_mov_b32 v14, v63
    s_nop 1
    v_permlane32_swap_b32 v63, v14
    v_add_f32 v63, v63, v14
    v_mov_b32 v14, v64
    s_nop 1
    v_permlane32_swap_b32 v64, v14
    v_add_f32 v64, v64, v14
    v_mov_b32 v15, s21
    v_lshlrev_b32 v15, 3, v15
    v_add_u32 v15, 28672, v15
    ds_write2_b32 v15, v63, v64 offset0:0 offset1:1
    s_add_u32 s36, s24, 0x400000
    buffer_store_dword v62, v12, s[8:11], s36 offen sc1
    s_waitcnt lgkmcnt(0)
    s_barrier
    v_mov_b32 v15, 28672
    ds_read_b128 v[68:71], v15
    ds_read_b128 v[72:75], v15 offset:16
    s_waitcnt lgkmcnt(0)
    v_add_f32 v63, v68, v70
    v_add_f32 v63, v63, v72
    v_add_f32 v63, v63, v74
    v_mul_f32 v63, 0x3b000000, v63
    v_add_f32 v64, v69, v71
    v_add_f32 v64, v64, v73
    v_add_f32 v64, v64, v75
    v_mul_f32 v64, 0x3b000000, v64
    v_fma_f32 v64, -v63, v63, v64
    v_max_f32 v64, 0, v64
    v_cvt_pk_bf16_f32 v14, v63, v64
    v_lshlrev_b32 v63, 16, v14
    v_and_b32 v64, 0xffff0000, v14
    v_add_f32 v64, 0x3727c5ac, v64
    v_cvt_pk_bf16_f32 v14, v64, v64
    v_lshlrev_b32 v64, 16, v14
    v_sqrt_f32 v64, v64
    s_nop 0
    v_cvt_pk_bf16_f32 v14, v64, v64
    v_lshlrev_b32 v64, 16, v14
    v_rcp_f32 v64, v64
    v_sub_f32 v65, v60, v63
    v_sub_f32 v66, v61, v63
    v_cvt_pk_bf16_f32 v14, v65, v66
    v_lshlrev_b32 v65, 16, v14
    v_and_b32 v66, 0xffff0000, v14
    v_mul_f32 v65, v65, v64
    v_mul_f32 v66, v66, v64
    v_cvt_pk_bf16_f32 v67, v65, v66
    v_lshlrev_b32 v65, 16, v67
    v_and_b32 v66, 0xffff0000, v67
    v_lshlrev_b32 v68, 16, v53
    v_and_b32 v69, 0xffff0000, v53
    v_mul_f32 v63, v65, v68
    v_fmac_f32 v63, v66, v69
    s_nop 1
    v_add_f32_dpp v63, v63, v63 quad_perm:[1,0,3,2] row_mask:0xf bank_mask:0xf
    s_nop 1
    v_add_f32_dpp v63, v63, v63 quad_perm:[2,3,0,1] row_mask:0xf bank_mask:0xf
    s_nop 1
    v_add_f32_dpp v63, v63, v63 row_half_mirror row_mask:0xf bank_mask:0xf
    s_nop 1
    v_add_f32_dpp v63, v63, v63 row_mirror row_mask:0xf bank_mask:0xf
    v_mov_b32 v14, v63
    s_nop 1
    v_permlane16_swap_b32 v63, v14
    v_add_f32 v63, v63, v14
    v_mov_b32 v14, v63
    s_nop 1
    v_permlane32_swap_b32 v63, v14
    v_add_f32 v63, v63, v14
    s_lshr_b32 s25, s24, 6
    s_lshl_b32 s37, s21, 2
    s_add_u32 s25, s25, s37
    s_add_u32 s36, s25, 0x194000
    v_cmp_ne_u32 vcc, 0, v1
    v_mov_b32 v15, 0x40000000
    s_nop 0
    v_cndmask_b32 v15, v1, v15, vcc
    buffer_store_dword v63, v15, s[8:11], s36 offen sc1
    v_add_f32 v60, v60, v65
    v_add_f32 v61, v61, v66
    v_cvt_pk_bf16_f32 v62, v60, v61
    buffer_store_dword v62, v12, s[60:63], s24 offen sc1
    s_add_u32 s36, s24, 0x600000
    buffer_store_dword v67, v12, s[8:11], s36 offen sc1
    s_add_u32 s30, s25, 0x1b8000
    s_add_u32 s29, s29, 1
    s_barrier
    s_add_u32 s23, s23, 6
    s_cmp_lt_u32 s23, 64
    s_cbranch_scc1 L_P2
    s_waitcnt vmcnt(0)
    v_cmp_ne_u32 vcc, 0, v1
    v_mov_b32 v15, 0x40000000
    v_mov_b32 v14, 0
    v_cndmask_b32 v15, v1, v15, vcc
    buffer_store_dword v14, v15, s[8:11], s30 offen sc1
    s_branch L_end
L_mlp:
    s_mov_b32 s12, s44
    s_and_b32 s13, s45, 0xffff
    s_mov_b32 s14, 0x200000
    s_mov_b32 s15, 0x20000
    s_mov_b32 s60, s82
    s_and_b32 s61, s83, 0xffff
    s_mov_b32 s62, 0x200000
    s_mov_b32 s63, 0x20000
    s_mov_b32 s92, s80
    s_and_b32 s93, s81, 0xffff
    s_mov_b32 s94, 0x400
    s_mov_b32 s95, 0x20000
    v_mov_b32 v1, 0x0
    v_bfe_u32 v14, v0, 0, 1
    s_mov_b32 s38, 0x10
    v_mad_u32_u24 v1, v14, s38, v1
    v_bfe_u32 v14, v0, 1, 1
    s_mov_b32 s38, 0x20
    v_mad_u32_u24 v1, v14, s38, v1
    v_bfe_u32 v14, v0, 2, 1
    s_mov_b32 s38, 0x40
    v_mad_u32_u24 v1, v14, s38, v1
    v_bfe_u32 v14, v0, 3, 1
    s_mov_b32 s38, 0x80
    v_mad_u32_u24 v1, v14, s38, v1
    v_bfe_u32 v14, v0, 4, 1
    s_mov_b32 s38, 0x100
    v_mad_u32_u24 v1, v14, s38, v1
    v_bfe_u32 v14, v0, 5, 1
    s_mov_b32 s38, 0x200
    v_mad_u32_u24 v1, v14, s38, v1
    v_mov_b32 v2, 0x0
    v_bfe_u32 v14, v0, 0, 1
    s_mov_b32 s38, 0x10
    v_mad_u32_u24 v2, v14, s38, v2
    v_bfe_u32 v14, v0, 1, 1
    s_mov_b32 s38, 0x20
    v_mad_u32_u24 v2, v14, s38, v2
    v_bfe_u32 v14, v0, 2, 1
    s_mov_b32 s38, 0x40
    v_mad_u32_u24 v2, v14, s38, v2
    v_bfe_u32 v14, v0, 3, 1
    s_mov_b32 s38, 0x80
    v_mad_u32_u24 v2, v14, s38, v2
    v_bfe_u32 v14, v0, 4, 1
    s_mov_b32 s38, 0x100
    v_mad_u32_u24 v2, v14, s38, v2
    v_bfe_u32 v14, v0, 5, 1
    s_mov_b32 s38, 0x200
    v_mad_u32_u24 v2, v14, s38, v2
    v_bfe_u32 v14, v0, 6, 1
    s_mov_b32 s38, 0x800
    v_mad_u32_u24 v2, v14, s38, v2
    v_bfe_u32 v14, v0, 7, 1
    s_mov_b32 s38, 0x1000
    v_mad_u32_u24 v2, v14, s38, v2
    v_mov_b32 v9, 0x0
    v_bfe_u32 v14, v0, 0, 1
    s_mov_b32 s38, 0x10
    v_mad_u32_u24 v9, v14, s38, v9
    v_bfe_u32 v14, v0, 1, 1
    s_mov_b32 s38, 0x20
    v_mad_u32_u24 v9, v14, s38, v9
    v_bfe_u32 v14, v0, 2, 1
    s_mov_b32 s38, 0x40
    v_mad_u32_u24 v9, v14, s38, v9
    v_bfe_u32 v14, v0, 3, 1
    s_mov_b32 s38, 0x80
    v_mad_u32_u24 v9, v14, s38, v9
    v_bfe_u32 v14, v0, 4, 1
    s_mov_b32 s38, 0x100
    v_mad_u32_u24 v9, v14, s38, v9
    v_bfe_u32 v14, v0, 5, 1
    s_mov_b32 s38, 0x200
    v_mad_u32_u24 v9, v14, s38, v9
    v_bfe_u32 v14, v0, 6, 1
    s_mov_b32 s38, 0x400
    v_mad_u32_u24 v9, v14, s38, v9
    v_bfe_u32 v14, v0, 7, 1
    s_mov_b32 s38, 0x800
    v_mad_u32_u24 v9, v14, s38, v9
    v_mov_b32 v7, 0x8000
    v_bfe_u32 v14, v0, 0, 1
    s_mov_b32 s38, 0x10
    v_mad_u32_u24 v7, v14, s38, v7
    v_bfe_u32 v14, v0, 1, 1
    s_mov_b32 s38, 0x20
    v_mad_u32_u24 v7, v14, s38, v7
    v_bfe_u32 v14, v0, 2, 1
    s_mov_b32 s38, 0x40
    v_mad_u32_u24 v7, v14, s38, v7
    v_bfe_u32 v14, v0, 3, 1
    s_mov_b32 s38, 0x80
    v_mad_u32_u24 v7, v14, s38, v7
    v_bfe_u32 v14, v0, 4, 1
    s_mov_b32 s38, 0x100
    v_mad_u32_u24 v7, v14, s38, v7
    v_bfe_u32 v14, v0, 5, 1
    s_mov_b32 s38, 0x200
    v_mad_u32_u24 v7, v14, s38, v7
    v_bfe_u32 v14, v0, 6, 1
    s_mov_b32 s38, 0x8000
    v_mad_u32_u24 v7, v14, s38, v7
    v_bfe_u32 v14, v0, 7, 1
    s_mov_b32 s38, 0x10000
    v_mad_u32_u24 v7, v14, s38, v7
    v_mov_b32 v3, 0x0
    v_bfe_u32 v14, v0, 0, 1
    s_mov_b32 s38, 0x10
    v_mad_u32_u24 v3, v14, s38, v3
    v_bfe_u32 v14, v0, 1, 1
    s_mov_b32 s38, 0x20
    v_mad_u32_u24 v3, v14, s38, v3
    v_bfe_u32 v14, v0, 2, 1
    s_mov_b32 s38, 0x40
    v_mad_u32_u24 v3, v14, s38, v3
    v_bfe_u32 v14, v0, 3, 1
    s_mov_b32 s38, 0x400
    v_mad_u32_u24 v3, v14, s38, v3
    v_bfe_u32 v14, v0, 4, 1
    s_mov_b32 s38, 0x800
    v_mad_u32_u24 v3, v14, s38, v3
    v_bfe_u32 v14, v0, 5, 1
    s_mov_b32 s38, 0x1000
    v_mad_u32_u24 v3, v14, s38, v3
    v_bfe_u32 v14, v0, 6, 1
    s_mov_b32 s38, 0x2000
    v_mad_u32_u24 v3, v14, s38, v3
    v_bfe_u32 v14, v0, 7, 1
    s_mov_b32 s38, 0x4000
    v_mad_u32_u24 v3, v14, s38, v3
    v_mov_b32 v4, 0x0
    v_bfe_u32 v14, v0, 0, 1
    s_mov_b32 s38, 0x100
    v_mad_u32_u24 v4, v14, s38, v4
    v_bfe_u32 v14, v0, 1, 1
    s_mov_b32 s38, 0x200
    v_mad_u32_u24 v4, v14, s38, v4
    v_bfe_u32 v14, v0, 2, 1
    s_mov_b32 s38, 0x400
    v_mad_u32_u24 v4, v14, s38, v4
    v_bfe_u32 v14, v0, 6, 1
    s_mov_b32 s38, 0x80
    v_mad_u32_u24 v4, v14, s38, v4
    v_bfe_u32 v14, v0, 7, 1
    s_mov_b32 s38, 0x4000
    v_mad_u32_u24 v4, v14, s38, v4
    v_lshrrev_b32 v15, 3, v0
    v_xor_b32 v15, v15, v0
    v_and_b32 v15, 7, v15
    v_lshl_add_u32 v4, v15, 4, v4
    v_bfe_u32 v15, v0, 4, 2
    v_lshlrev_b32 v15, 4, v15
    v_xor_b32 v5, v15, v1
    v_xor_b32 v6, 64, v5
    v_mov_b32 v8, 0x5000
    v_bfe_u32 v14, v0, 0, 1
    s_mov_b32 s38, 0x10
    v_mad_u32_u24 v8, v14, s38, v8
    v_bfe_u32 v14, v0, 1, 1
    s_mov_b32 s38, 0x40
    v_mad_u32_u24 v8, v14, s38, v8
    v_bfe_u32 v14, v0, 2, 1
    s_mov_b32 s38, 0x80
    v_mad_u32_u24 v8, v14, s38, v8
    v_bfe_u32 v14, v0, 4, 1
    s_mov_b32 s38, 0x20
    v_mad_u32_u24 v8, v14, s38, v8
    v_bfe_u32 v14, v0, 5, 1
    s_mov_b32 s38, 0x100
    v_mad_u32_u24 v8, v14, s38, v8
    v_mov_b32 v10, 0x0
    v_bfe_u32 v14, v0, 0, 1
    s_mov_b32 s38, 0x10
    v_mad_u32_u24 v10, v14, s38, v10
    v_bfe_u32 v14, v0, 1, 1
    s_mov_b32 s38, 0x20
    v_mad_u32_u24 v10, v14, s38, v10
    v_bfe_u32 v14, v0, 2, 1
    s_mov_b32 s38, 0x40
    v_mad_u32_u24 v10, v14, s38, v10
    v_bfe_u32 v14, v0, 3, 1
    s_mov_b32 s38, 0x80
    v_mad_u32_u24 v10, v14, s38, v10
    v_bfe_u32 v14, v0, 4, 1
    s_mov_b32 s38, 0x20000
    v_mad_u32_u24 v10, v14, s38, v10
    v_bfe_u32 v14, v0, 5, 1
    s_mov_b32 s38, 0x40000
    v_mad_u32_u24 v10, v14, s38, v10
    v_bfe_u32 v14, v0, 6, 1
    s_mov_b32 s38, 0x100
    v_mad_u32_u24 v10, v14, s38, v10
    v_bfe_u32 v14, v0, 7, 1
    s_mov_b32 s38, 0x200
    v_mad_u32_u24 v10, v14, s38, v10
    v_mov_b32 v11, 0x0
    v_bfe_u32 v14, v0, 0, 1
    s_mov_b32 s38, 0x10
    v_mad_u32_u24 v11, v14, s38, v11
    v_bfe_u32 v14, v0, 1, 1
    s_mov_b32 s38, 0x20
    v_mad_u32_u24 v11, v14, s38, v11
    v_bfe_u32 v14, v0, 2, 1
    s_mov_b32 s38, 0x40
    v_mad_u32_u24 v11, v14, s38, v11
    v_bfe_u32 v14, v0, 3, 1
    s_mov_b32 s38, 0x80
    v_mad_u32_u24 v11, v14, s38, v11
    v_bfe_u32 v14, v0, 4, 1
    s_mov_b32 s38, 0x400
    v_mad_u32_u24 v11, v14, s38, v11
    v_bfe_u32 v14, v0, 5, 1
    s_mov_b32 s38, 0x800
    v_mad_u32_u24 v11, v14, s38, v11
    v_bfe_u32 v14, v0, 6, 1
    s_mov_b32 s38, 0x100
    v_mad_u32_u24 v11, v14, s38, v11
    v_bfe_u32 v14, v0, 7, 1
    s_mov_b32 s38, 0x200
    v_mad_u32_u24 v11, v14, s38, v11
    v_mov_b32 v12, 0x0
    v_bfe_u32 v14, v0, 0, 1
    s_mov_b32 s38, 0x10
    v_mad_u32_u24 v12, v14, s38, v12
    v_bfe_u32 v14, v0, 1, 1
    s_mov_b32 s38, 0x20
    v_mad_u32_u24 v12, v14, s38, v12
    v_bfe_u32 v14, v0, 2, 1
    s_mov_b32 s38, 0x40
    v_mad_u32_u24 v12, v14, s38, v12
    v_bfe_u32 v14, v0, 3, 1
    s_mov_b32 s38, 0x80
    v_mad_u32_u24 v12, v14, s38, v12
    v_bfe_u32 v14, v0, 4, 1
    s_mov_b32 s38, 0x4
    v_mad_u32_u24 v12, v14, s38, v12
    v_bfe_u32 v14, v0, 5, 1
    s_mov_b32 s38, 0x8
    v_mad_u32_u24 v12, v14, s38, v12
    v_bfe_u32 v14, v0, 6, 1
    s_mov_b32 s38, 0x100
    v_mad_u32_u24 v12, v14, s38, v12
    v_bfe_u32 v14, v0, 7, 1
    s_mov_b32 s38, 0x200
    v_mad_u32_u24 v12, v14, s38, v12
    v_mov_b32 v13, 0xf149f2ca
    v_and_b32 v14, 15, v0
    v_bfe_u32 v15, v0, 4, 2
    v_cmp_gt_u32 s[72:73], 2, v15
    v_lshlrev_b32 v15, 2, v15
    v_cmp_le_u32 s[64:65], v15, v14
    v_add_u32 v15, 1, v15
    v_cmp_le_u32 s[66:67], v15, v14
    v_add_u32 v15, 1, v15
    v_cmp_le_u32 s[68:69], v15, v14
    v_add_u32 v15, 1, v15
    v_cmp_le_u32 s[70:71], v15, v14
    v_add_u32 v15, 1, v15
    s_mov_b32 s34, 0x05040100
    s_mov_b32 s35, 0x07060302
    s_mov_b32 s33, 0x3e0293ee
    s_mov_b32 s32, 0
    s_mov_b32 s4, 0x3f803f80
    s_mov_b32 s5, 0x3f803f80
    s_lshr_b32 s20, s2, 3
    s_lshr_b32 s23, s2, 3
    s_lshl_b32 s23, s23, 1
    s_lshl_b32 s36, s23, 15
    buffer_load_dwordx4 v[96:99], v3, s[12:15], s36 offen offset:0
    buffer_load_dwordx4 v[100:103], v3, s[12:15], s36 offen offset:128
    buffer_load_dwordx4 v[104:107], v3, s[12:15], s36 offen offset:256
    buffer_load_dwordx4 v[108:111], v3, s[12:15], s36 offen offset:384
    buffer_load_dwordx4 v[112:115], v3, s[12:15], s36 offen offset:512
    buffer_load_dwordx4 v[116:119], v3, s[12:15], s36 offen offset:640
    buffer_load_dwordx4 v[120:123], v3, s[12:15], s36 offen offset:768
    buffer_load_dwordx4 v[124:127], v3, s[12:15], s36 offen offset:896
    s_add_u32 s36, s36, 0x8000
    buffer_load_dwordx4 v[128:131], v3, s[12:15], s36 offen offset:0
    buffer_load_dwordx4 v[132:135], v3, s[12:15], s36 offen offset:128
    buffer_load_dwordx4 v[136:139], v3, s[12:15], s36 offen offset:256
    buffer_load_dwordx4 v[140:143], v3, s[12:15], s36 offen offset:384
    buffer_load_dwordx4 v[144:147], v3, s[12:15], s36 offen offset:512
    buffer_load_dwordx4 v[148:151], v3, s[12:15], s36 offen offset:640
    buffer_load_dwordx4 v[152:155], v3, s[12:15], s36 offen offset:768
    buffer_load_dwordx4 v[156:159], v3, s[12:15], s36 offen offset:896
    s_mov_b32 s96, s46
    s_and_b32 s97, s47, 0xffff
    s_mov_b32 s98, 0x2000
    s_mov_b32 s99, 0x20000
    v_mov_b32 v68, 0x0
    v_bfe_u32 v14, v0, 0, 1
    s_mov_b32 s38, 0x8
    v_mad_u32_u24 v68, v14, s38, v68
    v_bfe_u32 v14, v0, 1, 1
    s_mov_b32 s38, 0x10
    v_mad_u32_u24 v68, v14, s38, v68
    v_bfe_u32 v14, v0, 2, 1
    s_mov_b32 s38, 0x10000
    v_mad_u32_u24 v68, v14, s38, v68
    v_bfe_u32 v14, v0, 3, 1
    s_mov_b32 s38, 0x10000
    v_mad_u32_u24 v68, v14, s38, v68
    v_bfe_u32 v14, v0, 4, 1
    s_mov_b32 s38, 0x400
    v_mad_u32_u24 v68, v14, s38, v68
    v_bfe_u32 v14, v0, 5, 1
    s_mov_b32 s38, 0x4
    v_mad_u32_u24 v68, v14, s38, v68
    v_bfe_u32 v14, v0, 6, 1
    s_mov_b32 s38, 0x40
    v_mad_u32_u24 v68, v14, s38, v68
    v_bfe_u32 v14, v0, 7, 1
    s_mov_b32 s38, 0x80
    v_mad_u32_u24 v68, v14, s38, v68
    v_mov_b32 v70, s20
    v_mov_b32 v69, 0x0
    v_bfe_u32 v14, v70, 0, 1
    s_mov_b32 s38, 0x20
    v_mad_u32_u24 v69, v14, s38, v69
    v_bfe_u32 v14, v70, 1, 1
    s_mov_b32 s38, 0x800
    v_mad_u32_u24 v69, v14, s38, v69
    v_bfe_u32 v14, v70, 2, 1
    s_mov_b32 s38, 0x1000
    v_mad_u32_u24 v69, v14, s38, v69
    v_bfe_u32 v14, v70, 3, 1
    s_mov_b32 s38, 0x100
    v_mad_u32_u24 v69, v14, s38, v69
    v_bfe_u32 v14, v70, 4, 1
    s_mov_b32 s38, 0x200
    v_mad_u32_u24 v69, v14, s38, v69
    v_add_u32 v68, v68, v69
    buffer_load_dword v72, v68, s[96:99], 0 offen
    v_mov_b32 v64, -1
    v_mov_b32 v65, -1
    v_mov_b32 v66, -1
    v_mov_b32 v67, -1
    s_lshl_b32 s36, s20, 13
    s_add_u32 s36, s36, 0x0
    buffer_store_dwordx4 v[64:67], v2, s[8:11], s36 offen sc1
    buffer_store_dwordx4 v[64:67], v2, s[8:11], s36 offen offset:1024 sc1
    s_lshl_b32 s36, s20, 14
    s_add_u32 s36, s36, 0x100000
    s_add_u32 s37, s36, 0x2000
    buffer_store_dwordx4 v[64:67], v2, s[8:11], s36 offen sc1
    buffer_store_dwordx4 v[64:67], v2, s[8:11], s36 offen offset:1024 sc1
    buffer_store_dwordx4 v[64:67], v2, s[8:11], s37 offen sc1
    buffer_store_dwordx4 v[64:67], v2, s[8:11], s37 offen offset:1024 sc1
    s_mul_i32 s36, s20, 0x104200
    s_add_u32 s36, s36, 0x1102100
    s_add_u32 s37, s36, 0x82100
    buffer_store_dwordx4 v[64:67], v2, s[8:11], s36 offen sc1
    buffer_store_dwordx4 v[64:67], v2, s[8:11], s36 offen offset:1024 sc1
    buffer_store_dwordx4 v[64:67], v2, s[8:11], s37 offen sc1
    buffer_store_dwordx4 v[64:67], v2, s[8:11], s37 offen offset:1024 sc1
    v_lshlrev_b32 v68, 2, v0
    s_lshl_b32 s36, s20, 10
    s_add_u32 s37, s36, 0x194000
    buffer_store_dword v64, v68, s[8:11], s37 offen sc1
    s_add_u32 s37, s36, 0x1b0000
    buffer_store_dword v64, v68, s[8:11], s37 offen sc1
    s_add_u32 s37, s36, 0x1b8000
    buffer_store_dword v64, v68, s[8:11], s37 offen sc1
    v_mov_b32 v69, 0x40000000
    v_cmp_lt_u32 vcc, 63, v0
    s_nop 1
    v_cndmask_b32 v68, v68, v69, vcc
    v_mov_b32 v73, 0
    s_lshl_b32 s36, s20, 8
    s_add_u32 s37, s36, 0x192000
    buffer_store_dword v73, v68, s[8:11], s37 offen sc1
    s_mul_i32 s36, s20, 0x104200
    s_add_u32 s36, s36, 0x1082000
    s_add_u32 s37, s36, 0x82100
    buffer_store_dword v73, v68, s[8:11], s36 offen sc1
    buffer_store_dword v73, v68, s[8:11], s37 offen sc1
    v_mov_b32 v71, 0x80000
    v_bfe_u32 v14, v0, 0, 1
    s_mov_b32 s38, 0x8
    v_mad_u32_u24 v71, v14, s38, v71
    v_bfe_u32 v14, v0, 1, 1
    s_mov_b32 s38, 0x20
    v_mad_u32_u24 v71, v14, s38, v71
    v_bfe_u32 v14, v0, 4, 1
    s_mov_b32 s38, 0x10
    v_mad_u32_u24 v71, v14, s38, v71
    v_bfe_u32 v14, v0, 5, 1
    s_mov_b32 s38, 0x4
    v_mad_u32_u24 v71, v14, s38, v71
    v_bfe_u32 v14, v0, 6, 1
    s_mov_b32 s38, 0x800
    v_mad_u32_u24 v71, v14, s38, v71
    v_bfe_u32 v14, v0, 7, 1
    s_mov_b32 s38, 0x1000
    v_mad_u32_u24 v71, v14, s38, v71
    v_mov_b32 v69, s20
    v_mov_b32 v68, 0x0
    v_bfe_u32 v14, v69, 0, 1
    s_mov_b32 s38, 0x100
    v_mad_u32_u24 v68, v14, s38, v68
    v_bfe_u32 v14, v69, 1, 1
    s_mov_b32 s38, 0x40
    v_mad_u32_u24 v68, v14, s38, v68
    v_bfe_u32 v14, v69, 2, 1
    s_mov_b32 s38, 0x80
    v_mad_u32_u24 v68, v14, s38, v68
    v_bfe_u32 v14, v69, 3, 1
    s_mov_b32 s38, 0x200
    v_mad_u32_u24 v68, v14, s38, v68
    v_bfe_u32 v14, v69, 4, 1
    s_mov_b32 s38, 0x400
    v_mad_u32_u24 v68, v14, s38, v68
    v_add_u32 v71, v68, v71
    v_and_b32 v68, 12, v0
    v_cmp_ne_u32 vcc, 0, v68
    v_mov_b32 v68, 0x40000000
    s_nop 0
    v_cndmask_b32 v71, v71, v68, vcc
    s_waitcnt vmcnt(16)
    s_mov_b32 s36, 0x1000000
    buffer_store_dword v72, v71, s[8:11], s36 offen sc1
L_XN:
    v_mov_b32 v88, 0
    v_mov_b32 v89, 0
    v_dot2_f32_bf16 v88, v96, s4, v88
    v_dot2_f32_bf16 v89, v96, v96, v89
    v_dot2_f32_bf16 v88, v97, s4, v88
    v_dot2_f32_bf16 v89, v97, v97, v89
    v_dot2_f32_bf16 v88, v98, s4, v88
    v_dot2_f32_bf16 v89, v98, v98, v89
    v_dot2_f32_bf16 v88, v99, s4, v88
    v_dot2_f32_bf16 v89, v99, v99, v89
    v_dot2_f32_bf16 v88, v100, s4, v88
    v_dot2_f32_bf16 v89, v100, v100, v89
    v_dot2_f32_bf16 v88, v101, s4, v88
    v_dot2_f32_bf16 v89, v101, v101, v89
    v_dot2_f32_bf16 v88, v102, s4, v88
    v_dot2_f32_bf16 v89, v102, v102, v89
    v_dot2_f32_bf16 v88, v103, s4, v88
    v_dot2_f32_bf16 v89, v103, v103, v89
    v_dot2_f32_bf16 v88, v104, s4, v88
    v_dot2_f32_bf16 v89, v104, v104, v89
    v_dot2_f32_bf16 v88, v105, s4, v88
    v_dot2_f32_bf16 v89, v105, v105, v89
    v_dot2_f32_bf16 v88, v106, s4, v88
    v_dot2_f32_bf16 v89, v106, v106, v89
    v_dot2_f32_bf16 v88, v107, s4, v88
    v_dot2_f32_bf16 v89, v107, v107, v89
    v_dot2_f32_bf16 v88, v108, s4, v88
    v_dot2_f32_bf16 v89, v108, v108, v89
    v_dot2_f32_bf16 v88, v109, s4, v88
    v_dot2_f32_bf16 v89, v109, v109, v89
    v_dot2_f32_bf16 v88, v110, s4, v88
    v_dot2_f32_bf16 v89, v110, v110, v89
    v_dot2_f32_bf16 v88, v111, s4, v88
    v_dot2_f32_bf16 v89, v111, v111, v89
    v_dot2_f32_bf16 v88, v112, s4, v88
    v_dot2_f32_bf16 v89, v112, v112, v89
    v_dot2_f32_bf16 v88, v113, s4, v88
    v_dot2_f32_bf16 v89, v113, v113, v89
    v_dot2_f32_bf16 v88, v114, s4, v88
    v_dot2_f32_bf16 v89, v114, v114, v89
    v_dot2_f32_bf16 v88, v115, s4, v88
    v_dot2_f32_bf16 v89, v115, v115, v89
    v_dot2_f32_bf16 v88, v116, s4, v88
    v_dot2_f32_bf16 v89, v116, v116, v89
    v_dot2_f32_bf16 v88, v117, s4, v88
    v_dot2_f32_bf16 v89, v117, v117, v89
    v_dot2_f32_bf16 v88, v118, s4, v88
    v_dot2_f32_bf16 v89, v118, v118, v89
    v_dot2_f32_bf16 v88, v119, s4, v88
    v_dot2_f32_bf16 v89, v119, v119, v89
    v_dot2_f32_bf16 v88, v120, s4, v88
    v_dot2_f32_bf16 v89, v120, v120, v89
    v_dot2_f32_bf16 v88, v121, s4, v88
    v_dot2_f32_bf16 v89, v121, v121, v89
    v_dot2_f32_bf16 v88, v122, s4, v88
    v_dot2_f32_bf16 v89, v122, v122, v89
    v_dot2_f32_bf16 v88, v123, s4, v88
    v_dot2_f32_bf16 v89, v123, v123, v89
    v_dot2_f32_bf16 v88, v124, s4, v88
    v_dot2_f32_bf16 v89, v124, v124, v89
    v_dot2_f32_bf16 v88, v125, s4, v88
    v_dot2_f32_bf16 v89, v125, v125, v89
    v_dot2_f32_bf16 v88, v126, s4, v88
    v_dot2_f32_bf16 v89, v126, v126, v89
    v_dot2_f32_bf16 v88, v127, s4, v88
    v_dot2_f32_bf16 v89, v127, v127, v89
    s_nop 3
    v_add_f32_dpp v88, v88, v88 quad_perm:[1,0,3,2] row_mask:0xf bank_mask:0xf
    v_add_f32_dpp v89, v89, v89 quad_perm:[1,0,3,2] row_mask:0xf bank_mask:0xf
    s_nop 0
    v_add_f32_dpp v88, v88, v88 quad_perm:[2,3,0,1] row_mask:0xf bank_mask:0xf
    v_add_f32_dpp v89, v89, v89 quad_perm:[2,3,0,1] row_mask:0xf bank_mask:0xf
    s_nop 0
    v_add_f32_dpp v88, v88, v88 row_half_mirror row_mask:0xf bank_mask:0xf
    v_add_f32_dpp v89, v89, v89 row_half_mirror row_mask:0xf bank_mask:0xf
    v_mul_f32 v88, 0x3b000000, v88
    v_mul_f32 v89, 0x3b000000, v89
    v_fma_f32 v89, -v88, v88, v89
    v_max_f32 v89, 0, v89
    v_cvt_pk_bf16_f32 v14, v88, v89
    v_lshlrev_b32 v88, 16, v14
    v_and_b32 v89, 0xffff0000, v14
    v_add_f32 v89, 0x3727c5ac, v89
    v_cvt_pk_bf16_f32 v14, v89, v89
    v_lshlrev_b32 v89, 16, v14
    v_sqrt_f32 v89, v89
    s_nop 0
    v_cvt_pk_bf16_f32 v14, v89, v89
    v_lshlrev_b32 v89, 16, v14
    v_rcp_f32 v89, v89
    v_lshlrev_b32 v90, 16, v96
    v_and_b32 v91, 0xffff0000, v96
    v_sub_f32 v90, v90, v88
    v_sub_f32 v91, v91, v88
    v_cvt_pk_bf16_f32 v96, v90, v91
    v_lshlrev_b32 v90, 16, v96
    v_and_b32 v91, 0xffff0000, v96
    v_mul_f32 v90, v90, v89
    v_mul_f32 v91, v91, v89
    v_cvt_pk_bf16_f32 v96, v90, v91
    v_lshlrev_b32 v90, 16, v97
    v_and_b32 v91, 0xffff0000, v97
    v_sub_f32 v90, v90, v88
    v_sub_f32 v91, v91, v88
    v_cvt_pk_bf16_f32 v97, v90, v91
    v_lshlrev_b32 v90, 16, v97
    v_and_b32 v91, 0xffff0000, v97
    v_mul_f32 v90, v90, v89
    v_mul_f32 v91, v91, v89
    v_cvt_pk_bf16_f32 v97, v90, v91
    v_lshlrev_b32 v90, 16, v98
    v_and_b32 v91, 0xffff0000, v98
    v_sub_f32 v90, v90, v88
    v_sub_f32 v91, v91, v88
    v_cvt_pk_bf16_f32 v98, v90, v91
    v_lshlrev_b32 v90, 16, v98
    v_and_b32 v91, 0xffff0000, v98
    v_mul_f32 v90, v90, v89
    v_mul_f32 v91, v91, v89
    v_cvt_pk_bf16_f32 v98, v90, v91
    v_lshlrev_b32 v90, 16, v99
    v_and_b32 v91, 0xffff0000, v99
    v_sub_f32 v90, v90, v88
    v_sub_f32 v91, v91, v88
    v_cvt_pk_bf16_f32 v99, v90, v91
    v_lshlrev_b32 v90, 16, v99
    v_and_b32 v91, 0xffff0000, v99
    v_mul_f32 v90, v90, v89
    v_mul_f32 v91, v91, v89
    v_cvt_pk_bf16_f32 v99, v90, v91
    ds_write_b128 v4, v[96:99] offset:0
    v_lshlrev_b32 v90, 16, v100
    v_and_b32 v91, 0xffff0000, v100
    v_sub_f32 v90, v90, v88
    v_sub_f32 v91, v91, v88
    v_cvt_pk_bf16_f32 v100, v90, v91
    v_lshlrev_b32 v90, 16, v100
    v_and_b32 v91, 0xffff0000, v100
    v_mul_f32 v90, v90, v89
    v_mul_f32 v91, v91, v89
    v_cvt_pk_bf16_f32 v100, v90, v91
    v_lshlrev_b32 v90, 16, v101
    v_and_b32 v91, 0xffff0000, v101
    v_sub_f32 v90, v90, v88
    v_sub_f32 v91, v91, v88
    v_cvt_pk_bf16_f32 v101, v90, v91
    v_lshlrev_b32 v90, 16, v101
    v_and_b32 v91, 0xffff0000, v101
    v_mul_f32 v90, v90, v89
    v_mul_f32 v91, v91, v89
    v_cvt_pk_bf16_f32 v101, v90, v91
    v_lshlrev_b32 v90, 16, v102
    v_and_b32 v91, 0xffff0000, v102
    v_sub_f32 v90, v90, v88
    v_sub_f32 v91, v91, v88
    v_cvt_pk_bf16_f32 v102, v90, v91
    v_lshlrev_b32 v90, 16, v102
    v_and_b32 v91, 0xffff0000, v102
    v_mul_f32 v90, v90, v89
    v_mul_f32 v91, v91, v89
    v_cvt_pk_bf16_f32 v102, v90, v91
    v_lshlrev_b32 v90, 16, v103
    v_and_b32 v91, 0xffff0000, v103
    v_sub_f32 v90, v90, v88
    v_sub_f32 v91, v91, v88
    v_cvt_pk_bf16_f32 v103, v90, v91
    v_lshlrev_b32 v90, 16, v103
    v_and_b32 v91, 0xffff0000, v103
    v_mul_f32 v90, v90, v89
    v_mul_f32 v91, v91, v89
    v_cvt_pk_bf16_f32 v103, v90, v91
    ds_write_b128 v4, v[100:103] offset:2048
    v_lshlrev_b32 v90, 16, v104
    v_and_b32 v91, 0xffff0000, v104
    v_sub_f32 v90, v90, v88
    v_sub_f32 v91, v91, v88
    v_cvt_pk_bf16_f32 v104, v90, v91
    v_lshlrev_b32 v90, 16, v104
    v_and_b32 v91, 0xffff0000, v104
    v_mul_f32 v90, v90, v89
    v_mul_f32 v91, v91, v89
    v_cvt_pk_bf16_f32 v104, v90, v91
    v_lshlrev_b32 v90, 16, v105
    v_and_b32 v91, 0xffff0000, v105
    v_sub_f32 v90, v90, v88
    v_sub_f32 v91, v91, v88
    v_cvt_pk_bf16_f32 v105, v90, v91
    v_lshlrev_b32 v90, 16, v105
    v_and_b32 v91, 0xffff0000, v105
    v_mul_f32 v90, v90, v89
    v_mul_f32 v91, v91, v89
    v_cvt_pk_bf16_f32 v105, v90, v91
    v_lshlrev_b32 v90, 16, v106
    v_and_b32 v91, 0xffff0000, v106
    v_sub_f32 v90, v90, v88
    v_sub_f32 v91, v91, v88
    v_cvt_pk_bf16_f32 v106, v90, v91
    v_lshlrev_b32 v90, 16, v106
    v_and_b32 v91, 0xffff0000, v106
    v_mul_f32 v90, v90, v89
    v_mul_f32 v91, v91, v89
    v_cvt_pk_bf16_f32 v106, v90, v91
    v_lshlrev_b32 v90, 16, v107
    v_and_b32 v91, 0xffff0000, v107
    v_sub_f32 v90, v90, v88
    v_sub_f32 v91, v91, v88
    v_cvt_pk_bf16_f32 v107, v90, v91
    v_lshlrev_b32 v90, 16, v107
    v_and_b32 v91, 0xffff0000, v107
    v_mul_f32 v90, v90, v89
    v_mul_f32 v91, v91, v89
    v_cvt_pk_bf16_f32 v107, v90, v91
    ds_write_b128 v4, v[104:107] offset:4096
    v_lshlrev_b32 v90, 16, v108
    v_and_b32 v91, 0xffff0000, v108
    v_sub_f32 v90, v90, v88
    v_sub_f32 v91, v91, v88
    v_cvt_pk_bf16_f32 v108, v90, v91
    v_lshlrev_b32 v90, 16, v108
    v_and_b32 v91, 0xffff0000, v108
    v_mul_f32 v90, v90, v89
    v_mul_f32 v91, v91, v89
    v_cvt_pk_bf16_f32 v108, v90, v91
    v_lshlrev_b32 v90, 16, v109
    v_and_b32 v91, 0xffff0000, v109
    v_sub_f32 v90, v90, v88
    v_sub_f32 v91, v91, v88
    v_cvt_pk_bf16_f32 v109, v90, v91
    v_lshlrev_b32 v90, 16, v109
    v_and_b32 v91, 0xffff0000, v109
    v_mul_f32 v90, v90, v89
    v_mul_f32 v91, v91, v89
    v_cvt_pk_bf16_f32 v109, v90, v91
    v_lshlrev_b32 v90, 16, v110
    v_and_b32 v91, 0xffff0000, v110
    v_sub_f32 v90, v90, v88
    v_sub_f32 v91, v91, v88
    v_cvt_pk_bf16_f32 v110, v90, v91
    v_lshlrev_b32 v90, 16, v110
    v_and_b32 v91, 0xffff0000, v110
    v_mul_f32 v90, v90, v89
    v_mul_f32 v91, v91, v89
    v_cvt_pk_bf16_f32 v110, v90, v91
    v_lshlrev_b32 v90, 16, v111
    v_and_b32 v91, 0xffff0000, v111
    v_sub_f32 v90, v90, v88
    v_sub_f32 v91, v91, v88
    v_cvt_pk_bf16_f32 v111, v90, v91
    v_lshlrev_b32 v90, 16, v111
    v_and_b32 v91, 0xffff0000, v111
    v_mul_f32 v90, v90, v89
    v_mul_f32 v91, v91, v89
    v_cvt_pk_bf16_f32 v111, v90, v91
    ds_write_b128 v4, v[108:111] offset:6144
    v_lshlrev_b32 v90, 16, v112
    v_and_b32 v91, 0xffff0000, v112
    v_sub_f32 v90, v90, v88
    v_sub_f32 v91, v91, v88
    v_cvt_pk_bf16_f32 v112, v90, v91
    v_lshlrev_b32 v90, 16, v112
    v_and_b32 v91, 0xffff0000, v112
    v_mul_f32 v90, v90, v89
    v_mul_f32 v91, v91, v89
    v_cvt_pk_bf16_f32 v112, v90, v91
    v_lshlrev_b32 v90, 16, v113
    v_and_b32 v91, 0xffff0000, v113
    v_sub_f32 v90, v90, v88
    v_sub_f32 v91, v91, v88
    v_cvt_pk_bf16_f32 v113, v90, v91
    v_lshlrev_b32 v90, 16, v113
    v_and_b32 v91, 0xffff0000, v113
    v_mul_f32 v90, v90, v89
    v_mul_f32 v91, v91, v89
    v_cvt_pk_bf16_f32 v113, v90, v91
    v_lshlrev_b32 v90, 16, v114
    v_and_b32 v91, 0xffff0000, v114
    v_sub_f32 v90, v90, v88
    v_sub_f32 v91, v91, v88
    v_cvt_pk_bf16_f32 v114, v90, v91
    v_lshlrev_b32 v90, 16, v114
    v_and_b32 v91, 0xffff0000, v114
    v_mul_f32 v90, v90, v89
    v_mul_f32 v91, v91, v89
    v_cvt_pk_bf16_f32 v114, v90, v91
    v_lshlrev_b32 v90, 16, v115
    v_and_b32 v91, 0xffff0000, v115
    v_sub_f32 v90, v90, v88
    v_sub_f32 v91, v91, v88
    v_cvt_pk_bf16_f32 v115, v90, v91
    v_lshlrev_b32 v90, 16, v115
    v_and_b32 v91, 0xffff0000, v115
    v_mul_f32 v90, v90, v89
    v_mul_f32 v91, v91, v89
    v_cvt_pk_bf16_f32 v115, v90, v91
    ds_write_b128 v4, v[112:115] offset:8192
    v_lshlrev_b32 v90, 16, v116
    v_and_b32 v91, 0xffff0000, v116
    v_sub_f32 v90, v90, v88
    v_sub_f32 v91, v91, v88
    v_cvt_pk_bf16_f32 v116, v90, v91
    v_lshlrev_b32 v90, 16, v116
    v_and_b32 v91, 0xffff0000, v116
    v_mul_f32 v90, v90, v89
    v_mul_f32 v91, v91, v89
    v_cvt_pk_bf16_f32 v116, v90, v91
    v_lshlrev_b32 v90, 16, v117
    v_and_b32 v91, 0xffff0000, v117
    v_sub_f32 v90, v90, v88
    v_sub_f32 v91, v91, v88
    v_cvt_pk_bf16_f32 v117, v90, v91
    v_lshlrev_b32 v90, 16, v117
    v_and_b32 v91, 0xffff0000, v117
    v_mul_f32 v90, v90, v89
    v_mul_f32 v91, v91, v89
    v_cvt_pk_bf16_f32 v117, v90, v91
    v_lshlrev_b32 v90, 16, v118
    v_and_b32 v91, 0xffff0000, v118
    v_sub_f32 v90, v90, v88
    v_sub_f32 v91, v91, v88
    v_cvt_pk_bf16_f32 v118, v90, v91
    v_lshlrev_b32 v90, 16, v118
    v_and_b32 v91, 0xffff0000, v118
    v_mul_f32 v90, v90, v89
    v_mul_f32 v91, v91, v89
    v_cvt_pk_bf16_f32 v118, v90, v91
    v_lshlrev_b32 v90, 16, v119
    v_and_b32 v91, 0xffff0000, v119
    v_sub_f32 v90, v90, v88
    v_sub_f32 v91, v91, v88
    v_cvt_pk_bf16_f32 v119, v90, v91
    v_lshlrev_b32 v90, 16, v119
    v_and_b32 v91, 0xffff0000, v119
    v_mul_f32 v90, v90, v89
    v_mul_f32 v91, v91, v89
    v_cvt_pk_bf16_f32 v119, v90, v91
    ds_write_b128 v4, v[116:119] offset:10240
    v_lshlrev_b32 v90, 16, v120
    v_and_b32 v91, 0xffff0000, v120
    v_sub_f32 v90, v90, v88
    v_sub_f32 v91, v91, v88
    v_cvt_pk_bf16_f32 v120, v90, v91
    v_lshlrev_b32 v90, 16, v120
    v_and_b32 v91, 0xffff0000, v120
    v_mul_f32 v90, v90, v89
    v_mul_f32 v91, v91, v89
    v_cvt_pk_bf16_f32 v120, v90, v91
    v_lshlrev_b32 v90, 16, v121
    v_and_b32 v91, 0xffff0000, v121
    v_sub_f32 v90, v90, v88
    v_sub_f32 v91, v91, v88
    v_cvt_pk_bf16_f32 v121, v90, v91
    v_lshlrev_b32 v90, 16, v121
    v_and_b32 v91, 0xffff0000, v121
    v_mul_f32 v90, v90, v89
    v_mul_f32 v91, v91, v89
    v_cvt_pk_bf16_f32 v121, v90, v91
    v_lshlrev_b32 v90, 16, v122
    v_and_b32 v91, 0xffff0000, v122
    v_sub_f32 v90, v90, v88
    v_sub_f32 v91, v91, v88
    v_cvt_pk_bf16_f32 v122, v90, v91
    v_lshlrev_b32 v90, 16, v122
    v_and_b32 v91, 0xffff0000, v122
    v_mul_f32 v90, v90, v89
    v_mul_f32 v91, v91, v89
    v_cvt_pk_bf16_f32 v122, v90, v91
    v_lshlrev_b32 v90, 16, v123
    v_and_b32 v91, 0xffff0000, v123
    v_sub_f32 v90, v90, v88
    v_sub_f32 v91, v91, v88
    v_cvt_pk_bf16_f32 v123, v90, v91
    v_lshlrev_b32 v90, 16, v123
    v_and_b32 v91, 0xffff0000, v123
    v_mul_f32 v90, v90, v89
    v_mul_f32 v91, v91, v89
    v_cvt_pk_bf16_f32 v123, v90, v91
    ds_write_b128 v4, v[120:123] offset:12288
    v_lshlrev_b32 v90, 16, v124
    v_and_b32 v91, 0xffff0000, v124
    v_sub_f32 v90, v90, v88
    v_sub_f32 v91, v91, v88
    v_cvt_pk_bf16_f32 v124, v90, v91
    v_lshlrev_b32 v90, 16, v124
    v_and_b32 v91, 0xffff0000, v124
    v_mul_f32 v90, v90, v89
    v_mul_f32 v91, v91, v89
    v_cvt_pk_bf16_f32 v124, v90, v91
    v_lshlrev_b32 v90, 16, v125
    v_and_b32 v91, 0xffff0000, v125
    v_sub_f32 v90, v90, v88
    v_sub_f32 v91, v91, v88
    v_cvt_pk_bf16_f32 v125, v90, v91
    v_lshlrev_b32 v90, 16, v125
    v_and_b32 v91, 0xffff0000, v125
    v_mul_f32 v90, v90, v89
    v_mul_f32 v91, v91, v89
    v_cvt_pk_bf16_f32 v125, v90, v91
    v_lshlrev_b32 v90, 16, v126
    v_and_b32 v91, 0xffff0000, v126
    v_sub_f32 v90, v90, v88
    v_sub_f32 v91, v91, v88
    v_cvt_pk_bf16_f32 v126, v90, v91
    v_lshlrev_b32 v90, 16, v126
    v_and_b32 v91, 0xffff0000, v126
    v_mul_f32 v90, v90, v89
    v_mul_f32 v91, v91, v89
    v_cvt_pk_bf16_f32 v126, v90, v91
    v_lshlrev_b32 v90, 16, v127
    v_and_b32 v91, 0xffff0000, v127
    v_sub_f32 v90, v90, v88
    v_sub_f32 v91, v91, v88
    v_cvt_pk_bf16_f32 v127, v90, v91
    v_lshlrev_b32 v90, 16, v127
    v_and_b32 v91, 0xffff0000, v127
    v_mul_f32 v90, v90, v89
    v_mul_f32 v91, v91, v89
    v_cvt_pk_bf16_f32 v127, v90, v91
    ds_write_b128 v4, v[124:127] offset:14336
    s_waitcnt lgkmcnt(0)
    s_barrier
    s_lshl_b32 s24, s23, 15
    s_add_u32 s24, s24, 0x800000
    ds_read_b128 v[24:27], v9 offset:0
    ds_read_b128 v[28:31], v9 offset:4096
    ds_read_b128 v[32:35], v9 offset:8192
    ds_read_b128 v[36:39], v9 offset:12288
    ds_read_b128 v[40:43], v9 offset:16384
    ds_read_b128 v[44:47], v9 offset:20480
    ds_read_b128 v[48:51], v9 offset:24576
    ds_read_b128 v[52:55], v9 offset:28672
    s_waitcnt lgkmcnt(7)
    s_add_u32 s36, s24, 0
    buffer_store_dwordx4 v[24:27], v9, s[8:11], s36 offen sc1
    s_waitcnt lgkmcnt(6)
    s_add_u32 s36, s24, 4096
    buffer_store_dwordx4 v[28:31], v9, s[8:11], s36 offen sc1
    s_waitcnt lgkmcnt(5)
    s_add_u32 s36, s24, 8192
    buffer_store_dwordx4 v[32:35], v9, s[8:11], s36 offen sc1
    s_waitcnt lgkmcnt(4)
    s_add_u32 s36, s24, 12288
    buffer_store_dwordx4 v[36:39], v9, s[8:11], s36 offen sc1
    s_waitcnt lgkmcnt(3)
    s_add_u32 s36, s24, 16384
    buffer_store_dwordx4 v[40:43], v9, s[8:11], s36 offen sc1
    s_waitcnt lgkmcnt(2)
    s_add_u32 s36, s24, 20480
    buffer_store_dwordx4 v[44:47], v9, s[8:11], s36 offen sc1
    s_waitcnt lgkmcnt(1)
    s_add_u32 s36, s24, 24576
    buffer_store_dwordx4 v[48:51], v9, s[8:11], s36 offen sc1
    s_waitcnt lgkmcnt(0)
    s_add_u32 s36, s24, 28672
    buffer_store_dwordx4 v[52:55], v9, s[8:11], s36 offen sc1
    s_barrier
    v_mov_b64 v[96:97], v[128:129]
    v_mov_b64 v[98:99], v[130:131]
    v_mov_b64 v[100:101], v[132:133]
    v_mov_b64 v[102:103], v[134:135]
    v_mov_b64 v[104:105], v[136:137]
    v_mov_b64 v[106:107], v[138:139]
    v_mov_b64 v[108:109], v[140:141]
    v_mov_b64 v[110:111], v[142:143]
    v_mov_b64 v[112:113], v[144:145]
    v_mov_b64 v[114:115], v[146:147]
    v_mov_b64 v[116:117], v[148:149]
    v_mov_b64 v[118:119], v[150:151]
    v_mov_b64 v[120:121], v[152:153]
    v_mov_b64 v[122:123], v[154:155]
    v_mov_b64 v[124:125], v[156:157]
    v_mov_b64 v[126:127], v[158:159]
    s_add_u32 s23, s23, 1
    s_bitcmp1_b32 s23, 0
    s_cbranch_scc1 L_XN
    s_waitcnt vmcnt(0)
    s_barrier
    v_mov_b32 v14, 1
    s_lshl_b32 s37, s20, 2
    v_lshlrev_b32 v15, 20, v0
    buffer_store_dword v14, v15, s[16:19], s37 offen sc1
    s_lshr_b32 s20, s2, 3
    s_mov_b32 s34, 0x05040100
    s_mov_b32 s35, 0x07060302
    s_mov_b32 s32, 0
    s_mov_b32 s64, s84
    s_and_b32 s65, s85, 0xffff
    s_mov_b32 s66, 0x1c0000
    s_mov_b32 s67, 0x20000
    s_mov_b32 s68, s86
    s_and_b32 s69, s87, 0xffff
    s_mov_b32 s70, 0x1c0000
    s_mov_b32 s71, 0x20000
    s_mov_b32 s76, s88
    s_and_b32 s77, s89, 0xffff
    s_mov_b32 s78, 0x1c0000
    s_mov_b32 s79, 0x20000
    v_and_b32 v3, 31, v0
    v_lshlrev_b32 v3, 2, v3
L_M_hs:
    buffer_load_dword v5, v3, s[16:19], 0 offen sc1
    s_add_u32 s32, s32, 1
    s_cmp_gt_u32 s32, 200000
    s_waitcnt vmcnt(0)
    s_cbranch_scc1 L_M_hs_ok
    v_cmp_eq_u32 vcc, 0, v5
    s_cbranch_vccz L_M_hs_ok
    s_sleep 16
    s_branch L_M_hs
L_M_hs_ok:
    v_lshlrev_b32 v3, 4, v0
L_M00_rp:
    s_mov_b32 s36, 0x194000
    buffer_load_dwordx4 v[16:19], v3, s[8:11], s36 offen sc1
    s_add_u32 s32, s32, 1
    v_mov_b32 v5, 0
    s_waitcnt vmcnt(0)
    v_max3_u32 v5, v5, v16, v17
    v_max3_u32 v5, v5, v18, v19
    s_cmp_gt_u32 s32, 200000
    s_cbranch_scc1 L_M00_rp_ok
    v_cmp_eq_u32 vcc, -1, v5
    s_cbranch_vccz L_M00_rp_ok
    s_sleep 64
    s_branch L_M00_rp
L_M00_rp_ok:
    v_add_f32 v16, v16, v17
    v_add_f32 v18, v18, v19
    v_add_f32 v16, v16, v18
    v_cvt_pk_bf16_f32 v5, v16, v16
    v_lshlrev_b32 v16, 16, v5
    v_ashrrev_i32 v5, 31, v16
    v_or_b32 v5, 0x80000000, v5
    v_xor_b32 v5, v5, v16
    v_and_b32 v5, 0xffff0000, v5
    v_sub_u32 v6, 2047, v0
    v_or_b32 v120, v5, v6
    v_lshrrev_b32 v1, 5, v0
    v_and_b32 v2, 31, v0
    s_mov_b32 s36, 229376
    v_mul_lo_u32 v4, v1, s36
    v_lshl_add_u32 v4, v2, 2, v4
    v_mov_b32 v5, 0x40000000
    v_cmp_lt_u32 vcc, 27, v2
    s_nop 1
    v_cndmask_b32 v4, v4, v5, vcc
    s_mul_i32 s23, s20, 112
    s_add_u32 s36, s23, 0
    buffer_load_dword v16, v4, s[64:67], s36 offen
    s_add_u32 s36, s23, 3584
    buffer_load_dword v17, v4, s[64:67], s36 offen
    s_add_u32 s36, s23, 7168
    buffer_load_dword v18, v4, s[64:67], s36 offen
    s_add_u32 s36, s23, 10752
    buffer_load_dword v19, v4, s[64:67], s36 offen
    s_add_u32 s36, s23, 14336
    buffer_load_dword v20, v4, s[64:67], s36 offen
    s_add_u32 s36, s23, 17920
    buffer_load_dword v21, v4, s[64:67], s36 offen
    s_add_u32 s36, s23, 21504
    buffer_load_dword v22, v4, s[64:67], s36 offen
    s_add_u32 s36, s23, 25088
    buffer_load_dword v23, v4, s[64:67], s36 offen
    s_add_u32 s36, s23, 28672
    buffer_load_dword v24, v4, s[64:67], s36 offen
    s_add_u32 s36, s23, 32256
    buffer_load_dword v25, v4, s[64:67], s36 offen
    s_add_u32 s36, s23, 35840
    buffer_load_dword v26, v4, s[64:67], s36 offen
    s_add_u32 s36, s23, 39424
    buffer_load_dword v27, v4, s[64:67], s36 offen
    s_add_u32 s36, s23, 43008
    buffer_load_dword v28, v4, s[64:67], s36 offen
    s_add_u32 s36, s23, 46592
    buffer_load_dword v29, v4, s[64:67], s36 offen
    s_add_u32 s36, s23, 50176
    buffer_load_dword v30, v4, s[64:67], s36 offen
    s_add_u32 s36, s23, 53760
    buffer_load_dword v31, v4, s[64:67], s36 offen
    s_add_u32 s36, s23, 57344
    buffer_load_dword v32, v4, s[64:67], s36 offen
    s_add_u32 s36, s23, 60928
    buffer_load_dword v33, v4, s[64:67], s36 offen
    s_add_u32 s36, s23, 64512
    buffer_load_dword v34, v4, s[64:67], s36 offen
    s_add_u32 s36, s23, 68096
    buffer_load_dword v35, v4, s[64:67], s36 offen
    s_add_u32 s36, s23, 71680
    buffer_load_dword v36, v4, s[64:67], s36 offen
    s_add_u32 s36, s23, 75264
    buffer_load_dword v37, v4, s[64:67], s36 offen
    s_add_u32 s36, s23, 78848
    buffer_load_dword v38, v4, s[64:67], s36 offen
    s_add_u32 s36, s23, 82432
    buffer_load_dword v39, v4, s[64:67], s36 offen
    s_add_u32 s36, s23, 86016
    buffer_load_dword v40, v4, s[64:67], s36 offen
    s_add_u32 s36, s23, 89600
    buffer_load_dword v41, v4, s[64:67], s36 offen
    s_add_u32 s36, s23, 93184
    buffer_load_dword v42, v4, s[64:67], s36 offen
    s_add_u32 s36, s23, 96768
    buffer_load_dword v43, v4, s[64:67], s36 offen
    s_add_u32 s36, s23, 100352
    buffer_load_dword v44, v4, s[64:67], s36 offen
    s_add_u32 s36, s23, 103936
    buffer_load_dword v45, v4, s[64:67], s36 offen
    s_add_u32 s36, s23, 107520
    buffer_load_dword v46, v4, s[64:67], s36 offen
    s_add_u32 s36, s23, 111104
    buffer_load_dword v47, v4, s[64:67], s36 offen
    s_waitcnt vmcnt(0)
    v_perm_b32 v128, v17, v16, s34
    v_perm_b32 v129, v19, v18, s34
    v_perm_b32 v130, v21, v20, s34
    v_perm_b32 v131, v23, v22, s34
    v_perm_b32 v132, v25, v24, s34
    v_perm_b32 v133, v27, v26, s34
    v_perm_b32 v134, v29, v28, s34
    v_perm_b32 v135, v31, v30, s34
    v_perm_b32 v136, v33, v32, s34
    v_perm_b32 v137, v35, v34, s34
    v_perm_b32 v138, v37, v36, s34
    v_perm_b32 v139, v39, v38, s34
    v_perm_b32 v140, v41, v40, s34
    v_perm_b32 v141, v43, v42, s34
    v_perm_b32 v142, v45, v44, s34
    v_perm_b32 v143, v47, v46, s34
    v_perm_b32 v160, v17, v16, s35
    v_perm_b32 v161, v19, v18, s35
    v_perm_b32 v162, v21, v20, s35
    v_perm_b32 v163, v23, v22, s35
    v_perm_b32 v164, v25, v24, s35
    v_perm_b32 v165, v27, v26, s35
    v_perm_b32 v166, v29, v28, s35
    v_perm_b32 v167, v31, v30, s35
    v_perm_b32 v168, v33, v32, s35
    v_perm_b32 v169, v35, v34, s35
    v_perm_b32 v170, v37, v36, s35
    v_perm_b32 v171, v39, v38, s35
    v_perm_b32 v172, v41, v40, s35
    v_perm_b32 v173, v43, v42, s35
    v_perm_b32 v174, v45, v44, s35
    v_perm_b32 v175, v47, v46, s35
    s_add_u32 s36, s23, 114688
    buffer_load_dword v16, v4, s[64:67], s36 offen
    s_add_u32 s36, s23, 118272
    buffer_load_dword v17, v4, s[64:67], s36 offen
    s_add_u32 s36, s23, 121856
    buffer_load_dword v18, v4, s[64:67], s36 offen
    s_add_u32 s36, s23, 125440
    buffer_load_dword v19, v4, s[64:67], s36 offen
    s_add_u32 s36, s23, 129024
    buffer_load_dword v20, v4, s[64:67], s36 offen
    s_add_u32 s36, s23, 132608
    buffer_load_dword v21, v4, s[64:67], s36 offen
    s_add_u32 s36, s23, 136192
    buffer_load_dword v22, v4, s[64:67], s36 offen
    s_add_u32 s36, s23, 139776
    buffer_load_dword v23, v4, s[64:67], s36 offen
    s_add_u32 s36, s23, 143360
    buffer_load_dword v24, v4, s[64:67], s36 offen
    s_add_u32 s36, s23, 146944
    buffer_load_dword v25, v4, s[64:67], s36 offen
    s_add_u32 s36, s23, 150528
    buffer_load_dword v26, v4, s[64:67], s36 offen
    s_add_u32 s36, s23, 154112
    buffer_load_dword v27, v4, s[64:67], s36 offen
    s_add_u32 s36, s23, 157696
    buffer_load_dword v28, v4, s[64:67], s36 offen
    s_add_u32 s36, s23, 161280
    buffer_load_dword v29, v4, s[64:67], s36 offen
    s_add_u32 s36, s23, 164864
    buffer_load_dword v30, v4, s[64:67], s36 offen
    s_add_u32 s36, s23, 168448
    buffer_load_dword v31, v4, s[64:67], s36 offen
    s_add_u32 s36, s23, 172032
    buffer_load_dword v32, v4, s[64:67], s36 offen
    s_add_u32 s36, s23, 175616
    buffer_load_dword v33, v4, s[64:67], s36 offen
    s_add_u32 s36, s23, 179200
    buffer_load_dword v34, v4, s[64:67], s36 offen
    s_add_u32 s36, s23, 182784
    buffer_load_dword v35, v4, s[64:67], s36 offen
    s_add_u32 s36, s23, 186368
    buffer_load_dword v36, v4, s[64:67], s36 offen
    s_add_u32 s36, s23, 189952
    buffer_load_dword v37, v4, s[64:67], s36 offen
    s_add_u32 s36, s23, 193536
    buffer_load_dword v38, v4, s[64:67], s36 offen
    s_add_u32 s36, s23, 197120
    buffer_load_dword v39, v4, s[64:67], s36 offen
    s_add_u32 s36, s23, 200704
    buffer_load_dword v40, v4, s[64:67], s36 offen
    s_add_u32 s36, s23, 204288
    buffer_load_dword v41, v4, s[64:67], s36 offen
    s_add_u32 s36, s23, 207872
    buffer_load_dword v42, v4, s[64:67], s36 offen
    s_add_u32 s36, s23, 211456
    buffer_load_dword v43, v4, s[64:67], s36 offen
    s_add_u32 s36, s23, 215040
    buffer_load_dword v44, v4, s[64:67], s36 offen
    s_add_u32 s36, s23, 218624
    buffer_load_dword v45, v4, s[64:67], s36 offen
    s_add_u32 s36, s23, 222208
    buffer_load_dword v46, v4, s[64:67], s36 offen
    s_add_u32 s36, s23, 225792
    buffer_load_dword v47, v4, s[64:67], s36 offen
    s_waitcnt vmcnt(0)
    v_perm_b32 v144, v17, v16, s34
    v_perm_b32 v145, v19, v18, s34
    v_perm_b32 v146, v21, v20, s34
    v_perm_b32 v147, v23, v22, s34
    v_perm_b32 v148, v25, v24, s34
    v_perm_b32 v149, v27, v26, s34
    v_perm_b32 v150, v29, v28, s34
    v_perm_b32 v151, v31, v30, s34
    v_perm_b32 v152, v33, v32, s34
    v_perm_b32 v153, v35, v34, s34
    v_perm_b32 v154, v37, v36, s34
    v_perm_b32 v155, v39, v38, s34
    v_perm_b32 v156, v41, v40, s34
    v_perm_b32 v157, v43, v42, s34
    v_perm_b32 v158, v45, v44, s34
    v_perm_b32 v159, v47, v46, s34
    v_perm_b32 v176, v17, v16, s35
    v_perm_b32 v177, v19, v18, s35
    v_perm_b32 v178, v21, v20, s35
    v_perm_b32 v179, v23, v22, s35
    v_perm_b32 v180, v25, v24, s35
    v_perm_b32 v181, v27, v26, s35
    v_perm_b32 v182, v29, v28, s35
    v_perm_b32 v183, v31, v30, s35
    v_perm_b32 v184, v33, v32, s35
    v_perm_b32 v185, v35, v34, s35
    v_perm_b32 v186, v37, v36, s35
    v_perm_b32 v187, v39, v38, s35
    v_perm_b32 v188, v41, v40, s35
    v_perm_b32 v189, v43, v42, s35
    v_perm_b32 v190, v45, v44, s35
    v_perm_b32 v191, v47, v46, s35
    s_add_u32 s36, s23, 0
    buffer_load_dword v16, v4, s[68:71], s36 offen
    s_add_u32 s36, s23, 3584
    buffer_load_dword v17, v4, s[68:71], s36 offen
    s_add_u32 s36, s23, 7168
    buffer_load_dword v18, v4, s[68:71], s36 offen
    s_add_u32 s36, s23, 10752
    buffer_load_dword v19, v4, s[68:71], s36 offen
    s_add_u32 s36, s23, 14336
    buffer_load_dword v20, v4, s[68:71], s36 offen
    s_add_u32 s36, s23, 17920
    buffer_load_dword v21, v4, s[68:71], s36 offen
    s_add_u32 s36, s23, 21504
    buffer_load_dword v22, v4, s[68:71], s36 offen
    s_add_u32 s36, s23, 25088
    buffer_load_dword v23, v4, s[68:71], s36 offen
    s_add_u32 s36, s23, 28672
    buffer_load_dword v24, v4, s[68:71], s36 offen
    s_add_u32 s36, s23, 32256
    buffer_load_dword v25, v4, s[68:71], s36 offen
    s_add_u32 s36, s23, 35840
    buffer_load_dword v26, v4, s[68:71], s36 offen
    s_add_u32 s36, s23, 39424
    buffer_load_dword v27, v4, s[68:71], s36 offen
    s_add_u32 s36, s23, 43008
    buffer_load_dword v28, v4, s[68:71], s36 offen
    s_add_u32 s36, s23, 46592
    buffer_load_dword v29, v4, s[68:71], s36 offen
    s_add_u32 s36, s23, 50176
    buffer_load_dword v30, v4, s[68:71], s36 offen
    s_add_u32 s36, s23, 53760
    buffer_load_dword v31, v4, s[68:71], s36 offen
    s_add_u32 s36, s23, 57344
    buffer_load_dword v32, v4, s[68:71], s36 offen
    s_add_u32 s36, s23, 60928
    buffer_load_dword v33, v4, s[68:71], s36 offen
    s_add_u32 s36, s23, 64512
    buffer_load_dword v34, v4, s[68:71], s36 offen
    s_add_u32 s36, s23, 68096
    buffer_load_dword v35, v4, s[68:71], s36 offen
    s_add_u32 s36, s23, 71680
    buffer_load_dword v36, v4, s[68:71], s36 offen
    s_add_u32 s36, s23, 75264
    buffer_load_dword v37, v4, s[68:71], s36 offen
    s_add_u32 s36, s23, 78848
    buffer_load_dword v38, v4, s[68:71], s36 offen
    s_add_u32 s36, s23, 82432
    buffer_load_dword v39, v4, s[68:71], s36 offen
    s_add_u32 s36, s23, 86016
    buffer_load_dword v40, v4, s[68:71], s36 offen
    s_add_u32 s36, s23, 89600
    buffer_load_dword v41, v4, s[68:71], s36 offen
    s_add_u32 s36, s23, 93184
    buffer_load_dword v42, v4, s[68:71], s36 offen
    s_add_u32 s36, s23, 96768
    buffer_load_dword v43, v4, s[68:71], s36 offen
    s_add_u32 s36, s23, 100352
    buffer_load_dword v44, v4, s[68:71], s36 offen
    s_add_u32 s36, s23, 103936
    buffer_load_dword v45, v4, s[68:71], s36 offen
    s_add_u32 s36, s23, 107520
    buffer_load_dword v46, v4, s[68:71], s36 offen
    s_add_u32 s36, s23, 111104
    buffer_load_dword v47, v4, s[68:71], s36 offen
    s_waitcnt vmcnt(0)
    v_perm_b32 v192, v17, v16, s34
    v_perm_b32 v193, v19, v18, s34
    v_perm_b32 v194, v21, v20, s34
    v_perm_b32 v195, v23, v22, s34
    v_perm_b32 v196, v25, v24, s34
    v_perm_b32 v197, v27, v26, s34
    v_perm_b32 v198, v29, v28, s34
    v_perm_b32 v199, v31, v30, s34
    v_perm_b32 v200, v33, v32, s34
    v_perm_b32 v201, v35, v34, s34
    v_perm_b32 v202, v37, v36, s34
    v_perm_b32 v203, v39, v38, s34
    v_perm_b32 v204, v41, v40, s34
    v_perm_b32 v205, v43, v42, s34
    v_perm_b32 v206, v45, v44, s34
    v_perm_b32 v207, v47, v46, s34
    v_perm_b32 v224, v17, v16, s35
    v_perm_b32 v225, v19, v18, s35
    v_perm_b32 v226, v21, v20, s35
    v_perm_b32 v227, v23, v22, s35
    v_perm_b32 v228, v25, v24, s35
    v_perm_b32 v229, v27, v26, s35
    v_perm_b32 v230, v29, v28, s35
    v_perm_b32 v231, v31, v30, s35
    v_perm_b32 v232, v33, v32, s35
    v_perm_b32 v233, v35, v34, s35
    v_perm_b32 v234, v37, v36, s35
    v_perm_b32 v235, v39, v38, s35
    v_perm_b32 v236, v41, v40, s35
    v_perm_b32 v237, v43, v42, s35
    v_perm_b32 v238, v45, v44, s35
    v_perm_b32 v239, v47, v46, s35
    s_add_u32 s36, s23, 114688
    buffer_load_dword v16, v4, s[68:71], s36 offen
    s_add_u32 s36, s23, 118272
    buffer_load_dword v17, v4, s[68:71], s36 offen
    s_add_u32 s36, s23, 121856
    buffer_load_dword v18, v4, s[68:71], s36 offen
    s_add_u32 s36, s23, 125440
    buffer_load_dword v19, v4, s[68:71], s36 offen
    s_add_u32 s36, s23, 129024
    buffer_load_dword v20, v4, s[68:71], s36 offen
    s_add_u32 s36, s23, 132608
    buffer_load_dword v21, v4, s[68:71], s36 offen
    s_add_u32 s36, s23, 136192
    buffer_load_dword v22, v4, s[68:71], s36 offen
    s_add_u32 s36, s23, 139776
    buffer_load_dword v23, v4, s[68:71], s36 offen
    s_add_u32 s36, s23, 143360
    buffer_load_dword v24, v4, s[68:71], s36 offen
    s_add_u32 s36, s23, 146944
    buffer_load_dword v25, v4, s[68:71], s36 offen
    s_add_u32 s36, s23, 150528
    buffer_load_dword v26, v4, s[68:71], s36 offen
    s_add_u32 s36, s23, 154112
    buffer_load_dword v27, v4, s[68:71], s36 offen
    s_add_u32 s36, s23, 157696
    buffer_load_dword v28, v4, s[68:71], s36 offen
    s_add_u32 s36, s23, 161280
    buffer_load_dword v29, v4, s[68:71], s36 offen
    s_add_u32 s36, s23, 164864
    buffer_load_dword v30, v4, s[68:71], s36 offen
    s_add_u32 s36, s23, 168448
    buffer_load_dword v31, v4, s[68:71], s36 offen
    s_add_u32 s36, s23, 172032
    buffer_load_dword v32, v4, s[68:71], s36 offen
    s_add_u32 s36, s23, 175616
    buffer_load_dword v33, v4, s[68:71], s36 offen
    s_add_u32 s36, s23, 179200
    buffer_load_dword v34, v4, s[68:71], s36 offen
    s_add_u32 s36, s23, 182784
    buffer_load_dword v35, v4, s[68:71], s36 offen
    s_add_u32 s36, s23, 186368
    buffer_load_dword v36, v4, s[68:71], s36 offen
    s_add_u32 s36, s23, 189952
    buffer_load_dword v37, v4, s[68:71], s36 offen
    s_add_u32 s36, s23, 193536
    buffer_load_dword v38, v4, s[68:71], s36 offen
    s_add_u32 s36, s23, 197120
    buffer_load_dword v39, v4, s[68:71], s36 offen
    s_add_u32 s36, s23, 200704
    buffer_load_dword v40, v4, s[68:71], s36 offen
    s_add_u32 s36, s23, 204288
    buffer_load_dword v41, v4, s[68:71], s36 offen
    s_add_u32 s36, s23, 207872
    buffer_load_dword v42, v4, s[68:71], s36 offen
    s_add_u32 s36, s23, 211456
    buffer_load_dword v43, v4, s[68:71], s36 offen
    s_add_u32 s36, s23, 215040
    buffer_load_dword v44, v4, s[68:71], s36 offen
    s_add_u32 s36, s23, 218624
    buffer_load_dword v45, v4, s[68:71], s36 offen
    s_add_u32 s36, s23, 222208
    buffer_load_dword v46, v4, s[68:71], s36 offen
    s_add_u32 s36, s23, 225792
    buffer_load_dword v47, v4, s[68:71], s36 offen
    s_waitcnt vmcnt(0)
    v_perm_b32 v208, v17, v16, s34
    v_perm_b32 v209, v19, v18, s34
    v_perm_b32 v210, v21, v20, s34
    v_perm_b32 v211, v23, v22, s34
    v_perm_b32 v212, v25, v24, s34
    v_perm_b32 v213, v27, v26, s34
    v_perm_b32 v214, v29, v28, s34
    v_perm_b32 v215, v31, v30, s34
    v_perm_b32 v216, v33, v32, s34
    v_perm_b32 v217, v35, v34, s34
    v_perm_b32 v218, v37, v36, s34
    v_perm_b32 v219, v39, v38, s34
    v_perm_b32 v220, v41, v40, s34
    v_perm_b32 v221, v43, v42, s34
    v_perm_b32 v222, v45, v44, s34
    v_perm_b32 v223, v47, v46, s34
    v_perm_b32 v240, v17, v16, s35
    v_perm_b32 v241, v19, v18, s35
    v_perm_b32 v242, v21, v20, s35
    v_perm_b32 v243, v23, v22, s35
    v_perm_b32 v244, v25, v24, s35
    v_perm_b32 v245, v27, v26, s35
    v_perm_b32 v246, v29, v28, s35
    v_perm_b32 v247, v31, v30, s35
    v_perm_b32 v248, v33, v32, s35
    v_perm_b32 v249, v35, v34, s35
    v_perm_b32 v250, v37, v36, s35
    v_perm_b32 v251, v39, v38, s35
    v_perm_b32 v252, v41, v40, s35
    v_perm_b32 v253, v43, v42, s35
    v_perm_b32 v254, v45, v44, s35
    v_perm_b32 v255, v47, v46, s35
    v_lshrrev_b32 v3, 3, v0
    v_mul_u32_u24 v4, 57344, v3
    v_and_b32 v3, 7, v0
    v_lshl_add_u32 v4, v3, 2, v4
    s_lshl_b32 s37, s20, 5
    s_add_u32 s36, s37, 0
    buffer_load_dword v16, v4, s[76:79], s36 offen
    s_add_u32 s36, s37, 1024
    buffer_load_dword v17, v4, s[76:79], s36 offen
    s_add_u32 s36, s37, 2048
    buffer_load_dword v18, v4, s[76:79], s36 offen
    s_add_u32 s36, s37, 3072
    buffer_load_dword v19, v4, s[76:79], s36 offen
    s_add_u32 s36, s37, 4096
    buffer_load_dword v20, v4, s[76:79], s36 offen
    s_add_u32 s36, s37, 5120
    buffer_load_dword v21, v4, s[76:79], s36 offen
    s_add_u32 s36, s37, 6144
    buffer_load_dword v22, v4, s[76:79], s36 offen
    s_add_u32 s36, s37, 7168
    buffer_load_dword v23, v4, s[76:79], s36 offen
    s_add_u32 s36, s37, 8192
    buffer_load_dword v24, v4, s[76:79], s36 offen
    s_add_u32 s36, s37, 9216
    buffer_load_dword v25, v4, s[76:79], s36 offen
    s_add_u32 s36, s37, 10240
    buffer_load_dword v26, v4, s[76:79], s36 offen
    s_add_u32 s36, s37, 11264
    buffer_load_dword v27, v4, s[76:79], s36 offen
    s_add_u32 s36, s37, 12288
    buffer_load_dword v28, v4, s[76:79], s36 offen
    s_add_u32 s36, s37, 13312
    buffer_load_dword v29, v4, s[76:79], s36 offen
    s_add_u32 s36, s37, 14336
    buffer_load_dword v30, v4, s[76:79], s36 offen
    s_add_u32 s36, s37, 15360
    buffer_load_dword v31, v4, s[76:79], s36 offen
    s_add_u32 s36, s37, 16384
    buffer_load_dword v32, v4, s[76:79], s36 offen
    s_add_u32 s36, s37, 17408
    buffer_load_dword v33, v4, s[76:79], s36 offen
    s_add_u32 s36, s37, 18432
    buffer_load_dword v34, v4, s[76:79], s36 offen
    s_add_u32 s36, s37, 19456
    buffer_load_dword v35, v4, s[76:79], s36 offen
    s_add_u32 s36, s37, 20480
    buffer_load_dword v36, v4, s[76:79], s36 offen
    s_add_u32 s36, s37, 21504
    buffer_load_dword v37, v4, s[76:79], s36 offen
    s_add_u32 s36, s37, 22528
    buffer_load_dword v38, v4, s[76:79], s36 offen
    s_add_u32 s36, s37, 23552
    buffer_load_dword v39, v4, s[76:79], s36 offen
    s_add_u32 s36, s37, 24576
    buffer_load_dword v40, v4, s[76:79], s36 offen
    s_add_u32 s36, s37, 25600
    buffer_load_dword v41, v4, s[76:79], s36 offen
    s_add_u32 s36, s37, 26624
    buffer_load_dword v42, v4, s[76:79], s36 offen
    s_add_u32 s36, s37, 27648
    buffer_load_dword v43, v4, s[76:79], s36 offen
    s_waitcnt vmcnt(0)
    v_perm_b32 v64, v17, v16, s34
    v_perm_b32 v65, v19, v18, s34
    v_perm_b32 v66, v21, v20, s34
    v_perm_b32 v67, v23, v22, s34
    v_perm_b32 v68, v25, v24, s34
    v_perm_b32 v69, v27, v26, s34
    v_perm_b32 v70, v29, v28, s34
    v_perm_b32 v71, v31, v30, s34
    v_perm_b32 v72, v33, v32, s34
    v_perm_b32 v73, v35, v34, s34
    v_perm_b32 v74, v37, v36, s34
    v_perm_b32 v75, v39, v38, s34
    v_perm_b32 v76, v41, v40, s34
    v_perm_b32 v77, v43, v42, s34
    v_perm_b32 v92, v17, v16, s35
    v_perm_b32 v93, v19, v18, s35
    v_perm_b32 v94, v21, v20, s35
    v_perm_b32 v95, v23, v22, s35
    v_perm_b32 v96, v25, v24, s35
    v_perm_b32 v97, v27, v26, s35
    v_perm_b32 v98, v29, v28, s35
    v_perm_b32 v99, v31, v30, s35
    v_perm_b32 v100, v33, v32, s35
    v_perm_b32 v101, v35, v34, s35
    v_perm_b32 v102, v37, v36, s35
    v_perm_b32 v103, v39, v38, s35
    v_perm_b32 v104, v41, v40, s35
    v_perm_b32 v105, v43, v42, s35
    s_add_u32 s36, s37, 28672
    buffer_load_dword v16, v4, s[76:79], s36 offen
    s_add_u32 s36, s37, 29696
    buffer_load_dword v17, v4, s[76:79], s36 offen
    s_add_u32 s36, s37, 30720
    buffer_load_dword v18, v4, s[76:79], s36 offen
    s_add_u32 s36, s37, 31744
    buffer_load_dword v19, v4, s[76:79], s36 offen
    s_add_u32 s36, s37, 32768
    buffer_load_dword v20, v4, s[76:79], s36 offen
    s_add_u32 s36, s37, 33792
    buffer_load_dword v21, v4, s[76:79], s36 offen
    s_add_u32 s36, s37, 34816
    buffer_load_dword v22, v4, s[76:79], s36 offen
    s_add_u32 s36, s37, 35840
    buffer_load_dword v23, v4, s[76:79], s36 offen
    s_add_u32 s36, s37, 36864
    buffer_load_dword v24, v4, s[76:79], s36 offen
    s_add_u32 s36, s37, 37888
    buffer_load_dword v25, v4, s[76:79], s36 offen
    s_add_u32 s36, s37, 38912
    buffer_load_dword v26, v4, s[76:79], s36 offen
    s_add_u32 s36, s37, 39936
    buffer_load_dword v27, v4, s[76:79], s36 offen
    s_add_u32 s36, s37, 40960
    buffer_load_dword v28, v4, s[76:79], s36 offen
    s_add_u32 s36, s37, 41984
    buffer_load_dword v29, v4, s[76:79], s36 offen
    s_add_u32 s36, s37, 43008
    buffer_load_dword v30, v4, s[76:79], s36 offen
    s_add_u32 s36, s37, 44032
    buffer_load_dword v31, v4, s[76:79], s36 offen
    s_add_u32 s36, s37, 45056
    buffer_load_dword v32, v4, s[76:79], s36 offen
    s_add_u32 s36, s37, 46080
    buffer_load_dword v33, v4, s[76:79], s36 offen
    s_add_u32 s36, s37, 47104
    buffer_load_dword v34, v4, s[76:79], s36 offen
    s_add_u32 s36, s37, 48128
    buffer_load_dword v35, v4, s[76:79], s36 offen
    s_add_u32 s36, s37, 49152
    buffer_load_dword v36, v4, s[76:79], s36 offen
    s_add_u32 s36, s37, 50176
    buffer_load_dword v37, v4, s[76:79], s36 offen
    s_add_u32 s36, s37, 51200
    buffer_load_dword v38, v4, s[76:79], s36 offen
    s_add_u32 s36, s37, 52224
    buffer_load_dword v39, v4, s[76:79], s36 offen
    s_add_u32 s36, s37, 53248
    buffer_load_dword v40, v4, s[76:79], s36 offen
    s_add_u32 s36, s37, 54272
    buffer_load_dword v41, v4, s[76:79], s36 offen
    s_add_u32 s36, s37, 55296
    buffer_load_dword v42, v4, s[76:79], s36 offen
    s_add_u32 s36, s37, 56320
    buffer_load_dword v43, v4, s[76:79], s36 offen
    s_waitcnt vmcnt(0)
    v_perm_b32 v78, v17, v16, s34
    v_perm_b32 v79, v19, v18, s34
    v_perm_b32 v80, v21, v20, s34
    v_perm_b32 v81, v23, v22, s34
    v_perm_b32 v82, v25, v24, s34
    v_perm_b32 v83, v27, v26, s34
    v_perm_b32 v84, v29, v28, s34
    v_perm_b32 v85, v31, v30, s34
    v_perm_b32 v86, v33, v32, s34
    v_perm_b32 v87, v35, v34, s34
    v_perm_b32 v88, v37, v36, s34
    v_perm_b32 v89, v39, v38, s34
    v_perm_b32 v90, v41, v40, s34
    v_perm_b32 v91, v43, v42, s34
    v_perm_b32 v106, v17, v16, s35
    v_perm_b32 v107, v19, v18, s35
    v_perm_b32 v108, v21, v20, s35
    v_perm_b32 v109, v23, v22, s35
    v_perm_b32 v110, v25, v24, s35
    v_perm_b32 v111, v27, v26, s35
    v_perm_b32 v112, v29, v28, s35
    v_perm_b32 v113, v31, v30, s35
    v_perm_b32 v114, v33, v32, s35
    v_perm_b32 v115, v35, v34, s35
    v_perm_b32 v116, v37, v36, s35
    v_perm_b32 v117, v39, v38, s35
    v_perm_b32 v118, v41, v40, s35
    v_perm_b32 v119, v43, v42, s35
    s_mov_b32 s42, 0xffff0000
    s_mov_b32 s24, 0
    s_mov_b64 s[28:29], 0
    v_mov_b32 v12, 0x40000000
    v_mov_b32 v13, 0
    v_lshlrev_b32 v3, 4, v0
L_M06_rp:
    s_mov_b32 s36, 0x19a000
    buffer_load_dwordx4 v[40:43], v3, s[8:11], s36 offen sc1
    s_add_u32 s32, s32, 1
    v_mov_b32 v5, 0
    s_waitcnt vmcnt(0)
    v_max3_u32 v5, v5, v40, v41
    v_max3_u32 v5, v5, v42, v43
    s_cmp_gt_u32 s32, 200000
    s_cbranch_scc1 L_M06_rp_ok
    v_cmp_eq_u32 vcc, -1, v5
    s_cbranch_vccz L_M06_rp_ok
    s_sleep 32
    s_branch L_M06_rp
L_M06_rp_ok:
    v_add_f32 v40, v40, v41
    v_add_f32 v42, v42, v43
    v_add_f32 v40, v40, v42
    v_cvt_pk_bf16_f32 v5, v40, v40
    v_lshlrev_b32 v40, 16, v5
    v_ashrrev_i32 v5, 31, v40
    v_or_b32 v5, 0x80000000, v5
    v_xor_b32 v5, v5, v40
    v_and_b32 v5, 0xffff0000, v5
    v_sub_u32 v6, 511, v0
    v_or_b32 v126, v5, v6
    v_lshlrev_b32 v3, 4, v0
L_M01_rp:
    s_mov_b32 s36, 0x195000
    buffer_load_dwordx4 v[20:23], v3, s[8:11], s36 offen sc1
    s_mov_b32 s36, 0x196000
    buffer_load_dwordx4 v[24:27], v3, s[8:11], s36 offen sc1
    s_mov_b32 s36, 0x197000
    buffer_load_dwordx4 v[28:31], v3, s[8:11], s36 offen sc1
    s_mov_b32 s36, 0x198000
    buffer_load_dwordx4 v[32:35], v3, s[8:11], s36 offen sc1
    s_mov_b32 s36, 0x199000
    buffer_load_dwordx4 v[36:39], v3, s[8:11], s36 offen sc1
    s_add_u32 s32, s32, 1
    v_mov_b32 v5, 0
    s_waitcnt vmcnt(0)
    v_max3_u32 v5, v5, v20, v21
    v_max3_u32 v5, v5, v22, v23
    v_max3_u32 v5, v5, v24, v25
    v_max3_u32 v5, v5, v26, v27
    v_max3_u32 v5, v5, v28, v29
    v_max3_u32 v5, v5, v30, v31
    v_max3_u32 v5, v5, v32, v33
    v_max3_u32 v5, v5, v34, v35
    v_max3_u32 v5, v5, v36, v37
    v_max3_u32 v5, v5, v38, v39
    s_cmp_gt_u32 s32, 200000
    s_cbranch_scc1 L_M01_rp_ok
    v_cmp_eq_u32 vcc, -1, v5
    s_cbranch_vccz L_M01_rp_ok
    s_sleep 8
    s_branch L_M01_rp
L_M01_rp_ok:
    v_add_f32 v20, v20, v21
    v_add_f32 v22, v22, v23
    v_add_f32 v20, v20, v22
    v_cvt_pk_bf16_f32 v5, v20, v20
    v_lshlrev_b32 v20, 16, v5
    v_ashrrev_i32 v5, 31, v20
    v_or_b32 v5, 0x80000000, v5
    v_xor_b32 v5, v5, v20
    v_and_b32 v5, 0xffff0000, v5
    v_sub_u32 v6, 1791, v0
    v_or_b32 v121, v5, v6
    v_add_f32 v24, v24, v25
    v_add_f32 v26, v26, v27
    v_add_f32 v24, v24, v26
    v_cvt_pk_bf16_f32 v5, v24, v24
    v_lshlrev_b32 v24, 16, v5
    v_ashrrev_i32 v5, 31, v24
    v_or_b32 v5, 0x80000000, v5
    v_xor_b32 v5, v5, v24
    v_and_b32 v5, 0xffff0000, v5
    v_sub_u32 v6, 1535, v0
    v_or_b32 v122, v5, v6
    v_add_f32 v28, v28, v29
    v_add_f32 v30, v30, v31
    v_add_f32 v28, v28, v30
    v_cvt_pk_bf16_f32 v5, v28, v28
    v_lshlrev_b32 v28, 16, v5
    v_ashrrev_i32 v5, 31, v28
    v_or_b32 v5, 0x80000000, v5
    v_xor_b32 v5, v5, v28
    v_and_b32 v5, 0xffff0000, v5
    v_sub_u32 v6, 1279, v0
    v_or_b32 v123, v5, v6
    v_add_f32 v32, v32, v33
    v_add_f32 v34, v34, v35
    v_add_f32 v32, v32, v34
    v_cvt_pk_bf16_f32 v5, v32, v32
    v_lshlrev_b32 v32, 16, v5
    v_ashrrev_i32 v5, 31, v32
    v_or_b32 v5, 0x80000000, v5
    v_xor_b32 v5, v5, v32
    v_and_b32 v5, 0xffff0000, v5
    v_sub_u32 v6, 1023, v0
    v_or_b32 v124, v5, v6
    v_add_f32 v36, v36, v37
    v_add_f32 v38, v38, v39
    v_add_f32 v36, v36, v38
    v_cvt_pk_bf16_f32 v5, v36, v36
    v_lshlrev_b32 v36, 16, v5
    v_ashrrev_i32 v5, 31, v36
    v_or_b32 v5, 0x80000000, v5
    v_xor_b32 v5, v5, v36
    v_and_b32 v5, 0xffff0000, v5
    v_sub_u32 v6, 767, v0
    v_or_b32 v125, v5, v6
    v_max_u32 v5, v120, v121
    v_min_u32 v6, v120, v121
    v_med3_u32 v6, v5, v6, v122
    v_max_u32 v5, v5, v122
    v_med3_u32 v6, v5, v6, v123
    v_max_u32 v5, v5, v123
    v_med3_u32 v6, v5, v6, v124
    v_max_u32 v5, v5, v124
    v_med3_u32 v6, v5, v6, v125
    v_max_u32 v5, v5, v125
    v_med3_u32 v6, v5, v6, v126
    v_max_u32 v5, v5, v126
    v_mov_b32 v120, v5
    v_mov_b32 v121, v6
    s_mov_b32 s25, 32
L_M_round:
    v_lshlrev_b32 v3, 4, v0
    v_cmp_gt_u32 s[74:75], s25, v0
L_M7_rp:
    s_mov_b32 s36, 0x19b000
    buffer_load_dwordx4 v[44:47], v3, s[8:11], s36 offen sc1
    s_add_u32 s32, s32, 1
    v_mov_b32 v5, 0
    s_waitcnt vmcnt(0)
    v_max3_u32 v5, v5, v44, v45
    v_max3_u32 v5, v5, v46, v47
    v_cndmask_b32 v5, 0, v5, s[74:75]
    s_cmp_gt_u32 s32, 200000
    s_cbranch_scc1 L_M7_rp_ok
    v_cmp_eq_u32 vcc, -1, v5
    s_cbranch_vccnz L_M7_rp
L_M7_rp_ok:
    v_add_f32 v44, v44, v45
    v_add_f32 v46, v46, v47
    v_add_f32 v44, v44, v46
    v_cvt_pk_bf16_f32 v5, v44, v44
    v_lshlrev_b32 v44, 16, v5
    v_ashrrev_i32 v5, 31, v44
    v_or_b32 v5, 0x80000000, v5
    v_xor_b32 v5, v5, v44
    v_and_b32 v5, 0xffff0000, v5
    v_sub_u32 v6, 255, v0
    v_or_b32 v127, v5, v6
    v_cndmask_b32 v127, 0, v127, s[74:75]
    v_max_u32 v5, v120, v127
    v_med3_u32 v6, v120, v121, v127
    s_nop 0
    v_mov_b32_dpp v7, v5 quad_perm:[1,0,3,2] row_mask:0xf bank_mask:0xf
    v_mov_b32_dpp v8, v6 quad_perm:[1,0,3,2] row_mask:0xf bank_mask:0xf
    v_min_u32 v9, v5, v7
    v_max_u32 v5, v5, v7
    v_max3_u32 v6, v6, v8, v9
    s_nop 0
    v_mov_b32_dpp v7, v5 quad_perm:[2,3,0,1] row_mask:0xf bank_mask:0xf
    v_mov_b32_dpp v8, v6 quad_perm:[2,3,0,1] row_mask:0xf bank_mask:0xf
    v_min_u32 v9, v5, v7
    v_max_u32 v5, v5, v7
    v_max3_u32 v6, v6, v8, v9
    s_nop 0
    v_mov_b32_dpp v7, v5 row_half_mirror row_mask:0xf bank_mask:0xf
    v_mov_b32_dpp v8, v6 row_half_mirror row_mask:0xf bank_mask:0xf
    v_min_u32 v9, v5, v7
    v_max_u32 v5, v5, v7
    v_max3_u32 v6, v6, v8, v9
    s_nop 0
    v_mov_b32_dpp v7, v5 row_mirror row_mask:0xf bank_mask:0xf
    v_mov_b32_dpp v8, v6 row_mirror row_mask:0xf bank_mask:0xf
    v_min_u32 v9, v5, v7
    v_max_u32 v5, v5, v7
    v_max3_u32 v6, v6, v8, v9
    v_lshrrev_b32 v9, 4, v0
    v_lshlrev_b32 v9, 3, v9
    s_barrier
    ds_write2_b32 v9, v5, v6 offset0:0 offset1:1
    v_and_b32 v9, 15, v0
    v_lshlrev_b32 v9, 3, v9
    s_waitcnt lgkmcnt(0)
    s_barrier
    ds_read2_b32 v[10:11], v9 offset0:0 offset1:1
    s_waitcnt lgkmcnt(0)
    v_mov_b32 v5, v10
    v_mov_b32 v6, v11
    s_nop 0
    v_mov_b32_dpp v7, v5 quad_perm:[1,0,3,2] row_mask:0xf bank_mask:0xf
    v_mov_b32_dpp v8, v6 quad_perm:[1,0,3,2] row_mask:0xf bank_mask:0xf
    v_min_u32 v9, v5, v7
    v_max_u32 v5, v5, v7
    v_max3_u32 v6, v6, v8, v9
    s_nop 0
    v_mov_b32_dpp v7, v5 quad_perm:[2,3,0,1] row_mask:0xf bank_mask:0xf
    v_mov_b32_dpp v8, v6 quad_perm:[2,3,0,1] row_mask:0xf bank_mask:0xf
    v_min_u32 v9, v5, v7
    v_max_u32 v5, v5, v7
    v_max3_u32 v6, v6, v8, v9
    s_nop 0
    v_mov_b32_dpp v7, v5 row_half_mirror row_mask:0xf bank_mask:0xf
    v_mov_b32_dpp v8, v6 row_half_mirror row_mask:0xf bank_mask:0xf
    v_min_u32 v9, v5, v7
    v_max_u32 v5, v5, v7
    v_max3_u32 v6, v6, v8, v9
    s_nop 0
    v_mov_b32_dpp v7, v5 row_mirror row_mask:0xf bank_mask:0xf
    v_mov_b32_dpp v8, v6 row_mirror row_mask:0xf bank_mask:0xf
    v_min_u32 v9, v5, v7
    v_max_u32 v5, v5, v7
    v_max3_u32 v6, v6, v8, v9
    v_readfirstlane_b32 s26, v5
    v_readfirstlane_b32 s27, v6
    s_nop 3
    s_cmp_eq_u64 s[26:27], s[28:29]
    s_cbranch_scc1 L_M_next
    s_mov_b64 s[28:29], s[26:27]
    buffer_store_dword v13, v12, s[60:63], 0 offen sc1
    s_and_b32 s36, s26, 0x7ff
    s_sub_u32 s30, 2047, s36
    s_and_b32 s36, s26, 0xffff0000
    s_xor_b32 s37, s36, 0x80000000
    s_xor_b32 s40, s36, 0xffff0000
    s_bitcmp1_b32 s36, 31
    s_cselect_b32 s40, s37, s40
    s_and_b32 s36, s27, 0x7ff
    s_sub_u32 s31, 2047, s36
    s_and_b32 s36, s27, 0xffff0000
    s_xor_b32 s37, s36, 0x80000000
    s_xor_b32 s41, s36, 0xffff0000
    s_bitcmp1_b32 s36, 31
    s_cselect_b32 s41, s37, s41
    v_mov_b32 v8, 0
L_M_rows:
    s_lshl_b32 s36, s30, 4
    s_add_u32 s36, s36, 0x1b8000
    buffer_load_dwordx4 v[16:19], v8, s[8:11], s36 offen sc1
    s_lshl_b32 s36, s31, 4
    s_add_u32 s36, s36, 0x1b8000
    buffer_load_dwordx4 v[20:23], v8, s[8:11], s36 offen sc1
    s_add_u32 s32, s32, 1
    s_cmp_gt_u32 s32, 200000
    s_waitcnt vmcnt(0)
    v_or3_b32 v5, v16, v17, v18
    v_or3_b32 v5, v5, v19, v20
    v_or3_b32 v5, v5, v21, v22
    v_or_b32 v5, v5, v23
    s_cbranch_scc1 L_M_rows_ok
    v_cmp_ne_u32 vcc, 0, v5
    s_cbranch_vccnz L_M_rows
L_M_rows_ok:
    v_bfe_u32 v9, v0, 6, 1
    v_cmp_ne_u32 vcc, 0, v9
    v_mov_b32 v5, s30
    v_mov_b32 v6, s31
    v_cndmask_b32 v7, v5, v6, vcc
    v_lshlrev_b32 v7, 10, v7
    v_and_b32 v8, 63, v0
    v_lshl_add_u32 v7, v8, 4, v7
    s_mov_b32 s37, 0x600000
    buffer_load_dwordx4 v[16:19], v7, s[8:11], s37 offen sc1
    v_bfe_u32 v9, v0, 3, 1
    v_cmp_ne_u32 vcc, 0, v9
    s_nop 1
    v_cndmask_b32 v12, v5, v6, vcc
    v_mov_b32 v5, s40
    v_mov_b32 v6, s41
    v_cndmask_b32 v11, v5, v6, vcc
    v_lshlrev_b32 v12, 10, v12
    v_and_b32 v3, 7, v0
    v_lshl_add_u32 v12, v3, 2, v12
    s_lshl_b32 s36, s20, 5
    v_add_u32 v12, s36, v12
    v_mov_b32 v7, 0x40000000
    v_cmp_lt_u32 vcc, 15, v0
    s_nop 1
    v_cndmask_b32 v12, v12, v7, vcc
    s_mov_b32 s36, 0x400000
    buffer_load_dword v14, v12, s[8:11], s36 offen sc1
    buffer_load_dword v15, v12, s[8:11], s37 offen sc1
    v_and_b32 v8, 127, v0
    v_lshlrev_b32 v8, 4, v8
    s_waitcnt vmcnt(2)
    ds_write_b128 v8, v[16:19] offset:4096
    s_waitcnt lgkmcnt(0)
    s_barrier
    v_mov_b64 v[48:49], 0
    v_mov_b64 v[50:51], 0
    v_mov_b64 v[52:53], 0
    v_mov_b64 v[54:55], 0
    v_lshlrev_b32 v8, 7, v1
    ds_read_b128 v[16:19], v8 offset:4096
    ds_read_b128 v[20:23], v8 offset:4112
    ds_read_b128 v[24:27], v8 offset:4128
    ds_read_b128 v[28:31], v8 offset:4144
    ds_read_b128 v[32:35], v8 offset:5120
    ds_read_b128 v[36:39], v8 offset:5136
    ds_read_b128 v[40:43], v8 offset:5152
    ds_read_b128 v[44:47], v8 offset:5168
    s_waitcnt lgkmcnt(0)
    v_dot2_f32_bf16 v48, v16, v128, v48
    v_dot2_f32_bf16 v49, v16, v160, v49
    v_dot2_f32_bf16 v50, v32, v128, v50
    v_dot2_f32_bf16 v51, v32, v160, v51
    v_dot2_f32_bf16 v52, v16, v192, v52
    v_dot2_f32_bf16 v53, v16, v224, v53
    v_dot2_f32_bf16 v54, v32, v192, v54
    v_dot2_f32_bf16 v55, v32, v224, v55
    v_dot2_f32_bf16 v48, v17, v129, v48
    v_dot2_f32_bf16 v49, v17, v161, v49
    v_dot2_f32_bf16 v50, v33, v129, v50
    v_dot2_f32_bf16 v51, v33, v161, v51
    v_dot2_f32_bf16 v52, v17, v193, v52
    v_dot2_f32_bf16 v53, v17, v225, v53
    v_dot2_f32_bf16 v54, v33, v193, v54
    v_dot2_f32_bf16 v55, v33, v225, v55
    v_dot2_f32_bf16 v48, v18, v130, v48
    v_dot2_f32_bf16 v49, v18, v162, v49
    v_dot2_f32_bf16 v50, v34, v130, v50
    v_dot2_f32_bf16 v51, v34, v162, v51
    v_dot2_f32_bf16 v52, v18, v194, v52
    v_dot2_f32_bf16 v53, v18, v226, v53
    v_dot2_f32_bf16 v54, v34, v194, v54
    v_dot2_f32_bf16 v55, v34, v226, v55
    v_dot2_f32_bf16 v48, v19, v131, v48
    v_dot2_f32_bf16 v49, v19, v163, v49
    v_dot2_f32_bf16 v50, v35, v131, v50
    v_dot2_f32_bf16 v51, v35, v163, v51
    v_dot2_f32_bf16 v52, v19, v195, v52
    v_dot2_f32_bf16 v53, v19, v227, v53
    v_dot2_f32_bf16 v54, v35, v195, v54
    v_dot2_f32_bf16 v55, v35, v227, v55
    v_dot2_f32_bf16 v48, v20, v132, v48
    v_dot2_f32_bf16 v49, v20, v164, v49
    v_dot2_f32_bf16 v50, v36, v132, v50
    v_dot2_f32_bf16 v51, v36, v164, v51
    v_dot2_f32_bf16 v52, v20, v196, v52
    v_dot2_f32_bf16 v53, v20, v228, v53
    v_dot2_f32_bf16 v54, v36, v196, v54
    v_dot2_f32_bf16 v55, v36, v228, v55
    v_dot2_f32_bf16 v48, v21, v133, v48
    v_dot2_f32_bf16 v49, v21, v165, v49
    v_dot2_f32_bf16 v50, v37, v133, v50
    v_dot2_f32_bf16 v51, v37, v165, v51
    v_dot2_f32_bf16 v52, v21, v197, v52
    v_dot2_f32_bf16 v53, v21, v229, v53
    v_dot2_f32_bf16 v54, v37, v197, v54
    v_dot2_f32_bf16 v55, v37, v229, v55
    v_dot2_f32_bf16 v48, v22, v134, v48
    v_dot2_f32_bf16 v49, v22, v166, v49
    v_dot2_f32_bf16 v50, v38, v134, v50
    v_dot2_f32_bf16 v51, v38, v166, v51
    v_dot2_f32_bf16 v52, v22, v198, v52
    v_dot2_f32_bf16 v53, v22, v230, v53
    v_dot2_f32_bf16 v54, v38, v198, v54
    v_dot2_f32_bf16 v55, v38, v230, v55
    v_dot2_f32_bf16 v48, v23, v135, v48
    v_dot2_f32_bf16 v49, v23, v167, v49
    v_dot2_f32_bf16 v50, v39, v135, v50
    v_dot2_f32_bf16 v51, v39, v167, v51
    v_dot2_f32_bf16 v52, v23, v199, v52
    v_dot2_f32_bf16 v53, v23, v231, v53
    v_dot2_f32_bf16 v54, v39, v199, v54
    v_dot2_f32_bf16 v55, v39, v231, v55
    v_dot2_f32_bf16 v48, v24, v136, v48
    v_dot2_f32_bf16 v49, v24, v168, v49
    v_dot2_f32_bf16 v50, v40, v136, v50
    v_dot2_f32_bf16 v51, v40, v168, v51
    v_dot2_f32_bf16 v52, v24, v200, v52
    v_dot2_f32_bf16 v53, v24, v232, v53
    v_dot2_f32_bf16 v54, v40, v200, v54
    v_dot2_f32_bf16 v55, v40, v232, v55
    v_dot2_f32_bf16 v48, v25, v137, v48
    v_dot2_f32_bf16 v49, v25, v169, v49
    v_dot2_f32_bf16 v50, v41, v137, v50
    v_dot2_f32_bf16 v51, v41, v169, v51
    v_dot2_f32_bf16 v52, v25, v201, v52
    v_dot2_f32_bf16 v53, v25, v233, v53
    v_dot2_f32_bf16 v54, v41, v201, v54
    v_dot2_f32_bf16 v55, v41, v233, v55
    v_dot2_f32_bf16 v48, v26, v138, v48
    v_dot2_f32_bf16 v49, v26, v170, v49
    v_dot2_f32_bf16 v50, v42, v138, v50
    v_dot2_f32_bf16 v51, v42, v170, v51
    v_dot2_f32_bf16 v52, v26, v202, v52
    v_dot2_f32_bf16 v53, v26, v234, v53
    v_dot2_f32_bf16 v54, v42, v202, v54
    v_dot2_f32_bf16 v55, v42, v234, v55
    v_dot2_f32_bf16 v48, v27, v139, v48
    v_dot2_f32_bf16 v49, v27, v171, v49
    v_dot2_f32_bf16 v50, v43, v139, v50
    v_dot2_f32_bf16 v51, v43, v171, v51
    v_dot2_f32_bf16 v52, v27, v203, v52
    v_dot2_f32_bf16 v53, v27, v235, v53
    v_dot2_f32_bf16 v54, v43, v203, v54
    v_dot2_f32_bf16 v55, v43, v235, v55
    v_dot2_f32_bf16 v48, v28, v140, v48
    v_dot2_f32_bf16 v49, v28, v172, v49
    v_dot2_f32_bf16 v50, v44, v140, v50
    v_dot2_f32_bf16 v51, v44, v172, v51
    v_dot2_f32_bf16 v52, v28, v204, v52
    v_dot2_f32_bf16 v53, v28, v236, v53
    v_dot2_f32_bf16 v54, v44, v204, v54
    v_dot2_f32_bf16 v55, v44, v236, v55
    v_dot2_f32_bf16 v48, v29, v141, v48
    v_dot2_f32_bf16 v49, v29, v173, v49
    v_dot2_f32_bf16 v50, v45, v141, v50
    v_dot2_f32_bf16 v51, v45, v173, v51
    v_dot2_f32_bf16 v52, v29, v205, v52
    v_dot2_f32_bf16 v53, v29, v237, v53
    v_dot2_f32_bf16 v54, v45, v205, v54
    v_dot2_f32_bf16 v55, v45, v237, v55
    v_dot2_f32_bf16 v48, v30, v142, v48
    v_dot2_f32_bf16 v49, v30, v174, v49
    v_dot2_f32_bf16 v50, v46, v142, v50
    v_dot2_f32_bf16 v51, v46, v174, v51
    v_dot2_f32_bf16 v52, v30, v206, v52
    v_dot2_f32_bf16 v53, v30, v238, v53
    v_dot2_f32_bf16 v54, v46, v206, v54
    v_dot2_f32_bf16 v55, v46, v238, v55
    v_dot2_f32_bf16 v48, v31, v143, v48
    v_dot2_f32_bf16 v49, v31, v175, v49
    v_dot2_f32_bf16 v50, v47, v143, v50
    v_dot2_f32_bf16 v51, v47, v175, v51
    v_dot2_f32_bf16 v52, v31, v207, v52
    v_dot2_f32_bf16 v53, v31, v239, v53
    v_dot2_f32_bf16 v54, v47, v207, v54
    v_dot2_f32_bf16 v55, v47, v239, v55
    ds_read_b128 v[16:19], v8 offset:4160
    ds_read_b128 v[20:23], v8 offset:4176
    ds_read_b128 v[24:27], v8 offset:4192
    ds_read_b128 v[28:31], v8 offset:4208
    ds_read_b128 v[32:35], v8 offset:5184
    ds_read_b128 v[36:39], v8 offset:5200
    ds_read_b128 v[40:43], v8 offset:5216
    ds_read_b128 v[44:47], v8 offset:5232
    s_waitcnt lgkmcnt(0)
    v_dot2_f32_bf16 v48, v16, v144, v48
    v_dot2_f32_bf16 v49, v16, v176, v49
    v_dot2_f32_bf16 v50, v32, v144, v50
    v_dot2_f32_bf16 v51, v32, v176, v51
    v_dot2_f32_bf16 v52, v16, v208, v52
    v_dot2_f32_bf16 v53, v16, v240, v53
    v_dot2_f32_bf16 v54, v32, v208, v54
    v_dot2_f32_bf16 v55, v32, v240, v55
    v_dot2_f32_bf16 v48, v17, v145, v48
    v_dot2_f32_bf16 v49, v17, v177, v49
    v_dot2_f32_bf16 v50, v33, v145, v50
    v_dot2_f32_bf16 v51, v33, v177, v51
    v_dot2_f32_bf16 v52, v17, v209, v52
    v_dot2_f32_bf16 v53, v17, v241, v53
    v_dot2_f32_bf16 v54, v33, v209, v54
    v_dot2_f32_bf16 v55, v33, v241, v55
    v_dot2_f32_bf16 v48, v18, v146, v48
    v_dot2_f32_bf16 v49, v18, v178, v49
    v_dot2_f32_bf16 v50, v34, v146, v50
    v_dot2_f32_bf16 v51, v34, v178, v51
    v_dot2_f32_bf16 v52, v18, v210, v52
    v_dot2_f32_bf16 v53, v18, v242, v53
    v_dot2_f32_bf16 v54, v34, v210, v54
    v_dot2_f32_bf16 v55, v34, v242, v55
    v_dot2_f32_bf16 v48, v19, v147, v48
    v_dot2_f32_bf16 v49, v19, v179, v49
    v_dot2_f32_bf16 v50, v35, v147, v50
    v_dot2_f32_bf16 v51, v35, v179, v51
    v_dot2_f32_bf16 v52, v19, v211, v52
    v_dot2_f32_bf16 v53, v19, v243, v53
    v_dot2_f32_bf16 v54, v35, v211, v54
    v_dot2_f32_bf16 v55, v35, v243, v55
    v_dot2_f32_bf16 v48, v20, v148, v48
    v_dot2_f32_bf16 v49, v20, v180, v49
    v_dot2_f32_bf16 v50, v36, v148, v50
    v_dot2_f32_bf16 v51, v36, v180, v51
    v_dot2_f32_bf16 v52, v20, v212, v52
    v_dot2_f32_bf16 v53, v20, v244, v53
    v_dot2_f32_bf16 v54, v36, v212, v54
    v_dot2_f32_bf16 v55, v36, v244, v55
    v_dot2_f32_bf16 v48, v21, v149, v48
    v_dot2_f32_bf16 v49, v21, v181, v49
    v_dot2_f32_bf16 v50, v37, v149, v50
    v_dot2_f32_bf16 v51, v37, v181, v51
    v_dot2_f32_bf16 v52, v21, v213, v52
    v_dot2_f32_bf16 v53, v21, v245, v53
    v_dot2_f32_bf16 v54, v37, v213, v54
    v_dot2_f32_bf16 v55, v37, v245, v55
    v_dot2_f32_bf16 v48, v22, v150, v48
    v_dot2_f32_bf16 v49, v22, v182, v49
    v_dot2_f32_bf16 v50, v38, v150, v50
    v_dot2_f32_bf16 v51, v38, v182, v51
    v_dot2_f32_bf16 v52, v22, v214, v52
    v_dot2_f32_bf16 v53, v22, v246, v53
    v_dot2_f32_bf16 v54, v38, v214, v54
    v_dot2_f32_bf16 v55, v38, v246, v55
    v_dot2_f32_bf16 v48, v23, v151, v48
    v_dot2_f32_bf16 v49, v23, v183, v49
    v_dot2_f32_bf16 v50, v39, v151, v50
    v_dot2_f32_bf16 v51, v39, v183, v51
    v_dot2_f32_bf16 v52, v23, v215, v52
    v_dot2_f32_bf16 v53, v23, v247, v53
    v_dot2_f32_bf16 v54, v39, v215, v54
    v_dot2_f32_bf16 v55, v39, v247, v55
    v_dot2_f32_bf16 v48, v24, v152, v48
    v_dot2_f32_bf16 v49, v24, v184, v49
    v_dot2_f32_bf16 v50, v40, v152, v50
    v_dot2_f32_bf16 v51, v40, v184, v51
    v_dot2_f32_bf16 v52, v24, v216, v52
    v_dot2_f32_bf16 v53, v24, v248, v53
    v_dot2_f32_bf16 v54, v40, v216, v54
    v_dot2_f32_bf16 v55, v40, v248, v55
    v_dot2_f32_bf16 v48, v25, v153, v48
    v_dot2_f32_bf16 v49, v25, v185, v49
    v_dot2_f32_bf16 v50, v41, v153, v50
    v_dot2_f32_bf16 v51, v41, v185, v51
    v_dot2_f32_bf16 v52, v25, v217, v52
    v_dot2_f32_bf16 v53, v25, v249, v53
    v_dot2_f32_bf16 v54, v41, v217, v54
    v_dot2_f32_bf16 v55, v41, v249, v55
    v_dot2_f32_bf16 v48, v26, v154, v48
    v_dot2_f32_bf16 v49, v26, v186, v49
    v_dot2_f32_bf16 v50, v42, v154, v50
    v_dot2_f32_bf16 v51, v42, v186, v51
    v_dot2_f32_bf16 v52, v26, v218, v52
    v_dot2_f32_bf16 v53, v26, v250, v53
    v_dot2_f32_bf16 v54, v42, v218, v54
    v_dot2_f32_bf16 v55, v42, v250, v55
    v_dot2_f32_bf16 v48, v27, v155, v48
    v_dot2_f32_bf16 v49, v27, v187, v49
    v_dot2_f32_bf16 v50, v43, v155, v50
    v_dot2_f32_bf16 v51, v43, v187, v51
    v_dot2_f32_bf16 v52, v27, v219, v52
    v_dot2_f32_bf16 v53, v27, v251, v53
    v_dot2_f32_bf16 v54, v43, v219, v54
    v_dot2_f32_bf16 v55, v43, v251, v55
    v_dot2_f32_bf16 v48, v28, v156, v48
    v_dot2_f32_bf16 v49, v28, v188, v49
    v_dot2_f32_bf16 v50, v44, v156, v50
    v_dot2_f32_bf16 v51, v44, v188, v51
    v_dot2_f32_bf16 v52, v28, v220, v52
    v_dot2_f32_bf16 v53, v28, v252, v53
    v_dot2_f32_bf16 v54, v44, v220, v54
    v_dot2_f32_bf16 v55, v44, v252, v55
    v_dot2_f32_bf16 v48, v29, v157, v48
    v_dot2_f32_bf16 v49, v29, v189, v49
    v_dot2_f32_bf16 v50, v45, v157, v50
    v_dot2_f32_bf16 v51, v45, v189, v51
    v_dot2_f32_bf16 v52, v29, v221, v52
    v_dot2_f32_bf16 v53, v29, v253, v53
    v_dot2_f32_bf16 v54, v45, v221, v54
    v_dot2_f32_bf16 v55, v45, v253, v55
    v_dot2_f32_bf16 v48, v30, v158, v48
    v_dot2_f32_bf16 v49, v30, v190, v49
    v_dot2_f32_bf16 v50, v46, v158, v50
    v_dot2_f32_bf16 v51, v46, v190, v51
    v_dot2_f32_bf16 v52, v30, v222, v52
    v_dot2_f32_bf16 v53, v30, v254, v53
    v_dot2_f32_bf16 v54, v46, v222, v54
    v_dot2_f32_bf16 v55, v46, v254, v55
    v_dot2_f32_bf16 v48, v31, v159, v48
    v_dot2_f32_bf16 v49, v31, v191, v49
    v_dot2_f32_bf16 v50, v47, v159, v50
    v_dot2_f32_bf16 v51, v47, v191, v51
    v_dot2_f32_bf16 v52, v31, v223, v52
    v_dot2_f32_bf16 v53, v31, v255, v53
    v_dot2_f32_bf16 v54, v47, v223, v54
    v_dot2_f32_bf16 v55, v47, v255, v55
    s_nop 3
    v_lshlrev_b32 v7, 5, v0
    ds_write_b128 v7, v[48:51] offset:8192
    ds_write_b128 v7, v[52:55] offset:8208
    s_waitcnt lgkmcnt(0)
    s_barrier
    v_lshlrev_b32 v7, 5, v2
    v_bfe_u32 v8, v0, 5, 1
    v_lshl_add_u32 v7, v8, 3, v7
    ds_read_b64 v[16:17], v7 offset:8192
    ds_read_b64 v[18:19], v7 offset:8208
    ds_read_b64 v[20:21], v7 offset:9216
    ds_read_b64 v[22:23], v7 offset:9232
    ds_read_b64 v[24:25], v7 offset:10240
    ds_read_b64 v[26:27], v7 offset:10256
    ds_read_b64 v[28:29], v7 offset:11264
    ds_read_b64 v[30:31], v7 offset:11280
    s_waitcnt lgkmcnt(0)
    ds_read_b64 v[32:33], v7 offset:12288
    ds_read_b64 v[34:35], v7 offset:12304
    ds_read_b64 v[36:37], v7 offset:13312
    ds_read_b64 v[38:39], v7 offset:13328
    ds_read_b64 v[40:41], v7 offset:14336
    ds_read_b64 v[42:43], v7 offset:14352
    ds_read_b64 v[44:45], v7 offset:15360
    ds_read_b64 v[46:47], v7 offset:15376
    s_waitcnt lgkmcnt(0)
    v_add_f32 v16, v16, v20
    v_add_f32 v16, v16, v24
    v_add_f32 v16, v16, v28
    v_add_f32 v16, v16, v32
    v_add_f32 v16, v16, v36
    v_add_f32 v16, v16, v40
    v_add_f32 v16, v16, v44
    v_cvt_pk_bf16_f32 v5, v16, v16
    v_lshlrev_b32 v16, 16, v5
    v_add_f32 v17, v17, v21
    v_add_f32 v17, v17, v25
    v_add_f32 v17, v17, v29
    v_add_f32 v17, v17, v33
    v_add_f32 v17, v17, v37
    v_add_f32 v17, v17, v41
    v_add_f32 v17, v17, v45
    v_cvt_pk_bf16_f32 v5, v17, v17
    v_lshlrev_b32 v17, 16, v5
    v_add_f32 v18, v18, v22
    v_add_f32 v18, v18, v26
    v_add_f32 v18, v18, v30
    v_add_f32 v18, v18, v34
    v_add_f32 v18, v18, v38
    v_add_f32 v18, v18, v42
    v_add_f32 v18, v18, v46
    v_cvt_pk_bf16_f32 v5, v18, v18
    v_lshlrev_b32 v18, 16, v5
    v_add_f32 v19, v19, v23
    v_add_f32 v19, v19, v27
    v_add_f32 v19, v19, v31
    v_add_f32 v19, v19, v35
    v_add_f32 v19, v19, v39
    v_add_f32 v19, v19, v43
    v_add_f32 v19, v19, v47
    v_cvt_pk_bf16_f32 v5, v19, v19
    v_lshlrev_b32 v19, 16, v5
    v_mul_f32 v6, 0xbfb8aa3b, v16
    v_exp_f32 v6, v6
    s_nop 0
    v_add_f32 v6, 1.0, v6
    v_rcp_f32 v6, v6
    s_nop 0
    v_mul_f32 v16, v16, v6
    v_cvt_pk_bf16_f32 v5, v16, v16
    v_lshlrev_b32 v16, 16, v5
    v_mul_f32 v16, v16, v18
    v_mul_f32 v6, 0xbfb8aa3b, v17
    v_exp_f32 v6, v6
    s_nop 0
    v_add_f32 v6, 1.0, v6
    v_rcp_f32 v6, v6
    s_nop 0
    v_mul_f32 v17, v17, v6
    v_cvt_pk_bf16_f32 v5, v17, v17
    v_lshlrev_b32 v17, 16, v5
    v_mul_f32 v17, v17, v19
    v_cvt_pk_bf16_f32 v16, v16, v17
    v_mul_u32_u24 v8, 3584, v8
    v_lshl_add_u32 v7, v2, 2, v8
    v_mov_b32 v6, 0x40000000
    v_cmp_lt_u32 vcc, 27, v2
    s_nop 1
    v_cndmask_b32 v7, v7, v6, vcc
    v_cmp_lt_u32 vcc, 63, v0
    s_nop 1
    v_cndmask_b32 v7, v7, v6, vcc
    s_mul_i32 s37, s24, 8192
    s_add_u32 s37, s37, 0x1b0000
    s_add_u32 s36, s37, s23
    buffer_store_dword v16, v7, s[8:11], s36 offen sc1
    v_lshlrev_b32 v7, 4, v0
    v_add_u32 v8, 4096, v7
    v_cmp_lt_u32 vcc, 191, v0
    s_nop 1
    v_cndmask_b32 v8, v8, v6, vcc
L_M_act:
    buffer_load_dwordx4 v[20:23], v7, s[8:11], s37 offen sc1
    buffer_load_dwordx4 v[24:27], v8, s[8:11], s37 offen sc1
    s_add_u32 s32, s32, 1
    s_cmp_gt_u32 s32, 200000
    s_waitcnt vmcnt(0)
    v_max3_u32 v5, v20, v21, v22
    v_max3_u32 v5, v5, v23, v24
    v_max3_u32 v5, v5, v25, v26
    v_max_u32 v5, v5, v27
    s_cbranch_scc1 L_M_act_ok
    v_cmp_eq_u32 vcc, -1, v5
    s_cbranch_vccnz L_M_act
L_M_act_ok:
    ds_write_b128 v7, v[20:23] offset:16384
    ds_write_b128 v7, v[24:27] offset:20480
    s_waitcnt lgkmcnt(0)
    s_barrier
    v_lshrrev_b32 v7, 3, v0
    v_mul_u32_u24 v7, 112, v7
    v_mov_b64 v[48:49], 0
    v_mov_b64 v[50:51], 0
    ds_read_b128 v[16:19], v7 offset:16384
    ds_read_b128 v[20:23], v7 offset:16400
    ds_read_b128 v[24:27], v7 offset:16416
    ds_read_b128 v[28:31], v7 offset:16432
    ds_read_b128 v[32:35], v7 offset:16448
    ds_read_b128 v[36:39], v7 offset:16464
    ds_read_b128 v[40:43], v7 offset:16480
    s_waitcnt lgkmcnt(0)
    v_dot2_f32_bf16 v48, v16, v64, v48
    v_dot2_f32_bf16 v49, v16, v92, v49
    v_dot2_f32_bf16 v48, v17, v65, v48
    v_dot2_f32_bf16 v49, v17, v93, v49
    v_dot2_f32_bf16 v48, v18, v66, v48
    v_dot2_f32_bf16 v49, v18, v94, v49
    v_dot2_f32_bf16 v48, v19, v67, v48
    v_dot2_f32_bf16 v49, v19, v95, v49
    v_dot2_f32_bf16 v48, v20, v68, v48
    v_dot2_f32_bf16 v49, v20, v96, v49
    v_dot2_f32_bf16 v48, v21, v69, v48
    v_dot2_f32_bf16 v49, v21, v97, v49
    v_dot2_f32_bf16 v48, v22, v70, v48
    v_dot2_f32_bf16 v49, v22, v98, v49
    v_dot2_f32_bf16 v48, v23, v71, v48
    v_dot2_f32_bf16 v49, v23, v99, v49
    v_dot2_f32_bf16 v48, v24, v72, v48
    v_dot2_f32_bf16 v49, v24, v100, v49
    v_dot2_f32_bf16 v48, v25, v73, v48
    v_dot2_f32_bf16 v49, v25, v101, v49
    v_dot2_f32_bf16 v48, v26, v74, v48
    v_dot2_f32_bf16 v49, v26, v102, v49
    v_dot2_f32_bf16 v48, v27, v75, v48
    v_dot2_f32_bf16 v49, v27, v103, v49
    v_dot2_f32_bf16 v48, v28, v76, v48
    v_dot2_f32_bf16 v49, v28, v104, v49
    v_dot2_f32_bf16 v48, v29, v77, v48
    v_dot2_f32_bf16 v49, v29, v105, v49
    v_dot2_f32_bf16 v48, v30, v78, v48
    v_dot2_f32_bf16 v49, v30, v106, v49
    v_dot2_f32_bf16 v48, v31, v79, v48
    v_dot2_f32_bf16 v49, v31, v107, v49
    v_dot2_f32_bf16 v48, v32, v80, v48
    v_dot2_f32_bf16 v49, v32, v108, v49
    v_dot2_f32_bf16 v48, v33, v81, v48
    v_dot2_f32_bf16 v49, v33, v109, v49
    v_dot2_f32_bf16 v48, v34, v82, v48
    v_dot2_f32_bf16 v49, v34, v110, v49
    v_dot2_f32_bf16 v48, v35, v83, v48
    v_dot2_f32_bf16 v49, v35, v111, v49
    v_dot2_f32_bf16 v48, v36, v84, v48
    v_dot2_f32_bf16 v49, v36, v112, v49
    v_dot2_f32_bf16 v48, v37, v85, v48
    v_dot2_f32_bf16 v49, v37, v113, v49
    v_dot2_f32_bf16 v48, v38, v86, v48
    v_dot2_f32_bf16 v49, v38, v114, v49
    v_dot2_f32_bf16 v48, v39, v87, v48
    v_dot2_f32_bf16 v49, v39, v115, v49
    v_dot2_f32_bf16 v48, v40, v88, v48
    v_dot2_f32_bf16 v49, v40, v116, v49
    v_dot2_f32_bf16 v48, v41, v89, v48
    v_dot2_f32_bf16 v49, v41, v117, v49
    v_dot2_f32_bf16 v48, v42, v90, v48
    v_dot2_f32_bf16 v49, v42, v118, v49
    v_dot2_f32_bf16 v48, v43, v91, v48
    v_dot2_f32_bf16 v49, v43, v119, v49
    ds_read_b128 v[16:19], v7 offset:19968
    ds_read_b128 v[20:23], v7 offset:19984
    ds_read_b128 v[24:27], v7 offset:20000
    ds_read_b128 v[28:31], v7 offset:20016
    ds_read_b128 v[32:35], v7 offset:20032
    ds_read_b128 v[36:39], v7 offset:20048
    ds_read_b128 v[40:43], v7 offset:20064
    s_waitcnt lgkmcnt(0)
    v_dot2_f32_bf16 v50, v16, v64, v50
    v_dot2_f32_bf16 v51, v16, v92, v51
    v_dot2_f32_bf16 v50, v17, v65, v50
    v_dot2_f32_bf16 v51, v17, v93, v51
    v_dot2_f32_bf16 v50, v18, v66, v50
    v_dot2_f32_bf16 v51, v18, v94, v51
    v_dot2_f32_bf16 v50, v19, v67, v50
    v_dot2_f32_bf16 v51, v19, v95, v51
    v_dot2_f32_bf16 v50, v20, v68, v50
    v_dot2_f32_bf16 v51, v20, v96, v51
    v_dot2_f32_bf16 v50, v21, v69, v50
    v_dot2_f32_bf16 v51, v21, v97, v51
    v_dot2_f32_bf16 v50, v22, v70, v50
    v_dot2_f32_bf16 v51, v22, v98, v51
    v_dot2_f32_bf16 v50, v23, v71, v50
    v_dot2_f32_bf16 v51, v23, v99, v51
    v_dot2_f32_bf16 v50, v24, v72, v50
    v_dot2_f32_bf16 v51, v24, v100, v51
    v_dot2_f32_bf16 v50, v25, v73, v50
    v_dot2_f32_bf16 v51, v25, v101, v51
    v_dot2_f32_bf16 v50, v26, v74, v50
    v_dot2_f32_bf16 v51, v26, v102, v51
    v_dot2_f32_bf16 v50, v27, v75, v50
    v_dot2_f32_bf16 v51, v27, v103, v51
    v_dot2_f32_bf16 v50, v28, v76, v50
    v_dot2_f32_bf16 v51, v28, v104, v51
    v_dot2_f32_bf16 v50, v29, v77, v50
    v_dot2_f32_bf16 v51, v29, v105, v51
    v_dot2_f32_bf16 v50, v30, v78, v50
    v_dot2_f32_bf16 v51, v30, v106, v51
    v_dot2_f32_bf16 v50, v31, v79, v50
    v_dot2_f32_bf16 v51, v31, v107, v51
    v_dot2_f32_bf16 v50, v32, v80, v50
    v_dot2_f32_bf16 v51, v32, v108, v51
    v_dot2_f32_bf16 v50, v33, v81, v50
    v_dot2_f32_bf16 v51, v33, v109, v51
    v_dot2_f32_bf16 v50, v34, v82, v50
    v_dot2_f32_bf16 v51, v34, v110, v51
    v_dot2_f32_bf16 v50, v35, v83, v50
    v_dot2_f32_bf16 v51, v35, v111, v51
    v_dot2_f32_bf16 v50, v36, v84, v50
    v_dot2_f32_bf16 v51, v36, v112, v51
    v_dot2_f32_bf16 v50, v37, v85, v50
    v_dot2_f32_bf16 v51, v37, v113, v51
    v_dot2_f32_bf16 v50, v38, v86, v50
    v_dot2_f32_bf16 v51, v38, v114, v51
    v_dot2_f32_bf16 v50, v39, v87, v50
    v_dot2_f32_bf16 v51, v39, v115, v51
    v_dot2_f32_bf16 v50, v40, v88, v50
    v_dot2_f32_bf16 v51, v40, v116, v51
    v_dot2_f32_bf16 v50, v41, v89, v50
    v_dot2_f32_bf16 v51, v41, v117, v51
    v_dot2_f32_bf16 v50, v42, v90, v50
    v_dot2_f32_bf16 v51, v42, v118, v51
    v_dot2_f32_bf16 v50, v43, v91, v50
    v_dot2_f32_bf16 v51, v43, v119, v51
    s_nop 3
    v_add_f32_dpp v48, v48, v48 row_ror:8 row_mask:0xf bank_mask:0xf
    v_add_f32_dpp v49, v49, v49 row_ror:8 row_mask:0xf bank_mask:0xf
    v_add_f32_dpp v50, v50, v50 row_ror:8 row_mask:0xf bank_mask:0xf
    v_add_f32_dpp v51, v51, v51 row_ror:8 row_mask:0xf bank_mask:0xf
    v_mov_b32 v5, v48
    s_nop 1
    v_permlane16_swap_b32 v48, v5
    v_add_f32 v48, v48, v5
    v_mov_b32 v5, v49
    s_nop 1
    v_permlane16_swap_b32 v49, v5
    v_add_f32 v49, v49, v5
    v_mov_b32 v5, v50
    s_nop 1
    v_permlane16_swap_b32 v50, v5
    v_add_f32 v50, v50, v5
    v_mov_b32 v5, v51
    s_nop 1
    v_permlane16_swap_b32 v51, v5
    v_add_f32 v51, v51, v5
    v_mov_b32 v5, v48
    s_nop 1
    v_permlane32_swap_b32 v48, v5
    v_add_f32 v48, v48, v5
    v_mov_b32 v5, v49
    s_nop 1
    v_permlane32_swap_b32 v49, v5
    v_add_f32 v49, v49, v5
    v_mov_b32 v5, v50
    s_nop 1
    v_permlane32_swap_b32 v50, v5
    v_add_f32 v50, v50, v5
    v_mov_b32 v5, v51
    s_nop 1
    v_permlane32_swap_b32 v51, v5
    v_add_f32 v51, v51, v5
    v_lshrrev_b32 v7, 6, v0
    v_lshlrev_b32 v7, 7, v7
    v_lshl_add_u32 v7, v3, 4, v7
    ds_write_b128 v7, v[48:51] offset:1024
    s_waitcnt lgkmcnt(0)
    s_barrier
    v_lshlrev_b32 v7, 4, v3
    v_lshl_add_u32 v7, v9, 3, v7
    ds_read_b64 v[16:17], v7 offset:1024
    ds_read_b64 v[18:19], v7 offset:1152
    ds_read_b64 v[20:21], v7 offset:1280
    ds_read_b64 v[22:23], v7 offset:1408
    v_mul_f32 v10, 0xbfb8aa3b, v11
    v_exp_f32 v10, v10
    s_nop 0
    v_add_f32 v10, 1.0, v10
    v_rcp_f32 v10, v10
    s_nop 0
    v_cvt_pk_bf16_f32 v5, v10, v10
    v_lshlrev_b32 v10, 16, v5
    s_waitcnt lgkmcnt(0)
    v_lshlrev_b32 v24, 16, v15
    v_and_b32 v25, 0xffff0000, v15
    v_lshlrev_b32 v26, 16, v14
    v_and_b32 v27, 0xffff0000, v14
    v_add_f32 v16, v16, v18
    v_add_f32 v20, v20, v22
    v_add_f32 v16, v16, v20
    v_cvt_pk_bf16_f32 v5, v16, v16
    v_lshlrev_b32 v16, 16, v5
    v_mul_f32 v16, v16, v10
    v_cvt_pk_bf16_f32 v5, v16, v16
    v_lshlrev_b32 v16, 16, v5
    v_add_f32 v16, v16, v24
    v_cvt_pk_bf16_f32 v5, v16, v16
    v_lshlrev_b32 v16, 16, v5
    v_add_f32 v16, v16, v26
    v_add_f32 v17, v17, v19
    v_add_f32 v21, v21, v23
    v_add_f32 v17, v17, v21
    v_cvt_pk_bf16_f32 v5, v17, v17
    v_lshlrev_b32 v17, 16, v5
    v_mul_f32 v17, v17, v10
    v_cvt_pk_bf16_f32 v5, v17, v17
    v_lshlrev_b32 v17, 16, v5
    v_add_f32 v17, v17, v25
    v_cvt_pk_bf16_f32 v5, v17, v17
    v_lshlrev_b32 v17, 16, v5
    v_add_f32 v17, v17, v27
    v_cvt_pk_bf16_f32 v16, v16, v17
    buffer_store_dword v16, v12, s[60:63], 0 offen sc1
    v_add_f32 v24, v24, v26
    v_add_f32 v25, v25, v27
    v_cvt_pk_bf16_f32 v13, v24, v25
L_M_next:
    s_add_u32 s24, s24, 1
    s_mov_b32 s25, 192
    s_cmp_eq_u32 s24, 1
    s_cbranch_scc1 L_M_round
    s_cmp_eq_u32 s24, 3
    s_cbranch_scc1 L_end
    s_mov_b32 s25, 256
    v_and_b32 v7, 63, v0
    v_lshlrev_b32 v3, 4, v7
    s_mov_b32 s36, 0x19bc00
    v_sub_u32 v7, 63, v7
L_M_fin:
    buffer_load_dwordx4 v[16:19], v3, s[8:11], s36 offen sc1
    s_add_u32 s32, s32, 1
    s_cmp_gt_u32 s32, 200000
    s_cselect_b32 s37, -1, -2
    s_waitcnt vmcnt(0)
    v_max3_u32 v5, v16, v17, v18
    v_max_u32 v5, v5, v19
    v_cmp_lt_u32 vcc, s37, v5
    s_cbranch_vccnz L_M_fin
    v_add_f32 v16, v16, v17
    v_add_f32 v18, v18, v19
    v_add_f32 v16, v16, v18
    v_cvt_pk_bf16_f32 v5, v16, v16
    v_lshlrev_b32 v16, 16, v5
    v_ashrrev_i32 v5, 31, v16
    v_or_b32 v5, 0x80000000, v5
    v_xor_b32 v5, v5, v16
    v_and_or_b32 v5, v5, s42, v7
    v_cmp_lt_u32 vcc, s29, v5
    s_cbranch_vccnz L_M_round
L_end:
    s_endpgm
.section .rodata,"a"
.p2align 6
.amdhsa_kernel sequential_preLN__memory_aug_recurrent_mem_tr__moe_arch_mod__prompt_kernel
  .amdhsa_next_free_vgpr 512
  .amdhsa_next_free_sgpr 102
  .amdhsa_accum_offset 256
  .amdhsa_group_segment_fixed_size 0
  .amdhsa_kernarg_size 120
  .amdhsa_user_sgpr_count 2
  .amdhsa_user_sgpr_kernarg_segment_ptr 1
  .amdhsa_system_sgpr_workgroup_id_x 1
.end_amdhsa_kernel
```

```asm
; @launch grid=(256,1,1) block=(256,1,1) lds=163840
.amdgcn_target "amdgcn-amd-amdhsa--gfx950"
.text
.globl sequential_preLN__memory_aug_recurrent_mem_tr__moe_arch_mod__prompt_kernel
.p2align 8
.type sequential_preLN__memory_aug_recurrent_mem_tr__moe_arch_mod__prompt_kernel,@function
sequential_preLN__memory_aug_recurrent_mem_tr__moe_arch_mod__prompt_kernel:
    s_cmp_ge_u32 s2, 256
    s_cbranch_scc1 L_end
    s_load_dwordx8 s[44:51], s[0:1], 0
    s_load_dwordx4 s[52:55], s[0:1], 32
    s_load_dwordx4 s[56:59], s[0:1], 104
    s_load_dwordx2 s[80:81], s[0:1], 64
    s_load_dwordx2 s[82:83], s[0:1], 96
    s_load_dwordx4 s[84:87], s[0:1], 72
    s_load_dwordx2 s[88:89], s[0:1], 88
    v_lshrrev_b32 v1, 6, v0
    s_nop 0
    v_readfirstlane_b32 s21, v1
    s_waitcnt lgkmcnt(0)
    s_mov_b32 s8, s58
    s_and_b32 s9, s59, 0xffff
    s_mov_b32 s10, 0x10000000
    s_mov_b32 s11, 0x20000
    s_mov_b32 s16, s56
    s_and_b32 s17, s57, 0xffff
    s_mov_b32 s18, 0x100
    s_mov_b32 s19, 0x20000
    s_and_b32 s3, s2, 7
    s_cmp_lg_u32 s3, 0
    s_cbranch_scc1 L_worker
    s_lshr_b32 s20, s2, 3
    v_lshrrev_b32 v28, 4, v0
    v_and_b32 v16, 15, v0
    v_lshlrev_b32 v16, 4, v16
    v_lshl_add_u32 v16, v28, 13, v16
    v_bfe_u32 v29, v0, 4, 1
    v_lshlrev_b32 v29, 5, v29
    v_xor_b32 v16, v16, v29
    v_and_b32 v29, 192, v0
    v_xor_b32 v16, v16, v29
    s_lshl_b32 s28, s21, 10
    s_lshl_b32 s3, s20, 8
    s_mov_b32 s60, s52
    s_and_b32 s61, s53, 0xffff
    s_mov_b32 s62, 0x400000
    s_mov_b32 s63, 0x20000
    s_add_u32 m0, s28, 32768
    s_add_u32 s37, s3, 0x0
    buffer_load_dwordx4 v16, s[60:63], s37 offen lds
    s_add_u32 m0, s28, 36864
    s_add_u32 s37, s3, 0x20000
    buffer_load_dwordx4 v16, s[60:63], s37 offen lds
    s_add_u32 m0, s28, 65536
    s_add_u32 s37, s3, 0x40000
    buffer_load_dwordx4 v16, s[60:63], s37 offen lds
    s_add_u32 m0, s28, 69632
    s_add_u32 s37, s3, 0x60000
    buffer_load_dwordx4 v16, s[60:63], s37 offen lds
    s_add_u32 m0, s28, 98304
    s_add_u32 s37, s3, 0x80000
    buffer_load_dwordx4 v16, s[60:63], s37 offen lds
    s_add_u32 m0, s28, 102400
    s_add_u32 s37, s3, 0xa0000
    buffer_load_dwordx4 v16, s[60:63], s37 offen lds
    s_add_u32 m0, s28, 131072
    s_add_u32 s37, s3, 0xc0000
    buffer_load_dwordx4 v16, s[60:63], s37 offen lds
    s_add_u32 m0, s28, 135168
    s_add_u32 s37, s3, 0xe0000
    buffer_load_dwordx4 v16, s[60:63], s37 offen lds
    s_add_u32 m0, s28, 40960
    s_add_u32 s37, s3, 0x100000
    buffer_load_dwordx4 v16, s[60:63], s37 offen lds
    s_add_u32 m0, s28, 45056
    s_add_u32 s37, s3, 0x120000
    buffer_load_dwordx4 v16, s[60:63], s37 offen lds
    s_add_u32 m0, s28, 73728
    s_add_u32 s37, s3, 0x140000
    buffer_load_dwordx4 v16, s[60:63], s37 offen lds
    s_add_u32 m0, s28, 77824
    s_add_u32 s37, s3, 0x160000
    buffer_load_dwordx4 v16, s[60:63], s37 offen lds
    s_add_u32 m0, s28, 106496
    s_add_u32 s37, s3, 0x180000
    buffer_load_dwordx4 v16, s[60:63], s37 offen lds
    s_add_u32 m0, s28, 110592
    s_add_u32 s37, s3, 0x1a0000
    buffer_load_dwordx4 v16, s[60:63], s37 offen lds
    s_add_u32 m0, s28, 139264
    s_add_u32 s37, s3, 0x1c0000
    buffer_load_dwordx4 v16, s[60:63], s37 offen lds
    s_add_u32 m0, s28, 143360
    s_add_u32 s37, s3, 0x1e0000
    buffer_load_dwordx4 v16, s[60:63], s37 offen lds
    s_add_u32 m0, s28, 49152
    s_add_u32 s37, s3, 0x200000
    buffer_load_dwordx4 v16, s[60:63], s37 offen lds
    s_add_u32 m0, s28, 53248
    s_add_u32 s37, s3, 0x220000
    buffer_load_dwordx4 v16, s[60:63], s37 offen lds
    s_add_u32 m0, s28, 81920
    s_add_u32 s37, s3, 0x240000
    buffer_load_dwordx4 v16, s[60:63], s37 offen lds
    s_add_u32 m0, s28, 86016
    s_add_u32 s37, s3, 0x260000
    buffer_load_dwordx4 v16, s[60:63], s37 offen lds
    s_add_u32 m0, s28, 114688
    s_add_u32 s37, s3, 0x280000
    buffer_load_dwordx4 v16, s[60:63], s37 offen lds
    s_add_u32 m0, s28, 118784
    s_add_u32 s37, s3, 0x2a0000
    buffer_load_dwordx4 v16, s[60:63], s37 offen lds
    s_add_u32 m0, s28, 147456
    s_add_u32 s37, s3, 0x2c0000
    buffer_load_dwordx4 v16, s[60:63], s37 offen lds
    s_add_u32 m0, s28, 151552
    s_add_u32 s37, s3, 0x2e0000
    buffer_load_dwordx4 v16, s[60:63], s37 offen lds
    v_mov_b32 v20, 0x0
    v_bfe_u32 v14, v0, 0, 1
    s_mov_b32 s38, 0x8
    v_mad_u32_u24 v20, v14, s38, v20
    v_bfe_u32 v14, v0, 1, 1
    s_mov_b32 s38, 0x10
    v_mad_u32_u24 v20, v14, s38, v20
    v_bfe_u32 v14, v0, 2, 1
    s_mov_b32 s38, 0x100
    v_mad_u32_u24 v20, v14, s38, v20
    v_bfe_u32 v14, v0, 3, 1
    s_mov_b32 s38, 0x800
    v_mad_u32_u24 v20, v14, s38, v20
    v_bfe_u32 v14, v0, 4, 1
    s_mov_b32 s38, 0x400
    v_mad_u32_u24 v20, v14, s38, v20
    v_bfe_u32 v14, v0, 5, 1
    s_mov_b32 s38, 0x1000
    v_mad_u32_u24 v20, v14, s38, v20
    v_mov_b32 v30, 0x0
    v_bfe_u32 v14, v0, 2, 1
    s_mov_b32 s38, 0x20
    v_mad_u32_u24 v30, v14, s38, v30
    v_bfe_u32 v14, v0, 3, 1
    s_mov_b32 s38, 0x80
    v_mad_u32_u24 v30, v14, s38, v30
    v_bfe_u32 v14, v0, 4, 1
    s_mov_b32 s38, 0x40
    v_mad_u32_u24 v30, v14, s38, v30
    v_mov_b32 v31, 0x0
    v_bfe_u32 v14, v0, 6, 1
    s_mov_b32 s38, 0x40
    v_mad_u32_u24 v31, v14, s38, v31
    v_bfe_u32 v14, v0, 7, 1
    s_mov_b32 s38, 0x80
    v_mad_u32_u24 v31, v14, s38, v31
    v_xor_b32 v30, v30, v31
    v_add_u32 v30, v30, v20
    s_xor_b32 s36, s21, 0
    s_add_u32 s36, s36, 1
    s_lshl_b32 s36, s36, 15
    v_add_u32 v20, s36, v30
    v_xor_b32 v21, 32, v20
    s_xor_b32 s36, s21, 1
    s_add_u32 s36, s36, 1
    s_lshl_b32 s36, s36, 15
    v_add_u32 v22, s36, v30
    v_xor_b32 v23, 32, v22
    s_xor_b32 s36, s21, 2
    s_add_u32 s36, s36, 1
    s_lshl_b32 s36, s36, 15
    v_add_u32 v24, s36, v30
    v_xor_b32 v25, 32, v24
    s_xor_b32 s36, s21, 3
    s_add_u32 s36, s36, 1
    s_lshl_b32 s36, s36, 15
    v_add_u32 v26, s36, v30
    v_xor_b32 v27, 32, v26
    v_mov_b32 v11, 0x0
    v_bfe_u32 v14, v0, 0, 1
    s_mov_b32 s38, 0x4
    v_mad_u32_u24 v11, v14, s38, v11
    v_bfe_u32 v14, v0, 1, 1
    s_mov_b32 s38, 0x8
    v_mad_u32_u24 v11, v14, s38, v11
    v_bfe_u32 v14, v0, 2, 1
    s_mov_b32 s38, 0x10
    v_mad_u32_u24 v11, v14, s38, v11
    v_bfe_u32 v14, v0, 3, 1
    s_mov_b32 s38, 0x20
    v_mad_u32_u24 v11, v14, s38, v11
    v_bfe_u32 v14, v0, 4, 1
    s_mov_b32 s38, 0x800
    v_mad_u32_u24 v11, v14, s38, v11
    v_bfe_u32 v14, v0, 5, 1
    s_mov_b32 s38, 0x1000
    v_mad_u32_u24 v11, v14, s38, v11
    v_bfe_u32 v14, v0, 6, 1
    s_mov_b32 s38, 0x100
    v_mad_u32_u24 v11, v14, s38, v11
    v_bfe_u32 v14, v0, 7, 1
    s_mov_b32 s38, 0x200
    v_mad_u32_u24 v11, v14, s38, v11
    s_mov_b32 s92, s54
    s_and_b32 s93, s55, 0xffff
    s_mov_b32 s94, 0x400000
    s_mov_b32 s95, 0x20000
    s_lshl_b32 s29, s20, 17
    s_xor_b32 s36, s21, 3
    s_lshl_b32 s36, s36, 15
    s_add_u32 s36, s36, s29
    s_add_u32 s37, s36, 0x80
    buffer_load_dword v32, v11, s[92:95], s37 offen
    s_add_u32 s37, s36, 0x4080
    buffer_load_dword v33, v11, s[92:95], s37 offen
    s_add_u32 s37, s36, 0x480
    buffer_load_dword v34, v11, s[92:95], s37 offen
    s_add_u32 s37, s36, 0x4480
    buffer_load_dword v35, v11, s[92:95], s37 offen
    s_add_u32 s37, s36, 0x2080
    buffer_load_dword v36, v11, s[92:95], s37 offen
    s_add_u32 s37, s36, 0x6080
    buffer_load_dword v37, v11, s[92:95], s37 offen
    s_add_u32 s37, s36, 0x2480
    buffer_load_dword v38, v11, s[92:95], s37 offen
    s_add_u32 s37, s36, 0x6480
    buffer_load_dword v39, v11, s[92:95], s37 offen
    s_add_u32 s37, s36, 0xc0
    buffer_load_dword v40, v11, s[92:95], s37 offen
    s_add_u32 s37, s36, 0x40c0
    buffer_load_dword v41, v11, s[92:95], s37 offen
    s_add_u32 s37, s36, 0x4c0
    buffer_load_dword v42, v11, s[92:95], s37 offen
    s_add_u32 s37, s36, 0x44c0
    buffer_load_dword v43, v11, s[92:95], s37 offen
    s_add_u32 s37, s36, 0x20c0
    buffer_load_dword v44, v11, s[92:95], s37 offen
    s_add_u32 s37, s36, 0x60c0
    buffer_load_dword v45, v11, s[92:95], s37 offen
    s_add_u32 s37, s36, 0x24c0
    buffer_load_dword v46, v11, s[92:95], s37 offen
    s_add_u32 s37, s36, 0x64c0
    buffer_load_dword v47, v11, s[92:95], s37 offen
    s_getreg_b32 s36, hwreg(HW_REG_XCC_ID)
    s_and_b32 s36, s36, 15
    s_or_b32 s36, s36, 0x100
    v_mov_b32 v30, s36
    s_lshl_b32 s37, s20, 2
    v_lshlrev_b32 v31, 20, v0
    buffer_store_dword v30, v31, s[16:19], s37 offen offset:128 sc1
    s_mov_b32 s12, s46
    s_and_b32 s13, s47, 0xffff
    s_mov_b32 s14, 0x2000
    s_mov_b32 s15, 0x20000
    v_mov_b32 v104, 0x0
    v_bfe_u32 v14, v0, 0, 1
    s_mov_b32 s38, 0x8
    v_mad_u32_u24 v104, v14, s38, v104
    v_bfe_u32 v14, v0, 1, 1
    s_mov_b32 s38, 0x10
    v_mad_u32_u24 v104, v14, s38, v104
    v_bfe_u32 v14, v0, 2, 1
    s_mov_b32 s38, 0x10000
    v_mad_u32_u24 v104, v14, s38, v104
    v_bfe_u32 v14, v0, 3, 1
    s_mov_b32 s38, 0x10000
    v_mad_u32_u24 v104, v14, s38, v104
    v_bfe_u32 v14, v0, 4, 1
    s_mov_b32 s38, 0x400
    v_mad_u32_u24 v104, v14, s38, v104
    v_bfe_u32 v14, v0, 5, 1
    s_mov_b32 s38, 0x4
    v_mad_u32_u24 v104, v14, s38, v104
    v_bfe_u32 v14, v0, 6, 1
    s_mov_b32 s38, 0x40
    v_mad_u32_u24 v104, v14, s38, v104
    v_bfe_u32 v14, v0, 7, 1
    s_mov_b32 s38, 0x80
    v_mad_u32_u24 v104, v14, s38, v104
    v_mov_b32 v106, s20
    v_mov_b32 v105, 0x0
    v_bfe_u32 v14, v106, 0, 1
    s_mov_b32 s38, 0x20
    v_mad_u32_u24 v105, v14, s38, v105
    v_bfe_u32 v14, v106, 1, 1
    s_mov_b32 s38, 0x800
    v_mad_u32_u24 v105, v14, s38, v105
    v_bfe_u32 v14, v106, 2, 1
    s_mov_b32 s38, 0x1000
    v_mad_u32_u24 v105, v14, s38, v105
    v_bfe_u32 v14, v106, 3, 1
    s_mov_b32 s38, 0x100
    v_mad_u32_u24 v105, v14, s38, v105
    v_bfe_u32 v14, v106, 4, 1
    s_mov_b32 s38, 0x200
    v_mad_u32_u24 v105, v14, s38, v105
    v_add_u32 v104, v104, v105
    buffer_load_dword v12, v104, s[12:15], 0 offen
    v_mov_b32 v1, 0x4444
    v_bfe_u32 v14, v0, 1, 1
    s_mov_b32 s38, 0xaaaa
    v_mad_u32_u24 v1, v14, s38, v1
    v_mov_b32 v3, 0x0
    v_bfe_u32 v14, v0, 0, 1
    s_mov_b32 s38, 0x10
    v_mad_u32_u24 v3, v14, s38, v3
    v_bfe_u32 v14, v0, 1, 1
    s_mov_b32 s38, 0x20
    v_mad_u32_u24 v3, v14, s38, v3
    v_bfe_u32 v14, v0, 2, 1
    s_mov_b32 s38, 0x40
    v_mad_u32_u24 v3, v14, s38, v3
    v_bfe_u32 v14, v0, 3, 1
    s_mov_b32 s38, 0x80
    v_mad_u32_u24 v3, v14, s38, v3
    v_bfe_u32 v14, v0, 4, 1
    s_mov_b32 s38, 0x100
    v_mad_u32_u24 v3, v14, s38, v3
    v_bfe_u32 v14, v0, 5, 1
    s_mov_b32 s38, 0x200
    v_mad_u32_u24 v3, v14, s38, v3
    v_mov_b32 v2, 0x0
    v_bfe_u32 v14, v0, 0, 1
    s_mov_b32 s38, 0x10
    v_mad_u32_u24 v2, v14, s38, v2
    v_bfe_u32 v14, v0, 1, 1
    s_mov_b32 s38, 0x20
    v_mad_u32_u24 v2, v14, s38, v2
    v_bfe_u32 v14, v0, 2, 1
    s_mov_b32 s38, 0x40
    v_mad_u32_u24 v2, v14, s38, v2
    v_bfe_u32 v14, v0, 3, 1
    s_mov_b32 s38, 0x80
    v_mad_u32_u24 v2, v14, s38, v2
    v_bfe_u32 v14, v0, 4, 1
    s_mov_b32 s38, 0x100
    v_mad_u32_u24 v2, v14, s38, v2
    v_bfe_u32 v14, v0, 5, 1
    s_mov_b32 s38, 0x200
    v_mad_u32_u24 v2, v14, s38, v2
    v_bfe_u32 v14, v0, 6, 1
    s_mov_b32 s38, 0x800
    v_mad_u32_u24 v2, v14, s38, v2
    v_bfe_u32 v14, v0, 7, 1
    s_mov_b32 s38, 0x1000
    v_mad_u32_u24 v2, v14, s38, v2
    v_mov_b32 v4, 0x8000
    v_bfe_u32 v14, v0, 0, 1
    s_mov_b32 s38, 0x10
    v_mad_u32_u24 v4, v14, s38, v4
    v_bfe_u32 v14, v0, 1, 1
    s_mov_b32 s38, 0x20
    v_mad_u32_u24 v4, v14, s38, v4
    v_bfe_u32 v14, v0, 2, 1
    s_mov_b32 s38, 0x40
    v_mad_u32_u24 v4, v14, s38, v4
    v_bfe_u32 v14, v0, 3, 1
    s_mov_b32 s38, 0x80
    v_mad_u32_u24 v4, v14, s38, v4
    v_bfe_u32 v14, v0, 4, 1
    s_mov_b32 s38, 0x100
    v_mad_u32_u24 v4, v14, s38, v4
    v_bfe_u32 v14, v0, 5, 1
    s_mov_b32 s38, 0x200
    v_mad_u32_u24 v4, v14, s38, v4
    v_bfe_u32 v14, v0, 6, 1
    s_mov_b32 s38, 0x8000
    v_mad_u32_u24 v4, v14, s38, v4
    v_bfe_u32 v14, v0, 7, 1
    s_mov_b32 s38, 0x10000
    v_mad_u32_u24 v4, v14, s38, v4
    v_mov_b32 v5, 0x4000
    v_bfe_u32 v14, v0, 0, 1
    s_mov_b32 s38, 0x4
    v_mad_u32_u24 v5, v14, s38, v5
    v_bfe_u32 v14, v0, 1, 1
    s_mov_b32 s38, 0x8
    v_mad_u32_u24 v5, v14, s38, v5
    v_bfe_u32 v14, v0, 2, 1
    s_mov_b32 s38, 0x10
    v_mad_u32_u24 v5, v14, s38, v5
    v_bfe_u32 v14, v0, 3, 1
    s_mov_b32 s38, 0x20
    v_mad_u32_u24 v5, v14, s38, v5
    v_bfe_u32 v14, v0, 4, 1
    s_mov_b32 s38, 0x240
    v_mad_u32_u24 v5, v14, s38, v5
    v_bfe_u32 v14, v0, 5, 1
    s_mov_b32 s38, 0x480
    v_mad_u32_u24 v5, v14, s38, v5
    v_bfe_u32 v14, v0, 6, 1
    s_mov_b32 s38, 0x40
    v_mad_u32_u24 v5, v14, s38, v5
    v_bfe_u32 v14, v0, 7, 1
    s_mov_b32 s38, 0x80
    v_mad_u32_u24 v5, v14, s38, v5
    v_mov_b32 v6, 0x4000
    v_bfe_u32 v14, v0, 0, 1
    s_mov_b32 s38, 0x120
    v_mad_u32_u24 v6, v14, s38, v6
    v_bfe_u32 v14, v0, 2, 1
    s_mov_b32 s38, 0x240
    v_mad_u32_u24 v6, v14, s38, v6
    v_bfe_u32 v14, v0, 3, 1
    s_mov_b32 s38, 0x480
    v_mad_u32_u24 v6, v14, s38, v6
    v_bfe_u32 v14, v0, 4, 1
    s_mov_b32 s38, 0x10
    v_mad_u32_u24 v6, v14, s38, v6
    v_bfe_u32 v14, v0, 5, 1
    s_mov_b32 s38, 0x20
    v_mad_u32_u24 v6, v14, s38, v6
    v_add_u32 v7, 2304, v5
    v_xor_b32 v8, 0x1000, v2
    v_mov_b32 v104, 0x0
    v_bfe_u32 v14, v0, 3, 1
    s_mov_b32 s38, 0x1
    v_mad_u32_u24 v104, v14, s38, v104
    v_bfe_u32 v14, v0, 4, 1
    s_mov_b32 s38, 0x2
    v_mad_u32_u24 v104, v14, s38, v104
    v_bfe_u32 v14, v0, 5, 1
    s_mov_b32 s38, 0x4
    v_mad_u32_u24 v104, v14, s38, v104
    v_bfe_u32 v14, v0, 6, 1
    s_mov_b32 s38, 0x8
    v_mad_u32_u24 v104, v14, s38, v104
    v_bfe_u32 v14, v0, 7, 1
    s_mov_b32 s38, 0x10
    v_mad_u32_u24 v104, v14, s38, v104
    v_add_u32 v104, s20, v104
    v_and_b32 v104, 31, v104
    v_lshlrev_b32 v104, 6, v104
    v_mov_b32 v9, 0x0
    v_bfe_u32 v14, v0, 0, 1
    s_mov_b32 s38, 0x8
    v_mad_u32_u24 v9, v14, s38, v9
    v_bfe_u32 v14, v0, 1, 1
    s_mov_b32 s38, 0x10
    v_mad_u32_u24 v9, v14, s38, v9
    v_bfe_u32 v14, v0, 2, 1
    s_mov_b32 s38, 0x20
    v_mad_u32_u24 v9, v14, s38, v9
    v_bfe_u32 v14, v0, 3, 1
    s_mov_b32 s38, 0x2000
    v_mad_u32_u24 v9, v14, s38, v9
    v_bfe_u32 v14, v0, 4, 1
    s_mov_b32 s38, 0x4000
    v_mad_u32_u24 v9, v14, s38, v9
    v_bfe_u32 v14, v0, 5, 1
    s_mov_b32 s38, 0x8000
    v_mad_u32_u24 v9, v14, s38, v9
    v_bfe_u32 v14, v0, 6, 1
    s_mov_b32 s38, 0x10000
    v_mad_u32_u24 v9, v14, s38, v9
    v_bfe_u32 v14, v0, 7, 1
    s_mov_b32 s38, 0x20000
    v_mad_u32_u24 v9, v14, s38, v9
    v_add_u32 v9, v9, v104
    v_mov_b32 v10, 0x80000
    v_bfe_u32 v14, v0, 0, 1
    s_mov_b32 s38, 0x8
    v_mad_u32_u24 v10, v14, s38, v10
    v_bfe_u32 v14, v0, 1, 1
    s_mov_b32 s38, 0x20
    v_mad_u32_u24 v10, v14, s38, v10
    v_bfe_u32 v14, v0, 4, 1
    s_mov_b32 s38, 0x10
    v_mad_u32_u24 v10, v14, s38, v10
    v_bfe_u32 v14, v0, 5, 1
    s_mov_b32 s38, 0x4
    v_mad_u32_u24 v10, v14, s38, v10
    v_bfe_u32 v14, v0, 6, 1
    s_mov_b32 s38, 0x800
    v_mad_u32_u24 v10, v14, s38, v10
    v_bfe_u32 v14, v0, 7, 1
    s_mov_b32 s38, 0x1000
    v_mad_u32_u24 v10, v14, s38, v10
    v_mov_b32 v105, s20
    v_mov_b32 v104, 0x0
    v_bfe_u32 v14, v105, 0, 1
    s_mov_b32 s38, 0x100
    v_mad_u32_u24 v104, v14, s38, v104
    v_bfe_u32 v14, v105, 1, 1
    s_mov_b32 s38, 0x40
    v_mad_u32_u24 v104, v14, s38, v104
    v_bfe_u32 v14, v105, 2, 1
    s_mov_b32 s38, 0x80
    v_mad_u32_u24 v104, v14, s38, v104
    v_bfe_u32 v14, v105, 3, 1
    s_mov_b32 s38, 0x200
    v_mad_u32_u24 v104, v14, s38, v104
    v_bfe_u32 v14, v105, 4, 1
    s_mov_b32 s38, 0x400
    v_mad_u32_u24 v104, v14, s38, v104
    v_add_u32 v10, v104, v10
    v_and_b32 v104, 12, v0
    v_cmp_ne_u32 vcc, 0, v104
    v_mov_b32 v104, 0x40000000
    s_nop 0
    v_cndmask_b32 v10, v10, v104, vcc
    v_mov_b32 v13, 0x0
    v_bfe_u32 v14, v0, 0, 1
    s_mov_b32 s38, 0x10
    v_mad_u32_u24 v13, v14, s38, v13
    v_bfe_u32 v14, v0, 1, 1
    s_mov_b32 s38, 0x8
    v_mad_u32_u24 v13, v14, s38, v13
    v_bfe_u32 v14, v0, 2, 1
    s_mov_b32 s38, 0x20
    v_mad_u32_u24 v13, v14, s38, v13
    v_bfe_u32 v14, v0, 3, 1
    s_mov_b32 s38, 0x40
    v_mad_u32_u24 v13, v14, s38, v13
    v_bfe_u32 v14, v0, 4, 1
    s_mov_b32 s38, 0x80
    v_mad_u32_u24 v13, v14, s38, v13
    v_bfe_u32 v14, v0, 5, 1
    s_mov_b32 s38, 0x100
    v_mad_u32_u24 v13, v14, s38, v13
    v_bfe_u32 v14, v0, 6, 1
    s_mov_b32 s38, 0x800
    v_mad_u32_u24 v13, v14, s38, v13
    v_bfe_u32 v14, v0, 7, 1
    s_mov_b32 s38, 0x1000
    v_mad_u32_u24 v13, v14, s38, v13
    s_lshl_b32 s6, s20, 13
    s_add_u32 s6, s6, 0x0
    s_mov_b32 s26, 4096
    v_and_b32 v104, 15, v0
    v_mov_b32 v100, 0
    v_mov_b32 v105, 0x3f80
    v_cmp_eq_u32 vcc, 0, v104
    s_nop 1
    v_cndmask_b32 v100, v100, v105, vcc
    v_mov_b32 v105, 0x3f800000
    v_cmp_eq_u32 vcc, 1, v104
    s_nop 1
    v_cndmask_b32 v100, v100, v105, vcc
    v_mov_b32 v101, 0
    v_mov_b32 v105, 0x3f80
    v_cmp_eq_u32 vcc, 4, v104
    s_nop 1
    v_cndmask_b32 v101, v101, v105, vcc
    v_mov_b32 v105, 0x3f800000
    v_cmp_eq_u32 vcc, 5, v104
    s_nop 1
    v_cndmask_b32 v101, v101, v105, vcc
    v_mov_b32 v102, 0
    v_mov_b32 v105, 0x3f80
    v_cmp_eq_u32 vcc, 8, v104
    s_nop 1
    v_cndmask_b32 v102, v102, v105, vcc
    v_mov_b32 v105, 0x3f800000
    v_cmp_eq_u32 vcc, 9, v104
    s_nop 1
    v_cndmask_b32 v102, v102, v105, vcc
    v_mov_b32 v103, 0
    v_mov_b32 v105, 0x3f80
    v_cmp_eq_u32 vcc, 12, v104
    s_nop 1
    v_cndmask_b32 v103, v103, v105, vcc
    v_mov_b32 v105, 0x3f800000
    v_cmp_eq_u32 vcc, 13, v104
    s_nop 1
    v_cndmask_b32 v103, v103, v105, vcc
    ds_write_b128 v3, v[100:103] offset:23040
    s_mov_b32 s34, 0x05040100
    s_mov_b32 s35, 0x07060302
    s_mov_b32 s33, 0x3e0293ee
    s_mov_b32 s40, 0x4e800000
    s_mov_b32 s32, 0
    s_mov_b32 s4, 0x3f803f80
    s_mov_b32 s5, 0x3f803f80
    s_lshl_b32 s36, s20, 14
    s_lshr_b32 s37, s21, 1
    s_lshl_b32 s37, s37, 12
    s_add_u32 s25, s36, s37
    s_lshl_b32 s37, s21, 11
    s_add_u32 s39, s36, s37
    s_add_u32 s39, s39, 8192
    v_mov_b32 v104, 0x0
    v_bfe_u32 v14, v0, 0, 1
    s_mov_b32 s38, 0x80
    v_mad_u32_u24 v104, v14, s38, v104
    v_bfe_u32 v14, v0, 1, 1
    s_mov_b32 s38, 0x100
    v_mad_u32_u24 v104, v14, s38, v104
    v_bfe_u32 v14, v0, 2, 1
    s_mov_b32 s38, 0x200
    v_mad_u32_u24 v104, v14, s38, v104
    v_bfe_u32 v14, v0, 3, 1
    s_mov_b32 s38, 0x400
    v_mad_u32_u24 v104, v14, s38, v104
    v_bfe_u32 v14, v0, 4, 1
    s_mov_b32 s38, 0x800
    v_mad_u32_u24 v104, v14, s38, v104
    v_bfe_u32 v14, v0, 6, 1
    s_mov_b32 s38, 0x1000
    v_mad_u32_u24 v104, v14, s38, v104
    v_bfe_u32 v14, v0, 7, 1
    s_mov_b32 s38, 0x2000
    v_mad_u32_u24 v104, v14, s38, v104
    s_lshl_b32 s36, s20, 14
    v_add_u32 v104, s36, v104
    s_lshl_b32 s36, s20, 8
    s_lshr_b32 s37, s21, 1
    s_lshl_b32 s37, s37, 7
    s_add_u32 s36, s36, s37
    s_add_u32 s36, s36, 0x102100
    v_and_b32 v14, 63, v0
    v_mov_b32 v105, 0x40000000
    v_cmp_lt_u32 vcc, 32, v14
    s_nop 1
    v_cndmask_b32 v104, v104, v105, vcc
    v_mov_b32 v105, s36
    v_cmp_eq_u32 vcc, 32, v14
    s_nop 1
    v_cndmask_b32 v104, v104, v105, vcc
    s_lshl_b32 s36, s20, 2
    s_add_u32 s36, s36, 0x104100
    v_mov_b32 v105, s36
    v_cmp_eq_u32 vcc, 33, v14
    s_nop 1
    v_cndmask_b32 v0, v104, v105, vcc
    s_waitcnt vmcnt(34)
    s_barrier
    ds_read_b64_tr_b16 a[160:161], v20 offset:0
    ds_read_b64_tr_b16 a[162:163], v20 offset:512
    ds_read_b64_tr_b16 a[168:169], v21 offset:0
    ds_read_b64_tr_b16 a[170:171], v21 offset:512
    ds_read_b64_tr_b16 a[192:193], v22 offset:0
    ds_read_b64_tr_b16 a[194:195], v22 offset:512
    ds_read_b64_tr_b16 a[200:201], v23 offset:0
    ds_read_b64_tr_b16 a[202:203], v23 offset:512
    ds_read_b64_tr_b16 a[224:225], v24 offset:0
    ds_read_b64_tr_b16 a[226:227], v24 offset:512
    ds_read_b64_tr_b16 a[232:233], v25 offset:0
    ds_read_b64_tr_b16 a[234:235], v25 offset:512
    s_waitcnt lgkmcnt(4)
    ds_read_b64_tr_b16 v[128:129], v26 offset:0
    ds_read_b64_tr_b16 v[130:131], v26 offset:512
    ds_read_b64_tr_b16 v[136:137], v27 offset:0
    ds_read_b64_tr_b16 v[138:139], v27 offset:512
    s_waitcnt lgkmcnt(0)
    s_barrier
    s_add_u32 m0, s28, 32768
    s_add_u32 s37, s3, 0x300000
    buffer_load_dwordx4 v16, s[60:63], s37 offen lds
    s_add_u32 m0, s28, 36864
    s_add_u32 s37, s3, 0x320000
    buffer_load_dwordx4 v16, s[60:63], s37 offen lds
    s_add_u32 m0, s28, 65536
    s_add_u32 s37, s3, 0x340000
    buffer_load_dwordx4 v16, s[60:63], s37 offen lds
    s_add_u32 m0, s28, 69632
    s_add_u32 s37, s3, 0x360000
    buffer_load_dwordx4 v16, s[60:63], s37 offen lds
    s_add_u32 m0, s28, 98304
    s_add_u32 s37, s3, 0x380000
    buffer_load_dwordx4 v16, s[60:63], s37 offen lds
    s_add_u32 m0, s28, 102400
    s_add_u32 s37, s3, 0x3a0000
    buffer_load_dwordx4 v16, s[60:63], s37 offen lds
    s_add_u32 m0, s28, 131072
    s_add_u32 s37, s3, 0x3c0000
    buffer_load_dwordx4 v16, s[60:63], s37 offen lds
    s_add_u32 m0, s28, 135168
    s_add_u32 s37, s3, 0x3e0000
    buffer_load_dwordx4 v16, s[60:63], s37 offen lds
    s_xor_b32 s36, s21, 2
    s_lshl_b32 s36, s36, 15
    s_add_u32 s36, s36, s29
    s_add_u32 s37, s36, 0x80
    buffer_load_dword v48, v11, s[92:95], s37 offen
    s_add_u32 s37, s36, 0x4080
    buffer_load_dword v49, v11, s[92:95], s37 offen
    s_add_u32 s37, s36, 0x480
    buffer_load_dword v50, v11, s[92:95], s37 offen
    s_add_u32 s37, s36, 0x4480
    buffer_load_dword v51, v11, s[92:95], s37 offen
    s_add_u32 s37, s36, 0x2080
    buffer_load_dword v52, v11, s[92:95], s37 offen
    s_add_u32 s37, s36, 0x6080
    buffer_load_dword v53, v11, s[92:95], s37 offen
    s_add_u32 s37, s36, 0x2480
    buffer_load_dword v54, v11, s[92:95], s37 offen
    s_add_u32 s37, s36, 0x6480
    buffer_load_dword v55, v11, s[92:95], s37 offen
    s_add_u32 s37, s36, 0xc0
    buffer_load_dword v56, v11, s[92:95], s37 offen
    s_add_u32 s37, s36, 0x40c0
    buffer_load_dword v57, v11, s[92:95], s37 offen
    s_add_u32 s37, s36, 0x4c0
    buffer_load_dword v58, v11, s[92:95], s37 offen
    s_add_u32 s37, s36, 0x44c0
    buffer_load_dword v59, v11, s[92:95], s37 offen
    s_add_u32 s37, s36, 0x20c0
    buffer_load_dword v60, v11, s[92:95], s37 offen
    s_add_u32 s37, s36, 0x60c0
    buffer_load_dword v61, v11, s[92:95], s37 offen
    s_add_u32 s37, s36, 0x24c0
    buffer_load_dword v62, v11, s[92:95], s37 offen
    s_add_u32 s37, s36, 0x64c0
    buffer_load_dword v63, v11, s[92:95], s37 offen
    s_waitcnt vmcnt(50)
    s_barrier
    ds_read_b64_tr_b16 a[164:165], v20 offset:8192
    ds_read_b64_tr_b16 a[166:167], v20 offset:8704
    ds_read_b64_tr_b16 a[172:173], v21 offset:8192
    ds_read_b64_tr_b16 a[174:175], v21 offset:8704
    ds_read_b64_tr_b16 a[196:197], v22 offset:8192
    ds_read_b64_tr_b16 a[198:199], v22 offset:8704
    ds_read_b64_tr_b16 a[204:205], v23 offset:8192
    ds_read_b64_tr_b16 a[206:207], v23 offset:8704
    ds_read_b64_tr_b16 a[228:229], v24 offset:8192
    ds_read_b64_tr_b16 a[230:231], v24 offset:8704
    ds_read_b64_tr_b16 a[236:237], v25 offset:8192
    ds_read_b64_tr_b16 a[238:239], v25 offset:8704
    s_waitcnt lgkmcnt(4)
    ds_read_b64_tr_b16 v[132:133], v26 offset:8192
    ds_read_b64_tr_b16 v[134:135], v26 offset:8704
    ds_read_b64_tr_b16 v[140:141], v27 offset:8192
    ds_read_b64_tr_b16 v[142:143], v27 offset:8704
    s_waitcnt lgkmcnt(0)
    s_barrier
    s_mov_b32 s88, s50
    s_and_b32 s89, s51, 0xffff
    s_mov_b32 s90, 0x400000
    s_mov_b32 s91, 0x20000
    s_add_u32 m0, s28, 40960
    s_add_u32 s37, s3, 0x0
    buffer_load_dwordx4 v16, s[88:91], s37 offen lds
    s_add_u32 m0, s28, 45056
    s_add_u32 s37, s3, 0x20000
    buffer_load_dwordx4 v16, s[88:91], s37 offen lds
    s_add_u32 m0, s28, 73728
    s_add_u32 s37, s3, 0x40000
    buffer_load_dwordx4 v16, s[88:91], s37 offen lds
    s_add_u32 m0, s28, 77824
    s_add_u32 s37, s3, 0x60000
    buffer_load_dwordx4 v16, s[88:91], s37 offen lds
    s_add_u32 m0, s28, 106496
    s_add_u32 s37, s3, 0x80000
    buffer_load_dwordx4 v16, s[88:91], s37 offen lds
    s_add_u32 m0, s28, 110592
    s_add_u32 s37, s3, 0xa0000
    buffer_load_dwordx4 v16, s[88:91], s37 offen lds
    s_add_u32 m0, s28, 139264
    s_add_u32 s37, s3, 0xc0000
    buffer_load_dwordx4 v16, s[88:91], s37 offen lds
    s_add_u32 m0, s28, 143360
    s_add_u32 s37, s3, 0xe0000
    buffer_load_dwordx4 v16, s[88:91], s37 offen lds
    s_waitcnt vmcnt(34)
    v_perm_b32 v120, v33, v32, s34
    v_perm_b32 v121, v33, v32, s35
    v_perm_b32 v122, v35, v34, s34
    v_perm_b32 v123, v35, v34, s35
    v_perm_b32 v124, v37, v36, s34
    v_perm_b32 v125, v37, v36, s35
    v_perm_b32 v126, v39, v38, s34
    v_perm_b32 v127, v39, v38, s35
    ds_write_b128 v4, v[120:123] offset:24576
    ds_write_b128 v4, v[124:127] offset:25600
    s_waitcnt lgkmcnt(0)
    v_perm_b32 v120, v41, v40, s34
    v_perm_b32 v121, v41, v40, s35
    v_perm_b32 v122, v43, v42, s34
    v_perm_b32 v123, v43, v42, s35
    v_perm_b32 v124, v45, v44, s34
    v_perm_b32 v125, v45, v44, s35
    v_perm_b32 v126, v47, v46, s34
    v_perm_b32 v127, v47, v46, s35
    ds_write_b128 v4, v[120:123] offset:30720
    ds_write_b128 v4, v[124:127] offset:31744
    s_waitcnt lgkmcnt(0)
    s_xor_b32 s36, s21, 1
    s_lshl_b32 s36, s36, 15
    s_add_u32 s36, s36, s29
    s_add_u32 s37, s36, 0x80
    buffer_load_dword v80, v11, s[92:95], s37 offen
    s_add_u32 s37, s36, 0x4080
    buffer_load_dword v81, v11, s[92:95], s37 offen
    s_add_u32 s37, s36, 0x480
    buffer_load_dword v82, v11, s[92:95], s37 offen
    s_add_u32 s37, s36, 0x4480
    buffer_load_dword v83, v11, s[92:95], s37 offen
    s_add_u32 s37, s36, 0x2080
    buffer_load_dword v84, v11, s[92:95], s37 offen
    s_add_u32 s37, s36, 0x6080
    buffer_load_dword v85, v11, s[92:95], s37 offen
    s_add_u32 s37, s36, 0x2480
    buffer_load_dword v86, v11, s[92:95], s37 offen
    s_add_u32 s37, s36, 0x6480
    buffer_load_dword v87, v11, s[92:95], s37 offen
    s_add_u32 s37, s36, 0xc0
    buffer_load_dword v88, v11, s[92:95], s37 offen
    s_add_u32 s37, s36, 0x40c0
    buffer_load_dword v89, v11, s[92:95], s37 offen
    s_add_u32 s37, s36, 0x4c0
    buffer_load_dword v90, v11, s[92:95], s37 offen
    s_add_u32 s37, s36, 0x44c0
    buffer_load_dword v91, v11, s[92:95], s37 offen
    s_add_u32 s37, s36, 0x20c0
    buffer_load_dword v92, v11, s[92:95], s37 offen
    s_add_u32 s37, s36, 0x60c0
    buffer_load_dword v93, v11, s[92:95], s37 offen
    s_add_u32 s37, s36, 0x24c0
    buffer_load_dword v94, v11, s[92:95], s37 offen
    s_add_u32 s37, s36, 0x64c0
    buffer_load_dword v95, v11, s[92:95], s37 offen
    s_barrier
    ds_read_b64_tr_b16 a[176:177], v20 offset:16384
    ds_read_b64_tr_b16 a[178:179], v20 offset:16896
    ds_read_b64_tr_b16 a[184:185], v21 offset:16384
    ds_read_b64_tr_b16 a[186:187], v21 offset:16896
    ds_read_b64_tr_b16 a[208:209], v22 offset:16384
    ds_read_b64_tr_b16 a[210:211], v22 offset:16896
    ds_read_b64_tr_b16 a[216:217], v23 offset:16384
    ds_read_b64_tr_b16 a[218:219], v23 offset:16896
    ds_read_b64_tr_b16 a[240:241], v24 offset:16384
    ds_read_b64_tr_b16 a[242:243], v24 offset:16896
    ds_read_b64_tr_b16 a[248:249], v25 offset:16384
    ds_read_b64_tr_b16 a[250:251], v25 offset:16896
    s_waitcnt lgkmcnt(4)
    ds_read_b64_tr_b16 v[144:145], v26 offset:16384
    ds_read_b64_tr_b16 v[146:147], v26 offset:16896
    ds_read_b64_tr_b16 v[152:153], v27 offset:16384
    ds_read_b64_tr_b16 v[154:155], v27 offset:16896
    s_waitcnt lgkmcnt(0)
    s_barrier
    s_add_u32 m0, s28, 49152
    s_add_u32 s37, s3, 0x100000
    buffer_load_dwordx4 v16, s[88:91], s37 offen lds
    s_add_u32 m0, s28, 53248
    s_add_u32 s37, s3, 0x120000
    buffer_load_dwordx4 v16, s[88:91], s37 offen lds
    s_add_u32 m0, s28, 81920
    s_add_u32 s37, s3, 0x140000
    buffer_load_dwordx4 v16, s[88:91], s37 offen lds
    s_add_u32 m0, s28, 86016
    s_add_u32 s37, s3, 0x160000
    buffer_load_dwordx4 v16, s[88:91], s37 offen lds
    s_add_u32 m0, s28, 114688
    s_add_u32 s37, s3, 0x180000
    buffer_load_dwordx4 v16, s[88:91], s37 offen lds
    s_add_u32 m0, s28, 118784
    s_add_u32 s37, s3, 0x1a0000
    buffer_load_dwordx4 v16, s[88:91], s37 offen lds
    s_add_u32 m0, s28, 147456
    s_add_u32 s37, s3, 0x1c0000
    buffer_load_dwordx4 v16, s[88:91], s37 offen lds
    s_add_u32 m0, s28, 151552
    s_add_u32 s37, s3, 0x1e0000
    buffer_load_dwordx4 v16, s[88:91], s37 offen lds
    s_waitcnt vmcnt(32)
    v_perm_b32 v232, v49, v48, s34
    v_perm_b32 v233, v49, v48, s35
    v_perm_b32 v234, v51, v50, s34
    v_perm_b32 v235, v51, v50, s35
    v_perm_b32 v236, v53, v52, s34
    v_perm_b32 v237, v53, v52, s35
    v_perm_b32 v238, v55, v54, s34
    v_perm_b32 v239, v55, v54, s35
    v_perm_b32 v120, v57, v56, s34
    v_perm_b32 v121, v57, v56, s35
    v_perm_b32 v122, v59, v58, s34
    v_perm_b32 v123, v59, v58, s35
    v_perm_b32 v124, v61, v60, s34
    v_perm_b32 v125, v61, v60, s35
    v_perm_b32 v126, v63, v62, s34
    v_perm_b32 v127, v63, v62, s35
    ds_write_b128 v4, v[120:123] offset:28672
    ds_write_b128 v4, v[124:127] offset:29696
    s_waitcnt lgkmcnt(0)
    s_xor_b32 s36, s21, 3
    s_lshl_b32 s36, s36, 15
    s_add_u32 s36, s36, s29
    s_add_u32 s37, s36, 0x0
    buffer_load_dword v32, v11, s[92:95], s37 offen
    s_add_u32 s37, s36, 0x4000
    buffer_load_dword v33, v11, s[92:95], s37 offen
    s_add_u32 s37, s36, 0x400
    buffer_load_dword v34, v11, s[92:95], s37 offen
    s_add_u32 s37, s36, 0x4400
    buffer_load_dword v35, v11, s[92:95], s37 offen
    s_add_u32 s37, s36, 0x2000
    buffer_load_dword v36, v11, s[92:95], s37 offen
    s_add_u32 s37, s36, 0x6000
    buffer_load_dword v37, v11, s[92:95], s37 offen
    s_add_u32 s37, s36, 0x2400
    buffer_load_dword v38, v11, s[92:95], s37 offen
    s_add_u32 s37, s36, 0x6400
    buffer_load_dword v39, v11, s[92:95], s37 offen
    s_add_u32 s37, s36, 0x40
    buffer_load_dword v40, v11, s[92:95], s37 offen
    s_add_u32 s37, s36, 0x4040
    buffer_load_dword v41, v11, s[92:95], s37 offen
    s_add_u32 s37, s36, 0x440
    buffer_load_dword v42, v11, s[92:95], s37 offen
    s_add_u32 s37, s36, 0x4440
    buffer_load_dword v43, v11, s[92:95], s37 offen
    s_add_u32 s37, s36, 0x2040
    buffer_load_dword v44, v11, s[92:95], s37 offen
    s_add_u32 s37, s36, 0x6040
    buffer_load_dword v45, v11, s[92:95], s37 offen
    s_add_u32 s37, s36, 0x2440
    buffer_load_dword v46, v11, s[92:95], s37 offen
    s_add_u32 s37, s36, 0x6440
    buffer_load_dword v47, v11, s[92:95], s37 offen
    s_barrier
    ds_read_b64_tr_b16 a[180:181], v20 offset:0
    ds_read_b64_tr_b16 a[182:183], v20 offset:512
    ds_read_b64_tr_b16 a[188:189], v21 offset:0
    ds_read_b64_tr_b16 a[190:191], v21 offset:512
    ds_read_b64_tr_b16 a[212:213], v22 offset:0
    ds_read_b64_tr_b16 a[214:215], v22 offset:512
    ds_read_b64_tr_b16 a[220:221], v23 offset:0
    ds_read_b64_tr_b16 a[222:223], v23 offset:512
    ds_read_b64_tr_b16 a[244:245], v24 offset:0
    ds_read_b64_tr_b16 a[246:247], v24 offset:512
    ds_read_b64_tr_b16 a[252:253], v25 offset:0
    ds_read_b64_tr_b16 a[254:255], v25 offset:512
    s_waitcnt lgkmcnt(4)
    ds_read_b64_tr_b16 v[148:149], v26 offset:0
    ds_read_b64_tr_b16 v[150:151], v26 offset:512
    ds_read_b64_tr_b16 v[156:157], v27 offset:0
    ds_read_b64_tr_b16 v[158:159], v27 offset:512
    s_waitcnt lgkmcnt(0)
    s_barrier
    s_add_u32 m0, s28, 32768
    s_add_u32 s37, s3, 0x200000
    buffer_load_dwordx4 v16, s[88:91], s37 offen lds
    s_add_u32 m0, s28, 36864
    s_add_u32 s37, s3, 0x220000
    buffer_load_dwordx4 v16, s[88:91], s37 offen lds
    s_add_u32 m0, s28, 65536
    s_add_u32 s37, s3, 0x240000
    buffer_load_dwordx4 v16, s[88:91], s37 offen lds
    s_add_u32 m0, s28, 69632
    s_add_u32 s37, s3, 0x260000
    buffer_load_dwordx4 v16, s[88:91], s37 offen lds
    s_add_u32 m0, s28, 98304
    s_add_u32 s37, s3, 0x280000
    buffer_load_dwordx4 v16, s[88:91], s37 offen lds
    s_add_u32 m0, s28, 102400
    s_add_u32 s37, s3, 0x2a0000
    buffer_load_dwordx4 v16, s[88:91], s37 offen lds
    s_add_u32 m0, s28, 131072
    s_add_u32 s37, s3, 0x2c0000
    buffer_load_dwordx4 v16, s[88:91], s37 offen lds
    s_add_u32 m0, s28, 135168
    s_add_u32 s37, s3, 0x2e0000
    buffer_load_dwordx4 v16, s[88:91], s37 offen lds
    s_waitcnt vmcnt(32)
    v_perm_b32 v208, v81, v80, s34
    v_perm_b32 v209, v81, v80, s35
    v_perm_b32 v210, v83, v82, s34
    v_perm_b32 v211, v83, v82, s35
    v_perm_b32 v212, v85, v84, s34
    v_perm_b32 v213, v85, v84, s35
    v_perm_b32 v214, v87, v86, s34
    v_perm_b32 v215, v87, v86, s35
    v_perm_b32 v120, v89, v88, s34
    v_perm_b32 v121, v89, v88, s35
    v_perm_b32 v122, v91, v90, s34
    v_perm_b32 v123, v91, v90, s35
    v_perm_b32 v124, v93, v92, s34
    v_perm_b32 v125, v93, v92, s35
    v_perm_b32 v126, v95, v94, s34
    v_perm_b32 v127, v95, v94, s35
    ds_write_b128 v4, v[120:123] offset:26624
    ds_write_b128 v4, v[124:127] offset:27648
    s_waitcnt lgkmcnt(0)
    s_xor_b32 s36, s21, 2
    s_lshl_b32 s36, s36, 15
    s_add_u32 s36, s36, s29
    s_add_u32 s37, s36, 0x0
    buffer_load_dword v48, v11, s[92:95], s37 offen
    s_add_u32 s37, s36, 0x4000
    buffer_load_dword v49, v11, s[92:95], s37 offen
    s_add_u32 s37, s36, 0x400
    buffer_load_dword v50, v11, s[92:95], s37 offen
    s_add_u32 s37, s36, 0x4400
    buffer_load_dword v51, v11, s[92:95], s37 offen
    s_add_u32 s37, s36, 0x2000
    buffer_load_dword v52, v11, s[92:95], s37 offen
    s_add_u32 s37, s36, 0x6000
    buffer_load_dword v53, v11, s[92:95], s37 offen
    s_add_u32 s37, s36, 0x2400
    buffer_load_dword v54, v11, s[92:95], s37 offen
    s_add_u32 s37, s36, 0x6400
    buffer_load_dword v55, v11, s[92:95], s37 offen
    s_add_u32 s37, s36, 0x40
    buffer_load_dword v56, v11, s[92:95], s37 offen
    s_add_u32 s37, s36, 0x4040
    buffer_load_dword v57, v11, s[92:95], s37 offen
    s_add_u32 s37, s36, 0x440
    buffer_load_dword v58, v11, s[92:95], s37 offen
    s_add_u32 s37, s36, 0x4440
    buffer_load_dword v59, v11, s[92:95], s37 offen
    s_add_u32 s37, s36, 0x2040
    buffer_load_dword v60, v11, s[92:95], s37 offen
    s_add_u32 s37, s36, 0x6040
    buffer_load_dword v61, v11, s[92:95], s37 offen
    s_add_u32 s37, s36, 0x2440
    buffer_load_dword v62, v11, s[92:95], s37 offen
    s_add_u32 s37, s36, 0x6440
    buffer_load_dword v63, v11, s[92:95], s37 offen
    s_barrier
    ds_read_b64_tr_b16 v[64:65], v20 offset:8192
    ds_read_b64_tr_b16 v[66:67], v20 offset:8704
    ds_read_b64_tr_b16 v[72:73], v21 offset:8192
    ds_read_b64_tr_b16 v[74:75], v21 offset:8704
    ds_read_b64_tr_b16 v[96:97], v22 offset:8192
    ds_read_b64_tr_b16 v[98:99], v22 offset:8704
    ds_read_b64_tr_b16 v[104:105], v23 offset:8192
    ds_read_b64_tr_b16 v[106:107], v23 offset:8704
    ds_read_b64_tr_b16 a[112:113], v24 offset:8192
    ds_read_b64_tr_b16 a[114:115], v24 offset:8704
    ds_read_b64_tr_b16 a[120:121], v25 offset:8192
    ds_read_b64_tr_b16 a[122:123], v25 offset:8704
    s_waitcnt lgkmcnt(4)
    ds_read_b64_tr_b16 a[144:145], v26 offset:8192
    ds_read_b64_tr_b16 a[146:147], v26 offset:8704
    ds_read_b64_tr_b16 a[152:153], v27 offset:8192
    ds_read_b64_tr_b16 a[154:155], v27 offset:8704
    s_waitcnt lgkmcnt(0)
    s_barrier
    s_add_u32 m0, s28, 40960
    s_add_u32 s37, s3, 0x300000
    buffer_load_dwordx4 v16, s[88:91], s37 offen lds
    s_add_u32 m0, s28, 45056
    s_add_u32 s37, s3, 0x320000
    buffer_load_dwordx4 v16, s[88:91], s37 offen lds
    s_add_u32 m0, s28, 73728
    s_add_u32 s37, s3, 0x340000
    buffer_load_dwordx4 v16, s[88:91], s37 offen lds
    s_add_u32 m0, s28, 77824
    s_add_u32 s37, s3, 0x360000
    buffer_load_dwordx4 v16, s[88:91], s37 offen lds
    s_add_u32 m0, s28, 106496
    s_add_u32 s37, s3, 0x380000
    buffer_load_dwordx4 v16, s[88:91], s37 offen lds
    s_add_u32 m0, s28, 110592
    s_add_u32 s37, s3, 0x3a0000
    buffer_load_dwordx4 v16, s[88:91], s37 offen lds
    s_add_u32 m0, s28, 139264
    s_add_u32 s37, s3, 0x3c0000
    buffer_load_dwordx4 v16, s[88:91], s37 offen lds
    s_add_u32 m0, s28, 143360
    s_add_u32 s37, s3, 0x3e0000
    buffer_load_dwordx4 v16, s[88:91], s37 offen lds
    s_waitcnt vmcnt(32)
    v_perm_b32 v240, v33, v32, s34
    v_perm_b32 v241, v33, v32, s35
    v_perm_b32 v242, v35, v34, s34
    v_perm_b32 v243, v35, v34, s35
    v_perm_b32 v244, v37, v36, s34
    v_perm_b32 v245, v37, v36, s35
    v_perm_b32 v246, v39, v38, s34
    v_perm_b32 v247, v39, v38, s35
    v_perm_b32 v248, v41, v40, s34
    v_perm_b32 v249, v41, v40, s35
    v_perm_b32 v250, v43, v42, s34
    v_perm_b32 v251, v43, v42, s35
    v_perm_b32 v252, v45, v44, s34
    v_perm_b32 v253, v45, v44, s35
    v_perm_b32 v254, v47, v46, s34
    v_perm_b32 v255, v47, v46, s35
    s_xor_b32 s36, s21, 1
    s_lshl_b32 s36, s36, 15
    s_add_u32 s36, s36, s29
    s_add_u32 s37, s36, 0x0
    buffer_load_dword v80, v11, s[92:95], s37 offen
    s_add_u32 s37, s36, 0x4000
    buffer_load_dword v81, v11, s[92:95], s37 offen
    s_add_u32 s37, s36, 0x400
    buffer_load_dword v82, v11, s[92:95], s37 offen
    s_add_u32 s37, s36, 0x4400
    buffer_load_dword v83, v11, s[92:95], s37 offen
    s_add_u32 s37, s36, 0x2000
    buffer_load_dword v84, v11, s[92:95], s37 offen
    s_add_u32 s37, s36, 0x6000
    buffer_load_dword v85, v11, s[92:95], s37 offen
    s_add_u32 s37, s36, 0x2400
    buffer_load_dword v86, v11, s[92:95], s37 offen
    s_add_u32 s37, s36, 0x6400
    buffer_load_dword v87, v11, s[92:95], s37 offen
    s_add_u32 s37, s36, 0x40
    buffer_load_dword v88, v11, s[92:95], s37 offen
    s_add_u32 s37, s36, 0x4040
    buffer_load_dword v89, v11, s[92:95], s37 offen
    s_add_u32 s37, s36, 0x440
    buffer_load_dword v90, v11, s[92:95], s37 offen
    s_add_u32 s37, s36, 0x4440
    buffer_load_dword v91, v11, s[92:95], s37 offen
    s_add_u32 s37, s36, 0x2040
    buffer_load_dword v92, v11, s[92:95], s37 offen
    s_add_u32 s37, s36, 0x6040
    buffer_load_dword v93, v11, s[92:95], s37 offen
    s_add_u32 s37, s36, 0x2440
    buffer_load_dword v94, v11, s[92:95], s37 offen
    s_add_u32 s37, s36, 0x6440
    buffer_load_dword v95, v11, s[92:95], s37 offen
    s_barrier
    ds_read_b64_tr_b16 v[68:69], v20 offset:16384
    ds_read_b64_tr_b16 v[70:71], v20 offset:16896
    ds_read_b64_tr_b16 v[76:77], v21 offset:16384
    ds_read_b64_tr_b16 v[78:79], v21 offset:16896
    ds_read_b64_tr_b16 v[100:101], v22 offset:16384
    ds_read_b64_tr_b16 v[102:103], v22 offset:16896
    ds_read_b64_tr_b16 v[108:109], v23 offset:16384
    ds_read_b64_tr_b16 v[110:111], v23 offset:16896
    ds_read_b64_tr_b16 a[116:117], v24 offset:16384
    ds_read_b64_tr_b16 a[118:119], v24 offset:16896
    ds_read_b64_tr_b16 a[124:125], v25 offset:16384
    ds_read_b64_tr_b16 a[126:127], v25 offset:16896
    s_waitcnt lgkmcnt(4)
    ds_read_b64_tr_b16 a[148:149], v26 offset:16384
    ds_read_b64_tr_b16 a[150:151], v26 offset:16896
    ds_read_b64_tr_b16 a[156:157], v27 offset:16384
    ds_read_b64_tr_b16 a[158:159], v27 offset:16896
    s_waitcnt lgkmcnt(0)
    s_barrier
    s_mov_b32 s96, s48
    s_and_b32 s97, s49, 0xffff
    s_mov_b32 s98, 0x400000
    s_mov_b32 s99, 0x20000
    s_add_u32 m0, s28, 49152
    s_add_u32 s37, s3, 0x0
    buffer_load_dwordx4 v16, s[96:99], s37 offen lds
    s_add_u32 m0, s28, 53248
    s_add_u32 s37, s3, 0x20000
    buffer_load_dwordx4 v16, s[96:99], s37 offen lds
    s_add_u32 m0, s28, 81920
    s_add_u32 s37, s3, 0x40000
    buffer_load_dwordx4 v16, s[96:99], s37 offen lds
    s_add_u32 m0, s28, 86016
    s_add_u32 s37, s3, 0x60000
    buffer_load_dwordx4 v16, s[96:99], s37 offen lds
    s_add_u32 m0, s28, 114688
    s_add_u32 s37, s3, 0x80000
    buffer_load_dwordx4 v16, s[96:99], s37 offen lds
    s_add_u32 m0, s28, 118784
    s_add_u32 s37, s3, 0xa0000
    buffer_load_dwordx4 v16, s[96:99], s37 offen lds
    s_add_u32 m0, s28, 147456
    s_add_u32 s37, s3, 0xc0000
    buffer_load_dwordx4 v16, s[96:99], s37 offen lds
    s_add_u32 m0, s28, 151552
    s_add_u32 s37, s3, 0xe0000
    buffer_load_dwordx4 v16, s[96:99], s37 offen lds
    s_waitcnt vmcnt(32)
    v_perm_b32 v216, v49, v48, s34
    v_perm_b32 v217, v49, v48, s35
    v_perm_b32 v218, v51, v50, s34
    v_perm_b32 v219, v51, v50, s35
    v_perm_b32 v220, v53, v52, s34
    v_perm_b32 v221, v53, v52, s35
    v_perm_b32 v222, v55, v54, s34
    v_perm_b32 v223, v55, v54, s35
    v_perm_b32 v224, v57, v56, s34
    v_perm_b32 v225, v57, v56, s35
    v_perm_b32 v226, v59, v58, s34
    v_perm_b32 v227, v59, v58, s35
    v_perm_b32 v228, v61, v60, s34
    v_perm_b32 v229, v61, v60, s35
    v_perm_b32 v230, v63, v62, s34
    v_perm_b32 v231, v63, v62, s35
    s_xor_b32 s36, s21, 0
    s_lshl_b32 s36, s36, 15
    s_add_u32 s36, s36, s29
    s_add_u32 s37, s36, 0x80
    buffer_load_dword v32, v11, s[92:95], s37 offen
    s_add_u32 s37, s36, 0x4080
    buffer_load_dword v33, v11, s[92:95], s37 offen
    s_add_u32 s37, s36, 0x480
    buffer_load_dword v34, v11, s[92:95], s37 offen
    s_add_u32 s37, s36, 0x4480
    buffer_load_dword v35, v11, s[92:95], s37 offen
    s_add_u32 s37, s36, 0x2080
    buffer_load_dword v36, v11, s[92:95], s37 offen
    s_add_u32 s37, s36, 0x6080
    buffer_load_dword v37, v11, s[92:95], s37 offen
    s_add_u32 s37, s36, 0x2480
    buffer_load_dword v38, v11, s[92:95], s37 offen
    s_add_u32 s37, s36, 0x6480
    buffer_load_dword v39, v11, s[92:95], s37 offen
    s_add_u32 s37, s36, 0xc0
    buffer_load_dword v40, v11, s[92:95], s37 offen
    s_add_u32 s37, s36, 0x40c0
    buffer_load_dword v41, v11, s[92:95], s37 offen
    s_add_u32 s37, s36, 0x4c0
    buffer_load_dword v42, v11, s[92:95], s37 offen
    s_add_u32 s37, s36, 0x44c0
    buffer_load_dword v43, v11, s[92:95], s37 offen
    s_add_u32 s37, s36, 0x20c0
    buffer_load_dword v44, v11, s[92:95], s37 offen
    s_add_u32 s37, s36, 0x60c0
    buffer_load_dword v45, v11, s[92:95], s37 offen
    s_add_u32 s37, s36, 0x24c0
    buffer_load_dword v46, v11, s[92:95], s37 offen
    s_add_u32 s37, s36, 0x64c0
    buffer_load_dword v47, v11, s[92:95], s37 offen
    s_barrier
    ds_read_b64_tr_b16 a[80:81], v20 offset:0
    ds_read_b64_tr_b16 a[82:83], v20 offset:512
    ds_read_b64_tr_b16 a[88:89], v21 offset:0
    ds_read_b64_tr_b16 a[90:91], v21 offset:512
    ds_read_b64_tr_b16 a[96:97], v22 offset:0
    ds_read_b64_tr_b16 a[98:99], v22 offset:512
    ds_read_b64_tr_b16 a[104:105], v23 offset:0
    ds_read_b64_tr_b16 a[106:107], v23 offset:512
    ds_read_b64_tr_b16 a[128:129], v24 offset:0
    ds_read_b64_tr_b16 a[130:131], v24 offset:512
    ds_read_b64_tr_b16 a[136:137], v25 offset:0
    ds_read_b64_tr_b16 a[138:139], v25 offset:512
    s_waitcnt lgkmcnt(4)
    ds_read_b64_tr_b16 v[112:113], v26 offset:0
    ds_read_b64_tr_b16 v[114:115], v26 offset:512
    ds_read_b64_tr_b16 v[120:121], v27 offset:0
    ds_read_b64_tr_b16 v[122:123], v27 offset:512
    s_waitcnt lgkmcnt(0)
    s_barrier
    s_add_u32 m0, s28, 32768
    s_add_u32 s37, s3, 0x100000
    buffer_load_dwordx4 v16, s[96:99], s37 offen lds
    s_add_u32 m0, s28, 36864
    s_add_u32 s37, s3, 0x120000
    buffer_load_dwordx4 v16, s[96:99], s37 offen lds
    s_add_u32 m0, s28, 65536
    s_add_u32 s37, s3, 0x140000
    buffer_load_dwordx4 v16, s[96:99], s37 offen lds
    s_add_u32 m0, s28, 69632
    s_add_u32 s37, s3, 0x160000
    buffer_load_dwordx4 v16, s[96:99], s37 offen lds
    s_add_u32 m0, s28, 98304
    s_add_u32 s37, s3, 0x180000
    buffer_load_dwordx4 v16, s[96:99], s37 offen lds
    s_add_u32 m0, s28, 102400
    s_add_u32 s37, s3, 0x1a0000
    buffer_load_dwordx4 v16, s[96:99], s37 offen lds
    s_add_u32 m0, s28, 131072
    s_add_u32 s37, s3, 0x1c0000
    buffer_load_dwordx4 v16, s[96:99], s37 offen lds
    s_add_u32 m0, s28, 135168
    s_add_u32 s37, s3, 0x1e0000
    buffer_load_dwordx4 v16, s[96:99], s37 offen lds
    s_waitcnt vmcnt(32)
    v_perm_b32 v192, v81, v80, s34
    v_perm_b32 v193, v81, v80, s35
    v_perm_b32 v194, v83, v82, s34
    v_perm_b32 v195, v83, v82, s35
    v_perm_b32 v196, v85, v84, s34
    v_perm_b32 v197, v85, v84, s35
    v_perm_b32 v198, v87, v86, s34
    v_perm_b32 v199, v87, v86, s35
    v_perm_b32 v200, v89, v88, s34
    v_perm_b32 v201, v89, v88, s35
    v_perm_b32 v202, v91, v90, s34
    v_perm_b32 v203, v91, v90, s35
    v_perm_b32 v204, v93, v92, s34
    v_perm_b32 v205, v93, v92, s35
    v_perm_b32 v206, v95, v94, s34
    v_perm_b32 v207, v95, v94, s35
    s_xor_b32 s36, s21, 0
    s_lshl_b32 s36, s36, 15
    s_add_u32 s36, s36, s29
    s_add_u32 s37, s36, 0x0
    buffer_load_dword v48, v11, s[92:95], s37 offen
    s_add_u32 s37, s36, 0x4000
    buffer_load_dword v49, v11, s[92:95], s37 offen
    s_add_u32 s37, s36, 0x400
    buffer_load_dword v50, v11, s[92:95], s37 offen
    s_add_u32 s37, s36, 0x4400
    buffer_load_dword v51, v11, s[92:95], s37 offen
    s_add_u32 s37, s36, 0x2000
    buffer_load_dword v52, v11, s[92:95], s37 offen
    s_add_u32 s37, s36, 0x6000
    buffer_load_dword v53, v11, s[92:95], s37 offen
    s_add_u32 s37, s36, 0x2400
    buffer_load_dword v54, v11, s[92:95], s37 offen
    s_add_u32 s37, s36, 0x6400
    buffer_load_dword v55, v11, s[92:95], s37 offen
    s_add_u32 s37, s36, 0x40
    buffer_load_dword v56, v11, s[92:95], s37 offen
    s_add_u32 s37, s36, 0x4040
    buffer_load_dword v57, v11, s[92:95], s37 offen
    s_add_u32 s37, s36, 0x440
    buffer_load_dword v58, v11, s[92:95], s37 offen
    s_add_u32 s37, s36, 0x4440
    buffer_load_dword v59, v11, s[92:95], s37 offen
    s_add_u32 s37, s36, 0x2040
    buffer_load_dword v60, v11, s[92:95], s37 offen
    s_add_u32 s37, s36, 0x6040
    buffer_load_dword v61, v11, s[92:95], s37 offen
    s_add_u32 s37, s36, 0x2440
    buffer_load_dword v62, v11, s[92:95], s37 offen
    s_add_u32 s37, s36, 0x6440
    buffer_load_dword v63, v11, s[92:95], s37 offen
    s_barrier
    ds_read_b64_tr_b16 a[84:85], v20 offset:8192
    ds_read_b64_tr_b16 a[86:87], v20 offset:8704
    ds_read_b64_tr_b16 a[92:93], v21 offset:8192
    ds_read_b64_tr_b16 a[94:95], v21 offset:8704
    ds_read_b64_tr_b16 a[100:101], v22 offset:8192
    ds_read_b64_tr_b16 a[102:103], v22 offset:8704
    ds_read_b64_tr_b16 a[108:109], v23 offset:8192
    ds_read_b64_tr_b16 a[110:111], v23 offset:8704
    ds_read_b64_tr_b16 a[132:133], v24 offset:8192
    ds_read_b64_tr_b16 a[134:135], v24 offset:8704
    ds_read_b64_tr_b16 a[140:141], v25 offset:8192
    ds_read_b64_tr_b16 a[142:143], v25 offset:8704
    s_waitcnt lgkmcnt(4)
    ds_read_b64_tr_b16 v[116:117], v26 offset:8192
    ds_read_b64_tr_b16 v[118:119], v26 offset:8704
    ds_read_b64_tr_b16 v[124:125], v27 offset:8192
    ds_read_b64_tr_b16 v[126:127], v27 offset:8704
    s_waitcnt lgkmcnt(0)
    s_barrier
    s_add_u32 m0, s28, 40960
    s_add_u32 s37, s3, 0x200000
    buffer_load_dwordx4 v16, s[96:99], s37 offen lds
    s_add_u32 m0, s28, 45056
    s_add_u32 s37, s3, 0x220000
    buffer_load_dwordx4 v16, s[96:99], s37 offen lds
    s_add_u32 m0, s28, 73728
    s_add_u32 s37, s3, 0x240000
    buffer_load_dwordx4 v16, s[96:99], s37 offen lds
    s_add_u32 m0, s28, 77824
    s_add_u32 s37, s3, 0x260000
    buffer_load_dwordx4 v16, s[96:99], s37 offen lds
    s_add_u32 m0, s28, 106496
    s_add_u32 s37, s3, 0x280000
    buffer_load_dwordx4 v16, s[96:99], s37 offen lds
    s_add_u32 m0, s28, 110592
    s_add_u32 s37, s3, 0x2a0000
    buffer_load_dwordx4 v16, s[96:99], s37 offen lds
    s_add_u32 m0, s28, 139264
    s_add_u32 s37, s3, 0x2c0000
    buffer_load_dwordx4 v16, s[96:99], s37 offen lds
    s_add_u32 m0, s28, 143360
    s_add_u32 s37, s3, 0x2e0000
    buffer_load_dwordx4 v16, s[96:99], s37 offen lds
    s_waitcnt vmcnt(32)
    v_perm_b32 v176, v33, v32, s34
    v_perm_b32 v177, v33, v32, s35
    v_perm_b32 v178, v35, v34, s34
    v_perm_b32 v179, v35, v34, s35
    v_perm_b32 v180, v37, v36, s34
    v_perm_b32 v181, v37, v36, s35
    v_perm_b32 v182, v39, v38, s34
    v_perm_b32 v183, v39, v38, s35
    v_perm_b32 v184, v41, v40, s34
    v_perm_b32 v185, v41, v40, s35
    v_perm_b32 v186, v43, v42, s34
    v_perm_b32 v187, v43, v42, s35
    v_perm_b32 v188, v45, v44, s34
    v_perm_b32 v189, v45, v44, s35
    v_perm_b32 v190, v47, v46, s34
    v_perm_b32 v191, v47, v46, s35
    v_lshrrev_b32 v31, 2, v3
    buffer_load_dword v30, v31, s[16:19], 0 offen sc1
    s_barrier
    ds_read_b64_tr_b16 v[32:33], v20 offset:16384
    ds_read_b64_tr_b16 v[34:35], v20 offset:16896
    ds_read_b64_tr_b16 v[40:41], v21 offset:16384
    ds_read_b64_tr_b16 v[42:43], v21 offset:16896
    ds_read_b64_tr_b16 a[0:1], v22 offset:16384
    ds_read_b64_tr_b16 a[2:3], v22 offset:16896
    ds_read_b64_tr_b16 a[8:9], v23 offset:16384
    ds_read_b64_tr_b16 a[10:11], v23 offset:16896
    ds_read_b64_tr_b16 a[32:33], v24 offset:16384
    ds_read_b64_tr_b16 a[34:35], v24 offset:16896
    ds_read_b64_tr_b16 a[40:41], v25 offset:16384
    ds_read_b64_tr_b16 a[42:43], v25 offset:16896
    s_waitcnt lgkmcnt(4)
    ds_read_b64_tr_b16 a[64:65], v26 offset:16384
    ds_read_b64_tr_b16 a[66:67], v26 offset:16896
    ds_read_b64_tr_b16 a[72:73], v27 offset:16384
    ds_read_b64_tr_b16 a[74:75], v27 offset:16896
    s_waitcnt lgkmcnt(0)
    s_barrier
    s_add_u32 m0, s28, 49152
    s_add_u32 s37, s3, 0x300000
    buffer_load_dwordx4 v16, s[96:99], s37 offen lds
    s_add_u32 m0, s28, 53248
    s_add_u32 s37, s3, 0x320000
    buffer_load_dwordx4 v16, s[96:99], s37 offen lds
    s_add_u32 m0, s28, 81920
    s_add_u32 s37, s3, 0x340000
    buffer_load_dwordx4 v16, s[96:99], s37 offen lds
    s_add_u32 m0, s28, 86016
    s_add_u32 s37, s3, 0x360000
    buffer_load_dwordx4 v16, s[96:99], s37 offen lds
    s_add_u32 m0, s28, 114688
    s_add_u32 s37, s3, 0x380000
    buffer_load_dwordx4 v16, s[96:99], s37 offen lds
    s_add_u32 m0, s28, 118784
    s_add_u32 s37, s3, 0x3a0000
    buffer_load_dwordx4 v16, s[96:99], s37 offen lds
    s_add_u32 m0, s28, 147456
    s_add_u32 s37, s3, 0x3c0000
    buffer_load_dwordx4 v16, s[96:99], s37 offen lds
    s_add_u32 m0, s28, 151552
    s_add_u32 s37, s3, 0x3e0000
    buffer_load_dwordx4 v16, s[96:99], s37 offen lds
    s_waitcnt vmcnt(17)
    v_perm_b32 v160, v49, v48, s34
    v_perm_b32 v161, v49, v48, s35
    v_perm_b32 v162, v51, v50, s34
    v_perm_b32 v163, v51, v50, s35
    v_perm_b32 v164, v53, v52, s34
    v_perm_b32 v165, v53, v52, s35
    v_perm_b32 v166, v55, v54, s34
    v_perm_b32 v167, v55, v54, s35
    v_perm_b32 v168, v57, v56, s34
    v_perm_b32 v169, v57, v56, s35
    v_perm_b32 v170, v59, v58, s34
    v_perm_b32 v171, v59, v58, s35
    v_perm_b32 v172, v61, v60, s34
    v_perm_b32 v173, v61, v60, s35
    v_perm_b32 v174, v63, v62, s34
    v_perm_b32 v175, v63, v62, s35
    s_waitcnt vmcnt(8)
    s_mov_b32 s41, 1
L_HS:
    v_cmp_eq_u32 vcc, 0, v30
    s_cbranch_vccz L_HS_ok
    buffer_load_dword v30, v31, s[16:19], 0 offen sc1
    s_add_u32 s32, s32, 1
    s_cmp_gt_u32 s32, 200000
    s_waitcnt vmcnt(0)
    s_cbranch_scc0 L_HS
    s_branch L_HS_done
L_HS_ok:
    v_readlane_b32 s36, v30, 63
    s_nop 1
    v_cmp_ne_u32 vcc, s36, v30
    s_nop 1
    s_cmp_lg_u32 vcc_hi, 0
    s_cselect_b32 s41, 1, 0
L_HS_done:
    s_mov_b32 s7, 0xf7df00
    buffer_load_dword v15, v0, s[8:11], s7 offen sc1
    s_barrier
    ds_read_b64_tr_b16 v[36:37], v20 offset:0
    ds_read_b64_tr_b16 v[38:39], v20 offset:512
    ds_read_b64_tr_b16 v[44:45], v21 offset:0
    ds_read_b64_tr_b16 v[46:47], v21 offset:512
    ds_read_b64_tr_b16 a[4:5], v22 offset:0
    ds_read_b64_tr_b16 a[6:7], v22 offset:512
    ds_read_b64_tr_b16 a[12:13], v23 offset:0
    ds_read_b64_tr_b16 a[14:15], v23 offset:512
    ds_read_b64_tr_b16 a[36:37], v24 offset:0
    ds_read_b64_tr_b16 a[38:39], v24 offset:512
    ds_read_b64_tr_b16 a[44:45], v25 offset:0
    ds_read_b64_tr_b16 a[46:47], v25 offset:512
    s_waitcnt lgkmcnt(4)
    ds_read_b64_tr_b16 a[68:69], v26 offset:0
    ds_read_b64_tr_b16 a[70:71], v26 offset:512
    ds_read_b64_tr_b16 a[76:77], v27 offset:0
    ds_read_b64_tr_b16 a[78:79], v27 offset:512
    s_waitcnt lgkmcnt(0)
    s_barrier
    s_barrier
    ds_read_b64_tr_b16 v[48:49], v20 offset:8192
    ds_read_b64_tr_b16 v[50:51], v20 offset:8704
    ds_read_b64_tr_b16 v[56:57], v21 offset:8192
    ds_read_b64_tr_b16 v[58:59], v21 offset:8704
    ds_read_b64_tr_b16 a[16:17], v22 offset:8192
    ds_read_b64_tr_b16 a[18:19], v22 offset:8704
    ds_read_b64_tr_b16 a[24:25], v23 offset:8192
    ds_read_b64_tr_b16 a[26:27], v23 offset:8704
    ds_read_b64_tr_b16 a[48:49], v24 offset:8192
    ds_read_b64_tr_b16 a[50:51], v24 offset:8704
    ds_read_b64_tr_b16 a[56:57], v25 offset:8192
    ds_read_b64_tr_b16 a[58:59], v25 offset:8704
    s_waitcnt lgkmcnt(4)
    ds_read_b64_tr_b16 v[80:81], v26 offset:8192
    ds_read_b64_tr_b16 v[82:83], v26 offset:8704
    ds_read_b64_tr_b16 v[88:89], v27 offset:8192
    ds_read_b64_tr_b16 v[90:91], v27 offset:8704
    s_waitcnt lgkmcnt(0)
    s_barrier
    s_waitcnt vmcnt(0)
L_F0:
    v_readlane_b32 s36, v15, 33
    s_nop 1
    s_cmp_lg_u32 s36, 0
    s_cbranch_scc1 L_F0_ok
    buffer_load_dword v15, v0, s[8:11], s7 offen sc1
    s_add_u32 s32, s32, 1
    s_cmp_gt_u32 s32, 200000
    s_waitcnt vmcnt(0)
    s_cbranch_scc0 L_F0
L_F0_ok:
    s_mov_b32 s7, 0x1000000
    buffer_load_dword v15, v0, s[8:11], s7 offen sc1
    s_barrier
    ds_read_b64_tr_b16 v[52:53], v20 offset:16384
    ds_read_b64_tr_b16 v[54:55], v20 offset:16896
    ds_read_b64_tr_b16 v[60:61], v21 offset:16384
    ds_read_b64_tr_b16 v[62:63], v21 offset:16896
    ds_read_b64_tr_b16 a[20:21], v22 offset:16384
    ds_read_b64_tr_b16 a[22:23], v22 offset:16896
    ds_read_b64_tr_b16 a[28:29], v23 offset:16384
    ds_read_b64_tr_b16 a[30:31], v23 offset:16896
    ds_read_b64_tr_b16 a[52:53], v24 offset:16384
    ds_read_b64_tr_b16 a[54:55], v24 offset:16896
    ds_read_b64_tr_b16 a[60:61], v25 offset:16384
    ds_read_b64_tr_b16 a[62:63], v25 offset:16896
    s_waitcnt lgkmcnt(4)
    ds_read_b64_tr_b16 v[84:85], v26 offset:16384
    ds_read_b64_tr_b16 v[86:87], v26 offset:16896
    ds_read_b64_tr_b16 v[92:93], v27 offset:16384
    ds_read_b64_tr_b16 v[94:95], v27 offset:16896
    s_waitcnt lgkmcnt(0)
    s_barrier
    ds_write_b128 v4, v[32:35] offset:0
    ds_write_b128 v4, v[36:39] offset:1024
    ds_write_b128 v4, v[40:43] offset:2048
    ds_write_b128 v4, v[44:47] offset:3072
    ds_write_b128 v4, v[48:51] offset:4096
    ds_write_b128 v4, v[52:55] offset:5120
    ds_write_b128 v4, v[56:59] offset:6144
    ds_write_b128 v4, v[60:63] offset:7168
    s_waitcnt lgkmcnt(0)
    ds_write_b128 v4, v[64:67] offset:8192
    ds_write_b128 v4, v[68:71] offset:9216
    ds_write_b128 v4, v[72:75] offset:10240
    ds_write_b128 v4, v[76:79] offset:11264
    ds_write_b128 v4, v[80:83] offset:12288
    ds_write_b128 v4, v[84:87] offset:13312
    ds_write_b128 v4, v[88:91] offset:14336
    ds_write_b128 v4, v[92:95] offset:15360
    s_waitcnt lgkmcnt(0)
    ds_write_b128 v4, v[96:99] offset:16384
    ds_write_b128 v4, v[100:103] offset:17408
    ds_write_b128 v4, v[104:107] offset:18432
    ds_write_b128 v4, v[108:111] offset:19456
    ds_write_b128 v4, v[112:115] offset:20480
    ds_write_b128 v4, v[116:119] offset:21504
    ds_write_b128 v4, v[120:123] offset:22528
    ds_write_b128 v4, v[124:127] offset:23552
    s_waitcnt lgkmcnt(0)
    s_waitcnt lgkmcnt(0)
    s_cmp_lg_u32 s41, 0
    s_cbranch_scc1 L_slow_start
L_fast_start:
    s_mov_b32 s22, 0
    s_mov_b32 s23, 0x1000000
    s_mov_b32 s27, 0
    s_mov_b32 s31, 0x80000
    s_mov_b32 s61, 0x40000000
    s_mov_b32 s96, 0x800
    s_mov_b32 s97, 0x1000
    s_mov_b32 s98, 0x1800
    s_mov_b32 s92, 0xcccccccc
    s_mov_b32 s93, 0xcccccccc
    s_mov_b32 s91, 0
    ds_read_b128 v[104:107], v4 offset:0
    ds_read_b128 v[108:111], v4 offset:1024
    ds_read_b128 v[112:115], v4 offset:2048
    ds_read_b128 v[116:119], v4 offset:3072
    ds_read_b128 v[88:91], v4 offset:4096
    ds_read_b128 v[92:95], v4 offset:5120
    ds_read_b128 v[96:99], v4 offset:6144
    ds_read_b128 v[100:103], v4 offset:7168
    ds_read_b128 v[72:75], v4 offset:8192
    ds_read_b128 v[76:79], v4 offset:9216
    ds_read_b128 v[80:83], v4 offset:10240
    ds_read_b128 v[84:87], v4 offset:11264
    v_mov_b64 v[48:49], 0
    v_mov_b64 v[50:51], 0
    v_mov_b64 v[52:53], 0
    v_mov_b64 v[54:55], 0
    v_mov_b64 v[56:57], 0
    v_mov_b64 v[58:59], 0
    v_mov_b64 v[60:61], 0
    v_mov_b64 v[62:63], 0
    v_mov_b64 v[64:65], 0
    v_mov_b64 v[66:67], 0
    v_mov_b64 v[68:69], 0
    v_mov_b64 v[70:71], 0
    s_add_u32 s7, s23, 0x80000
    buffer_load_dwordx4 v[16:19], v2, s[8:11], s7 offen sc1
    buffer_load_dwordx4 v[20:23], v2, s[8:11], s7 offen offset:1024 sc1
    s_waitcnt vmcnt(2)
.p2align 3
L_fast_step:
    v_readlane_b32 s36, v15, 33
    s_add_u32 s24, s23, 0x82100
    s_cmp_eq_u32 s36, 0
    s_cbranch_scc1 L_fast_refresh
L_fast_fresh:
    s_add_u32 s29, s23, s25
    s_add_u32 s30, s23, s39
    s_xor_b32 s28, s27, 1
    s_add_u32 s90, s22, 1
    s_nop 15
L_fast_retrym:
    buffer_load_dwordx4 v[16:19], v2, s[8:11], s7 offen sc1
    buffer_load_dwordx4 v[20:23], v2, s[8:11], s7 offen offset:1024 sc1
L_fast_prem:
    s_add_u32 s32, s32, 1
    s_cmp_gt_u32 s32, 200000
    s_cselect_b32 s94, -1, -2
    v_xor_b32 v28, 0x800, v2
    v_xor_b32 v44, 0x1800, v2
    v_mov_b64 v[48:49], 0
    v_mov_b64 v[50:51], 0
    v_mov_b64 v[52:53], 0
    v_mov_b64 v[54:55], 0
L_fast_waitm:
    s_waitcnt vmcnt(3) lgkmcnt(0)
L_fast_gotm:
    v_max3_u32 v14, v16, v17, v18
    v_max_u32_e64 v14, v14, v19
    v_smfmac_f32_16x16x64_bf16 v[48:51], v[16:19], v[104:111], v1
    s_nop 0
    s_waitcnt vmcnt(2)
    v_max3_u32 v14, v14, v20, v21
    v_smfmac_f32_16x16x64_bf16 v[52:55], v[16:19], v[112:119], v1
    v_max3_u32 v14, v14, v22, v23
    v_cmp_lt_u32_e64 vcc, s94, v14
    v_smfmac_f32_16x16x64_bf16 v[48:51], v[20:23], v[88:95], v1
    ds_write_b128 v2, v[16:19] offset:0
    s_cbranch_vccnz L_fast_retrym
    v_smfmac_f32_16x16x64_bf16 v[52:55], v[20:23], v[96:103], v1
    ds_write_b128 v2, v[20:23] offset:1024
    v_smfmac_f32_16x16x64_bf16 v[56:59], v[16:19], v[72:79], v1
    buffer_load_dwordx4 v[104:107], v3, s[8:11], s29 offen offset:0 sc1
    buffer_load_dwordx4 v[120:123], v3, s[8:11], s30 offen offset:0 sc1
    v_smfmac_f32_16x16x64_bf16 v[60:63], v[16:19], v[80:87], v1
    buffer_load_dwordx4 v[108:111], v3, s[8:11], s29 offen offset:1024 sc1
    buffer_load_dwordx4 v[124:127], v3, s[8:11], s30 offen offset:1024 sc1
    v_smfmac_f32_16x16x64_bf16 v[56:59], v[20:23], a[80:87], v1
    buffer_load_dwordx4 v[112:115], v3, s[8:11], s29 offen offset:2048 sc1
    buffer_load_dwordx4 v[116:119], v3, s[8:11], s29 offen offset:3072 sc1
    v_smfmac_f32_16x16x64_bf16 v[60:63], v[20:23], a[88:95], v1
    s_waitcnt lgkmcnt(0)
    s_barrier
    ds_read_b128 v[24:27], v28 offset:0
    v_smfmac_f32_16x16x64_bf16 v[64:67], v[16:19], a[160:167], v1
    ds_read_b128 v[28:31], v28 offset:1024
    v_smfmac_f32_16x16x64_bf16 v[68:71], v[16:19], a[168:175], v1
    buffer_load_dword v15, v0, s[8:11], s24 offen sc1
    v_smfmac_f32_16x16x64_bf16 v[64:67], v[20:23], a[176:183], v1
    ds_read_b128 v[32:35], v8 offset:0
    v_smfmac_f32_16x16x64_bf16 v[68:71], v[20:23], a[184:191], v1
    ds_read_b128 v[36:39], v8 offset:1024
    s_waitcnt lgkmcnt(3)
    v_smfmac_f32_16x16x64_bf16 v[48:51], v[24:27], a[0:7], v1
    ds_read_b128 v[40:43], v44 offset:0
    v_smfmac_f32_16x16x64_bf16 v[52:55], v[24:27], a[8:15], v1
    ds_read_b128 v[44:47], v44 offset:1024
    s_waitcnt lgkmcnt(4)
    v_smfmac_f32_16x16x64_bf16 v[48:51], v[28:31], a[16:23], v1
    ds_read_b128 v[88:91], v4 offset:12288
    v_smfmac_f32_16x16x64_bf16 v[52:55], v[28:31], a[24:31], v1
    ds_read_b128 v[92:95], v4 offset:13312
    s_waitcnt lgkmcnt(4)
    v_smfmac_f32_16x16x64_bf16 v[48:51], v[32:35], a[32:39], v1
    ds_read_b128 v[96:99], v4 offset:14336
    v_smfmac_f32_16x16x64_bf16 v[52:55], v[32:35], a[40:47], v1
    ds_read_b128 v[100:103], v4 offset:15360
    s_waitcnt lgkmcnt(4)
    v_smfmac_f32_16x16x64_bf16 v[48:51], v[36:39], a[48:55], v1
    v_smfmac_f32_16x16x64_bf16 v[52:55], v[36:39], a[56:63], v1
    ds_read_b128 v[72:75], v4 offset:16384
    v_smfmac_f32_16x16x64_bf16 v[48:51], v[40:43], a[64:71], v1
    v_smfmac_f32_16x16x64_bf16 v[52:55], v[40:43], a[72:79], v1
    ds_read_b128 v[76:79], v4 offset:17408
    s_waitcnt lgkmcnt(2)
    v_smfmac_f32_16x16x64_bf16 v[48:51], v[44:47], v[88:95], v1
    ds_read_b128 v[80:83], v4 offset:18432
    v_smfmac_f32_16x16x64_bf16 v[52:55], v[44:47], v[96:103], v1
    ds_read_b128 v[84:87], v4 offset:19456
    v_smfmac_f32_16x16x64_bf16 v[56:59], v[28:31], a[96:103], v1
    ds_read_b128 v[88:91], v4 offset:20480
    v_smfmac_f32_16x16x64_bf16 v[60:63], v[28:31], a[104:111], v1
    ds_read_b128 v[92:95], v4 offset:21504
    v_smfmac_f32_16x16x64_bf16 v[56:59], v[32:35], a[112:119], v1
    ds_read_b128 v[96:99], v4 offset:22528
    v_add_f32 v48, v48, v50
    v_add_f32 v49, v49, v51
    v_smfmac_f32_16x16x64_bf16 v[60:63], v[32:35], a[120:127], v1
    ds_read_b128 v[100:103], v4 offset:23552
    v_add_f32 v52, v52, v54
    v_add_f32 v53, v53, v55
    v_smfmac_f32_16x16x64_bf16 v[56:59], v[36:39], a[128:135], v1
    s_waitcnt lgkmcnt(4)
    v_mul_f32 v48, s33, v48
    v_mul_f32_e64 v52, s33, v52
    v_smfmac_f32_16x16x64_bf16 v[56:59], v[24:27], v[72:79], v1
    v_mul_f32 v49, s33, v49
    v_mul_f32 v53, s33, v53
    v_smfmac_f32_16x16x64_bf16 v[60:63], v[24:27], v[80:87], v1
    v_cvt_pk_bf16_f32 v50, v48, v52
    v_cvt_pk_bf16_f32 v51, v49, v53
    v_smfmac_f32_16x16x64_bf16 v[60:63], v[36:39], a[136:143], v1
    ds_write2_b32 v5, v50, v51 offset0:0 offset1:72
    v_smfmac_f32_16x16x64_bf16 v[56:59], v[40:43], a[144:151], v1
    buffer_store_dword v12, v10, s[8:11], s31 offen sc1
    v_smfmac_f32_16x16x64_bf16 v[60:63], v[40:43], a[152:159], v1
    s_nop 0
    s_waitcnt lgkmcnt(1)
    v_smfmac_f32_16x16x64_bf16 v[56:59], v[44:47], v[88:95], v1
    v_smfmac_f32_16x16x64_bf16 v[60:63], v[44:47], v[96:103], v1
    s_waitcnt lgkmcnt(0)
    s_barrier
    v_smfmac_f32_16x16x64_bf16 v[64:67], v[24:27], a[192:199], v1
    ds_read_b128 v[72:75], v6 offset:0
    v_smfmac_f32_16x16x64_bf16 v[68:71], v[24:27], a[200:207], v1
    ds_read_b128 v[76:79], v6 offset:64
    s_nop 0
    v_add_f32 v56, v56, v58
    v_smfmac_f32_16x16x64_bf16 v[64:67], v[28:31], a[208:215], v1
    ds_read_b128 v[80:83], v6 offset:128
    v_add_f32_e64 v57, v57, v59
    v_smfmac_f32_16x16x64_bf16 v[68:71], v[28:31], a[216:223], v1
    ds_read_b128 v[84:87], v6 offset:192
    s_waitcnt vmcnt(2) lgkmcnt(3)
    v_mfma_f32_16x16x32_bf16 v[48:51], v[104:107], v[72:75], 0
    s_waitcnt lgkmcnt(2)
    v_add_f32 v60, v60, v62
    v_add_f32 v61, v61, v63
    v_mfma_f32_16x16x32_bf16 v[48:51], v[108:111], v[76:79], v[48:51]
    s_waitcnt lgkmcnt(1)
    v_cvt_pk_bf16_f32 v58, v56, v60
    v_cvt_pk_bf16_f32 v59, v57, v61
    v_mfma_f32_16x16x32_bf16 v[48:51], v[112:115], v[80:83], v[48:51]
    ds_write2_b32 v7, v58, v59 offset0:0 offset1:72
    s_waitcnt lgkmcnt(1)
    v_mfma_f32_16x16x32_bf16 v[48:51], v[116:119], v[84:87], v[48:51]
    v_mov_b64 v[104:105], s[4:5]
    v_mov_b64 v[106:107], s[4:5]
    v_smfmac_f32_16x16x64_bf16 v[64:67], v[32:35], a[224:231], v1
    v_mov_b32_e64 v113, 0
    v_smfmac_f32_16x16x64_bf16 v[68:71], v[32:35], a[232:239], v1
    s_nop 1
    v_mov_b32 v115, 0
    v_smfmac_f32_16x16x64_bf16 v[64:67], v[36:39], a[240:247], v1
    s_waitcnt lgkmcnt(0)
    s_barrier
    v_exp_f32_e64 v48, v48
    v_smfmac_f32_16x16x64_bf16 v[68:71], v[36:39], a[248:255], v1
    ds_read_b128 v[88:91], v6 offset:2304
    v_exp_f32_e64 v49, v49
    v_smfmac_f32_16x16x64_bf16 v[64:67], v[40:43], v[128:135], v1
    ds_read_b128 v[92:95], v6 offset:2368
    v_exp_f32_e64 v50, v50
    v_smfmac_f32_16x16x64_bf16 v[68:71], v[40:43], v[136:143], v1
    ds_read_b128 v[96:99], v6 offset:2432
    v_exp_f32_e64 v51, v51
    v_smfmac_f32_16x16x64_bf16 v[64:67], v[44:47], v[144:151], v1
    ds_read_b128 v[100:103], v6 offset:2496
    v_cvt_pk_bf16_f32 v108, v48, v49
    v_cvt_pk_bf16_f32 v109, v50, v51
    v_smfmac_f32_16x16x64_bf16 v[68:71], v[44:47], v[152:159], v1
    ds_write_b64 v2, v[108:109] offset:8192
    s_waitcnt lgkmcnt(4)
    v_mfma_f32_16x16x32_bf16 v[52:55], v[88:91], v[72:75], 0
    s_waitcnt lgkmcnt(3)
    v_mov_b32 v117, 0
    v_mov_b64 v[16:17], 0
    v_mfma_f32_16x16x32_bf16 v[52:55], v[92:95], v[76:79], v[52:55]
    s_waitcnt lgkmcnt(2)
    v_mov_b64 v[18:19], 0
    v_mov_b64_e64 v[20:21], 0
    v_mfma_f32_16x16x32_bf16 v[52:55], v[96:99], v[80:83], v[52:55]
    s_waitcnt lgkmcnt(1)
    v_add_f32 v64, v64, v66
    v_add_f32_e64 v65, v65, v67
    v_mfma_f32_16x16x32_bf16 v[52:55], v[100:103], v[84:87], v[52:55]
    s_waitcnt lgkmcnt(0)
    s_barrier
    ds_read_b64 v[110:111], v8 offset:8192
    v_add_f32 v68, v68, v70
    v_add_f32 v69, v69, v71
    v_cvt_pk_bf16_f32 v114, v64, v65
    v_cvt_pk_bf16_f32 v116, v68, v69
    v_mov_b64 v[22:23], 0
    v_exp_f32 v52, v52
    v_exp_f32 v53, v53
    s_waitcnt lgkmcnt(0)
    v_mfma_f32_16x16x32_bf16 v[48:51], v[104:107], v[108:111], 0
    v_cvt_pk_bf16_f32 v112, v52, v53
    v_mov_b64_e64 v[24:25], 0
    v_mfma_f32_16x16x32_bf16 v[56:59], v[120:123], v[108:111], 0
    v_mov_b64 v[26:27], 0
    v_mov_b64 v[28:29], 0
    v_mfma_f32_16x16x32_bf16 v[60:63], v[124:127], v[108:111], 0
    v_mov_b64_e64 v[30:31], 0
    v_bitop3_b32 v32, v13, s96, -9 bitop3:0x28
    v_mfma_f32_16x16x16_bf16 v[48:51], v[104:105], v[112:113], v[48:51]
    v_bitop3_b32 v36, v13, s97, -9 bitop3:0x28
    v_bitop3_b32 v40, v13, s98, -9 bitop3:0x28
    v_mfma_f32_16x16x16_bf16 v[56:59], v[114:115], v[112:113], v[56:59]
    s_nop 1
    v_mfma_f32_16x16x16_bf16 v[60:63], v[116:117], v[112:113], v[60:63]
    s_nop 1
    v_rcp_f32 v118, v48
    s_nop 0
    v_max_f32 v14, v118, v48
    v_cmp_nge_f32 vcc, s40, v14
    v_pk_mul_f32 v[56:57], v[56:57], v[118:119] op_sel_hi:[1,0]
    v_pk_mul_f32 v[58:59], v[58:59], v[118:119] op_sel_hi:[1,0]
    v_pk_mul_f32 v[60:61], v[60:61], v[118:119] op_sel_hi:[1,0]
    v_pk_mul_f32 v[62:63], v[62:63], v[118:119] op_sel_hi:[1,0]
    v_cvt_pk_bf16_f32 v52, v56, v60
    v_cvt_pk_bf16_f32 v54, v58, v62
    v_cvt_pk_bf16_f32 v53, v57, v61
    v_cvt_pk_bf16_f32 v55, v59, v63
L_fast_rejoin:
    v_cndmask_b32 v50, v52, v54, s[92:93]
    v_cndmask_b32 v51, v53, v55, s[92:93]
    ds_write_b64 v13, v[50:51] offset:9216
    v_smfmac_f32_16x16x64_bf16 v[16:19], v[52:55], v[160:167], v1
    v_smfmac_f32_16x16x64_bf16 v[20:23], v[52:55], v[168:175], v1
    s_waitcnt lgkmcnt(0)
    s_barrier
    ds_read_b128 v[32:35], v32 offset:9216
    ds_read_b128 v[36:39], v36 offset:9216
    v_smfmac_f32_16x16x64_bf16 v[24:27], v[52:55], v[176:183], v1
    ds_read_b128 v[40:43], v40 offset:9216
    v_smfmac_f32_16x16x64_bf16 v[28:31], v[52:55], v[184:191], v1
    ds_read_b128 v[88:91], v4 offset:24576
    ds_read_b128 v[92:95], v4 offset:25600
    s_waitcnt lgkmcnt(4)
    v_smfmac_f32_16x16x64_bf16 v[16:19], v[32:35], v[192:199], v1
    ds_read_b128 v[96:99], v4 offset:26624
    s_waitcnt lgkmcnt(4)
    v_smfmac_f32_16x16x64_bf16 v[16:19], v[36:39], v[216:223], v1
    ds_read_b128 v[100:103], v4 offset:27648
    s_waitcnt lgkmcnt(4)
    v_smfmac_f32_16x16x64_bf16 v[16:19], v[40:43], v[240:247], v1
    ds_read_b128 v[72:75], v4 offset:28672
    s_cmp_lg_u64 vcc, 0
    v_smfmac_f32_16x16x64_bf16 v[20:23], v[32:35], v[200:207], v1
    ds_read_b128 v[76:79], v4 offset:29696
    s_cselect_b32 s60, s28, s27
    v_smfmac_f32_16x16x64_bf16 v[20:23], v[36:39], v[224:231], v1
    ds_read_b128 v[80:83], v4 offset:30720
    s_nop 0
    v_cvt_pk_bf16_f32 v56, v16, v18
    v_smfmac_f32_16x16x64_bf16 v[20:23], v[40:43], v[248:255], v1
    ds_read_b128 v[84:87], v4 offset:31744
    v_cvt_pk_bf16_f32 v57, v17, v19
    v_and_or_b32 v56, v56, -2, s60
    v_smfmac_f32_16x16x64_bf16 v[24:27], v[32:35], v[208:215], v1
    buffer_store_dwordx2 v[56:57], v9, s[8:11], 0 offen offset:0
    v_smfmac_f32_16x16x64_bf16 v[24:27], v[36:39], v[232:239], v1
    s_waitcnt lgkmcnt(4)
    s_nop 0
    v_cvt_pk_bf16_f32 v58, v20, v22
    v_smfmac_f32_16x16x64_bf16 v[24:27], v[40:43], v[88:95], v1
    ds_read_b128 v[64:67], v3 offset:23040
    v_cvt_pk_bf16_f32 v59, v21, v23
    v_and_or_b32 v58, v58, -2, s60
    v_smfmac_f32_16x16x64_bf16 v[28:31], v[32:35], v[96:103], v1
    buffer_store_dwordx2 v[58:59], v9, s[8:11], 0 offen offset:2048
    s_waitcnt lgkmcnt(1)
    v_smfmac_f32_16x16x64_bf16 v[28:31], v[36:39], v[72:79], v1
    s_nop 1
    v_cvt_pk_bf16_f32 v60, v24, v26
    v_smfmac_f32_16x16x64_bf16 v[28:31], v[40:43], v[80:87], v1
    s_nop 0
    s_nop 2
    v_cvt_pk_bf16_f32 v61, v25, v27
    v_and_or_b32 v60, v60, -2, s60
    buffer_store_dwordx2 v[60:61], v9, s[8:11], s26 offen offset:0
    s_nop 1
    v_cvt_pk_bf16_f32 v62, v28, v30
    v_cvt_pk_bf16_f32 v63, v29, v31
    v_and_or_b32 v62, v62, -2, s60
    buffer_store_dwordx2 v[62:63], v9, s[8:11], s26 offen offset:2048
L_fast_stored:
    s_cmp_lg_u32 s60, s27
    s_cbranch_scc1 L_fast_safe
    ds_read_b128 v[104:107], v4 offset:0
    ds_read_b128 v[108:111], v4 offset:1024
    ds_read_b128 v[112:115], v4 offset:2048
    ds_read_b128 v[116:119], v4 offset:3072
    ds_read_b128 v[88:91], v4 offset:4096
    ds_read_b128 v[92:95], v4 offset:5120
    ds_read_b128 v[96:99], v4 offset:6144
    ds_read_b128 v[100:103], v4 offset:7168
    ds_read_b128 v[72:75], v4 offset:8192
    ds_read_b128 v[76:79], v4 offset:9216
    ds_read_b128 v[80:83], v4 offset:10240
    ds_read_b128 v[84:87], v4 offset:11264
    s_cmp_lt_u32 s21, 1
    s_cbranch_scc1 L_fast_pollp
    s_nop 9
    s_cmp_lt_u32 s21, 2
    s_cbranch_scc1 L_fast_pollp
    s_nop 9
    s_cmp_lt_u32 s21, 3
    s_cbranch_scc1 L_fast_pollp
    s_nop 9
L_fast_pollp:
    buffer_load_dwordx4 v[120:123], v2, s[8:11], s6 offen sc1
    buffer_load_dwordx4 v[124:127], v2, s[8:11], s6 offen offset:1024 sc1
    v_mov_b64 v[56:57], 0
    v_mov_b64 v[58:59], 0
    v_mov_b64 v[60:61], 0
    v_mov_b64 v[62:63], 0
    s_nop 15
    s_nop 15
    buffer_load_dwordx4 v[32:35], v2, s[8:11], s6 offen sc1
    buffer_load_dwordx4 v[36:39], v2, s[8:11], s6 offen offset:1024 sc1
L_fast_prep:
    s_add_u32 s7, s24, 0x80000
    s_waitcnt vmcnt(3) lgkmcnt(0)
    v_mfma_f32_16x16x32_bf16 v[68:71], v[64:67], v[120:123], 0
    v_bitop3_b32 v14, v120, v122, s27 bitop3:0x7e
    s_waitcnt vmcnt(2)
    v_mfma_f32_16x16x32_bf16 v[68:71], v[64:67], v[124:127], v[68:71]
    v_bitop3_b32 v11, v124, v126, s27 bitop3:0x7e
    v_bitop3_b32 v14, v14, v11, 1 bitop3:0xa8
    v_cmp_ne_u32 vcc, 0, v14
    s_nop 2
    s_cmp_eq_u64 vcc, 0
    s_cselect_b32 s36, s24, s61
    v_add_f32_dpp v68, v68, v68 row_ror:8 row_mask:0xf bank_mask:0xf
    v_add_f32_dpp v69, v69, v69 row_ror:8 row_mask:0xf bank_mask:0xf
    s_nop 0
    v_add_f32_dpp v68, v68, v68 row_ror:4 row_mask:0xf bank_mask:0xf
    v_add_f32_dpp v69, v69, v69 row_ror:4 row_mask:0xf bank_mask:0xf
    v_cvt_pk_bf16_f32 v12, v68, v69
    buffer_store_dword v12, v10, s[8:11], s36 offen
    s_cbranch_scc1 L_fast_gotp
L_fast_retryp:
    buffer_load_dwordx4 v[120:123], v2, s[8:11], s6 offen sc1
    buffer_load_dwordx4 v[124:127], v2, s[8:11], s6 offen offset:1024 sc1
    s_waitcnt vmcnt(4) lgkmcnt(0)
    v_mfma_f32_16x16x32_bf16 v[68:71], v[64:67], v[32:35], 0
    v_bitop3_b32 v14, v32, v34, s27 bitop3:0x7e
    s_waitcnt vmcnt(3)
    v_mfma_f32_16x16x32_bf16 v[68:71], v[64:67], v[36:39], v[68:71]
    v_bitop3_b32 v11, v36, v38, s27 bitop3:0x7e
    v_bitop3_b32 v14, v14, v11, 1 bitop3:0xa8
    v_cmp_ne_u32 vcc, 0, v14
    s_nop 2
    s_cmp_eq_u64 vcc, 0
    s_cselect_b32 s36, s24, s61
    v_add_f32_dpp v68, v68, v68 row_ror:8 row_mask:0xf bank_mask:0xf
    v_add_f32_dpp v69, v69, v69 row_ror:8 row_mask:0xf bank_mask:0xf
    s_nop 0
    v_add_f32_dpp v68, v68, v68 row_ror:4 row_mask:0xf bank_mask:0xf
    v_add_f32_dpp v69, v69, v69 row_ror:4 row_mask:0xf bank_mask:0xf
    v_cvt_pk_bf16_f32 v12, v68, v69
    buffer_store_dword v12, v10, s[8:11], s36 offen
    s_cbranch_scc1 L_fast_gotp
    buffer_load_dwordx4 v[32:35], v2, s[8:11], s6 offen sc1
    buffer_load_dwordx4 v[36:39], v2, s[8:11], s6 offen offset:1024 sc1
    s_waitcnt vmcnt(4) lgkmcnt(0)
    v_mfma_f32_16x16x32_bf16 v[68:71], v[64:67], v[120:123], 0
    v_bitop3_b32 v14, v120, v122, s27 bitop3:0x7e
    s_waitcnt vmcnt(3)
    v_mfma_f32_16x16x32_bf16 v[68:71], v[64:67], v[124:127], v[68:71]
    v_bitop3_b32 v11, v124, v126, s27 bitop3:0x7e
    v_bitop3_b32 v14, v14, v11, 1 bitop3:0xa8
    v_cmp_ne_u32 vcc, 0, v14
    s_nop 2
    s_cmp_eq_u64 vcc, 0
    s_cselect_b32 s36, s24, s61
    v_add_f32_dpp v68, v68, v68 row_ror:8 row_mask:0xf bank_mask:0xf
    v_add_f32_dpp v69, v69, v69 row_ror:8 row_mask:0xf bank_mask:0xf
    s_nop 0
    v_add_f32_dpp v68, v68, v68 row_ror:4 row_mask:0xf bank_mask:0xf
    v_add_f32_dpp v69, v69, v69 row_ror:4 row_mask:0xf bank_mask:0xf
    v_cvt_pk_bf16_f32 v12, v68, v69
    buffer_store_dword v12, v10, s[8:11], s36 offen
    s_cbranch_scc1 L_fast_gotp
    s_add_u32 s32, s32, 1
    s_cmp_le_u32 s32, 200000
    s_cbranch_scc1 L_fast_retryp
    s_mov_b32 s36, s24
    buffer_store_dword v12, v10, s[8:11], s36 offen
L_fast_gotp:
    s_add_u32 s31, s31, 0x2000
    s_cmp_ge_u32 s90, 63
    s_cbranch_scc1 L_fast_last
    s_mov_b32 s23, s24
    s_mov_b32 s22, s90
    s_mov_b32 s27, s28
    v_mov_b64 v[64:65], 0
    v_mov_b64 v[66:67], 0
    v_mov_b64 v[68:69], 0
    v_mov_b64 v[70:71], 0
    s_nop 15
    s_nop 11
    buffer_load_dwordx4 v[16:19], v2, s[8:11], s7 offen sc1
    buffer_load_dwordx4 v[20:23], v2, s[8:11], s7 offen offset:1024 sc1
    s_branch L_fast_step
L_fast_last:
    buffer_store_dword v12, v10, s[8:11], s31 offen sc1
    s_branch L_fast_done
L_fast_refresh:
    buffer_load_dword v15, v0, s[8:11], s23 offen sc1
    s_add_u32 s32, s32, 1
    s_cmp_le_u32 s32, 200000
    s_waitcnt vmcnt(0)
    s_cbranch_scc1 L_fast_step
    s_branch L_fast_fresh
L_fast_safe:
    s_nop 11
    s_waitcnt vmcnt(0) lgkmcnt(0)
    s_barrier
    ds_read_b128 v[72:75], v6 offset:0
    ds_read_b128 v[88:91], v6 offset:2304
    ds_read_b128 v[76:79], v6 offset:64
    ds_read_b128 v[92:95], v6 offset:2368
    ds_read_b128 v[80:83], v6 offset:128
    ds_read_b128 v[96:99], v6 offset:2432
    ds_read_b128 v[84:87], v6 offset:192
    ds_read_b128 v[100:103], v6 offset:2496
    s_xor_b32 s36, s25, 0x1000
    s_add_u32 s36, s36, s23
    buffer_load_dwordx4 v[16:19], v3, s[8:11], s29 offen offset:0 sc1
    buffer_load_dwordx4 v[32:35], v3, s[8:11], s36 offen offset:0 sc1
    buffer_load_dwordx4 v[20:23], v3, s[8:11], s29 offen offset:1024 sc1
    buffer_load_dwordx4 v[36:39], v3, s[8:11], s36 offen offset:1024 sc1
    buffer_load_dwordx4 v[24:27], v3, s[8:11], s29 offen offset:2048 sc1
    buffer_load_dwordx4 v[40:43], v3, s[8:11], s36 offen offset:2048 sc1
    buffer_load_dwordx4 v[28:31], v3, s[8:11], s29 offen offset:3072 sc1
    buffer_load_dwordx4 v[44:47], v3, s[8:11], s36 offen offset:3072 sc1
    s_waitcnt vmcnt(0) lgkmcnt(0)
    v_mfma_f32_16x16x32_bf16 v[48:51], v[16:19], v[72:75], 0
    v_mfma_f32_16x16x32_bf16 v[48:51], v[20:23], v[76:79], v[48:51]
    v_mfma_f32_16x16x32_bf16 v[48:51], v[24:27], v[80:83], v[48:51]
    v_mfma_f32_16x16x32_bf16 v[48:51], v[28:31], v[84:87], v[48:51]
    v_mfma_f32_16x16x32_bf16 v[52:55], v[32:35], v[72:75], 0
    v_mfma_f32_16x16x32_bf16 v[52:55], v[36:39], v[76:79], v[52:55]
    v_mfma_f32_16x16x32_bf16 v[52:55], v[40:43], v[80:83], v[52:55]
    v_mfma_f32_16x16x32_bf16 v[52:55], v[44:47], v[84:87], v[52:55]
    v_mfma_f32_16x16x32_bf16 v[56:59], v[88:91], v[72:75], 0
    v_mfma_f32_16x16x32_bf16 v[56:59], v[92:95], v[76:79], v[56:59]
    v_mfma_f32_16x16x32_bf16 v[56:59], v[96:99], v[80:83], v[56:59]
    v_mfma_f32_16x16x32_bf16 v[56:59], v[100:103], v[84:87], v[56:59]
    v_max3_f32 v16, v48, v49, v50
    s_nop 2
    v_max3_f32 v16, v16, v51, v52
    v_max3_f32 v16, v16, v53, v54
    s_nop 1
    v_max3_f32 v16, v16, v55, v56
    v_max_f32 v16, v16, v57
    v_mov_b32 v17, v16
    s_nop 1
    v_permlane16_swap_b32 v16, v17
    v_max_f32 v16, v16, v17
    v_mov_b32 v17, v16
    s_nop 1
    v_permlane32_swap_b32 v16, v17
    v_max_f32 v16, v16, v17
    v_sub_f32 v48, v48, v16
    v_exp_f32 v48, v48
    v_sub_f32 v49, v49, v16
    v_exp_f32 v49, v49
    v_sub_f32 v50, v50, v16
    v_exp_f32 v50, v50
    v_sub_f32 v51, v51, v16
    v_exp_f32 v51, v51
    v_sub_f32 v52, v52, v16
    v_exp_f32 v52, v52
    v_sub_f32 v53, v53, v16
    v_exp_f32 v53, v53
    v_sub_f32 v54, v54, v16
    v_exp_f32 v54, v54
    v_sub_f32 v55, v55, v16
    v_exp_f32 v55, v55
    v_sub_f32 v56, v56, v16
    v_exp_f32 v56, v56
    v_sub_f32 v57, v57, v16
    v_exp_f32 v57, v57
    v_cvt_pk_bf16_f32 v108, v48, v49
    v_cvt_pk_bf16_f32 v109, v50, v51
    v_cvt_pk_bf16_f32 v110, v52, v53
    v_cvt_pk_bf16_f32 v111, v54, v55
    v_cvt_pk_bf16_f32 v112, v56, v57
    s_nop 0
    v_mfma_f32_16x16x32_bf16 v[48:51], v[104:107], v[108:111], 0
    v_mfma_f32_16x16x32_bf16 v[56:59], v[120:123], v[108:111], 0
    v_mfma_f32_16x16x32_bf16 v[60:63], v[124:127], v[108:111], 0
    s_nop 3
    v_mfma_f32_16x16x16_bf16 v[48:51], v[104:105], v[112:113], v[48:51]
    v_mfma_f32_16x16x16_bf16 v[56:59], v[114:115], v[112:113], v[56:59]
    v_mfma_f32_16x16x16_bf16 v[60:63], v[116:117], v[112:113], v[60:63]
    s_nop 5
    v_rcp_f32 v118, v48
    s_nop 0
    v_mul_f32 v56, v56, v118
    v_mul_f32 v57, v57, v118
    v_mul_f32 v58, v58, v118
    v_mul_f32 v59, v59, v118
    v_mul_f32 v60, v60, v118
    v_mul_f32 v61, v61, v118
    v_mul_f32 v62, v62, v118
    v_mul_f32 v63, v63, v118
    v_cvt_pk_bf16_f32 v52, v56, v60
    v_cvt_pk_bf16_f32 v53, v57, v61
    v_cvt_pk_bf16_f32 v54, v58, v62
    v_cvt_pk_bf16_f32 v55, v59, v63
    v_mov_b32 v16, 0
    v_mov_b32 v17, 0
    v_mov_b32 v18, 0
    v_mov_b32 v19, 0
    v_mov_b32 v20, 0
    v_mov_b32 v21, 0
    v_mov_b32 v22, 0
    v_mov_b32 v23, 0
    v_mov_b32 v24, 0
    v_mov_b32 v25, 0
    v_mov_b32 v26, 0
    v_mov_b32 v27, 0
    v_mov_b32 v28, 0
    v_mov_b32 v29, 0
    v_mov_b32 v30, 0
    v_mov_b32 v31, 0
    v_bitop3_b32 v32, v13, s96, -9 bitop3:0x28
    v_bitop3_b32 v36, v13, s97, -9 bitop3:0x28
    v_bitop3_b32 v40, v13, s98, -9 bitop3:0x28
    s_mov_b64 vcc, 0
    s_branch L_fast_rejoin
L_fast_done:
    s_branch L_end
L_slow_start:
    s_mov_b32 s22, 0
    s_mov_b32 s23, 0x1000000
    s_mov_b32 s27, 0
    s_mov_b32 s31, 0x80000
    s_mov_b32 s61, 0x40000000
    s_mov_b32 s96, 0x800
    s_mov_b32 s97, 0x1000
    s_mov_b32 s98, 0x1800
    s_mov_b32 s92, 0xcccccccc
    s_mov_b32 s93, 0xcccccccc
    s_mov_b32 s91, 0
    ds_read_b128 v[104:107], v4 offset:0
    ds_read_b128 v[108:111], v4 offset:1024
    ds_read_b128 v[112:115], v4 offset:2048
    ds_read_b128 v[116:119], v4 offset:3072
    ds_read_b128 v[88:91], v4 offset:4096
    ds_read_b128 v[92:95], v4 offset:5120
    ds_read_b128 v[96:99], v4 offset:6144
    ds_read_b128 v[100:103], v4 offset:7168
    ds_read_b128 v[72:75], v4 offset:8192
    ds_read_b128 v[76:79], v4 offset:9216
    ds_read_b128 v[80:83], v4 offset:10240
    ds_read_b128 v[84:87], v4 offset:11264
    v_mov_b64 v[48:49], 0
    v_mov_b64 v[50:51], 0
    v_mov_b64 v[52:53], 0
    v_mov_b64 v[54:55], 0
    v_mov_b64 v[56:57], 0
    v_mov_b64 v[58:59], 0
    v_mov_b64 v[60:61], 0
    v_mov_b64 v[62:63], 0
    v_mov_b64 v[64:65], 0
    v_mov_b64 v[66:67], 0
    v_mov_b64 v[68:69], 0
    v_mov_b64 v[70:71], 0
    s_add_u32 s7, s23, 0x80000
    buffer_load_dwordx4 v[16:19], v2, s[8:11], s7 offen sc1
    buffer_load_dwordx4 v[20:23], v2, s[8:11], s7 offen offset:1024 sc1
    s_waitcnt vmcnt(2)
L_slow_step:
    v_readlane_b32 s36, v15, 33
    s_add_u32 s24, s23, 0x82100
    s_cmp_eq_u32 s36, 0
    s_cbranch_scc1 L_slow_refresh
L_slow_fresh:
    s_add_u32 s29, s23, s25
    s_add_u32 s30, s23, s39
    s_xor_b32 s28, s27, 1
    s_add_u32 s90, s22, 1
    s_nop 15
L_slow_retrym:
    buffer_load_dwordx4 v[16:19], v2, s[8:11], s7 offen sc1
    buffer_load_dwordx4 v[20:23], v2, s[8:11], s7 offen offset:1024 sc1
L_slow_prem:
    s_add_u32 s32, s32, 1
    s_cmp_gt_u32 s32, 200000
    s_cselect_b32 s94, -1, -2
    v_xor_b32 v28, 0x800, v2
    v_xor_b32 v44, 0x1800, v2
    v_mov_b64 v[48:49], 0
    v_mov_b64 v[50:51], 0
    v_mov_b64 v[52:53], 0
    v_mov_b64 v[54:55], 0
L_slow_waitm:
    s_waitcnt vmcnt(3) lgkmcnt(0)
L_slow_gotm:
    v_max3_u32 v14, v16, v17, v18
    v_max_u32 v14, v14, v19
    v_smfmac_f32_16x16x64_bf16 v[48:51], v[16:19], v[104:111], v1
    s_waitcnt vmcnt(2)
    v_max3_u32 v14, v14, v20, v21
    v_smfmac_f32_16x16x64_bf16 v[52:55], v[16:19], v[112:119], v1
    v_max3_u32 v14, v14, v22, v23
    v_cmp_lt_u32 vcc, s94, v14
    v_smfmac_f32_16x16x64_bf16 v[48:51], v[20:23], v[88:95], v1
    ds_write_b128 v2, v[16:19] offset:0
    s_cbranch_vccnz L_slow_retrym
    v_smfmac_f32_16x16x64_bf16 v[52:55], v[20:23], v[96:103], v1
    ds_write_b128 v2, v[20:23] offset:1024
    v_smfmac_f32_16x16x64_bf16 v[56:59], v[16:19], v[72:79], v1
    buffer_load_dwordx4 v[104:107], v3, s[8:11], s29 offen offset:0 sc1
    buffer_load_dwordx4 v[120:123], v3, s[8:11], s30 offen offset:0 sc1
    v_smfmac_f32_16x16x64_bf16 v[60:63], v[16:19], v[80:87], v1
    buffer_load_dwordx4 v[108:111], v3, s[8:11], s29 offen offset:1024 sc1
    buffer_load_dwordx4 v[124:127], v3, s[8:11], s30 offen offset:1024 sc1
    v_smfmac_f32_16x16x64_bf16 v[56:59], v[20:23], a[80:87], v1
    buffer_load_dwordx4 v[112:115], v3, s[8:11], s29 offen offset:2048 sc1
    buffer_load_dwordx4 v[116:119], v3, s[8:11], s29 offen offset:3072 sc1
    v_smfmac_f32_16x16x64_bf16 v[60:63], v[20:23], a[88:95], v1
    s_waitcnt lgkmcnt(0)
    s_barrier
    ds_read_b128 v[24:27], v28 offset:0
    v_smfmac_f32_16x16x64_bf16 v[64:67], v[16:19], a[160:167], v1
    ds_read_b128 v[28:31], v28 offset:1024
    v_smfmac_f32_16x16x64_bf16 v[68:71], v[16:19], a[168:175], v1
    buffer_load_dword v15, v0, s[8:11], s24 offen sc1
    v_smfmac_f32_16x16x64_bf16 v[64:67], v[20:23], a[176:183], v1
    ds_read_b128 v[32:35], v8 offset:0
    v_smfmac_f32_16x16x64_bf16 v[68:71], v[20:23], a[184:191], v1
    ds_read_b128 v[36:39], v8 offset:1024
    s_waitcnt lgkmcnt(3)
    v_smfmac_f32_16x16x64_bf16 v[48:51], v[24:27], a[0:7], v1
    ds_read_b128 v[40:43], v44 offset:0
    v_smfmac_f32_16x16x64_bf16 v[52:55], v[24:27], a[8:15], v1
    ds_read_b128 v[44:47], v44 offset:1024
    s_waitcnt lgkmcnt(4)
    v_smfmac_f32_16x16x64_bf16 v[48:51], v[28:31], a[16:23], v1
    ds_read_b128 v[88:91], v4 offset:12288
    v_smfmac_f32_16x16x64_bf16 v[52:55], v[28:31], a[24:31], v1
    ds_read_b128 v[92:95], v4 offset:13312
    s_waitcnt lgkmcnt(4)
    v_smfmac_f32_16x16x64_bf16 v[48:51], v[32:35], a[32:39], v1
    ds_read_b128 v[96:99], v4 offset:14336
    v_smfmac_f32_16x16x64_bf16 v[52:55], v[32:35], a[40:47], v1
    ds_read_b128 v[100:103], v4 offset:15360
    s_waitcnt lgkmcnt(4)
    v_smfmac_f32_16x16x64_bf16 v[48:51], v[36:39], a[48:55], v1
    v_smfmac_f32_16x16x64_bf16 v[52:55], v[36:39], a[56:63], v1
    ds_read_b128 v[72:75], v4 offset:16384
    v_smfmac_f32_16x16x64_bf16 v[48:51], v[40:43], a[64:71], v1
    v_smfmac_f32_16x16x64_bf16 v[52:55], v[40:43], a[72:79], v1
    ds_read_b128 v[76:79], v4 offset:17408
    s_waitcnt lgkmcnt(2)
    v_smfmac_f32_16x16x64_bf16 v[48:51], v[44:47], v[88:95], v1
    ds_read_b128 v[80:83], v4 offset:18432
    v_smfmac_f32_16x16x64_bf16 v[52:55], v[44:47], v[96:103], v1
    ds_read_b128 v[84:87], v4 offset:19456
    v_smfmac_f32_16x16x64_bf16 v[56:59], v[28:31], a[96:103], v1
    ds_read_b128 v[88:91], v4 offset:20480
    v_smfmac_f32_16x16x64_bf16 v[60:63], v[28:31], a[104:111], v1
    ds_read_b128 v[92:95], v4 offset:21504
    v_smfmac_f32_16x16x64_bf16 v[56:59], v[32:35], a[112:119], v1
    ds_read_b128 v[96:99], v4 offset:22528
    v_add_f32 v48, v48, v50
    v_add_f32 v49, v49, v51
    v_smfmac_f32_16x16x64_bf16 v[60:63], v[32:35], a[120:127], v1
    ds_read_b128 v[100:103], v4 offset:23552
    v_add_f32 v52, v52, v54
    v_add_f32 v53, v53, v55
    v_smfmac_f32_16x16x64_bf16 v[56:59], v[36:39], a[128:135], v1
    s_waitcnt lgkmcnt(4)
    v_mul_f32 v48, s33, v48
    v_mul_f32 v52, s33, v52
    v_smfmac_f32_16x16x64_bf16 v[56:59], v[24:27], v[72:79], v1
    v_mul_f32 v49, s33, v49
    v_mul_f32 v53, s33, v53
    v_smfmac_f32_16x16x64_bf16 v[60:63], v[24:27], v[80:87], v1
    v_cvt_pk_bf16_f32 v50, v48, v52
    v_cvt_pk_bf16_f32 v51, v49, v53
    v_smfmac_f32_16x16x64_bf16 v[60:63], v[36:39], a[136:143], v1
    ds_write2_b32 v5, v50, v51 offset0:0 offset1:72
    v_smfmac_f32_16x16x64_bf16 v[56:59], v[40:43], a[144:151], v1
    buffer_store_dword v12, v10, s[8:11], s31 offen sc1
    v_smfmac_f32_16x16x64_bf16 v[60:63], v[40:43], a[152:159], v1
    s_waitcnt lgkmcnt(1)
    v_smfmac_f32_16x16x64_bf16 v[56:59], v[44:47], v[88:95], v1
    v_smfmac_f32_16x16x64_bf16 v[60:63], v[44:47], v[96:103], v1
    s_waitcnt lgkmcnt(0)
    s_barrier
    v_smfmac_f32_16x16x64_bf16 v[64:67], v[24:27], a[192:199], v1
    ds_read_b128 v[72:75], v6 offset:0
    v_smfmac_f32_16x16x64_bf16 v[68:71], v[24:27], a[200:207], v1
    ds_read_b128 v[76:79], v6 offset:64
    s_nop 0
    v_add_f32 v56, v56, v58
    v_smfmac_f32_16x16x64_bf16 v[64:67], v[28:31], a[208:215], v1
    ds_read_b128 v[80:83], v6 offset:128
    v_add_f32 v57, v57, v59
    v_smfmac_f32_16x16x64_bf16 v[68:71], v[28:31], a[216:223], v1
    ds_read_b128 v[84:87], v6 offset:192
    s_waitcnt vmcnt(2) lgkmcnt(3)
    v_mfma_f32_16x16x32_bf16 v[48:51], v[104:107], v[72:75], 0
    s_waitcnt lgkmcnt(2)
    v_add_f32 v60, v60, v62
    v_add_f32 v61, v61, v63
    v_mfma_f32_16x16x32_bf16 v[48:51], v[108:111], v[76:79], v[48:51]
    s_waitcnt lgkmcnt(1)
    v_cvt_pk_bf16_f32 v58, v56, v60
    v_cvt_pk_bf16_f32 v59, v57, v61
    v_mfma_f32_16x16x32_bf16 v[48:51], v[112:115], v[80:83], v[48:51]
    ds_write2_b32 v7, v58, v59 offset0:0 offset1:72
    s_waitcnt lgkmcnt(1)
    v_mfma_f32_16x16x32_bf16 v[48:51], v[116:119], v[84:87], v[48:51]
    v_mov_b64 v[104:105], s[4:5]
    v_mov_b64 v[106:107], s[4:5]
    v_smfmac_f32_16x16x64_bf16 v[64:67], v[32:35], a[224:231], v1
    v_mov_b32 v113, 0
    v_smfmac_f32_16x16x64_bf16 v[68:71], v[32:35], a[232:239], v1
    s_nop 1
    v_mov_b32 v115, 0
    v_smfmac_f32_16x16x64_bf16 v[64:67], v[36:39], a[240:247], v1
    s_waitcnt lgkmcnt(0)
    s_barrier
    v_exp_f32 v48, v48
    v_smfmac_f32_16x16x64_bf16 v[68:71], v[36:39], a[248:255], v1
    ds_read_b128 v[88:91], v6 offset:2304
    v_exp_f32 v49, v49
    v_smfmac_f32_16x16x64_bf16 v[64:67], v[40:43], v[128:135], v1
    ds_read_b128 v[92:95], v6 offset:2368
    v_exp_f32 v50, v50
    v_smfmac_f32_16x16x64_bf16 v[68:71], v[40:43], v[136:143], v1
    ds_read_b128 v[96:99], v6 offset:2432
    v_exp_f32 v51, v51
    v_smfmac_f32_16x16x64_bf16 v[64:67], v[44:47], v[144:151], v1
    ds_read_b128 v[100:103], v6 offset:2496
    v_cvt_pk_bf16_f32 v108, v48, v49
    v_cvt_pk_bf16_f32 v109, v50, v51
    v_smfmac_f32_16x16x64_bf16 v[68:71], v[44:47], v[152:159], v1
    ds_write_b64 v2, v[108:109] offset:8192
    s_waitcnt lgkmcnt(4)
    v_mfma_f32_16x16x32_bf16 v[52:55], v[88:91], v[72:75], 0
    s_waitcnt lgkmcnt(3)
    v_mov_b32 v117, 0
    v_mov_b64 v[16:17], 0
    v_mfma_f32_16x16x32_bf16 v[52:55], v[92:95], v[76:79], v[52:55]
    s_waitcnt lgkmcnt(2)
    v_mov_b64 v[18:19], 0
    v_mov_b64 v[20:21], 0
    v_mfma_f32_16x16x32_bf16 v[52:55], v[96:99], v[80:83], v[52:55]
    s_waitcnt lgkmcnt(1)
    v_add_f32 v64, v64, v66
    v_add_f32 v65, v65, v67
    v_mfma_f32_16x16x32_bf16 v[52:55], v[100:103], v[84:87], v[52:55]
    s_waitcnt lgkmcnt(0)
    s_barrier
    ds_read_b64 v[110:111], v8 offset:8192
    v_add_f32 v68, v68, v70
    v_add_f32 v69, v69, v71
    v_cvt_pk_bf16_f32 v114, v64, v65
    v_cvt_pk_bf16_f32 v116, v68, v69
    v_mov_b64 v[22:23], 0
    v_exp_f32 v52, v52
    v_exp_f32 v53, v53
    s_waitcnt lgkmcnt(0)
    v_mfma_f32_16x16x32_bf16 v[48:51], v[104:107], v[108:111], 0
    v_cvt_pk_bf16_f32 v112, v52, v53
    v_mov_b64 v[24:25], 0
    v_mfma_f32_16x16x32_bf16 v[56:59], v[120:123], v[108:111], 0
    v_mov_b64 v[26:27], 0
    v_mov_b64 v[28:29], 0
    v_mfma_f32_16x16x32_bf16 v[60:63], v[124:127], v[108:111], 0
    v_mov_b64 v[30:31], 0
    v_bitop3_b32 v32, v13, s96, -9 bitop3:0x28
    v_mfma_f32_16x16x16_bf16 v[48:51], v[104:105], v[112:113], v[48:51]
    v_bitop3_b32 v36, v13, s97, -9 bitop3:0x28
    v_bitop3_b32 v40, v13, s98, -9 bitop3:0x28
    v_mfma_f32_16x16x16_bf16 v[56:59], v[114:115], v[112:113], v[56:59]
    s_nop 1
    v_mfma_f32_16x16x16_bf16 v[60:63], v[116:117], v[112:113], v[60:63]
    s_nop 1
    v_rcp_f32 v118, v48
    s_nop 0
    v_max_f32 v14, v118, v48
    v_cmp_nge_f32 vcc, s40, v14
    v_pk_mul_f32 v[56:57], v[56:57], v[118:119] op_sel_hi:[1,0]
    v_pk_mul_f32 v[58:59], v[58:59], v[118:119] op_sel_hi:[1,0]
    v_pk_mul_f32 v[60:61], v[60:61], v[118:119] op_sel_hi:[1,0]
    v_pk_mul_f32 v[62:63], v[62:63], v[118:119] op_sel_hi:[1,0]
    v_cvt_pk_bf16_f32 v52, v56, v60
    v_cvt_pk_bf16_f32 v54, v58, v62
    v_cvt_pk_bf16_f32 v53, v57, v61
    v_cvt_pk_bf16_f32 v55, v59, v63
L_slow_rejoin:
    v_cndmask_b32 v50, v52, v54, s[92:93]
    v_cndmask_b32 v51, v53, v55, s[92:93]
    ds_write_b64 v13, v[50:51] offset:9216
    v_smfmac_f32_16x16x64_bf16 v[16:19], v[52:55], v[160:167], v1
    v_smfmac_f32_16x16x64_bf16 v[20:23], v[52:55], v[168:175], v1
    s_waitcnt lgkmcnt(0)
    s_barrier
    ds_read_b128 v[32:35], v32 offset:9216
    ds_read_b128 v[36:39], v36 offset:9216
    v_smfmac_f32_16x16x64_bf16 v[24:27], v[52:55], v[176:183], v1
    ds_read_b128 v[40:43], v40 offset:9216
    v_smfmac_f32_16x16x64_bf16 v[28:31], v[52:55], v[184:191], v1
    ds_read_b128 v[88:91], v4 offset:24576
    ds_read_b128 v[92:95], v4 offset:25600
    s_waitcnt lgkmcnt(4)
    v_smfmac_f32_16x16x64_bf16 v[16:19], v[32:35], v[192:199], v1
    ds_read_b128 v[96:99], v4 offset:26624
    s_waitcnt lgkmcnt(4)
    v_smfmac_f32_16x16x64_bf16 v[16:19], v[36:39], v[216:223], v1
    ds_read_b128 v[100:103], v4 offset:27648
    s_waitcnt lgkmcnt(4)
    v_smfmac_f32_16x16x64_bf16 v[16:19], v[40:43], v[240:247], v1
    ds_read_b128 v[72:75], v4 offset:28672
    s_cmp_lg_u64 vcc, 0
    v_smfmac_f32_16x16x64_bf16 v[20:23], v[32:35], v[200:207], v1
    ds_read_b128 v[76:79], v4 offset:29696
    s_cselect_b32 s60, s28, s27
    v_smfmac_f32_16x16x64_bf16 v[20:23], v[36:39], v[224:231], v1
    ds_read_b128 v[80:83], v4 offset:30720
    s_nop 0
    v_cvt_pk_bf16_f32 v56, v16, v18
    v_smfmac_f32_16x16x64_bf16 v[20:23], v[40:43], v[248:255], v1
    ds_read_b128 v[84:87], v4 offset:31744
    v_cvt_pk_bf16_f32 v57, v17, v19
    v_and_or_b32 v56, v56, -2, s60
    v_smfmac_f32_16x16x64_bf16 v[24:27], v[32:35], v[208:215], v1
    buffer_store_dwordx2 v[56:57], v9, s[8:11], 0 offen offset:0 sc1
    v_smfmac_f32_16x16x64_bf16 v[24:27], v[36:39], v[232:239], v1
    s_waitcnt lgkmcnt(4)
    s_nop 0
    v_cvt_pk_bf16_f32 v58, v20, v22
    v_smfmac_f32_16x16x64_bf16 v[24:27], v[40:43], v[88:95], v1
    ds_read_b128 v[64:67], v3 offset:23040
    v_cvt_pk_bf16_f32 v59, v21, v23
    v_and_or_b32 v58, v58, -2, s60
    v_smfmac_f32_16x16x64_bf16 v[28:31], v[32:35], v[96:103], v1
    buffer_store_dwordx2 v[58:59], v9, s[8:11], 0 offen offset:2048 sc1
    s_waitcnt lgkmcnt(1)
    v_smfmac_f32_16x16x64_bf16 v[28:31], v[36:39], v[72:79], v1
    s_nop 1
    v_cvt_pk_bf16_f32 v60, v24, v26
    v_smfmac_f32_16x16x64_bf16 v[28:31], v[40:43], v[80:87], v1
    s_nop 2
    v_cvt_pk_bf16_f32 v61, v25, v27
    v_and_or_b32 v60, v60, -2, s60
    buffer_store_dwordx2 v[60:61], v9, s[8:11], s26 offen offset:0 sc1
    s_nop 1
    v_cvt_pk_bf16_f32 v62, v28, v30
    v_cvt_pk_bf16_f32 v63, v29, v31
    v_and_or_b32 v62, v62, -2, s60
    buffer_store_dwordx2 v[62:63], v9, s[8:11], s26 offen offset:2048 sc1
L_slow_stored:
    s_cmp_lg_u32 s60, s27
    s_cbranch_scc1 L_slow_safe
    ds_read_b128 v[104:107], v4 offset:0
    ds_read_b128 v[108:111], v4 offset:1024
    ds_read_b128 v[112:115], v4 offset:2048
    ds_read_b128 v[116:119], v4 offset:3072
    ds_read_b128 v[88:91], v4 offset:4096
    ds_read_b128 v[92:95], v4 offset:5120
    ds_read_b128 v[96:99], v4 offset:6144
    ds_read_b128 v[100:103], v4 offset:7168
    ds_read_b128 v[72:75], v4 offset:8192
    ds_read_b128 v[76:79], v4 offset:9216
    ds_read_b128 v[80:83], v4 offset:10240
    ds_read_b128 v[84:87], v4 offset:11264
    s_cmp_lt_u32 s21, 1
    s_cbranch_scc1 L_slow_pollp
    s_nop 9
    s_cmp_lt_u32 s21, 2
    s_cbranch_scc1 L_slow_pollp
    s_nop 9
    s_cmp_lt_u32 s21, 3
    s_cbranch_scc1 L_slow_pollp
    s_nop 9
L_slow_pollp:
    buffer_load_dwordx4 v[120:123], v2, s[8:11], s6 offen sc1
    buffer_load_dwordx4 v[124:127], v2, s[8:11], s6 offen offset:1024 sc1
    v_mov_b64 v[56:57], 0
    v_mov_b64 v[58:59], 0
    v_mov_b64 v[60:61], 0
    v_mov_b64 v[62:63], 0
    s_nop 15
    s_nop 15
    buffer_load_dwordx4 v[32:35], v2, s[8:11], s6 offen sc1
    buffer_load_dwordx4 v[36:39], v2, s[8:11], s6 offen offset:1024 sc1
L_slow_prep:
    s_add_u32 s7, s24, 0x80000
    s_waitcnt vmcnt(3) lgkmcnt(0)
    v_mfma_f32_16x16x32_bf16 v[68:71], v[64:67], v[120:123], 0
    v_bitop3_b32 v14, v120, v122, s27 bitop3:0x7e
    s_waitcnt vmcnt(2)
    v_mfma_f32_16x16x32_bf16 v[68:71], v[64:67], v[124:127], v[68:71]
    v_bitop3_b32 v11, v124, v126, s27 bitop3:0x7e
    v_bitop3_b32 v14, v14, v11, 1 bitop3:0xa8
    v_cmp_ne_u32 vcc, 0, v14
    s_nop 2
    s_cmp_eq_u64 vcc, 0
    s_cselect_b32 s36, s24, s61
    v_add_f32_dpp v68, v68, v68 row_ror:8 row_mask:0xf bank_mask:0xf
    v_add_f32_dpp v69, v69, v69 row_ror:8 row_mask:0xf bank_mask:0xf
    s_nop 0
    v_add_f32_dpp v68, v68, v68 row_ror:4 row_mask:0xf bank_mask:0xf
    v_add_f32_dpp v69, v69, v69 row_ror:4 row_mask:0xf bank_mask:0xf
    v_cvt_pk_bf16_f32 v12, v68, v69
    buffer_store_dword v12, v10, s[8:11], s36 offen sc1
    s_cbranch_scc1 L_slow_gotp
L_slow_retryp:
    buffer_load_dwordx4 v[120:123], v2, s[8:11], s6 offen sc1
    buffer_load_dwordx4 v[124:127], v2, s[8:11], s6 offen offset:1024 sc1
    s_waitcnt vmcnt(4) lgkmcnt(0)
    v_mfma_f32_16x16x32_bf16 v[68:71], v[64:67], v[32:35], 0
    v_bitop3_b32 v14, v32, v34, s27 bitop3:0x7e
    s_waitcnt vmcnt(3)
    v_mfma_f32_16x16x32_bf16 v[68:71], v[64:67], v[36:39], v[68:71]
    v_bitop3_b32 v11, v36, v38, s27 bitop3:0x7e
    v_bitop3_b32 v14, v14, v11, 1 bitop3:0xa8
    v_cmp_ne_u32 vcc, 0, v14
    s_nop 2
    s_cmp_eq_u64 vcc, 0
    s_cselect_b32 s36, s24, s61
    v_add_f32_dpp v68, v68, v68 row_ror:8 row_mask:0xf bank_mask:0xf
    v_add_f32_dpp v69, v69, v69 row_ror:8 row_mask:0xf bank_mask:0xf
    s_nop 0
    v_add_f32_dpp v68, v68, v68 row_ror:4 row_mask:0xf bank_mask:0xf
    v_add_f32_dpp v69, v69, v69 row_ror:4 row_mask:0xf bank_mask:0xf
    v_cvt_pk_bf16_f32 v12, v68, v69
    buffer_store_dword v12, v10, s[8:11], s36 offen sc1
    s_cbranch_scc1 L_slow_gotp
    buffer_load_dwordx4 v[32:35], v2, s[8:11], s6 offen sc1
    buffer_load_dwordx4 v[36:39], v2, s[8:11], s6 offen offset:1024 sc1
    s_waitcnt vmcnt(4) lgkmcnt(0)
    v_mfma_f32_16x16x32_bf16 v[68:71], v[64:67], v[120:123], 0
    v_bitop3_b32 v14, v120, v122, s27 bitop3:0x7e
    s_waitcnt vmcnt(3)
    v_mfma_f32_16x16x32_bf16 v[68:71], v[64:67], v[124:127], v[68:71]
    v_bitop3_b32 v11, v124, v126, s27 bitop3:0x7e
    v_bitop3_b32 v14, v14, v11, 1 bitop3:0xa8
    v_cmp_ne_u32 vcc, 0, v14
    s_nop 2
    s_cmp_eq_u64 vcc, 0
    s_cselect_b32 s36, s24, s61
    v_add_f32_dpp v68, v68, v68 row_ror:8 row_mask:0xf bank_mask:0xf
    v_add_f32_dpp v69, v69, v69 row_ror:8 row_mask:0xf bank_mask:0xf
    s_nop 0
    v_add_f32_dpp v68, v68, v68 row_ror:4 row_mask:0xf bank_mask:0xf
    v_add_f32_dpp v69, v69, v69 row_ror:4 row_mask:0xf bank_mask:0xf
    v_cvt_pk_bf16_f32 v12, v68, v69
    buffer_store_dword v12, v10, s[8:11], s36 offen sc1
    s_cbranch_scc1 L_slow_gotp
    s_add_u32 s32, s32, 1
    s_cmp_le_u32 s32, 200000
    s_cbranch_scc1 L_slow_retryp
    s_mov_b32 s36, s24
    buffer_store_dword v12, v10, s[8:11], s36 offen sc1
L_slow_gotp:
    s_add_u32 s31, s31, 0x2000
    s_cmp_ge_u32 s90, 63
    s_cbranch_scc1 L_slow_last
    s_mov_b32 s23, s24
    s_mov_b32 s22, s90
    s_mov_b32 s27, s28
    v_mov_b64 v[64:65], 0
    v_mov_b64 v[66:67], 0
    v_mov_b64 v[68:69], 0
    v_mov_b64 v[70:71], 0
    s_nop 15
    s_nop 11
    buffer_load_dwordx4 v[16:19], v2, s[8:11], s7 offen sc1
    buffer_load_dwordx4 v[20:23], v2, s[8:11], s7 offen offset:1024 sc1
    s_branch L_slow_step
L_slow_last:
    buffer_store_dword v12, v10, s[8:11], s31 offen sc1
    s_branch L_slow_done
L_slow_refresh:
    buffer_load_dword v15, v0, s[8:11], s23 offen sc1
    s_add_u32 s32, s32, 1
    s_cmp_le_u32 s32, 200000
    s_waitcnt vmcnt(0)
    s_cbranch_scc1 L_slow_step
    s_branch L_slow_fresh
L_slow_safe:
    s_nop 11
    s_waitcnt vmcnt(0) lgkmcnt(0)
    s_barrier
    ds_read_b128 v[72:75], v6 offset:0
    ds_read_b128 v[88:91], v6 offset:2304
    ds_read_b128 v[76:79], v6 offset:64
    ds_read_b128 v[92:95], v6 offset:2368
    ds_read_b128 v[80:83], v6 offset:128
    ds_read_b128 v[96:99], v6 offset:2432
    ds_read_b128 v[84:87], v6 offset:192
    ds_read_b128 v[100:103], v6 offset:2496
    s_xor_b32 s36, s25, 0x1000
    s_add_u32 s36, s36, s23
    buffer_load_dwordx4 v[16:19], v3, s[8:11], s29 offen offset:0 sc1
    buffer_load_dwordx4 v[32:35], v3, s[8:11], s36 offen offset:0 sc1
    buffer_load_dwordx4 v[20:23], v3, s[8:11], s29 offen offset:1024 sc1
    buffer_load_dwordx4 v[36:39], v3, s[8:11], s36 offen offset:1024 sc1
    buffer_load_dwordx4 v[24:27], v3, s[8:11], s29 offen offset:2048 sc1
    buffer_load_dwordx4 v[40:43], v3, s[8:11], s36 offen offset:2048 sc1
    buffer_load_dwordx4 v[28:31], v3, s[8:11], s29 offen offset:3072 sc1
    buffer_load_dwordx4 v[44:47], v3, s[8:11], s36 offen offset:3072 sc1
    s_waitcnt vmcnt(0) lgkmcnt(0)
    v_mfma_f32_16x16x32_bf16 v[48:51], v[16:19], v[72:75], 0
    v_mfma_f32_16x16x32_bf16 v[48:51], v[20:23], v[76:79], v[48:51]
    v_mfma_f32_16x16x32_bf16 v[48:51], v[24:27], v[80:83], v[48:51]
    v_mfma_f32_16x16x32_bf16 v[48:51], v[28:31], v[84:87], v[48:51]
    v_mfma_f32_16x16x32_bf16 v[52:55], v[32:35], v[72:75], 0
    v_mfma_f32_16x16x32_bf16 v[52:55], v[36:39], v[76:79], v[52:55]
    v_mfma_f32_16x16x32_bf16 v[52:55], v[40:43], v[80:83], v[52:55]
    v_mfma_f32_16x16x32_bf16 v[52:55], v[44:47], v[84:87], v[52:55]
    v_mfma_f32_16x16x32_bf16 v[56:59], v[88:91], v[72:75], 0
    v_mfma_f32_16x16x32_bf16 v[56:59], v[92:95], v[76:79], v[56:59]
    v_mfma_f32_16x16x32_bf16 v[56:59], v[96:99], v[80:83], v[56:59]
    v_mfma_f32_16x16x32_bf16 v[56:59], v[100:103], v[84:87], v[56:59]
    v_max3_f32 v16, v48, v49, v50
    s_nop 2
    v_max3_f32 v16, v16, v51, v52
    v_max3_f32 v16, v16, v53, v54
    s_nop 1
    v_max3_f32 v16, v16, v55, v56
    v_max_f32 v16, v16, v57
    v_mov_b32 v17, v16
    s_nop 1
    v_permlane16_swap_b32 v16, v17
    v_max_f32 v16, v16, v17
    v_mov_b32 v17, v16
    s_nop 1
    v_permlane32_swap_b32 v16, v17
    v_max_f32 v16, v16, v17
    v_sub_f32 v48, v48, v16
    v_exp_f32 v48, v48
    v_sub_f32 v49, v49, v16
    v_exp_f32 v49, v49
    v_sub_f32 v50, v50, v16
    v_exp_f32 v50, v50
    v_sub_f32 v51, v51, v16
    v_exp_f32 v51, v51
    v_sub_f32 v52, v52, v16
    v_exp_f32 v52, v52
    v_sub_f32 v53, v53, v16
    v_exp_f32 v53, v53
    v_sub_f32 v54, v54, v16
    v_exp_f32 v54, v54
    v_sub_f32 v55, v55, v16
    v_exp_f32 v55, v55
    v_sub_f32 v56, v56, v16
    v_exp_f32 v56, v56
    v_sub_f32 v57, v57, v16
    v_exp_f32 v57, v57
    v_cvt_pk_bf16_f32 v108, v48, v49
    v_cvt_pk_bf16_f32 v109, v50, v51
    v_cvt_pk_bf16_f32 v110, v52, v53
    v_cvt_pk_bf16_f32 v111, v54, v55
    v_cvt_pk_bf16_f32 v112, v56, v57
    s_nop 0
    v_mfma_f32_16x16x32_bf16 v[48:51], v[104:107], v[108:111], 0
    v_mfma_f32_16x16x32_bf16 v[56:59], v[120:123], v[108:111], 0
    v_mfma_f32_16x16x32_bf16 v[60:63], v[124:127], v[108:111], 0
    s_nop 3
    v_mfma_f32_16x16x16_bf16 v[48:51], v[104:105], v[112:113], v[48:51]
    v_mfma_f32_16x16x16_bf16 v[56:59], v[114:115], v[112:113], v[56:59]
    v_mfma_f32_16x16x16_bf16 v[60:63], v[116:117], v[112:113], v[60:63]
    s_nop 5
    v_rcp_f32 v118, v48
    s_nop 0
    v_mul_f32 v56, v56, v118
    v_mul_f32 v57, v57, v118
    v_mul_f32 v58, v58, v118
    v_mul_f32 v59, v59, v118
    v_mul_f32 v60, v60, v118
    v_mul_f32 v61, v61, v118
    v_mul_f32 v62, v62, v118
    v_mul_f32 v63, v63, v118
    v_cvt_pk_bf16_f32 v52, v56, v60
    v_cvt_pk_bf16_f32 v53, v57, v61
    v_cvt_pk_bf16_f32 v54, v58, v62
    v_cvt_pk_bf16_f32 v55, v59, v63
    v_mov_b32 v16, 0
    v_mov_b32 v17, 0
    v_mov_b32 v18, 0
    v_mov_b32 v19, 0
    v_mov_b32 v20, 0
    v_mov_b32 v21, 0
    v_mov_b32 v22, 0
    v_mov_b32 v23, 0
    v_mov_b32 v24, 0
    v_mov_b32 v25, 0
    v_mov_b32 v26, 0
    v_mov_b32 v27, 0
    v_mov_b32 v28, 0
    v_mov_b32 v29, 0
    v_mov_b32 v30, 0
    v_mov_b32 v31, 0
    v_bitop3_b32 v32, v13, s96, -9 bitop3:0x28
    v_bitop3_b32 v36, v13, s97, -9 bitop3:0x28
    v_bitop3_b32 v40, v13, s98, -9 bitop3:0x28
    s_mov_b64 vcc, 0
    s_branch L_slow_rejoin
L_slow_done:
    s_branch L_end
L_worker:
    s_cmp_eq_u32 s3, 7
    s_cbranch_scc1 L_mlp
    s_and_b32 s36, s2, 7
    s_sub_u32 s36, s36, 1
    s_lshl_b32 s36, s36, 5
    s_lshr_b32 s37, s2, 3
    s_add_u32 s36, s36, s37
    s_mul_i32 s20, s36, 10923
    s_lshr_b32 s20, s20, 16
    s_mul_i32 s37, s20, 6
    s_sub_u32 s22, s36, s37
    v_lshrrev_b32 v28, 4, v0
    v_and_b32 v16, 15, v0
    v_lshlrev_b32 v16, 4, v16
    v_lshl_add_u32 v16, v28, 13, v16
    v_bfe_u32 v29, v0, 4, 2
    v_lshlrev_b32 v29, 5, v29
    v_xor_b32 v16, v16, v29
    v_and_b32 v29, 128, v0
    v_xor_b32 v16, v16, v29
    s_lshl_b32 s28, s21, 10
    s_lshl_b32 s3, s20, 8
    s_mov_b32 s76, s52
    s_and_b32 s77, s53, 0xffff
    s_mov_b32 s78, 0x400000
    s_mov_b32 s79, 0x20000
    s_add_u32 m0, s28, 32768
    s_add_u32 s37, s3, 0x0
    buffer_load_dwordx4 v16, s[76:79], s37 offen lds
    s_add_u32 m0, s28, 36864
    s_add_u32 s37, s3, 0x20000
    buffer_load_dwordx4 v16, s[76:79], s37 offen lds
    s_add_u32 m0, s28, 65536
    s_add_u32 s37, s3, 0x40000
    buffer_load_dwordx4 v16, s[76:79], s37 offen lds
    s_add_u32 m0, s28, 69632
    s_add_u32 s37, s3, 0x60000
    buffer_load_dwordx4 v16, s[76:79], s37 offen lds
    s_add_u32 m0, s28, 98304
    s_add_u32 s37, s3, 0x80000
    buffer_load_dwordx4 v16, s[76:79], s37 offen lds
    s_add_u32 m0, s28, 102400
    s_add_u32 s37, s3, 0xa0000
    buffer_load_dwordx4 v16, s[76:79], s37 offen lds
    s_add_u32 m0, s28, 131072
    s_add_u32 s37, s3, 0xc0000
    buffer_load_dwordx4 v16, s[76:79], s37 offen lds
    s_add_u32 m0, s28, 135168
    s_add_u32 s37, s3, 0xe0000
    buffer_load_dwordx4 v16, s[76:79], s37 offen lds
    s_add_u32 m0, s28, 40960
    s_add_u32 s37, s3, 0x100000
    buffer_load_dwordx4 v16, s[76:79], s37 offen lds
    s_add_u32 m0, s28, 45056
    s_add_u32 s37, s3, 0x120000
    buffer_load_dwordx4 v16, s[76:79], s37 offen lds
    s_add_u32 m0, s28, 73728
    s_add_u32 s37, s3, 0x140000
    buffer_load_dwordx4 v16, s[76:79], s37 offen lds
    s_add_u32 m0, s28, 77824
    s_add_u32 s37, s3, 0x160000
    buffer_load_dwordx4 v16, s[76:79], s37 offen lds
    s_add_u32 m0, s28, 106496
    s_add_u32 s37, s3, 0x180000
    buffer_load_dwordx4 v16, s[76:79], s37 offen lds
    s_add_u32 m0, s28, 110592
    s_add_u32 s37, s3, 0x1a0000
    buffer_load_dwordx4 v16, s[76:79], s37 offen lds
    s_add_u32 m0, s28, 139264
    s_add_u32 s37, s3, 0x1c0000
    buffer_load_dwordx4 v16, s[76:79], s37 offen lds
    s_add_u32 m0, s28, 143360
    s_add_u32 s37, s3, 0x1e0000
    buffer_load_dwordx4 v16, s[76:79], s37 offen lds
    s_add_u32 m0, s28, 49152
    s_add_u32 s37, s3, 0x200000
    buffer_load_dwordx4 v16, s[76:79], s37 offen lds
    s_add_u32 m0, s28, 53248
    s_add_u32 s37, s3, 0x220000
    buffer_load_dwordx4 v16, s[76:79], s37 offen lds
    s_add_u32 m0, s28, 81920
    s_add_u32 s37, s3, 0x240000
    buffer_load_dwordx4 v16, s[76:79], s37 offen lds
    s_add_u32 m0, s28, 86016
    s_add_u32 s37, s3, 0x260000
    buffer_load_dwordx4 v16, s[76:79], s37 offen lds
    s_add_u32 m0, s28, 114688
    s_add_u32 s37, s3, 0x280000
    buffer_load_dwordx4 v16, s[76:79], s37 offen lds
    s_add_u32 m0, s28, 118784
    s_add_u32 s37, s3, 0x2a0000
    buffer_load_dwordx4 v16, s[76:79], s37 offen lds
    s_add_u32 m0, s28, 147456
    s_add_u32 s37, s3, 0x2c0000
    buffer_load_dwordx4 v16, s[76:79], s37 offen lds
    s_add_u32 m0, s28, 151552
    s_add_u32 s37, s3, 0x2e0000
    buffer_load_dwordx4 v16, s[76:79], s37 offen lds
    s_add_u32 m0, s28, 57344
    s_add_u32 s37, s3, 0x300000
    buffer_load_dwordx4 v16, s[76:79], s37 offen lds
    s_add_u32 m0, s28, 61440
    s_add_u32 s37, s3, 0x320000
    buffer_load_dwordx4 v16, s[76:79], s37 offen lds
    s_add_u32 m0, s28, 90112
    s_add_u32 s37, s3, 0x340000
    buffer_load_dwordx4 v16, s[76:79], s37 offen lds
    s_add_u32 m0, s28, 94208
    s_add_u32 s37, s3, 0x360000
    buffer_load_dwordx4 v16, s[76:79], s37 offen lds
    s_add_u32 m0, s28, 122880
    s_add_u32 s37, s3, 0x380000
    buffer_load_dwordx4 v16, s[76:79], s37 offen lds
    s_add_u32 m0, s28, 126976
    s_add_u32 s37, s3, 0x3a0000
    buffer_load_dwordx4 v16, s[76:79], s37 offen lds
    s_add_u32 m0, s28, 155648
    s_add_u32 s37, s3, 0x3c0000
    buffer_load_dwordx4 v16, s[76:79], s37 offen lds
    s_add_u32 m0, s28, 159744
    s_add_u32 s37, s3, 0x3e0000
    buffer_load_dwordx4 v16, s[76:79], s37 offen lds
    v_mov_b32 v20, 0x0
    v_bfe_u32 v14, v0, 0, 1
    s_mov_b32 s38, 0x8
    v_mad_u32_u24 v20, v14, s38, v20
    v_bfe_u32 v14, v0, 1, 1
    s_mov_b32 s38, 0x10
    v_mad_u32_u24 v20, v14, s38, v20
    v_bfe_u32 v14, v0, 2, 1
    s_mov_b32 s38, 0x100
    v_mad_u32_u24 v20, v14, s38, v20
    v_bfe_u32 v14, v0, 3, 1
    s_mov_b32 s38, 0x200
    v_mad_u32_u24 v20, v14, s38, v20
    v_bfe_u32 v14, v0, 4, 1
    s_mov_b32 s38, 0x800
    v_mad_u32_u24 v20, v14, s38, v20
    v_bfe_u32 v14, v0, 5, 1
    s_mov_b32 s38, 0x1000
    v_mad_u32_u24 v20, v14, s38, v20
    v_mov_b32 v30, 0x0
    v_bfe_u32 v14, v0, 2, 1
    s_mov_b32 s38, 0x20
    v_mad_u32_u24 v30, v14, s38, v30
    v_bfe_u32 v14, v0, 3, 1
    s_mov_b32 s38, 0x40
    v_mad_u32_u24 v30, v14, s38, v30
    v_bfe_u32 v14, v0, 4, 1
    s_mov_b32 s38, 0x80
    v_mad_u32_u24 v30, v14, s38, v30
    v_mov_b32 v31, 0x0
    v_bfe_u32 v14, v0, 6, 1
    s_mov_b32 s38, 0x40
    v_mad_u32_u24 v31, v14, s38, v31
    v_bfe_u32 v14, v0, 7, 1
    s_mov_b32 s38, 0x80
    v_mad_u32_u24 v31, v14, s38, v31
    v_xor_b32 v30, v30, v31
    v_add_u32 v30, v30, v20
    v_add_u32 v20, 0x8000, v30
    v_xor_b32 v21, 32, v20
    v_add_u32 v22, 0x10000, v30
    v_xor_b32 v23, 32, v22
    v_add_u32 v24, 0x18000, v30
    v_xor_b32 v25, 32, v24
    v_add_u32 v26, 0x20000, v30
    v_xor_b32 v27, 32, v26
    s_mov_b32 s12, s54
    s_and_b32 s13, s55, 0xffff
    s_mov_b32 s14, 0x400000
    s_mov_b32 s15, 0x20000
    s_lshl_b32 s24, s20, 17
    s_and_b32 s25, s22, 3
    s_lshl_b32 s25, s25, 15
    s_add_u32 s24, s24, s25
    v_lshlrev_b32 v30, 7, v0
    buffer_load_dword v31, v30, s[12:15], s24 offen
    s_mov_b32 s12, s44
    s_and_b32 s13, s45, 0xffff
    s_mov_b32 s14, 0x200000
    s_mov_b32 s15, 0x20000
    s_mov_b32 s60, s82
    s_and_b32 s61, s83, 0xffff
    s_mov_b32 s62, 0x200000
    s_mov_b32 s63, 0x20000
    s_mov_b32 s92, s80
    s_and_b32 s93, s81, 0xffff
    s_mov_b32 s94, 0x400
    s_mov_b32 s95, 0x20000
    v_mov_b32 v1, 0x0
    v_bfe_u32 v14, v0, 0, 1
    s_mov_b32 s38, 0x10
    v_mad_u32_u24 v1, v14, s38, v1
    v_bfe_u32 v14, v0, 1, 1
    s_mov_b32 s38, 0x20
    v_mad_u32_u24 v1, v14, s38, v1
    v_bfe_u32 v14, v0, 2, 1
    s_mov_b32 s38, 0x40
    v_mad_u32_u24 v1, v14, s38, v1
    v_bfe_u32 v14, v0, 3, 1
    s_mov_b32 s38, 0x80
    v_mad_u32_u24 v1, v14, s38, v1
    v_bfe_u32 v14, v0, 4, 1
    s_mov_b32 s38, 0x100
    v_mad_u32_u24 v1, v14, s38, v1
    v_bfe_u32 v14, v0, 5, 1
    s_mov_b32 s38, 0x200
    v_mad_u32_u24 v1, v14, s38, v1
    v_mov_b32 v2, 0x0
    v_bfe_u32 v14, v0, 0, 1
    s_mov_b32 s38, 0x10
    v_mad_u32_u24 v2, v14, s38, v2
    v_bfe_u32 v14, v0, 1, 1
    s_mov_b32 s38, 0x20
    v_mad_u32_u24 v2, v14, s38, v2
    v_bfe_u32 v14, v0, 2, 1
    s_mov_b32 s38, 0x40
    v_mad_u32_u24 v2, v14, s38, v2
    v_bfe_u32 v14, v0, 3, 1
    s_mov_b32 s38, 0x80
    v_mad_u32_u24 v2, v14, s38, v2
    v_bfe_u32 v14, v0, 4, 1
    s_mov_b32 s38, 0x100
    v_mad_u32_u24 v2, v14, s38, v2
    v_bfe_u32 v14, v0, 5, 1
    s_mov_b32 s38, 0x200
    v_mad_u32_u24 v2, v14, s38, v2
    v_bfe_u32 v14, v0, 6, 1
    s_mov_b32 s38, 0x800
    v_mad_u32_u24 v2, v14, s38, v2
    v_bfe_u32 v14, v0, 7, 1
    s_mov_b32 s38, 0x1000
    v_mad_u32_u24 v2, v14, s38, v2
    v_mov_b32 v9, 0x0
    v_bfe_u32 v14, v0, 0, 1
    s_mov_b32 s38, 0x10
    v_mad_u32_u24 v9, v14, s38, v9
    v_bfe_u32 v14, v0, 1, 1
    s_mov_b32 s38, 0x20
    v_mad_u32_u24 v9, v14, s38, v9
    v_bfe_u32 v14, v0, 2, 1
    s_mov_b32 s38, 0x40
    v_mad_u32_u24 v9, v14, s38, v9
    v_bfe_u32 v14, v0, 3, 1
    s_mov_b32 s38, 0x80
    v_mad_u32_u24 v9, v14, s38, v9
    v_bfe_u32 v14, v0, 4, 1
    s_mov_b32 s38, 0x100
    v_mad_u32_u24 v9, v14, s38, v9
    v_bfe_u32 v14, v0, 5, 1
    s_mov_b32 s38, 0x200
    v_mad_u32_u24 v9, v14, s38, v9
    v_bfe_u32 v14, v0, 6, 1
    s_mov_b32 s38, 0x400
    v_mad_u32_u24 v9, v14, s38, v9
    v_bfe_u32 v14, v0, 7, 1
    s_mov_b32 s38, 0x800
    v_mad_u32_u24 v9, v14, s38, v9
    v_mov_b32 v7, 0x8000
    v_bfe_u32 v14, v0, 0, 1
    s_mov_b32 s38, 0x10
    v_mad_u32_u24 v7, v14, s38, v7
    v_bfe_u32 v14, v0, 1, 1
    s_mov_b32 s38, 0x20
    v_mad_u32_u24 v7, v14, s38, v7
    v_bfe_u32 v14, v0, 2, 1
    s_mov_b32 s38, 0x40
    v_mad_u32_u24 v7, v14, s38, v7
    v_bfe_u32 v14, v0, 3, 1
    s_mov_b32 s38, 0x80
    v_mad_u32_u24 v7, v14, s38, v7
    v_bfe_u32 v14, v0, 4, 1
    s_mov_b32 s38, 0x100
    v_mad_u32_u24 v7, v14, s38, v7
    v_bfe_u32 v14, v0, 5, 1
    s_mov_b32 s38, 0x200
    v_mad_u32_u24 v7, v14, s38, v7
    v_bfe_u32 v14, v0, 6, 1
    s_mov_b32 s38, 0x8000
    v_mad_u32_u24 v7, v14, s38, v7
    v_bfe_u32 v14, v0, 7, 1
    s_mov_b32 s38, 0x10000
    v_mad_u32_u24 v7, v14, s38, v7
    v_mov_b32 v3, 0x0
    v_bfe_u32 v14, v0, 0, 1
    s_mov_b32 s38, 0x10
    v_mad_u32_u24 v3, v14, s38, v3
    v_bfe_u32 v14, v0, 1, 1
    s_mov_b32 s38, 0x20
    v_mad_u32_u24 v3, v14, s38, v3
    v_bfe_u32 v14, v0, 2, 1
    s_mov_b32 s38, 0x40
    v_mad_u32_u24 v3, v14, s38, v3
    v_bfe_u32 v14, v0, 3, 1
    s_mov_b32 s38, 0x400
    v_mad_u32_u24 v3, v14, s38, v3
    v_bfe_u32 v14, v0, 4, 1
    s_mov_b32 s38, 0x800
    v_mad_u32_u24 v3, v14, s38, v3
    v_bfe_u32 v14, v0, 5, 1
    s_mov_b32 s38, 0x1000
    v_mad_u32_u24 v3, v14, s38, v3
    v_bfe_u32 v14, v0, 6, 1
    s_mov_b32 s38, 0x2000
    v_mad_u32_u24 v3, v14, s38, v3
    v_bfe_u32 v14, v0, 7, 1
    s_mov_b32 s38, 0x4000
    v_mad_u32_u24 v3, v14, s38, v3
    v_mov_b32 v4, 0x0
    v_bfe_u32 v14, v0, 0, 1
    s_mov_b32 s38, 0x100
    v_mad_u32_u24 v4, v14, s38, v4
    v_bfe_u32 v14, v0, 1, 1
    s_mov_b32 s38, 0x200
    v_mad_u32_u24 v4, v14, s38, v4
    v_bfe_u32 v14, v0, 2, 1
    s_mov_b32 s38, 0x400
    v_mad_u32_u24 v4, v14, s38, v4
    v_bfe_u32 v14, v0, 6, 1
    s_mov_b32 s38, 0x80
    v_mad_u32_u24 v4, v14, s38, v4
    v_bfe_u32 v14, v0, 7, 1
    s_mov_b32 s38, 0x4000
    v_mad_u32_u24 v4, v14, s38, v4
    v_lshrrev_b32 v15, 3, v0
    v_xor_b32 v15, v15, v0
    v_and_b32 v15, 7, v15
    v_lshl_add_u32 v4, v15, 4, v4
    v_bfe_u32 v15, v0, 4, 2
    v_lshlrev_b32 v15, 4, v15
    v_xor_b32 v5, v15, v1
    v_xor_b32 v6, 64, v5
    v_mov_b32 v8, 0x5000
    v_bfe_u32 v14, v0, 0, 1
    s_mov_b32 s38, 0x10
    v_mad_u32_u24 v8, v14, s38, v8
    v_bfe_u32 v14, v0, 1, 1
    s_mov_b32 s38, 0x40
    v_mad_u32_u24 v8, v14, s38, v8
    v_bfe_u32 v14, v0, 2, 1
    s_mov_b32 s38, 0x80
    v_mad_u32_u24 v8, v14, s38, v8
    v_bfe_u32 v14, v0, 4, 1
    s_mov_b32 s38, 0x20
    v_mad_u32_u24 v8, v14, s38, v8
    v_bfe_u32 v14, v0, 5, 1
    s_mov_b32 s38, 0x100
    v_mad_u32_u24 v8, v14, s38, v8
    v_mov_b32 v10, 0x0
    v_bfe_u32 v14, v0, 0, 1
    s_mov_b32 s38, 0x10
    v_mad_u32_u24 v10, v14, s38, v10
    v_bfe_u32 v14, v0, 1, 1
    s_mov_b32 s38, 0x20
    v_mad_u32_u24 v10, v14, s38, v10
    v_bfe_u32 v14, v0, 2, 1
    s_mov_b32 s38, 0x40
    v_mad_u32_u24 v10, v14, s38, v10
    v_bfe_u32 v14, v0, 3, 1
    s_mov_b32 s38, 0x80
    v_mad_u32_u24 v10, v14, s38, v10
    v_bfe_u32 v14, v0, 4, 1
    s_mov_b32 s38, 0x20000
    v_mad_u32_u24 v10, v14, s38, v10
    v_bfe_u32 v14, v0, 5, 1
    s_mov_b32 s38, 0x40000
    v_mad_u32_u24 v10, v14, s38, v10
    v_bfe_u32 v14, v0, 6, 1
    s_mov_b32 s38, 0x100
    v_mad_u32_u24 v10, v14, s38, v10
    v_bfe_u32 v14, v0, 7, 1
    s_mov_b32 s38, 0x200
    v_mad_u32_u24 v10, v14, s38, v10
    v_mov_b32 v11, 0x0
    v_bfe_u32 v14, v0, 0, 1
    s_mov_b32 s38, 0x10
    v_mad_u32_u24 v11, v14, s38, v11
    v_bfe_u32 v14, v0, 1, 1
    s_mov_b32 s38, 0x20
    v_mad_u32_u24 v11, v14, s38, v11
    v_bfe_u32 v14, v0, 2, 1
    s_mov_b32 s38, 0x40
    v_mad_u32_u24 v11, v14, s38, v11
    v_bfe_u32 v14, v0, 3, 1
    s_mov_b32 s38, 0x80
    v_mad_u32_u24 v11, v14, s38, v11
    v_bfe_u32 v14, v0, 4, 1
    s_mov_b32 s38, 0x400
    v_mad_u32_u24 v11, v14, s38, v11
    v_bfe_u32 v14, v0, 5, 1
    s_mov_b32 s38, 0x800
    v_mad_u32_u24 v11, v14, s38, v11
    v_bfe_u32 v14, v0, 6, 1
    s_mov_b32 s38, 0x100
    v_mad_u32_u24 v11, v14, s38, v11
    v_bfe_u32 v14, v0, 7, 1
    s_mov_b32 s38, 0x200
    v_mad_u32_u24 v11, v14, s38, v11
    v_mov_b32 v12, 0x0
    v_bfe_u32 v14, v0, 0, 1
    s_mov_b32 s38, 0x10
    v_mad_u32_u24 v12, v14, s38, v12
    v_bfe_u32 v14, v0, 1, 1
    s_mov_b32 s38, 0x20
    v_mad_u32_u24 v12, v14, s38, v12
    v_bfe_u32 v14, v0, 2, 1
    s_mov_b32 s38, 0x40
    v_mad_u32_u24 v12, v14, s38, v12
    v_bfe_u32 v14, v0, 3, 1
    s_mov_b32 s38, 0x80
    v_mad_u32_u24 v12, v14, s38, v12
    v_bfe_u32 v14, v0, 4, 1
    s_mov_b32 s38, 0x4
    v_mad_u32_u24 v12, v14, s38, v12
    v_bfe_u32 v14, v0, 5, 1
    s_mov_b32 s38, 0x8
    v_mad_u32_u24 v12, v14, s38, v12
    v_bfe_u32 v14, v0, 6, 1
    s_mov_b32 s38, 0x100
    v_mad_u32_u24 v12, v14, s38, v12
    v_bfe_u32 v14, v0, 7, 1
    s_mov_b32 s38, 0x200
    v_mad_u32_u24 v12, v14, s38, v12
    v_mov_b32 v13, 0xf149f2ca
    v_and_b32 v14, 15, v0
    v_bfe_u32 v15, v0, 4, 2
    v_cmp_gt_u32 s[72:73], 2, v15
    v_lshlrev_b32 v15, 2, v15
    v_cmp_le_u32 s[64:65], v15, v14
    v_add_u32 v15, 1, v15
    v_cmp_le_u32 s[66:67], v15, v14
    v_add_u32 v15, 1, v15
    v_cmp_le_u32 s[68:69], v15, v14
    v_add_u32 v15, 1, v15
    v_cmp_le_u32 s[70:71], v15, v14
    v_add_u32 v15, 1, v15
    s_mov_b32 s34, 0x05040100
    s_mov_b32 s35, 0x07060302
    s_mov_b32 s33, 0x3e0293ee
    s_mov_b32 s32, 0
    s_mov_b32 s4, 0x3f803f80
    s_mov_b32 s5, 0x3f803f80
    s_mov_b32 s23, s22
    s_lshl_b32 s36, s23, 15
    buffer_load_dwordx4 v[96:99], v3, s[12:15], s36 offen offset:0
    buffer_load_dwordx4 v[100:103], v3, s[12:15], s36 offen offset:128
    buffer_load_dwordx4 v[104:107], v3, s[12:15], s36 offen offset:256
    buffer_load_dwordx4 v[108:111], v3, s[12:15], s36 offen offset:384
    buffer_load_dwordx4 v[112:115], v3, s[12:15], s36 offen offset:512
    buffer_load_dwordx4 v[116:119], v3, s[12:15], s36 offen offset:640
    buffer_load_dwordx4 v[120:123], v3, s[12:15], s36 offen offset:768
    buffer_load_dwordx4 v[124:127], v3, s[12:15], s36 offen offset:896
    s_waitcnt vmcnt(33)
    s_barrier
    ds_read_b64_tr_b16 v[128:129], v20 offset:0
    ds_read_b64_tr_b16 v[130:131], v20 offset:1024
    ds_read_b64_tr_b16 v[132:133], v21 offset:0
    ds_read_b64_tr_b16 v[134:135], v21 offset:1024
    ds_read_b64_tr_b16 v[136:137], v22 offset:0
    ds_read_b64_tr_b16 v[138:139], v22 offset:1024
    ds_read_b64_tr_b16 v[140:141], v23 offset:0
    ds_read_b64_tr_b16 v[142:143], v23 offset:1024
    ds_read_b64_tr_b16 v[144:145], v24 offset:0
    ds_read_b64_tr_b16 v[146:147], v24 offset:1024
    ds_read_b64_tr_b16 v[148:149], v25 offset:0
    ds_read_b64_tr_b16 v[150:151], v25 offset:1024
    s_waitcnt lgkmcnt(4)
    ds_read_b64_tr_b16 v[152:153], v26 offset:0
    ds_read_b64_tr_b16 v[154:155], v26 offset:1024
    ds_read_b64_tr_b16 v[156:157], v27 offset:0
    ds_read_b64_tr_b16 v[158:159], v27 offset:1024
    s_waitcnt lgkmcnt(0)
    s_barrier
    s_mov_b32 s40, s50
    s_and_b32 s41, s51, 0xffff
    s_mov_b32 s42, 0x400000
    s_mov_b32 s43, 0x20000
    s_add_u32 m0, s28, 32768
    s_add_u32 s37, s3, 0x0
    buffer_load_dwordx4 v16, s[40:43], s37 offen lds
    s_add_u32 m0, s28, 36864
    s_add_u32 s37, s3, 0x20000
    buffer_load_dwordx4 v16, s[40:43], s37 offen lds
    s_add_u32 m0, s28, 65536
    s_add_u32 s37, s3, 0x40000
    buffer_load_dwordx4 v16, s[40:43], s37 offen lds
    s_add_u32 m0, s28, 69632
    s_add_u32 s37, s3, 0x60000
    buffer_load_dwordx4 v16, s[40:43], s37 offen lds
    s_add_u32 m0, s28, 98304
    s_add_u32 s37, s3, 0x80000
    buffer_load_dwordx4 v16, s[40:43], s37 offen lds
    s_add_u32 m0, s28, 102400
    s_add_u32 s37, s3, 0xa0000
    buffer_load_dwordx4 v16, s[40:43], s37 offen lds
    s_add_u32 m0, s28, 131072
    s_add_u32 s37, s3, 0xc0000
    buffer_load_dwordx4 v16, s[40:43], s37 offen lds
    s_add_u32 m0, s28, 135168
    s_add_u32 s37, s3, 0xe0000
    buffer_load_dwordx4 v16, s[40:43], s37 offen lds
    s_waitcnt vmcnt(33)
    s_barrier
    ds_read_b64_tr_b16 v[160:161], v20 offset:8192
    ds_read_b64_tr_b16 v[162:163], v20 offset:9216
    ds_read_b64_tr_b16 v[164:165], v21 offset:8192
    ds_read_b64_tr_b16 v[166:167], v21 offset:9216
    ds_read_b64_tr_b16 v[168:169], v22 offset:8192
    ds_read_b64_tr_b16 v[170:171], v22 offset:9216
    ds_read_b64_tr_b16 v[172:173], v23 offset:8192
    ds_read_b64_tr_b16 v[174:175], v23 offset:9216
    ds_read_b64_tr_b16 v[176:177], v24 offset:8192
    ds_read_b64_tr_b16 v[178:179], v24 offset:9216
    ds_read_b64_tr_b16 v[180:181], v25 offset:8192
    ds_read_b64_tr_b16 v[182:183], v25 offset:9216
    s_waitcnt lgkmcnt(4)
    ds_read_b64_tr_b16 v[184:185], v26 offset:8192
    ds_read_b64_tr_b16 v[186:187], v26 offset:9216
    ds_read_b64_tr_b16 v[188:189], v27 offset:8192
    ds_read_b64_tr_b16 v[190:191], v27 offset:9216
    s_waitcnt lgkmcnt(0)
    s_barrier
    s_add_u32 m0, s28, 40960
    s_add_u32 s37, s3, 0x100000
    buffer_load_dwordx4 v16, s[40:43], s37 offen lds
    s_add_u32 m0, s28, 45056
    s_add_u32 s37, s3, 0x120000
    buffer_load_dwordx4 v16, s[40:43], s37 offen lds
    s_add_u32 m0, s28, 73728
    s_add_u32 s37, s3, 0x140000
    buffer_load_dwordx4 v16, s[40:43], s37 offen lds
    s_add_u32 m0, s28, 77824
    s_add_u32 s37, s3, 0x160000
    buffer_load_dwordx4 v16, s[40:43], s37 offen lds
    s_add_u32 m0, s28, 106496
    s_add_u32 s37, s3, 0x180000
    buffer_load_dwordx4 v16, s[40:43], s37 offen lds
    s_add_u32 m0, s28, 110592
    s_add_u32 s37, s3, 0x1a0000
    buffer_load_dwordx4 v16, s[40:43], s37 offen lds
    s_add_u32 m0, s28, 139264
    s_add_u32 s37, s3, 0x1c0000
    buffer_load_dwordx4 v16, s[40:43], s37 offen lds
    s_add_u32 m0, s28, 143360
    s_add_u32 s37, s3, 0x1e0000
    buffer_load_dwordx4 v16, s[40:43], s37 offen lds
    s_waitcnt vmcnt(33)
    s_barrier
    ds_read_b64_tr_b16 v[192:193], v20 offset:16384
    ds_read_b64_tr_b16 v[194:195], v20 offset:17408
    ds_read_b64_tr_b16 v[196:197], v21 offset:16384
    ds_read_b64_tr_b16 v[198:199], v21 offset:17408
    ds_read_b64_tr_b16 v[200:201], v22 offset:16384
    ds_read_b64_tr_b16 v[202:203], v22 offset:17408
    ds_read_b64_tr_b16 v[204:205], v23 offset:16384
    ds_read_b64_tr_b16 v[206:207], v23 offset:17408
    ds_read_b64_tr_b16 v[208:209], v24 offset:16384
    ds_read_b64_tr_b16 v[210:211], v24 offset:17408
    ds_read_b64_tr_b16 v[212:213], v25 offset:16384
    ds_read_b64_tr_b16 v[214:215], v25 offset:17408
    s_waitcnt lgkmcnt(4)
    ds_read_b64_tr_b16 v[216:217], v26 offset:16384
    ds_read_b64_tr_b16 v[218:219], v26 offset:17408
    ds_read_b64_tr_b16 v[220:221], v27 offset:16384
    ds_read_b64_tr_b16 v[222:223], v27 offset:17408
    s_waitcnt lgkmcnt(0)
    s_barrier
    s_add_u32 m0, s28, 49152
    s_add_u32 s37, s3, 0x200000
    buffer_load_dwordx4 v16, s[40:43], s37 offen lds
    s_add_u32 m0, s28, 53248
    s_add_u32 s37, s3, 0x220000
    buffer_load_dwordx4 v16, s[40:43], s37 offen lds
    s_add_u32 m0, s28, 81920
    s_add_u32 s37, s3, 0x240000
    buffer_load_dwordx4 v16, s[40:43], s37 offen lds
    s_add_u32 m0, s28, 86016
    s_add_u32 s37, s3, 0x260000
    buffer_load_dwordx4 v16, s[40:43], s37 offen lds
    s_add_u32 m0, s28, 114688
    s_add_u32 s37, s3, 0x280000
    buffer_load_dwordx4 v16, s[40:43], s37 offen lds
    s_add_u32 m0, s28, 118784
    s_add_u32 s37, s3, 0x2a0000
    buffer_load_dwordx4 v16, s[40:43], s37 offen lds
    s_add_u32 m0, s28, 147456
    s_add_u32 s37, s3, 0x2c0000
    buffer_load_dwordx4 v16, s[40:43], s37 offen lds
    s_add_u32 m0, s28, 151552
    s_add_u32 s37, s3, 0x2e0000
    buffer_load_dwordx4 v16, s[40:43], s37 offen lds
    s_waitcnt vmcnt(33)
    s_barrier
    ds_read_b64_tr_b16 v[224:225], v20 offset:24576
    ds_read_b64_tr_b16 v[226:227], v20 offset:25600
    ds_read_b64_tr_b16 v[228:229], v21 offset:24576
    ds_read_b64_tr_b16 v[230:231], v21 offset:25600
    ds_read_b64_tr_b16 v[232:233], v22 offset:24576
    ds_read_b64_tr_b16 v[234:235], v22 offset:25600
    ds_read_b64_tr_b16 v[236:237], v23 offset:24576
    ds_read_b64_tr_b16 v[238:239], v23 offset:25600
    ds_read_b64_tr_b16 v[240:241], v24 offset:24576
    ds_read_b64_tr_b16 v[242:243], v24 offset:25600
    ds_read_b64_tr_b16 v[244:245], v25 offset:24576
    ds_read_b64_tr_b16 v[246:247], v25 offset:25600
    s_waitcnt lgkmcnt(4)
    ds_read_b64_tr_b16 v[248:249], v26 offset:24576
    ds_read_b64_tr_b16 v[250:251], v26 offset:25600
    ds_read_b64_tr_b16 v[252:253], v27 offset:24576
    ds_read_b64_tr_b16 v[254:255], v27 offset:25600
    s_waitcnt lgkmcnt(0)
    s_barrier
    s_add_u32 m0, s28, 57344
    s_add_u32 s37, s3, 0x300000
    buffer_load_dwordx4 v16, s[40:43], s37 offen lds
    s_add_u32 m0, s28, 61440
    s_add_u32 s37, s3, 0x320000
    buffer_load_dwordx4 v16, s[40:43], s37 offen lds
    s_add_u32 m0, s28, 90112
    s_add_u32 s37, s3, 0x340000
    buffer_load_dwordx4 v16, s[40:43], s37 offen lds
    s_add_u32 m0, s28, 94208
    s_add_u32 s37, s3, 0x360000
    buffer_load_dwordx4 v16, s[40:43], s37 offen lds
    s_add_u32 m0, s28, 122880
    s_add_u32 s37, s3, 0x380000
    buffer_load_dwordx4 v16, s[40:43], s37 offen lds
    s_add_u32 m0, s28, 126976
    s_add_u32 s37, s3, 0x3a0000
    buffer_load_dwordx4 v16, s[40:43], s37 offen lds
    s_add_u32 m0, s28, 155648
    s_add_u32 s37, s3, 0x3c0000
    buffer_load_dwordx4 v16, s[40:43], s37 offen lds
    s_add_u32 m0, s28, 159744
    s_add_u32 s37, s3, 0x3e0000
    buffer_load_dwordx4 v16, s[40:43], s37 offen lds
    s_waitcnt vmcnt(32)
    v_mov_b32 v88, 0
    v_mov_b32 v89, 0
    v_dot2_f32_bf16 v88, v96, s4, v88
    v_dot2_f32_bf16 v89, v96, v96, v89
    v_dot2_f32_bf16 v88, v97, s4, v88
    v_dot2_f32_bf16 v89, v97, v97, v89
    v_dot2_f32_bf16 v88, v98, s4, v88
    v_dot2_f32_bf16 v89, v98, v98, v89
    v_dot2_f32_bf16 v88, v99, s4, v88
    v_dot2_f32_bf16 v89, v99, v99, v89
    v_dot2_f32_bf16 v88, v100, s4, v88
    v_dot2_f32_bf16 v89, v100, v100, v89
    v_dot2_f32_bf16 v88, v101, s4, v88
    v_dot2_f32_bf16 v89, v101, v101, v89
    v_dot2_f32_bf16 v88, v102, s4, v88
    v_dot2_f32_bf16 v89, v102, v102, v89
    v_dot2_f32_bf16 v88, v103, s4, v88
    v_dot2_f32_bf16 v89, v103, v103, v89
    v_dot2_f32_bf16 v88, v104, s4, v88
    v_dot2_f32_bf16 v89, v104, v104, v89
    v_dot2_f32_bf16 v88, v105, s4, v88
    v_dot2_f32_bf16 v89, v105, v105, v89
    v_dot2_f32_bf16 v88, v106, s4, v88
    v_dot2_f32_bf16 v89, v106, v106, v89
    v_dot2_f32_bf16 v88, v107, s4, v88
    v_dot2_f32_bf16 v89, v107, v107, v89
    v_dot2_f32_bf16 v88, v108, s4, v88
    v_dot2_f32_bf16 v89, v108, v108, v89
    v_dot2_f32_bf16 v88, v109, s4, v88
    v_dot2_f32_bf16 v89, v109, v109, v89
    v_dot2_f32_bf16 v88, v110, s4, v88
    v_dot2_f32_bf16 v89, v110, v110, v89
    v_dot2_f32_bf16 v88, v111, s4, v88
    v_dot2_f32_bf16 v89, v111, v111, v89
    v_dot2_f32_bf16 v88, v112, s4, v88
    v_dot2_f32_bf16 v89, v112, v112, v89
    v_dot2_f32_bf16 v88, v113, s4, v88
    v_dot2_f32_bf16 v89, v113, v113, v89
    v_dot2_f32_bf16 v88, v114, s4, v88
    v_dot2_f32_bf16 v89, v114, v114, v89
    v_dot2_f32_bf16 v88, v115, s4, v88
    v_dot2_f32_bf16 v89, v115, v115, v89
    v_dot2_f32_bf16 v88, v116, s4, v88
    v_dot2_f32_bf16 v89, v116, v116, v89
    v_dot2_f32_bf16 v88, v117, s4, v88
    v_dot2_f32_bf16 v89, v117, v117, v89
    v_dot2_f32_bf16 v88, v118, s4, v88
    v_dot2_f32_bf16 v89, v118, v118, v89
    v_dot2_f32_bf16 v88, v119, s4, v88
    v_dot2_f32_bf16 v89, v119, v119, v89
    v_dot2_f32_bf16 v88, v120, s4, v88
    v_dot2_f32_bf16 v89, v120, v120, v89
    v_dot2_f32_bf16 v88, v121, s4, v88
    v_dot2_f32_bf16 v89, v121, v121, v89
    v_dot2_f32_bf16 v88, v122, s4, v88
    v_dot2_f32_bf16 v89, v122, v122, v89
    v_dot2_f32_bf16 v88, v123, s4, v88
    v_dot2_f32_bf16 v89, v123, v123, v89
    v_dot2_f32_bf16 v88, v124, s4, v88
    v_dot2_f32_bf16 v89, v124, v124, v89
    v_dot2_f32_bf16 v88, v125, s4, v88
    v_dot2_f32_bf16 v89, v125, v125, v89
    v_dot2_f32_bf16 v88, v126, s4, v88
    v_dot2_f32_bf16 v89, v126, v126, v89
    v_dot2_f32_bf16 v88, v127, s4, v88
    v_dot2_f32_bf16 v89, v127, v127, v89
    s_nop 3
    v_add_f32_dpp v88, v88, v88 quad_perm:[1,0,3,2] row_mask:0xf bank_mask:0xf
    v_add_f32_dpp v89, v89, v89 quad_perm:[1,0,3,2] row_mask:0xf bank_mask:0xf
    s_nop 0
    v_add_f32_dpp v88, v88, v88 quad_perm:[2,3,0,1] row_mask:0xf bank_mask:0xf
    v_add_f32_dpp v89, v89, v89 quad_perm:[2,3,0,1] row_mask:0xf bank_mask:0xf
    s_nop 0
    v_add_f32_dpp v88, v88, v88 row_half_mirror row_mask:0xf bank_mask:0xf
    v_add_f32_dpp v89, v89, v89 row_half_mirror row_mask:0xf bank_mask:0xf
    v_mul_f32 v88, 0x3b000000, v88
    v_mul_f32 v89, 0x3b000000, v89
    v_fma_f32 v89, -v88, v88, v89
    v_max_f32 v89, 0, v89
    v_cvt_pk_bf16_f32 v14, v88, v89
    v_lshlrev_b32 v88, 16, v14
    v_and_b32 v89, 0xffff0000, v14
    v_add_f32 v89, 0x3727c5ac, v89
    v_cvt_pk_bf16_f32 v14, v89, v89
    v_lshlrev_b32 v89, 16, v14
    v_sqrt_f32 v89, v89
    s_nop 0
    v_cvt_pk_bf16_f32 v14, v89, v89
    v_lshlrev_b32 v89, 16, v14
    v_rcp_f32 v89, v89
    v_lshlrev_b32 v90, 16, v96
    v_and_b32 v91, 0xffff0000, v96
    v_sub_f32 v90, v90, v88
    v_sub_f32 v91, v91, v88
    v_cvt_pk_bf16_f32 v96, v90, v91
    v_lshlrev_b32 v90, 16, v96
    v_and_b32 v91, 0xffff0000, v96
    v_mul_f32 v90, v90, v89
    v_mul_f32 v91, v91, v89
    v_cvt_pk_bf16_f32 v96, v90, v91
    v_lshlrev_b32 v90, 16, v97
    v_and_b32 v91, 0xffff0000, v97
    v_sub_f32 v90, v90, v88
    v_sub_f32 v91, v91, v88
    v_cvt_pk_bf16_f32 v97, v90, v91
    v_lshlrev_b32 v90, 16, v97
    v_and_b32 v91, 0xffff0000, v97
    v_mul_f32 v90, v90, v89
    v_mul_f32 v91, v91, v89
    v_cvt_pk_bf16_f32 v97, v90, v91
    v_lshlrev_b32 v90, 16, v98
    v_and_b32 v91, 0xffff0000, v98
    v_sub_f32 v90, v90, v88
    v_sub_f32 v91, v91, v88
    v_cvt_pk_bf16_f32 v98, v90, v91
    v_lshlrev_b32 v90, 16, v98
    v_and_b32 v91, 0xffff0000, v98
    v_mul_f32 v90, v90, v89
    v_mul_f32 v91, v91, v89
    v_cvt_pk_bf16_f32 v98, v90, v91
    v_lshlrev_b32 v90, 16, v99
    v_and_b32 v91, 0xffff0000, v99
    v_sub_f32 v90, v90, v88
    v_sub_f32 v91, v91, v88
    v_cvt_pk_bf16_f32 v99, v90, v91
    v_lshlrev_b32 v90, 16, v99
    v_and_b32 v91, 0xffff0000, v99
    v_mul_f32 v90, v90, v89
    v_mul_f32 v91, v91, v89
    v_cvt_pk_bf16_f32 v99, v90, v91
    ds_write_b128 v4, v[96:99] offset:0
    v_lshlrev_b32 v90, 16, v100
    v_and_b32 v91, 0xffff0000, v100
    v_sub_f32 v90, v90, v88
    v_sub_f32 v91, v91, v88
    v_cvt_pk_bf16_f32 v100, v90, v91
    v_lshlrev_b32 v90, 16, v100
    v_and_b32 v91, 0xffff0000, v100
    v_mul_f32 v90, v90, v89
    v_mul_f32 v91, v91, v89
    v_cvt_pk_bf16_f32 v100, v90, v91
    v_lshlrev_b32 v90, 16, v101
    v_and_b32 v91, 0xffff0000, v101
    v_sub_f32 v90, v90, v88
    v_sub_f32 v91, v91, v88
    v_cvt_pk_bf16_f32 v101, v90, v91
    v_lshlrev_b32 v90, 16, v101
    v_and_b32 v91, 0xffff0000, v101
    v_mul_f32 v90, v90, v89
    v_mul_f32 v91, v91, v89
    v_cvt_pk_bf16_f32 v101, v90, v91
    v_lshlrev_b32 v90, 16, v102
    v_and_b32 v91, 0xffff0000, v102
    v_sub_f32 v90, v90, v88
    v_sub_f32 v91, v91, v88
    v_cvt_pk_bf16_f32 v102, v90, v91
    v_lshlrev_b32 v90, 16, v102
    v_and_b32 v91, 0xffff0000, v102
    v_mul_f32 v90, v90, v89
    v_mul_f32 v91, v91, v89
    v_cvt_pk_bf16_f32 v102, v90, v91
    v_lshlrev_b32 v90, 16, v103
    v_and_b32 v91, 0xffff0000, v103
    v_sub_f32 v90, v90, v88
    v_sub_f32 v91, v91, v88
    v_cvt_pk_bf16_f32 v103, v90, v91
    v_lshlrev_b32 v90, 16, v103
    v_and_b32 v91, 0xffff0000, v103
    v_mul_f32 v90, v90, v89
    v_mul_f32 v91, v91, v89
    v_cvt_pk_bf16_f32 v103, v90, v91
    ds_write_b128 v4, v[100:103] offset:2048
    v_lshlrev_b32 v90, 16, v104
    v_and_b32 v91, 0xffff0000, v104
    v_sub_f32 v90, v90, v88
    v_sub_f32 v91, v91, v88
    v_cvt_pk_bf16_f32 v104, v90, v91
    v_lshlrev_b32 v90, 16, v104
    v_and_b32 v91, 0xffff0000, v104
    v_mul_f32 v90, v90, v89
    v_mul_f32 v91, v91, v89
    v_cvt_pk_bf16_f32 v104, v90, v91
    v_lshlrev_b32 v90, 16, v105
    v_and_b32 v91, 0xffff0000, v105
    v_sub_f32 v90, v90, v88
    v_sub_f32 v91, v91, v88
    v_cvt_pk_bf16_f32 v105, v90, v91
    v_lshlrev_b32 v90, 16, v105
    v_and_b32 v91, 0xffff0000, v105
    v_mul_f32 v90, v90, v89
    v_mul_f32 v91, v91, v89
    v_cvt_pk_bf16_f32 v105, v90, v91
    v_lshlrev_b32 v90, 16, v106
    v_and_b32 v91, 0xffff0000, v106
    v_sub_f32 v90, v90, v88
    v_sub_f32 v91, v91, v88
    v_cvt_pk_bf16_f32 v106, v90, v91
    v_lshlrev_b32 v90, 16, v106
    v_and_b32 v91, 0xffff0000, v106
    v_mul_f32 v90, v90, v89
    v_mul_f32 v91, v91, v89
    v_cvt_pk_bf16_f32 v106, v90, v91
    v_lshlrev_b32 v90, 16, v107
    v_and_b32 v91, 0xffff0000, v107
    v_sub_f32 v90, v90, v88
    v_sub_f32 v91, v91, v88
    v_cvt_pk_bf16_f32 v107, v90, v91
    v_lshlrev_b32 v90, 16, v107
    v_and_b32 v91, 0xffff0000, v107
    v_mul_f32 v90, v90, v89
    v_mul_f32 v91, v91, v89
    v_cvt_pk_bf16_f32 v107, v90, v91
    ds_write_b128 v4, v[104:107] offset:4096
    v_lshlrev_b32 v90, 16, v108
    v_and_b32 v91, 0xffff0000, v108
    v_sub_f32 v90, v90, v88
    v_sub_f32 v91, v91, v88
    v_cvt_pk_bf16_f32 v108, v90, v91
    v_lshlrev_b32 v90, 16, v108
    v_and_b32 v91, 0xffff0000, v108
    v_mul_f32 v90, v90, v89
    v_mul_f32 v91, v91, v89
    v_cvt_pk_bf16_f32 v108, v90, v91
    v_lshlrev_b32 v90, 16, v109
    v_and_b32 v91, 0xffff0000, v109
    v_sub_f32 v90, v90, v88
    v_sub_f32 v91, v91, v88
    v_cvt_pk_bf16_f32 v109, v90, v91
    v_lshlrev_b32 v90, 16, v109
    v_and_b32 v91, 0xffff0000, v109
    v_mul_f32 v90, v90, v89
    v_mul_f32 v91, v91, v89
    v_cvt_pk_bf16_f32 v109, v90, v91
    v_lshlrev_b32 v90, 16, v110
    v_and_b32 v91, 0xffff0000, v110
    v_sub_f32 v90, v90, v88
    v_sub_f32 v91, v91, v88
    v_cvt_pk_bf16_f32 v110, v90, v91
    v_lshlrev_b32 v90, 16, v110
    v_and_b32 v91, 0xffff0000, v110
    v_mul_f32 v90, v90, v89
    v_mul_f32 v91, v91, v89
    v_cvt_pk_bf16_f32 v110, v90, v91
    v_lshlrev_b32 v90, 16, v111
    v_and_b32 v91, 0xffff0000, v111
    v_sub_f32 v90, v90, v88
    v_sub_f32 v91, v91, v88
    v_cvt_pk_bf16_f32 v111, v90, v91
    v_lshlrev_b32 v90, 16, v111
    v_and_b32 v91, 0xffff0000, v111
    v_mul_f32 v90, v90, v89
    v_mul_f32 v91, v91, v89
    v_cvt_pk_bf16_f32 v111, v90, v91
    ds_write_b128 v4, v[108:111] offset:6144
    v_lshlrev_b32 v90, 16, v112
    v_and_b32 v91, 0xffff0000, v112
    v_sub_f32 v90, v90, v88
    v_sub_f32 v91, v91, v88
    v_cvt_pk_bf16_f32 v112, v90, v91
    v_lshlrev_b32 v90, 16, v112
    v_and_b32 v91, 0xffff0000, v112
    v_mul_f32 v90, v90, v89
    v_mul_f32 v91, v91, v89
    v_cvt_pk_bf16_f32 v112, v90, v91
    v_lshlrev_b32 v90, 16, v113
    v_and_b32 v91, 0xffff0000, v113
    v_sub_f32 v90, v90, v88
    v_sub_f32 v91, v91, v88
    v_cvt_pk_bf16_f32 v113, v90, v91
    v_lshlrev_b32 v90, 16, v113
    v_and_b32 v91, 0xffff0000, v113
    v_mul_f32 v90, v90, v89
    v_mul_f32 v91, v91, v89
    v_cvt_pk_bf16_f32 v113, v90, v91
    v_lshlrev_b32 v90, 16, v114
    v_and_b32 v91, 0xffff0000, v114
    v_sub_f32 v90, v90, v88
    v_sub_f32 v91, v91, v88
    v_cvt_pk_bf16_f32 v114, v90, v91
    v_lshlrev_b32 v90, 16, v114
    v_and_b32 v91, 0xffff0000, v114
    v_mul_f32 v90, v90, v89
    v_mul_f32 v91, v91, v89
    v_cvt_pk_bf16_f32 v114, v90, v91
    v_lshlrev_b32 v90, 16, v115
    v_and_b32 v91, 0xffff0000, v115
    v_sub_f32 v90, v90, v88
    v_sub_f32 v91, v91, v88
    v_cvt_pk_bf16_f32 v115, v90, v91
    v_lshlrev_b32 v90, 16, v115
    v_and_b32 v91, 0xffff0000, v115
    v_mul_f32 v90, v90, v89
    v_mul_f32 v91, v91, v89
    v_cvt_pk_bf16_f32 v115, v90, v91
    ds_write_b128 v4, v[112:115] offset:8192
    v_lshlrev_b32 v90, 16, v116
    v_and_b32 v91, 0xffff0000, v116
    v_sub_f32 v90, v90, v88
    v_sub_f32 v91, v91, v88
    v_cvt_pk_bf16_f32 v116, v90, v91
    v_lshlrev_b32 v90, 16, v116
    v_and_b32 v91, 0xffff0000, v116
    v_mul_f32 v90, v90, v89
    v_mul_f32 v91, v91, v89
    v_cvt_pk_bf16_f32 v116, v90, v91
    v_lshlrev_b32 v90, 16, v117
    v_and_b32 v91, 0xffff0000, v117
    v_sub_f32 v90, v90, v88
    v_sub_f32 v91, v91, v88
    v_cvt_pk_bf16_f32 v117, v90, v91
    v_lshlrev_b32 v90, 16, v117
    v_and_b32 v91, 0xffff0000, v117
    v_mul_f32 v90, v90, v89
    v_mul_f32 v91, v91, v89
    v_cvt_pk_bf16_f32 v117, v90, v91
    v_lshlrev_b32 v90, 16, v118
    v_and_b32 v91, 0xffff0000, v118
    v_sub_f32 v90, v90, v88
    v_sub_f32 v91, v91, v88
    v_cvt_pk_bf16_f32 v118, v90, v91
    v_lshlrev_b32 v90, 16, v118
    v_and_b32 v91, 0xffff0000, v118
    v_mul_f32 v90, v90, v89
    v_mul_f32 v91, v91, v89
    v_cvt_pk_bf16_f32 v118, v90, v91
    v_lshlrev_b32 v90, 16, v119
    v_and_b32 v91, 0xffff0000, v119
    v_sub_f32 v90, v90, v88
    v_sub_f32 v91, v91, v88
    v_cvt_pk_bf16_f32 v119, v90, v91
    v_lshlrev_b32 v90, 16, v119
    v_and_b32 v91, 0xffff0000, v119
    v_mul_f32 v90, v90, v89
    v_mul_f32 v91, v91, v89
    v_cvt_pk_bf16_f32 v119, v90, v91
    ds_write_b128 v4, v[116:119] offset:10240
    v_lshlrev_b32 v90, 16, v120
    v_and_b32 v91, 0xffff0000, v120
    v_sub_f32 v90, v90, v88
    v_sub_f32 v91, v91, v88
    v_cvt_pk_bf16_f32 v120, v90, v91
    v_lshlrev_b32 v90, 16, v120
    v_and_b32 v91, 0xffff0000, v120
    v_mul_f32 v90, v90, v89
    v_mul_f32 v91, v91, v89
    v_cvt_pk_bf16_f32 v120, v90, v91
    v_lshlrev_b32 v90, 16, v121
    v_and_b32 v91, 0xffff0000, v121
    v_sub_f32 v90, v90, v88
    v_sub_f32 v91, v91, v88
    v_cvt_pk_bf16_f32 v121, v90, v91
    v_lshlrev_b32 v90, 16, v121
    v_and_b32 v91, 0xffff0000, v121
    v_mul_f32 v90, v90, v89
    v_mul_f32 v91, v91, v89
    v_cvt_pk_bf16_f32 v121, v90, v91
    v_lshlrev_b32 v90, 16, v122
    v_and_b32 v91, 0xffff0000, v122
    v_sub_f32 v90, v90, v88
    v_sub_f32 v91, v91, v88
    v_cvt_pk_bf16_f32 v122, v90, v91
    v_lshlrev_b32 v90, 16, v122
    v_and_b32 v91, 0xffff0000, v122
    v_mul_f32 v90, v90, v89
    v_mul_f32 v91, v91, v89
    v_cvt_pk_bf16_f32 v122, v90, v91
    v_lshlrev_b32 v90, 16, v123
    v_and_b32 v91, 0xffff0000, v123
    v_sub_f32 v90, v90, v88
    v_sub_f32 v91, v91, v88
    v_cvt_pk_bf16_f32 v123, v90, v91
    v_lshlrev_b32 v90, 16, v123
    v_and_b32 v91, 0xffff0000, v123
    v_mul_f32 v90, v90, v89
    v_mul_f32 v91, v91, v89
    v_cvt_pk_bf16_f32 v123, v90, v91
    ds_write_b128 v4, v[120:123] offset:12288
    v_lshlrev_b32 v90, 16, v124
    v_and_b32 v91, 0xffff0000, v124
    v_sub_f32 v90, v90, v88
    v_sub_f32 v91, v91, v88
    v_cvt_pk_bf16_f32 v124, v90, v91
    v_lshlrev_b32 v90, 16, v124
    v_and_b32 v91, 0xffff0000, v124
    v_mul_f32 v90, v90, v89
    v_mul_f32 v91, v91, v89
    v_cvt_pk_bf16_f32 v124, v90, v91
    v_lshlrev_b32 v90, 16, v125
    v_and_b32 v91, 0xffff0000, v125
    v_sub_f32 v90, v90, v88
    v_sub_f32 v91, v91, v88
    v_cvt_pk_bf16_f32 v125, v90, v91
    v_lshlrev_b32 v90, 16, v125
    v_and_b32 v91, 0xffff0000, v125
    v_mul_f32 v90, v90, v89
    v_mul_f32 v91, v91, v89
    v_cvt_pk_bf16_f32 v125, v90, v91
    v_lshlrev_b32 v90, 16, v126
    v_and_b32 v91, 0xffff0000, v126
    v_sub_f32 v90, v90, v88
    v_sub_f32 v91, v91, v88
    v_cvt_pk_bf16_f32 v126, v90, v91
    v_lshlrev_b32 v90, 16, v126
    v_and_b32 v91, 0xffff0000, v126
    v_mul_f32 v90, v90, v89
    v_mul_f32 v91, v91, v89
    v_cvt_pk_bf16_f32 v126, v90, v91
    v_lshlrev_b32 v90, 16, v127
    v_and_b32 v91, 0xffff0000, v127
    v_sub_f32 v90, v90, v88
    v_sub_f32 v91, v91, v88
    v_cvt_pk_bf16_f32 v127, v90, v91
    v_lshlrev_b32 v90, 16, v127
    v_and_b32 v91, 0xffff0000, v127
    v_mul_f32 v90, v90, v89
    v_mul_f32 v91, v91, v89
    v_cvt_pk_bf16_f32 v127, v90, v91
    ds_write_b128 v4, v[124:127] offset:14336
    s_lshr_b32 s36, s21, 1
    s_lshl_b32 s36, s36, 14
    s_xor_b32 s37, s36, 16384
    v_add_u32 v80, s36, v5
    v_add_u32 v81, s37, v5
    v_add_u32 v82, s36, v6
    v_add_u32 v83, s37, v6
    s_mov_b32 s31, 0
    s_waitcnt vmcnt(24)
    s_barrier
    ds_read_b64_tr_b16 a[128:129], v20 offset:0
    ds_read_b64_tr_b16 a[130:131], v20 offset:1024
    ds_read_b64_tr_b16 a[132:133], v21 offset:0
    ds_read_b64_tr_b16 a[134:135], v21 offset:1024
    ds_read_b64_tr_b16 a[136:137], v22 offset:0
    ds_read_b64_tr_b16 a[138:139], v22 offset:1024
    ds_read_b64_tr_b16 a[140:141], v23 offset:0
    ds_read_b64_tr_b16 a[142:143], v23 offset:1024
    ds_read_b64_tr_b16 a[144:145], v24 offset:0
    ds_read_b64_tr_b16 a[146:147], v24 offset:1024
    ds_read_b64_tr_b16 a[148:149], v25 offset:0
    ds_read_b64_tr_b16 a[150:151], v25 offset:1024
    s_waitcnt lgkmcnt(4)
    ds_read_b64_tr_b16 a[152:153], v26 offset:0
    ds_read_b64_tr_b16 a[154:155], v26 offset:1024
    ds_read_b64_tr_b16 a[156:157], v27 offset:0
    ds_read_b64_tr_b16 a[158:159], v27 offset:1024
    s_waitcnt lgkmcnt(0)
    s_barrier
    s_mov_b32 s96, s48
    s_and_b32 s97, s49, 0xffff
    s_mov_b32 s98, 0x400000
    s_mov_b32 s99, 0x20000
    s_add_u32 m0, s28, 32768
    s_add_u32 s37, s3, 0x0
    buffer_load_dwordx4 v16, s[96:99], s37 offen lds
    s_add_u32 m0, s28, 36864
    s_add_u32 s37, s3, 0x20000
    buffer_load_dwordx4 v16, s[96:99], s37 offen lds
    s_add_u32 m0, s28, 65536
    s_add_u32 s37, s3, 0x40000
    buffer_load_dwordx4 v16, s[96:99], s37 offen lds
    s_add_u32 m0, s28, 69632
    s_add_u32 s37, s3, 0x60000
    buffer_load_dwordx4 v16, s[96:99], s37 offen lds
    s_add_u32 m0, s28, 98304
    s_add_u32 s37, s3, 0x80000
    buffer_load_dwordx4 v16, s[96:99], s37 offen lds
    s_add_u32 m0, s28, 102400
    s_add_u32 s37, s3, 0xa0000
    buffer_load_dwordx4 v16, s[96:99], s37 offen lds
    s_add_u32 m0, s28, 131072
    s_add_u32 s37, s3, 0xc0000
    buffer_load_dwordx4 v16, s[96:99], s37 offen lds
    s_add_u32 m0, s28, 135168
    s_add_u32 s37, s3, 0xe0000
    buffer_load_dwordx4 v16, s[96:99], s37 offen lds
    s_waitcnt vmcnt(24)
    s_barrier
    ds_read_b64_tr_b16 a[160:161], v20 offset:8192
    ds_read_b64_tr_b16 a[162:163], v20 offset:9216
    ds_read_b64_tr_b16 a[164:165], v21 offset:8192
    ds_read_b64_tr_b16 a[166:167], v21 offset:9216
    ds_read_b64_tr_b16 a[168:169], v22 offset:8192
    ds_read_b64_tr_b16 a[170:171], v22 offset:9216
    ds_read_b64_tr_b16 a[172:173], v23 offset:8192
    ds_read_b64_tr_b16 a[174:175], v23 offset:9216
    ds_read_b64_tr_b16 a[176:177], v24 offset:8192
    ds_read_b64_tr_b16 a[178:179], v24 offset:9216
    ds_read_b64_tr_b16 a[180:181], v25 offset:8192
    ds_read_b64_tr_b16 a[182:183], v25 offset:9216
    s_waitcnt lgkmcnt(4)
    ds_read_b64_tr_b16 a[184:185], v26 offset:8192
    ds_read_b64_tr_b16 a[186:187], v26 offset:9216
    ds_read_b64_tr_b16 a[188:189], v27 offset:8192
    ds_read_b64_tr_b16 a[190:191], v27 offset:9216
    s_waitcnt lgkmcnt(0)
    s_barrier
    s_add_u32 m0, s28, 40960
    s_add_u32 s37, s3, 0x100000
    buffer_load_dwordx4 v16, s[96:99], s37 offen lds
    s_add_u32 m0, s28, 45056
    s_add_u32 s37, s3, 0x120000
    buffer_load_dwordx4 v16, s[96:99], s37 offen lds
    s_add_u32 m0, s28, 73728
    s_add_u32 s37, s3, 0x140000
    buffer_load_dwordx4 v16, s[96:99], s37 offen lds
    s_add_u32 m0, s28, 77824
    s_add_u32 s37, s3, 0x160000
    buffer_load_dwordx4 v16, s[96:99], s37 offen lds
    s_add_u32 m0, s28, 106496
    s_add_u32 s37, s3, 0x180000
    buffer_load_dwordx4 v16, s[96:99], s37 offen lds
    s_add_u32 m0, s28, 110592
    s_add_u32 s37, s3, 0x1a0000
    buffer_load_dwordx4 v16, s[96:99], s37 offen lds
    s_add_u32 m0, s28, 139264
    s_add_u32 s37, s3, 0x1c0000
    buffer_load_dwordx4 v16, s[96:99], s37 offen lds
    s_add_u32 m0, s28, 143360
    s_add_u32 s37, s3, 0x1e0000
    buffer_load_dwordx4 v16, s[96:99], s37 offen lds
    s_waitcnt vmcnt(24)
    s_barrier
    ds_read_b64_tr_b16 a[192:193], v20 offset:16384
    ds_read_b64_tr_b16 a[194:195], v20 offset:17408
    ds_read_b64_tr_b16 a[196:197], v21 offset:16384
    ds_read_b64_tr_b16 a[198:199], v21 offset:17408
    ds_read_b64_tr_b16 a[200:201], v22 offset:16384
    ds_read_b64_tr_b16 a[202:203], v22 offset:17408
    ds_read_b64_tr_b16 a[204:205], v23 offset:16384
    ds_read_b64_tr_b16 a[206:207], v23 offset:17408
    ds_read_b64_tr_b16 a[208:209], v24 offset:16384
    ds_read_b64_tr_b16 a[210:211], v24 offset:17408
    ds_read_b64_tr_b16 a[212:213], v25 offset:16384
    ds_read_b64_tr_b16 a[214:215], v25 offset:17408
    s_waitcnt lgkmcnt(4)
    ds_read_b64_tr_b16 a[216:217], v26 offset:16384
    ds_read_b64_tr_b16 a[218:219], v26 offset:17408
    ds_read_b64_tr_b16 a[220:221], v27 offset:16384
    ds_read_b64_tr_b16 a[222:223], v27 offset:17408
    s_waitcnt lgkmcnt(0)
    s_barrier
    s_add_u32 m0, s28, 49152
    s_add_u32 s37, s3, 0x200000
    buffer_load_dwordx4 v16, s[96:99], s37 offen lds
    s_add_u32 m0, s28, 53248
    s_add_u32 s37, s3, 0x220000
    buffer_load_dwordx4 v16, s[96:99], s37 offen lds
    s_add_u32 m0, s28, 81920
    s_add_u32 s37, s3, 0x240000
    buffer_load_dwordx4 v16, s[96:99], s37 offen lds
    s_add_u32 m0, s28, 86016
    s_add_u32 s37, s3, 0x260000
    buffer_load_dwordx4 v16, s[96:99], s37 offen lds
    s_add_u32 m0, s28, 114688
    s_add_u32 s37, s3, 0x280000
    buffer_load_dwordx4 v16, s[96:99], s37 offen lds
    s_add_u32 m0, s28, 118784
    s_add_u32 s37, s3, 0x2a0000
    buffer_load_dwordx4 v16, s[96:99], s37 offen lds
    s_add_u32 m0, s28, 147456
    s_add_u32 s37, s3, 0x2c0000
    buffer_load_dwordx4 v16, s[96:99], s37 offen lds
    s_add_u32 m0, s28, 151552
    s_add_u32 s37, s3, 0x2e0000
    buffer_load_dwordx4 v16, s[96:99], s37 offen lds
    s_waitcnt vmcnt(24)
    s_barrier
    ds_read_b64_tr_b16 a[224:225], v20 offset:24576
    ds_read_b64_tr_b16 a[226:227], v20 offset:25600
    ds_read_b64_tr_b16 a[228:229], v21 offset:24576
    ds_read_b64_tr_b16 a[230:231], v21 offset:25600
    ds_read_b64_tr_b16 a[232:233], v22 offset:24576
    ds_read_b64_tr_b16 a[234:235], v22 offset:25600
    ds_read_b64_tr_b16 a[236:237], v23 offset:24576
    ds_read_b64_tr_b16 a[238:239], v23 offset:25600
    ds_read_b64_tr_b16 a[240:241], v24 offset:24576
    ds_read_b64_tr_b16 a[242:243], v24 offset:25600
    ds_read_b64_tr_b16 a[244:245], v25 offset:24576
    ds_read_b64_tr_b16 a[246:247], v25 offset:25600
    s_waitcnt lgkmcnt(4)
    ds_read_b64_tr_b16 a[248:249], v26 offset:24576
    ds_read_b64_tr_b16 a[250:251], v26 offset:25600
    ds_read_b64_tr_b16 a[252:253], v27 offset:24576
    ds_read_b64_tr_b16 a[254:255], v27 offset:25600
    s_waitcnt lgkmcnt(0)
    s_barrier
    s_add_u32 m0, s28, 57344
    s_add_u32 s37, s3, 0x300000
    buffer_load_dwordx4 v16, s[96:99], s37 offen lds
    s_add_u32 m0, s28, 61440
    s_add_u32 s37, s3, 0x320000
    buffer_load_dwordx4 v16, s[96:99], s37 offen lds
    s_add_u32 m0, s28, 90112
    s_add_u32 s37, s3, 0x340000
    buffer_load_dwordx4 v16, s[96:99], s37 offen lds
    s_add_u32 m0, s28, 94208
    s_add_u32 s37, s3, 0x360000
    buffer_load_dwordx4 v16, s[96:99], s37 offen lds
    s_add_u32 m0, s28, 122880
    s_add_u32 s37, s3, 0x380000
    buffer_load_dwordx4 v16, s[96:99], s37 offen lds
    s_add_u32 m0, s28, 126976
    s_add_u32 s37, s3, 0x3a0000
    buffer_load_dwordx4 v16, s[96:99], s37 offen lds
    s_add_u32 m0, s28, 155648
    s_add_u32 s37, s3, 0x3c0000
    buffer_load_dwordx4 v16, s[96:99], s37 offen lds
    s_add_u32 m0, s28, 159744
    s_add_u32 s37, s3, 0x3e0000
    buffer_load_dwordx4 v16, s[96:99], s37 offen lds
    ds_read_b128 v[64:67], v80 offset:0
    ds_read_b128 v[68:71], v81 offset:0
    ds_read_b128 v[72:75], v82 offset:1024
    ds_read_b128 v[76:79], v83 offset:1024
    s_waitcnt lgkmcnt(2)
    v_mfma_f32_16x16x32_bf16 v[32:35], a[128:131], v[64:67], 0
    v_mfma_f32_16x16x32_bf16 v[36:39], a[128:131], v[68:71], 0
    v_mfma_f32_16x16x32_bf16 v[40:43], a[132:135], v[64:67], 0
    v_mfma_f32_16x16x32_bf16 v[44:47], a[132:135], v[68:71], 0
    v_mfma_f32_16x16x32_bf16 v[48:51], v[64:67], v[128:131], 0
    v_mfma_f32_16x16x32_bf16 v[56:59], v[68:71], v[128:131], 0
    v_mfma_f32_16x16x32_bf16 v[52:55], v[64:67], v[132:135], 0
    v_mfma_f32_16x16x32_bf16 v[60:63], v[68:71], v[132:135], 0
    ds_read_b128 v[64:67], v80 offset:2048
    ds_read_b128 v[68:71], v81 offset:2048
    s_waitcnt lgkmcnt(2)
    v_mfma_f32_16x16x32_bf16 v[32:35], a[136:139], v[72:75], v[32:35]
    v_mfma_f32_16x16x32_bf16 v[36:39], a[136:139], v[76:79], v[36:39]
    v_mfma_f32_16x16x32_bf16 v[40:43], a[140:143], v[72:75], v[40:43]
    v_mfma_f32_16x16x32_bf16 v[44:47], a[140:143], v[76:79], v[44:47]
    v_mfma_f32_16x16x32_bf16 v[48:51], v[72:75], v[136:139], v[48:51]
    v_mfma_f32_16x16x32_bf16 v[56:59], v[76:79], v[136:139], v[56:59]
    v_mfma_f32_16x16x32_bf16 v[52:55], v[72:75], v[140:143], v[52:55]
    v_mfma_f32_16x16x32_bf16 v[60:63], v[76:79], v[140:143], v[60:63]
    ds_read_b128 v[72:75], v82 offset:3072
    ds_read_b128 v[76:79], v83 offset:3072
    s_waitcnt lgkmcnt(2)
    v_mfma_f32_16x16x32_bf16 v[32:35], a[144:147], v[64:67], v[32:35]
    v_mfma_f32_16x16x32_bf16 v[36:39], a[144:147], v[68:71], v[36:39]
    v_mfma_f32_16x16x32_bf16 v[40:43], a[148:151], v[64:67], v[40:43]
    v_mfma_f32_16x16x32_bf16 v[44:47], a[148:151], v[68:71], v[44:47]
    v_mfma_f32_16x16x32_bf16 v[48:51], v[64:67], v[144:147], v[48:51]
    v_mfma_f32_16x16x32_bf16 v[56:59], v[68:71], v[144:147], v[56:59]
    v_mfma_f32_16x16x32_bf16 v[52:55], v[64:67], v[148:151], v[52:55]
    v_mfma_f32_16x16x32_bf16 v[60:63], v[68:71], v[148:151], v[60:63]
    ds_read_b128 v[64:67], v80 offset:4096
    ds_read_b128 v[68:71], v81 offset:4096
    s_waitcnt lgkmcnt(2)
    v_mfma_f32_16x16x32_bf16 v[32:35], a[152:155], v[72:75], v[32:35]
    v_mfma_f32_16x16x32_bf16 v[36:39], a[152:155], v[76:79], v[36:39]
    v_mfma_f32_16x16x32_bf16 v[40:43], a[156:159], v[72:75], v[40:43]
    v_mfma_f32_16x16x32_bf16 v[44:47], a[156:159], v[76:79], v[44:47]
    v_mfma_f32_16x16x32_bf16 v[48:51], v[72:75], v[152:155], v[48:51]
    v_mfma_f32_16x16x32_bf16 v[56:59], v[76:79], v[152:155], v[56:59]
    v_mfma_f32_16x16x32_bf16 v[52:55], v[72:75], v[156:159], v[52:55]
    v_mfma_f32_16x16x32_bf16 v[60:63], v[76:79], v[156:159], v[60:63]
    ds_read_b128 v[72:75], v82 offset:5120
    ds_read_b128 v[76:79], v83 offset:5120
    s_waitcnt lgkmcnt(2)
    v_mfma_f32_16x16x32_bf16 v[32:35], a[160:163], v[64:67], v[32:35]
    v_mfma_f32_16x16x32_bf16 v[36:39], a[160:163], v[68:71], v[36:39]
    v_mfma_f32_16x16x32_bf16 v[40:43], a[164:167], v[64:67], v[40:43]
    v_mfma_f32_16x16x32_bf16 v[44:47], a[164:167], v[68:71], v[44:47]
    v_mfma_f32_16x16x32_bf16 v[48:51], v[64:67], v[160:163], v[48:51]
    v_mfma_f32_16x16x32_bf16 v[56:59], v[68:71], v[160:163], v[56:59]
    v_mfma_f32_16x16x32_bf16 v[52:55], v[64:67], v[164:167], v[52:55]
    v_mfma_f32_16x16x32_bf16 v[60:63], v[68:71], v[164:167], v[60:63]
    ds_read_b128 v[64:67], v80 offset:6144
    ds_read_b128 v[68:71], v81 offset:6144
    s_waitcnt lgkmcnt(2)
    v_mfma_f32_16x16x32_bf16 v[32:35], a[168:171], v[72:75], v[32:35]
    v_mfma_f32_16x16x32_bf16 v[36:39], a[168:171], v[76:79], v[36:39]
    v_mfma_f32_16x16x32_bf16 v[40:43], a[172:175], v[72:75], v[40:43]
    v_mfma_f32_16x16x32_bf16 v[44:47], a[172:175], v[76:79], v[44:47]
    v_mfma_f32_16x16x32_bf16 v[48:51], v[72:75], v[168:171], v[48:51]
    v_mfma_f32_16x16x32_bf16 v[56:59], v[76:79], v[168:171], v[56:59]
    v_mfma_f32_16x16x32_bf16 v[52:55], v[72:75], v[172:175], v[52:55]
    v_mfma_f32_16x16x32_bf16 v[60:63], v[76:79], v[172:175], v[60:63]
    ds_read_b128 v[72:75], v82 offset:7168
    ds_read_b128 v[76:79], v83 offset:7168
    s_waitcnt lgkmcnt(2)
    v_mfma_f32_16x16x32_bf16 v[32:35], a[176:179], v[64:67], v[32:35]
    v_mfma_f32_16x16x32_bf16 v[36:39], a[176:179], v[68:71], v[36:39]
    v_mfma_f32_16x16x32_bf16 v[40:43], a[180:183], v[64:67], v[40:43]
    v_mfma_f32_16x16x32_bf16 v[44:47], a[180:183], v[68:71], v[44:47]
    v_mfma_f32_16x16x32_bf16 v[48:51], v[64:67], v[176:179], v[48:51]
    v_mfma_f32_16x16x32_bf16 v[56:59], v[68:71], v[176:179], v[56:59]
    v_mfma_f32_16x16x32_bf16 v[52:55], v[64:67], v[180:183], v[52:55]
    v_mfma_f32_16x16x32_bf16 v[60:63], v[68:71], v[180:183], v[60:63]
    ds_read_b128 v[64:67], v80 offset:8192
    ds_read_b128 v[68:71], v81 offset:8192
    s_waitcnt lgkmcnt(2)
    v_mfma_f32_16x16x32_bf16 v[32:35], a[184:187], v[72:75], v[32:35]
    v_mfma_f32_16x16x32_bf16 v[36:39], a[184:187], v[76:79], v[36:39]
    v_mfma_f32_16x16x32_bf16 v[40:43], a[188:191], v[72:75], v[40:43]
    v_mfma_f32_16x16x32_bf16 v[44:47], a[188:191], v[76:79], v[44:47]
    v_mfma_f32_16x16x32_bf16 v[48:51], v[72:75], v[184:187], v[48:51]
    v_mfma_f32_16x16x32_bf16 v[56:59], v[76:79], v[184:187], v[56:59]
    v_mfma_f32_16x16x32_bf16 v[52:55], v[72:75], v[188:191], v[52:55]
    v_mfma_f32_16x16x32_bf16 v[60:63], v[76:79], v[188:191], v[60:63]
    ds_read_b128 v[72:75], v82 offset:9216
    ds_read_b128 v[76:79], v83 offset:9216
    s_waitcnt lgkmcnt(2)
    v_mfma_f32_16x16x32_bf16 v[32:35], a[192:195], v[64:67], v[32:35]
    v_mfma_f32_16x16x32_bf16 v[36:39], a[192:195], v[68:71], v[36:39]
    v_mfma_f32_16x16x32_bf16 v[40:43], a[196:199], v[64:67], v[40:43]
    v_mfma_f32_16x16x32_bf16 v[44:47], a[196:199], v[68:71], v[44:47]
    v_mfma_f32_16x16x32_bf16 v[48:51], v[64:67], v[192:195], v[48:51]
    v_mfma_f32_16x16x32_bf16 v[56:59], v[68:71], v[192:195], v[56:59]
    v_mfma_f32_16x16x32_bf16 v[52:55], v[64:67], v[196:199], v[52:55]
    v_mfma_f32_16x16x32_bf16 v[60:63], v[68:71], v[196:199], v[60:63]
    ds_read_b128 v[64:67], v80 offset:10240
    ds_read_b128 v[68:71], v81 offset:10240
    s_waitcnt lgkmcnt(2)
    v_mfma_f32_16x16x32_bf16 v[32:35], a[200:203], v[72:75], v[32:35]
    v_mfma_f32_16x16x32_bf16 v[36:39], a[200:203], v[76:79], v[36:39]
    v_mfma_f32_16x16x32_bf16 v[40:43], a[204:207], v[72:75], v[40:43]
    v_mfma_f32_16x16x32_bf16 v[44:47], a[204:207], v[76:79], v[44:47]
    v_mfma_f32_16x16x32_bf16 v[48:51], v[72:75], v[200:203], v[48:51]
    v_mfma_f32_16x16x32_bf16 v[56:59], v[76:79], v[200:203], v[56:59]
    v_mfma_f32_16x16x32_bf16 v[52:55], v[72:75], v[204:207], v[52:55]
    v_mfma_f32_16x16x32_bf16 v[60:63], v[76:79], v[204:207], v[60:63]
    ds_read_b128 v[72:75], v82 offset:11264
    ds_read_b128 v[76:79], v83 offset:11264
    s_waitcnt lgkmcnt(2)
    v_mfma_f32_16x16x32_bf16 v[32:35], a[208:211], v[64:67], v[32:35]
    v_mfma_f32_16x16x32_bf16 v[36:39], a[208:211], v[68:71], v[36:39]
    v_mfma_f32_16x16x32_bf16 v[40:43], a[212:215], v[64:67], v[40:43]
    v_mfma_f32_16x16x32_bf16 v[44:47], a[212:215], v[68:71], v[44:47]
    v_mfma_f32_16x16x32_bf16 v[48:51], v[64:67], v[208:211], v[48:51]
    v_mfma_f32_16x16x32_bf16 v[56:59], v[68:71], v[208:211], v[56:59]
    v_mfma_f32_16x16x32_bf16 v[52:55], v[64:67], v[212:215], v[52:55]
    v_mfma_f32_16x16x32_bf16 v[60:63], v[68:71], v[212:215], v[60:63]
    ds_read_b128 v[64:67], v80 offset:12288
    ds_read_b128 v[68:71], v81 offset:12288
    s_waitcnt lgkmcnt(2)
    v_mfma_f32_16x16x32_bf16 v[32:35], a[216:219], v[72:75], v[32:35]
    v_mfma_f32_16x16x32_bf16 v[36:39], a[216:219], v[76:79], v[36:39]
    v_mfma_f32_16x16x32_bf16 v[40:43], a[220:223], v[72:75], v[40:43]
    v_mfma_f32_16x16x32_bf16 v[44:47], a[220:223], v[76:79], v[44:47]
    v_mfma_f32_16x16x32_bf16 v[48:51], v[72:75], v[216:219], v[48:51]
    v_mfma_f32_16x16x32_bf16 v[56:59], v[76:79], v[216:219], v[56:59]
    v_mfma_f32_16x16x32_bf16 v[52:55], v[72:75], v[220:223], v[52:55]
    v_mfma_f32_16x16x32_bf16 v[60:63], v[76:79], v[220:223], v[60:63]
    ds_read_b128 v[72:75], v82 offset:13312
    ds_read_b128 v[76:79], v83 offset:13312
    s_waitcnt lgkmcnt(2)
    v_mfma_f32_16x16x32_bf16 v[32:35], a[224:227], v[64:67], v[32:35]
    v_mfma_f32_16x16x32_bf16 v[36:39], a[224:227], v[68:71], v[36:39]
    v_mfma_f32_16x16x32_bf16 v[40:43], a[228:231], v[64:67], v[40:43]
    v_mfma_f32_16x16x32_bf16 v[44:47], a[228:231], v[68:71], v[44:47]
    v_mfma_f32_16x16x32_bf16 v[48:51], v[64:67], v[224:227], v[48:51]
    v_mfma_f32_16x16x32_bf16 v[56:59], v[68:71], v[224:227], v[56:59]
    v_mfma_f32_16x16x32_bf16 v[52:55], v[64:67], v[228:231], v[52:55]
    v_mfma_f32_16x16x32_bf16 v[60:63], v[68:71], v[228:231], v[60:63]
    ds_read_b128 v[64:67], v80 offset:14336
    ds_read_b128 v[68:71], v81 offset:14336
    s_waitcnt lgkmcnt(2)
    v_mfma_f32_16x16x32_bf16 v[32:35], a[232:235], v[72:75], v[32:35]
    v_mfma_f32_16x16x32_bf16 v[36:39], a[232:235], v[76:79], v[36:39]
    v_mfma_f32_16x16x32_bf16 v[40:43], a[236:239], v[72:75], v[40:43]
    v_mfma_f32_16x16x32_bf16 v[44:47], a[236:239], v[76:79], v[44:47]
    v_mfma_f32_16x16x32_bf16 v[48:51], v[72:75], v[232:235], v[48:51]
    v_mfma_f32_16x16x32_bf16 v[56:59], v[76:79], v[232:235], v[56:59]
    v_mfma_f32_16x16x32_bf16 v[52:55], v[72:75], v[236:239], v[52:55]
    v_mfma_f32_16x16x32_bf16 v[60:63], v[76:79], v[236:239], v[60:63]
    ds_read_b128 v[72:75], v82 offset:15360
    ds_read_b128 v[76:79], v83 offset:15360
    s_waitcnt lgkmcnt(2)
    v_mfma_f32_16x16x32_bf16 v[32:35], a[240:243], v[64:67], v[32:35]
    v_mfma_f32_16x16x32_bf16 v[36:39], a[240:243], v[68:71], v[36:39]
    v_mfma_f32_16x16x32_bf16 v[40:43], a[244:247], v[64:67], v[40:43]
    v_mfma_f32_16x16x32_bf16 v[44:47], a[244:247], v[68:71], v[44:47]
    v_mfma_f32_16x16x32_bf16 v[48:51], v[64:67], v[240:243], v[48:51]
    v_mfma_f32_16x16x32_bf16 v[56:59], v[68:71], v[240:243], v[56:59]
    v_mfma_f32_16x16x32_bf16 v[52:55], v[64:67], v[244:247], v[52:55]
    v_mfma_f32_16x16x32_bf16 v[60:63], v[68:71], v[244:247], v[60:63]
    s_waitcnt lgkmcnt(0)
    v_mfma_f32_16x16x32_bf16 v[32:35], a[248:251], v[72:75], v[32:35]
    v_mfma_f32_16x16x32_bf16 v[36:39], a[248:251], v[76:79], v[36:39]
    v_mfma_f32_16x16x32_bf16 v[40:43], a[252:255], v[72:75], v[40:43]
    v_mfma_f32_16x16x32_bf16 v[44:47], a[252:255], v[76:79], v[44:47]
    v_mfma_f32_16x16x32_bf16 v[48:51], v[72:75], v[248:251], v[48:51]
    v_mfma_f32_16x16x32_bf16 v[56:59], v[76:79], v[248:251], v[56:59]
    v_mfma_f32_16x16x32_bf16 v[52:55], v[72:75], v[252:255], v[52:55]
    v_mfma_f32_16x16x32_bf16 v[60:63], v[76:79], v[252:255], v[60:63]
    s_nop 2
    v_cvt_pk_bf16_f32 v88, v32, v40
    v_cvt_pk_bf16_f32 v89, v33, v41
    v_cvt_pk_bf16_f32 v90, v34, v42
    v_cvt_pk_bf16_f32 v91, v35, v43
    v_cvt_pk_bf16_f32 v92, v36, v44
    v_cvt_pk_bf16_f32 v93, v37, v45
    v_cvt_pk_bf16_f32 v94, v38, v46
    v_cvt_pk_bf16_f32 v95, v39, v47
    v_cvt_pk_bf16_f32 v96, v48, v49
    v_cvt_pk_bf16_f32 v97, v50, v51
    v_cvt_pk_bf16_f32 v98, v56, v57
    v_cvt_pk_bf16_f32 v99, v58, v59
    v_cvt_pk_bf16_f32 v100, v52, v53
    v_cvt_pk_bf16_f32 v101, v54, v55
    v_cvt_pk_bf16_f32 v102, v60, v61
    v_cvt_pk_bf16_f32 v103, v62, v63
    s_mul_i32 s24, s23, 0x82100
    s_lshl_b32 s36, s20, 14
    s_add_u32 s24, s24, s36
    s_add_u32 s24, s24, 0x1000000
    s_mov_b32 s30, s24
    s_lshr_b32 s36, s21, 1
    s_lshl_b32 s36, s36, 12
    s_xor_b32 s37, s36, 4096
    s_add_u32 s36, s36, s24
    s_add_u32 s37, s37, s24
    buffer_store_dwordx4 v[88:91], v9, s[8:11], s36 offen sc1
    buffer_store_dwordx4 v[92:95], v9, s[8:11], s37 offen sc1
    s_add_u32 s24, s24, 8192
    buffer_store_dwordx4 v[96:99], v2, s[8:11], s24 offen sc1
    buffer_store_dwordx4 v[100:103], v2, s[8:11], s24 offen offset:1024 sc1
    s_mul_i32 s25, s23, 0x82100
    s_lshl_b32 s36, s20, 2
    s_add_u32 s25, s25, s36
    s_add_u32 s25, s25, 0x1082000
    v_lshrrev_b32 v15, 2, v1
    v_and_b32 v15, 127, v15
L_WHS:
    buffer_load_dword v14, v15, s[16:19], 0 offen sc1
    s_add_u32 s32, s32, 1
    s_cmp_gt_u32 s32, 200000
    s_cbranch_scc1 L_WHS_done
    s_waitcnt vmcnt(0)
    v_cmp_eq_u32 vcc, 0, v14
    s_cbranch_vccnz L_WHS
L_WHS_done:
    s_waitcnt vmcnt(0)
    s_barrier
    v_cmp_ne_u32 vcc, 0, v0
    v_mov_b32 v15, 0x40000000
    v_mov_b32 v14, 1
    v_cndmask_b32 v15, v0, v15, vcc
    buffer_store_dword v14, v15, s[8:11], s25 offen sc1
    s_barrier
    ds_read_b64_tr_b16 a[0:1], v20 offset:0
    ds_read_b64_tr_b16 a[2:3], v20 offset:1024
    ds_read_b64_tr_b16 a[4:5], v21 offset:0
    ds_read_b64_tr_b16 a[6:7], v21 offset:1024
    ds_read_b64_tr_b16 a[8:9], v22 offset:0
    ds_read_b64_tr_b16 a[10:11], v22 offset:1024
    ds_read_b64_tr_b16 a[12:13], v23 offset:0
    ds_read_b64_tr_b16 a[14:15], v23 offset:1024
    ds_read_b64_tr_b16 a[16:17], v24 offset:0
    ds_read_b64_tr_b16 a[18:19], v24 offset:1024
    ds_read_b64_tr_b16 a[20:21], v25 offset:0
    ds_read_b64_tr_b16 a[22:23], v25 offset:1024
    s_waitcnt lgkmcnt(4)
    ds_read_b64_tr_b16 a[24:25], v26 offset:0
    ds_read_b64_tr_b16 a[26:27], v26 offset:1024
    ds_read_b64_tr_b16 a[28:29], v27 offset:0
    ds_read_b64_tr_b16 a[30:31], v27 offset:1024
    s_waitcnt lgkmcnt(0)
    s_barrier
    s_barrier
    ds_read_b64_tr_b16 a[32:33], v20 offset:8192
    ds_read_b64_tr_b16 a[34:35], v20 offset:9216
    ds_read_b64_tr_b16 a[36:37], v21 offset:8192
    ds_read_b64_tr_b16 a[38:39], v21 offset:9216
    ds_read_b64_tr_b16 a[40:41], v22 offset:8192
    ds_read_b64_tr_b16 a[42:43], v22 offset:9216
    ds_read_b64_tr_b16 a[44:45], v23 offset:8192
    ds_read_b64_tr_b16 a[46:47], v23 offset:9216
    ds_read_b64_tr_b16 a[48:49], v24 offset:8192
    ds_read_b64_tr_b16 a[50:51], v24 offset:9216
    ds_read_b64_tr_b16 a[52:53], v25 offset:8192
    ds_read_b64_tr_b16 a[54:55], v25 offset:9216
    s_waitcnt lgkmcnt(4)
    ds_read_b64_tr_b16 a[56:57], v26 offset:8192
    ds_read_b64_tr_b16 a[58:59], v26 offset:9216
    ds_read_b64_tr_b16 a[60:61], v27 offset:8192
    ds_read_b64_tr_b16 a[62:63], v27 offset:9216
    s_waitcnt lgkmcnt(0)
    s_barrier
    s_barrier
    ds_read_b64_tr_b16 a[64:65], v20 offset:16384
    ds_read_b64_tr_b16 a[66:67], v20 offset:17408
    ds_read_b64_tr_b16 a[68:69], v21 offset:16384
    ds_read_b64_tr_b16 a[70:71], v21 offset:17408
    ds_read_b64_tr_b16 a[72:73], v22 offset:16384
    ds_read_b64_tr_b16 a[74:75], v22 offset:17408
    ds_read_b64_tr_b16 a[76:77], v23 offset:16384
    ds_read_b64_tr_b16 a[78:79], v23 offset:17408
    ds_read_b64_tr_b16 a[80:81], v24 offset:16384
    ds_read_b64_tr_b16 a[82:83], v24 offset:17408
    ds_read_b64_tr_b16 a[84:85], v25 offset:16384
    ds_read_b64_tr_b16 a[86:87], v25 offset:17408
    s_waitcnt lgkmcnt(4)
    ds_read_b64_tr_b16 a[88:89], v26 offset:16384
    ds_read_b64_tr_b16 a[90:91], v26 offset:17408
    ds_read_b64_tr_b16 a[92:93], v27 offset:16384
    ds_read_b64_tr_b16 a[94:95], v27 offset:17408
    s_waitcnt lgkmcnt(0)
    s_barrier
    s_barrier
    ds_read_b64_tr_b16 a[96:97], v20 offset:24576
    ds_read_b64_tr_b16 a[98:99], v20 offset:25600
    ds_read_b64_tr_b16 a[100:101], v21 offset:24576
    ds_read_b64_tr_b16 a[102:103], v21 offset:25600
    ds_read_b64_tr_b16 a[104:105], v22 offset:24576
    ds_read_b64_tr_b16 a[106:107], v22 offset:25600
    ds_read_b64_tr_b16 a[108:109], v23 offset:24576
    ds_read_b64_tr_b16 a[110:111], v23 offset:25600
    ds_read_b64_tr_b16 a[112:113], v24 offset:24576
    ds_read_b64_tr_b16 a[114:115], v24 offset:25600
    ds_read_b64_tr_b16 a[116:117], v25 offset:24576
    ds_read_b64_tr_b16 a[118:119], v25 offset:25600
    s_waitcnt lgkmcnt(4)
    ds_read_b64_tr_b16 a[120:121], v26 offset:24576
    ds_read_b64_tr_b16 a[122:123], v26 offset:25600
    ds_read_b64_tr_b16 a[124:125], v27 offset:24576
    ds_read_b64_tr_b16 a[126:127], v27 offset:25600
    s_waitcnt lgkmcnt(0)
    s_barrier
L_P1:
    s_waitcnt vmcnt(6)
    s_barrier
    s_xor_b32 s31, s31, 32768
    s_add_u32 s24, s23, 6
    s_min_u32 s24, s24, 63
    s_lshl_b32 s36, s24, 15
    s_add_u32 s36, s36, 0x800000
    s_lshl_b32 s37, s21, 10
    s_add_u32 s37, s37, s31
    s_add_u32 m0, s37, 0
    s_add_u32 s38, s36, 0
    buffer_load_dwordx4 v9, s[8:11], s38 offen sc1 lds
    s_add_u32 m0, s37, 4096
    s_add_u32 s38, s36, 4096
    buffer_load_dwordx4 v9, s[8:11], s38 offen sc1 lds
    s_add_u32 m0, s37, 8192
    s_add_u32 s38, s36, 8192
    buffer_load_dwordx4 v9, s[8:11], s38 offen sc1 lds
    s_add_u32 m0, s37, 12288
    s_add_u32 s38, s36, 12288
    buffer_load_dwordx4 v9, s[8:11], s38 offen sc1 lds
    s_add_u32 m0, s37, 16384
    s_add_u32 s38, s36, 16384
    buffer_load_dwordx4 v9, s[8:11], s38 offen sc1 lds
    s_add_u32 m0, s37, 20480
    s_add_u32 s38, s36, 20480
    buffer_load_dwordx4 v9, s[8:11], s38 offen sc1 lds
    s_add_u32 m0, s37, 24576
    s_add_u32 s38, s36, 24576
    buffer_load_dwordx4 v9, s[8:11], s38 offen sc1 lds
    s_add_u32 m0, s37, 28672
    s_add_u32 s38, s36, 28672
    buffer_load_dwordx4 v9, s[8:11], s38 offen sc1 lds
    ds_read_b128 v[64:67], v80 offset:0
    ds_read_b128 v[68:71], v81 offset:0
    ds_read_b128 v[72:75], v82 offset:1024
    ds_read_b128 v[76:79], v83 offset:1024
    s_waitcnt lgkmcnt(2)
    v_mfma_f32_16x16x32_bf16 v[32:35], a[128:131], v[64:67], 0
    v_mfma_f32_16x16x32_bf16 v[36:39], a[128:131], v[68:71], 0
    v_mfma_f32_16x16x32_bf16 v[40:43], a[132:135], v[64:67], 0
    v_mfma_f32_16x16x32_bf16 v[44:47], a[132:135], v[68:71], 0
    v_mfma_f32_16x16x32_bf16 v[48:51], v[64:67], v[128:131], 0
    v_mfma_f32_16x16x32_bf16 v[56:59], v[68:71], v[128:131], 0
    v_mfma_f32_16x16x32_bf16 v[52:55], v[64:67], v[132:135], 0
    v_mfma_f32_16x16x32_bf16 v[60:63], v[68:71], v[132:135], 0
    v_mfma_f32_16x16x32_bf16 v[16:19], a[0:3], v[64:67], 0
    v_mfma_f32_16x16x32_bf16 v[20:23], a[0:3], v[68:71], 0
    v_mfma_f32_16x16x32_bf16 v[24:27], a[4:7], v[64:67], 0
    v_mfma_f32_16x16x32_bf16 v[28:31], a[4:7], v[68:71], 0
    ds_read_b128 v[64:67], v80 offset:2048
    ds_read_b128 v[68:71], v81 offset:2048
    s_waitcnt lgkmcnt(2)
    v_mfma_f32_16x16x32_bf16 v[32:35], a[136:139], v[72:75], v[32:35]
    v_mfma_f32_16x16x32_bf16 v[36:39], a[136:139], v[76:79], v[36:39]
    v_mfma_f32_16x16x32_bf16 v[40:43], a[140:143], v[72:75], v[40:43]
    v_mfma_f32_16x16x32_bf16 v[44:47], a[140:143], v[76:79], v[44:47]
    v_mfma_f32_16x16x32_bf16 v[48:51], v[72:75], v[136:139], v[48:51]
    v_mfma_f32_16x16x32_bf16 v[56:59], v[76:79], v[136:139], v[56:59]
    v_mfma_f32_16x16x32_bf16 v[52:55], v[72:75], v[140:143], v[52:55]
    v_mfma_f32_16x16x32_bf16 v[60:63], v[76:79], v[140:143], v[60:63]
    v_mfma_f32_16x16x32_bf16 v[16:19], a[8:11], v[72:75], v[16:19]
    v_mfma_f32_16x16x32_bf16 v[20:23], a[8:11], v[76:79], v[20:23]
    v_mfma_f32_16x16x32_bf16 v[24:27], a[12:15], v[72:75], v[24:27]
    v_mfma_f32_16x16x32_bf16 v[28:31], a[12:15], v[76:79], v[28:31]
    ds_read_b128 v[72:75], v82 offset:3072
    ds_read_b128 v[76:79], v83 offset:3072
    s_waitcnt lgkmcnt(2)
    v_mfma_f32_16x16x32_bf16 v[32:35], a[144:147], v[64:67], v[32:35]
    v_mfma_f32_16x16x32_bf16 v[36:39], a[144:147], v[68:71], v[36:39]
    v_mfma_f32_16x16x32_bf16 v[40:43], a[148:151], v[64:67], v[40:43]
    v_mfma_f32_16x16x32_bf16 v[44:47], a[148:151], v[68:71], v[44:47]
    v_mfma_f32_16x16x32_bf16 v[48:51], v[64:67], v[144:147], v[48:51]
    v_mfma_f32_16x16x32_bf16 v[56:59], v[68:71], v[144:147], v[56:59]
    v_mfma_f32_16x16x32_bf16 v[52:55], v[64:67], v[148:151], v[52:55]
    v_mfma_f32_16x16x32_bf16 v[60:63], v[68:71], v[148:151], v[60:63]
    v_mfma_f32_16x16x32_bf16 v[16:19], a[16:19], v[64:67], v[16:19]
    v_mfma_f32_16x16x32_bf16 v[20:23], a[16:19], v[68:71], v[20:23]
    v_mfma_f32_16x16x32_bf16 v[24:27], a[20:23], v[64:67], v[24:27]
    v_mfma_f32_16x16x32_bf16 v[28:31], a[20:23], v[68:71], v[28:31]
    ds_read_b128 v[64:67], v80 offset:4096
    ds_read_b128 v[68:71], v81 offset:4096
    s_waitcnt lgkmcnt(2)
    v_mfma_f32_16x16x32_bf16 v[32:35], a[152:155], v[72:75], v[32:35]
    v_mfma_f32_16x16x32_bf16 v[36:39], a[152:155], v[76:79], v[36:39]
    v_mfma_f32_16x16x32_bf16 v[40:43], a[156:159], v[72:75], v[40:43]
    v_mfma_f32_16x16x32_bf16 v[44:47], a[156:159], v[76:79], v[44:47]
    v_mfma_f32_16x16x32_bf16 v[48:51], v[72:75], v[152:155], v[48:51]
    v_mfma_f32_16x16x32_bf16 v[56:59], v[76:79], v[152:155], v[56:59]
    v_mfma_f32_16x16x32_bf16 v[52:55], v[72:75], v[156:159], v[52:55]
    v_mfma_f32_16x16x32_bf16 v[60:63], v[76:79], v[156:159], v[60:63]
    v_mfma_f32_16x16x32_bf16 v[16:19], a[24:27], v[72:75], v[16:19]
    v_mfma_f32_16x16x32_bf16 v[20:23], a[24:27], v[76:79], v[20:23]
    v_mfma_f32_16x16x32_bf16 v[24:27], a[28:31], v[72:75], v[24:27]
    v_mfma_f32_16x16x32_bf16 v[28:31], a[28:31], v[76:79], v[28:31]
    ds_read_b128 v[72:75], v82 offset:5120
    ds_read_b128 v[76:79], v83 offset:5120
    s_waitcnt lgkmcnt(2)
    v_mfma_f32_16x16x32_bf16 v[32:35], a[160:163], v[64:67], v[32:35]
    v_mfma_f32_16x16x32_bf16 v[36:39], a[160:163], v[68:71], v[36:39]
    v_mfma_f32_16x16x32_bf16 v[40:43], a[164:167], v[64:67], v[40:43]
    v_mfma_f32_16x16x32_bf16 v[44:47], a[164:167], v[68:71], v[44:47]
    v_mfma_f32_16x16x32_bf16 v[48:51], v[64:67], v[160:163], v[48:51]
    v_mfma_f32_16x16x32_bf16 v[56:59], v[68:71], v[160:163], v[56:59]
    v_mfma_f32_16x16x32_bf16 v[52:55], v[64:67], v[164:167], v[52:55]
    v_mfma_f32_16x16x32_bf16 v[60:63], v[68:71], v[164:167], v[60:63]
    v_mfma_f32_16x16x32_bf16 v[16:19], a[32:35], v[64:67], v[16:19]
    v_mfma_f32_16x16x32_bf16 v[20:23], a[32:35], v[68:71], v[20:23]
    v_mfma_f32_16x16x32_bf16 v[24:27], a[36:39], v[64:67], v[24:27]
    v_mfma_f32_16x16x32_bf16 v[28:31], a[36:39], v[68:71], v[28:31]
    ds_read_b128 v[64:67], v80 offset:6144
    ds_read_b128 v[68:71], v81 offset:6144
    s_waitcnt lgkmcnt(2)
    v_mfma_f32_16x16x32_bf16 v[32:35], a[168:171], v[72:75], v[32:35]
    v_mfma_f32_16x16x32_bf16 v[36:39], a[168:171], v[76:79], v[36:39]
    v_mfma_f32_16x16x32_bf16 v[40:43], a[172:175], v[72:75], v[40:43]
    v_mfma_f32_16x16x32_bf16 v[44:47], a[172:175], v[76:79], v[44:47]
    v_mfma_f32_16x16x32_bf16 v[48:51], v[72:75], v[168:171], v[48:51]
    v_mfma_f32_16x16x32_bf16 v[56:59], v[76:79], v[168:171], v[56:59]
    v_mfma_f32_16x16x32_bf16 v[52:55], v[72:75], v[172:175], v[52:55]
    v_mfma_f32_16x16x32_bf16 v[60:63], v[76:79], v[172:175], v[60:63]
    v_mfma_f32_16x16x32_bf16 v[16:19], a[40:43], v[72:75], v[16:19]
    v_mfma_f32_16x16x32_bf16 v[20:23], a[40:43], v[76:79], v[20:23]
    v_mfma_f32_16x16x32_bf16 v[24:27], a[44:47], v[72:75], v[24:27]
    v_mfma_f32_16x16x32_bf16 v[28:31], a[44:47], v[76:79], v[28:31]
    ds_read_b128 v[72:75], v82 offset:7168
    ds_read_b128 v[76:79], v83 offset:7168
    s_waitcnt lgkmcnt(2)
    s_waitcnt vmcnt(8)
    s_barrier
    v_cmp_ne_u32 vcc, 0, v0
    v_mov_b32 v15, 0x40000000
    v_mov_b32 v14, 1
    v_cndmask_b32 v15, v0, v15, vcc
    buffer_store_dword v14, v15, s[8:11], s25 offen sc1
    v_mfma_f32_16x16x32_bf16 v[32:35], a[176:179], v[64:67], v[32:35]
    v_mfma_f32_16x16x32_bf16 v[36:39], a[176:179], v[68:71], v[36:39]
    v_mfma_f32_16x16x32_bf16 v[40:43], a[180:183], v[64:67], v[40:43]
    v_mfma_f32_16x16x32_bf16 v[44:47], a[180:183], v[68:71], v[44:47]
    v_mfma_f32_16x16x32_bf16 v[48:51], v[64:67], v[176:179], v[48:51]
    v_mfma_f32_16x16x32_bf16 v[56:59], v[68:71], v[176:179], v[56:59]
    v_mfma_f32_16x16x32_bf16 v[52:55], v[64:67], v[180:183], v[52:55]
    v_mfma_f32_16x16x32_bf16 v[60:63], v[68:71], v[180:183], v[60:63]
    v_mfma_f32_16x16x32_bf16 v[16:19], a[48:51], v[64:67], v[16:19]
    v_mfma_f32_16x16x32_bf16 v[20:23], a[48:51], v[68:71], v[20:23]
    v_mfma_f32_16x16x32_bf16 v[24:27], a[52:55], v[64:67], v[24:27]
    v_mfma_f32_16x16x32_bf16 v[28:31], a[52:55], v[68:71], v[28:31]
    ds_read_b128 v[64:67], v80 offset:8192
    ds_read_b128 v[68:71], v81 offset:8192
    s_waitcnt lgkmcnt(2)
    v_mfma_f32_16x16x32_bf16 v[32:35], a[184:187], v[72:75], v[32:35]
    v_mfma_f32_16x16x32_bf16 v[36:39], a[184:187], v[76:79], v[36:39]
    v_mfma_f32_16x16x32_bf16 v[40:43], a[188:191], v[72:75], v[40:43]
    v_mfma_f32_16x16x32_bf16 v[44:47], a[188:191], v[76:79], v[44:47]
    v_mfma_f32_16x16x32_bf16 v[48:51], v[72:75], v[184:187], v[48:51]
    v_mfma_f32_16x16x32_bf16 v[56:59], v[76:79], v[184:187], v[56:59]
    v_mfma_f32_16x16x32_bf16 v[52:55], v[72:75], v[188:191], v[52:55]
    v_mfma_f32_16x16x32_bf16 v[60:63], v[76:79], v[188:191], v[60:63]
    v_mfma_f32_16x16x32_bf16 v[16:19], a[56:59], v[72:75], v[16:19]
    v_mfma_f32_16x16x32_bf16 v[20:23], a[56:59], v[76:79], v[20:23]
    v_mfma_f32_16x16x32_bf16 v[24:27], a[60:63], v[72:75], v[24:27]
    v_mfma_f32_16x16x32_bf16 v[28:31], a[60:63], v[76:79], v[28:31]
    ds_read_b128 v[72:75], v82 offset:9216
    ds_read_b128 v[76:79], v83 offset:9216
    s_waitcnt lgkmcnt(2)
    v_mfma_f32_16x16x32_bf16 v[32:35], a[192:195], v[64:67], v[32:35]
    v_mfma_f32_16x16x32_bf16 v[36:39], a[192:195], v[68:71], v[36:39]
    v_mfma_f32_16x16x32_bf16 v[40:43], a[196:199], v[64:67], v[40:43]
    v_mfma_f32_16x16x32_bf16 v[44:47], a[196:199], v[68:71], v[44:47]
    v_mfma_f32_16x16x32_bf16 v[48:51], v[64:67], v[192:195], v[48:51]
    v_mfma_f32_16x16x32_bf16 v[56:59], v[68:71], v[192:195], v[56:59]
    v_mfma_f32_16x16x32_bf16 v[52:55], v[64:67], v[196:199], v[52:55]
    v_mfma_f32_16x16x32_bf16 v[60:63], v[68:71], v[196:199], v[60:63]
    v_mfma_f32_16x16x32_bf16 v[16:19], a[64:67], v[64:67], v[16:19]
    v_mfma_f32_16x16x32_bf16 v[20:23], a[64:67], v[68:71], v[20:23]
    v_mfma_f32_16x16x32_bf16 v[24:27], a[68:71], v[64:67], v[24:27]
    v_mfma_f32_16x16x32_bf16 v[28:31], a[68:71], v[68:71], v[28:31]
    ds_read_b128 v[64:67], v80 offset:10240
    ds_read_b128 v[68:71], v81 offset:10240
    s_waitcnt lgkmcnt(2)
    v_mfma_f32_16x16x32_bf16 v[32:35], a[200:203], v[72:75], v[32:35]
    v_mfma_f32_16x16x32_bf16 v[36:39], a[200:203], v[76:79], v[36:39]
    v_mfma_f32_16x16x32_bf16 v[40:43], a[204:207], v[72:75], v[40:43]
    v_mfma_f32_16x16x32_bf16 v[44:47], a[204:207], v[76:79], v[44:47]
    v_mfma_f32_16x16x32_bf16 v[48:51], v[72:75], v[200:203], v[48:51]
    v_mfma_f32_16x16x32_bf16 v[56:59], v[76:79], v[200:203], v[56:59]
    v_mfma_f32_16x16x32_bf16 v[52:55], v[72:75], v[204:207], v[52:55]
    v_mfma_f32_16x16x32_bf16 v[60:63], v[76:79], v[204:207], v[60:63]
    v_mfma_f32_16x16x32_bf16 v[16:19], a[72:75], v[72:75], v[16:19]
    v_mfma_f32_16x16x32_bf16 v[20:23], a[72:75], v[76:79], v[20:23]
    v_mfma_f32_16x16x32_bf16 v[24:27], a[76:79], v[72:75], v[24:27]
    v_mfma_f32_16x16x32_bf16 v[28:31], a[76:79], v[76:79], v[28:31]
    ds_read_b128 v[72:75], v82 offset:11264
    ds_read_b128 v[76:79], v83 offset:11264
    s_waitcnt lgkmcnt(2)
    v_mfma_f32_16x16x32_bf16 v[32:35], a[208:211], v[64:67], v[32:35]
    v_mfma_f32_16x16x32_bf16 v[36:39], a[208:211], v[68:71], v[36:39]
    v_mfma_f32_16x16x32_bf16 v[40:43], a[212:215], v[64:67], v[40:43]
    v_mfma_f32_16x16x32_bf16 v[44:47], a[212:215], v[68:71], v[44:47]
    v_mfma_f32_16x16x32_bf16 v[48:51], v[64:67], v[208:211], v[48:51]
    v_mfma_f32_16x16x32_bf16 v[56:59], v[68:71], v[208:211], v[56:59]
    v_mfma_f32_16x16x32_bf16 v[52:55], v[64:67], v[212:215], v[52:55]
    v_mfma_f32_16x16x32_bf16 v[60:63], v[68:71], v[212:215], v[60:63]
    v_mfma_f32_16x16x32_bf16 v[16:19], a[80:83], v[64:67], v[16:19]
    v_mfma_f32_16x16x32_bf16 v[20:23], a[80:83], v[68:71], v[20:23]
    v_mfma_f32_16x16x32_bf16 v[24:27], a[84:87], v[64:67], v[24:27]
    v_mfma_f32_16x16x32_bf16 v[28:31], a[84:87], v[68:71], v[28:31]
    ds_read_b128 v[64:67], v80 offset:12288
    ds_read_b128 v[68:71], v81 offset:12288
    s_waitcnt lgkmcnt(2)
    v_mfma_f32_16x16x32_bf16 v[32:35], a[216:219], v[72:75], v[32:35]
    v_mfma_f32_16x16x32_bf16 v[36:39], a[216:219], v[76:79], v[36:39]
    v_mfma_f32_16x16x32_bf16 v[40:43], a[220:223], v[72:75], v[40:43]
    v_mfma_f32_16x16x32_bf16 v[44:47], a[220:223], v[76:79], v[44:47]
    v_mfma_f32_16x16x32_bf16 v[48:51], v[72:75], v[216:219], v[48:51]
    v_mfma_f32_16x16x32_bf16 v[56:59], v[76:79], v[216:219], v[56:59]
    v_mfma_f32_16x16x32_bf16 v[52:55], v[72:75], v[220:223], v[52:55]
    v_mfma_f32_16x16x32_bf16 v[60:63], v[76:79], v[220:223], v[60:63]
    v_mfma_f32_16x16x32_bf16 v[16:19], a[88:91], v[72:75], v[16:19]
    v_mfma_f32_16x16x32_bf16 v[20:23], a[88:91], v[76:79], v[20:23]
    v_mfma_f32_16x16x32_bf16 v[24:27], a[92:95], v[72:75], v[24:27]
    v_mfma_f32_16x16x32_bf16 v[28:31], a[92:95], v[76:79], v[28:31]
    ds_read_b128 v[72:75], v82 offset:13312
    ds_read_b128 v[76:79], v83 offset:13312
    s_waitcnt lgkmcnt(2)
    v_mfma_f32_16x16x32_bf16 v[32:35], a[224:227], v[64:67], v[32:35]
    v_mfma_f32_16x16x32_bf16 v[36:39], a[224:227], v[68:71], v[36:39]
    v_mfma_f32_16x16x32_bf16 v[40:43], a[228:231], v[64:67], v[40:43]
    v_mfma_f32_16x16x32_bf16 v[44:47], a[228:231], v[68:71], v[44:47]
    v_mfma_f32_16x16x32_bf16 v[48:51], v[64:67], v[224:227], v[48:51]
    v_mfma_f32_16x16x32_bf16 v[56:59], v[68:71], v[224:227], v[56:59]
    v_mfma_f32_16x16x32_bf16 v[52:55], v[64:67], v[228:231], v[52:55]
    v_mfma_f32_16x16x32_bf16 v[60:63], v[68:71], v[228:231], v[60:63]
    v_mfma_f32_16x16x32_bf16 v[16:19], a[96:99], v[64:67], v[16:19]
    v_mfma_f32_16x16x32_bf16 v[20:23], a[96:99], v[68:71], v[20:23]
    v_mfma_f32_16x16x32_bf16 v[24:27], a[100:103], v[64:67], v[24:27]
    v_mfma_f32_16x16x32_bf16 v[28:31], a[100:103], v[68:71], v[28:31]
    ds_read_b128 v[64:67], v80 offset:14336
    ds_read_b128 v[68:71], v81 offset:14336
    s_waitcnt lgkmcnt(2)
    v_mfma_f32_16x16x32_bf16 v[32:35], a[232:235], v[72:75], v[32:35]
    v_mfma_f32_16x16x32_bf16 v[36:39], a[232:235], v[76:79], v[36:39]
    v_mfma_f32_16x16x32_bf16 v[40:43], a[236:239], v[72:75], v[40:43]
    v_mfma_f32_16x16x32_bf16 v[44:47], a[236:239], v[76:79], v[44:47]
    v_mfma_f32_16x16x32_bf16 v[48:51], v[72:75], v[232:235], v[48:51]
    v_mfma_f32_16x16x32_bf16 v[56:59], v[76:79], v[232:235], v[56:59]
    v_mfma_f32_16x16x32_bf16 v[52:55], v[72:75], v[236:239], v[52:55]
    v_mfma_f32_16x16x32_bf16 v[60:63], v[76:79], v[236:239], v[60:63]
    v_mfma_f32_16x16x32_bf16 v[16:19], a[104:107], v[72:75], v[16:19]
    v_mfma_f32_16x16x32_bf16 v[20:23], a[104:107], v[76:79], v[20:23]
    v_mfma_f32_16x16x32_bf16 v[24:27], a[108:111], v[72:75], v[24:27]
    v_mfma_f32_16x16x32_bf16 v[28:31], a[108:111], v[76:79], v[28:31]
    ds_read_b128 v[72:75], v82 offset:15360
    ds_read_b128 v[76:79], v83 offset:15360
    s_waitcnt lgkmcnt(2)
    v_mfma_f32_16x16x32_bf16 v[32:35], a[240:243], v[64:67], v[32:35]
    v_mfma_f32_16x16x32_bf16 v[36:39], a[240:243], v[68:71], v[36:39]
    v_mfma_f32_16x16x32_bf16 v[40:43], a[244:247], v[64:67], v[40:43]
    v_mfma_f32_16x16x32_bf16 v[44:47], a[244:247], v[68:71], v[44:47]
    v_mfma_f32_16x16x32_bf16 v[48:51], v[64:67], v[240:243], v[48:51]
    v_mfma_f32_16x16x32_bf16 v[56:59], v[68:71], v[240:243], v[56:59]
    v_mfma_f32_16x16x32_bf16 v[52:55], v[64:67], v[244:247], v[52:55]
    v_mfma_f32_16x16x32_bf16 v[60:63], v[68:71], v[244:247], v[60:63]
    v_mfma_f32_16x16x32_bf16 v[16:19], a[112:115], v[64:67], v[16:19]
    v_mfma_f32_16x16x32_bf16 v[20:23], a[112:115], v[68:71], v[20:23]
    v_mfma_f32_16x16x32_bf16 v[24:27], a[116:119], v[64:67], v[24:27]
    v_mfma_f32_16x16x32_bf16 v[28:31], a[116:119], v[68:71], v[28:31]
    s_waitcnt lgkmcnt(0)
    v_mfma_f32_16x16x32_bf16 v[32:35], a[248:251], v[72:75], v[32:35]
    v_mfma_f32_16x16x32_bf16 v[36:39], a[248:251], v[76:79], v[36:39]
    v_mfma_f32_16x16x32_bf16 v[40:43], a[252:255], v[72:75], v[40:43]
    v_mfma_f32_16x16x32_bf16 v[44:47], a[252:255], v[76:79], v[44:47]
    v_mfma_f32_16x16x32_bf16 v[48:51], v[72:75], v[248:251], v[48:51]
    v_mfma_f32_16x16x32_bf16 v[56:59], v[76:79], v[248:251], v[56:59]
    v_mfma_f32_16x16x32_bf16 v[52:55], v[72:75], v[252:255], v[52:55]
    v_mfma_f32_16x16x32_bf16 v[60:63], v[76:79], v[252:255], v[60:63]
    v_mfma_f32_16x16x32_bf16 v[16:19], a[120:123], v[72:75], v[16:19]
    v_mfma_f32_16x16x32_bf16 v[20:23], a[120:123], v[76:79], v[20:23]
    v_mfma_f32_16x16x32_bf16 v[24:27], a[124:127], v[72:75], v[24:27]
    v_mfma_f32_16x16x32_bf16 v[28:31], a[124:127], v[76:79], v[28:31]
    v_xor_b32 v80, 0x8000, v80
    v_xor_b32 v81, 0x8000, v81
    v_xor_b32 v82, 0x8000, v82
    v_xor_b32 v83, 0x8000, v83
    v_cvt_pk_bf16_f32 v88, v32, v40
    v_cvt_pk_bf16_f32 v89, v33, v41
    v_cvt_pk_bf16_f32 v90, v34, v42
    v_cvt_pk_bf16_f32 v91, v35, v43
    v_cvt_pk_bf16_f32 v92, v36, v44
    v_cvt_pk_bf16_f32 v93, v37, v45
    v_cvt_pk_bf16_f32 v94, v38, v46
    v_cvt_pk_bf16_f32 v95, v39, v47
    v_cvt_pk_bf16_f32 v96, v48, v49
    v_cvt_pk_bf16_f32 v97, v50, v51
    v_cvt_pk_bf16_f32 v98, v56, v57
    v_cvt_pk_bf16_f32 v99, v58, v59
    v_cvt_pk_bf16_f32 v100, v52, v53
    v_cvt_pk_bf16_f32 v101, v54, v55
    v_cvt_pk_bf16_f32 v102, v60, v61
    v_cvt_pk_bf16_f32 v103, v62, v63
    v_cvt_pk_bf16_f32 v104, v16, v24
    v_cvt_pk_bf16_f32 v105, v17, v25
    v_cvt_pk_bf16_f32 v106, v18, v26
    v_cvt_pk_bf16_f32 v107, v19, v27
    v_cvt_pk_bf16_f32 v108, v20, v28
    v_cvt_pk_bf16_f32 v109, v21, v29
    v_cvt_pk_bf16_f32 v110, v22, v30
    v_cvt_pk_bf16_f32 v111, v23, v31
    s_mul_i32 s24, s23, 0x82100
    s_lshl_b32 s36, s20, 14
    s_add_u32 s24, s24, s36
    s_add_u32 s24, s24, 0x1000000
    s_mov_b32 s30, s24
    s_lshr_b32 s36, s21, 1
    s_lshl_b32 s36, s36, 12
    s_xor_b32 s37, s36, 4096
    s_add_u32 s36, s36, s24
    s_add_u32 s37, s37, s24
    buffer_store_dwordx4 v[88:91], v9, s[8:11], s36 offen sc1
    buffer_store_dwordx4 v[92:95], v9, s[8:11], s37 offen sc1
    s_add_u32 s24, s24, 8192
    buffer_store_dwordx4 v[96:99], v2, s[8:11], s24 offen sc1
    buffer_store_dwordx4 v[100:103], v2, s[8:11], s24 offen offset:1024 sc1
    s_add_u32 s36, s36, 0x7000000
    s_add_u32 s37, s37, 0x7000000
    buffer_store_dwordx4 v[104:107], v9, s[8:11], s36 offen sc1
    buffer_store_dwordx4 v[108:111], v9, s[8:11], s37 offen sc1
    s_mul_i32 s25, s23, 0x82100
    s_lshl_b32 s36, s20, 2
    s_add_u32 s25, s25, s36
    s_add_u32 s25, s25, 0x1082000
    s_add_u32 s23, s23, 6
    s_cmp_lt_u32 s23, 64
    s_cbranch_scc1 L_P1
    v_mov_b32 v20, -1
    v_mov_b32 v21, -1
    v_mov_b32 v22, -1
    v_mov_b32 v23, -1
    s_lshl_b32 s24, s22, 21
    s_lshl_b32 s36, s20, 15
    s_add_u32 s24, s24, s36
    s_add_u32 s36, s24, 0x4000000
    buffer_store_dwordx4 v[20:23], v11, s[8:11], s36 offen sc1
    s_add_u32 s36, s24, 0x4001000
    buffer_store_dwordx4 v[20:23], v11, s[8:11], s36 offen sc1
    s_add_u32 s36, s24, 0x4002000
    buffer_store_dwordx4 v[20:23], v11, s[8:11], s36 offen sc1
    s_add_u32 s36, s24, 0x4003000
    buffer_store_dwordx4 v[20:23], v11, s[8:11], s36 offen sc1
    s_add_u32 s36, s24, 0x4004000
    buffer_store_dwordx4 v[20:23], v11, s[8:11], s36 offen sc1
    s_add_u32 s36, s24, 0x4005000
    buffer_store_dwordx4 v[20:23], v11, s[8:11], s36 offen sc1
    s_add_u32 s36, s24, 0x4006000
    buffer_store_dwordx4 v[20:23], v11, s[8:11], s36 offen sc1
    s_add_u32 s36, s24, 0x4007000
    buffer_store_dwordx4 v[20:23], v11, s[8:11], s36 offen sc1
    s_add_u32 s36, s24, 0x4100000
    buffer_store_dwordx4 v[20:23], v11, s[8:11], s36 offen sc1
    s_add_u32 s36, s24, 0x4101000
    buffer_store_dwordx4 v[20:23], v11, s[8:11], s36 offen sc1
    s_add_u32 s36, s24, 0x4102000
    buffer_store_dwordx4 v[20:23], v11, s[8:11], s36 offen sc1
    s_add_u32 s36, s24, 0x4103000
    buffer_store_dwordx4 v[20:23], v11, s[8:11], s36 offen sc1
    s_add_u32 s36, s24, 0x4104000
    buffer_store_dwordx4 v[20:23], v11, s[8:11], s36 offen sc1
    s_add_u32 s36, s24, 0x4105000
    buffer_store_dwordx4 v[20:23], v11, s[8:11], s36 offen sc1
    s_add_u32 s36, s24, 0x4106000
    buffer_store_dwordx4 v[20:23], v11, s[8:11], s36 offen sc1
    s_add_u32 s36, s24, 0x4107000
    buffer_store_dwordx4 v[20:23], v11, s[8:11], s36 offen sc1
    s_waitcnt vmcnt(0)
    s_barrier
    v_cmp_ne_u32 vcc, 0, v0
    v_mov_b32 v15, 0x40000000
    v_mov_b32 v14, 1
    v_cndmask_b32 v15, v0, v15, vcc
    buffer_store_dword v14, v15, s[8:11], s25 offen sc1
    s_lshl_b32 s25, s22, 7
    s_lshl_b32 s36, s20, 2
    s_add_u32 s36, s36, s25
    s_add_u32 s36, s36, 0x192000
    v_cmp_ne_u32 vcc, 0, v0
    v_mov_b32 v15, 0x40000000
    v_mov_b32 v14, 1
    v_cndmask_b32 v15, v0, v15, vcc
    buffer_store_dword v14, v15, s[8:11], s36 offen sc1
    s_mov_b32 s96, s54
    s_and_b32 s97, s55, 0xffff
    s_mov_b32 s98, 0x400000
    s_mov_b32 s99, 0x20000
    v_mov_b32 v15, 0x0
    v_bfe_u32 v14, v0, 0, 1
    s_mov_b32 s38, 0x10
    v_mad_u32_u24 v15, v14, s38, v15
    v_bfe_u32 v14, v0, 1, 1
    s_mov_b32 s38, 0x20
    v_mad_u32_u24 v15, v14, s38, v15
    v_bfe_u32 v14, v0, 2, 1
    s_mov_b32 s38, 0x40
    v_mad_u32_u24 v15, v14, s38, v15
    v_bfe_u32 v14, v0, 3, 1
    s_mov_b32 s38, 0x80
    v_mad_u32_u24 v15, v14, s38, v15
    v_bfe_u32 v14, v0, 4, 1
    s_mov_b32 s38, 0x1000
    v_mad_u32_u24 v15, v14, s38, v15
    v_bfe_u32 v14, v0, 5, 1
    s_mov_b32 s38, 0x2000
    v_mad_u32_u24 v15, v14, s38, v15
    v_bfe_u32 v14, v0, 6, 1
    s_mov_b32 s38, 0x100
    v_mad_u32_u24 v15, v14, s38, v15
    v_bfe_u32 v14, v0, 7, 1
    s_mov_b32 s38, 0x200
    v_mad_u32_u24 v15, v14, s38, v15
    s_lshl_b32 s36, s20, 17
    s_add_u32 s37, s36, 0x0
    buffer_load_dwordx4 v[16:19], v15, s[96:99], s37 offen
    s_add_u32 s37, s36, 0x4000
    buffer_load_dwordx4 v[20:23], v15, s[96:99], s37 offen
    s_add_u32 s37, s36, 0x400
    buffer_load_dwordx4 v[24:27], v15, s[96:99], s37 offen
    s_add_u32 s37, s36, 0x4400
    buffer_load_dwordx4 v[28:31], v15, s[96:99], s37 offen
    s_add_u32 s37, s36, 0x800
    buffer_load_dwordx4 v[32:35], v15, s[96:99], s37 offen
    s_add_u32 s37, s36, 0x4800
    buffer_load_dwordx4 v[36:39], v15, s[96:99], s37 offen
    s_add_u32 s37, s36, 0xc00
    buffer_load_dwordx4 v[40:43], v15, s[96:99], s37 offen
    s_add_u32 s37, s36, 0x4c00
    buffer_load_dwordx4 v[44:47], v15, s[96:99], s37 offen
    s_add_u32 s37, s36, 0x8000
    buffer_load_dwordx4 v[48:51], v15, s[96:99], s37 offen
    s_add_u32 s37, s36, 0xc000
    buffer_load_dwordx4 v[52:55], v15, s[96:99], s37 offen
    s_add_u32 s37, s36, 0x8400
    buffer_load_dwordx4 v[56:59], v15, s[96:99], s37 offen
    s_add_u32 s37, s36, 0xc400
    buffer_load_dwordx4 v[60:63], v15, s[96:99], s37 offen
    s_add_u32 s37, s36, 0x8800
    buffer_load_dwordx4 v[64:67], v15, s[96:99], s37 offen
    s_add_u32 s37, s36, 0xc800
    buffer_load_dwordx4 v[68:71], v15, s[96:99], s37 offen
    s_add_u32 s37, s36, 0x8c00
    buffer_load_dwordx4 v[72:75], v15, s[96:99], s37 offen
    s_add_u32 s37, s36, 0xcc00
    buffer_load_dwordx4 v[76:79], v15, s[96:99], s37 offen
    s_add_u32 s37, s36, 0x10000
    buffer_load_dwordx4 v[80:83], v15, s[96:99], s37 offen
    s_add_u32 s37, s36, 0x14000
    buffer_load_dwordx4 v[84:87], v15, s[96:99], s37 offen
    s_add_u32 s37, s36, 0x10400
    buffer_load_dwordx4 v[88:91], v15, s[96:99], s37 offen
    s_add_u32 s37, s36, 0x14400
    buffer_load_dwordx4 v[92:95], v15, s[96:99], s37 offen
    s_add_u32 s37, s36, 0x10800
    buffer_load_dwordx4 v[96:99], v15, s[96:99], s37 offen
    s_add_u32 s37, s36, 0x14800
    buffer_load_dwordx4 v[100:103], v15, s[96:99], s37 offen
    s_add_u32 s37, s36, 0x10c00
    buffer_load_dwordx4 v[104:107], v15, s[96:99], s37 offen
    s_add_u32 s37, s36, 0x14c00
    buffer_load_dwordx4 v[108:111], v15, s[96:99], s37 offen
    s_waitcnt vmcnt(16)
    v_perm_b32 v112, v20, v16, s34
    v_perm_b32 v113, v28, v24, s34
    v_perm_b32 v114, v36, v32, s34
    v_perm_b32 v115, v44, v40, s34
    ds_write_b128 v7, v[112:115] offset:0
    v_perm_b32 v116, v20, v16, s35
    v_perm_b32 v117, v28, v24, s35
    v_perm_b32 v118, v36, v32, s35
    v_perm_b32 v119, v44, v40, s35
    ds_write_b128 v7, v[116:119] offset:1024
    v_perm_b32 v120, v21, v17, s34
    v_perm_b32 v121, v29, v25, s34
    v_perm_b32 v122, v37, v33, s34
    v_perm_b32 v123, v45, v41, s34
    ds_write_b128 v7, v[120:123] offset:2048
    v_perm_b32 v124, v21, v17, s35
    v_perm_b32 v125, v29, v25, s35
    v_perm_b32 v126, v37, v33, s35
    v_perm_b32 v127, v45, v41, s35
    ds_write_b128 v7, v[124:127] offset:3072
    s_waitcnt lgkmcnt(0)
    v_perm_b32 v112, v22, v18, s34
    v_perm_b32 v113, v30, v26, s34
    v_perm_b32 v114, v38, v34, s34
    v_perm_b32 v115, v46, v42, s34
    ds_write_b128 v7, v[112:115] offset:4096
    v_perm_b32 v116, v22, v18, s35
    v_perm_b32 v117, v30, v26, s35
    v_perm_b32 v118, v38, v34, s35
    v_perm_b32 v119, v46, v42, s35
    ds_write_b128 v7, v[116:119] offset:5120
    v_perm_b32 v120, v23, v19, s34
    v_perm_b32 v121, v31, v27, s34
    v_perm_b32 v122, v39, v35, s34
    v_perm_b32 v123, v47, v43, s34
    ds_write_b128 v7, v[120:123] offset:6144
    v_perm_b32 v124, v23, v19, s35
    v_perm_b32 v125, v31, v27, s35
    v_perm_b32 v126, v39, v35, s35
    v_perm_b32 v127, v47, v43, s35
    ds_write_b128 v7, v[124:127] offset:7168
    s_waitcnt lgkmcnt(0)
    s_add_u32 s37, s36, 0x18000
    buffer_load_dwordx4 v[16:19], v15, s[96:99], s37 offen
    s_add_u32 s37, s36, 0x1c000
    buffer_load_dwordx4 v[20:23], v15, s[96:99], s37 offen
    s_add_u32 s37, s36, 0x18400
    buffer_load_dwordx4 v[24:27], v15, s[96:99], s37 offen
    s_add_u32 s37, s36, 0x1c400
    buffer_load_dwordx4 v[28:31], v15, s[96:99], s37 offen
    s_add_u32 s37, s36, 0x18800
    buffer_load_dwordx4 v[32:35], v15, s[96:99], s37 offen
    s_add_u32 s37, s36, 0x1c800
    buffer_load_dwordx4 v[36:39], v15, s[96:99], s37 offen
    s_add_u32 s37, s36, 0x18c00
    buffer_load_dwordx4 v[40:43], v15, s[96:99], s37 offen
    s_add_u32 s37, s36, 0x1cc00
    buffer_load_dwordx4 v[44:47], v15, s[96:99], s37 offen
    s_waitcnt vmcnt(16)
    v_perm_b32 v112, v52, v48, s34
    v_perm_b32 v113, v60, v56, s34
    v_perm_b32 v114, v68, v64, s34
    v_perm_b32 v115, v76, v72, s34
    ds_write_b128 v7, v[112:115] offset:8192
    v_perm_b32 v116, v52, v48, s35
    v_perm_b32 v117, v60, v56, s35
    v_perm_b32 v118, v68, v64, s35
    v_perm_b32 v119, v76, v72, s35
    ds_write_b128 v7, v[116:119] offset:9216
    v_perm_b32 v120, v53, v49, s34
    v_perm_b32 v121, v61, v57, s34
    v_perm_b32 v122, v69, v65, s34
    v_perm_b32 v123, v77, v73, s34
    ds_write_b128 v7, v[120:123] offset:10240
    v_perm_b32 v124, v53, v49, s35
    v_perm_b32 v125, v61, v57, s35
    v_perm_b32 v126, v69, v65, s35
    v_perm_b32 v127, v77, v73, s35
    ds_write_b128 v7, v[124:127] offset:11264
    s_waitcnt lgkmcnt(0)
    v_perm_b32 v112, v54, v50, s34
    v_perm_b32 v113, v62, v58, s34
    v_perm_b32 v114, v70, v66, s34
    v_perm_b32 v115, v78, v74, s34
    ds_write_b128 v7, v[112:115] offset:12288
    v_perm_b32 v116, v54, v50, s35
    v_perm_b32 v117, v62, v58, s35
    v_perm_b32 v118, v70, v66, s35
    v_perm_b32 v119, v78, v74, s35
    ds_write_b128 v7, v[116:119] offset:13312
    v_perm_b32 v120, v55, v51, s34
    v_perm_b32 v121, v63, v59, s34
    v_perm_b32 v122, v71, v67, s34
    v_perm_b32 v123, v79, v75, s34
    ds_write_b128 v7, v[120:123] offset:14336
    v_perm_b32 v124, v55, v51, s35
    v_perm_b32 v125, v63, v59, s35
    v_perm_b32 v126, v71, v67, s35
    v_perm_b32 v127, v79, v75, s35
    ds_write_b128 v7, v[124:127] offset:15360
    s_waitcnt lgkmcnt(0)
    s_waitcnt vmcnt(8)
    v_perm_b32 v112, v84, v80, s34
    v_perm_b32 v113, v92, v88, s34
    v_perm_b32 v114, v100, v96, s34
    v_perm_b32 v115, v108, v104, s34
    ds_write_b128 v7, v[112:115] offset:16384
    v_perm_b32 v116, v84, v80, s35
    v_perm_b32 v117, v92, v88, s35
    v_perm_b32 v118, v100, v96, s35
    v_perm_b32 v119, v108, v104, s35
    ds_write_b128 v7, v[116:119] offset:17408
    v_perm_b32 v120, v85, v81, s34
    v_perm_b32 v121, v93, v89, s34
    v_perm_b32 v122, v101, v97, s34
    v_perm_b32 v123, v109, v105, s34
    ds_write_b128 v7, v[120:123] offset:18432
    v_perm_b32 v124, v85, v81, s35
    v_perm_b32 v125, v93, v89, s35
    v_perm_b32 v126, v101, v97, s35
    v_perm_b32 v127, v109, v105, s35
    ds_write_b128 v7, v[124:127] offset:19456
    s_waitcnt lgkmcnt(0)
    v_perm_b32 v112, v86, v82, s34
    v_perm_b32 v113, v94, v90, s34
    v_perm_b32 v114, v102, v98, s34
    v_perm_b32 v115, v110, v106, s34
    ds_write_b128 v7, v[112:115] offset:20480
    v_perm_b32 v116, v86, v82, s35
    v_perm_b32 v117, v94, v90, s35
    v_perm_b32 v118, v102, v98, s35
    v_perm_b32 v119, v110, v106, s35
    ds_write_b128 v7, v[116:119] offset:21504
    v_perm_b32 v120, v87, v83, s34
    v_perm_b32 v121, v95, v91, s34
    v_perm_b32 v122, v103, v99, s34
    v_perm_b32 v123, v111, v107, s34
    ds_write_b128 v7, v[120:123] offset:22528
    v_perm_b32 v124, v87, v83, s35
    v_perm_b32 v125, v95, v91, s35
    v_perm_b32 v126, v103, v99, s35
    v_perm_b32 v127, v111, v107, s35
    ds_write_b128 v7, v[124:127] offset:23552
    s_waitcnt lgkmcnt(0)
    s_waitcnt vmcnt(0)
    v_perm_b32 v112, v20, v16, s34
    v_perm_b32 v113, v28, v24, s34
    v_perm_b32 v114, v36, v32, s34
    v_perm_b32 v115, v44, v40, s34
    ds_write_b128 v7, v[112:115] offset:24576
    v_perm_b32 v116, v20, v16, s35
    v_perm_b32 v117, v28, v24, s35
    v_perm_b32 v118, v36, v32, s35
    v_perm_b32 v119, v44, v40, s35
    ds_write_b128 v7, v[116:119] offset:25600
    v_perm_b32 v120, v21, v17, s34
    v_perm_b32 v121, v29, v25, s34
    v_perm_b32 v122, v37, v33, s34
    v_perm_b32 v123, v45, v41, s34
    ds_write_b128 v7, v[120:123] offset:26624
    v_perm_b32 v124, v21, v17, s35
    v_perm_b32 v125, v29, v25, s35
    v_perm_b32 v126, v37, v33, s35
    v_perm_b32 v127, v45, v41, s35
    ds_write_b128 v7, v[124:127] offset:27648
    s_waitcnt lgkmcnt(0)
    v_perm_b32 v112, v22, v18, s34
    v_perm_b32 v113, v30, v26, s34
    v_perm_b32 v114, v38, v34, s34
    v_perm_b32 v115, v46, v42, s34
    ds_write_b128 v7, v[112:115] offset:28672
    v_perm_b32 v116, v22, v18, s35
    v_perm_b32 v117, v30, v26, s35
    v_perm_b32 v118, v38, v34, s35
    v_perm_b32 v119, v46, v42, s35
    ds_write_b128 v7, v[116:119] offset:29696
    v_perm_b32 v120, v23, v19, s34
    v_perm_b32 v121, v31, v27, s34
    v_perm_b32 v122, v39, v35, s34
    v_perm_b32 v123, v47, v43, s34
    ds_write_b128 v7, v[120:123] offset:30720
    v_perm_b32 v124, v23, v19, s35
    v_perm_b32 v125, v31, v27, s35
    v_perm_b32 v126, v39, v35, s35
    v_perm_b32 v127, v47, v43, s35
    ds_write_b128 v7, v[124:127] offset:31744
    s_waitcnt lgkmcnt(0)
    s_lshl_b32 s25, s22, 7
    s_add_u32 s25, s25, 0x192000
    v_lshrrev_b32 v15, 2, v1
    v_and_b32 v15, 127, v15
L_TPI:
    buffer_load_dword v14, v15, s[8:11], s25 offen sc1
    s_add_u32 s32, s32, 1
    s_cmp_gt_u32 s32, 200000
    s_waitcnt vmcnt(0)
    s_cbranch_scc1 L_TPI_ok
    v_cmp_eq_u32 vcc, 0, v14
    s_cbranch_vccz L_TPI_ok
    s_sleep 8
    s_branch L_TPI
L_TPI_ok:
    s_mov_b32 s23, s22
    s_mov_b32 s29, 0
    s_mov_b32 s30, 0x40000000
    s_mov_b32 s42, 0x3db504f3
    s_mov_b32 s43, 0x3fb8aa3b
    s_mul_i32 s24, s23, 0x82100
    s_lshl_b32 s36, s20, 14
    s_add_u32 s24, s24, s36
    s_add_u32 s24, s24, 0x1000000
    s_add_u32 s36, s24, 0
    s_add_u32 s37, s36, 0x7000000
    buffer_load_dwordx4 a[32:35], v1, s[8:11], s36 offen offset:0 sc1
    buffer_load_dwordx4 a[0:3], v1, s[8:11], s37 offen offset:0 sc1
    buffer_load_dwordx4 a[36:39], v1, s[8:11], s36 offen offset:1024 sc1
    buffer_load_dwordx4 a[4:7], v1, s[8:11], s37 offen offset:1024 sc1
    buffer_load_dwordx4 a[40:43], v1, s[8:11], s36 offen offset:2048 sc1
    buffer_load_dwordx4 a[8:11], v1, s[8:11], s37 offen offset:2048 sc1
    buffer_load_dwordx4 a[44:47], v1, s[8:11], s36 offen offset:3072 sc1
    buffer_load_dwordx4 a[12:15], v1, s[8:11], s37 offen offset:3072 sc1
    s_add_u32 s36, s24, 4096
    s_add_u32 s37, s36, 0x7000000
    buffer_load_dwordx4 a[48:51], v1, s[8:11], s36 offen offset:0 sc1
    buffer_load_dwordx4 a[16:19], v1, s[8:11], s37 offen offset:0 sc1
    buffer_load_dwordx4 a[52:55], v1, s[8:11], s36 offen offset:1024 sc1
    buffer_load_dwordx4 a[20:23], v1, s[8:11], s37 offen offset:1024 sc1
    buffer_load_dwordx4 a[56:59], v1, s[8:11], s36 offen offset:2048 sc1
    buffer_load_dwordx4 a[24:27], v1, s[8:11], s37 offen offset:2048 sc1
    buffer_load_dwordx4 a[60:63], v1, s[8:11], s36 offen offset:3072 sc1
    buffer_load_dwordx4 a[28:31], v1, s[8:11], s37 offen offset:3072 sc1
    s_lshr_b32 s36, s21, 1
    s_lshl_b32 s36, s36, 3
    s_xor_b32 s37, s36, 8
    s_add_u32 s24, s24, 8192
    s_add_u32 s36, s36, s24
    s_add_u32 s37, s37, s24
    buffer_load_dwordx2 a[64:65], v2, s[8:11], s36 offen offset:0 sc1
    buffer_load_dwordx2 a[66:67], v2, s[8:11], s37 offen offset:0 sc1
    buffer_load_dwordx2 a[68:69], v2, s[8:11], s36 offen offset:1024 sc1
    buffer_load_dwordx2 a[70:71], v2, s[8:11], s37 offen offset:1024 sc1
L_P2:
    s_and_b32 s36, s29, 1
    s_lshl_b32 s36, s36, 20
    s_lshl_b32 s26, s22, 21
    s_add_u32 s26, s26, s36
    s_add_u32 s26, s26, 0x4000000
    s_bfe_u32 s27, s29, 0x10001
    s_lshl_b32 s24, s23, 13
    s_add_u32 s24, s24, 0x100000
    s_max_u32 s25, s23, 1
    s_lshl_b32 s25, s25, 13
    s_add_u32 s25, s25, 0xfe000
    buffer_load_dwordx4 v[48:51], v2, s[8:11], s24 offen sc1
    buffer_load_dwordx4 v[52:55], v2, s[8:11], s24 offen offset:1024 sc1
    s_lshl_b32 s36, s23, 5
    s_add_u32 s36, s36, s20
    s_lshl_b32 s36, s36, 10
    buffer_load_dword a72, v12, s[12:15], s36 offen
    buffer_load_dword a73, v12, s[92:95], 0 offen
    s_waitcnt vmcnt(4)
    v_cmp_ne_u32 vcc, 0, v1
    v_mov_b32 v15, 0x40000000
    v_mov_b32 v14, 0
    v_cndmask_b32 v15, v1, v15, vcc
    buffer_store_dword v14, v15, s[8:11], s30 offen sc1
    v_mfma_f32_16x16x32_bf16 v[80:83], a[32:35], a[0:3], 0
    v_mfma_f32_16x16x32_bf16 v[80:83], a[36:39], a[4:7], v[80:83]
    v_mfma_f32_16x16x32_bf16 v[80:83], a[40:43], a[8:11], v[80:83]
    v_mfma_f32_16x16x32_bf16 v[80:83], a[44:47], a[12:15], v[80:83]
    v_mfma_f32_16x16x32_bf16 v[88:91], a[48:51], a[16:19], 0
    v_mfma_f32_16x16x32_bf16 v[88:91], a[52:55], a[20:23], v[88:91]
    v_mfma_f32_16x16x32_bf16 v[88:91], a[56:59], a[24:27], v[88:91]
    v_mfma_f32_16x16x32_bf16 v[88:91], a[60:63], a[28:31], v[88:91]
    v_mfma_f32_16x16x32_bf16 v[84:87], a[32:35], a[16:19], 0
    v_mfma_f32_16x16x32_bf16 v[84:87], a[36:39], a[20:23], v[84:87]
    v_mfma_f32_16x16x32_bf16 v[84:87], a[40:43], a[24:27], v[84:87]
    v_mfma_f32_16x16x32_bf16 v[84:87], a[44:47], a[28:31], v[84:87]
    v_cvt_pk_bf16_f32 v81, v80, v81
    v_lshlrev_b32 v80, 16, v81
    v_and_b32 v81, 0xffff0000, v81
    v_mul_f32 v80, s42, v80
    v_mul_f32 v81, s42, v81
    v_cvt_pk_bf16_f32 v81, v80, v81
    v_lshlrev_b32 v80, 16, v81
    v_and_b32 v81, 0xffff0000, v81
    v_cvt_pk_bf16_f32 v83, v82, v83
    v_lshlrev_b32 v82, 16, v83
    v_and_b32 v83, 0xffff0000, v83
    v_mul_f32 v82, s42, v82
    v_mul_f32 v83, s42, v83
    v_cvt_pk_bf16_f32 v83, v82, v83
    v_lshlrev_b32 v82, 16, v83
    v_and_b32 v83, 0xffff0000, v83
    v_cvt_pk_bf16_f32 v89, v88, v89
    v_lshlrev_b32 v88, 16, v89
    v_and_b32 v89, 0xffff0000, v89
    v_mul_f32 v88, s42, v88
    v_mul_f32 v89, s42, v89
    v_cvt_pk_bf16_f32 v89, v88, v89
    v_lshlrev_b32 v88, 16, v89
    v_and_b32 v89, 0xffff0000, v89
    v_cvt_pk_bf16_f32 v91, v90, v91
    v_lshlrev_b32 v90, 16, v91
    v_and_b32 v91, 0xffff0000, v91
    v_mul_f32 v90, s42, v90
    v_mul_f32 v91, s42, v91
    v_cvt_pk_bf16_f32 v91, v90, v91
    v_lshlrev_b32 v90, 16, v91
    v_and_b32 v91, 0xffff0000, v91
    v_cvt_pk_bf16_f32 v85, v84, v85
    v_lshlrev_b32 v84, 16, v85
    v_and_b32 v85, 0xffff0000, v85
    v_mul_f32 v84, s42, v84
    v_mul_f32 v85, s42, v85
    v_cvt_pk_bf16_f32 v85, v84, v85
    v_lshlrev_b32 v84, 16, v85
    v_and_b32 v85, 0xffff0000, v85
    v_cvt_pk_bf16_f32 v87, v86, v87
    v_lshlrev_b32 v86, 16, v87
    v_and_b32 v87, 0xffff0000, v87
    v_mul_f32 v86, s42, v86
    v_mul_f32 v87, s42, v87
    v_cvt_pk_bf16_f32 v87, v86, v87
    v_lshlrev_b32 v86, 16, v87
    v_and_b32 v87, 0xffff0000, v87
    v_cndmask_b32 v80, v13, v80, s[64:65]
    v_cndmask_b32 v81, v13, v81, s[66:67]
    v_cndmask_b32 v82, v13, v82, s[68:69]
    v_cndmask_b32 v83, v13, v83, s[70:71]
    v_cndmask_b32 v88, v13, v88, s[64:65]
    v_cndmask_b32 v89, v13, v89, s[66:67]
    v_cndmask_b32 v90, v13, v90, s[68:69]
    v_cndmask_b32 v91, v13, v91, s[70:71]
    v_max_f32 v116, v80, v81
    v_max3_f32 v116, v116, v82, v83
    v_max_f32 v117, v84, v85
    v_max3_f32 v117, v117, v86, v87
    v_max3_f32 v117, v117, v88, v89
    v_max3_f32 v117, v117, v90, v91
    v_mov_b32 v14, v116
    s_nop 1
    v_permlane16_swap_b32 v116, v14
    v_max_f32 v116, v116, v14
    v_mov_b32 v14, v117
    s_nop 1
    v_permlane16_swap_b32 v117, v14
    v_max_f32 v117, v117, v14
    v_mov_b32 v14, v116
    s_nop 1
    v_permlane32_swap_b32 v116, v14
    v_max_f32 v116, v116, v14
    v_mov_b32 v14, v117
    s_nop 1
    v_permlane32_swap_b32 v117, v14
    v_max_f32 v117, v117, v14
    v_mul_f32 v14, s43, v116
    v_fma_f32 v80, v80, s43, -v14
    v_exp_f32 v80, v80
    v_fma_f32 v81, v81, s43, -v14
    v_exp_f32 v81, v81
    v_fma_f32 v82, v82, s43, -v14
    v_exp_f32 v82, v82
    v_fma_f32 v83, v83, s43, -v14
    v_exp_f32 v83, v83
    v_mul_f32 v14, s43, v117
    v_fma_f32 v84, v84, s43, -v14
    v_exp_f32 v84, v84
    v_fma_f32 v85, v85, s43, -v14
    v_exp_f32 v85, v85
    v_fma_f32 v86, v86, s43, -v14
    v_exp_f32 v86, v86
    v_fma_f32 v87, v87, s43, -v14
    v_exp_f32 v87, v87
    v_fma_f32 v88, v88, s43, -v14
    v_exp_f32 v88, v88
    v_fma_f32 v89, v89, s43, -v14
    v_exp_f32 v89, v89
    v_fma_f32 v90, v90, s43, -v14
    v_exp_f32 v90, v90
    v_fma_f32 v91, v91, s43, -v14
    v_exp_f32 v91, v91
    v_cvt_pk_bf16_f32 v100, v80, v81
    v_cvt_pk_bf16_f32 v101, v82, v83
    v_mov_b64 v[102:103], 0
    v_cvt_pk_bf16_f32 v104, v84, v85
    v_cvt_pk_bf16_f32 v105, v86, v87
    v_cvt_pk_bf16_f32 v106, v88, v89
    v_cvt_pk_bf16_f32 v107, v90, v91
    v_mov_b64 v[108:109], s[4:5]
    v_mov_b64 v[110:111], s[4:5]
    v_cndmask_b32 v112, 0, v108, s[72:73]
    v_cndmask_b32 v113, 0, v108, s[72:73]
    v_mfma_f32_16x16x32_bf16 v[16:19], v[108:111], v[100:103], 0
    v_mfma_f32_16x16x32_bf16 v[24:27], a[64:67], v[100:103], 0
    v_mfma_f32_16x16x32_bf16 v[28:31], a[68:71], v[100:103], 0
    v_mfma_f32_16x16x32_bf16 v[20:23], v[108:111], v[104:107], 0
    v_mfma_f32_16x16x32_bf16 v[32:35], a[64:67], v[104:107], 0
    v_mfma_f32_16x16x32_bf16 v[36:39], a[68:71], v[104:107], 0
    s_branch L_P2_chk
L_P2_far:
    buffer_load_dword v14, v2, s[8:11], s25 offen sc1
    s_add_u32 s32, s32, 1
    s_cmp_gt_u32 s32, 200000
    s_waitcnt vmcnt(0)
    s_cbranch_scc1 L_P2_poll
    v_cmp_eq_u32 vcc, -1, v14
    s_cbranch_vccz L_P2_near
    s_sleep 12
    s_branch L_P2_far
L_P2_near:
    s_mov_b32 s25, 0x40000000
L_P2_poll:
    buffer_load_dwordx4 v[48:51], v2, s[8:11], s24 offen sc1
    buffer_load_dwordx4 v[52:55], v2, s[8:11], s24 offen offset:1024 sc1
L_P2_chk:
    s_add_u32 s32, s32, 1
    s_waitcnt vmcnt(0)
    ds_write_b128 v2, v[48:51] offset:20480
    ds_write_b128 v2, v[52:55] offset:21504
    v_max3_u32 v14, v48, v49, v50
    v_max3_u32 v15, v51, v52, v53
    v_max3_u32 v14, v14, v54, v55
    v_max_u32 v14, v14, v15
    v_cmp_eq_u32 vcc, -1, v14
    s_cbranch_vccz L_P2_got
    s_cmp_gt_u32 s32, 200000
    s_cbranch_scc1 L_P2_got
    s_cmp_eq_u32 s25, 0x40000000
    s_cbranch_scc1 L_P2_poll
    s_branch L_P2_far
L_P2_got:
    s_waitcnt lgkmcnt(0)
    s_barrier
    ds_read_b128 v[48:51], v8 offset:0
    ds_read_b128 v[52:55], v8 offset:2048
    ds_read_b128 v[56:59], v8 offset:4096
    ds_read_b128 v[60:63], v8 offset:6144
    s_waitcnt lgkmcnt(3)
    v_mfma_f32_16x16x32_bf16 v[80:83], a[128:131], v[48:51], 0
    v_mfma_f32_16x16x32_bf16 v[84:87], a[132:135], v[48:51], 0
    ds_read_b128 v[48:51], v8 offset:512
    s_waitcnt lgkmcnt(3)
    v_mfma_f32_16x16x32_bf16 v[80:83], a[136:139], v[52:55], v[80:83]
    v_mfma_f32_16x16x32_bf16 v[84:87], a[140:143], v[52:55], v[84:87]
    ds_read_b128 v[52:55], v8 offset:2560
    s_waitcnt lgkmcnt(3)
    v_mfma_f32_16x16x32_bf16 v[80:83], a[144:147], v[56:59], v[80:83]
    v_mfma_f32_16x16x32_bf16 v[84:87], a[148:151], v[56:59], v[84:87]
    ds_read_b128 v[56:59], v8 offset:4608
    s_waitcnt lgkmcnt(3)
    v_mfma_f32_16x16x32_bf16 v[80:83], a[152:155], v[60:63], v[80:83]
    v_mfma_f32_16x16x32_bf16 v[84:87], a[156:159], v[60:63], v[84:87]
    ds_read_b128 v[60:63], v8 offset:6656
    s_waitcnt lgkmcnt(3)
    v_mfma_f32_16x16x32_bf16 v[80:83], a[160:163], v[48:51], v[80:83]
    v_mfma_f32_16x16x32_bf16 v[84:87], a[164:167], v[48:51], v[84:87]
    ds_read_b128 v[48:51], v8 offset:1024
    s_waitcnt lgkmcnt(3)
    v_mfma_f32_16x16x32_bf16 v[80:83], a[168:171], v[52:55], v[80:83]
    v_mfma_f32_16x16x32_bf16 v[84:87], a[172:175], v[52:55], v[84:87]
    ds_read_b128 v[52:55], v8 offset:3072
    s_waitcnt lgkmcnt(3)
    v_mfma_f32_16x16x32_bf16 v[80:83], a[176:179], v[56:59], v[80:83]
    v_mfma_f32_16x16x32_bf16 v[84:87], a[180:183], v[56:59], v[84:87]
    ds_read_b128 v[56:59], v8 offset:5120
    s_waitcnt lgkmcnt(3)
    v_mfma_f32_16x16x32_bf16 v[80:83], a[184:187], v[60:63], v[80:83]
    v_mfma_f32_16x16x32_bf16 v[84:87], a[188:191], v[60:63], v[84:87]
    ds_read_b128 v[60:63], v8 offset:7168
    s_waitcnt lgkmcnt(3)
    v_mfma_f32_16x16x32_bf16 v[80:83], a[192:195], v[48:51], v[80:83]
    v_mfma_f32_16x16x32_bf16 v[84:87], a[196:199], v[48:51], v[84:87]
    ds_read_b128 v[48:51], v8 offset:1536
    s_waitcnt lgkmcnt(3)
    v_mfma_f32_16x16x32_bf16 v[80:83], a[200:203], v[52:55], v[80:83]
    v_mfma_f32_16x16x32_bf16 v[84:87], a[204:207], v[52:55], v[84:87]
    ds_read_b128 v[52:55], v8 offset:3584
    s_waitcnt lgkmcnt(3)
    v_mfma_f32_16x16x32_bf16 v[80:83], a[208:211], v[56:59], v[80:83]
    v_mfma_f32_16x16x32_bf16 v[84:87], a[212:215], v[56:59], v[84:87]
    ds_read_b128 v[56:59], v8 offset:5632
    s_waitcnt lgkmcnt(3)
    v_mfma_f32_16x16x32_bf16 v[80:83], a[216:219], v[60:63], v[80:83]
    v_mfma_f32_16x16x32_bf16 v[84:87], a[220:223], v[60:63], v[84:87]
    ds_read_b128 v[60:63], v8 offset:7680
    s_waitcnt lgkmcnt(3)
    v_mfma_f32_16x16x32_bf16 v[80:83], a[224:227], v[48:51], v[80:83]
    v_mfma_f32_16x16x32_bf16 v[84:87], a[228:231], v[48:51], v[84:87]
    ds_read_b128 v[48:51], v8 offset:0
    s_waitcnt lgkmcnt(3)
    v_mfma_f32_16x16x32_bf16 v[80:83], a[232:235], v[52:55], v[80:83]
    v_mfma_f32_16x16x32_bf16 v[84:87], a[236:239], v[52:55], v[84:87]
    ds_read_b128 v[52:55], v8 offset:2048
    s_waitcnt lgkmcnt(3)
    v_mfma_f32_16x16x32_bf16 v[80:83], a[240:243], v[56:59], v[80:83]
    v_mfma_f32_16x16x32_bf16 v[84:87], a[244:247], v[56:59], v[84:87]
    ds_read_b128 v[56:59], v8 offset:4096
    s_waitcnt lgkmcnt(3)
    v_mfma_f32_16x16x32_bf16 v[80:83], a[248:251], v[60:63], v[80:83]
    v_mfma_f32_16x16x32_bf16 v[84:87], a[252:255], v[60:63], v[84:87]
    ds_read_b128 v[60:63], v8 offset:6144
    s_waitcnt lgkmcnt(3)
    v_mfma_f32_16x16x32_bf16 v[40:43], v[48:51], v[128:131], 0
    v_mfma_f32_16x16x32_bf16 v[44:47], v[48:51], v[132:135], 0
    ds_read_b128 v[48:51], v8 offset:512
    s_waitcnt lgkmcnt(3)
    v_mfma_f32_16x16x32_bf16 v[40:43], v[52:55], v[136:139], v[40:43]
    v_mfma_f32_16x16x32_bf16 v[44:47], v[52:55], v[140:143], v[44:47]
    v_cvt_pk_bf16_f32 v88, v80, v84
    v_cvt_pk_bf16_f32 v89, v81, v85
    v_cvt_pk_bf16_f32 v90, v82, v86
    v_cvt_pk_bf16_f32 v91, v83, v87
    ds_write_b128 v9, v[88:91] offset:16384
    ds_read_b128 v[52:55], v8 offset:2560
    s_waitcnt lgkmcnt(4)
    v_mfma_f32_16x16x32_bf16 v[40:43], v[56:59], v[144:147], v[40:43]
    v_mfma_f32_16x16x32_bf16 v[44:47], v[56:59], v[148:151], v[44:47]
    ds_read_b128 v[56:59], v8 offset:4608
    s_waitcnt lgkmcnt(4)
    v_mfma_f32_16x16x32_bf16 v[40:43], v[60:63], v[152:155], v[40:43]
    v_mfma_f32_16x16x32_bf16 v[44:47], v[60:63], v[156:159], v[44:47]
    ds_read_b128 v[60:63], v8 offset:6656
    s_waitcnt lgkmcnt(4)
    v_mfma_f32_16x16x32_bf16 v[40:43], v[48:51], v[160:163], v[40:43]
    v_mfma_f32_16x16x32_bf16 v[44:47], v[48:51], v[164:167], v[44:47]
    s_waitcnt lgkmcnt(3)
    s_barrier
    ds_read_b128 v[64:67], v1 offset:16384
    ds_read_b128 v[68:71], v1 offset:17408
    ds_read_b128 v[72:75], v1 offset:18432
    ds_read_b128 v[76:79], v1 offset:19456
    ds_read_b128 v[48:51], v8 offset:1024
    s_waitcnt lgkmcnt(7)
    v_mfma_f32_16x16x32_bf16 v[40:43], v[52:55], v[168:171], v[40:43]
    v_mfma_f32_16x16x32_bf16 v[44:47], v[52:55], v[172:175], v[44:47]
    ds_read_b128 v[52:55], v8 offset:3072
    s_waitcnt lgkmcnt(7)
    v_mfma_f32_16x16x32_bf16 v[40:43], v[56:59], v[176:179], v[40:43]
    v_mfma_f32_16x16x32_bf16 v[44:47], v[56:59], v[180:183], v[44:47]
    s_waitcnt lgkmcnt(2)
    v_mfma_f32_16x16x32_bf16 v[92:95], v[64:67], a[0:3], 0
    v_mfma_f32_16x16x32_bf16 v[96:99], v[64:67], a[16:19], 0
    v_mfma_f32_16x16x32_bf16 v[92:95], v[68:71], a[4:7], v[92:95]
    v_mfma_f32_16x16x32_bf16 v[96:99], v[68:71], a[20:23], v[96:99]
    v_mfma_f32_16x16x32_bf16 v[92:95], v[72:75], a[8:11], v[92:95]
    v_mfma_f32_16x16x32_bf16 v[96:99], v[72:75], a[24:27], v[96:99]
    v_mfma_f32_16x16x32_bf16 v[92:95], v[76:79], a[12:15], v[92:95]
    v_mfma_f32_16x16x32_bf16 v[96:99], v[76:79], a[28:31], v[96:99]
    ds_read_b128 v[56:59], v8 offset:5120
    s_waitcnt lgkmcnt(3)
    v_mfma_f32_16x16x32_bf16 v[40:43], v[60:63], v[184:187], v[40:43]
    v_mfma_f32_16x16x32_bf16 v[44:47], v[60:63], v[188:191], v[44:47]
    ds_read_b128 v[60:63], v8 offset:7168
    s_waitcnt lgkmcnt(3)
    v_mfma_f32_16x16x32_bf16 v[40:43], v[48:51], v[192:195], v[40:43]
    v_mfma_f32_16x16x32_bf16 v[44:47], v[48:51], v[196:199], v[44:47]
    v_cvt_pk_bf16_f32 v93, v92, v93
    v_lshlrev_b32 v92, 16, v93
    v_and_b32 v93, 0xffff0000, v93
    v_mul_f32 v92, s42, v92
    v_mul_f32 v93, s42, v93
    v_cvt_pk_bf16_f32 v93, v92, v93
    v_lshlrev_b32 v92, 16, v93
    ds_read_b128 v[48:51], v8 offset:1536
    s_waitcnt lgkmcnt(3)
    v_mfma_f32_16x16x32_bf16 v[40:43], v[52:55], v[200:203], v[40:43]
    v_mfma_f32_16x16x32_bf16 v[44:47], v[52:55], v[204:207], v[44:47]
    v_and_b32 v93, 0xffff0000, v93
    v_cvt_pk_bf16_f32 v95, v94, v95
    v_lshlrev_b32 v94, 16, v95
    v_and_b32 v95, 0xffff0000, v95
    v_mul_f32 v94, s42, v94
    v_mul_f32 v95, s42, v95
    v_cvt_pk_bf16_f32 v95, v94, v95
    ds_read_b128 v[52:55], v8 offset:3584
    s_waitcnt lgkmcnt(3)
    v_mfma_f32_16x16x32_bf16 v[40:43], v[56:59], v[208:211], v[40:43]
    v_mfma_f32_16x16x32_bf16 v[44:47], v[56:59], v[212:215], v[44:47]
    v_lshlrev_b32 v94, 16, v95
    v_and_b32 v95, 0xffff0000, v95
    v_cvt_pk_bf16_f32 v97, v96, v97
    v_lshlrev_b32 v96, 16, v97
    v_and_b32 v97, 0xffff0000, v97
    v_mul_f32 v96, s42, v96
    v_mul_f32 v97, s42, v97
    ds_read_b128 v[56:59], v8 offset:5632
    s_waitcnt lgkmcnt(3)
    v_mfma_f32_16x16x32_bf16 v[40:43], v[60:63], v[216:219], v[40:43]
    v_mfma_f32_16x16x32_bf16 v[44:47], v[60:63], v[220:223], v[44:47]
    v_cvt_pk_bf16_f32 v97, v96, v97
    v_lshlrev_b32 v96, 16, v97
    v_and_b32 v97, 0xffff0000, v97
    v_cvt_pk_bf16_f32 v99, v98, v99
    v_lshlrev_b32 v98, 16, v99
    v_and_b32 v99, 0xffff0000, v99
    v_mul_f32 v98, s42, v98
    ds_read_b128 v[60:63], v8 offset:7680
    s_waitcnt lgkmcnt(3)
    v_mfma_f32_16x16x32_bf16 v[40:43], v[48:51], v[224:227], v[40:43]
    v_mfma_f32_16x16x32_bf16 v[44:47], v[48:51], v[228:231], v[44:47]
    v_mul_f32 v99, s42, v99
    v_cvt_pk_bf16_f32 v99, v98, v99
    v_lshlrev_b32 v98, 16, v99
    v_and_b32 v99, 0xffff0000, v99
    v_max3_f32 v118, v92, v93, v94
    v_max3_f32 v118, v118, v95, v116
    v_max3_f32 v119, v96, v97, v98
    s_waitcnt lgkmcnt(2)
    v_mfma_f32_16x16x32_bf16 v[40:43], v[52:55], v[232:235], v[40:43]
    v_mfma_f32_16x16x32_bf16 v[44:47], v[52:55], v[236:239], v[44:47]
    v_max3_f32 v119, v119, v99, v117
    v_mov_b32 v14, v118
    v_mov_b32 v15, v119
    s_nop 0
    v_permlane16_swap_b32 v118, v14
    v_permlane16_swap_b32 v119, v15
    v_max_f32 v118, v118, v14
    v_max_f32 v119, v119, v15
    s_waitcnt lgkmcnt(1)
    v_mfma_f32_16x16x32_bf16 v[40:43], v[56:59], v[240:243], v[40:43]
    v_mfma_f32_16x16x32_bf16 v[44:47], v[56:59], v[244:247], v[44:47]
    v_sub_f32 v104, v116, v118
    v_mul_f32 v118, s43, v118
    v_mul_f32 v104, s43, v104
    v_exp_f32 v104, v104
    v_fma_f32 v92, v92, s43, -v118
    v_exp_f32 v92, v92
    v_fma_f32 v93, v93, s43, -v118
    s_waitcnt lgkmcnt(0)
    v_mfma_f32_16x16x32_bf16 v[40:43], v[60:63], v[248:251], v[40:43]
    v_mfma_f32_16x16x32_bf16 v[44:47], v[60:63], v[252:255], v[44:47]
    v_exp_f32 v93, v93
    v_fma_f32 v94, v94, s43, -v118
    v_exp_f32 v94, v94
    v_fma_f32 v95, v95, s43, -v118
    v_exp_f32 v95, v95
    v_cvt_pk_bf16_f32 v100, v92, v93
    v_cvt_pk_bf16_f32 v101, v94, v95
    v_sub_f32 v105, v117, v119
    v_mul_f32 v119, s43, v119
    v_mul_f32 v105, s43, v105
    v_exp_f32 v105, v105
    v_fma_f32 v96, v96, s43, -v119
    v_exp_f32 v96, v96
    v_fma_f32 v97, v97, s43, -v119
    v_exp_f32 v97, v97
    v_fma_f32 v98, v98, s43, -v119
    v_exp_f32 v98, v98
    v_fma_f32 v99, v99, s43, -v119
    v_exp_f32 v99, v99
    v_cvt_pk_bf16_f32 v102, v96, v97
    v_cvt_pk_bf16_f32 v103, v98, v99
    v_mfma_f32_16x16x16_bf16 v[48:51], v[112:113], v[100:101], 0
    s_nop 0
    v_mfma_f32_16x16x16_bf16 v[52:55], v[112:113], v[102:103], 0
    v_cvt_pk_bf16_f32 v80, v40, v41
    v_cndmask_b32 v80, 0, v80, s[72:73]
    v_cvt_pk_bf16_f32 v81, v42, v43
    v_cndmask_b32 v81, 0, v81, s[72:73]
    v_cvt_pk_bf16_f32 v82, v44, v45
    v_cndmask_b32 v82, 0, v82, s[72:73]
    v_cvt_pk_bf16_f32 v83, v46, v47
    v_cndmask_b32 v83, 0, v83, s[72:73]
    v_mfma_f32_16x16x16_bf16 v[56:59], v[80:81], v[100:101], 0
    s_nop 0
    v_mfma_f32_16x16x16_bf16 v[60:63], v[82:83], v[100:101], 0
    v_mfma_f32_16x16x16_bf16 v[64:67], v[80:81], v[102:103], 0
    v_mfma_f32_16x16x16_bf16 v[68:71], v[82:83], v[102:103], 0
    v_fma_f32 v48, v16, v104, v48
    v_rcp_f32 v48, v48
    v_fma_f32 v52, v20, v105, v52
    v_rcp_f32 v52, v52
    v_fma_f32 v56, v24, v104, v56
    v_fma_f32 v57, v25, v104, v57
    v_fma_f32 v58, v26, v104, v58
    v_fma_f32 v59, v27, v104, v59
    v_fma_f32 v60, v28, v104, v60
    v_fma_f32 v61, v29, v104, v61
    v_fma_f32 v62, v30, v104, v62
    v_fma_f32 v63, v31, v104, v63
    v_pk_mul_f32 v[56:57], v[56:57], v[48:49] op_sel_hi:[1,0]
    v_pk_mul_f32 v[58:59], v[58:59], v[48:49] op_sel_hi:[1,0]
    v_pk_mul_f32 v[60:61], v[60:61], v[48:49] op_sel_hi:[1,0]
    v_pk_mul_f32 v[62:63], v[62:63], v[48:49] op_sel_hi:[1,0]
    v_cvt_pk_bf16_f32 v72, v56, v60
    v_cvt_pk_bf16_f32 v73, v57, v61
    v_cvt_pk_bf16_f32 v74, v58, v62
    v_cvt_pk_bf16_f32 v75, v59, v63
    ds_write_b128 v9, v[72:75] offset:0
    v_fma_f32 v64, v32, v105, v64
    v_fma_f32 v65, v33, v105, v65
    v_fma_f32 v66, v34, v105, v66
    v_fma_f32 v67, v35, v105, v67
    v_fma_f32 v68, v36, v105, v68
    v_fma_f32 v69, v37, v105, v69
    v_fma_f32 v70, v38, v105, v70
    v_fma_f32 v71, v39, v105, v71
    v_pk_mul_f32 v[64:65], v[64:65], v[52:53] op_sel_hi:[1,0]
    v_pk_mul_f32 v[66:67], v[66:67], v[52:53] op_sel_hi:[1,0]
    v_pk_mul_f32 v[68:69], v[68:69], v[52:53] op_sel_hi:[1,0]
    v_pk_mul_f32 v[70:71], v[70:71], v[52:53] op_sel_hi:[1,0]
    v_cvt_pk_bf16_f32 v76, v64, v68
    v_cvt_pk_bf16_f32 v77, v65, v69
    v_cvt_pk_bf16_f32 v78, v66, v70
    v_cvt_pk_bf16_f32 v79, v67, v71
    ds_write_b128 v9, v[76:79] offset:4096
    s_waitcnt lgkmcnt(0)
    s_barrier
    ds_read_b128 v[16:19], v1 offset:0
    ds_read_b128 v[20:23], v1 offset:1024
    ds_read_b128 v[24:27], v1 offset:2048
    ds_read_b128 v[28:31], v1 offset:3072
    ds_read_b128 v[32:35], v1 offset:4096
    ds_read_b128 v[36:39], v1 offset:5120
    ds_read_b128 v[40:43], v1 offset:6144
    ds_read_b128 v[44:47], v1 offset:7168
    ds_read_b128 v[48:51], v7 offset:0
    ds_read_b128 v[52:55], v7 offset:1024
    ds_read_b128 v[56:59], v7 offset:2048
    s_lshl_b32 s36, s20, 10
    s_add_u32 s25, s26, s36
    s_waitcnt lgkmcnt(2)
    v_mfma_f32_16x16x32_bf16 v[64:67], v[16:19], v[48:51], 0
    ds_read_b128 v[60:63], v7 offset:3072
    s_waitcnt lgkmcnt(2)
    v_mfma_f32_16x16x32_bf16 v[68:71], v[16:19], v[52:55], 0
    ds_read_b128 v[48:51], v7 offset:4096
    s_waitcnt lgkmcnt(2)
    v_mfma_f32_16x16x32_bf16 v[72:75], v[16:19], v[56:59], 0
    ds_read_b128 v[52:55], v7 offset:5120
    s_waitcnt lgkmcnt(2)
    v_mfma_f32_16x16x32_bf16 v[76:79], v[16:19], v[60:63], 0
    ds_read_b128 v[56:59], v7 offset:6144
    s_waitcnt lgkmcnt(2)
    v_mfma_f32_16x16x32_bf16 v[80:83], v[16:19], v[48:51], 0
    ds_read_b128 v[60:63], v7 offset:7168
    s_waitcnt lgkmcnt(2)
    v_mfma_f32_16x16x32_bf16 v[84:87], v[16:19], v[52:55], 0
    ds_read_b128 v[48:51], v7 offset:8192
    s_waitcnt lgkmcnt(2)
    v_mfma_f32_16x16x32_bf16 v[88:91], v[16:19], v[56:59], 0
    ds_read_b128 v[52:55], v7 offset:9216
    s_waitcnt lgkmcnt(2)
    v_mfma_f32_16x16x32_bf16 v[92:95], v[16:19], v[60:63], 0
    ds_read_b128 v[56:59], v7 offset:10240
    s_waitcnt lgkmcnt(2)
    v_mfma_f32_16x16x32_bf16 v[64:67], v[20:23], v[48:51], v[64:67]
    ds_read_b128 v[60:63], v7 offset:11264
    s_waitcnt lgkmcnt(2)
    v_mfma_f32_16x16x32_bf16 v[68:71], v[20:23], v[52:55], v[68:71]
    ds_read_b128 v[48:51], v7 offset:12288
    s_waitcnt lgkmcnt(2)
    v_mfma_f32_16x16x32_bf16 v[72:75], v[20:23], v[56:59], v[72:75]
    ds_read_b128 v[52:55], v7 offset:13312
    s_waitcnt lgkmcnt(2)
    v_mfma_f32_16x16x32_bf16 v[76:79], v[20:23], v[60:63], v[76:79]
    ds_read_b128 v[56:59], v7 offset:14336
    s_waitcnt lgkmcnt(2)
    v_mfma_f32_16x16x32_bf16 v[80:83], v[20:23], v[48:51], v[80:83]
    ds_read_b128 v[60:63], v7 offset:15360
    s_waitcnt lgkmcnt(2)
    v_mfma_f32_16x16x32_bf16 v[84:87], v[20:23], v[52:55], v[84:87]
    ds_read_b128 v[48:51], v7 offset:16384
    s_waitcnt lgkmcnt(2)
    v_mfma_f32_16x16x32_bf16 v[88:91], v[20:23], v[56:59], v[88:91]
    ds_read_b128 v[52:55], v7 offset:17408
    s_waitcnt lgkmcnt(2)
    v_mfma_f32_16x16x32_bf16 v[92:95], v[20:23], v[60:63], v[92:95]
    ds_read_b128 v[56:59], v7 offset:18432
    s_waitcnt lgkmcnt(2)
    v_mfma_f32_16x16x32_bf16 v[64:67], v[24:27], v[48:51], v[64:67]
    ds_read_b128 v[60:63], v7 offset:19456
    s_waitcnt lgkmcnt(2)
    v_mfma_f32_16x16x32_bf16 v[68:71], v[24:27], v[52:55], v[68:71]
    ds_read_b128 v[48:51], v7 offset:20480
    s_waitcnt lgkmcnt(2)
    v_mfma_f32_16x16x32_bf16 v[72:75], v[24:27], v[56:59], v[72:75]
    ds_read_b128 v[52:55], v7 offset:21504
    s_waitcnt lgkmcnt(2)
    v_mfma_f32_16x16x32_bf16 v[76:79], v[24:27], v[60:63], v[76:79]
    ds_read_b128 v[56:59], v7 offset:22528
    s_waitcnt lgkmcnt(2)
    v_mfma_f32_16x16x32_bf16 v[80:83], v[24:27], v[48:51], v[80:83]
    ds_read_b128 v[60:63], v7 offset:23552
    s_waitcnt lgkmcnt(2)
    v_mfma_f32_16x16x32_bf16 v[84:87], v[24:27], v[52:55], v[84:87]
    ds_read_b128 v[48:51], v7 offset:24576
    s_waitcnt lgkmcnt(2)
    v_mfma_f32_16x16x32_bf16 v[88:91], v[24:27], v[56:59], v[88:91]
    ds_read_b128 v[52:55], v7 offset:25600
    s_waitcnt lgkmcnt(2)
    v_mfma_f32_16x16x32_bf16 v[92:95], v[24:27], v[60:63], v[92:95]
    ds_read_b128 v[56:59], v7 offset:26624
    s_waitcnt lgkmcnt(2)
    v_mfma_f32_16x16x32_bf16 v[64:67], v[28:31], v[48:51], v[64:67]
    ds_read_b128 v[60:63], v7 offset:27648
    s_waitcnt lgkmcnt(2)
    v_mfma_f32_16x16x32_bf16 v[68:71], v[28:31], v[52:55], v[68:71]
    ds_read_b128 v[48:51], v7 offset:28672
    s_waitcnt lgkmcnt(2)
    v_mfma_f32_16x16x32_bf16 v[72:75], v[28:31], v[56:59], v[72:75]
    ds_read_b128 v[52:55], v7 offset:29696
    s_waitcnt lgkmcnt(2)
    v_mfma_f32_16x16x32_bf16 v[76:79], v[28:31], v[60:63], v[76:79]
    ds_read_b128 v[56:59], v7 offset:30720
    s_waitcnt lgkmcnt(2)
    v_mfma_f32_16x16x32_bf16 v[80:83], v[28:31], v[48:51], v[80:83]
    ds_read_b128 v[60:63], v7 offset:31744
    s_waitcnt lgkmcnt(2)
    v_mfma_f32_16x16x32_bf16 v[84:87], v[28:31], v[52:55], v[84:87]
    ds_read_b128 v[48:51], v7 offset:0
    s_waitcnt lgkmcnt(2)
    v_mfma_f32_16x16x32_bf16 v[88:91], v[28:31], v[56:59], v[88:91]
    ds_read_b128 v[52:55], v7 offset:1024
    s_waitcnt lgkmcnt(2)
    v_mfma_f32_16x16x32_bf16 v[92:95], v[28:31], v[60:63], v[92:95]
    ds_read_b128 v[56:59], v7 offset:2048
    s_waitcnt lgkmcnt(2)
    v_mfma_f32_16x16x32_bf16 v[96:99], v[32:35], v[48:51], 0
    ds_read_b128 v[60:63], v7 offset:3072
    s_waitcnt lgkmcnt(2)
    v_mfma_f32_16x16x32_bf16 v[100:103], v[32:35], v[52:55], 0
    ds_read_b128 v[48:51], v7 offset:4096
    s_waitcnt lgkmcnt(2)
    v_mfma_f32_16x16x32_bf16 v[104:107], v[32:35], v[56:59], 0
    ds_read_b128 v[52:55], v7 offset:5120
    s_waitcnt lgkmcnt(2)
    v_mfma_f32_16x16x32_bf16 v[108:111], v[32:35], v[60:63], 0
    ds_read_b128 v[56:59], v7 offset:6144
    v_cvt_pk_bf16_f32 v16, v64, v68
    s_waitcnt lgkmcnt(2)
    v_mfma_f32_16x16x32_bf16 v[112:115], v[32:35], v[48:51], 0
    ds_read_b128 v[60:63], v7 offset:7168
    v_cvt_pk_bf16_f32 v17, v72, v76
    s_waitcnt lgkmcnt(2)
    v_mfma_f32_16x16x32_bf16 v[116:119], v[32:35], v[52:55], 0
    ds_read_b128 v[48:51], v7 offset:8192
    v_cvt_pk_bf16_f32 v18, v80, v84
    s_waitcnt lgkmcnt(2)
    v_mfma_f32_16x16x32_bf16 v[120:123], v[32:35], v[56:59], 0
    ds_read_b128 v[52:55], v7 offset:9216
    v_cvt_pk_bf16_f32 v19, v88, v92
    s_waitcnt lgkmcnt(2)
    v_mfma_f32_16x16x32_bf16 v[124:127], v[32:35], v[60:63], 0
    ds_read_b128 v[56:59], v7 offset:10240
    v_and_or_b32 v16, v16, -2, s27
    s_waitcnt lgkmcnt(2)
    v_mfma_f32_16x16x32_bf16 v[96:99], v[36:39], v[48:51], v[96:99]
    ds_read_b128 v[60:63], v7 offset:11264
    s_add_u32 s36, s25, 0x0
    s_waitcnt lgkmcnt(2)
    v_mfma_f32_16x16x32_bf16 v[100:103], v[36:39], v[52:55], v[100:103]
    ds_read_b128 v[48:51], v7 offset:12288
    buffer_store_dwordx4 v[16:19], v10, s[8:11], s36 offen sc1
    s_waitcnt lgkmcnt(2)
    v_mfma_f32_16x16x32_bf16 v[104:107], v[36:39], v[56:59], v[104:107]
    ds_read_b128 v[52:55], v7 offset:13312
    v_cvt_pk_bf16_f32 v20, v65, v69
    s_waitcnt lgkmcnt(2)
    v_mfma_f32_16x16x32_bf16 v[108:111], v[36:39], v[60:63], v[108:111]
    ds_read_b128 v[56:59], v7 offset:14336
    v_cvt_pk_bf16_f32 v21, v73, v77
    s_waitcnt lgkmcnt(2)
    v_mfma_f32_16x16x32_bf16 v[112:115], v[36:39], v[48:51], v[112:115]
    ds_read_b128 v[60:63], v7 offset:15360
    v_cvt_pk_bf16_f32 v22, v81, v85
    s_waitcnt lgkmcnt(2)
    v_mfma_f32_16x16x32_bf16 v[116:119], v[36:39], v[52:55], v[116:119]
    ds_read_b128 v[48:51], v7 offset:16384
    v_cvt_pk_bf16_f32 v23, v89, v93
    s_waitcnt lgkmcnt(2)
    v_mfma_f32_16x16x32_bf16 v[120:123], v[36:39], v[56:59], v[120:123]
    ds_read_b128 v[52:55], v7 offset:17408
    v_and_or_b32 v20, v20, -2, s27
    s_waitcnt lgkmcnt(2)
    v_mfma_f32_16x16x32_bf16 v[124:127], v[36:39], v[60:63], v[124:127]
    ds_read_b128 v[56:59], v7 offset:18432
    s_add_u32 s36, s25, 0x8000
    s_waitcnt lgkmcnt(2)
    v_mfma_f32_16x16x32_bf16 v[96:99], v[40:43], v[48:51], v[96:99]
    ds_read_b128 v[60:63], v7 offset:19456
    buffer_store_dwordx4 v[20:23], v10, s[8:11], s36 offen sc1
    s_waitcnt lgkmcnt(2)
    v_mfma_f32_16x16x32_bf16 v[100:103], v[40:43], v[52:55], v[100:103]
    ds_read_b128 v[48:51], v7 offset:20480
    v_cvt_pk_bf16_f32 v24, v66, v70
    s_waitcnt lgkmcnt(2)
    v_mfma_f32_16x16x32_bf16 v[104:107], v[40:43], v[56:59], v[104:107]
    ds_read_b128 v[52:55], v7 offset:21504
    v_cvt_pk_bf16_f32 v25, v74, v78
    s_waitcnt lgkmcnt(2)
    v_mfma_f32_16x16x32_bf16 v[108:111], v[40:43], v[60:63], v[108:111]
    ds_read_b128 v[56:59], v7 offset:22528
    v_cvt_pk_bf16_f32 v26, v82, v86
    s_waitcnt lgkmcnt(2)
    v_mfma_f32_16x16x32_bf16 v[112:115], v[40:43], v[48:51], v[112:115]
    ds_read_b128 v[60:63], v7 offset:23552
    v_cvt_pk_bf16_f32 v27, v90, v94
    s_waitcnt lgkmcnt(2)
    v_mfma_f32_16x16x32_bf16 v[116:119], v[40:43], v[52:55], v[116:119]
    ds_read_b128 v[48:51], v7 offset:24576
    v_and_or_b32 v24, v24, -2, s27
    s_waitcnt lgkmcnt(2)
    v_mfma_f32_16x16x32_bf16 v[120:123], v[40:43], v[56:59], v[120:123]
    ds_read_b128 v[52:55], v7 offset:25600
    s_add_u32 s36, s25, 0x10000
    s_waitcnt lgkmcnt(2)
    v_mfma_f32_16x16x32_bf16 v[124:127], v[40:43], v[60:63], v[124:127]
    ds_read_b128 v[56:59], v7 offset:26624
    buffer_store_dwordx4 v[24:27], v10, s[8:11], s36 offen sc1
    s_waitcnt lgkmcnt(2)
    v_mfma_f32_16x16x32_bf16 v[96:99], v[44:47], v[48:51], v[96:99]
    ds_read_b128 v[60:63], v7 offset:27648
    v_cvt_pk_bf16_f32 v28, v67, v71
    s_waitcnt lgkmcnt(2)
    v_mfma_f32_16x16x32_bf16 v[100:103], v[44:47], v[52:55], v[100:103]
    ds_read_b128 v[48:51], v7 offset:28672
    v_cvt_pk_bf16_f32 v29, v75, v79
    s_waitcnt lgkmcnt(2)
    v_mfma_f32_16x16x32_bf16 v[104:107], v[44:47], v[56:59], v[104:107]
    ds_read_b128 v[52:55], v7 offset:29696
    v_cvt_pk_bf16_f32 v30, v83, v87
    s_waitcnt lgkmcnt(2)
    v_mfma_f32_16x16x32_bf16 v[108:111], v[44:47], v[60:63], v[108:111]
    ds_read_b128 v[56:59], v7 offset:30720
    v_cvt_pk_bf16_f32 v31, v91, v95
    s_waitcnt lgkmcnt(2)
    v_mfma_f32_16x16x32_bf16 v[112:115], v[44:47], v[48:51], v[112:115]
    ds_read_b128 v[60:63], v7 offset:31744
    v_and_or_b32 v28, v28, -2, s27
    s_waitcnt lgkmcnt(2)
    v_mfma_f32_16x16x32_bf16 v[116:119], v[44:47], v[52:55], v[116:119]
    s_add_u32 s36, s25, 0x18000
    s_waitcnt lgkmcnt(1)
    v_mfma_f32_16x16x32_bf16 v[120:123], v[44:47], v[56:59], v[120:123]
    buffer_store_dwordx4 v[28:31], v10, s[8:11], s36 offen sc1
    s_waitcnt lgkmcnt(0)
    v_mfma_f32_16x16x32_bf16 v[124:127], v[44:47], v[60:63], v[124:127]
    v_cvt_pk_bf16_f32 v32, v96, v100
    v_cvt_pk_bf16_f32 v33, v104, v108
    v_cvt_pk_bf16_f32 v34, v112, v116
    s_nop 4
    v_cvt_pk_bf16_f32 v35, v120, v124
    v_and_or_b32 v32, v32, -2, s27
    s_add_u32 s36, s25, 0x80000
    buffer_store_dwordx4 v[32:35], v10, s[8:11], s36 offen sc1
    v_cvt_pk_bf16_f32 v36, v97, v101
    v_cvt_pk_bf16_f32 v37, v105, v109
    v_cvt_pk_bf16_f32 v38, v113, v117
    v_cvt_pk_bf16_f32 v39, v121, v125
    v_and_or_b32 v36, v36, -2, s27
    s_add_u32 s36, s25, 0x88000
    buffer_store_dwordx4 v[36:39], v10, s[8:11], s36 offen sc1
    v_cvt_pk_bf16_f32 v40, v98, v102
    v_cvt_pk_bf16_f32 v41, v106, v110
    v_cvt_pk_bf16_f32 v42, v114, v118
    v_cvt_pk_bf16_f32 v43, v122, v126
    v_and_or_b32 v40, v40, -2, s27
    s_add_u32 s36, s25, 0x90000
    buffer_store_dwordx4 v[40:43], v10, s[8:11], s36 offen sc1
    v_cvt_pk_bf16_f32 v44, v99, v103
    v_cvt_pk_bf16_f32 v45, v107, v111
    v_cvt_pk_bf16_f32 v46, v115, v119
    v_cvt_pk_bf16_f32 v47, v123, v127
    v_and_or_b32 v44, v44, -2, s27
    s_add_u32 s36, s25, 0x98000
    buffer_store_dwordx4 v[44:47], v10, s[8:11], s36 offen sc1
    s_add_u32 s38, s23, 6
    s_cmp_ge_u32 s38, 64
    s_cbranch_scc1 L_P2_last
    s_mul_i32 s24, s38, 0x82100
    s_lshl_b32 s36, s20, 14
    s_add_u32 s24, s24, s36
    s_add_u32 s24, s24, 0x1000000
    s_add_u32 s36, s24, 0
    s_add_u32 s37, s36, 0x7000000
    buffer_load_dwordx4 a[32:35], v1, s[8:11], s36 offen offset:0 sc1
    buffer_load_dwordx4 a[0:3], v1, s[8:11], s37 offen offset:0 sc1
    buffer_load_dwordx4 a[36:39], v1, s[8:11], s36 offen offset:1024 sc1
    buffer_load_dwordx4 a[4:7], v1, s[8:11], s37 offen offset:1024 sc1
    buffer_load_dwordx4 a[40:43], v1, s[8:11], s36 offen offset:2048 sc1
    buffer_load_dwordx4 a[8:11], v1, s[8:11], s37 offen offset:2048 sc1
    buffer_load_dwordx4 a[44:47], v1, s[8:11], s36 offen offset:3072 sc1
    buffer_load_dwordx4 a[12:15], v1, s[8:11], s37 offen offset:3072 sc1
    s_add_u32 s36, s24, 4096
    s_add_u32 s37, s36, 0x7000000
    buffer_load_dwordx4 a[48:51], v1, s[8:11], s36 offen offset:0 sc1
    buffer_load_dwordx4 a[16:19], v1, s[8:11], s37 offen offset:0 sc1
    buffer_load_dwordx4 a[52:55], v1, s[8:11], s36 offen offset:1024 sc1
    buffer_load_dwordx4 a[20:23], v1, s[8:11], s37 offen offset:1024 sc1
    buffer_load_dwordx4 a[56:59], v1, s[8:11], s36 offen offset:2048 sc1
    buffer_load_dwordx4 a[24:27], v1, s[8:11], s37 offen offset:2048 sc1
    buffer_load_dwordx4 a[60:63], v1, s[8:11], s36 offen offset:3072 sc1
    buffer_load_dwordx4 a[28:31], v1, s[8:11], s37 offen offset:3072 sc1
    s_lshr_b32 s36, s21, 1
    s_lshl_b32 s36, s36, 3
    s_xor_b32 s37, s36, 8
    s_add_u32 s24, s24, 8192
    s_add_u32 s36, s36, s24
    s_add_u32 s37, s37, s24
    buffer_load_dwordx2 a[64:65], v2, s[8:11], s36 offen offset:0 sc1
    buffer_load_dwordx2 a[66:67], v2, s[8:11], s37 offen offset:0 sc1
    buffer_load_dwordx2 a[68:69], v2, s[8:11], s36 offen offset:1024 sc1
    buffer_load_dwordx2 a[70:71], v2, s[8:11], s37 offen offset:1024 sc1
L_P2_last:
    s_lshl_b32 s24, s23, 5
    s_add_u32 s24, s24, s20
    s_lshl_b32 s24, s24, 10
    v_accvgpr_read_b32 v52, a72
    v_accvgpr_read_b32 v53, a73
    v_and_b32 v15, 15, v0
    v_mov_b32 v48, 0
    v_mov_b32 v14, 0x3f80
    v_cmp_eq_u32 vcc, 0, v15
    s_nop 1
    v_cndmask_b32 v48, v48, v14, vcc
    v_mov_b32 v14, 0x3f800000
    v_cmp_eq_u32 vcc, 1, v15
    s_nop 1
    v_cndmask_b32 v48, v48, v14, vcc
    v_mov_b32 v49, 0
    v_mov_b32 v14, 0x3f80
    v_cmp_eq_u32 vcc, 4, v15
    s_nop 1
    v_cndmask_b32 v49, v49, v14, vcc
    v_mov_b32 v14, 0x3f800000
    v_cmp_eq_u32 vcc, 5, v15
    s_nop 1
    v_cndmask_b32 v49, v49, v14, vcc
    v_mov_b32 v50, 0
    v_mov_b32 v14, 0x3f80
    v_cmp_eq_u32 vcc, 8, v15
    s_nop 1
    v_cndmask_b32 v50, v50, v14, vcc
    v_mov_b32 v14, 0x3f800000
    v_cmp_eq_u32 vcc, 9, v15
    s_nop 1
    v_cndmask_b32 v50, v50, v14, vcc
    v_mov_b32 v51, 0
    v_mov_b32 v14, 0x3f80
    v_cmp_eq_u32 vcc, 12, v15
    s_nop 1
    v_cndmask_b32 v51, v51, v14, vcc
    v_mov_b32 v14, 0x3f800000
    v_cmp_eq_u32 vcc, 13, v15
    s_nop 1
    v_cndmask_b32 v51, v51, v14, vcc
    s_lshl_b32 s25, s20, 15
    s_add_u32 s25, s25, s26
L_P3_poll:
    s_add_u32 s36, s25, 0
    buffer_load_dwordx4 v[80:83], v11, s[8:11], s36 offen sc1
    s_add_u32 s36, s25, 4096
    buffer_load_dwordx4 v[84:87], v11, s[8:11], s36 offen sc1
    s_add_u32 s36, s25, 8192
    buffer_load_dwordx4 v[88:91], v11, s[8:11], s36 offen sc1
    s_add_u32 s36, s25, 12288
    buffer_load_dwordx4 v[92:95], v11, s[8:11], s36 offen sc1
    s_add_u32 s36, s25, 16384
    buffer_load_dwordx4 v[96:99], v11, s[8:11], s36 offen sc1
    s_add_u32 s36, s25, 20480
    buffer_load_dwordx4 v[100:103], v11, s[8:11], s36 offen sc1
    s_add_u32 s36, s25, 24576
    buffer_load_dwordx4 v[104:107], v11, s[8:11], s36 offen sc1
    s_add_u32 s36, s25, 28672
    buffer_load_dwordx4 v[108:111], v11, s[8:11], s36 offen sc1
    s_mov_b64 exec, -1
    s_add_u32 s32, s32, 1
    s_cmp_gt_u32 s32, 200000
    s_waitcnt vmcnt(7)
    v_mfma_f32_16x16x32_bf16 v[56:59], v[48:51], v[80:83], 0
    s_waitcnt vmcnt(6)
    v_mfma_f32_16x16x32_bf16 v[56:59], v[48:51], v[84:87], v[56:59]
    v_bitop3_b32 v60, v80, v84, s27 bitop3:0x7e
    s_waitcnt vmcnt(5)
    v_mfma_f32_16x16x32_bf16 v[56:59], v[48:51], v[88:91], v[56:59]
    s_waitcnt vmcnt(4)
    v_mfma_f32_16x16x32_bf16 v[56:59], v[48:51], v[92:95], v[56:59]
    v_bitop3_b32 v61, v88, v92, s27 bitop3:0x7e
    s_waitcnt vmcnt(3)
    v_mfma_f32_16x16x32_bf16 v[56:59], v[48:51], v[96:99], v[56:59]
    s_waitcnt vmcnt(2)
    v_mfma_f32_16x16x32_bf16 v[56:59], v[48:51], v[100:103], v[56:59]
    v_bitop3_b32 v62, v96, v100, s27 bitop3:0x7e
    s_waitcnt vmcnt(1)
    v_mfma_f32_16x16x32_bf16 v[56:59], v[48:51], v[104:107], v[56:59]
    s_waitcnt vmcnt(0)
    v_mfma_f32_16x16x32_bf16 v[56:59], v[48:51], v[108:111], v[56:59]
    v_bitop3_b32 v63, v104, v108, s27 bitop3:0x7e
    v_or3_b32 v14, v60, v61, v62
    v_bitop3_b32 v14, v14, v63, 1 bitop3:0xa8
    s_cbranch_scc1 L_P3_got
    v_cmp_ne_u32 vcc, 0, v14
    s_cbranch_vccz L_P3_got
    s_mov_b64 exec, vcc
    s_branch L_P3_poll
L_P3_got:
    s_nop 4
    v_cvt_pk_bf16_f32 v62, v56, v57
    v_lshlrev_b32 v65, 16, v62
    v_and_b32 v66, 0xffff0000, v62
    v_lshlrev_b32 v60, 16, v52
    v_and_b32 v61, 0xffff0000, v52
    v_add_f32 v60, v60, v65
    v_add_f32 v61, v61, v66
    v_cvt_pk_bf16_f32 v62, v60, v61
    v_lshlrev_b32 v60, 16, v62
    v_and_b32 v61, 0xffff0000, v62
    v_add_f32 v63, v60, v61
    v_mul_f32 v64, v60, v60
    v_fmac_f32 v64, v61, v61
    v_add_f32_dpp v63, v63, v63 quad_perm:[1,0,3,2] row_mask:0xf bank_mask:0xf
    s_nop 0
    v_add_f32_dpp v64, v64, v64 quad_perm:[1,0,3,2] row_mask:0xf bank_mask:0xf
    v_add_f32_dpp v63, v63, v63 quad_perm:[2,3,0,1] row_mask:0xf bank_mask:0xf
    s_nop 0
    v_add_f32_dpp v64, v64, v64 quad_perm:[2,3,0,1] row_mask:0xf bank_mask:0xf
    v_add_f32_dpp v63, v63, v63 row_half_mirror row_mask:0xf bank_mask:0xf
    s_nop 0
    v_add_f32_dpp v64, v64, v64 row_half_mirror row_mask:0xf bank_mask:0xf
    v_add_f32_dpp v63, v63, v63 row_mirror row_mask:0xf bank_mask:0xf
    s_nop 0
    v_add_f32_dpp v64, v64, v64 row_mirror row_mask:0xf bank_mask:0xf
    v_mov_b32 v14, v63
    s_nop 1
    v_permlane16_swap_b32 v63, v14
    v_add_f32 v63, v63, v14
    v_mov_b32 v14, v64
    s_nop 1
    v_permlane16_swap_b32 v64, v14
    v_add_f32 v64, v64, v14
    v_mov_b32 v14, v63
    s_nop 1
    v_permlane32_swap_b32 v63, v14
    v_add_f32 v63, v63, v14
    v_mov_b32 v14, v64
    s_nop 1
    v_permlane32_swap_b32 v64, v14
    v_add_f32 v64, v64, v14
    v_mov_b32 v15, s21
    v_lshlrev_b32 v15, 3, v15
    v_add_u32 v15, 28672, v15
    ds_write2_b32 v15, v63, v64 offset0:0 offset1:1
    s_add_u32 s36, s24, 0x400000
    buffer_store_dword v62, v12, s[8:11], s36 offen sc1
    s_waitcnt lgkmcnt(0)
    s_barrier
    v_mov_b32 v15, 28672
    ds_read_b128 v[68:71], v15
    ds_read_b128 v[72:75], v15 offset:16
    s_waitcnt lgkmcnt(0)
    v_add_f32 v63, v68, v70
    v_add_f32 v63, v63, v72
    v_add_f32 v63, v63, v74
    v_mul_f32 v63, 0x3b000000, v63
    v_add_f32 v64, v69, v71
    v_add_f32 v64, v64, v73
    v_add_f32 v64, v64, v75
    v_mul_f32 v64, 0x3b000000, v64
    v_fma_f32 v64, -v63, v63, v64
    v_max_f32 v64, 0, v64
    v_cvt_pk_bf16_f32 v14, v63, v64
    v_lshlrev_b32 v63, 16, v14
    v_and_b32 v64, 0xffff0000, v14
    v_add_f32 v64, 0x3727c5ac, v64
    v_cvt_pk_bf16_f32 v14, v64, v64
    v_lshlrev_b32 v64, 16, v14
    v_sqrt_f32 v64, v64
    s_nop 0
    v_cvt_pk_bf16_f32 v14, v64, v64
    v_lshlrev_b32 v64, 16, v14
    v_rcp_f32 v64, v64
    v_sub_f32 v65, v60, v63
    v_sub_f32 v66, v61, v63
    v_cvt_pk_bf16_f32 v14, v65, v66
    v_lshlrev_b32 v65, 16, v14
    v_and_b32 v66, 0xffff0000, v14
    v_mul_f32 v65, v65, v64
    v_mul_f32 v66, v66, v64
    v_cvt_pk_bf16_f32 v67, v65, v66
    v_lshlrev_b32 v65, 16, v67
    v_and_b32 v66, 0xffff0000, v67
    v_lshlrev_b32 v68, 16, v53
    v_and_b32 v69, 0xffff0000, v53
    v_mul_f32 v63, v65, v68
    v_fmac_f32 v63, v66, v69
    s_nop 1
    v_add_f32_dpp v63, v63, v63 quad_perm:[1,0,3,2] row_mask:0xf bank_mask:0xf
    s_nop 1
    v_add_f32_dpp v63, v63, v63 quad_perm:[2,3,0,1] row_mask:0xf bank_mask:0xf
    s_nop 1
    v_add_f32_dpp v63, v63, v63 row_half_mirror row_mask:0xf bank_mask:0xf
    s_nop 1
    v_add_f32_dpp v63, v63, v63 row_mirror row_mask:0xf bank_mask:0xf
    v_mov_b32 v14, v63
    s_nop 1
    v_permlane16_swap_b32 v63, v14
    v_add_f32 v63, v63, v14
    v_mov_b32 v14, v63
    s_nop 1
    v_permlane32_swap_b32 v63, v14
    v_add_f32 v63, v63, v14
    s_lshr_b32 s25, s24, 6
    s_lshl_b32 s37, s21, 2
    s_add_u32 s25, s25, s37
    s_add_u32 s36, s25, 0x194000
    v_cmp_ne_u32 vcc, 0, v1
    v_mov_b32 v15, 0x40000000
    s_nop 0
    v_cndmask_b32 v15, v1, v15, vcc
    buffer_store_dword v63, v15, s[8:11], s36 offen sc1
    v_add_f32 v60, v60, v65
    v_add_f32 v61, v61, v66
    v_cvt_pk_bf16_f32 v62, v60, v61
    buffer_store_dword v62, v12, s[60:63], s24 offen sc1
    s_add_u32 s36, s24, 0x600000
    buffer_store_dword v67, v12, s[8:11], s36 offen sc1
    s_add_u32 s30, s25, 0x1b8000
    s_add_u32 s29, s29, 1
    s_barrier
    s_add_u32 s23, s23, 6
    s_cmp_lt_u32 s23, 64
    s_cbranch_scc1 L_P2
    s_waitcnt vmcnt(0)
    v_cmp_ne_u32 vcc, 0, v1
    v_mov_b32 v15, 0x40000000
    v_mov_b32 v14, 0
    v_cndmask_b32 v15, v1, v15, vcc
    buffer_store_dword v14, v15, s[8:11], s30 offen sc1
    s_branch L_end
L_mlp:
    s_mov_b32 s12, s44
    s_and_b32 s13, s45, 0xffff
    s_mov_b32 s14, 0x200000
    s_mov_b32 s15, 0x20000
    s_mov_b32 s60, s82
    s_and_b32 s61, s83, 0xffff
    s_mov_b32 s62, 0x200000
    s_mov_b32 s63, 0x20000
    s_mov_b32 s92, s80
    s_and_b32 s93, s81, 0xffff
    s_mov_b32 s94, 0x400
    s_mov_b32 s95, 0x20000
    v_mov_b32 v1, 0x0
    v_bfe_u32 v14, v0, 0, 1
    s_mov_b32 s38, 0x10
    v_mad_u32_u24 v1, v14, s38, v1
    v_bfe_u32 v14, v0, 1, 1
    s_mov_b32 s38, 0x20
    v_mad_u32_u24 v1, v14, s38, v1
    v_bfe_u32 v14, v0, 2, 1
    s_mov_b32 s38, 0x40
    v_mad_u32_u24 v1, v14, s38, v1
    v_bfe_u32 v14, v0, 3, 1
    s_mov_b32 s38, 0x80
    v_mad_u32_u24 v1, v14, s38, v1
    v_bfe_u32 v14, v0, 4, 1
    s_mov_b32 s38, 0x100
    v_mad_u32_u24 v1, v14, s38, v1
    v_bfe_u32 v14, v0, 5, 1
    s_mov_b32 s38, 0x200
    v_mad_u32_u24 v1, v14, s38, v1
    v_mov_b32 v2, 0x0
    v_bfe_u32 v14, v0, 0, 1
    s_mov_b32 s38, 0x10
    v_mad_u32_u24 v2, v14, s38, v2
    v_bfe_u32 v14, v0, 1, 1
    s_mov_b32 s38, 0x20
    v_mad_u32_u24 v2, v14, s38, v2
    v_bfe_u32 v14, v0, 2, 1
    s_mov_b32 s38, 0x40
    v_mad_u32_u24 v2, v14, s38, v2
    v_bfe_u32 v14, v0, 3, 1
    s_mov_b32 s38, 0x80
    v_mad_u32_u24 v2, v14, s38, v2
    v_bfe_u32 v14, v0, 4, 1
    s_mov_b32 s38, 0x100
    v_mad_u32_u24 v2, v14, s38, v2
    v_bfe_u32 v14, v0, 5, 1
    s_mov_b32 s38, 0x200
    v_mad_u32_u24 v2, v14, s38, v2
    v_bfe_u32 v14, v0, 6, 1
    s_mov_b32 s38, 0x800
    v_mad_u32_u24 v2, v14, s38, v2
    v_bfe_u32 v14, v0, 7, 1
    s_mov_b32 s38, 0x1000
    v_mad_u32_u24 v2, v14, s38, v2
    v_mov_b32 v9, 0x0
    v_bfe_u32 v14, v0, 0, 1
    s_mov_b32 s38, 0x10
    v_mad_u32_u24 v9, v14, s38, v9
    v_bfe_u32 v14, v0, 1, 1
    s_mov_b32 s38, 0x20
    v_mad_u32_u24 v9, v14, s38, v9
    v_bfe_u32 v14, v0, 2, 1
    s_mov_b32 s38, 0x40
    v_mad_u32_u24 v9, v14, s38, v9
    v_bfe_u32 v14, v0, 3, 1
    s_mov_b32 s38, 0x80
    v_mad_u32_u24 v9, v14, s38, v9
    v_bfe_u32 v14, v0, 4, 1
    s_mov_b32 s38, 0x100
    v_mad_u32_u24 v9, v14, s38, v9
    v_bfe_u32 v14, v0, 5, 1
    s_mov_b32 s38, 0x200
    v_mad_u32_u24 v9, v14, s38, v9
    v_bfe_u32 v14, v0, 6, 1
    s_mov_b32 s38, 0x400
    v_mad_u32_u24 v9, v14, s38, v9
    v_bfe_u32 v14, v0, 7, 1
    s_mov_b32 s38, 0x800
    v_mad_u32_u24 v9, v14, s38, v9
    v_mov_b32 v7, 0x8000
    v_bfe_u32 v14, v0, 0, 1
    s_mov_b32 s38, 0x10
    v_mad_u32_u24 v7, v14, s38, v7
    v_bfe_u32 v14, v0, 1, 1
    s_mov_b32 s38, 0x20
    v_mad_u32_u24 v7, v14, s38, v7
    v_bfe_u32 v14, v0, 2, 1
    s_mov_b32 s38, 0x40
    v_mad_u32_u24 v7, v14, s38, v7
    v_bfe_u32 v14, v0, 3, 1
    s_mov_b32 s38, 0x80
    v_mad_u32_u24 v7, v14, s38, v7
    v_bfe_u32 v14, v0, 4, 1
    s_mov_b32 s38, 0x100
    v_mad_u32_u24 v7, v14, s38, v7
    v_bfe_u32 v14, v0, 5, 1
    s_mov_b32 s38, 0x200
    v_mad_u32_u24 v7, v14, s38, v7
    v_bfe_u32 v14, v0, 6, 1
    s_mov_b32 s38, 0x8000
    v_mad_u32_u24 v7, v14, s38, v7
    v_bfe_u32 v14, v0, 7, 1
    s_mov_b32 s38, 0x10000
    v_mad_u32_u24 v7, v14, s38, v7
    v_mov_b32 v3, 0x0
    v_bfe_u32 v14, v0, 0, 1
    s_mov_b32 s38, 0x10
    v_mad_u32_u24 v3, v14, s38, v3
    v_bfe_u32 v14, v0, 1, 1
    s_mov_b32 s38, 0x20
    v_mad_u32_u24 v3, v14, s38, v3
    v_bfe_u32 v14, v0, 2, 1
    s_mov_b32 s38, 0x40
    v_mad_u32_u24 v3, v14, s38, v3
    v_bfe_u32 v14, v0, 3, 1
    s_mov_b32 s38, 0x400
    v_mad_u32_u24 v3, v14, s38, v3
    v_bfe_u32 v14, v0, 4, 1
    s_mov_b32 s38, 0x800
    v_mad_u32_u24 v3, v14, s38, v3
    v_bfe_u32 v14, v0, 5, 1
    s_mov_b32 s38, 0x1000
    v_mad_u32_u24 v3, v14, s38, v3
    v_bfe_u32 v14, v0, 6, 1
    s_mov_b32 s38, 0x2000
    v_mad_u32_u24 v3, v14, s38, v3
    v_bfe_u32 v14, v0, 7, 1
    s_mov_b32 s38, 0x4000
    v_mad_u32_u24 v3, v14, s38, v3
    v_mov_b32 v4, 0x0
    v_bfe_u32 v14, v0, 0, 1
    s_mov_b32 s38, 0x100
    v_mad_u32_u24 v4, v14, s38, v4
    v_bfe_u32 v14, v0, 1, 1
    s_mov_b32 s38, 0x200
    v_mad_u32_u24 v4, v14, s38, v4
    v_bfe_u32 v14, v0, 2, 1
    s_mov_b32 s38, 0x400
    v_mad_u32_u24 v4, v14, s38, v4
    v_bfe_u32 v14, v0, 6, 1
    s_mov_b32 s38, 0x80
    v_mad_u32_u24 v4, v14, s38, v4
    v_bfe_u32 v14, v0, 7, 1
    s_mov_b32 s38, 0x4000
    v_mad_u32_u24 v4, v14, s38, v4
    v_lshrrev_b32 v15, 3, v0
    v_xor_b32 v15, v15, v0
    v_and_b32 v15, 7, v15
    v_lshl_add_u32 v4, v15, 4, v4
    v_bfe_u32 v15, v0, 4, 2
    v_lshlrev_b32 v15, 4, v15
    v_xor_b32 v5, v15, v1
    v_xor_b32 v6, 64, v5
    v_mov_b32 v8, 0x5000
    v_bfe_u32 v14, v0, 0, 1
    s_mov_b32 s38, 0x10
    v_mad_u32_u24 v8, v14, s38, v8
    v_bfe_u32 v14, v0, 1, 1
    s_mov_b32 s38, 0x40
    v_mad_u32_u24 v8, v14, s38, v8
    v_bfe_u32 v14, v0, 2, 1
    s_mov_b32 s38, 0x80
    v_mad_u32_u24 v8, v14, s38, v8
    v_bfe_u32 v14, v0, 4, 1
    s_mov_b32 s38, 0x20
    v_mad_u32_u24 v8, v14, s38, v8
    v_bfe_u32 v14, v0, 5, 1
    s_mov_b32 s38, 0x100
    v_mad_u32_u24 v8, v14, s38, v8
    v_mov_b32 v10, 0x0
    v_bfe_u32 v14, v0, 0, 1
    s_mov_b32 s38, 0x10
    v_mad_u32_u24 v10, v14, s38, v10
    v_bfe_u32 v14, v0, 1, 1
    s_mov_b32 s38, 0x20
    v_mad_u32_u24 v10, v14, s38, v10
    v_bfe_u32 v14, v0, 2, 1
    s_mov_b32 s38, 0x40
    v_mad_u32_u24 v10, v14, s38, v10
    v_bfe_u32 v14, v0, 3, 1
    s_mov_b32 s38, 0x80
    v_mad_u32_u24 v10, v14, s38, v10
    v_bfe_u32 v14, v0, 4, 1
    s_mov_b32 s38, 0x20000
    v_mad_u32_u24 v10, v14, s38, v10
    v_bfe_u32 v14, v0, 5, 1
    s_mov_b32 s38, 0x40000
    v_mad_u32_u24 v10, v14, s38, v10
    v_bfe_u32 v14, v0, 6, 1
    s_mov_b32 s38, 0x100
    v_mad_u32_u24 v10, v14, s38, v10
    v_bfe_u32 v14, v0, 7, 1
    s_mov_b32 s38, 0x200
    v_mad_u32_u24 v10, v14, s38, v10
    v_mov_b32 v11, 0x0
    v_bfe_u32 v14, v0, 0, 1
    s_mov_b32 s38, 0x10
    v_mad_u32_u24 v11, v14, s38, v11
    v_bfe_u32 v14, v0, 1, 1
    s_mov_b32 s38, 0x20
    v_mad_u32_u24 v11, v14, s38, v11
    v_bfe_u32 v14, v0, 2, 1
    s_mov_b32 s38, 0x40
    v_mad_u32_u24 v11, v14, s38, v11
    v_bfe_u32 v14, v0, 3, 1
    s_mov_b32 s38, 0x80
    v_mad_u32_u24 v11, v14, s38, v11
    v_bfe_u32 v14, v0, 4, 1
    s_mov_b32 s38, 0x400
    v_mad_u32_u24 v11, v14, s38, v11
    v_bfe_u32 v14, v0, 5, 1
    s_mov_b32 s38, 0x800
    v_mad_u32_u24 v11, v14, s38, v11
    v_bfe_u32 v14, v0, 6, 1
    s_mov_b32 s38, 0x100
    v_mad_u32_u24 v11, v14, s38, v11
    v_bfe_u32 v14, v0, 7, 1
    s_mov_b32 s38, 0x200
    v_mad_u32_u24 v11, v14, s38, v11
    v_mov_b32 v12, 0x0
    v_bfe_u32 v14, v0, 0, 1
    s_mov_b32 s38, 0x10
    v_mad_u32_u24 v12, v14, s38, v12
    v_bfe_u32 v14, v0, 1, 1
    s_mov_b32 s38, 0x20
    v_mad_u32_u24 v12, v14, s38, v12
    v_bfe_u32 v14, v0, 2, 1
    s_mov_b32 s38, 0x40
    v_mad_u32_u24 v12, v14, s38, v12
    v_bfe_u32 v14, v0, 3, 1
    s_mov_b32 s38, 0x80
    v_mad_u32_u24 v12, v14, s38, v12
    v_bfe_u32 v14, v0, 4, 1
    s_mov_b32 s38, 0x4
    v_mad_u32_u24 v12, v14, s38, v12
    v_bfe_u32 v14, v0, 5, 1
    s_mov_b32 s38, 0x8
    v_mad_u32_u24 v12, v14, s38, v12
    v_bfe_u32 v14, v0, 6, 1
    s_mov_b32 s38, 0x100
    v_mad_u32_u24 v12, v14, s38, v12
    v_bfe_u32 v14, v0, 7, 1
    s_mov_b32 s38, 0x200
    v_mad_u32_u24 v12, v14, s38, v12
    v_mov_b32 v13, 0xf149f2ca
    v_and_b32 v14, 15, v0
    v_bfe_u32 v15, v0, 4, 2
    v_cmp_gt_u32 s[72:73], 2, v15
    v_lshlrev_b32 v15, 2, v15
    v_cmp_le_u32 s[64:65], v15, v14
    v_add_u32 v15, 1, v15
    v_cmp_le_u32 s[66:67], v15, v14
    v_add_u32 v15, 1, v15
    v_cmp_le_u32 s[68:69], v15, v14
    v_add_u32 v15, 1, v15
    v_cmp_le_u32 s[70:71], v15, v14
    v_add_u32 v15, 1, v15
    s_mov_b32 s34, 0x05040100
    s_mov_b32 s35, 0x07060302
    s_mov_b32 s33, 0x3e0293ee
    s_mov_b32 s32, 0
    s_mov_b32 s4, 0x3f803f80
    s_mov_b32 s5, 0x3f803f80
    s_lshr_b32 s20, s2, 3
    s_lshr_b32 s23, s2, 3
    s_lshl_b32 s23, s23, 1
    s_lshl_b32 s36, s23, 15
    buffer_load_dwordx4 v[96:99], v3, s[12:15], s36 offen offset:0
    buffer_load_dwordx4 v[100:103], v3, s[12:15], s36 offen offset:128
    buffer_load_dwordx4 v[104:107], v3, s[12:15], s36 offen offset:256
    buffer_load_dwordx4 v[108:111], v3, s[12:15], s36 offen offset:384
    buffer_load_dwordx4 v[112:115], v3, s[12:15], s36 offen offset:512
    buffer_load_dwordx4 v[116:119], v3, s[12:15], s36 offen offset:640
    buffer_load_dwordx4 v[120:123], v3, s[12:15], s36 offen offset:768
    buffer_load_dwordx4 v[124:127], v3, s[12:15], s36 offen offset:896
    s_add_u32 s36, s36, 0x8000
    buffer_load_dwordx4 v[128:131], v3, s[12:15], s36 offen offset:0
    buffer_load_dwordx4 v[132:135], v3, s[12:15], s36 offen offset:128
    buffer_load_dwordx4 v[136:139], v3, s[12:15], s36 offen offset:256
    buffer_load_dwordx4 v[140:143], v3, s[12:15], s36 offen offset:384
    buffer_load_dwordx4 v[144:147], v3, s[12:15], s36 offen offset:512
    buffer_load_dwordx4 v[148:151], v3, s[12:15], s36 offen offset:640
    buffer_load_dwordx4 v[152:155], v3, s[12:15], s36 offen offset:768
    buffer_load_dwordx4 v[156:159], v3, s[12:15], s36 offen offset:896
    s_mov_b32 s96, s46
    s_and_b32 s97, s47, 0xffff
    s_mov_b32 s98, 0x2000
    s_mov_b32 s99, 0x20000
    v_mov_b32 v68, 0x0
    v_bfe_u32 v14, v0, 0, 1
    s_mov_b32 s38, 0x8
    v_mad_u32_u24 v68, v14, s38, v68
    v_bfe_u32 v14, v0, 1, 1
    s_mov_b32 s38, 0x10
    v_mad_u32_u24 v68, v14, s38, v68
    v_bfe_u32 v14, v0, 2, 1
    s_mov_b32 s38, 0x10000
    v_mad_u32_u24 v68, v14, s38, v68
    v_bfe_u32 v14, v0, 3, 1
    s_mov_b32 s38, 0x10000
    v_mad_u32_u24 v68, v14, s38, v68
    v_bfe_u32 v14, v0, 4, 1
    s_mov_b32 s38, 0x400
    v_mad_u32_u24 v68, v14, s38, v68
    v_bfe_u32 v14, v0, 5, 1
    s_mov_b32 s38, 0x4
    v_mad_u32_u24 v68, v14, s38, v68
    v_bfe_u32 v14, v0, 6, 1
    s_mov_b32 s38, 0x40
    v_mad_u32_u24 v68, v14, s38, v68
    v_bfe_u32 v14, v0, 7, 1
    s_mov_b32 s38, 0x80
    v_mad_u32_u24 v68, v14, s38, v68
    v_mov_b32 v70, s20
    v_mov_b32 v69, 0x0
    v_bfe_u32 v14, v70, 0, 1
    s_mov_b32 s38, 0x20
    v_mad_u32_u24 v69, v14, s38, v69
    v_bfe_u32 v14, v70, 1, 1
    s_mov_b32 s38, 0x800
    v_mad_u32_u24 v69, v14, s38, v69
    v_bfe_u32 v14, v70, 2, 1
    s_mov_b32 s38, 0x1000
    v_mad_u32_u24 v69, v14, s38, v69
    v_bfe_u32 v14, v70, 3, 1
    s_mov_b32 s38, 0x100
    v_mad_u32_u24 v69, v14, s38, v69
    v_bfe_u32 v14, v70, 4, 1
    s_mov_b32 s38, 0x200
    v_mad_u32_u24 v69, v14, s38, v69
    v_add_u32 v68, v68, v69
    buffer_load_dword v72, v68, s[96:99], 0 offen
    v_mov_b32 v64, -1
    v_mov_b32 v65, -1
    v_mov_b32 v66, -1
    v_mov_b32 v67, -1
    s_lshl_b32 s36, s20, 13
    s_add_u32 s36, s36, 0x0
    buffer_store_dwordx4 v[64:67], v2, s[8:11], s36 offen sc1
    buffer_store_dwordx4 v[64:67], v2, s[8:11], s36 offen offset:1024 sc1
    s_lshl_b32 s36, s20, 14
    s_add_u32 s36, s36, 0x100000
    s_add_u32 s37, s36, 0x2000
    buffer_store_dwordx4 v[64:67], v2, s[8:11], s36 offen sc1
    buffer_store_dwordx4 v[64:67], v2, s[8:11], s36 offen offset:1024 sc1
    buffer_store_dwordx4 v[64:67], v2, s[8:11], s37 offen sc1
    buffer_store_dwordx4 v[64:67], v2, s[8:11], s37 offen offset:1024 sc1
    s_mul_i32 s36, s20, 0x104200
    s_add_u32 s36, s36, 0x1102100
    s_add_u32 s37, s36, 0x82100
    buffer_store_dwordx4 v[64:67], v2, s[8:11], s36 offen sc1
    buffer_store_dwordx4 v[64:67], v2, s[8:11], s36 offen offset:1024 sc1
    buffer_store_dwordx4 v[64:67], v2, s[8:11], s37 offen sc1
    buffer_store_dwordx4 v[64:67], v2, s[8:11], s37 offen offset:1024 sc1
    v_lshlrev_b32 v68, 2, v0
    s_lshl_b32 s36, s20, 10
    s_add_u32 s37, s36, 0x194000
    buffer_store_dword v64, v68, s[8:11], s37 offen sc1
    s_add_u32 s37, s36, 0x1b0000
    buffer_store_dword v64, v68, s[8:11], s37 offen sc1
    s_add_u32 s37, s36, 0x1b8000
    buffer_store_dword v64, v68, s[8:11], s37 offen sc1
    v_mov_b32 v69, 0x40000000
    v_cmp_lt_u32 vcc, 63, v0
    s_nop 1
    v_cndmask_b32 v68, v68, v69, vcc
    v_mov_b32 v73, 0
    s_lshl_b32 s36, s20, 8
    s_add_u32 s37, s36, 0x192000
    buffer_store_dword v73, v68, s[8:11], s37 offen sc1
    s_mul_i32 s36, s20, 0x104200
    s_add_u32 s36, s36, 0x1082000
    s_add_u32 s37, s36, 0x82100
    buffer_store_dword v73, v68, s[8:11], s36 offen sc1
    buffer_store_dword v73, v68, s[8:11], s37 offen sc1
    v_mov_b32 v71, 0x80000
    v_bfe_u32 v14, v0, 0, 1
    s_mov_b32 s38, 0x8
    v_mad_u32_u24 v71, v14, s38, v71
    v_bfe_u32 v14, v0, 1, 1
    s_mov_b32 s38, 0x20
    v_mad_u32_u24 v71, v14, s38, v71
    v_bfe_u32 v14, v0, 4, 1
    s_mov_b32 s38, 0x10
    v_mad_u32_u24 v71, v14, s38, v71
    v_bfe_u32 v14, v0, 5, 1
    s_mov_b32 s38, 0x4
    v_mad_u32_u24 v71, v14, s38, v71
    v_bfe_u32 v14, v0, 6, 1
    s_mov_b32 s38, 0x800
    v_mad_u32_u24 v71, v14, s38, v71
    v_bfe_u32 v14, v0, 7, 1
    s_mov_b32 s38, 0x1000
    v_mad_u32_u24 v71, v14, s38, v71
    v_mov_b32 v69, s20
    v_mov_b32 v68, 0x0
    v_bfe_u32 v14, v69, 0, 1
    s_mov_b32 s38, 0x100
    v_mad_u32_u24 v68, v14, s38, v68
    v_bfe_u32 v14, v69, 1, 1
    s_mov_b32 s38, 0x40
    v_mad_u32_u24 v68, v14, s38, v68
    v_bfe_u32 v14, v69, 2, 1
    s_mov_b32 s38, 0x80
    v_mad_u32_u24 v68, v14, s38, v68
    v_bfe_u32 v14, v69, 3, 1
    s_mov_b32 s38, 0x200
    v_mad_u32_u24 v68, v14, s38, v68
    v_bfe_u32 v14, v69, 4, 1
    s_mov_b32 s38, 0x400
    v_mad_u32_u24 v68, v14, s38, v68
    v_add_u32 v71, v68, v71
    v_and_b32 v68, 12, v0
    v_cmp_ne_u32 vcc, 0, v68
    v_mov_b32 v68, 0x40000000
    s_nop 0
    v_cndmask_b32 v71, v71, v68, vcc
    s_waitcnt vmcnt(16)
    s_mov_b32 s36, 0x1000000
    buffer_store_dword v72, v71, s[8:11], s36 offen sc1
L_XN:
    v_mov_b32 v88, 0
    v_mov_b32 v89, 0
    v_dot2_f32_bf16 v88, v96, s4, v88
    v_dot2_f32_bf16 v89, v96, v96, v89
    v_dot2_f32_bf16 v88, v97, s4, v88
    v_dot2_f32_bf16 v89, v97, v97, v89
    v_dot2_f32_bf16 v88, v98, s4, v88
    v_dot2_f32_bf16 v89, v98, v98, v89
    v_dot2_f32_bf16 v88, v99, s4, v88
    v_dot2_f32_bf16 v89, v99, v99, v89
    v_dot2_f32_bf16 v88, v100, s4, v88
    v_dot2_f32_bf16 v89, v100, v100, v89
    v_dot2_f32_bf16 v88, v101, s4, v88
    v_dot2_f32_bf16 v89, v101, v101, v89
    v_dot2_f32_bf16 v88, v102, s4, v88
    v_dot2_f32_bf16 v89, v102, v102, v89
    v_dot2_f32_bf16 v88, v103, s4, v88
    v_dot2_f32_bf16 v89, v103, v103, v89
    v_dot2_f32_bf16 v88, v104, s4, v88
    v_dot2_f32_bf16 v89, v104, v104, v89
    v_dot2_f32_bf16 v88, v105, s4, v88
    v_dot2_f32_bf16 v89, v105, v105, v89
    v_dot2_f32_bf16 v88, v106, s4, v88
    v_dot2_f32_bf16 v89, v106, v106, v89
    v_dot2_f32_bf16 v88, v107, s4, v88
    v_dot2_f32_bf16 v89, v107, v107, v89
    v_dot2_f32_bf16 v88, v108, s4, v88
    v_dot2_f32_bf16 v89, v108, v108, v89
    v_dot2_f32_bf16 v88, v109, s4, v88
    v_dot2_f32_bf16 v89, v109, v109, v89
    v_dot2_f32_bf16 v88, v110, s4, v88
    v_dot2_f32_bf16 v89, v110, v110, v89
    v_dot2_f32_bf16 v88, v111, s4, v88
    v_dot2_f32_bf16 v89, v111, v111, v89
    v_dot2_f32_bf16 v88, v112, s4, v88
    v_dot2_f32_bf16 v89, v112, v112, v89
    v_dot2_f32_bf16 v88, v113, s4, v88
    v_dot2_f32_bf16 v89, v113, v113, v89
    v_dot2_f32_bf16 v88, v114, s4, v88
    v_dot2_f32_bf16 v89, v114, v114, v89
    v_dot2_f32_bf16 v88, v115, s4, v88
    v_dot2_f32_bf16 v89, v115, v115, v89
    v_dot2_f32_bf16 v88, v116, s4, v88
    v_dot2_f32_bf16 v89, v116, v116, v89
    v_dot2_f32_bf16 v88, v117, s4, v88
    v_dot2_f32_bf16 v89, v117, v117, v89
    v_dot2_f32_bf16 v88, v118, s4, v88
    v_dot2_f32_bf16 v89, v118, v118, v89
    v_dot2_f32_bf16 v88, v119, s4, v88
    v_dot2_f32_bf16 v89, v119, v119, v89
    v_dot2_f32_bf16 v88, v120, s4, v88
    v_dot2_f32_bf16 v89, v120, v120, v89
    v_dot2_f32_bf16 v88, v121, s4, v88
    v_dot2_f32_bf16 v89, v121, v121, v89
    v_dot2_f32_bf16 v88, v122, s4, v88
    v_dot2_f32_bf16 v89, v122, v122, v89
    v_dot2_f32_bf16 v88, v123, s4, v88
    v_dot2_f32_bf16 v89, v123, v123, v89
    v_dot2_f32_bf16 v88, v124, s4, v88
    v_dot2_f32_bf16 v89, v124, v124, v89
    v_dot2_f32_bf16 v88, v125, s4, v88
    v_dot2_f32_bf16 v89, v125, v125, v89
    v_dot2_f32_bf16 v88, v126, s4, v88
    v_dot2_f32_bf16 v89, v126, v126, v89
    v_dot2_f32_bf16 v88, v127, s4, v88
    v_dot2_f32_bf16 v89, v127, v127, v89
    s_nop 3
    v_add_f32_dpp v88, v88, v88 quad_perm:[1,0,3,2] row_mask:0xf bank_mask:0xf
    v_add_f32_dpp v89, v89, v89 quad_perm:[1,0,3,2] row_mask:0xf bank_mask:0xf
    s_nop 0
    v_add_f32_dpp v88, v88, v88 quad_perm:[2,3,0,1] row_mask:0xf bank_mask:0xf
    v_add_f32_dpp v89, v89, v89 quad_perm:[2,3,0,1] row_mask:0xf bank_mask:0xf
    s_nop 0
    v_add_f32_dpp v88, v88, v88 row_half_mirror row_mask:0xf bank_mask:0xf
    v_add_f32_dpp v89, v89, v89 row_half_mirror row_mask:0xf bank_mask:0xf
    v_mul_f32 v88, 0x3b000000, v88
    v_mul_f32 v89, 0x3b000000, v89
    v_fma_f32 v89, -v88, v88, v89
    v_max_f32 v89, 0, v89
    v_cvt_pk_bf16_f32 v14, v88, v89
    v_lshlrev_b32 v88, 16, v14
    v_and_b32 v89, 0xffff0000, v14
    v_add_f32 v89, 0x3727c5ac, v89
    v_cvt_pk_bf16_f32 v14, v89, v89
    v_lshlrev_b32 v89, 16, v14
    v_sqrt_f32 v89, v89
    s_nop 0
    v_cvt_pk_bf16_f32 v14, v89, v89
    v_lshlrev_b32 v89, 16, v14
    v_rcp_f32 v89, v89
    v_lshlrev_b32 v90, 16, v96
    v_and_b32 v91, 0xffff0000, v96
    v_sub_f32 v90, v90, v88
    v_sub_f32 v91, v91, v88
    v_cvt_pk_bf16_f32 v96, v90, v91
    v_lshlrev_b32 v90, 16, v96
    v_and_b32 v91, 0xffff0000, v96
    v_mul_f32 v90, v90, v89
    v_mul_f32 v91, v91, v89
    v_cvt_pk_bf16_f32 v96, v90, v91
    v_lshlrev_b32 v90, 16, v97
    v_and_b32 v91, 0xffff0000, v97
    v_sub_f32 v90, v90, v88
    v_sub_f32 v91, v91, v88
    v_cvt_pk_bf16_f32 v97, v90, v91
    v_lshlrev_b32 v90, 16, v97
    v_and_b32 v91, 0xffff0000, v97
    v_mul_f32 v90, v90, v89
    v_mul_f32 v91, v91, v89
    v_cvt_pk_bf16_f32 v97, v90, v91
    v_lshlrev_b32 v90, 16, v98
    v_and_b32 v91, 0xffff0000, v98
    v_sub_f32 v90, v90, v88
    v_sub_f32 v91, v91, v88
    v_cvt_pk_bf16_f32 v98, v90, v91
    v_lshlrev_b32 v90, 16, v98
    v_and_b32 v91, 0xffff0000, v98
    v_mul_f32 v90, v90, v89
    v_mul_f32 v91, v91, v89
    v_cvt_pk_bf16_f32 v98, v90, v91
    v_lshlrev_b32 v90, 16, v99
    v_and_b32 v91, 0xffff0000, v99
    v_sub_f32 v90, v90, v88
    v_sub_f32 v91, v91, v88
    v_cvt_pk_bf16_f32 v99, v90, v91
    v_lshlrev_b32 v90, 16, v99
    v_and_b32 v91, 0xffff0000, v99
    v_mul_f32 v90, v90, v89
    v_mul_f32 v91, v91, v89
    v_cvt_pk_bf16_f32 v99, v90, v91
    ds_write_b128 v4, v[96:99] offset:0
    v_lshlrev_b32 v90, 16, v100
    v_and_b32 v91, 0xffff0000, v100
    v_sub_f32 v90, v90, v88
    v_sub_f32 v91, v91, v88
    v_cvt_pk_bf16_f32 v100, v90, v91
    v_lshlrev_b32 v90, 16, v100
    v_and_b32 v91, 0xffff0000, v100
    v_mul_f32 v90, v90, v89
    v_mul_f32 v91, v91, v89
    v_cvt_pk_bf16_f32 v100, v90, v91
    v_lshlrev_b32 v90, 16, v101
    v_and_b32 v91, 0xffff0000, v101
    v_sub_f32 v90, v90, v88
    v_sub_f32 v91, v91, v88
    v_cvt_pk_bf16_f32 v101, v90, v91
    v_lshlrev_b32 v90, 16, v101
    v_and_b32 v91, 0xffff0000, v101
    v_mul_f32 v90, v90, v89
    v_mul_f32 v91, v91, v89
    v_cvt_pk_bf16_f32 v101, v90, v91
    v_lshlrev_b32 v90, 16, v102
    v_and_b32 v91, 0xffff0000, v102
    v_sub_f32 v90, v90, v88
    v_sub_f32 v91, v91, v88
    v_cvt_pk_bf16_f32 v102, v90, v91
    v_lshlrev_b32 v90, 16, v102
    v_and_b32 v91, 0xffff0000, v102
    v_mul_f32 v90, v90, v89
    v_mul_f32 v91, v91, v89
    v_cvt_pk_bf16_f32 v102, v90, v91
    v_lshlrev_b32 v90, 16, v103
    v_and_b32 v91, 0xffff0000, v103
    v_sub_f32 v90, v90, v88
    v_sub_f32 v91, v91, v88
    v_cvt_pk_bf16_f32 v103, v90, v91
    v_lshlrev_b32 v90, 16, v103
    v_and_b32 v91, 0xffff0000, v103
    v_mul_f32 v90, v90, v89
    v_mul_f32 v91, v91, v89
    v_cvt_pk_bf16_f32 v103, v90, v91
    ds_write_b128 v4, v[100:103] offset:2048
    v_lshlrev_b32 v90, 16, v104
    v_and_b32 v91, 0xffff0000, v104
    v_sub_f32 v90, v90, v88
    v_sub_f32 v91, v91, v88
    v_cvt_pk_bf16_f32 v104, v90, v91
    v_lshlrev_b32 v90, 16, v104
    v_and_b32 v91, 0xffff0000, v104
    v_mul_f32 v90, v90, v89
    v_mul_f32 v91, v91, v89
    v_cvt_pk_bf16_f32 v104, v90, v91
    v_lshlrev_b32 v90, 16, v105
    v_and_b32 v91, 0xffff0000, v105
    v_sub_f32 v90, v90, v88
    v_sub_f32 v91, v91, v88
    v_cvt_pk_bf16_f32 v105, v90, v91
    v_lshlrev_b32 v90, 16, v105
    v_and_b32 v91, 0xffff0000, v105
    v_mul_f32 v90, v90, v89
    v_mul_f32 v91, v91, v89
    v_cvt_pk_bf16_f32 v105, v90, v91
    v_lshlrev_b32 v90, 16, v106
    v_and_b32 v91, 0xffff0000, v106
    v_sub_f32 v90, v90, v88
    v_sub_f32 v91, v91, v88
    v_cvt_pk_bf16_f32 v106, v90, v91
    v_lshlrev_b32 v90, 16, v106
    v_and_b32 v91, 0xffff0000, v106
    v_mul_f32 v90, v90, v89
    v_mul_f32 v91, v91, v89
    v_cvt_pk_bf16_f32 v106, v90, v91
    v_lshlrev_b32 v90, 16, v107
    v_and_b32 v91, 0xffff0000, v107
    v_sub_f32 v90, v90, v88
    v_sub_f32 v91, v91, v88
    v_cvt_pk_bf16_f32 v107, v90, v91
    v_lshlrev_b32 v90, 16, v107
    v_and_b32 v91, 0xffff0000, v107
    v_mul_f32 v90, v90, v89
    v_mul_f32 v91, v91, v89
    v_cvt_pk_bf16_f32 v107, v90, v91
    ds_write_b128 v4, v[104:107] offset:4096
    v_lshlrev_b32 v90, 16, v108
    v_and_b32 v91, 0xffff0000, v108
    v_sub_f32 v90, v90, v88
    v_sub_f32 v91, v91, v88
    v_cvt_pk_bf16_f32 v108, v90, v91
    v_lshlrev_b32 v90, 16, v108
    v_and_b32 v91, 0xffff0000, v108
    v_mul_f32 v90, v90, v89
    v_mul_f32 v91, v91, v89
    v_cvt_pk_bf16_f32 v108, v90, v91
    v_lshlrev_b32 v90, 16, v109
    v_and_b32 v91, 0xffff0000, v109
    v_sub_f32 v90, v90, v88
    v_sub_f32 v91, v91, v88
    v_cvt_pk_bf16_f32 v109, v90, v91
    v_lshlrev_b32 v90, 16, v109
    v_and_b32 v91, 0xffff0000, v109
    v_mul_f32 v90, v90, v89
    v_mul_f32 v91, v91, v89
    v_cvt_pk_bf16_f32 v109, v90, v91
    v_lshlrev_b32 v90, 16, v110
    v_and_b32 v91, 0xffff0000, v110
    v_sub_f32 v90, v90, v88
    v_sub_f32 v91, v91, v88
    v_cvt_pk_bf16_f32 v110, v90, v91
    v_lshlrev_b32 v90, 16, v110
    v_and_b32 v91, 0xffff0000, v110
    v_mul_f32 v90, v90, v89
    v_mul_f32 v91, v91, v89
    v_cvt_pk_bf16_f32 v110, v90, v91
    v_lshlrev_b32 v90, 16, v111
    v_and_b32 v91, 0xffff0000, v111
    v_sub_f32 v90, v90, v88
    v_sub_f32 v91, v91, v88
    v_cvt_pk_bf16_f32 v111, v90, v91
    v_lshlrev_b32 v90, 16, v111
    v_and_b32 v91, 0xffff0000, v111
    v_mul_f32 v90, v90, v89
    v_mul_f32 v91, v91, v89
    v_cvt_pk_bf16_f32 v111, v90, v91
    ds_write_b128 v4, v[108:111] offset:6144
    v_lshlrev_b32 v90, 16, v112
    v_and_b32 v91, 0xffff0000, v112
    v_sub_f32 v90, v90, v88
    v_sub_f32 v91, v91, v88
    v_cvt_pk_bf16_f32 v112, v90, v91
    v_lshlrev_b32 v90, 16, v112
    v_and_b32 v91, 0xffff0000, v112
    v_mul_f32 v90, v90, v89
    v_mul_f32 v91, v91, v89
    v_cvt_pk_bf16_f32 v112, v90, v91
    v_lshlrev_b32 v90, 16, v113
    v_and_b32 v91, 0xffff0000, v113
    v_sub_f32 v90, v90, v88
    v_sub_f32 v91, v91, v88
    v_cvt_pk_bf16_f32 v113, v90, v91
    v_lshlrev_b32 v90, 16, v113
    v_and_b32 v91, 0xffff0000, v113
    v_mul_f32 v90, v90, v89
    v_mul_f32 v91, v91, v89
    v_cvt_pk_bf16_f32 v113, v90, v91
    v_lshlrev_b32 v90, 16, v114
    v_and_b32 v91, 0xffff0000, v114
    v_sub_f32 v90, v90, v88
    v_sub_f32 v91, v91, v88
    v_cvt_pk_bf16_f32 v114, v90, v91
    v_lshlrev_b32 v90, 16, v114
    v_and_b32 v91, 0xffff0000, v114
    v_mul_f32 v90, v90, v89
    v_mul_f32 v91, v91, v89
    v_cvt_pk_bf16_f32 v114, v90, v91
    v_lshlrev_b32 v90, 16, v115
    v_and_b32 v91, 0xffff0000, v115
    v_sub_f32 v90, v90, v88
    v_sub_f32 v91, v91, v88
    v_cvt_pk_bf16_f32 v115, v90, v91
    v_lshlrev_b32 v90, 16, v115
    v_and_b32 v91, 0xffff0000, v115
    v_mul_f32 v90, v90, v89
    v_mul_f32 v91, v91, v89
    v_cvt_pk_bf16_f32 v115, v90, v91
    ds_write_b128 v4, v[112:115] offset:8192
    v_lshlrev_b32 v90, 16, v116
    v_and_b32 v91, 0xffff0000, v116
    v_sub_f32 v90, v90, v88
    v_sub_f32 v91, v91, v88
    v_cvt_pk_bf16_f32 v116, v90, v91
    v_lshlrev_b32 v90, 16, v116
    v_and_b32 v91, 0xffff0000, v116
    v_mul_f32 v90, v90, v89
    v_mul_f32 v91, v91, v89
    v_cvt_pk_bf16_f32 v116, v90, v91
    v_lshlrev_b32 v90, 16, v117
    v_and_b32 v91, 0xffff0000, v117
    v_sub_f32 v90, v90, v88
    v_sub_f32 v91, v91, v88
    v_cvt_pk_bf16_f32 v117, v90, v91
    v_lshlrev_b32 v90, 16, v117
    v_and_b32 v91, 0xffff0000, v117
    v_mul_f32 v90, v90, v89
    v_mul_f32 v91, v91, v89
    v_cvt_pk_bf16_f32 v117, v90, v91
    v_lshlrev_b32 v90, 16, v118
    v_and_b32 v91, 0xffff0000, v118
    v_sub_f32 v90, v90, v88
    v_sub_f32 v91, v91, v88
    v_cvt_pk_bf16_f32 v118, v90, v91
    v_lshlrev_b32 v90, 16, v118
    v_and_b32 v91, 0xffff0000, v118
    v_mul_f32 v90, v90, v89
    v_mul_f32 v91, v91, v89
    v_cvt_pk_bf16_f32 v118, v90, v91
    v_lshlrev_b32 v90, 16, v119
    v_and_b32 v91, 0xffff0000, v119
    v_sub_f32 v90, v90, v88
    v_sub_f32 v91, v91, v88
    v_cvt_pk_bf16_f32 v119, v90, v91
    v_lshlrev_b32 v90, 16, v119
    v_and_b32 v91, 0xffff0000, v119
    v_mul_f32 v90, v90, v89
    v_mul_f32 v91, v91, v89
    v_cvt_pk_bf16_f32 v119, v90, v91
    ds_write_b128 v4, v[116:119] offset:10240
    v_lshlrev_b32 v90, 16, v120
    v_and_b32 v91, 0xffff0000, v120
    v_sub_f32 v90, v90, v88
    v_sub_f32 v91, v91, v88
    v_cvt_pk_bf16_f32 v120, v90, v91
    v_lshlrev_b32 v90, 16, v120
    v_and_b32 v91, 0xffff0000, v120
    v_mul_f32 v90, v90, v89
    v_mul_f32 v91, v91, v89
    v_cvt_pk_bf16_f32 v120, v90, v91
    v_lshlrev_b32 v90, 16, v121
    v_and_b32 v91, 0xffff0000, v121
    v_sub_f32 v90, v90, v88
    v_sub_f32 v91, v91, v88
    v_cvt_pk_bf16_f32 v121, v90, v91
    v_lshlrev_b32 v90, 16, v121
    v_and_b32 v91, 0xffff0000, v121
    v_mul_f32 v90, v90, v89
    v_mul_f32 v91, v91, v89
    v_cvt_pk_bf16_f32 v121, v90, v91
    v_lshlrev_b32 v90, 16, v122
    v_and_b32 v91, 0xffff0000, v122
    v_sub_f32 v90, v90, v88
    v_sub_f32 v91, v91, v88
    v_cvt_pk_bf16_f32 v122, v90, v91
    v_lshlrev_b32 v90, 16, v122
    v_and_b32 v91, 0xffff0000, v122
    v_mul_f32 v90, v90, v89
    v_mul_f32 v91, v91, v89
    v_cvt_pk_bf16_f32 v122, v90, v91
    v_lshlrev_b32 v90, 16, v123
    v_and_b32 v91, 0xffff0000, v123
    v_sub_f32 v90, v90, v88
    v_sub_f32 v91, v91, v88
    v_cvt_pk_bf16_f32 v123, v90, v91
    v_lshlrev_b32 v90, 16, v123
    v_and_b32 v91, 0xffff0000, v123
    v_mul_f32 v90, v90, v89
    v_mul_f32 v91, v91, v89
    v_cvt_pk_bf16_f32 v123, v90, v91
    ds_write_b128 v4, v[120:123] offset:12288
    v_lshlrev_b32 v90, 16, v124
    v_and_b32 v91, 0xffff0000, v124
    v_sub_f32 v90, v90, v88
    v_sub_f32 v91, v91, v88
    v_cvt_pk_bf16_f32 v124, v90, v91
    v_lshlrev_b32 v90, 16, v124
    v_and_b32 v91, 0xffff0000, v124
    v_mul_f32 v90, v90, v89
    v_mul_f32 v91, v91, v89
    v_cvt_pk_bf16_f32 v124, v90, v91
    v_lshlrev_b32 v90, 16, v125
    v_and_b32 v91, 0xffff0000, v125
    v_sub_f32 v90, v90, v88
    v_sub_f32 v91, v91, v88
    v_cvt_pk_bf16_f32 v125, v90, v91
    v_lshlrev_b32 v90, 16, v125
    v_and_b32 v91, 0xffff0000, v125
    v_mul_f32 v90, v90, v89
    v_mul_f32 v91, v91, v89
    v_cvt_pk_bf16_f32 v125, v90, v91
    v_lshlrev_b32 v90, 16, v126
    v_and_b32 v91, 0xffff0000, v126
    v_sub_f32 v90, v90, v88
    v_sub_f32 v91, v91, v88
    v_cvt_pk_bf16_f32 v126, v90, v91
    v_lshlrev_b32 v90, 16, v126
    v_and_b32 v91, 0xffff0000, v126
    v_mul_f32 v90, v90, v89
    v_mul_f32 v91, v91, v89
    v_cvt_pk_bf16_f32 v126, v90, v91
    v_lshlrev_b32 v90, 16, v127
    v_and_b32 v91, 0xffff0000, v127
    v_sub_f32 v90, v90, v88
    v_sub_f32 v91, v91, v88
    v_cvt_pk_bf16_f32 v127, v90, v91
    v_lshlrev_b32 v90, 16, v127
    v_and_b32 v91, 0xffff0000, v127
    v_mul_f32 v90, v90, v89
    v_mul_f32 v91, v91, v89
    v_cvt_pk_bf16_f32 v127, v90, v91
    ds_write_b128 v4, v[124:127] offset:14336
    s_waitcnt lgkmcnt(0)
    s_barrier
    s_lshl_b32 s24, s23, 15
    s_add_u32 s24, s24, 0x800000
    ds_read_b128 v[24:27], v9 offset:0
    ds_read_b128 v[28:31], v9 offset:4096
    ds_read_b128 v[32:35], v9 offset:8192
    ds_read_b128 v[36:39], v9 offset:12288
    ds_read_b128 v[40:43], v9 offset:16384
    ds_read_b128 v[44:47], v9 offset:20480
    ds_read_b128 v[48:51], v9 offset:24576
    ds_read_b128 v[52:55], v9 offset:28672
    s_waitcnt lgkmcnt(7)
    s_add_u32 s36, s24, 0
    buffer_store_dwordx4 v[24:27], v9, s[8:11], s36 offen sc1
    s_waitcnt lgkmcnt(6)
    s_add_u32 s36, s24, 4096
    buffer_store_dwordx4 v[28:31], v9, s[8:11], s36 offen sc1
    s_waitcnt lgkmcnt(5)
    s_add_u32 s36, s24, 8192
    buffer_store_dwordx4 v[32:35], v9, s[8:11], s36 offen sc1
    s_waitcnt lgkmcnt(4)
    s_add_u32 s36, s24, 12288
    buffer_store_dwordx4 v[36:39], v9, s[8:11], s36 offen sc1
    s_waitcnt lgkmcnt(3)
    s_add_u32 s36, s24, 16384
    buffer_store_dwordx4 v[40:43], v9, s[8:11], s36 offen sc1
    s_waitcnt lgkmcnt(2)
    s_add_u32 s36, s24, 20480
    buffer_store_dwordx4 v[44:47], v9, s[8:11], s36 offen sc1
    s_waitcnt lgkmcnt(1)
    s_add_u32 s36, s24, 24576
    buffer_store_dwordx4 v[48:51], v9, s[8:11], s36 offen sc1
    s_waitcnt lgkmcnt(0)
    s_add_u32 s36, s24, 28672
    buffer_store_dwordx4 v[52:55], v9, s[8:11], s36 offen sc1
    s_barrier
    v_mov_b64 v[96:97], v[128:129]
    v_mov_b64 v[98:99], v[130:131]
    v_mov_b64 v[100:101], v[132:133]
    v_mov_b64 v[102:103], v[134:135]
    v_mov_b64 v[104:105], v[136:137]
    v_mov_b64 v[106:107], v[138:139]
    v_mov_b64 v[108:109], v[140:141]
    v_mov_b64 v[110:111], v[142:143]
    v_mov_b64 v[112:113], v[144:145]
    v_mov_b64 v[114:115], v[146:147]
    v_mov_b64 v[116:117], v[148:149]
    v_mov_b64 v[118:119], v[150:151]
    v_mov_b64 v[120:121], v[152:153]
    v_mov_b64 v[122:123], v[154:155]
    v_mov_b64 v[124:125], v[156:157]
    v_mov_b64 v[126:127], v[158:159]
    s_add_u32 s23, s23, 1
    s_bitcmp1_b32 s23, 0
    s_cbranch_scc1 L_XN
    s_waitcnt vmcnt(0)
    s_barrier
    v_mov_b32 v14, 1
    s_lshl_b32 s37, s20, 2
    v_lshlrev_b32 v15, 20, v0
    buffer_store_dword v14, v15, s[16:19], s37 offen sc1
    s_lshr_b32 s20, s2, 3
    s_mov_b32 s34, 0x05040100
    s_mov_b32 s35, 0x07060302
    s_mov_b32 s32, 0
    s_mov_b32 s64, s84
    s_and_b32 s65, s85, 0xffff
    s_mov_b32 s66, 0x1c0000
    s_mov_b32 s67, 0x20000
    s_mov_b32 s68, s86
    s_and_b32 s69, s87, 0xffff
    s_mov_b32 s70, 0x1c0000
    s_mov_b32 s71, 0x20000
    s_mov_b32 s76, s88
    s_and_b32 s77, s89, 0xffff
    s_mov_b32 s78, 0x1c0000
    s_mov_b32 s79, 0x20000
    v_and_b32 v3, 31, v0
    v_lshlrev_b32 v3, 2, v3
L_M_hs:
    buffer_load_dword v5, v3, s[16:19], 0 offen sc1
    s_add_u32 s32, s32, 1
    s_cmp_gt_u32 s32, 200000
    s_waitcnt vmcnt(0)
    s_cbranch_scc1 L_M_hs_ok
    v_cmp_eq_u32 vcc, 0, v5
    s_cbranch_vccz L_M_hs_ok
    s_sleep 16
    s_branch L_M_hs
L_M_hs_ok:
    v_lshlrev_b32 v3, 4, v0
L_M00_rp:
    s_mov_b32 s36, 0x194000
    buffer_load_dwordx4 v[16:19], v3, s[8:11], s36 offen sc1
    s_add_u32 s32, s32, 1
    v_mov_b32 v5, 0
    s_waitcnt vmcnt(0)
    v_max3_u32 v5, v5, v16, v17
    v_max3_u32 v5, v5, v18, v19
    s_cmp_gt_u32 s32, 200000
    s_cbranch_scc1 L_M00_rp_ok
    v_cmp_eq_u32 vcc, -1, v5
    s_cbranch_vccz L_M00_rp_ok
    s_sleep 64
    s_branch L_M00_rp
L_M00_rp_ok:
    v_add_f32 v16, v16, v17
    v_add_f32 v18, v18, v19
    v_add_f32 v16, v16, v18
    v_cvt_pk_bf16_f32 v5, v16, v16
    v_lshlrev_b32 v16, 16, v5
    v_ashrrev_i32 v5, 31, v16
    v_or_b32 v5, 0x80000000, v5
    v_xor_b32 v5, v5, v16
    v_and_b32 v5, 0xffff0000, v5
    v_sub_u32 v6, 2047, v0
    v_or_b32 v120, v5, v6
    v_lshrrev_b32 v1, 5, v0
    v_and_b32 v2, 31, v0
    s_mov_b32 s36, 229376
    v_mul_lo_u32 v4, v1, s36
    v_lshl_add_u32 v4, v2, 2, v4
    v_mov_b32 v5, 0x40000000
    v_cmp_lt_u32 vcc, 27, v2
    s_nop 1
    v_cndmask_b32 v4, v4, v5, vcc
    s_mul_i32 s23, s20, 112
    s_add_u32 s36, s23, 0
    buffer_load_dword v16, v4, s[64:67], s36 offen
    s_add_u32 s36, s23, 3584
    buffer_load_dword v17, v4, s[64:67], s36 offen
    s_add_u32 s36, s23, 7168
    buffer_load_dword v18, v4, s[64:67], s36 offen
    s_add_u32 s36, s23, 10752
    buffer_load_dword v19, v4, s[64:67], s36 offen
    s_add_u32 s36, s23, 14336
    buffer_load_dword v20, v4, s[64:67], s36 offen
    s_add_u32 s36, s23, 17920
    buffer_load_dword v21, v4, s[64:67], s36 offen
    s_add_u32 s36, s23, 21504
    buffer_load_dword v22, v4, s[64:67], s36 offen
    s_add_u32 s36, s23, 25088
    buffer_load_dword v23, v4, s[64:67], s36 offen
    s_add_u32 s36, s23, 28672
    buffer_load_dword v24, v4, s[64:67], s36 offen
    s_add_u32 s36, s23, 32256
    buffer_load_dword v25, v4, s[64:67], s36 offen
    s_add_u32 s36, s23, 35840
    buffer_load_dword v26, v4, s[64:67], s36 offen
    s_add_u32 s36, s23, 39424
    buffer_load_dword v27, v4, s[64:67], s36 offen
    s_add_u32 s36, s23, 43008
    buffer_load_dword v28, v4, s[64:67], s36 offen
    s_add_u32 s36, s23, 46592
    buffer_load_dword v29, v4, s[64:67], s36 offen
    s_add_u32 s36, s23, 50176
    buffer_load_dword v30, v4, s[64:67], s36 offen
    s_add_u32 s36, s23, 53760
    buffer_load_dword v31, v4, s[64:67], s36 offen
    s_add_u32 s36, s23, 57344
    buffer_load_dword v32, v4, s[64:67], s36 offen
    s_add_u32 s36, s23, 60928
    buffer_load_dword v33, v4, s[64:67], s36 offen
    s_add_u32 s36, s23, 64512
    buffer_load_dword v34, v4, s[64:67], s36 offen
    s_add_u32 s36, s23, 68096
    buffer_load_dword v35, v4, s[64:67], s36 offen
    s_add_u32 s36, s23, 71680
    buffer_load_dword v36, v4, s[64:67], s36 offen
    s_add_u32 s36, s23, 75264
    buffer_load_dword v37, v4, s[64:67], s36 offen
    s_add_u32 s36, s23, 78848
    buffer_load_dword v38, v4, s[64:67], s36 offen
    s_add_u32 s36, s23, 82432
    buffer_load_dword v39, v4, s[64:67], s36 offen
    s_add_u32 s36, s23, 86016
    buffer_load_dword v40, v4, s[64:67], s36 offen
    s_add_u32 s36, s23, 89600
    buffer_load_dword v41, v4, s[64:67], s36 offen
    s_add_u32 s36, s23, 93184
    buffer_load_dword v42, v4, s[64:67], s36 offen
    s_add_u32 s36, s23, 96768
    buffer_load_dword v43, v4, s[64:67], s36 offen
    s_add_u32 s36, s23, 100352
    buffer_load_dword v44, v4, s[64:67], s36 offen
    s_add_u32 s36, s23, 103936
    buffer_load_dword v45, v4, s[64:67], s36 offen
    s_add_u32 s36, s23, 107520
    buffer_load_dword v46, v4, s[64:67], s36 offen
    s_add_u32 s36, s23, 111104
    buffer_load_dword v47, v4, s[64:67], s36 offen
    s_waitcnt vmcnt(0)
    v_perm_b32 v128, v17, v16, s34
    v_perm_b32 v129, v19, v18, s34
    v_perm_b32 v130, v21, v20, s34
    v_perm_b32 v131, v23, v22, s34
    v_perm_b32 v132, v25, v24, s34
    v_perm_b32 v133, v27, v26, s34
    v_perm_b32 v134, v29, v28, s34
    v_perm_b32 v135, v31, v30, s34
    v_perm_b32 v136, v33, v32, s34
    v_perm_b32 v137, v35, v34, s34
    v_perm_b32 v138, v37, v36, s34
    v_perm_b32 v139, v39, v38, s34
    v_perm_b32 v140, v41, v40, s34
    v_perm_b32 v141, v43, v42, s34
    v_perm_b32 v142, v45, v44, s34
    v_perm_b32 v143, v47, v46, s34
    v_perm_b32 v160, v17, v16, s35
    v_perm_b32 v161, v19, v18, s35
    v_perm_b32 v162, v21, v20, s35
    v_perm_b32 v163, v23, v22, s35
    v_perm_b32 v164, v25, v24, s35
    v_perm_b32 v165, v27, v26, s35
    v_perm_b32 v166, v29, v28, s35
    v_perm_b32 v167, v31, v30, s35
    v_perm_b32 v168, v33, v32, s35
    v_perm_b32 v169, v35, v34, s35
    v_perm_b32 v170, v37, v36, s35
    v_perm_b32 v171, v39, v38, s35
    v_perm_b32 v172, v41, v40, s35
    v_perm_b32 v173, v43, v42, s35
    v_perm_b32 v174, v45, v44, s35
    v_perm_b32 v175, v47, v46, s35
    s_add_u32 s36, s23, 114688
    buffer_load_dword v16, v4, s[64:67], s36 offen
    s_add_u32 s36, s23, 118272
    buffer_load_dword v17, v4, s[64:67], s36 offen
    s_add_u32 s36, s23, 121856
    buffer_load_dword v18, v4, s[64:67], s36 offen
    s_add_u32 s36, s23, 125440
    buffer_load_dword v19, v4, s[64:67], s36 offen
    s_add_u32 s36, s23, 129024
    buffer_load_dword v20, v4, s[64:67], s36 offen
    s_add_u32 s36, s23, 132608
    buffer_load_dword v21, v4, s[64:67], s36 offen
    s_add_u32 s36, s23, 136192
    buffer_load_dword v22, v4, s[64:67], s36 offen
    s_add_u32 s36, s23, 139776
    buffer_load_dword v23, v4, s[64:67], s36 offen
    s_add_u32 s36, s23, 143360
    buffer_load_dword v24, v4, s[64:67], s36 offen
    s_add_u32 s36, s23, 146944
    buffer_load_dword v25, v4, s[64:67], s36 offen
    s_add_u32 s36, s23, 150528
    buffer_load_dword v26, v4, s[64:67], s36 offen
    s_add_u32 s36, s23, 154112
    buffer_load_dword v27, v4, s[64:67], s36 offen
    s_add_u32 s36, s23, 157696
    buffer_load_dword v28, v4, s[64:67], s36 offen
    s_add_u32 s36, s23, 161280
    buffer_load_dword v29, v4, s[64:67], s36 offen
    s_add_u32 s36, s23, 164864
    buffer_load_dword v30, v4, s[64:67], s36 offen
    s_add_u32 s36, s23, 168448
    buffer_load_dword v31, v4, s[64:67], s36 offen
    s_add_u32 s36, s23, 172032
    buffer_load_dword v32, v4, s[64:67], s36 offen
    s_add_u32 s36, s23, 175616
    buffer_load_dword v33, v4, s[64:67], s36 offen
    s_add_u32 s36, s23, 179200
    buffer_load_dword v34, v4, s[64:67], s36 offen
    s_add_u32 s36, s23, 182784
    buffer_load_dword v35, v4, s[64:67], s36 offen
    s_add_u32 s36, s23, 186368
    buffer_load_dword v36, v4, s[64:67], s36 offen
    s_add_u32 s36, s23, 189952
    buffer_load_dword v37, v4, s[64:67], s36 offen
    s_add_u32 s36, s23, 193536
    buffer_load_dword v38, v4, s[64:67], s36 offen
    s_add_u32 s36, s23, 197120
    buffer_load_dword v39, v4, s[64:67], s36 offen
    s_add_u32 s36, s23, 200704
    buffer_load_dword v40, v4, s[64:67], s36 offen
    s_add_u32 s36, s23, 204288
    buffer_load_dword v41, v4, s[64:67], s36 offen
    s_add_u32 s36, s23, 207872
    buffer_load_dword v42, v4, s[64:67], s36 offen
    s_add_u32 s36, s23, 211456
    buffer_load_dword v43, v4, s[64:67], s36 offen
    s_add_u32 s36, s23, 215040
    buffer_load_dword v44, v4, s[64:67], s36 offen
    s_add_u32 s36, s23, 218624
    buffer_load_dword v45, v4, s[64:67], s36 offen
    s_add_u32 s36, s23, 222208
    buffer_load_dword v46, v4, s[64:67], s36 offen
    s_add_u32 s36, s23, 225792
    buffer_load_dword v47, v4, s[64:67], s36 offen
    s_waitcnt vmcnt(0)
    v_perm_b32 v144, v17, v16, s34
    v_perm_b32 v145, v19, v18, s34
    v_perm_b32 v146, v21, v20, s34
    v_perm_b32 v147, v23, v22, s34
    v_perm_b32 v148, v25, v24, s34
    v_perm_b32 v149, v27, v26, s34
    v_perm_b32 v150, v29, v28, s34
    v_perm_b32 v151, v31, v30, s34
    v_perm_b32 v152, v33, v32, s34
    v_perm_b32 v153, v35, v34, s34
    v_perm_b32 v154, v37, v36, s34
    v_perm_b32 v155, v39, v38, s34
    v_perm_b32 v156, v41, v40, s34
    v_perm_b32 v157, v43, v42, s34
    v_perm_b32 v158, v45, v44, s34
    v_perm_b32 v159, v47, v46, s34
    v_perm_b32 v176, v17, v16, s35
    v_perm_b32 v177, v19, v18, s35
    v_perm_b32 v178, v21, v20, s35
    v_perm_b32 v179, v23, v22, s35
    v_perm_b32 v180, v25, v24, s35
    v_perm_b32 v181, v27, v26, s35
    v_perm_b32 v182, v29, v28, s35
    v_perm_b32 v183, v31, v30, s35
    v_perm_b32 v184, v33, v32, s35
    v_perm_b32 v185, v35, v34, s35
    v_perm_b32 v186, v37, v36, s35
    v_perm_b32 v187, v39, v38, s35
    v_perm_b32 v188, v41, v40, s35
    v_perm_b32 v189, v43, v42, s35
    v_perm_b32 v190, v45, v44, s35
    v_perm_b32 v191, v47, v46, s35
    s_add_u32 s36, s23, 0
    buffer_load_dword v16, v4, s[68:71], s36 offen
    s_add_u32 s36, s23, 3584
    buffer_load_dword v17, v4, s[68:71], s36 offen
    s_add_u32 s36, s23, 7168
    buffer_load_dword v18, v4, s[68:71], s36 offen
    s_add_u32 s36, s23, 10752
    buffer_load_dword v19, v4, s[68:71], s36 offen
    s_add_u32 s36, s23, 14336
    buffer_load_dword v20, v4, s[68:71], s36 offen
    s_add_u32 s36, s23, 17920
    buffer_load_dword v21, v4, s[68:71], s36 offen
    s_add_u32 s36, s23, 21504
    buffer_load_dword v22, v4, s[68:71], s36 offen
    s_add_u32 s36, s23, 25088
    buffer_load_dword v23, v4, s[68:71], s36 offen
    s_add_u32 s36, s23, 28672
    buffer_load_dword v24, v4, s[68:71], s36 offen
    s_add_u32 s36, s23, 32256
    buffer_load_dword v25, v4, s[68:71], s36 offen
    s_add_u32 s36, s23, 35840
    buffer_load_dword v26, v4, s[68:71], s36 offen
    s_add_u32 s36, s23, 39424
    buffer_load_dword v27, v4, s[68:71], s36 offen
    s_add_u32 s36, s23, 43008
    buffer_load_dword v28, v4, s[68:71], s36 offen
    s_add_u32 s36, s23, 46592
    buffer_load_dword v29, v4, s[68:71], s36 offen
    s_add_u32 s36, s23, 50176
    buffer_load_dword v30, v4, s[68:71], s36 offen
    s_add_u32 s36, s23, 53760
    buffer_load_dword v31, v4, s[68:71], s36 offen
    s_add_u32 s36, s23, 57344
    buffer_load_dword v32, v4, s[68:71], s36 offen
    s_add_u32 s36, s23, 60928
    buffer_load_dword v33, v4, s[68:71], s36 offen
    s_add_u32 s36, s23, 64512
    buffer_load_dword v34, v4, s[68:71], s36 offen
    s_add_u32 s36, s23, 68096
    buffer_load_dword v35, v4, s[68:71], s36 offen
    s_add_u32 s36, s23, 71680
    buffer_load_dword v36, v4, s[68:71], s36 offen
    s_add_u32 s36, s23, 75264
    buffer_load_dword v37, v4, s[68:71], s36 offen
    s_add_u32 s36, s23, 78848
    buffer_load_dword v38, v4, s[68:71], s36 offen
    s_add_u32 s36, s23, 82432
    buffer_load_dword v39, v4, s[68:71], s36 offen
    s_add_u32 s36, s23, 86016
    buffer_load_dword v40, v4, s[68:71], s36 offen
    s_add_u32 s36, s23, 89600
    buffer_load_dword v41, v4, s[68:71], s36 offen
    s_add_u32 s36, s23, 93184
    buffer_load_dword v42, v4, s[68:71], s36 offen
    s_add_u32 s36, s23, 96768
    buffer_load_dword v43, v4, s[68:71], s36 offen
    s_add_u32 s36, s23, 100352
    buffer_load_dword v44, v4, s[68:71], s36 offen
    s_add_u32 s36, s23, 103936
    buffer_load_dword v45, v4, s[68:71], s36 offen
    s_add_u32 s36, s23, 107520
    buffer_load_dword v46, v4, s[68:71], s36 offen
    s_add_u32 s36, s23, 111104
    buffer_load_dword v47, v4, s[68:71], s36 offen
    s_waitcnt vmcnt(0)
    v_perm_b32 v192, v17, v16, s34
    v_perm_b32 v193, v19, v18, s34
    v_perm_b32 v194, v21, v20, s34
    v_perm_b32 v195, v23, v22, s34
    v_perm_b32 v196, v25, v24, s34
    v_perm_b32 v197, v27, v26, s34
    v_perm_b32 v198, v29, v28, s34
    v_perm_b32 v199, v31, v30, s34
    v_perm_b32 v200, v33, v32, s34
    v_perm_b32 v201, v35, v34, s34
    v_perm_b32 v202, v37, v36, s34
    v_perm_b32 v203, v39, v38, s34
    v_perm_b32 v204, v41, v40, s34
    v_perm_b32 v205, v43, v42, s34
    v_perm_b32 v206, v45, v44, s34
    v_perm_b32 v207, v47, v46, s34
    v_perm_b32 v224, v17, v16, s35
    v_perm_b32 v225, v19, v18, s35
    v_perm_b32 v226, v21, v20, s35
    v_perm_b32 v227, v23, v22, s35
    v_perm_b32 v228, v25, v24, s35
    v_perm_b32 v229, v27, v26, s35
    v_perm_b32 v230, v29, v28, s35
    v_perm_b32 v231, v31, v30, s35
    v_perm_b32 v232, v33, v32, s35
    v_perm_b32 v233, v35, v34, s35
    v_perm_b32 v234, v37, v36, s35
    v_perm_b32 v235, v39, v38, s35
    v_perm_b32 v236, v41, v40, s35
    v_perm_b32 v237, v43, v42, s35
    v_perm_b32 v238, v45, v44, s35
    v_perm_b32 v239, v47, v46, s35
    s_add_u32 s36, s23, 114688
    buffer_load_dword v16, v4, s[68:71], s36 offen
    s_add_u32 s36, s23, 118272
    buffer_load_dword v17, v4, s[68:71], s36 offen
    s_add_u32 s36, s23, 121856
    buffer_load_dword v18, v4, s[68:71], s36 offen
    s_add_u32 s36, s23, 125440
    buffer_load_dword v19, v4, s[68:71], s36 offen
    s_add_u32 s36, s23, 129024
    buffer_load_dword v20, v4, s[68:71], s36 offen
    s_add_u32 s36, s23, 132608
    buffer_load_dword v21, v4, s[68:71], s36 offen
    s_add_u32 s36, s23, 136192
    buffer_load_dword v22, v4, s[68:71], s36 offen
    s_add_u32 s36, s23, 139776
    buffer_load_dword v23, v4, s[68:71], s36 offen
    s_add_u32 s36, s23, 143360
    buffer_load_dword v24, v4, s[68:71], s36 offen
    s_add_u32 s36, s23, 146944
    buffer_load_dword v25, v4, s[68:71], s36 offen
    s_add_u32 s36, s23, 150528
    buffer_load_dword v26, v4, s[68:71], s36 offen
    s_add_u32 s36, s23, 154112
    buffer_load_dword v27, v4, s[68:71], s36 offen
    s_add_u32 s36, s23, 157696
    buffer_load_dword v28, v4, s[68:71], s36 offen
    s_add_u32 s36, s23, 161280
    buffer_load_dword v29, v4, s[68:71], s36 offen
    s_add_u32 s36, s23, 164864
    buffer_load_dword v30, v4, s[68:71], s36 offen
    s_add_u32 s36, s23, 168448
    buffer_load_dword v31, v4, s[68:71], s36 offen
    s_add_u32 s36, s23, 172032
    buffer_load_dword v32, v4, s[68:71], s36 offen
    s_add_u32 s36, s23, 175616
    buffer_load_dword v33, v4, s[68:71], s36 offen
    s_add_u32 s36, s23, 179200
    buffer_load_dword v34, v4, s[68:71], s36 offen
    s_add_u32 s36, s23, 182784
    buffer_load_dword v35, v4, s[68:71], s36 offen
    s_add_u32 s36, s23, 186368
    buffer_load_dword v36, v4, s[68:71], s36 offen
    s_add_u32 s36, s23, 189952
    buffer_load_dword v37, v4, s[68:71], s36 offen
    s_add_u32 s36, s23, 193536
    buffer_load_dword v38, v4, s[68:71], s36 offen
    s_add_u32 s36, s23, 197120
    buffer_load_dword v39, v4, s[68:71], s36 offen
    s_add_u32 s36, s23, 200704
    buffer_load_dword v40, v4, s[68:71], s36 offen
    s_add_u32 s36, s23, 204288
    buffer_load_dword v41, v4, s[68:71], s36 offen
    s_add_u32 s36, s23, 207872
    buffer_load_dword v42, v4, s[68:71], s36 offen
    s_add_u32 s36, s23, 211456
    buffer_load_dword v43, v4, s[68:71], s36 offen
    s_add_u32 s36, s23, 215040
    buffer_load_dword v44, v4, s[68:71], s36 offen
    s_add_u32 s36, s23, 218624
    buffer_load_dword v45, v4, s[68:71], s36 offen
    s_add_u32 s36, s23, 222208
    buffer_load_dword v46, v4, s[68:71], s36 offen
    s_add_u32 s36, s23, 225792
    buffer_load_dword v47, v4, s[68:71], s36 offen
    s_waitcnt vmcnt(0)
    v_perm_b32 v208, v17, v16, s34
    v_perm_b32 v209, v19, v18, s34
    v_perm_b32 v210, v21, v20, s34
    v_perm_b32 v211, v23, v22, s34
    v_perm_b32 v212, v25, v24, s34
    v_perm_b32 v213, v27, v26, s34
    v_perm_b32 v214, v29, v28, s34
    v_perm_b32 v215, v31, v30, s34
    v_perm_b32 v216, v33, v32, s34
    v_perm_b32 v217, v35, v34, s34
    v_perm_b32 v218, v37, v36, s34
    v_perm_b32 v219, v39, v38, s34
    v_perm_b32 v220, v41, v40, s34
    v_perm_b32 v221, v43, v42, s34
    v_perm_b32 v222, v45, v44, s34
    v_perm_b32 v223, v47, v46, s34
    v_perm_b32 v240, v17, v16, s35
    v_perm_b32 v241, v19, v18, s35
    v_perm_b32 v242, v21, v20, s35
    v_perm_b32 v243, v23, v22, s35
    v_perm_b32 v244, v25, v24, s35
    v_perm_b32 v245, v27, v26, s35
    v_perm_b32 v246, v29, v28, s35
    v_perm_b32 v247, v31, v30, s35
    v_perm_b32 v248, v33, v32, s35
    v_perm_b32 v249, v35, v34, s35
    v_perm_b32 v250, v37, v36, s35
    v_perm_b32 v251, v39, v38, s35
    v_perm_b32 v252, v41, v40, s35
    v_perm_b32 v253, v43, v42, s35
    v_perm_b32 v254, v45, v44, s35
    v_perm_b32 v255, v47, v46, s35
    v_lshrrev_b32 v3, 3, v0
    v_mul_u32_u24 v4, 57344, v3
    v_and_b32 v3, 7, v0
    v_lshl_add_u32 v4, v3, 2, v4
    s_lshl_b32 s37, s20, 5
    s_add_u32 s36, s37, 0
    buffer_load_dword v16, v4, s[76:79], s36 offen
    s_add_u32 s36, s37, 1024
    buffer_load_dword v17, v4, s[76:79], s36 offen
    s_add_u32 s36, s37, 2048
    buffer_load_dword v18, v4, s[76:79], s36 offen
    s_add_u32 s36, s37, 3072
    buffer_load_dword v19, v4, s[76:79], s36 offen
    s_add_u32 s36, s37, 4096
    buffer_load_dword v20, v4, s[76:79], s36 offen
    s_add_u32 s36, s37, 5120
    buffer_load_dword v21, v4, s[76:79], s36 offen
    s_add_u32 s36, s37, 6144
    buffer_load_dword v22, v4, s[76:79], s36 offen
    s_add_u32 s36, s37, 7168
    buffer_load_dword v23, v4, s[76:79], s36 offen
    s_add_u32 s36, s37, 8192
    buffer_load_dword v24, v4, s[76:79], s36 offen
    s_add_u32 s36, s37, 9216
    buffer_load_dword v25, v4, s[76:79], s36 offen
    s_add_u32 s36, s37, 10240
    buffer_load_dword v26, v4, s[76:79], s36 offen
    s_add_u32 s36, s37, 11264
    buffer_load_dword v27, v4, s[76:79], s36 offen
    s_add_u32 s36, s37, 12288
    buffer_load_dword v28, v4, s[76:79], s36 offen
    s_add_u32 s36, s37, 13312
    buffer_load_dword v29, v4, s[76:79], s36 offen
    s_add_u32 s36, s37, 14336
    buffer_load_dword v30, v4, s[76:79], s36 offen
    s_add_u32 s36, s37, 15360
    buffer_load_dword v31, v4, s[76:79], s36 offen
    s_add_u32 s36, s37, 16384
    buffer_load_dword v32, v4, s[76:79], s36 offen
    s_add_u32 s36, s37, 17408
    buffer_load_dword v33, v4, s[76:79], s36 offen
    s_add_u32 s36, s37, 18432
    buffer_load_dword v34, v4, s[76:79], s36 offen
    s_add_u32 s36, s37, 19456
    buffer_load_dword v35, v4, s[76:79], s36 offen
    s_add_u32 s36, s37, 20480
    buffer_load_dword v36, v4, s[76:79], s36 offen
    s_add_u32 s36, s37, 21504
    buffer_load_dword v37, v4, s[76:79], s36 offen
    s_add_u32 s36, s37, 22528
    buffer_load_dword v38, v4, s[76:79], s36 offen
    s_add_u32 s36, s37, 23552
    buffer_load_dword v39, v4, s[76:79], s36 offen
    s_add_u32 s36, s37, 24576
    buffer_load_dword v40, v4, s[76:79], s36 offen
    s_add_u32 s36, s37, 25600
    buffer_load_dword v41, v4, s[76:79], s36 offen
    s_add_u32 s36, s37, 26624
    buffer_load_dword v42, v4, s[76:79], s36 offen
    s_add_u32 s36, s37, 27648
    buffer_load_dword v43, v4, s[76:79], s36 offen
    s_waitcnt vmcnt(0)
    v_perm_b32 v64, v17, v16, s34
    v_perm_b32 v65, v19, v18, s34
    v_perm_b32 v66, v21, v20, s34
    v_perm_b32 v67, v23, v22, s34
    v_perm_b32 v68, v25, v24, s34
    v_perm_b32 v69, v27, v26, s34
    v_perm_b32 v70, v29, v28, s34
    v_perm_b32 v71, v31, v30, s34
    v_perm_b32 v72, v33, v32, s34
    v_perm_b32 v73, v35, v34, s34
    v_perm_b32 v74, v37, v36, s34
    v_perm_b32 v75, v39, v38, s34
    v_perm_b32 v76, v41, v40, s34
    v_perm_b32 v77, v43, v42, s34
    v_perm_b32 v92, v17, v16, s35
    v_perm_b32 v93, v19, v18, s35
    v_perm_b32 v94, v21, v20, s35
    v_perm_b32 v95, v23, v22, s35
    v_perm_b32 v96, v25, v24, s35
    v_perm_b32 v97, v27, v26, s35
    v_perm_b32 v98, v29, v28, s35
    v_perm_b32 v99, v31, v30, s35
    v_perm_b32 v100, v33, v32, s35
    v_perm_b32 v101, v35, v34, s35
    v_perm_b32 v102, v37, v36, s35
    v_perm_b32 v103, v39, v38, s35
    v_perm_b32 v104, v41, v40, s35
    v_perm_b32 v105, v43, v42, s35
    s_add_u32 s36, s37, 28672
    buffer_load_dword v16, v4, s[76:79], s36 offen
    s_add_u32 s36, s37, 29696
    buffer_load_dword v17, v4, s[76:79], s36 offen
    s_add_u32 s36, s37, 30720
    buffer_load_dword v18, v4, s[76:79], s36 offen
    s_add_u32 s36, s37, 31744
    buffer_load_dword v19, v4, s[76:79], s36 offen
    s_add_u32 s36, s37, 32768
    buffer_load_dword v20, v4, s[76:79], s36 offen
    s_add_u32 s36, s37, 33792
    buffer_load_dword v21, v4, s[76:79], s36 offen
    s_add_u32 s36, s37, 34816
    buffer_load_dword v22, v4, s[76:79], s36 offen
    s_add_u32 s36, s37, 35840
    buffer_load_dword v23, v4, s[76:79], s36 offen
    s_add_u32 s36, s37, 36864
    buffer_load_dword v24, v4, s[76:79], s36 offen
    s_add_u32 s36, s37, 37888
    buffer_load_dword v25, v4, s[76:79], s36 offen
    s_add_u32 s36, s37, 38912
    buffer_load_dword v26, v4, s[76:79], s36 offen
    s_add_u32 s36, s37, 39936
    buffer_load_dword v27, v4, s[76:79], s36 offen
    s_add_u32 s36, s37, 40960
    buffer_load_dword v28, v4, s[76:79], s36 offen
    s_add_u32 s36, s37, 41984
    buffer_load_dword v29, v4, s[76:79], s36 offen
    s_add_u32 s36, s37, 43008
    buffer_load_dword v30, v4, s[76:79], s36 offen
    s_add_u32 s36, s37, 44032
    buffer_load_dword v31, v4, s[76:79], s36 offen
    s_add_u32 s36, s37, 45056
    buffer_load_dword v32, v4, s[76:79], s36 offen
    s_add_u32 s36, s37, 46080
    buffer_load_dword v33, v4, s[76:79], s36 offen
    s_add_u32 s36, s37, 47104
    buffer_load_dword v34, v4, s[76:79], s36 offen
    s_add_u32 s36, s37, 48128
    buffer_load_dword v35, v4, s[76:79], s36 offen
    s_add_u32 s36, s37, 49152
    buffer_load_dword v36, v4, s[76:79], s36 offen
    s_add_u32 s36, s37, 50176
    buffer_load_dword v37, v4, s[76:79], s36 offen
    s_add_u32 s36, s37, 51200
    buffer_load_dword v38, v4, s[76:79], s36 offen
    s_add_u32 s36, s37, 52224
    buffer_load_dword v39, v4, s[76:79], s36 offen
    s_add_u32 s36, s37, 53248
    buffer_load_dword v40, v4, s[76:79], s36 offen
    s_add_u32 s36, s37, 54272
    buffer_load_dword v41, v4, s[76:79], s36 offen
    s_add_u32 s36, s37, 55296
    buffer_load_dword v42, v4, s[76:79], s36 offen
    s_add_u32 s36, s37, 56320
    buffer_load_dword v43, v4, s[76:79], s36 offen
    s_waitcnt vmcnt(0)
    v_perm_b32 v78, v17, v16, s34
    v_perm_b32 v79, v19, v18, s34
    v_perm_b32 v80, v21, v20, s34
    v_perm_b32 v81, v23, v22, s34
    v_perm_b32 v82, v25, v24, s34
    v_perm_b32 v83, v27, v26, s34
    v_perm_b32 v84, v29, v28, s34
    v_perm_b32 v85, v31, v30, s34
    v_perm_b32 v86, v33, v32, s34
    v_perm_b32 v87, v35, v34, s34
    v_perm_b32 v88, v37, v36, s34
    v_perm_b32 v89, v39, v38, s34
    v_perm_b32 v90, v41, v40, s34
    v_perm_b32 v91, v43, v42, s34
    v_perm_b32 v106, v17, v16, s35
    v_perm_b32 v107, v19, v18, s35
    v_perm_b32 v108, v21, v20, s35
    v_perm_b32 v109, v23, v22, s35
    v_perm_b32 v110, v25, v24, s35
    v_perm_b32 v111, v27, v26, s35
    v_perm_b32 v112, v29, v28, s35
    v_perm_b32 v113, v31, v30, s35
    v_perm_b32 v114, v33, v32, s35
    v_perm_b32 v115, v35, v34, s35
    v_perm_b32 v116, v37, v36, s35
    v_perm_b32 v117, v39, v38, s35
    v_perm_b32 v118, v41, v40, s35
    v_perm_b32 v119, v43, v42, s35
    s_mov_b32 s42, 0xffff0000
    s_mov_b32 s24, 0
    s_mov_b64 s[28:29], 0
    v_mov_b32 v12, 0x40000000
    v_mov_b32 v13, 0
    v_lshlrev_b32 v3, 4, v0
L_M06_rp:
    s_mov_b32 s36, 0x19a000
    buffer_load_dwordx4 v[40:43], v3, s[8:11], s36 offen sc1
    s_add_u32 s32, s32, 1
    v_mov_b32 v5, 0
    s_waitcnt vmcnt(0)
    v_max3_u32 v5, v5, v40, v41
    v_max3_u32 v5, v5, v42, v43
    s_cmp_gt_u32 s32, 200000
    s_cbranch_scc1 L_M06_rp_ok
    v_cmp_eq_u32 vcc, -1, v5
    s_cbranch_vccz L_M06_rp_ok
    s_sleep 32
    s_branch L_M06_rp
L_M06_rp_ok:
    v_add_f32 v40, v40, v41
    v_add_f32 v42, v42, v43
    v_add_f32 v40, v40, v42
    v_cvt_pk_bf16_f32 v5, v40, v40
    v_lshlrev_b32 v40, 16, v5
    v_ashrrev_i32 v5, 31, v40
    v_or_b32 v5, 0x80000000, v5
    v_xor_b32 v5, v5, v40
    v_and_b32 v5, 0xffff0000, v5
    v_sub_u32 v6, 511, v0
    v_or_b32 v126, v5, v6
    v_lshlrev_b32 v3, 4, v0
L_M01_rp:
    s_mov_b32 s36, 0x195000
    buffer_load_dwordx4 v[20:23], v3, s[8:11], s36 offen sc1
    s_mov_b32 s36, 0x196000
    buffer_load_dwordx4 v[24:27], v3, s[8:11], s36 offen sc1
    s_mov_b32 s36, 0x197000
    buffer_load_dwordx4 v[28:31], v3, s[8:11], s36 offen sc1
    s_mov_b32 s36, 0x198000
    buffer_load_dwordx4 v[32:35], v3, s[8:11], s36 offen sc1
    s_mov_b32 s36, 0x199000
    buffer_load_dwordx4 v[36:39], v3, s[8:11], s36 offen sc1
    s_add_u32 s32, s32, 1
    v_mov_b32 v5, 0
    s_waitcnt vmcnt(0)
    v_max3_u32 v5, v5, v20, v21
    v_max3_u32 v5, v5, v22, v23
    v_max3_u32 v5, v5, v24, v25
    v_max3_u32 v5, v5, v26, v27
    v_max3_u32 v5, v5, v28, v29
    v_max3_u32 v5, v5, v30, v31
    v_max3_u32 v5, v5, v32, v33
    v_max3_u32 v5, v5, v34, v35
    v_max3_u32 v5, v5, v36, v37
    v_max3_u32 v5, v5, v38, v39
    s_cmp_gt_u32 s32, 200000
    s_cbranch_scc1 L_M01_rp_ok
    v_cmp_eq_u32 vcc, -1, v5
    s_cbranch_vccz L_M01_rp_ok
    s_sleep 8
    s_branch L_M01_rp
L_M01_rp_ok:
    v_add_f32 v20, v20, v21
    v_add_f32 v22, v22, v23
    v_add_f32 v20, v20, v22
    v_cvt_pk_bf16_f32 v5, v20, v20
    v_lshlrev_b32 v20, 16, v5
    v_ashrrev_i32 v5, 31, v20
    v_or_b32 v5, 0x80000000, v5
    v_xor_b32 v5, v5, v20
    v_and_b32 v5, 0xffff0000, v5
    v_sub_u32 v6, 1791, v0
    v_or_b32 v121, v5, v6
    v_add_f32 v24, v24, v25
    v_add_f32 v26, v26, v27
    v_add_f32 v24, v24, v26
    v_cvt_pk_bf16_f32 v5, v24, v24
    v_lshlrev_b32 v24, 16, v5
    v_ashrrev_i32 v5, 31, v24
    v_or_b32 v5, 0x80000000, v5
    v_xor_b32 v5, v5, v24
    v_and_b32 v5, 0xffff0000, v5
    v_sub_u32 v6, 1535, v0
    v_or_b32 v122, v5, v6
    v_add_f32 v28, v28, v29
    v_add_f32 v30, v30, v31
    v_add_f32 v28, v28, v30
    v_cvt_pk_bf16_f32 v5, v28, v28
    v_lshlrev_b32 v28, 16, v5
    v_ashrrev_i32 v5, 31, v28
    v_or_b32 v5, 0x80000000, v5
    v_xor_b32 v5, v5, v28
    v_and_b32 v5, 0xffff0000, v5
    v_sub_u32 v6, 1279, v0
    v_or_b32 v123, v5, v6
    v_add_f32 v32, v32, v33
    v_add_f32 v34, v34, v35
    v_add_f32 v32, v32, v34
    v_cvt_pk_bf16_f32 v5, v32, v32
    v_lshlrev_b32 v32, 16, v5
    v_ashrrev_i32 v5, 31, v32
    v_or_b32 v5, 0x80000000, v5
    v_xor_b32 v5, v5, v32
    v_and_b32 v5, 0xffff0000, v5
    v_sub_u32 v6, 1023, v0
    v_or_b32 v124, v5, v6
    v_add_f32 v36, v36, v37
    v_add_f32 v38, v38, v39
    v_add_f32 v36, v36, v38
    v_cvt_pk_bf16_f32 v5, v36, v36
    v_lshlrev_b32 v36, 16, v5
    v_ashrrev_i32 v5, 31, v36
    v_or_b32 v5, 0x80000000, v5
    v_xor_b32 v5, v5, v36
    v_and_b32 v5, 0xffff0000, v5
    v_sub_u32 v6, 767, v0
    v_or_b32 v125, v5, v6
    v_max_u32 v5, v120, v121
    v_min_u32 v6, v120, v121
    v_med3_u32 v6, v5, v6, v122
    v_max_u32 v5, v5, v122
    v_med3_u32 v6, v5, v6, v123
    v_max_u32 v5, v5, v123
    v_med3_u32 v6, v5, v6, v124
    v_max_u32 v5, v5, v124
    v_med3_u32 v6, v5, v6, v125
    v_max_u32 v5, v5, v125
    v_med3_u32 v6, v5, v6, v126
    v_max_u32 v5, v5, v126
    v_mov_b32 v120, v5
    v_mov_b32 v121, v6
    s_mov_b32 s25, 32
L_M_round:
    v_lshlrev_b32 v3, 4, v0
    v_cmp_gt_u32 s[74:75], s25, v0
L_M7_rp:
    s_mov_b32 s36, 0x19b000
    buffer_load_dwordx4 v[44:47], v3, s[8:11], s36 offen sc1
    s_add_u32 s32, s32, 1
    v_mov_b32 v5, 0
    s_waitcnt vmcnt(0)
    v_max3_u32 v5, v5, v44, v45
    v_max3_u32 v5, v5, v46, v47
    v_cndmask_b32 v5, 0, v5, s[74:75]
    s_cmp_gt_u32 s32, 200000
    s_cbranch_scc1 L_M7_rp_ok
    v_cmp_eq_u32 vcc, -1, v5
    s_cbranch_vccnz L_M7_rp
L_M7_rp_ok:
    v_add_f32 v44, v44, v45
    v_add_f32 v46, v46, v47
    v_add_f32 v44, v44, v46
    v_cvt_pk_bf16_f32 v5, v44, v44
    v_lshlrev_b32 v44, 16, v5
    v_ashrrev_i32 v5, 31, v44
    v_or_b32 v5, 0x80000000, v5
    v_xor_b32 v5, v5, v44
    v_and_b32 v5, 0xffff0000, v5
    v_sub_u32 v6, 255, v0
    v_or_b32 v127, v5, v6
    v_cndmask_b32 v127, 0, v127, s[74:75]
    v_max_u32 v5, v120, v127
    v_med3_u32 v6, v120, v121, v127
    s_nop 0
    v_mov_b32_dpp v7, v5 quad_perm:[1,0,3,2] row_mask:0xf bank_mask:0xf
    v_mov_b32_dpp v8, v6 quad_perm:[1,0,3,2] row_mask:0xf bank_mask:0xf
    v_min_u32 v9, v5, v7
    v_max_u32 v5, v5, v7
    v_max3_u32 v6, v6, v8, v9
    s_nop 0
    v_mov_b32_dpp v7, v5 quad_perm:[2,3,0,1] row_mask:0xf bank_mask:0xf
    v_mov_b32_dpp v8, v6 quad_perm:[2,3,0,1] row_mask:0xf bank_mask:0xf
    v_min_u32 v9, v5, v7
    v_max_u32 v5, v5, v7
    v_max3_u32 v6, v6, v8, v9
    s_nop 0
    v_mov_b32_dpp v7, v5 row_half_mirror row_mask:0xf bank_mask:0xf
    v_mov_b32_dpp v8, v6 row_half_mirror row_mask:0xf bank_mask:0xf
    v_min_u32 v9, v5, v7
    v_max_u32 v5, v5, v7
    v_max3_u32 v6, v6, v8, v9
    s_nop 0
    v_mov_b32_dpp v7, v5 row_mirror row_mask:0xf bank_mask:0xf
    v_mov_b32_dpp v8, v6 row_mirror row_mask:0xf bank_mask:0xf
    v_min_u32 v9, v5, v7
    v_max_u32 v5, v5, v7
    v_max3_u32 v6, v6, v8, v9
    v_lshrrev_b32 v9, 4, v0
    v_lshlrev_b32 v9, 3, v9
    s_barrier
    ds_write2_b32 v9, v5, v6 offset0:0 offset1:1
    v_and_b32 v9, 15, v0
    v_lshlrev_b32 v9, 3, v9
    s_waitcnt lgkmcnt(0)
    s_barrier
    ds_read2_b32 v[10:11], v9 offset0:0 offset1:1
    s_waitcnt lgkmcnt(0)
    v_mov_b32 v5, v10
    v_mov_b32 v6, v11
    s_nop 0
    v_mov_b32_dpp v7, v5 quad_perm:[1,0,3,2] row_mask:0xf bank_mask:0xf
    v_mov_b32_dpp v8, v6 quad_perm:[1,0,3,2] row_mask:0xf bank_mask:0xf
    v_min_u32 v9, v5, v7
    v_max_u32 v5, v5, v7
    v_max3_u32 v6, v6, v8, v9
    s_nop 0
    v_mov_b32_dpp v7, v5 quad_perm:[2,3,0,1] row_mask:0xf bank_mask:0xf
    v_mov_b32_dpp v8, v6 quad_perm:[2,3,0,1] row_mask:0xf bank_mask:0xf
    v_min_u32 v9, v5, v7
    v_max_u32 v5, v5, v7
    v_max3_u32 v6, v6, v8, v9
    s_nop 0
    v_mov_b32_dpp v7, v5 row_half_mirror row_mask:0xf bank_mask:0xf
    v_mov_b32_dpp v8, v6 row_half_mirror row_mask:0xf bank_mask:0xf
    v_min_u32 v9, v5, v7
    v_max_u32 v5, v5, v7
    v_max3_u32 v6, v6, v8, v9
    s_nop 0
    v_mov_b32_dpp v7, v5 row_mirror row_mask:0xf bank_mask:0xf
    v_mov_b32_dpp v8, v6 row_mirror row_mask:0xf bank_mask:0xf
    v_min_u32 v9, v5, v7
    v_max_u32 v5, v5, v7
    v_max3_u32 v6, v6, v8, v9
    v_readfirstlane_b32 s26, v5
    v_readfirstlane_b32 s27, v6
    s_nop 3
    s_cmp_eq_u64 s[26:27], s[28:29]
    s_cbranch_scc1 L_M_next
    s_mov_b64 s[28:29], s[26:27]
    buffer_store_dword v13, v12, s[60:63], 0 offen sc1
    s_and_b32 s36, s26, 0x7ff
    s_sub_u32 s30, 2047, s36
    s_and_b32 s36, s26, 0xffff0000
    s_xor_b32 s37, s36, 0x80000000
    s_xor_b32 s40, s36, 0xffff0000
    s_bitcmp1_b32 s36, 31
    s_cselect_b32 s40, s37, s40
    s_and_b32 s36, s27, 0x7ff
    s_sub_u32 s31, 2047, s36
    s_and_b32 s36, s27, 0xffff0000
    s_xor_b32 s37, s36, 0x80000000
    s_xor_b32 s41, s36, 0xffff0000
    s_bitcmp1_b32 s36, 31
    s_cselect_b32 s41, s37, s41
    v_mov_b32 v8, 0
L_M_rows:
    s_lshl_b32 s36, s30, 4
    s_add_u32 s36, s36, 0x1b8000
    buffer_load_dwordx4 v[16:19], v8, s[8:11], s36 offen sc1
    s_lshl_b32 s36, s31, 4
    s_add_u32 s36, s36, 0x1b8000
    buffer_load_dwordx4 v[20:23], v8, s[8:11], s36 offen sc1
    s_add_u32 s32, s32, 1
    s_cmp_gt_u32 s32, 200000
    s_waitcnt vmcnt(0)
    v_or3_b32 v5, v16, v17, v18
    v_or3_b32 v5, v5, v19, v20
    v_or3_b32 v5, v5, v21, v22
    v_or_b32 v5, v5, v23
    s_cbranch_scc1 L_M_rows_ok
    v_cmp_ne_u32 vcc, 0, v5
    s_cbranch_vccnz L_M_rows
L_M_rows_ok:
    v_bfe_u32 v9, v0, 6, 1
    v_cmp_ne_u32 vcc, 0, v9
    v_mov_b32 v5, s30
    v_mov_b32 v6, s31
    v_cndmask_b32 v7, v5, v6, vcc
    v_lshlrev_b32 v7, 10, v7
    v_and_b32 v8, 63, v0
    v_lshl_add_u32 v7, v8, 4, v7
    s_mov_b32 s37, 0x600000
    buffer_load_dwordx4 v[16:19], v7, s[8:11], s37 offen sc1
    v_bfe_u32 v9, v0, 3, 1
    v_cmp_ne_u32 vcc, 0, v9
    s_nop 1
    v_cndmask_b32 v12, v5, v6, vcc
    v_mov_b32 v5, s40
    v_mov_b32 v6, s41
    v_cndmask_b32 v11, v5, v6, vcc
    v_lshlrev_b32 v12, 10, v12
    v_and_b32 v3, 7, v0
    v_lshl_add_u32 v12, v3, 2, v12
    s_lshl_b32 s36, s20, 5
    v_add_u32 v12, s36, v12
    v_mov_b32 v7, 0x40000000
    v_cmp_lt_u32 vcc, 15, v0
    s_nop 1
    v_cndmask_b32 v12, v12, v7, vcc
    s_mov_b32 s36, 0x400000
    buffer_load_dword v14, v12, s[8:11], s36 offen sc1
    buffer_load_dword v15, v12, s[8:11], s37 offen sc1
    v_and_b32 v8, 127, v0
    v_lshlrev_b32 v8, 4, v8
    s_waitcnt vmcnt(2)
    ds_write_b128 v8, v[16:19] offset:4096
    s_waitcnt lgkmcnt(0)
    s_barrier
    v_mov_b64 v[48:49], 0
    v_mov_b64 v[50:51], 0
    v_mov_b64 v[52:53], 0
    v_mov_b64 v[54:55], 0
    v_lshlrev_b32 v8, 7, v1
    ds_read_b128 v[16:19], v8 offset:4096
    ds_read_b128 v[20:23], v8 offset:4112
    ds_read_b128 v[24:27], v8 offset:4128
    ds_read_b128 v[28:31], v8 offset:4144
    ds_read_b128 v[32:35], v8 offset:5120
    ds_read_b128 v[36:39], v8 offset:5136
    ds_read_b128 v[40:43], v8 offset:5152
    ds_read_b128 v[44:47], v8 offset:5168
    s_waitcnt lgkmcnt(0)
    v_dot2_f32_bf16 v48, v16, v128, v48
    v_dot2_f32_bf16 v49, v16, v160, v49
    v_dot2_f32_bf16 v50, v32, v128, v50
    v_dot2_f32_bf16 v51, v32, v160, v51
    v_dot2_f32_bf16 v52, v16, v192, v52
    v_dot2_f32_bf16 v53, v16, v224, v53
    v_dot2_f32_bf16 v54, v32, v192, v54
    v_dot2_f32_bf16 v55, v32, v224, v55
    v_dot2_f32_bf16 v48, v17, v129, v48
    v_dot2_f32_bf16 v49, v17, v161, v49
    v_dot2_f32_bf16 v50, v33, v129, v50
    v_dot2_f32_bf16 v51, v33, v161, v51
    v_dot2_f32_bf16 v52, v17, v193, v52
    v_dot2_f32_bf16 v53, v17, v225, v53
    v_dot2_f32_bf16 v54, v33, v193, v54
    v_dot2_f32_bf16 v55, v33, v225, v55
    v_dot2_f32_bf16 v48, v18, v130, v48
    v_dot2_f32_bf16 v49, v18, v162, v49
    v_dot2_f32_bf16 v50, v34, v130, v50
    v_dot2_f32_bf16 v51, v34, v162, v51
    v_dot2_f32_bf16 v52, v18, v194, v52
    v_dot2_f32_bf16 v53, v18, v226, v53
    v_dot2_f32_bf16 v54, v34, v194, v54
    v_dot2_f32_bf16 v55, v34, v226, v55
    v_dot2_f32_bf16 v48, v19, v131, v48
    v_dot2_f32_bf16 v49, v19, v163, v49
    v_dot2_f32_bf16 v50, v35, v131, v50
    v_dot2_f32_bf16 v51, v35, v163, v51
    v_dot2_f32_bf16 v52, v19, v195, v52
    v_dot2_f32_bf16 v53, v19, v227, v53
    v_dot2_f32_bf16 v54, v35, v195, v54
    v_dot2_f32_bf16 v55, v35, v227, v55
    v_dot2_f32_bf16 v48, v20, v132, v48
    v_dot2_f32_bf16 v49, v20, v164, v49
    v_dot2_f32_bf16 v50, v36, v132, v50
    v_dot2_f32_bf16 v51, v36, v164, v51
    v_dot2_f32_bf16 v52, v20, v196, v52
    v_dot2_f32_bf16 v53, v20, v228, v53
    v_dot2_f32_bf16 v54, v36, v196, v54
    v_dot2_f32_bf16 v55, v36, v228, v55
    v_dot2_f32_bf16 v48, v21, v133, v48
    v_dot2_f32_bf16 v49, v21, v165, v49
    v_dot2_f32_bf16 v50, v37, v133, v50
    v_dot2_f32_bf16 v51, v37, v165, v51
    v_dot2_f32_bf16 v52, v21, v197, v52
    v_dot2_f32_bf16 v53, v21, v229, v53
    v_dot2_f32_bf16 v54, v37, v197, v54
    v_dot2_f32_bf16 v55, v37, v229, v55
    v_dot2_f32_bf16 v48, v22, v134, v48
    v_dot2_f32_bf16 v49, v22, v166, v49
    v_dot2_f32_bf16 v50, v38, v134, v50
    v_dot2_f32_bf16 v51, v38, v166, v51
    v_dot2_f32_bf16 v52, v22, v198, v52
    v_dot2_f32_bf16 v53, v22, v230, v53
    v_dot2_f32_bf16 v54, v38, v198, v54
    v_dot2_f32_bf16 v55, v38, v230, v55
    v_dot2_f32_bf16 v48, v23, v135, v48
    v_dot2_f32_bf16 v49, v23, v167, v49
    v_dot2_f32_bf16 v50, v39, v135, v50
    v_dot2_f32_bf16 v51, v39, v167, v51
    v_dot2_f32_bf16 v52, v23, v199, v52
    v_dot2_f32_bf16 v53, v23, v231, v53
    v_dot2_f32_bf16 v54, v39, v199, v54
    v_dot2_f32_bf16 v55, v39, v231, v55
    v_dot2_f32_bf16 v48, v24, v136, v48
    v_dot2_f32_bf16 v49, v24, v168, v49
    v_dot2_f32_bf16 v50, v40, v136, v50
    v_dot2_f32_bf16 v51, v40, v168, v51
    v_dot2_f32_bf16 v52, v24, v200, v52
    v_dot2_f32_bf16 v53, v24, v232, v53
    v_dot2_f32_bf16 v54, v40, v200, v54
    v_dot2_f32_bf16 v55, v40, v232, v55
    v_dot2_f32_bf16 v48, v25, v137, v48
    v_dot2_f32_bf16 v49, v25, v169, v49
    v_dot2_f32_bf16 v50, v41, v137, v50
    v_dot2_f32_bf16 v51, v41, v169, v51
    v_dot2_f32_bf16 v52, v25, v201, v52
    v_dot2_f32_bf16 v53, v25, v233, v53
    v_dot2_f32_bf16 v54, v41, v201, v54
    v_dot2_f32_bf16 v55, v41, v233, v55
    v_dot2_f32_bf16 v48, v26, v138, v48
    v_dot2_f32_bf16 v49, v26, v170, v49
    v_dot2_f32_bf16 v50, v42, v138, v50
    v_dot2_f32_bf16 v51, v42, v170, v51
    v_dot2_f32_bf16 v52, v26, v202, v52
    v_dot2_f32_bf16 v53, v26, v234, v53
    v_dot2_f32_bf16 v54, v42, v202, v54
    v_dot2_f32_bf16 v55, v42, v234, v55
    v_dot2_f32_bf16 v48, v27, v139, v48
    v_dot2_f32_bf16 v49, v27, v171, v49
    v_dot2_f32_bf16 v50, v43, v139, v50
    v_dot2_f32_bf16 v51, v43, v171, v51
    v_dot2_f32_bf16 v52, v27, v203, v52
    v_dot2_f32_bf16 v53, v27, v235, v53
    v_dot2_f32_bf16 v54, v43, v203, v54
    v_dot2_f32_bf16 v55, v43, v235, v55
    v_dot2_f32_bf16 v48, v28, v140, v48
    v_dot2_f32_bf16 v49, v28, v172, v49
    v_dot2_f32_bf16 v50, v44, v140, v50
    v_dot2_f32_bf16 v51, v44, v172, v51
    v_dot2_f32_bf16 v52, v28, v204, v52
    v_dot2_f32_bf16 v53, v28, v236, v53
    v_dot2_f32_bf16 v54, v44, v204, v54
    v_dot2_f32_bf16 v55, v44, v236, v55
    v_dot2_f32_bf16 v48, v29, v141, v48
    v_dot2_f32_bf16 v49, v29, v173, v49
    v_dot2_f32_bf16 v50, v45, v141, v50
    v_dot2_f32_bf16 v51, v45, v173, v51
    v_dot2_f32_bf16 v52, v29, v205, v52
    v_dot2_f32_bf16 v53, v29, v237, v53
    v_dot2_f32_bf16 v54, v45, v205, v54
    v_dot2_f32_bf16 v55, v45, v237, v55
    v_dot2_f32_bf16 v48, v30, v142, v48
    v_dot2_f32_bf16 v49, v30, v174, v49
    v_dot2_f32_bf16 v50, v46, v142, v50
    v_dot2_f32_bf16 v51, v46, v174, v51
    v_dot2_f32_bf16 v52, v30, v206, v52
    v_dot2_f32_bf16 v53, v30, v238, v53
    v_dot2_f32_bf16 v54, v46, v206, v54
    v_dot2_f32_bf16 v55, v46, v238, v55
    v_dot2_f32_bf16 v48, v31, v143, v48
    v_dot2_f32_bf16 v49, v31, v175, v49
    v_dot2_f32_bf16 v50, v47, v143, v50
    v_dot2_f32_bf16 v51, v47, v175, v51
    v_dot2_f32_bf16 v52, v31, v207, v52
    v_dot2_f32_bf16 v53, v31, v239, v53
    v_dot2_f32_bf16 v54, v47, v207, v54
    v_dot2_f32_bf16 v55, v47, v239, v55
    ds_read_b128 v[16:19], v8 offset:4160
    ds_read_b128 v[20:23], v8 offset:4176
    ds_read_b128 v[24:27], v8 offset:4192
    ds_read_b128 v[28:31], v8 offset:4208
    ds_read_b128 v[32:35], v8 offset:5184
    ds_read_b128 v[36:39], v8 offset:5200
    ds_read_b128 v[40:43], v8 offset:5216
    ds_read_b128 v[44:47], v8 offset:5232
    s_waitcnt lgkmcnt(0)
    v_dot2_f32_bf16 v48, v16, v144, v48
    v_dot2_f32_bf16 v49, v16, v176, v49
    v_dot2_f32_bf16 v50, v32, v144, v50
    v_dot2_f32_bf16 v51, v32, v176, v51
    v_dot2_f32_bf16 v52, v16, v208, v52
    v_dot2_f32_bf16 v53, v16, v240, v53
    v_dot2_f32_bf16 v54, v32, v208, v54
    v_dot2_f32_bf16 v55, v32, v240, v55
    v_dot2_f32_bf16 v48, v17, v145, v48
    v_dot2_f32_bf16 v49, v17, v177, v49
    v_dot2_f32_bf16 v50, v33, v145, v50
    v_dot2_f32_bf16 v51, v33, v177, v51
    v_dot2_f32_bf16 v52, v17, v209, v52
    v_dot2_f32_bf16 v53, v17, v241, v53
    v_dot2_f32_bf16 v54, v33, v209, v54
    v_dot2_f32_bf16 v55, v33, v241, v55
    v_dot2_f32_bf16 v48, v18, v146, v48
    v_dot2_f32_bf16 v49, v18, v178, v49
    v_dot2_f32_bf16 v50, v34, v146, v50
    v_dot2_f32_bf16 v51, v34, v178, v51
    v_dot2_f32_bf16 v52, v18, v210, v52
    v_dot2_f32_bf16 v53, v18, v242, v53
    v_dot2_f32_bf16 v54, v34, v210, v54
    v_dot2_f32_bf16 v55, v34, v242, v55
    v_dot2_f32_bf16 v48, v19, v147, v48
    v_dot2_f32_bf16 v49, v19, v179, v49
    v_dot2_f32_bf16 v50, v35, v147, v50
    v_dot2_f32_bf16 v51, v35, v179, v51
    v_dot2_f32_bf16 v52, v19, v211, v52
    v_dot2_f32_bf16 v53, v19, v243, v53
    v_dot2_f32_bf16 v54, v35, v211, v54
    v_dot2_f32_bf16 v55, v35, v243, v55
    v_dot2_f32_bf16 v48, v20, v148, v48
    v_dot2_f32_bf16 v49, v20, v180, v49
    v_dot2_f32_bf16 v50, v36, v148, v50
    v_dot2_f32_bf16 v51, v36, v180, v51
    v_dot2_f32_bf16 v52, v20, v212, v52
    v_dot2_f32_bf16 v53, v20, v244, v53
    v_dot2_f32_bf16 v54, v36, v212, v54
    v_dot2_f32_bf16 v55, v36, v244, v55
    v_dot2_f32_bf16 v48, v21, v149, v48
    v_dot2_f32_bf16 v49, v21, v181, v49
    v_dot2_f32_bf16 v50, v37, v149, v50
    v_dot2_f32_bf16 v51, v37, v181, v51
    v_dot2_f32_bf16 v52, v21, v213, v52
    v_dot2_f32_bf16 v53, v21, v245, v53
    v_dot2_f32_bf16 v54, v37, v213, v54
    v_dot2_f32_bf16 v55, v37, v245, v55
    v_dot2_f32_bf16 v48, v22, v150, v48
    v_dot2_f32_bf16 v49, v22, v182, v49
    v_dot2_f32_bf16 v50, v38, v150, v50
    v_dot2_f32_bf16 v51, v38, v182, v51
    v_dot2_f32_bf16 v52, v22, v214, v52
    v_dot2_f32_bf16 v53, v22, v246, v53
    v_dot2_f32_bf16 v54, v38, v214, v54
    v_dot2_f32_bf16 v55, v38, v246, v55
    v_dot2_f32_bf16 v48, v23, v151, v48
    v_dot2_f32_bf16 v49, v23, v183, v49
    v_dot2_f32_bf16 v50, v39, v151, v50
    v_dot2_f32_bf16 v51, v39, v183, v51
    v_dot2_f32_bf16 v52, v23, v215, v52
    v_dot2_f32_bf16 v53, v23, v247, v53
    v_dot2_f32_bf16 v54, v39, v215, v54
    v_dot2_f32_bf16 v55, v39, v247, v55
    v_dot2_f32_bf16 v48, v24, v152, v48
    v_dot2_f32_bf16 v49, v24, v184, v49
    v_dot2_f32_bf16 v50, v40, v152, v50
    v_dot2_f32_bf16 v51, v40, v184, v51
    v_dot2_f32_bf16 v52, v24, v216, v52
    v_dot2_f32_bf16 v53, v24, v248, v53
    v_dot2_f32_bf16 v54, v40, v216, v54
    v_dot2_f32_bf16 v55, v40, v248, v55
    v_dot2_f32_bf16 v48, v25, v153, v48
    v_dot2_f32_bf16 v49, v25, v185, v49
    v_dot2_f32_bf16 v50, v41, v153, v50
    v_dot2_f32_bf16 v51, v41, v185, v51
    v_dot2_f32_bf16 v52, v25, v217, v52
    v_dot2_f32_bf16 v53, v25, v249, v53
    v_dot2_f32_bf16 v54, v41, v217, v54
    v_dot2_f32_bf16 v55, v41, v249, v55
    v_dot2_f32_bf16 v48, v26, v154, v48
    v_dot2_f32_bf16 v49, v26, v186, v49
    v_dot2_f32_bf16 v50, v42, v154, v50
    v_dot2_f32_bf16 v51, v42, v186, v51
    v_dot2_f32_bf16 v52, v26, v218, v52
    v_dot2_f32_bf16 v53, v26, v250, v53
    v_dot2_f32_bf16 v54, v42, v218, v54
    v_dot2_f32_bf16 v55, v42, v250, v55
    v_dot2_f32_bf16 v48, v27, v155, v48
    v_dot2_f32_bf16 v49, v27, v187, v49
    v_dot2_f32_bf16 v50, v43, v155, v50
    v_dot2_f32_bf16 v51, v43, v187, v51
    v_dot2_f32_bf16 v52, v27, v219, v52
    v_dot2_f32_bf16 v53, v27, v251, v53
    v_dot2_f32_bf16 v54, v43, v219, v54
    v_dot2_f32_bf16 v55, v43, v251, v55
    v_dot2_f32_bf16 v48, v28, v156, v48
    v_dot2_f32_bf16 v49, v28, v188, v49
    v_dot2_f32_bf16 v50, v44, v156, v50
    v_dot2_f32_bf16 v51, v44, v188, v51
    v_dot2_f32_bf16 v52, v28, v220, v52
    v_dot2_f32_bf16 v53, v28, v252, v53
    v_dot2_f32_bf16 v54, v44, v220, v54
    v_dot2_f32_bf16 v55, v44, v252, v55
    v_dot2_f32_bf16 v48, v29, v157, v48
    v_dot2_f32_bf16 v49, v29, v189, v49
    v_dot2_f32_bf16 v50, v45, v157, v50
    v_dot2_f32_bf16 v51, v45, v189, v51
    v_dot2_f32_bf16 v52, v29, v221, v52
    v_dot2_f32_bf16 v53, v29, v253, v53
    v_dot2_f32_bf16 v54, v45, v221, v54
    v_dot2_f32_bf16 v55, v45, v253, v55
    v_dot2_f32_bf16 v48, v30, v158, v48
    v_dot2_f32_bf16 v49, v30, v190, v49
    v_dot2_f32_bf16 v50, v46, v158, v50
    v_dot2_f32_bf16 v51, v46, v190, v51
    v_dot2_f32_bf16 v52, v30, v222, v52
    v_dot2_f32_bf16 v53, v30, v254, v53
    v_dot2_f32_bf16 v54, v46, v222, v54
    v_dot2_f32_bf16 v55, v46, v254, v55
    v_dot2_f32_bf16 v48, v31, v159, v48
    v_dot2_f32_bf16 v49, v31, v191, v49
    v_dot2_f32_bf16 v50, v47, v159, v50
    v_dot2_f32_bf16 v51, v47, v191, v51
    v_dot2_f32_bf16 v52, v31, v223, v52
    v_dot2_f32_bf16 v53, v31, v255, v53
    v_dot2_f32_bf16 v54, v47, v223, v54
    v_dot2_f32_bf16 v55, v47, v255, v55
    s_nop 3
    v_lshlrev_b32 v7, 5, v0
    ds_write_b128 v7, v[48:51] offset:8192
    ds_write_b128 v7, v[52:55] offset:8208
    s_waitcnt lgkmcnt(0)
    s_barrier
    v_lshlrev_b32 v7, 5, v2
    v_bfe_u32 v8, v0, 5, 1
    v_lshl_add_u32 v7, v8, 3, v7
    ds_read_b64 v[16:17], v7 offset:8192
    ds_read_b64 v[18:19], v7 offset:8208
    ds_read_b64 v[20:21], v7 offset:9216
    ds_read_b64 v[22:23], v7 offset:9232
    ds_read_b64 v[24:25], v7 offset:10240
    ds_read_b64 v[26:27], v7 offset:10256
    ds_read_b64 v[28:29], v7 offset:11264
    ds_read_b64 v[30:31], v7 offset:11280
    s_waitcnt lgkmcnt(0)
    ds_read_b64 v[32:33], v7 offset:12288
    ds_read_b64 v[34:35], v7 offset:12304
    ds_read_b64 v[36:37], v7 offset:13312
    ds_read_b64 v[38:39], v7 offset:13328
    ds_read_b64 v[40:41], v7 offset:14336
    ds_read_b64 v[42:43], v7 offset:14352
    ds_read_b64 v[44:45], v7 offset:15360
    ds_read_b64 v[46:47], v7 offset:15376
    s_waitcnt lgkmcnt(0)
    v_add_f32 v16, v16, v20
    v_add_f32 v16, v16, v24
    v_add_f32 v16, v16, v28
    v_add_f32 v16, v16, v32
    v_add_f32 v16, v16, v36
    v_add_f32 v16, v16, v40
    v_add_f32 v16, v16, v44
    v_cvt_pk_bf16_f32 v5, v16, v16
    v_lshlrev_b32 v16, 16, v5
    v_add_f32 v17, v17, v21
    v_add_f32 v17, v17, v25
    v_add_f32 v17, v17, v29
    v_add_f32 v17, v17, v33
    v_add_f32 v17, v17, v37
    v_add_f32 v17, v17, v41
    v_add_f32 v17, v17, v45
    v_cvt_pk_bf16_f32 v5, v17, v17
    v_lshlrev_b32 v17, 16, v5
    v_add_f32 v18, v18, v22
    v_add_f32 v18, v18, v26
    v_add_f32 v18, v18, v30
    v_add_f32 v18, v18, v34
    v_add_f32 v18, v18, v38
    v_add_f32 v18, v18, v42
    v_add_f32 v18, v18, v46
    v_cvt_pk_bf16_f32 v5, v18, v18
    v_lshlrev_b32 v18, 16, v5
    v_add_f32 v19, v19, v23
    v_add_f32 v19, v19, v27
    v_add_f32 v19, v19, v31
    v_add_f32 v19, v19, v35
    v_add_f32 v19, v19, v39
    v_add_f32 v19, v19, v43
    v_add_f32 v19, v19, v47
    v_cvt_pk_bf16_f32 v5, v19, v19
    v_lshlrev_b32 v19, 16, v5
    v_mul_f32 v6, 0xbfb8aa3b, v16
    v_exp_f32 v6, v6
    s_nop 0
    v_add_f32 v6, 1.0, v6
    v_rcp_f32 v6, v6
    s_nop 0
    v_mul_f32 v16, v16, v6
    v_cvt_pk_bf16_f32 v5, v16, v16
    v_lshlrev_b32 v16, 16, v5
    v_mul_f32 v16, v16, v18
    v_mul_f32 v6, 0xbfb8aa3b, v17
    v_exp_f32 v6, v6
    s_nop 0
    v_add_f32 v6, 1.0, v6
    v_rcp_f32 v6, v6
    s_nop 0
    v_mul_f32 v17, v17, v6
    v_cvt_pk_bf16_f32 v5, v17, v17
    v_lshlrev_b32 v17, 16, v5
    v_mul_f32 v17, v17, v19
    v_cvt_pk_bf16_f32 v16, v16, v17
    v_mul_u32_u24 v8, 3584, v8
    v_lshl_add_u32 v7, v2, 2, v8
    v_mov_b32 v6, 0x40000000
    v_cmp_lt_u32 vcc, 27, v2
    s_nop 1
    v_cndmask_b32 v7, v7, v6, vcc
    v_cmp_lt_u32 vcc, 63, v0
    s_nop 1
    v_cndmask_b32 v7, v7, v6, vcc
    s_mul_i32 s37, s24, 8192
    s_add_u32 s37, s37, 0x1b0000
    s_add_u32 s36, s37, s23
    buffer_store_dword v16, v7, s[8:11], s36 offen sc1
    v_lshlrev_b32 v7, 4, v0
    v_add_u32 v8, 4096, v7
    v_cmp_lt_u32 vcc, 191, v0
    s_nop 1
    v_cndmask_b32 v8, v8, v6, vcc
L_M_act:
    buffer_load_dwordx4 v[20:23], v7, s[8:11], s37 offen sc1
    buffer_load_dwordx4 v[24:27], v8, s[8:11], s37 offen sc1
    s_add_u32 s32, s32, 1
    s_cmp_gt_u32 s32, 200000
    s_waitcnt vmcnt(0)
    v_max3_u32 v5, v20, v21, v22
    v_max3_u32 v5, v5, v23, v24
    v_max3_u32 v5, v5, v25, v26
    v_max_u32 v5, v5, v27
    s_cbranch_scc1 L_M_act_ok
    v_cmp_eq_u32 vcc, -1, v5
    s_cbranch_vccnz L_M_act
L_M_act_ok:
    ds_write_b128 v7, v[20:23] offset:16384
    ds_write_b128 v7, v[24:27] offset:20480
    s_waitcnt lgkmcnt(0)
    s_barrier
    v_lshrrev_b32 v7, 3, v0
    v_mul_u32_u24 v7, 112, v7
    v_mov_b64 v[48:49], 0
    v_mov_b64 v[50:51], 0
    ds_read_b128 v[16:19], v7 offset:16384
    ds_read_b128 v[20:23], v7 offset:16400
    ds_read_b128 v[24:27], v7 offset:16416
    ds_read_b128 v[28:31], v7 offset:16432
    ds_read_b128 v[32:35], v7 offset:16448
    ds_read_b128 v[36:39], v7 offset:16464
    ds_read_b128 v[40:43], v7 offset:16480
    s_waitcnt lgkmcnt(0)
    v_dot2_f32_bf16 v48, v16, v64, v48
    v_dot2_f32_bf16 v49, v16, v92, v49
    v_dot2_f32_bf16 v48, v17, v65, v48
    v_dot2_f32_bf16 v49, v17, v93, v49
    v_dot2_f32_bf16 v48, v18, v66, v48
    v_dot2_f32_bf16 v49, v18, v94, v49
    v_dot2_f32_bf16 v48, v19, v67, v48
    v_dot2_f32_bf16 v49, v19, v95, v49
    v_dot2_f32_bf16 v48, v20, v68, v48
    v_dot2_f32_bf16 v49, v20, v96, v49
    v_dot2_f32_bf16 v48, v21, v69, v48
    v_dot2_f32_bf16 v49, v21, v97, v49
    v_dot2_f32_bf16 v48, v22, v70, v48
    v_dot2_f32_bf16 v49, v22, v98, v49
    v_dot2_f32_bf16 v48, v23, v71, v48
    v_dot2_f32_bf16 v49, v23, v99, v49
    v_dot2_f32_bf16 v48, v24, v72, v48
    v_dot2_f32_bf16 v49, v24, v100, v49
    v_dot2_f32_bf16 v48, v25, v73, v48
    v_dot2_f32_bf16 v49, v25, v101, v49
    v_dot2_f32_bf16 v48, v26, v74, v48
    v_dot2_f32_bf16 v49, v26, v102, v49
    v_dot2_f32_bf16 v48, v27, v75, v48
    v_dot2_f32_bf16 v49, v27, v103, v49
    v_dot2_f32_bf16 v48, v28, v76, v48
    v_dot2_f32_bf16 v49, v28, v104, v49
    v_dot2_f32_bf16 v48, v29, v77, v48
    v_dot2_f32_bf16 v49, v29, v105, v49
    v_dot2_f32_bf16 v48, v30, v78, v48
    v_dot2_f32_bf16 v49, v30, v106, v49
    v_dot2_f32_bf16 v48, v31, v79, v48
    v_dot2_f32_bf16 v49, v31, v107, v49
    v_dot2_f32_bf16 v48, v32, v80, v48
    v_dot2_f32_bf16 v49, v32, v108, v49
    v_dot2_f32_bf16 v48, v33, v81, v48
    v_dot2_f32_bf16 v49, v33, v109, v49
    v_dot2_f32_bf16 v48, v34, v82, v48
    v_dot2_f32_bf16 v49, v34, v110, v49
    v_dot2_f32_bf16 v48, v35, v83, v48
    v_dot2_f32_bf16 v49, v35, v111, v49
    v_dot2_f32_bf16 v48, v36, v84, v48
    v_dot2_f32_bf16 v49, v36, v112, v49
    v_dot2_f32_bf16 v48, v37, v85, v48
    v_dot2_f32_bf16 v49, v37, v113, v49
    v_dot2_f32_bf16 v48, v38, v86, v48
    v_dot2_f32_bf16 v49, v38, v114, v49
    v_dot2_f32_bf16 v48, v39, v87, v48
    v_dot2_f32_bf16 v49, v39, v115, v49
    v_dot2_f32_bf16 v48, v40, v88, v48
    v_dot2_f32_bf16 v49, v40, v116, v49
    v_dot2_f32_bf16 v48, v41, v89, v48
    v_dot2_f32_bf16 v49, v41, v117, v49
    v_dot2_f32_bf16 v48, v42, v90, v48
    v_dot2_f32_bf16 v49, v42, v118, v49
    v_dot2_f32_bf16 v48, v43, v91, v48
    v_dot2_f32_bf16 v49, v43, v119, v49
    ds_read_b128 v[16:19], v7 offset:19968
    ds_read_b128 v[20:23], v7 offset:19984
    ds_read_b128 v[24:27], v7 offset:20000
    ds_read_b128 v[28:31], v7 offset:20016
    ds_read_b128 v[32:35], v7 offset:20032
    ds_read_b128 v[36:39], v7 offset:20048
    ds_read_b128 v[40:43], v7 offset:20064
    s_waitcnt lgkmcnt(0)
    v_dot2_f32_bf16 v50, v16, v64, v50
    v_dot2_f32_bf16 v51, v16, v92, v51
    v_dot2_f32_bf16 v50, v17, v65, v50
    v_dot2_f32_bf16 v51, v17, v93, v51
    v_dot2_f32_bf16 v50, v18, v66, v50
    v_dot2_f32_bf16 v51, v18, v94, v51
    v_dot2_f32_bf16 v50, v19, v67, v50
    v_dot2_f32_bf16 v51, v19, v95, v51
    v_dot2_f32_bf16 v50, v20, v68, v50
    v_dot2_f32_bf16 v51, v20, v96, v51
    v_dot2_f32_bf16 v50, v21, v69, v50
    v_dot2_f32_bf16 v51, v21, v97, v51
    v_dot2_f32_bf16 v50, v22, v70, v50
    v_dot2_f32_bf16 v51, v22, v98, v51
    v_dot2_f32_bf16 v50, v23, v71, v50
    v_dot2_f32_bf16 v51, v23, v99, v51
    v_dot2_f32_bf16 v50, v24, v72, v50
    v_dot2_f32_bf16 v51, v24, v100, v51
    v_dot2_f32_bf16 v50, v25, v73, v50
    v_dot2_f32_bf16 v51, v25, v101, v51
    v_dot2_f32_bf16 v50, v26, v74, v50
    v_dot2_f32_bf16 v51, v26, v102, v51
    v_dot2_f32_bf16 v50, v27, v75, v50
    v_dot2_f32_bf16 v51, v27, v103, v51
    v_dot2_f32_bf16 v50, v28, v76, v50
    v_dot2_f32_bf16 v51, v28, v104, v51
    v_dot2_f32_bf16 v50, v29, v77, v50
    v_dot2_f32_bf16 v51, v29, v105, v51
    v_dot2_f32_bf16 v50, v30, v78, v50
    v_dot2_f32_bf16 v51, v30, v106, v51
    v_dot2_f32_bf16 v50, v31, v79, v50
    v_dot2_f32_bf16 v51, v31, v107, v51
    v_dot2_f32_bf16 v50, v32, v80, v50
    v_dot2_f32_bf16 v51, v32, v108, v51
    v_dot2_f32_bf16 v50, v33, v81, v50
    v_dot2_f32_bf16 v51, v33, v109, v51
    v_dot2_f32_bf16 v50, v34, v82, v50
    v_dot2_f32_bf16 v51, v34, v110, v51
    v_dot2_f32_bf16 v50, v35, v83, v50
    v_dot2_f32_bf16 v51, v35, v111, v51
    v_dot2_f32_bf16 v50, v36, v84, v50
    v_dot2_f32_bf16 v51, v36, v112, v51
    v_dot2_f32_bf16 v50, v37, v85, v50
    v_dot2_f32_bf16 v51, v37, v113, v51
    v_dot2_f32_bf16 v50, v38, v86, v50
    v_dot2_f32_bf16 v51, v38, v114, v51
    v_dot2_f32_bf16 v50, v39, v87, v50
    v_dot2_f32_bf16 v51, v39, v115, v51
    v_dot2_f32_bf16 v50, v40, v88, v50
    v_dot2_f32_bf16 v51, v40, v116, v51
    v_dot2_f32_bf16 v50, v41, v89, v50
    v_dot2_f32_bf16 v51, v41, v117, v51
    v_dot2_f32_bf16 v50, v42, v90, v50
    v_dot2_f32_bf16 v51, v42, v118, v51
    v_dot2_f32_bf16 v50, v43, v91, v50
    v_dot2_f32_bf16 v51, v43, v119, v51
    s_nop 3
    v_add_f32_dpp v48, v48, v48 row_ror:8 row_mask:0xf bank_mask:0xf
    v_add_f32_dpp v49, v49, v49 row_ror:8 row_mask:0xf bank_mask:0xf
    v_add_f32_dpp v50, v50, v50 row_ror:8 row_mask:0xf bank_mask:0xf
    v_add_f32_dpp v51, v51, v51 row_ror:8 row_mask:0xf bank_mask:0xf
    v_mov_b32 v5, v48
    s_nop 1
    v_permlane16_swap_b32 v48, v5
    v_add_f32 v48, v48, v5
    v_mov_b32 v5, v49
    s_nop 1
    v_permlane16_swap_b32 v49, v5
    v_add_f32 v49, v49, v5
    v_mov_b32 v5, v50
    s_nop 1
    v_permlane16_swap_b32 v50, v5
    v_add_f32 v50, v50, v5
    v_mov_b32 v5, v51
    s_nop 1
    v_permlane16_swap_b32 v51, v5
    v_add_f32 v51, v51, v5
    v_mov_b32 v5, v48
    s_nop 1
    v_permlane32_swap_b32 v48, v5
    v_add_f32 v48, v48, v5
    v_mov_b32 v5, v49
    s_nop 1
    v_permlane32_swap_b32 v49, v5
    v_add_f32 v49, v49, v5
    v_mov_b32 v5, v50
    s_nop 1
    v_permlane32_swap_b32 v50, v5
    v_add_f32 v50, v50, v5
    v_mov_b32 v5, v51
    s_nop 1
    v_permlane32_swap_b32 v51, v5
    v_add_f32 v51, v51, v5
    v_lshrrev_b32 v7, 6, v0
    v_lshlrev_b32 v7, 7, v7
    v_lshl_add_u32 v7, v3, 4, v7
    ds_write_b128 v7, v[48:51] offset:1024
    s_waitcnt lgkmcnt(0)
    s_barrier
    v_lshlrev_b32 v7, 4, v3
    v_lshl_add_u32 v7, v9, 3, v7
    ds_read_b64 v[16:17], v7 offset:1024
    ds_read_b64 v[18:19], v7 offset:1152
    ds_read_b64 v[20:21], v7 offset:1280
    ds_read_b64 v[22:23], v7 offset:1408
    v_mul_f32 v10, 0xbfb8aa3b, v11
    v_exp_f32 v10, v10
    s_nop 0
    v_add_f32 v10, 1.0, v10
    v_rcp_f32 v10, v10
    s_nop 0
    v_cvt_pk_bf16_f32 v5, v10, v10
    v_lshlrev_b32 v10, 16, v5
    s_waitcnt lgkmcnt(0)
    v_lshlrev_b32 v24, 16, v15
    v_and_b32 v25, 0xffff0000, v15
    v_lshlrev_b32 v26, 16, v14
    v_and_b32 v27, 0xffff0000, v14
    v_add_f32 v16, v16, v18
    v_add_f32 v20, v20, v22
    v_add_f32 v16, v16, v20
    v_cvt_pk_bf16_f32 v5, v16, v16
    v_lshlrev_b32 v16, 16, v5
    v_mul_f32 v16, v16, v10
    v_cvt_pk_bf16_f32 v5, v16, v16
    v_lshlrev_b32 v16, 16, v5
    v_add_f32 v16, v16, v24
    v_cvt_pk_bf16_f32 v5, v16, v16
    v_lshlrev_b32 v16, 16, v5
    v_add_f32 v16, v16, v26
    v_add_f32 v17, v17, v19
    v_add_f32 v21, v21, v23
    v_add_f32 v17, v17, v21
    v_cvt_pk_bf16_f32 v5, v17, v17
    v_lshlrev_b32 v17, 16, v5
    v_mul_f32 v17, v17, v10
    v_cvt_pk_bf16_f32 v5, v17, v17
    v_lshlrev_b32 v17, 16, v5
    v_add_f32 v17, v17, v25
    v_cvt_pk_bf16_f32 v5, v17, v17
    v_lshlrev_b32 v17, 16, v5
    v_add_f32 v17, v17, v27
    v_cvt_pk_bf16_f32 v16, v16, v17
    buffer_store_dword v16, v12, s[60:63], 0 offen sc1
    v_add_f32 v24, v24, v26
    v_add_f32 v25, v25, v27
    v_cvt_pk_bf16_f32 v13, v24, v25
L_M_next:
    s_add_u32 s24, s24, 1
    s_mov_b32 s25, 192
    s_cmp_eq_u32 s24, 1
    s_cbranch_scc1 L_M_round
    s_cmp_eq_u32 s24, 3
    s_cbranch_scc1 L_end
    s_mov_b32 s25, 256
    v_and_b32 v7, 63, v0
    v_lshlrev_b32 v3, 4, v7
    s_mov_b32 s36, 0x19bc00
    v_sub_u32 v7, 63, v7
L_M_fin:
    buffer_load_dwordx4 v[16:19], v3, s[8:11], s36 offen sc1
    s_add_u32 s32, s32, 1
    s_cmp_gt_u32 s32, 200000
    s_cselect_b32 s37, -1, -2
    s_waitcnt vmcnt(0)
    v_max3_u32 v5, v16, v17, v18
    v_max_u32 v5, v5, v19
    v_cmp_lt_u32 vcc, s37, v5
    s_cbranch_vccnz L_M_fin
    v_add_f32 v16, v16, v17
    v_add_f32 v18, v18, v19
    v_add_f32 v16, v16, v18
    v_cvt_pk_bf16_f32 v5, v16, v16
    v_lshlrev_b32 v16, 16, v5
    v_ashrrev_i32 v5, 31, v16
    v_or_b32 v5, 0x80000000, v5
    v_xor_b32 v5, v5, v16
    v_and_or_b32 v5, v5, s42, v7
    v_cmp_lt_u32 vcc, s29, v5
    s_cbranch_vccnz L_M_round
L_end:
    s_endpgm
.section .rodata,"a"
.p2align 6
.amdhsa_kernel sequential_preLN__memory_aug_recurrent_mem_tr__moe_arch_mod__prompt_kernel
  .amdhsa_next_free_vgpr 512
  .amdhsa_next_free_sgpr 102
  .amdhsa_accum_offset 256
  .amdhsa_group_segment_fixed_size 0
  .amdhsa_kernarg_size 120
  .amdhsa_user_sgpr_count 2
  .amdhsa_user_sgpr_kernarg_segment_ptr 1
  .amdhsa_system_sgpr_workgroup_id_x 1
.end_amdhsa_kernel
```

```asm
; @launch grid=(256,1,1) block=(256,1,1) lds=163840
.amdgcn_target "amdgcn-amd-amdhsa--gfx950"
.text
.globl sequential_preLN__memory_aug_recurrent_mem_tr__moe_arch_mod__prompt_kernel
.p2align 8
.type sequential_preLN__memory_aug_recurrent_mem_tr__moe_arch_mod__prompt_kernel,@function
sequential_preLN__memory_aug_recurrent_mem_tr__moe_arch_mod__prompt_kernel:
    s_cmp_ge_u32 s2, 256
    s_cbranch_scc1 L_end
    s_load_dwordx8 s[44:51], s[0:1], 0
    s_load_dwordx4 s[52:55], s[0:1], 32
    s_load_dwordx4 s[56:59], s[0:1], 104
    s_load_dwordx2 s[80:81], s[0:1], 64
    s_load_dwordx2 s[82:83], s[0:1], 96
    s_load_dwordx4 s[84:87], s[0:1], 72
    s_load_dwordx2 s[88:89], s[0:1], 88
    v_lshrrev_b32 v1, 6, v0
    s_nop 0
    v_readfirstlane_b32 s21, v1
    s_waitcnt lgkmcnt(0)
    s_mov_b32 s8, s58
    s_and_b32 s9, s59, 0xffff
    s_mov_b32 s10, 0x10000000
    s_mov_b32 s11, 0x20000
    s_mov_b32 s16, s56
    s_and_b32 s17, s57, 0xffff
    s_mov_b32 s18, 0x100
    s_mov_b32 s19, 0x20000
    s_and_b32 s3, s2, 7
    s_cmp_lg_u32 s3, 0
    s_cbranch_scc1 L_worker
    s_lshr_b32 s20, s2, 3
    v_lshrrev_b32 v28, 4, v0
    v_and_b32 v16, 15, v0
    v_lshlrev_b32 v16, 4, v16
    v_lshl_add_u32 v16, v28, 13, v16
    v_bfe_u32 v29, v0, 4, 1
    v_lshlrev_b32 v29, 5, v29
    v_xor_b32 v16, v16, v29
    v_and_b32 v29, 192, v0
    v_xor_b32 v16, v16, v29
    s_lshl_b32 s28, s21, 10
    s_lshl_b32 s3, s20, 8
    s_mov_b32 s60, s52
    s_and_b32 s61, s53, 0xffff
    s_mov_b32 s62, 0x400000
    s_mov_b32 s63, 0x20000
    s_add_u32 m0, s28, 32768
    s_add_u32 s37, s3, 0x0
    buffer_load_dwordx4 v16, s[60:63], s37 offen lds
    s_add_u32 m0, s28, 36864
    s_add_u32 s37, s3, 0x20000
    buffer_load_dwordx4 v16, s[60:63], s37 offen lds
    s_add_u32 m0, s28, 65536
    s_add_u32 s37, s3, 0x40000
    buffer_load_dwordx4 v16, s[60:63], s37 offen lds
    s_add_u32 m0, s28, 69632
    s_add_u32 s37, s3, 0x60000
    buffer_load_dwordx4 v16, s[60:63], s37 offen lds
    s_add_u32 m0, s28, 98304
    s_add_u32 s37, s3, 0x80000
    buffer_load_dwordx4 v16, s[60:63], s37 offen lds
    s_add_u32 m0, s28, 102400
    s_add_u32 s37, s3, 0xa0000
    buffer_load_dwordx4 v16, s[60:63], s37 offen lds
    s_add_u32 m0, s28, 131072
    s_add_u32 s37, s3, 0xc0000
    buffer_load_dwordx4 v16, s[60:63], s37 offen lds
    s_add_u32 m0, s28, 135168
    s_add_u32 s37, s3, 0xe0000
    buffer_load_dwordx4 v16, s[60:63], s37 offen lds
    s_add_u32 m0, s28, 40960
    s_add_u32 s37, s3, 0x100000
    buffer_load_dwordx4 v16, s[60:63], s37 offen lds
    s_add_u32 m0, s28, 45056
    s_add_u32 s37, s3, 0x120000
    buffer_load_dwordx4 v16, s[60:63], s37 offen lds
    s_add_u32 m0, s28, 73728
    s_add_u32 s37, s3, 0x140000
    buffer_load_dwordx4 v16, s[60:63], s37 offen lds
    s_add_u32 m0, s28, 77824
    s_add_u32 s37, s3, 0x160000
    buffer_load_dwordx4 v16, s[60:63], s37 offen lds
    s_add_u32 m0, s28, 106496
    s_add_u32 s37, s3, 0x180000
    buffer_load_dwordx4 v16, s[60:63], s37 offen lds
    s_add_u32 m0, s28, 110592
    s_add_u32 s37, s3, 0x1a0000
    buffer_load_dwordx4 v16, s[60:63], s37 offen lds
    s_add_u32 m0, s28, 139264
    s_add_u32 s37, s3, 0x1c0000
    buffer_load_dwordx4 v16, s[60:63], s37 offen lds
    s_add_u32 m0, s28, 143360
    s_add_u32 s37, s3, 0x1e0000
    buffer_load_dwordx4 v16, s[60:63], s37 offen lds
    s_add_u32 m0, s28, 49152
    s_add_u32 s37, s3, 0x200000
    buffer_load_dwordx4 v16, s[60:63], s37 offen lds
    s_add_u32 m0, s28, 53248
    s_add_u32 s37, s3, 0x220000
    buffer_load_dwordx4 v16, s[60:63], s37 offen lds
    s_add_u32 m0, s28, 81920
    s_add_u32 s37, s3, 0x240000
    buffer_load_dwordx4 v16, s[60:63], s37 offen lds
    s_add_u32 m0, s28, 86016
    s_add_u32 s37, s3, 0x260000
    buffer_load_dwordx4 v16, s[60:63], s37 offen lds
    s_add_u32 m0, s28, 114688
    s_add_u32 s37, s3, 0x280000
    buffer_load_dwordx4 v16, s[60:63], s37 offen lds
    s_add_u32 m0, s28, 118784
    s_add_u32 s37, s3, 0x2a0000
    buffer_load_dwordx4 v16, s[60:63], s37 offen lds
    s_add_u32 m0, s28, 147456
    s_add_u32 s37, s3, 0x2c0000
    buffer_load_dwordx4 v16, s[60:63], s37 offen lds
    s_add_u32 m0, s28, 151552
    s_add_u32 s37, s3, 0x2e0000
    buffer_load_dwordx4 v16, s[60:63], s37 offen lds
    v_mov_b32 v20, 0x0
    v_bfe_u32 v14, v0, 0, 1
    s_mov_b32 s38, 0x8
    v_mad_u32_u24 v20, v14, s38, v20
    v_bfe_u32 v14, v0, 1, 1
    s_mov_b32 s38, 0x10
    v_mad_u32_u24 v20, v14, s38, v20
    v_bfe_u32 v14, v0, 2, 1
    s_mov_b32 s38, 0x100
    v_mad_u32_u24 v20, v14, s38, v20
    v_bfe_u32 v14, v0, 3, 1
    s_mov_b32 s38, 0x800
    v_mad_u32_u24 v20, v14, s38, v20
    v_bfe_u32 v14, v0, 4, 1
    s_mov_b32 s38, 0x400
    v_mad_u32_u24 v20, v14, s38, v20
    v_bfe_u32 v14, v0, 5, 1
    s_mov_b32 s38, 0x1000
    v_mad_u32_u24 v20, v14, s38, v20
    v_mov_b32 v30, 0x0
    v_bfe_u32 v14, v0, 2, 1
    s_mov_b32 s38, 0x20
    v_mad_u32_u24 v30, v14, s38, v30
    v_bfe_u32 v14, v0, 3, 1
    s_mov_b32 s38, 0x80
    v_mad_u32_u24 v30, v14, s38, v30
    v_bfe_u32 v14, v0, 4, 1
    s_mov_b32 s38, 0x40
    v_mad_u32_u24 v30, v14, s38, v30
    v_mov_b32 v31, 0x0
    v_bfe_u32 v14, v0, 6, 1
    s_mov_b32 s38, 0x40
    v_mad_u32_u24 v31, v14, s38, v31
    v_bfe_u32 v14, v0, 7, 1
    s_mov_b32 s38, 0x80
    v_mad_u32_u24 v31, v14, s38, v31
    v_xor_b32 v30, v30, v31
    v_add_u32 v30, v30, v20
    s_xor_b32 s36, s21, 0
    s_add_u32 s36, s36, 1
    s_lshl_b32 s36, s36, 15
    v_add_u32 v20, s36, v30
    v_xor_b32 v21, 32, v20
    s_xor_b32 s36, s21, 1
    s_add_u32 s36, s36, 1
    s_lshl_b32 s36, s36, 15
    v_add_u32 v22, s36, v30
    v_xor_b32 v23, 32, v22
    s_xor_b32 s36, s21, 2
    s_add_u32 s36, s36, 1
    s_lshl_b32 s36, s36, 15
    v_add_u32 v24, s36, v30
    v_xor_b32 v25, 32, v24
    s_xor_b32 s36, s21, 3
    s_add_u32 s36, s36, 1
    s_lshl_b32 s36, s36, 15
    v_add_u32 v26, s36, v30
    v_xor_b32 v27, 32, v26
    v_mov_b32 v11, 0x0
    v_bfe_u32 v14, v0, 0, 1
    s_mov_b32 s38, 0x4
    v_mad_u32_u24 v11, v14, s38, v11
    v_bfe_u32 v14, v0, 1, 1
    s_mov_b32 s38, 0x8
    v_mad_u32_u24 v11, v14, s38, v11
    v_bfe_u32 v14, v0, 2, 1
    s_mov_b32 s38, 0x10
    v_mad_u32_u24 v11, v14, s38, v11
    v_bfe_u32 v14, v0, 3, 1
    s_mov_b32 s38, 0x20
    v_mad_u32_u24 v11, v14, s38, v11
    v_bfe_u32 v14, v0, 4, 1
    s_mov_b32 s38, 0x800
    v_mad_u32_u24 v11, v14, s38, v11
    v_bfe_u32 v14, v0, 5, 1
    s_mov_b32 s38, 0x1000
    v_mad_u32_u24 v11, v14, s38, v11
    v_bfe_u32 v14, v0, 6, 1
    s_mov_b32 s38, 0x100
    v_mad_u32_u24 v11, v14, s38, v11
    v_bfe_u32 v14, v0, 7, 1
    s_mov_b32 s38, 0x200
    v_mad_u32_u24 v11, v14, s38, v11
    s_mov_b32 s92, s54
    s_and_b32 s93, s55, 0xffff
    s_mov_b32 s94, 0x400000
    s_mov_b32 s95, 0x20000
    s_lshl_b32 s29, s20, 17
    s_xor_b32 s36, s21, 3
    s_lshl_b32 s36, s36, 15
    s_add_u32 s36, s36, s29
    s_add_u32 s37, s36, 0x80
    buffer_load_dword v32, v11, s[92:95], s37 offen
    s_add_u32 s37, s36, 0x4080
    buffer_load_dword v33, v11, s[92:95], s37 offen
    s_add_u32 s37, s36, 0x480
    buffer_load_dword v34, v11, s[92:95], s37 offen
    s_add_u32 s37, s36, 0x4480
    buffer_load_dword v35, v11, s[92:95], s37 offen
    s_add_u32 s37, s36, 0x2080
    buffer_load_dword v36, v11, s[92:95], s37 offen
    s_add_u32 s37, s36, 0x6080
    buffer_load_dword v37, v11, s[92:95], s37 offen
    s_add_u32 s37, s36, 0x2480
    buffer_load_dword v38, v11, s[92:95], s37 offen
    s_add_u32 s37, s36, 0x6480
    buffer_load_dword v39, v11, s[92:95], s37 offen
    s_add_u32 s37, s36, 0xc0
    buffer_load_dword v40, v11, s[92:95], s37 offen
    s_add_u32 s37, s36, 0x40c0
    buffer_load_dword v41, v11, s[92:95], s37 offen
    s_add_u32 s37, s36, 0x4c0
    buffer_load_dword v42, v11, s[92:95], s37 offen
    s_add_u32 s37, s36, 0x44c0
    buffer_load_dword v43, v11, s[92:95], s37 offen
    s_add_u32 s37, s36, 0x20c0
    buffer_load_dword v44, v11, s[92:95], s37 offen
    s_add_u32 s37, s36, 0x60c0
    buffer_load_dword v45, v11, s[92:95], s37 offen
    s_add_u32 s37, s36, 0x24c0
    buffer_load_dword v46, v11, s[92:95], s37 offen
    s_add_u32 s37, s36, 0x64c0
    buffer_load_dword v47, v11, s[92:95], s37 offen
    s_getreg_b32 s36, hwreg(HW_REG_XCC_ID)
    s_and_b32 s36, s36, 15
    s_or_b32 s36, s36, 0x100
    v_mov_b32 v30, s36
    s_lshl_b32 s37, s20, 2
    v_lshlrev_b32 v31, 20, v0
    buffer_store_dword v30, v31, s[16:19], s37 offen offset:128 sc1
    s_mov_b32 s12, s46
    s_and_b32 s13, s47, 0xffff
    s_mov_b32 s14, 0x2000
    s_mov_b32 s15, 0x20000
    v_mov_b32 v104, 0x0
    v_bfe_u32 v14, v0, 0, 1
    s_mov_b32 s38, 0x8
    v_mad_u32_u24 v104, v14, s38, v104
    v_bfe_u32 v14, v0, 1, 1
    s_mov_b32 s38, 0x10
    v_mad_u32_u24 v104, v14, s38, v104
    v_bfe_u32 v14, v0, 2, 1
    s_mov_b32 s38, 0x10000
    v_mad_u32_u24 v104, v14, s38, v104
    v_bfe_u32 v14, v0, 3, 1
    s_mov_b32 s38, 0x10000
    v_mad_u32_u24 v104, v14, s38, v104
    v_bfe_u32 v14, v0, 4, 1
    s_mov_b32 s38, 0x400
    v_mad_u32_u24 v104, v14, s38, v104
    v_bfe_u32 v14, v0, 5, 1
    s_mov_b32 s38, 0x4
    v_mad_u32_u24 v104, v14, s38, v104
    v_bfe_u32 v14, v0, 6, 1
    s_mov_b32 s38, 0x40
    v_mad_u32_u24 v104, v14, s38, v104
    v_bfe_u32 v14, v0, 7, 1
    s_mov_b32 s38, 0x80
    v_mad_u32_u24 v104, v14, s38, v104
    v_mov_b32 v106, s20
    v_mov_b32 v105, 0x0
    v_bfe_u32 v14, v106, 0, 1
    s_mov_b32 s38, 0x20
    v_mad_u32_u24 v105, v14, s38, v105
    v_bfe_u32 v14, v106, 1, 1
    s_mov_b32 s38, 0x800
    v_mad_u32_u24 v105, v14, s38, v105
    v_bfe_u32 v14, v106, 2, 1
    s_mov_b32 s38, 0x1000
    v_mad_u32_u24 v105, v14, s38, v105
    v_bfe_u32 v14, v106, 3, 1
    s_mov_b32 s38, 0x100
    v_mad_u32_u24 v105, v14, s38, v105
    v_bfe_u32 v14, v106, 4, 1
    s_mov_b32 s38, 0x200
    v_mad_u32_u24 v105, v14, s38, v105
    v_add_u32 v104, v104, v105
    buffer_load_dword v12, v104, s[12:15], 0 offen
    v_mov_b32 v1, 0x4444
    v_bfe_u32 v14, v0, 1, 1
    s_mov_b32 s38, 0xaaaa
    v_mad_u32_u24 v1, v14, s38, v1
    v_mov_b32 v3, 0x0
    v_bfe_u32 v14, v0, 0, 1
    s_mov_b32 s38, 0x10
    v_mad_u32_u24 v3, v14, s38, v3
    v_bfe_u32 v14, v0, 1, 1
    s_mov_b32 s38, 0x20
    v_mad_u32_u24 v3, v14, s38, v3
    v_bfe_u32 v14, v0, 2, 1
    s_mov_b32 s38, 0x40
    v_mad_u32_u24 v3, v14, s38, v3
    v_bfe_u32 v14, v0, 3, 1
    s_mov_b32 s38, 0x80
    v_mad_u32_u24 v3, v14, s38, v3
    v_bfe_u32 v14, v0, 4, 1
    s_mov_b32 s38, 0x100
    v_mad_u32_u24 v3, v14, s38, v3
    v_bfe_u32 v14, v0, 5, 1
    s_mov_b32 s38, 0x200
    v_mad_u32_u24 v3, v14, s38, v3
    v_mov_b32 v2, 0x0
    v_bfe_u32 v14, v0, 0, 1
    s_mov_b32 s38, 0x10
    v_mad_u32_u24 v2, v14, s38, v2
    v_bfe_u32 v14, v0, 1, 1
    s_mov_b32 s38, 0x20
    v_mad_u32_u24 v2, v14, s38, v2
    v_bfe_u32 v14, v0, 2, 1
    s_mov_b32 s38, 0x40
    v_mad_u32_u24 v2, v14, s38, v2
    v_bfe_u32 v14, v0, 3, 1
    s_mov_b32 s38, 0x80
    v_mad_u32_u24 v2, v14, s38, v2
    v_bfe_u32 v14, v0, 4, 1
    s_mov_b32 s38, 0x100
    v_mad_u32_u24 v2, v14, s38, v2
    v_bfe_u32 v14, v0, 5, 1
    s_mov_b32 s38, 0x200
    v_mad_u32_u24 v2, v14, s38, v2
    v_bfe_u32 v14, v0, 6, 1
    s_mov_b32 s38, 0x800
    v_mad_u32_u24 v2, v14, s38, v2
    v_bfe_u32 v14, v0, 7, 1
    s_mov_b32 s38, 0x1000
    v_mad_u32_u24 v2, v14, s38, v2
    v_mov_b32 v4, 0x8000
    v_bfe_u32 v14, v0, 0, 1
    s_mov_b32 s38, 0x10
    v_mad_u32_u24 v4, v14, s38, v4
    v_bfe_u32 v14, v0, 1, 1
    s_mov_b32 s38, 0x20
    v_mad_u32_u24 v4, v14, s38, v4
    v_bfe_u32 v14, v0, 2, 1
    s_mov_b32 s38, 0x40
    v_mad_u32_u24 v4, v14, s38, v4
    v_bfe_u32 v14, v0, 3, 1
    s_mov_b32 s38, 0x80
    v_mad_u32_u24 v4, v14, s38, v4
    v_bfe_u32 v14, v0, 4, 1
    s_mov_b32 s38, 0x100
    v_mad_u32_u24 v4, v14, s38, v4
    v_bfe_u32 v14, v0, 5, 1
    s_mov_b32 s38, 0x200
    v_mad_u32_u24 v4, v14, s38, v4
    v_bfe_u32 v14, v0, 6, 1
    s_mov_b32 s38, 0x8000
    v_mad_u32_u24 v4, v14, s38, v4
    v_bfe_u32 v14, v0, 7, 1
    s_mov_b32 s38, 0x10000
    v_mad_u32_u24 v4, v14, s38, v4
    v_mov_b32 v5, 0x4000
    v_bfe_u32 v14, v0, 0, 1
    s_mov_b32 s38, 0x4
    v_mad_u32_u24 v5, v14, s38, v5
    v_bfe_u32 v14, v0, 1, 1
    s_mov_b32 s38, 0x8
    v_mad_u32_u24 v5, v14, s38, v5
    v_bfe_u32 v14, v0, 2, 1
    s_mov_b32 s38, 0x10
    v_mad_u32_u24 v5, v14, s38, v5
    v_bfe_u32 v14, v0, 3, 1
    s_mov_b32 s38, 0x20
    v_mad_u32_u24 v5, v14, s38, v5
    v_bfe_u32 v14, v0, 4, 1
    s_mov_b32 s38, 0x240
    v_mad_u32_u24 v5, v14, s38, v5
    v_bfe_u32 v14, v0, 5, 1
    s_mov_b32 s38, 0x480
    v_mad_u32_u24 v5, v14, s38, v5
    v_bfe_u32 v14, v0, 6, 1
    s_mov_b32 s38, 0x40
    v_mad_u32_u24 v5, v14, s38, v5
    v_bfe_u32 v14, v0, 7, 1
    s_mov_b32 s38, 0x80
    v_mad_u32_u24 v5, v14, s38, v5
    v_mov_b32 v6, 0x4000
    v_bfe_u32 v14, v0, 0, 1
    s_mov_b32 s38, 0x120
    v_mad_u32_u24 v6, v14, s38, v6
    v_bfe_u32 v14, v0, 2, 1
    s_mov_b32 s38, 0x240
    v_mad_u32_u24 v6, v14, s38, v6
    v_bfe_u32 v14, v0, 3, 1
    s_mov_b32 s38, 0x480
    v_mad_u32_u24 v6, v14, s38, v6
    v_bfe_u32 v14, v0, 4, 1
    s_mov_b32 s38, 0x10
    v_mad_u32_u24 v6, v14, s38, v6
    v_bfe_u32 v14, v0, 5, 1
    s_mov_b32 s38, 0x20
    v_mad_u32_u24 v6, v14, s38, v6
    v_add_u32 v7, 2304, v5
    v_xor_b32 v8, 0x1000, v2
    v_mov_b32 v104, 0x0
    v_bfe_u32 v14, v0, 3, 1
    s_mov_b32 s38, 0x1
    v_mad_u32_u24 v104, v14, s38, v104
    v_bfe_u32 v14, v0, 4, 1
    s_mov_b32 s38, 0x2
    v_mad_u32_u24 v104, v14, s38, v104
    v_bfe_u32 v14, v0, 5, 1
    s_mov_b32 s38, 0x4
    v_mad_u32_u24 v104, v14, s38, v104
    v_bfe_u32 v14, v0, 6, 1
    s_mov_b32 s38, 0x8
    v_mad_u32_u24 v104, v14, s38, v104
    v_bfe_u32 v14, v0, 7, 1
    s_mov_b32 s38, 0x10
    v_mad_u32_u24 v104, v14, s38, v104
    v_add_u32 v104, s20, v104
    v_and_b32 v104, 31, v104
    v_lshlrev_b32 v104, 6, v104
    v_mov_b32 v9, 0x0
    v_bfe_u32 v14, v0, 0, 1
    s_mov_b32 s38, 0x8
    v_mad_u32_u24 v9, v14, s38, v9
    v_bfe_u32 v14, v0, 1, 1
    s_mov_b32 s38, 0x10
    v_mad_u32_u24 v9, v14, s38, v9
    v_bfe_u32 v14, v0, 2, 1
    s_mov_b32 s38, 0x20
    v_mad_u32_u24 v9, v14, s38, v9
    v_bfe_u32 v14, v0, 3, 1
    s_mov_b32 s38, 0x2000
    v_mad_u32_u24 v9, v14, s38, v9
    v_bfe_u32 v14, v0, 4, 1
    s_mov_b32 s38, 0x4000
    v_mad_u32_u24 v9, v14, s38, v9
    v_bfe_u32 v14, v0, 5, 1
    s_mov_b32 s38, 0x8000
    v_mad_u32_u24 v9, v14, s38, v9
    v_bfe_u32 v14, v0, 6, 1
    s_mov_b32 s38, 0x10000
    v_mad_u32_u24 v9, v14, s38, v9
    v_bfe_u32 v14, v0, 7, 1
    s_mov_b32 s38, 0x20000
    v_mad_u32_u24 v9, v14, s38, v9
    v_add_u32 v9, v9, v104
    v_mov_b32 v10, 0x80000
    v_bfe_u32 v14, v0, 0, 1
    s_mov_b32 s38, 0x8
    v_mad_u32_u24 v10, v14, s38, v10
    v_bfe_u32 v14, v0, 1, 1
    s_mov_b32 s38, 0x20
    v_mad_u32_u24 v10, v14, s38, v10
    v_bfe_u32 v14, v0, 4, 1
    s_mov_b32 s38, 0x10
    v_mad_u32_u24 v10, v14, s38, v10
    v_bfe_u32 v14, v0, 5, 1
    s_mov_b32 s38, 0x4
    v_mad_u32_u24 v10, v14, s38, v10
    v_bfe_u32 v14, v0, 6, 1
    s_mov_b32 s38, 0x800
    v_mad_u32_u24 v10, v14, s38, v10
    v_bfe_u32 v14, v0, 7, 1
    s_mov_b32 s38, 0x1000
    v_mad_u32_u24 v10, v14, s38, v10
    v_mov_b32 v105, s20
    v_mov_b32 v104, 0x0
    v_bfe_u32 v14, v105, 0, 1
    s_mov_b32 s38, 0x100
    v_mad_u32_u24 v104, v14, s38, v104
    v_bfe_u32 v14, v105, 1, 1
    s_mov_b32 s38, 0x40
    v_mad_u32_u24 v104, v14, s38, v104
    v_bfe_u32 v14, v105, 2, 1
    s_mov_b32 s38, 0x80
    v_mad_u32_u24 v104, v14, s38, v104
    v_bfe_u32 v14, v105, 3, 1
    s_mov_b32 s38, 0x200
    v_mad_u32_u24 v104, v14, s38, v104
    v_bfe_u32 v14, v105, 4, 1
    s_mov_b32 s38, 0x400
    v_mad_u32_u24 v104, v14, s38, v104
    v_add_u32 v10, v104, v10
    v_and_b32 v104, 12, v0
    v_cmp_ne_u32 vcc, 0, v104
    v_mov_b32 v104, 0x40000000
    s_nop 0
    v_cndmask_b32 v10, v10, v104, vcc
    v_mov_b32 v13, 0x0
    v_bfe_u32 v14, v0, 0, 1
    s_mov_b32 s38, 0x10
    v_mad_u32_u24 v13, v14, s38, v13
    v_bfe_u32 v14, v0, 1, 1
    s_mov_b32 s38, 0x8
    v_mad_u32_u24 v13, v14, s38, v13
    v_bfe_u32 v14, v0, 2, 1
    s_mov_b32 s38, 0x20
    v_mad_u32_u24 v13, v14, s38, v13
    v_bfe_u32 v14, v0, 3, 1
    s_mov_b32 s38, 0x40
    v_mad_u32_u24 v13, v14, s38, v13
    v_bfe_u32 v14, v0, 4, 1
    s_mov_b32 s38, 0x80
    v_mad_u32_u24 v13, v14, s38, v13
    v_bfe_u32 v14, v0, 5, 1
    s_mov_b32 s38, 0x100
    v_mad_u32_u24 v13, v14, s38, v13
    v_bfe_u32 v14, v0, 6, 1
    s_mov_b32 s38, 0x800
    v_mad_u32_u24 v13, v14, s38, v13
    v_bfe_u32 v14, v0, 7, 1
    s_mov_b32 s38, 0x1000
    v_mad_u32_u24 v13, v14, s38, v13
    s_lshl_b32 s6, s20, 13
    s_add_u32 s6, s6, 0x0
    s_mov_b32 s26, 4096
    v_and_b32 v104, 15, v0
    v_mov_b32 v100, 0
    v_mov_b32 v105, 0x3f80
    v_cmp_eq_u32 vcc, 0, v104
    s_nop 1
    v_cndmask_b32 v100, v100, v105, vcc
    v_mov_b32 v105, 0x3f800000
    v_cmp_eq_u32 vcc, 1, v104
    s_nop 1
    v_cndmask_b32 v100, v100, v105, vcc
    v_mov_b32 v101, 0
    v_mov_b32 v105, 0x3f80
    v_cmp_eq_u32 vcc, 4, v104
    s_nop 1
    v_cndmask_b32 v101, v101, v105, vcc
    v_mov_b32 v105, 0x3f800000
    v_cmp_eq_u32 vcc, 5, v104
    s_nop 1
    v_cndmask_b32 v101, v101, v105, vcc
    v_mov_b32 v102, 0
    v_mov_b32 v105, 0x3f80
    v_cmp_eq_u32 vcc, 8, v104
    s_nop 1
    v_cndmask_b32 v102, v102, v105, vcc
    v_mov_b32 v105, 0x3f800000
    v_cmp_eq_u32 vcc, 9, v104
    s_nop 1
    v_cndmask_b32 v102, v102, v105, vcc
    v_mov_b32 v103, 0
    v_mov_b32 v105, 0x3f80
    v_cmp_eq_u32 vcc, 12, v104
    s_nop 1
    v_cndmask_b32 v103, v103, v105, vcc
    v_mov_b32 v105, 0x3f800000
    v_cmp_eq_u32 vcc, 13, v104
    s_nop 1
    v_cndmask_b32 v103, v103, v105, vcc
    ds_write_b128 v3, v[100:103] offset:23040
    s_mov_b32 s34, 0x05040100
    s_mov_b32 s35, 0x07060302
    s_mov_b32 s33, 0x3e0293ee
    s_mov_b32 s40, 0x4e800000
    s_mov_b32 s32, 0
    s_mov_b32 s4, 0x3f803f80
    s_mov_b32 s5, 0x3f803f80
    s_lshl_b32 s36, s20, 14
    s_lshr_b32 s37, s21, 1
    s_lshl_b32 s37, s37, 12
    s_add_u32 s25, s36, s37
    s_lshl_b32 s37, s21, 11
    s_add_u32 s39, s36, s37
    s_add_u32 s39, s39, 8192
    v_mov_b32 v104, 0x0
    v_bfe_u32 v14, v0, 0, 1
    s_mov_b32 s38, 0x80
    v_mad_u32_u24 v104, v14, s38, v104
    v_bfe_u32 v14, v0, 1, 1
    s_mov_b32 s38, 0x100
    v_mad_u32_u24 v104, v14, s38, v104
    v_bfe_u32 v14, v0, 2, 1
    s_mov_b32 s38, 0x200
    v_mad_u32_u24 v104, v14, s38, v104
    v_bfe_u32 v14, v0, 3, 1
    s_mov_b32 s38, 0x400
    v_mad_u32_u24 v104, v14, s38, v104
    v_bfe_u32 v14, v0, 4, 1
    s_mov_b32 s38, 0x800
    v_mad_u32_u24 v104, v14, s38, v104
    v_bfe_u32 v14, v0, 6, 1
    s_mov_b32 s38, 0x1000
    v_mad_u32_u24 v104, v14, s38, v104
    v_bfe_u32 v14, v0, 7, 1
    s_mov_b32 s38, 0x2000
    v_mad_u32_u24 v104, v14, s38, v104
    s_lshl_b32 s36, s20, 14
    v_add_u32 v104, s36, v104
    s_lshl_b32 s36, s20, 8
    s_lshr_b32 s37, s21, 1
    s_lshl_b32 s37, s37, 7
    s_add_u32 s36, s36, s37
    s_add_u32 s36, s36, 0x102100
    v_and_b32 v14, 63, v0
    v_mov_b32 v105, 0x40000000
    v_cmp_lt_u32 vcc, 32, v14
    s_nop 1
    v_cndmask_b32 v104, v104, v105, vcc
    v_mov_b32 v105, s36
    v_cmp_eq_u32 vcc, 32, v14
    s_nop 1
    v_cndmask_b32 v104, v104, v105, vcc
    s_lshl_b32 s36, s20, 2
    s_add_u32 s36, s36, 0x104100
    v_mov_b32 v105, s36
    v_cmp_eq_u32 vcc, 33, v14
    s_nop 1
    v_cndmask_b32 v0, v104, v105, vcc
    s_waitcnt vmcnt(34)
    s_barrier
    ds_read_b64_tr_b16 a[160:161], v20 offset:0
    ds_read_b64_tr_b16 a[162:163], v20 offset:512
    ds_read_b64_tr_b16 a[168:169], v21 offset:0
    ds_read_b64_tr_b16 a[170:171], v21 offset:512
    ds_read_b64_tr_b16 a[192:193], v22 offset:0
    ds_read_b64_tr_b16 a[194:195], v22 offset:512
    ds_read_b64_tr_b16 a[200:201], v23 offset:0
    ds_read_b64_tr_b16 a[202:203], v23 offset:512
    ds_read_b64_tr_b16 a[224:225], v24 offset:0
    ds_read_b64_tr_b16 a[226:227], v24 offset:512
    ds_read_b64_tr_b16 a[232:233], v25 offset:0
    ds_read_b64_tr_b16 a[234:235], v25 offset:512
    s_waitcnt lgkmcnt(4)
    ds_read_b64_tr_b16 v[128:129], v26 offset:0
    ds_read_b64_tr_b16 v[130:131], v26 offset:512
    ds_read_b64_tr_b16 v[136:137], v27 offset:0
    ds_read_b64_tr_b16 v[138:139], v27 offset:512
    s_waitcnt lgkmcnt(0)
    s_barrier
    s_add_u32 m0, s28, 32768
    s_add_u32 s37, s3, 0x300000
    buffer_load_dwordx4 v16, s[60:63], s37 offen lds
    s_add_u32 m0, s28, 36864
    s_add_u32 s37, s3, 0x320000
    buffer_load_dwordx4 v16, s[60:63], s37 offen lds
    s_add_u32 m0, s28, 65536
    s_add_u32 s37, s3, 0x340000
    buffer_load_dwordx4 v16, s[60:63], s37 offen lds
    s_add_u32 m0, s28, 69632
    s_add_u32 s37, s3, 0x360000
    buffer_load_dwordx4 v16, s[60:63], s37 offen lds
    s_add_u32 m0, s28, 98304
    s_add_u32 s37, s3, 0x380000
    buffer_load_dwordx4 v16, s[60:63], s37 offen lds
    s_add_u32 m0, s28, 102400
    s_add_u32 s37, s3, 0x3a0000
    buffer_load_dwordx4 v16, s[60:63], s37 offen lds
    s_add_u32 m0, s28, 131072
    s_add_u32 s37, s3, 0x3c0000
    buffer_load_dwordx4 v16, s[60:63], s37 offen lds
    s_add_u32 m0, s28, 135168
    s_add_u32 s37, s3, 0x3e0000
    buffer_load_dwordx4 v16, s[60:63], s37 offen lds
    s_xor_b32 s36, s21, 2
    s_lshl_b32 s36, s36, 15
    s_add_u32 s36, s36, s29
    s_add_u32 s37, s36, 0x80
    buffer_load_dword v48, v11, s[92:95], s37 offen
    s_add_u32 s37, s36, 0x4080
    buffer_load_dword v49, v11, s[92:95], s37 offen
    s_add_u32 s37, s36, 0x480
    buffer_load_dword v50, v11, s[92:95], s37 offen
    s_add_u32 s37, s36, 0x4480
    buffer_load_dword v51, v11, s[92:95], s37 offen
    s_add_u32 s37, s36, 0x2080
    buffer_load_dword v52, v11, s[92:95], s37 offen
    s_add_u32 s37, s36, 0x6080
    buffer_load_dword v53, v11, s[92:95], s37 offen
    s_add_u32 s37, s36, 0x2480
    buffer_load_dword v54, v11, s[92:95], s37 offen
    s_add_u32 s37, s36, 0x6480
    buffer_load_dword v55, v11, s[92:95], s37 offen
    s_add_u32 s37, s36, 0xc0
    buffer_load_dword v56, v11, s[92:95], s37 offen
    s_add_u32 s37, s36, 0x40c0
    buffer_load_dword v57, v11, s[92:95], s37 offen
    s_add_u32 s37, s36, 0x4c0
    buffer_load_dword v58, v11, s[92:95], s37 offen
    s_add_u32 s37, s36, 0x44c0
    buffer_load_dword v59, v11, s[92:95], s37 offen
    s_add_u32 s37, s36, 0x20c0
    buffer_load_dword v60, v11, s[92:95], s37 offen
    s_add_u32 s37, s36, 0x60c0
    buffer_load_dword v61, v11, s[92:95], s37 offen
    s_add_u32 s37, s36, 0x24c0
    buffer_load_dword v62, v11, s[92:95], s37 offen
    s_add_u32 s37, s36, 0x64c0
    buffer_load_dword v63, v11, s[92:95], s37 offen
    s_waitcnt vmcnt(50)
    s_barrier
    ds_read_b64_tr_b16 a[164:165], v20 offset:8192
    ds_read_b64_tr_b16 a[166:167], v20 offset:8704
    ds_read_b64_tr_b16 a[172:173], v21 offset:8192
    ds_read_b64_tr_b16 a[174:175], v21 offset:8704
    ds_read_b64_tr_b16 a[196:197], v22 offset:8192
    ds_read_b64_tr_b16 a[198:199], v22 offset:8704
    ds_read_b64_tr_b16 a[204:205], v23 offset:8192
    ds_read_b64_tr_b16 a[206:207], v23 offset:8704
    ds_read_b64_tr_b16 a[228:229], v24 offset:8192
    ds_read_b64_tr_b16 a[230:231], v24 offset:8704
    ds_read_b64_tr_b16 a[236:237], v25 offset:8192
    ds_read_b64_tr_b16 a[238:239], v25 offset:8704
    s_waitcnt lgkmcnt(4)
    ds_read_b64_tr_b16 v[132:133], v26 offset:8192
    ds_read_b64_tr_b16 v[134:135], v26 offset:8704
    ds_read_b64_tr_b16 v[140:141], v27 offset:8192
    ds_read_b64_tr_b16 v[142:143], v27 offset:8704
    s_waitcnt lgkmcnt(0)
    s_barrier
    s_mov_b32 s88, s50
    s_and_b32 s89, s51, 0xffff
    s_mov_b32 s90, 0x400000
    s_mov_b32 s91, 0x20000
    s_add_u32 m0, s28, 40960
    s_add_u32 s37, s3, 0x0
    buffer_load_dwordx4 v16, s[88:91], s37 offen lds
    s_add_u32 m0, s28, 45056
    s_add_u32 s37, s3, 0x20000
    buffer_load_dwordx4 v16, s[88:91], s37 offen lds
    s_add_u32 m0, s28, 73728
    s_add_u32 s37, s3, 0x40000
    buffer_load_dwordx4 v16, s[88:91], s37 offen lds
    s_add_u32 m0, s28, 77824
    s_add_u32 s37, s3, 0x60000
    buffer_load_dwordx4 v16, s[88:91], s37 offen lds
    s_add_u32 m0, s28, 106496
    s_add_u32 s37, s3, 0x80000
    buffer_load_dwordx4 v16, s[88:91], s37 offen lds
    s_add_u32 m0, s28, 110592
    s_add_u32 s37, s3, 0xa0000
    buffer_load_dwordx4 v16, s[88:91], s37 offen lds
    s_add_u32 m0, s28, 139264
    s_add_u32 s37, s3, 0xc0000
    buffer_load_dwordx4 v16, s[88:91], s37 offen lds
    s_add_u32 m0, s28, 143360
    s_add_u32 s37, s3, 0xe0000
    buffer_load_dwordx4 v16, s[88:91], s37 offen lds
    s_waitcnt vmcnt(34)
    v_perm_b32 v120, v33, v32, s34
    v_perm_b32 v121, v33, v32, s35
    v_perm_b32 v122, v35, v34, s34
    v_perm_b32 v123, v35, v34, s35
    v_perm_b32 v124, v37, v36, s34
    v_perm_b32 v125, v37, v36, s35
    v_perm_b32 v126, v39, v38, s34
    v_perm_b32 v127, v39, v38, s35
    ds_write_b128 v4, v[120:123] offset:24576
    ds_write_b128 v4, v[124:127] offset:25600
    s_waitcnt lgkmcnt(0)
    v_perm_b32 v120, v41, v40, s34
    v_perm_b32 v121, v41, v40, s35
    v_perm_b32 v122, v43, v42, s34
    v_perm_b32 v123, v43, v42, s35
    v_perm_b32 v124, v45, v44, s34
    v_perm_b32 v125, v45, v44, s35
    v_perm_b32 v126, v47, v46, s34
    v_perm_b32 v127, v47, v46, s35
    ds_write_b128 v4, v[120:123] offset:30720
    ds_write_b128 v4, v[124:127] offset:31744
    s_waitcnt lgkmcnt(0)
    s_xor_b32 s36, s21, 1
    s_lshl_b32 s36, s36, 15
    s_add_u32 s36, s36, s29
    s_add_u32 s37, s36, 0x80
    buffer_load_dword v80, v11, s[92:95], s37 offen
    s_add_u32 s37, s36, 0x4080
    buffer_load_dword v81, v11, s[92:95], s37 offen
    s_add_u32 s37, s36, 0x480
    buffer_load_dword v82, v11, s[92:95], s37 offen
    s_add_u32 s37, s36, 0x4480
    buffer_load_dword v83, v11, s[92:95], s37 offen
    s_add_u32 s37, s36, 0x2080
    buffer_load_dword v84, v11, s[92:95], s37 offen
    s_add_u32 s37, s36, 0x6080
    buffer_load_dword v85, v11, s[92:95], s37 offen
    s_add_u32 s37, s36, 0x2480
    buffer_load_dword v86, v11, s[92:95], s37 offen
    s_add_u32 s37, s36, 0x6480
    buffer_load_dword v87, v11, s[92:95], s37 offen
    s_add_u32 s37, s36, 0xc0
    buffer_load_dword v88, v11, s[92:95], s37 offen
    s_add_u32 s37, s36, 0x40c0
    buffer_load_dword v89, v11, s[92:95], s37 offen
    s_add_u32 s37, s36, 0x4c0
    buffer_load_dword v90, v11, s[92:95], s37 offen
    s_add_u32 s37, s36, 0x44c0
    buffer_load_dword v91, v11, s[92:95], s37 offen
    s_add_u32 s37, s36, 0x20c0
    buffer_load_dword v92, v11, s[92:95], s37 offen
    s_add_u32 s37, s36, 0x60c0
    buffer_load_dword v93, v11, s[92:95], s37 offen
    s_add_u32 s37, s36, 0x24c0
    buffer_load_dword v94, v11, s[92:95], s37 offen
    s_add_u32 s37, s36, 0x64c0
    buffer_load_dword v95, v11, s[92:95], s37 offen
    s_barrier
    ds_read_b64_tr_b16 a[176:177], v20 offset:16384
    ds_read_b64_tr_b16 a[178:179], v20 offset:16896
    ds_read_b64_tr_b16 a[184:185], v21 offset:16384
    ds_read_b64_tr_b16 a[186:187], v21 offset:16896
    ds_read_b64_tr_b16 a[208:209], v22 offset:16384
    ds_read_b64_tr_b16 a[210:211], v22 offset:16896
    ds_read_b64_tr_b16 a[216:217], v23 offset:16384
    ds_read_b64_tr_b16 a[218:219], v23 offset:16896
    ds_read_b64_tr_b16 a[240:241], v24 offset:16384
    ds_read_b64_tr_b16 a[242:243], v24 offset:16896
    ds_read_b64_tr_b16 a[248:249], v25 offset:16384
    ds_read_b64_tr_b16 a[250:251], v25 offset:16896
    s_waitcnt lgkmcnt(4)
    ds_read_b64_tr_b16 v[144:145], v26 offset:16384
    ds_read_b64_tr_b16 v[146:147], v26 offset:16896
    ds_read_b64_tr_b16 v[152:153], v27 offset:16384
    ds_read_b64_tr_b16 v[154:155], v27 offset:16896
    s_waitcnt lgkmcnt(0)
    s_barrier
    s_add_u32 m0, s28, 49152
    s_add_u32 s37, s3, 0x100000
    buffer_load_dwordx4 v16, s[88:91], s37 offen lds
    s_add_u32 m0, s28, 53248
    s_add_u32 s37, s3, 0x120000
    buffer_load_dwordx4 v16, s[88:91], s37 offen lds
    s_add_u32 m0, s28, 81920
    s_add_u32 s37, s3, 0x140000
    buffer_load_dwordx4 v16, s[88:91], s37 offen lds
    s_add_u32 m0, s28, 86016
    s_add_u32 s37, s3, 0x160000
    buffer_load_dwordx4 v16, s[88:91], s37 offen lds
    s_add_u32 m0, s28, 114688
    s_add_u32 s37, s3, 0x180000
    buffer_load_dwordx4 v16, s[88:91], s37 offen lds
    s_add_u32 m0, s28, 118784
    s_add_u32 s37, s3, 0x1a0000
    buffer_load_dwordx4 v16, s[88:91], s37 offen lds
    s_add_u32 m0, s28, 147456
    s_add_u32 s37, s3, 0x1c0000
    buffer_load_dwordx4 v16, s[88:91], s37 offen lds
    s_add_u32 m0, s28, 151552
    s_add_u32 s37, s3, 0x1e0000
    buffer_load_dwordx4 v16, s[88:91], s37 offen lds
    s_waitcnt vmcnt(32)
    v_perm_b32 v232, v49, v48, s34
    v_perm_b32 v233, v49, v48, s35
    v_perm_b32 v234, v51, v50, s34
    v_perm_b32 v235, v51, v50, s35
    v_perm_b32 v236, v53, v52, s34
    v_perm_b32 v237, v53, v52, s35
    v_perm_b32 v238, v55, v54, s34
    v_perm_b32 v239, v55, v54, s35
    v_perm_b32 v120, v57, v56, s34
    v_perm_b32 v121, v57, v56, s35
    v_perm_b32 v122, v59, v58, s34
    v_perm_b32 v123, v59, v58, s35
    v_perm_b32 v124, v61, v60, s34
    v_perm_b32 v125, v61, v60, s35
    v_perm_b32 v126, v63, v62, s34
    v_perm_b32 v127, v63, v62, s35
    ds_write_b128 v4, v[120:123] offset:28672
    ds_write_b128 v4, v[124:127] offset:29696
    s_waitcnt lgkmcnt(0)
    s_xor_b32 s36, s21, 3
    s_lshl_b32 s36, s36, 15
    s_add_u32 s36, s36, s29
    s_add_u32 s37, s36, 0x0
    buffer_load_dword v32, v11, s[92:95], s37 offen
    s_add_u32 s37, s36, 0x4000
    buffer_load_dword v33, v11, s[92:95], s37 offen
    s_add_u32 s37, s36, 0x400
    buffer_load_dword v34, v11, s[92:95], s37 offen
    s_add_u32 s37, s36, 0x4400
    buffer_load_dword v35, v11, s[92:95], s37 offen
    s_add_u32 s37, s36, 0x2000
    buffer_load_dword v36, v11, s[92:95], s37 offen
    s_add_u32 s37, s36, 0x6000
    buffer_load_dword v37, v11, s[92:95], s37 offen
    s_add_u32 s37, s36, 0x2400
    buffer_load_dword v38, v11, s[92:95], s37 offen
    s_add_u32 s37, s36, 0x6400
    buffer_load_dword v39, v11, s[92:95], s37 offen
    s_add_u32 s37, s36, 0x40
    buffer_load_dword v40, v11, s[92:95], s37 offen
    s_add_u32 s37, s36, 0x4040
    buffer_load_dword v41, v11, s[92:95], s37 offen
    s_add_u32 s37, s36, 0x440
    buffer_load_dword v42, v11, s[92:95], s37 offen
    s_add_u32 s37, s36, 0x4440
    buffer_load_dword v43, v11, s[92:95], s37 offen
    s_add_u32 s37, s36, 0x2040
    buffer_load_dword v44, v11, s[92:95], s37 offen
    s_add_u32 s37, s36, 0x6040
    buffer_load_dword v45, v11, s[92:95], s37 offen
    s_add_u32 s37, s36, 0x2440
    buffer_load_dword v46, v11, s[92:95], s37 offen
    s_add_u32 s37, s36, 0x6440
    buffer_load_dword v47, v11, s[92:95], s37 offen
    s_barrier
    ds_read_b64_tr_b16 a[180:181], v20 offset:0
    ds_read_b64_tr_b16 a[182:183], v20 offset:512
    ds_read_b64_tr_b16 a[188:189], v21 offset:0
    ds_read_b64_tr_b16 a[190:191], v21 offset:512
    ds_read_b64_tr_b16 a[212:213], v22 offset:0
    ds_read_b64_tr_b16 a[214:215], v22 offset:512
    ds_read_b64_tr_b16 a[220:221], v23 offset:0
    ds_read_b64_tr_b16 a[222:223], v23 offset:512
    ds_read_b64_tr_b16 a[244:245], v24 offset:0
    ds_read_b64_tr_b16 a[246:247], v24 offset:512
    ds_read_b64_tr_b16 a[252:253], v25 offset:0
    ds_read_b64_tr_b16 a[254:255], v25 offset:512
    s_waitcnt lgkmcnt(4)
    ds_read_b64_tr_b16 v[148:149], v26 offset:0
    ds_read_b64_tr_b16 v[150:151], v26 offset:512
    ds_read_b64_tr_b16 v[156:157], v27 offset:0
    ds_read_b64_tr_b16 v[158:159], v27 offset:512
    s_waitcnt lgkmcnt(0)
    s_barrier
    s_add_u32 m0, s28, 32768
    s_add_u32 s37, s3, 0x200000
    buffer_load_dwordx4 v16, s[88:91], s37 offen lds
    s_add_u32 m0, s28, 36864
    s_add_u32 s37, s3, 0x220000
    buffer_load_dwordx4 v16, s[88:91], s37 offen lds
    s_add_u32 m0, s28, 65536
    s_add_u32 s37, s3, 0x240000
    buffer_load_dwordx4 v16, s[88:91], s37 offen lds
    s_add_u32 m0, s28, 69632
    s_add_u32 s37, s3, 0x260000
    buffer_load_dwordx4 v16, s[88:91], s37 offen lds
    s_add_u32 m0, s28, 98304
    s_add_u32 s37, s3, 0x280000
    buffer_load_dwordx4 v16, s[88:91], s37 offen lds
    s_add_u32 m0, s28, 102400
    s_add_u32 s37, s3, 0x2a0000
    buffer_load_dwordx4 v16, s[88:91], s37 offen lds
    s_add_u32 m0, s28, 131072
    s_add_u32 s37, s3, 0x2c0000
    buffer_load_dwordx4 v16, s[88:91], s37 offen lds
    s_add_u32 m0, s28, 135168
    s_add_u32 s37, s3, 0x2e0000
    buffer_load_dwordx4 v16, s[88:91], s37 offen lds
    s_waitcnt vmcnt(32)
    v_perm_b32 v208, v81, v80, s34
    v_perm_b32 v209, v81, v80, s35
    v_perm_b32 v210, v83, v82, s34
    v_perm_b32 v211, v83, v82, s35
    v_perm_b32 v212, v85, v84, s34
    v_perm_b32 v213, v85, v84, s35
    v_perm_b32 v214, v87, v86, s34
    v_perm_b32 v215, v87, v86, s35
    v_perm_b32 v120, v89, v88, s34
    v_perm_b32 v121, v89, v88, s35
    v_perm_b32 v122, v91, v90, s34
    v_perm_b32 v123, v91, v90, s35
    v_perm_b32 v124, v93, v92, s34
    v_perm_b32 v125, v93, v92, s35
    v_perm_b32 v126, v95, v94, s34
    v_perm_b32 v127, v95, v94, s35
    ds_write_b128 v4, v[120:123] offset:26624
    ds_write_b128 v4, v[124:127] offset:27648
    s_waitcnt lgkmcnt(0)
    s_xor_b32 s36, s21, 2
    s_lshl_b32 s36, s36, 15
    s_add_u32 s36, s36, s29
    s_add_u32 s37, s36, 0x0
    buffer_load_dword v48, v11, s[92:95], s37 offen
    s_add_u32 s37, s36, 0x4000
    buffer_load_dword v49, v11, s[92:95], s37 offen
    s_add_u32 s37, s36, 0x400
    buffer_load_dword v50, v11, s[92:95], s37 offen
    s_add_u32 s37, s36, 0x4400
    buffer_load_dword v51, v11, s[92:95], s37 offen
    s_add_u32 s37, s36, 0x2000
    buffer_load_dword v52, v11, s[92:95], s37 offen
    s_add_u32 s37, s36, 0x6000
    buffer_load_dword v53, v11, s[92:95], s37 offen
    s_add_u32 s37, s36, 0x2400
    buffer_load_dword v54, v11, s[92:95], s37 offen
    s_add_u32 s37, s36, 0x6400
    buffer_load_dword v55, v11, s[92:95], s37 offen
    s_add_u32 s37, s36, 0x40
    buffer_load_dword v56, v11, s[92:95], s37 offen
    s_add_u32 s37, s36, 0x4040
    buffer_load_dword v57, v11, s[92:95], s37 offen
    s_add_u32 s37, s36, 0x440
    buffer_load_dword v58, v11, s[92:95], s37 offen
    s_add_u32 s37, s36, 0x4440
    buffer_load_dword v59, v11, s[92:95], s37 offen
    s_add_u32 s37, s36, 0x2040
    buffer_load_dword v60, v11, s[92:95], s37 offen
    s_add_u32 s37, s36, 0x6040
    buffer_load_dword v61, v11, s[92:95], s37 offen
    s_add_u32 s37, s36, 0x2440
    buffer_load_dword v62, v11, s[92:95], s37 offen
    s_add_u32 s37, s36, 0x6440
    buffer_load_dword v63, v11, s[92:95], s37 offen
    s_barrier
    ds_read_b64_tr_b16 v[64:65], v20 offset:8192
    ds_read_b64_tr_b16 v[66:67], v20 offset:8704
    ds_read_b64_tr_b16 v[72:73], v21 offset:8192
    ds_read_b64_tr_b16 v[74:75], v21 offset:8704
    ds_read_b64_tr_b16 v[96:97], v22 offset:8192
    ds_read_b64_tr_b16 v[98:99], v22 offset:8704
    ds_read_b64_tr_b16 v[104:105], v23 offset:8192
    ds_read_b64_tr_b16 v[106:107], v23 offset:8704
    ds_read_b64_tr_b16 a[112:113], v24 offset:8192
    ds_read_b64_tr_b16 a[114:115], v24 offset:8704
    ds_read_b64_tr_b16 a[120:121], v25 offset:8192
    ds_read_b64_tr_b16 a[122:123], v25 offset:8704
    s_waitcnt lgkmcnt(4)
    ds_read_b64_tr_b16 a[144:145], v26 offset:8192
    ds_read_b64_tr_b16 a[146:147], v26 offset:8704
    ds_read_b64_tr_b16 a[152:153], v27 offset:8192
    ds_read_b64_tr_b16 a[154:155], v27 offset:8704
    s_waitcnt lgkmcnt(0)
    s_barrier
    s_add_u32 m0, s28, 40960
    s_add_u32 s37, s3, 0x300000
    buffer_load_dwordx4 v16, s[88:91], s37 offen lds
    s_add_u32 m0, s28, 45056
    s_add_u32 s37, s3, 0x320000
    buffer_load_dwordx4 v16, s[88:91], s37 offen lds
    s_add_u32 m0, s28, 73728
    s_add_u32 s37, s3, 0x340000
    buffer_load_dwordx4 v16, s[88:91], s37 offen lds
    s_add_u32 m0, s28, 77824
    s_add_u32 s37, s3, 0x360000
    buffer_load_dwordx4 v16, s[88:91], s37 offen lds
    s_add_u32 m0, s28, 106496
    s_add_u32 s37, s3, 0x380000
    buffer_load_dwordx4 v16, s[88:91], s37 offen lds
    s_add_u32 m0, s28, 110592
    s_add_u32 s37, s3, 0x3a0000
    buffer_load_dwordx4 v16, s[88:91], s37 offen lds
    s_add_u32 m0, s28, 139264
    s_add_u32 s37, s3, 0x3c0000
    buffer_load_dwordx4 v16, s[88:91], s37 offen lds
    s_add_u32 m0, s28, 143360
    s_add_u32 s37, s3, 0x3e0000
    buffer_load_dwordx4 v16, s[88:91], s37 offen lds
    s_waitcnt vmcnt(32)
    v_perm_b32 v240, v33, v32, s34
    v_perm_b32 v241, v33, v32, s35
    v_perm_b32 v242, v35, v34, s34
    v_perm_b32 v243, v35, v34, s35
    v_perm_b32 v244, v37, v36, s34
    v_perm_b32 v245, v37, v36, s35
    v_perm_b32 v246, v39, v38, s34
    v_perm_b32 v247, v39, v38, s35
    v_perm_b32 v248, v41, v40, s34
    v_perm_b32 v249, v41, v40, s35
    v_perm_b32 v250, v43, v42, s34
    v_perm_b32 v251, v43, v42, s35
    v_perm_b32 v252, v45, v44, s34
    v_perm_b32 v253, v45, v44, s35
    v_perm_b32 v254, v47, v46, s34
    v_perm_b32 v255, v47, v46, s35
    s_xor_b32 s36, s21, 1
    s_lshl_b32 s36, s36, 15
    s_add_u32 s36, s36, s29
    s_add_u32 s37, s36, 0x0
    buffer_load_dword v80, v11, s[92:95], s37 offen
    s_add_u32 s37, s36, 0x4000
    buffer_load_dword v81, v11, s[92:95], s37 offen
    s_add_u32 s37, s36, 0x400
    buffer_load_dword v82, v11, s[92:95], s37 offen
    s_add_u32 s37, s36, 0x4400
    buffer_load_dword v83, v11, s[92:95], s37 offen
    s_add_u32 s37, s36, 0x2000
    buffer_load_dword v84, v11, s[92:95], s37 offen
    s_add_u32 s37, s36, 0x6000
    buffer_load_dword v85, v11, s[92:95], s37 offen
    s_add_u32 s37, s36, 0x2400
    buffer_load_dword v86, v11, s[92:95], s37 offen
    s_add_u32 s37, s36, 0x6400
    buffer_load_dword v87, v11, s[92:95], s37 offen
    s_add_u32 s37, s36, 0x40
    buffer_load_dword v88, v11, s[92:95], s37 offen
    s_add_u32 s37, s36, 0x4040
    buffer_load_dword v89, v11, s[92:95], s37 offen
    s_add_u32 s37, s36, 0x440
    buffer_load_dword v90, v11, s[92:95], s37 offen
    s_add_u32 s37, s36, 0x4440
    buffer_load_dword v91, v11, s[92:95], s37 offen
    s_add_u32 s37, s36, 0x2040
    buffer_load_dword v92, v11, s[92:95], s37 offen
    s_add_u32 s37, s36, 0x6040
    buffer_load_dword v93, v11, s[92:95], s37 offen
    s_add_u32 s37, s36, 0x2440
    buffer_load_dword v94, v11, s[92:95], s37 offen
    s_add_u32 s37, s36, 0x6440
    buffer_load_dword v95, v11, s[92:95], s37 offen
    s_barrier
    ds_read_b64_tr_b16 v[68:69], v20 offset:16384
    ds_read_b64_tr_b16 v[70:71], v20 offset:16896
    ds_read_b64_tr_b16 v[76:77], v21 offset:16384
    ds_read_b64_tr_b16 v[78:79], v21 offset:16896
    ds_read_b64_tr_b16 v[100:101], v22 offset:16384
    ds_read_b64_tr_b16 v[102:103], v22 offset:16896
    ds_read_b64_tr_b16 v[108:109], v23 offset:16384
    ds_read_b64_tr_b16 v[110:111], v23 offset:16896
    ds_read_b64_tr_b16 a[116:117], v24 offset:16384
    ds_read_b64_tr_b16 a[118:119], v24 offset:16896
    ds_read_b64_tr_b16 a[124:125], v25 offset:16384
    ds_read_b64_tr_b16 a[126:127], v25 offset:16896
    s_waitcnt lgkmcnt(4)
    ds_read_b64_tr_b16 a[148:149], v26 offset:16384
    ds_read_b64_tr_b16 a[150:151], v26 offset:16896
    ds_read_b64_tr_b16 a[156:157], v27 offset:16384
    ds_read_b64_tr_b16 a[158:159], v27 offset:16896
    s_waitcnt lgkmcnt(0)
    s_barrier
    s_mov_b32 s96, s48
    s_and_b32 s97, s49, 0xffff
    s_mov_b32 s98, 0x400000
    s_mov_b32 s99, 0x20000
    s_add_u32 m0, s28, 49152
    s_add_u32 s37, s3, 0x0
    buffer_load_dwordx4 v16, s[96:99], s37 offen lds
    s_add_u32 m0, s28, 53248
    s_add_u32 s37, s3, 0x20000
    buffer_load_dwordx4 v16, s[96:99], s37 offen lds
    s_add_u32 m0, s28, 81920
    s_add_u32 s37, s3, 0x40000
    buffer_load_dwordx4 v16, s[96:99], s37 offen lds
    s_add_u32 m0, s28, 86016
    s_add_u32 s37, s3, 0x60000
    buffer_load_dwordx4 v16, s[96:99], s37 offen lds
    s_add_u32 m0, s28, 114688
    s_add_u32 s37, s3, 0x80000
    buffer_load_dwordx4 v16, s[96:99], s37 offen lds
    s_add_u32 m0, s28, 118784
    s_add_u32 s37, s3, 0xa0000
    buffer_load_dwordx4 v16, s[96:99], s37 offen lds
    s_add_u32 m0, s28, 147456
    s_add_u32 s37, s3, 0xc0000
    buffer_load_dwordx4 v16, s[96:99], s37 offen lds
    s_add_u32 m0, s28, 151552
    s_add_u32 s37, s3, 0xe0000
    buffer_load_dwordx4 v16, s[96:99], s37 offen lds
    s_waitcnt vmcnt(32)
    v_perm_b32 v216, v49, v48, s34
    v_perm_b32 v217, v49, v48, s35
    v_perm_b32 v218, v51, v50, s34
    v_perm_b32 v219, v51, v50, s35
    v_perm_b32 v220, v53, v52, s34
    v_perm_b32 v221, v53, v52, s35
    v_perm_b32 v222, v55, v54, s34
    v_perm_b32 v223, v55, v54, s35
    v_perm_b32 v224, v57, v56, s34
    v_perm_b32 v225, v57, v56, s35
    v_perm_b32 v226, v59, v58, s34
    v_perm_b32 v227, v59, v58, s35
    v_perm_b32 v228, v61, v60, s34
    v_perm_b32 v229, v61, v60, s35
    v_perm_b32 v230, v63, v62, s34
    v_perm_b32 v231, v63, v62, s35
    s_xor_b32 s36, s21, 0
    s_lshl_b32 s36, s36, 15
    s_add_u32 s36, s36, s29
    s_add_u32 s37, s36, 0x80
    buffer_load_dword v32, v11, s[92:95], s37 offen
    s_add_u32 s37, s36, 0x4080
    buffer_load_dword v33, v11, s[92:95], s37 offen
    s_add_u32 s37, s36, 0x480
    buffer_load_dword v34, v11, s[92:95], s37 offen
    s_add_u32 s37, s36, 0x4480
    buffer_load_dword v35, v11, s[92:95], s37 offen
    s_add_u32 s37, s36, 0x2080
    buffer_load_dword v36, v11, s[92:95], s37 offen
    s_add_u32 s37, s36, 0x6080
    buffer_load_dword v37, v11, s[92:95], s37 offen
    s_add_u32 s37, s36, 0x2480
    buffer_load_dword v38, v11, s[92:95], s37 offen
    s_add_u32 s37, s36, 0x6480
    buffer_load_dword v39, v11, s[92:95], s37 offen
    s_add_u32 s37, s36, 0xc0
    buffer_load_dword v40, v11, s[92:95], s37 offen
    s_add_u32 s37, s36, 0x40c0
    buffer_load_dword v41, v11, s[92:95], s37 offen
    s_add_u32 s37, s36, 0x4c0
    buffer_load_dword v42, v11, s[92:95], s37 offen
    s_add_u32 s37, s36, 0x44c0
    buffer_load_dword v43, v11, s[92:95], s37 offen
    s_add_u32 s37, s36, 0x20c0
    buffer_load_dword v44, v11, s[92:95], s37 offen
    s_add_u32 s37, s36, 0x60c0
    buffer_load_dword v45, v11, s[92:95], s37 offen
    s_add_u32 s37, s36, 0x24c0
    buffer_load_dword v46, v11, s[92:95], s37 offen
    s_add_u32 s37, s36, 0x64c0
    buffer_load_dword v47, v11, s[92:95], s37 offen
    s_barrier
    ds_read_b64_tr_b16 a[80:81], v20 offset:0
    ds_read_b64_tr_b16 a[82:83], v20 offset:512
    ds_read_b64_tr_b16 a[88:89], v21 offset:0
    ds_read_b64_tr_b16 a[90:91], v21 offset:512
    ds_read_b64_tr_b16 a[96:97], v22 offset:0
    ds_read_b64_tr_b16 a[98:99], v22 offset:512
    ds_read_b64_tr_b16 a[104:105], v23 offset:0
    ds_read_b64_tr_b16 a[106:107], v23 offset:512
    ds_read_b64_tr_b16 a[128:129], v24 offset:0
    ds_read_b64_tr_b16 a[130:131], v24 offset:512
    ds_read_b64_tr_b16 a[136:137], v25 offset:0
    ds_read_b64_tr_b16 a[138:139], v25 offset:512
    s_waitcnt lgkmcnt(4)
    ds_read_b64_tr_b16 v[112:113], v26 offset:0
    ds_read_b64_tr_b16 v[114:115], v26 offset:512
    ds_read_b64_tr_b16 v[120:121], v27 offset:0
    ds_read_b64_tr_b16 v[122:123], v27 offset:512
    s_waitcnt lgkmcnt(0)
    s_barrier
    s_add_u32 m0, s28, 32768
    s_add_u32 s37, s3, 0x100000
    buffer_load_dwordx4 v16, s[96:99], s37 offen lds
    s_add_u32 m0, s28, 36864
    s_add_u32 s37, s3, 0x120000
    buffer_load_dwordx4 v16, s[96:99], s37 offen lds
    s_add_u32 m0, s28, 65536
    s_add_u32 s37, s3, 0x140000
    buffer_load_dwordx4 v16, s[96:99], s37 offen lds
    s_add_u32 m0, s28, 69632
    s_add_u32 s37, s3, 0x160000
    buffer_load_dwordx4 v16, s[96:99], s37 offen lds
    s_add_u32 m0, s28, 98304
    s_add_u32 s37, s3, 0x180000
    buffer_load_dwordx4 v16, s[96:99], s37 offen lds
    s_add_u32 m0, s28, 102400
    s_add_u32 s37, s3, 0x1a0000
    buffer_load_dwordx4 v16, s[96:99], s37 offen lds
    s_add_u32 m0, s28, 131072
    s_add_u32 s37, s3, 0x1c0000
    buffer_load_dwordx4 v16, s[96:99], s37 offen lds
    s_add_u32 m0, s28, 135168
    s_add_u32 s37, s3, 0x1e0000
    buffer_load_dwordx4 v16, s[96:99], s37 offen lds
    s_waitcnt vmcnt(32)
    v_perm_b32 v192, v81, v80, s34
    v_perm_b32 v193, v81, v80, s35
    v_perm_b32 v194, v83, v82, s34
    v_perm_b32 v195, v83, v82, s35
    v_perm_b32 v196, v85, v84, s34
    v_perm_b32 v197, v85, v84, s35
    v_perm_b32 v198, v87, v86, s34
    v_perm_b32 v199, v87, v86, s35
    v_perm_b32 v200, v89, v88, s34
    v_perm_b32 v201, v89, v88, s35
    v_perm_b32 v202, v91, v90, s34
    v_perm_b32 v203, v91, v90, s35
    v_perm_b32 v204, v93, v92, s34
    v_perm_b32 v205, v93, v92, s35
    v_perm_b32 v206, v95, v94, s34
    v_perm_b32 v207, v95, v94, s35
    s_xor_b32 s36, s21, 0
    s_lshl_b32 s36, s36, 15
    s_add_u32 s36, s36, s29
    s_add_u32 s37, s36, 0x0
    buffer_load_dword v48, v11, s[92:95], s37 offen
    s_add_u32 s37, s36, 0x4000
    buffer_load_dword v49, v11, s[92:95], s37 offen
    s_add_u32 s37, s36, 0x400
    buffer_load_dword v50, v11, s[92:95], s37 offen
    s_add_u32 s37, s36, 0x4400
    buffer_load_dword v51, v11, s[92:95], s37 offen
    s_add_u32 s37, s36, 0x2000
    buffer_load_dword v52, v11, s[92:95], s37 offen
    s_add_u32 s37, s36, 0x6000
    buffer_load_dword v53, v11, s[92:95], s37 offen
    s_add_u32 s37, s36, 0x2400
    buffer_load_dword v54, v11, s[92:95], s37 offen
    s_add_u32 s37, s36, 0x6400
    buffer_load_dword v55, v11, s[92:95], s37 offen
    s_add_u32 s37, s36, 0x40
    buffer_load_dword v56, v11, s[92:95], s37 offen
    s_add_u32 s37, s36, 0x4040
    buffer_load_dword v57, v11, s[92:95], s37 offen
    s_add_u32 s37, s36, 0x440
    buffer_load_dword v58, v11, s[92:95], s37 offen
    s_add_u32 s37, s36, 0x4440
    buffer_load_dword v59, v11, s[92:95], s37 offen
    s_add_u32 s37, s36, 0x2040
    buffer_load_dword v60, v11, s[92:95], s37 offen
    s_add_u32 s37, s36, 0x6040
    buffer_load_dword v61, v11, s[92:95], s37 offen
    s_add_u32 s37, s36, 0x2440
    buffer_load_dword v62, v11, s[92:95], s37 offen
    s_add_u32 s37, s36, 0x6440
    buffer_load_dword v63, v11, s[92:95], s37 offen
    s_barrier
    ds_read_b64_tr_b16 a[84:85], v20 offset:8192
    ds_read_b64_tr_b16 a[86:87], v20 offset:8704
    ds_read_b64_tr_b16 a[92:93], v21 offset:8192
    ds_read_b64_tr_b16 a[94:95], v21 offset:8704
    ds_read_b64_tr_b16 a[100:101], v22 offset:8192
    ds_read_b64_tr_b16 a[102:103], v22 offset:8704
    ds_read_b64_tr_b16 a[108:109], v23 offset:8192
    ds_read_b64_tr_b16 a[110:111], v23 offset:8704
    ds_read_b64_tr_b16 a[132:133], v24 offset:8192
    ds_read_b64_tr_b16 a[134:135], v24 offset:8704
    ds_read_b64_tr_b16 a[140:141], v25 offset:8192
    ds_read_b64_tr_b16 a[142:143], v25 offset:8704
    s_waitcnt lgkmcnt(4)
    ds_read_b64_tr_b16 v[116:117], v26 offset:8192
    ds_read_b64_tr_b16 v[118:119], v26 offset:8704
    ds_read_b64_tr_b16 v[124:125], v27 offset:8192
    ds_read_b64_tr_b16 v[126:127], v27 offset:8704
    s_waitcnt lgkmcnt(0)
    s_barrier
    s_add_u32 m0, s28, 40960
    s_add_u32 s37, s3, 0x200000
    buffer_load_dwordx4 v16, s[96:99], s37 offen lds
    s_add_u32 m0, s28, 45056
    s_add_u32 s37, s3, 0x220000
    buffer_load_dwordx4 v16, s[96:99], s37 offen lds
    s_add_u32 m0, s28, 73728
    s_add_u32 s37, s3, 0x240000
    buffer_load_dwordx4 v16, s[96:99], s37 offen lds
    s_add_u32 m0, s28, 77824
    s_add_u32 s37, s3, 0x260000
    buffer_load_dwordx4 v16, s[96:99], s37 offen lds
    s_add_u32 m0, s28, 106496
    s_add_u32 s37, s3, 0x280000
    buffer_load_dwordx4 v16, s[96:99], s37 offen lds
    s_add_u32 m0, s28, 110592
    s_add_u32 s37, s3, 0x2a0000
    buffer_load_dwordx4 v16, s[96:99], s37 offen lds
    s_add_u32 m0, s28, 139264
    s_add_u32 s37, s3, 0x2c0000
    buffer_load_dwordx4 v16, s[96:99], s37 offen lds
    s_add_u32 m0, s28, 143360
    s_add_u32 s37, s3, 0x2e0000
    buffer_load_dwordx4 v16, s[96:99], s37 offen lds
    s_waitcnt vmcnt(32)
    v_perm_b32 v176, v33, v32, s34
    v_perm_b32 v177, v33, v32, s35
    v_perm_b32 v178, v35, v34, s34
    v_perm_b32 v179, v35, v34, s35
    v_perm_b32 v180, v37, v36, s34
    v_perm_b32 v181, v37, v36, s35
    v_perm_b32 v182, v39, v38, s34
    v_perm_b32 v183, v39, v38, s35
    v_perm_b32 v184, v41, v40, s34
    v_perm_b32 v185, v41, v40, s35
    v_perm_b32 v186, v43, v42, s34
    v_perm_b32 v187, v43, v42, s35
    v_perm_b32 v188, v45, v44, s34
    v_perm_b32 v189, v45, v44, s35
    v_perm_b32 v190, v47, v46, s34
    v_perm_b32 v191, v47, v46, s35
    v_lshrrev_b32 v31, 2, v3
    buffer_load_dword v30, v31, s[16:19], 0 offen sc1
    s_barrier
    ds_read_b64_tr_b16 v[32:33], v20 offset:16384
    ds_read_b64_tr_b16 v[34:35], v20 offset:16896
    ds_read_b64_tr_b16 v[40:41], v21 offset:16384
    ds_read_b64_tr_b16 v[42:43], v21 offset:16896
    ds_read_b64_tr_b16 a[0:1], v22 offset:16384
    ds_read_b64_tr_b16 a[2:3], v22 offset:16896
    ds_read_b64_tr_b16 a[8:9], v23 offset:16384
    ds_read_b64_tr_b16 a[10:11], v23 offset:16896
    ds_read_b64_tr_b16 a[32:33], v24 offset:16384
    ds_read_b64_tr_b16 a[34:35], v24 offset:16896
    ds_read_b64_tr_b16 a[40:41], v25 offset:16384
    ds_read_b64_tr_b16 a[42:43], v25 offset:16896
    s_waitcnt lgkmcnt(4)
    ds_read_b64_tr_b16 a[64:65], v26 offset:16384
    ds_read_b64_tr_b16 a[66:67], v26 offset:16896
    ds_read_b64_tr_b16 a[72:73], v27 offset:16384
    ds_read_b64_tr_b16 a[74:75], v27 offset:16896
    s_waitcnt lgkmcnt(0)
    s_barrier
    s_add_u32 m0, s28, 49152
    s_add_u32 s37, s3, 0x300000
    buffer_load_dwordx4 v16, s[96:99], s37 offen lds
    s_add_u32 m0, s28, 53248
    s_add_u32 s37, s3, 0x320000
    buffer_load_dwordx4 v16, s[96:99], s37 offen lds
    s_add_u32 m0, s28, 81920
    s_add_u32 s37, s3, 0x340000
    buffer_load_dwordx4 v16, s[96:99], s37 offen lds
    s_add_u32 m0, s28, 86016
    s_add_u32 s37, s3, 0x360000
    buffer_load_dwordx4 v16, s[96:99], s37 offen lds
    s_add_u32 m0, s28, 114688
    s_add_u32 s37, s3, 0x380000
    buffer_load_dwordx4 v16, s[96:99], s37 offen lds
    s_add_u32 m0, s28, 118784
    s_add_u32 s37, s3, 0x3a0000
    buffer_load_dwordx4 v16, s[96:99], s37 offen lds
    s_add_u32 m0, s28, 147456
    s_add_u32 s37, s3, 0x3c0000
    buffer_load_dwordx4 v16, s[96:99], s37 offen lds
    s_add_u32 m0, s28, 151552
    s_add_u32 s37, s3, 0x3e0000
    buffer_load_dwordx4 v16, s[96:99], s37 offen lds
    s_waitcnt vmcnt(17)
    v_perm_b32 v160, v49, v48, s34
    v_perm_b32 v161, v49, v48, s35
    v_perm_b32 v162, v51, v50, s34
    v_perm_b32 v163, v51, v50, s35
    v_perm_b32 v164, v53, v52, s34
    v_perm_b32 v165, v53, v52, s35
    v_perm_b32 v166, v55, v54, s34
    v_perm_b32 v167, v55, v54, s35
    v_perm_b32 v168, v57, v56, s34
    v_perm_b32 v169, v57, v56, s35
    v_perm_b32 v170, v59, v58, s34
    v_perm_b32 v171, v59, v58, s35
    v_perm_b32 v172, v61, v60, s34
    v_perm_b32 v173, v61, v60, s35
    v_perm_b32 v174, v63, v62, s34
    v_perm_b32 v175, v63, v62, s35
    s_waitcnt vmcnt(8)
    s_mov_b32 s41, 1
L_HS:
    v_cmp_eq_u32 vcc, 0, v30
    s_cbranch_vccz L_HS_ok
    buffer_load_dword v30, v31, s[16:19], 0 offen sc1
    s_add_u32 s32, s32, 1
    s_cmp_gt_u32 s32, 200000
    s_waitcnt vmcnt(0)
    s_cbranch_scc0 L_HS
    s_branch L_HS_done
L_HS_ok:
    v_readlane_b32 s36, v30, 63
    s_nop 1
    v_cmp_ne_u32 vcc, s36, v30
    s_nop 1
    s_cmp_lg_u32 vcc_hi, 0
    s_cselect_b32 s41, 1, 0
L_HS_done:
    s_mov_b32 s7, 0xf7df00
    buffer_load_dword v15, v0, s[8:11], s7 offen sc1
    s_barrier
    ds_read_b64_tr_b16 v[36:37], v20 offset:0
    ds_read_b64_tr_b16 v[38:39], v20 offset:512
    ds_read_b64_tr_b16 v[44:45], v21 offset:0
    ds_read_b64_tr_b16 v[46:47], v21 offset:512
    ds_read_b64_tr_b16 a[4:5], v22 offset:0
    ds_read_b64_tr_b16 a[6:7], v22 offset:512
    ds_read_b64_tr_b16 a[12:13], v23 offset:0
    ds_read_b64_tr_b16 a[14:15], v23 offset:512
    ds_read_b64_tr_b16 a[36:37], v24 offset:0
    ds_read_b64_tr_b16 a[38:39], v24 offset:512
    ds_read_b64_tr_b16 a[44:45], v25 offset:0
    ds_read_b64_tr_b16 a[46:47], v25 offset:512
    s_waitcnt lgkmcnt(4)
    ds_read_b64_tr_b16 a[68:69], v26 offset:0
    ds_read_b64_tr_b16 a[70:71], v26 offset:512
    ds_read_b64_tr_b16 a[76:77], v27 offset:0
    ds_read_b64_tr_b16 a[78:79], v27 offset:512
    s_waitcnt lgkmcnt(0)
    s_barrier
    s_barrier
    ds_read_b64_tr_b16 v[48:49], v20 offset:8192
    ds_read_b64_tr_b16 v[50:51], v20 offset:8704
    ds_read_b64_tr_b16 v[56:57], v21 offset:8192
    ds_read_b64_tr_b16 v[58:59], v21 offset:8704
    ds_read_b64_tr_b16 a[16:17], v22 offset:8192
    ds_read_b64_tr_b16 a[18:19], v22 offset:8704
    ds_read_b64_tr_b16 a[24:25], v23 offset:8192
    ds_read_b64_tr_b16 a[26:27], v23 offset:8704
    ds_read_b64_tr_b16 a[48:49], v24 offset:8192
    ds_read_b64_tr_b16 a[50:51], v24 offset:8704
    ds_read_b64_tr_b16 a[56:57], v25 offset:8192
    ds_read_b64_tr_b16 a[58:59], v25 offset:8704
    s_waitcnt lgkmcnt(4)
    ds_read_b64_tr_b16 v[80:81], v26 offset:8192
    ds_read_b64_tr_b16 v[82:83], v26 offset:8704
    ds_read_b64_tr_b16 v[88:89], v27 offset:8192
    ds_read_b64_tr_b16 v[90:91], v27 offset:8704
    s_waitcnt lgkmcnt(0)
    s_barrier
    s_waitcnt vmcnt(0)
L_F0:
    v_readlane_b32 s36, v15, 33
    s_nop 1
    s_cmp_lg_u32 s36, 0
    s_cbranch_scc1 L_F0_ok
    buffer_load_dword v15, v0, s[8:11], s7 offen sc1
    s_add_u32 s32, s32, 1
    s_cmp_gt_u32 s32, 200000
    s_waitcnt vmcnt(0)
    s_cbranch_scc0 L_F0
L_F0_ok:
    s_mov_b32 s7, 0x1000000
    buffer_load_dword v15, v0, s[8:11], s7 offen sc1
    s_barrier
    ds_read_b64_tr_b16 v[52:53], v20 offset:16384
    ds_read_b64_tr_b16 v[54:55], v20 offset:16896
    ds_read_b64_tr_b16 v[60:61], v21 offset:16384
    ds_read_b64_tr_b16 v[62:63], v21 offset:16896
    ds_read_b64_tr_b16 a[20:21], v22 offset:16384
    ds_read_b64_tr_b16 a[22:23], v22 offset:16896
    ds_read_b64_tr_b16 a[28:29], v23 offset:16384
    ds_read_b64_tr_b16 a[30:31], v23 offset:16896
    ds_read_b64_tr_b16 a[52:53], v24 offset:16384
    ds_read_b64_tr_b16 a[54:55], v24 offset:16896
    ds_read_b64_tr_b16 a[60:61], v25 offset:16384
    ds_read_b64_tr_b16 a[62:63], v25 offset:16896
    s_waitcnt lgkmcnt(4)
    ds_read_b64_tr_b16 v[84:85], v26 offset:16384
    ds_read_b64_tr_b16 v[86:87], v26 offset:16896
    ds_read_b64_tr_b16 v[92:93], v27 offset:16384
    ds_read_b64_tr_b16 v[94:95], v27 offset:16896
    s_waitcnt lgkmcnt(0)
    s_barrier
    ds_write_b128 v4, v[32:35] offset:0
    ds_write_b128 v4, v[36:39] offset:1024
    ds_write_b128 v4, v[40:43] offset:2048
    ds_write_b128 v4, v[44:47] offset:3072
    ds_write_b128 v4, v[48:51] offset:4096
    ds_write_b128 v4, v[52:55] offset:5120
    ds_write_b128 v4, v[56:59] offset:6144
    ds_write_b128 v4, v[60:63] offset:7168
    s_waitcnt lgkmcnt(0)
    ds_write_b128 v4, v[64:67] offset:8192
    ds_write_b128 v4, v[68:71] offset:9216
    ds_write_b128 v4, v[72:75] offset:10240
    ds_write_b128 v4, v[76:79] offset:11264
    ds_write_b128 v4, v[80:83] offset:12288
    ds_write_b128 v4, v[84:87] offset:13312
    ds_write_b128 v4, v[88:91] offset:14336
    ds_write_b128 v4, v[92:95] offset:15360
    s_waitcnt lgkmcnt(0)
    ds_write_b128 v4, v[96:99] offset:16384
    ds_write_b128 v4, v[100:103] offset:17408
    ds_write_b128 v4, v[104:107] offset:18432
    ds_write_b128 v4, v[108:111] offset:19456
    ds_write_b128 v4, v[112:115] offset:20480
    ds_write_b128 v4, v[116:119] offset:21504
    ds_write_b128 v4, v[120:123] offset:22528
    ds_write_b128 v4, v[124:127] offset:23552
    s_waitcnt lgkmcnt(0)
    s_waitcnt lgkmcnt(0)
    s_cmp_lg_u32 s41, 0
    s_cbranch_scc1 L_slow_start
L_fast_start:
    s_mov_b32 s22, 0
    s_mov_b32 s23, 0x1000000
    s_mov_b32 s27, 0
    s_mov_b32 s31, 0x80000
    s_mov_b32 s61, 0x40000000
    s_mov_b32 s96, 0x800
    s_mov_b32 s97, 0x1000
    s_mov_b32 s98, 0x1800
    s_mov_b32 s92, 0xcccccccc
    s_mov_b32 s93, 0xcccccccc
    s_mov_b32 s91, 0
    ds_read_b128 v[104:107], v4 offset:0
    ds_read_b128 v[108:111], v4 offset:1024
    ds_read_b128 v[112:115], v4 offset:2048
    ds_read_b128 v[116:119], v4 offset:3072
    ds_read_b128 v[88:91], v4 offset:4096
    ds_read_b128 v[92:95], v4 offset:5120
    ds_read_b128 v[96:99], v4 offset:6144
    ds_read_b128 v[100:103], v4 offset:7168
    ds_read_b128 v[72:75], v4 offset:8192
    ds_read_b128 v[76:79], v4 offset:9216
    ds_read_b128 v[80:83], v4 offset:10240
    ds_read_b128 v[84:87], v4 offset:11264
    v_mov_b64 v[48:49], 0
    v_mov_b64 v[50:51], 0
    v_mov_b64 v[52:53], 0
    v_mov_b64 v[54:55], 0
    v_mov_b64 v[56:57], 0
    v_mov_b64 v[58:59], 0
    v_mov_b64 v[60:61], 0
    v_mov_b64 v[62:63], 0
    v_mov_b64 v[64:65], 0
    v_mov_b64 v[66:67], 0
    v_mov_b64 v[68:69], 0
    v_mov_b64 v[70:71], 0
    s_add_u32 s7, s23, 0x80000
    buffer_load_dwordx4 v[16:19], v2, s[8:11], s7 offen sc1
    buffer_load_dwordx4 v[20:23], v2, s[8:11], s7 offen offset:1024 sc1
    s_waitcnt vmcnt(2)
.p2align 3
L_fast_step:
    v_readlane_b32 s36, v15, 33
    s_add_u32 s24, s23, 0x82100
    s_cmp_eq_u32 s36, 0
    s_cbranch_scc1 L_fast_refresh
L_fast_fresh:
    s_add_u32 s29, s23, s25
    s_add_u32 s30, s23, s39
    s_xor_b32 s28, s27, 1
    s_add_u32 s90, s22, 1
    s_nop 15
L_fast_retrym:
    buffer_load_dwordx4 v[16:19], v2, s[8:11], s7 offen sc1
    buffer_load_dwordx4 v[20:23], v2, s[8:11], s7 offen offset:1024 sc1
L_fast_prem:
    s_add_u32 s32, s32, 1
    s_cmp_gt_u32 s32, 200000
    s_cselect_b32 s94, -1, -2
    v_xor_b32 v28, 0x800, v2
    v_xor_b32 v44, 0x1800, v2
    v_mov_b64 v[48:49], 0
    v_mov_b64 v[50:51], 0
    v_mov_b64 v[52:53], 0
    v_mov_b64 v[54:55], 0
L_fast_waitm:
    s_waitcnt vmcnt(3) lgkmcnt(0)
L_fast_gotm:
    v_max3_u32 v14, v16, v17, v18
    v_max_u32_e64 v14, v14, v19
    v_smfmac_f32_16x16x64_bf16 v[48:51], v[16:19], v[104:111], v1
    s_nop 0
    s_waitcnt vmcnt(2)
    v_max3_u32 v14, v14, v20, v21
    v_smfmac_f32_16x16x64_bf16 v[52:55], v[16:19], v[112:119], v1
    v_max3_u32 v14, v14, v22, v23
    v_cmp_lt_u32_e64 vcc, s94, v14
    v_smfmac_f32_16x16x64_bf16 v[48:51], v[20:23], v[88:95], v1
    ds_write_b128 v2, v[16:19] offset:0
    s_cbranch_vccnz L_fast_retrym
    v_smfmac_f32_16x16x64_bf16 v[52:55], v[20:23], v[96:103], v1
    ds_write_b128 v2, v[20:23] offset:1024
    v_smfmac_f32_16x16x64_bf16 v[56:59], v[16:19], v[72:79], v1
    buffer_load_dwordx4 v[104:107], v3, s[8:11], s29 offen offset:0 sc1
    buffer_load_dwordx4 v[120:123], v3, s[8:11], s30 offen offset:0 sc1
    v_smfmac_f32_16x16x64_bf16 v[60:63], v[16:19], v[80:87], v1
    buffer_load_dwordx4 v[108:111], v3, s[8:11], s29 offen offset:1024 sc1
    buffer_load_dwordx4 v[124:127], v3, s[8:11], s30 offen offset:1024 sc1
    v_smfmac_f32_16x16x64_bf16 v[56:59], v[20:23], a[80:87], v1
    buffer_load_dwordx4 v[112:115], v3, s[8:11], s29 offen offset:2048 sc1
    buffer_load_dwordx4 v[116:119], v3, s[8:11], s29 offen offset:3072 sc1
    v_smfmac_f32_16x16x64_bf16 v[60:63], v[20:23], a[88:95], v1
    s_waitcnt lgkmcnt(0)
    s_barrier
    ds_read_b128 v[24:27], v28 offset:0
    v_smfmac_f32_16x16x64_bf16 v[64:67], v[16:19], a[160:167], v1
    ds_read_b128 v[28:31], v28 offset:1024
    v_smfmac_f32_16x16x64_bf16 v[68:71], v[16:19], a[168:175], v1
    buffer_load_dword v15, v0, s[8:11], s24 offen sc1
    v_smfmac_f32_16x16x64_bf16 v[64:67], v[20:23], a[176:183], v1
    ds_read_b128 v[32:35], v8 offset:0
    v_smfmac_f32_16x16x64_bf16 v[68:71], v[20:23], a[184:191], v1
    ds_read_b128 v[36:39], v8 offset:1024
    s_waitcnt lgkmcnt(3)
    v_smfmac_f32_16x16x64_bf16 v[48:51], v[24:27], a[0:7], v1
    ds_read_b128 v[40:43], v44 offset:0
    v_smfmac_f32_16x16x64_bf16 v[52:55], v[24:27], a[8:15], v1
    ds_read_b128 v[44:47], v44 offset:1024
    s_waitcnt lgkmcnt(4)
    v_smfmac_f32_16x16x64_bf16 v[48:51], v[28:31], a[16:23], v1
    ds_read_b128 v[88:91], v4 offset:12288
    v_smfmac_f32_16x16x64_bf16 v[52:55], v[28:31], a[24:31], v1
    ds_read_b128 v[92:95], v4 offset:13312
    s_waitcnt lgkmcnt(4)
    v_smfmac_f32_16x16x64_bf16 v[48:51], v[32:35], a[32:39], v1
    ds_read_b128 v[96:99], v4 offset:14336
    v_smfmac_f32_16x16x64_bf16 v[52:55], v[32:35], a[40:47], v1
    ds_read_b128 v[100:103], v4 offset:15360
    s_waitcnt lgkmcnt(4)
    v_smfmac_f32_16x16x64_bf16 v[48:51], v[36:39], a[48:55], v1
    v_smfmac_f32_16x16x64_bf16 v[52:55], v[36:39], a[56:63], v1
    ds_read_b128 v[72:75], v4 offset:16384
    v_smfmac_f32_16x16x64_bf16 v[48:51], v[40:43], a[64:71], v1
    v_smfmac_f32_16x16x64_bf16 v[52:55], v[40:43], a[72:79], v1
    ds_read_b128 v[76:79], v4 offset:17408
    s_waitcnt lgkmcnt(2)
    v_smfmac_f32_16x16x64_bf16 v[48:51], v[44:47], v[88:95], v1
    ds_read_b128 v[80:83], v4 offset:18432
    v_smfmac_f32_16x16x64_bf16 v[52:55], v[44:47], v[96:103], v1
    ds_read_b128 v[84:87], v4 offset:19456
    v_smfmac_f32_16x16x64_bf16 v[56:59], v[28:31], a[96:103], v1
    ds_read_b128 v[88:91], v4 offset:20480
    s_nop 0
    v_smfmac_f32_16x16x64_bf16 v[60:63], v[28:31], a[104:111], v1
    ds_read_b128 v[92:95], v4 offset:21504
    v_add_f32 v48, v48, v50
    v_add_f32_e64 v49, v49, v51
    v_smfmac_f32_16x16x64_bf16 v[56:59], v[32:35], a[112:119], v1
    ds_read_b128 v[96:99], v4 offset:22528
    v_add_f32 v52, v52, v54
    v_add_f32 v53, v53, v55
    v_mul_f32_e64 v48, s33, v48
    v_smfmac_f32_16x16x64_bf16 v[60:63], v[32:35], a[120:127], v1
    ds_read_b128 v[100:103], v4 offset:23552
    v_mul_f32 v52, s33, v52
    v_mul_f32 v49, s33, v49
    v_mul_f32_e64 v53, s33, v53
    v_smfmac_f32_16x16x64_bf16 v[56:59], v[36:39], a[128:135], v1
    s_nop 0
    s_waitcnt lgkmcnt(4)
    v_cvt_pk_bf16_f32 v50, v48, v52
    v_cvt_pk_bf16_f32 v51, v49, v53
    v_smfmac_f32_16x16x64_bf16 v[56:59], v[24:27], v[72:79], v1
    ds_write2_b32 v5, v50, v51 offset0:0 offset1:72
    v_smfmac_f32_16x16x64_bf16 v[60:63], v[24:27], v[80:87], v1
    v_smfmac_f32_16x16x64_bf16 v[60:63], v[36:39], a[136:143], v1
    v_smfmac_f32_16x16x64_bf16 v[56:59], v[40:43], a[144:151], v1
    buffer_store_dword v12, v10, s[8:11], s31 offen sc1
    v_smfmac_f32_16x16x64_bf16 v[60:63], v[40:43], a[152:159], v1
    s_waitcnt lgkmcnt(0)
    s_barrier
    v_smfmac_f32_16x16x64_bf16 v[56:59], v[44:47], v[88:95], v1
    ds_read_b128 v[72:75], v6 offset:0
    v_smfmac_f32_16x16x64_bf16 v[60:63], v[44:47], v[96:103], v1
    ds_read_b128 v[76:79], v6 offset:64
    v_smfmac_f32_16x16x64_bf16 v[64:67], v[24:27], a[192:199], v1
    ds_read_b128 v[80:83], v6 offset:128
    v_smfmac_f32_16x16x64_bf16 v[68:71], v[24:27], a[200:207], v1
    ds_read_b128 v[84:87], v6 offset:192
    s_waitcnt vmcnt(2) lgkmcnt(3)
    v_mfma_f32_16x16x32_bf16 v[48:51], v[104:107], v[72:75], 0
    s_waitcnt lgkmcnt(2)
    v_add_f32 v56, v56, v58
    v_add_f32 v57, v57, v59
    v_mfma_f32_16x16x32_bf16 v[48:51], v[108:111], v[76:79], v[48:51]
    s_waitcnt lgkmcnt(1)
    v_add_f32 v60, v60, v62
    v_add_f32_e64 v61, v61, v63
    v_mfma_f32_16x16x32_bf16 v[48:51], v[112:115], v[80:83], v[48:51]
    s_waitcnt lgkmcnt(0)
    v_cvt_pk_bf16_f32 v58, v56, v60
    v_cvt_pk_bf16_f32 v59, v57, v61
    v_mfma_f32_16x16x32_bf16 v[48:51], v[116:119], v[84:87], v[48:51]
    ds_write2_b32 v7, v58, v59 offset0:0 offset1:72
    v_smfmac_f32_16x16x64_bf16 v[64:67], v[28:31], a[208:215], v1
    v_mov_b64 v[104:105], s[4:5]
    v_smfmac_f32_16x16x64_bf16 v[68:71], v[28:31], a[216:223], v1
    s_nop 1
    v_mov_b64 v[106:107], s[4:5]
    v_smfmac_f32_16x16x64_bf16 v[64:67], v[32:35], a[224:231], v1
    v_exp_f32_e64 v48, v48
    v_smfmac_f32_16x16x64_bf16 v[68:71], v[32:35], a[232:239], v1
    s_waitcnt lgkmcnt(0)
    s_barrier
    v_exp_f32_e64 v49, v49
    v_smfmac_f32_16x16x64_bf16 v[64:67], v[36:39], a[240:247], v1
    ds_read_b128 v[88:91], v6 offset:2304
    v_exp_f32_e64 v50, v50
    v_smfmac_f32_16x16x64_bf16 v[68:71], v[36:39], a[248:255], v1
    ds_read_b128 v[92:95], v6 offset:2368
    v_exp_f32_e64 v51, v51
    v_smfmac_f32_16x16x64_bf16 v[64:67], v[40:43], v[128:135], v1
    ds_read_b128 v[96:99], v6 offset:2432
    v_cvt_pk_bf16_f32 v108, v48, v49
    v_cvt_pk_bf16_f32 v109, v50, v51
    v_smfmac_f32_16x16x64_bf16 v[68:71], v[40:43], v[136:143], v1
    ds_read_b128 v[100:103], v6 offset:2496
    ds_write_b64 v2, v[108:109] offset:8192
    s_waitcnt lgkmcnt(4)
    v_mfma_f32_16x16x32_bf16 v[52:55], v[88:91], v[72:75], 0
    s_waitcnt lgkmcnt(3)
    v_mov_b32 v113, 0
    v_mov_b32 v115, 0
    v_mfma_f32_16x16x32_bf16 v[52:55], v[92:95], v[76:79], v[52:55]
    s_waitcnt lgkmcnt(2)
    v_mov_b32 v117, 0
    v_mov_b64_e64 v[16:17], 0
    v_mfma_f32_16x16x32_bf16 v[52:55], v[96:99], v[80:83], v[52:55]
    s_waitcnt lgkmcnt(1)
    v_mov_b64 v[18:19], 0
    v_mov_b64_e64 v[20:21], 0
    v_mfma_f32_16x16x32_bf16 v[52:55], v[100:103], v[84:87], v[52:55]
    s_waitcnt lgkmcnt(0)
    s_barrier
    v_smfmac_f32_16x16x64_bf16 v[64:67], v[44:47], v[144:151], v1
    ds_read_b64 v[110:111], v8 offset:8192
    v_mov_b64_e64 v[22:23], 0
    v_smfmac_f32_16x16x64_bf16 v[68:71], v[44:47], v[152:159], v1
    v_mov_b64 v[24:25], 0
    v_mov_b64 v[26:27], 0
    v_exp_f32 v52, v52
    v_exp_f32_e64 v53, v53
    s_waitcnt lgkmcnt(0)
    v_mfma_f32_16x16x32_bf16 v[48:51], v[104:107], v[108:111], 0
    v_cvt_pk_bf16_f32 v112, v52, v53
    v_add_f32_e64 v64, v64, v66
    v_mfma_f32_16x16x32_bf16 v[56:59], v[120:123], v[108:111], 0
    v_add_f32 v65, v65, v67
    v_add_f32 v68, v68, v70
    v_mfma_f32_16x16x32_bf16 v[60:63], v[124:127], v[108:111], 0
    v_cvt_pk_bf16_f32 v114, v64, v65
    v_add_f32_e64 v69, v69, v71
    v_mfma_f32_16x16x16_bf16 v[48:51], v[104:105], v[112:113], v[48:51]
    v_cvt_pk_bf16_f32 v116, v68, v69
    v_mov_b64_e64 v[28:29], 0
    v_mfma_f32_16x16x16_bf16 v[56:59], v[114:115], v[112:113], v[56:59]
    v_mov_b64_e64 v[30:31], 0
    v_bitop3_b32 v32, v13, s96, -9 bitop3:0x28
    v_mfma_f32_16x16x16_bf16 v[60:63], v[116:117], v[112:113], v[60:63]
    v_bitop3_b32 v36, v13, s97, -9 bitop3:0x28
    v_bitop3_b32 v40, v13, s98, -9 bitop3:0x28
    v_rcp_f32 v118, v48
    s_nop 0
    v_max_f32 v14, v118, v48
    v_cmp_nge_f32 vcc, s40, v14
    v_pk_mul_f32 v[56:57], v[56:57], v[118:119] op_sel_hi:[1,0]
    v_pk_mul_f32 v[58:59], v[58:59], v[118:119] op_sel_hi:[1,0]
    v_pk_mul_f32 v[60:61], v[60:61], v[118:119] op_sel_hi:[1,0]
    v_pk_mul_f32 v[62:63], v[62:63], v[118:119] op_sel_hi:[1,0]
    v_cvt_pk_bf16_f32 v52, v56, v60
    v_cvt_pk_bf16_f32 v54, v58, v62
    v_cvt_pk_bf16_f32 v53, v57, v61
    v_cvt_pk_bf16_f32 v55, v59, v63
L_fast_rejoin:
    v_cndmask_b32 v50, v52, v54, s[92:93]
    v_cndmask_b32 v51, v53, v55, s[92:93]
    ds_write_b64 v13, v[50:51] offset:9216
    v_smfmac_f32_16x16x64_bf16 v[16:19], v[52:55], v[160:167], v1
    v_smfmac_f32_16x16x64_bf16 v[20:23], v[52:55], v[168:175], v1
    s_waitcnt lgkmcnt(0)
    s_barrier
    ds_read_b128 v[32:35], v32 offset:9216
    ds_read_b128 v[36:39], v36 offset:9216
    v_smfmac_f32_16x16x64_bf16 v[24:27], v[52:55], v[176:183], v1
    ds_read_b128 v[40:43], v40 offset:9216
    v_smfmac_f32_16x16x64_bf16 v[28:31], v[52:55], v[184:191], v1
    ds_read_b128 v[88:91], v4 offset:24576
    ds_read_b128 v[92:95], v4 offset:25600
    s_waitcnt lgkmcnt(4)
    v_smfmac_f32_16x16x64_bf16 v[16:19], v[32:35], v[192:199], v1
    ds_read_b128 v[96:99], v4 offset:26624
    s_waitcnt lgkmcnt(4)
    v_smfmac_f32_16x16x64_bf16 v[16:19], v[36:39], v[216:223], v1
    ds_read_b128 v[100:103], v4 offset:27648
    s_waitcnt lgkmcnt(4)
    v_smfmac_f32_16x16x64_bf16 v[16:19], v[40:43], v[240:247], v1
    ds_read_b128 v[72:75], v4 offset:28672
    s_cmp_lg_u64 vcc, 0
    v_smfmac_f32_16x16x64_bf16 v[20:23], v[32:35], v[200:207], v1
    ds_read_b128 v[76:79], v4 offset:29696
    s_cselect_b32 s60, s28, s27
    v_smfmac_f32_16x16x64_bf16 v[20:23], v[36:39], v[224:231], v1
    ds_read_b128 v[80:83], v4 offset:30720
    s_nop 0
    v_cvt_pk_bf16_f32 v56, v16, v18
    v_smfmac_f32_16x16x64_bf16 v[20:23], v[40:43], v[248:255], v1
    ds_read_b128 v[84:87], v4 offset:31744
    v_cvt_pk_bf16_f32 v57, v17, v19
    v_and_or_b32 v56, v56, -2, s60
    v_smfmac_f32_16x16x64_bf16 v[24:27], v[32:35], v[208:215], v1
    buffer_store_dwordx2 v[56:57], v9, s[8:11], 0 offen offset:0
    v_smfmac_f32_16x16x64_bf16 v[24:27], v[36:39], v[232:239], v1
    s_waitcnt lgkmcnt(4)
    s_nop 0
    v_cvt_pk_bf16_f32 v58, v20, v22
    v_smfmac_f32_16x16x64_bf16 v[24:27], v[40:43], v[88:95], v1
    ds_read_b128 v[64:67], v3 offset:23040
    v_cvt_pk_bf16_f32 v59, v21, v23
    v_and_or_b32 v58, v58, -2, s60
    v_smfmac_f32_16x16x64_bf16 v[28:31], v[32:35], v[96:103], v1
    buffer_store_dwordx2 v[58:59], v9, s[8:11], 0 offen offset:2048
    s_waitcnt lgkmcnt(1)
    v_smfmac_f32_16x16x64_bf16 v[28:31], v[36:39], v[72:79], v1
    s_nop 1
    v_cvt_pk_bf16_f32 v60, v24, v26
    v_smfmac_f32_16x16x64_bf16 v[28:31], v[40:43], v[80:87], v1
    s_nop 0
    s_nop 2
    v_cvt_pk_bf16_f32 v61, v25, v27
    v_and_or_b32 v60, v60, -2, s60
    buffer_store_dwordx2 v[60:61], v9, s[8:11], s26 offen offset:0
    s_nop 1
    v_cvt_pk_bf16_f32 v62, v28, v30
    v_cvt_pk_bf16_f32 v63, v29, v31
    v_and_or_b32 v62, v62, -2, s60
    buffer_store_dwordx2 v[62:63], v9, s[8:11], s26 offen offset:2048
L_fast_stored:
    s_cmp_lg_u32 s60, s27
    s_cbranch_scc1 L_fast_safe
    ds_read_b128 v[104:107], v4 offset:0
    ds_read_b128 v[108:111], v4 offset:1024
    ds_read_b128 v[112:115], v4 offset:2048
    ds_read_b128 v[116:119], v4 offset:3072
    ds_read_b128 v[88:91], v4 offset:4096
    ds_read_b128 v[92:95], v4 offset:5120
    ds_read_b128 v[96:99], v4 offset:6144
    ds_read_b128 v[100:103], v4 offset:7168
    ds_read_b128 v[72:75], v4 offset:8192
    ds_read_b128 v[76:79], v4 offset:9216
    ds_read_b128 v[80:83], v4 offset:10240
    ds_read_b128 v[84:87], v4 offset:11264
    s_cmp_lt_u32 s21, 1
    s_cbranch_scc1 L_fast_pollp
    s_nop 9
    s_cmp_lt_u32 s21, 2
    s_cbranch_scc1 L_fast_pollp
    s_nop 9
    s_cmp_lt_u32 s21, 3
    s_cbranch_scc1 L_fast_pollp
    s_nop 9
L_fast_pollp:
    buffer_load_dwordx4 v[120:123], v2, s[8:11], s6 offen sc1
    buffer_load_dwordx4 v[124:127], v2, s[8:11], s6 offen offset:1024 sc1
    v_mov_b64 v[56:57], 0
    v_mov_b64 v[58:59], 0
    v_mov_b64 v[60:61], 0
    v_mov_b64 v[62:63], 0
    s_nop 15
    s_nop 15
    buffer_load_dwordx4 v[32:35], v2, s[8:11], s6 offen sc1
    buffer_load_dwordx4 v[36:39], v2, s[8:11], s6 offen offset:1024 sc1
L_fast_prep:
    s_add_u32 s7, s24, 0x80000
    s_waitcnt vmcnt(3) lgkmcnt(0)
    v_mfma_f32_16x16x32_bf16 v[68:71], v[64:67], v[120:123], 0
    v_bitop3_b32 v14, v120, v122, s27 bitop3:0x7e
    s_waitcnt vmcnt(2)
    v_mfma_f32_16x16x32_bf16 v[68:71], v[64:67], v[124:127], v[68:71]
    v_bitop3_b32 v11, v124, v126, s27 bitop3:0x7e
    v_bitop3_b32 v14, v14, v11, 1 bitop3:0xa8
    v_cmp_ne_u32 vcc, 0, v14
    s_nop 2
    s_cmp_eq_u64 vcc, 0
    s_cselect_b32 s36, s24, s61
    v_add_f32_dpp v68, v68, v68 row_ror:8 row_mask:0xf bank_mask:0xf
    v_add_f32_dpp v69, v69, v69 row_ror:8 row_mask:0xf bank_mask:0xf
    s_nop 0
    v_add_f32_dpp v68, v68, v68 row_ror:4 row_mask:0xf bank_mask:0xf
    v_add_f32_dpp v69, v69, v69 row_ror:4 row_mask:0xf bank_mask:0xf
    v_cvt_pk_bf16_f32 v12, v68, v69
    buffer_store_dword v12, v10, s[8:11], s36 offen
    s_cbranch_scc1 L_fast_gotp
L_fast_retryp:
    buffer_load_dwordx4 v[120:123], v2, s[8:11], s6 offen sc1
    buffer_load_dwordx4 v[124:127], v2, s[8:11], s6 offen offset:1024 sc1
    s_waitcnt vmcnt(4) lgkmcnt(0)
    v_mfma_f32_16x16x32_bf16 v[68:71], v[64:67], v[32:35], 0
    v_bitop3_b32 v14, v32, v34, s27 bitop3:0x7e
    s_waitcnt vmcnt(3)
    v_mfma_f32_16x16x32_bf16 v[68:71], v[64:67], v[36:39], v[68:71]
    v_bitop3_b32 v11, v36, v38, s27 bitop3:0x7e
    v_bitop3_b32 v14, v14, v11, 1 bitop3:0xa8
    v_cmp_ne_u32 vcc, 0, v14
    s_nop 2
    s_cmp_eq_u64 vcc, 0
    s_cselect_b32 s36, s24, s61
    v_add_f32_dpp v68, v68, v68 row_ror:8 row_mask:0xf bank_mask:0xf
    v_add_f32_dpp v69, v69, v69 row_ror:8 row_mask:0xf bank_mask:0xf
    s_nop 0
    v_add_f32_dpp v68, v68, v68 row_ror:4 row_mask:0xf bank_mask:0xf
    v_add_f32_dpp v69, v69, v69 row_ror:4 row_mask:0xf bank_mask:0xf
    v_cvt_pk_bf16_f32 v12, v68, v69
    buffer_store_dword v12, v10, s[8:11], s36 offen
    s_cbranch_scc1 L_fast_gotp
    buffer_load_dwordx4 v[32:35], v2, s[8:11], s6 offen sc1
    buffer_load_dwordx4 v[36:39], v2, s[8:11], s6 offen offset:1024 sc1
    s_waitcnt vmcnt(4) lgkmcnt(0)
    v_mfma_f32_16x16x32_bf16 v[68:71], v[64:67], v[120:123], 0
    v_bitop3_b32 v14, v120, v122, s27 bitop3:0x7e
    s_waitcnt vmcnt(3)
    v_mfma_f32_16x16x32_bf16 v[68:71], v[64:67], v[124:127], v[68:71]
    v_bitop3_b32 v11, v124, v126, s27 bitop3:0x7e
    v_bitop3_b32 v14, v14, v11, 1 bitop3:0xa8
    v_cmp_ne_u32 vcc, 0, v14
    s_nop 2
    s_cmp_eq_u64 vcc, 0
    s_cselect_b32 s36, s24, s61
    v_add_f32_dpp v68, v68, v68 row_ror:8 row_mask:0xf bank_mask:0xf
    v_add_f32_dpp v69, v69, v69 row_ror:8 row_mask:0xf bank_mask:0xf
    s_nop 0
    v_add_f32_dpp v68, v68, v68 row_ror:4 row_mask:0xf bank_mask:0xf
    v_add_f32_dpp v69, v69, v69 row_ror:4 row_mask:0xf bank_mask:0xf
    v_cvt_pk_bf16_f32 v12, v68, v69
    buffer_store_dword v12, v10, s[8:11], s36 offen
    s_cbranch_scc1 L_fast_gotp
    s_add_u32 s32, s32, 1
    s_cmp_le_u32 s32, 200000
    s_cbranch_scc1 L_fast_retryp
    s_mov_b32 s36, s24
    buffer_store_dword v12, v10, s[8:11], s36 offen
L_fast_gotp:
    s_add_u32 s31, s31, 0x2000
    s_cmp_ge_u32 s90, 63
    s_cbranch_scc1 L_fast_last
    s_mov_b32 s23, s24
    s_mov_b32 s22, s90
    s_mov_b32 s27, s28
    v_mov_b64 v[64:65], 0
    v_mov_b64 v[66:67], 0
    v_mov_b64 v[68:69], 0
    v_mov_b64 v[70:71], 0
    s_nop 15
    s_nop 11
    buffer_load_dwordx4 v[16:19], v2, s[8:11], s7 offen sc1
    buffer_load_dwordx4 v[20:23], v2, s[8:11], s7 offen offset:1024 sc1
    s_branch L_fast_step
L_fast_last:
    buffer_store_dword v12, v10, s[8:11], s31 offen sc1
    s_branch L_fast_done
L_fast_refresh:
    buffer_load_dword v15, v0, s[8:11], s23 offen sc1
    s_add_u32 s32, s32, 1
    s_cmp_le_u32 s32, 200000
    s_waitcnt vmcnt(0)
    s_cbranch_scc1 L_fast_step
    s_branch L_fast_fresh
L_fast_safe:
    s_nop 11
    s_waitcnt vmcnt(0) lgkmcnt(0)
    s_barrier
    ds_read_b128 v[72:75], v6 offset:0
    ds_read_b128 v[88:91], v6 offset:2304
    ds_read_b128 v[76:79], v6 offset:64
    ds_read_b128 v[92:95], v6 offset:2368
    ds_read_b128 v[80:83], v6 offset:128
    ds_read_b128 v[96:99], v6 offset:2432
    ds_read_b128 v[84:87], v6 offset:192
    ds_read_b128 v[100:103], v6 offset:2496
    s_xor_b32 s36, s25, 0x1000
    s_add_u32 s36, s36, s23
    buffer_load_dwordx4 v[16:19], v3, s[8:11], s29 offen offset:0 sc1
    buffer_load_dwordx4 v[32:35], v3, s[8:11], s36 offen offset:0 sc1
    buffer_load_dwordx4 v[20:23], v3, s[8:11], s29 offen offset:1024 sc1
    buffer_load_dwordx4 v[36:39], v3, s[8:11], s36 offen offset:1024 sc1
    buffer_load_dwordx4 v[24:27], v3, s[8:11], s29 offen offset:2048 sc1
    buffer_load_dwordx4 v[40:43], v3, s[8:11], s36 offen offset:2048 sc1
    buffer_load_dwordx4 v[28:31], v3, s[8:11], s29 offen offset:3072 sc1
    buffer_load_dwordx4 v[44:47], v3, s[8:11], s36 offen offset:3072 sc1
    s_waitcnt vmcnt(0) lgkmcnt(0)
    v_mfma_f32_16x16x32_bf16 v[48:51], v[16:19], v[72:75], 0
    v_mfma_f32_16x16x32_bf16 v[48:51], v[20:23], v[76:79], v[48:51]
    v_mfma_f32_16x16x32_bf16 v[48:51], v[24:27], v[80:83], v[48:51]
    v_mfma_f32_16x16x32_bf16 v[48:51], v[28:31], v[84:87], v[48:51]
    v_mfma_f32_16x16x32_bf16 v[52:55], v[32:35], v[72:75], 0
    v_mfma_f32_16x16x32_bf16 v[52:55], v[36:39], v[76:79], v[52:55]
    v_mfma_f32_16x16x32_bf16 v[52:55], v[40:43], v[80:83], v[52:55]
    v_mfma_f32_16x16x32_bf16 v[52:55], v[44:47], v[84:87], v[52:55]
    v_mfma_f32_16x16x32_bf16 v[56:59], v[88:91], v[72:75], 0
    v_mfma_f32_16x16x32_bf16 v[56:59], v[92:95], v[76:79], v[56:59]
    v_mfma_f32_16x16x32_bf16 v[56:59], v[96:99], v[80:83], v[56:59]
    v_mfma_f32_16x16x32_bf16 v[56:59], v[100:103], v[84:87], v[56:59]
    v_max3_f32 v16, v48, v49, v50
    s_nop 2
    v_max3_f32 v16, v16, v51, v52
    v_max3_f32 v16, v16, v53, v54
    s_nop 1
    v_max3_f32 v16, v16, v55, v56
    v_max_f32 v16, v16, v57
    v_mov_b32 v17, v16
    s_nop 1
    v_permlane16_swap_b32 v16, v17
    v_max_f32 v16, v16, v17
    v_mov_b32 v17, v16
    s_nop 1
    v_permlane32_swap_b32 v16, v17
    v_max_f32 v16, v16, v17
    v_sub_f32 v48, v48, v16
    v_exp_f32 v48, v48
    v_sub_f32 v49, v49, v16
    v_exp_f32 v49, v49
    v_sub_f32 v50, v50, v16
    v_exp_f32 v50, v50
    v_sub_f32 v51, v51, v16
    v_exp_f32 v51, v51
    v_sub_f32 v52, v52, v16
    v_exp_f32 v52, v52
    v_sub_f32 v53, v53, v16
    v_exp_f32 v53, v53
    v_sub_f32 v54, v54, v16
    v_exp_f32 v54, v54
    v_sub_f32 v55, v55, v16
    v_exp_f32 v55, v55
    v_sub_f32 v56, v56, v16
    v_exp_f32 v56, v56
    v_sub_f32 v57, v57, v16
    v_exp_f32 v57, v57
    v_cvt_pk_bf16_f32 v108, v48, v49
    v_cvt_pk_bf16_f32 v109, v50, v51
    v_cvt_pk_bf16_f32 v110, v52, v53
    v_cvt_pk_bf16_f32 v111, v54, v55
    v_cvt_pk_bf16_f32 v112, v56, v57
    s_nop 0
    v_mfma_f32_16x16x32_bf16 v[48:51], v[104:107], v[108:111], 0
    v_mfma_f32_16x16x32_bf16 v[56:59], v[120:123], v[108:111], 0
    v_mfma_f32_16x16x32_bf16 v[60:63], v[124:127], v[108:111], 0
    s_nop 3
    v_mfma_f32_16x16x16_bf16 v[48:51], v[104:105], v[112:113], v[48:51]
    v_mfma_f32_16x16x16_bf16 v[56:59], v[114:115], v[112:113], v[56:59]
    v_mfma_f32_16x16x16_bf16 v[60:63], v[116:117], v[112:113], v[60:63]
    s_nop 5
    v_rcp_f32 v118, v48
    s_nop 0
    v_mul_f32 v56, v56, v118
    v_mul_f32 v57, v57, v118
    v_mul_f32 v58, v58, v118
    v_mul_f32 v59, v59, v118
    v_mul_f32 v60, v60, v118
    v_mul_f32 v61, v61, v118
    v_mul_f32 v62, v62, v118
    v_mul_f32 v63, v63, v118
    v_cvt_pk_bf16_f32 v52, v56, v60
    v_cvt_pk_bf16_f32 v53, v57, v61
    v_cvt_pk_bf16_f32 v54, v58, v62
    v_cvt_pk_bf16_f32 v55, v59, v63
    v_mov_b32 v16, 0
    v_mov_b32 v17, 0
    v_mov_b32 v18, 0
    v_mov_b32 v19, 0
    v_mov_b32 v20, 0
    v_mov_b32 v21, 0
    v_mov_b32 v22, 0
    v_mov_b32 v23, 0
    v_mov_b32 v24, 0
    v_mov_b32 v25, 0
    v_mov_b32 v26, 0
    v_mov_b32 v27, 0
    v_mov_b32 v28, 0
    v_mov_b32 v29, 0
    v_mov_b32 v30, 0
    v_mov_b32 v31, 0
    v_bitop3_b32 v32, v13, s96, -9 bitop3:0x28
    v_bitop3_b32 v36, v13, s97, -9 bitop3:0x28
    v_bitop3_b32 v40, v13, s98, -9 bitop3:0x28
    s_mov_b64 vcc, 0
    s_branch L_fast_rejoin
L_fast_done:
    s_branch L_end
L_slow_start:
    s_mov_b32 s22, 0
    s_mov_b32 s23, 0x1000000
    s_mov_b32 s27, 0
    s_mov_b32 s31, 0x80000
    s_mov_b32 s61, 0x40000000
    s_mov_b32 s96, 0x800
    s_mov_b32 s97, 0x1000
    s_mov_b32 s98, 0x1800
    s_mov_b32 s92, 0xcccccccc
    s_mov_b32 s93, 0xcccccccc
    s_mov_b32 s91, 0
    ds_read_b128 v[104:107], v4 offset:0
    ds_read_b128 v[108:111], v4 offset:1024
    ds_read_b128 v[112:115], v4 offset:2048
    ds_read_b128 v[116:119], v4 offset:3072
    ds_read_b128 v[88:91], v4 offset:4096
    ds_read_b128 v[92:95], v4 offset:5120
    ds_read_b128 v[96:99], v4 offset:6144
    ds_read_b128 v[100:103], v4 offset:7168
    ds_read_b128 v[72:75], v4 offset:8192
    ds_read_b128 v[76:79], v4 offset:9216
    ds_read_b128 v[80:83], v4 offset:10240
    ds_read_b128 v[84:87], v4 offset:11264
    v_mov_b64 v[48:49], 0
    v_mov_b64 v[50:51], 0
    v_mov_b64 v[52:53], 0
    v_mov_b64 v[54:55], 0
    v_mov_b64 v[56:57], 0
    v_mov_b64 v[58:59], 0
    v_mov_b64 v[60:61], 0
    v_mov_b64 v[62:63], 0
    v_mov_b64 v[64:65], 0
    v_mov_b64 v[66:67], 0
    v_mov_b64 v[68:69], 0
    v_mov_b64 v[70:71], 0
    s_add_u32 s7, s23, 0x80000
    buffer_load_dwordx4 v[16:19], v2, s[8:11], s7 offen sc1
    buffer_load_dwordx4 v[20:23], v2, s[8:11], s7 offen offset:1024 sc1
    s_waitcnt vmcnt(2)
L_slow_step:
    v_readlane_b32 s36, v15, 33
    s_add_u32 s24, s23, 0x82100
    s_cmp_eq_u32 s36, 0
    s_cbranch_scc1 L_slow_refresh
L_slow_fresh:
    s_add_u32 s29, s23, s25
    s_add_u32 s30, s23, s39
    s_xor_b32 s28, s27, 1
    s_add_u32 s90, s22, 1
    s_nop 15
L_slow_retrym:
    buffer_load_dwordx4 v[16:19], v2, s[8:11], s7 offen sc1
    buffer_load_dwordx4 v[20:23], v2, s[8:11], s7 offen offset:1024 sc1
L_slow_prem:
    s_add_u32 s32, s32, 1
    s_cmp_gt_u32 s32, 200000
    s_cselect_b32 s94, -1, -2
    v_xor_b32 v28, 0x800, v2
    v_xor_b32 v44, 0x1800, v2
    v_mov_b64 v[48:49], 0
    v_mov_b64 v[50:51], 0
    v_mov_b64 v[52:53], 0
    v_mov_b64 v[54:55], 0
L_slow_waitm:
    s_waitcnt vmcnt(3) lgkmcnt(0)
L_slow_gotm:
    v_max3_u32 v14, v16, v17, v18
    v_max_u32 v14, v14, v19
    v_smfmac_f32_16x16x64_bf16 v[48:51], v[16:19], v[104:111], v1
    s_waitcnt vmcnt(2)
    v_max3_u32 v14, v14, v20, v21
    v_smfmac_f32_16x16x64_bf16 v[52:55], v[16:19], v[112:119], v1
    v_max3_u32 v14, v14, v22, v23
    v_cmp_lt_u32 vcc, s94, v14
    v_smfmac_f32_16x16x64_bf16 v[48:51], v[20:23], v[88:95], v1
    ds_write_b128 v2, v[16:19] offset:0
    s_cbranch_vccnz L_slow_retrym
    v_smfmac_f32_16x16x64_bf16 v[52:55], v[20:23], v[96:103], v1
    ds_write_b128 v2, v[20:23] offset:1024
    v_smfmac_f32_16x16x64_bf16 v[56:59], v[16:19], v[72:79], v1
    buffer_load_dwordx4 v[104:107], v3, s[8:11], s29 offen offset:0 sc1
    buffer_load_dwordx4 v[120:123], v3, s[8:11], s30 offen offset:0 sc1
    v_smfmac_f32_16x16x64_bf16 v[60:63], v[16:19], v[80:87], v1
    buffer_load_dwordx4 v[108:111], v3, s[8:11], s29 offen offset:1024 sc1
    buffer_load_dwordx4 v[124:127], v3, s[8:11], s30 offen offset:1024 sc1
    v_smfmac_f32_16x16x64_bf16 v[56:59], v[20:23], a[80:87], v1
    buffer_load_dwordx4 v[112:115], v3, s[8:11], s29 offen offset:2048 sc1
    buffer_load_dwordx4 v[116:119], v3, s[8:11], s29 offen offset:3072 sc1
    v_smfmac_f32_16x16x64_bf16 v[60:63], v[20:23], a[88:95], v1
    s_waitcnt lgkmcnt(0)
    s_barrier
    ds_read_b128 v[24:27], v28 offset:0
    v_smfmac_f32_16x16x64_bf16 v[64:67], v[16:19], a[160:167], v1
    ds_read_b128 v[28:31], v28 offset:1024
    v_smfmac_f32_16x16x64_bf16 v[68:71], v[16:19], a[168:175], v1
    buffer_load_dword v15, v0, s[8:11], s24 offen sc1
    v_smfmac_f32_16x16x64_bf16 v[64:67], v[20:23], a[176:183], v1
    ds_read_b128 v[32:35], v8 offset:0
    v_smfmac_f32_16x16x64_bf16 v[68:71], v[20:23], a[184:191], v1
    ds_read_b128 v[36:39], v8 offset:1024
    s_waitcnt lgkmcnt(3)
    v_smfmac_f32_16x16x64_bf16 v[48:51], v[24:27], a[0:7], v1
    ds_read_b128 v[40:43], v44 offset:0
    v_smfmac_f32_16x16x64_bf16 v[52:55], v[24:27], a[8:15], v1
    ds_read_b128 v[44:47], v44 offset:1024
    s_waitcnt lgkmcnt(4)
    v_smfmac_f32_16x16x64_bf16 v[48:51], v[28:31], a[16:23], v1
    ds_read_b128 v[88:91], v4 offset:12288
    v_smfmac_f32_16x16x64_bf16 v[52:55], v[28:31], a[24:31], v1
    ds_read_b128 v[92:95], v4 offset:13312
    s_waitcnt lgkmcnt(4)
    v_smfmac_f32_16x16x64_bf16 v[48:51], v[32:35], a[32:39], v1
    ds_read_b128 v[96:99], v4 offset:14336
    v_smfmac_f32_16x16x64_bf16 v[52:55], v[32:35], a[40:47], v1
    ds_read_b128 v[100:103], v4 offset:15360
    s_waitcnt lgkmcnt(4)
    v_smfmac_f32_16x16x64_bf16 v[48:51], v[36:39], a[48:55], v1
    v_smfmac_f32_16x16x64_bf16 v[52:55], v[36:39], a[56:63], v1
    ds_read_b128 v[72:75], v4 offset:16384
    v_smfmac_f32_16x16x64_bf16 v[48:51], v[40:43], a[64:71], v1
    v_smfmac_f32_16x16x64_bf16 v[52:55], v[40:43], a[72:79], v1
    ds_read_b128 v[76:79], v4 offset:17408
    s_waitcnt lgkmcnt(2)
    v_smfmac_f32_16x16x64_bf16 v[48:51], v[44:47], v[88:95], v1
    ds_read_b128 v[80:83], v4 offset:18432
    v_smfmac_f32_16x16x64_bf16 v[52:55], v[44:47], v[96:103], v1
    ds_read_b128 v[84:87], v4 offset:19456
    v_smfmac_f32_16x16x64_bf16 v[56:59], v[28:31], a[96:103], v1
    ds_read_b128 v[88:91], v4 offset:20480
    s_nop 0
    v_smfmac_f32_16x16x64_bf16 v[60:63], v[28:31], a[104:111], v1
    ds_read_b128 v[92:95], v4 offset:21504
    v_add_f32 v48, v48, v50
    v_add_f32 v49, v49, v51
    v_smfmac_f32_16x16x64_bf16 v[56:59], v[32:35], a[112:119], v1
    ds_read_b128 v[96:99], v4 offset:22528
    v_add_f32 v52, v52, v54
    v_add_f32 v53, v53, v55
    v_mul_f32 v48, s33, v48
    v_smfmac_f32_16x16x64_bf16 v[60:63], v[32:35], a[120:127], v1
    ds_read_b128 v[100:103], v4 offset:23552
    v_mul_f32 v52, s33, v52
    v_mul_f32 v49, s33, v49
    v_mul_f32 v53, s33, v53
    v_smfmac_f32_16x16x64_bf16 v[56:59], v[36:39], a[128:135], v1
    s_waitcnt lgkmcnt(4)
    v_cvt_pk_bf16_f32 v50, v48, v52
    v_cvt_pk_bf16_f32 v51, v49, v53
    v_smfmac_f32_16x16x64_bf16 v[56:59], v[24:27], v[72:79], v1
    ds_write2_b32 v5, v50, v51 offset0:0 offset1:72
    v_smfmac_f32_16x16x64_bf16 v[60:63], v[24:27], v[80:87], v1
    v_smfmac_f32_16x16x64_bf16 v[60:63], v[36:39], a[136:143], v1
    v_smfmac_f32_16x16x64_bf16 v[56:59], v[40:43], a[144:151], v1
    buffer_store_dword v12, v10, s[8:11], s31 offen sc1
    v_smfmac_f32_16x16x64_bf16 v[60:63], v[40:43], a[152:159], v1
    s_waitcnt lgkmcnt(0)
    s_barrier
    v_smfmac_f32_16x16x64_bf16 v[56:59], v[44:47], v[88:95], v1
    ds_read_b128 v[72:75], v6 offset:0
    v_smfmac_f32_16x16x64_bf16 v[60:63], v[44:47], v[96:103], v1
    ds_read_b128 v[76:79], v6 offset:64
    v_smfmac_f32_16x16x64_bf16 v[64:67], v[24:27], a[192:199], v1
    ds_read_b128 v[80:83], v6 offset:128
    v_smfmac_f32_16x16x64_bf16 v[68:71], v[24:27], a[200:207], v1
    ds_read_b128 v[84:87], v6 offset:192
    s_waitcnt vmcnt(2) lgkmcnt(3)
    v_mfma_f32_16x16x32_bf16 v[48:51], v[104:107], v[72:75], 0
    s_waitcnt lgkmcnt(2)
    v_add_f32 v56, v56, v58
    v_add_f32 v57, v57, v59
    v_mfma_f32_16x16x32_bf16 v[48:51], v[108:111], v[76:79], v[48:51]
    s_waitcnt lgkmcnt(1)
    v_add_f32 v60, v60, v62
    v_add_f32 v61, v61, v63
    v_mfma_f32_16x16x32_bf16 v[48:51], v[112:115], v[80:83], v[48:51]
    s_waitcnt lgkmcnt(0)
    v_cvt_pk_bf16_f32 v58, v56, v60
    v_cvt_pk_bf16_f32 v59, v57, v61
    v_mfma_f32_16x16x32_bf16 v[48:51], v[116:119], v[84:87], v[48:51]
    ds_write2_b32 v7, v58, v59 offset0:0 offset1:72
    v_smfmac_f32_16x16x64_bf16 v[64:67], v[28:31], a[208:215], v1
    v_mov_b64 v[104:105], s[4:5]
    v_smfmac_f32_16x16x64_bf16 v[68:71], v[28:31], a[216:223], v1
    s_nop 1
    v_mov_b64 v[106:107], s[4:5]
    v_smfmac_f32_16x16x64_bf16 v[64:67], v[32:35], a[224:231], v1
    v_exp_f32 v48, v48
    v_smfmac_f32_16x16x64_bf16 v[68:71], v[32:35], a[232:239], v1
    s_waitcnt lgkmcnt(0)
    s_barrier
    v_exp_f32 v49, v49
    v_smfmac_f32_16x16x64_bf16 v[64:67], v[36:39], a[240:247], v1
    ds_read_b128 v[88:91], v6 offset:2304
    v_exp_f32 v50, v50
    v_smfmac_f32_16x16x64_bf16 v[68:71], v[36:39], a[248:255], v1
    ds_read_b128 v[92:95], v6 offset:2368
    v_exp_f32 v51, v51
    v_smfmac_f32_16x16x64_bf16 v[64:67], v[40:43], v[128:135], v1
    ds_read_b128 v[96:99], v6 offset:2432
    v_cvt_pk_bf16_f32 v108, v48, v49
    v_cvt_pk_bf16_f32 v109, v50, v51
    v_smfmac_f32_16x16x64_bf16 v[68:71], v[40:43], v[136:143], v1
    ds_read_b128 v[100:103], v6 offset:2496
    ds_write_b64 v2, v[108:109] offset:8192
    s_waitcnt lgkmcnt(4)
    v_mfma_f32_16x16x32_bf16 v[52:55], v[88:91], v[72:75], 0
    s_waitcnt lgkmcnt(3)
    v_mov_b32 v113, 0
    v_mov_b32 v115, 0
    v_mfma_f32_16x16x32_bf16 v[52:55], v[92:95], v[76:79], v[52:55]
    s_waitcnt lgkmcnt(2)
    v_mov_b32 v117, 0
    v_mov_b64 v[16:17], 0
    v_mfma_f32_16x16x32_bf16 v[52:55], v[96:99], v[80:83], v[52:55]
    s_waitcnt lgkmcnt(1)
    v_mov_b64 v[18:19], 0
    v_mov_b64 v[20:21], 0
    v_mfma_f32_16x16x32_bf16 v[52:55], v[100:103], v[84:87], v[52:55]
    s_waitcnt lgkmcnt(0)
    s_barrier
    v_smfmac_f32_16x16x64_bf16 v[64:67], v[44:47], v[144:151], v1
    ds_read_b64 v[110:111], v8 offset:8192
    v_mov_b64 v[22:23], 0
    v_smfmac_f32_16x16x64_bf16 v[68:71], v[44:47], v[152:159], v1
    v_mov_b64 v[24:25], 0
    v_mov_b64 v[26:27], 0
    v_exp_f32 v52, v52
    v_exp_f32 v53, v53
    s_waitcnt lgkmcnt(0)
    v_mfma_f32_16x16x32_bf16 v[48:51], v[104:107], v[108:111], 0
    v_cvt_pk_bf16_f32 v112, v52, v53
    v_add_f32 v64, v64, v66
    v_mfma_f32_16x16x32_bf16 v[56:59], v[120:123], v[108:111], 0
    v_add_f32 v65, v65, v67
    v_add_f32 v68, v68, v70
    v_mfma_f32_16x16x32_bf16 v[60:63], v[124:127], v[108:111], 0
    v_cvt_pk_bf16_f32 v114, v64, v65
    v_add_f32 v69, v69, v71
    v_mfma_f32_16x16x16_bf16 v[48:51], v[104:105], v[112:113], v[48:51]
    v_cvt_pk_bf16_f32 v116, v68, v69
    v_mov_b64 v[28:29], 0
    v_mfma_f32_16x16x16_bf16 v[56:59], v[114:115], v[112:113], v[56:59]
    v_mov_b64 v[30:31], 0
    v_bitop3_b32 v32, v13, s96, -9 bitop3:0x28
    v_mfma_f32_16x16x16_bf16 v[60:63], v[116:117], v[112:113], v[60:63]
    v_bitop3_b32 v36, v13, s97, -9 bitop3:0x28
    v_bitop3_b32 v40, v13, s98, -9 bitop3:0x28
    v_rcp_f32 v118, v48
    s_nop 0
    v_max_f32 v14, v118, v48
    v_cmp_nge_f32 vcc, s40, v14
    v_pk_mul_f32 v[56:57], v[56:57], v[118:119] op_sel_hi:[1,0]
    v_pk_mul_f32 v[58:59], v[58:59], v[118:119] op_sel_hi:[1,0]
    v_pk_mul_f32 v[60:61], v[60:61], v[118:119] op_sel_hi:[1,0]
    v_pk_mul_f32 v[62:63], v[62:63], v[118:119] op_sel_hi:[1,0]
    v_cvt_pk_bf16_f32 v52, v56, v60
    v_cvt_pk_bf16_f32 v54, v58, v62
    v_cvt_pk_bf16_f32 v53, v57, v61
    v_cvt_pk_bf16_f32 v55, v59, v63
L_slow_rejoin:
    v_cndmask_b32 v50, v52, v54, s[92:93]
    v_cndmask_b32 v51, v53, v55, s[92:93]
    ds_write_b64 v13, v[50:51] offset:9216
    v_smfmac_f32_16x16x64_bf16 v[16:19], v[52:55], v[160:167], v1
    v_smfmac_f32_16x16x64_bf16 v[20:23], v[52:55], v[168:175], v1
    s_waitcnt lgkmcnt(0)
    s_barrier
    ds_read_b128 v[32:35], v32 offset:9216
    ds_read_b128 v[36:39], v36 offset:9216
    v_smfmac_f32_16x16x64_bf16 v[24:27], v[52:55], v[176:183], v1
    ds_read_b128 v[40:43], v40 offset:9216
    v_smfmac_f32_16x16x64_bf16 v[28:31], v[52:55], v[184:191], v1
    ds_read_b128 v[88:91], v4 offset:24576
    ds_read_b128 v[92:95], v4 offset:25600
    s_waitcnt lgkmcnt(4)
    v_smfmac_f32_16x16x64_bf16 v[16:19], v[32:35], v[192:199], v1
    ds_read_b128 v[96:99], v4 offset:26624
    s_waitcnt lgkmcnt(4)
    v_smfmac_f32_16x16x64_bf16 v[16:19], v[36:39], v[216:223], v1
    ds_read_b128 v[100:103], v4 offset:27648
    s_waitcnt lgkmcnt(4)
    v_smfmac_f32_16x16x64_bf16 v[16:19], v[40:43], v[240:247], v1
    ds_read_b128 v[72:75], v4 offset:28672
    s_cmp_lg_u64 vcc, 0
    v_smfmac_f32_16x16x64_bf16 v[20:23], v[32:35], v[200:207], v1
    ds_read_b128 v[76:79], v4 offset:29696
    s_cselect_b32 s60, s28, s27
    v_smfmac_f32_16x16x64_bf16 v[20:23], v[36:39], v[224:231], v1
    ds_read_b128 v[80:83], v4 offset:30720
    s_nop 0
    v_cvt_pk_bf16_f32 v56, v16, v18
    v_smfmac_f32_16x16x64_bf16 v[20:23], v[40:43], v[248:255], v1
    ds_read_b128 v[84:87], v4 offset:31744
    v_cvt_pk_bf16_f32 v57, v17, v19
    v_and_or_b32 v56, v56, -2, s60
    v_smfmac_f32_16x16x64_bf16 v[24:27], v[32:35], v[208:215], v1
    buffer_store_dwordx2 v[56:57], v9, s[8:11], 0 offen offset:0 sc1
    v_smfmac_f32_16x16x64_bf16 v[24:27], v[36:39], v[232:239], v1
    s_waitcnt lgkmcnt(4)
    s_nop 0
    v_cvt_pk_bf16_f32 v58, v20, v22
    v_smfmac_f32_16x16x64_bf16 v[24:27], v[40:43], v[88:95], v1
    ds_read_b128 v[64:67], v3 offset:23040
    v_cvt_pk_bf16_f32 v59, v21, v23
    v_and_or_b32 v58, v58, -2, s60
    v_smfmac_f32_16x16x64_bf16 v[28:31], v[32:35], v[96:103], v1
    buffer_store_dwordx2 v[58:59], v9, s[8:11], 0 offen offset:2048 sc1
    s_waitcnt lgkmcnt(1)
    v_smfmac_f32_16x16x64_bf16 v[28:31], v[36:39], v[72:79], v1
    s_nop 1
    v_cvt_pk_bf16_f32 v60, v24, v26
    v_smfmac_f32_16x16x64_bf16 v[28:31], v[40:43], v[80:87], v1
    s_nop 2
    v_cvt_pk_bf16_f32 v61, v25, v27
    v_and_or_b32 v60, v60, -2, s60
    buffer_store_dwordx2 v[60:61], v9, s[8:11], s26 offen offset:0 sc1
    s_nop 1
    v_cvt_pk_bf16_f32 v62, v28, v30
    v_cvt_pk_bf16_f32 v63, v29, v31
    v_and_or_b32 v62, v62, -2, s60
    buffer_store_dwordx2 v[62:63], v9, s[8:11], s26 offen offset:2048 sc1
L_slow_stored:
    s_cmp_lg_u32 s60, s27
    s_cbranch_scc1 L_slow_safe
    ds_read_b128 v[104:107], v4 offset:0
    ds_read_b128 v[108:111], v4 offset:1024
    ds_read_b128 v[112:115], v4 offset:2048
    ds_read_b128 v[116:119], v4 offset:3072
    ds_read_b128 v[88:91], v4 offset:4096
    ds_read_b128 v[92:95], v4 offset:5120
    ds_read_b128 v[96:99], v4 offset:6144
    ds_read_b128 v[100:103], v4 offset:7168
    ds_read_b128 v[72:75], v4 offset:8192
    ds_read_b128 v[76:79], v4 offset:9216
    ds_read_b128 v[80:83], v4 offset:10240
    ds_read_b128 v[84:87], v4 offset:11264
    s_cmp_lt_u32 s21, 1
    s_cbranch_scc1 L_slow_pollp
    s_nop 9
    s_cmp_lt_u32 s21, 2
    s_cbranch_scc1 L_slow_pollp
    s_nop 9
    s_cmp_lt_u32 s21, 3
    s_cbranch_scc1 L_slow_pollp
    s_nop 9
L_slow_pollp:
    buffer_load_dwordx4 v[120:123], v2, s[8:11], s6 offen sc1
    buffer_load_dwordx4 v[124:127], v2, s[8:11], s6 offen offset:1024 sc1
    v_mov_b64 v[56:57], 0
    v_mov_b64 v[58:59], 0
    v_mov_b64 v[60:61], 0
    v_mov_b64 v[62:63], 0
    s_nop 15
    s_nop 15
    buffer_load_dwordx4 v[32:35], v2, s[8:11], s6 offen sc1
    buffer_load_dwordx4 v[36:39], v2, s[8:11], s6 offen offset:1024 sc1
L_slow_prep:
    s_add_u32 s7, s24, 0x80000
    s_waitcnt vmcnt(3) lgkmcnt(0)
    v_mfma_f32_16x16x32_bf16 v[68:71], v[64:67], v[120:123], 0
    v_bitop3_b32 v14, v120, v122, s27 bitop3:0x7e
    s_waitcnt vmcnt(2)
    v_mfma_f32_16x16x32_bf16 v[68:71], v[64:67], v[124:127], v[68:71]
    v_bitop3_b32 v11, v124, v126, s27 bitop3:0x7e
    v_bitop3_b32 v14, v14, v11, 1 bitop3:0xa8
    v_cmp_ne_u32 vcc, 0, v14
    s_nop 2
    s_cmp_eq_u64 vcc, 0
    s_cselect_b32 s36, s24, s61
    v_add_f32_dpp v68, v68, v68 row_ror:8 row_mask:0xf bank_mask:0xf
    v_add_f32_dpp v69, v69, v69 row_ror:8 row_mask:0xf bank_mask:0xf
    s_nop 0
    v_add_f32_dpp v68, v68, v68 row_ror:4 row_mask:0xf bank_mask:0xf
    v_add_f32_dpp v69, v69, v69 row_ror:4 row_mask:0xf bank_mask:0xf
    v_cvt_pk_bf16_f32 v12, v68, v69
    buffer_store_dword v12, v10, s[8:11], s36 offen sc1
    s_cbranch_scc1 L_slow_gotp
L_slow_retryp:
    buffer_load_dwordx4 v[120:123], v2, s[8:11], s6 offen sc1
    buffer_load_dwordx4 v[124:127], v2, s[8:11], s6 offen offset:1024 sc1
    s_waitcnt vmcnt(4) lgkmcnt(0)
    v_mfma_f32_16x16x32_bf16 v[68:71], v[64:67], v[32:35], 0
    v_bitop3_b32 v14, v32, v34, s27 bitop3:0x7e
    s_waitcnt vmcnt(3)
    v_mfma_f32_16x16x32_bf16 v[68:71], v[64:67], v[36:39], v[68:71]
    v_bitop3_b32 v11, v36, v38, s27 bitop3:0x7e
    v_bitop3_b32 v14, v14, v11, 1 bitop3:0xa8
    v_cmp_ne_u32 vcc, 0, v14
    s_nop 2
    s_cmp_eq_u64 vcc, 0
    s_cselect_b32 s36, s24, s61
    v_add_f32_dpp v68, v68, v68 row_ror:8 row_mask:0xf bank_mask:0xf
    v_add_f32_dpp v69, v69, v69 row_ror:8 row_mask:0xf bank_mask:0xf
    s_nop 0
    v_add_f32_dpp v68, v68, v68 row_ror:4 row_mask:0xf bank_mask:0xf
    v_add_f32_dpp v69, v69, v69 row_ror:4 row_mask:0xf bank_mask:0xf
    v_cvt_pk_bf16_f32 v12, v68, v69
    buffer_store_dword v12, v10, s[8:11], s36 offen sc1
    s_cbranch_scc1 L_slow_gotp
    buffer_load_dwordx4 v[32:35], v2, s[8:11], s6 offen sc1
    buffer_load_dwordx4 v[36:39], v2, s[8:11], s6 offen offset:1024 sc1
    s_waitcnt vmcnt(4) lgkmcnt(0)
    v_mfma_f32_16x16x32_bf16 v[68:71], v[64:67], v[120:123], 0
    v_bitop3_b32 v14, v120, v122, s27 bitop3:0x7e
    s_waitcnt vmcnt(3)
    v_mfma_f32_16x16x32_bf16 v[68:71], v[64:67], v[124:127], v[68:71]
    v_bitop3_b32 v11, v124, v126, s27 bitop3:0x7e
    v_bitop3_b32 v14, v14, v11, 1 bitop3:0xa8
    v_cmp_ne_u32 vcc, 0, v14
    s_nop 2
    s_cmp_eq_u64 vcc, 0
    s_cselect_b32 s36, s24, s61
    v_add_f32_dpp v68, v68, v68 row_ror:8 row_mask:0xf bank_mask:0xf
    v_add_f32_dpp v69, v69, v69 row_ror:8 row_mask:0xf bank_mask:0xf
    s_nop 0
    v_add_f32_dpp v68, v68, v68 row_ror:4 row_mask:0xf bank_mask:0xf
    v_add_f32_dpp v69, v69, v69 row_ror:4 row_mask:0xf bank_mask:0xf
    v_cvt_pk_bf16_f32 v12, v68, v69
    buffer_store_dword v12, v10, s[8:11], s36 offen sc1
    s_cbranch_scc1 L_slow_gotp
    s_add_u32 s32, s32, 1
    s_cmp_le_u32 s32, 200000
    s_cbranch_scc1 L_slow_retryp
    s_mov_b32 s36, s24
    buffer_store_dword v12, v10, s[8:11], s36 offen sc1
L_slow_gotp:
    s_add_u32 s31, s31, 0x2000
    s_cmp_ge_u32 s90, 63
    s_cbranch_scc1 L_slow_last
    s_mov_b32 s23, s24
    s_mov_b32 s22, s90
    s_mov_b32 s27, s28
    v_mov_b64 v[64:65], 0
    v_mov_b64 v[66:67], 0
    v_mov_b64 v[68:69], 0
    v_mov_b64 v[70:71], 0
    s_nop 15
    s_nop 11
    buffer_load_dwordx4 v[16:19], v2, s[8:11], s7 offen sc1
    buffer_load_dwordx4 v[20:23], v2, s[8:11], s7 offen offset:1024 sc1
    s_branch L_slow_step
L_slow_last:
    buffer_store_dword v12, v10, s[8:11], s31 offen sc1
    s_branch L_slow_done
L_slow_refresh:
    buffer_load_dword v15, v0, s[8:11], s23 offen sc1
    s_add_u32 s32, s32, 1
    s_cmp_le_u32 s32, 200000
    s_waitcnt vmcnt(0)
    s_cbranch_scc1 L_slow_step
    s_branch L_slow_fresh
L_slow_safe:
    s_nop 11
    s_waitcnt vmcnt(0) lgkmcnt(0)
    s_barrier
    ds_read_b128 v[72:75], v6 offset:0
    ds_read_b128 v[88:91], v6 offset:2304
    ds_read_b128 v[76:79], v6 offset:64
    ds_read_b128 v[92:95], v6 offset:2368
    ds_read_b128 v[80:83], v6 offset:128
    ds_read_b128 v[96:99], v6 offset:2432
    ds_read_b128 v[84:87], v6 offset:192
    ds_read_b128 v[100:103], v6 offset:2496
    s_xor_b32 s36, s25, 0x1000
    s_add_u32 s36, s36, s23
    buffer_load_dwordx4 v[16:19], v3, s[8:11], s29 offen offset:0 sc1
    buffer_load_dwordx4 v[32:35], v3, s[8:11], s36 offen offset:0 sc1
    buffer_load_dwordx4 v[20:23], v3, s[8:11], s29 offen offset:1024 sc1
    buffer_load_dwordx4 v[36:39], v3, s[8:11], s36 offen offset:1024 sc1
    buffer_load_dwordx4 v[24:27], v3, s[8:11], s29 offen offset:2048 sc1
    buffer_load_dwordx4 v[40:43], v3, s[8:11], s36 offen offset:2048 sc1
    buffer_load_dwordx4 v[28:31], v3, s[8:11], s29 offen offset:3072 sc1
    buffer_load_dwordx4 v[44:47], v3, s[8:11], s36 offen offset:3072 sc1
    s_waitcnt vmcnt(0) lgkmcnt(0)
    v_mfma_f32_16x16x32_bf16 v[48:51], v[16:19], v[72:75], 0
    v_mfma_f32_16x16x32_bf16 v[48:51], v[20:23], v[76:79], v[48:51]
    v_mfma_f32_16x16x32_bf16 v[48:51], v[24:27], v[80:83], v[48:51]
    v_mfma_f32_16x16x32_bf16 v[48:51], v[28:31], v[84:87], v[48:51]
    v_mfma_f32_16x16x32_bf16 v[52:55], v[32:35], v[72:75], 0
    v_mfma_f32_16x16x32_bf16 v[52:55], v[36:39], v[76:79], v[52:55]
    v_mfma_f32_16x16x32_bf16 v[52:55], v[40:43], v[80:83], v[52:55]
    v_mfma_f32_16x16x32_bf16 v[52:55], v[44:47], v[84:87], v[52:55]
    v_mfma_f32_16x16x32_bf16 v[56:59], v[88:91], v[72:75], 0
    v_mfma_f32_16x16x32_bf16 v[56:59], v[92:95], v[76:79], v[56:59]
    v_mfma_f32_16x16x32_bf16 v[56:59], v[96:99], v[80:83], v[56:59]
    v_mfma_f32_16x16x32_bf16 v[56:59], v[100:103], v[84:87], v[56:59]
    v_max3_f32 v16, v48, v49, v50
    s_nop 2
    v_max3_f32 v16, v16, v51, v52
    v_max3_f32 v16, v16, v53, v54
    s_nop 1
    v_max3_f32 v16, v16, v55, v56
    v_max_f32 v16, v16, v57
    v_mov_b32 v17, v16
    s_nop 1
    v_permlane16_swap_b32 v16, v17
    v_max_f32 v16, v16, v17
    v_mov_b32 v17, v16
    s_nop 1
    v_permlane32_swap_b32 v16, v17
    v_max_f32 v16, v16, v17
    v_sub_f32 v48, v48, v16
    v_exp_f32 v48, v48
    v_sub_f32 v49, v49, v16
    v_exp_f32 v49, v49
    v_sub_f32 v50, v50, v16
    v_exp_f32 v50, v50
    v_sub_f32 v51, v51, v16
    v_exp_f32 v51, v51
    v_sub_f32 v52, v52, v16
    v_exp_f32 v52, v52
    v_sub_f32 v53, v53, v16
    v_exp_f32 v53, v53
    v_sub_f32 v54, v54, v16
    v_exp_f32 v54, v54
    v_sub_f32 v55, v55, v16
    v_exp_f32 v55, v55
    v_sub_f32 v56, v56, v16
    v_exp_f32 v56, v56
    v_sub_f32 v57, v57, v16
    v_exp_f32 v57, v57
    v_cvt_pk_bf16_f32 v108, v48, v49
    v_cvt_pk_bf16_f32 v109, v50, v51
    v_cvt_pk_bf16_f32 v110, v52, v53
    v_cvt_pk_bf16_f32 v111, v54, v55
    v_cvt_pk_bf16_f32 v112, v56, v57
    s_nop 0
    v_mfma_f32_16x16x32_bf16 v[48:51], v[104:107], v[108:111], 0
    v_mfma_f32_16x16x32_bf16 v[56:59], v[120:123], v[108:111], 0
    v_mfma_f32_16x16x32_bf16 v[60:63], v[124:127], v[108:111], 0
    s_nop 3
    v_mfma_f32_16x16x16_bf16 v[48:51], v[104:105], v[112:113], v[48:51]
    v_mfma_f32_16x16x16_bf16 v[56:59], v[114:115], v[112:113], v[56:59]
    v_mfma_f32_16x16x16_bf16 v[60:63], v[116:117], v[112:113], v[60:63]
    s_nop 5
    v_rcp_f32 v118, v48
    s_nop 0
    v_mul_f32 v56, v56, v118
    v_mul_f32 v57, v57, v118
    v_mul_f32 v58, v58, v118
    v_mul_f32 v59, v59, v118
    v_mul_f32 v60, v60, v118
    v_mul_f32 v61, v61, v118
    v_mul_f32 v62, v62, v118
    v_mul_f32 v63, v63, v118
    v_cvt_pk_bf16_f32 v52, v56, v60
    v_cvt_pk_bf16_f32 v53, v57, v61
    v_cvt_pk_bf16_f32 v54, v58, v62
    v_cvt_pk_bf16_f32 v55, v59, v63
    v_mov_b32 v16, 0
    v_mov_b32 v17, 0
    v_mov_b32 v18, 0
    v_mov_b32 v19, 0
    v_mov_b32 v20, 0
    v_mov_b32 v21, 0
    v_mov_b32 v22, 0
    v_mov_b32 v23, 0
    v_mov_b32 v24, 0
    v_mov_b32 v25, 0
    v_mov_b32 v26, 0
    v_mov_b32 v27, 0
    v_mov_b32 v28, 0
    v_mov_b32 v29, 0
    v_mov_b32 v30, 0
    v_mov_b32 v31, 0
    v_bitop3_b32 v32, v13, s96, -9 bitop3:0x28
    v_bitop3_b32 v36, v13, s97, -9 bitop3:0x28
    v_bitop3_b32 v40, v13, s98, -9 bitop3:0x28
    s_mov_b64 vcc, 0
    s_branch L_slow_rejoin
L_slow_done:
    s_branch L_end
L_worker:
    s_cmp_eq_u32 s3, 7
    s_cbranch_scc1 L_mlp
    s_and_b32 s36, s2, 7
    s_sub_u32 s36, s36, 1
    s_lshl_b32 s36, s36, 5
    s_lshr_b32 s37, s2, 3
    s_add_u32 s36, s36, s37
    s_mul_i32 s20, s36, 10923
    s_lshr_b32 s20, s20, 16
    s_mul_i32 s37, s20, 6
    s_sub_u32 s22, s36, s37
    v_lshrrev_b32 v28, 4, v0
    v_and_b32 v16, 15, v0
    v_lshlrev_b32 v16, 4, v16
    v_lshl_add_u32 v16, v28, 13, v16
    v_bfe_u32 v29, v0, 4, 2
    v_lshlrev_b32 v29, 5, v29
    v_xor_b32 v16, v16, v29
    v_and_b32 v29, 128, v0
    v_xor_b32 v16, v16, v29
    s_lshl_b32 s28, s21, 10
    s_lshl_b32 s3, s20, 8
    s_mov_b32 s76, s52
    s_and_b32 s77, s53, 0xffff
    s_mov_b32 s78, 0x400000
    s_mov_b32 s79, 0x20000
    s_add_u32 m0, s28, 32768
    s_add_u32 s37, s3, 0x0
    buffer_load_dwordx4 v16, s[76:79], s37 offen lds
    s_add_u32 m0, s28, 36864
    s_add_u32 s37, s3, 0x20000
    buffer_load_dwordx4 v16, s[76:79], s37 offen lds
    s_add_u32 m0, s28, 65536
    s_add_u32 s37, s3, 0x40000
    buffer_load_dwordx4 v16, s[76:79], s37 offen lds
    s_add_u32 m0, s28, 69632
    s_add_u32 s37, s3, 0x60000
    buffer_load_dwordx4 v16, s[76:79], s37 offen lds
    s_add_u32 m0, s28, 98304
    s_add_u32 s37, s3, 0x80000
    buffer_load_dwordx4 v16, s[76:79], s37 offen lds
    s_add_u32 m0, s28, 102400
    s_add_u32 s37, s3, 0xa0000
    buffer_load_dwordx4 v16, s[76:79], s37 offen lds
    s_add_u32 m0, s28, 131072
    s_add_u32 s37, s3, 0xc0000
    buffer_load_dwordx4 v16, s[76:79], s37 offen lds
    s_add_u32 m0, s28, 135168
    s_add_u32 s37, s3, 0xe0000
    buffer_load_dwordx4 v16, s[76:79], s37 offen lds
    s_add_u32 m0, s28, 40960
    s_add_u32 s37, s3, 0x100000
    buffer_load_dwordx4 v16, s[76:79], s37 offen lds
    s_add_u32 m0, s28, 45056
    s_add_u32 s37, s3, 0x120000
    buffer_load_dwordx4 v16, s[76:79], s37 offen lds
    s_add_u32 m0, s28, 73728
    s_add_u32 s37, s3, 0x140000
    buffer_load_dwordx4 v16, s[76:79], s37 offen lds
    s_add_u32 m0, s28, 77824
    s_add_u32 s37, s3, 0x160000
    buffer_load_dwordx4 v16, s[76:79], s37 offen lds
    s_add_u32 m0, s28, 106496
    s_add_u32 s37, s3, 0x180000
    buffer_load_dwordx4 v16, s[76:79], s37 offen lds
    s_add_u32 m0, s28, 110592
    s_add_u32 s37, s3, 0x1a0000
    buffer_load_dwordx4 v16, s[76:79], s37 offen lds
    s_add_u32 m0, s28, 139264
    s_add_u32 s37, s3, 0x1c0000
    buffer_load_dwordx4 v16, s[76:79], s37 offen lds
    s_add_u32 m0, s28, 143360
    s_add_u32 s37, s3, 0x1e0000
    buffer_load_dwordx4 v16, s[76:79], s37 offen lds
    s_add_u32 m0, s28, 49152
    s_add_u32 s37, s3, 0x200000
    buffer_load_dwordx4 v16, s[76:79], s37 offen lds
    s_add_u32 m0, s28, 53248
    s_add_u32 s37, s3, 0x220000
    buffer_load_dwordx4 v16, s[76:79], s37 offen lds
    s_add_u32 m0, s28, 81920
    s_add_u32 s37, s3, 0x240000
    buffer_load_dwordx4 v16, s[76:79], s37 offen lds
    s_add_u32 m0, s28, 86016
    s_add_u32 s37, s3, 0x260000
    buffer_load_dwordx4 v16, s[76:79], s37 offen lds
    s_add_u32 m0, s28, 114688
    s_add_u32 s37, s3, 0x280000
    buffer_load_dwordx4 v16, s[76:79], s37 offen lds
    s_add_u32 m0, s28, 118784
    s_add_u32 s37, s3, 0x2a0000
    buffer_load_dwordx4 v16, s[76:79], s37 offen lds
    s_add_u32 m0, s28, 147456
    s_add_u32 s37, s3, 0x2c0000
    buffer_load_dwordx4 v16, s[76:79], s37 offen lds
    s_add_u32 m0, s28, 151552
    s_add_u32 s37, s3, 0x2e0000
    buffer_load_dwordx4 v16, s[76:79], s37 offen lds
    s_add_u32 m0, s28, 57344
    s_add_u32 s37, s3, 0x300000
    buffer_load_dwordx4 v16, s[76:79], s37 offen lds
    s_add_u32 m0, s28, 61440
    s_add_u32 s37, s3, 0x320000
    buffer_load_dwordx4 v16, s[76:79], s37 offen lds
    s_add_u32 m0, s28, 90112
    s_add_u32 s37, s3, 0x340000
    buffer_load_dwordx4 v16, s[76:79], s37 offen lds
    s_add_u32 m0, s28, 94208
    s_add_u32 s37, s3, 0x360000
    buffer_load_dwordx4 v16, s[76:79], s37 offen lds
    s_add_u32 m0, s28, 122880
    s_add_u32 s37, s3, 0x380000
    buffer_load_dwordx4 v16, s[76:79], s37 offen lds
    s_add_u32 m0, s28, 126976
    s_add_u32 s37, s3, 0x3a0000
    buffer_load_dwordx4 v16, s[76:79], s37 offen lds
    s_add_u32 m0, s28, 155648
    s_add_u32 s37, s3, 0x3c0000
    buffer_load_dwordx4 v16, s[76:79], s37 offen lds
    s_add_u32 m0, s28, 159744
    s_add_u32 s37, s3, 0x3e0000
    buffer_load_dwordx4 v16, s[76:79], s37 offen lds
    v_mov_b32 v20, 0x0
    v_bfe_u32 v14, v0, 0, 1
    s_mov_b32 s38, 0x8
    v_mad_u32_u24 v20, v14, s38, v20
    v_bfe_u32 v14, v0, 1, 1
    s_mov_b32 s38, 0x10
    v_mad_u32_u24 v20, v14, s38, v20
    v_bfe_u32 v14, v0, 2, 1
    s_mov_b32 s38, 0x100
    v_mad_u32_u24 v20, v14, s38, v20
    v_bfe_u32 v14, v0, 3, 1
    s_mov_b32 s38, 0x200
    v_mad_u32_u24 v20, v14, s38, v20
    v_bfe_u32 v14, v0, 4, 1
    s_mov_b32 s38, 0x800
    v_mad_u32_u24 v20, v14, s38, v20
    v_bfe_u32 v14, v0, 5, 1
    s_mov_b32 s38, 0x1000
    v_mad_u32_u24 v20, v14, s38, v20
    v_mov_b32 v30, 0x0
    v_bfe_u32 v14, v0, 2, 1
    s_mov_b32 s38, 0x20
    v_mad_u32_u24 v30, v14, s38, v30
    v_bfe_u32 v14, v0, 3, 1
    s_mov_b32 s38, 0x40
    v_mad_u32_u24 v30, v14, s38, v30
    v_bfe_u32 v14, v0, 4, 1
    s_mov_b32 s38, 0x80
    v_mad_u32_u24 v30, v14, s38, v30
    v_mov_b32 v31, 0x0
    v_bfe_u32 v14, v0, 6, 1
    s_mov_b32 s38, 0x40
    v_mad_u32_u24 v31, v14, s38, v31
    v_bfe_u32 v14, v0, 7, 1
    s_mov_b32 s38, 0x80
    v_mad_u32_u24 v31, v14, s38, v31
    v_xor_b32 v30, v30, v31
    v_add_u32 v30, v30, v20
    v_add_u32 v20, 0x8000, v30
    v_xor_b32 v21, 32, v20
    v_add_u32 v22, 0x10000, v30
    v_xor_b32 v23, 32, v22
    v_add_u32 v24, 0x18000, v30
    v_xor_b32 v25, 32, v24
    v_add_u32 v26, 0x20000, v30
    v_xor_b32 v27, 32, v26
    s_mov_b32 s12, s54
    s_and_b32 s13, s55, 0xffff
    s_mov_b32 s14, 0x400000
    s_mov_b32 s15, 0x20000
    s_lshl_b32 s24, s20, 17
    s_and_b32 s25, s22, 3
    s_lshl_b32 s25, s25, 15
    s_add_u32 s24, s24, s25
    v_lshlrev_b32 v30, 7, v0
    buffer_load_dword v31, v30, s[12:15], s24 offen
    s_mov_b32 s12, s44
    s_and_b32 s13, s45, 0xffff
    s_mov_b32 s14, 0x200000
    s_mov_b32 s15, 0x20000
    s_mov_b32 s60, s82
    s_and_b32 s61, s83, 0xffff
    s_mov_b32 s62, 0x200000
    s_mov_b32 s63, 0x20000
    s_mov_b32 s92, s80
    s_and_b32 s93, s81, 0xffff
    s_mov_b32 s94, 0x400
    s_mov_b32 s95, 0x20000
    v_mov_b32 v1, 0x0
    v_bfe_u32 v14, v0, 0, 1
    s_mov_b32 s38, 0x10
    v_mad_u32_u24 v1, v14, s38, v1
    v_bfe_u32 v14, v0, 1, 1
    s_mov_b32 s38, 0x20
    v_mad_u32_u24 v1, v14, s38, v1
    v_bfe_u32 v14, v0, 2, 1
    s_mov_b32 s38, 0x40
    v_mad_u32_u24 v1, v14, s38, v1
    v_bfe_u32 v14, v0, 3, 1
    s_mov_b32 s38, 0x80
    v_mad_u32_u24 v1, v14, s38, v1
    v_bfe_u32 v14, v0, 4, 1
    s_mov_b32 s38, 0x100
    v_mad_u32_u24 v1, v14, s38, v1
    v_bfe_u32 v14, v0, 5, 1
    s_mov_b32 s38, 0x200
    v_mad_u32_u24 v1, v14, s38, v1
    v_mov_b32 v2, 0x0
    v_bfe_u32 v14, v0, 0, 1
    s_mov_b32 s38, 0x10
    v_mad_u32_u24 v2, v14, s38, v2
    v_bfe_u32 v14, v0, 1, 1
    s_mov_b32 s38, 0x20
    v_mad_u32_u24 v2, v14, s38, v2
    v_bfe_u32 v14, v0, 2, 1
    s_mov_b32 s38, 0x40
    v_mad_u32_u24 v2, v14, s38, v2
    v_bfe_u32 v14, v0, 3, 1
    s_mov_b32 s38, 0x80
    v_mad_u32_u24 v2, v14, s38, v2
    v_bfe_u32 v14, v0, 4, 1
    s_mov_b32 s38, 0x100
    v_mad_u32_u24 v2, v14, s38, v2
    v_bfe_u32 v14, v0, 5, 1
    s_mov_b32 s38, 0x200
    v_mad_u32_u24 v2, v14, s38, v2
    v_bfe_u32 v14, v0, 6, 1
    s_mov_b32 s38, 0x800
    v_mad_u32_u24 v2, v14, s38, v2
    v_bfe_u32 v14, v0, 7, 1
    s_mov_b32 s38, 0x1000
    v_mad_u32_u24 v2, v14, s38, v2
    v_mov_b32 v9, 0x0
    v_bfe_u32 v14, v0, 0, 1
    s_mov_b32 s38, 0x10
    v_mad_u32_u24 v9, v14, s38, v9
    v_bfe_u32 v14, v0, 1, 1
    s_mov_b32 s38, 0x20
    v_mad_u32_u24 v9, v14, s38, v9
    v_bfe_u32 v14, v0, 2, 1
    s_mov_b32 s38, 0x40
    v_mad_u32_u24 v9, v14, s38, v9
    v_bfe_u32 v14, v0, 3, 1
    s_mov_b32 s38, 0x80
    v_mad_u32_u24 v9, v14, s38, v9
    v_bfe_u32 v14, v0, 4, 1
    s_mov_b32 s38, 0x100
    v_mad_u32_u24 v9, v14, s38, v9
    v_bfe_u32 v14, v0, 5, 1
    s_mov_b32 s38, 0x200
    v_mad_u32_u24 v9, v14, s38, v9
    v_bfe_u32 v14, v0, 6, 1
    s_mov_b32 s38, 0x400
    v_mad_u32_u24 v9, v14, s38, v9
    v_bfe_u32 v14, v0, 7, 1
    s_mov_b32 s38, 0x800
    v_mad_u32_u24 v9, v14, s38, v9
    v_mov_b32 v7, 0x8000
    v_bfe_u32 v14, v0, 0, 1
    s_mov_b32 s38, 0x10
    v_mad_u32_u24 v7, v14, s38, v7
    v_bfe_u32 v14, v0, 1, 1
    s_mov_b32 s38, 0x20
    v_mad_u32_u24 v7, v14, s38, v7
    v_bfe_u32 v14, v0, 2, 1
    s_mov_b32 s38, 0x40
    v_mad_u32_u24 v7, v14, s38, v7
    v_bfe_u32 v14, v0, 3, 1
    s_mov_b32 s38, 0x80
    v_mad_u32_u24 v7, v14, s38, v7
    v_bfe_u32 v14, v0, 4, 1
    s_mov_b32 s38, 0x100
    v_mad_u32_u24 v7, v14, s38, v7
    v_bfe_u32 v14, v0, 5, 1
    s_mov_b32 s38, 0x200
    v_mad_u32_u24 v7, v14, s38, v7
    v_bfe_u32 v14, v0, 6, 1
    s_mov_b32 s38, 0x8000
    v_mad_u32_u24 v7, v14, s38, v7
    v_bfe_u32 v14, v0, 7, 1
    s_mov_b32 s38, 0x10000
    v_mad_u32_u24 v7, v14, s38, v7
    v_mov_b32 v3, 0x0
    v_bfe_u32 v14, v0, 0, 1
    s_mov_b32 s38, 0x10
    v_mad_u32_u24 v3, v14, s38, v3
    v_bfe_u32 v14, v0, 1, 1
    s_mov_b32 s38, 0x20
    v_mad_u32_u24 v3, v14, s38, v3
    v_bfe_u32 v14, v0, 2, 1
    s_mov_b32 s38, 0x40
    v_mad_u32_u24 v3, v14, s38, v3
    v_bfe_u32 v14, v0, 3, 1
    s_mov_b32 s38, 0x400
    v_mad_u32_u24 v3, v14, s38, v3
    v_bfe_u32 v14, v0, 4, 1
    s_mov_b32 s38, 0x800
    v_mad_u32_u24 v3, v14, s38, v3
    v_bfe_u32 v14, v0, 5, 1
    s_mov_b32 s38, 0x1000
    v_mad_u32_u24 v3, v14, s38, v3
    v_bfe_u32 v14, v0, 6, 1
    s_mov_b32 s38, 0x2000
    v_mad_u32_u24 v3, v14, s38, v3
    v_bfe_u32 v14, v0, 7, 1
    s_mov_b32 s38, 0x4000
    v_mad_u32_u24 v3, v14, s38, v3
    v_mov_b32 v4, 0x0
    v_bfe_u32 v14, v0, 0, 1
    s_mov_b32 s38, 0x100
    v_mad_u32_u24 v4, v14, s38, v4
    v_bfe_u32 v14, v0, 1, 1
    s_mov_b32 s38, 0x200
    v_mad_u32_u24 v4, v14, s38, v4
    v_bfe_u32 v14, v0, 2, 1
    s_mov_b32 s38, 0x400
    v_mad_u32_u24 v4, v14, s38, v4
    v_bfe_u32 v14, v0, 6, 1
    s_mov_b32 s38, 0x80
    v_mad_u32_u24 v4, v14, s38, v4
    v_bfe_u32 v14, v0, 7, 1
    s_mov_b32 s38, 0x4000
    v_mad_u32_u24 v4, v14, s38, v4
    v_lshrrev_b32 v15, 3, v0
    v_xor_b32 v15, v15, v0
    v_and_b32 v15, 7, v15
    v_lshl_add_u32 v4, v15, 4, v4
    v_bfe_u32 v15, v0, 4, 2
    v_lshlrev_b32 v15, 4, v15
    v_xor_b32 v5, v15, v1
    v_xor_b32 v6, 64, v5
    v_mov_b32 v8, 0x5000
    v_bfe_u32 v14, v0, 0, 1
    s_mov_b32 s38, 0x10
    v_mad_u32_u24 v8, v14, s38, v8
    v_bfe_u32 v14, v0, 1, 1
    s_mov_b32 s38, 0x40
    v_mad_u32_u24 v8, v14, s38, v8
    v_bfe_u32 v14, v0, 2, 1
    s_mov_b32 s38, 0x80
    v_mad_u32_u24 v8, v14, s38, v8
    v_bfe_u32 v14, v0, 4, 1
    s_mov_b32 s38, 0x20
    v_mad_u32_u24 v8, v14, s38, v8
    v_bfe_u32 v14, v0, 5, 1
    s_mov_b32 s38, 0x100
    v_mad_u32_u24 v8, v14, s38, v8
    v_mov_b32 v10, 0x0
    v_bfe_u32 v14, v0, 0, 1
    s_mov_b32 s38, 0x10
    v_mad_u32_u24 v10, v14, s38, v10
    v_bfe_u32 v14, v0, 1, 1
    s_mov_b32 s38, 0x20
    v_mad_u32_u24 v10, v14, s38, v10
    v_bfe_u32 v14, v0, 2, 1
    s_mov_b32 s38, 0x40
    v_mad_u32_u24 v10, v14, s38, v10
    v_bfe_u32 v14, v0, 3, 1
    s_mov_b32 s38, 0x80
    v_mad_u32_u24 v10, v14, s38, v10
    v_bfe_u32 v14, v0, 4, 1
    s_mov_b32 s38, 0x20000
    v_mad_u32_u24 v10, v14, s38, v10
    v_bfe_u32 v14, v0, 5, 1
    s_mov_b32 s38, 0x40000
    v_mad_u32_u24 v10, v14, s38, v10
    v_bfe_u32 v14, v0, 6, 1
    s_mov_b32 s38, 0x100
    v_mad_u32_u24 v10, v14, s38, v10
    v_bfe_u32 v14, v0, 7, 1
    s_mov_b32 s38, 0x200
    v_mad_u32_u24 v10, v14, s38, v10
    v_mov_b32 v11, 0x0
    v_bfe_u32 v14, v0, 0, 1
    s_mov_b32 s38, 0x10
    v_mad_u32_u24 v11, v14, s38, v11
    v_bfe_u32 v14, v0, 1, 1
    s_mov_b32 s38, 0x20
    v_mad_u32_u24 v11, v14, s38, v11
    v_bfe_u32 v14, v0, 2, 1
    s_mov_b32 s38, 0x40
    v_mad_u32_u24 v11, v14, s38, v11
    v_bfe_u32 v14, v0, 3, 1
    s_mov_b32 s38, 0x80
    v_mad_u32_u24 v11, v14, s38, v11
    v_bfe_u32 v14, v0, 4, 1
    s_mov_b32 s38, 0x400
    v_mad_u32_u24 v11, v14, s38, v11
    v_bfe_u32 v14, v0, 5, 1
    s_mov_b32 s38, 0x800
    v_mad_u32_u24 v11, v14, s38, v11
    v_bfe_u32 v14, v0, 6, 1
    s_mov_b32 s38, 0x100
    v_mad_u32_u24 v11, v14, s38, v11
    v_bfe_u32 v14, v0, 7, 1
    s_mov_b32 s38, 0x200
    v_mad_u32_u24 v11, v14, s38, v11
    v_mov_b32 v12, 0x0
    v_bfe_u32 v14, v0, 0, 1
    s_mov_b32 s38, 0x10
    v_mad_u32_u24 v12, v14, s38, v12
    v_bfe_u32 v14, v0, 1, 1
    s_mov_b32 s38, 0x20
    v_mad_u32_u24 v12, v14, s38, v12
    v_bfe_u32 v14, v0, 2, 1
    s_mov_b32 s38, 0x40
    v_mad_u32_u24 v12, v14, s38, v12
    v_bfe_u32 v14, v0, 3, 1
    s_mov_b32 s38, 0x80
    v_mad_u32_u24 v12, v14, s38, v12
    v_bfe_u32 v14, v0, 4, 1
    s_mov_b32 s38, 0x4
    v_mad_u32_u24 v12, v14, s38, v12
    v_bfe_u32 v14, v0, 5, 1
    s_mov_b32 s38, 0x8
    v_mad_u32_u24 v12, v14, s38, v12
    v_bfe_u32 v14, v0, 6, 1
    s_mov_b32 s38, 0x100
    v_mad_u32_u24 v12, v14, s38, v12
    v_bfe_u32 v14, v0, 7, 1
    s_mov_b32 s38, 0x200
    v_mad_u32_u24 v12, v14, s38, v12
    v_mov_b32 v13, 0xf149f2ca
    v_and_b32 v14, 15, v0
    v_bfe_u32 v15, v0, 4, 2
    v_cmp_gt_u32 s[72:73], 2, v15
    v_lshlrev_b32 v15, 2, v15
    v_cmp_le_u32 s[64:65], v15, v14
    v_add_u32 v15, 1, v15
    v_cmp_le_u32 s[66:67], v15, v14
    v_add_u32 v15, 1, v15
    v_cmp_le_u32 s[68:69], v15, v14
    v_add_u32 v15, 1, v15
    v_cmp_le_u32 s[70:71], v15, v14
    v_add_u32 v15, 1, v15
    s_mov_b32 s34, 0x05040100
    s_mov_b32 s35, 0x07060302
    s_mov_b32 s33, 0x3e0293ee
    s_mov_b32 s32, 0
    s_mov_b32 s4, 0x3f803f80
    s_mov_b32 s5, 0x3f803f80
    s_mov_b32 s23, s22
    s_lshl_b32 s36, s23, 15
    buffer_load_dwordx4 v[96:99], v3, s[12:15], s36 offen offset:0
    buffer_load_dwordx4 v[100:103], v3, s[12:15], s36 offen offset:128
    buffer_load_dwordx4 v[104:107], v3, s[12:15], s36 offen offset:256
    buffer_load_dwordx4 v[108:111], v3, s[12:15], s36 offen offset:384
    buffer_load_dwordx4 v[112:115], v3, s[12:15], s36 offen offset:512
    buffer_load_dwordx4 v[116:119], v3, s[12:15], s36 offen offset:640
    buffer_load_dwordx4 v[120:123], v3, s[12:15], s36 offen offset:768
    buffer_load_dwordx4 v[124:127], v3, s[12:15], s36 offen offset:896
    s_waitcnt vmcnt(33)
    s_barrier
    ds_read_b64_tr_b16 v[128:129], v20 offset:0
    ds_read_b64_tr_b16 v[130:131], v20 offset:1024
    ds_read_b64_tr_b16 v[132:133], v21 offset:0
    ds_read_b64_tr_b16 v[134:135], v21 offset:1024
    ds_read_b64_tr_b16 v[136:137], v22 offset:0
    ds_read_b64_tr_b16 v[138:139], v22 offset:1024
    ds_read_b64_tr_b16 v[140:141], v23 offset:0
    ds_read_b64_tr_b16 v[142:143], v23 offset:1024
    ds_read_b64_tr_b16 v[144:145], v24 offset:0
    ds_read_b64_tr_b16 v[146:147], v24 offset:1024
    ds_read_b64_tr_b16 v[148:149], v25 offset:0
    ds_read_b64_tr_b16 v[150:151], v25 offset:1024
    s_waitcnt lgkmcnt(4)
    ds_read_b64_tr_b16 v[152:153], v26 offset:0
    ds_read_b64_tr_b16 v[154:155], v26 offset:1024
    ds_read_b64_tr_b16 v[156:157], v27 offset:0
    ds_read_b64_tr_b16 v[158:159], v27 offset:1024
    s_waitcnt lgkmcnt(0)
    s_barrier
    s_mov_b32 s40, s50
    s_and_b32 s41, s51, 0xffff
    s_mov_b32 s42, 0x400000
    s_mov_b32 s43, 0x20000
    s_add_u32 m0, s28, 32768
    s_add_u32 s37, s3, 0x0
    buffer_load_dwordx4 v16, s[40:43], s37 offen lds
    s_add_u32 m0, s28, 36864
    s_add_u32 s37, s3, 0x20000
    buffer_load_dwordx4 v16, s[40:43], s37 offen lds
    s_add_u32 m0, s28, 65536
    s_add_u32 s37, s3, 0x40000
    buffer_load_dwordx4 v16, s[40:43], s37 offen lds
    s_add_u32 m0, s28, 69632
    s_add_u32 s37, s3, 0x60000
    buffer_load_dwordx4 v16, s[40:43], s37 offen lds
    s_add_u32 m0, s28, 98304
    s_add_u32 s37, s3, 0x80000
    buffer_load_dwordx4 v16, s[40:43], s37 offen lds
    s_add_u32 m0, s28, 102400
    s_add_u32 s37, s3, 0xa0000
    buffer_load_dwordx4 v16, s[40:43], s37 offen lds
    s_add_u32 m0, s28, 131072
    s_add_u32 s37, s3, 0xc0000
    buffer_load_dwordx4 v16, s[40:43], s37 offen lds
    s_add_u32 m0, s28, 135168
    s_add_u32 s37, s3, 0xe0000
    buffer_load_dwordx4 v16, s[40:43], s37 offen lds
    s_waitcnt vmcnt(33)
    s_barrier
    ds_read_b64_tr_b16 v[160:161], v20 offset:8192
    ds_read_b64_tr_b16 v[162:163], v20 offset:9216
    ds_read_b64_tr_b16 v[164:165], v21 offset:8192
    ds_read_b64_tr_b16 v[166:167], v21 offset:9216
    ds_read_b64_tr_b16 v[168:169], v22 offset:8192
    ds_read_b64_tr_b16 v[170:171], v22 offset:9216
    ds_read_b64_tr_b16 v[172:173], v23 offset:8192
    ds_read_b64_tr_b16 v[174:175], v23 offset:9216
    ds_read_b64_tr_b16 v[176:177], v24 offset:8192
    ds_read_b64_tr_b16 v[178:179], v24 offset:9216
    ds_read_b64_tr_b16 v[180:181], v25 offset:8192
    ds_read_b64_tr_b16 v[182:183], v25 offset:9216
    s_waitcnt lgkmcnt(4)
    ds_read_b64_tr_b16 v[184:185], v26 offset:8192
    ds_read_b64_tr_b16 v[186:187], v26 offset:9216
    ds_read_b64_tr_b16 v[188:189], v27 offset:8192
    ds_read_b64_tr_b16 v[190:191], v27 offset:9216
    s_waitcnt lgkmcnt(0)
    s_barrier
    s_add_u32 m0, s28, 40960
    s_add_u32 s37, s3, 0x100000
    buffer_load_dwordx4 v16, s[40:43], s37 offen lds
    s_add_u32 m0, s28, 45056
    s_add_u32 s37, s3, 0x120000
    buffer_load_dwordx4 v16, s[40:43], s37 offen lds
    s_add_u32 m0, s28, 73728
    s_add_u32 s37, s3, 0x140000
    buffer_load_dwordx4 v16, s[40:43], s37 offen lds
    s_add_u32 m0, s28, 77824
    s_add_u32 s37, s3, 0x160000
    buffer_load_dwordx4 v16, s[40:43], s37 offen lds
    s_add_u32 m0, s28, 106496
    s_add_u32 s37, s3, 0x180000
    buffer_load_dwordx4 v16, s[40:43], s37 offen lds
    s_add_u32 m0, s28, 110592
    s_add_u32 s37, s3, 0x1a0000
    buffer_load_dwordx4 v16, s[40:43], s37 offen lds
    s_add_u32 m0, s28, 139264
    s_add_u32 s37, s3, 0x1c0000
    buffer_load_dwordx4 v16, s[40:43], s37 offen lds
    s_add_u32 m0, s28, 143360
    s_add_u32 s37, s3, 0x1e0000
    buffer_load_dwordx4 v16, s[40:43], s37 offen lds
    s_waitcnt vmcnt(33)
    s_barrier
    ds_read_b64_tr_b16 v[192:193], v20 offset:16384
    ds_read_b64_tr_b16 v[194:195], v20 offset:17408
    ds_read_b64_tr_b16 v[196:197], v21 offset:16384
    ds_read_b64_tr_b16 v[198:199], v21 offset:17408
    ds_read_b64_tr_b16 v[200:201], v22 offset:16384
    ds_read_b64_tr_b16 v[202:203], v22 offset:17408
    ds_read_b64_tr_b16 v[204:205], v23 offset:16384
    ds_read_b64_tr_b16 v[206:207], v23 offset:17408
    ds_read_b64_tr_b16 v[208:209], v24 offset:16384
    ds_read_b64_tr_b16 v[210:211], v24 offset:17408
    ds_read_b64_tr_b16 v[212:213], v25 offset:16384
    ds_read_b64_tr_b16 v[214:215], v25 offset:17408
    s_waitcnt lgkmcnt(4)
    ds_read_b64_tr_b16 v[216:217], v26 offset:16384
    ds_read_b64_tr_b16 v[218:219], v26 offset:17408
    ds_read_b64_tr_b16 v[220:221], v27 offset:16384
    ds_read_b64_tr_b16 v[222:223], v27 offset:17408
    s_waitcnt lgkmcnt(0)
    s_barrier
    s_add_u32 m0, s28, 49152
    s_add_u32 s37, s3, 0x200000
    buffer_load_dwordx4 v16, s[40:43], s37 offen lds
    s_add_u32 m0, s28, 53248
    s_add_u32 s37, s3, 0x220000
    buffer_load_dwordx4 v16, s[40:43], s37 offen lds
    s_add_u32 m0, s28, 81920
    s_add_u32 s37, s3, 0x240000
    buffer_load_dwordx4 v16, s[40:43], s37 offen lds
    s_add_u32 m0, s28, 86016
    s_add_u32 s37, s3, 0x260000
    buffer_load_dwordx4 v16, s[40:43], s37 offen lds
    s_add_u32 m0, s28, 114688
    s_add_u32 s37, s3, 0x280000
    buffer_load_dwordx4 v16, s[40:43], s37 offen lds
    s_add_u32 m0, s28, 118784
    s_add_u32 s37, s3, 0x2a0000
    buffer_load_dwordx4 v16, s[40:43], s37 offen lds
    s_add_u32 m0, s28, 147456
    s_add_u32 s37, s3, 0x2c0000
    buffer_load_dwordx4 v16, s[40:43], s37 offen lds
    s_add_u32 m0, s28, 151552
    s_add_u32 s37, s3, 0x2e0000
    buffer_load_dwordx4 v16, s[40:43], s37 offen lds
    s_waitcnt vmcnt(33)
    s_barrier
    ds_read_b64_tr_b16 v[224:225], v20 offset:24576
    ds_read_b64_tr_b16 v[226:227], v20 offset:25600
    ds_read_b64_tr_b16 v[228:229], v21 offset:24576
    ds_read_b64_tr_b16 v[230:231], v21 offset:25600
    ds_read_b64_tr_b16 v[232:233], v22 offset:24576
    ds_read_b64_tr_b16 v[234:235], v22 offset:25600
    ds_read_b64_tr_b16 v[236:237], v23 offset:24576
    ds_read_b64_tr_b16 v[238:239], v23 offset:25600
    ds_read_b64_tr_b16 v[240:241], v24 offset:24576
    ds_read_b64_tr_b16 v[242:243], v24 offset:25600
    ds_read_b64_tr_b16 v[244:245], v25 offset:24576
    ds_read_b64_tr_b16 v[246:247], v25 offset:25600
    s_waitcnt lgkmcnt(4)
    ds_read_b64_tr_b16 v[248:249], v26 offset:24576
    ds_read_b64_tr_b16 v[250:251], v26 offset:25600
    ds_read_b64_tr_b16 v[252:253], v27 offset:24576
    ds_read_b64_tr_b16 v[254:255], v27 offset:25600
    s_waitcnt lgkmcnt(0)
    s_barrier
    s_add_u32 m0, s28, 57344
    s_add_u32 s37, s3, 0x300000
    buffer_load_dwordx4 v16, s[40:43], s37 offen lds
    s_add_u32 m0, s28, 61440
    s_add_u32 s37, s3, 0x320000
    buffer_load_dwordx4 v16, s[40:43], s37 offen lds
    s_add_u32 m0, s28, 90112
    s_add_u32 s37, s3, 0x340000
    buffer_load_dwordx4 v16, s[40:43], s37 offen lds
    s_add_u32 m0, s28, 94208
    s_add_u32 s37, s3, 0x360000
    buffer_load_dwordx4 v16, s[40:43], s37 offen lds
    s_add_u32 m0, s28, 122880
    s_add_u32 s37, s3, 0x380000
    buffer_load_dwordx4 v16, s[40:43], s37 offen lds
    s_add_u32 m0, s28, 126976
    s_add_u32 s37, s3, 0x3a0000
    buffer_load_dwordx4 v16, s[40:43], s37 offen lds
    s_add_u32 m0, s28, 155648
    s_add_u32 s37, s3, 0x3c0000
    buffer_load_dwordx4 v16, s[40:43], s37 offen lds
    s_add_u32 m0, s28, 159744
    s_add_u32 s37, s3, 0x3e0000
    buffer_load_dwordx4 v16, s[40:43], s37 offen lds
    s_waitcnt vmcnt(32)
    v_mov_b32 v88, 0
    v_mov_b32 v89, 0
    v_dot2_f32_bf16 v88, v96, s4, v88
    v_dot2_f32_bf16 v89, v96, v96, v89
    v_dot2_f32_bf16 v88, v97, s4, v88
    v_dot2_f32_bf16 v89, v97, v97, v89
    v_dot2_f32_bf16 v88, v98, s4, v88
    v_dot2_f32_bf16 v89, v98, v98, v89
    v_dot2_f32_bf16 v88, v99, s4, v88
    v_dot2_f32_bf16 v89, v99, v99, v89
    v_dot2_f32_bf16 v88, v100, s4, v88
    v_dot2_f32_bf16 v89, v100, v100, v89
    v_dot2_f32_bf16 v88, v101, s4, v88
    v_dot2_f32_bf16 v89, v101, v101, v89
    v_dot2_f32_bf16 v88, v102, s4, v88
    v_dot2_f32_bf16 v89, v102, v102, v89
    v_dot2_f32_bf16 v88, v103, s4, v88
    v_dot2_f32_bf16 v89, v103, v103, v89
    v_dot2_f32_bf16 v88, v104, s4, v88
    v_dot2_f32_bf16 v89, v104, v104, v89
    v_dot2_f32_bf16 v88, v105, s4, v88
    v_dot2_f32_bf16 v89, v105, v105, v89
    v_dot2_f32_bf16 v88, v106, s4, v88
    v_dot2_f32_bf16 v89, v106, v106, v89
    v_dot2_f32_bf16 v88, v107, s4, v88
    v_dot2_f32_bf16 v89, v107, v107, v89
    v_dot2_f32_bf16 v88, v108, s4, v88
    v_dot2_f32_bf16 v89, v108, v108, v89
    v_dot2_f32_bf16 v88, v109, s4, v88
    v_dot2_f32_bf16 v89, v109, v109, v89
    v_dot2_f32_bf16 v88, v110, s4, v88
    v_dot2_f32_bf16 v89, v110, v110, v89
    v_dot2_f32_bf16 v88, v111, s4, v88
    v_dot2_f32_bf16 v89, v111, v111, v89
    v_dot2_f32_bf16 v88, v112, s4, v88
    v_dot2_f32_bf16 v89, v112, v112, v89
    v_dot2_f32_bf16 v88, v113, s4, v88
    v_dot2_f32_bf16 v89, v113, v113, v89
    v_dot2_f32_bf16 v88, v114, s4, v88
    v_dot2_f32_bf16 v89, v114, v114, v89
    v_dot2_f32_bf16 v88, v115, s4, v88
    v_dot2_f32_bf16 v89, v115, v115, v89
    v_dot2_f32_bf16 v88, v116, s4, v88
    v_dot2_f32_bf16 v89, v116, v116, v89
    v_dot2_f32_bf16 v88, v117, s4, v88
    v_dot2_f32_bf16 v89, v117, v117, v89
    v_dot2_f32_bf16 v88, v118, s4, v88
    v_dot2_f32_bf16 v89, v118, v118, v89
    v_dot2_f32_bf16 v88, v119, s4, v88
    v_dot2_f32_bf16 v89, v119, v119, v89
    v_dot2_f32_bf16 v88, v120, s4, v88
    v_dot2_f32_bf16 v89, v120, v120, v89
    v_dot2_f32_bf16 v88, v121, s4, v88
    v_dot2_f32_bf16 v89, v121, v121, v89
    v_dot2_f32_bf16 v88, v122, s4, v88
    v_dot2_f32_bf16 v89, v122, v122, v89
    v_dot2_f32_bf16 v88, v123, s4, v88
    v_dot2_f32_bf16 v89, v123, v123, v89
    v_dot2_f32_bf16 v88, v124, s4, v88
    v_dot2_f32_bf16 v89, v124, v124, v89
    v_dot2_f32_bf16 v88, v125, s4, v88
    v_dot2_f32_bf16 v89, v125, v125, v89
    v_dot2_f32_bf16 v88, v126, s4, v88
    v_dot2_f32_bf16 v89, v126, v126, v89
    v_dot2_f32_bf16 v88, v127, s4, v88
    v_dot2_f32_bf16 v89, v127, v127, v89
    s_nop 3
    v_add_f32_dpp v88, v88, v88 quad_perm:[1,0,3,2] row_mask:0xf bank_mask:0xf
    v_add_f32_dpp v89, v89, v89 quad_perm:[1,0,3,2] row_mask:0xf bank_mask:0xf
    s_nop 0
    v_add_f32_dpp v88, v88, v88 quad_perm:[2,3,0,1] row_mask:0xf bank_mask:0xf
    v_add_f32_dpp v89, v89, v89 quad_perm:[2,3,0,1] row_mask:0xf bank_mask:0xf
    s_nop 0
    v_add_f32_dpp v88, v88, v88 row_half_mirror row_mask:0xf bank_mask:0xf
    v_add_f32_dpp v89, v89, v89 row_half_mirror row_mask:0xf bank_mask:0xf
    v_mul_f32 v88, 0x3b000000, v88
    v_mul_f32 v89, 0x3b000000, v89
    v_fma_f32 v89, -v88, v88, v89
    v_max_f32 v89, 0, v89
    v_cvt_pk_bf16_f32 v14, v88, v89
    v_lshlrev_b32 v88, 16, v14
    v_and_b32 v89, 0xffff0000, v14
    v_add_f32 v89, 0x3727c5ac, v89
    v_cvt_pk_bf16_f32 v14, v89, v89
    v_lshlrev_b32 v89, 16, v14
    v_sqrt_f32 v89, v89
    s_nop 0
    v_cvt_pk_bf16_f32 v14, v89, v89
    v_lshlrev_b32 v89, 16, v14
    v_rcp_f32 v89, v89
    v_lshlrev_b32 v90, 16, v96
    v_and_b32 v91, 0xffff0000, v96
    v_sub_f32 v90, v90, v88
    v_sub_f32 v91, v91, v88
    v_cvt_pk_bf16_f32 v96, v90, v91
    v_lshlrev_b32 v90, 16, v96
    v_and_b32 v91, 0xffff0000, v96
    v_mul_f32 v90, v90, v89
    v_mul_f32 v91, v91, v89
    v_cvt_pk_bf16_f32 v96, v90, v91
    v_lshlrev_b32 v90, 16, v97
    v_and_b32 v91, 0xffff0000, v97
    v_sub_f32 v90, v90, v88
    v_sub_f32 v91, v91, v88
    v_cvt_pk_bf16_f32 v97, v90, v91
    v_lshlrev_b32 v90, 16, v97
    v_and_b32 v91, 0xffff0000, v97
    v_mul_f32 v90, v90, v89
    v_mul_f32 v91, v91, v89
    v_cvt_pk_bf16_f32 v97, v90, v91
    v_lshlrev_b32 v90, 16, v98
    v_and_b32 v91, 0xffff0000, v98
    v_sub_f32 v90, v90, v88
    v_sub_f32 v91, v91, v88
    v_cvt_pk_bf16_f32 v98, v90, v91
    v_lshlrev_b32 v90, 16, v98
    v_and_b32 v91, 0xffff0000, v98
    v_mul_f32 v90, v90, v89
    v_mul_f32 v91, v91, v89
    v_cvt_pk_bf16_f32 v98, v90, v91
    v_lshlrev_b32 v90, 16, v99
    v_and_b32 v91, 0xffff0000, v99
    v_sub_f32 v90, v90, v88
    v_sub_f32 v91, v91, v88
    v_cvt_pk_bf16_f32 v99, v90, v91
    v_lshlrev_b32 v90, 16, v99
    v_and_b32 v91, 0xffff0000, v99
    v_mul_f32 v90, v90, v89
    v_mul_f32 v91, v91, v89
    v_cvt_pk_bf16_f32 v99, v90, v91
    ds_write_b128 v4, v[96:99] offset:0
    v_lshlrev_b32 v90, 16, v100
    v_and_b32 v91, 0xffff0000, v100
    v_sub_f32 v90, v90, v88
    v_sub_f32 v91, v91, v88
    v_cvt_pk_bf16_f32 v100, v90, v91
    v_lshlrev_b32 v90, 16, v100
    v_and_b32 v91, 0xffff0000, v100
    v_mul_f32 v90, v90, v89
    v_mul_f32 v91, v91, v89
    v_cvt_pk_bf16_f32 v100, v90, v91
    v_lshlrev_b32 v90, 16, v101
    v_and_b32 v91, 0xffff0000, v101
    v_sub_f32 v90, v90, v88
    v_sub_f32 v91, v91, v88
    v_cvt_pk_bf16_f32 v101, v90, v91
    v_lshlrev_b32 v90, 16, v101
    v_and_b32 v91, 0xffff0000, v101
    v_mul_f32 v90, v90, v89
    v_mul_f32 v91, v91, v89
    v_cvt_pk_bf16_f32 v101, v90, v91
    v_lshlrev_b32 v90, 16, v102
    v_and_b32 v91, 0xffff0000, v102
    v_sub_f32 v90, v90, v88
    v_sub_f32 v91, v91, v88
    v_cvt_pk_bf16_f32 v102, v90, v91
    v_lshlrev_b32 v90, 16, v102
    v_and_b32 v91, 0xffff0000, v102
    v_mul_f32 v90, v90, v89
    v_mul_f32 v91, v91, v89
    v_cvt_pk_bf16_f32 v102, v90, v91
    v_lshlrev_b32 v90, 16, v103
    v_and_b32 v91, 0xffff0000, v103
    v_sub_f32 v90, v90, v88
    v_sub_f32 v91, v91, v88
    v_cvt_pk_bf16_f32 v103, v90, v91
    v_lshlrev_b32 v90, 16, v103
    v_and_b32 v91, 0xffff0000, v103
    v_mul_f32 v90, v90, v89
    v_mul_f32 v91, v91, v89
    v_cvt_pk_bf16_f32 v103, v90, v91
    ds_write_b128 v4, v[100:103] offset:2048
    v_lshlrev_b32 v90, 16, v104
    v_and_b32 v91, 0xffff0000, v104
    v_sub_f32 v90, v90, v88
    v_sub_f32 v91, v91, v88
    v_cvt_pk_bf16_f32 v104, v90, v91
    v_lshlrev_b32 v90, 16, v104
    v_and_b32 v91, 0xffff0000, v104
    v_mul_f32 v90, v90, v89
    v_mul_f32 v91, v91, v89
    v_cvt_pk_bf16_f32 v104, v90, v91
    v_lshlrev_b32 v90, 16, v105
    v_and_b32 v91, 0xffff0000, v105
    v_sub_f32 v90, v90, v88
    v_sub_f32 v91, v91, v88
    v_cvt_pk_bf16_f32 v105, v90, v91
    v_lshlrev_b32 v90, 16, v105
    v_and_b32 v91, 0xffff0000, v105
    v_mul_f32 v90, v90, v89
    v_mul_f32 v91, v91, v89
    v_cvt_pk_bf16_f32 v105, v90, v91
    v_lshlrev_b32 v90, 16, v106
    v_and_b32 v91, 0xffff0000, v106
    v_sub_f32 v90, v90, v88
    v_sub_f32 v91, v91, v88
    v_cvt_pk_bf16_f32 v106, v90, v91
    v_lshlrev_b32 v90, 16, v106
    v_and_b32 v91, 0xffff0000, v106
    v_mul_f32 v90, v90, v89
    v_mul_f32 v91, v91, v89
    v_cvt_pk_bf16_f32 v106, v90, v91
    v_lshlrev_b32 v90, 16, v107
    v_and_b32 v91, 0xffff0000, v107
    v_sub_f32 v90, v90, v88
    v_sub_f32 v91, v91, v88
    v_cvt_pk_bf16_f32 v107, v90, v91
    v_lshlrev_b32 v90, 16, v107
    v_and_b32 v91, 0xffff0000, v107
    v_mul_f32 v90, v90, v89
    v_mul_f32 v91, v91, v89
    v_cvt_pk_bf16_f32 v107, v90, v91
    ds_write_b128 v4, v[104:107] offset:4096
    v_lshlrev_b32 v90, 16, v108
    v_and_b32 v91, 0xffff0000, v108
    v_sub_f32 v90, v90, v88
    v_sub_f32 v91, v91, v88
    v_cvt_pk_bf16_f32 v108, v90, v91
    v_lshlrev_b32 v90, 16, v108
    v_and_b32 v91, 0xffff0000, v108
    v_mul_f32 v90, v90, v89
    v_mul_f32 v91, v91, v89
    v_cvt_pk_bf16_f32 v108, v90, v91
    v_lshlrev_b32 v90, 16, v109
    v_and_b32 v91, 0xffff0000, v109
    v_sub_f32 v90, v90, v88
    v_sub_f32 v91, v91, v88
    v_cvt_pk_bf16_f32 v109, v90, v91
    v_lshlrev_b32 v90, 16, v109
    v_and_b32 v91, 0xffff0000, v109
    v_mul_f32 v90, v90, v89
    v_mul_f32 v91, v91, v89
    v_cvt_pk_bf16_f32 v109, v90, v91
    v_lshlrev_b32 v90, 16, v110
    v_and_b32 v91, 0xffff0000, v110
    v_sub_f32 v90, v90, v88
    v_sub_f32 v91, v91, v88
    v_cvt_pk_bf16_f32 v110, v90, v91
    v_lshlrev_b32 v90, 16, v110
    v_and_b32 v91, 0xffff0000, v110
    v_mul_f32 v90, v90, v89
    v_mul_f32 v91, v91, v89
    v_cvt_pk_bf16_f32 v110, v90, v91
    v_lshlrev_b32 v90, 16, v111
    v_and_b32 v91, 0xffff0000, v111
    v_sub_f32 v90, v90, v88
    v_sub_f32 v91, v91, v88
    v_cvt_pk_bf16_f32 v111, v90, v91
    v_lshlrev_b32 v90, 16, v111
    v_and_b32 v91, 0xffff0000, v111
    v_mul_f32 v90, v90, v89
    v_mul_f32 v91, v91, v89
    v_cvt_pk_bf16_f32 v111, v90, v91
    ds_write_b128 v4, v[108:111] offset:6144
    v_lshlrev_b32 v90, 16, v112
    v_and_b32 v91, 0xffff0000, v112
    v_sub_f32 v90, v90, v88
    v_sub_f32 v91, v91, v88
    v_cvt_pk_bf16_f32 v112, v90, v91
    v_lshlrev_b32 v90, 16, v112
    v_and_b32 v91, 0xffff0000, v112
    v_mul_f32 v90, v90, v89
    v_mul_f32 v91, v91, v89
    v_cvt_pk_bf16_f32 v112, v90, v91
    v_lshlrev_b32 v90, 16, v113
    v_and_b32 v91, 0xffff0000, v113
    v_sub_f32 v90, v90, v88
    v_sub_f32 v91, v91, v88
    v_cvt_pk_bf16_f32 v113, v90, v91
    v_lshlrev_b32 v90, 16, v113
    v_and_b32 v91, 0xffff0000, v113
    v_mul_f32 v90, v90, v89
    v_mul_f32 v91, v91, v89
    v_cvt_pk_bf16_f32 v113, v90, v91
    v_lshlrev_b32 v90, 16, v114
    v_and_b32 v91, 0xffff0000, v114
    v_sub_f32 v90, v90, v88
    v_sub_f32 v91, v91, v88
    v_cvt_pk_bf16_f32 v114, v90, v91
    v_lshlrev_b32 v90, 16, v114
    v_and_b32 v91, 0xffff0000, v114
    v_mul_f32 v90, v90, v89
    v_mul_f32 v91, v91, v89
    v_cvt_pk_bf16_f32 v114, v90, v91
    v_lshlrev_b32 v90, 16, v115
    v_and_b32 v91, 0xffff0000, v115
    v_sub_f32 v90, v90, v88
    v_sub_f32 v91, v91, v88
    v_cvt_pk_bf16_f32 v115, v90, v91
    v_lshlrev_b32 v90, 16, v115
    v_and_b32 v91, 0xffff0000, v115
    v_mul_f32 v90, v90, v89
    v_mul_f32 v91, v91, v89
    v_cvt_pk_bf16_f32 v115, v90, v91
    ds_write_b128 v4, v[112:115] offset:8192
    v_lshlrev_b32 v90, 16, v116
    v_and_b32 v91, 0xffff0000, v116
    v_sub_f32 v90, v90, v88
    v_sub_f32 v91, v91, v88
    v_cvt_pk_bf16_f32 v116, v90, v91
    v_lshlrev_b32 v90, 16, v116
    v_and_b32 v91, 0xffff0000, v116
    v_mul_f32 v90, v90, v89
    v_mul_f32 v91, v91, v89
    v_cvt_pk_bf16_f32 v116, v90, v91
    v_lshlrev_b32 v90, 16, v117
    v_and_b32 v91, 0xffff0000, v117
    v_sub_f32 v90, v90, v88
    v_sub_f32 v91, v91, v88
    v_cvt_pk_bf16_f32 v117, v90, v91
    v_lshlrev_b32 v90, 16, v117
    v_and_b32 v91, 0xffff0000, v117
    v_mul_f32 v90, v90, v89
    v_mul_f32 v91, v91, v89
    v_cvt_pk_bf16_f32 v117, v90, v91
    v_lshlrev_b32 v90, 16, v118
    v_and_b32 v91, 0xffff0000, v118
    v_sub_f32 v90, v90, v88
    v_sub_f32 v91, v91, v88
    v_cvt_pk_bf16_f32 v118, v90, v91
    v_lshlrev_b32 v90, 16, v118
    v_and_b32 v91, 0xffff0000, v118
    v_mul_f32 v90, v90, v89
    v_mul_f32 v91, v91, v89
    v_cvt_pk_bf16_f32 v118, v90, v91
    v_lshlrev_b32 v90, 16, v119
    v_and_b32 v91, 0xffff0000, v119
    v_sub_f32 v90, v90, v88
    v_sub_f32 v91, v91, v88
    v_cvt_pk_bf16_f32 v119, v90, v91
    v_lshlrev_b32 v90, 16, v119
    v_and_b32 v91, 0xffff0000, v119
    v_mul_f32 v90, v90, v89
    v_mul_f32 v91, v91, v89
    v_cvt_pk_bf16_f32 v119, v90, v91
    ds_write_b128 v4, v[116:119] offset:10240
    v_lshlrev_b32 v90, 16, v120
    v_and_b32 v91, 0xffff0000, v120
    v_sub_f32 v90, v90, v88
    v_sub_f32 v91, v91, v88
    v_cvt_pk_bf16_f32 v120, v90, v91
    v_lshlrev_b32 v90, 16, v120
    v_and_b32 v91, 0xffff0000, v120
    v_mul_f32 v90, v90, v89
    v_mul_f32 v91, v91, v89
    v_cvt_pk_bf16_f32 v120, v90, v91
    v_lshlrev_b32 v90, 16, v121
    v_and_b32 v91, 0xffff0000, v121
    v_sub_f32 v90, v90, v88
    v_sub_f32 v91, v91, v88
    v_cvt_pk_bf16_f32 v121, v90, v91
    v_lshlrev_b32 v90, 16, v121
    v_and_b32 v91, 0xffff0000, v121
    v_mul_f32 v90, v90, v89
    v_mul_f32 v91, v91, v89
    v_cvt_pk_bf16_f32 v121, v90, v91
    v_lshlrev_b32 v90, 16, v122
    v_and_b32 v91, 0xffff0000, v122
    v_sub_f32 v90, v90, v88
    v_sub_f32 v91, v91, v88
    v_cvt_pk_bf16_f32 v122, v90, v91
    v_lshlrev_b32 v90, 16, v122
    v_and_b32 v91, 0xffff0000, v122
    v_mul_f32 v90, v90, v89
    v_mul_f32 v91, v91, v89
    v_cvt_pk_bf16_f32 v122, v90, v91
    v_lshlrev_b32 v90, 16, v123
    v_and_b32 v91, 0xffff0000, v123
    v_sub_f32 v90, v90, v88
    v_sub_f32 v91, v91, v88
    v_cvt_pk_bf16_f32 v123, v90, v91
    v_lshlrev_b32 v90, 16, v123
    v_and_b32 v91, 0xffff0000, v123
    v_mul_f32 v90, v90, v89
    v_mul_f32 v91, v91, v89
    v_cvt_pk_bf16_f32 v123, v90, v91
    ds_write_b128 v4, v[120:123] offset:12288
    v_lshlrev_b32 v90, 16, v124
    v_and_b32 v91, 0xffff0000, v124
    v_sub_f32 v90, v90, v88
    v_sub_f32 v91, v91, v88
    v_cvt_pk_bf16_f32 v124, v90, v91
    v_lshlrev_b32 v90, 16, v124
    v_and_b32 v91, 0xffff0000, v124
    v_mul_f32 v90, v90, v89
    v_mul_f32 v91, v91, v89
    v_cvt_pk_bf16_f32 v124, v90, v91
    v_lshlrev_b32 v90, 16, v125
    v_and_b32 v91, 0xffff0000, v125
    v_sub_f32 v90, v90, v88
    v_sub_f32 v91, v91, v88
    v_cvt_pk_bf16_f32 v125, v90, v91
    v_lshlrev_b32 v90, 16, v125
    v_and_b32 v91, 0xffff0000, v125
    v_mul_f32 v90, v90, v89
    v_mul_f32 v91, v91, v89
    v_cvt_pk_bf16_f32 v125, v90, v91
    v_lshlrev_b32 v90, 16, v126
    v_and_b32 v91, 0xffff0000, v126
    v_sub_f32 v90, v90, v88
    v_sub_f32 v91, v91, v88
    v_cvt_pk_bf16_f32 v126, v90, v91
    v_lshlrev_b32 v90, 16, v126
    v_and_b32 v91, 0xffff0000, v126
    v_mul_f32 v90, v90, v89
    v_mul_f32 v91, v91, v89
    v_cvt_pk_bf16_f32 v126, v90, v91
    v_lshlrev_b32 v90, 16, v127
    v_and_b32 v91, 0xffff0000, v127
    v_sub_f32 v90, v90, v88
    v_sub_f32 v91, v91, v88
    v_cvt_pk_bf16_f32 v127, v90, v91
    v_lshlrev_b32 v90, 16, v127
    v_and_b32 v91, 0xffff0000, v127
    v_mul_f32 v90, v90, v89
    v_mul_f32 v91, v91, v89
    v_cvt_pk_bf16_f32 v127, v90, v91
    ds_write_b128 v4, v[124:127] offset:14336
    s_lshr_b32 s36, s21, 1
    s_lshl_b32 s36, s36, 14
    s_xor_b32 s37, s36, 16384
    v_add_u32 v80, s36, v5
    v_add_u32 v81, s37, v5
    v_add_u32 v82, s36, v6
    v_add_u32 v83, s37, v6
    s_mov_b32 s31, 0
    s_waitcnt vmcnt(24)
    s_barrier
    ds_read_b64_tr_b16 a[128:129], v20 offset:0
    ds_read_b64_tr_b16 a[130:131], v20 offset:1024
    ds_read_b64_tr_b16 a[132:133], v21 offset:0
    ds_read_b64_tr_b16 a[134:135], v21 offset:1024
    ds_read_b64_tr_b16 a[136:137], v22 offset:0
    ds_read_b64_tr_b16 a[138:139], v22 offset:1024
    ds_read_b64_tr_b16 a[140:141], v23 offset:0
    ds_read_b64_tr_b16 a[142:143], v23 offset:1024
    ds_read_b64_tr_b16 a[144:145], v24 offset:0
    ds_read_b64_tr_b16 a[146:147], v24 offset:1024
    ds_read_b64_tr_b16 a[148:149], v25 offset:0
    ds_read_b64_tr_b16 a[150:151], v25 offset:1024
    s_waitcnt lgkmcnt(4)
    ds_read_b64_tr_b16 a[152:153], v26 offset:0
    ds_read_b64_tr_b16 a[154:155], v26 offset:1024
    ds_read_b64_tr_b16 a[156:157], v27 offset:0
    ds_read_b64_tr_b16 a[158:159], v27 offset:1024
    s_waitcnt lgkmcnt(0)
    s_barrier
    s_mov_b32 s96, s48
    s_and_b32 s97, s49, 0xffff
    s_mov_b32 s98, 0x400000
    s_mov_b32 s99, 0x20000
    s_add_u32 m0, s28, 32768
    s_add_u32 s37, s3, 0x0
    buffer_load_dwordx4 v16, s[96:99], s37 offen lds
    s_add_u32 m0, s28, 36864
    s_add_u32 s37, s3, 0x20000
    buffer_load_dwordx4 v16, s[96:99], s37 offen lds
    s_add_u32 m0, s28, 65536
    s_add_u32 s37, s3, 0x40000
    buffer_load_dwordx4 v16, s[96:99], s37 offen lds
    s_add_u32 m0, s28, 69632
    s_add_u32 s37, s3, 0x60000
    buffer_load_dwordx4 v16, s[96:99], s37 offen lds
    s_add_u32 m0, s28, 98304
    s_add_u32 s37, s3, 0x80000
    buffer_load_dwordx4 v16, s[96:99], s37 offen lds
    s_add_u32 m0, s28, 102400
    s_add_u32 s37, s3, 0xa0000
    buffer_load_dwordx4 v16, s[96:99], s37 offen lds
    s_add_u32 m0, s28, 131072
    s_add_u32 s37, s3, 0xc0000
    buffer_load_dwordx4 v16, s[96:99], s37 offen lds
    s_add_u32 m0, s28, 135168
    s_add_u32 s37, s3, 0xe0000
    buffer_load_dwordx4 v16, s[96:99], s37 offen lds
    s_waitcnt vmcnt(24)
    s_barrier
    ds_read_b64_tr_b16 a[160:161], v20 offset:8192
    ds_read_b64_tr_b16 a[162:163], v20 offset:9216
    ds_read_b64_tr_b16 a[164:165], v21 offset:8192
    ds_read_b64_tr_b16 a[166:167], v21 offset:9216
    ds_read_b64_tr_b16 a[168:169], v22 offset:8192
    ds_read_b64_tr_b16 a[170:171], v22 offset:9216
    ds_read_b64_tr_b16 a[172:173], v23 offset:8192
    ds_read_b64_tr_b16 a[174:175], v23 offset:9216
    ds_read_b64_tr_b16 a[176:177], v24 offset:8192
    ds_read_b64_tr_b16 a[178:179], v24 offset:9216
    ds_read_b64_tr_b16 a[180:181], v25 offset:8192
    ds_read_b64_tr_b16 a[182:183], v25 offset:9216
    s_waitcnt lgkmcnt(4)
    ds_read_b64_tr_b16 a[184:185], v26 offset:8192
    ds_read_b64_tr_b16 a[186:187], v26 offset:9216
    ds_read_b64_tr_b16 a[188:189], v27 offset:8192
    ds_read_b64_tr_b16 a[190:191], v27 offset:9216
    s_waitcnt lgkmcnt(0)
    s_barrier
    s_add_u32 m0, s28, 40960
    s_add_u32 s37, s3, 0x100000
    buffer_load_dwordx4 v16, s[96:99], s37 offen lds
    s_add_u32 m0, s28, 45056
    s_add_u32 s37, s3, 0x120000
    buffer_load_dwordx4 v16, s[96:99], s37 offen lds
    s_add_u32 m0, s28, 73728
    s_add_u32 s37, s3, 0x140000
    buffer_load_dwordx4 v16, s[96:99], s37 offen lds
    s_add_u32 m0, s28, 77824
    s_add_u32 s37, s3, 0x160000
    buffer_load_dwordx4 v16, s[96:99], s37 offen lds
    s_add_u32 m0, s28, 106496
    s_add_u32 s37, s3, 0x180000
    buffer_load_dwordx4 v16, s[96:99], s37 offen lds
    s_add_u32 m0, s28, 110592
    s_add_u32 s37, s3, 0x1a0000
    buffer_load_dwordx4 v16, s[96:99], s37 offen lds
    s_add_u32 m0, s28, 139264
    s_add_u32 s37, s3, 0x1c0000
    buffer_load_dwordx4 v16, s[96:99], s37 offen lds
    s_add_u32 m0, s28, 143360
    s_add_u32 s37, s3, 0x1e0000
    buffer_load_dwordx4 v16, s[96:99], s37 offen lds
    s_waitcnt vmcnt(24)
    s_barrier
    ds_read_b64_tr_b16 a[192:193], v20 offset:16384
    ds_read_b64_tr_b16 a[194:195], v20 offset:17408
    ds_read_b64_tr_b16 a[196:197], v21 offset:16384
    ds_read_b64_tr_b16 a[198:199], v21 offset:17408
    ds_read_b64_tr_b16 a[200:201], v22 offset:16384
    ds_read_b64_tr_b16 a[202:203], v22 offset:17408
    ds_read_b64_tr_b16 a[204:205], v23 offset:16384
    ds_read_b64_tr_b16 a[206:207], v23 offset:17408
    ds_read_b64_tr_b16 a[208:209], v24 offset:16384
    ds_read_b64_tr_b16 a[210:211], v24 offset:17408
    ds_read_b64_tr_b16 a[212:213], v25 offset:16384
    ds_read_b64_tr_b16 a[214:215], v25 offset:17408
    s_waitcnt lgkmcnt(4)
    ds_read_b64_tr_b16 a[216:217], v26 offset:16384
    ds_read_b64_tr_b16 a[218:219], v26 offset:17408
    ds_read_b64_tr_b16 a[220:221], v27 offset:16384
    ds_read_b64_tr_b16 a[222:223], v27 offset:17408
    s_waitcnt lgkmcnt(0)
    s_barrier
    s_add_u32 m0, s28, 49152
    s_add_u32 s37, s3, 0x200000
    buffer_load_dwordx4 v16, s[96:99], s37 offen lds
    s_add_u32 m0, s28, 53248
    s_add_u32 s37, s3, 0x220000
    buffer_load_dwordx4 v16, s[96:99], s37 offen lds
    s_add_u32 m0, s28, 81920
    s_add_u32 s37, s3, 0x240000
    buffer_load_dwordx4 v16, s[96:99], s37 offen lds
    s_add_u32 m0, s28, 86016
    s_add_u32 s37, s3, 0x260000
    buffer_load_dwordx4 v16, s[96:99], s37 offen lds
    s_add_u32 m0, s28, 114688
    s_add_u32 s37, s3, 0x280000
    buffer_load_dwordx4 v16, s[96:99], s37 offen lds
    s_add_u32 m0, s28, 118784
    s_add_u32 s37, s3, 0x2a0000
    buffer_load_dwordx4 v16, s[96:99], s37 offen lds
    s_add_u32 m0, s28, 147456
    s_add_u32 s37, s3, 0x2c0000
    buffer_load_dwordx4 v16, s[96:99], s37 offen lds
    s_add_u32 m0, s28, 151552
    s_add_u32 s37, s3, 0x2e0000
    buffer_load_dwordx4 v16, s[96:99], s37 offen lds
    s_waitcnt vmcnt(24)
    s_barrier
    ds_read_b64_tr_b16 a[224:225], v20 offset:24576
    ds_read_b64_tr_b16 a[226:227], v20 offset:25600
    ds_read_b64_tr_b16 a[228:229], v21 offset:24576
    ds_read_b64_tr_b16 a[230:231], v21 offset:25600
    ds_read_b64_tr_b16 a[232:233], v22 offset:24576
    ds_read_b64_tr_b16 a[234:235], v22 offset:25600
    ds_read_b64_tr_b16 a[236:237], v23 offset:24576
    ds_read_b64_tr_b16 a[238:239], v23 offset:25600
    ds_read_b64_tr_b16 a[240:241], v24 offset:24576
    ds_read_b64_tr_b16 a[242:243], v24 offset:25600
    ds_read_b64_tr_b16 a[244:245], v25 offset:24576
    ds_read_b64_tr_b16 a[246:247], v25 offset:25600
    s_waitcnt lgkmcnt(4)
    ds_read_b64_tr_b16 a[248:249], v26 offset:24576
    ds_read_b64_tr_b16 a[250:251], v26 offset:25600
    ds_read_b64_tr_b16 a[252:253], v27 offset:24576
    ds_read_b64_tr_b16 a[254:255], v27 offset:25600
    s_waitcnt lgkmcnt(0)
    s_barrier
    s_add_u32 m0, s28, 57344
    s_add_u32 s37, s3, 0x300000
    buffer_load_dwordx4 v16, s[96:99], s37 offen lds
    s_add_u32 m0, s28, 61440
    s_add_u32 s37, s3, 0x320000
    buffer_load_dwordx4 v16, s[96:99], s37 offen lds
    s_add_u32 m0, s28, 90112
    s_add_u32 s37, s3, 0x340000
    buffer_load_dwordx4 v16, s[96:99], s37 offen lds
    s_add_u32 m0, s28, 94208
    s_add_u32 s37, s3, 0x360000
    buffer_load_dwordx4 v16, s[96:99], s37 offen lds
    s_add_u32 m0, s28, 122880
    s_add_u32 s37, s3, 0x380000
    buffer_load_dwordx4 v16, s[96:99], s37 offen lds
    s_add_u32 m0, s28, 126976
    s_add_u32 s37, s3, 0x3a0000
    buffer_load_dwordx4 v16, s[96:99], s37 offen lds
    s_add_u32 m0, s28, 155648
    s_add_u32 s37, s3, 0x3c0000
    buffer_load_dwordx4 v16, s[96:99], s37 offen lds
    s_add_u32 m0, s28, 159744
    s_add_u32 s37, s3, 0x3e0000
    buffer_load_dwordx4 v16, s[96:99], s37 offen lds
    ds_read_b128 v[64:67], v80 offset:0
    ds_read_b128 v[68:71], v81 offset:0
    ds_read_b128 v[72:75], v82 offset:1024
    ds_read_b128 v[76:79], v83 offset:1024
    s_waitcnt lgkmcnt(2)
    v_mfma_f32_16x16x32_bf16 v[32:35], a[128:131], v[64:67], 0
    v_mfma_f32_16x16x32_bf16 v[36:39], a[128:131], v[68:71], 0
    v_mfma_f32_16x16x32_bf16 v[40:43], a[132:135], v[64:67], 0
    v_mfma_f32_16x16x32_bf16 v[44:47], a[132:135], v[68:71], 0
    v_mfma_f32_16x16x32_bf16 v[48:51], v[64:67], v[128:131], 0
    v_mfma_f32_16x16x32_bf16 v[56:59], v[68:71], v[128:131], 0
    v_mfma_f32_16x16x32_bf16 v[52:55], v[64:67], v[132:135], 0
    v_mfma_f32_16x16x32_bf16 v[60:63], v[68:71], v[132:135], 0
    ds_read_b128 v[64:67], v80 offset:2048
    ds_read_b128 v[68:71], v81 offset:2048
    s_waitcnt lgkmcnt(2)
    v_mfma_f32_16x16x32_bf16 v[32:35], a[136:139], v[72:75], v[32:35]
    v_mfma_f32_16x16x32_bf16 v[36:39], a[136:139], v[76:79], v[36:39]
    v_mfma_f32_16x16x32_bf16 v[40:43], a[140:143], v[72:75], v[40:43]
    v_mfma_f32_16x16x32_bf16 v[44:47], a[140:143], v[76:79], v[44:47]
    v_mfma_f32_16x16x32_bf16 v[48:51], v[72:75], v[136:139], v[48:51]
    v_mfma_f32_16x16x32_bf16 v[56:59], v[76:79], v[136:139], v[56:59]
    v_mfma_f32_16x16x32_bf16 v[52:55], v[72:75], v[140:143], v[52:55]
    v_mfma_f32_16x16x32_bf16 v[60:63], v[76:79], v[140:143], v[60:63]
    ds_read_b128 v[72:75], v82 offset:3072
    ds_read_b128 v[76:79], v83 offset:3072
    s_waitcnt lgkmcnt(2)
    v_mfma_f32_16x16x32_bf16 v[32:35], a[144:147], v[64:67], v[32:35]
    v_mfma_f32_16x16x32_bf16 v[36:39], a[144:147], v[68:71], v[36:39]
    v_mfma_f32_16x16x32_bf16 v[40:43], a[148:151], v[64:67], v[40:43]
    v_mfma_f32_16x16x32_bf16 v[44:47], a[148:151], v[68:71], v[44:47]
    v_mfma_f32_16x16x32_bf16 v[48:51], v[64:67], v[144:147], v[48:51]
    v_mfma_f32_16x16x32_bf16 v[56:59], v[68:71], v[144:147], v[56:59]
    v_mfma_f32_16x16x32_bf16 v[52:55], v[64:67], v[148:151], v[52:55]
    v_mfma_f32_16x16x32_bf16 v[60:63], v[68:71], v[148:151], v[60:63]
    ds_read_b128 v[64:67], v80 offset:4096
    ds_read_b128 v[68:71], v81 offset:4096
    s_waitcnt lgkmcnt(2)
    v_mfma_f32_16x16x32_bf16 v[32:35], a[152:155], v[72:75], v[32:35]
    v_mfma_f32_16x16x32_bf16 v[36:39], a[152:155], v[76:79], v[36:39]
    v_mfma_f32_16x16x32_bf16 v[40:43], a[156:159], v[72:75], v[40:43]
    v_mfma_f32_16x16x32_bf16 v[44:47], a[156:159], v[76:79], v[44:47]
    v_mfma_f32_16x16x32_bf16 v[48:51], v[72:75], v[152:155], v[48:51]
    v_mfma_f32_16x16x32_bf16 v[56:59], v[76:79], v[152:155], v[56:59]
    v_mfma_f32_16x16x32_bf16 v[52:55], v[72:75], v[156:159], v[52:55]
    v_mfma_f32_16x16x32_bf16 v[60:63], v[76:79], v[156:159], v[60:63]
    ds_read_b128 v[72:75], v82 offset:5120
    ds_read_b128 v[76:79], v83 offset:5120
    s_waitcnt lgkmcnt(2)
    v_mfma_f32_16x16x32_bf16 v[32:35], a[160:163], v[64:67], v[32:35]
    v_mfma_f32_16x16x32_bf16 v[36:39], a[160:163], v[68:71], v[36:39]
    v_mfma_f32_16x16x32_bf16 v[40:43], a[164:167], v[64:67], v[40:43]
    v_mfma_f32_16x16x32_bf16 v[44:47], a[164:167], v[68:71], v[44:47]
    v_mfma_f32_16x16x32_bf16 v[48:51], v[64:67], v[160:163], v[48:51]
    v_mfma_f32_16x16x32_bf16 v[56:59], v[68:71], v[160:163], v[56:59]
    v_mfma_f32_16x16x32_bf16 v[52:55], v[64:67], v[164:167], v[52:55]
    v_mfma_f32_16x16x32_bf16 v[60:63], v[68:71], v[164:167], v[60:63]
    ds_read_b128 v[64:67], v80 offset:6144
    ds_read_b128 v[68:71], v81 offset:6144
    s_waitcnt lgkmcnt(2)
    v_mfma_f32_16x16x32_bf16 v[32:35], a[168:171], v[72:75], v[32:35]
    v_mfma_f32_16x16x32_bf16 v[36:39], a[168:171], v[76:79], v[36:39]
    v_mfma_f32_16x16x32_bf16 v[40:43], a[172:175], v[72:75], v[40:43]
    v_mfma_f32_16x16x32_bf16 v[44:47], a[172:175], v[76:79], v[44:47]
    v_mfma_f32_16x16x32_bf16 v[48:51], v[72:75], v[168:171], v[48:51]
    v_mfma_f32_16x16x32_bf16 v[56:59], v[76:79], v[168:171], v[56:59]
    v_mfma_f32_16x16x32_bf16 v[52:55], v[72:75], v[172:175], v[52:55]
    v_mfma_f32_16x16x32_bf16 v[60:63], v[76:79], v[172:175], v[60:63]
    ds_read_b128 v[72:75], v82 offset:7168
    ds_read_b128 v[76:79], v83 offset:7168
    s_waitcnt lgkmcnt(2)
    v_mfma_f32_16x16x32_bf16 v[32:35], a[176:179], v[64:67], v[32:35]
    v_mfma_f32_16x16x32_bf16 v[36:39], a[176:179], v[68:71], v[36:39]
    v_mfma_f32_16x16x32_bf16 v[40:43], a[180:183], v[64:67], v[40:43]
    v_mfma_f32_16x16x32_bf16 v[44:47], a[180:183], v[68:71], v[44:47]
    v_mfma_f32_16x16x32_bf16 v[48:51], v[64:67], v[176:179], v[48:51]
    v_mfma_f32_16x16x32_bf16 v[56:59], v[68:71], v[176:179], v[56:59]
    v_mfma_f32_16x16x32_bf16 v[52:55], v[64:67], v[180:183], v[52:55]
    v_mfma_f32_16x16x32_bf16 v[60:63], v[68:71], v[180:183], v[60:63]
    ds_read_b128 v[64:67], v80 offset:8192
    ds_read_b128 v[68:71], v81 offset:8192
    s_waitcnt lgkmcnt(2)
    v_mfma_f32_16x16x32_bf16 v[32:35], a[184:187], v[72:75], v[32:35]
    v_mfma_f32_16x16x32_bf16 v[36:39], a[184:187], v[76:79], v[36:39]
    v_mfma_f32_16x16x32_bf16 v[40:43], a[188:191], v[72:75], v[40:43]
    v_mfma_f32_16x16x32_bf16 v[44:47], a[188:191], v[76:79], v[44:47]
    v_mfma_f32_16x16x32_bf16 v[48:51], v[72:75], v[184:187], v[48:51]
    v_mfma_f32_16x16x32_bf16 v[56:59], v[76:79], v[184:187], v[56:59]
    v_mfma_f32_16x16x32_bf16 v[52:55], v[72:75], v[188:191], v[52:55]
    v_mfma_f32_16x16x32_bf16 v[60:63], v[76:79], v[188:191], v[60:63]
    ds_read_b128 v[72:75], v82 offset:9216
    ds_read_b128 v[76:79], v83 offset:9216
    s_waitcnt lgkmcnt(2)
    v_mfma_f32_16x16x32_bf16 v[32:35], a[192:195], v[64:67], v[32:35]
    v_mfma_f32_16x16x32_bf16 v[36:39], a[192:195], v[68:71], v[36:39]
    v_mfma_f32_16x16x32_bf16 v[40:43], a[196:199], v[64:67], v[40:43]
    v_mfma_f32_16x16x32_bf16 v[44:47], a[196:199], v[68:71], v[44:47]
    v_mfma_f32_16x16x32_bf16 v[48:51], v[64:67], v[192:195], v[48:51]
    v_mfma_f32_16x16x32_bf16 v[56:59], v[68:71], v[192:195], v[56:59]
    v_mfma_f32_16x16x32_bf16 v[52:55], v[64:67], v[196:199], v[52:55]
    v_mfma_f32_16x16x32_bf16 v[60:63], v[68:71], v[196:199], v[60:63]
    ds_read_b128 v[64:67], v80 offset:10240
    ds_read_b128 v[68:71], v81 offset:10240
    s_waitcnt lgkmcnt(2)
    v_mfma_f32_16x16x32_bf16 v[32:35], a[200:203], v[72:75], v[32:35]
    v_mfma_f32_16x16x32_bf16 v[36:39], a[200:203], v[76:79], v[36:39]
    v_mfma_f32_16x16x32_bf16 v[40:43], a[204:207], v[72:75], v[40:43]
    v_mfma_f32_16x16x32_bf16 v[44:47], a[204:207], v[76:79], v[44:47]
    v_mfma_f32_16x16x32_bf16 v[48:51], v[72:75], v[200:203], v[48:51]
    v_mfma_f32_16x16x32_bf16 v[56:59], v[76:79], v[200:203], v[56:59]
    v_mfma_f32_16x16x32_bf16 v[52:55], v[72:75], v[204:207], v[52:55]
    v_mfma_f32_16x16x32_bf16 v[60:63], v[76:79], v[204:207], v[60:63]
    ds_read_b128 v[72:75], v82 offset:11264
    ds_read_b128 v[76:79], v83 offset:11264
    s_waitcnt lgkmcnt(2)
    v_mfma_f32_16x16x32_bf16 v[32:35], a[208:211], v[64:67], v[32:35]
    v_mfma_f32_16x16x32_bf16 v[36:39], a[208:211], v[68:71], v[36:39]
    v_mfma_f32_16x16x32_bf16 v[40:43], a[212:215], v[64:67], v[40:43]
    v_mfma_f32_16x16x32_bf16 v[44:47], a[212:215], v[68:71], v[44:47]
    v_mfma_f32_16x16x32_bf16 v[48:51], v[64:67], v[208:211], v[48:51]
    v_mfma_f32_16x16x32_bf16 v[56:59], v[68:71], v[208:211], v[56:59]
    v_mfma_f32_16x16x32_bf16 v[52:55], v[64:67], v[212:215], v[52:55]
    v_mfma_f32_16x16x32_bf16 v[60:63], v[68:71], v[212:215], v[60:63]
    ds_read_b128 v[64:67], v80 offset:12288
    ds_read_b128 v[68:71], v81 offset:12288
    s_waitcnt lgkmcnt(2)
    v_mfma_f32_16x16x32_bf16 v[32:35], a[216:219], v[72:75], v[32:35]
    v_mfma_f32_16x16x32_bf16 v[36:39], a[216:219], v[76:79], v[36:39]
    v_mfma_f32_16x16x32_bf16 v[40:43], a[220:223], v[72:75], v[40:43]
    v_mfma_f32_16x16x32_bf16 v[44:47], a[220:223], v[76:79], v[44:47]
    v_mfma_f32_16x16x32_bf16 v[48:51], v[72:75], v[216:219], v[48:51]
    v_mfma_f32_16x16x32_bf16 v[56:59], v[76:79], v[216:219], v[56:59]
    v_mfma_f32_16x16x32_bf16 v[52:55], v[72:75], v[220:223], v[52:55]
    v_mfma_f32_16x16x32_bf16 v[60:63], v[76:79], v[220:223], v[60:63]
    ds_read_b128 v[72:75], v82 offset:13312
    ds_read_b128 v[76:79], v83 offset:13312
    s_waitcnt lgkmcnt(2)
    v_mfma_f32_16x16x32_bf16 v[32:35], a[224:227], v[64:67], v[32:35]
    v_mfma_f32_16x16x32_bf16 v[36:39], a[224:227], v[68:71], v[36:39]
    v_mfma_f32_16x16x32_bf16 v[40:43], a[228:231], v[64:67], v[40:43]
    v_mfma_f32_16x16x32_bf16 v[44:47], a[228:231], v[68:71], v[44:47]
    v_mfma_f32_16x16x32_bf16 v[48:51], v[64:67], v[224:227], v[48:51]
    v_mfma_f32_16x16x32_bf16 v[56:59], v[68:71], v[224:227], v[56:59]
    v_mfma_f32_16x16x32_bf16 v[52:55], v[64:67], v[228:231], v[52:55]
    v_mfma_f32_16x16x32_bf16 v[60:63], v[68:71], v[228:231], v[60:63]
    ds_read_b128 v[64:67], v80 offset:14336
    ds_read_b128 v[68:71], v81 offset:14336
    s_waitcnt lgkmcnt(2)
    v_mfma_f32_16x16x32_bf16 v[32:35], a[232:235], v[72:75], v[32:35]
    v_mfma_f32_16x16x32_bf16 v[36:39], a[232:235], v[76:79], v[36:39]
    v_mfma_f32_16x16x32_bf16 v[40:43], a[236:239], v[72:75], v[40:43]
    v_mfma_f32_16x16x32_bf16 v[44:47], a[236:239], v[76:79], v[44:47]
    v_mfma_f32_16x16x32_bf16 v[48:51], v[72:75], v[232:235], v[48:51]
    v_mfma_f32_16x16x32_bf16 v[56:59], v[76:79], v[232:235], v[56:59]
    v_mfma_f32_16x16x32_bf16 v[52:55], v[72:75], v[236:239], v[52:55]
    v_mfma_f32_16x16x32_bf16 v[60:63], v[76:79], v[236:239], v[60:63]
    ds_read_b128 v[72:75], v82 offset:15360
    ds_read_b128 v[76:79], v83 offset:15360
    s_waitcnt lgkmcnt(2)
    v_mfma_f32_16x16x32_bf16 v[32:35], a[240:243], v[64:67], v[32:35]
    v_mfma_f32_16x16x32_bf16 v[36:39], a[240:243], v[68:71], v[36:39]
    v_mfma_f32_16x16x32_bf16 v[40:43], a[244:247], v[64:67], v[40:43]
    v_mfma_f32_16x16x32_bf16 v[44:47], a[244:247], v[68:71], v[44:47]
    v_mfma_f32_16x16x32_bf16 v[48:51], v[64:67], v[240:243], v[48:51]
    v_mfma_f32_16x16x32_bf16 v[56:59], v[68:71], v[240:243], v[56:59]
    v_mfma_f32_16x16x32_bf16 v[52:55], v[64:67], v[244:247], v[52:55]
    v_mfma_f32_16x16x32_bf16 v[60:63], v[68:71], v[244:247], v[60:63]
    s_waitcnt lgkmcnt(0)
    v_mfma_f32_16x16x32_bf16 v[32:35], a[248:251], v[72:75], v[32:35]
    v_mfma_f32_16x16x32_bf16 v[36:39], a[248:251], v[76:79], v[36:39]
    v_mfma_f32_16x16x32_bf16 v[40:43], a[252:255], v[72:75], v[40:43]
    v_mfma_f32_16x16x32_bf16 v[44:47], a[252:255], v[76:79], v[44:47]
    v_mfma_f32_16x16x32_bf16 v[48:51], v[72:75], v[248:251], v[48:51]
    v_mfma_f32_16x16x32_bf16 v[56:59], v[76:79], v[248:251], v[56:59]
    v_mfma_f32_16x16x32_bf16 v[52:55], v[72:75], v[252:255], v[52:55]
    v_mfma_f32_16x16x32_bf16 v[60:63], v[76:79], v[252:255], v[60:63]
    s_nop 2
    v_cvt_pk_bf16_f32 v88, v32, v40
    v_cvt_pk_bf16_f32 v89, v33, v41
    v_cvt_pk_bf16_f32 v90, v34, v42
    v_cvt_pk_bf16_f32 v91, v35, v43
    v_cvt_pk_bf16_f32 v92, v36, v44
    v_cvt_pk_bf16_f32 v93, v37, v45
    v_cvt_pk_bf16_f32 v94, v38, v46
    v_cvt_pk_bf16_f32 v95, v39, v47
    v_cvt_pk_bf16_f32 v96, v48, v49
    v_cvt_pk_bf16_f32 v97, v50, v51
    v_cvt_pk_bf16_f32 v98, v56, v57
    v_cvt_pk_bf16_f32 v99, v58, v59
    v_cvt_pk_bf16_f32 v100, v52, v53
    v_cvt_pk_bf16_f32 v101, v54, v55
    v_cvt_pk_bf16_f32 v102, v60, v61
    v_cvt_pk_bf16_f32 v103, v62, v63
    s_mul_i32 s24, s23, 0x82100
    s_lshl_b32 s36, s20, 14
    s_add_u32 s24, s24, s36
    s_add_u32 s24, s24, 0x1000000
    s_mov_b32 s30, s24
    s_lshr_b32 s36, s21, 1
    s_lshl_b32 s36, s36, 12
    s_xor_b32 s37, s36, 4096
    s_add_u32 s36, s36, s24
    s_add_u32 s37, s37, s24
    buffer_store_dwordx4 v[88:91], v9, s[8:11], s36 offen sc1
    buffer_store_dwordx4 v[92:95], v9, s[8:11], s37 offen sc1
    s_add_u32 s24, s24, 8192
    buffer_store_dwordx4 v[96:99], v2, s[8:11], s24 offen sc1
    buffer_store_dwordx4 v[100:103], v2, s[8:11], s24 offen offset:1024 sc1
    s_mul_i32 s25, s23, 0x82100
    s_lshl_b32 s36, s20, 2
    s_add_u32 s25, s25, s36
    s_add_u32 s25, s25, 0x1082000
    v_lshrrev_b32 v15, 2, v1
    v_and_b32 v15, 127, v15
L_WHS:
    buffer_load_dword v14, v15, s[16:19], 0 offen sc1
    s_add_u32 s32, s32, 1
    s_cmp_gt_u32 s32, 200000
    s_cbranch_scc1 L_WHS_done
    s_waitcnt vmcnt(0)
    v_cmp_eq_u32 vcc, 0, v14
    s_cbranch_vccnz L_WHS
L_WHS_done:
    s_waitcnt vmcnt(0)
    s_barrier
    v_cmp_ne_u32 vcc, 0, v0
    v_mov_b32 v15, 0x40000000
    v_mov_b32 v14, 1
    v_cndmask_b32 v15, v0, v15, vcc
    buffer_store_dword v14, v15, s[8:11], s25 offen sc1
    s_barrier
    ds_read_b64_tr_b16 a[0:1], v20 offset:0
    ds_read_b64_tr_b16 a[2:3], v20 offset:1024
    ds_read_b64_tr_b16 a[4:5], v21 offset:0
    ds_read_b64_tr_b16 a[6:7], v21 offset:1024
    ds_read_b64_tr_b16 a[8:9], v22 offset:0
    ds_read_b64_tr_b16 a[10:11], v22 offset:1024
    ds_read_b64_tr_b16 a[12:13], v23 offset:0
    ds_read_b64_tr_b16 a[14:15], v23 offset:1024
    ds_read_b64_tr_b16 a[16:17], v24 offset:0
    ds_read_b64_tr_b16 a[18:19], v24 offset:1024
    ds_read_b64_tr_b16 a[20:21], v25 offset:0
    ds_read_b64_tr_b16 a[22:23], v25 offset:1024
    s_waitcnt lgkmcnt(4)
    ds_read_b64_tr_b16 a[24:25], v26 offset:0
    ds_read_b64_tr_b16 a[26:27], v26 offset:1024
    ds_read_b64_tr_b16 a[28:29], v27 offset:0
    ds_read_b64_tr_b16 a[30:31], v27 offset:1024
    s_waitcnt lgkmcnt(0)
    s_barrier
    s_barrier
    ds_read_b64_tr_b16 a[32:33], v20 offset:8192
    ds_read_b64_tr_b16 a[34:35], v20 offset:9216
    ds_read_b64_tr_b16 a[36:37], v21 offset:8192
    ds_read_b64_tr_b16 a[38:39], v21 offset:9216
    ds_read_b64_tr_b16 a[40:41], v22 offset:8192
    ds_read_b64_tr_b16 a[42:43], v22 offset:9216
    ds_read_b64_tr_b16 a[44:45], v23 offset:8192
    ds_read_b64_tr_b16 a[46:47], v23 offset:9216
    ds_read_b64_tr_b16 a[48:49], v24 offset:8192
    ds_read_b64_tr_b16 a[50:51], v24 offset:9216
    ds_read_b64_tr_b16 a[52:53], v25 offset:8192
    ds_read_b64_tr_b16 a[54:55], v25 offset:9216
    s_waitcnt lgkmcnt(4)
    ds_read_b64_tr_b16 a[56:57], v26 offset:8192
    ds_read_b64_tr_b16 a[58:59], v26 offset:9216
    ds_read_b64_tr_b16 a[60:61], v27 offset:8192
    ds_read_b64_tr_b16 a[62:63], v27 offset:9216
    s_waitcnt lgkmcnt(0)
    s_barrier
    s_barrier
    ds_read_b64_tr_b16 a[64:65], v20 offset:16384
    ds_read_b64_tr_b16 a[66:67], v20 offset:17408
    ds_read_b64_tr_b16 a[68:69], v21 offset:16384
    ds_read_b64_tr_b16 a[70:71], v21 offset:17408
    ds_read_b64_tr_b16 a[72:73], v22 offset:16384
    ds_read_b64_tr_b16 a[74:75], v22 offset:17408
    ds_read_b64_tr_b16 a[76:77], v23 offset:16384
    ds_read_b64_tr_b16 a[78:79], v23 offset:17408
    ds_read_b64_tr_b16 a[80:81], v24 offset:16384
    ds_read_b64_tr_b16 a[82:83], v24 offset:17408
    ds_read_b64_tr_b16 a[84:85], v25 offset:16384
    ds_read_b64_tr_b16 a[86:87], v25 offset:17408
    s_waitcnt lgkmcnt(4)
    ds_read_b64_tr_b16 a[88:89], v26 offset:16384
    ds_read_b64_tr_b16 a[90:91], v26 offset:17408
    ds_read_b64_tr_b16 a[92:93], v27 offset:16384
    ds_read_b64_tr_b16 a[94:95], v27 offset:17408
    s_waitcnt lgkmcnt(0)
    s_barrier
    s_barrier
    ds_read_b64_tr_b16 a[96:97], v20 offset:24576
    ds_read_b64_tr_b16 a[98:99], v20 offset:25600
    ds_read_b64_tr_b16 a[100:101], v21 offset:24576
    ds_read_b64_tr_b16 a[102:103], v21 offset:25600
    ds_read_b64_tr_b16 a[104:105], v22 offset:24576
    ds_read_b64_tr_b16 a[106:107], v22 offset:25600
    ds_read_b64_tr_b16 a[108:109], v23 offset:24576
    ds_read_b64_tr_b16 a[110:111], v23 offset:25600
    ds_read_b64_tr_b16 a[112:113], v24 offset:24576
    ds_read_b64_tr_b16 a[114:115], v24 offset:25600
    ds_read_b64_tr_b16 a[116:117], v25 offset:24576
    ds_read_b64_tr_b16 a[118:119], v25 offset:25600
    s_waitcnt lgkmcnt(4)
    ds_read_b64_tr_b16 a[120:121], v26 offset:24576
    ds_read_b64_tr_b16 a[122:123], v26 offset:25600
    ds_read_b64_tr_b16 a[124:125], v27 offset:24576
    ds_read_b64_tr_b16 a[126:127], v27 offset:25600
    s_waitcnt lgkmcnt(0)
    s_barrier
L_P1:
    s_waitcnt vmcnt(6)
    s_barrier
    s_xor_b32 s31, s31, 32768
    s_add_u32 s24, s23, 6
    s_min_u32 s24, s24, 63
    s_lshl_b32 s36, s24, 15
    s_add_u32 s36, s36, 0x800000
    s_lshl_b32 s37, s21, 10
    s_add_u32 s37, s37, s31
    s_add_u32 m0, s37, 0
    s_add_u32 s38, s36, 0
    buffer_load_dwordx4 v9, s[8:11], s38 offen sc1 lds
    s_add_u32 m0, s37, 4096
    s_add_u32 s38, s36, 4096
    buffer_load_dwordx4 v9, s[8:11], s38 offen sc1 lds
    s_add_u32 m0, s37, 8192
    s_add_u32 s38, s36, 8192
    buffer_load_dwordx4 v9, s[8:11], s38 offen sc1 lds
    s_add_u32 m0, s37, 12288
    s_add_u32 s38, s36, 12288
    buffer_load_dwordx4 v9, s[8:11], s38 offen sc1 lds
    s_add_u32 m0, s37, 16384
    s_add_u32 s38, s36, 16384
    buffer_load_dwordx4 v9, s[8:11], s38 offen sc1 lds
    s_add_u32 m0, s37, 20480
    s_add_u32 s38, s36, 20480
    buffer_load_dwordx4 v9, s[8:11], s38 offen sc1 lds
    s_add_u32 m0, s37, 24576
    s_add_u32 s38, s36, 24576
    buffer_load_dwordx4 v9, s[8:11], s38 offen sc1 lds
    s_add_u32 m0, s37, 28672
    s_add_u32 s38, s36, 28672
    buffer_load_dwordx4 v9, s[8:11], s38 offen sc1 lds
    ds_read_b128 v[64:67], v80 offset:0
    ds_read_b128 v[68:71], v81 offset:0
    ds_read_b128 v[72:75], v82 offset:1024
    ds_read_b128 v[76:79], v83 offset:1024
    s_waitcnt lgkmcnt(2)
    v_mfma_f32_16x16x32_bf16 v[32:35], a[128:131], v[64:67], 0
    v_mfma_f32_16x16x32_bf16 v[36:39], a[128:131], v[68:71], 0
    v_mfma_f32_16x16x32_bf16 v[40:43], a[132:135], v[64:67], 0
    v_mfma_f32_16x16x32_bf16 v[44:47], a[132:135], v[68:71], 0
    v_mfma_f32_16x16x32_bf16 v[48:51], v[64:67], v[128:131], 0
    v_mfma_f32_16x16x32_bf16 v[56:59], v[68:71], v[128:131], 0
    v_mfma_f32_16x16x32_bf16 v[52:55], v[64:67], v[132:135], 0
    v_mfma_f32_16x16x32_bf16 v[60:63], v[68:71], v[132:135], 0
    v_mfma_f32_16x16x32_bf16 v[16:19], a[0:3], v[64:67], 0
    v_mfma_f32_16x16x32_bf16 v[20:23], a[0:3], v[68:71], 0
    v_mfma_f32_16x16x32_bf16 v[24:27], a[4:7], v[64:67], 0
    v_mfma_f32_16x16x32_bf16 v[28:31], a[4:7], v[68:71], 0
    ds_read_b128 v[64:67], v80 offset:2048
    ds_read_b128 v[68:71], v81 offset:2048
    s_waitcnt lgkmcnt(2)
    v_mfma_f32_16x16x32_bf16 v[32:35], a[136:139], v[72:75], v[32:35]
    v_mfma_f32_16x16x32_bf16 v[36:39], a[136:139], v[76:79], v[36:39]
    v_mfma_f32_16x16x32_bf16 v[40:43], a[140:143], v[72:75], v[40:43]
    v_mfma_f32_16x16x32_bf16 v[44:47], a[140:143], v[76:79], v[44:47]
    v_mfma_f32_16x16x32_bf16 v[48:51], v[72:75], v[136:139], v[48:51]
    v_mfma_f32_16x16x32_bf16 v[56:59], v[76:79], v[136:139], v[56:59]
    v_mfma_f32_16x16x32_bf16 v[52:55], v[72:75], v[140:143], v[52:55]
    v_mfma_f32_16x16x32_bf16 v[60:63], v[76:79], v[140:143], v[60:63]
    v_mfma_f32_16x16x32_bf16 v[16:19], a[8:11], v[72:75], v[16:19]
    v_mfma_f32_16x16x32_bf16 v[20:23], a[8:11], v[76:79], v[20:23]
    v_mfma_f32_16x16x32_bf16 v[24:27], a[12:15], v[72:75], v[24:27]
    v_mfma_f32_16x16x32_bf16 v[28:31], a[12:15], v[76:79], v[28:31]
    ds_read_b128 v[72:75], v82 offset:3072
    ds_read_b128 v[76:79], v83 offset:3072
    s_waitcnt lgkmcnt(2)
    v_mfma_f32_16x16x32_bf16 v[32:35], a[144:147], v[64:67], v[32:35]
    v_mfma_f32_16x16x32_bf16 v[36:39], a[144:147], v[68:71], v[36:39]
    v_mfma_f32_16x16x32_bf16 v[40:43], a[148:151], v[64:67], v[40:43]
    v_mfma_f32_16x16x32_bf16 v[44:47], a[148:151], v[68:71], v[44:47]
    v_mfma_f32_16x16x32_bf16 v[48:51], v[64:67], v[144:147], v[48:51]
    v_mfma_f32_16x16x32_bf16 v[56:59], v[68:71], v[144:147], v[56:59]
    v_mfma_f32_16x16x32_bf16 v[52:55], v[64:67], v[148:151], v[52:55]
    v_mfma_f32_16x16x32_bf16 v[60:63], v[68:71], v[148:151], v[60:63]
    v_mfma_f32_16x16x32_bf16 v[16:19], a[16:19], v[64:67], v[16:19]
    v_mfma_f32_16x16x32_bf16 v[20:23], a[16:19], v[68:71], v[20:23]
    v_mfma_f32_16x16x32_bf16 v[24:27], a[20:23], v[64:67], v[24:27]
    v_mfma_f32_16x16x32_bf16 v[28:31], a[20:23], v[68:71], v[28:31]
    ds_read_b128 v[64:67], v80 offset:4096
    ds_read_b128 v[68:71], v81 offset:4096
    s_waitcnt lgkmcnt(2)
    v_mfma_f32_16x16x32_bf16 v[32:35], a[152:155], v[72:75], v[32:35]
    v_mfma_f32_16x16x32_bf16 v[36:39], a[152:155], v[76:79], v[36:39]
    v_mfma_f32_16x16x32_bf16 v[40:43], a[156:159], v[72:75], v[40:43]
    v_mfma_f32_16x16x32_bf16 v[44:47], a[156:159], v[76:79], v[44:47]
    v_mfma_f32_16x16x32_bf16 v[48:51], v[72:75], v[152:155], v[48:51]
    v_mfma_f32_16x16x32_bf16 v[56:59], v[76:79], v[152:155], v[56:59]
    v_mfma_f32_16x16x32_bf16 v[52:55], v[72:75], v[156:159], v[52:55]
    v_mfma_f32_16x16x32_bf16 v[60:63], v[76:79], v[156:159], v[60:63]
    v_mfma_f32_16x16x32_bf16 v[16:19], a[24:27], v[72:75], v[16:19]
    v_mfma_f32_16x16x32_bf16 v[20:23], a[24:27], v[76:79], v[20:23]
    v_mfma_f32_16x16x32_bf16 v[24:27], a[28:31], v[72:75], v[24:27]
    v_mfma_f32_16x16x32_bf16 v[28:31], a[28:31], v[76:79], v[28:31]
    ds_read_b128 v[72:75], v82 offset:5120
    ds_read_b128 v[76:79], v83 offset:5120
    s_waitcnt lgkmcnt(2)
    v_mfma_f32_16x16x32_bf16 v[32:35], a[160:163], v[64:67], v[32:35]
    v_mfma_f32_16x16x32_bf16 v[36:39], a[160:163], v[68:71], v[36:39]
    v_mfma_f32_16x16x32_bf16 v[40:43], a[164:167], v[64:67], v[40:43]
    v_mfma_f32_16x16x32_bf16 v[44:47], a[164:167], v[68:71], v[44:47]
    v_mfma_f32_16x16x32_bf16 v[48:51], v[64:67], v[160:163], v[48:51]
    v_mfma_f32_16x16x32_bf16 v[56:59], v[68:71], v[160:163], v[56:59]
    v_mfma_f32_16x16x32_bf16 v[52:55], v[64:67], v[164:167], v[52:55]
    v_mfma_f32_16x16x32_bf16 v[60:63], v[68:71], v[164:167], v[60:63]
    v_mfma_f32_16x16x32_bf16 v[16:19], a[32:35], v[64:67], v[16:19]
    v_mfma_f32_16x16x32_bf16 v[20:23], a[32:35], v[68:71], v[20:23]
    v_mfma_f32_16x16x32_bf16 v[24:27], a[36:39], v[64:67], v[24:27]
    v_mfma_f32_16x16x32_bf16 v[28:31], a[36:39], v[68:71], v[28:31]
    ds_read_b128 v[64:67], v80 offset:6144
    ds_read_b128 v[68:71], v81 offset:6144
    s_waitcnt lgkmcnt(2)
    v_mfma_f32_16x16x32_bf16 v[32:35], a[168:171], v[72:75], v[32:35]
    v_mfma_f32_16x16x32_bf16 v[36:39], a[168:171], v[76:79], v[36:39]
    v_mfma_f32_16x16x32_bf16 v[40:43], a[172:175], v[72:75], v[40:43]
    v_mfma_f32_16x16x32_bf16 v[44:47], a[172:175], v[76:79], v[44:47]
    v_mfma_f32_16x16x32_bf16 v[48:51], v[72:75], v[168:171], v[48:51]
    v_mfma_f32_16x16x32_bf16 v[56:59], v[76:79], v[168:171], v[56:59]
    v_mfma_f32_16x16x32_bf16 v[52:55], v[72:75], v[172:175], v[52:55]
    v_mfma_f32_16x16x32_bf16 v[60:63], v[76:79], v[172:175], v[60:63]
    v_mfma_f32_16x16x32_bf16 v[16:19], a[40:43], v[72:75], v[16:19]
    v_mfma_f32_16x16x32_bf16 v[20:23], a[40:43], v[76:79], v[20:23]
    v_mfma_f32_16x16x32_bf16 v[24:27], a[44:47], v[72:75], v[24:27]
    v_mfma_f32_16x16x32_bf16 v[28:31], a[44:47], v[76:79], v[28:31]
    ds_read_b128 v[72:75], v82 offset:7168
    ds_read_b128 v[76:79], v83 offset:7168
    s_waitcnt lgkmcnt(2)
    s_waitcnt vmcnt(8)
    s_barrier
    v_cmp_ne_u32 vcc, 0, v0
    v_mov_b32 v15, 0x40000000
    v_mov_b32 v14, 1
    v_cndmask_b32 v15, v0, v15, vcc
    buffer_store_dword v14, v15, s[8:11], s25 offen sc1
    v_mfma_f32_16x16x32_bf16 v[32:35], a[176:179], v[64:67], v[32:35]
    v_mfma_f32_16x16x32_bf16 v[36:39], a[176:179], v[68:71], v[36:39]
    v_mfma_f32_16x16x32_bf16 v[40:43], a[180:183], v[64:67], v[40:43]
    v_mfma_f32_16x16x32_bf16 v[44:47], a[180:183], v[68:71], v[44:47]
    v_mfma_f32_16x16x32_bf16 v[48:51], v[64:67], v[176:179], v[48:51]
    v_mfma_f32_16x16x32_bf16 v[56:59], v[68:71], v[176:179], v[56:59]
    v_mfma_f32_16x16x32_bf16 v[52:55], v[64:67], v[180:183], v[52:55]
    v_mfma_f32_16x16x32_bf16 v[60:63], v[68:71], v[180:183], v[60:63]
    v_mfma_f32_16x16x32_bf16 v[16:19], a[48:51], v[64:67], v[16:19]
    v_mfma_f32_16x16x32_bf16 v[20:23], a[48:51], v[68:71], v[20:23]
    v_mfma_f32_16x16x32_bf16 v[24:27], a[52:55], v[64:67], v[24:27]
    v_mfma_f32_16x16x32_bf16 v[28:31], a[52:55], v[68:71], v[28:31]
    ds_read_b128 v[64:67], v80 offset:8192
    ds_read_b128 v[68:71], v81 offset:8192
    s_waitcnt lgkmcnt(2)
    v_mfma_f32_16x16x32_bf16 v[32:35], a[184:187], v[72:75], v[32:35]
    v_mfma_f32_16x16x32_bf16 v[36:39], a[184:187], v[76:79], v[36:39]
    v_mfma_f32_16x16x32_bf16 v[40:43], a[188:191], v[72:75], v[40:43]
    v_mfma_f32_16x16x32_bf16 v[44:47], a[188:191], v[76:79], v[44:47]
    v_mfma_f32_16x16x32_bf16 v[48:51], v[72:75], v[184:187], v[48:51]
    v_mfma_f32_16x16x32_bf16 v[56:59], v[76:79], v[184:187], v[56:59]
    v_mfma_f32_16x16x32_bf16 v[52:55], v[72:75], v[188:191], v[52:55]
    v_mfma_f32_16x16x32_bf16 v[60:63], v[76:79], v[188:191], v[60:63]
    v_mfma_f32_16x16x32_bf16 v[16:19], a[56:59], v[72:75], v[16:19]
    v_mfma_f32_16x16x32_bf16 v[20:23], a[56:59], v[76:79], v[20:23]
    v_mfma_f32_16x16x32_bf16 v[24:27], a[60:63], v[72:75], v[24:27]
    v_mfma_f32_16x16x32_bf16 v[28:31], a[60:63], v[76:79], v[28:31]
    ds_read_b128 v[72:75], v82 offset:9216
    ds_read_b128 v[76:79], v83 offset:9216
    s_waitcnt lgkmcnt(2)
    v_mfma_f32_16x16x32_bf16 v[32:35], a[192:195], v[64:67], v[32:35]
    v_mfma_f32_16x16x32_bf16 v[36:39], a[192:195], v[68:71], v[36:39]
    v_mfma_f32_16x16x32_bf16 v[40:43], a[196:199], v[64:67], v[40:43]
    v_mfma_f32_16x16x32_bf16 v[44:47], a[196:199], v[68:71], v[44:47]
    v_mfma_f32_16x16x32_bf16 v[48:51], v[64:67], v[192:195], v[48:51]
    v_mfma_f32_16x16x32_bf16 v[56:59], v[68:71], v[192:195], v[56:59]
    v_mfma_f32_16x16x32_bf16 v[52:55], v[64:67], v[196:199], v[52:55]
    v_mfma_f32_16x16x32_bf16 v[60:63], v[68:71], v[196:199], v[60:63]
    v_mfma_f32_16x16x32_bf16 v[16:19], a[64:67], v[64:67], v[16:19]
    v_mfma_f32_16x16x32_bf16 v[20:23], a[64:67], v[68:71], v[20:23]
    v_mfma_f32_16x16x32_bf16 v[24:27], a[68:71], v[64:67], v[24:27]
    v_mfma_f32_16x16x32_bf16 v[28:31], a[68:71], v[68:71], v[28:31]
    ds_read_b128 v[64:67], v80 offset:10240
    ds_read_b128 v[68:71], v81 offset:10240
    s_waitcnt lgkmcnt(2)
    v_mfma_f32_16x16x32_bf16 v[32:35], a[200:203], v[72:75], v[32:35]
    v_mfma_f32_16x16x32_bf16 v[36:39], a[200:203], v[76:79], v[36:39]
    v_mfma_f32_16x16x32_bf16 v[40:43], a[204:207], v[72:75], v[40:43]
    v_mfma_f32_16x16x32_bf16 v[44:47], a[204:207], v[76:79], v[44:47]
    v_mfma_f32_16x16x32_bf16 v[48:51], v[72:75], v[200:203], v[48:51]
    v_mfma_f32_16x16x32_bf16 v[56:59], v[76:79], v[200:203], v[56:59]
    v_mfma_f32_16x16x32_bf16 v[52:55], v[72:75], v[204:207], v[52:55]
    v_mfma_f32_16x16x32_bf16 v[60:63], v[76:79], v[204:207], v[60:63]
    v_mfma_f32_16x16x32_bf16 v[16:19], a[72:75], v[72:75], v[16:19]
    v_mfma_f32_16x16x32_bf16 v[20:23], a[72:75], v[76:79], v[20:23]
    v_mfma_f32_16x16x32_bf16 v[24:27], a[76:79], v[72:75], v[24:27]
    v_mfma_f32_16x16x32_bf16 v[28:31], a[76:79], v[76:79], v[28:31]
    ds_read_b128 v[72:75], v82 offset:11264
    ds_read_b128 v[76:79], v83 offset:11264
    s_waitcnt lgkmcnt(2)
    v_mfma_f32_16x16x32_bf16 v[32:35], a[208:211], v[64:67], v[32:35]
    v_mfma_f32_16x16x32_bf16 v[36:39], a[208:211], v[68:71], v[36:39]
    v_mfma_f32_16x16x32_bf16 v[40:43], a[212:215], v[64:67], v[40:43]
    v_mfma_f32_16x16x32_bf16 v[44:47], a[212:215], v[68:71], v[44:47]
    v_mfma_f32_16x16x32_bf16 v[48:51], v[64:67], v[208:211], v[48:51]
    v_mfma_f32_16x16x32_bf16 v[56:59], v[68:71], v[208:211], v[56:59]
    v_mfma_f32_16x16x32_bf16 v[52:55], v[64:67], v[212:215], v[52:55]
    v_mfma_f32_16x16x32_bf16 v[60:63], v[68:71], v[212:215], v[60:63]
    v_mfma_f32_16x16x32_bf16 v[16:19], a[80:83], v[64:67], v[16:19]
    v_mfma_f32_16x16x32_bf16 v[20:23], a[80:83], v[68:71], v[20:23]
    v_mfma_f32_16x16x32_bf16 v[24:27], a[84:87], v[64:67], v[24:27]
    v_mfma_f32_16x16x32_bf16 v[28:31], a[84:87], v[68:71], v[28:31]
    ds_read_b128 v[64:67], v80 offset:12288
    ds_read_b128 v[68:71], v81 offset:12288
    s_waitcnt lgkmcnt(2)
    v_mfma_f32_16x16x32_bf16 v[32:35], a[216:219], v[72:75], v[32:35]
    v_mfma_f32_16x16x32_bf16 v[36:39], a[216:219], v[76:79], v[36:39]
    v_mfma_f32_16x16x32_bf16 v[40:43], a[220:223], v[72:75], v[40:43]
    v_mfma_f32_16x16x32_bf16 v[44:47], a[220:223], v[76:79], v[44:47]
    v_mfma_f32_16x16x32_bf16 v[48:51], v[72:75], v[216:219], v[48:51]
    v_mfma_f32_16x16x32_bf16 v[56:59], v[76:79], v[216:219], v[56:59]
    v_mfma_f32_16x16x32_bf16 v[52:55], v[72:75], v[220:223], v[52:55]
    v_mfma_f32_16x16x32_bf16 v[60:63], v[76:79], v[220:223], v[60:63]
    v_mfma_f32_16x16x32_bf16 v[16:19], a[88:91], v[72:75], v[16:19]
    v_mfma_f32_16x16x32_bf16 v[20:23], a[88:91], v[76:79], v[20:23]
    v_mfma_f32_16x16x32_bf16 v[24:27], a[92:95], v[72:75], v[24:27]
    v_mfma_f32_16x16x32_bf16 v[28:31], a[92:95], v[76:79], v[28:31]
    ds_read_b128 v[72:75], v82 offset:13312
    ds_read_b128 v[76:79], v83 offset:13312
    s_waitcnt lgkmcnt(2)
    v_mfma_f32_16x16x32_bf16 v[32:35], a[224:227], v[64:67], v[32:35]
    v_mfma_f32_16x16x32_bf16 v[36:39], a[224:227], v[68:71], v[36:39]
    v_mfma_f32_16x16x32_bf16 v[40:43], a[228:231], v[64:67], v[40:43]
    v_mfma_f32_16x16x32_bf16 v[44:47], a[228:231], v[68:71], v[44:47]
    v_mfma_f32_16x16x32_bf16 v[48:51], v[64:67], v[224:227], v[48:51]
    v_mfma_f32_16x16x32_bf16 v[56:59], v[68:71], v[224:227], v[56:59]
    v_mfma_f32_16x16x32_bf16 v[52:55], v[64:67], v[228:231], v[52:55]
    v_mfma_f32_16x16x32_bf16 v[60:63], v[68:71], v[228:231], v[60:63]
    v_mfma_f32_16x16x32_bf16 v[16:19], a[96:99], v[64:67], v[16:19]
    v_mfma_f32_16x16x32_bf16 v[20:23], a[96:99], v[68:71], v[20:23]
    v_mfma_f32_16x16x32_bf16 v[24:27], a[100:103], v[64:67], v[24:27]
    v_mfma_f32_16x16x32_bf16 v[28:31], a[100:103], v[68:71], v[28:31]
    ds_read_b128 v[64:67], v80 offset:14336
    ds_read_b128 v[68:71], v81 offset:14336
    s_waitcnt lgkmcnt(2)
    v_mfma_f32_16x16x32_bf16 v[32:35], a[232:235], v[72:75], v[32:35]
    v_mfma_f32_16x16x32_bf16 v[36:39], a[232:235], v[76:79], v[36:39]
    v_mfma_f32_16x16x32_bf16 v[40:43], a[236:239], v[72:75], v[40:43]
    v_mfma_f32_16x16x32_bf16 v[44:47], a[236:239], v[76:79], v[44:47]
    v_mfma_f32_16x16x32_bf16 v[48:51], v[72:75], v[232:235], v[48:51]
    v_mfma_f32_16x16x32_bf16 v[56:59], v[76:79], v[232:235], v[56:59]
    v_mfma_f32_16x16x32_bf16 v[52:55], v[72:75], v[236:239], v[52:55]
    v_mfma_f32_16x16x32_bf16 v[60:63], v[76:79], v[236:239], v[60:63]
    v_mfma_f32_16x16x32_bf16 v[16:19], a[104:107], v[72:75], v[16:19]
    v_mfma_f32_16x16x32_bf16 v[20:23], a[104:107], v[76:79], v[20:23]
    v_mfma_f32_16x16x32_bf16 v[24:27], a[108:111], v[72:75], v[24:27]
    v_mfma_f32_16x16x32_bf16 v[28:31], a[108:111], v[76:79], v[28:31]
    ds_read_b128 v[72:75], v82 offset:15360
    ds_read_b128 v[76:79], v83 offset:15360
    s_waitcnt lgkmcnt(2)
    v_mfma_f32_16x16x32_bf16 v[32:35], a[240:243], v[64:67], v[32:35]
    v_mfma_f32_16x16x32_bf16 v[36:39], a[240:243], v[68:71], v[36:39]
    v_mfma_f32_16x16x32_bf16 v[40:43], a[244:247], v[64:67], v[40:43]
    v_mfma_f32_16x16x32_bf16 v[44:47], a[244:247], v[68:71], v[44:47]
    v_mfma_f32_16x16x32_bf16 v[48:51], v[64:67], v[240:243], v[48:51]
    v_mfma_f32_16x16x32_bf16 v[56:59], v[68:71], v[240:243], v[56:59]
    v_mfma_f32_16x16x32_bf16 v[52:55], v[64:67], v[244:247], v[52:55]
    v_mfma_f32_16x16x32_bf16 v[60:63], v[68:71], v[244:247], v[60:63]
    v_mfma_f32_16x16x32_bf16 v[16:19], a[112:115], v[64:67], v[16:19]
    v_mfma_f32_16x16x32_bf16 v[20:23], a[112:115], v[68:71], v[20:23]
    v_mfma_f32_16x16x32_bf16 v[24:27], a[116:119], v[64:67], v[24:27]
    v_mfma_f32_16x16x32_bf16 v[28:31], a[116:119], v[68:71], v[28:31]
    s_waitcnt lgkmcnt(0)
    v_mfma_f32_16x16x32_bf16 v[32:35], a[248:251], v[72:75], v[32:35]
    v_mfma_f32_16x16x32_bf16 v[36:39], a[248:251], v[76:79], v[36:39]
    v_mfma_f32_16x16x32_bf16 v[40:43], a[252:255], v[72:75], v[40:43]
    v_mfma_f32_16x16x32_bf16 v[44:47], a[252:255], v[76:79], v[44:47]
    v_mfma_f32_16x16x32_bf16 v[48:51], v[72:75], v[248:251], v[48:51]
    v_mfma_f32_16x16x32_bf16 v[56:59], v[76:79], v[248:251], v[56:59]
    v_mfma_f32_16x16x32_bf16 v[52:55], v[72:75], v[252:255], v[52:55]
    v_mfma_f32_16x16x32_bf16 v[60:63], v[76:79], v[252:255], v[60:63]
    v_mfma_f32_16x16x32_bf16 v[16:19], a[120:123], v[72:75], v[16:19]
    v_mfma_f32_16x16x32_bf16 v[20:23], a[120:123], v[76:79], v[20:23]
    v_mfma_f32_16x16x32_bf16 v[24:27], a[124:127], v[72:75], v[24:27]
    v_mfma_f32_16x16x32_bf16 v[28:31], a[124:127], v[76:79], v[28:31]
    v_xor_b32 v80, 0x8000, v80
    v_xor_b32 v81, 0x8000, v81
    v_xor_b32 v82, 0x8000, v82
    v_xor_b32 v83, 0x8000, v83
    v_cvt_pk_bf16_f32 v88, v32, v40
    v_cvt_pk_bf16_f32 v89, v33, v41
    v_cvt_pk_bf16_f32 v90, v34, v42
    v_cvt_pk_bf16_f32 v91, v35, v43
    v_cvt_pk_bf16_f32 v92, v36, v44
    v_cvt_pk_bf16_f32 v93, v37, v45
    v_cvt_pk_bf16_f32 v94, v38, v46
    v_cvt_pk_bf16_f32 v95, v39, v47
    v_cvt_pk_bf16_f32 v96, v48, v49
    v_cvt_pk_bf16_f32 v97, v50, v51
    v_cvt_pk_bf16_f32 v98, v56, v57
    v_cvt_pk_bf16_f32 v99, v58, v59
    v_cvt_pk_bf16_f32 v100, v52, v53
    v_cvt_pk_bf16_f32 v101, v54, v55
    v_cvt_pk_bf16_f32 v102, v60, v61
    v_cvt_pk_bf16_f32 v103, v62, v63
    v_cvt_pk_bf16_f32 v104, v16, v24
    v_cvt_pk_bf16_f32 v105, v17, v25
    v_cvt_pk_bf16_f32 v106, v18, v26
    v_cvt_pk_bf16_f32 v107, v19, v27
    v_cvt_pk_bf16_f32 v108, v20, v28
    v_cvt_pk_bf16_f32 v109, v21, v29
    v_cvt_pk_bf16_f32 v110, v22, v30
    v_cvt_pk_bf16_f32 v111, v23, v31
    s_mul_i32 s24, s23, 0x82100
    s_lshl_b32 s36, s20, 14
    s_add_u32 s24, s24, s36
    s_add_u32 s24, s24, 0x1000000
    s_mov_b32 s30, s24
    s_lshr_b32 s36, s21, 1
    s_lshl_b32 s36, s36, 12
    s_xor_b32 s37, s36, 4096
    s_add_u32 s36, s36, s24
    s_add_u32 s37, s37, s24
    buffer_store_dwordx4 v[88:91], v9, s[8:11], s36 offen sc1
    buffer_store_dwordx4 v[92:95], v9, s[8:11], s37 offen sc1
    s_add_u32 s24, s24, 8192
    buffer_store_dwordx4 v[96:99], v2, s[8:11], s24 offen sc1
    buffer_store_dwordx4 v[100:103], v2, s[8:11], s24 offen offset:1024 sc1
    s_add_u32 s36, s36, 0x7000000
    s_add_u32 s37, s37, 0x7000000
    buffer_store_dwordx4 v[104:107], v9, s[8:11], s36 offen sc1
    buffer_store_dwordx4 v[108:111], v9, s[8:11], s37 offen sc1
    s_mul_i32 s25, s23, 0x82100
    s_lshl_b32 s36, s20, 2
    s_add_u32 s25, s25, s36
    s_add_u32 s25, s25, 0x1082000
    s_add_u32 s23, s23, 6
    s_cmp_lt_u32 s23, 64
    s_cbranch_scc1 L_P1
    v_mov_b32 v20, -1
    v_mov_b32 v21, -1
    v_mov_b32 v22, -1
    v_mov_b32 v23, -1
    s_lshl_b32 s24, s22, 21
    s_lshl_b32 s36, s20, 15
    s_add_u32 s24, s24, s36
    s_add_u32 s36, s24, 0x4000000
    buffer_store_dwordx4 v[20:23], v11, s[8:11], s36 offen sc1
    s_add_u32 s36, s24, 0x4001000
    buffer_store_dwordx4 v[20:23], v11, s[8:11], s36 offen sc1
    s_add_u32 s36, s24, 0x4002000
    buffer_store_dwordx4 v[20:23], v11, s[8:11], s36 offen sc1
    s_add_u32 s36, s24, 0x4003000
    buffer_store_dwordx4 v[20:23], v11, s[8:11], s36 offen sc1
    s_add_u32 s36, s24, 0x4004000
    buffer_store_dwordx4 v[20:23], v11, s[8:11], s36 offen sc1
    s_add_u32 s36, s24, 0x4005000
    buffer_store_dwordx4 v[20:23], v11, s[8:11], s36 offen sc1
    s_add_u32 s36, s24, 0x4006000
    buffer_store_dwordx4 v[20:23], v11, s[8:11], s36 offen sc1
    s_add_u32 s36, s24, 0x4007000
    buffer_store_dwordx4 v[20:23], v11, s[8:11], s36 offen sc1
    s_add_u32 s36, s24, 0x4100000
    buffer_store_dwordx4 v[20:23], v11, s[8:11], s36 offen sc1
    s_add_u32 s36, s24, 0x4101000
    buffer_store_dwordx4 v[20:23], v11, s[8:11], s36 offen sc1
    s_add_u32 s36, s24, 0x4102000
    buffer_store_dwordx4 v[20:23], v11, s[8:11], s36 offen sc1
    s_add_u32 s36, s24, 0x4103000
    buffer_store_dwordx4 v[20:23], v11, s[8:11], s36 offen sc1
    s_add_u32 s36, s24, 0x4104000
    buffer_store_dwordx4 v[20:23], v11, s[8:11], s36 offen sc1
    s_add_u32 s36, s24, 0x4105000
    buffer_store_dwordx4 v[20:23], v11, s[8:11], s36 offen sc1
    s_add_u32 s36, s24, 0x4106000
    buffer_store_dwordx4 v[20:23], v11, s[8:11], s36 offen sc1
    s_add_u32 s36, s24, 0x4107000
    buffer_store_dwordx4 v[20:23], v11, s[8:11], s36 offen sc1
    s_waitcnt vmcnt(0)
    s_barrier
    v_cmp_ne_u32 vcc, 0, v0
    v_mov_b32 v15, 0x40000000
    v_mov_b32 v14, 1
    v_cndmask_b32 v15, v0, v15, vcc
    buffer_store_dword v14, v15, s[8:11], s25 offen sc1
    s_lshl_b32 s25, s22, 7
    s_lshl_b32 s36, s20, 2
    s_add_u32 s36, s36, s25
    s_add_u32 s36, s36, 0x192000
    v_cmp_ne_u32 vcc, 0, v0
    v_mov_b32 v15, 0x40000000
    v_mov_b32 v14, 1
    v_cndmask_b32 v15, v0, v15, vcc
    buffer_store_dword v14, v15, s[8:11], s36 offen sc1
    s_mov_b32 s96, s54
    s_and_b32 s97, s55, 0xffff
    s_mov_b32 s98, 0x400000
    s_mov_b32 s99, 0x20000
    v_mov_b32 v15, 0x0
    v_bfe_u32 v14, v0, 0, 1
    s_mov_b32 s38, 0x10
    v_mad_u32_u24 v15, v14, s38, v15
    v_bfe_u32 v14, v0, 1, 1
    s_mov_b32 s38, 0x20
    v_mad_u32_u24 v15, v14, s38, v15
    v_bfe_u32 v14, v0, 2, 1
    s_mov_b32 s38, 0x40
    v_mad_u32_u24 v15, v14, s38, v15
    v_bfe_u32 v14, v0, 3, 1
    s_mov_b32 s38, 0x80
    v_mad_u32_u24 v15, v14, s38, v15
    v_bfe_u32 v14, v0, 4, 1
    s_mov_b32 s38, 0x1000
    v_mad_u32_u24 v15, v14, s38, v15
    v_bfe_u32 v14, v0, 5, 1
    s_mov_b32 s38, 0x2000
    v_mad_u32_u24 v15, v14, s38, v15
    v_bfe_u32 v14, v0, 6, 1
    s_mov_b32 s38, 0x100
    v_mad_u32_u24 v15, v14, s38, v15
    v_bfe_u32 v14, v0, 7, 1
    s_mov_b32 s38, 0x200
    v_mad_u32_u24 v15, v14, s38, v15
    s_lshl_b32 s36, s20, 17
    s_add_u32 s37, s36, 0x0
    buffer_load_dwordx4 v[16:19], v15, s[96:99], s37 offen
    s_add_u32 s37, s36, 0x4000
    buffer_load_dwordx4 v[20:23], v15, s[96:99], s37 offen
    s_add_u32 s37, s36, 0x400
    buffer_load_dwordx4 v[24:27], v15, s[96:99], s37 offen
    s_add_u32 s37, s36, 0x4400
    buffer_load_dwordx4 v[28:31], v15, s[96:99], s37 offen
    s_add_u32 s37, s36, 0x800
    buffer_load_dwordx4 v[32:35], v15, s[96:99], s37 offen
    s_add_u32 s37, s36, 0x4800
    buffer_load_dwordx4 v[36:39], v15, s[96:99], s37 offen
    s_add_u32 s37, s36, 0xc00
    buffer_load_dwordx4 v[40:43], v15, s[96:99], s37 offen
    s_add_u32 s37, s36, 0x4c00
    buffer_load_dwordx4 v[44:47], v15, s[96:99], s37 offen
    s_add_u32 s37, s36, 0x8000
    buffer_load_dwordx4 v[48:51], v15, s[96:99], s37 offen
    s_add_u32 s37, s36, 0xc000
    buffer_load_dwordx4 v[52:55], v15, s[96:99], s37 offen
    s_add_u32 s37, s36, 0x8400
    buffer_load_dwordx4 v[56:59], v15, s[96:99], s37 offen
    s_add_u32 s37, s36, 0xc400
    buffer_load_dwordx4 v[60:63], v15, s[96:99], s37 offen
    s_add_u32 s37, s36, 0x8800
    buffer_load_dwordx4 v[64:67], v15, s[96:99], s37 offen
    s_add_u32 s37, s36, 0xc800
    buffer_load_dwordx4 v[68:71], v15, s[96:99], s37 offen
    s_add_u32 s37, s36, 0x8c00
    buffer_load_dwordx4 v[72:75], v15, s[96:99], s37 offen
    s_add_u32 s37, s36, 0xcc00
    buffer_load_dwordx4 v[76:79], v15, s[96:99], s37 offen
    s_add_u32 s37, s36, 0x10000
    buffer_load_dwordx4 v[80:83], v15, s[96:99], s37 offen
    s_add_u32 s37, s36, 0x14000
    buffer_load_dwordx4 v[84:87], v15, s[96:99], s37 offen
    s_add_u32 s37, s36, 0x10400
    buffer_load_dwordx4 v[88:91], v15, s[96:99], s37 offen
    s_add_u32 s37, s36, 0x14400
    buffer_load_dwordx4 v[92:95], v15, s[96:99], s37 offen
    s_add_u32 s37, s36, 0x10800
    buffer_load_dwordx4 v[96:99], v15, s[96:99], s37 offen
    s_add_u32 s37, s36, 0x14800
    buffer_load_dwordx4 v[100:103], v15, s[96:99], s37 offen
    s_add_u32 s37, s36, 0x10c00
    buffer_load_dwordx4 v[104:107], v15, s[96:99], s37 offen
    s_add_u32 s37, s36, 0x14c00
    buffer_load_dwordx4 v[108:111], v15, s[96:99], s37 offen
    s_waitcnt vmcnt(16)
    v_perm_b32 v112, v20, v16, s34
    v_perm_b32 v113, v28, v24, s34
    v_perm_b32 v114, v36, v32, s34
    v_perm_b32 v115, v44, v40, s34
    ds_write_b128 v7, v[112:115] offset:0
    v_perm_b32 v116, v20, v16, s35
    v_perm_b32 v117, v28, v24, s35
    v_perm_b32 v118, v36, v32, s35
    v_perm_b32 v119, v44, v40, s35
    ds_write_b128 v7, v[116:119] offset:1024
    v_perm_b32 v120, v21, v17, s34
    v_perm_b32 v121, v29, v25, s34
    v_perm_b32 v122, v37, v33, s34
    v_perm_b32 v123, v45, v41, s34
    ds_write_b128 v7, v[120:123] offset:2048
    v_perm_b32 v124, v21, v17, s35
    v_perm_b32 v125, v29, v25, s35
    v_perm_b32 v126, v37, v33, s35
    v_perm_b32 v127, v45, v41, s35
    ds_write_b128 v7, v[124:127] offset:3072
    s_waitcnt lgkmcnt(0)
    v_perm_b32 v112, v22, v18, s34
    v_perm_b32 v113, v30, v26, s34
    v_perm_b32 v114, v38, v34, s34
    v_perm_b32 v115, v46, v42, s34
    ds_write_b128 v7, v[112:115] offset:4096
    v_perm_b32 v116, v22, v18, s35
    v_perm_b32 v117, v30, v26, s35
    v_perm_b32 v118, v38, v34, s35
    v_perm_b32 v119, v46, v42, s35
    ds_write_b128 v7, v[116:119] offset:5120
    v_perm_b32 v120, v23, v19, s34
    v_perm_b32 v121, v31, v27, s34
    v_perm_b32 v122, v39, v35, s34
    v_perm_b32 v123, v47, v43, s34
    ds_write_b128 v7, v[120:123] offset:6144
    v_perm_b32 v124, v23, v19, s35
    v_perm_b32 v125, v31, v27, s35
    v_perm_b32 v126, v39, v35, s35
    v_perm_b32 v127, v47, v43, s35
    ds_write_b128 v7, v[124:127] offset:7168
    s_waitcnt lgkmcnt(0)
    s_add_u32 s37, s36, 0x18000
    buffer_load_dwordx4 v[16:19], v15, s[96:99], s37 offen
    s_add_u32 s37, s36, 0x1c000
    buffer_load_dwordx4 v[20:23], v15, s[96:99], s37 offen
    s_add_u32 s37, s36, 0x18400
    buffer_load_dwordx4 v[24:27], v15, s[96:99], s37 offen
    s_add_u32 s37, s36, 0x1c400
    buffer_load_dwordx4 v[28:31], v15, s[96:99], s37 offen
    s_add_u32 s37, s36, 0x18800
    buffer_load_dwordx4 v[32:35], v15, s[96:99], s37 offen
    s_add_u32 s37, s36, 0x1c800
    buffer_load_dwordx4 v[36:39], v15, s[96:99], s37 offen
    s_add_u32 s37, s36, 0x18c00
    buffer_load_dwordx4 v[40:43], v15, s[96:99], s37 offen
    s_add_u32 s37, s36, 0x1cc00
    buffer_load_dwordx4 v[44:47], v15, s[96:99], s37 offen
    s_waitcnt vmcnt(16)
    v_perm_b32 v112, v52, v48, s34
    v_perm_b32 v113, v60, v56, s34
    v_perm_b32 v114, v68, v64, s34
    v_perm_b32 v115, v76, v72, s34
    ds_write_b128 v7, v[112:115] offset:8192
    v_perm_b32 v116, v52, v48, s35
    v_perm_b32 v117, v60, v56, s35
    v_perm_b32 v118, v68, v64, s35
    v_perm_b32 v119, v76, v72, s35
    ds_write_b128 v7, v[116:119] offset:9216
    v_perm_b32 v120, v53, v49, s34
    v_perm_b32 v121, v61, v57, s34
    v_perm_b32 v122, v69, v65, s34
    v_perm_b32 v123, v77, v73, s34
    ds_write_b128 v7, v[120:123] offset:10240
    v_perm_b32 v124, v53, v49, s35
    v_perm_b32 v125, v61, v57, s35
    v_perm_b32 v126, v69, v65, s35
    v_perm_b32 v127, v77, v73, s35
    ds_write_b128 v7, v[124:127] offset:11264
    s_waitcnt lgkmcnt(0)
    v_perm_b32 v112, v54, v50, s34
    v_perm_b32 v113, v62, v58, s34
    v_perm_b32 v114, v70, v66, s34
    v_perm_b32 v115, v78, v74, s34
    ds_write_b128 v7, v[112:115] offset:12288
    v_perm_b32 v116, v54, v50, s35
    v_perm_b32 v117, v62, v58, s35
    v_perm_b32 v118, v70, v66, s35
    v_perm_b32 v119, v78, v74, s35
    ds_write_b128 v7, v[116:119] offset:13312
    v_perm_b32 v120, v55, v51, s34
    v_perm_b32 v121, v63, v59, s34
    v_perm_b32 v122, v71, v67, s34
    v_perm_b32 v123, v79, v75, s34
    ds_write_b128 v7, v[120:123] offset:14336
    v_perm_b32 v124, v55, v51, s35
    v_perm_b32 v125, v63, v59, s35
    v_perm_b32 v126, v71, v67, s35
    v_perm_b32 v127, v79, v75, s35
    ds_write_b128 v7, v[124:127] offset:15360
    s_waitcnt lgkmcnt(0)
    s_waitcnt vmcnt(8)
    v_perm_b32 v112, v84, v80, s34
    v_perm_b32 v113, v92, v88, s34
    v_perm_b32 v114, v100, v96, s34
    v_perm_b32 v115, v108, v104, s34
    ds_write_b128 v7, v[112:115] offset:16384
    v_perm_b32 v116, v84, v80, s35
    v_perm_b32 v117, v92, v88, s35
    v_perm_b32 v118, v100, v96, s35
    v_perm_b32 v119, v108, v104, s35
    ds_write_b128 v7, v[116:119] offset:17408
    v_perm_b32 v120, v85, v81, s34
    v_perm_b32 v121, v93, v89, s34
    v_perm_b32 v122, v101, v97, s34
    v_perm_b32 v123, v109, v105, s34
    ds_write_b128 v7, v[120:123] offset:18432
    v_perm_b32 v124, v85, v81, s35
    v_perm_b32 v125, v93, v89, s35
    v_perm_b32 v126, v101, v97, s35
    v_perm_b32 v127, v109, v105, s35
    ds_write_b128 v7, v[124:127] offset:19456
    s_waitcnt lgkmcnt(0)
    v_perm_b32 v112, v86, v82, s34
    v_perm_b32 v113, v94, v90, s34
    v_perm_b32 v114, v102, v98, s34
    v_perm_b32 v115, v110, v106, s34
    ds_write_b128 v7, v[112:115] offset:20480
    v_perm_b32 v116, v86, v82, s35
    v_perm_b32 v117, v94, v90, s35
    v_perm_b32 v118, v102, v98, s35
    v_perm_b32 v119, v110, v106, s35
    ds_write_b128 v7, v[116:119] offset:21504
    v_perm_b32 v120, v87, v83, s34
    v_perm_b32 v121, v95, v91, s34
    v_perm_b32 v122, v103, v99, s34
    v_perm_b32 v123, v111, v107, s34
    ds_write_b128 v7, v[120:123] offset:22528
    v_perm_b32 v124, v87, v83, s35
    v_perm_b32 v125, v95, v91, s35
    v_perm_b32 v126, v103, v99, s35
    v_perm_b32 v127, v111, v107, s35
    ds_write_b128 v7, v[124:127] offset:23552
    s_waitcnt lgkmcnt(0)
    s_waitcnt vmcnt(0)
    v_perm_b32 v112, v20, v16, s34
    v_perm_b32 v113, v28, v24, s34
    v_perm_b32 v114, v36, v32, s34
    v_perm_b32 v115, v44, v40, s34
    ds_write_b128 v7, v[112:115] offset:24576
    v_perm_b32 v116, v20, v16, s35
    v_perm_b32 v117, v28, v24, s35
    v_perm_b32 v118, v36, v32, s35
    v_perm_b32 v119, v44, v40, s35
    ds_write_b128 v7, v[116:119] offset:25600
    v_perm_b32 v120, v21, v17, s34
    v_perm_b32 v121, v29, v25, s34
    v_perm_b32 v122, v37, v33, s34
    v_perm_b32 v123, v45, v41, s34
    ds_write_b128 v7, v[120:123] offset:26624
    v_perm_b32 v124, v21, v17, s35
    v_perm_b32 v125, v29, v25, s35
    v_perm_b32 v126, v37, v33, s35
    v_perm_b32 v127, v45, v41, s35
    ds_write_b128 v7, v[124:127] offset:27648
    s_waitcnt lgkmcnt(0)
    v_perm_b32 v112, v22, v18, s34
    v_perm_b32 v113, v30, v26, s34
    v_perm_b32 v114, v38, v34, s34
    v_perm_b32 v115, v46, v42, s34
    ds_write_b128 v7, v[112:115] offset:28672
    v_perm_b32 v116, v22, v18, s35
    v_perm_b32 v117, v30, v26, s35
    v_perm_b32 v118, v38, v34, s35
    v_perm_b32 v119, v46, v42, s35
    ds_write_b128 v7, v[116:119] offset:29696
    v_perm_b32 v120, v23, v19, s34
    v_perm_b32 v121, v31, v27, s34
    v_perm_b32 v122, v39, v35, s34
    v_perm_b32 v123, v47, v43, s34
    ds_write_b128 v7, v[120:123] offset:30720
    v_perm_b32 v124, v23, v19, s35
    v_perm_b32 v125, v31, v27, s35
    v_perm_b32 v126, v39, v35, s35
    v_perm_b32 v127, v47, v43, s35
    ds_write_b128 v7, v[124:127] offset:31744
    s_waitcnt lgkmcnt(0)
    s_lshl_b32 s25, s22, 7
    s_add_u32 s25, s25, 0x192000
    v_lshrrev_b32 v15, 2, v1
    v_and_b32 v15, 127, v15
L_TPI:
    buffer_load_dword v14, v15, s[8:11], s25 offen sc1
    s_add_u32 s32, s32, 1
    s_cmp_gt_u32 s32, 200000
    s_waitcnt vmcnt(0)
    s_cbranch_scc1 L_TPI_ok
    v_cmp_eq_u32 vcc, 0, v14
    s_cbranch_vccz L_TPI_ok
    s_sleep 8
    s_branch L_TPI
L_TPI_ok:
    s_mov_b32 s23, s22
    s_mov_b32 s29, 0
    s_mov_b32 s30, 0x40000000
    s_mov_b32 s42, 0x3db504f3
    s_mov_b32 s43, 0x3fb8aa3b
    s_mul_i32 s24, s23, 0x82100
    s_lshl_b32 s36, s20, 14
    s_add_u32 s24, s24, s36
    s_add_u32 s24, s24, 0x1000000
    s_add_u32 s36, s24, 0
    s_add_u32 s37, s36, 0x7000000
    buffer_load_dwordx4 a[32:35], v1, s[8:11], s36 offen offset:0 sc1
    buffer_load_dwordx4 a[0:3], v1, s[8:11], s37 offen offset:0 sc1
    buffer_load_dwordx4 a[36:39], v1, s[8:11], s36 offen offset:1024 sc1
    buffer_load_dwordx4 a[4:7], v1, s[8:11], s37 offen offset:1024 sc1
    buffer_load_dwordx4 a[40:43], v1, s[8:11], s36 offen offset:2048 sc1
    buffer_load_dwordx4 a[8:11], v1, s[8:11], s37 offen offset:2048 sc1
    buffer_load_dwordx4 a[44:47], v1, s[8:11], s36 offen offset:3072 sc1
    buffer_load_dwordx4 a[12:15], v1, s[8:11], s37 offen offset:3072 sc1
    s_add_u32 s36, s24, 4096
    s_add_u32 s37, s36, 0x7000000
    buffer_load_dwordx4 a[48:51], v1, s[8:11], s36 offen offset:0 sc1
    buffer_load_dwordx4 a[16:19], v1, s[8:11], s37 offen offset:0 sc1
    buffer_load_dwordx4 a[52:55], v1, s[8:11], s36 offen offset:1024 sc1
    buffer_load_dwordx4 a[20:23], v1, s[8:11], s37 offen offset:1024 sc1
    buffer_load_dwordx4 a[56:59], v1, s[8:11], s36 offen offset:2048 sc1
    buffer_load_dwordx4 a[24:27], v1, s[8:11], s37 offen offset:2048 sc1
    buffer_load_dwordx4 a[60:63], v1, s[8:11], s36 offen offset:3072 sc1
    buffer_load_dwordx4 a[28:31], v1, s[8:11], s37 offen offset:3072 sc1
    s_lshr_b32 s36, s21, 1
    s_lshl_b32 s36, s36, 3
    s_xor_b32 s37, s36, 8
    s_add_u32 s24, s24, 8192
    s_add_u32 s36, s36, s24
    s_add_u32 s37, s37, s24
    buffer_load_dwordx2 a[64:65], v2, s[8:11], s36 offen offset:0 sc1
    buffer_load_dwordx2 a[66:67], v2, s[8:11], s37 offen offset:0 sc1
    buffer_load_dwordx2 a[68:69], v2, s[8:11], s36 offen offset:1024 sc1
    buffer_load_dwordx2 a[70:71], v2, s[8:11], s37 offen offset:1024 sc1
L_P2:
    s_and_b32 s36, s29, 1
    s_lshl_b32 s36, s36, 20
    s_lshl_b32 s26, s22, 21
    s_add_u32 s26, s26, s36
    s_add_u32 s26, s26, 0x4000000
    s_bfe_u32 s27, s29, 0x10001
    s_lshl_b32 s24, s23, 13
    s_add_u32 s24, s24, 0x100000
    s_max_u32 s25, s23, 1
    s_lshl_b32 s25, s25, 13
    s_add_u32 s25, s25, 0xfe000
    buffer_load_dwordx4 v[48:51], v2, s[8:11], s24 offen sc1
    buffer_load_dwordx4 v[52:55], v2, s[8:11], s24 offen offset:1024 sc1
    s_lshl_b32 s36, s23, 5
    s_add_u32 s36, s36, s20
    s_lshl_b32 s36, s36, 10
    buffer_load_dword a72, v12, s[12:15], s36 offen
    buffer_load_dword a73, v12, s[92:95], 0 offen
    s_waitcnt vmcnt(4)
    v_cmp_ne_u32 vcc, 0, v1
    v_mov_b32 v15, 0x40000000
    v_mov_b32 v14, 0
    v_cndmask_b32 v15, v1, v15, vcc
    buffer_store_dword v14, v15, s[8:11], s30 offen sc1
    v_mfma_f32_16x16x32_bf16 v[80:83], a[32:35], a[0:3], 0
    v_mfma_f32_16x16x32_bf16 v[80:83], a[36:39], a[4:7], v[80:83]
    v_mfma_f32_16x16x32_bf16 v[80:83], a[40:43], a[8:11], v[80:83]
    v_mfma_f32_16x16x32_bf16 v[80:83], a[44:47], a[12:15], v[80:83]
    v_mfma_f32_16x16x32_bf16 v[88:91], a[48:51], a[16:19], 0
    v_mfma_f32_16x16x32_bf16 v[88:91], a[52:55], a[20:23], v[88:91]
    v_mfma_f32_16x16x32_bf16 v[88:91], a[56:59], a[24:27], v[88:91]
    v_mfma_f32_16x16x32_bf16 v[88:91], a[60:63], a[28:31], v[88:91]
    v_mfma_f32_16x16x32_bf16 v[84:87], a[32:35], a[16:19], 0
    v_mfma_f32_16x16x32_bf16 v[84:87], a[36:39], a[20:23], v[84:87]
    v_mfma_f32_16x16x32_bf16 v[84:87], a[40:43], a[24:27], v[84:87]
    v_mfma_f32_16x16x32_bf16 v[84:87], a[44:47], a[28:31], v[84:87]
    v_cvt_pk_bf16_f32 v81, v80, v81
    v_lshlrev_b32 v80, 16, v81
    v_and_b32 v81, 0xffff0000, v81
    v_mul_f32 v80, s42, v80
    v_mul_f32 v81, s42, v81
    v_cvt_pk_bf16_f32 v81, v80, v81
    v_lshlrev_b32 v80, 16, v81
    v_and_b32 v81, 0xffff0000, v81
    v_cvt_pk_bf16_f32 v83, v82, v83
    v_lshlrev_b32 v82, 16, v83
    v_and_b32 v83, 0xffff0000, v83
    v_mul_f32 v82, s42, v82
    v_mul_f32 v83, s42, v83
    v_cvt_pk_bf16_f32 v83, v82, v83
    v_lshlrev_b32 v82, 16, v83
    v_and_b32 v83, 0xffff0000, v83
    v_cvt_pk_bf16_f32 v89, v88, v89
    v_lshlrev_b32 v88, 16, v89
    v_and_b32 v89, 0xffff0000, v89
    v_mul_f32 v88, s42, v88
    v_mul_f32 v89, s42, v89
    v_cvt_pk_bf16_f32 v89, v88, v89
    v_lshlrev_b32 v88, 16, v89
    v_and_b32 v89, 0xffff0000, v89
    v_cvt_pk_bf16_f32 v91, v90, v91
    v_lshlrev_b32 v90, 16, v91
    v_and_b32 v91, 0xffff0000, v91
    v_mul_f32 v90, s42, v90
    v_mul_f32 v91, s42, v91
    v_cvt_pk_bf16_f32 v91, v90, v91
    v_lshlrev_b32 v90, 16, v91
    v_and_b32 v91, 0xffff0000, v91
    v_cvt_pk_bf16_f32 v85, v84, v85
    v_lshlrev_b32 v84, 16, v85
    v_and_b32 v85, 0xffff0000, v85
    v_mul_f32 v84, s42, v84
    v_mul_f32 v85, s42, v85
    v_cvt_pk_bf16_f32 v85, v84, v85
    v_lshlrev_b32 v84, 16, v85
    v_and_b32 v85, 0xffff0000, v85
    v_cvt_pk_bf16_f32 v87, v86, v87
    v_lshlrev_b32 v86, 16, v87
    v_and_b32 v87, 0xffff0000, v87
    v_mul_f32 v86, s42, v86
    v_mul_f32 v87, s42, v87
    v_cvt_pk_bf16_f32 v87, v86, v87
    v_lshlrev_b32 v86, 16, v87
    v_and_b32 v87, 0xffff0000, v87
    v_cndmask_b32 v80, v13, v80, s[64:65]
    v_cndmask_b32 v81, v13, v81, s[66:67]
    v_cndmask_b32 v82, v13, v82, s[68:69]
    v_cndmask_b32 v83, v13, v83, s[70:71]
    v_cndmask_b32 v88, v13, v88, s[64:65]
    v_cndmask_b32 v89, v13, v89, s[66:67]
    v_cndmask_b32 v90, v13, v90, s[68:69]
    v_cndmask_b32 v91, v13, v91, s[70:71]
    v_max_f32 v116, v80, v81
    v_max3_f32 v116, v116, v82, v83
    v_max_f32 v117, v84, v85
    v_max3_f32 v117, v117, v86, v87
    v_max3_f32 v117, v117, v88, v89
    v_max3_f32 v117, v117, v90, v91
    v_mov_b32 v14, v116
    s_nop 1
    v_permlane16_swap_b32 v116, v14
    v_max_f32 v116, v116, v14
    v_mov_b32 v14, v117
    s_nop 1
    v_permlane16_swap_b32 v117, v14
    v_max_f32 v117, v117, v14
    v_mov_b32 v14, v116
    s_nop 1
    v_permlane32_swap_b32 v116, v14
    v_max_f32 v116, v116, v14
    v_mov_b32 v14, v117
    s_nop 1
    v_permlane32_swap_b32 v117, v14
    v_max_f32 v117, v117, v14
    v_mul_f32 v14, s43, v116
    v_fma_f32 v80, v80, s43, -v14
    v_exp_f32 v80, v80
    v_fma_f32 v81, v81, s43, -v14
    v_exp_f32 v81, v81
    v_fma_f32 v82, v82, s43, -v14
    v_exp_f32 v82, v82
    v_fma_f32 v83, v83, s43, -v14
    v_exp_f32 v83, v83
    v_mul_f32 v14, s43, v117
    v_fma_f32 v84, v84, s43, -v14
    v_exp_f32 v84, v84
    v_fma_f32 v85, v85, s43, -v14
    v_exp_f32 v85, v85
    v_fma_f32 v86, v86, s43, -v14
    v_exp_f32 v86, v86
    v_fma_f32 v87, v87, s43, -v14
    v_exp_f32 v87, v87
    v_fma_f32 v88, v88, s43, -v14
    v_exp_f32 v88, v88
    v_fma_f32 v89, v89, s43, -v14
    v_exp_f32 v89, v89
    v_fma_f32 v90, v90, s43, -v14
    v_exp_f32 v90, v90
    v_fma_f32 v91, v91, s43, -v14
    v_exp_f32 v91, v91
    v_cvt_pk_bf16_f32 v100, v80, v81
    v_cvt_pk_bf16_f32 v101, v82, v83
    v_mov_b64 v[102:103], 0
    v_cvt_pk_bf16_f32 v104, v84, v85
    v_cvt_pk_bf16_f32 v105, v86, v87
    v_cvt_pk_bf16_f32 v106, v88, v89
    v_cvt_pk_bf16_f32 v107, v90, v91
    v_mov_b64 v[108:109], s[4:5]
    v_mov_b64 v[110:111], s[4:5]
    v_cndmask_b32 v112, 0, v108, s[72:73]
    v_cndmask_b32 v113, 0, v108, s[72:73]
    v_mfma_f32_16x16x32_bf16 v[16:19], v[108:111], v[100:103], 0
    v_mfma_f32_16x16x32_bf16 v[24:27], a[64:67], v[100:103], 0
    v_mfma_f32_16x16x32_bf16 v[28:31], a[68:71], v[100:103], 0
    v_mfma_f32_16x16x32_bf16 v[20:23], v[108:111], v[104:107], 0
    v_mfma_f32_16x16x32_bf16 v[32:35], a[64:67], v[104:107], 0
    v_mfma_f32_16x16x32_bf16 v[36:39], a[68:71], v[104:107], 0
    s_branch L_P2_chk
L_P2_far:
    buffer_load_dword v14, v2, s[8:11], s25 offen sc1
    s_add_u32 s32, s32, 1
    s_cmp_gt_u32 s32, 200000
    s_waitcnt vmcnt(0)
    s_cbranch_scc1 L_P2_poll
    v_cmp_eq_u32 vcc, -1, v14
    s_cbranch_vccz L_P2_near
    s_sleep 12
    s_branch L_P2_far
L_P2_near:
    s_mov_b32 s25, 0x40000000
L_P2_poll:
    buffer_load_dwordx4 v[48:51], v2, s[8:11], s24 offen sc1
    buffer_load_dwordx4 v[52:55], v2, s[8:11], s24 offen offset:1024 sc1
L_P2_chk:
    s_add_u32 s32, s32, 1
    s_waitcnt vmcnt(0)
    ds_write_b128 v2, v[48:51] offset:20480
    ds_write_b128 v2, v[52:55] offset:21504
    v_max3_u32 v14, v48, v49, v50
    v_max3_u32 v15, v51, v52, v53
    v_max3_u32 v14, v14, v54, v55
    v_max_u32 v14, v14, v15
    v_cmp_eq_u32 vcc, -1, v14
    s_cbranch_vccz L_P2_got
    s_cmp_gt_u32 s32, 200000
    s_cbranch_scc1 L_P2_got
    s_cmp_eq_u32 s25, 0x40000000
    s_cbranch_scc1 L_P2_poll
    s_branch L_P2_far
L_P2_got:
    s_waitcnt lgkmcnt(0)
    s_barrier
    ds_read_b128 v[48:51], v8 offset:0
    ds_read_b128 v[52:55], v8 offset:2048
    ds_read_b128 v[56:59], v8 offset:4096
    ds_read_b128 v[60:63], v8 offset:6144
    s_waitcnt lgkmcnt(3)
    v_mfma_f32_16x16x32_bf16 v[80:83], a[128:131], v[48:51], 0
    v_mfma_f32_16x16x32_bf16 v[84:87], a[132:135], v[48:51], 0
    ds_read_b128 v[48:51], v8 offset:512
    s_waitcnt lgkmcnt(3)
    v_mfma_f32_16x16x32_bf16 v[80:83], a[136:139], v[52:55], v[80:83]
    v_mfma_f32_16x16x32_bf16 v[84:87], a[140:143], v[52:55], v[84:87]
    ds_read_b128 v[52:55], v8 offset:2560
    s_waitcnt lgkmcnt(3)
    v_mfma_f32_16x16x32_bf16 v[80:83], a[144:147], v[56:59], v[80:83]
    v_mfma_f32_16x16x32_bf16 v[84:87], a[148:151], v[56:59], v[84:87]
    ds_read_b128 v[56:59], v8 offset:4608
    s_waitcnt lgkmcnt(3)
    v_mfma_f32_16x16x32_bf16 v[80:83], a[152:155], v[60:63], v[80:83]
    v_mfma_f32_16x16x32_bf16 v[84:87], a[156:159], v[60:63], v[84:87]
    ds_read_b128 v[60:63], v8 offset:6656
    s_waitcnt lgkmcnt(3)
    v_mfma_f32_16x16x32_bf16 v[80:83], a[160:163], v[48:51], v[80:83]
    v_mfma_f32_16x16x32_bf16 v[84:87], a[164:167], v[48:51], v[84:87]
    ds_read_b128 v[48:51], v8 offset:1024
    s_waitcnt lgkmcnt(3)
    v_mfma_f32_16x16x32_bf16 v[80:83], a[168:171], v[52:55], v[80:83]
    v_mfma_f32_16x16x32_bf16 v[84:87], a[172:175], v[52:55], v[84:87]
    ds_read_b128 v[52:55], v8 offset:3072
    s_waitcnt lgkmcnt(3)
    v_mfma_f32_16x16x32_bf16 v[80:83], a[176:179], v[56:59], v[80:83]
    v_mfma_f32_16x16x32_bf16 v[84:87], a[180:183], v[56:59], v[84:87]
    ds_read_b128 v[56:59], v8 offset:5120
    s_waitcnt lgkmcnt(3)
    v_mfma_f32_16x16x32_bf16 v[80:83], a[184:187], v[60:63], v[80:83]
    v_mfma_f32_16x16x32_bf16 v[84:87], a[188:191], v[60:63], v[84:87]
    ds_read_b128 v[60:63], v8 offset:7168
    s_waitcnt lgkmcnt(3)
    v_mfma_f32_16x16x32_bf16 v[80:83], a[192:195], v[48:51], v[80:83]
    v_mfma_f32_16x16x32_bf16 v[84:87], a[196:199], v[48:51], v[84:87]
    ds_read_b128 v[48:51], v8 offset:1536
    s_waitcnt lgkmcnt(3)
    v_mfma_f32_16x16x32_bf16 v[80:83], a[200:203], v[52:55], v[80:83]
    v_mfma_f32_16x16x32_bf16 v[84:87], a[204:207], v[52:55], v[84:87]
    ds_read_b128 v[52:55], v8 offset:3584
    s_waitcnt lgkmcnt(3)
    v_mfma_f32_16x16x32_bf16 v[80:83], a[208:211], v[56:59], v[80:83]
    v_mfma_f32_16x16x32_bf16 v[84:87], a[212:215], v[56:59], v[84:87]
    ds_read_b128 v[56:59], v8 offset:5632
    s_waitcnt lgkmcnt(3)
    v_mfma_f32_16x16x32_bf16 v[80:83], a[216:219], v[60:63], v[80:83]
    v_mfma_f32_16x16x32_bf16 v[84:87], a[220:223], v[60:63], v[84:87]
    ds_read_b128 v[60:63], v8 offset:7680
    s_waitcnt lgkmcnt(3)
    v_mfma_f32_16x16x32_bf16 v[80:83], a[224:227], v[48:51], v[80:83]
    v_mfma_f32_16x16x32_bf16 v[84:87], a[228:231], v[48:51], v[84:87]
    ds_read_b128 v[48:51], v8 offset:0
    s_waitcnt lgkmcnt(3)
    v_mfma_f32_16x16x32_bf16 v[80:83], a[232:235], v[52:55], v[80:83]
    v_mfma_f32_16x16x32_bf16 v[84:87], a[236:239], v[52:55], v[84:87]
    ds_read_b128 v[52:55], v8 offset:2048
    s_waitcnt lgkmcnt(3)
    v_mfma_f32_16x16x32_bf16 v[80:83], a[240:243], v[56:59], v[80:83]
    v_mfma_f32_16x16x32_bf16 v[84:87], a[244:247], v[56:59], v[84:87]
    ds_read_b128 v[56:59], v8 offset:4096
    s_waitcnt lgkmcnt(3)
    v_mfma_f32_16x16x32_bf16 v[80:83], a[248:251], v[60:63], v[80:83]
    v_mfma_f32_16x16x32_bf16 v[84:87], a[252:255], v[60:63], v[84:87]
    ds_read_b128 v[60:63], v8 offset:6144
    s_waitcnt lgkmcnt(3)
    v_mfma_f32_16x16x32_bf16 v[40:43], v[48:51], v[128:131], 0
    v_mfma_f32_16x16x32_bf16 v[44:47], v[48:51], v[132:135], 0
    ds_read_b128 v[48:51], v8 offset:512
    s_waitcnt lgkmcnt(3)
    v_mfma_f32_16x16x32_bf16 v[40:43], v[52:55], v[136:139], v[40:43]
    v_mfma_f32_16x16x32_bf16 v[44:47], v[52:55], v[140:143], v[44:47]
    v_cvt_pk_bf16_f32 v88, v80, v84
    v_cvt_pk_bf16_f32 v89, v81, v85
    v_cvt_pk_bf16_f32 v90, v82, v86
    v_cvt_pk_bf16_f32 v91, v83, v87
    ds_write_b128 v9, v[88:91] offset:16384
    ds_read_b128 v[52:55], v8 offset:2560
    s_waitcnt lgkmcnt(4)
    v_mfma_f32_16x16x32_bf16 v[40:43], v[56:59], v[144:147], v[40:43]
    v_mfma_f32_16x16x32_bf16 v[44:47], v[56:59], v[148:151], v[44:47]
    ds_read_b128 v[56:59], v8 offset:4608
    s_waitcnt lgkmcnt(4)
    v_mfma_f32_16x16x32_bf16 v[40:43], v[60:63], v[152:155], v[40:43]
    v_mfma_f32_16x16x32_bf16 v[44:47], v[60:63], v[156:159], v[44:47]
    ds_read_b128 v[60:63], v8 offset:6656
    s_waitcnt lgkmcnt(4)
    v_mfma_f32_16x16x32_bf16 v[40:43], v[48:51], v[160:163], v[40:43]
    v_mfma_f32_16x16x32_bf16 v[44:47], v[48:51], v[164:167], v[44:47]
    s_waitcnt lgkmcnt(3)
    s_barrier
    ds_read_b128 v[64:67], v1 offset:16384
    ds_read_b128 v[68:71], v1 offset:17408
    ds_read_b128 v[72:75], v1 offset:18432
    ds_read_b128 v[76:79], v1 offset:19456
    ds_read_b128 v[48:51], v8 offset:1024
    s_waitcnt lgkmcnt(7)
    v_mfma_f32_16x16x32_bf16 v[40:43], v[52:55], v[168:171], v[40:43]
    v_mfma_f32_16x16x32_bf16 v[44:47], v[52:55], v[172:175], v[44:47]
    ds_read_b128 v[52:55], v8 offset:3072
    s_waitcnt lgkmcnt(7)
    v_mfma_f32_16x16x32_bf16 v[40:43], v[56:59], v[176:179], v[40:43]
    v_mfma_f32_16x16x32_bf16 v[44:47], v[56:59], v[180:183], v[44:47]
    s_waitcnt lgkmcnt(2)
    v_mfma_f32_16x16x32_bf16 v[92:95], v[64:67], a[0:3], 0
    v_mfma_f32_16x16x32_bf16 v[96:99], v[64:67], a[16:19], 0
    v_mfma_f32_16x16x32_bf16 v[92:95], v[68:71], a[4:7], v[92:95]
    v_mfma_f32_16x16x32_bf16 v[96:99], v[68:71], a[20:23], v[96:99]
    v_mfma_f32_16x16x32_bf16 v[92:95], v[72:75], a[8:11], v[92:95]
    v_mfma_f32_16x16x32_bf16 v[96:99], v[72:75], a[24:27], v[96:99]
    v_mfma_f32_16x16x32_bf16 v[92:95], v[76:79], a[12:15], v[92:95]
    v_mfma_f32_16x16x32_bf16 v[96:99], v[76:79], a[28:31], v[96:99]
    ds_read_b128 v[56:59], v8 offset:5120
    s_waitcnt lgkmcnt(3)
    v_mfma_f32_16x16x32_bf16 v[40:43], v[60:63], v[184:187], v[40:43]
    v_mfma_f32_16x16x32_bf16 v[44:47], v[60:63], v[188:191], v[44:47]
    ds_read_b128 v[60:63], v8 offset:7168
    s_waitcnt lgkmcnt(3)
    v_mfma_f32_16x16x32_bf16 v[40:43], v[48:51], v[192:195], v[40:43]
    v_mfma_f32_16x16x32_bf16 v[44:47], v[48:51], v[196:199], v[44:47]
    v_cvt_pk_bf16_f32 v93, v92, v93
    v_lshlrev_b32 v92, 16, v93
    v_and_b32 v93, 0xffff0000, v93
    v_mul_f32 v92, s42, v92
    v_mul_f32 v93, s42, v93
    v_cvt_pk_bf16_f32 v93, v92, v93
    v_lshlrev_b32 v92, 16, v93
    ds_read_b128 v[48:51], v8 offset:1536
    s_waitcnt lgkmcnt(3)
    v_mfma_f32_16x16x32_bf16 v[40:43], v[52:55], v[200:203], v[40:43]
    v_mfma_f32_16x16x32_bf16 v[44:47], v[52:55], v[204:207], v[44:47]
    v_and_b32 v93, 0xffff0000, v93
    v_cvt_pk_bf16_f32 v95, v94, v95
    v_lshlrev_b32 v94, 16, v95
    v_and_b32 v95, 0xffff0000, v95
    v_mul_f32 v94, s42, v94
    v_mul_f32 v95, s42, v95
    v_cvt_pk_bf16_f32 v95, v94, v95
    ds_read_b128 v[52:55], v8 offset:3584
    s_waitcnt lgkmcnt(3)
    v_mfma_f32_16x16x32_bf16 v[40:43], v[56:59], v[208:211], v[40:43]
    v_mfma_f32_16x16x32_bf16 v[44:47], v[56:59], v[212:215], v[44:47]
    v_lshlrev_b32 v94, 16, v95
    v_and_b32 v95, 0xffff0000, v95
    v_cvt_pk_bf16_f32 v97, v96, v97
    v_lshlrev_b32 v96, 16, v97
    v_and_b32 v97, 0xffff0000, v97
    v_mul_f32 v96, s42, v96
    v_mul_f32 v97, s42, v97
    ds_read_b128 v[56:59], v8 offset:5632
    s_waitcnt lgkmcnt(3)
    v_mfma_f32_16x16x32_bf16 v[40:43], v[60:63], v[216:219], v[40:43]
    v_mfma_f32_16x16x32_bf16 v[44:47], v[60:63], v[220:223], v[44:47]
    v_cvt_pk_bf16_f32 v97, v96, v97
    v_lshlrev_b32 v96, 16, v97
    v_and_b32 v97, 0xffff0000, v97
    v_cvt_pk_bf16_f32 v99, v98, v99
    v_lshlrev_b32 v98, 16, v99
    v_and_b32 v99, 0xffff0000, v99
    v_mul_f32 v98, s42, v98
    ds_read_b128 v[60:63], v8 offset:7680
    s_waitcnt lgkmcnt(3)
    v_mfma_f32_16x16x32_bf16 v[40:43], v[48:51], v[224:227], v[40:43]
    v_mfma_f32_16x16x32_bf16 v[44:47], v[48:51], v[228:231], v[44:47]
    v_mul_f32 v99, s42, v99
    v_cvt_pk_bf16_f32 v99, v98, v99
    v_lshlrev_b32 v98, 16, v99
    v_and_b32 v99, 0xffff0000, v99
    v_max3_f32 v118, v92, v93, v94
    v_max3_f32 v118, v118, v95, v116
    v_max3_f32 v119, v96, v97, v98
    s_waitcnt lgkmcnt(2)
    v_mfma_f32_16x16x32_bf16 v[40:43], v[52:55], v[232:235], v[40:43]
    v_mfma_f32_16x16x32_bf16 v[44:47], v[52:55], v[236:239], v[44:47]
    v_max3_f32 v119, v119, v99, v117
    v_mov_b32 v14, v118
    v_mov_b32 v15, v119
    s_nop 0
    v_permlane16_swap_b32 v118, v14
    v_permlane16_swap_b32 v119, v15
    v_max_f32 v118, v118, v14
    v_max_f32 v119, v119, v15
    s_waitcnt lgkmcnt(1)
    v_mfma_f32_16x16x32_bf16 v[40:43], v[56:59], v[240:243], v[40:43]
    v_mfma_f32_16x16x32_bf16 v[44:47], v[56:59], v[244:247], v[44:47]
    v_sub_f32 v104, v116, v118
    v_mul_f32 v118, s43, v118
    v_mul_f32 v104, s43, v104
    v_exp_f32 v104, v104
    v_fma_f32 v92, v92, s43, -v118
    v_exp_f32 v92, v92
    v_fma_f32 v93, v93, s43, -v118
    s_waitcnt lgkmcnt(0)
    v_mfma_f32_16x16x32_bf16 v[40:43], v[60:63], v[248:251], v[40:43]
    v_mfma_f32_16x16x32_bf16 v[44:47], v[60:63], v[252:255], v[44:47]
    v_exp_f32 v93, v93
    v_fma_f32 v94, v94, s43, -v118
    v_exp_f32 v94, v94
    v_fma_f32 v95, v95, s43, -v118
    v_exp_f32 v95, v95
    v_cvt_pk_bf16_f32 v100, v92, v93
    v_cvt_pk_bf16_f32 v101, v94, v95
    v_sub_f32 v105, v117, v119
    v_mul_f32 v119, s43, v119
    v_mul_f32 v105, s43, v105
    v_exp_f32 v105, v105
    v_fma_f32 v96, v96, s43, -v119
    v_exp_f32 v96, v96
    v_fma_f32 v97, v97, s43, -v119
    v_exp_f32 v97, v97
    v_fma_f32 v98, v98, s43, -v119
    v_exp_f32 v98, v98
    v_fma_f32 v99, v99, s43, -v119
    v_exp_f32 v99, v99
    v_cvt_pk_bf16_f32 v102, v96, v97
    v_cvt_pk_bf16_f32 v103, v98, v99
    v_mfma_f32_16x16x16_bf16 v[48:51], v[112:113], v[100:101], 0
    s_nop 0
    v_mfma_f32_16x16x16_bf16 v[52:55], v[112:113], v[102:103], 0
    v_cvt_pk_bf16_f32 v80, v40, v41
    v_cndmask_b32 v80, 0, v80, s[72:73]
    v_cvt_pk_bf16_f32 v81, v42, v43
    v_cndmask_b32 v81, 0, v81, s[72:73]
    v_cvt_pk_bf16_f32 v82, v44, v45
    v_cndmask_b32 v82, 0, v82, s[72:73]
    v_cvt_pk_bf16_f32 v83, v46, v47
    v_cndmask_b32 v83, 0, v83, s[72:73]
    v_mfma_f32_16x16x16_bf16 v[56:59], v[80:81], v[100:101], 0
    s_nop 0
    v_mfma_f32_16x16x16_bf16 v[60:63], v[82:83], v[100:101], 0
    v_mfma_f32_16x16x16_bf16 v[64:67], v[80:81], v[102:103], 0
    v_mfma_f32_16x16x16_bf16 v[68:71], v[82:83], v[102:103], 0
    v_fma_f32 v48, v16, v104, v48
    v_rcp_f32 v48, v48
    v_fma_f32 v52, v20, v105, v52
    v_rcp_f32 v52, v52
    v_fma_f32 v56, v24, v104, v56
    v_fma_f32 v57, v25, v104, v57
    v_fma_f32 v58, v26, v104, v58
    v_fma_f32 v59, v27, v104, v59
    v_fma_f32 v60, v28, v104, v60
    v_fma_f32 v61, v29, v104, v61
    v_fma_f32 v62, v30, v104, v62
    v_fma_f32 v63, v31, v104, v63
    v_pk_mul_f32 v[56:57], v[56:57], v[48:49] op_sel_hi:[1,0]
    v_pk_mul_f32 v[58:59], v[58:59], v[48:49] op_sel_hi:[1,0]
    v_pk_mul_f32 v[60:61], v[60:61], v[48:49] op_sel_hi:[1,0]
    v_pk_mul_f32 v[62:63], v[62:63], v[48:49] op_sel_hi:[1,0]
    v_cvt_pk_bf16_f32 v72, v56, v60
    v_cvt_pk_bf16_f32 v73, v57, v61
    v_cvt_pk_bf16_f32 v74, v58, v62
    v_cvt_pk_bf16_f32 v75, v59, v63
    ds_write_b128 v9, v[72:75] offset:0
    v_fma_f32 v64, v32, v105, v64
    v_fma_f32 v65, v33, v105, v65
    v_fma_f32 v66, v34, v105, v66
    v_fma_f32 v67, v35, v105, v67
    v_fma_f32 v68, v36, v105, v68
    v_fma_f32 v69, v37, v105, v69
    v_fma_f32 v70, v38, v105, v70
    v_fma_f32 v71, v39, v105, v71
    v_pk_mul_f32 v[64:65], v[64:65], v[52:53] op_sel_hi:[1,0]
    v_pk_mul_f32 v[66:67], v[66:67], v[52:53] op_sel_hi:[1,0]
    v_pk_mul_f32 v[68:69], v[68:69], v[52:53] op_sel_hi:[1,0]
    v_pk_mul_f32 v[70:71], v[70:71], v[52:53] op_sel_hi:[1,0]
    v_cvt_pk_bf16_f32 v76, v64, v68
    v_cvt_pk_bf16_f32 v77, v65, v69
    v_cvt_pk_bf16_f32 v78, v66, v70
    v_cvt_pk_bf16_f32 v79, v67, v71
    ds_write_b128 v9, v[76:79] offset:4096
    s_waitcnt lgkmcnt(0)
    s_barrier
    ds_read_b128 v[16:19], v1 offset:0
    ds_read_b128 v[20:23], v1 offset:1024
    ds_read_b128 v[24:27], v1 offset:2048
    ds_read_b128 v[28:31], v1 offset:3072
    ds_read_b128 v[32:35], v1 offset:4096
    ds_read_b128 v[36:39], v1 offset:5120
    ds_read_b128 v[40:43], v1 offset:6144
    ds_read_b128 v[44:47], v1 offset:7168
    ds_read_b128 v[48:51], v7 offset:0
    ds_read_b128 v[52:55], v7 offset:1024
    ds_read_b128 v[56:59], v7 offset:2048
    s_lshl_b32 s36, s20, 10
    s_add_u32 s25, s26, s36
    s_waitcnt lgkmcnt(2)
    v_mfma_f32_16x16x32_bf16 v[64:67], v[16:19], v[48:51], 0
    ds_read_b128 v[60:63], v7 offset:3072
    s_waitcnt lgkmcnt(2)
    v_mfma_f32_16x16x32_bf16 v[68:71], v[16:19], v[52:55], 0
    ds_read_b128 v[48:51], v7 offset:4096
    s_waitcnt lgkmcnt(2)
    v_mfma_f32_16x16x32_bf16 v[72:75], v[16:19], v[56:59], 0
    ds_read_b128 v[52:55], v7 offset:5120
    s_waitcnt lgkmcnt(2)
    v_mfma_f32_16x16x32_bf16 v[76:79], v[16:19], v[60:63], 0
    ds_read_b128 v[56:59], v7 offset:6144
    s_waitcnt lgkmcnt(2)
    v_mfma_f32_16x16x32_bf16 v[80:83], v[16:19], v[48:51], 0
    ds_read_b128 v[60:63], v7 offset:7168
    s_waitcnt lgkmcnt(2)
    v_mfma_f32_16x16x32_bf16 v[84:87], v[16:19], v[52:55], 0
    ds_read_b128 v[48:51], v7 offset:8192
    s_waitcnt lgkmcnt(2)
    v_mfma_f32_16x16x32_bf16 v[88:91], v[16:19], v[56:59], 0
    ds_read_b128 v[52:55], v7 offset:9216
    s_waitcnt lgkmcnt(2)
    v_mfma_f32_16x16x32_bf16 v[92:95], v[16:19], v[60:63], 0
    ds_read_b128 v[56:59], v7 offset:10240
    s_waitcnt lgkmcnt(2)
    v_mfma_f32_16x16x32_bf16 v[64:67], v[20:23], v[48:51], v[64:67]
    ds_read_b128 v[60:63], v7 offset:11264
    s_waitcnt lgkmcnt(2)
    v_mfma_f32_16x16x32_bf16 v[68:71], v[20:23], v[52:55], v[68:71]
    ds_read_b128 v[48:51], v7 offset:12288
    s_waitcnt lgkmcnt(2)
    v_mfma_f32_16x16x32_bf16 v[72:75], v[20:23], v[56:59], v[72:75]
    ds_read_b128 v[52:55], v7 offset:13312
    s_waitcnt lgkmcnt(2)
    v_mfma_f32_16x16x32_bf16 v[76:79], v[20:23], v[60:63], v[76:79]
    ds_read_b128 v[56:59], v7 offset:14336
    s_waitcnt lgkmcnt(2)
    v_mfma_f32_16x16x32_bf16 v[80:83], v[20:23], v[48:51], v[80:83]
    ds_read_b128 v[60:63], v7 offset:15360
    s_waitcnt lgkmcnt(2)
    v_mfma_f32_16x16x32_bf16 v[84:87], v[20:23], v[52:55], v[84:87]
    ds_read_b128 v[48:51], v7 offset:16384
    s_waitcnt lgkmcnt(2)
    v_mfma_f32_16x16x32_bf16 v[88:91], v[20:23], v[56:59], v[88:91]
    ds_read_b128 v[52:55], v7 offset:17408
    s_waitcnt lgkmcnt(2)
    v_mfma_f32_16x16x32_bf16 v[92:95], v[20:23], v[60:63], v[92:95]
    ds_read_b128 v[56:59], v7 offset:18432
    s_waitcnt lgkmcnt(2)
    v_mfma_f32_16x16x32_bf16 v[64:67], v[24:27], v[48:51], v[64:67]
    ds_read_b128 v[60:63], v7 offset:19456
    s_waitcnt lgkmcnt(2)
    v_mfma_f32_16x16x32_bf16 v[68:71], v[24:27], v[52:55], v[68:71]
    ds_read_b128 v[48:51], v7 offset:20480
    s_waitcnt lgkmcnt(2)
    v_mfma_f32_16x16x32_bf16 v[72:75], v[24:27], v[56:59], v[72:75]
    ds_read_b128 v[52:55], v7 offset:21504
    s_waitcnt lgkmcnt(2)
    v_mfma_f32_16x16x32_bf16 v[76:79], v[24:27], v[60:63], v[76:79]
    ds_read_b128 v[56:59], v7 offset:22528
    s_waitcnt lgkmcnt(2)
    v_mfma_f32_16x16x32_bf16 v[80:83], v[24:27], v[48:51], v[80:83]
    ds_read_b128 v[60:63], v7 offset:23552
    s_waitcnt lgkmcnt(2)
    v_mfma_f32_16x16x32_bf16 v[84:87], v[24:27], v[52:55], v[84:87]
    ds_read_b128 v[48:51], v7 offset:24576
    s_waitcnt lgkmcnt(2)
    v_mfma_f32_16x16x32_bf16 v[88:91], v[24:27], v[56:59], v[88:91]
    ds_read_b128 v[52:55], v7 offset:25600
    s_waitcnt lgkmcnt(2)
    v_mfma_f32_16x16x32_bf16 v[92:95], v[24:27], v[60:63], v[92:95]
    ds_read_b128 v[56:59], v7 offset:26624
    s_waitcnt lgkmcnt(2)
    v_mfma_f32_16x16x32_bf16 v[64:67], v[28:31], v[48:51], v[64:67]
    ds_read_b128 v[60:63], v7 offset:27648
    s_waitcnt lgkmcnt(2)
    v_mfma_f32_16x16x32_bf16 v[68:71], v[28:31], v[52:55], v[68:71]
    ds_read_b128 v[48:51], v7 offset:28672
    s_waitcnt lgkmcnt(2)
    v_mfma_f32_16x16x32_bf16 v[72:75], v[28:31], v[56:59], v[72:75]
    ds_read_b128 v[52:55], v7 offset:29696
    s_waitcnt lgkmcnt(2)
    v_mfma_f32_16x16x32_bf16 v[76:79], v[28:31], v[60:63], v[76:79]
    ds_read_b128 v[56:59], v7 offset:30720
    s_waitcnt lgkmcnt(2)
    v_mfma_f32_16x16x32_bf16 v[80:83], v[28:31], v[48:51], v[80:83]
    ds_read_b128 v[60:63], v7 offset:31744
    s_waitcnt lgkmcnt(2)
    v_mfma_f32_16x16x32_bf16 v[84:87], v[28:31], v[52:55], v[84:87]
    ds_read_b128 v[48:51], v7 offset:0
    s_waitcnt lgkmcnt(2)
    v_mfma_f32_16x16x32_bf16 v[88:91], v[28:31], v[56:59], v[88:91]
    ds_read_b128 v[52:55], v7 offset:1024
    s_waitcnt lgkmcnt(2)
    v_mfma_f32_16x16x32_bf16 v[92:95], v[28:31], v[60:63], v[92:95]
    ds_read_b128 v[56:59], v7 offset:2048
    s_waitcnt lgkmcnt(2)
    v_mfma_f32_16x16x32_bf16 v[96:99], v[32:35], v[48:51], 0
    ds_read_b128 v[60:63], v7 offset:3072
    s_waitcnt lgkmcnt(2)
    v_mfma_f32_16x16x32_bf16 v[100:103], v[32:35], v[52:55], 0
    ds_read_b128 v[48:51], v7 offset:4096
    s_waitcnt lgkmcnt(2)
    v_mfma_f32_16x16x32_bf16 v[104:107], v[32:35], v[56:59], 0
    ds_read_b128 v[52:55], v7 offset:5120
    s_waitcnt lgkmcnt(2)
    v_mfma_f32_16x16x32_bf16 v[108:111], v[32:35], v[60:63], 0
    ds_read_b128 v[56:59], v7 offset:6144
    v_cvt_pk_bf16_f32 v16, v64, v68
    s_waitcnt lgkmcnt(2)
    v_mfma_f32_16x16x32_bf16 v[112:115], v[32:35], v[48:51], 0
    ds_read_b128 v[60:63], v7 offset:7168
    v_cvt_pk_bf16_f32 v17, v72, v76
    s_waitcnt lgkmcnt(2)
    v_mfma_f32_16x16x32_bf16 v[116:119], v[32:35], v[52:55], 0
    ds_read_b128 v[48:51], v7 offset:8192
    v_cvt_pk_bf16_f32 v18, v80, v84
    s_waitcnt lgkmcnt(2)
    v_mfma_f32_16x16x32_bf16 v[120:123], v[32:35], v[56:59], 0
    ds_read_b128 v[52:55], v7 offset:9216
    v_cvt_pk_bf16_f32 v19, v88, v92
    s_waitcnt lgkmcnt(2)
    v_mfma_f32_16x16x32_bf16 v[124:127], v[32:35], v[60:63], 0
    ds_read_b128 v[56:59], v7 offset:10240
    v_and_or_b32 v16, v16, -2, s27
    s_waitcnt lgkmcnt(2)
    v_mfma_f32_16x16x32_bf16 v[96:99], v[36:39], v[48:51], v[96:99]
    ds_read_b128 v[60:63], v7 offset:11264
    s_add_u32 s36, s25, 0x0
    s_waitcnt lgkmcnt(2)
    v_mfma_f32_16x16x32_bf16 v[100:103], v[36:39], v[52:55], v[100:103]
    ds_read_b128 v[48:51], v7 offset:12288
    buffer_store_dwordx4 v[16:19], v10, s[8:11], s36 offen sc1
    s_waitcnt lgkmcnt(2)
    v_mfma_f32_16x16x32_bf16 v[104:107], v[36:39], v[56:59], v[104:107]
    ds_read_b128 v[52:55], v7 offset:13312
    v_cvt_pk_bf16_f32 v20, v65, v69
    s_waitcnt lgkmcnt(2)
    v_mfma_f32_16x16x32_bf16 v[108:111], v[36:39], v[60:63], v[108:111]
    ds_read_b128 v[56:59], v7 offset:14336
    v_cvt_pk_bf16_f32 v21, v73, v77
    s_waitcnt lgkmcnt(2)
    v_mfma_f32_16x16x32_bf16 v[112:115], v[36:39], v[48:51], v[112:115]
    ds_read_b128 v[60:63], v7 offset:15360
    v_cvt_pk_bf16_f32 v22, v81, v85
    s_waitcnt lgkmcnt(2)
    v_mfma_f32_16x16x32_bf16 v[116:119], v[36:39], v[52:55], v[116:119]
    ds_read_b128 v[48:51], v7 offset:16384
    v_cvt_pk_bf16_f32 v23, v89, v93
    s_waitcnt lgkmcnt(2)
    v_mfma_f32_16x16x32_bf16 v[120:123], v[36:39], v[56:59], v[120:123]
    ds_read_b128 v[52:55], v7 offset:17408
    v_and_or_b32 v20, v20, -2, s27
    s_waitcnt lgkmcnt(2)
    v_mfma_f32_16x16x32_bf16 v[124:127], v[36:39], v[60:63], v[124:127]
    ds_read_b128 v[56:59], v7 offset:18432
    s_add_u32 s36, s25, 0x8000
    s_waitcnt lgkmcnt(2)
    v_mfma_f32_16x16x32_bf16 v[96:99], v[40:43], v[48:51], v[96:99]
    ds_read_b128 v[60:63], v7 offset:19456
    buffer_store_dwordx4 v[20:23], v10, s[8:11], s36 offen sc1
    s_waitcnt lgkmcnt(2)
    v_mfma_f32_16x16x32_bf16 v[100:103], v[40:43], v[52:55], v[100:103]
    ds_read_b128 v[48:51], v7 offset:20480
    v_cvt_pk_bf16_f32 v24, v66, v70
    s_waitcnt lgkmcnt(2)
    v_mfma_f32_16x16x32_bf16 v[104:107], v[40:43], v[56:59], v[104:107]
    ds_read_b128 v[52:55], v7 offset:21504
    v_cvt_pk_bf16_f32 v25, v74, v78
    s_waitcnt lgkmcnt(2)
    v_mfma_f32_16x16x32_bf16 v[108:111], v[40:43], v[60:63], v[108:111]
    ds_read_b128 v[56:59], v7 offset:22528
    v_cvt_pk_bf16_f32 v26, v82, v86
    s_waitcnt lgkmcnt(2)
    v_mfma_f32_16x16x32_bf16 v[112:115], v[40:43], v[48:51], v[112:115]
    ds_read_b128 v[60:63], v7 offset:23552
    v_cvt_pk_bf16_f32 v27, v90, v94
    s_waitcnt lgkmcnt(2)
    v_mfma_f32_16x16x32_bf16 v[116:119], v[40:43], v[52:55], v[116:119]
    ds_read_b128 v[48:51], v7 offset:24576
    v_and_or_b32 v24, v24, -2, s27
    s_waitcnt lgkmcnt(2)
    v_mfma_f32_16x16x32_bf16 v[120:123], v[40:43], v[56:59], v[120:123]
    ds_read_b128 v[52:55], v7 offset:25600
    s_add_u32 s36, s25, 0x10000
    s_waitcnt lgkmcnt(2)
    v_mfma_f32_16x16x32_bf16 v[124:127], v[40:43], v[60:63], v[124:127]
    ds_read_b128 v[56:59], v7 offset:26624
    buffer_store_dwordx4 v[24:27], v10, s[8:11], s36 offen sc1
    s_waitcnt lgkmcnt(2)
    v_mfma_f32_16x16x32_bf16 v[96:99], v[44:47], v[48:51], v[96:99]
    ds_read_b128 v[60:63], v7 offset:27648
    v_cvt_pk_bf16_f32 v28, v67, v71
    s_waitcnt lgkmcnt(2)
    v_mfma_f32_16x16x32_bf16 v[100:103], v[44:47], v[52:55], v[100:103]
    ds_read_b128 v[48:51], v7 offset:28672
    v_cvt_pk_bf16_f32 v29, v75, v79
    s_waitcnt lgkmcnt(2)
    v_mfma_f32_16x16x32_bf16 v[104:107], v[44:47], v[56:59], v[104:107]
    ds_read_b128 v[52:55], v7 offset:29696
    v_cvt_pk_bf16_f32 v30, v83, v87
    s_waitcnt lgkmcnt(2)
    v_mfma_f32_16x16x32_bf16 v[108:111], v[44:47], v[60:63], v[108:111]
    ds_read_b128 v[56:59], v7 offset:30720
    v_cvt_pk_bf16_f32 v31, v91, v95
    s_waitcnt lgkmcnt(2)
    v_mfma_f32_16x16x32_bf16 v[112:115], v[44:47], v[48:51], v[112:115]
    ds_read_b128 v[60:63], v7 offset:31744
    v_and_or_b32 v28, v28, -2, s27
    s_waitcnt lgkmcnt(2)
    v_mfma_f32_16x16x32_bf16 v[116:119], v[44:47], v[52:55], v[116:119]
    s_add_u32 s36, s25, 0x18000
    s_waitcnt lgkmcnt(1)
    v_mfma_f32_16x16x32_bf16 v[120:123], v[44:47], v[56:59], v[120:123]
    buffer_store_dwordx4 v[28:31], v10, s[8:11], s36 offen sc1
    s_waitcnt lgkmcnt(0)
    v_mfma_f32_16x16x32_bf16 v[124:127], v[44:47], v[60:63], v[124:127]
    v_cvt_pk_bf16_f32 v32, v96, v100
    v_cvt_pk_bf16_f32 v33, v104, v108
    v_cvt_pk_bf16_f32 v34, v112, v116
    s_nop 4
    v_cvt_pk_bf16_f32 v35, v120, v124
    v_and_or_b32 v32, v32, -2, s27
    s_add_u32 s36, s25, 0x80000
    buffer_store_dwordx4 v[32:35], v10, s[8:11], s36 offen sc1
    v_cvt_pk_bf16_f32 v36, v97, v101
    v_cvt_pk_bf16_f32 v37, v105, v109
    v_cvt_pk_bf16_f32 v38, v113, v117
    v_cvt_pk_bf16_f32 v39, v121, v125
    v_and_or_b32 v36, v36, -2, s27
    s_add_u32 s36, s25, 0x88000
    buffer_store_dwordx4 v[36:39], v10, s[8:11], s36 offen sc1
    v_cvt_pk_bf16_f32 v40, v98, v102
    v_cvt_pk_bf16_f32 v41, v106, v110
    v_cvt_pk_bf16_f32 v42, v114, v118
    v_cvt_pk_bf16_f32 v43, v122, v126
    v_and_or_b32 v40, v40, -2, s27
    s_add_u32 s36, s25, 0x90000
    buffer_store_dwordx4 v[40:43], v10, s[8:11], s36 offen sc1
    v_cvt_pk_bf16_f32 v44, v99, v103
    v_cvt_pk_bf16_f32 v45, v107, v111
    v_cvt_pk_bf16_f32 v46, v115, v119
    v_cvt_pk_bf16_f32 v47, v123, v127
    v_and_or_b32 v44, v44, -2, s27
    s_add_u32 s36, s25, 0x98000
    buffer_store_dwordx4 v[44:47], v10, s[8:11], s36 offen sc1
    s_add_u32 s38, s23, 6
    s_cmp_ge_u32 s38, 64
    s_cbranch_scc1 L_P2_last
    s_mul_i32 s24, s38, 0x82100
    s_lshl_b32 s36, s20, 14
    s_add_u32 s24, s24, s36
    s_add_u32 s24, s24, 0x1000000
    s_add_u32 s36, s24, 0
    s_add_u32 s37, s36, 0x7000000
    buffer_load_dwordx4 a[32:35], v1, s[8:11], s36 offen offset:0 sc1
    buffer_load_dwordx4 a[0:3], v1, s[8:11], s37 offen offset:0 sc1
    buffer_load_dwordx4 a[36:39], v1, s[8:11], s36 offen offset:1024 sc1
    buffer_load_dwordx4 a[4:7], v1, s[8:11], s37 offen offset:1024 sc1
    buffer_load_dwordx4 a[40:43], v1, s[8:11], s36 offen offset:2048 sc1
    buffer_load_dwordx4 a[8:11], v1, s[8:11], s37 offen offset:2048 sc1
    buffer_load_dwordx4 a[44:47], v1, s[8:11], s36 offen offset:3072 sc1
    buffer_load_dwordx4 a[12:15], v1, s[8:11], s37 offen offset:3072 sc1
    s_add_u32 s36, s24, 4096
    s_add_u32 s37, s36, 0x7000000
    buffer_load_dwordx4 a[48:51], v1, s[8:11], s36 offen offset:0 sc1
    buffer_load_dwordx4 a[16:19], v1, s[8:11], s37 offen offset:0 sc1
    buffer_load_dwordx4 a[52:55], v1, s[8:11], s36 offen offset:1024 sc1
    buffer_load_dwordx4 a[20:23], v1, s[8:11], s37 offen offset:1024 sc1
    buffer_load_dwordx4 a[56:59], v1, s[8:11], s36 offen offset:2048 sc1
    buffer_load_dwordx4 a[24:27], v1, s[8:11], s37 offen offset:2048 sc1
    buffer_load_dwordx4 a[60:63], v1, s[8:11], s36 offen offset:3072 sc1
    buffer_load_dwordx4 a[28:31], v1, s[8:11], s37 offen offset:3072 sc1
    s_lshr_b32 s36, s21, 1
    s_lshl_b32 s36, s36, 3
    s_xor_b32 s37, s36, 8
    s_add_u32 s24, s24, 8192
    s_add_u32 s36, s36, s24
    s_add_u32 s37, s37, s24
    buffer_load_dwordx2 a[64:65], v2, s[8:11], s36 offen offset:0 sc1
    buffer_load_dwordx2 a[66:67], v2, s[8:11], s37 offen offset:0 sc1
    buffer_load_dwordx2 a[68:69], v2, s[8:11], s36 offen offset:1024 sc1
    buffer_load_dwordx2 a[70:71], v2, s[8:11], s37 offen offset:1024 sc1
L_P2_last:
    s_lshl_b32 s24, s23, 5
    s_add_u32 s24, s24, s20
    s_lshl_b32 s24, s24, 10
    v_accvgpr_read_b32 v52, a72
    v_accvgpr_read_b32 v53, a73
    v_and_b32 v15, 15, v0
    v_mov_b32 v48, 0
    v_mov_b32 v14, 0x3f80
    v_cmp_eq_u32 vcc, 0, v15
    s_nop 1
    v_cndmask_b32 v48, v48, v14, vcc
    v_mov_b32 v14, 0x3f800000
    v_cmp_eq_u32 vcc, 1, v15
    s_nop 1
    v_cndmask_b32 v48, v48, v14, vcc
    v_mov_b32 v49, 0
    v_mov_b32 v14, 0x3f80
    v_cmp_eq_u32 vcc, 4, v15
    s_nop 1
    v_cndmask_b32 v49, v49, v14, vcc
    v_mov_b32 v14, 0x3f800000
    v_cmp_eq_u32 vcc, 5, v15
    s_nop 1
    v_cndmask_b32 v49, v49, v14, vcc
    v_mov_b32 v50, 0
    v_mov_b32 v14, 0x3f80
    v_cmp_eq_u32 vcc, 8, v15
    s_nop 1
    v_cndmask_b32 v50, v50, v14, vcc
    v_mov_b32 v14, 0x3f800000
    v_cmp_eq_u32 vcc, 9, v15
    s_nop 1
    v_cndmask_b32 v50, v50, v14, vcc
    v_mov_b32 v51, 0
    v_mov_b32 v14, 0x3f80
    v_cmp_eq_u32 vcc, 12, v15
    s_nop 1
    v_cndmask_b32 v51, v51, v14, vcc
    v_mov_b32 v14, 0x3f800000
    v_cmp_eq_u32 vcc, 13, v15
    s_nop 1
    v_cndmask_b32 v51, v51, v14, vcc
    s_lshl_b32 s25, s20, 15
    s_add_u32 s25, s25, s26
L_P3_poll:
    s_add_u32 s36, s25, 0
    buffer_load_dwordx4 v[80:83], v11, s[8:11], s36 offen sc1
    s_add_u32 s36, s25, 4096
    buffer_load_dwordx4 v[84:87], v11, s[8:11], s36 offen sc1
    s_add_u32 s36, s25, 8192
    buffer_load_dwordx4 v[88:91], v11, s[8:11], s36 offen sc1
    s_add_u32 s36, s25, 12288
    buffer_load_dwordx4 v[92:95], v11, s[8:11], s36 offen sc1
    s_add_u32 s36, s25, 16384
    buffer_load_dwordx4 v[96:99], v11, s[8:11], s36 offen sc1
    s_add_u32 s36, s25, 20480
    buffer_load_dwordx4 v[100:103], v11, s[8:11], s36 offen sc1
    s_add_u32 s36, s25, 24576
    buffer_load_dwordx4 v[104:107], v11, s[8:11], s36 offen sc1
    s_add_u32 s36, s25, 28672
    buffer_load_dwordx4 v[108:111], v11, s[8:11], s36 offen sc1
    s_mov_b64 exec, -1
    s_add_u32 s32, s32, 1
    s_cmp_gt_u32 s32, 200000
    s_waitcnt vmcnt(7)
    v_mfma_f32_16x16x32_bf16 v[56:59], v[48:51], v[80:83], 0
    s_waitcnt vmcnt(6)
    v_mfma_f32_16x16x32_bf16 v[56:59], v[48:51], v[84:87], v[56:59]
    v_bitop3_b32 v60, v80, v84, s27 bitop3:0x7e
    s_waitcnt vmcnt(5)
    v_mfma_f32_16x16x32_bf16 v[56:59], v[48:51], v[88:91], v[56:59]
    s_waitcnt vmcnt(4)
    v_mfma_f32_16x16x32_bf16 v[56:59], v[48:51], v[92:95], v[56:59]
    v_bitop3_b32 v61, v88, v92, s27 bitop3:0x7e
    s_waitcnt vmcnt(3)
    v_mfma_f32_16x16x32_bf16 v[56:59], v[48:51], v[96:99], v[56:59]
    s_waitcnt vmcnt(2)
    v_mfma_f32_16x16x32_bf16 v[56:59], v[48:51], v[100:103], v[56:59]
    v_bitop3_b32 v62, v96, v100, s27 bitop3:0x7e
    s_waitcnt vmcnt(1)
    v_mfma_f32_16x16x32_bf16 v[56:59], v[48:51], v[104:107], v[56:59]
    s_waitcnt vmcnt(0)
    v_mfma_f32_16x16x32_bf16 v[56:59], v[48:51], v[108:111], v[56:59]
    v_bitop3_b32 v63, v104, v108, s27 bitop3:0x7e
    v_or3_b32 v14, v60, v61, v62
    v_bitop3_b32 v14, v14, v63, 1 bitop3:0xa8
    s_cbranch_scc1 L_P3_got
    v_cmp_ne_u32 vcc, 0, v14
    s_cbranch_vccz L_P3_got
    s_mov_b64 exec, vcc
    s_branch L_P3_poll
L_P3_got:
    s_nop 4
    v_cvt_pk_bf16_f32 v62, v56, v57
    v_lshlrev_b32 v65, 16, v62
    v_and_b32 v66, 0xffff0000, v62
    v_lshlrev_b32 v60, 16, v52
    v_and_b32 v61, 0xffff0000, v52
    v_add_f32 v60, v60, v65
    v_add_f32 v61, v61, v66
    v_cvt_pk_bf16_f32 v62, v60, v61
    v_lshlrev_b32 v60, 16, v62
    v_and_b32 v61, 0xffff0000, v62
    v_add_f32 v63, v60, v61
    v_mul_f32 v64, v60, v60
    v_fmac_f32 v64, v61, v61
    v_add_f32_dpp v63, v63, v63 quad_perm:[1,0,3,2] row_mask:0xf bank_mask:0xf
    s_nop 0
    v_add_f32_dpp v64, v64, v64 quad_perm:[1,0,3,2] row_mask:0xf bank_mask:0xf
    v_add_f32_dpp v63, v63, v63 quad_perm:[2,3,0,1] row_mask:0xf bank_mask:0xf
    s_nop 0
    v_add_f32_dpp v64, v64, v64 quad_perm:[2,3,0,1] row_mask:0xf bank_mask:0xf
    v_add_f32_dpp v63, v63, v63 row_half_mirror row_mask:0xf bank_mask:0xf
    s_nop 0
    v_add_f32_dpp v64, v64, v64 row_half_mirror row_mask:0xf bank_mask:0xf
    v_add_f32_dpp v63, v63, v63 row_mirror row_mask:0xf bank_mask:0xf
    s_nop 0
    v_add_f32_dpp v64, v64, v64 row_mirror row_mask:0xf bank_mask:0xf
    v_mov_b32 v14, v63
    s_nop 1
    v_permlane16_swap_b32 v63, v14
    v_add_f32 v63, v63, v14
    v_mov_b32 v14, v64
    s_nop 1
    v_permlane16_swap_b32 v64, v14
    v_add_f32 v64, v64, v14
    v_mov_b32 v14, v63
    s_nop 1
    v_permlane32_swap_b32 v63, v14
    v_add_f32 v63, v63, v14
    v_mov_b32 v14, v64
    s_nop 1
    v_permlane32_swap_b32 v64, v14
    v_add_f32 v64, v64, v14
    v_mov_b32 v15, s21
    v_lshlrev_b32 v15, 3, v15
    v_add_u32 v15, 28672, v15
    ds_write2_b32 v15, v63, v64 offset0:0 offset1:1
    s_add_u32 s36, s24, 0x400000
    buffer_store_dword v62, v12, s[8:11], s36 offen sc1
    s_waitcnt lgkmcnt(0)
    s_barrier
    v_mov_b32 v15, 28672
    ds_read_b128 v[68:71], v15
    ds_read_b128 v[72:75], v15 offset:16
    s_waitcnt lgkmcnt(0)
    v_add_f32 v63, v68, v70
    v_add_f32 v63, v63, v72
    v_add_f32 v63, v63, v74
    v_mul_f32 v63, 0x3b000000, v63
    v_add_f32 v64, v69, v71
    v_add_f32 v64, v64, v73
    v_add_f32 v64, v64, v75
    v_mul_f32 v64, 0x3b000000, v64
    v_fma_f32 v64, -v63, v63, v64
    v_max_f32 v64, 0, v64
    v_cvt_pk_bf16_f32 v14, v63, v64
    v_lshlrev_b32 v63, 16, v14
    v_and_b32 v64, 0xffff0000, v14
    v_add_f32 v64, 0x3727c5ac, v64
    v_cvt_pk_bf16_f32 v14, v64, v64
    v_lshlrev_b32 v64, 16, v14
    v_sqrt_f32 v64, v64
    s_nop 0
    v_cvt_pk_bf16_f32 v14, v64, v64
    v_lshlrev_b32 v64, 16, v14
    v_rcp_f32 v64, v64
    v_sub_f32 v65, v60, v63
    v_sub_f32 v66, v61, v63
    v_cvt_pk_bf16_f32 v14, v65, v66
    v_lshlrev_b32 v65, 16, v14
    v_and_b32 v66, 0xffff0000, v14
    v_mul_f32 v65, v65, v64
    v_mul_f32 v66, v66, v64
    v_cvt_pk_bf16_f32 v67, v65, v66
    v_lshlrev_b32 v65, 16, v67
    v_and_b32 v66, 0xffff0000, v67
    v_lshlrev_b32 v68, 16, v53
    v_and_b32 v69, 0xffff0000, v53
    v_mul_f32 v63, v65, v68
    v_fmac_f32 v63, v66, v69
    s_nop 1
    v_add_f32_dpp v63, v63, v63 quad_perm:[1,0,3,2] row_mask:0xf bank_mask:0xf
    s_nop 1
    v_add_f32_dpp v63, v63, v63 quad_perm:[2,3,0,1] row_mask:0xf bank_mask:0xf
    s_nop 1
    v_add_f32_dpp v63, v63, v63 row_half_mirror row_mask:0xf bank_mask:0xf
    s_nop 1
    v_add_f32_dpp v63, v63, v63 row_mirror row_mask:0xf bank_mask:0xf
    v_mov_b32 v14, v63
    s_nop 1
    v_permlane16_swap_b32 v63, v14
    v_add_f32 v63, v63, v14
    v_mov_b32 v14, v63
    s_nop 1
    v_permlane32_swap_b32 v63, v14
    v_add_f32 v63, v63, v14
    s_lshr_b32 s25, s24, 6
    s_lshl_b32 s37, s21, 2
    s_add_u32 s25, s25, s37
    s_add_u32 s36, s25, 0x194000
    v_cmp_ne_u32 vcc, 0, v1
    v_mov_b32 v15, 0x40000000
    s_nop 0
    v_cndmask_b32 v15, v1, v15, vcc
    buffer_store_dword v63, v15, s[8:11], s36 offen sc1
    v_add_f32 v60, v60, v65
    v_add_f32 v61, v61, v66
    v_cvt_pk_bf16_f32 v62, v60, v61
    buffer_store_dword v62, v12, s[60:63], s24 offen sc1
    s_add_u32 s36, s24, 0x600000
    buffer_store_dword v67, v12, s[8:11], s36 offen sc1
    s_add_u32 s30, s25, 0x1b8000
    s_add_u32 s29, s29, 1
    s_barrier
    s_add_u32 s23, s23, 6
    s_cmp_lt_u32 s23, 64
    s_cbranch_scc1 L_P2
    s_waitcnt vmcnt(0)
    v_cmp_ne_u32 vcc, 0, v1
    v_mov_b32 v15, 0x40000000
    v_mov_b32 v14, 0
    v_cndmask_b32 v15, v1, v15, vcc
    buffer_store_dword v14, v15, s[8:11], s30 offen sc1
    s_branch L_end
L_mlp:
    s_mov_b32 s12, s44
    s_and_b32 s13, s45, 0xffff
    s_mov_b32 s14, 0x200000
    s_mov_b32 s15, 0x20000
    s_mov_b32 s60, s82
    s_and_b32 s61, s83, 0xffff
    s_mov_b32 s62, 0x200000
    s_mov_b32 s63, 0x20000
    s_mov_b32 s92, s80
    s_and_b32 s93, s81, 0xffff
    s_mov_b32 s94, 0x400
    s_mov_b32 s95, 0x20000
    v_mov_b32 v1, 0x0
    v_bfe_u32 v14, v0, 0, 1
    s_mov_b32 s38, 0x10
    v_mad_u32_u24 v1, v14, s38, v1
    v_bfe_u32 v14, v0, 1, 1
    s_mov_b32 s38, 0x20
    v_mad_u32_u24 v1, v14, s38, v1
    v_bfe_u32 v14, v0, 2, 1
    s_mov_b32 s38, 0x40
    v_mad_u32_u24 v1, v14, s38, v1
    v_bfe_u32 v14, v0, 3, 1
    s_mov_b32 s38, 0x80
    v_mad_u32_u24 v1, v14, s38, v1
    v_bfe_u32 v14, v0, 4, 1
    s_mov_b32 s38, 0x100
    v_mad_u32_u24 v1, v14, s38, v1
    v_bfe_u32 v14, v0, 5, 1
    s_mov_b32 s38, 0x200
    v_mad_u32_u24 v1, v14, s38, v1
    v_mov_b32 v2, 0x0
    v_bfe_u32 v14, v0, 0, 1
    s_mov_b32 s38, 0x10
    v_mad_u32_u24 v2, v14, s38, v2
    v_bfe_u32 v14, v0, 1, 1
    s_mov_b32 s38, 0x20
    v_mad_u32_u24 v2, v14, s38, v2
    v_bfe_u32 v14, v0, 2, 1
    s_mov_b32 s38, 0x40
    v_mad_u32_u24 v2, v14, s38, v2
    v_bfe_u32 v14, v0, 3, 1
    s_mov_b32 s38, 0x80
    v_mad_u32_u24 v2, v14, s38, v2
    v_bfe_u32 v14, v0, 4, 1
    s_mov_b32 s38, 0x100
    v_mad_u32_u24 v2, v14, s38, v2
    v_bfe_u32 v14, v0, 5, 1
    s_mov_b32 s38, 0x200
    v_mad_u32_u24 v2, v14, s38, v2
    v_bfe_u32 v14, v0, 6, 1
    s_mov_b32 s38, 0x800
    v_mad_u32_u24 v2, v14, s38, v2
    v_bfe_u32 v14, v0, 7, 1
    s_mov_b32 s38, 0x1000
    v_mad_u32_u24 v2, v14, s38, v2
    v_mov_b32 v9, 0x0
    v_bfe_u32 v14, v0, 0, 1
    s_mov_b32 s38, 0x10
    v_mad_u32_u24 v9, v14, s38, v9
    v_bfe_u32 v14, v0, 1, 1
    s_mov_b32 s38, 0x20
    v_mad_u32_u24 v9, v14, s38, v9
    v_bfe_u32 v14, v0, 2, 1
    s_mov_b32 s38, 0x40
    v_mad_u32_u24 v9, v14, s38, v9
    v_bfe_u32 v14, v0, 3, 1
    s_mov_b32 s38, 0x80
    v_mad_u32_u24 v9, v14, s38, v9
    v_bfe_u32 v14, v0, 4, 1
    s_mov_b32 s38, 0x100
    v_mad_u32_u24 v9, v14, s38, v9
    v_bfe_u32 v14, v0, 5, 1
    s_mov_b32 s38, 0x200
    v_mad_u32_u24 v9, v14, s38, v9
    v_bfe_u32 v14, v0, 6, 1
    s_mov_b32 s38, 0x400
    v_mad_u32_u24 v9, v14, s38, v9
    v_bfe_u32 v14, v0, 7, 1
    s_mov_b32 s38, 0x800
    v_mad_u32_u24 v9, v14, s38, v9
    v_mov_b32 v7, 0x8000
    v_bfe_u32 v14, v0, 0, 1
    s_mov_b32 s38, 0x10
    v_mad_u32_u24 v7, v14, s38, v7
    v_bfe_u32 v14, v0, 1, 1
    s_mov_b32 s38, 0x20
    v_mad_u32_u24 v7, v14, s38, v7
    v_bfe_u32 v14, v0, 2, 1
    s_mov_b32 s38, 0x40
    v_mad_u32_u24 v7, v14, s38, v7
    v_bfe_u32 v14, v0, 3, 1
    s_mov_b32 s38, 0x80
    v_mad_u32_u24 v7, v14, s38, v7
    v_bfe_u32 v14, v0, 4, 1
    s_mov_b32 s38, 0x100
    v_mad_u32_u24 v7, v14, s38, v7
    v_bfe_u32 v14, v0, 5, 1
    s_mov_b32 s38, 0x200
    v_mad_u32_u24 v7, v14, s38, v7
    v_bfe_u32 v14, v0, 6, 1
    s_mov_b32 s38, 0x8000
    v_mad_u32_u24 v7, v14, s38, v7
    v_bfe_u32 v14, v0, 7, 1
    s_mov_b32 s38, 0x10000
    v_mad_u32_u24 v7, v14, s38, v7
    v_mov_b32 v3, 0x0
    v_bfe_u32 v14, v0, 0, 1
    s_mov_b32 s38, 0x10
    v_mad_u32_u24 v3, v14, s38, v3
    v_bfe_u32 v14, v0, 1, 1
    s_mov_b32 s38, 0x20
    v_mad_u32_u24 v3, v14, s38, v3
    v_bfe_u32 v14, v0, 2, 1
    s_mov_b32 s38, 0x40
    v_mad_u32_u24 v3, v14, s38, v3
    v_bfe_u32 v14, v0, 3, 1
    s_mov_b32 s38, 0x400
    v_mad_u32_u24 v3, v14, s38, v3
    v_bfe_u32 v14, v0, 4, 1
    s_mov_b32 s38, 0x800
    v_mad_u32_u24 v3, v14, s38, v3
    v_bfe_u32 v14, v0, 5, 1
    s_mov_b32 s38, 0x1000
    v_mad_u32_u24 v3, v14, s38, v3
    v_bfe_u32 v14, v0, 6, 1
    s_mov_b32 s38, 0x2000
    v_mad_u32_u24 v3, v14, s38, v3
    v_bfe_u32 v14, v0, 7, 1
    s_mov_b32 s38, 0x4000
    v_mad_u32_u24 v3, v14, s38, v3
    v_mov_b32 v4, 0x0
    v_bfe_u32 v14, v0, 0, 1
    s_mov_b32 s38, 0x100
    v_mad_u32_u24 v4, v14, s38, v4
    v_bfe_u32 v14, v0, 1, 1
    s_mov_b32 s38, 0x200
    v_mad_u32_u24 v4, v14, s38, v4
    v_bfe_u32 v14, v0, 2, 1
    s_mov_b32 s38, 0x400
    v_mad_u32_u24 v4, v14, s38, v4
    v_bfe_u32 v14, v0, 6, 1
    s_mov_b32 s38, 0x80
    v_mad_u32_u24 v4, v14, s38, v4
    v_bfe_u32 v14, v0, 7, 1
    s_mov_b32 s38, 0x4000
    v_mad_u32_u24 v4, v14, s38, v4
    v_lshrrev_b32 v15, 3, v0
    v_xor_b32 v15, v15, v0
    v_and_b32 v15, 7, v15
    v_lshl_add_u32 v4, v15, 4, v4
    v_bfe_u32 v15, v0, 4, 2
    v_lshlrev_b32 v15, 4, v15
    v_xor_b32 v5, v15, v1
    v_xor_b32 v6, 64, v5
    v_mov_b32 v8, 0x5000
    v_bfe_u32 v14, v0, 0, 1
    s_mov_b32 s38, 0x10
    v_mad_u32_u24 v8, v14, s38, v8
    v_bfe_u32 v14, v0, 1, 1
    s_mov_b32 s38, 0x40
    v_mad_u32_u24 v8, v14, s38, v8
    v_bfe_u32 v14, v0, 2, 1
    s_mov_b32 s38, 0x80
    v_mad_u32_u24 v8, v14, s38, v8
    v_bfe_u32 v14, v0, 4, 1
    s_mov_b32 s38, 0x20
    v_mad_u32_u24 v8, v14, s38, v8
    v_bfe_u32 v14, v0, 5, 1
    s_mov_b32 s38, 0x100
    v_mad_u32_u24 v8, v14, s38, v8
    v_mov_b32 v10, 0x0
    v_bfe_u32 v14, v0, 0, 1
    s_mov_b32 s38, 0x10
    v_mad_u32_u24 v10, v14, s38, v10
    v_bfe_u32 v14, v0, 1, 1
    s_mov_b32 s38, 0x20
    v_mad_u32_u24 v10, v14, s38, v10
    v_bfe_u32 v14, v0, 2, 1
    s_mov_b32 s38, 0x40
    v_mad_u32_u24 v10, v14, s38, v10
    v_bfe_u32 v14, v0, 3, 1
    s_mov_b32 s38, 0x80
    v_mad_u32_u24 v10, v14, s38, v10
    v_bfe_u32 v14, v0, 4, 1
    s_mov_b32 s38, 0x20000
    v_mad_u32_u24 v10, v14, s38, v10
    v_bfe_u32 v14, v0, 5, 1
    s_mov_b32 s38, 0x40000
    v_mad_u32_u24 v10, v14, s38, v10
    v_bfe_u32 v14, v0, 6, 1
    s_mov_b32 s38, 0x100
    v_mad_u32_u24 v10, v14, s38, v10
    v_bfe_u32 v14, v0, 7, 1
    s_mov_b32 s38, 0x200
    v_mad_u32_u24 v10, v14, s38, v10
    v_mov_b32 v11, 0x0
    v_bfe_u32 v14, v0, 0, 1
    s_mov_b32 s38, 0x10
    v_mad_u32_u24 v11, v14, s38, v11
    v_bfe_u32 v14, v0, 1, 1
    s_mov_b32 s38, 0x20
    v_mad_u32_u24 v11, v14, s38, v11
    v_bfe_u32 v14, v0, 2, 1
    s_mov_b32 s38, 0x40
    v_mad_u32_u24 v11, v14, s38, v11
    v_bfe_u32 v14, v0, 3, 1
    s_mov_b32 s38, 0x80
    v_mad_u32_u24 v11, v14, s38, v11
    v_bfe_u32 v14, v0, 4, 1
    s_mov_b32 s38, 0x400
    v_mad_u32_u24 v11, v14, s38, v11
    v_bfe_u32 v14, v0, 5, 1
    s_mov_b32 s38, 0x800
    v_mad_u32_u24 v11, v14, s38, v11
    v_bfe_u32 v14, v0, 6, 1
    s_mov_b32 s38, 0x100
    v_mad_u32_u24 v11, v14, s38, v11
    v_bfe_u32 v14, v0, 7, 1
    s_mov_b32 s38, 0x200
    v_mad_u32_u24 v11, v14, s38, v11
    v_mov_b32 v12, 0x0
    v_bfe_u32 v14, v0, 0, 1
    s_mov_b32 s38, 0x10
    v_mad_u32_u24 v12, v14, s38, v12
    v_bfe_u32 v14, v0, 1, 1
    s_mov_b32 s38, 0x20
    v_mad_u32_u24 v12, v14, s38, v12
    v_bfe_u32 v14, v0, 2, 1
    s_mov_b32 s38, 0x40
    v_mad_u32_u24 v12, v14, s38, v12
    v_bfe_u32 v14, v0, 3, 1
    s_mov_b32 s38, 0x80
    v_mad_u32_u24 v12, v14, s38, v12
    v_bfe_u32 v14, v0, 4, 1
    s_mov_b32 s38, 0x4
    v_mad_u32_u24 v12, v14, s38, v12
    v_bfe_u32 v14, v0, 5, 1
    s_mov_b32 s38, 0x8
    v_mad_u32_u24 v12, v14, s38, v12
    v_bfe_u32 v14, v0, 6, 1
    s_mov_b32 s38, 0x100
    v_mad_u32_u24 v12, v14, s38, v12
    v_bfe_u32 v14, v0, 7, 1
    s_mov_b32 s38, 0x200
    v_mad_u32_u24 v12, v14, s38, v12
    v_mov_b32 v13, 0xf149f2ca
    v_and_b32 v14, 15, v0
    v_bfe_u32 v15, v0, 4, 2
    v_cmp_gt_u32 s[72:73], 2, v15
    v_lshlrev_b32 v15, 2, v15
    v_cmp_le_u32 s[64:65], v15, v14
    v_add_u32 v15, 1, v15
    v_cmp_le_u32 s[66:67], v15, v14
    v_add_u32 v15, 1, v15
    v_cmp_le_u32 s[68:69], v15, v14
    v_add_u32 v15, 1, v15
    v_cmp_le_u32 s[70:71], v15, v14
    v_add_u32 v15, 1, v15
    s_mov_b32 s34, 0x05040100
    s_mov_b32 s35, 0x07060302
    s_mov_b32 s33, 0x3e0293ee
    s_mov_b32 s32, 0
    s_mov_b32 s4, 0x3f803f80
    s_mov_b32 s5, 0x3f803f80
    s_lshr_b32 s20, s2, 3
    s_lshr_b32 s23, s2, 3
    s_lshl_b32 s23, s23, 1
    s_lshl_b32 s36, s23, 15
    buffer_load_dwordx4 v[96:99], v3, s[12:15], s36 offen offset:0
    buffer_load_dwordx4 v[100:103], v3, s[12:15], s36 offen offset:128
    buffer_load_dwordx4 v[104:107], v3, s[12:15], s36 offen offset:256
    buffer_load_dwordx4 v[108:111], v3, s[12:15], s36 offen offset:384
    buffer_load_dwordx4 v[112:115], v3, s[12:15], s36 offen offset:512
    buffer_load_dwordx4 v[116:119], v3, s[12:15], s36 offen offset:640
    buffer_load_dwordx4 v[120:123], v3, s[12:15], s36 offen offset:768
    buffer_load_dwordx4 v[124:127], v3, s[12:15], s36 offen offset:896
    s_add_u32 s36, s36, 0x8000
    buffer_load_dwordx4 v[128:131], v3, s[12:15], s36 offen offset:0
    buffer_load_dwordx4 v[132:135], v3, s[12:15], s36 offen offset:128
    buffer_load_dwordx4 v[136:139], v3, s[12:15], s36 offen offset:256
    buffer_load_dwordx4 v[140:143], v3, s[12:15], s36 offen offset:384
    buffer_load_dwordx4 v[144:147], v3, s[12:15], s36 offen offset:512
    buffer_load_dwordx4 v[148:151], v3, s[12:15], s36 offen offset:640
    buffer_load_dwordx4 v[152:155], v3, s[12:15], s36 offen offset:768
    buffer_load_dwordx4 v[156:159], v3, s[12:15], s36 offen offset:896
    s_mov_b32 s96, s46
    s_and_b32 s97, s47, 0xffff
    s_mov_b32 s98, 0x2000
    s_mov_b32 s99, 0x20000
    v_mov_b32 v68, 0x0
    v_bfe_u32 v14, v0, 0, 1
    s_mov_b32 s38, 0x8
    v_mad_u32_u24 v68, v14, s38, v68
    v_bfe_u32 v14, v0, 1, 1
    s_mov_b32 s38, 0x10
    v_mad_u32_u24 v68, v14, s38, v68
    v_bfe_u32 v14, v0, 2, 1
    s_mov_b32 s38, 0x10000
    v_mad_u32_u24 v68, v14, s38, v68
    v_bfe_u32 v14, v0, 3, 1
    s_mov_b32 s38, 0x10000
    v_mad_u32_u24 v68, v14, s38, v68
    v_bfe_u32 v14, v0, 4, 1
    s_mov_b32 s38, 0x400
    v_mad_u32_u24 v68, v14, s38, v68
    v_bfe_u32 v14, v0, 5, 1
    s_mov_b32 s38, 0x4
    v_mad_u32_u24 v68, v14, s38, v68
    v_bfe_u32 v14, v0, 6, 1
    s_mov_b32 s38, 0x40
    v_mad_u32_u24 v68, v14, s38, v68
    v_bfe_u32 v14, v0, 7, 1
    s_mov_b32 s38, 0x80
    v_mad_u32_u24 v68, v14, s38, v68
    v_mov_b32 v70, s20
    v_mov_b32 v69, 0x0
    v_bfe_u32 v14, v70, 0, 1
    s_mov_b32 s38, 0x20
    v_mad_u32_u24 v69, v14, s38, v69
    v_bfe_u32 v14, v70, 1, 1
    s_mov_b32 s38, 0x800
    v_mad_u32_u24 v69, v14, s38, v69
    v_bfe_u32 v14, v70, 2, 1
    s_mov_b32 s38, 0x1000
    v_mad_u32_u24 v69, v14, s38, v69
    v_bfe_u32 v14, v70, 3, 1
    s_mov_b32 s38, 0x100
    v_mad_u32_u24 v69, v14, s38, v69
    v_bfe_u32 v14, v70, 4, 1
    s_mov_b32 s38, 0x200
    v_mad_u32_u24 v69, v14, s38, v69
    v_add_u32 v68, v68, v69
    buffer_load_dword v72, v68, s[96:99], 0 offen
    v_mov_b32 v64, -1
    v_mov_b32 v65, -1
    v_mov_b32 v66, -1
    v_mov_b32 v67, -1
    s_lshl_b32 s36, s20, 13
    s_add_u32 s36, s36, 0x0
    buffer_store_dwordx4 v[64:67], v2, s[8:11], s36 offen sc1
    buffer_store_dwordx4 v[64:67], v2, s[8:11], s36 offen offset:1024 sc1
    s_lshl_b32 s36, s20, 14
    s_add_u32 s36, s36, 0x100000
    s_add_u32 s37, s36, 0x2000
    buffer_store_dwordx4 v[64:67], v2, s[8:11], s36 offen sc1
    buffer_store_dwordx4 v[64:67], v2, s[8:11], s36 offen offset:1024 sc1
    buffer_store_dwordx4 v[64:67], v2, s[8:11], s37 offen sc1
    buffer_store_dwordx4 v[64:67], v2, s[8:11], s37 offen offset:1024 sc1
    s_mul_i32 s36, s20, 0x104200
    s_add_u32 s36, s36, 0x1102100
    s_add_u32 s37, s36, 0x82100
    buffer_store_dwordx4 v[64:67], v2, s[8:11], s36 offen sc1
    buffer_store_dwordx4 v[64:67], v2, s[8:11], s36 offen offset:1024 sc1
    buffer_store_dwordx4 v[64:67], v2, s[8:11], s37 offen sc1
    buffer_store_dwordx4 v[64:67], v2, s[8:11], s37 offen offset:1024 sc1
    v_lshlrev_b32 v68, 2, v0
    s_lshl_b32 s36, s20, 10
    s_add_u32 s37, s36, 0x194000
    buffer_store_dword v64, v68, s[8:11], s37 offen sc1
    s_add_u32 s37, s36, 0x1b0000
    buffer_store_dword v64, v68, s[8:11], s37 offen sc1
    s_add_u32 s37, s36, 0x1b8000
    buffer_store_dword v64, v68, s[8:11], s37 offen sc1
    v_mov_b32 v69, 0x40000000
    v_cmp_lt_u32 vcc, 63, v0
    s_nop 1
    v_cndmask_b32 v68, v68, v69, vcc
    v_mov_b32 v73, 0
    s_lshl_b32 s36, s20, 8
    s_add_u32 s37, s36, 0x192000
    buffer_store_dword v73, v68, s[8:11], s37 offen sc1
    s_mul_i32 s36, s20, 0x104200
    s_add_u32 s36, s36, 0x1082000
    s_add_u32 s37, s36, 0x82100
    buffer_store_dword v73, v68, s[8:11], s36 offen sc1
    buffer_store_dword v73, v68, s[8:11], s37 offen sc1
    v_mov_b32 v71, 0x80000
    v_bfe_u32 v14, v0, 0, 1
    s_mov_b32 s38, 0x8
    v_mad_u32_u24 v71, v14, s38, v71
    v_bfe_u32 v14, v0, 1, 1
    s_mov_b32 s38, 0x20
    v_mad_u32_u24 v71, v14, s38, v71
    v_bfe_u32 v14, v0, 4, 1
    s_mov_b32 s38, 0x10
    v_mad_u32_u24 v71, v14, s38, v71
    v_bfe_u32 v14, v0, 5, 1
    s_mov_b32 s38, 0x4
    v_mad_u32_u24 v71, v14, s38, v71
    v_bfe_u32 v14, v0, 6, 1
    s_mov_b32 s38, 0x800
    v_mad_u32_u24 v71, v14, s38, v71
    v_bfe_u32 v14, v0, 7, 1
    s_mov_b32 s38, 0x1000
    v_mad_u32_u24 v71, v14, s38, v71
    v_mov_b32 v69, s20
    v_mov_b32 v68, 0x0
    v_bfe_u32 v14, v69, 0, 1
    s_mov_b32 s38, 0x100
    v_mad_u32_u24 v68, v14, s38, v68
    v_bfe_u32 v14, v69, 1, 1
    s_mov_b32 s38, 0x40
    v_mad_u32_u24 v68, v14, s38, v68
    v_bfe_u32 v14, v69, 2, 1
    s_mov_b32 s38, 0x80
    v_mad_u32_u24 v68, v14, s38, v68
    v_bfe_u32 v14, v69, 3, 1
    s_mov_b32 s38, 0x200
    v_mad_u32_u24 v68, v14, s38, v68
    v_bfe_u32 v14, v69, 4, 1
    s_mov_b32 s38, 0x400
    v_mad_u32_u24 v68, v14, s38, v68
    v_add_u32 v71, v68, v71
    v_and_b32 v68, 12, v0
    v_cmp_ne_u32 vcc, 0, v68
    v_mov_b32 v68, 0x40000000
    s_nop 0
    v_cndmask_b32 v71, v71, v68, vcc
    s_waitcnt vmcnt(16)
    s_mov_b32 s36, 0x1000000
    buffer_store_dword v72, v71, s[8:11], s36 offen sc1
L_XN:
    v_mov_b32 v88, 0
    v_mov_b32 v89, 0
    v_dot2_f32_bf16 v88, v96, s4, v88
    v_dot2_f32_bf16 v89, v96, v96, v89
    v_dot2_f32_bf16 v88, v97, s4, v88
    v_dot2_f32_bf16 v89, v97, v97, v89
    v_dot2_f32_bf16 v88, v98, s4, v88
    v_dot2_f32_bf16 v89, v98, v98, v89
    v_dot2_f32_bf16 v88, v99, s4, v88
    v_dot2_f32_bf16 v89, v99, v99, v89
    v_dot2_f32_bf16 v88, v100, s4, v88
    v_dot2_f32_bf16 v89, v100, v100, v89
    v_dot2_f32_bf16 v88, v101, s4, v88
    v_dot2_f32_bf16 v89, v101, v101, v89
    v_dot2_f32_bf16 v88, v102, s4, v88
    v_dot2_f32_bf16 v89, v102, v102, v89
    v_dot2_f32_bf16 v88, v103, s4, v88
    v_dot2_f32_bf16 v89, v103, v103, v89
    v_dot2_f32_bf16 v88, v104, s4, v88
    v_dot2_f32_bf16 v89, v104, v104, v89
    v_dot2_f32_bf16 v88, v105, s4, v88
    v_dot2_f32_bf16 v89, v105, v105, v89
    v_dot2_f32_bf16 v88, v106, s4, v88
    v_dot2_f32_bf16 v89, v106, v106, v89
    v_dot2_f32_bf16 v88, v107, s4, v88
    v_dot2_f32_bf16 v89, v107, v107, v89
    v_dot2_f32_bf16 v88, v108, s4, v88
    v_dot2_f32_bf16 v89, v108, v108, v89
    v_dot2_f32_bf16 v88, v109, s4, v88
    v_dot2_f32_bf16 v89, v109, v109, v89
    v_dot2_f32_bf16 v88, v110, s4, v88
    v_dot2_f32_bf16 v89, v110, v110, v89
    v_dot2_f32_bf16 v88, v111, s4, v88
    v_dot2_f32_bf16 v89, v111, v111, v89
    v_dot2_f32_bf16 v88, v112, s4, v88
    v_dot2_f32_bf16 v89, v112, v112, v89
    v_dot2_f32_bf16 v88, v113, s4, v88
    v_dot2_f32_bf16 v89, v113, v113, v89
    v_dot2_f32_bf16 v88, v114, s4, v88
    v_dot2_f32_bf16 v89, v114, v114, v89
    v_dot2_f32_bf16 v88, v115, s4, v88
    v_dot2_f32_bf16 v89, v115, v115, v89
    v_dot2_f32_bf16 v88, v116, s4, v88
    v_dot2_f32_bf16 v89, v116, v116, v89
    v_dot2_f32_bf16 v88, v117, s4, v88
    v_dot2_f32_bf16 v89, v117, v117, v89
    v_dot2_f32_bf16 v88, v118, s4, v88
    v_dot2_f32_bf16 v89, v118, v118, v89
    v_dot2_f32_bf16 v88, v119, s4, v88
    v_dot2_f32_bf16 v89, v119, v119, v89
    v_dot2_f32_bf16 v88, v120, s4, v88
    v_dot2_f32_bf16 v89, v120, v120, v89
    v_dot2_f32_bf16 v88, v121, s4, v88
    v_dot2_f32_bf16 v89, v121, v121, v89
    v_dot2_f32_bf16 v88, v122, s4, v88
    v_dot2_f32_bf16 v89, v122, v122, v89
    v_dot2_f32_bf16 v88, v123, s4, v88
    v_dot2_f32_bf16 v89, v123, v123, v89
    v_dot2_f32_bf16 v88, v124, s4, v88
    v_dot2_f32_bf16 v89, v124, v124, v89
    v_dot2_f32_bf16 v88, v125, s4, v88
    v_dot2_f32_bf16 v89, v125, v125, v89
    v_dot2_f32_bf16 v88, v126, s4, v88
    v_dot2_f32_bf16 v89, v126, v126, v89
    v_dot2_f32_bf16 v88, v127, s4, v88
    v_dot2_f32_bf16 v89, v127, v127, v89
    s_nop 3
    v_add_f32_dpp v88, v88, v88 quad_perm:[1,0,3,2] row_mask:0xf bank_mask:0xf
    v_add_f32_dpp v89, v89, v89 quad_perm:[1,0,3,2] row_mask:0xf bank_mask:0xf
    s_nop 0
    v_add_f32_dpp v88, v88, v88 quad_perm:[2,3,0,1] row_mask:0xf bank_mask:0xf
    v_add_f32_dpp v89, v89, v89 quad_perm:[2,3,0,1] row_mask:0xf bank_mask:0xf
    s_nop 0
    v_add_f32_dpp v88, v88, v88 row_half_mirror row_mask:0xf bank_mask:0xf
    v_add_f32_dpp v89, v89, v89 row_half_mirror row_mask:0xf bank_mask:0xf
    v_mul_f32 v88, 0x3b000000, v88
    v_mul_f32 v89, 0x3b000000, v89
    v_fma_f32 v89, -v88, v88, v89
    v_max_f32 v89, 0, v89
    v_cvt_pk_bf16_f32 v14, v88, v89
    v_lshlrev_b32 v88, 16, v14
    v_and_b32 v89, 0xffff0000, v14
    v_add_f32 v89, 0x3727c5ac, v89
    v_cvt_pk_bf16_f32 v14, v89, v89
    v_lshlrev_b32 v89, 16, v14
    v_sqrt_f32 v89, v89
    s_nop 0
    v_cvt_pk_bf16_f32 v14, v89, v89
    v_lshlrev_b32 v89, 16, v14
    v_rcp_f32 v89, v89
    v_lshlrev_b32 v90, 16, v96
    v_and_b32 v91, 0xffff0000, v96
    v_sub_f32 v90, v90, v88
    v_sub_f32 v91, v91, v88
    v_cvt_pk_bf16_f32 v96, v90, v91
    v_lshlrev_b32 v90, 16, v96
    v_and_b32 v91, 0xffff0000, v96
    v_mul_f32 v90, v90, v89
    v_mul_f32 v91, v91, v89
    v_cvt_pk_bf16_f32 v96, v90, v91
    v_lshlrev_b32 v90, 16, v97
    v_and_b32 v91, 0xffff0000, v97
    v_sub_f32 v90, v90, v88
    v_sub_f32 v91, v91, v88
    v_cvt_pk_bf16_f32 v97, v90, v91
    v_lshlrev_b32 v90, 16, v97
    v_and_b32 v91, 0xffff0000, v97
    v_mul_f32 v90, v90, v89
    v_mul_f32 v91, v91, v89
    v_cvt_pk_bf16_f32 v97, v90, v91
    v_lshlrev_b32 v90, 16, v98
    v_and_b32 v91, 0xffff0000, v98
    v_sub_f32 v90, v90, v88
    v_sub_f32 v91, v91, v88
    v_cvt_pk_bf16_f32 v98, v90, v91
    v_lshlrev_b32 v90, 16, v98
    v_and_b32 v91, 0xffff0000, v98
    v_mul_f32 v90, v90, v89
    v_mul_f32 v91, v91, v89
    v_cvt_pk_bf16_f32 v98, v90, v91
    v_lshlrev_b32 v90, 16, v99
    v_and_b32 v91, 0xffff0000, v99
    v_sub_f32 v90, v90, v88
    v_sub_f32 v91, v91, v88
    v_cvt_pk_bf16_f32 v99, v90, v91
    v_lshlrev_b32 v90, 16, v99
    v_and_b32 v91, 0xffff0000, v99
    v_mul_f32 v90, v90, v89
    v_mul_f32 v91, v91, v89
    v_cvt_pk_bf16_f32 v99, v90, v91
    ds_write_b128 v4, v[96:99] offset:0
    v_lshlrev_b32 v90, 16, v100
    v_and_b32 v91, 0xffff0000, v100
    v_sub_f32 v90, v90, v88
    v_sub_f32 v91, v91, v88
    v_cvt_pk_bf16_f32 v100, v90, v91
    v_lshlrev_b32 v90, 16, v100
    v_and_b32 v91, 0xffff0000, v100
    v_mul_f32 v90, v90, v89
    v_mul_f32 v91, v91, v89
    v_cvt_pk_bf16_f32 v100, v90, v91
    v_lshlrev_b32 v90, 16, v101
    v_and_b32 v91, 0xffff0000, v101
    v_sub_f32 v90, v90, v88
    v_sub_f32 v91, v91, v88
    v_cvt_pk_bf16_f32 v101, v90, v91
    v_lshlrev_b32 v90, 16, v101
    v_and_b32 v91, 0xffff0000, v101
    v_mul_f32 v90, v90, v89
    v_mul_f32 v91, v91, v89
    v_cvt_pk_bf16_f32 v101, v90, v91
    v_lshlrev_b32 v90, 16, v102
    v_and_b32 v91, 0xffff0000, v102
    v_sub_f32 v90, v90, v88
    v_sub_f32 v91, v91, v88
    v_cvt_pk_bf16_f32 v102, v90, v91
    v_lshlrev_b32 v90, 16, v102
    v_and_b32 v91, 0xffff0000, v102
    v_mul_f32 v90, v90, v89
    v_mul_f32 v91, v91, v89
    v_cvt_pk_bf16_f32 v102, v90, v91
    v_lshlrev_b32 v90, 16, v103
    v_and_b32 v91, 0xffff0000, v103
    v_sub_f32 v90, v90, v88
    v_sub_f32 v91, v91, v88
    v_cvt_pk_bf16_f32 v103, v90, v91
    v_lshlrev_b32 v90, 16, v103
    v_and_b32 v91, 0xffff0000, v103
    v_mul_f32 v90, v90, v89
    v_mul_f32 v91, v91, v89
    v_cvt_pk_bf16_f32 v103, v90, v91
    ds_write_b128 v4, v[100:103] offset:2048
    v_lshlrev_b32 v90, 16, v104
    v_and_b32 v91, 0xffff0000, v104
    v_sub_f32 v90, v90, v88
    v_sub_f32 v91, v91, v88
    v_cvt_pk_bf16_f32 v104, v90, v91
    v_lshlrev_b32 v90, 16, v104
    v_and_b32 v91, 0xffff0000, v104
    v_mul_f32 v90, v90, v89
    v_mul_f32 v91, v91, v89
    v_cvt_pk_bf16_f32 v104, v90, v91
    v_lshlrev_b32 v90, 16, v105
    v_and_b32 v91, 0xffff0000, v105
    v_sub_f32 v90, v90, v88
    v_sub_f32 v91, v91, v88
    v_cvt_pk_bf16_f32 v105, v90, v91
    v_lshlrev_b32 v90, 16, v105
    v_and_b32 v91, 0xffff0000, v105
    v_mul_f32 v90, v90, v89
    v_mul_f32 v91, v91, v89
    v_cvt_pk_bf16_f32 v105, v90, v91
    v_lshlrev_b32 v90, 16, v106
    v_and_b32 v91, 0xffff0000, v106
    v_sub_f32 v90, v90, v88
    v_sub_f32 v91, v91, v88
    v_cvt_pk_bf16_f32 v106, v90, v91
    v_lshlrev_b32 v90, 16, v106
    v_and_b32 v91, 0xffff0000, v106
    v_mul_f32 v90, v90, v89
    v_mul_f32 v91, v91, v89
    v_cvt_pk_bf16_f32 v106, v90, v91
    v_lshlrev_b32 v90, 16, v107
    v_and_b32 v91, 0xffff0000, v107
    v_sub_f32 v90, v90, v88
    v_sub_f32 v91, v91, v88
    v_cvt_pk_bf16_f32 v107, v90, v91
    v_lshlrev_b32 v90, 16, v107
    v_and_b32 v91, 0xffff0000, v107
    v_mul_f32 v90, v90, v89
    v_mul_f32 v91, v91, v89
    v_cvt_pk_bf16_f32 v107, v90, v91
    ds_write_b128 v4, v[104:107] offset:4096
    v_lshlrev_b32 v90, 16, v108
    v_and_b32 v91, 0xffff0000, v108
    v_sub_f32 v90, v90, v88
    v_sub_f32 v91, v91, v88
    v_cvt_pk_bf16_f32 v108, v90, v91
    v_lshlrev_b32 v90, 16, v108
    v_and_b32 v91, 0xffff0000, v108
    v_mul_f32 v90, v90, v89
    v_mul_f32 v91, v91, v89
    v_cvt_pk_bf16_f32 v108, v90, v91
    v_lshlrev_b32 v90, 16, v109
    v_and_b32 v91, 0xffff0000, v109
    v_sub_f32 v90, v90, v88
    v_sub_f32 v91, v91, v88
    v_cvt_pk_bf16_f32 v109, v90, v91
    v_lshlrev_b32 v90, 16, v109
    v_and_b32 v91, 0xffff0000, v109
    v_mul_f32 v90, v90, v89
    v_mul_f32 v91, v91, v89
    v_cvt_pk_bf16_f32 v109, v90, v91
    v_lshlrev_b32 v90, 16, v110
    v_and_b32 v91, 0xffff0000, v110
    v_sub_f32 v90, v90, v88
    v_sub_f32 v91, v91, v88
    v_cvt_pk_bf16_f32 v110, v90, v91
    v_lshlrev_b32 v90, 16, v110
    v_and_b32 v91, 0xffff0000, v110
    v_mul_f32 v90, v90, v89
    v_mul_f32 v91, v91, v89
    v_cvt_pk_bf16_f32 v110, v90, v91
    v_lshlrev_b32 v90, 16, v111
    v_and_b32 v91, 0xffff0000, v111
    v_sub_f32 v90, v90, v88
    v_sub_f32 v91, v91, v88
    v_cvt_pk_bf16_f32 v111, v90, v91
    v_lshlrev_b32 v90, 16, v111
    v_and_b32 v91, 0xffff0000, v111
    v_mul_f32 v90, v90, v89
    v_mul_f32 v91, v91, v89
    v_cvt_pk_bf16_f32 v111, v90, v91
    ds_write_b128 v4, v[108:111] offset:6144
    v_lshlrev_b32 v90, 16, v112
    v_and_b32 v91, 0xffff0000, v112
    v_sub_f32 v90, v90, v88
    v_sub_f32 v91, v91, v88
    v_cvt_pk_bf16_f32 v112, v90, v91
    v_lshlrev_b32 v90, 16, v112
    v_and_b32 v91, 0xffff0000, v112
    v_mul_f32 v90, v90, v89
    v_mul_f32 v91, v91, v89
    v_cvt_pk_bf16_f32 v112, v90, v91
    v_lshlrev_b32 v90, 16, v113
    v_and_b32 v91, 0xffff0000, v113
    v_sub_f32 v90, v90, v88
    v_sub_f32 v91, v91, v88
    v_cvt_pk_bf16_f32 v113, v90, v91
    v_lshlrev_b32 v90, 16, v113
    v_and_b32 v91, 0xffff0000, v113
    v_mul_f32 v90, v90, v89
    v_mul_f32 v91, v91, v89
    v_cvt_pk_bf16_f32 v113, v90, v91
    v_lshlrev_b32 v90, 16, v114
    v_and_b32 v91, 0xffff0000, v114
    v_sub_f32 v90, v90, v88
    v_sub_f32 v91, v91, v88
    v_cvt_pk_bf16_f32 v114, v90, v91
    v_lshlrev_b32 v90, 16, v114
    v_and_b32 v91, 0xffff0000, v114
    v_mul_f32 v90, v90, v89
    v_mul_f32 v91, v91, v89
    v_cvt_pk_bf16_f32 v114, v90, v91
    v_lshlrev_b32 v90, 16, v115
    v_and_b32 v91, 0xffff0000, v115
    v_sub_f32 v90, v90, v88
    v_sub_f32 v91, v91, v88
    v_cvt_pk_bf16_f32 v115, v90, v91
    v_lshlrev_b32 v90, 16, v115
    v_and_b32 v91, 0xffff0000, v115
    v_mul_f32 v90, v90, v89
    v_mul_f32 v91, v91, v89
    v_cvt_pk_bf16_f32 v115, v90, v91
    ds_write_b128 v4, v[112:115] offset:8192
    v_lshlrev_b32 v90, 16, v116
    v_and_b32 v91, 0xffff0000, v116
    v_sub_f32 v90, v90, v88
    v_sub_f32 v91, v91, v88
    v_cvt_pk_bf16_f32 v116, v90, v91
    v_lshlrev_b32 v90, 16, v116
    v_and_b32 v91, 0xffff0000, v116
    v_mul_f32 v90, v90, v89
    v_mul_f32 v91, v91, v89
    v_cvt_pk_bf16_f32 v116, v90, v91
    v_lshlrev_b32 v90, 16, v117
    v_and_b32 v91, 0xffff0000, v117
    v_sub_f32 v90, v90, v88
    v_sub_f32 v91, v91, v88
    v_cvt_pk_bf16_f32 v117, v90, v91
    v_lshlrev_b32 v90, 16, v117
    v_and_b32 v91, 0xffff0000, v117
    v_mul_f32 v90, v90, v89
    v_mul_f32 v91, v91, v89
    v_cvt_pk_bf16_f32 v117, v90, v91
    v_lshlrev_b32 v90, 16, v118
    v_and_b32 v91, 0xffff0000, v118
    v_sub_f32 v90, v90, v88
    v_sub_f32 v91, v91, v88
    v_cvt_pk_bf16_f32 v118, v90, v91
    v_lshlrev_b32 v90, 16, v118
    v_and_b32 v91, 0xffff0000, v118
    v_mul_f32 v90, v90, v89
    v_mul_f32 v91, v91, v89
    v_cvt_pk_bf16_f32 v118, v90, v91
    v_lshlrev_b32 v90, 16, v119
    v_and_b32 v91, 0xffff0000, v119
    v_sub_f32 v90, v90, v88
    v_sub_f32 v91, v91, v88
    v_cvt_pk_bf16_f32 v119, v90, v91
    v_lshlrev_b32 v90, 16, v119
    v_and_b32 v91, 0xffff0000, v119
    v_mul_f32 v90, v90, v89
    v_mul_f32 v91, v91, v89
    v_cvt_pk_bf16_f32 v119, v90, v91
    ds_write_b128 v4, v[116:119] offset:10240
    v_lshlrev_b32 v90, 16, v120
    v_and_b32 v91, 0xffff0000, v120
    v_sub_f32 v90, v90, v88
    v_sub_f32 v91, v91, v88
    v_cvt_pk_bf16_f32 v120, v90, v91
    v_lshlrev_b32 v90, 16, v120
    v_and_b32 v91, 0xffff0000, v120
    v_mul_f32 v90, v90, v89
    v_mul_f32 v91, v91, v89
    v_cvt_pk_bf16_f32 v120, v90, v91
    v_lshlrev_b32 v90, 16, v121
    v_and_b32 v91, 0xffff0000, v121
    v_sub_f32 v90, v90, v88
    v_sub_f32 v91, v91, v88
    v_cvt_pk_bf16_f32 v121, v90, v91
    v_lshlrev_b32 v90, 16, v121
    v_and_b32 v91, 0xffff0000, v121
    v_mul_f32 v90, v90, v89
    v_mul_f32 v91, v91, v89
    v_cvt_pk_bf16_f32 v121, v90, v91
    v_lshlrev_b32 v90, 16, v122
    v_and_b32 v91, 0xffff0000, v122
    v_sub_f32 v90, v90, v88
    v_sub_f32 v91, v91, v88
    v_cvt_pk_bf16_f32 v122, v90, v91
    v_lshlrev_b32 v90, 16, v122
    v_and_b32 v91, 0xffff0000, v122
    v_mul_f32 v90, v90, v89
    v_mul_f32 v91, v91, v89
    v_cvt_pk_bf16_f32 v122, v90, v91
    v_lshlrev_b32 v90, 16, v123
    v_and_b32 v91, 0xffff0000, v123
    v_sub_f32 v90, v90, v88
    v_sub_f32 v91, v91, v88
    v_cvt_pk_bf16_f32 v123, v90, v91
    v_lshlrev_b32 v90, 16, v123
    v_and_b32 v91, 0xffff0000, v123
    v_mul_f32 v90, v90, v89
    v_mul_f32 v91, v91, v89
    v_cvt_pk_bf16_f32 v123, v90, v91
    ds_write_b128 v4, v[120:123] offset:12288
    v_lshlrev_b32 v90, 16, v124
    v_and_b32 v91, 0xffff0000, v124
    v_sub_f32 v90, v90, v88
    v_sub_f32 v91, v91, v88
    v_cvt_pk_bf16_f32 v124, v90, v91
    v_lshlrev_b32 v90, 16, v124
    v_and_b32 v91, 0xffff0000, v124
    v_mul_f32 v90, v90, v89
    v_mul_f32 v91, v91, v89
    v_cvt_pk_bf16_f32 v124, v90, v91
    v_lshlrev_b32 v90, 16, v125
    v_and_b32 v91, 0xffff0000, v125
    v_sub_f32 v90, v90, v88
    v_sub_f32 v91, v91, v88
    v_cvt_pk_bf16_f32 v125, v90, v91
    v_lshlrev_b32 v90, 16, v125
    v_and_b32 v91, 0xffff0000, v125
    v_mul_f32 v90, v90, v89
    v_mul_f32 v91, v91, v89
    v_cvt_pk_bf16_f32 v125, v90, v91
    v_lshlrev_b32 v90, 16, v126
    v_and_b32 v91, 0xffff0000, v126
    v_sub_f32 v90, v90, v88
    v_sub_f32 v91, v91, v88
    v_cvt_pk_bf16_f32 v126, v90, v91
    v_lshlrev_b32 v90, 16, v126
    v_and_b32 v91, 0xffff0000, v126
    v_mul_f32 v90, v90, v89
    v_mul_f32 v91, v91, v89
    v_cvt_pk_bf16_f32 v126, v90, v91
    v_lshlrev_b32 v90, 16, v127
    v_and_b32 v91, 0xffff0000, v127
    v_sub_f32 v90, v90, v88
    v_sub_f32 v91, v91, v88
    v_cvt_pk_bf16_f32 v127, v90, v91
    v_lshlrev_b32 v90, 16, v127
    v_and_b32 v91, 0xffff0000, v127
    v_mul_f32 v90, v90, v89
    v_mul_f32 v91, v91, v89
    v_cvt_pk_bf16_f32 v127, v90, v91
    ds_write_b128 v4, v[124:127] offset:14336
    s_waitcnt lgkmcnt(0)
    s_barrier
    s_lshl_b32 s24, s23, 15
    s_add_u32 s24, s24, 0x800000
    ds_read_b128 v[24:27], v9 offset:0
    ds_read_b128 v[28:31], v9 offset:4096
    ds_read_b128 v[32:35], v9 offset:8192
    ds_read_b128 v[36:39], v9 offset:12288
    ds_read_b128 v[40:43], v9 offset:16384
    ds_read_b128 v[44:47], v9 offset:20480
    ds_read_b128 v[48:51], v9 offset:24576
    ds_read_b128 v[52:55], v9 offset:28672
    s_waitcnt lgkmcnt(7)
    s_add_u32 s36, s24, 0
    buffer_store_dwordx4 v[24:27], v9, s[8:11], s36 offen sc1
    s_waitcnt lgkmcnt(6)
    s_add_u32 s36, s24, 4096
    buffer_store_dwordx4 v[28:31], v9, s[8:11], s36 offen sc1
    s_waitcnt lgkmcnt(5)
    s_add_u32 s36, s24, 8192
    buffer_store_dwordx4 v[32:35], v9, s[8:11], s36 offen sc1
    s_waitcnt lgkmcnt(4)
    s_add_u32 s36, s24, 12288
    buffer_store_dwordx4 v[36:39], v9, s[8:11], s36 offen sc1
    s_waitcnt lgkmcnt(3)
    s_add_u32 s36, s24, 16384
    buffer_store_dwordx4 v[40:43], v9, s[8:11], s36 offen sc1
    s_waitcnt lgkmcnt(2)
    s_add_u32 s36, s24, 20480
    buffer_store_dwordx4 v[44:47], v9, s[8:11], s36 offen sc1
    s_waitcnt lgkmcnt(1)
    s_add_u32 s36, s24, 24576
    buffer_store_dwordx4 v[48:51], v9, s[8:11], s36 offen sc1
    s_waitcnt lgkmcnt(0)
    s_add_u32 s36, s24, 28672
    buffer_store_dwordx4 v[52:55], v9, s[8:11], s36 offen sc1
    s_barrier
    v_mov_b64 v[96:97], v[128:129]
    v_mov_b64 v[98:99], v[130:131]
    v_mov_b64 v[100:101], v[132:133]
    v_mov_b64 v[102:103], v[134:135]
    v_mov_b64 v[104:105], v[136:137]
    v_mov_b64 v[106:107], v[138:139]
    v_mov_b64 v[108:109], v[140:141]
    v_mov_b64 v[110:111], v[142:143]
    v_mov_b64 v[112:113], v[144:145]
    v_mov_b64 v[114:115], v[146:147]
    v_mov_b64 v[116:117], v[148:149]
    v_mov_b64 v[118:119], v[150:151]
    v_mov_b64 v[120:121], v[152:153]
    v_mov_b64 v[122:123], v[154:155]
    v_mov_b64 v[124:125], v[156:157]
    v_mov_b64 v[126:127], v[158:159]
    s_add_u32 s23, s23, 1
    s_bitcmp1_b32 s23, 0
    s_cbranch_scc1 L_XN
    s_waitcnt vmcnt(0)
    s_barrier
    v_mov_b32 v14, 1
    s_lshl_b32 s37, s20, 2
    v_lshlrev_b32 v15, 20, v0
    buffer_store_dword v14, v15, s[16:19], s37 offen sc1
    s_lshr_b32 s20, s2, 3
    s_mov_b32 s34, 0x05040100
    s_mov_b32 s35, 0x07060302
    s_mov_b32 s32, 0
    s_mov_b32 s64, s84
    s_and_b32 s65, s85, 0xffff
    s_mov_b32 s66, 0x1c0000
    s_mov_b32 s67, 0x20000
    s_mov_b32 s68, s86
    s_and_b32 s69, s87, 0xffff
    s_mov_b32 s70, 0x1c0000
    s_mov_b32 s71, 0x20000
    s_mov_b32 s76, s88
    s_and_b32 s77, s89, 0xffff
    s_mov_b32 s78, 0x1c0000
    s_mov_b32 s79, 0x20000
    v_and_b32 v3, 31, v0
    v_lshlrev_b32 v3, 2, v3
L_M_hs:
    buffer_load_dword v5, v3, s[16:19], 0 offen sc1
    s_add_u32 s32, s32, 1
    s_cmp_gt_u32 s32, 200000
    s_waitcnt vmcnt(0)
    s_cbranch_scc1 L_M_hs_ok
    v_cmp_eq_u32 vcc, 0, v5
    s_cbranch_vccz L_M_hs_ok
    s_sleep 16
    s_branch L_M_hs
L_M_hs_ok:
    v_lshlrev_b32 v3, 4, v0
L_M00_rp:
    s_mov_b32 s36, 0x194000
    buffer_load_dwordx4 v[16:19], v3, s[8:11], s36 offen sc1
    s_add_u32 s32, s32, 1
    v_mov_b32 v5, 0
    s_waitcnt vmcnt(0)
    v_max3_u32 v5, v5, v16, v17
    v_max3_u32 v5, v5, v18, v19
    s_cmp_gt_u32 s32, 200000
    s_cbranch_scc1 L_M00_rp_ok
    v_cmp_eq_u32 vcc, -1, v5
    s_cbranch_vccz L_M00_rp_ok
    s_sleep 64
    s_branch L_M00_rp
L_M00_rp_ok:
    v_add_f32 v16, v16, v17
    v_add_f32 v18, v18, v19
    v_add_f32 v16, v16, v18
    v_cvt_pk_bf16_f32 v5, v16, v16
    v_lshlrev_b32 v16, 16, v5
    v_ashrrev_i32 v5, 31, v16
    v_or_b32 v5, 0x80000000, v5
    v_xor_b32 v5, v5, v16
    v_and_b32 v5, 0xffff0000, v5
    v_sub_u32 v6, 2047, v0
    v_or_b32 v120, v5, v6
    v_lshrrev_b32 v1, 5, v0
    v_and_b32 v2, 31, v0
    s_mov_b32 s36, 229376
    v_mul_lo_u32 v4, v1, s36
    v_lshl_add_u32 v4, v2, 2, v4
    v_mov_b32 v5, 0x40000000
    v_cmp_lt_u32 vcc, 27, v2
    s_nop 1
    v_cndmask_b32 v4, v4, v5, vcc
    s_mul_i32 s23, s20, 112
    s_add_u32 s36, s23, 0
    buffer_load_dword v16, v4, s[64:67], s36 offen
    s_add_u32 s36, s23, 3584
    buffer_load_dword v17, v4, s[64:67], s36 offen
    s_add_u32 s36, s23, 7168
    buffer_load_dword v18, v4, s[64:67], s36 offen
    s_add_u32 s36, s23, 10752
    buffer_load_dword v19, v4, s[64:67], s36 offen
    s_add_u32 s36, s23, 14336
    buffer_load_dword v20, v4, s[64:67], s36 offen
    s_add_u32 s36, s23, 17920
    buffer_load_dword v21, v4, s[64:67], s36 offen
    s_add_u32 s36, s23, 21504
    buffer_load_dword v22, v4, s[64:67], s36 offen
    s_add_u32 s36, s23, 25088
    buffer_load_dword v23, v4, s[64:67], s36 offen
    s_add_u32 s36, s23, 28672
    buffer_load_dword v24, v4, s[64:67], s36 offen
    s_add_u32 s36, s23, 32256
    buffer_load_dword v25, v4, s[64:67], s36 offen
    s_add_u32 s36, s23, 35840
    buffer_load_dword v26, v4, s[64:67], s36 offen
    s_add_u32 s36, s23, 39424
    buffer_load_dword v27, v4, s[64:67], s36 offen
    s_add_u32 s36, s23, 43008
    buffer_load_dword v28, v4, s[64:67], s36 offen
    s_add_u32 s36, s23, 46592
    buffer_load_dword v29, v4, s[64:67], s36 offen
    s_add_u32 s36, s23, 50176
    buffer_load_dword v30, v4, s[64:67], s36 offen
    s_add_u32 s36, s23, 53760
    buffer_load_dword v31, v4, s[64:67], s36 offen
    s_add_u32 s36, s23, 57344
    buffer_load_dword v32, v4, s[64:67], s36 offen
    s_add_u32 s36, s23, 60928
    buffer_load_dword v33, v4, s[64:67], s36 offen
    s_add_u32 s36, s23, 64512
    buffer_load_dword v34, v4, s[64:67], s36 offen
    s_add_u32 s36, s23, 68096
    buffer_load_dword v35, v4, s[64:67], s36 offen
    s_add_u32 s36, s23, 71680
    buffer_load_dword v36, v4, s[64:67], s36 offen
    s_add_u32 s36, s23, 75264
    buffer_load_dword v37, v4, s[64:67], s36 offen
    s_add_u32 s36, s23, 78848
    buffer_load_dword v38, v4, s[64:67], s36 offen
    s_add_u32 s36, s23, 82432
    buffer_load_dword v39, v4, s[64:67], s36 offen
    s_add_u32 s36, s23, 86016
    buffer_load_dword v40, v4, s[64:67], s36 offen
    s_add_u32 s36, s23, 89600
    buffer_load_dword v41, v4, s[64:67], s36 offen
    s_add_u32 s36, s23, 93184
    buffer_load_dword v42, v4, s[64:67], s36 offen
    s_add_u32 s36, s23, 96768
    buffer_load_dword v43, v4, s[64:67], s36 offen
    s_add_u32 s36, s23, 100352
    buffer_load_dword v44, v4, s[64:67], s36 offen
    s_add_u32 s36, s23, 103936
    buffer_load_dword v45, v4, s[64:67], s36 offen
    s_add_u32 s36, s23, 107520
    buffer_load_dword v46, v4, s[64:67], s36 offen
    s_add_u32 s36, s23, 111104
    buffer_load_dword v47, v4, s[64:67], s36 offen
    s_waitcnt vmcnt(0)
    v_perm_b32 v128, v17, v16, s34
    v_perm_b32 v129, v19, v18, s34
    v_perm_b32 v130, v21, v20, s34
    v_perm_b32 v131, v23, v22, s34
    v_perm_b32 v132, v25, v24, s34
    v_perm_b32 v133, v27, v26, s34
    v_perm_b32 v134, v29, v28, s34
    v_perm_b32 v135, v31, v30, s34
    v_perm_b32 v136, v33, v32, s34
    v_perm_b32 v137, v35, v34, s34
    v_perm_b32 v138, v37, v36, s34
    v_perm_b32 v139, v39, v38, s34
    v_perm_b32 v140, v41, v40, s34
    v_perm_b32 v141, v43, v42, s34
    v_perm_b32 v142, v45, v44, s34
    v_perm_b32 v143, v47, v46, s34
    v_perm_b32 v160, v17, v16, s35
    v_perm_b32 v161, v19, v18, s35
    v_perm_b32 v162, v21, v20, s35
    v_perm_b32 v163, v23, v22, s35
    v_perm_b32 v164, v25, v24, s35
    v_perm_b32 v165, v27, v26, s35
    v_perm_b32 v166, v29, v28, s35
    v_perm_b32 v167, v31, v30, s35
    v_perm_b32 v168, v33, v32, s35
    v_perm_b32 v169, v35, v34, s35
    v_perm_b32 v170, v37, v36, s35
    v_perm_b32 v171, v39, v38, s35
    v_perm_b32 v172, v41, v40, s35
    v_perm_b32 v173, v43, v42, s35
    v_perm_b32 v174, v45, v44, s35
    v_perm_b32 v175, v47, v46, s35
    s_add_u32 s36, s23, 114688
    buffer_load_dword v16, v4, s[64:67], s36 offen
    s_add_u32 s36, s23, 118272
    buffer_load_dword v17, v4, s[64:67], s36 offen
    s_add_u32 s36, s23, 121856
    buffer_load_dword v18, v4, s[64:67], s36 offen
    s_add_u32 s36, s23, 125440
    buffer_load_dword v19, v4, s[64:67], s36 offen
    s_add_u32 s36, s23, 129024
    buffer_load_dword v20, v4, s[64:67], s36 offen
    s_add_u32 s36, s23, 132608
    buffer_load_dword v21, v4, s[64:67], s36 offen
    s_add_u32 s36, s23, 136192
    buffer_load_dword v22, v4, s[64:67], s36 offen
    s_add_u32 s36, s23, 139776
    buffer_load_dword v23, v4, s[64:67], s36 offen
    s_add_u32 s36, s23, 143360
    buffer_load_dword v24, v4, s[64:67], s36 offen
    s_add_u32 s36, s23, 146944
    buffer_load_dword v25, v4, s[64:67], s36 offen
    s_add_u32 s36, s23, 150528
    buffer_load_dword v26, v4, s[64:67], s36 offen
    s_add_u32 s36, s23, 154112
    buffer_load_dword v27, v4, s[64:67], s36 offen
    s_add_u32 s36, s23, 157696
    buffer_load_dword v28, v4, s[64:67], s36 offen
    s_add_u32 s36, s23, 161280
    buffer_load_dword v29, v4, s[64:67], s36 offen
    s_add_u32 s36, s23, 164864
    buffer_load_dword v30, v4, s[64:67], s36 offen
    s_add_u32 s36, s23, 168448
    buffer_load_dword v31, v4, s[64:67], s36 offen
    s_add_u32 s36, s23, 172032
    buffer_load_dword v32, v4, s[64:67], s36 offen
    s_add_u32 s36, s23, 175616
    buffer_load_dword v33, v4, s[64:67], s36 offen
    s_add_u32 s36, s23, 179200
    buffer_load_dword v34, v4, s[64:67], s36 offen
    s_add_u32 s36, s23, 182784
    buffer_load_dword v35, v4, s[64:67], s36 offen
    s_add_u32 s36, s23, 186368
    buffer_load_dword v36, v4, s[64:67], s36 offen
    s_add_u32 s36, s23, 189952
    buffer_load_dword v37, v4, s[64:67], s36 offen
    s_add_u32 s36, s23, 193536
    buffer_load_dword v38, v4, s[64:67], s36 offen
    s_add_u32 s36, s23, 197120
    buffer_load_dword v39, v4, s[64:67], s36 offen
    s_add_u32 s36, s23, 200704
    buffer_load_dword v40, v4, s[64:67], s36 offen
    s_add_u32 s36, s23, 204288
    buffer_load_dword v41, v4, s[64:67], s36 offen
    s_add_u32 s36, s23, 207872
    buffer_load_dword v42, v4, s[64:67], s36 offen
    s_add_u32 s36, s23, 211456
    buffer_load_dword v43, v4, s[64:67], s36 offen
    s_add_u32 s36, s23, 215040
    buffer_load_dword v44, v4, s[64:67], s36 offen
    s_add_u32 s36, s23, 218624
    buffer_load_dword v45, v4, s[64:67], s36 offen
    s_add_u32 s36, s23, 222208
    buffer_load_dword v46, v4, s[64:67], s36 offen
    s_add_u32 s36, s23, 225792
    buffer_load_dword v47, v4, s[64:67], s36 offen
    s_waitcnt vmcnt(0)
    v_perm_b32 v144, v17, v16, s34
    v_perm_b32 v145, v19, v18, s34
    v_perm_b32 v146, v21, v20, s34
    v_perm_b32 v147, v23, v22, s34
    v_perm_b32 v148, v25, v24, s34
    v_perm_b32 v149, v27, v26, s34
    v_perm_b32 v150, v29, v28, s34
    v_perm_b32 v151, v31, v30, s34
    v_perm_b32 v152, v33, v32, s34
    v_perm_b32 v153, v35, v34, s34
    v_perm_b32 v154, v37, v36, s34
    v_perm_b32 v155, v39, v38, s34
    v_perm_b32 v156, v41, v40, s34
    v_perm_b32 v157, v43, v42, s34
    v_perm_b32 v158, v45, v44, s34
    v_perm_b32 v159, v47, v46, s34
    v_perm_b32 v176, v17, v16, s35
    v_perm_b32 v177, v19, v18, s35
    v_perm_b32 v178, v21, v20, s35
    v_perm_b32 v179, v23, v22, s35
    v_perm_b32 v180, v25, v24, s35
    v_perm_b32 v181, v27, v26, s35
    v_perm_b32 v182, v29, v28, s35
    v_perm_b32 v183, v31, v30, s35
    v_perm_b32 v184, v33, v32, s35
    v_perm_b32 v185, v35, v34, s35
    v_perm_b32 v186, v37, v36, s35
    v_perm_b32 v187, v39, v38, s35
    v_perm_b32 v188, v41, v40, s35
    v_perm_b32 v189, v43, v42, s35
    v_perm_b32 v190, v45, v44, s35
    v_perm_b32 v191, v47, v46, s35
    s_add_u32 s36, s23, 0
    buffer_load_dword v16, v4, s[68:71], s36 offen
    s_add_u32 s36, s23, 3584
    buffer_load_dword v17, v4, s[68:71], s36 offen
    s_add_u32 s36, s23, 7168
    buffer_load_dword v18, v4, s[68:71], s36 offen
    s_add_u32 s36, s23, 10752
    buffer_load_dword v19, v4, s[68:71], s36 offen
    s_add_u32 s36, s23, 14336
    buffer_load_dword v20, v4, s[68:71], s36 offen
    s_add_u32 s36, s23, 17920
    buffer_load_dword v21, v4, s[68:71], s36 offen
    s_add_u32 s36, s23, 21504
    buffer_load_dword v22, v4, s[68:71], s36 offen
    s_add_u32 s36, s23, 25088
    buffer_load_dword v23, v4, s[68:71], s36 offen
    s_add_u32 s36, s23, 28672
    buffer_load_dword v24, v4, s[68:71], s36 offen
    s_add_u32 s36, s23, 32256
    buffer_load_dword v25, v4, s[68:71], s36 offen
    s_add_u32 s36, s23, 35840
    buffer_load_dword v26, v4, s[68:71], s36 offen
    s_add_u32 s36, s23, 39424
    buffer_load_dword v27, v4, s[68:71], s36 offen
    s_add_u32 s36, s23, 43008
    buffer_load_dword v28, v4, s[68:71], s36 offen
    s_add_u32 s36, s23, 46592
    buffer_load_dword v29, v4, s[68:71], s36 offen
    s_add_u32 s36, s23, 50176
    buffer_load_dword v30, v4, s[68:71], s36 offen
    s_add_u32 s36, s23, 53760
    buffer_load_dword v31, v4, s[68:71], s36 offen
    s_add_u32 s36, s23, 57344
    buffer_load_dword v32, v4, s[68:71], s36 offen
    s_add_u32 s36, s23, 60928
    buffer_load_dword v33, v4, s[68:71], s36 offen
    s_add_u32 s36, s23, 64512
    buffer_load_dword v34, v4, s[68:71], s36 offen
    s_add_u32 s36, s23, 68096
    buffer_load_dword v35, v4, s[68:71], s36 offen
    s_add_u32 s36, s23, 71680
    buffer_load_dword v36, v4, s[68:71], s36 offen
    s_add_u32 s36, s23, 75264
    buffer_load_dword v37, v4, s[68:71], s36 offen
    s_add_u32 s36, s23, 78848
    buffer_load_dword v38, v4, s[68:71], s36 offen
    s_add_u32 s36, s23, 82432
    buffer_load_dword v39, v4, s[68:71], s36 offen
    s_add_u32 s36, s23, 86016
    buffer_load_dword v40, v4, s[68:71], s36 offen
    s_add_u32 s36, s23, 89600
    buffer_load_dword v41, v4, s[68:71], s36 offen
    s_add_u32 s36, s23, 93184
    buffer_load_dword v42, v4, s[68:71], s36 offen
    s_add_u32 s36, s23, 96768
    buffer_load_dword v43, v4, s[68:71], s36 offen
    s_add_u32 s36, s23, 100352
    buffer_load_dword v44, v4, s[68:71], s36 offen
    s_add_u32 s36, s23, 103936
    buffer_load_dword v45, v4, s[68:71], s36 offen
    s_add_u32 s36, s23, 107520
    buffer_load_dword v46, v4, s[68:71], s36 offen
    s_add_u32 s36, s23, 111104
    buffer_load_dword v47, v4, s[68:71], s36 offen
    s_waitcnt vmcnt(0)
    v_perm_b32 v192, v17, v16, s34
    v_perm_b32 v193, v19, v18, s34
    v_perm_b32 v194, v21, v20, s34
    v_perm_b32 v195, v23, v22, s34
    v_perm_b32 v196, v25, v24, s34
    v_perm_b32 v197, v27, v26, s34
    v_perm_b32 v198, v29, v28, s34
    v_perm_b32 v199, v31, v30, s34
    v_perm_b32 v200, v33, v32, s34
    v_perm_b32 v201, v35, v34, s34
    v_perm_b32 v202, v37, v36, s34
    v_perm_b32 v203, v39, v38, s34
    v_perm_b32 v204, v41, v40, s34
    v_perm_b32 v205, v43, v42, s34
    v_perm_b32 v206, v45, v44, s34
    v_perm_b32 v207, v47, v46, s34
    v_perm_b32 v224, v17, v16, s35
    v_perm_b32 v225, v19, v18, s35
    v_perm_b32 v226, v21, v20, s35
    v_perm_b32 v227, v23, v22, s35
    v_perm_b32 v228, v25, v24, s35
    v_perm_b32 v229, v27, v26, s35
    v_perm_b32 v230, v29, v28, s35
    v_perm_b32 v231, v31, v30, s35
    v_perm_b32 v232, v33, v32, s35
    v_perm_b32 v233, v35, v34, s35
    v_perm_b32 v234, v37, v36, s35
    v_perm_b32 v235, v39, v38, s35
    v_perm_b32 v236, v41, v40, s35
    v_perm_b32 v237, v43, v42, s35
    v_perm_b32 v238, v45, v44, s35
    v_perm_b32 v239, v47, v46, s35
    s_add_u32 s36, s23, 114688
    buffer_load_dword v16, v4, s[68:71], s36 offen
    s_add_u32 s36, s23, 118272
    buffer_load_dword v17, v4, s[68:71], s36 offen
    s_add_u32 s36, s23, 121856
    buffer_load_dword v18, v4, s[68:71], s36 offen
    s_add_u32 s36, s23, 125440
    buffer_load_dword v19, v4, s[68:71], s36 offen
    s_add_u32 s36, s23, 129024
    buffer_load_dword v20, v4, s[68:71], s36 offen
    s_add_u32 s36, s23, 132608
    buffer_load_dword v21, v4, s[68:71], s36 offen
    s_add_u32 s36, s23, 136192
    buffer_load_dword v22, v4, s[68:71], s36 offen
    s_add_u32 s36, s23, 139776
    buffer_load_dword v23, v4, s[68:71], s36 offen
    s_add_u32 s36, s23, 143360
    buffer_load_dword v24, v4, s[68:71], s36 offen
    s_add_u32 s36, s23, 146944
    buffer_load_dword v25, v4, s[68:71], s36 offen
    s_add_u32 s36, s23, 150528
    buffer_load_dword v26, v4, s[68:71], s36 offen
    s_add_u32 s36, s23, 154112
    buffer_load_dword v27, v4, s[68:71], s36 offen
    s_add_u32 s36, s23, 157696
    buffer_load_dword v28, v4, s[68:71], s36 offen
    s_add_u32 s36, s23, 161280
    buffer_load_dword v29, v4, s[68:71], s36 offen
    s_add_u32 s36, s23, 164864
    buffer_load_dword v30, v4, s[68:71], s36 offen
    s_add_u32 s36, s23, 168448
    buffer_load_dword v31, v4, s[68:71], s36 offen
    s_add_u32 s36, s23, 172032
    buffer_load_dword v32, v4, s[68:71], s36 offen
    s_add_u32 s36, s23, 175616
    buffer_load_dword v33, v4, s[68:71], s36 offen
    s_add_u32 s36, s23, 179200
    buffer_load_dword v34, v4, s[68:71], s36 offen
    s_add_u32 s36, s23, 182784
    buffer_load_dword v35, v4, s[68:71], s36 offen
    s_add_u32 s36, s23, 186368
    buffer_load_dword v36, v4, s[68:71], s36 offen
    s_add_u32 s36, s23, 189952
    buffer_load_dword v37, v4, s[68:71], s36 offen
    s_add_u32 s36, s23, 193536
    buffer_load_dword v38, v4, s[68:71], s36 offen
    s_add_u32 s36, s23, 197120
    buffer_load_dword v39, v4, s[68:71], s36 offen
    s_add_u32 s36, s23, 200704
    buffer_load_dword v40, v4, s[68:71], s36 offen
    s_add_u32 s36, s23, 204288
    buffer_load_dword v41, v4, s[68:71], s36 offen
    s_add_u32 s36, s23, 207872
    buffer_load_dword v42, v4, s[68:71], s36 offen
    s_add_u32 s36, s23, 211456
    buffer_load_dword v43, v4, s[68:71], s36 offen
    s_add_u32 s36, s23, 215040
    buffer_load_dword v44, v4, s[68:71], s36 offen
    s_add_u32 s36, s23, 218624
    buffer_load_dword v45, v4, s[68:71], s36 offen
    s_add_u32 s36, s23, 222208
    buffer_load_dword v46, v4, s[68:71], s36 offen
    s_add_u32 s36, s23, 225792
    buffer_load_dword v47, v4, s[68:71], s36 offen
    s_waitcnt vmcnt(0)
    v_perm_b32 v208, v17, v16, s34
    v_perm_b32 v209, v19, v18, s34
    v_perm_b32 v210, v21, v20, s34
    v_perm_b32 v211, v23, v22, s34
    v_perm_b32 v212, v25, v24, s34
    v_perm_b32 v213, v27, v26, s34
    v_perm_b32 v214, v29, v28, s34
    v_perm_b32 v215, v31, v30, s34
    v_perm_b32 v216, v33, v32, s34
    v_perm_b32 v217, v35, v34, s34
    v_perm_b32 v218, v37, v36, s34
    v_perm_b32 v219, v39, v38, s34
    v_perm_b32 v220, v41, v40, s34
    v_perm_b32 v221, v43, v42, s34
    v_perm_b32 v222, v45, v44, s34
    v_perm_b32 v223, v47, v46, s34
    v_perm_b32 v240, v17, v16, s35
    v_perm_b32 v241, v19, v18, s35
    v_perm_b32 v242, v21, v20, s35
    v_perm_b32 v243, v23, v22, s35
    v_perm_b32 v244, v25, v24, s35
    v_perm_b32 v245, v27, v26, s35
    v_perm_b32 v246, v29, v28, s35
    v_perm_b32 v247, v31, v30, s35
    v_perm_b32 v248, v33, v32, s35
    v_perm_b32 v249, v35, v34, s35
    v_perm_b32 v250, v37, v36, s35
    v_perm_b32 v251, v39, v38, s35
    v_perm_b32 v252, v41, v40, s35
    v_perm_b32 v253, v43, v42, s35
    v_perm_b32 v254, v45, v44, s35
    v_perm_b32 v255, v47, v46, s35
    v_lshrrev_b32 v3, 3, v0
    v_mul_u32_u24 v4, 57344, v3
    v_and_b32 v3, 7, v0
    v_lshl_add_u32 v4, v3, 2, v4
    s_lshl_b32 s37, s20, 5
    s_add_u32 s36, s37, 0
    buffer_load_dword v16, v4, s[76:79], s36 offen
    s_add_u32 s36, s37, 1024
    buffer_load_dword v17, v4, s[76:79], s36 offen
    s_add_u32 s36, s37, 2048
    buffer_load_dword v18, v4, s[76:79], s36 offen
    s_add_u32 s36, s37, 3072
    buffer_load_dword v19, v4, s[76:79], s36 offen
    s_add_u32 s36, s37, 4096
    buffer_load_dword v20, v4, s[76:79], s36 offen
    s_add_u32 s36, s37, 5120
    buffer_load_dword v21, v4, s[76:79], s36 offen
    s_add_u32 s36, s37, 6144
    buffer_load_dword v22, v4, s[76:79], s36 offen
    s_add_u32 s36, s37, 7168
    buffer_load_dword v23, v4, s[76:79], s36 offen
    s_add_u32 s36, s37, 8192
    buffer_load_dword v24, v4, s[76:79], s36 offen
    s_add_u32 s36, s37, 9216
    buffer_load_dword v25, v4, s[76:79], s36 offen
    s_add_u32 s36, s37, 10240
    buffer_load_dword v26, v4, s[76:79], s36 offen
    s_add_u32 s36, s37, 11264
    buffer_load_dword v27, v4, s[76:79], s36 offen
    s_add_u32 s36, s37, 12288
    buffer_load_dword v28, v4, s[76:79], s36 offen
    s_add_u32 s36, s37, 13312
    buffer_load_dword v29, v4, s[76:79], s36 offen
    s_add_u32 s36, s37, 14336
    buffer_load_dword v30, v4, s[76:79], s36 offen
    s_add_u32 s36, s37, 15360
    buffer_load_dword v31, v4, s[76:79], s36 offen
    s_add_u32 s36, s37, 16384
    buffer_load_dword v32, v4, s[76:79], s36 offen
    s_add_u32 s36, s37, 17408
    buffer_load_dword v33, v4, s[76:79], s36 offen
    s_add_u32 s36, s37, 18432
    buffer_load_dword v34, v4, s[76:79], s36 offen
    s_add_u32 s36, s37, 19456
    buffer_load_dword v35, v4, s[76:79], s36 offen
    s_add_u32 s36, s37, 20480
    buffer_load_dword v36, v4, s[76:79], s36 offen
    s_add_u32 s36, s37, 21504
    buffer_load_dword v37, v4, s[76:79], s36 offen
    s_add_u32 s36, s37, 22528
    buffer_load_dword v38, v4, s[76:79], s36 offen
    s_add_u32 s36, s37, 23552
    buffer_load_dword v39, v4, s[76:79], s36 offen
    s_add_u32 s36, s37, 24576
    buffer_load_dword v40, v4, s[76:79], s36 offen
    s_add_u32 s36, s37, 25600
    buffer_load_dword v41, v4, s[76:79], s36 offen
    s_add_u32 s36, s37, 26624
    buffer_load_dword v42, v4, s[76:79], s36 offen
    s_add_u32 s36, s37, 27648
    buffer_load_dword v43, v4, s[76:79], s36 offen
    s_waitcnt vmcnt(0)
    v_perm_b32 v64, v17, v16, s34
    v_perm_b32 v65, v19, v18, s34
    v_perm_b32 v66, v21, v20, s34
    v_perm_b32 v67, v23, v22, s34
    v_perm_b32 v68, v25, v24, s34
    v_perm_b32 v69, v27, v26, s34
    v_perm_b32 v70, v29, v28, s34
    v_perm_b32 v71, v31, v30, s34
    v_perm_b32 v72, v33, v32, s34
    v_perm_b32 v73, v35, v34, s34
    v_perm_b32 v74, v37, v36, s34
    v_perm_b32 v75, v39, v38, s34
    v_perm_b32 v76, v41, v40, s34
    v_perm_b32 v77, v43, v42, s34
    v_perm_b32 v92, v17, v16, s35
    v_perm_b32 v93, v19, v18, s35
    v_perm_b32 v94, v21, v20, s35
    v_perm_b32 v95, v23, v22, s35
    v_perm_b32 v96, v25, v24, s35
    v_perm_b32 v97, v27, v26, s35
    v_perm_b32 v98, v29, v28, s35
    v_perm_b32 v99, v31, v30, s35
    v_perm_b32 v100, v33, v32, s35
    v_perm_b32 v101, v35, v34, s35
    v_perm_b32 v102, v37, v36, s35
    v_perm_b32 v103, v39, v38, s35
    v_perm_b32 v104, v41, v40, s35
    v_perm_b32 v105, v43, v42, s35
    s_add_u32 s36, s37, 28672
    buffer_load_dword v16, v4, s[76:79], s36 offen
    s_add_u32 s36, s37, 29696
    buffer_load_dword v17, v4, s[76:79], s36 offen
    s_add_u32 s36, s37, 30720
    buffer_load_dword v18, v4, s[76:79], s36 offen
    s_add_u32 s36, s37, 31744
    buffer_load_dword v19, v4, s[76:79], s36 offen
    s_add_u32 s36, s37, 32768
    buffer_load_dword v20, v4, s[76:79], s36 offen
    s_add_u32 s36, s37, 33792
    buffer_load_dword v21, v4, s[76:79], s36 offen
    s_add_u32 s36, s37, 34816
    buffer_load_dword v22, v4, s[76:79], s36 offen
    s_add_u32 s36, s37, 35840
    buffer_load_dword v23, v4, s[76:79], s36 offen
    s_add_u32 s36, s37, 36864
    buffer_load_dword v24, v4, s[76:79], s36 offen
    s_add_u32 s36, s37, 37888
    buffer_load_dword v25, v4, s[76:79], s36 offen
    s_add_u32 s36, s37, 38912
    buffer_load_dword v26, v4, s[76:79], s36 offen
    s_add_u32 s36, s37, 39936
    buffer_load_dword v27, v4, s[76:79], s36 offen
    s_add_u32 s36, s37, 40960
    buffer_load_dword v28, v4, s[76:79], s36 offen
    s_add_u32 s36, s37, 41984
    buffer_load_dword v29, v4, s[76:79], s36 offen
    s_add_u32 s36, s37, 43008
    buffer_load_dword v30, v4, s[76:79], s36 offen
    s_add_u32 s36, s37, 44032
    buffer_load_dword v31, v4, s[76:79], s36 offen
    s_add_u32 s36, s37, 45056
    buffer_load_dword v32, v4, s[76:79], s36 offen
    s_add_u32 s36, s37, 46080
    buffer_load_dword v33, v4, s[76:79], s36 offen
    s_add_u32 s36, s37, 47104
    buffer_load_dword v34, v4, s[76:79], s36 offen
    s_add_u32 s36, s37, 48128
    buffer_load_dword v35, v4, s[76:79], s36 offen
    s_add_u32 s36, s37, 49152
    buffer_load_dword v36, v4, s[76:79], s36 offen
    s_add_u32 s36, s37, 50176
    buffer_load_dword v37, v4, s[76:79], s36 offen
    s_add_u32 s36, s37, 51200
    buffer_load_dword v38, v4, s[76:79], s36 offen
    s_add_u32 s36, s37, 52224
    buffer_load_dword v39, v4, s[76:79], s36 offen
    s_add_u32 s36, s37, 53248
    buffer_load_dword v40, v4, s[76:79], s36 offen
    s_add_u32 s36, s37, 54272
    buffer_load_dword v41, v4, s[76:79], s36 offen
    s_add_u32 s36, s37, 55296
    buffer_load_dword v42, v4, s[76:79], s36 offen
    s_add_u32 s36, s37, 56320
    buffer_load_dword v43, v4, s[76:79], s36 offen
    s_waitcnt vmcnt(0)
    v_perm_b32 v78, v17, v16, s34
    v_perm_b32 v79, v19, v18, s34
    v_perm_b32 v80, v21, v20, s34
    v_perm_b32 v81, v23, v22, s34
    v_perm_b32 v82, v25, v24, s34
    v_perm_b32 v83, v27, v26, s34
    v_perm_b32 v84, v29, v28, s34
    v_perm_b32 v85, v31, v30, s34
    v_perm_b32 v86, v33, v32, s34
    v_perm_b32 v87, v35, v34, s34
    v_perm_b32 v88, v37, v36, s34
    v_perm_b32 v89, v39, v38, s34
    v_perm_b32 v90, v41, v40, s34
    v_perm_b32 v91, v43, v42, s34
    v_perm_b32 v106, v17, v16, s35
    v_perm_b32 v107, v19, v18, s35
    v_perm_b32 v108, v21, v20, s35
    v_perm_b32 v109, v23, v22, s35
    v_perm_b32 v110, v25, v24, s35
    v_perm_b32 v111, v27, v26, s35
    v_perm_b32 v112, v29, v28, s35
    v_perm_b32 v113, v31, v30, s35
    v_perm_b32 v114, v33, v32, s35
    v_perm_b32 v115, v35, v34, s35
    v_perm_b32 v116, v37, v36, s35
    v_perm_b32 v117, v39, v38, s35
    v_perm_b32 v118, v41, v40, s35
    v_perm_b32 v119, v43, v42, s35
    s_mov_b32 s42, 0xffff0000
    s_mov_b32 s24, 0
    s_mov_b64 s[28:29], 0
    v_mov_b32 v12, 0x40000000
    v_mov_b32 v13, 0
    v_lshlrev_b32 v3, 4, v0
L_M06_rp:
    s_mov_b32 s36, 0x19a000
    buffer_load_dwordx4 v[40:43], v3, s[8:11], s36 offen sc1
    s_add_u32 s32, s32, 1
    v_mov_b32 v5, 0
    s_waitcnt vmcnt(0)
    v_max3_u32 v5, v5, v40, v41
    v_max3_u32 v5, v5, v42, v43
    s_cmp_gt_u32 s32, 200000
    s_cbranch_scc1 L_M06_rp_ok
    v_cmp_eq_u32 vcc, -1, v5
    s_cbranch_vccz L_M06_rp_ok
    s_sleep 32
    s_branch L_M06_rp
L_M06_rp_ok:
    v_add_f32 v40, v40, v41
    v_add_f32 v42, v42, v43
    v_add_f32 v40, v40, v42
    v_cvt_pk_bf16_f32 v5, v40, v40
    v_lshlrev_b32 v40, 16, v5
    v_ashrrev_i32 v5, 31, v40
    v_or_b32 v5, 0x80000000, v5
    v_xor_b32 v5, v5, v40
    v_and_b32 v5, 0xffff0000, v5
    v_sub_u32 v6, 511, v0
    v_or_b32 v126, v5, v6
    v_lshlrev_b32 v3, 4, v0
L_M01_rp:
    s_mov_b32 s36, 0x195000
    buffer_load_dwordx4 v[20:23], v3, s[8:11], s36 offen sc1
    s_mov_b32 s36, 0x196000
    buffer_load_dwordx4 v[24:27], v3, s[8:11], s36 offen sc1
    s_mov_b32 s36, 0x197000
    buffer_load_dwordx4 v[28:31], v3, s[8:11], s36 offen sc1
    s_mov_b32 s36, 0x198000
    buffer_load_dwordx4 v[32:35], v3, s[8:11], s36 offen sc1
    s_mov_b32 s36, 0x199000
    buffer_load_dwordx4 v[36:39], v3, s[8:11], s36 offen sc1
    s_add_u32 s32, s32, 1
    v_mov_b32 v5, 0
    s_waitcnt vmcnt(0)
    v_max3_u32 v5, v5, v20, v21
    v_max3_u32 v5, v5, v22, v23
    v_max3_u32 v5, v5, v24, v25
    v_max3_u32 v5, v5, v26, v27
    v_max3_u32 v5, v5, v28, v29
    v_max3_u32 v5, v5, v30, v31
    v_max3_u32 v5, v5, v32, v33
    v_max3_u32 v5, v5, v34, v35
    v_max3_u32 v5, v5, v36, v37
    v_max3_u32 v5, v5, v38, v39
    s_cmp_gt_u32 s32, 200000
    s_cbranch_scc1 L_M01_rp_ok
    v_cmp_eq_u32 vcc, -1, v5
    s_cbranch_vccz L_M01_rp_ok
    s_sleep 8
    s_branch L_M01_rp
L_M01_rp_ok:
    v_add_f32 v20, v20, v21
    v_add_f32 v22, v22, v23
    v_add_f32 v20, v20, v22
    v_cvt_pk_bf16_f32 v5, v20, v20
    v_lshlrev_b32 v20, 16, v5
    v_ashrrev_i32 v5, 31, v20
    v_or_b32 v5, 0x80000000, v5
    v_xor_b32 v5, v5, v20
    v_and_b32 v5, 0xffff0000, v5
    v_sub_u32 v6, 1791, v0
    v_or_b32 v121, v5, v6
    v_add_f32 v24, v24, v25
    v_add_f32 v26, v26, v27
    v_add_f32 v24, v24, v26
    v_cvt_pk_bf16_f32 v5, v24, v24
    v_lshlrev_b32 v24, 16, v5
    v_ashrrev_i32 v5, 31, v24
    v_or_b32 v5, 0x80000000, v5
    v_xor_b32 v5, v5, v24
    v_and_b32 v5, 0xffff0000, v5
    v_sub_u32 v6, 1535, v0
    v_or_b32 v122, v5, v6
    v_add_f32 v28, v28, v29
    v_add_f32 v30, v30, v31
    v_add_f32 v28, v28, v30
    v_cvt_pk_bf16_f32 v5, v28, v28
    v_lshlrev_b32 v28, 16, v5
    v_ashrrev_i32 v5, 31, v28
    v_or_b32 v5, 0x80000000, v5
    v_xor_b32 v5, v5, v28
    v_and_b32 v5, 0xffff0000, v5
    v_sub_u32 v6, 1279, v0
    v_or_b32 v123, v5, v6
    v_add_f32 v32, v32, v33
    v_add_f32 v34, v34, v35
    v_add_f32 v32, v32, v34
    v_cvt_pk_bf16_f32 v5, v32, v32
    v_lshlrev_b32 v32, 16, v5
    v_ashrrev_i32 v5, 31, v32
    v_or_b32 v5, 0x80000000, v5
    v_xor_b32 v5, v5, v32
    v_and_b32 v5, 0xffff0000, v5
    v_sub_u32 v6, 1023, v0
    v_or_b32 v124, v5, v6
    v_add_f32 v36, v36, v37
    v_add_f32 v38, v38, v39
    v_add_f32 v36, v36, v38
    v_cvt_pk_bf16_f32 v5, v36, v36
    v_lshlrev_b32 v36, 16, v5
    v_ashrrev_i32 v5, 31, v36
    v_or_b32 v5, 0x80000000, v5
    v_xor_b32 v5, v5, v36
    v_and_b32 v5, 0xffff0000, v5
    v_sub_u32 v6, 767, v0
    v_or_b32 v125, v5, v6
    v_max_u32 v5, v120, v121
    v_min_u32 v6, v120, v121
    v_med3_u32 v6, v5, v6, v122
    v_max_u32 v5, v5, v122
    v_med3_u32 v6, v5, v6, v123
    v_max_u32 v5, v5, v123
    v_med3_u32 v6, v5, v6, v124
    v_max_u32 v5, v5, v124
    v_med3_u32 v6, v5, v6, v125
    v_max_u32 v5, v5, v125
    v_med3_u32 v6, v5, v6, v126
    v_max_u32 v5, v5, v126
    v_mov_b32 v120, v5
    v_mov_b32 v121, v6
    s_mov_b32 s25, 32
L_M_round:
    v_lshlrev_b32 v3, 4, v0
    v_cmp_gt_u32 s[74:75], s25, v0
L_M7_rp:
    s_mov_b32 s36, 0x19b000
    buffer_load_dwordx4 v[44:47], v3, s[8:11], s36 offen sc1
    s_add_u32 s32, s32, 1
    v_mov_b32 v5, 0
    s_waitcnt vmcnt(0)
    v_max3_u32 v5, v5, v44, v45
    v_max3_u32 v5, v5, v46, v47
    v_cndmask_b32 v5, 0, v5, s[74:75]
    s_cmp_gt_u32 s32, 200000
    s_cbranch_scc1 L_M7_rp_ok
    v_cmp_eq_u32 vcc, -1, v5
    s_cbranch_vccnz L_M7_rp
L_M7_rp_ok:
    v_add_f32 v44, v44, v45
    v_add_f32 v46, v46, v47
    v_add_f32 v44, v44, v46
    v_cvt_pk_bf16_f32 v5, v44, v44
    v_lshlrev_b32 v44, 16, v5
    v_ashrrev_i32 v5, 31, v44
    v_or_b32 v5, 0x80000000, v5
    v_xor_b32 v5, v5, v44
    v_and_b32 v5, 0xffff0000, v5
    v_sub_u32 v6, 255, v0
    v_or_b32 v127, v5, v6
    v_cndmask_b32 v127, 0, v127, s[74:75]
    v_max_u32 v5, v120, v127
    v_med3_u32 v6, v120, v121, v127
    s_nop 0
    v_mov_b32_dpp v7, v5 quad_perm:[1,0,3,2] row_mask:0xf bank_mask:0xf
    v_mov_b32_dpp v8, v6 quad_perm:[1,0,3,2] row_mask:0xf bank_mask:0xf
    v_min_u32 v9, v5, v7
    v_max_u32 v5, v5, v7
    v_max3_u32 v6, v6, v8, v9
    s_nop 0
    v_mov_b32_dpp v7, v5 quad_perm:[2,3,0,1] row_mask:0xf bank_mask:0xf
    v_mov_b32_dpp v8, v6 quad_perm:[2,3,0,1] row_mask:0xf bank_mask:0xf
    v_min_u32 v9, v5, v7
    v_max_u32 v5, v5, v7
    v_max3_u32 v6, v6, v8, v9
    s_nop 0
    v_mov_b32_dpp v7, v5 row_half_mirror row_mask:0xf bank_mask:0xf
    v_mov_b32_dpp v8, v6 row_half_mirror row_mask:0xf bank_mask:0xf
    v_min_u32 v9, v5, v7
    v_max_u32 v5, v5, v7
    v_max3_u32 v6, v6, v8, v9
    s_nop 0
    v_mov_b32_dpp v7, v5 row_mirror row_mask:0xf bank_mask:0xf
    v_mov_b32_dpp v8, v6 row_mirror row_mask:0xf bank_mask:0xf
    v_min_u32 v9, v5, v7
    v_max_u32 v5, v5, v7
    v_max3_u32 v6, v6, v8, v9
    v_lshrrev_b32 v9, 4, v0
    v_lshlrev_b32 v9, 3, v9
    s_barrier
    ds_write2_b32 v9, v5, v6 offset0:0 offset1:1
    v_and_b32 v9, 15, v0
    v_lshlrev_b32 v9, 3, v9
    s_waitcnt lgkmcnt(0)
    s_barrier
    ds_read2_b32 v[10:11], v9 offset0:0 offset1:1
    s_waitcnt lgkmcnt(0)
    v_mov_b32 v5, v10
    v_mov_b32 v6, v11
    s_nop 0
    v_mov_b32_dpp v7, v5 quad_perm:[1,0,3,2] row_mask:0xf bank_mask:0xf
    v_mov_b32_dpp v8, v6 quad_perm:[1,0,3,2] row_mask:0xf bank_mask:0xf
    v_min_u32 v9, v5, v7
    v_max_u32 v5, v5, v7
    v_max3_u32 v6, v6, v8, v9
    s_nop 0
    v_mov_b32_dpp v7, v5 quad_perm:[2,3,0,1] row_mask:0xf bank_mask:0xf
    v_mov_b32_dpp v8, v6 quad_perm:[2,3,0,1] row_mask:0xf bank_mask:0xf
    v_min_u32 v9, v5, v7
    v_max_u32 v5, v5, v7
    v_max3_u32 v6, v6, v8, v9
    s_nop 0
    v_mov_b32_dpp v7, v5 row_half_mirror row_mask:0xf bank_mask:0xf
    v_mov_b32_dpp v8, v6 row_half_mirror row_mask:0xf bank_mask:0xf
    v_min_u32 v9, v5, v7
    v_max_u32 v5, v5, v7
    v_max3_u32 v6, v6, v8, v9
    s_nop 0
    v_mov_b32_dpp v7, v5 row_mirror row_mask:0xf bank_mask:0xf
    v_mov_b32_dpp v8, v6 row_mirror row_mask:0xf bank_mask:0xf
    v_min_u32 v9, v5, v7
    v_max_u32 v5, v5, v7
    v_max3_u32 v6, v6, v8, v9
    v_readfirstlane_b32 s26, v5
    v_readfirstlane_b32 s27, v6
    s_nop 3
    s_cmp_eq_u64 s[26:27], s[28:29]
    s_cbranch_scc1 L_M_next
    s_mov_b64 s[28:29], s[26:27]
    buffer_store_dword v13, v12, s[60:63], 0 offen sc1
    s_and_b32 s36, s26, 0x7ff
    s_sub_u32 s30, 2047, s36
    s_and_b32 s36, s26, 0xffff0000
    s_xor_b32 s37, s36, 0x80000000
    s_xor_b32 s40, s36, 0xffff0000
    s_bitcmp1_b32 s36, 31
    s_cselect_b32 s40, s37, s40
    s_and_b32 s36, s27, 0x7ff
    s_sub_u32 s31, 2047, s36
    s_and_b32 s36, s27, 0xffff0000
    s_xor_b32 s37, s36, 0x80000000
    s_xor_b32 s41, s36, 0xffff0000
    s_bitcmp1_b32 s36, 31
    s_cselect_b32 s41, s37, s41
    v_mov_b32 v8, 0
L_M_rows:
    s_lshl_b32 s36, s30, 4
    s_add_u32 s36, s36, 0x1b8000
    buffer_load_dwordx4 v[16:19], v8, s[8:11], s36 offen sc1
    s_lshl_b32 s36, s31, 4
    s_add_u32 s36, s36, 0x1b8000
    buffer_load_dwordx4 v[20:23], v8, s[8:11], s36 offen sc1
    s_add_u32 s32, s32, 1
    s_cmp_gt_u32 s32, 200000
    s_waitcnt vmcnt(0)
    v_or3_b32 v5, v16, v17, v18
    v_or3_b32 v5, v5, v19, v20
    v_or3_b32 v5, v5, v21, v22
    v_or_b32 v5, v5, v23
    s_cbranch_scc1 L_M_rows_ok
    v_cmp_ne_u32 vcc, 0, v5
    s_cbranch_vccnz L_M_rows
L_M_rows_ok:
    v_bfe_u32 v9, v0, 6, 1
    v_cmp_ne_u32 vcc, 0, v9
    v_mov_b32 v5, s30
    v_mov_b32 v6, s31
    v_cndmask_b32 v7, v5, v6, vcc
    v_lshlrev_b32 v7, 10, v7
    v_and_b32 v8, 63, v0
    v_lshl_add_u32 v7, v8, 4, v7
    s_mov_b32 s37, 0x600000
    buffer_load_dwordx4 v[16:19], v7, s[8:11], s37 offen sc1
    v_bfe_u32 v9, v0, 3, 1
    v_cmp_ne_u32 vcc, 0, v9
    s_nop 1
    v_cndmask_b32 v12, v5, v6, vcc
    v_mov_b32 v5, s40
    v_mov_b32 v6, s41
    v_cndmask_b32 v11, v5, v6, vcc
    v_lshlrev_b32 v12, 10, v12
    v_and_b32 v3, 7, v0
    v_lshl_add_u32 v12, v3, 2, v12
    s_lshl_b32 s36, s20, 5
    v_add_u32 v12, s36, v12
    v_mov_b32 v7, 0x40000000
    v_cmp_lt_u32 vcc, 15, v0
    s_nop 1
    v_cndmask_b32 v12, v12, v7, vcc
    s_mov_b32 s36, 0x400000
    buffer_load_dword v14, v12, s[8:11], s36 offen sc1
    buffer_load_dword v15, v12, s[8:11], s37 offen sc1
    v_and_b32 v8, 127, v0
    v_lshlrev_b32 v8, 4, v8
    s_waitcnt vmcnt(2)
    ds_write_b128 v8, v[16:19] offset:4096
    s_waitcnt lgkmcnt(0)
    s_barrier
    v_mov_b64 v[48:49], 0
    v_mov_b64 v[50:51], 0
    v_mov_b64 v[52:53], 0
    v_mov_b64 v[54:55], 0
    v_lshlrev_b32 v8, 7, v1
    ds_read_b128 v[16:19], v8 offset:4096
    ds_read_b128 v[20:23], v8 offset:4112
    ds_read_b128 v[24:27], v8 offset:4128
    ds_read_b128 v[28:31], v8 offset:4144
    ds_read_b128 v[32:35], v8 offset:5120
    ds_read_b128 v[36:39], v8 offset:5136
    ds_read_b128 v[40:43], v8 offset:5152
    ds_read_b128 v[44:47], v8 offset:5168
    s_waitcnt lgkmcnt(0)
    v_dot2_f32_bf16 v48, v16, v128, v48
    v_dot2_f32_bf16 v49, v16, v160, v49
    v_dot2_f32_bf16 v50, v32, v128, v50
    v_dot2_f32_bf16 v51, v32, v160, v51
    v_dot2_f32_bf16 v52, v16, v192, v52
    v_dot2_f32_bf16 v53, v16, v224, v53
    v_dot2_f32_bf16 v54, v32, v192, v54
    v_dot2_f32_bf16 v55, v32, v224, v55
    v_dot2_f32_bf16 v48, v17, v129, v48
    v_dot2_f32_bf16 v49, v17, v161, v49
    v_dot2_f32_bf16 v50, v33, v129, v50
    v_dot2_f32_bf16 v51, v33, v161, v51
    v_dot2_f32_bf16 v52, v17, v193, v52
    v_dot2_f32_bf16 v53, v17, v225, v53
    v_dot2_f32_bf16 v54, v33, v193, v54
    v_dot2_f32_bf16 v55, v33, v225, v55
    v_dot2_f32_bf16 v48, v18, v130, v48
    v_dot2_f32_bf16 v49, v18, v162, v49
    v_dot2_f32_bf16 v50, v34, v130, v50
    v_dot2_f32_bf16 v51, v34, v162, v51
    v_dot2_f32_bf16 v52, v18, v194, v52
    v_dot2_f32_bf16 v53, v18, v226, v53
    v_dot2_f32_bf16 v54, v34, v194, v54
    v_dot2_f32_bf16 v55, v34, v226, v55
    v_dot2_f32_bf16 v48, v19, v131, v48
    v_dot2_f32_bf16 v49, v19, v163, v49
    v_dot2_f32_bf16 v50, v35, v131, v50
    v_dot2_f32_bf16 v51, v35, v163, v51
    v_dot2_f32_bf16 v52, v19, v195, v52
    v_dot2_f32_bf16 v53, v19, v227, v53
    v_dot2_f32_bf16 v54, v35, v195, v54
    v_dot2_f32_bf16 v55, v35, v227, v55
    v_dot2_f32_bf16 v48, v20, v132, v48
    v_dot2_f32_bf16 v49, v20, v164, v49
    v_dot2_f32_bf16 v50, v36, v132, v50
    v_dot2_f32_bf16 v51, v36, v164, v51
    v_dot2_f32_bf16 v52, v20, v196, v52
    v_dot2_f32_bf16 v53, v20, v228, v53
    v_dot2_f32_bf16 v54, v36, v196, v54
    v_dot2_f32_bf16 v55, v36, v228, v55
    v_dot2_f32_bf16 v48, v21, v133, v48
    v_dot2_f32_bf16 v49, v21, v165, v49
    v_dot2_f32_bf16 v50, v37, v133, v50
    v_dot2_f32_bf16 v51, v37, v165, v51
    v_dot2_f32_bf16 v52, v21, v197, v52
    v_dot2_f32_bf16 v53, v21, v229, v53
    v_dot2_f32_bf16 v54, v37, v197, v54
    v_dot2_f32_bf16 v55, v37, v229, v55
    v_dot2_f32_bf16 v48, v22, v134, v48
    v_dot2_f32_bf16 v49, v22, v166, v49
    v_dot2_f32_bf16 v50, v38, v134, v50
    v_dot2_f32_bf16 v51, v38, v166, v51
    v_dot2_f32_bf16 v52, v22, v198, v52
    v_dot2_f32_bf16 v53, v22, v230, v53
    v_dot2_f32_bf16 v54, v38, v198, v54
    v_dot2_f32_bf16 v55, v38, v230, v55
    v_dot2_f32_bf16 v48, v23, v135, v48
    v_dot2_f32_bf16 v49, v23, v167, v49
    v_dot2_f32_bf16 v50, v39, v135, v50
    v_dot2_f32_bf16 v51, v39, v167, v51
    v_dot2_f32_bf16 v52, v23, v199, v52
    v_dot2_f32_bf16 v53, v23, v231, v53
    v_dot2_f32_bf16 v54, v39, v199, v54
    v_dot2_f32_bf16 v55, v39, v231, v55
    v_dot2_f32_bf16 v48, v24, v136, v48
    v_dot2_f32_bf16 v49, v24, v168, v49
    v_dot2_f32_bf16 v50, v40, v136, v50
    v_dot2_f32_bf16 v51, v40, v168, v51
    v_dot2_f32_bf16 v52, v24, v200, v52
    v_dot2_f32_bf16 v53, v24, v232, v53
    v_dot2_f32_bf16 v54, v40, v200, v54
    v_dot2_f32_bf16 v55, v40, v232, v55
    v_dot2_f32_bf16 v48, v25, v137, v48
    v_dot2_f32_bf16 v49, v25, v169, v49
    v_dot2_f32_bf16 v50, v41, v137, v50
    v_dot2_f32_bf16 v51, v41, v169, v51
    v_dot2_f32_bf16 v52, v25, v201, v52
    v_dot2_f32_bf16 v53, v25, v233, v53
    v_dot2_f32_bf16 v54, v41, v201, v54
    v_dot2_f32_bf16 v55, v41, v233, v55
    v_dot2_f32_bf16 v48, v26, v138, v48
    v_dot2_f32_bf16 v49, v26, v170, v49
    v_dot2_f32_bf16 v50, v42, v138, v50
    v_dot2_f32_bf16 v51, v42, v170, v51
    v_dot2_f32_bf16 v52, v26, v202, v52
    v_dot2_f32_bf16 v53, v26, v234, v53
    v_dot2_f32_bf16 v54, v42, v202, v54
    v_dot2_f32_bf16 v55, v42, v234, v55
    v_dot2_f32_bf16 v48, v27, v139, v48
    v_dot2_f32_bf16 v49, v27, v171, v49
    v_dot2_f32_bf16 v50, v43, v139, v50
    v_dot2_f32_bf16 v51, v43, v171, v51
    v_dot2_f32_bf16 v52, v27, v203, v52
    v_dot2_f32_bf16 v53, v27, v235, v53
    v_dot2_f32_bf16 v54, v43, v203, v54
    v_dot2_f32_bf16 v55, v43, v235, v55
    v_dot2_f32_bf16 v48, v28, v140, v48
    v_dot2_f32_bf16 v49, v28, v172, v49
    v_dot2_f32_bf16 v50, v44, v140, v50
    v_dot2_f32_bf16 v51, v44, v172, v51
    v_dot2_f32_bf16 v52, v28, v204, v52
    v_dot2_f32_bf16 v53, v28, v236, v53
    v_dot2_f32_bf16 v54, v44, v204, v54
    v_dot2_f32_bf16 v55, v44, v236, v55
    v_dot2_f32_bf16 v48, v29, v141, v48
    v_dot2_f32_bf16 v49, v29, v173, v49
    v_dot2_f32_bf16 v50, v45, v141, v50
    v_dot2_f32_bf16 v51, v45, v173, v51
    v_dot2_f32_bf16 v52, v29, v205, v52
    v_dot2_f32_bf16 v53, v29, v237, v53
    v_dot2_f32_bf16 v54, v45, v205, v54
    v_dot2_f32_bf16 v55, v45, v237, v55
    v_dot2_f32_bf16 v48, v30, v142, v48
    v_dot2_f32_bf16 v49, v30, v174, v49
    v_dot2_f32_bf16 v50, v46, v142, v50
    v_dot2_f32_bf16 v51, v46, v174, v51
    v_dot2_f32_bf16 v52, v30, v206, v52
    v_dot2_f32_bf16 v53, v30, v238, v53
    v_dot2_f32_bf16 v54, v46, v206, v54
    v_dot2_f32_bf16 v55, v46, v238, v55
    v_dot2_f32_bf16 v48, v31, v143, v48
    v_dot2_f32_bf16 v49, v31, v175, v49
    v_dot2_f32_bf16 v50, v47, v143, v50
    v_dot2_f32_bf16 v51, v47, v175, v51
    v_dot2_f32_bf16 v52, v31, v207, v52
    v_dot2_f32_bf16 v53, v31, v239, v53
    v_dot2_f32_bf16 v54, v47, v207, v54
    v_dot2_f32_bf16 v55, v47, v239, v55
    ds_read_b128 v[16:19], v8 offset:4160
    ds_read_b128 v[20:23], v8 offset:4176
    ds_read_b128 v[24:27], v8 offset:4192
    ds_read_b128 v[28:31], v8 offset:4208
    ds_read_b128 v[32:35], v8 offset:5184
    ds_read_b128 v[36:39], v8 offset:5200
    ds_read_b128 v[40:43], v8 offset:5216
    ds_read_b128 v[44:47], v8 offset:5232
    s_waitcnt lgkmcnt(0)
    v_dot2_f32_bf16 v48, v16, v144, v48
    v_dot2_f32_bf16 v49, v16, v176, v49
    v_dot2_f32_bf16 v50, v32, v144, v50
    v_dot2_f32_bf16 v51, v32, v176, v51
    v_dot2_f32_bf16 v52, v16, v208, v52
    v_dot2_f32_bf16 v53, v16, v240, v53
    v_dot2_f32_bf16 v54, v32, v208, v54
    v_dot2_f32_bf16 v55, v32, v240, v55
    v_dot2_f32_bf16 v48, v17, v145, v48
    v_dot2_f32_bf16 v49, v17, v177, v49
    v_dot2_f32_bf16 v50, v33, v145, v50
    v_dot2_f32_bf16 v51, v33, v177, v51
    v_dot2_f32_bf16 v52, v17, v209, v52
    v_dot2_f32_bf16 v53, v17, v241, v53
    v_dot2_f32_bf16 v54, v33, v209, v54
    v_dot2_f32_bf16 v55, v33, v241, v55
    v_dot2_f32_bf16 v48, v18, v146, v48
    v_dot2_f32_bf16 v49, v18, v178, v49
    v_dot2_f32_bf16 v50, v34, v146, v50
    v_dot2_f32_bf16 v51, v34, v178, v51
    v_dot2_f32_bf16 v52, v18, v210, v52
    v_dot2_f32_bf16 v53, v18, v242, v53
    v_dot2_f32_bf16 v54, v34, v210, v54
    v_dot2_f32_bf16 v55, v34, v242, v55
    v_dot2_f32_bf16 v48, v19, v147, v48
    v_dot2_f32_bf16 v49, v19, v179, v49
    v_dot2_f32_bf16 v50, v35, v147, v50
    v_dot2_f32_bf16 v51, v35, v179, v51
    v_dot2_f32_bf16 v52, v19, v211, v52
    v_dot2_f32_bf16 v53, v19, v243, v53
    v_dot2_f32_bf16 v54, v35, v211, v54
    v_dot2_f32_bf16 v55, v35, v243, v55
    v_dot2_f32_bf16 v48, v20, v148, v48
    v_dot2_f32_bf16 v49, v20, v180, v49
    v_dot2_f32_bf16 v50, v36, v148, v50
    v_dot2_f32_bf16 v51, v36, v180, v51
    v_dot2_f32_bf16 v52, v20, v212, v52
    v_dot2_f32_bf16 v53, v20, v244, v53
    v_dot2_f32_bf16 v54, v36, v212, v54
    v_dot2_f32_bf16 v55, v36, v244, v55
    v_dot2_f32_bf16 v48, v21, v149, v48
    v_dot2_f32_bf16 v49, v21, v181, v49
    v_dot2_f32_bf16 v50, v37, v149, v50
    v_dot2_f32_bf16 v51, v37, v181, v51
    v_dot2_f32_bf16 v52, v21, v213, v52
    v_dot2_f32_bf16 v53, v21, v245, v53
    v_dot2_f32_bf16 v54, v37, v213, v54
    v_dot2_f32_bf16 v55, v37, v245, v55
    v_dot2_f32_bf16 v48, v22, v150, v48
    v_dot2_f32_bf16 v49, v22, v182, v49
    v_dot2_f32_bf16 v50, v38, v150, v50
    v_dot2_f32_bf16 v51, v38, v182, v51
    v_dot2_f32_bf16 v52, v22, v214, v52
    v_dot2_f32_bf16 v53, v22, v246, v53
    v_dot2_f32_bf16 v54, v38, v214, v54
    v_dot2_f32_bf16 v55, v38, v246, v55
    v_dot2_f32_bf16 v48, v23, v151, v48
    v_dot2_f32_bf16 v49, v23, v183, v49
    v_dot2_f32_bf16 v50, v39, v151, v50
    v_dot2_f32_bf16 v51, v39, v183, v51
    v_dot2_f32_bf16 v52, v23, v215, v52
    v_dot2_f32_bf16 v53, v23, v247, v53
    v_dot2_f32_bf16 v54, v39, v215, v54
    v_dot2_f32_bf16 v55, v39, v247, v55
    v_dot2_f32_bf16 v48, v24, v152, v48
    v_dot2_f32_bf16 v49, v24, v184, v49
    v_dot2_f32_bf16 v50, v40, v152, v50
    v_dot2_f32_bf16 v51, v40, v184, v51
    v_dot2_f32_bf16 v52, v24, v216, v52
    v_dot2_f32_bf16 v53, v24, v248, v53
    v_dot2_f32_bf16 v54, v40, v216, v54
    v_dot2_f32_bf16 v55, v40, v248, v55
    v_dot2_f32_bf16 v48, v25, v153, v48
    v_dot2_f32_bf16 v49, v25, v185, v49
    v_dot2_f32_bf16 v50, v41, v153, v50
    v_dot2_f32_bf16 v51, v41, v185, v51
    v_dot2_f32_bf16 v52, v25, v217, v52
    v_dot2_f32_bf16 v53, v25, v249, v53
    v_dot2_f32_bf16 v54, v41, v217, v54
    v_dot2_f32_bf16 v55, v41, v249, v55
    v_dot2_f32_bf16 v48, v26, v154, v48
    v_dot2_f32_bf16 v49, v26, v186, v49
    v_dot2_f32_bf16 v50, v42, v154, v50
    v_dot2_f32_bf16 v51, v42, v186, v51
    v_dot2_f32_bf16 v52, v26, v218, v52
    v_dot2_f32_bf16 v53, v26, v250, v53
    v_dot2_f32_bf16 v54, v42, v218, v54
    v_dot2_f32_bf16 v55, v42, v250, v55
    v_dot2_f32_bf16 v48, v27, v155, v48
    v_dot2_f32_bf16 v49, v27, v187, v49
    v_dot2_f32_bf16 v50, v43, v155, v50
    v_dot2_f32_bf16 v51, v43, v187, v51
    v_dot2_f32_bf16 v52, v27, v219, v52
    v_dot2_f32_bf16 v53, v27, v251, v53
    v_dot2_f32_bf16 v54, v43, v219, v54
    v_dot2_f32_bf16 v55, v43, v251, v55
    v_dot2_f32_bf16 v48, v28, v156, v48
    v_dot2_f32_bf16 v49, v28, v188, v49
    v_dot2_f32_bf16 v50, v44, v156, v50
    v_dot2_f32_bf16 v51, v44, v188, v51
    v_dot2_f32_bf16 v52, v28, v220, v52
    v_dot2_f32_bf16 v53, v28, v252, v53
    v_dot2_f32_bf16 v54, v44, v220, v54
    v_dot2_f32_bf16 v55, v44, v252, v55
    v_dot2_f32_bf16 v48, v29, v157, v48
    v_dot2_f32_bf16 v49, v29, v189, v49
    v_dot2_f32_bf16 v50, v45, v157, v50
    v_dot2_f32_bf16 v51, v45, v189, v51
    v_dot2_f32_bf16 v52, v29, v221, v52
    v_dot2_f32_bf16 v53, v29, v253, v53
    v_dot2_f32_bf16 v54, v45, v221, v54
    v_dot2_f32_bf16 v55, v45, v253, v55
    v_dot2_f32_bf16 v48, v30, v158, v48
    v_dot2_f32_bf16 v49, v30, v190, v49
    v_dot2_f32_bf16 v50, v46, v158, v50
    v_dot2_f32_bf16 v51, v46, v190, v51
    v_dot2_f32_bf16 v52, v30, v222, v52
    v_dot2_f32_bf16 v53, v30, v254, v53
    v_dot2_f32_bf16 v54, v46, v222, v54
    v_dot2_f32_bf16 v55, v46, v254, v55
    v_dot2_f32_bf16 v48, v31, v159, v48
    v_dot2_f32_bf16 v49, v31, v191, v49
    v_dot2_f32_bf16 v50, v47, v159, v50
    v_dot2_f32_bf16 v51, v47, v191, v51
    v_dot2_f32_bf16 v52, v31, v223, v52
    v_dot2_f32_bf16 v53, v31, v255, v53
    v_dot2_f32_bf16 v54, v47, v223, v54
    v_dot2_f32_bf16 v55, v47, v255, v55
    s_nop 3
    v_lshlrev_b32 v7, 5, v0
    ds_write_b128 v7, v[48:51] offset:8192
    ds_write_b128 v7, v[52:55] offset:8208
    s_waitcnt lgkmcnt(0)
    s_barrier
    v_lshlrev_b32 v7, 5, v2
    v_bfe_u32 v8, v0, 5, 1
    v_lshl_add_u32 v7, v8, 3, v7
    ds_read_b64 v[16:17], v7 offset:8192
    ds_read_b64 v[18:19], v7 offset:8208
    ds_read_b64 v[20:21], v7 offset:9216
    ds_read_b64 v[22:23], v7 offset:9232
    ds_read_b64 v[24:25], v7 offset:10240
    ds_read_b64 v[26:27], v7 offset:10256
    ds_read_b64 v[28:29], v7 offset:11264
    ds_read_b64 v[30:31], v7 offset:11280
    s_waitcnt lgkmcnt(0)
    ds_read_b64 v[32:33], v7 offset:12288
    ds_read_b64 v[34:35], v7 offset:12304
    ds_read_b64 v[36:37], v7 offset:13312
    ds_read_b64 v[38:39], v7 offset:13328
    ds_read_b64 v[40:41], v7 offset:14336
    ds_read_b64 v[42:43], v7 offset:14352
    ds_read_b64 v[44:45], v7 offset:15360
    ds_read_b64 v[46:47], v7 offset:15376
    s_waitcnt lgkmcnt(0)
    v_add_f32 v16, v16, v20
    v_add_f32 v16, v16, v24
    v_add_f32 v16, v16, v28
    v_add_f32 v16, v16, v32
    v_add_f32 v16, v16, v36
    v_add_f32 v16, v16, v40
    v_add_f32 v16, v16, v44
    v_cvt_pk_bf16_f32 v5, v16, v16
    v_lshlrev_b32 v16, 16, v5
    v_add_f32 v17, v17, v21
    v_add_f32 v17, v17, v25
    v_add_f32 v17, v17, v29
    v_add_f32 v17, v17, v33
    v_add_f32 v17, v17, v37
    v_add_f32 v17, v17, v41
    v_add_f32 v17, v17, v45
    v_cvt_pk_bf16_f32 v5, v17, v17
    v_lshlrev_b32 v17, 16, v5
    v_add_f32 v18, v18, v22
    v_add_f32 v18, v18, v26
    v_add_f32 v18, v18, v30
    v_add_f32 v18, v18, v34
    v_add_f32 v18, v18, v38
    v_add_f32 v18, v18, v42
    v_add_f32 v18, v18, v46
    v_cvt_pk_bf16_f32 v5, v18, v18
    v_lshlrev_b32 v18, 16, v5
    v_add_f32 v19, v19, v23
    v_add_f32 v19, v19, v27
    v_add_f32 v19, v19, v31
    v_add_f32 v19, v19, v35
    v_add_f32 v19, v19, v39
    v_add_f32 v19, v19, v43
    v_add_f32 v19, v19, v47
    v_cvt_pk_bf16_f32 v5, v19, v19
    v_lshlrev_b32 v19, 16, v5
    v_mul_f32 v6, 0xbfb8aa3b, v16
    v_exp_f32 v6, v6
    s_nop 0
    v_add_f32 v6, 1.0, v6
    v_rcp_f32 v6, v6
    s_nop 0
    v_mul_f32 v16, v16, v6
    v_cvt_pk_bf16_f32 v5, v16, v16
    v_lshlrev_b32 v16, 16, v5
    v_mul_f32 v16, v16, v18
    v_mul_f32 v6, 0xbfb8aa3b, v17
    v_exp_f32 v6, v6
    s_nop 0
    v_add_f32 v6, 1.0, v6
    v_rcp_f32 v6, v6
    s_nop 0
    v_mul_f32 v17, v17, v6
    v_cvt_pk_bf16_f32 v5, v17, v17
    v_lshlrev_b32 v17, 16, v5
    v_mul_f32 v17, v17, v19
    v_cvt_pk_bf16_f32 v16, v16, v17
    v_mul_u32_u24 v8, 3584, v8
    v_lshl_add_u32 v7, v2, 2, v8
    v_mov_b32 v6, 0x40000000
    v_cmp_lt_u32 vcc, 27, v2
    s_nop 1
    v_cndmask_b32 v7, v7, v6, vcc
    v_cmp_lt_u32 vcc, 63, v0
    s_nop 1
    v_cndmask_b32 v7, v7, v6, vcc
    s_mul_i32 s37, s24, 8192
    s_add_u32 s37, s37, 0x1b0000
    s_add_u32 s36, s37, s23
    buffer_store_dword v16, v7, s[8:11], s36 offen sc1
    v_lshlrev_b32 v7, 4, v0
    v_add_u32 v8, 4096, v7
    v_cmp_lt_u32 vcc, 191, v0
    s_nop 1
    v_cndmask_b32 v8, v8, v6, vcc
L_M_act:
    buffer_load_dwordx4 v[20:23], v7, s[8:11], s37 offen sc1
    buffer_load_dwordx4 v[24:27], v8, s[8:11], s37 offen sc1
    s_add_u32 s32, s32, 1
    s_cmp_gt_u32 s32, 200000
    s_waitcnt vmcnt(0)
    v_max3_u32 v5, v20, v21, v22
    v_max3_u32 v5, v5, v23, v24
    v_max3_u32 v5, v5, v25, v26
    v_max_u32 v5, v5, v27
    s_cbranch_scc1 L_M_act_ok
    v_cmp_eq_u32 vcc, -1, v5
    s_cbranch_vccnz L_M_act
L_M_act_ok:
    ds_write_b128 v7, v[20:23] offset:16384
    ds_write_b128 v7, v[24:27] offset:20480
    s_waitcnt lgkmcnt(0)
    s_barrier
    v_lshrrev_b32 v7, 3, v0
    v_mul_u32_u24 v7, 112, v7
    v_mov_b64 v[48:49], 0
    v_mov_b64 v[50:51], 0
    ds_read_b128 v[16:19], v7 offset:16384
    ds_read_b128 v[20:23], v7 offset:16400
    ds_read_b128 v[24:27], v7 offset:16416
    ds_read_b128 v[28:31], v7 offset:16432
    ds_read_b128 v[32:35], v7 offset:16448
    ds_read_b128 v[36:39], v7 offset:16464
    ds_read_b128 v[40:43], v7 offset:16480
    s_waitcnt lgkmcnt(0)
    v_dot2_f32_bf16 v48, v16, v64, v48
    v_dot2_f32_bf16 v49, v16, v92, v49
    v_dot2_f32_bf16 v48, v17, v65, v48
    v_dot2_f32_bf16 v49, v17, v93, v49
    v_dot2_f32_bf16 v48, v18, v66, v48
    v_dot2_f32_bf16 v49, v18, v94, v49
    v_dot2_f32_bf16 v48, v19, v67, v48
    v_dot2_f32_bf16 v49, v19, v95, v49
    v_dot2_f32_bf16 v48, v20, v68, v48
    v_dot2_f32_bf16 v49, v20, v96, v49
    v_dot2_f32_bf16 v48, v21, v69, v48
    v_dot2_f32_bf16 v49, v21, v97, v49
    v_dot2_f32_bf16 v48, v22, v70, v48
    v_dot2_f32_bf16 v49, v22, v98, v49
    v_dot2_f32_bf16 v48, v23, v71, v48
    v_dot2_f32_bf16 v49, v23, v99, v49
    v_dot2_f32_bf16 v48, v24, v72, v48
    v_dot2_f32_bf16 v49, v24, v100, v49
    v_dot2_f32_bf16 v48, v25, v73, v48
    v_dot2_f32_bf16 v49, v25, v101, v49
    v_dot2_f32_bf16 v48, v26, v74, v48
    v_dot2_f32_bf16 v49, v26, v102, v49
    v_dot2_f32_bf16 v48, v27, v75, v48
    v_dot2_f32_bf16 v49, v27, v103, v49
    v_dot2_f32_bf16 v48, v28, v76, v48
    v_dot2_f32_bf16 v49, v28, v104, v49
    v_dot2_f32_bf16 v48, v29, v77, v48
    v_dot2_f32_bf16 v49, v29, v105, v49
    v_dot2_f32_bf16 v48, v30, v78, v48
    v_dot2_f32_bf16 v49, v30, v106, v49
    v_dot2_f32_bf16 v48, v31, v79, v48
    v_dot2_f32_bf16 v49, v31, v107, v49
    v_dot2_f32_bf16 v48, v32, v80, v48
    v_dot2_f32_bf16 v49, v32, v108, v49
    v_dot2_f32_bf16 v48, v33, v81, v48
    v_dot2_f32_bf16 v49, v33, v109, v49
    v_dot2_f32_bf16 v48, v34, v82, v48
    v_dot2_f32_bf16 v49, v34, v110, v49
    v_dot2_f32_bf16 v48, v35, v83, v48
    v_dot2_f32_bf16 v49, v35, v111, v49
    v_dot2_f32_bf16 v48, v36, v84, v48
    v_dot2_f32_bf16 v49, v36, v112, v49
    v_dot2_f32_bf16 v48, v37, v85, v48
    v_dot2_f32_bf16 v49, v37, v113, v49
    v_dot2_f32_bf16 v48, v38, v86, v48
    v_dot2_f32_bf16 v49, v38, v114, v49
    v_dot2_f32_bf16 v48, v39, v87, v48
    v_dot2_f32_bf16 v49, v39, v115, v49
    v_dot2_f32_bf16 v48, v40, v88, v48
    v_dot2_f32_bf16 v49, v40, v116, v49
    v_dot2_f32_bf16 v48, v41, v89, v48
    v_dot2_f32_bf16 v49, v41, v117, v49
    v_dot2_f32_bf16 v48, v42, v90, v48
    v_dot2_f32_bf16 v49, v42, v118, v49
    v_dot2_f32_bf16 v48, v43, v91, v48
    v_dot2_f32_bf16 v49, v43, v119, v49
    ds_read_b128 v[16:19], v7 offset:19968
    ds_read_b128 v[20:23], v7 offset:19984
    ds_read_b128 v[24:27], v7 offset:20000
    ds_read_b128 v[28:31], v7 offset:20016
    ds_read_b128 v[32:35], v7 offset:20032
    ds_read_b128 v[36:39], v7 offset:20048
    ds_read_b128 v[40:43], v7 offset:20064
    s_waitcnt lgkmcnt(0)
    v_dot2_f32_bf16 v50, v16, v64, v50
    v_dot2_f32_bf16 v51, v16, v92, v51
    v_dot2_f32_bf16 v50, v17, v65, v50
    v_dot2_f32_bf16 v51, v17, v93, v51
    v_dot2_f32_bf16 v50, v18, v66, v50
    v_dot2_f32_bf16 v51, v18, v94, v51
    v_dot2_f32_bf16 v50, v19, v67, v50
    v_dot2_f32_bf16 v51, v19, v95, v51
    v_dot2_f32_bf16 v50, v20, v68, v50
    v_dot2_f32_bf16 v51, v20, v96, v51
    v_dot2_f32_bf16 v50, v21, v69, v50
    v_dot2_f32_bf16 v51, v21, v97, v51
    v_dot2_f32_bf16 v50, v22, v70, v50
    v_dot2_f32_bf16 v51, v22, v98, v51
    v_dot2_f32_bf16 v50, v23, v71, v50
    v_dot2_f32_bf16 v51, v23, v99, v51
    v_dot2_f32_bf16 v50, v24, v72, v50
    v_dot2_f32_bf16 v51, v24, v100, v51
    v_dot2_f32_bf16 v50, v25, v73, v50
    v_dot2_f32_bf16 v51, v25, v101, v51
    v_dot2_f32_bf16 v50, v26, v74, v50
    v_dot2_f32_bf16 v51, v26, v102, v51
    v_dot2_f32_bf16 v50, v27, v75, v50
    v_dot2_f32_bf16 v51, v27, v103, v51
    v_dot2_f32_bf16 v50, v28, v76, v50
    v_dot2_f32_bf16 v51, v28, v104, v51
    v_dot2_f32_bf16 v50, v29, v77, v50
    v_dot2_f32_bf16 v51, v29, v105, v51
    v_dot2_f32_bf16 v50, v30, v78, v50
    v_dot2_f32_bf16 v51, v30, v106, v51
    v_dot2_f32_bf16 v50, v31, v79, v50
    v_dot2_f32_bf16 v51, v31, v107, v51
    v_dot2_f32_bf16 v50, v32, v80, v50
    v_dot2_f32_bf16 v51, v32, v108, v51
    v_dot2_f32_bf16 v50, v33, v81, v50
    v_dot2_f32_bf16 v51, v33, v109, v51
    v_dot2_f32_bf16 v50, v34, v82, v50
    v_dot2_f32_bf16 v51, v34, v110, v51
    v_dot2_f32_bf16 v50, v35, v83, v50
    v_dot2_f32_bf16 v51, v35, v111, v51
    v_dot2_f32_bf16 v50, v36, v84, v50
    v_dot2_f32_bf16 v51, v36, v112, v51
    v_dot2_f32_bf16 v50, v37, v85, v50
    v_dot2_f32_bf16 v51, v37, v113, v51
    v_dot2_f32_bf16 v50, v38, v86, v50
    v_dot2_f32_bf16 v51, v38, v114, v51
    v_dot2_f32_bf16 v50, v39, v87, v50
    v_dot2_f32_bf16 v51, v39, v115, v51
    v_dot2_f32_bf16 v50, v40, v88, v50
    v_dot2_f32_bf16 v51, v40, v116, v51
    v_dot2_f32_bf16 v50, v41, v89, v50
    v_dot2_f32_bf16 v51, v41, v117, v51
    v_dot2_f32_bf16 v50, v42, v90, v50
    v_dot2_f32_bf16 v51, v42, v118, v51
    v_dot2_f32_bf16 v50, v43, v91, v50
    v_dot2_f32_bf16 v51, v43, v119, v51
    s_nop 3
    v_add_f32_dpp v48, v48, v48 row_ror:8 row_mask:0xf bank_mask:0xf
    v_add_f32_dpp v49, v49, v49 row_ror:8 row_mask:0xf bank_mask:0xf
    v_add_f32_dpp v50, v50, v50 row_ror:8 row_mask:0xf bank_mask:0xf
    v_add_f32_dpp v51, v51, v51 row_ror:8 row_mask:0xf bank_mask:0xf
    v_mov_b32 v5, v48
    s_nop 1
    v_permlane16_swap_b32 v48, v5
    v_add_f32 v48, v48, v5
    v_mov_b32 v5, v49
    s_nop 1
    v_permlane16_swap_b32 v49, v5
    v_add_f32 v49, v49, v5
    v_mov_b32 v5, v50
    s_nop 1
    v_permlane16_swap_b32 v50, v5
    v_add_f32 v50, v50, v5
    v_mov_b32 v5, v51
    s_nop 1
    v_permlane16_swap_b32 v51, v5
    v_add_f32 v51, v51, v5
    v_mov_b32 v5, v48
    s_nop 1
    v_permlane32_swap_b32 v48, v5
    v_add_f32 v48, v48, v5
    v_mov_b32 v5, v49
    s_nop 1
    v_permlane32_swap_b32 v49, v5
    v_add_f32 v49, v49, v5
    v_mov_b32 v5, v50
    s_nop 1
    v_permlane32_swap_b32 v50, v5
    v_add_f32 v50, v50, v5
    v_mov_b32 v5, v51
    s_nop 1
    v_permlane32_swap_b32 v51, v5
    v_add_f32 v51, v51, v5
    v_lshrrev_b32 v7, 6, v0
    v_lshlrev_b32 v7, 7, v7
    v_lshl_add_u32 v7, v3, 4, v7
    ds_write_b128 v7, v[48:51] offset:1024
    s_waitcnt lgkmcnt(0)
    s_barrier
    v_lshlrev_b32 v7, 4, v3
    v_lshl_add_u32 v7, v9, 3, v7
    ds_read_b64 v[16:17], v7 offset:1024
    ds_read_b64 v[18:19], v7 offset:1152
    ds_read_b64 v[20:21], v7 offset:1280
    ds_read_b64 v[22:23], v7 offset:1408
    v_mul_f32 v10, 0xbfb8aa3b, v11
    v_exp_f32 v10, v10
    s_nop 0
    v_add_f32 v10, 1.0, v10
    v_rcp_f32 v10, v10
    s_nop 0
    v_cvt_pk_bf16_f32 v5, v10, v10
    v_lshlrev_b32 v10, 16, v5
    s_waitcnt lgkmcnt(0)
    v_lshlrev_b32 v24, 16, v15
    v_and_b32 v25, 0xffff0000, v15
    v_lshlrev_b32 v26, 16, v14
    v_and_b32 v27, 0xffff0000, v14
    v_add_f32 v16, v16, v18
    v_add_f32 v20, v20, v22
    v_add_f32 v16, v16, v20
    v_cvt_pk_bf16_f32 v5, v16, v16
    v_lshlrev_b32 v16, 16, v5
    v_mul_f32 v16, v16, v10
    v_cvt_pk_bf16_f32 v5, v16, v16
    v_lshlrev_b32 v16, 16, v5
    v_add_f32 v16, v16, v24
    v_cvt_pk_bf16_f32 v5, v16, v16
    v_lshlrev_b32 v16, 16, v5
    v_add_f32 v16, v16, v26
    v_add_f32 v17, v17, v19
    v_add_f32 v21, v21, v23
    v_add_f32 v17, v17, v21
    v_cvt_pk_bf16_f32 v5, v17, v17
    v_lshlrev_b32 v17, 16, v5
    v_mul_f32 v17, v17, v10
    v_cvt_pk_bf16_f32 v5, v17, v17
    v_lshlrev_b32 v17, 16, v5
    v_add_f32 v17, v17, v25
    v_cvt_pk_bf16_f32 v5, v17, v17
    v_lshlrev_b32 v17, 16, v5
    v_add_f32 v17, v17, v27
    v_cvt_pk_bf16_f32 v16, v16, v17
    buffer_store_dword v16, v12, s[60:63], 0 offen sc1
    v_add_f32 v24, v24, v26
    v_add_f32 v25, v25, v27
    v_cvt_pk_bf16_f32 v13, v24, v25
L_M_next:
    s_add_u32 s24, s24, 1
    s_mov_b32 s25, 192
    s_cmp_eq_u32 s24, 1
    s_cbranch_scc1 L_M_round
    s_cmp_eq_u32 s24, 3
    s_cbranch_scc1 L_end
    s_mov_b32 s25, 256
    v_and_b32 v7, 63, v0
    v_lshlrev_b32 v3, 4, v7
    s_mov_b32 s36, 0x19bc00
    v_sub_u32 v7, 63, v7
L_M_fin:
    buffer_load_dwordx4 v[16:19], v3, s[8:11], s36 offen sc1
    s_add_u32 s32, s32, 1
    s_cmp_gt_u32 s32, 200000
    s_cselect_b32 s37, -1, -2
    s_waitcnt vmcnt(0)
    v_max3_u32 v5, v16, v17, v18
    v_max_u32 v5, v5, v19
    v_cmp_lt_u32 vcc, s37, v5
    s_cbranch_vccnz L_M_fin
    v_add_f32 v16, v16, v17
    v_add_f32 v18, v18, v19
    v_add_f32 v16, v16, v18
    v_cvt_pk_bf16_f32 v5, v16, v16
    v_lshlrev_b32 v16, 16, v5
    v_ashrrev_i32 v5, 31, v16
    v_or_b32 v5, 0x80000000, v5
    v_xor_b32 v5, v5, v16
    v_and_or_b32 v5, v5, s42, v7
    v_cmp_lt_u32 vcc, s29, v5
    s_cbranch_vccnz L_M_round
L_end:
    s_endpgm
.section .rodata,"a"
.p2align 6
.amdhsa_kernel sequential_preLN__memory_aug_recurrent_mem_tr__moe_arch_mod__prompt_kernel
  .amdhsa_next_free_vgpr 512
  .amdhsa_next_free_sgpr 102
  .amdhsa_accum_offset 256
  .amdhsa_group_segment_fixed_size 0
  .amdhsa_kernarg_size 120
  .amdhsa_user_sgpr_count 2
  .amdhsa_user_sgpr_kernarg_segment_ptr 1
  .amdhsa_system_sgpr_workgroup_id_x 1
.end_amdhsa_kernel
```
